```python
import torch

def _softmax(x, axis=-1):
    return torch.softmax(x, dim=axis)
def _gelu(x):
    return torch.nn.functional.gelu(x, approximate="tanh")
def _silu(x):
    return torch.nn.functional.silu(x)
def _sigmoid(x):
    return torch.sigmoid(x)
def _layernorm(x, axis=-1, eps=1e-5):
    m = x.mean(dim=axis, keepdim=True)
    v = x.var(dim=axis, keepdim=True, unbiased=False)
    return (x - m) / torch.sqrt(v + eps)
def _scatter_add(tgt, idx, src, axis=0):
    return tgt.clone().index_add_(axis, idx, src)
def _segment_sum(src, seg, n):
    out = torch.zeros((n,) + src.shape[1:], dtype=src.dtype)
    return out.index_add_(0, seg, src)
def _pad(x, pw):
    flat = tuple(v for pair in reversed(pw) for v in pair)
    return torch.nn.functional.pad(x, flat)

kernel_name = 'standalone__molecular_angular_gemnet__graph'

def setup_inputs():

    _w = (lambda a: (lambda t: t.to(torch.bfloat16) if t.is_floating_point() else t)(torch.as_tensor(a)))
    N, deg, De, L = 12500, 64, 4, 1
    E = N * deg
    T = E * deg
    NR = 8
    dist = torch.rand(E).to(float)
    angle = (torch.rand(T) * torch.pi).to(float)
    centers = torch.linspace(0.0, 1.0, NR).to(float)
    ang_freq = torch.arange(1, L + 1).to(float)
    return {
        "m": _w((lambda *s: torch.randn(*s, dtype=torch.bfloat16) * 0.05)(E, De)),
        "idx_in": _w((lambda lo, hi, *s: torch.randint(lo, hi, s))(0, E, T).to(torch.int64)),
        "idx_out": _w((lambda lo, hi, *s: torch.randint(lo, hi, s))(0, E, T).to(torch.int64)),
        "dist": _w(dist),
        "angle": _w(angle),
        "centers": _w(centers),
        "ang_freq": _w(ang_freq),
        "w_rbf": _w((lambda *s: torch.randn(*s, dtype=torch.bfloat16) * 0.2)(NR, De)),
        "w_sbf": _w((lambda *s: torch.randn(*s, dtype=torch.bfloat16) * 0.2)(NR * L, De)),
        "w_down": _w((lambda *s: torch.randn(*s, dtype=torch.bfloat16) * 0.2)(De, De)),
        "w_up": _w((lambda *s: torch.randn(*s, dtype=torch.bfloat16) * 0.2)(De, De)),
    }

def reference(m, idx_in, idx_out, dist, angle, centers, ang_freq, w_rbf, w_sbf, w_down, w_up):
    E, De = m.shape[0], m.shape[1]
    NR = centers.shape[0]
    L = ang_freq.shape[0]
    rbf = torch.exp(-10.0 * (dist[:, None] - centers[None, :]) ** 2)
    cbf = torch.cos(ang_freq[None, :] * angle[:, None])
    rbf_t = rbf[idx_out]
    sbf = torch.reshape(rbf_t[:, :, None] * cbf[:, None, :], (-1, NR * L))
    x = (m[idx_in] @ w_down) * (sbf @ w_sbf)
    agg = _segment_sum(x, idx_out, E)
    return m + (agg @ w_up) * (rbf @ w_rbf)
```

```asm
; @launch kernel=g0_kernel grid=(256,1,1) block=(256,1,1) lds=0
; @launch kernel=g1_kernel grid=(256,1,1) block=(1024,1,1) lds=163840
; @launch kernel=g2_kernel grid=(256,1,1) block=(1024,1,1) lds=161520
; @launch kernel=standalone__molecular_angular_gemnet__graph_kernel grid=(3125,1,1) block=(256,1,1) lds=0
.amdgcn_target "amdgcn-amd-amdhsa--gfx950"
.text
.globl g0_kernel
.p2align 8
.type g0_kernel,@function
g0_kernel:
    s_cmp_ge_u32 s2, 256
    s_cbranch_scc1 L_k0done_1
    s_load_dwordx2 s[4:5], s[0:1], 0
    s_load_dwordx2 s[6:7], s[0:1], 104
    s_mul_i32 s3, s2, 25000
    v_lshlrev_b32 v1, 4, v0
    s_waitcnt lgkmcnt(0)

    s_add_u32 s8, s4, s3
    s_addc_u32 s9, s5, 0
    s_mov_b32 s10, 25000
    s_mov_b32 s11, 0x20000
    s_mov_b32 s12, s6
    s_mov_b32 s13, s7
    s_mov_b32 s14, 131328
    s_mov_b32 s15, 0x20000
    s_add_u32 s16, s6, 135168
    s_addc_u32 s17, s7, 0
    s_mov_b32 s18, 4096
    s_mov_b32 s19, 0x20000
    s_movk_i32 s20, 0
    buffer_load_dwordx4 v[4:7], v1, s[8:11], s20 offen
    s_movk_i32 s20, 4096
    buffer_load_dwordx4 v[8:11], v1, s[8:11], s20 offen
    s_movk_i32 s20, 8192
    buffer_load_dwordx4 v[12:15], v1, s[8:11], s20 offen
    s_movk_i32 s20, 12288
    buffer_load_dwordx4 v[16:19], v1, s[8:11], s20 offen
    s_movk_i32 s20, 16384
    buffer_load_dwordx4 v[20:23], v1, s[8:11], s20 offen
    s_movk_i32 s20, 20480
    buffer_load_dwordx4 v[24:27], v1, s[8:11], s20 offen
    s_movk_i32 s20, 24576
    buffer_load_dwordx4 v[28:31], v1, s[8:11], s20 offen
    s_lshl_b32 s21, s2, 12
    v_add_u32 v2, s21, v1
    v_mov_b32 v32, 0
    v_mov_b32 v33, 0
    v_mov_b32 v34, 0
    v_mov_b32 v35, 0
    buffer_store_dwordx4 v[32:35], v2, s[12:15], 0 offen
    s_mov_b32 s22, 0x7fff7fff
    s_waitcnt vmcnt(1)

    v_and_b32 v4, s22, v4
    v_and_b32 v5, s22, v5
    v_and_b32 v6, s22, v6
    v_and_b32 v7, s22, v7
    v_and_b32 v8, s22, v8
    v_and_b32 v9, s22, v9
    v_and_b32 v10, s22, v10
    v_and_b32 v11, s22, v11
    v_and_b32 v12, s22, v12
    v_and_b32 v13, s22, v13
    v_and_b32 v14, s22, v14
    v_and_b32 v15, s22, v15
    v_and_b32 v16, s22, v16
    v_and_b32 v17, s22, v17
    v_and_b32 v18, s22, v18
    v_and_b32 v19, s22, v19
    v_and_b32 v20, s22, v20
    v_and_b32 v21, s22, v21
    v_and_b32 v22, s22, v22
    v_and_b32 v23, s22, v23
    v_and_b32 v24, s22, v24
    v_and_b32 v25, s22, v25
    v_and_b32 v26, s22, v26
    v_and_b32 v27, s22, v27
    v_and_b32 v28, s22, v28
    v_and_b32 v29, s22, v29
    v_and_b32 v30, s22, v30
    v_and_b32 v31, s22, v31
    v_pk_max_u16 v4, v4, v5
    v_pk_max_u16 v4, v4, v6
    v_pk_max_u16 v4, v4, v7
    v_pk_max_u16 v4, v4, v8
    v_pk_max_u16 v4, v4, v9
    v_pk_max_u16 v4, v4, v10
    v_pk_max_u16 v4, v4, v11
    v_pk_max_u16 v4, v4, v12
    v_pk_max_u16 v4, v4, v13
    v_pk_max_u16 v4, v4, v14
    v_pk_max_u16 v4, v4, v15
    v_pk_max_u16 v4, v4, v16
    v_pk_max_u16 v4, v4, v17
    v_pk_max_u16 v4, v4, v18
    v_pk_max_u16 v4, v4, v19
    v_pk_max_u16 v4, v4, v20
    v_pk_max_u16 v4, v4, v21
    v_pk_max_u16 v4, v4, v22
    v_pk_max_u16 v4, v4, v23
    v_pk_max_u16 v4, v4, v24
    v_pk_max_u16 v4, v4, v25
    v_pk_max_u16 v4, v4, v26
    v_pk_max_u16 v4, v4, v27
    v_pk_max_u16 v4, v4, v28
    v_pk_max_u16 v4, v4, v29
    v_pk_max_u16 v4, v4, v30
    v_pk_max_u16 v4, v4, v31
    v_lshrrev_b32 v5, 16, v4
    v_and_b32 v4, 0xffff, v4
    v_max_u32 v4, v4, v5

    s_nop 1
    v_max_u32_dpp v4, v4, v4 row_shr:1 row_mask:0xf bank_mask:0xf
    s_nop 1
    v_max_u32_dpp v4, v4, v4 row_shr:2 row_mask:0xf bank_mask:0xf
    s_nop 1
    v_max_u32_dpp v4, v4, v4 row_shr:4 row_mask:0xf bank_mask:0xf
    s_nop 1
    v_max_u32_dpp v4, v4, v4 row_shr:8 row_mask:0xf bank_mask:0xf
    s_nop 1
    v_max_u32_dpp v4, v4, v4 row_bcast:15 row_mask:0xa bank_mask:0xf
    s_nop 1
    v_max_u32_dpp v4, v4, v4 row_bcast:31 row_mask:0xc bank_mask:0xf
    v_lshrrev_b32 v6, 6, v0
    s_lshl_b32 s21, s2, 2
    v_add_lshl_u32 v6, v6, s21, 2
    v_and_b32 v7, 63, v0
    v_cmp_eq_u32 vcc, 63, v7
    s_and_saveexec_b64 s[24:25], vcc
    buffer_store_dword v4, v6, s[16:19], 0 offen
L_k0done_1:
    s_endpgm

.globl g1_kernel
.p2align 8
.type g1_kernel,@function
g1_kernel:
    s_cmp_ge_u32 s2, 256
    s_cbranch_scc1 L_p1done_2
    s_load_dwordx4 s[68:71], s[0:1], 8
    s_load_dwordx2 s[72:73], s[0:1], 32
    s_load_dwordx2 s[74:75], s[0:1], 48
    s_load_dwordx2 s[6:7], s[0:1], 104
    v_lshlrev_b32 v1, 4, v0
    v_lshlrev_b32 v2, 3, v0
    v_lshlrev_b32 v3, 2, v0
    s_mul_i32 s3, s2, 800000
    s_mul_i32 s4, s2, 400000
    s_waitcnt lgkmcnt(0)
    s_load_dword s76, s[74:75], 0

    s_add_u32 s8, s68, s3
    s_addc_u32 s9, s69, 0
    s_mov_b32 s10, 72960
    s_mov_b32 s11, 0x20000
    s_add_u32 s12, s70, s3
    s_addc_u32 s13, s71, 0
    s_mov_b32 s14, 72960
    s_mov_b32 s15, 0x20000
    s_add_u32 s16, s72, s4
    s_addc_u32 s17, s73, 0
    s_mov_b32 s18, 36480
    s_mov_b32 s19, 0x20000
    s_mov_b32 s50, 0
    s_mov_b32 s55, 0
    s_mov_b32 s51, 16384
    s_mov_b32 s56, 8192
    s_mov_b32 s52, 32768
    s_mov_b32 s57, 16384
    s_mov_b32 s53, 49152
    s_mov_b32 s58, 24576
    s_mov_b32 s54, 65536
    s_mov_b32 s59, 32768
    buffer_load_dwordx4 v[22:25], v1, s[12:15], s50 offen nt
    buffer_load_dwordx4 v[4:7], v1, s[8:11], s50 offen nt
    buffer_load_dwordx2 v[40:41], v2, s[16:19], s55 offen nt
    buffer_load_dwordx4 v[26:29], v1, s[12:15], s51 offen nt
    buffer_load_dwordx4 v[8:11], v1, s[8:11], s51 offen nt
    buffer_load_dwordx2 v[42:43], v2, s[16:19], s56 offen nt
    buffer_load_dwordx4 v[30:33], v1, s[12:15], s52 offen nt
    buffer_load_dwordx4 v[12:15], v1, s[8:11], s52 offen nt
    buffer_load_dwordx2 v[44:45], v2, s[16:19], s57 offen nt
    buffer_load_dwordx4 v[34:37], v1, s[12:15], s53 offen nt
    buffer_load_dwordx4 v[16:19], v1, s[8:11], s53 offen nt
    buffer_load_dwordx2 v[46:47], v2, s[16:19], s58 offen nt
    buffer_load_dwordx2 v[38:39], v2, s[12:15], s54 offen nt
    buffer_load_dwordx2 v[20:21], v2, s[8:11], s54 offen nt
    buffer_load_dword v48, v3, s[16:19], s59 offen nt
    s_and_b32 s5, s2, 7
    s_mul_i32 s3, s5, 8192

    s_add_u32 s20, s6, s3
    s_addc_u32 s21, s7, 0
    s_mov_b32 s22, 8192
    s_mov_b32 s23, 0x20000
    s_mul_i32 s3, s5, 32505856
    s_add_u32 s3, s3, 27262976
    s_add_u32 s24, s6, s3
    s_addc_u32 s25, s7, 0
    s_mov_b32 s26, 32505856
    s_mov_b32 s27, 0x20000
    s_mul_i32 s3, s5, 8126464
    s_add_u32 s3, s3, 287309824
    s_add_u32 s28, s6, s3
    s_addc_u32 s29, s7, 0
    s_mov_b32 s30, 8126464
    s_mov_b32 s31, 0x20000
    s_add_u32 s32, s6, 352321536
    s_addc_u32 s33, s7, 0
    s_mov_b32 s34, 409600000
    s_mov_b32 s35, 0x20000
    s_add_u32 s36, s6, 131072
    s_addc_u32 s37, s7, 0
    s_mov_b32 s38, 4
    s_mov_b32 s39, 0x20000
    s_mov_b32 s40, 687195
    s_mov_b32 s41, 85899
    s_mov_b32 s42, -6250
    s_mov_b32 s43, -50000
    s_mov_b32 s45, 0x06050400
    s_mov_b32 s46, 992
    s_mov_b32 s47, 3968
    s_mov_b32 s48, 0
    s_mov_b32 s49, 0
    v_mov_b32 v104, 0x10001
    v_mov_b32 v105, 0x447fc000
    v_mov_b32 v106, 0
    v_mov_b32 v107, 0

    ds_write_b64 v2, v[106:107]
    v_mov_b32 v114, 0
    v_mov_b32 v115, -1

    ds_write_b64 v2, v[114:115] offset:16384
    ds_write_b64 v2, v[114:115] offset:24576
    ds_write_b64 v2, v[114:115] offset:32768
    ds_write_b64 v2, v[114:115] offset:40960
    ds_write_b64 v2, v[114:115] offset:49152
    ds_write_b64 v2, v[114:115] offset:57344
    v_add_u32 v127, 65536, v2
    ds_write_b64 v127, v[114:115] offset:0
    ds_write_b64 v127, v[114:115] offset:8192
    ds_write_b64 v127, v[114:115] offset:16384
    ds_write_b64 v127, v[114:115] offset:24576
    ds_write_b64 v127, v[114:115] offset:32768
    ds_write_b64 v127, v[114:115] offset:40960
    ds_write_b64 v127, v[114:115] offset:49152
    ds_write_b64 v127, v[114:115] offset:57344
    v_add_u32 v127, 131072, v2
    ds_write_b64 v127, v[114:115] offset:0
    ds_write_b64 v127, v[114:115] offset:8192
    ds_write_b64 v127, v[114:115] offset:16384
    ds_write_b64 v127, v[114:115] offset:24576
    s_waitcnt lgkmcnt(0)
    s_lshl_b32 s76, s76, 16
    v_mov_b32 v114, 0.15915494
    v_mul_f32 v114, s76, v114
    s_nop 0
    v_readfirstlane_b32 s44, v114
    s_waitcnt vmcnt(0)
    s_barrier

L_p1loop_3:
    s_sub_u32 s64, 200000, s49
    s_min_u32 s64, s64, 18240
    s_sub_u32 s65, s64, 16384
    s_lshl_b32 s65, s65, 1
    v_cmp_gt_u32 s[60:61], s65, v3

    s_waitcnt vmcnt(48)
    v_mul_hi_u32_u24 v51, s40, v22
    v_mul_hi_u32_u24 v50, s41, v4
    v_mul_hi_u32_u24 v53, s40, v23
    v_mul_hi_u32_u24 v52, s41, v5
    v_mul_hi_u32_u24 v55, s40, v24
    v_mul_hi_u32_u24 v54, s41, v6
    v_mul_hi_u32_u24 v57, s40, v25
    v_mul_hi_u32_u24 v56, s41, v7
    v_mad_i32_i24 v22, v51, s42, v22
    v_lshl_add_u32 v51, v50, 7, v51
    v_mad_i32_i24 v23, v53, s42, v23
    v_lshl_add_u32 v53, v52, 7, v53
    v_mad_i32_i24 v24, v55, s42, v24
    v_lshl_add_u32 v55, v54, 7, v55
    v_mad_i32_i24 v25, v57, s42, v25
    v_lshl_add_u32 v57, v56, 7, v57
    v_mad_i32_i24 v4, v50, s43, v4
    v_lshlrev_b32 v51, 2, v51
    ds_add_rtn_u32 v86, v51, v104
    v_mad_i32_i24 v5, v52, s43, v5
    v_lshlrev_b32 v53, 2, v53
    ds_add_rtn_u32 v87, v53, v104
    v_mad_i32_i24 v6, v54, s43, v6
    v_lshlrev_b32 v55, 2, v55
    ds_add_rtn_u32 v88, v55, v104
    v_mad_i32_i24 v7, v56, s43, v7
    v_lshlrev_b32 v57, 2, v57
    ds_add_rtn_u32 v89, v57, v104
    v_lshlrev_b32 v114, 16, v40
    v_and_b32 v115, 0xffff0000, v40
    v_lshlrev_b32 v116, 16, v41
    v_and_b32 v117, 0xffff0000, v41
    v_mul_f32 v114, s44, v114
    v_mul_f32 v115, s44, v115
    v_mul_f32 v116, s44, v116
    v_mul_f32 v117, s44, v117
    v_fract_f32 v114, v114
    v_fract_f32 v115, v115
    v_fract_f32 v116, v116
    v_fract_f32 v117, v117
    v_cos_f32 v114, v114
    v_cos_f32 v115, v115
    v_cos_f32 v116, v116
    v_cos_f32 v117, v117
    s_nop 0
    v_fmaak_f32 v114, v114, v105, 0x4b000c00
    v_fmaak_f32 v115, v115, v105, 0x4b000c00
    v_fmaak_f32 v116, v116, v105, 0x4b000c00
    v_fmaak_f32 v117, v117, v105, 0x4b000c00
    v_bfe_u32 v50, v114, 8, 4
    v_perm_b32 v51, v51, v114, s45
    v_bfe_u32 v52, v115, 8, 4
    v_perm_b32 v53, v53, v115, s45
    v_bfe_u32 v54, v116, 8, 4
    v_perm_b32 v55, v55, v116, s45
    v_bfe_u32 v56, v117, 8, 4
    v_perm_b32 v57, v57, v117, s45
    v_lshl_add_u32 v50, v22, 3, v50
    v_lshl_add_u32 v52, v23, 3, v52
    v_lshl_add_u32 v54, v24, 3, v54
    v_lshl_add_u32 v56, v25, 3, v56
    v_lshl_or_b32 v50, v4, 16, v50
    v_lshl_or_b32 v52, v5, 16, v52
    v_lshl_or_b32 v54, v6, 16, v54
    v_lshl_or_b32 v56, v7, 16, v56
    s_waitcnt vmcnt(45)
    v_mul_hi_u32_u24 v59, s40, v26
    v_mul_hi_u32_u24 v58, s41, v8
    v_mul_hi_u32_u24 v61, s40, v27
    v_mul_hi_u32_u24 v60, s41, v9
    v_mul_hi_u32_u24 v63, s40, v28
    v_mul_hi_u32_u24 v62, s41, v10
    v_mul_hi_u32_u24 v65, s40, v29
    v_mul_hi_u32_u24 v64, s41, v11
    v_mad_i32_i24 v26, v59, s42, v26
    v_lshl_add_u32 v59, v58, 7, v59
    v_mad_i32_i24 v27, v61, s42, v27
    v_lshl_add_u32 v61, v60, 7, v61
    v_mad_i32_i24 v28, v63, s42, v28
    v_lshl_add_u32 v63, v62, 7, v63
    v_mad_i32_i24 v29, v65, s42, v29
    v_lshl_add_u32 v65, v64, 7, v65
    v_mad_i32_i24 v8, v58, s43, v8
    v_lshlrev_b32 v59, 2, v59
    ds_add_rtn_u32 v90, v59, v104
    v_mad_i32_i24 v9, v60, s43, v9
    v_lshlrev_b32 v61, 2, v61
    ds_add_rtn_u32 v91, v61, v104
    v_mad_i32_i24 v10, v62, s43, v10
    v_lshlrev_b32 v63, 2, v63
    ds_add_rtn_u32 v92, v63, v104
    v_mad_i32_i24 v11, v64, s43, v11
    v_lshlrev_b32 v65, 2, v65
    ds_add_rtn_u32 v93, v65, v104
    v_lshlrev_b32 v114, 16, v42
    v_and_b32 v115, 0xffff0000, v42
    v_lshlrev_b32 v116, 16, v43
    v_and_b32 v117, 0xffff0000, v43
    v_mul_f32 v114, s44, v114
    v_mul_f32 v115, s44, v115
    v_mul_f32 v116, s44, v116
    v_mul_f32 v117, s44, v117
    v_fract_f32 v114, v114
    v_fract_f32 v115, v115
    v_fract_f32 v116, v116
    v_fract_f32 v117, v117
    v_cos_f32 v114, v114
    v_cos_f32 v115, v115
    v_cos_f32 v116, v116
    v_cos_f32 v117, v117
    s_nop 0
    v_fmaak_f32 v114, v114, v105, 0x4b000c00
    v_fmaak_f32 v115, v115, v105, 0x4b000c00
    v_fmaak_f32 v116, v116, v105, 0x4b000c00
    v_fmaak_f32 v117, v117, v105, 0x4b000c00
    v_bfe_u32 v58, v114, 8, 4
    v_perm_b32 v59, v59, v114, s45
    v_bfe_u32 v60, v115, 8, 4
    v_perm_b32 v61, v61, v115, s45
    v_bfe_u32 v62, v116, 8, 4
    v_perm_b32 v63, v63, v116, s45
    v_bfe_u32 v64, v117, 8, 4
    v_perm_b32 v65, v65, v117, s45
    v_lshl_add_u32 v58, v26, 3, v58
    v_lshl_add_u32 v60, v27, 3, v60
    v_lshl_add_u32 v62, v28, 3, v62
    v_lshl_add_u32 v64, v29, 3, v64
    v_lshl_or_b32 v58, v8, 16, v58
    v_lshl_or_b32 v60, v9, 16, v60
    v_lshl_or_b32 v62, v10, 16, v62
    v_lshl_or_b32 v64, v11, 16, v64
    s_waitcnt vmcnt(42)
    v_mul_hi_u32_u24 v67, s40, v30
    v_mul_hi_u32_u24 v66, s41, v12
    v_mul_hi_u32_u24 v69, s40, v31
    v_mul_hi_u32_u24 v68, s41, v13
    v_mul_hi_u32_u24 v71, s40, v32
    v_mul_hi_u32_u24 v70, s41, v14
    v_mul_hi_u32_u24 v73, s40, v33
    v_mul_hi_u32_u24 v72, s41, v15
    v_mad_i32_i24 v30, v67, s42, v30
    v_lshl_add_u32 v67, v66, 7, v67
    v_mad_i32_i24 v31, v69, s42, v31
    v_lshl_add_u32 v69, v68, 7, v69
    v_mad_i32_i24 v32, v71, s42, v32
    v_lshl_add_u32 v71, v70, 7, v71
    v_mad_i32_i24 v33, v73, s42, v33
    v_lshl_add_u32 v73, v72, 7, v73
    v_mad_i32_i24 v12, v66, s43, v12
    v_lshlrev_b32 v67, 2, v67
    ds_add_rtn_u32 v94, v67, v104
    v_mad_i32_i24 v13, v68, s43, v13
    v_lshlrev_b32 v69, 2, v69
    ds_add_rtn_u32 v95, v69, v104
    v_mad_i32_i24 v14, v70, s43, v14
    v_lshlrev_b32 v71, 2, v71
    ds_add_rtn_u32 v96, v71, v104
    v_mad_i32_i24 v15, v72, s43, v15
    v_lshlrev_b32 v73, 2, v73
    ds_add_rtn_u32 v97, v73, v104
    v_lshlrev_b32 v114, 16, v44
    v_and_b32 v115, 0xffff0000, v44
    v_lshlrev_b32 v116, 16, v45
    v_and_b32 v117, 0xffff0000, v45
    v_mul_f32 v114, s44, v114
    v_mul_f32 v115, s44, v115
    v_mul_f32 v116, s44, v116
    v_mul_f32 v117, s44, v117
    v_fract_f32 v114, v114
    v_fract_f32 v115, v115
    v_fract_f32 v116, v116
    v_fract_f32 v117, v117
    v_cos_f32 v114, v114
    v_cos_f32 v115, v115
    v_cos_f32 v116, v116
    v_cos_f32 v117, v117
    s_nop 0
    v_fmaak_f32 v114, v114, v105, 0x4b000c00
    v_fmaak_f32 v115, v115, v105, 0x4b000c00
    v_fmaak_f32 v116, v116, v105, 0x4b000c00
    v_fmaak_f32 v117, v117, v105, 0x4b000c00
    v_bfe_u32 v66, v114, 8, 4
    v_perm_b32 v67, v67, v114, s45
    v_bfe_u32 v68, v115, 8, 4
    v_perm_b32 v69, v69, v115, s45
    v_bfe_u32 v70, v116, 8, 4
    v_perm_b32 v71, v71, v116, s45
    v_bfe_u32 v72, v117, 8, 4
    v_perm_b32 v73, v73, v117, s45
    v_lshl_add_u32 v66, v30, 3, v66
    v_lshl_add_u32 v68, v31, 3, v68
    v_lshl_add_u32 v70, v32, 3, v70
    v_lshl_add_u32 v72, v33, 3, v72
    v_lshl_or_b32 v66, v12, 16, v66
    v_lshl_or_b32 v68, v13, 16, v68
    v_lshl_or_b32 v70, v14, 16, v70
    v_lshl_or_b32 v72, v15, 16, v72
    s_waitcnt vmcnt(39)
    v_mul_hi_u32_u24 v75, s40, v34
    v_mul_hi_u32_u24 v74, s41, v16
    v_mul_hi_u32_u24 v77, s40, v35
    v_mul_hi_u32_u24 v76, s41, v17
    v_mul_hi_u32_u24 v79, s40, v36
    v_mul_hi_u32_u24 v78, s41, v18
    v_mul_hi_u32_u24 v81, s40, v37
    v_mul_hi_u32_u24 v80, s41, v19
    v_mad_i32_i24 v34, v75, s42, v34
    v_lshl_add_u32 v75, v74, 7, v75
    v_mad_i32_i24 v35, v77, s42, v35
    v_lshl_add_u32 v77, v76, 7, v77
    v_mad_i32_i24 v36, v79, s42, v36
    v_lshl_add_u32 v79, v78, 7, v79
    v_mad_i32_i24 v37, v81, s42, v37
    v_lshl_add_u32 v81, v80, 7, v81
    v_mad_i32_i24 v16, v74, s43, v16
    v_lshlrev_b32 v75, 2, v75
    ds_add_rtn_u32 v98, v75, v104
    v_mad_i32_i24 v17, v76, s43, v17
    v_lshlrev_b32 v77, 2, v77
    ds_add_rtn_u32 v99, v77, v104
    v_mad_i32_i24 v18, v78, s43, v18
    v_lshlrev_b32 v79, 2, v79
    ds_add_rtn_u32 v100, v79, v104
    v_mad_i32_i24 v19, v80, s43, v19
    v_lshlrev_b32 v81, 2, v81
    ds_add_rtn_u32 v101, v81, v104
    v_lshlrev_b32 v114, 16, v46
    v_and_b32 v115, 0xffff0000, v46
    v_lshlrev_b32 v116, 16, v47
    v_and_b32 v117, 0xffff0000, v47
    v_mul_f32 v114, s44, v114
    v_mul_f32 v115, s44, v115
    v_mul_f32 v116, s44, v116
    v_mul_f32 v117, s44, v117
    v_fract_f32 v114, v114
    v_fract_f32 v115, v115
    v_fract_f32 v116, v116
    v_fract_f32 v117, v117
    v_cos_f32 v114, v114
    v_cos_f32 v115, v115
    v_cos_f32 v116, v116
    v_cos_f32 v117, v117
    s_nop 0
    v_fmaak_f32 v114, v114, v105, 0x4b000c00
    v_fmaak_f32 v115, v115, v105, 0x4b000c00
    v_fmaak_f32 v116, v116, v105, 0x4b000c00
    v_fmaak_f32 v117, v117, v105, 0x4b000c00
    v_bfe_u32 v74, v114, 8, 4
    v_perm_b32 v75, v75, v114, s45
    v_bfe_u32 v76, v115, 8, 4
    v_perm_b32 v77, v77, v115, s45
    v_bfe_u32 v78, v116, 8, 4
    v_perm_b32 v79, v79, v116, s45
    v_bfe_u32 v80, v117, 8, 4
    v_perm_b32 v81, v81, v117, s45
    v_lshl_add_u32 v74, v34, 3, v74
    v_lshl_add_u32 v76, v35, 3, v76
    v_lshl_add_u32 v78, v36, 3, v78
    v_lshl_add_u32 v80, v37, 3, v80
    v_lshl_or_b32 v74, v16, 16, v74
    v_lshl_or_b32 v76, v17, 16, v76
    v_lshl_or_b32 v78, v18, 16, v78
    v_lshl_or_b32 v80, v19, 16, v80
    s_waitcnt vmcnt(36)
    s_mov_b64 exec, s[60:61]
    v_mul_hi_u32_u24 v83, s40, v38
    v_mul_hi_u32_u24 v82, s41, v20
    v_mul_hi_u32_u24 v85, s40, v39
    v_mul_hi_u32_u24 v84, s41, v21
    v_mad_i32_i24 v38, v83, s42, v38
    v_lshl_add_u32 v83, v82, 7, v83
    v_mad_i32_i24 v39, v85, s42, v39
    v_lshl_add_u32 v85, v84, 7, v85
    v_mad_i32_i24 v20, v82, s43, v20
    v_lshlrev_b32 v83, 2, v83
    ds_add_rtn_u32 v102, v83, v104
    v_mad_i32_i24 v21, v84, s43, v21
    v_lshlrev_b32 v85, 2, v85
    ds_add_rtn_u32 v103, v85, v104
    v_lshlrev_b32 v114, 16, v48
    v_and_b32 v115, 0xffff0000, v48
    v_mul_f32 v114, s44, v114
    v_mul_f32 v115, s44, v115
    v_fract_f32 v114, v114
    v_fract_f32 v115, v115
    v_cos_f32 v114, v114
    v_cos_f32 v115, v115
    s_nop 0
    v_fmaak_f32 v114, v114, v105, 0x4b000c00
    v_fmaak_f32 v115, v115, v105, 0x4b000c00
    v_bfe_u32 v82, v114, 8, 4
    v_perm_b32 v83, v83, v114, s45
    v_bfe_u32 v84, v115, 8, 4
    v_perm_b32 v85, v85, v115, s45
    v_lshl_add_u32 v82, v38, 3, v82
    v_lshl_add_u32 v84, v39, 3, v84
    v_lshl_or_b32 v82, v20, 16, v82
    v_lshl_or_b32 v84, v21, 16, v84
    s_mov_b64 exec, -1
    s_waitcnt lgkmcnt(0)
    s_barrier
    ds_read_b64 v[108:109], v2

    s_add_u32 s66, s49, 36480
    s_min_u32 s66, s66, 200000
    s_lshl_b32 s10, s66, 2
    s_lshl_b32 s14, s66, 2
    s_lshl_b32 s18, s66, 1

    s_add_u32 s50, s50, 72960
    s_add_u32 s55, s55, 36480
    s_add_u32 s51, s51, 72960
    s_add_u32 s56, s56, 36480
    s_add_u32 s52, s52, 72960
    s_add_u32 s57, s57, 36480
    s_add_u32 s53, s53, 72960
    s_add_u32 s58, s58, 36480
    s_add_u32 s54, s54, 72960
    s_add_u32 s59, s59, 36480
    s_waitcnt lgkmcnt(0)
    v_sub_u32 v112, v108, v106
    v_sub_u32 v113, v109, v107
    v_and_b32 v112, 0xffff, v112
    v_and_b32 v113, 0xffff, v113
    v_mov_b32 v110, v112
    v_mov_b32 v111, v113
    buffer_atomic_add_x2 v[110:111], v2, s[20:23], 0 offen sc0

    s_cmp_eq_u32 s48, 10
    s_cbranch_scc1 L_nold_4
    buffer_load_dwordx4 v[22:25], v1, s[12:15], s50 offen nt
    buffer_load_dwordx4 v[4:7], v1, s[8:11], s50 offen nt
    buffer_load_dwordx2 v[40:41], v2, s[16:19], s55 offen nt
    buffer_load_dwordx4 v[26:29], v1, s[12:15], s51 offen nt
    buffer_load_dwordx4 v[8:11], v1, s[8:11], s51 offen nt
    buffer_load_dwordx2 v[42:43], v2, s[16:19], s56 offen nt
    buffer_load_dwordx4 v[30:33], v1, s[12:15], s52 offen nt
    buffer_load_dwordx4 v[12:15], v1, s[8:11], s52 offen nt
    buffer_load_dwordx2 v[44:45], v2, s[16:19], s57 offen nt
    buffer_load_dwordx4 v[34:37], v1, s[12:15], s53 offen nt
    buffer_load_dwordx4 v[16:19], v1, s[8:11], s53 offen nt
    buffer_load_dwordx2 v[46:47], v2, s[16:19], s58 offen nt
    buffer_load_dwordx2 v[38:39], v2, s[12:15], s54 offen nt
    buffer_load_dwordx2 v[20:21], v2, s[8:11], s54 offen nt
    buffer_load_dword v48, v3, s[16:19], s59 offen nt
L_nold_4:
    v_add_u32 v126, v112, v113
    s_nop 1
    v_add_u32_dpp v126, v126, v126 row_shr:1 row_mask:0xf bank_mask:0xf
    s_nop 1
    v_add_u32_dpp v126, v126, v126 row_shr:2 row_mask:0xf bank_mask:0xf
    s_nop 1
    v_add_u32_dpp v126, v126, v126 row_shr:4 row_mask:0xf bank_mask:0xf
    s_nop 1
    v_add_u32_dpp v126, v126, v126 row_shr:8 row_mask:0xf bank_mask:0xf
    s_nop 1
    v_add_u32_dpp v126, v126, v126 row_bcast:15 row_mask:0xa bank_mask:0xf
    s_nop 1
    v_add_u32_dpp v126, v126, v126 row_bcast:31 row_mask:0xc bank_mask:0xf
    v_mov_b32 v114, 163832
    s_mov_b32 exec_lo, 0
    s_brev_b32 exec_hi, 1
    ds_add_rtn_u32 v115, v114, v126
    s_mov_b64 exec, -1
    s_waitcnt lgkmcnt(0)
    v_readlane_b32 s67, v115, 63
    s_nop 1
    s_sub_u32 s67, s67, s49
    v_sub_u32 v126, v126, v113
    v_add_u32 v126, s67, v126

    v_lshlrev_b32 v114, 16, v126
    v_sub_u32 v126, v126, v112
    v_sub_u32 v107, v114, v107
    v_lshlrev_b32 v114, 16, v126
    v_sub_u32 v106, v114, v106

    ds_read_b64 v[114:115], v2 offset:16384
    ds_read_b64 v[116:117], v2 offset:24576
    ds_read_b64 v[118:119], v2 offset:32768
    ds_read_b64 v[120:121], v2 offset:40960
    s_waitcnt lgkmcnt(3)
    v_lshrrev_b32 v122, 8, v115
    v_lshlrev_b32 v123, 2, v122
    buffer_store_byte v115, v122, s[28:31], 0 offen
    buffer_store_dword v114, v123, s[24:27], 0 offen

    s_waitcnt lgkmcnt(2)
    v_lshrrev_b32 v124, 8, v117
    v_lshlrev_b32 v125, 2, v124
    buffer_store_byte v117, v124, s[28:31], 0 offen
    buffer_store_dword v116, v125, s[24:27], 0 offen

    s_waitcnt lgkmcnt(1)
    v_lshrrev_b32 v122, 8, v119
    v_lshlrev_b32 v123, 2, v122
    buffer_store_byte v119, v122, s[28:31], 0 offen
    buffer_store_dword v118, v123, s[24:27], 0 offen

    s_waitcnt lgkmcnt(0)
    v_lshrrev_b32 v124, 8, v121
    v_lshlrev_b32 v125, 2, v124
    buffer_store_byte v121, v124, s[28:31], 0 offen
    buffer_store_dword v120, v125, s[24:27], 0 offen

    ds_read_b64 v[114:115], v2 offset:49152
    ds_read_b64 v[116:117], v2 offset:57344
    v_add_u32 v127, 65536, v2
    ds_read_b64 v[118:119], v127 offset:0
    ds_read_b64 v[120:121], v127 offset:8192
    s_waitcnt lgkmcnt(3)
    v_lshrrev_b32 v122, 8, v115
    v_lshlrev_b32 v123, 2, v122
    buffer_store_byte v115, v122, s[28:31], 0 offen
    buffer_store_dword v114, v123, s[24:27], 0 offen

    s_waitcnt lgkmcnt(2)
    v_lshrrev_b32 v124, 8, v117
    v_lshlrev_b32 v125, 2, v124
    buffer_store_byte v117, v124, s[28:31], 0 offen
    buffer_store_dword v116, v125, s[24:27], 0 offen

    s_waitcnt lgkmcnt(1)
    v_lshrrev_b32 v122, 8, v119
    v_lshlrev_b32 v123, 2, v122
    buffer_store_byte v119, v122, s[28:31], 0 offen
    buffer_store_dword v118, v123, s[24:27], 0 offen

    s_waitcnt lgkmcnt(0)
    v_lshrrev_b32 v124, 8, v121
    v_lshlrev_b32 v125, 2, v124
    buffer_store_byte v121, v124, s[28:31], 0 offen
    buffer_store_dword v120, v125, s[24:27], 0 offen

    ds_read_b64 v[114:115], v127 offset:16384
    ds_read_b64 v[116:117], v127 offset:24576
    ds_read_b64 v[118:119], v127 offset:32768
    ds_read_b64 v[120:121], v127 offset:40960
    s_waitcnt lgkmcnt(3)
    v_lshrrev_b32 v122, 8, v115
    v_lshlrev_b32 v123, 2, v122
    buffer_store_byte v115, v122, s[28:31], 0 offen
    buffer_store_dword v114, v123, s[24:27], 0 offen

    s_waitcnt lgkmcnt(2)
    v_lshrrev_b32 v124, 8, v117
    v_lshlrev_b32 v125, 2, v124
    buffer_store_byte v117, v124, s[28:31], 0 offen
    buffer_store_dword v116, v125, s[24:27], 0 offen

    s_waitcnt lgkmcnt(1)
    v_lshrrev_b32 v122, 8, v119
    v_lshlrev_b32 v123, 2, v122
    buffer_store_byte v119, v122, s[28:31], 0 offen
    buffer_store_dword v118, v123, s[24:27], 0 offen

    s_waitcnt lgkmcnt(0)
    v_lshrrev_b32 v124, 8, v121
    v_lshlrev_b32 v125, 2, v124
    buffer_store_byte v121, v124, s[28:31], 0 offen
    buffer_store_dword v120, v125, s[24:27], 0 offen

    ds_read_b64 v[114:115], v127 offset:49152
    ds_read_b64 v[116:117], v127 offset:57344
    v_add_u32 v127, 131072, v2
    ds_read_b64 v[118:119], v127 offset:0
    ds_read_b64 v[120:121], v127 offset:8192
    s_waitcnt lgkmcnt(3)
    v_lshrrev_b32 v122, 8, v115
    v_lshlrev_b32 v123, 2, v122
    buffer_store_byte v115, v122, s[28:31], 0 offen
    buffer_store_dword v114, v123, s[24:27], 0 offen

    s_waitcnt lgkmcnt(2)
    v_lshrrev_b32 v124, 8, v117
    v_lshlrev_b32 v125, 2, v124
    buffer_store_byte v117, v124, s[28:31], 0 offen
    buffer_store_dword v116, v125, s[24:27], 0 offen

    s_waitcnt lgkmcnt(1)
    v_lshrrev_b32 v122, 8, v119
    v_lshlrev_b32 v123, 2, v122
    buffer_store_byte v119, v122, s[28:31], 0 offen
    buffer_store_dword v118, v123, s[24:27], 0 offen

    s_waitcnt lgkmcnt(0)
    v_lshrrev_b32 v124, 8, v121
    v_lshlrev_b32 v125, 2, v124
    buffer_store_byte v121, v124, s[28:31], 0 offen
    buffer_store_dword v120, v125, s[24:27], 0 offen

    ds_read_b64 v[114:115], v127 offset:16384
    ds_read_b64 v[116:117], v127 offset:24576
    s_waitcnt lgkmcnt(1)
    v_lshrrev_b32 v122, 8, v115
    v_lshlrev_b32 v123, 2, v122
    buffer_store_byte v115, v122, s[28:31], 0 offen
    buffer_store_dword v114, v123, s[24:27], 0 offen

    s_waitcnt lgkmcnt(0)
    v_lshrrev_b32 v124, 8, v117
    v_lshlrev_b32 v125, 2, v124
    buffer_store_byte v117, v124, s[28:31], 0 offen
    buffer_store_dword v116, v125, s[24:27], 0 offen

    s_waitcnt vmcnt(51)
    s_cmp_lg_u32 s48, 10
    s_cbranch_scc1 L_nl2_6
    s_waitcnt vmcnt(36)
L_nl2_6:
    v_add_u32 v114, v110, v112
    v_add_u32 v115, v111, v113
    v_max_u32 v114, v114, v115
    v_cmp_lt_u32 vcc, s47, v114
    v_min_u32 v110, s47, v110
    v_min_u32 v111, s47, v111
    v_add_u32 v110, v110, v106
    v_add_u32 v111, v111, v107
    ds_write_b64 v2, v[110:111] offset:8192
    v_mov_b32 v106, v108
    v_mov_b32 v107, v109
    v_mov_b32 v126, 163824
    s_cbranch_vccz L_noov_5
    ds_write_b32 v126, v104
L_noov_5:
    s_waitcnt lgkmcnt(0)
    s_barrier
    ds_read_b32 v127, v126

    v_lshrrev_b32 v114, 8, v51
    ds_read_b32 v115, v114 offset:8192
    v_lshrrev_b32 v116, 8, v53
    ds_read_b32 v117, v116 offset:8192
    v_lshrrev_b32 v118, 8, v55
    ds_read_b32 v119, v118 offset:8192
    v_lshrrev_b32 v120, 8, v57
    ds_read_b32 v121, v120 offset:8192
    v_lshrrev_b32 v122, 8, v59
    ds_read_b32 v123, v122 offset:8192
    v_lshrrev_b32 v124, 8, v61
    ds_read_b32 v125, v124 offset:8192
    s_waitcnt lgkmcnt(6)
    v_readfirstlane_b32 s68, v127
    s_nop 1
    s_cmp_lg_u32 s68, 0
    s_cbranch_scc1 L_slow_7

    s_waitcnt lgkmcnt(5)
    v_add_u32 v86, v115, v86
    v_lshlrev_b32_sdwa v115, 3, v86 dst_sel:DWORD dst_unused:UNUSED_PAD src0_sel:DWORD src1_sel:WORD_1
    v_and_b32 v86, 0xffff, v86
    v_mad_u32_u24 v86, v114, s46, v86
    v_perm_b32 v51, v86, v51, s45
    ds_write_b64 v115, v[50:51] offset:16384

    s_waitcnt lgkmcnt(5)
    v_add_u32 v87, v117, v87
    v_lshlrev_b32_sdwa v117, 3, v87 dst_sel:DWORD dst_unused:UNUSED_PAD src0_sel:DWORD src1_sel:WORD_1
    v_and_b32 v87, 0xffff, v87
    v_mad_u32_u24 v87, v116, s46, v87
    v_perm_b32 v53, v87, v53, s45
    ds_write_b64 v117, v[52:53] offset:16384

    s_waitcnt lgkmcnt(5)
    v_add_u32 v88, v119, v88
    v_lshlrev_b32_sdwa v119, 3, v88 dst_sel:DWORD dst_unused:UNUSED_PAD src0_sel:DWORD src1_sel:WORD_1
    v_and_b32 v88, 0xffff, v88
    v_mad_u32_u24 v88, v118, s46, v88
    v_perm_b32 v55, v88, v55, s45
    ds_write_b64 v119, v[54:55] offset:16384

    s_waitcnt lgkmcnt(5)
    v_add_u32 v89, v121, v89
    v_lshlrev_b32_sdwa v121, 3, v89 dst_sel:DWORD dst_unused:UNUSED_PAD src0_sel:DWORD src1_sel:WORD_1
    v_and_b32 v89, 0xffff, v89
    v_mad_u32_u24 v89, v120, s46, v89
    v_perm_b32 v57, v89, v57, s45
    ds_write_b64 v121, v[56:57] offset:16384

    s_waitcnt lgkmcnt(5)
    v_add_u32 v90, v123, v90
    v_lshlrev_b32_sdwa v123, 3, v90 dst_sel:DWORD dst_unused:UNUSED_PAD src0_sel:DWORD src1_sel:WORD_1
    v_and_b32 v90, 0xffff, v90
    v_mad_u32_u24 v90, v122, s46, v90
    v_perm_b32 v59, v90, v59, s45
    ds_write_b64 v123, v[58:59] offset:16384

    s_waitcnt lgkmcnt(5)
    v_add_u32 v91, v125, v91
    v_lshlrev_b32_sdwa v125, 3, v91 dst_sel:DWORD dst_unused:UNUSED_PAD src0_sel:DWORD src1_sel:WORD_1
    v_and_b32 v91, 0xffff, v91
    v_mad_u32_u24 v91, v124, s46, v91
    v_perm_b32 v61, v91, v61, s45
    ds_write_b64 v125, v[60:61] offset:16384

    v_lshrrev_b32 v114, 8, v63
    ds_read_b32 v115, v114 offset:8192
    v_lshrrev_b32 v116, 8, v65
    ds_read_b32 v117, v116 offset:8192
    v_lshrrev_b32 v118, 8, v67
    ds_read_b32 v119, v118 offset:8192
    v_lshrrev_b32 v120, 8, v69
    ds_read_b32 v121, v120 offset:8192
    v_lshrrev_b32 v122, 8, v71
    ds_read_b32 v123, v122 offset:8192
    v_lshrrev_b32 v124, 8, v73
    ds_read_b32 v125, v124 offset:8192
    s_waitcnt lgkmcnt(5)
    v_add_u32 v92, v115, v92
    v_lshlrev_b32_sdwa v115, 3, v92 dst_sel:DWORD dst_unused:UNUSED_PAD src0_sel:DWORD src1_sel:WORD_1
    v_and_b32 v92, 0xffff, v92
    v_mad_u32_u24 v92, v114, s46, v92
    v_perm_b32 v63, v92, v63, s45
    ds_write_b64 v115, v[62:63] offset:16384

    s_waitcnt lgkmcnt(5)
    v_add_u32 v93, v117, v93
    v_lshlrev_b32_sdwa v117, 3, v93 dst_sel:DWORD dst_unused:UNUSED_PAD src0_sel:DWORD src1_sel:WORD_1
    v_and_b32 v93, 0xffff, v93
    v_mad_u32_u24 v93, v116, s46, v93
    v_perm_b32 v65, v93, v65, s45
    ds_write_b64 v117, v[64:65] offset:16384

    s_waitcnt lgkmcnt(5)
    v_add_u32 v94, v119, v94
    v_lshlrev_b32_sdwa v119, 3, v94 dst_sel:DWORD dst_unused:UNUSED_PAD src0_sel:DWORD src1_sel:WORD_1
    v_and_b32 v94, 0xffff, v94
    v_mad_u32_u24 v94, v118, s46, v94
    v_perm_b32 v67, v94, v67, s45
    ds_write_b64 v119, v[66:67] offset:16384

    s_waitcnt lgkmcnt(5)
    v_add_u32 v95, v121, v95
    v_lshlrev_b32_sdwa v121, 3, v95 dst_sel:DWORD dst_unused:UNUSED_PAD src0_sel:DWORD src1_sel:WORD_1
    v_and_b32 v95, 0xffff, v95
    v_mad_u32_u24 v95, v120, s46, v95
    v_perm_b32 v69, v95, v69, s45
    ds_write_b64 v121, v[68:69] offset:16384

    s_waitcnt lgkmcnt(5)
    v_add_u32 v96, v123, v96
    v_lshlrev_b32_sdwa v123, 3, v96 dst_sel:DWORD dst_unused:UNUSED_PAD src0_sel:DWORD src1_sel:WORD_1
    v_and_b32 v96, 0xffff, v96
    v_mad_u32_u24 v96, v122, s46, v96
    v_perm_b32 v71, v96, v71, s45
    ds_write_b64 v123, v[70:71] offset:16384

    s_waitcnt lgkmcnt(5)
    v_add_u32 v97, v125, v97
    v_lshlrev_b32_sdwa v125, 3, v97 dst_sel:DWORD dst_unused:UNUSED_PAD src0_sel:DWORD src1_sel:WORD_1
    v_and_b32 v97, 0xffff, v97
    v_mad_u32_u24 v97, v124, s46, v97
    v_perm_b32 v73, v97, v73, s45
    ds_write_b64 v125, v[72:73] offset:16384

    v_lshrrev_b32 v114, 8, v75
    ds_read_b32 v115, v114 offset:8192
    v_lshrrev_b32 v116, 8, v77
    ds_read_b32 v117, v116 offset:8192
    v_lshrrev_b32 v118, 8, v79
    ds_read_b32 v119, v118 offset:8192
    v_lshrrev_b32 v120, 8, v81
    ds_read_b32 v121, v120 offset:8192
    s_waitcnt lgkmcnt(3)
    v_add_u32 v98, v115, v98
    v_lshlrev_b32_sdwa v115, 3, v98 dst_sel:DWORD dst_unused:UNUSED_PAD src0_sel:DWORD src1_sel:WORD_1
    v_and_b32 v98, 0xffff, v98
    v_mad_u32_u24 v98, v114, s46, v98
    v_perm_b32 v75, v98, v75, s45
    ds_write_b64 v115, v[74:75] offset:16384

    s_waitcnt lgkmcnt(3)
    v_add_u32 v99, v117, v99
    v_lshlrev_b32_sdwa v117, 3, v99 dst_sel:DWORD dst_unused:UNUSED_PAD src0_sel:DWORD src1_sel:WORD_1
    v_and_b32 v99, 0xffff, v99
    v_mad_u32_u24 v99, v116, s46, v99
    v_perm_b32 v77, v99, v77, s45
    ds_write_b64 v117, v[76:77] offset:16384

    s_waitcnt lgkmcnt(3)
    v_add_u32 v100, v119, v100
    v_lshlrev_b32_sdwa v119, 3, v100 dst_sel:DWORD dst_unused:UNUSED_PAD src0_sel:DWORD src1_sel:WORD_1
    v_and_b32 v100, 0xffff, v100
    v_mad_u32_u24 v100, v118, s46, v100
    v_perm_b32 v79, v100, v79, s45
    ds_write_b64 v119, v[78:79] offset:16384

    s_waitcnt lgkmcnt(3)
    v_add_u32 v101, v121, v101
    v_lshlrev_b32_sdwa v121, 3, v101 dst_sel:DWORD dst_unused:UNUSED_PAD src0_sel:DWORD src1_sel:WORD_1
    v_and_b32 v101, 0xffff, v101
    v_mad_u32_u24 v101, v120, s46, v101
    v_perm_b32 v81, v101, v81, s45
    ds_write_b64 v121, v[80:81] offset:16384

    s_mov_b64 exec, s[60:61]
    v_lshrrev_b32 v114, 8, v83
    ds_read_b32 v115, v114 offset:8192
    v_lshrrev_b32 v116, 8, v85
    ds_read_b32 v117, v116 offset:8192
    s_waitcnt lgkmcnt(1)
    v_add_u32 v102, v115, v102
    v_lshlrev_b32_sdwa v115, 3, v102 dst_sel:DWORD dst_unused:UNUSED_PAD src0_sel:DWORD src1_sel:WORD_1
    v_and_b32 v102, 0xffff, v102
    v_mad_u32_u24 v102, v114, s46, v102
    v_perm_b32 v83, v102, v83, s45
    ds_write_b64 v115, v[82:83] offset:16384

    s_waitcnt lgkmcnt(1)
    v_add_u32 v103, v117, v103
    v_lshlrev_b32_sdwa v117, 3, v103 dst_sel:DWORD dst_unused:UNUSED_PAD src0_sel:DWORD src1_sel:WORD_1
    v_and_b32 v103, 0xffff, v103
    v_mad_u32_u24 v103, v116, s46, v103
    v_perm_b32 v85, v103, v85, s45
    ds_write_b64 v117, v[84:85] offset:16384

L_join_8:
    s_mov_b64 exec, -1
    s_add_u32 s49, s49, s64
    s_add_u32 s48, s48, 1
    s_cmp_lt_u32 s48, 11
    s_cbranch_scc1 L_p1loop_3
    s_waitcnt lgkmcnt(0)
    s_barrier

    ds_read_b64 v[114:115], v2 offset:16384
    ds_read_b64 v[116:117], v2 offset:24576
    ds_read_b64 v[118:119], v2 offset:32768
    ds_read_b64 v[120:121], v2 offset:40960
    s_waitcnt lgkmcnt(3)
    v_lshrrev_b32 v122, 8, v115
    v_lshlrev_b32 v123, 2, v122
    buffer_store_byte v115, v122, s[28:31], 0 offen
    buffer_store_dword v114, v123, s[24:27], 0 offen

    s_waitcnt lgkmcnt(2)
    v_lshrrev_b32 v124, 8, v117
    v_lshlrev_b32 v125, 2, v124
    buffer_store_byte v117, v124, s[28:31], 0 offen
    buffer_store_dword v116, v125, s[24:27], 0 offen

    s_waitcnt lgkmcnt(1)
    v_lshrrev_b32 v122, 8, v119
    v_lshlrev_b32 v123, 2, v122
    buffer_store_byte v119, v122, s[28:31], 0 offen
    buffer_store_dword v118, v123, s[24:27], 0 offen

    s_waitcnt lgkmcnt(0)
    v_lshrrev_b32 v124, 8, v121
    v_lshlrev_b32 v125, 2, v124
    buffer_store_byte v121, v124, s[28:31], 0 offen
    buffer_store_dword v120, v125, s[24:27], 0 offen

    ds_read_b64 v[114:115], v2 offset:49152
    ds_read_b64 v[116:117], v2 offset:57344
    v_add_u32 v127, 65536, v2
    ds_read_b64 v[118:119], v127 offset:0
    ds_read_b64 v[120:121], v127 offset:8192
    s_waitcnt lgkmcnt(3)
    v_lshrrev_b32 v122, 8, v115
    v_lshlrev_b32 v123, 2, v122
    buffer_store_byte v115, v122, s[28:31], 0 offen
    buffer_store_dword v114, v123, s[24:27], 0 offen

    s_waitcnt lgkmcnt(2)
    v_lshrrev_b32 v124, 8, v117
    v_lshlrev_b32 v125, 2, v124
    buffer_store_byte v117, v124, s[28:31], 0 offen
    buffer_store_dword v116, v125, s[24:27], 0 offen

    s_waitcnt lgkmcnt(1)
    v_lshrrev_b32 v122, 8, v119
    v_lshlrev_b32 v123, 2, v122
    buffer_store_byte v119, v122, s[28:31], 0 offen
    buffer_store_dword v118, v123, s[24:27], 0 offen

    s_waitcnt lgkmcnt(0)
    v_lshrrev_b32 v124, 8, v121
    v_lshlrev_b32 v125, 2, v124
    buffer_store_byte v121, v124, s[28:31], 0 offen
    buffer_store_dword v120, v125, s[24:27], 0 offen

    ds_read_b64 v[114:115], v127 offset:16384
    ds_read_b64 v[116:117], v127 offset:24576
    ds_read_b64 v[118:119], v127 offset:32768
    ds_read_b64 v[120:121], v127 offset:40960
    s_waitcnt lgkmcnt(3)
    v_lshrrev_b32 v122, 8, v115
    v_lshlrev_b32 v123, 2, v122
    buffer_store_byte v115, v122, s[28:31], 0 offen
    buffer_store_dword v114, v123, s[24:27], 0 offen

    s_waitcnt lgkmcnt(2)
    v_lshrrev_b32 v124, 8, v117
    v_lshlrev_b32 v125, 2, v124
    buffer_store_byte v117, v124, s[28:31], 0 offen
    buffer_store_dword v116, v125, s[24:27], 0 offen

    s_waitcnt lgkmcnt(1)
    v_lshrrev_b32 v122, 8, v119
    v_lshlrev_b32 v123, 2, v122
    buffer_store_byte v119, v122, s[28:31], 0 offen
    buffer_store_dword v118, v123, s[24:27], 0 offen

    s_waitcnt lgkmcnt(0)
    v_lshrrev_b32 v124, 8, v121
    v_lshlrev_b32 v125, 2, v124
    buffer_store_byte v121, v124, s[28:31], 0 offen
    buffer_store_dword v120, v125, s[24:27], 0 offen

    ds_read_b64 v[114:115], v127 offset:49152
    ds_read_b64 v[116:117], v127 offset:57344
    v_add_u32 v127, 131072, v2
    ds_read_b64 v[118:119], v127 offset:0
    ds_read_b64 v[120:121], v127 offset:8192
    s_waitcnt lgkmcnt(3)
    v_lshrrev_b32 v122, 8, v115
    v_lshlrev_b32 v123, 2, v122
    buffer_store_byte v115, v122, s[28:31], 0 offen
    buffer_store_dword v114, v123, s[24:27], 0 offen

    s_waitcnt lgkmcnt(2)
    v_lshrrev_b32 v124, 8, v117
    v_lshlrev_b32 v125, 2, v124
    buffer_store_byte v117, v124, s[28:31], 0 offen
    buffer_store_dword v116, v125, s[24:27], 0 offen

    s_waitcnt lgkmcnt(1)
    v_lshrrev_b32 v122, 8, v119
    v_lshlrev_b32 v123, 2, v122
    buffer_store_byte v119, v122, s[28:31], 0 offen
    buffer_store_dword v118, v123, s[24:27], 0 offen

    s_waitcnt lgkmcnt(0)
    v_lshrrev_b32 v124, 8, v121
    v_lshlrev_b32 v125, 2, v124
    buffer_store_byte v121, v124, s[28:31], 0 offen
    buffer_store_dword v120, v125, s[24:27], 0 offen

    ds_read_b64 v[114:115], v127 offset:16384
    ds_read_b64 v[116:117], v127 offset:24576
    s_waitcnt lgkmcnt(1)
    v_lshrrev_b32 v122, 8, v115
    v_lshlrev_b32 v123, 2, v122
    buffer_store_byte v115, v122, s[28:31], 0 offen
    buffer_store_dword v114, v123, s[24:27], 0 offen

    s_waitcnt lgkmcnt(0)
    v_lshrrev_b32 v124, 8, v117
    v_lshlrev_b32 v125, 2, v124
    buffer_store_byte v117, v124, s[28:31], 0 offen
    buffer_store_dword v116, v125, s[24:27], 0 offen

L_p1done_2:
    s_endpgm

L_slow_7:
    s_waitcnt lgkmcnt(0)
    v_mov_b32 v119, 0
    v_lshrrev_b32 v114, 8, v51
    ds_read_b32 v115, v114 offset:8192
    s_waitcnt lgkmcnt(0)
    v_add_u32 v86, v115, v86
    v_lshlrev_b32_sdwa v115, 3, v86 dst_sel:DWORD dst_unused:UNUSED_PAD src0_sel:DWORD src1_sel:WORD_1
    v_and_b32 v86, 0xffff, v86
    v_cmp_le_u32 vcc, s47, v86
    v_mad_u32_u24 v86, v114, s46, v86
    v_perm_b32 v116, v86, v51, s45
    v_cndmask_b32 v116, v116, -1, vcc
    v_mov_b32 v117, 1
    s_and_saveexec_b64 s[62:63], vcc
    s_cbranch_execz L_sk_9
    buffer_atomic_add v117, v119, s[36:39], 0 offen sc0
    s_waitcnt vmcnt(0)
    v_lshlrev_b32 v117, 3, v117
    buffer_store_dwordx2 v[50:51], v117, s[32:35], 0 offen
    s_waitcnt vmcnt(0)
L_sk_9:
    s_mov_b64 exec, s[62:63]
    v_mov_b32 v51, v116
    ds_write_b64 v115, v[50:51] offset:16384

    v_lshrrev_b32 v114, 8, v53
    ds_read_b32 v115, v114 offset:8192
    s_waitcnt lgkmcnt(0)
    v_add_u32 v87, v115, v87
    v_lshlrev_b32_sdwa v115, 3, v87 dst_sel:DWORD dst_unused:UNUSED_PAD src0_sel:DWORD src1_sel:WORD_1
    v_and_b32 v87, 0xffff, v87
    v_cmp_le_u32 vcc, s47, v87
    v_mad_u32_u24 v87, v114, s46, v87
    v_perm_b32 v116, v87, v53, s45
    v_cndmask_b32 v116, v116, -1, vcc
    v_mov_b32 v117, 1
    s_and_saveexec_b64 s[62:63], vcc
    s_cbranch_execz L_sk_10
    buffer_atomic_add v117, v119, s[36:39], 0 offen sc0
    s_waitcnt vmcnt(0)
    v_lshlrev_b32 v117, 3, v117
    buffer_store_dwordx2 v[52:53], v117, s[32:35], 0 offen
    s_waitcnt vmcnt(0)
L_sk_10:
    s_mov_b64 exec, s[62:63]
    v_mov_b32 v53, v116
    ds_write_b64 v115, v[52:53] offset:16384

    v_lshrrev_b32 v114, 8, v55
    ds_read_b32 v115, v114 offset:8192
    s_waitcnt lgkmcnt(0)
    v_add_u32 v88, v115, v88
    v_lshlrev_b32_sdwa v115, 3, v88 dst_sel:DWORD dst_unused:UNUSED_PAD src0_sel:DWORD src1_sel:WORD_1
    v_and_b32 v88, 0xffff, v88
    v_cmp_le_u32 vcc, s47, v88
    v_mad_u32_u24 v88, v114, s46, v88
    v_perm_b32 v116, v88, v55, s45
    v_cndmask_b32 v116, v116, -1, vcc
    v_mov_b32 v117, 1
    s_and_saveexec_b64 s[62:63], vcc
    s_cbranch_execz L_sk_11
    buffer_atomic_add v117, v119, s[36:39], 0 offen sc0
    s_waitcnt vmcnt(0)
    v_lshlrev_b32 v117, 3, v117
    buffer_store_dwordx2 v[54:55], v117, s[32:35], 0 offen
    s_waitcnt vmcnt(0)
L_sk_11:
    s_mov_b64 exec, s[62:63]
    v_mov_b32 v55, v116
    ds_write_b64 v115, v[54:55] offset:16384

    v_lshrrev_b32 v114, 8, v57
    ds_read_b32 v115, v114 offset:8192
    s_waitcnt lgkmcnt(0)
    v_add_u32 v89, v115, v89
    v_lshlrev_b32_sdwa v115, 3, v89 dst_sel:DWORD dst_unused:UNUSED_PAD src0_sel:DWORD src1_sel:WORD_1
    v_and_b32 v89, 0xffff, v89
    v_cmp_le_u32 vcc, s47, v89
    v_mad_u32_u24 v89, v114, s46, v89
    v_perm_b32 v116, v89, v57, s45
    v_cndmask_b32 v116, v116, -1, vcc
    v_mov_b32 v117, 1
    s_and_saveexec_b64 s[62:63], vcc
    s_cbranch_execz L_sk_12
    buffer_atomic_add v117, v119, s[36:39], 0 offen sc0
    s_waitcnt vmcnt(0)
    v_lshlrev_b32 v117, 3, v117
    buffer_store_dwordx2 v[56:57], v117, s[32:35], 0 offen
    s_waitcnt vmcnt(0)
L_sk_12:
    s_mov_b64 exec, s[62:63]
    v_mov_b32 v57, v116
    ds_write_b64 v115, v[56:57] offset:16384

    v_lshrrev_b32 v114, 8, v59
    ds_read_b32 v115, v114 offset:8192
    s_waitcnt lgkmcnt(0)
    v_add_u32 v90, v115, v90
    v_lshlrev_b32_sdwa v115, 3, v90 dst_sel:DWORD dst_unused:UNUSED_PAD src0_sel:DWORD src1_sel:WORD_1
    v_and_b32 v90, 0xffff, v90
    v_cmp_le_u32 vcc, s47, v90
    v_mad_u32_u24 v90, v114, s46, v90
    v_perm_b32 v116, v90, v59, s45
    v_cndmask_b32 v116, v116, -1, vcc
    v_mov_b32 v117, 1
    s_and_saveexec_b64 s[62:63], vcc
    s_cbranch_execz L_sk_13
    buffer_atomic_add v117, v119, s[36:39], 0 offen sc0
    s_waitcnt vmcnt(0)
    v_lshlrev_b32 v117, 3, v117
    buffer_store_dwordx2 v[58:59], v117, s[32:35], 0 offen
    s_waitcnt vmcnt(0)
L_sk_13:
    s_mov_b64 exec, s[62:63]
    v_mov_b32 v59, v116
    ds_write_b64 v115, v[58:59] offset:16384

    v_lshrrev_b32 v114, 8, v61
    ds_read_b32 v115, v114 offset:8192
    s_waitcnt lgkmcnt(0)
    v_add_u32 v91, v115, v91
    v_lshlrev_b32_sdwa v115, 3, v91 dst_sel:DWORD dst_unused:UNUSED_PAD src0_sel:DWORD src1_sel:WORD_1
    v_and_b32 v91, 0xffff, v91
    v_cmp_le_u32 vcc, s47, v91
    v_mad_u32_u24 v91, v114, s46, v91
    v_perm_b32 v116, v91, v61, s45
    v_cndmask_b32 v116, v116, -1, vcc
    v_mov_b32 v117, 1
    s_and_saveexec_b64 s[62:63], vcc
    s_cbranch_execz L_sk_14
    buffer_atomic_add v117, v119, s[36:39], 0 offen sc0
    s_waitcnt vmcnt(0)
    v_lshlrev_b32 v117, 3, v117
    buffer_store_dwordx2 v[60:61], v117, s[32:35], 0 offen
    s_waitcnt vmcnt(0)
L_sk_14:
    s_mov_b64 exec, s[62:63]
    v_mov_b32 v61, v116
    ds_write_b64 v115, v[60:61] offset:16384

    v_lshrrev_b32 v114, 8, v63
    ds_read_b32 v115, v114 offset:8192
    s_waitcnt lgkmcnt(0)
    v_add_u32 v92, v115, v92
    v_lshlrev_b32_sdwa v115, 3, v92 dst_sel:DWORD dst_unused:UNUSED_PAD src0_sel:DWORD src1_sel:WORD_1
    v_and_b32 v92, 0xffff, v92
    v_cmp_le_u32 vcc, s47, v92
    v_mad_u32_u24 v92, v114, s46, v92
    v_perm_b32 v116, v92, v63, s45
    v_cndmask_b32 v116, v116, -1, vcc
    v_mov_b32 v117, 1
    s_and_saveexec_b64 s[62:63], vcc
    s_cbranch_execz L_sk_15
    buffer_atomic_add v117, v119, s[36:39], 0 offen sc0
    s_waitcnt vmcnt(0)
    v_lshlrev_b32 v117, 3, v117
    buffer_store_dwordx2 v[62:63], v117, s[32:35], 0 offen
    s_waitcnt vmcnt(0)
L_sk_15:
    s_mov_b64 exec, s[62:63]
    v_mov_b32 v63, v116
    ds_write_b64 v115, v[62:63] offset:16384

    v_lshrrev_b32 v114, 8, v65
    ds_read_b32 v115, v114 offset:8192
    s_waitcnt lgkmcnt(0)
    v_add_u32 v93, v115, v93
    v_lshlrev_b32_sdwa v115, 3, v93 dst_sel:DWORD dst_unused:UNUSED_PAD src0_sel:DWORD src1_sel:WORD_1
    v_and_b32 v93, 0xffff, v93
    v_cmp_le_u32 vcc, s47, v93
    v_mad_u32_u24 v93, v114, s46, v93
    v_perm_b32 v116, v93, v65, s45
    v_cndmask_b32 v116, v116, -1, vcc
    v_mov_b32 v117, 1
    s_and_saveexec_b64 s[62:63], vcc
    s_cbranch_execz L_sk_16
    buffer_atomic_add v117, v119, s[36:39], 0 offen sc0
    s_waitcnt vmcnt(0)
    v_lshlrev_b32 v117, 3, v117
    buffer_store_dwordx2 v[64:65], v117, s[32:35], 0 offen
    s_waitcnt vmcnt(0)
L_sk_16:
    s_mov_b64 exec, s[62:63]
    v_mov_b32 v65, v116
    ds_write_b64 v115, v[64:65] offset:16384

    v_lshrrev_b32 v114, 8, v67
    ds_read_b32 v115, v114 offset:8192
    s_waitcnt lgkmcnt(0)
    v_add_u32 v94, v115, v94
    v_lshlrev_b32_sdwa v115, 3, v94 dst_sel:DWORD dst_unused:UNUSED_PAD src0_sel:DWORD src1_sel:WORD_1
    v_and_b32 v94, 0xffff, v94
    v_cmp_le_u32 vcc, s47, v94
    v_mad_u32_u24 v94, v114, s46, v94
    v_perm_b32 v116, v94, v67, s45
    v_cndmask_b32 v116, v116, -1, vcc
    v_mov_b32 v117, 1
    s_and_saveexec_b64 s[62:63], vcc
    s_cbranch_execz L_sk_17
    buffer_atomic_add v117, v119, s[36:39], 0 offen sc0
    s_waitcnt vmcnt(0)
    v_lshlrev_b32 v117, 3, v117
    buffer_store_dwordx2 v[66:67], v117, s[32:35], 0 offen
    s_waitcnt vmcnt(0)
L_sk_17:
    s_mov_b64 exec, s[62:63]
    v_mov_b32 v67, v116
    ds_write_b64 v115, v[66:67] offset:16384

    v_lshrrev_b32 v114, 8, v69
    ds_read_b32 v115, v114 offset:8192
    s_waitcnt lgkmcnt(0)
    v_add_u32 v95, v115, v95
    v_lshlrev_b32_sdwa v115, 3, v95 dst_sel:DWORD dst_unused:UNUSED_PAD src0_sel:DWORD src1_sel:WORD_1
    v_and_b32 v95, 0xffff, v95
    v_cmp_le_u32 vcc, s47, v95
    v_mad_u32_u24 v95, v114, s46, v95
    v_perm_b32 v116, v95, v69, s45
    v_cndmask_b32 v116, v116, -1, vcc
    v_mov_b32 v117, 1
    s_and_saveexec_b64 s[62:63], vcc
    s_cbranch_execz L_sk_18
    buffer_atomic_add v117, v119, s[36:39], 0 offen sc0
    s_waitcnt vmcnt(0)
    v_lshlrev_b32 v117, 3, v117
    buffer_store_dwordx2 v[68:69], v117, s[32:35], 0 offen
    s_waitcnt vmcnt(0)
L_sk_18:
    s_mov_b64 exec, s[62:63]
    v_mov_b32 v69, v116
    ds_write_b64 v115, v[68:69] offset:16384

    v_lshrrev_b32 v114, 8, v71
    ds_read_b32 v115, v114 offset:8192
    s_waitcnt lgkmcnt(0)
    v_add_u32 v96, v115, v96
    v_lshlrev_b32_sdwa v115, 3, v96 dst_sel:DWORD dst_unused:UNUSED_PAD src0_sel:DWORD src1_sel:WORD_1
    v_and_b32 v96, 0xffff, v96
    v_cmp_le_u32 vcc, s47, v96
    v_mad_u32_u24 v96, v114, s46, v96
    v_perm_b32 v116, v96, v71, s45
    v_cndmask_b32 v116, v116, -1, vcc
    v_mov_b32 v117, 1
    s_and_saveexec_b64 s[62:63], vcc
    s_cbranch_execz L_sk_19
    buffer_atomic_add v117, v119, s[36:39], 0 offen sc0
    s_waitcnt vmcnt(0)
    v_lshlrev_b32 v117, 3, v117
    buffer_store_dwordx2 v[70:71], v117, s[32:35], 0 offen
    s_waitcnt vmcnt(0)
L_sk_19:
    s_mov_b64 exec, s[62:63]
    v_mov_b32 v71, v116
    ds_write_b64 v115, v[70:71] offset:16384

    v_lshrrev_b32 v114, 8, v73
    ds_read_b32 v115, v114 offset:8192
    s_waitcnt lgkmcnt(0)
    v_add_u32 v97, v115, v97
    v_lshlrev_b32_sdwa v115, 3, v97 dst_sel:DWORD dst_unused:UNUSED_PAD src0_sel:DWORD src1_sel:WORD_1
    v_and_b32 v97, 0xffff, v97
    v_cmp_le_u32 vcc, s47, v97
    v_mad_u32_u24 v97, v114, s46, v97
    v_perm_b32 v116, v97, v73, s45
    v_cndmask_b32 v116, v116, -1, vcc
    v_mov_b32 v117, 1
    s_and_saveexec_b64 s[62:63], vcc
    s_cbranch_execz L_sk_20
    buffer_atomic_add v117, v119, s[36:39], 0 offen sc0
    s_waitcnt vmcnt(0)
    v_lshlrev_b32 v117, 3, v117
    buffer_store_dwordx2 v[72:73], v117, s[32:35], 0 offen
    s_waitcnt vmcnt(0)
L_sk_20:
    s_mov_b64 exec, s[62:63]
    v_mov_b32 v73, v116
    ds_write_b64 v115, v[72:73] offset:16384

    v_lshrrev_b32 v114, 8, v75
    ds_read_b32 v115, v114 offset:8192
    s_waitcnt lgkmcnt(0)
    v_add_u32 v98, v115, v98
    v_lshlrev_b32_sdwa v115, 3, v98 dst_sel:DWORD dst_unused:UNUSED_PAD src0_sel:DWORD src1_sel:WORD_1
    v_and_b32 v98, 0xffff, v98
    v_cmp_le_u32 vcc, s47, v98
    v_mad_u32_u24 v98, v114, s46, v98
    v_perm_b32 v116, v98, v75, s45
    v_cndmask_b32 v116, v116, -1, vcc
    v_mov_b32 v117, 1
    s_and_saveexec_b64 s[62:63], vcc
    s_cbranch_execz L_sk_21
    buffer_atomic_add v117, v119, s[36:39], 0 offen sc0
    s_waitcnt vmcnt(0)
    v_lshlrev_b32 v117, 3, v117
    buffer_store_dwordx2 v[74:75], v117, s[32:35], 0 offen
    s_waitcnt vmcnt(0)
L_sk_21:
    s_mov_b64 exec, s[62:63]
    v_mov_b32 v75, v116
    ds_write_b64 v115, v[74:75] offset:16384

    v_lshrrev_b32 v114, 8, v77
    ds_read_b32 v115, v114 offset:8192
    s_waitcnt lgkmcnt(0)
    v_add_u32 v99, v115, v99
    v_lshlrev_b32_sdwa v115, 3, v99 dst_sel:DWORD dst_unused:UNUSED_PAD src0_sel:DWORD src1_sel:WORD_1
    v_and_b32 v99, 0xffff, v99
    v_cmp_le_u32 vcc, s47, v99
    v_mad_u32_u24 v99, v114, s46, v99
    v_perm_b32 v116, v99, v77, s45
    v_cndmask_b32 v116, v116, -1, vcc
    v_mov_b32 v117, 1
    s_and_saveexec_b64 s[62:63], vcc
    s_cbranch_execz L_sk_22
    buffer_atomic_add v117, v119, s[36:39], 0 offen sc0
    s_waitcnt vmcnt(0)
    v_lshlrev_b32 v117, 3, v117
    buffer_store_dwordx2 v[76:77], v117, s[32:35], 0 offen
    s_waitcnt vmcnt(0)
L_sk_22:
    s_mov_b64 exec, s[62:63]
    v_mov_b32 v77, v116
    ds_write_b64 v115, v[76:77] offset:16384

    v_lshrrev_b32 v114, 8, v79
    ds_read_b32 v115, v114 offset:8192
    s_waitcnt lgkmcnt(0)
    v_add_u32 v100, v115, v100
    v_lshlrev_b32_sdwa v115, 3, v100 dst_sel:DWORD dst_unused:UNUSED_PAD src0_sel:DWORD src1_sel:WORD_1
    v_and_b32 v100, 0xffff, v100
    v_cmp_le_u32 vcc, s47, v100
    v_mad_u32_u24 v100, v114, s46, v100
    v_perm_b32 v116, v100, v79, s45
    v_cndmask_b32 v116, v116, -1, vcc
    v_mov_b32 v117, 1
    s_and_saveexec_b64 s[62:63], vcc
    s_cbranch_execz L_sk_23
    buffer_atomic_add v117, v119, s[36:39], 0 offen sc0
    s_waitcnt vmcnt(0)
    v_lshlrev_b32 v117, 3, v117
    buffer_store_dwordx2 v[78:79], v117, s[32:35], 0 offen
    s_waitcnt vmcnt(0)
L_sk_23:
    s_mov_b64 exec, s[62:63]
    v_mov_b32 v79, v116
    ds_write_b64 v115, v[78:79] offset:16384

    v_lshrrev_b32 v114, 8, v81
    ds_read_b32 v115, v114 offset:8192
    s_waitcnt lgkmcnt(0)
    v_add_u32 v101, v115, v101
    v_lshlrev_b32_sdwa v115, 3, v101 dst_sel:DWORD dst_unused:UNUSED_PAD src0_sel:DWORD src1_sel:WORD_1
    v_and_b32 v101, 0xffff, v101
    v_cmp_le_u32 vcc, s47, v101
    v_mad_u32_u24 v101, v114, s46, v101
    v_perm_b32 v116, v101, v81, s45
    v_cndmask_b32 v116, v116, -1, vcc
    v_mov_b32 v117, 1
    s_and_saveexec_b64 s[62:63], vcc
    s_cbranch_execz L_sk_24
    buffer_atomic_add v117, v119, s[36:39], 0 offen sc0
    s_waitcnt vmcnt(0)
    v_lshlrev_b32 v117, 3, v117
    buffer_store_dwordx2 v[80:81], v117, s[32:35], 0 offen
    s_waitcnt vmcnt(0)
L_sk_24:
    s_mov_b64 exec, s[62:63]
    v_mov_b32 v81, v116
    ds_write_b64 v115, v[80:81] offset:16384

    s_mov_b64 exec, s[60:61]
    v_lshrrev_b32 v114, 8, v83
    ds_read_b32 v115, v114 offset:8192
    s_waitcnt lgkmcnt(0)
    v_add_u32 v102, v115, v102
    v_lshlrev_b32_sdwa v115, 3, v102 dst_sel:DWORD dst_unused:UNUSED_PAD src0_sel:DWORD src1_sel:WORD_1
    v_and_b32 v102, 0xffff, v102
    v_cmp_le_u32 vcc, s47, v102
    v_mad_u32_u24 v102, v114, s46, v102
    v_perm_b32 v116, v102, v83, s45
    v_cndmask_b32 v116, v116, -1, vcc
    v_mov_b32 v117, 1
    s_and_saveexec_b64 s[62:63], vcc
    s_cbranch_execz L_sk_25
    buffer_atomic_add v117, v119, s[36:39], 0 offen sc0
    s_waitcnt vmcnt(0)
    v_lshlrev_b32 v117, 3, v117
    buffer_store_dwordx2 v[82:83], v117, s[32:35], 0 offen
    s_waitcnt vmcnt(0)
L_sk_25:
    s_mov_b64 exec, s[62:63]
    v_mov_b32 v83, v116
    ds_write_b64 v115, v[82:83] offset:16384

    v_lshrrev_b32 v114, 8, v85
    ds_read_b32 v115, v114 offset:8192
    s_waitcnt lgkmcnt(0)
    v_add_u32 v103, v115, v103
    v_lshlrev_b32_sdwa v115, 3, v103 dst_sel:DWORD dst_unused:UNUSED_PAD src0_sel:DWORD src1_sel:WORD_1
    v_and_b32 v103, 0xffff, v103
    v_cmp_le_u32 vcc, s47, v103
    v_mad_u32_u24 v103, v114, s46, v103
    v_perm_b32 v116, v103, v85, s45
    v_cndmask_b32 v116, v116, -1, vcc
    v_mov_b32 v117, 1
    s_and_saveexec_b64 s[62:63], vcc
    s_cbranch_execz L_sk_26
    buffer_atomic_add v117, v119, s[36:39], 0 offen sc0
    s_waitcnt vmcnt(0)
    v_lshlrev_b32 v117, 3, v117
    buffer_store_dwordx2 v[84:85], v117, s[32:35], 0 offen
    s_waitcnt vmcnt(0)
L_sk_26:
    s_mov_b64 exec, s[62:63]
    v_mov_b32 v85, v116
    ds_write_b64 v115, v[84:85] offset:16384

    s_branch L_join_8
.globl g2_kernel
.p2align 8
.type g2_kernel,@function
g2_kernel:
    s_cmp_ge_u32 s2, 256
    s_cbranch_scc1 L_p2done_27
    s_load_dwordx2 s[52:53], s[0:1], 0
    s_load_dwordx2 s[6:7], s[0:1], 104
    v_lshrrev_b32 v2, 6, v0
    v_lshlrev_b32 v3, 2, v0
    s_lshr_b32 s41, s2, 2
    s_and_b32 s41, s41, 1
    s_lshr_b32 s40, s2, 3
    s_lshl_b32 s40, s40, 2
    s_and_b32 s3, s2, 3
    s_or_b32 s40, s40, s3
    v_readfirstlane_b32 s4, v2
    s_waitcnt lgkmcnt(0)
    s_lshr_b32 s43, s4, 1
    s_and_b32 s44, s4, 1

    s_add_u32 s24, s6, 135168
    s_addc_u32 s25, s7, 0
    s_mov_b32 s26, 4096
    s_mov_b32 s27, 0x20000
    buffer_load_dword v4, v3, s[24:27], 0 offen
    s_mul_i32 s3, s41, 12800000
    s_mul_i32 s5, s40, 100000
    s_add_u32 s3, s3, s5
    s_add_u32 s3, s3, 1048576

    s_add_u32 s20, s6, s3
    s_addc_u32 s21, s7, 0
    s_mov_b32 s22, 100000
    s_mov_b32 s23, 0x20000
    s_mul_i32 s3, s43, 32505856
    s_add_u32 s3, s3, 27262976
    s_add_u32 s48, s6, s3
    s_addc_u32 s49, s7, 0
    s_mul_i32 s3, s43, 8126464
    s_add_u32 s3, s3, 287309824
    s_add_u32 s50, s6, s3
    s_addc_u32 s51, s7, 0
    s_mul_i32 s3, s43, 8192
    s_add_u32 s64, s6, s3
    s_addc_u32 s65, s7, 0
    s_mov_b32 s15, 0x20000
    s_mov_b32 s19, 0x20000
    s_mov_b32 s11, 0x20000
    s_mov_b32 s32, 0x4b400000
    s_mov_b32 s33, 0x4b400000
    s_mov_b32 s34, 0xb4c00000
    s_mov_b32 s35, 0xb4bfffff
    s_movk_i32 s36, 0x7ff
    s_mov_b32 s38, 0xffff0000
    s_mov_b32 s46, 0
    s_mov_b32 s66, 66060288

    s_mov_b32 s28, 0xc0c0400
    s_mov_b32 s29, 0xc0c0401
    s_mov_b32 s30, 0xc0c0402
    s_mov_b32 s31, 0xc0c0403
    v_mov_b32 v108, 0
    v_mov_b32 v109, 0
    v_mov_b32 v110, 0
    v_mov_b32 v111, 0
    v_lshlrev_b32 v112, 4, v0
    v_add_u32 v112, 61440, v112
    v_add_u32 v113, 65536, v112

    ds_write_b128 v112, v[108:111] offset:0
    ds_write_b128 v112, v[108:111] offset:16384
    ds_write_b128 v112, v[108:111] offset:32768
    ds_write_b128 v112, v[108:111] offset:49152
    ds_write_b128 v113, v[108:111] offset:0
    ds_write_b128 v113, v[108:111] offset:16384
    v_cmp_gt_u32 vcc, 107, v0
    s_mov_b64 exec, vcc
    ds_write_b128 v113, v[108:111] offset:32768
    s_mov_b64 exec, -1
    v_mov_b32 v114, 161456
    ds_write_b64 v114, v[108:109]
    s_waitcnt vmcnt(0)

    s_nop 1
    v_max_u32_dpp v4, v4, v4 row_shr:1 row_mask:0xf bank_mask:0xf
    s_nop 1
    v_max_u32_dpp v4, v4, v4 row_shr:2 row_mask:0xf bank_mask:0xf
    s_nop 1
    v_max_u32_dpp v4, v4, v4 row_shr:4 row_mask:0xf bank_mask:0xf
    s_nop 1
    v_max_u32_dpp v4, v4, v4 row_shr:8 row_mask:0xf bank_mask:0xf
    s_nop 1
    v_max_u32_dpp v4, v4, v4 row_bcast:15 row_mask:0xa bank_mask:0xf
    s_nop 1
    v_max_u32_dpp v4, v4, v4 row_bcast:31 row_mask:0xc bank_mask:0xf
    s_waitcnt lgkmcnt(0)
    s_barrier
    s_mov_b32 exec_lo, 0
    s_brev_b32 exec_hi, 1
    ds_max_u32 v114, v4
    s_mov_b64 exec, -1
    s_waitcnt lgkmcnt(0)
    s_barrier
    ds_read_b32 v4, v114
    s_waitcnt lgkmcnt(0)
    v_readfirstlane_b32 s3, v4
    s_nop 1
    s_lshr_b32 s3, s3, 7
    s_max_u32 s3, s3, 27
    s_sub_u32 s5, 281, s3
    s_lshl_b32 s5, s5, 23
    v_mov_b32 v1, s5
    s_or_b32 s37, s5, 1024
    s_sub_u32 s3, s3, 4
    s_lshl_b32 s3, s3, 23
    v_mov_b32 v4, 0x3a802008
    v_mul_f32 v4, s3, v4
    s_nop 0
    v_readfirstlane_b32 s39, v4

    s_mov_b32 s42, 0
L_batch_28:
    s_mul_i32 s54, s41, 8
    s_add_u32 s54, s54, s42
    s_lshl_b32 s47, s54, 7
    s_add_u32 s47, s47, s40
    s_lshl_b32 s55, s47, 2
    s_load_dword s45, s[64:65], s55
    s_mul_i32 s56, s54, 400000
    s_add_u32 s8, s52, s56
    s_addc_u32 s9, s53, 0
    s_sub_u32 s10, 6400000, s56
    s_mul_i32 s56, s47, 15872
    s_add_u32 s12, s48, s56
    s_addc_u32 s13, s49, 0
    s_mul_i32 s56, s47, 3968
    s_add_u32 s16, s50, s56
    s_addc_u32 s17, s51, 0
    s_mov_b32 s18, 3968
    s_waitcnt lgkmcnt(0)
    s_min_u32 s45, s45, 3968
    s_lshl_b32 s14, s45, 2

    s_lshl_b32 s57, s44, 6
    s_add_u32 s57, s57, 0
    v_and_b32 v116, 63, v0
    v_add_u32 v116, s57, v116
L_left_29:
    s_cmp_ge_u32 s57, s45
    s_cbranch_scc1 L_leftend_30
    v_lshlrev_b32 v117, 2, v116
    buffer_load_dword v118, v117, s[12:15], 0 offen
    buffer_load_ubyte v119, v116, s[16:19], 0 offen
    s_waitcnt vmcnt(1)
    v_lshlrev_b32_sdwa v117, 3, v118 dst_sel:DWORD dst_unused:UNUSED_PAD src0_sel:DWORD src1_sel:WORD_1
    buffer_load_dwordx2 v[120:121], v117, s[8:11], 0 offen
    v_cmp_gt_u32 vcc, s45, v116
    s_waitcnt vmcnt(0)
    s_mov_b64 exec, vcc

    v_perm_b32 v112, v118, v119, s28
    v_and_b32 v114, 0xfff8, v118
    v_and_or_b32 v112, v112, s36, v1
    v_lshlrev_b32 v108, 16, v120
    v_and_b32 v109, s38, v120
    v_subrev_f32 v112, s37, v112
    v_lshlrev_b32 v110, 16, v121
    v_and_b32 v111, s38, v121
    v_pk_fma_f32 v[108:109], v[108:109], v[112:113], s[32:33] op_sel_hi:[1,0,1]
    v_pk_fma_f32 v[110:111], v[110:111], v[112:113], s[32:33] op_sel_hi:[1,0,1]
    v_add_u32 v115, 50008, v114
    v_lshl_add_u64 v[108:109], v[108:109], 0, s[34:35]
    v_lshl_add_u64 v[110:111], v[110:111], 0, s[34:35]
    ds_add_u64 v114, v[108:109] offset:61440
    ds_add_u64 v115, v[110:111] offset:61440

    s_mov_b64 exec, -1
    v_add_u32 v116, 128, v116
    s_add_u32 s57, s57, 128
    s_branch L_left_29
L_leftend_30:

    s_add_u32 s42, s42, 1
    s_and_b32 s54, s42, 1
    s_cbranch_scc1 L_nochk_31

    s_waitcnt lgkmcnt(0)
    s_barrier
    v_lshlrev_b32 v116, 3, v0
    v_add_u32 v117, 50008, v116
    v_mov_b32 v118, 0
    v_mov_b32 v119, 0

    ds_read_b64 v[108:109], v116 offset:61448
    ds_read_b64 v[110:111], v117 offset:61448
    s_waitcnt lgkmcnt(0)
    v_max3_i32 v118, v108, v109, v118
    v_min3_i32 v119, v108, v109, v119
    v_max3_i32 v118, v110, v111, v118
    v_min3_i32 v119, v110, v111, v119

    v_add_u32 v116, 69640, v116
    v_add_u32 v117, 69640, v117
    ds_read_b64 v[112:113], v116 offset:0
    ds_read_b64 v[114:115], v117 offset:0
    s_waitcnt lgkmcnt(0)
    v_max3_i32 v118, v112, v113, v118
    v_min3_i32 v119, v112, v113, v119
    v_max3_i32 v118, v114, v115, v118
    v_min3_i32 v119, v114, v115, v119

    ds_read_b64 v[108:109], v116 offset:8192
    ds_read_b64 v[110:111], v117 offset:8192
    s_waitcnt lgkmcnt(0)
    v_max3_i32 v118, v108, v109, v118
    v_min3_i32 v119, v108, v109, v119
    v_max3_i32 v118, v110, v111, v118
    v_min3_i32 v119, v110, v111, v119

    ds_read_b64 v[112:113], v116 offset:16384
    ds_read_b64 v[114:115], v117 offset:16384
    s_waitcnt lgkmcnt(0)
    v_max3_i32 v118, v112, v113, v118
    v_min3_i32 v119, v112, v113, v119
    v_max3_i32 v118, v114, v115, v118
    v_min3_i32 v119, v114, v115, v119

    ds_read_b64 v[108:109], v116 offset:24576
    ds_read_b64 v[110:111], v117 offset:24576
    s_waitcnt lgkmcnt(0)
    v_max3_i32 v118, v108, v109, v118
    v_min3_i32 v119, v108, v109, v119
    v_max3_i32 v118, v110, v111, v118
    v_min3_i32 v119, v110, v111, v119

    ds_read_b64 v[112:113], v116 offset:32768
    ds_read_b64 v[114:115], v117 offset:32768
    s_waitcnt lgkmcnt(0)
    v_max3_i32 v118, v112, v113, v118
    v_min3_i32 v119, v112, v113, v119
    v_max3_i32 v118, v114, v115, v118
    v_min3_i32 v119, v114, v115, v119

    v_cmp_gt_u32 vcc, 106, v0
    s_mov_b64 exec, vcc
    ds_read_b64 v[108:109], v116 offset:40960
    ds_read_b64 v[110:111], v117 offset:40960
    s_waitcnt lgkmcnt(0)
    v_max3_i32 v118, v108, v109, v118
    v_min3_i32 v119, v108, v109, v119
    v_max3_i32 v118, v110, v111, v118
    v_min3_i32 v119, v110, v111, v119

    s_mov_b64 exec, -1
    v_not_b32 v119, v119
    v_max_i32 v118, v118, v119
    v_cmp_lt_i32 vcc, s66, v118
    v_mov_b32 v120, 161460
    v_mov_b32 v121, 1
    s_cbranch_vccz L_nf_33
    ds_write_b32 v120, v121
L_nf_33:
    s_waitcnt lgkmcnt(0)
    s_barrier
    ds_read_b32 v121, v120
    s_waitcnt lgkmcnt(0)
    v_readfirstlane_b32 s55, v121
    s_nop 1
    s_cmp_eq_u32 s55, 0
    s_cbranch_scc1 L_ok_32
    s_barrier
    v_mov_b32 v121, 0
    ds_write_b32 v120, v121

    s_mov_b32 s54, 0
    v_lshlrev_b32 v120, 3, v0
    v_lshlrev_b32 v121, 4, v0
    v_mov_b32 v122, v0
L_fl_34:
    v_cmp_gt_u32 vcc, 6250, v122
    v_add_u32 v123, 50008, v120
    v_mov_b32 v116, 0
    v_mov_b32 v117, 0
    v_mov_b32 v118, 0
    v_mov_b32 v119, 0
    s_cmp_eq_u32 s46, 0
    s_cbranch_scc1 L_nold_35
    buffer_load_dwordx4 v[116:119], v121, s[20:23], 0 offen sc1
    s_waitcnt vmcnt(0)
L_nold_35:
    s_mov_b64 exec, vcc
    ds_read_b64 v[108:109], v120 offset:61448
    ds_read_b64 v[110:111], v123 offset:61448
    s_mov_b64 exec, -1
    s_waitcnt lgkmcnt(0)
    v_ashrrev_i32 v112, 31, v108
    v_ashrrev_i32 v113, 31, v110
    v_sub_u32 v109, v109, v112
    v_sub_u32 v111, v111, v113
    v_cvt_f32_i32 v108, v108
    v_cvt_f32_i32 v109, v109
    v_cvt_f32_i32 v110, v110
    v_cvt_f32_i32 v111, v111
    v_fma_f32 v112, v108, s39, v116
    v_fma_f32 v113, v109, s39, v117
    v_fma_f32 v114, v110, s39, v118
    v_fma_f32 v115, v111, s39, v119
    buffer_store_dwordx4 v[112:115], v121, s[20:23], 0 offen
    v_add_u32 v120, 8192, v120
    v_add_u32 v121, 16384, v121
    v_add_u32 v122, 1024, v122
    s_add_u32 s54, s54, 1
    s_cmp_lt_u32 s54, 7
    s_cbranch_scc1 L_fl_34

    s_waitcnt vmcnt(0)
    s_barrier
    s_mov_b32 s46, 1
    v_mov_b32 v108, 0
    v_mov_b32 v109, 0
    v_mov_b32 v110, 0
    v_mov_b32 v111, 0
    v_lshlrev_b32 v112, 4, v0
    v_add_u32 v112, 61440, v112
    v_add_u32 v113, 65536, v112

    ds_write_b128 v112, v[108:111] offset:0
    ds_write_b128 v112, v[108:111] offset:16384
    ds_write_b128 v112, v[108:111] offset:32768
    ds_write_b128 v112, v[108:111] offset:49152
    ds_write_b128 v113, v[108:111] offset:0
    ds_write_b128 v113, v[108:111] offset:16384
    v_cmp_gt_u32 vcc, 107, v0
    s_mov_b64 exec, vcc
    ds_write_b128 v113, v[108:111] offset:32768
    s_mov_b64 exec, -1
    s_waitcnt lgkmcnt(0)
    s_barrier
L_ok_32:
L_nochk_31:
    s_cmp_lt_u32 s42, 8
    s_cbranch_scc1 L_batch_28

    s_add_u32 s58, s6, 131072
    s_addc_u32 s59, s7, 0
    s_load_dword s45, s[58:59], 0

    s_add_u32 s24, s6, 352321536
    s_addc_u32 s25, s7, 0
    s_mov_b32 s26, 409600000
    s_mov_b32 s27, 0x20000
    s_mov_b32 s8, s52
    s_mov_b32 s9, s53
    s_mov_b32 s10, 6400000
    s_mov_b32 s11, 0x20000
    s_mov_b32 s42, 0
    s_mul_i32 s47, s41, 8
    s_mov_b32 s60, 50000
    v_mov_b32 v2, v0
    s_waitcnt lgkmcnt(0)
L_ovf_36:
    s_cmp_ge_u32 s42, s45
    s_cbranch_scc1 L_ovfend_37
    v_lshlrev_b32 v117, 3, v2
    buffer_load_dwordx2 v[118:119], v117, s[24:27], 0 offen
    s_waitcnt vmcnt(0)
    v_bfe_u32 v122, v119, 10, 7
    v_lshrrev_b32 v123, 17, v119
    v_lshrrev_b32 v117, 16, v118
    v_and_b32 v123, 63, v123
    v_mad_u32_u24 v117, v123, s60, v117
    v_lshlrev_b32 v117, 3, v117
    buffer_load_dwordx2 v[120:121], v117, s[8:11], 0 offen
    v_subrev_u32 v123, s47, v123
    v_cmp_gt_u32 vcc, s45, v2
    v_cmp_eq_u32 s[62:63], s40, v122
    s_and_b64 vcc, vcc, s[62:63]
    v_cmp_gt_u32 s[62:63], 8, v123
    s_and_b64 vcc, vcc, s[62:63]
    s_waitcnt vmcnt(0)
    s_mov_b64 exec, vcc

    v_perm_b32 v112, v118, v119, s28
    v_and_b32 v114, 0xfff8, v118
    v_and_or_b32 v112, v112, s36, v1
    v_lshlrev_b32 v108, 16, v120
    v_and_b32 v109, s38, v120
    v_subrev_f32 v112, s37, v112
    v_lshlrev_b32 v110, 16, v121
    v_and_b32 v111, s38, v121
    v_pk_fma_f32 v[108:109], v[108:109], v[112:113], s[32:33] op_sel_hi:[1,0,1]
    v_pk_fma_f32 v[110:111], v[110:111], v[112:113], s[32:33] op_sel_hi:[1,0,1]
    v_add_u32 v115, 50008, v114
    v_lshl_add_u64 v[108:109], v[108:109], 0, s[34:35]
    v_lshl_add_u64 v[110:111], v[110:111], 0, s[34:35]
    ds_add_u64 v114, v[108:109] offset:61440
    ds_add_u64 v115, v[110:111] offset:61440

    s_mov_b64 exec, -1
    v_add_u32 v2, 1024, v2
    s_add_u32 s42, s42, 1024
    s_and_b32 s54, s42, 0x7fff
    s_cbranch_scc1 L_ovf_36

    s_waitcnt lgkmcnt(0)
    s_barrier
    v_lshlrev_b32 v116, 3, v0
    v_add_u32 v117, 50008, v116
    v_mov_b32 v118, 0
    v_mov_b32 v119, 0

    ds_read_b64 v[108:109], v116 offset:61448
    ds_read_b64 v[110:111], v117 offset:61448
    s_waitcnt lgkmcnt(0)
    v_max3_i32 v118, v108, v109, v118
    v_min3_i32 v119, v108, v109, v119
    v_max3_i32 v118, v110, v111, v118
    v_min3_i32 v119, v110, v111, v119

    v_add_u32 v116, 69640, v116
    v_add_u32 v117, 69640, v117
    ds_read_b64 v[112:113], v116 offset:0
    ds_read_b64 v[114:115], v117 offset:0
    s_waitcnt lgkmcnt(0)
    v_max3_i32 v118, v112, v113, v118
    v_min3_i32 v119, v112, v113, v119
    v_max3_i32 v118, v114, v115, v118
    v_min3_i32 v119, v114, v115, v119

    ds_read_b64 v[108:109], v116 offset:8192
    ds_read_b64 v[110:111], v117 offset:8192
    s_waitcnt lgkmcnt(0)
    v_max3_i32 v118, v108, v109, v118
    v_min3_i32 v119, v108, v109, v119
    v_max3_i32 v118, v110, v111, v118
    v_min3_i32 v119, v110, v111, v119

    ds_read_b64 v[112:113], v116 offset:16384
    ds_read_b64 v[114:115], v117 offset:16384
    s_waitcnt lgkmcnt(0)
    v_max3_i32 v118, v112, v113, v118
    v_min3_i32 v119, v112, v113, v119
    v_max3_i32 v118, v114, v115, v118
    v_min3_i32 v119, v114, v115, v119

    ds_read_b64 v[108:109], v116 offset:24576
    ds_read_b64 v[110:111], v117 offset:24576
    s_waitcnt lgkmcnt(0)
    v_max3_i32 v118, v108, v109, v118
    v_min3_i32 v119, v108, v109, v119
    v_max3_i32 v118, v110, v111, v118
    v_min3_i32 v119, v110, v111, v119

    ds_read_b64 v[112:113], v116 offset:32768
    ds_read_b64 v[114:115], v117 offset:32768
    s_waitcnt lgkmcnt(0)
    v_max3_i32 v118, v112, v113, v118
    v_min3_i32 v119, v112, v113, v119
    v_max3_i32 v118, v114, v115, v118
    v_min3_i32 v119, v114, v115, v119

    v_cmp_gt_u32 vcc, 106, v0
    s_mov_b64 exec, vcc
    ds_read_b64 v[108:109], v116 offset:40960
    ds_read_b64 v[110:111], v117 offset:40960
    s_waitcnt lgkmcnt(0)
    v_max3_i32 v118, v108, v109, v118
    v_min3_i32 v119, v108, v109, v119
    v_max3_i32 v118, v110, v111, v118
    v_min3_i32 v119, v110, v111, v119

    s_mov_b64 exec, -1
    v_not_b32 v119, v119
    v_max_i32 v118, v118, v119
    v_cmp_lt_i32 vcc, s66, v118
    v_mov_b32 v120, 161460
    v_mov_b32 v121, 1
    s_cbranch_vccz L_nf_40
    ds_write_b32 v120, v121
L_nf_40:
    s_waitcnt lgkmcnt(0)
    s_barrier
    ds_read_b32 v121, v120
    s_waitcnt lgkmcnt(0)
    v_readfirstlane_b32 s55, v121
    s_nop 1
    s_cmp_eq_u32 s55, 0
    s_cbranch_scc1 L_ok_39
    s_barrier
    v_mov_b32 v121, 0
    ds_write_b32 v120, v121

    s_mov_b32 s54, 0
    v_lshlrev_b32 v120, 3, v0
    v_lshlrev_b32 v121, 4, v0
    v_mov_b32 v122, v0
L_fl_41:
    v_cmp_gt_u32 vcc, 6250, v122
    v_add_u32 v123, 50008, v120
    v_mov_b32 v116, 0
    v_mov_b32 v117, 0
    v_mov_b32 v118, 0
    v_mov_b32 v119, 0
    s_cmp_eq_u32 s46, 0
    s_cbranch_scc1 L_nold_42
    buffer_load_dwordx4 v[116:119], v121, s[20:23], 0 offen sc1
    s_waitcnt vmcnt(0)
L_nold_42:
    s_mov_b64 exec, vcc
    ds_read_b64 v[108:109], v120 offset:61448
    ds_read_b64 v[110:111], v123 offset:61448
    s_mov_b64 exec, -1
    s_waitcnt lgkmcnt(0)
    v_ashrrev_i32 v112, 31, v108
    v_ashrrev_i32 v113, 31, v110
    v_sub_u32 v109, v109, v112
    v_sub_u32 v111, v111, v113
    v_cvt_f32_i32 v108, v108
    v_cvt_f32_i32 v109, v109
    v_cvt_f32_i32 v110, v110
    v_cvt_f32_i32 v111, v111
    v_fma_f32 v112, v108, s39, v116
    v_fma_f32 v113, v109, s39, v117
    v_fma_f32 v114, v110, s39, v118
    v_fma_f32 v115, v111, s39, v119
    buffer_store_dwordx4 v[112:115], v121, s[20:23], 0 offen
    v_add_u32 v120, 8192, v120
    v_add_u32 v121, 16384, v121
    v_add_u32 v122, 1024, v122
    s_add_u32 s54, s54, 1
    s_cmp_lt_u32 s54, 7
    s_cbranch_scc1 L_fl_41

    s_waitcnt vmcnt(0)
    s_barrier
    s_mov_b32 s46, 1
    v_mov_b32 v108, 0
    v_mov_b32 v109, 0
    v_mov_b32 v110, 0
    v_mov_b32 v111, 0
    v_lshlrev_b32 v112, 4, v0
    v_add_u32 v112, 61440, v112
    v_add_u32 v113, 65536, v112

    ds_write_b128 v112, v[108:111] offset:0
    ds_write_b128 v112, v[108:111] offset:16384
    ds_write_b128 v112, v[108:111] offset:32768
    ds_write_b128 v112, v[108:111] offset:49152
    ds_write_b128 v113, v[108:111] offset:0
    ds_write_b128 v113, v[108:111] offset:16384
    v_cmp_gt_u32 vcc, 107, v0
    s_mov_b64 exec, vcc
    ds_write_b128 v113, v[108:111] offset:32768
    s_mov_b64 exec, -1
    s_waitcnt lgkmcnt(0)
    s_barrier
L_ok_39:
    s_branch L_ovf_36
L_ovfend_37:
    s_waitcnt lgkmcnt(0)
    s_barrier

    s_mov_b32 s54, 0
    v_lshlrev_b32 v120, 3, v0
    v_lshlrev_b32 v121, 4, v0
    v_mov_b32 v122, v0
L_fl_43:
    v_cmp_gt_u32 vcc, 6250, v122
    v_add_u32 v123, 50008, v120
    v_mov_b32 v116, 0
    v_mov_b32 v117, 0
    v_mov_b32 v118, 0
    v_mov_b32 v119, 0
    s_cmp_eq_u32 s46, 0
    s_cbranch_scc1 L_nold_44
    buffer_load_dwordx4 v[116:119], v121, s[20:23], 0 offen sc1
    s_waitcnt vmcnt(0)
L_nold_44:
    s_mov_b64 exec, vcc
    ds_read_b64 v[108:109], v120 offset:61448
    ds_read_b64 v[110:111], v123 offset:61448
    s_mov_b64 exec, -1
    s_waitcnt lgkmcnt(0)
    v_ashrrev_i32 v112, 31, v108
    v_ashrrev_i32 v113, 31, v110
    v_sub_u32 v109, v109, v112
    v_sub_u32 v111, v111, v113
    v_cvt_f32_i32 v108, v108
    v_cvt_f32_i32 v109, v109
    v_cvt_f32_i32 v110, v110
    v_cvt_f32_i32 v111, v111
    v_fma_f32 v112, v108, s39, v116
    v_fma_f32 v113, v109, s39, v117
    v_fma_f32 v114, v110, s39, v118
    v_fma_f32 v115, v111, s39, v119
    buffer_store_dwordx4 v[112:115], v121, s[20:23], 0 offen
    v_add_u32 v120, 8192, v120
    v_add_u32 v121, 16384, v121
    v_add_u32 v122, 1024, v122
    s_add_u32 s54, s54, 1
    s_cmp_lt_u32 s54, 7
    s_cbranch_scc1 L_fl_43

L_p2done_27:
    s_endpgm

.globl standalone__molecular_angular_gemnet__graph_kernel
.p2align 8
.type standalone__molecular_angular_gemnet__graph_kernel,@function
standalone__molecular_angular_gemnet__graph_kernel:
    s_cmp_ge_u32 s2, 3125
    s_cbranch_scc1 L_fdone_45
    s_load_dwordx2 s[4:5], s[0:1], 0
    s_load_dwordx2 s[6:7], s[0:1], 24
    s_load_dwordx2 s[8:9], s[0:1], 40
    s_load_dwordx8 s[12:19], s[0:1], 56
    s_load_dwordx2 s[10:11], s[0:1], 88
    s_load_dwordx2 s[20:21], s[0:1], 104
    s_lshl_b32 s3, s2, 8
    v_add_u32 v0, s3, v0
    v_lshlrev_b32 v1, 4, v0
    v_lshlrev_b32 v2, 3, v0
    v_lshlrev_b32 v3, 1, v0
    s_waitcnt lgkmcnt(0)
    s_load_dwordx4 s[40:43], s[8:9], 0
    s_load_dwordx16 s[44:59], s[12:13], 0
    s_load_dwordx16 s[60:75], s[14:15], 0
    s_load_dwordx8 s[76:83], s[16:17], 0
    s_load_dwordx8 s[84:91], s[18:19], 0

    s_add_u32 s24, s20, 1048576
    s_addc_u32 s25, s21, 0
    s_mov_b32 s26, 25600000
    s_mov_b32 s27, 0x20000
    s_mov_b32 s28, s4
    s_mov_b32 s29, s5
    s_mov_b32 s30, 6400000
    s_mov_b32 s31, 0x20000
    s_mov_b32 s32, s6
    s_mov_b32 s33, s7
    s_mov_b32 s34, 1600000
    s_mov_b32 s35, 0x20000
    s_mov_b32 s36, s10
    s_mov_b32 s37, s11
    s_mov_b32 s38, 6400000
    s_mov_b32 s39, 0x20000
    s_mov_b32 s3, 12800000
    buffer_load_ushort v4, v3, s[32:35], 0 offen
    buffer_load_dwordx4 v[8:11], v1, s[24:27], 0 offen
    buffer_load_dwordx4 v[12:15], v1, s[24:27], s3 offen
    buffer_load_dwordx2 v[6:7], v2, s[28:31], 0 offen
    s_mov_b32 s94, 0xffff0000
    s_mov_b32 s95, 0xc1200000
    s_mov_b32 s96, 0x3fb8aa3b
    s_waitcnt vmcnt(3) lgkmcnt(0)
    v_lshlrev_b32 v4, 16, v4

    s_lshl_b32 s92, s40, 16
    v_subrev_f32 v16, s92, v4
    s_and_b32 s93, s40, s94
    v_subrev_f32 v17, s93, v4
    s_lshl_b32 s92, s41, 16
    v_subrev_f32 v18, s92, v4
    s_and_b32 s93, s41, s94
    v_subrev_f32 v19, s93, v4
    s_lshl_b32 s92, s42, 16
    v_subrev_f32 v20, s92, v4
    s_and_b32 s93, s42, s94
    v_subrev_f32 v21, s93, v4
    s_lshl_b32 s92, s43, 16
    v_subrev_f32 v22, s92, v4
    s_and_b32 s93, s43, s94
    v_subrev_f32 v23, s93, v4
    v_cvt_pk_bf16_f32 v16, v16, v17
    v_and_b32 v17, s94, v16
    v_lshlrev_b32 v16, 16, v16
    v_cvt_pk_bf16_f32 v18, v18, v19
    v_and_b32 v19, s94, v18
    v_lshlrev_b32 v18, 16, v18
    v_cvt_pk_bf16_f32 v20, v20, v21
    v_and_b32 v21, s94, v20
    v_lshlrev_b32 v20, 16, v20
    v_cvt_pk_bf16_f32 v22, v22, v23
    v_and_b32 v23, s94, v22
    v_lshlrev_b32 v22, 16, v22
    v_mul_f32 v16, v16, v16
    v_mul_f32 v17, v17, v17
    v_mul_f32 v18, v18, v18
    v_mul_f32 v19, v19, v19
    v_mul_f32 v20, v20, v20
    v_mul_f32 v21, v21, v21
    v_mul_f32 v22, v22, v22
    v_mul_f32 v23, v23, v23
    v_cvt_pk_bf16_f32 v16, v16, v17
    v_and_b32 v17, s94, v16
    v_lshlrev_b32 v16, 16, v16
    v_cvt_pk_bf16_f32 v18, v18, v19
    v_and_b32 v19, s94, v18
    v_lshlrev_b32 v18, 16, v18
    v_cvt_pk_bf16_f32 v20, v20, v21
    v_and_b32 v21, s94, v20
    v_lshlrev_b32 v20, 16, v20
    v_cvt_pk_bf16_f32 v22, v22, v23
    v_and_b32 v23, s94, v22
    v_lshlrev_b32 v22, 16, v22
    v_mul_f32 v16, s95, v16
    v_mul_f32 v17, s95, v17
    v_mul_f32 v18, s95, v18
    v_mul_f32 v19, s95, v19
    v_mul_f32 v20, s95, v20
    v_mul_f32 v21, s95, v21
    v_mul_f32 v22, s95, v22
    v_mul_f32 v23, s95, v23
    v_cvt_pk_bf16_f32 v16, v16, v17
    v_and_b32 v17, s94, v16
    v_lshlrev_b32 v16, 16, v16
    v_cvt_pk_bf16_f32 v18, v18, v19
    v_and_b32 v19, s94, v18
    v_lshlrev_b32 v18, 16, v18
    v_cvt_pk_bf16_f32 v20, v20, v21
    v_and_b32 v21, s94, v20
    v_lshlrev_b32 v20, 16, v20
    v_cvt_pk_bf16_f32 v22, v22, v23
    v_and_b32 v23, s94, v22
    v_lshlrev_b32 v22, 16, v22
    v_mul_f32 v16, s96, v16
    v_mul_f32 v17, s96, v17
    v_mul_f32 v18, s96, v18
    v_mul_f32 v19, s96, v19
    v_mul_f32 v20, s96, v20
    v_mul_f32 v21, s96, v21
    v_mul_f32 v22, s96, v22
    v_mul_f32 v23, s96, v23
    v_exp_f32 v16, v16
    v_exp_f32 v17, v17
    v_exp_f32 v18, v18
    v_exp_f32 v19, v19
    v_exp_f32 v20, v20
    v_exp_f32 v21, v21
    v_exp_f32 v22, v22
    v_exp_f32 v23, v23
    s_nop 0
    v_cvt_pk_bf16_f32 v16, v16, v17
    v_and_b32 v17, s94, v16
    v_lshlrev_b32 v16, 16, v16
    v_cvt_pk_bf16_f32 v18, v18, v19
    v_and_b32 v19, s94, v18
    v_lshlrev_b32 v18, 16, v18
    v_cvt_pk_bf16_f32 v20, v20, v21
    v_and_b32 v21, s94, v20
    v_lshlrev_b32 v20, 16, v20
    v_cvt_pk_bf16_f32 v22, v22, v23
    v_and_b32 v23, s94, v22
    v_lshlrev_b32 v22, 16, v22
    s_lshl_b32 s92, s60, 16
    v_mul_f32 v24, s92, v16
    s_and_b32 s93, s60, s94
    v_mul_f32 v25, s93, v16
    s_lshl_b32 s92, s61, 16
    v_mul_f32 v26, s92, v16
    s_and_b32 s93, s61, s94
    v_mul_f32 v27, s93, v16
    s_lshl_b32 s92, s62, 16
    v_fmac_f32 v24, s92, v17
    s_and_b32 s93, s62, s94
    v_fmac_f32 v25, s93, v17
    s_lshl_b32 s92, s63, 16
    v_fmac_f32 v26, s92, v17
    s_and_b32 s93, s63, s94
    v_fmac_f32 v27, s93, v17
    s_lshl_b32 s92, s64, 16
    v_fmac_f32 v24, s92, v18
    s_and_b32 s93, s64, s94
    v_fmac_f32 v25, s93, v18
    s_lshl_b32 s92, s65, 16
    v_fmac_f32 v26, s92, v18
    s_and_b32 s93, s65, s94
    v_fmac_f32 v27, s93, v18
    s_lshl_b32 s92, s66, 16
    v_fmac_f32 v24, s92, v19
    s_and_b32 s93, s66, s94
    v_fmac_f32 v25, s93, v19
    s_lshl_b32 s92, s67, 16
    v_fmac_f32 v26, s92, v19
    s_and_b32 s93, s67, s94
    v_fmac_f32 v27, s93, v19
    s_lshl_b32 s92, s68, 16
    v_fmac_f32 v24, s92, v20
    s_and_b32 s93, s68, s94
    v_fmac_f32 v25, s93, v20
    s_lshl_b32 s92, s69, 16
    v_fmac_f32 v26, s92, v20
    s_and_b32 s93, s69, s94
    v_fmac_f32 v27, s93, v20
    s_lshl_b32 s92, s70, 16
    v_fmac_f32 v24, s92, v21
    s_and_b32 s93, s70, s94
    v_fmac_f32 v25, s93, v21
    s_lshl_b32 s92, s71, 16
    v_fmac_f32 v26, s92, v21
    s_and_b32 s93, s71, s94
    v_fmac_f32 v27, s93, v21
    s_lshl_b32 s92, s72, 16
    v_fmac_f32 v24, s92, v22
    s_and_b32 s93, s72, s94
    v_fmac_f32 v25, s93, v22
    s_lshl_b32 s92, s73, 16
    v_fmac_f32 v26, s92, v22
    s_and_b32 s93, s73, s94
    v_fmac_f32 v27, s93, v22
    s_lshl_b32 s92, s74, 16
    v_fmac_f32 v24, s92, v23
    s_and_b32 s93, s74, s94
    v_fmac_f32 v25, s93, v23
    s_lshl_b32 s92, s75, 16
    v_fmac_f32 v26, s92, v23
    s_and_b32 s93, s75, s94
    v_fmac_f32 v27, s93, v23
    s_lshl_b32 s92, s44, 16
    v_mul_f32 v28, s92, v16
    s_and_b32 s93, s44, s94
    v_mul_f32 v29, s93, v16
    s_lshl_b32 s92, s45, 16
    v_mul_f32 v30, s92, v16
    s_and_b32 s93, s45, s94
    v_mul_f32 v31, s93, v16
    s_lshl_b32 s92, s46, 16
    v_fmac_f32 v28, s92, v17
    s_and_b32 s93, s46, s94
    v_fmac_f32 v29, s93, v17
    s_lshl_b32 s92, s47, 16
    v_fmac_f32 v30, s92, v17
    s_and_b32 s93, s47, s94
    v_fmac_f32 v31, s93, v17
    s_lshl_b32 s92, s48, 16
    v_fmac_f32 v28, s92, v18
    s_and_b32 s93, s48, s94
    v_fmac_f32 v29, s93, v18
    s_lshl_b32 s92, s49, 16
    v_fmac_f32 v30, s92, v18
    s_and_b32 s93, s49, s94
    v_fmac_f32 v31, s93, v18
    s_lshl_b32 s92, s50, 16
    v_fmac_f32 v28, s92, v19
    s_and_b32 s93, s50, s94
    v_fmac_f32 v29, s93, v19
    s_lshl_b32 s92, s51, 16
    v_fmac_f32 v30, s92, v19
    s_and_b32 s93, s51, s94
    v_fmac_f32 v31, s93, v19
    s_lshl_b32 s92, s52, 16
    v_fmac_f32 v28, s92, v20
    s_and_b32 s93, s52, s94
    v_fmac_f32 v29, s93, v20
    s_lshl_b32 s92, s53, 16
    v_fmac_f32 v30, s92, v20
    s_and_b32 s93, s53, s94
    v_fmac_f32 v31, s93, v20
    s_lshl_b32 s92, s54, 16
    v_fmac_f32 v28, s92, v21
    s_and_b32 s93, s54, s94
    v_fmac_f32 v29, s93, v21
    s_lshl_b32 s92, s55, 16
    v_fmac_f32 v30, s92, v21
    s_and_b32 s93, s55, s94
    v_fmac_f32 v31, s93, v21
    s_lshl_b32 s92, s56, 16
    v_fmac_f32 v28, s92, v22
    s_and_b32 s93, s56, s94
    v_fmac_f32 v29, s93, v22
    s_lshl_b32 s92, s57, 16
    v_fmac_f32 v30, s92, v22
    s_and_b32 s93, s57, s94
    v_fmac_f32 v31, s93, v22
    s_lshl_b32 s92, s58, 16
    v_fmac_f32 v28, s92, v23
    s_and_b32 s93, s58, s94
    v_fmac_f32 v29, s93, v23
    s_lshl_b32 s92, s59, 16
    v_fmac_f32 v30, s92, v23
    s_and_b32 s93, s59, s94
    v_fmac_f32 v31, s93, v23
    v_cvt_pk_bf16_f32 v28, v28, v29
    v_and_b32 v29, s94, v28
    v_lshlrev_b32 v28, 16, v28
    v_cvt_pk_bf16_f32 v30, v30, v31
    v_and_b32 v31, s94, v30
    v_lshlrev_b32 v30, 16, v30
    s_waitcnt vmcnt(1)
    v_add_f32 v8, v8, v12
    v_add_f32 v9, v9, v13
    v_add_f32 v10, v10, v14
    v_add_f32 v11, v11, v15
    s_lshl_b32 s92, s76, 16
    v_mul_f32 v16, s92, v8
    s_and_b32 s93, s76, s94
    v_mul_f32 v17, s93, v8
    s_lshl_b32 s92, s77, 16
    v_mul_f32 v18, s92, v8
    s_and_b32 s93, s77, s94
    v_mul_f32 v19, s93, v8
    s_lshl_b32 s92, s78, 16
    v_fmac_f32 v16, s92, v9
    s_and_b32 s93, s78, s94
    v_fmac_f32 v17, s93, v9
    s_lshl_b32 s92, s79, 16
    v_fmac_f32 v18, s92, v9
    s_and_b32 s93, s79, s94
    v_fmac_f32 v19, s93, v9
    s_lshl_b32 s92, s80, 16
    v_fmac_f32 v16, s92, v10
    s_and_b32 s93, s80, s94
    v_fmac_f32 v17, s93, v10
    s_lshl_b32 s92, s81, 16
    v_fmac_f32 v18, s92, v10
    s_and_b32 s93, s81, s94
    v_fmac_f32 v19, s93, v10
    s_lshl_b32 s92, s82, 16
    v_fmac_f32 v16, s92, v11
    s_and_b32 s93, s82, s94
    v_fmac_f32 v17, s93, v11
    s_lshl_b32 s92, s83, 16
    v_fmac_f32 v18, s92, v11
    s_and_b32 s93, s83, s94
    v_fmac_f32 v19, s93, v11
    v_mul_f32 v16, v16, v24
    v_mul_f32 v17, v17, v25
    v_mul_f32 v18, v18, v26
    v_mul_f32 v19, v19, v27
    v_cvt_pk_bf16_f32 v16, v16, v17
    v_and_b32 v17, s94, v16
    v_lshlrev_b32 v16, 16, v16
    v_cvt_pk_bf16_f32 v18, v18, v19
    v_and_b32 v19, s94, v18
    v_lshlrev_b32 v18, 16, v18
    s_lshl_b32 s92, s84, 16
    v_mul_f32 v20, s92, v16
    s_and_b32 s93, s84, s94
    v_mul_f32 v21, s93, v16
    s_lshl_b32 s92, s85, 16
    v_mul_f32 v22, s92, v16
    s_and_b32 s93, s85, s94
    v_mul_f32 v23, s93, v16
    s_lshl_b32 s92, s86, 16
    v_fmac_f32 v20, s92, v17
    s_and_b32 s93, s86, s94
    v_fmac_f32 v21, s93, v17
    s_lshl_b32 s92, s87, 16
    v_fmac_f32 v22, s92, v17
    s_and_b32 s93, s87, s94
    v_fmac_f32 v23, s93, v17
    s_lshl_b32 s92, s88, 16
    v_fmac_f32 v20, s92, v18
    s_and_b32 s93, s88, s94
    v_fmac_f32 v21, s93, v18
    s_lshl_b32 s92, s89, 16
    v_fmac_f32 v22, s92, v18
    s_and_b32 s93, s89, s94
    v_fmac_f32 v23, s93, v18
    s_lshl_b32 s92, s90, 16
    v_fmac_f32 v20, s92, v19
    s_and_b32 s93, s90, s94
    v_fmac_f32 v21, s93, v19
    s_lshl_b32 s92, s91, 16
    v_fmac_f32 v22, s92, v19
    s_and_b32 s93, s91, s94
    v_fmac_f32 v23, s93, v19
    v_cvt_pk_bf16_f32 v20, v20, v21
    v_and_b32 v21, s94, v20
    v_lshlrev_b32 v20, 16, v20
    v_cvt_pk_bf16_f32 v22, v22, v23
    v_and_b32 v23, s94, v22
    v_lshlrev_b32 v22, 16, v22
    v_mul_f32 v20, v20, v28
    v_mul_f32 v21, v21, v29
    v_mul_f32 v22, v22, v30
    v_mul_f32 v23, v23, v31
    v_cvt_pk_bf16_f32 v20, v20, v21
    v_and_b32 v21, s94, v20
    v_lshlrev_b32 v20, 16, v20
    v_cvt_pk_bf16_f32 v22, v22, v23
    v_and_b32 v23, s94, v22
    v_lshlrev_b32 v22, 16, v22
    s_waitcnt vmcnt(0)
    v_lshlrev_b32 v8, 16, v6
    v_and_b32 v9, s94, v6
    v_lshlrev_b32 v10, 16, v7
    v_and_b32 v11, s94, v7

    v_add_f32 v8, v8, v20
    v_add_f32 v9, v9, v21
    v_add_f32 v10, v10, v22
    v_add_f32 v11, v11, v23
    v_cvt_pk_bf16_f32 v12, v8, v9
    v_cvt_pk_bf16_f32 v13, v10, v11
    buffer_store_dwordx2 v[12:13], v2, s[36:39], 0 offen
L_fdone_45:
    s_endpgm

.section .rodata,"a"
.p2align 6
.amdhsa_kernel g0_kernel
  .amdhsa_next_free_vgpr 40
  .amdhsa_next_free_sgpr 32
  .amdhsa_accum_offset 40
  .amdhsa_group_segment_fixed_size 0
  .amdhsa_kernarg_size 112
  .amdhsa_user_sgpr_count 2
  .amdhsa_user_sgpr_kernarg_segment_ptr 1
  .amdhsa_system_sgpr_workgroup_id_x 1
.end_amdhsa_kernel
.p2align 6
.amdhsa_kernel g1_kernel
  .amdhsa_next_free_vgpr 128
  .amdhsa_next_free_sgpr 80
  .amdhsa_accum_offset 128
  .amdhsa_group_segment_fixed_size 0
  .amdhsa_kernarg_size 112
  .amdhsa_user_sgpr_count 2
  .amdhsa_user_sgpr_kernarg_segment_ptr 1
  .amdhsa_system_sgpr_workgroup_id_x 1
.end_amdhsa_kernel
.p2align 6
.amdhsa_kernel g2_kernel
  .amdhsa_next_free_vgpr 128
  .amdhsa_next_free_sgpr 80
  .amdhsa_accum_offset 128
  .amdhsa_group_segment_fixed_size 0
  .amdhsa_kernarg_size 112
  .amdhsa_user_sgpr_count 2
  .amdhsa_user_sgpr_kernarg_segment_ptr 1
  .amdhsa_system_sgpr_workgroup_id_x 1
.end_amdhsa_kernel
.p2align 6
.amdhsa_kernel standalone__molecular_angular_gemnet__graph_kernel
  .amdhsa_next_free_vgpr 32
  .amdhsa_next_free_sgpr 100
  .amdhsa_accum_offset 32
  .amdhsa_group_segment_fixed_size 0
  .amdhsa_kernarg_size 112
  .amdhsa_user_sgpr_count 2
  .amdhsa_user_sgpr_kernarg_segment_ptr 1
  .amdhsa_system_sgpr_workgroup_id_x 1
  .amdhsa_float_denorm_mode_32 3
.end_amdhsa_kernel
```

```asm
; @launch kernel=g0_kernel grid=(256,1,1) block=(256,1,1) lds=0
; @launch kernel=g1_kernel grid=(256,1,1) block=(1024,1,1) lds=163840
; @launch kernel=g2_kernel grid=(256,1,1) block=(1024,1,1) lds=161520
; @launch kernel=standalone__molecular_angular_gemnet__graph_kernel grid=(3125,1,1) block=(256,1,1) lds=0
.amdgcn_target "amdgcn-amd-amdhsa--gfx950"
.text
.globl g0_kernel
.p2align 8
.type g0_kernel,@function
g0_kernel:
    s_cmp_ge_u32 s2, 256
    s_cbranch_scc1 L_k0done_1
    s_load_dwordx2 s[4:5], s[0:1], 0
    s_load_dwordx2 s[6:7], s[0:1], 104
    s_mul_i32 s3, s2, 25000
    v_lshlrev_b32 v1, 4, v0
    s_waitcnt lgkmcnt(0)

    s_add_u32 s8, s4, s3
    s_addc_u32 s9, s5, 0
    s_mov_b32 s10, 25000
    s_mov_b32 s11, 0x20000
    s_mov_b32 s12, s6
    s_mov_b32 s13, s7
    s_mov_b32 s14, 131328
    s_mov_b32 s15, 0x20000
    s_add_u32 s16, s6, 135168
    s_addc_u32 s17, s7, 0
    s_mov_b32 s18, 4096
    s_mov_b32 s19, 0x20000
    s_movk_i32 s20, 0
    buffer_load_dwordx4 v[4:7], v1, s[8:11], s20 offen
    s_movk_i32 s20, 4096
    buffer_load_dwordx4 v[8:11], v1, s[8:11], s20 offen
    s_movk_i32 s20, 8192
    buffer_load_dwordx4 v[12:15], v1, s[8:11], s20 offen
    s_movk_i32 s20, 12288
    buffer_load_dwordx4 v[16:19], v1, s[8:11], s20 offen
    s_movk_i32 s20, 16384
    buffer_load_dwordx4 v[20:23], v1, s[8:11], s20 offen
    s_movk_i32 s20, 20480
    buffer_load_dwordx4 v[24:27], v1, s[8:11], s20 offen
    s_movk_i32 s20, 24576
    buffer_load_dwordx4 v[28:31], v1, s[8:11], s20 offen
    s_lshl_b32 s21, s2, 12
    v_add_u32 v2, s21, v1
    v_mov_b32 v32, 0
    v_mov_b32 v33, 0
    v_mov_b32 v34, 0
    v_mov_b32 v35, 0
    buffer_store_dwordx4 v[32:35], v2, s[12:15], 0 offen
    s_mov_b32 s22, 0x7fff7fff
    s_waitcnt vmcnt(1)

    v_and_b32 v4, s22, v4
    v_and_b32 v5, s22, v5
    v_and_b32 v6, s22, v6
    v_and_b32 v7, s22, v7
    v_and_b32 v8, s22, v8
    v_and_b32 v9, s22, v9
    v_and_b32 v10, s22, v10
    v_and_b32 v11, s22, v11
    v_and_b32 v12, s22, v12
    v_and_b32 v13, s22, v13
    v_and_b32 v14, s22, v14
    v_and_b32 v15, s22, v15
    v_and_b32 v16, s22, v16
    v_and_b32 v17, s22, v17
    v_and_b32 v18, s22, v18
    v_and_b32 v19, s22, v19
    v_and_b32 v20, s22, v20
    v_and_b32 v21, s22, v21
    v_and_b32 v22, s22, v22
    v_and_b32 v23, s22, v23
    v_and_b32 v24, s22, v24
    v_and_b32 v25, s22, v25
    v_and_b32 v26, s22, v26
    v_and_b32 v27, s22, v27
    v_and_b32 v28, s22, v28
    v_and_b32 v29, s22, v29
    v_and_b32 v30, s22, v30
    v_and_b32 v31, s22, v31
    v_pk_max_u16 v4, v4, v5
    v_pk_max_u16 v4, v4, v6
    v_pk_max_u16 v4, v4, v7
    v_pk_max_u16 v4, v4, v8
    v_pk_max_u16 v4, v4, v9
    v_pk_max_u16 v4, v4, v10
    v_pk_max_u16 v4, v4, v11
    v_pk_max_u16 v4, v4, v12
    v_pk_max_u16 v4, v4, v13
    v_pk_max_u16 v4, v4, v14
    v_pk_max_u16 v4, v4, v15
    v_pk_max_u16 v4, v4, v16
    v_pk_max_u16 v4, v4, v17
    v_pk_max_u16 v4, v4, v18
    v_pk_max_u16 v4, v4, v19
    v_pk_max_u16 v4, v4, v20
    v_pk_max_u16 v4, v4, v21
    v_pk_max_u16 v4, v4, v22
    v_pk_max_u16 v4, v4, v23
    v_pk_max_u16 v4, v4, v24
    v_pk_max_u16 v4, v4, v25
    v_pk_max_u16 v4, v4, v26
    v_pk_max_u16 v4, v4, v27
    v_pk_max_u16 v4, v4, v28
    v_pk_max_u16 v4, v4, v29
    v_pk_max_u16 v4, v4, v30
    v_pk_max_u16 v4, v4, v31
    v_lshrrev_b32 v5, 16, v4
    v_and_b32 v4, 0xffff, v4
    v_max_u32 v4, v4, v5

    s_nop 1
    v_max_u32_dpp v4, v4, v4 row_shr:1 row_mask:0xf bank_mask:0xf
    s_nop 1
    v_max_u32_dpp v4, v4, v4 row_shr:2 row_mask:0xf bank_mask:0xf
    s_nop 1
    v_max_u32_dpp v4, v4, v4 row_shr:4 row_mask:0xf bank_mask:0xf
    s_nop 1
    v_max_u32_dpp v4, v4, v4 row_shr:8 row_mask:0xf bank_mask:0xf
    s_nop 1
    v_max_u32_dpp v4, v4, v4 row_bcast:15 row_mask:0xa bank_mask:0xf
    s_nop 1
    v_max_u32_dpp v4, v4, v4 row_bcast:31 row_mask:0xc bank_mask:0xf
    v_lshrrev_b32 v6, 6, v0
    s_lshl_b32 s21, s2, 2
    v_add_lshl_u32 v6, v6, s21, 2
    v_and_b32 v7, 63, v0
    v_cmp_eq_u32 vcc, 63, v7
    s_and_saveexec_b64 s[24:25], vcc
    buffer_store_dword v4, v6, s[16:19], 0 offen
L_k0done_1:
    s_endpgm

.globl g1_kernel
.p2align 8
.type g1_kernel,@function
g1_kernel:
    s_cmp_ge_u32 s2, 256
    s_cbranch_scc1 L_p1done_2
    s_load_dwordx4 s[80:83], s[0:1], 8
    s_load_dwordx2 s[84:85], s[0:1], 32
    s_load_dwordx2 s[86:87], s[0:1], 48
    s_load_dwordx2 s[6:7], s[0:1], 104
    v_lshlrev_b32 v1, 4, v0
    v_lshlrev_b32 v2, 3, v0
    v_lshlrev_b32 v3, 2, v0
    s_mul_i32 s3, s2, 800000
    s_mul_i32 s4, s2, 400000
    s_waitcnt lgkmcnt(0)
    s_load_dword s88, s[86:87], 0

    s_add_u32 s8, s80, s3
    s_addc_u32 s9, s81, 0
    s_mov_b32 s10, 72960
    s_mov_b32 s11, 0x20000
    s_add_u32 s12, s82, s3
    s_addc_u32 s13, s83, 0
    s_mov_b32 s14, 72960
    s_mov_b32 s15, 0x20000
    s_add_u32 s16, s84, s4
    s_addc_u32 s17, s85, 0
    s_mov_b32 s18, 36480
    s_mov_b32 s19, 0x20000
    s_mov_b32 s56, 0
    s_mov_b32 s61, 0
    s_mov_b32 s57, 16384
    s_mov_b32 s62, 8192
    s_mov_b32 s58, 32768
    s_mov_b32 s63, 16384
    s_mov_b32 s59, 49152
    s_mov_b32 s64, 24576
    s_mov_b32 s60, 65536
    s_mov_b32 s65, 32768
    buffer_load_dwordx4 v[22:25], v1, s[12:15], s56 offen nt
    buffer_load_dwordx4 v[4:7], v1, s[8:11], s56 offen nt
    buffer_load_dwordx2 v[40:41], v2, s[16:19], s61 offen nt
    buffer_load_dwordx4 v[26:29], v1, s[12:15], s57 offen nt
    buffer_load_dwordx4 v[8:11], v1, s[8:11], s57 offen nt
    buffer_load_dwordx2 v[42:43], v2, s[16:19], s62 offen nt
    buffer_load_dwordx4 v[30:33], v1, s[12:15], s58 offen nt
    buffer_load_dwordx4 v[12:15], v1, s[8:11], s58 offen nt
    buffer_load_dwordx2 v[44:45], v2, s[16:19], s63 offen nt
    buffer_load_dwordx4 v[34:37], v1, s[12:15], s59 offen nt
    buffer_load_dwordx4 v[16:19], v1, s[8:11], s59 offen nt
    buffer_load_dwordx2 v[46:47], v2, s[16:19], s64 offen nt
    buffer_load_dwordx2 v[38:39], v2, s[12:15], s60 offen nt
    buffer_load_dwordx2 v[20:21], v2, s[8:11], s60 offen nt
    buffer_load_dword v48, v3, s[16:19], s65 offen nt
    s_and_b32 s5, s2, 7
    s_mul_i32 s3, s5, 8192

    s_add_u32 s20, s6, s3
    s_addc_u32 s21, s7, 0
    s_mov_b32 s22, 8192
    s_mov_b32 s23, 0x20000
    s_mul_i32 s3, s5, 40632320
    s_add_u32 s3, s3, 27262976
    s_add_u32 s24, s6, s3
    s_addc_u32 s25, s7, 0
    s_mov_b32 s26, 40632320
    s_mov_b32 s27, 0x20000
    s_add_u32 s28, s6, s3
    s_addc_u32 s29, s7, 0
    s_mov_b32 s30, 40632320
    s_mov_b32 s31, 0x20000
    s_add_u32 s32, s6, 352321536
    s_addc_u32 s33, s7, 0
    s_mov_b32 s34, 409600000
    s_mov_b32 s35, 0x20000
    s_add_u32 s36, s6, 131072
    s_addc_u32 s37, s7, 0
    s_mov_b32 s38, 4
    s_mov_b32 s39, 0x20000
    s_mov_b32 s40, 687195
    s_mov_b32 s41, 85899
    s_mov_b32 s42, -6250
    s_mov_b32 s43, -50000
    s_mov_b32 s45, 0x06050400
    s_mov_b32 s46, 0x05040c00
    s_mov_b32 s47, 0x04020100
    s_mov_b32 s48, 3968
    s_mov_b32 s49, 0
    s_mov_b32 s50, 0
    s_mov_b32 s51, 0
    s_mov_b32 s53, 0
    v_mov_b32 v104, 1
    v_mov_b32 v105, 0x447fc000
    v_mul_u32_u24 v49, 5, v0
    v_mov_b32 v106, 0
    v_mov_b32 v107, 0
    v_mov_b32 v108, 0
    v_mov_b32 v109, 0
    v_mov_b32 v110, 0
    v_mov_b32 v111, 0
    v_mov_b32 v113, 16384
    ds_write_b64 v2, v[106:107]
    v_mov_b32 v114, 0
    v_mov_b32 v115, 0
    v_mov_b32 v116, 0
    v_mov_b32 v117, -1
    s_mov_b64 exec, 1
    ds_write_b128 v113, v[114:117]
    s_mov_b64 exec, -1
    s_waitcnt lgkmcnt(0)
    s_lshl_b32 s88, s88, 16
    v_mov_b32 v114, 0.15915494
    v_mul_f32 v114, s88, v114
    s_nop 0
    v_readfirstlane_b32 s44, v114
    s_barrier

    s_mov_b32 s52, s51
    s_sub_u32 s51, 200000, s50
    s_min_u32 s51, s51, 18240
    s_sub_u32 s75, s51, 16384
    s_lshl_b32 s75, s75, 1
    v_cmp_gt_u32 s[66:67], s75, v3

    s_add_u32 s76, s50, 36480
    s_min_u32 s76, s76, 200000
    s_lshl_b32 s10, s76, 2
    s_lshl_b32 s14, s76, 2
    s_lshl_b32 s18, s76, 1

    s_add_u32 s56, s56, 72960
    s_add_u32 s61, s61, 36480
    s_add_u32 s57, s57, 72960
    s_add_u32 s62, s62, 36480
    s_add_u32 s58, s58, 72960
    s_add_u32 s63, s63, 36480
    s_add_u32 s59, s59, 72960
    s_add_u32 s64, s64, 36480
    s_add_u32 s60, s60, 72960
    s_add_u32 s65, s65, 36480
    s_waitcnt vmcnt(12)
    v_mul_hi_u32_u24 v51, s40, v22
    v_mul_hi_u32_u24 v50, s41, v4
    v_mul_hi_u32_u24 v53, s40, v23
    v_mul_hi_u32_u24 v52, s41, v5
    v_mul_hi_u32_u24 v55, s40, v24
    v_mul_hi_u32_u24 v54, s41, v6
    v_mul_hi_u32_u24 v57, s40, v25
    v_mul_hi_u32_u24 v56, s41, v7
    v_mad_i32_i24 v22, v51, s42, v22
    v_lshl_add_u32 v51, v50, 7, v51
    v_mad_i32_i24 v23, v53, s42, v23
    v_lshl_add_u32 v53, v52, 7, v53
    v_mad_i32_i24 v24, v55, s42, v24
    v_lshl_add_u32 v55, v54, 7, v55
    v_mad_i32_i24 v25, v57, s42, v25
    v_lshl_add_u32 v57, v56, 7, v57
    v_mad_i32_i24 v4, v50, s43, v4
    v_lshlrev_b32 v51, 2, v51
    ds_add_rtn_u32 v86, v51, v104
    v_mad_i32_i24 v5, v52, s43, v5
    v_lshlrev_b32 v53, 2, v53
    ds_add_rtn_u32 v87, v53, v104
    v_mad_i32_i24 v6, v54, s43, v6
    v_lshlrev_b32 v55, 2, v55
    ds_add_rtn_u32 v88, v55, v104
    v_mad_i32_i24 v7, v56, s43, v7
    v_lshlrev_b32 v57, 2, v57
    ds_add_rtn_u32 v89, v57, v104
    v_lshlrev_b32 v114, 16, v40
    v_and_b32 v115, 0xffff0000, v40
    v_lshlrev_b32 v116, 16, v41
    v_and_b32 v117, 0xffff0000, v41
    v_mul_f32 v114, s44, v114
    v_mul_f32 v115, s44, v115
    v_mul_f32 v116, s44, v116
    v_mul_f32 v117, s44, v117
    v_fract_f32 v114, v114
    v_fract_f32 v115, v115
    v_fract_f32 v116, v116
    v_fract_f32 v117, v117
    v_cos_f32 v114, v114
    v_cos_f32 v115, v115
    v_cos_f32 v116, v116
    v_cos_f32 v117, v117
    v_lshlrev_b32 v22, 3, v22
    v_lshlrev_b32 v23, 3, v23
    v_lshlrev_b32 v24, 3, v24
    v_lshlrev_b32 v25, 3, v25
    v_lshl_or_b32 v50, v4, 16, v22
    v_lshl_or_b32 v52, v5, 16, v23
    v_lshl_or_b32 v54, v6, 16, v24
    v_lshl_or_b32 v56, v7, 16, v25
    buffer_load_dwordx4 v[22:25], v1, s[12:15], s56 offen nt
    buffer_load_dwordx4 v[4:7], v1, s[8:11], s56 offen nt
    buffer_load_dwordx2 v[40:41], v2, s[16:19], s61 offen nt
    v_fmaak_f32 v114, v114, v105, 0x4b000c00
    v_fmaak_f32 v115, v115, v105, 0x4b000c00
    v_fmaak_f32 v116, v116, v105, 0x4b000c00
    v_fmaak_f32 v117, v117, v105, 0x4b000c00
    v_perm_b32 v51, v51, v114, s46
    v_bfe_u32 v114, v114, 8, 4
    v_perm_b32 v53, v53, v115, s46
    v_bfe_u32 v115, v115, 8, 4
    v_perm_b32 v55, v55, v116, s46
    v_bfe_u32 v116, v116, 8, 4
    v_perm_b32 v57, v57, v117, s46
    v_bfe_u32 v117, v117, 8, 4
    v_add_u32 v50, v50, v114
    v_add_u32 v52, v52, v115
    v_add_u32 v54, v54, v116
    v_add_u32 v56, v56, v117
    s_waitcnt vmcnt(12)
    v_mul_hi_u32_u24 v59, s40, v26
    v_mul_hi_u32_u24 v58, s41, v8
    v_mul_hi_u32_u24 v61, s40, v27
    v_mul_hi_u32_u24 v60, s41, v9
    v_mul_hi_u32_u24 v63, s40, v28
    v_mul_hi_u32_u24 v62, s41, v10
    v_mul_hi_u32_u24 v65, s40, v29
    v_mul_hi_u32_u24 v64, s41, v11
    v_mad_i32_i24 v26, v59, s42, v26
    v_lshl_add_u32 v59, v58, 7, v59
    v_mad_i32_i24 v27, v61, s42, v27
    v_lshl_add_u32 v61, v60, 7, v61
    v_mad_i32_i24 v28, v63, s42, v28
    v_lshl_add_u32 v63, v62, 7, v63
    v_mad_i32_i24 v29, v65, s42, v29
    v_lshl_add_u32 v65, v64, 7, v65
    v_mad_i32_i24 v8, v58, s43, v8
    v_lshlrev_b32 v59, 2, v59
    ds_add_rtn_u32 v90, v59, v104
    v_mad_i32_i24 v9, v60, s43, v9
    v_lshlrev_b32 v61, 2, v61
    ds_add_rtn_u32 v91, v61, v104
    v_mad_i32_i24 v10, v62, s43, v10
    v_lshlrev_b32 v63, 2, v63
    ds_add_rtn_u32 v92, v63, v104
    v_mad_i32_i24 v11, v64, s43, v11
    v_lshlrev_b32 v65, 2, v65
    ds_add_rtn_u32 v93, v65, v104
    v_lshlrev_b32 v114, 16, v42
    v_and_b32 v115, 0xffff0000, v42
    v_lshlrev_b32 v116, 16, v43
    v_and_b32 v117, 0xffff0000, v43
    v_mul_f32 v114, s44, v114
    v_mul_f32 v115, s44, v115
    v_mul_f32 v116, s44, v116
    v_mul_f32 v117, s44, v117
    v_fract_f32 v114, v114
    v_fract_f32 v115, v115
    v_fract_f32 v116, v116
    v_fract_f32 v117, v117
    v_cos_f32 v114, v114
    v_cos_f32 v115, v115
    v_cos_f32 v116, v116
    v_cos_f32 v117, v117
    v_lshlrev_b32 v26, 3, v26
    v_lshlrev_b32 v27, 3, v27
    v_lshlrev_b32 v28, 3, v28
    v_lshlrev_b32 v29, 3, v29
    v_lshl_or_b32 v58, v8, 16, v26
    v_lshl_or_b32 v60, v9, 16, v27
    v_lshl_or_b32 v62, v10, 16, v28
    v_lshl_or_b32 v64, v11, 16, v29
    v_fmaak_f32 v114, v114, v105, 0x4b000c00
    v_fmaak_f32 v115, v115, v105, 0x4b000c00
    v_fmaak_f32 v116, v116, v105, 0x4b000c00
    v_fmaak_f32 v117, v117, v105, 0x4b000c00
    v_perm_b32 v59, v59, v114, s46
    v_bfe_u32 v114, v114, 8, 4
    v_perm_b32 v61, v61, v115, s46
    v_bfe_u32 v115, v115, 8, 4
    v_perm_b32 v63, v63, v116, s46
    v_bfe_u32 v116, v116, 8, 4
    v_perm_b32 v65, v65, v117, s46
    v_bfe_u32 v117, v117, 8, 4
    v_add_u32 v58, v58, v114
    v_add_u32 v60, v60, v115
    v_add_u32 v62, v62, v116
    v_add_u32 v64, v64, v117
    s_waitcnt vmcnt(9)
    v_mul_hi_u32_u24 v67, s40, v30
    v_mul_hi_u32_u24 v66, s41, v12
    v_mul_hi_u32_u24 v69, s40, v31
    v_mul_hi_u32_u24 v68, s41, v13
    v_mul_hi_u32_u24 v71, s40, v32
    v_mul_hi_u32_u24 v70, s41, v14
    v_mul_hi_u32_u24 v73, s40, v33
    v_mul_hi_u32_u24 v72, s41, v15
    v_mad_i32_i24 v30, v67, s42, v30
    v_lshl_add_u32 v67, v66, 7, v67
    v_mad_i32_i24 v31, v69, s42, v31
    v_lshl_add_u32 v69, v68, 7, v69
    v_mad_i32_i24 v32, v71, s42, v32
    v_lshl_add_u32 v71, v70, 7, v71
    v_mad_i32_i24 v33, v73, s42, v33
    v_lshl_add_u32 v73, v72, 7, v73
    v_mad_i32_i24 v12, v66, s43, v12
    v_lshlrev_b32 v67, 2, v67
    ds_add_rtn_u32 v94, v67, v104
    v_mad_i32_i24 v13, v68, s43, v13
    v_lshlrev_b32 v69, 2, v69
    ds_add_rtn_u32 v95, v69, v104
    v_mad_i32_i24 v14, v70, s43, v14
    v_lshlrev_b32 v71, 2, v71
    ds_add_rtn_u32 v96, v71, v104
    v_mad_i32_i24 v15, v72, s43, v15
    v_lshlrev_b32 v73, 2, v73
    ds_add_rtn_u32 v97, v73, v104
    v_lshlrev_b32 v114, 16, v44
    v_and_b32 v115, 0xffff0000, v44
    v_lshlrev_b32 v116, 16, v45
    v_and_b32 v117, 0xffff0000, v45
    v_mul_f32 v114, s44, v114
    v_mul_f32 v115, s44, v115
    v_mul_f32 v116, s44, v116
    v_mul_f32 v117, s44, v117
    v_fract_f32 v114, v114
    v_fract_f32 v115, v115
    v_fract_f32 v116, v116
    v_fract_f32 v117, v117
    v_cos_f32 v114, v114
    v_cos_f32 v115, v115
    v_cos_f32 v116, v116
    v_cos_f32 v117, v117
    v_lshlrev_b32 v30, 3, v30
    v_lshlrev_b32 v31, 3, v31
    v_lshlrev_b32 v32, 3, v32
    v_lshlrev_b32 v33, 3, v33
    v_lshl_or_b32 v66, v12, 16, v30
    v_lshl_or_b32 v68, v13, 16, v31
    v_lshl_or_b32 v70, v14, 16, v32
    v_lshl_or_b32 v72, v15, 16, v33
    v_fmaak_f32 v114, v114, v105, 0x4b000c00
    v_fmaak_f32 v115, v115, v105, 0x4b000c00
    v_fmaak_f32 v116, v116, v105, 0x4b000c00
    v_fmaak_f32 v117, v117, v105, 0x4b000c00
    v_perm_b32 v67, v67, v114, s46
    v_bfe_u32 v114, v114, 8, 4
    v_perm_b32 v69, v69, v115, s46
    v_bfe_u32 v115, v115, 8, 4
    v_perm_b32 v71, v71, v116, s46
    v_bfe_u32 v116, v116, 8, 4
    v_perm_b32 v73, v73, v117, s46
    v_bfe_u32 v117, v117, 8, 4
    v_add_u32 v66, v66, v114
    v_add_u32 v68, v68, v115
    v_add_u32 v70, v70, v116
    v_add_u32 v72, v72, v117
    s_waitcnt vmcnt(6)
    v_mul_hi_u32_u24 v75, s40, v34
    v_mul_hi_u32_u24 v74, s41, v16
    v_mul_hi_u32_u24 v77, s40, v35
    v_mul_hi_u32_u24 v76, s41, v17
    v_mul_hi_u32_u24 v79, s40, v36
    v_mul_hi_u32_u24 v78, s41, v18
    v_mul_hi_u32_u24 v81, s40, v37
    v_mul_hi_u32_u24 v80, s41, v19
    v_mad_i32_i24 v34, v75, s42, v34
    v_lshl_add_u32 v75, v74, 7, v75
    v_mad_i32_i24 v35, v77, s42, v35
    v_lshl_add_u32 v77, v76, 7, v77
    v_mad_i32_i24 v36, v79, s42, v36
    v_lshl_add_u32 v79, v78, 7, v79
    v_mad_i32_i24 v37, v81, s42, v37
    v_lshl_add_u32 v81, v80, 7, v81
    v_mad_i32_i24 v16, v74, s43, v16
    v_lshlrev_b32 v75, 2, v75
    ds_add_rtn_u32 v98, v75, v104
    v_mad_i32_i24 v17, v76, s43, v17
    v_lshlrev_b32 v77, 2, v77
    ds_add_rtn_u32 v99, v77, v104
    v_mad_i32_i24 v18, v78, s43, v18
    v_lshlrev_b32 v79, 2, v79
    ds_add_rtn_u32 v100, v79, v104
    v_mad_i32_i24 v19, v80, s43, v19
    v_lshlrev_b32 v81, 2, v81
    ds_add_rtn_u32 v101, v81, v104
    v_lshlrev_b32 v114, 16, v46
    v_and_b32 v115, 0xffff0000, v46
    v_lshlrev_b32 v116, 16, v47
    v_and_b32 v117, 0xffff0000, v47
    v_mul_f32 v114, s44, v114
    v_mul_f32 v115, s44, v115
    v_mul_f32 v116, s44, v116
    v_mul_f32 v117, s44, v117
    v_fract_f32 v114, v114
    v_fract_f32 v115, v115
    v_fract_f32 v116, v116
    v_fract_f32 v117, v117
    v_cos_f32 v114, v114
    v_cos_f32 v115, v115
    v_cos_f32 v116, v116
    v_cos_f32 v117, v117
    v_lshlrev_b32 v34, 3, v34
    v_lshlrev_b32 v35, 3, v35
    v_lshlrev_b32 v36, 3, v36
    v_lshlrev_b32 v37, 3, v37
    v_lshl_or_b32 v74, v16, 16, v34
    v_lshl_or_b32 v76, v17, 16, v35
    v_lshl_or_b32 v78, v18, 16, v36
    v_lshl_or_b32 v80, v19, 16, v37
    v_fmaak_f32 v114, v114, v105, 0x4b000c00
    v_fmaak_f32 v115, v115, v105, 0x4b000c00
    v_fmaak_f32 v116, v116, v105, 0x4b000c00
    v_fmaak_f32 v117, v117, v105, 0x4b000c00
    v_perm_b32 v75, v75, v114, s46
    v_bfe_u32 v114, v114, 8, 4
    v_perm_b32 v77, v77, v115, s46
    v_bfe_u32 v115, v115, 8, 4
    v_perm_b32 v79, v79, v116, s46
    v_bfe_u32 v116, v116, 8, 4
    v_perm_b32 v81, v81, v117, s46
    v_bfe_u32 v117, v117, 8, 4
    v_add_u32 v74, v74, v114
    v_add_u32 v76, v76, v115
    v_add_u32 v78, v78, v116
    v_add_u32 v80, v80, v117
    s_waitcnt vmcnt(3)
    s_mov_b64 exec, s[66:67]
    v_mul_hi_u32_u24 v83, s40, v38
    v_mul_hi_u32_u24 v82, s41, v20
    v_mul_hi_u32_u24 v85, s40, v39
    v_mul_hi_u32_u24 v84, s41, v21
    v_mad_i32_i24 v38, v83, s42, v38
    v_lshl_add_u32 v83, v82, 7, v83
    v_mad_i32_i24 v39, v85, s42, v39
    v_lshl_add_u32 v85, v84, 7, v85
    v_mad_i32_i24 v20, v82, s43, v20
    v_lshlrev_b32 v83, 2, v83
    ds_add_rtn_u32 v102, v83, v104
    v_mad_i32_i24 v21, v84, s43, v21
    v_lshlrev_b32 v85, 2, v85
    ds_add_rtn_u32 v103, v85, v104
    v_lshlrev_b32 v114, 16, v48
    v_and_b32 v115, 0xffff0000, v48
    v_mul_f32 v114, s44, v114
    v_mul_f32 v115, s44, v115
    v_fract_f32 v114, v114
    v_fract_f32 v115, v115
    v_cos_f32 v114, v114
    v_cos_f32 v115, v115
    v_lshlrev_b32 v38, 3, v38
    v_lshlrev_b32 v39, 3, v39
    v_lshl_or_b32 v82, v20, 16, v38
    v_lshl_or_b32 v84, v21, 16, v39
    s_mov_b64 exec, -1
    v_fmaak_f32 v114, v114, v105, 0x4b000c00
    v_fmaak_f32 v115, v115, v105, 0x4b000c00
    v_perm_b32 v83, v83, v114, s46
    v_bfe_u32 v114, v114, 8, 4
    v_perm_b32 v85, v85, v115, s46
    v_bfe_u32 v115, v115, 8, 4
    v_add_u32 v82, v82, v114
    v_add_u32 v84, v84, v115
    s_waitcnt lgkmcnt(0)
    s_barrier

    ds_read_b64 v[108:109], v2
    s_waitcnt lgkmcnt(0)
    v_and_b32 v108, 0xffff, v108
    v_and_b32 v109, 0xffff, v109
    v_mov_b32 v106, v108
    v_mov_b32 v107, v109
    v_add_u32 v111, v108, v109

    buffer_atomic_add_x2 v[106:107], v2, s[20:23], 0 offen sc0
    s_nop 1
    v_add_u32_dpp v111, v111, v111 row_shr:1 row_mask:0xf bank_mask:0xf
    s_nop 1
    v_add_u32_dpp v111, v111, v111 row_shr:2 row_mask:0xf bank_mask:0xf
    s_nop 1
    v_add_u32_dpp v111, v111, v111 row_shr:4 row_mask:0xf bank_mask:0xf
    s_nop 1
    v_add_u32_dpp v111, v111, v111 row_shr:8 row_mask:0xf bank_mask:0xf
    s_nop 1
    v_add_u32_dpp v111, v111, v111 row_bcast:15 row_mask:0xa bank_mask:0xf
    s_nop 1
    v_add_u32_dpp v111, v111, v111 row_bcast:31 row_mask:0xc bank_mask:0xf
    s_mov_b32 exec_lo, 0
    s_brev_b32 exec_hi, 1
    ds_add_rtn_u32 v110, v113, v111
    s_mov_b64 exec, -1

    s_waitcnt lgkmcnt(0)
    v_readlane_b32 s77, v110, 63
    v_mul_u32_u24 v116, 7936, v0
    v_sub_u32 v111, v111, v109
    s_sub_u32 s77, s77, s50
    v_add_u32 v111, s77, v111
    v_sub_u32 v110, v111, v108
    v_lshlrev_b32 v115, 16, v111
    v_lshlrev_b32 v114, 16, v110
    ds_write_b64 v2, v[114:115]
    v_sub_u32 v110, v116, v110
    v_sub_u32 v111, v116, v111
    v_add_u32 v111, s48, v111
    s_lshl_b32 s74, s51, 3
    v_mov_b32 v126, s74
    v_mov_b32 v127, -1

    s_waitcnt lgkmcnt(0)
    s_barrier

    s_mov_b64 exec, 1
    ds_write_b32 v126, v127 offset:16404
    s_mov_b64 exec, -1

    v_lshrrev_b32 v114, 16, v51
    ds_read_b32 v114, v114
    v_lshrrev_b32 v115, 16, v53
    ds_read_b32 v115, v115
    v_lshrrev_b32 v116, 16, v55
    ds_read_b32 v116, v116
    v_lshrrev_b32 v117, 16, v57
    ds_read_b32 v117, v117
    v_lshrrev_b32 v118, 16, v59
    ds_read_b32 v118, v118
    v_lshrrev_b32 v119, 16, v61
    ds_read_b32 v119, v119
    v_lshrrev_b32 v120, 16, v63
    ds_read_b32 v120, v120
    v_lshrrev_b32 v121, 16, v65
    ds_read_b32 v121, v121
    s_waitcnt lgkmcnt(7)
    v_add_u32_sdwa v114, v114, v86 dst_sel:DWORD dst_unused:UNUSED_PAD src0_sel:WORD_1 src1_sel:WORD_0
    v_lshlrev_b32 v114, 3, v114
    ds_write_b64 v114, v[50:51] offset:16400

    s_waitcnt lgkmcnt(7)
    v_add_u32_sdwa v115, v115, v87 dst_sel:DWORD dst_unused:UNUSED_PAD src0_sel:WORD_1 src1_sel:WORD_0
    v_lshlrev_b32 v115, 3, v115
    ds_write_b64 v115, v[52:53] offset:16400

    s_waitcnt lgkmcnt(7)
    v_add_u32_sdwa v116, v116, v88 dst_sel:DWORD dst_unused:UNUSED_PAD src0_sel:WORD_1 src1_sel:WORD_0
    v_lshlrev_b32 v116, 3, v116
    ds_write_b64 v116, v[54:55] offset:16400

    s_waitcnt lgkmcnt(7)
    v_add_u32_sdwa v117, v117, v89 dst_sel:DWORD dst_unused:UNUSED_PAD src0_sel:WORD_1 src1_sel:WORD_0
    v_lshlrev_b32 v117, 3, v117
    ds_write_b64 v117, v[56:57] offset:16400

    s_waitcnt lgkmcnt(7)
    v_add_u32_sdwa v118, v118, v90 dst_sel:DWORD dst_unused:UNUSED_PAD src0_sel:WORD_1 src1_sel:WORD_0
    v_lshlrev_b32 v118, 3, v118
    ds_write_b64 v118, v[58:59] offset:16400

    s_waitcnt lgkmcnt(7)
    v_add_u32_sdwa v119, v119, v91 dst_sel:DWORD dst_unused:UNUSED_PAD src0_sel:WORD_1 src1_sel:WORD_0
    v_lshlrev_b32 v119, 3, v119
    ds_write_b64 v119, v[60:61] offset:16400

    s_waitcnt lgkmcnt(7)
    v_add_u32_sdwa v120, v120, v92 dst_sel:DWORD dst_unused:UNUSED_PAD src0_sel:WORD_1 src1_sel:WORD_0
    v_lshlrev_b32 v120, 3, v120
    ds_write_b64 v120, v[62:63] offset:16400

    s_waitcnt lgkmcnt(7)
    v_add_u32_sdwa v121, v121, v93 dst_sel:DWORD dst_unused:UNUSED_PAD src0_sel:WORD_1 src1_sel:WORD_0
    v_lshlrev_b32 v121, 3, v121
    ds_write_b64 v121, v[64:65] offset:16400

    v_lshrrev_b32 v114, 16, v67
    ds_read_b32 v114, v114
    v_lshrrev_b32 v115, 16, v69
    ds_read_b32 v115, v115
    v_lshrrev_b32 v116, 16, v71
    ds_read_b32 v116, v116
    v_lshrrev_b32 v117, 16, v73
    ds_read_b32 v117, v117
    v_lshrrev_b32 v118, 16, v75
    ds_read_b32 v118, v118
    v_lshrrev_b32 v119, 16, v77
    ds_read_b32 v119, v119
    v_lshrrev_b32 v120, 16, v79
    ds_read_b32 v120, v120
    v_lshrrev_b32 v121, 16, v81
    ds_read_b32 v121, v121
    s_waitcnt lgkmcnt(7)
    v_add_u32_sdwa v114, v114, v94 dst_sel:DWORD dst_unused:UNUSED_PAD src0_sel:WORD_1 src1_sel:WORD_0
    v_lshlrev_b32 v114, 3, v114
    ds_write_b64 v114, v[66:67] offset:16400

    s_waitcnt lgkmcnt(7)
    v_add_u32_sdwa v115, v115, v95 dst_sel:DWORD dst_unused:UNUSED_PAD src0_sel:WORD_1 src1_sel:WORD_0
    v_lshlrev_b32 v115, 3, v115
    ds_write_b64 v115, v[68:69] offset:16400

    s_waitcnt lgkmcnt(7)
    v_add_u32_sdwa v116, v116, v96 dst_sel:DWORD dst_unused:UNUSED_PAD src0_sel:WORD_1 src1_sel:WORD_0
    v_lshlrev_b32 v116, 3, v116
    ds_write_b64 v116, v[70:71] offset:16400

    s_waitcnt lgkmcnt(7)
    v_add_u32_sdwa v117, v117, v97 dst_sel:DWORD dst_unused:UNUSED_PAD src0_sel:WORD_1 src1_sel:WORD_0
    v_lshlrev_b32 v117, 3, v117
    ds_write_b64 v117, v[72:73] offset:16400

    s_waitcnt lgkmcnt(7)
    v_add_u32_sdwa v118, v118, v98 dst_sel:DWORD dst_unused:UNUSED_PAD src0_sel:WORD_1 src1_sel:WORD_0
    v_lshlrev_b32 v118, 3, v118
    ds_write_b64 v118, v[74:75] offset:16400

    s_waitcnt lgkmcnt(7)
    v_add_u32_sdwa v119, v119, v99 dst_sel:DWORD dst_unused:UNUSED_PAD src0_sel:WORD_1 src1_sel:WORD_0
    v_lshlrev_b32 v119, 3, v119
    ds_write_b64 v119, v[76:77] offset:16400

    s_waitcnt lgkmcnt(7)
    v_add_u32_sdwa v120, v120, v100 dst_sel:DWORD dst_unused:UNUSED_PAD src0_sel:WORD_1 src1_sel:WORD_0
    v_lshlrev_b32 v120, 3, v120
    ds_write_b64 v120, v[78:79] offset:16400

    s_waitcnt lgkmcnt(7)
    v_add_u32_sdwa v121, v121, v101 dst_sel:DWORD dst_unused:UNUSED_PAD src0_sel:WORD_1 src1_sel:WORD_0
    v_lshlrev_b32 v121, 3, v121
    ds_write_b64 v121, v[80:81] offset:16400

    s_mov_b64 exec, s[66:67]
    v_lshrrev_b32 v114, 16, v83
    ds_read_b32 v114, v114
    v_lshrrev_b32 v115, 16, v85
    ds_read_b32 v115, v115
    s_waitcnt lgkmcnt(1)
    v_add_u32_sdwa v114, v114, v102 dst_sel:DWORD dst_unused:UNUSED_PAD src0_sel:WORD_1 src1_sel:WORD_0
    v_lshlrev_b32 v114, 3, v114
    ds_write_b64 v114, v[82:83] offset:16400

    s_waitcnt lgkmcnt(1)
    v_add_u32_sdwa v115, v115, v103 dst_sel:DWORD dst_unused:UNUSED_PAD src0_sel:WORD_1 src1_sel:WORD_0
    v_lshlrev_b32 v115, 3, v115
    ds_write_b64 v115, v[84:85] offset:16400

    s_mov_b64 exec, -1
    s_add_u32 s50, s50, s51
    s_add_u32 s49, s49, 1

    buffer_load_dwordx4 v[26:29], v1, s[12:15], s57 offen nt
    buffer_load_dwordx4 v[8:11], v1, s[8:11], s57 offen nt
    buffer_load_dwordx2 v[42:43], v2, s[16:19], s62 offen nt
    buffer_load_dwordx4 v[30:33], v1, s[12:15], s58 offen nt
    buffer_load_dwordx4 v[12:15], v1, s[8:11], s58 offen nt
    buffer_load_dwordx2 v[44:45], v2, s[16:19], s63 offen nt
    buffer_load_dwordx4 v[34:37], v1, s[12:15], s59 offen nt
    buffer_load_dwordx4 v[16:19], v1, s[8:11], s59 offen nt
    buffer_load_dwordx2 v[46:47], v2, s[16:19], s64 offen nt
    buffer_load_dwordx2 v[38:39], v2, s[12:15], s60 offen nt
    buffer_load_dwordx2 v[20:21], v2, s[8:11], s60 offen nt
    buffer_load_dword v48, v3, s[16:19], s65 offen nt
L_p1loop_3:
    s_mov_b32 s52, s51
    s_sub_u32 s51, 200000, s50
    s_min_u32 s51, s51, 18240
    s_sub_u32 s75, s51, 16384
    s_lshl_b32 s75, s75, 1
    v_cmp_gt_u32 s[66:67], s75, v3

    s_add_u32 s76, s50, 36480
    s_min_u32 s76, s76, 200000
    s_lshl_b32 s10, s76, 2
    s_lshl_b32 s14, s76, 2
    s_lshl_b32 s18, s76, 1

    s_add_u32 s56, s56, 72960
    s_add_u32 s61, s61, 36480
    s_add_u32 s57, s57, 72960
    s_add_u32 s62, s62, 36480
    s_add_u32 s58, s58, 72960
    s_add_u32 s63, s63, 36480
    s_add_u32 s59, s59, 72960
    s_add_u32 s64, s64, 36480
    s_add_u32 s60, s60, 72960
    s_add_u32 s65, s65, 36480
    s_waitcnt vmcnt(13)
    v_mul_hi_u32_u24 v51, s40, v22
    v_mul_hi_u32_u24 v50, s41, v4
    v_mul_hi_u32_u24 v53, s40, v23
    v_mul_hi_u32_u24 v52, s41, v5
    v_mul_hi_u32_u24 v55, s40, v24
    v_mul_hi_u32_u24 v54, s41, v6
    v_mul_hi_u32_u24 v57, s40, v25
    v_mul_hi_u32_u24 v56, s41, v7
    v_mad_i32_i24 v22, v51, s42, v22
    v_lshl_add_u32 v51, v50, 7, v51
    v_mad_i32_i24 v23, v53, s42, v23
    v_lshl_add_u32 v53, v52, 7, v53
    v_mad_i32_i24 v24, v55, s42, v24
    v_lshl_add_u32 v55, v54, 7, v55
    v_mad_i32_i24 v25, v57, s42, v25
    v_lshl_add_u32 v57, v56, 7, v57
    v_mad_i32_i24 v4, v50, s43, v4
    v_lshlrev_b32 v51, 2, v51
    ds_add_rtn_u32 v86, v51, v104
    v_mad_i32_i24 v5, v52, s43, v5
    v_lshlrev_b32 v53, 2, v53
    ds_add_rtn_u32 v87, v53, v104
    v_mad_i32_i24 v6, v54, s43, v6
    v_lshlrev_b32 v55, 2, v55
    ds_add_rtn_u32 v88, v55, v104
    v_mad_i32_i24 v7, v56, s43, v7
    v_lshlrev_b32 v57, 2, v57
    ds_add_rtn_u32 v89, v57, v104
    v_lshlrev_b32 v114, 16, v40
    v_and_b32 v115, 0xffff0000, v40
    v_lshlrev_b32 v116, 16, v41
    v_and_b32 v117, 0xffff0000, v41
    v_mul_f32 v114, s44, v114
    v_mul_f32 v115, s44, v115
    v_mul_f32 v116, s44, v116
    v_mul_f32 v117, s44, v117
    v_fract_f32 v114, v114
    v_fract_f32 v115, v115
    v_fract_f32 v116, v116
    v_fract_f32 v117, v117
    v_cos_f32 v114, v114
    v_cos_f32 v115, v115
    v_cos_f32 v116, v116
    v_cos_f32 v117, v117
    v_lshlrev_b32 v22, 3, v22
    v_lshlrev_b32 v23, 3, v23
    v_lshlrev_b32 v24, 3, v24
    v_lshlrev_b32 v25, 3, v25
    v_lshl_or_b32 v50, v4, 16, v22
    v_lshl_or_b32 v52, v5, 16, v23
    v_lshl_or_b32 v54, v6, 16, v24
    v_lshl_or_b32 v56, v7, 16, v25
    buffer_load_dwordx4 v[22:25], v1, s[12:15], s56 offen nt
    buffer_load_dwordx4 v[4:7], v1, s[8:11], s56 offen nt
    buffer_load_dwordx2 v[40:41], v2, s[16:19], s61 offen nt
    v_fmaak_f32 v114, v114, v105, 0x4b000c00
    v_fmaak_f32 v115, v115, v105, 0x4b000c00
    v_fmaak_f32 v116, v116, v105, 0x4b000c00
    v_fmaak_f32 v117, v117, v105, 0x4b000c00
    v_perm_b32 v51, v51, v114, s46
    v_bfe_u32 v114, v114, 8, 4
    v_perm_b32 v53, v53, v115, s46
    v_bfe_u32 v115, v115, 8, 4
    v_perm_b32 v55, v55, v116, s46
    v_bfe_u32 v116, v116, 8, 4
    v_perm_b32 v57, v57, v117, s46
    v_bfe_u32 v117, v117, 8, 4
    v_add_u32 v50, v50, v114
    v_add_u32 v52, v52, v115
    v_add_u32 v54, v54, v116
    v_add_u32 v56, v56, v117
    s_waitcnt vmcnt(15)
    v_add_u32 v114, v106, v108
    v_add_u32 v115, v107, v109
    v_max_u32 v114, v114, v115
    v_cmp_lt_u32 vcc, s48, v114
    v_min_u32 v106, s48, v106
    v_min_u32 v107, s48, v107
    v_add_u32 v106, v106, v110
    v_add_u32 v107, v107, v111
    v_lshl_add_u32 v106, v106, 2, v106
    v_lshl_add_u32 v107, v107, 2, v107
    ds_write_b64 v2, v[106:107] offset:8192
    s_cbranch_vccz L_noov_4
    ds_write_b32 v113, v104 offset:4
L_noov_4:
    s_sub_u32 s74, s52, 17408
    s_max_i32 s74, s74, 0
    v_cmp_gt_u32 s[68:69], s74, v0
    s_waitcnt lgkmcnt(0)
    s_barrier
    ds_read_b32 v114, v113 offset:4
    s_waitcnt lgkmcnt(0)
    v_readfirstlane_b32 s53, v114
    s_nop 1
    s_cmp_lg_u32 s53, 0
    s_cbranch_scc1 L_slow_5
L_sback_6:

    ds_read_b64 v[114:115], v2 offset:16400
    ds_read_b64 v[116:117], v2 offset:16408
    ds_read_b64 v[118:119], v2 offset:16392

    ds_read_b64 v[120:121], v2 offset:24592
    ds_read_b64 v[122:123], v2 offset:24600
    ds_read_b64 v[124:125], v2 offset:24584

    s_waitcnt lgkmcnt(3)
    v_lshrrev_b32 v126, 16, v115
    ds_read_b32 v126, v126 offset:8192

    s_waitcnt lgkmcnt(1)
    v_lshrrev_b32 v127, 16, v121
    ds_read_b32 v127, v127 offset:8192

    v_cmp_ne_u32_sdwa s[70:71], v115, v117 src0_sel:WORD_1 src1_sel:WORD_1
    v_cmp_ne_u32_sdwa vcc, v115, v119 src0_sel:WORD_1 src1_sel:WORD_1
    v_perm_b32 v115, v116, v115, s45
    s_mov_b32 s54, 0
    v_alignbyte_b32 v118, v119, v118, 2
    s_waitcnt lgkmcnt(1)
    v_add3_u32 v126, v126, v49, s54

    s_and_b64 vcc, vcc, s[70:71]
    s_cbranch_scc1 L_fix_10
L_back_11:
    s_mov_b64 exec, s[70:71]
    v_alignbyte_b32 v115, v115, v114, 1
    v_perm_b32 v114, v114, v118, s47
    v_subrev_u32 v126, 3, v126
    s_mov_b64 exec, -1

    buffer_store_dwordx2 v[114:115], v126, s[24:27], 0 offen
    v_cmp_ne_u32_sdwa s[70:71], v121, v123 src0_sel:WORD_1 src1_sel:WORD_1
    v_cmp_ne_u32_sdwa vcc, v121, v125 src0_sel:WORD_1 src1_sel:WORD_1
    v_perm_b32 v121, v122, v121, s45
    s_mov_b32 s54, 5120
    v_alignbyte_b32 v124, v125, v124, 2
    s_waitcnt lgkmcnt(0)
    v_add3_u32 v127, v127, v49, s54

    s_and_b64 vcc, vcc, s[70:71]
    s_cbranch_scc1 L_fix_12
L_back_13:
    s_mov_b64 exec, s[70:71]
    v_alignbyte_b32 v121, v121, v120, 1
    v_perm_b32 v120, v120, v124, s47
    v_subrev_u32 v127, 3, v127
    s_mov_b64 exec, -1

    buffer_store_dwordx2 v[120:121], v127, s[24:27], 0 offen
    ds_read_b64 v[114:115], v2 offset:32784
    ds_read_b64 v[116:117], v2 offset:32792
    ds_read_b64 v[118:119], v2 offset:32776

    ds_read_b64 v[120:121], v2 offset:40976
    ds_read_b64 v[122:123], v2 offset:40984
    ds_read_b64 v[124:125], v2 offset:40968

    s_waitcnt lgkmcnt(3)
    v_lshrrev_b32 v126, 16, v115
    ds_read_b32 v126, v126 offset:8192

    s_waitcnt lgkmcnt(1)
    v_lshrrev_b32 v127, 16, v121
    ds_read_b32 v127, v127 offset:8192

    v_cmp_ne_u32_sdwa s[70:71], v115, v117 src0_sel:WORD_1 src1_sel:WORD_1
    v_cmp_ne_u32_sdwa vcc, v115, v119 src0_sel:WORD_1 src1_sel:WORD_1
    v_perm_b32 v115, v116, v115, s45
    s_mov_b32 s54, 10240
    v_alignbyte_b32 v118, v119, v118, 2
    s_waitcnt lgkmcnt(1)
    v_add3_u32 v126, v126, v49, s54

    s_and_b64 vcc, vcc, s[70:71]
    s_cbranch_scc1 L_fix_14
L_back_15:
    s_mov_b64 exec, s[70:71]
    v_alignbyte_b32 v115, v115, v114, 1
    v_perm_b32 v114, v114, v118, s47
    v_subrev_u32 v126, 3, v126
    s_mov_b64 exec, -1

    buffer_store_dwordx2 v[114:115], v126, s[24:27], 0 offen
    v_cmp_ne_u32_sdwa s[70:71], v121, v123 src0_sel:WORD_1 src1_sel:WORD_1
    v_cmp_ne_u32_sdwa vcc, v121, v125 src0_sel:WORD_1 src1_sel:WORD_1
    v_perm_b32 v121, v122, v121, s45
    s_mov_b32 s54, 15360
    v_alignbyte_b32 v124, v125, v124, 2
    s_waitcnt lgkmcnt(0)
    v_add3_u32 v127, v127, v49, s54

    s_and_b64 vcc, vcc, s[70:71]
    s_cbranch_scc1 L_fix_16
L_back_17:
    s_mov_b64 exec, s[70:71]
    v_alignbyte_b32 v121, v121, v120, 1
    v_perm_b32 v120, v120, v124, s47
    v_subrev_u32 v127, 3, v127
    s_mov_b64 exec, -1

    buffer_store_dwordx2 v[120:121], v127, s[24:27], 0 offen
    s_waitcnt vmcnt(16)
    v_mul_hi_u32_u24 v59, s40, v26
    v_mul_hi_u32_u24 v58, s41, v8
    v_mul_hi_u32_u24 v61, s40, v27
    v_mul_hi_u32_u24 v60, s41, v9
    v_mul_hi_u32_u24 v63, s40, v28
    v_mul_hi_u32_u24 v62, s41, v10
    v_mul_hi_u32_u24 v65, s40, v29
    v_mul_hi_u32_u24 v64, s41, v11
    v_mad_i32_i24 v26, v59, s42, v26
    v_lshl_add_u32 v59, v58, 7, v59
    v_mad_i32_i24 v27, v61, s42, v27
    v_lshl_add_u32 v61, v60, 7, v61
    v_mad_i32_i24 v28, v63, s42, v28
    v_lshl_add_u32 v63, v62, 7, v63
    v_mad_i32_i24 v29, v65, s42, v29
    v_lshl_add_u32 v65, v64, 7, v65
    v_mad_i32_i24 v8, v58, s43, v8
    v_lshlrev_b32 v59, 2, v59
    ds_add_rtn_u32 v90, v59, v104
    v_mad_i32_i24 v9, v60, s43, v9
    v_lshlrev_b32 v61, 2, v61
    ds_add_rtn_u32 v91, v61, v104
    v_mad_i32_i24 v10, v62, s43, v10
    v_lshlrev_b32 v63, 2, v63
    ds_add_rtn_u32 v92, v63, v104
    v_mad_i32_i24 v11, v64, s43, v11
    v_lshlrev_b32 v65, 2, v65
    ds_add_rtn_u32 v93, v65, v104
    v_lshlrev_b32 v114, 16, v42
    v_and_b32 v115, 0xffff0000, v42
    v_lshlrev_b32 v116, 16, v43
    v_and_b32 v117, 0xffff0000, v43
    v_mul_f32 v114, s44, v114
    v_mul_f32 v115, s44, v115
    v_mul_f32 v116, s44, v116
    v_mul_f32 v117, s44, v117
    v_fract_f32 v114, v114
    v_fract_f32 v115, v115
    v_fract_f32 v116, v116
    v_fract_f32 v117, v117
    v_cos_f32 v114, v114
    v_cos_f32 v115, v115
    v_cos_f32 v116, v116
    v_cos_f32 v117, v117
    v_lshlrev_b32 v26, 3, v26
    v_lshlrev_b32 v27, 3, v27
    v_lshlrev_b32 v28, 3, v28
    v_lshlrev_b32 v29, 3, v29
    v_lshl_or_b32 v58, v8, 16, v26
    v_lshl_or_b32 v60, v9, 16, v27
    v_lshl_or_b32 v62, v10, 16, v28
    v_lshl_or_b32 v64, v11, 16, v29
    v_fmaak_f32 v114, v114, v105, 0x4b000c00
    v_fmaak_f32 v115, v115, v105, 0x4b000c00
    v_fmaak_f32 v116, v116, v105, 0x4b000c00
    v_fmaak_f32 v117, v117, v105, 0x4b000c00
    v_perm_b32 v59, v59, v114, s46
    v_bfe_u32 v114, v114, 8, 4
    v_perm_b32 v61, v61, v115, s46
    v_bfe_u32 v115, v115, 8, 4
    v_perm_b32 v63, v63, v116, s46
    v_bfe_u32 v116, v116, 8, 4
    v_perm_b32 v65, v65, v117, s46
    v_bfe_u32 v117, v117, 8, 4
    v_add_u32 v58, v58, v114
    v_add_u32 v60, v60, v115
    v_add_u32 v62, v62, v116
    v_add_u32 v64, v64, v117
    ds_read_b64 v[114:115], v2 offset:49168
    ds_read_b64 v[116:117], v2 offset:49176
    ds_read_b64 v[118:119], v2 offset:49160

    ds_read_b64 v[120:121], v2 offset:57360
    ds_read_b64 v[122:123], v2 offset:57368
    ds_read_b64 v[124:125], v2 offset:57352

    s_waitcnt lgkmcnt(3)
    v_lshrrev_b32 v126, 16, v115
    ds_read_b32 v126, v126 offset:8192

    s_waitcnt lgkmcnt(1)
    v_lshrrev_b32 v127, 16, v121
    ds_read_b32 v127, v127 offset:8192

    v_cmp_ne_u32_sdwa s[70:71], v115, v117 src0_sel:WORD_1 src1_sel:WORD_1
    v_cmp_ne_u32_sdwa vcc, v115, v119 src0_sel:WORD_1 src1_sel:WORD_1
    v_perm_b32 v115, v116, v115, s45
    s_mov_b32 s54, 20480
    v_alignbyte_b32 v118, v119, v118, 2
    s_waitcnt lgkmcnt(1)
    v_add3_u32 v126, v126, v49, s54

    s_and_b64 vcc, vcc, s[70:71]
    s_cbranch_scc1 L_fix_18
L_back_19:
    s_mov_b64 exec, s[70:71]
    v_alignbyte_b32 v115, v115, v114, 1
    v_perm_b32 v114, v114, v118, s47
    v_subrev_u32 v126, 3, v126
    s_mov_b64 exec, -1

    buffer_store_dwordx2 v[114:115], v126, s[24:27], 0 offen
    v_cmp_ne_u32_sdwa s[70:71], v121, v123 src0_sel:WORD_1 src1_sel:WORD_1
    v_cmp_ne_u32_sdwa vcc, v121, v125 src0_sel:WORD_1 src1_sel:WORD_1
    v_perm_b32 v121, v122, v121, s45
    s_mov_b32 s54, 25600
    v_alignbyte_b32 v124, v125, v124, 2
    s_waitcnt lgkmcnt(0)
    v_add3_u32 v127, v127, v49, s54

    s_and_b64 vcc, vcc, s[70:71]
    s_cbranch_scc1 L_fix_20
L_back_21:
    s_mov_b64 exec, s[70:71]
    v_alignbyte_b32 v121, v121, v120, 1
    v_perm_b32 v120, v120, v124, s47
    v_subrev_u32 v127, 3, v127
    s_mov_b64 exec, -1

    buffer_store_dwordx2 v[120:121], v127, s[24:27], 0 offen
    v_add_u32 v112, 65536, v2
    ds_read_b64 v[114:115], v112 offset:16
    ds_read_b64 v[116:117], v112 offset:24
    ds_read_b64 v[118:119], v112 offset:8

    ds_read_b64 v[120:121], v112 offset:8208
    ds_read_b64 v[122:123], v112 offset:8216
    ds_read_b64 v[124:125], v112 offset:8200

    s_waitcnt lgkmcnt(3)
    v_lshrrev_b32 v126, 16, v115
    ds_read_b32 v126, v126 offset:8192

    s_waitcnt lgkmcnt(1)
    v_lshrrev_b32 v127, 16, v121
    ds_read_b32 v127, v127 offset:8192

    v_cmp_ne_u32_sdwa s[70:71], v115, v117 src0_sel:WORD_1 src1_sel:WORD_1
    v_cmp_ne_u32_sdwa vcc, v115, v119 src0_sel:WORD_1 src1_sel:WORD_1
    v_perm_b32 v115, v116, v115, s45
    s_mov_b32 s54, 30720
    v_alignbyte_b32 v118, v119, v118, 2
    s_waitcnt lgkmcnt(1)
    v_add3_u32 v126, v126, v49, s54

    s_and_b64 vcc, vcc, s[70:71]
    s_cbranch_scc1 L_fix_22
L_back_23:
    s_mov_b64 exec, s[70:71]
    v_alignbyte_b32 v115, v115, v114, 1
    v_perm_b32 v114, v114, v118, s47
    v_subrev_u32 v126, 3, v126
    s_mov_b64 exec, -1

    buffer_store_dwordx2 v[114:115], v126, s[24:27], 0 offen
    v_cmp_ne_u32_sdwa s[70:71], v121, v123 src0_sel:WORD_1 src1_sel:WORD_1
    v_cmp_ne_u32_sdwa vcc, v121, v125 src0_sel:WORD_1 src1_sel:WORD_1
    v_perm_b32 v121, v122, v121, s45
    s_mov_b32 s54, 35840
    v_alignbyte_b32 v124, v125, v124, 2
    s_waitcnt lgkmcnt(0)
    v_add3_u32 v127, v127, v49, s54

    s_and_b64 vcc, vcc, s[70:71]
    s_cbranch_scc1 L_fix_24
L_back_25:
    s_mov_b64 exec, s[70:71]
    v_alignbyte_b32 v121, v121, v120, 1
    v_perm_b32 v120, v120, v124, s47
    v_subrev_u32 v127, 3, v127
    s_mov_b64 exec, -1

    buffer_store_dwordx2 v[120:121], v127, s[24:27], 0 offen
    s_waitcnt vmcnt(17)
    v_mul_hi_u32_u24 v67, s40, v30
    v_mul_hi_u32_u24 v66, s41, v12
    v_mul_hi_u32_u24 v69, s40, v31
    v_mul_hi_u32_u24 v68, s41, v13
    v_mul_hi_u32_u24 v71, s40, v32
    v_mul_hi_u32_u24 v70, s41, v14
    v_mul_hi_u32_u24 v73, s40, v33
    v_mul_hi_u32_u24 v72, s41, v15
    v_mad_i32_i24 v30, v67, s42, v30
    v_lshl_add_u32 v67, v66, 7, v67
    v_mad_i32_i24 v31, v69, s42, v31
    v_lshl_add_u32 v69, v68, 7, v69
    v_mad_i32_i24 v32, v71, s42, v32
    v_lshl_add_u32 v71, v70, 7, v71
    v_mad_i32_i24 v33, v73, s42, v33
    v_lshl_add_u32 v73, v72, 7, v73
    v_mad_i32_i24 v12, v66, s43, v12
    v_lshlrev_b32 v67, 2, v67
    ds_add_rtn_u32 v94, v67, v104
    v_mad_i32_i24 v13, v68, s43, v13
    v_lshlrev_b32 v69, 2, v69
    ds_add_rtn_u32 v95, v69, v104
    v_mad_i32_i24 v14, v70, s43, v14
    v_lshlrev_b32 v71, 2, v71
    ds_add_rtn_u32 v96, v71, v104
    v_mad_i32_i24 v15, v72, s43, v15
    v_lshlrev_b32 v73, 2, v73
    ds_add_rtn_u32 v97, v73, v104
    v_lshlrev_b32 v114, 16, v44
    v_and_b32 v115, 0xffff0000, v44
    v_lshlrev_b32 v116, 16, v45
    v_and_b32 v117, 0xffff0000, v45
    v_mul_f32 v114, s44, v114
    v_mul_f32 v115, s44, v115
    v_mul_f32 v116, s44, v116
    v_mul_f32 v117, s44, v117
    v_fract_f32 v114, v114
    v_fract_f32 v115, v115
    v_fract_f32 v116, v116
    v_fract_f32 v117, v117
    v_cos_f32 v114, v114
    v_cos_f32 v115, v115
    v_cos_f32 v116, v116
    v_cos_f32 v117, v117
    v_lshlrev_b32 v30, 3, v30
    v_lshlrev_b32 v31, 3, v31
    v_lshlrev_b32 v32, 3, v32
    v_lshlrev_b32 v33, 3, v33
    v_lshl_or_b32 v66, v12, 16, v30
    v_lshl_or_b32 v68, v13, 16, v31
    v_lshl_or_b32 v70, v14, 16, v32
    v_lshl_or_b32 v72, v15, 16, v33
    v_fmaak_f32 v114, v114, v105, 0x4b000c00
    v_fmaak_f32 v115, v115, v105, 0x4b000c00
    v_fmaak_f32 v116, v116, v105, 0x4b000c00
    v_fmaak_f32 v117, v117, v105, 0x4b000c00
    v_perm_b32 v67, v67, v114, s46
    v_bfe_u32 v114, v114, 8, 4
    v_perm_b32 v69, v69, v115, s46
    v_bfe_u32 v115, v115, 8, 4
    v_perm_b32 v71, v71, v116, s46
    v_bfe_u32 v116, v116, 8, 4
    v_perm_b32 v73, v73, v117, s46
    v_bfe_u32 v117, v117, 8, 4
    v_add_u32 v66, v66, v114
    v_add_u32 v68, v68, v115
    v_add_u32 v70, v70, v116
    v_add_u32 v72, v72, v117
    ds_read_b64 v[114:115], v112 offset:16400
    ds_read_b64 v[116:117], v112 offset:16408
    ds_read_b64 v[118:119], v112 offset:16392

    ds_read_b64 v[120:121], v112 offset:24592
    ds_read_b64 v[122:123], v112 offset:24600
    ds_read_b64 v[124:125], v112 offset:24584

    s_waitcnt lgkmcnt(3)
    v_lshrrev_b32 v126, 16, v115
    ds_read_b32 v126, v126 offset:8192

    s_waitcnt lgkmcnt(1)
    v_lshrrev_b32 v127, 16, v121
    ds_read_b32 v127, v127 offset:8192

    v_cmp_ne_u32_sdwa s[70:71], v115, v117 src0_sel:WORD_1 src1_sel:WORD_1
    v_cmp_ne_u32_sdwa vcc, v115, v119 src0_sel:WORD_1 src1_sel:WORD_1
    v_perm_b32 v115, v116, v115, s45
    s_mov_b32 s54, 40960
    v_alignbyte_b32 v118, v119, v118, 2
    s_waitcnt lgkmcnt(1)
    v_add3_u32 v126, v126, v49, s54

    s_and_b64 vcc, vcc, s[70:71]
    s_cbranch_scc1 L_fix_26
L_back_27:
    s_mov_b64 exec, s[70:71]
    v_alignbyte_b32 v115, v115, v114, 1
    v_perm_b32 v114, v114, v118, s47
    v_subrev_u32 v126, 3, v126
    s_mov_b64 exec, -1

    buffer_store_dwordx2 v[114:115], v126, s[24:27], 0 offen
    v_cmp_ne_u32_sdwa s[70:71], v121, v123 src0_sel:WORD_1 src1_sel:WORD_1
    v_cmp_ne_u32_sdwa vcc, v121, v125 src0_sel:WORD_1 src1_sel:WORD_1
    v_perm_b32 v121, v122, v121, s45
    s_mov_b32 s54, 46080
    v_alignbyte_b32 v124, v125, v124, 2
    s_waitcnt lgkmcnt(0)
    v_add3_u32 v127, v127, v49, s54

    s_and_b64 vcc, vcc, s[70:71]
    s_cbranch_scc1 L_fix_28
L_back_29:
    s_mov_b64 exec, s[70:71]
    v_alignbyte_b32 v121, v121, v120, 1
    v_perm_b32 v120, v120, v124, s47
    v_subrev_u32 v127, 3, v127
    s_mov_b64 exec, -1

    buffer_store_dwordx2 v[120:121], v127, s[24:27], 0 offen
    ds_read_b64 v[114:115], v112 offset:32784
    ds_read_b64 v[116:117], v112 offset:32792
    ds_read_b64 v[118:119], v112 offset:32776

    ds_read_b64 v[120:121], v112 offset:40976
    ds_read_b64 v[122:123], v112 offset:40984
    ds_read_b64 v[124:125], v112 offset:40968

    s_waitcnt lgkmcnt(3)
    v_lshrrev_b32 v126, 16, v115
    ds_read_b32 v126, v126 offset:8192

    s_waitcnt lgkmcnt(1)
    v_lshrrev_b32 v127, 16, v121
    ds_read_b32 v127, v127 offset:8192

    v_cmp_ne_u32_sdwa s[70:71], v115, v117 src0_sel:WORD_1 src1_sel:WORD_1
    v_cmp_ne_u32_sdwa vcc, v115, v119 src0_sel:WORD_1 src1_sel:WORD_1
    v_perm_b32 v115, v116, v115, s45
    s_mov_b32 s54, 51200
    v_alignbyte_b32 v118, v119, v118, 2
    s_waitcnt lgkmcnt(1)
    v_add3_u32 v126, v126, v49, s54

    s_and_b64 vcc, vcc, s[70:71]
    s_cbranch_scc1 L_fix_30
L_back_31:
    s_mov_b64 exec, s[70:71]
    v_alignbyte_b32 v115, v115, v114, 1
    v_perm_b32 v114, v114, v118, s47
    v_subrev_u32 v126, 3, v126
    s_mov_b64 exec, -1

    buffer_store_dwordx2 v[114:115], v126, s[24:27], 0 offen
    v_cmp_ne_u32_sdwa s[70:71], v121, v123 src0_sel:WORD_1 src1_sel:WORD_1
    v_cmp_ne_u32_sdwa vcc, v121, v125 src0_sel:WORD_1 src1_sel:WORD_1
    v_perm_b32 v121, v122, v121, s45
    s_mov_b32 s54, 56320
    v_alignbyte_b32 v124, v125, v124, 2
    s_waitcnt lgkmcnt(0)
    v_add3_u32 v127, v127, v49, s54

    s_and_b64 vcc, vcc, s[70:71]
    s_cbranch_scc1 L_fix_32
L_back_33:
    s_mov_b64 exec, s[70:71]
    v_alignbyte_b32 v121, v121, v120, 1
    v_perm_b32 v120, v120, v124, s47
    v_subrev_u32 v127, 3, v127
    s_mov_b64 exec, -1

    buffer_store_dwordx2 v[120:121], v127, s[24:27], 0 offen
    s_waitcnt vmcnt(18)
    v_mul_hi_u32_u24 v75, s40, v34
    v_mul_hi_u32_u24 v74, s41, v16
    v_mul_hi_u32_u24 v77, s40, v35
    v_mul_hi_u32_u24 v76, s41, v17
    v_mul_hi_u32_u24 v79, s40, v36
    v_mul_hi_u32_u24 v78, s41, v18
    v_mul_hi_u32_u24 v81, s40, v37
    v_mul_hi_u32_u24 v80, s41, v19
    v_mad_i32_i24 v34, v75, s42, v34
    v_lshl_add_u32 v75, v74, 7, v75
    v_mad_i32_i24 v35, v77, s42, v35
    v_lshl_add_u32 v77, v76, 7, v77
    v_mad_i32_i24 v36, v79, s42, v36
    v_lshl_add_u32 v79, v78, 7, v79
    v_mad_i32_i24 v37, v81, s42, v37
    v_lshl_add_u32 v81, v80, 7, v81
    v_mad_i32_i24 v16, v74, s43, v16
    v_lshlrev_b32 v75, 2, v75
    ds_add_rtn_u32 v98, v75, v104
    v_mad_i32_i24 v17, v76, s43, v17
    v_lshlrev_b32 v77, 2, v77
    ds_add_rtn_u32 v99, v77, v104
    v_mad_i32_i24 v18, v78, s43, v18
    v_lshlrev_b32 v79, 2, v79
    ds_add_rtn_u32 v100, v79, v104
    v_mad_i32_i24 v19, v80, s43, v19
    v_lshlrev_b32 v81, 2, v81
    ds_add_rtn_u32 v101, v81, v104
    v_lshlrev_b32 v114, 16, v46
    v_and_b32 v115, 0xffff0000, v46
    v_lshlrev_b32 v116, 16, v47
    v_and_b32 v117, 0xffff0000, v47
    v_mul_f32 v114, s44, v114
    v_mul_f32 v115, s44, v115
    v_mul_f32 v116, s44, v116
    v_mul_f32 v117, s44, v117
    v_fract_f32 v114, v114
    v_fract_f32 v115, v115
    v_fract_f32 v116, v116
    v_fract_f32 v117, v117
    v_cos_f32 v114, v114
    v_cos_f32 v115, v115
    v_cos_f32 v116, v116
    v_cos_f32 v117, v117
    v_lshlrev_b32 v34, 3, v34
    v_lshlrev_b32 v35, 3, v35
    v_lshlrev_b32 v36, 3, v36
    v_lshlrev_b32 v37, 3, v37
    v_lshl_or_b32 v74, v16, 16, v34
    v_lshl_or_b32 v76, v17, 16, v35
    v_lshl_or_b32 v78, v18, 16, v36
    v_lshl_or_b32 v80, v19, 16, v37
    v_fmaak_f32 v114, v114, v105, 0x4b000c00
    v_fmaak_f32 v115, v115, v105, 0x4b000c00
    v_fmaak_f32 v116, v116, v105, 0x4b000c00
    v_fmaak_f32 v117, v117, v105, 0x4b000c00
    v_perm_b32 v75, v75, v114, s46
    v_bfe_u32 v114, v114, 8, 4
    v_perm_b32 v77, v77, v115, s46
    v_bfe_u32 v115, v115, 8, 4
    v_perm_b32 v79, v79, v116, s46
    v_bfe_u32 v116, v116, 8, 4
    v_perm_b32 v81, v81, v117, s46
    v_bfe_u32 v117, v117, 8, 4
    v_add_u32 v74, v74, v114
    v_add_u32 v76, v76, v115
    v_add_u32 v78, v78, v116
    v_add_u32 v80, v80, v117
    ds_read_b64 v[114:115], v112 offset:49168
    ds_read_b64 v[116:117], v112 offset:49176
    ds_read_b64 v[118:119], v112 offset:49160

    ds_read_b64 v[120:121], v112 offset:57360
    ds_read_b64 v[122:123], v112 offset:57368
    ds_read_b64 v[124:125], v112 offset:57352

    s_waitcnt lgkmcnt(3)
    v_lshrrev_b32 v126, 16, v115
    ds_read_b32 v126, v126 offset:8192

    s_waitcnt lgkmcnt(1)
    v_lshrrev_b32 v127, 16, v121
    ds_read_b32 v127, v127 offset:8192

    v_cmp_ne_u32_sdwa s[70:71], v115, v117 src0_sel:WORD_1 src1_sel:WORD_1
    v_cmp_ne_u32_sdwa vcc, v115, v119 src0_sel:WORD_1 src1_sel:WORD_1
    v_perm_b32 v115, v116, v115, s45
    s_mov_b32 s54, 61440
    v_alignbyte_b32 v118, v119, v118, 2
    s_waitcnt lgkmcnt(1)
    v_add3_u32 v126, v126, v49, s54

    s_and_b64 vcc, vcc, s[70:71]
    s_cbranch_scc1 L_fix_34
L_back_35:
    s_mov_b64 exec, s[70:71]
    v_alignbyte_b32 v115, v115, v114, 1
    v_perm_b32 v114, v114, v118, s47
    v_subrev_u32 v126, 3, v126
    s_mov_b64 exec, -1

    buffer_store_dwordx2 v[114:115], v126, s[24:27], 0 offen
    v_cmp_ne_u32_sdwa s[70:71], v121, v123 src0_sel:WORD_1 src1_sel:WORD_1
    v_cmp_ne_u32_sdwa vcc, v121, v125 src0_sel:WORD_1 src1_sel:WORD_1
    v_perm_b32 v121, v122, v121, s45
    s_mov_b32 s54, 66560
    v_alignbyte_b32 v124, v125, v124, 2
    s_waitcnt lgkmcnt(0)
    v_add3_u32 v127, v127, v49, s54

    s_and_b64 vcc, vcc, s[70:71]
    s_cbranch_scc1 L_fix_36
L_back_37:
    s_mov_b64 exec, s[70:71]
    v_alignbyte_b32 v121, v121, v120, 1
    v_perm_b32 v120, v120, v124, s47
    v_subrev_u32 v127, 3, v127
    s_mov_b64 exec, -1

    buffer_store_dwordx2 v[120:121], v127, s[24:27], 0 offen
    v_add_u32 v112, 131072, v2
    ds_read_b64 v[114:115], v112 offset:16
    ds_read_b64 v[116:117], v112 offset:24
    ds_read_b64 v[118:119], v112 offset:8

    ds_read_b64 v[120:121], v112 offset:8208
    ds_read_b64 v[122:123], v112 offset:8216
    ds_read_b64 v[124:125], v112 offset:8200

    s_waitcnt lgkmcnt(3)
    v_lshrrev_b32 v126, 16, v115
    ds_read_b32 v126, v126 offset:8192

    s_waitcnt lgkmcnt(1)
    v_lshrrev_b32 v127, 16, v121
    ds_read_b32 v127, v127 offset:8192

    v_cmp_ne_u32_sdwa s[70:71], v115, v117 src0_sel:WORD_1 src1_sel:WORD_1
    v_cmp_ne_u32_sdwa vcc, v115, v119 src0_sel:WORD_1 src1_sel:WORD_1
    v_perm_b32 v115, v116, v115, s45
    s_mov_b32 s54, 71680
    v_alignbyte_b32 v118, v119, v118, 2
    s_waitcnt lgkmcnt(1)
    v_add3_u32 v126, v126, v49, s54

    s_and_b64 vcc, vcc, s[70:71]
    s_cbranch_scc1 L_fix_38
L_back_39:
    s_mov_b64 exec, s[70:71]
    v_alignbyte_b32 v115, v115, v114, 1
    v_perm_b32 v114, v114, v118, s47
    v_subrev_u32 v126, 3, v126
    s_mov_b64 exec, -1

    buffer_store_dwordx2 v[114:115], v126, s[24:27], 0 offen
    v_cmp_ne_u32_sdwa s[70:71], v121, v123 src0_sel:WORD_1 src1_sel:WORD_1
    v_cmp_ne_u32_sdwa vcc, v121, v125 src0_sel:WORD_1 src1_sel:WORD_1
    v_perm_b32 v121, v122, v121, s45
    s_mov_b32 s54, 76800
    v_alignbyte_b32 v124, v125, v124, 2
    s_waitcnt lgkmcnt(0)
    v_add3_u32 v127, v127, v49, s54

    s_and_b64 vcc, vcc, s[70:71]
    s_cbranch_scc1 L_fix_40
L_back_41:
    s_mov_b64 exec, s[70:71]
    v_alignbyte_b32 v121, v121, v120, 1
    v_perm_b32 v120, v120, v124, s47
    v_subrev_u32 v127, 3, v127
    s_mov_b64 exec, -1

    buffer_store_dwordx2 v[120:121], v127, s[24:27], 0 offen
    s_waitcnt vmcnt(19)
    s_mov_b64 exec, s[66:67]
    v_mul_hi_u32_u24 v83, s40, v38
    v_mul_hi_u32_u24 v82, s41, v20
    v_mul_hi_u32_u24 v85, s40, v39
    v_mul_hi_u32_u24 v84, s41, v21
    v_mad_i32_i24 v38, v83, s42, v38
    v_lshl_add_u32 v83, v82, 7, v83
    v_mad_i32_i24 v39, v85, s42, v39
    v_lshl_add_u32 v85, v84, 7, v85
    v_mad_i32_i24 v20, v82, s43, v20
    v_lshlrev_b32 v83, 2, v83
    ds_add_rtn_u32 v102, v83, v104
    v_mad_i32_i24 v21, v84, s43, v21
    v_lshlrev_b32 v85, 2, v85
    ds_add_rtn_u32 v103, v85, v104
    v_lshlrev_b32 v114, 16, v48
    v_and_b32 v115, 0xffff0000, v48
    v_mul_f32 v114, s44, v114
    v_mul_f32 v115, s44, v115
    v_fract_f32 v114, v114
    v_fract_f32 v115, v115
    v_cos_f32 v114, v114
    v_cos_f32 v115, v115
    v_lshlrev_b32 v38, 3, v38
    v_lshlrev_b32 v39, 3, v39
    v_lshl_or_b32 v82, v20, 16, v38
    v_lshl_or_b32 v84, v21, 16, v39
    s_mov_b64 exec, -1
    v_fmaak_f32 v114, v114, v105, 0x4b000c00
    v_fmaak_f32 v115, v115, v105, 0x4b000c00
    v_perm_b32 v83, v83, v114, s46
    v_bfe_u32 v114, v114, 8, 4
    v_perm_b32 v85, v85, v115, s46
    v_bfe_u32 v115, v115, 8, 4
    v_add_u32 v82, v82, v114
    v_add_u32 v84, v84, v115
    s_waitcnt lgkmcnt(0)
    s_barrier

    ds_read_b64 v[108:109], v2
    s_waitcnt lgkmcnt(0)
    v_and_b32 v108, 0xffff, v108
    v_and_b32 v109, 0xffff, v109
    v_mov_b32 v106, v108
    v_mov_b32 v107, v109
    v_add_u32 v111, v108, v109

    buffer_atomic_add_x2 v[106:107], v2, s[20:23], 0 offen sc0
    s_nop 1
    v_add_u32_dpp v111, v111, v111 row_shr:1 row_mask:0xf bank_mask:0xf
    s_nop 1
    v_add_u32_dpp v111, v111, v111 row_shr:2 row_mask:0xf bank_mask:0xf
    s_nop 1
    v_add_u32_dpp v111, v111, v111 row_shr:4 row_mask:0xf bank_mask:0xf
    s_nop 1
    v_add_u32_dpp v111, v111, v111 row_shr:8 row_mask:0xf bank_mask:0xf
    s_nop 1
    v_add_u32_dpp v111, v111, v111 row_bcast:15 row_mask:0xa bank_mask:0xf
    s_nop 1
    v_add_u32_dpp v111, v111, v111 row_bcast:31 row_mask:0xc bank_mask:0xf
    s_mov_b32 exec_lo, 0
    s_brev_b32 exec_hi, 1
    ds_add_rtn_u32 v110, v113, v111
    s_mov_b64 exec, -1

    ds_read_b64 v[114:115], v112 offset:16400
    ds_read_b64 v[116:117], v112 offset:16408
    ds_read_b64 v[118:119], v112 offset:16392

    ds_read_b64 v[120:121], v112 offset:24592
    ds_read_b64 v[122:123], v112 offset:24600
    ds_read_b64 v[124:125], v112 offset:24584

    s_waitcnt lgkmcnt(3)
    v_lshrrev_b32 v126, 16, v115
    ds_read_b32 v126, v126 offset:8192

    s_waitcnt lgkmcnt(1)
    v_lshrrev_b32 v127, 16, v121
    ds_read_b32 v127, v127 offset:8192

    v_cmp_ne_u32_sdwa s[70:71], v115, v117 src0_sel:WORD_1 src1_sel:WORD_1
    v_cmp_ne_u32_sdwa vcc, v115, v119 src0_sel:WORD_1 src1_sel:WORD_1
    v_perm_b32 v115, v116, v115, s45
    s_mov_b32 s54, 81920
    v_alignbyte_b32 v118, v119, v118, 2
    s_waitcnt lgkmcnt(1)
    v_add3_u32 v126, v126, v49, s54

    s_and_b64 vcc, vcc, s[70:71]
    s_cbranch_scc1 L_fix_42
L_back_43:
    s_mov_b64 exec, s[70:71]
    v_alignbyte_b32 v115, v115, v114, 1
    v_perm_b32 v114, v114, v118, s47
    v_subrev_u32 v126, 3, v126
    s_mov_b64 exec, -1

    buffer_store_dwordx2 v[114:115], v126, s[24:27], 0 offen
    v_cmp_ne_u32_sdwa s[70:71], v121, v123 src0_sel:WORD_1 src1_sel:WORD_1
    v_cmp_ne_u32_sdwa vcc, v121, v125 src0_sel:WORD_1 src1_sel:WORD_1
    v_perm_b32 v121, v122, v121, s45
    s_mov_b32 s54, 87040
    v_alignbyte_b32 v124, v125, v124, 2
    s_waitcnt lgkmcnt(0)
    v_add3_u32 v127, v127, v49, s54

    s_andn2_b64 exec, -1, s[68:69]
    v_bfrev_b32 v127, 1
    s_mov_b64 exec, -1
    s_and_b64 vcc, vcc, s[68:69]

    s_and_b64 vcc, vcc, s[70:71]
    s_cbranch_scc1 L_fix_44
L_back_45:
    s_mov_b64 exec, s[70:71]
    v_alignbyte_b32 v121, v121, v120, 1
    v_perm_b32 v120, v120, v124, s47
    v_subrev_u32 v127, 3, v127
    s_mov_b64 exec, -1

    buffer_store_dwordx2 v[120:121], v127, s[24:27], 0 offen
    s_waitcnt lgkmcnt(0)
    v_readlane_b32 s77, v110, 63
    v_mul_u32_u24 v116, 7936, v0
    v_sub_u32 v111, v111, v109
    s_sub_u32 s77, s77, s50
    v_add_u32 v111, s77, v111
    v_sub_u32 v110, v111, v108
    v_lshlrev_b32 v115, 16, v111
    v_lshlrev_b32 v114, 16, v110
    ds_write_b64 v2, v[114:115]
    v_sub_u32 v110, v116, v110
    v_sub_u32 v111, v116, v111
    v_add_u32 v111, s48, v111
    s_lshl_b32 s74, s51, 3
    v_mov_b32 v126, s74
    v_mov_b32 v127, -1

    s_waitcnt lgkmcnt(0)
    s_barrier

    s_mov_b64 exec, 1
    ds_write_b32 v126, v127 offset:16404
    s_mov_b64 exec, -1

    v_lshrrev_b32 v114, 16, v51
    ds_read_b32 v114, v114
    v_lshrrev_b32 v115, 16, v53
    ds_read_b32 v115, v115
    v_lshrrev_b32 v116, 16, v55
    ds_read_b32 v116, v116
    v_lshrrev_b32 v117, 16, v57
    ds_read_b32 v117, v117
    v_lshrrev_b32 v118, 16, v59
    ds_read_b32 v118, v118
    v_lshrrev_b32 v119, 16, v61
    ds_read_b32 v119, v119
    v_lshrrev_b32 v120, 16, v63
    ds_read_b32 v120, v120
    v_lshrrev_b32 v121, 16, v65
    ds_read_b32 v121, v121
    s_waitcnt lgkmcnt(7)
    v_add_u32_sdwa v114, v114, v86 dst_sel:DWORD dst_unused:UNUSED_PAD src0_sel:WORD_1 src1_sel:WORD_0
    v_lshlrev_b32 v114, 3, v114
    ds_write_b64 v114, v[50:51] offset:16400

    s_waitcnt lgkmcnt(7)
    v_add_u32_sdwa v115, v115, v87 dst_sel:DWORD dst_unused:UNUSED_PAD src0_sel:WORD_1 src1_sel:WORD_0
    v_lshlrev_b32 v115, 3, v115
    ds_write_b64 v115, v[52:53] offset:16400

    s_waitcnt lgkmcnt(7)
    v_add_u32_sdwa v116, v116, v88 dst_sel:DWORD dst_unused:UNUSED_PAD src0_sel:WORD_1 src1_sel:WORD_0
    v_lshlrev_b32 v116, 3, v116
    ds_write_b64 v116, v[54:55] offset:16400

    s_waitcnt lgkmcnt(7)
    v_add_u32_sdwa v117, v117, v89 dst_sel:DWORD dst_unused:UNUSED_PAD src0_sel:WORD_1 src1_sel:WORD_0
    v_lshlrev_b32 v117, 3, v117
    ds_write_b64 v117, v[56:57] offset:16400

    s_waitcnt lgkmcnt(7)
    v_add_u32_sdwa v118, v118, v90 dst_sel:DWORD dst_unused:UNUSED_PAD src0_sel:WORD_1 src1_sel:WORD_0
    v_lshlrev_b32 v118, 3, v118
    ds_write_b64 v118, v[58:59] offset:16400

    s_waitcnt lgkmcnt(7)
    v_add_u32_sdwa v119, v119, v91 dst_sel:DWORD dst_unused:UNUSED_PAD src0_sel:WORD_1 src1_sel:WORD_0
    v_lshlrev_b32 v119, 3, v119
    ds_write_b64 v119, v[60:61] offset:16400

    s_waitcnt lgkmcnt(7)
    v_add_u32_sdwa v120, v120, v92 dst_sel:DWORD dst_unused:UNUSED_PAD src0_sel:WORD_1 src1_sel:WORD_0
    v_lshlrev_b32 v120, 3, v120
    ds_write_b64 v120, v[62:63] offset:16400

    s_waitcnt lgkmcnt(7)
    v_add_u32_sdwa v121, v121, v93 dst_sel:DWORD dst_unused:UNUSED_PAD src0_sel:WORD_1 src1_sel:WORD_0
    v_lshlrev_b32 v121, 3, v121
    ds_write_b64 v121, v[64:65] offset:16400

    v_lshrrev_b32 v114, 16, v67
    ds_read_b32 v114, v114
    v_lshrrev_b32 v115, 16, v69
    ds_read_b32 v115, v115
    v_lshrrev_b32 v116, 16, v71
    ds_read_b32 v116, v116
    v_lshrrev_b32 v117, 16, v73
    ds_read_b32 v117, v117
    v_lshrrev_b32 v118, 16, v75
    ds_read_b32 v118, v118
    v_lshrrev_b32 v119, 16, v77
    ds_read_b32 v119, v119
    v_lshrrev_b32 v120, 16, v79
    ds_read_b32 v120, v120
    v_lshrrev_b32 v121, 16, v81
    ds_read_b32 v121, v121
    s_waitcnt lgkmcnt(7)
    v_add_u32_sdwa v114, v114, v94 dst_sel:DWORD dst_unused:UNUSED_PAD src0_sel:WORD_1 src1_sel:WORD_0
    v_lshlrev_b32 v114, 3, v114
    ds_write_b64 v114, v[66:67] offset:16400

    s_waitcnt lgkmcnt(7)
    v_add_u32_sdwa v115, v115, v95 dst_sel:DWORD dst_unused:UNUSED_PAD src0_sel:WORD_1 src1_sel:WORD_0
    v_lshlrev_b32 v115, 3, v115
    ds_write_b64 v115, v[68:69] offset:16400

    s_waitcnt lgkmcnt(7)
    v_add_u32_sdwa v116, v116, v96 dst_sel:DWORD dst_unused:UNUSED_PAD src0_sel:WORD_1 src1_sel:WORD_0
    v_lshlrev_b32 v116, 3, v116
    ds_write_b64 v116, v[70:71] offset:16400

    s_waitcnt lgkmcnt(7)
    v_add_u32_sdwa v117, v117, v97 dst_sel:DWORD dst_unused:UNUSED_PAD src0_sel:WORD_1 src1_sel:WORD_0
    v_lshlrev_b32 v117, 3, v117
    ds_write_b64 v117, v[72:73] offset:16400

    s_waitcnt lgkmcnt(7)
    v_add_u32_sdwa v118, v118, v98 dst_sel:DWORD dst_unused:UNUSED_PAD src0_sel:WORD_1 src1_sel:WORD_0
    v_lshlrev_b32 v118, 3, v118
    ds_write_b64 v118, v[74:75] offset:16400

    s_waitcnt lgkmcnt(7)
    v_add_u32_sdwa v119, v119, v99 dst_sel:DWORD dst_unused:UNUSED_PAD src0_sel:WORD_1 src1_sel:WORD_0
    v_lshlrev_b32 v119, 3, v119
    ds_write_b64 v119, v[76:77] offset:16400

    s_waitcnt lgkmcnt(7)
    v_add_u32_sdwa v120, v120, v100 dst_sel:DWORD dst_unused:UNUSED_PAD src0_sel:WORD_1 src1_sel:WORD_0
    v_lshlrev_b32 v120, 3, v120
    ds_write_b64 v120, v[78:79] offset:16400

    s_waitcnt lgkmcnt(7)
    v_add_u32_sdwa v121, v121, v101 dst_sel:DWORD dst_unused:UNUSED_PAD src0_sel:WORD_1 src1_sel:WORD_0
    v_lshlrev_b32 v121, 3, v121
    ds_write_b64 v121, v[80:81] offset:16400

    s_mov_b64 exec, s[66:67]
    v_lshrrev_b32 v114, 16, v83
    ds_read_b32 v114, v114
    v_lshrrev_b32 v115, 16, v85
    ds_read_b32 v115, v115
    s_waitcnt lgkmcnt(1)
    v_add_u32_sdwa v114, v114, v102 dst_sel:DWORD dst_unused:UNUSED_PAD src0_sel:WORD_1 src1_sel:WORD_0
    v_lshlrev_b32 v114, 3, v114
    ds_write_b64 v114, v[82:83] offset:16400

    s_waitcnt lgkmcnt(1)
    v_add_u32_sdwa v115, v115, v103 dst_sel:DWORD dst_unused:UNUSED_PAD src0_sel:WORD_1 src1_sel:WORD_0
    v_lshlrev_b32 v115, 3, v115
    ds_write_b64 v115, v[84:85] offset:16400

    s_mov_b64 exec, -1
    s_add_u32 s50, s50, s51
    s_add_u32 s49, s49, 1

    buffer_load_dwordx4 v[26:29], v1, s[12:15], s57 offen nt
    buffer_load_dwordx4 v[8:11], v1, s[8:11], s57 offen nt
    buffer_load_dwordx2 v[42:43], v2, s[16:19], s62 offen nt
    buffer_load_dwordx4 v[30:33], v1, s[12:15], s58 offen nt
    buffer_load_dwordx4 v[12:15], v1, s[8:11], s58 offen nt
    buffer_load_dwordx2 v[44:45], v2, s[16:19], s63 offen nt
    buffer_load_dwordx4 v[34:37], v1, s[12:15], s59 offen nt
    buffer_load_dwordx4 v[16:19], v1, s[8:11], s59 offen nt
    buffer_load_dwordx2 v[46:47], v2, s[16:19], s64 offen nt
    buffer_load_dwordx2 v[38:39], v2, s[12:15], s60 offen nt
    buffer_load_dwordx2 v[20:21], v2, s[8:11], s60 offen nt
    buffer_load_dword v48, v3, s[16:19], s65 offen nt
    s_cmp_lt_u32 s49, 10
    s_cbranch_scc1 L_p1loop_3
    s_mov_b32 s52, s51
    s_sub_u32 s51, 200000, s50
    s_min_u32 s51, s51, 18240
    s_sub_u32 s75, s51, 16384
    s_lshl_b32 s75, s75, 1
    v_cmp_gt_u32 s[66:67], s75, v3

    s_waitcnt vmcnt(31)
    v_mul_hi_u32_u24 v51, s40, v22
    v_mul_hi_u32_u24 v50, s41, v4
    v_mul_hi_u32_u24 v53, s40, v23
    v_mul_hi_u32_u24 v52, s41, v5
    v_mul_hi_u32_u24 v55, s40, v24
    v_mul_hi_u32_u24 v54, s41, v6
    v_mul_hi_u32_u24 v57, s40, v25
    v_mul_hi_u32_u24 v56, s41, v7
    v_mad_i32_i24 v22, v51, s42, v22
    v_lshl_add_u32 v51, v50, 7, v51
    v_mad_i32_i24 v23, v53, s42, v23
    v_lshl_add_u32 v53, v52, 7, v53
    v_mad_i32_i24 v24, v55, s42, v24
    v_lshl_add_u32 v55, v54, 7, v55
    v_mad_i32_i24 v25, v57, s42, v25
    v_lshl_add_u32 v57, v56, 7, v57
    v_mad_i32_i24 v4, v50, s43, v4
    v_lshlrev_b32 v51, 2, v51
    ds_add_rtn_u32 v86, v51, v104
    v_mad_i32_i24 v5, v52, s43, v5
    v_lshlrev_b32 v53, 2, v53
    ds_add_rtn_u32 v87, v53, v104
    v_mad_i32_i24 v6, v54, s43, v6
    v_lshlrev_b32 v55, 2, v55
    ds_add_rtn_u32 v88, v55, v104
    v_mad_i32_i24 v7, v56, s43, v7
    v_lshlrev_b32 v57, 2, v57
    ds_add_rtn_u32 v89, v57, v104
    v_lshlrev_b32 v114, 16, v40
    v_and_b32 v115, 0xffff0000, v40
    v_lshlrev_b32 v116, 16, v41
    v_and_b32 v117, 0xffff0000, v41
    v_mul_f32 v114, s44, v114
    v_mul_f32 v115, s44, v115
    v_mul_f32 v116, s44, v116
    v_mul_f32 v117, s44, v117
    v_fract_f32 v114, v114
    v_fract_f32 v115, v115
    v_fract_f32 v116, v116
    v_fract_f32 v117, v117
    v_cos_f32 v114, v114
    v_cos_f32 v115, v115
    v_cos_f32 v116, v116
    v_cos_f32 v117, v117
    v_lshlrev_b32 v22, 3, v22
    v_lshlrev_b32 v23, 3, v23
    v_lshlrev_b32 v24, 3, v24
    v_lshlrev_b32 v25, 3, v25
    v_lshl_or_b32 v50, v4, 16, v22
    v_lshl_or_b32 v52, v5, 16, v23
    v_lshl_or_b32 v54, v6, 16, v24
    v_lshl_or_b32 v56, v7, 16, v25
    v_fmaak_f32 v114, v114, v105, 0x4b000c00
    v_fmaak_f32 v115, v115, v105, 0x4b000c00
    v_fmaak_f32 v116, v116, v105, 0x4b000c00
    v_fmaak_f32 v117, v117, v105, 0x4b000c00
    v_perm_b32 v51, v51, v114, s46
    v_bfe_u32 v114, v114, 8, 4
    v_perm_b32 v53, v53, v115, s46
    v_bfe_u32 v115, v115, 8, 4
    v_perm_b32 v55, v55, v116, s46
    v_bfe_u32 v116, v116, 8, 4
    v_perm_b32 v57, v57, v117, s46
    v_bfe_u32 v117, v117, 8, 4
    v_add_u32 v50, v50, v114
    v_add_u32 v52, v52, v115
    v_add_u32 v54, v54, v116
    v_add_u32 v56, v56, v117
    s_waitcnt vmcnt(14)
    v_add_u32 v114, v106, v108
    v_add_u32 v115, v107, v109
    v_max_u32 v114, v114, v115
    v_cmp_lt_u32 vcc, s48, v114
    v_min_u32 v106, s48, v106
    v_min_u32 v107, s48, v107
    v_add_u32 v106, v106, v110
    v_add_u32 v107, v107, v111
    v_lshl_add_u32 v106, v106, 2, v106
    v_lshl_add_u32 v107, v107, 2, v107
    ds_write_b64 v2, v[106:107] offset:8192
    s_cbranch_vccz L_noov_46
    ds_write_b32 v113, v104 offset:4
L_noov_46:
    s_sub_u32 s74, s52, 17408
    s_max_i32 s74, s74, 0
    v_cmp_gt_u32 s[68:69], s74, v0
    s_waitcnt lgkmcnt(0)
    s_barrier
    ds_read_b32 v114, v113 offset:4
    s_waitcnt lgkmcnt(0)
    v_readfirstlane_b32 s53, v114
    s_nop 1
    s_cmp_lg_u32 s53, 0
    s_cbranch_scc1 L_slow_47
L_sback_48:

    ds_read_b64 v[114:115], v2 offset:16400
    ds_read_b64 v[116:117], v2 offset:16408
    ds_read_b64 v[118:119], v2 offset:16392

    ds_read_b64 v[120:121], v2 offset:24592
    ds_read_b64 v[122:123], v2 offset:24600
    ds_read_b64 v[124:125], v2 offset:24584

    s_waitcnt lgkmcnt(3)
    v_lshrrev_b32 v126, 16, v115
    ds_read_b32 v126, v126 offset:8192

    s_waitcnt lgkmcnt(1)
    v_lshrrev_b32 v127, 16, v121
    ds_read_b32 v127, v127 offset:8192

    v_cmp_ne_u32_sdwa s[70:71], v115, v117 src0_sel:WORD_1 src1_sel:WORD_1
    v_cmp_ne_u32_sdwa vcc, v115, v119 src0_sel:WORD_1 src1_sel:WORD_1
    v_perm_b32 v115, v116, v115, s45
    s_mov_b32 s54, 0
    v_alignbyte_b32 v118, v119, v118, 2
    s_waitcnt lgkmcnt(1)
    v_add3_u32 v126, v126, v49, s54

    s_and_b64 vcc, vcc, s[70:71]
    s_cbranch_scc1 L_fix_52
L_back_53:
    s_mov_b64 exec, s[70:71]
    v_alignbyte_b32 v115, v115, v114, 1
    v_perm_b32 v114, v114, v118, s47
    v_subrev_u32 v126, 3, v126
    s_mov_b64 exec, -1

    buffer_store_dwordx2 v[114:115], v126, s[24:27], 0 offen
    v_cmp_ne_u32_sdwa s[70:71], v121, v123 src0_sel:WORD_1 src1_sel:WORD_1
    v_cmp_ne_u32_sdwa vcc, v121, v125 src0_sel:WORD_1 src1_sel:WORD_1
    v_perm_b32 v121, v122, v121, s45
    s_mov_b32 s54, 5120
    v_alignbyte_b32 v124, v125, v124, 2
    s_waitcnt lgkmcnt(0)
    v_add3_u32 v127, v127, v49, s54

    s_and_b64 vcc, vcc, s[70:71]
    s_cbranch_scc1 L_fix_54
L_back_55:
    s_mov_b64 exec, s[70:71]
    v_alignbyte_b32 v121, v121, v120, 1
    v_perm_b32 v120, v120, v124, s47
    v_subrev_u32 v127, 3, v127
    s_mov_b64 exec, -1

    buffer_store_dwordx2 v[120:121], v127, s[24:27], 0 offen
    ds_read_b64 v[114:115], v2 offset:32784
    ds_read_b64 v[116:117], v2 offset:32792
    ds_read_b64 v[118:119], v2 offset:32776

    ds_read_b64 v[120:121], v2 offset:40976
    ds_read_b64 v[122:123], v2 offset:40984
    ds_read_b64 v[124:125], v2 offset:40968

    s_waitcnt lgkmcnt(3)
    v_lshrrev_b32 v126, 16, v115
    ds_read_b32 v126, v126 offset:8192

    s_waitcnt lgkmcnt(1)
    v_lshrrev_b32 v127, 16, v121
    ds_read_b32 v127, v127 offset:8192

    v_cmp_ne_u32_sdwa s[70:71], v115, v117 src0_sel:WORD_1 src1_sel:WORD_1
    v_cmp_ne_u32_sdwa vcc, v115, v119 src0_sel:WORD_1 src1_sel:WORD_1
    v_perm_b32 v115, v116, v115, s45
    s_mov_b32 s54, 10240
    v_alignbyte_b32 v118, v119, v118, 2
    s_waitcnt lgkmcnt(1)
    v_add3_u32 v126, v126, v49, s54

    s_and_b64 vcc, vcc, s[70:71]
    s_cbranch_scc1 L_fix_56
L_back_57:
    s_mov_b64 exec, s[70:71]
    v_alignbyte_b32 v115, v115, v114, 1
    v_perm_b32 v114, v114, v118, s47
    v_subrev_u32 v126, 3, v126
    s_mov_b64 exec, -1

    buffer_store_dwordx2 v[114:115], v126, s[24:27], 0 offen
    v_cmp_ne_u32_sdwa s[70:71], v121, v123 src0_sel:WORD_1 src1_sel:WORD_1
    v_cmp_ne_u32_sdwa vcc, v121, v125 src0_sel:WORD_1 src1_sel:WORD_1
    v_perm_b32 v121, v122, v121, s45
    s_mov_b32 s54, 15360
    v_alignbyte_b32 v124, v125, v124, 2
    s_waitcnt lgkmcnt(0)
    v_add3_u32 v127, v127, v49, s54

    s_and_b64 vcc, vcc, s[70:71]
    s_cbranch_scc1 L_fix_58
L_back_59:
    s_mov_b64 exec, s[70:71]
    v_alignbyte_b32 v121, v121, v120, 1
    v_perm_b32 v120, v120, v124, s47
    v_subrev_u32 v127, 3, v127
    s_mov_b64 exec, -1

    buffer_store_dwordx2 v[120:121], v127, s[24:27], 0 offen
    s_waitcnt vmcnt(13)
    v_mul_hi_u32_u24 v59, s40, v26
    v_mul_hi_u32_u24 v58, s41, v8
    v_mul_hi_u32_u24 v61, s40, v27
    v_mul_hi_u32_u24 v60, s41, v9
    v_mul_hi_u32_u24 v63, s40, v28
    v_mul_hi_u32_u24 v62, s41, v10
    v_mul_hi_u32_u24 v65, s40, v29
    v_mul_hi_u32_u24 v64, s41, v11
    v_mad_i32_i24 v26, v59, s42, v26
    v_lshl_add_u32 v59, v58, 7, v59
    v_mad_i32_i24 v27, v61, s42, v27
    v_lshl_add_u32 v61, v60, 7, v61
    v_mad_i32_i24 v28, v63, s42, v28
    v_lshl_add_u32 v63, v62, 7, v63
    v_mad_i32_i24 v29, v65, s42, v29
    v_lshl_add_u32 v65, v64, 7, v65
    v_mad_i32_i24 v8, v58, s43, v8
    v_lshlrev_b32 v59, 2, v59
    ds_add_rtn_u32 v90, v59, v104
    v_mad_i32_i24 v9, v60, s43, v9
    v_lshlrev_b32 v61, 2, v61
    ds_add_rtn_u32 v91, v61, v104
    v_mad_i32_i24 v10, v62, s43, v10
    v_lshlrev_b32 v63, 2, v63
    ds_add_rtn_u32 v92, v63, v104
    v_mad_i32_i24 v11, v64, s43, v11
    v_lshlrev_b32 v65, 2, v65
    ds_add_rtn_u32 v93, v65, v104
    v_lshlrev_b32 v114, 16, v42
    v_and_b32 v115, 0xffff0000, v42
    v_lshlrev_b32 v116, 16, v43
    v_and_b32 v117, 0xffff0000, v43
    v_mul_f32 v114, s44, v114
    v_mul_f32 v115, s44, v115
    v_mul_f32 v116, s44, v116
    v_mul_f32 v117, s44, v117
    v_fract_f32 v114, v114
    v_fract_f32 v115, v115
    v_fract_f32 v116, v116
    v_fract_f32 v117, v117
    v_cos_f32 v114, v114
    v_cos_f32 v115, v115
    v_cos_f32 v116, v116
    v_cos_f32 v117, v117
    v_lshlrev_b32 v26, 3, v26
    v_lshlrev_b32 v27, 3, v27
    v_lshlrev_b32 v28, 3, v28
    v_lshlrev_b32 v29, 3, v29
    v_lshl_or_b32 v58, v8, 16, v26
    v_lshl_or_b32 v60, v9, 16, v27
    v_lshl_or_b32 v62, v10, 16, v28
    v_lshl_or_b32 v64, v11, 16, v29
    v_fmaak_f32 v114, v114, v105, 0x4b000c00
    v_fmaak_f32 v115, v115, v105, 0x4b000c00
    v_fmaak_f32 v116, v116, v105, 0x4b000c00
    v_fmaak_f32 v117, v117, v105, 0x4b000c00
    v_perm_b32 v59, v59, v114, s46
    v_bfe_u32 v114, v114, 8, 4
    v_perm_b32 v61, v61, v115, s46
    v_bfe_u32 v115, v115, 8, 4
    v_perm_b32 v63, v63, v116, s46
    v_bfe_u32 v116, v116, 8, 4
    v_perm_b32 v65, v65, v117, s46
    v_bfe_u32 v117, v117, 8, 4
    v_add_u32 v58, v58, v114
    v_add_u32 v60, v60, v115
    v_add_u32 v62, v62, v116
    v_add_u32 v64, v64, v117
    ds_read_b64 v[114:115], v2 offset:49168
    ds_read_b64 v[116:117], v2 offset:49176
    ds_read_b64 v[118:119], v2 offset:49160

    ds_read_b64 v[120:121], v2 offset:57360
    ds_read_b64 v[122:123], v2 offset:57368
    ds_read_b64 v[124:125], v2 offset:57352

    s_waitcnt lgkmcnt(3)
    v_lshrrev_b32 v126, 16, v115
    ds_read_b32 v126, v126 offset:8192

    s_waitcnt lgkmcnt(1)
    v_lshrrev_b32 v127, 16, v121
    ds_read_b32 v127, v127 offset:8192

    v_cmp_ne_u32_sdwa s[70:71], v115, v117 src0_sel:WORD_1 src1_sel:WORD_1
    v_cmp_ne_u32_sdwa vcc, v115, v119 src0_sel:WORD_1 src1_sel:WORD_1
    v_perm_b32 v115, v116, v115, s45
    s_mov_b32 s54, 20480
    v_alignbyte_b32 v118, v119, v118, 2
    s_waitcnt lgkmcnt(1)
    v_add3_u32 v126, v126, v49, s54

    s_and_b64 vcc, vcc, s[70:71]
    s_cbranch_scc1 L_fix_60
L_back_61:
    s_mov_b64 exec, s[70:71]
    v_alignbyte_b32 v115, v115, v114, 1
    v_perm_b32 v114, v114, v118, s47
    v_subrev_u32 v126, 3, v126
    s_mov_b64 exec, -1

    buffer_store_dwordx2 v[114:115], v126, s[24:27], 0 offen
    v_cmp_ne_u32_sdwa s[70:71], v121, v123 src0_sel:WORD_1 src1_sel:WORD_1
    v_cmp_ne_u32_sdwa vcc, v121, v125 src0_sel:WORD_1 src1_sel:WORD_1
    v_perm_b32 v121, v122, v121, s45
    s_mov_b32 s54, 25600
    v_alignbyte_b32 v124, v125, v124, 2
    s_waitcnt lgkmcnt(0)
    v_add3_u32 v127, v127, v49, s54

    s_and_b64 vcc, vcc, s[70:71]
    s_cbranch_scc1 L_fix_62
L_back_63:
    s_mov_b64 exec, s[70:71]
    v_alignbyte_b32 v121, v121, v120, 1
    v_perm_b32 v120, v120, v124, s47
    v_subrev_u32 v127, 3, v127
    s_mov_b64 exec, -1

    buffer_store_dwordx2 v[120:121], v127, s[24:27], 0 offen
    v_add_u32 v112, 65536, v2
    ds_read_b64 v[114:115], v112 offset:16
    ds_read_b64 v[116:117], v112 offset:24
    ds_read_b64 v[118:119], v112 offset:8

    ds_read_b64 v[120:121], v112 offset:8208
    ds_read_b64 v[122:123], v112 offset:8216
    ds_read_b64 v[124:125], v112 offset:8200

    s_waitcnt lgkmcnt(3)
    v_lshrrev_b32 v126, 16, v115
    ds_read_b32 v126, v126 offset:8192

    s_waitcnt lgkmcnt(1)
    v_lshrrev_b32 v127, 16, v121
    ds_read_b32 v127, v127 offset:8192

    v_cmp_ne_u32_sdwa s[70:71], v115, v117 src0_sel:WORD_1 src1_sel:WORD_1
    v_cmp_ne_u32_sdwa vcc, v115, v119 src0_sel:WORD_1 src1_sel:WORD_1
    v_perm_b32 v115, v116, v115, s45
    s_mov_b32 s54, 30720
    v_alignbyte_b32 v118, v119, v118, 2
    s_waitcnt lgkmcnt(1)
    v_add3_u32 v126, v126, v49, s54

    s_and_b64 vcc, vcc, s[70:71]
    s_cbranch_scc1 L_fix_64
L_back_65:
    s_mov_b64 exec, s[70:71]
    v_alignbyte_b32 v115, v115, v114, 1
    v_perm_b32 v114, v114, v118, s47
    v_subrev_u32 v126, 3, v126
    s_mov_b64 exec, -1

    buffer_store_dwordx2 v[114:115], v126, s[24:27], 0 offen
    v_cmp_ne_u32_sdwa s[70:71], v121, v123 src0_sel:WORD_1 src1_sel:WORD_1
    v_cmp_ne_u32_sdwa vcc, v121, v125 src0_sel:WORD_1 src1_sel:WORD_1
    v_perm_b32 v121, v122, v121, s45
    s_mov_b32 s54, 35840
    v_alignbyte_b32 v124, v125, v124, 2
    s_waitcnt lgkmcnt(0)
    v_add3_u32 v127, v127, v49, s54

    s_and_b64 vcc, vcc, s[70:71]
    s_cbranch_scc1 L_fix_66
L_back_67:
    s_mov_b64 exec, s[70:71]
    v_alignbyte_b32 v121, v121, v120, 1
    v_perm_b32 v120, v120, v124, s47
    v_subrev_u32 v127, 3, v127
    s_mov_b64 exec, -1

    buffer_store_dwordx2 v[120:121], v127, s[24:27], 0 offen
    s_waitcnt vmcnt(14)
    v_mul_hi_u32_u24 v67, s40, v30
    v_mul_hi_u32_u24 v66, s41, v12
    v_mul_hi_u32_u24 v69, s40, v31
    v_mul_hi_u32_u24 v68, s41, v13
    v_mul_hi_u32_u24 v71, s40, v32
    v_mul_hi_u32_u24 v70, s41, v14
    v_mul_hi_u32_u24 v73, s40, v33
    v_mul_hi_u32_u24 v72, s41, v15
    v_mad_i32_i24 v30, v67, s42, v30
    v_lshl_add_u32 v67, v66, 7, v67
    v_mad_i32_i24 v31, v69, s42, v31
    v_lshl_add_u32 v69, v68, 7, v69
    v_mad_i32_i24 v32, v71, s42, v32
    v_lshl_add_u32 v71, v70, 7, v71
    v_mad_i32_i24 v33, v73, s42, v33
    v_lshl_add_u32 v73, v72, 7, v73
    v_mad_i32_i24 v12, v66, s43, v12
    v_lshlrev_b32 v67, 2, v67
    ds_add_rtn_u32 v94, v67, v104
    v_mad_i32_i24 v13, v68, s43, v13
    v_lshlrev_b32 v69, 2, v69
    ds_add_rtn_u32 v95, v69, v104
    v_mad_i32_i24 v14, v70, s43, v14
    v_lshlrev_b32 v71, 2, v71
    ds_add_rtn_u32 v96, v71, v104
    v_mad_i32_i24 v15, v72, s43, v15
    v_lshlrev_b32 v73, 2, v73
    ds_add_rtn_u32 v97, v73, v104
    v_lshlrev_b32 v114, 16, v44
    v_and_b32 v115, 0xffff0000, v44
    v_lshlrev_b32 v116, 16, v45
    v_and_b32 v117, 0xffff0000, v45
    v_mul_f32 v114, s44, v114
    v_mul_f32 v115, s44, v115
    v_mul_f32 v116, s44, v116
    v_mul_f32 v117, s44, v117
    v_fract_f32 v114, v114
    v_fract_f32 v115, v115
    v_fract_f32 v116, v116
    v_fract_f32 v117, v117
    v_cos_f32 v114, v114
    v_cos_f32 v115, v115
    v_cos_f32 v116, v116
    v_cos_f32 v117, v117
    v_lshlrev_b32 v30, 3, v30
    v_lshlrev_b32 v31, 3, v31
    v_lshlrev_b32 v32, 3, v32
    v_lshlrev_b32 v33, 3, v33
    v_lshl_or_b32 v66, v12, 16, v30
    v_lshl_or_b32 v68, v13, 16, v31
    v_lshl_or_b32 v70, v14, 16, v32
    v_lshl_or_b32 v72, v15, 16, v33
    v_fmaak_f32 v114, v114, v105, 0x4b000c00
    v_fmaak_f32 v115, v115, v105, 0x4b000c00
    v_fmaak_f32 v116, v116, v105, 0x4b000c00
    v_fmaak_f32 v117, v117, v105, 0x4b000c00
    v_perm_b32 v67, v67, v114, s46
    v_bfe_u32 v114, v114, 8, 4
    v_perm_b32 v69, v69, v115, s46
    v_bfe_u32 v115, v115, 8, 4
    v_perm_b32 v71, v71, v116, s46
    v_bfe_u32 v116, v116, 8, 4
    v_perm_b32 v73, v73, v117, s46
    v_bfe_u32 v117, v117, 8, 4
    v_add_u32 v66, v66, v114
    v_add_u32 v68, v68, v115
    v_add_u32 v70, v70, v116
    v_add_u32 v72, v72, v117
    ds_read_b64 v[114:115], v112 offset:16400
    ds_read_b64 v[116:117], v112 offset:16408
    ds_read_b64 v[118:119], v112 offset:16392

    ds_read_b64 v[120:121], v112 offset:24592
    ds_read_b64 v[122:123], v112 offset:24600
    ds_read_b64 v[124:125], v112 offset:24584

    s_waitcnt lgkmcnt(3)
    v_lshrrev_b32 v126, 16, v115
    ds_read_b32 v126, v126 offset:8192

    s_waitcnt lgkmcnt(1)
    v_lshrrev_b32 v127, 16, v121
    ds_read_b32 v127, v127 offset:8192

    v_cmp_ne_u32_sdwa s[70:71], v115, v117 src0_sel:WORD_1 src1_sel:WORD_1
    v_cmp_ne_u32_sdwa vcc, v115, v119 src0_sel:WORD_1 src1_sel:WORD_1
    v_perm_b32 v115, v116, v115, s45
    s_mov_b32 s54, 40960
    v_alignbyte_b32 v118, v119, v118, 2
    s_waitcnt lgkmcnt(1)
    v_add3_u32 v126, v126, v49, s54

    s_and_b64 vcc, vcc, s[70:71]
    s_cbranch_scc1 L_fix_68
L_back_69:
    s_mov_b64 exec, s[70:71]
    v_alignbyte_b32 v115, v115, v114, 1
    v_perm_b32 v114, v114, v118, s47
    v_subrev_u32 v126, 3, v126
    s_mov_b64 exec, -1

    buffer_store_dwordx2 v[114:115], v126, s[24:27], 0 offen
    v_cmp_ne_u32_sdwa s[70:71], v121, v123 src0_sel:WORD_1 src1_sel:WORD_1
    v_cmp_ne_u32_sdwa vcc, v121, v125 src0_sel:WORD_1 src1_sel:WORD_1
    v_perm_b32 v121, v122, v121, s45
    s_mov_b32 s54, 46080
    v_alignbyte_b32 v124, v125, v124, 2
    s_waitcnt lgkmcnt(0)
    v_add3_u32 v127, v127, v49, s54

    s_and_b64 vcc, vcc, s[70:71]
    s_cbranch_scc1 L_fix_70
L_back_71:
    s_mov_b64 exec, s[70:71]
    v_alignbyte_b32 v121, v121, v120, 1
    v_perm_b32 v120, v120, v124, s47
    v_subrev_u32 v127, 3, v127
    s_mov_b64 exec, -1

    buffer_store_dwordx2 v[120:121], v127, s[24:27], 0 offen
    ds_read_b64 v[114:115], v112 offset:32784
    ds_read_b64 v[116:117], v112 offset:32792
    ds_read_b64 v[118:119], v112 offset:32776

    ds_read_b64 v[120:121], v112 offset:40976
    ds_read_b64 v[122:123], v112 offset:40984
    ds_read_b64 v[124:125], v112 offset:40968

    s_waitcnt lgkmcnt(3)
    v_lshrrev_b32 v126, 16, v115
    ds_read_b32 v126, v126 offset:8192

    s_waitcnt lgkmcnt(1)
    v_lshrrev_b32 v127, 16, v121
    ds_read_b32 v127, v127 offset:8192

    v_cmp_ne_u32_sdwa s[70:71], v115, v117 src0_sel:WORD_1 src1_sel:WORD_1
    v_cmp_ne_u32_sdwa vcc, v115, v119 src0_sel:WORD_1 src1_sel:WORD_1
    v_perm_b32 v115, v116, v115, s45
    s_mov_b32 s54, 51200
    v_alignbyte_b32 v118, v119, v118, 2
    s_waitcnt lgkmcnt(1)
    v_add3_u32 v126, v126, v49, s54

    s_and_b64 vcc, vcc, s[70:71]
    s_cbranch_scc1 L_fix_72
L_back_73:
    s_mov_b64 exec, s[70:71]
    v_alignbyte_b32 v115, v115, v114, 1
    v_perm_b32 v114, v114, v118, s47
    v_subrev_u32 v126, 3, v126
    s_mov_b64 exec, -1

    buffer_store_dwordx2 v[114:115], v126, s[24:27], 0 offen
    v_cmp_ne_u32_sdwa s[70:71], v121, v123 src0_sel:WORD_1 src1_sel:WORD_1
    v_cmp_ne_u32_sdwa vcc, v121, v125 src0_sel:WORD_1 src1_sel:WORD_1
    v_perm_b32 v121, v122, v121, s45
    s_mov_b32 s54, 56320
    v_alignbyte_b32 v124, v125, v124, 2
    s_waitcnt lgkmcnt(0)
    v_add3_u32 v127, v127, v49, s54

    s_and_b64 vcc, vcc, s[70:71]
    s_cbranch_scc1 L_fix_74
L_back_75:
    s_mov_b64 exec, s[70:71]
    v_alignbyte_b32 v121, v121, v120, 1
    v_perm_b32 v120, v120, v124, s47
    v_subrev_u32 v127, 3, v127
    s_mov_b64 exec, -1

    buffer_store_dwordx2 v[120:121], v127, s[24:27], 0 offen
    s_waitcnt vmcnt(15)
    v_mul_hi_u32_u24 v75, s40, v34
    v_mul_hi_u32_u24 v74, s41, v16
    v_mul_hi_u32_u24 v77, s40, v35
    v_mul_hi_u32_u24 v76, s41, v17
    v_mul_hi_u32_u24 v79, s40, v36
    v_mul_hi_u32_u24 v78, s41, v18
    v_mul_hi_u32_u24 v81, s40, v37
    v_mul_hi_u32_u24 v80, s41, v19
    v_mad_i32_i24 v34, v75, s42, v34
    v_lshl_add_u32 v75, v74, 7, v75
    v_mad_i32_i24 v35, v77, s42, v35
    v_lshl_add_u32 v77, v76, 7, v77
    v_mad_i32_i24 v36, v79, s42, v36
    v_lshl_add_u32 v79, v78, 7, v79
    v_mad_i32_i24 v37, v81, s42, v37
    v_lshl_add_u32 v81, v80, 7, v81
    v_mad_i32_i24 v16, v74, s43, v16
    v_lshlrev_b32 v75, 2, v75
    ds_add_rtn_u32 v98, v75, v104
    v_mad_i32_i24 v17, v76, s43, v17
    v_lshlrev_b32 v77, 2, v77
    ds_add_rtn_u32 v99, v77, v104
    v_mad_i32_i24 v18, v78, s43, v18
    v_lshlrev_b32 v79, 2, v79
    ds_add_rtn_u32 v100, v79, v104
    v_mad_i32_i24 v19, v80, s43, v19
    v_lshlrev_b32 v81, 2, v81
    ds_add_rtn_u32 v101, v81, v104
    v_lshlrev_b32 v114, 16, v46
    v_and_b32 v115, 0xffff0000, v46
    v_lshlrev_b32 v116, 16, v47
    v_and_b32 v117, 0xffff0000, v47
    v_mul_f32 v114, s44, v114
    v_mul_f32 v115, s44, v115
    v_mul_f32 v116, s44, v116
    v_mul_f32 v117, s44, v117
    v_fract_f32 v114, v114
    v_fract_f32 v115, v115
    v_fract_f32 v116, v116
    v_fract_f32 v117, v117
    v_cos_f32 v114, v114
    v_cos_f32 v115, v115
    v_cos_f32 v116, v116
    v_cos_f32 v117, v117
    v_lshlrev_b32 v34, 3, v34
    v_lshlrev_b32 v35, 3, v35
    v_lshlrev_b32 v36, 3, v36
    v_lshlrev_b32 v37, 3, v37
    v_lshl_or_b32 v74, v16, 16, v34
    v_lshl_or_b32 v76, v17, 16, v35
    v_lshl_or_b32 v78, v18, 16, v36
    v_lshl_or_b32 v80, v19, 16, v37
    v_fmaak_f32 v114, v114, v105, 0x4b000c00
    v_fmaak_f32 v115, v115, v105, 0x4b000c00
    v_fmaak_f32 v116, v116, v105, 0x4b000c00
    v_fmaak_f32 v117, v117, v105, 0x4b000c00
    v_perm_b32 v75, v75, v114, s46
    v_bfe_u32 v114, v114, 8, 4
    v_perm_b32 v77, v77, v115, s46
    v_bfe_u32 v115, v115, 8, 4
    v_perm_b32 v79, v79, v116, s46
    v_bfe_u32 v116, v116, 8, 4
    v_perm_b32 v81, v81, v117, s46
    v_bfe_u32 v117, v117, 8, 4
    v_add_u32 v74, v74, v114
    v_add_u32 v76, v76, v115
    v_add_u32 v78, v78, v116
    v_add_u32 v80, v80, v117
    ds_read_b64 v[114:115], v112 offset:49168
    ds_read_b64 v[116:117], v112 offset:49176
    ds_read_b64 v[118:119], v112 offset:49160

    ds_read_b64 v[120:121], v112 offset:57360
    ds_read_b64 v[122:123], v112 offset:57368
    ds_read_b64 v[124:125], v112 offset:57352

    s_waitcnt lgkmcnt(3)
    v_lshrrev_b32 v126, 16, v115
    ds_read_b32 v126, v126 offset:8192

    s_waitcnt lgkmcnt(1)
    v_lshrrev_b32 v127, 16, v121
    ds_read_b32 v127, v127 offset:8192

    v_cmp_ne_u32_sdwa s[70:71], v115, v117 src0_sel:WORD_1 src1_sel:WORD_1
    v_cmp_ne_u32_sdwa vcc, v115, v119 src0_sel:WORD_1 src1_sel:WORD_1
    v_perm_b32 v115, v116, v115, s45
    s_mov_b32 s54, 61440
    v_alignbyte_b32 v118, v119, v118, 2
    s_waitcnt lgkmcnt(1)
    v_add3_u32 v126, v126, v49, s54

    s_and_b64 vcc, vcc, s[70:71]
    s_cbranch_scc1 L_fix_76
L_back_77:
    s_mov_b64 exec, s[70:71]
    v_alignbyte_b32 v115, v115, v114, 1
    v_perm_b32 v114, v114, v118, s47
    v_subrev_u32 v126, 3, v126
    s_mov_b64 exec, -1

    buffer_store_dwordx2 v[114:115], v126, s[24:27], 0 offen
    v_cmp_ne_u32_sdwa s[70:71], v121, v123 src0_sel:WORD_1 src1_sel:WORD_1
    v_cmp_ne_u32_sdwa vcc, v121, v125 src0_sel:WORD_1 src1_sel:WORD_1
    v_perm_b32 v121, v122, v121, s45
    s_mov_b32 s54, 66560
    v_alignbyte_b32 v124, v125, v124, 2
    s_waitcnt lgkmcnt(0)
    v_add3_u32 v127, v127, v49, s54

    s_and_b64 vcc, vcc, s[70:71]
    s_cbranch_scc1 L_fix_78
L_back_79:
    s_mov_b64 exec, s[70:71]
    v_alignbyte_b32 v121, v121, v120, 1
    v_perm_b32 v120, v120, v124, s47
    v_subrev_u32 v127, 3, v127
    s_mov_b64 exec, -1

    buffer_store_dwordx2 v[120:121], v127, s[24:27], 0 offen
    v_add_u32 v112, 131072, v2
    ds_read_b64 v[114:115], v112 offset:16
    ds_read_b64 v[116:117], v112 offset:24
    ds_read_b64 v[118:119], v112 offset:8

    ds_read_b64 v[120:121], v112 offset:8208
    ds_read_b64 v[122:123], v112 offset:8216
    ds_read_b64 v[124:125], v112 offset:8200

    s_waitcnt lgkmcnt(3)
    v_lshrrev_b32 v126, 16, v115
    ds_read_b32 v126, v126 offset:8192

    s_waitcnt lgkmcnt(1)
    v_lshrrev_b32 v127, 16, v121
    ds_read_b32 v127, v127 offset:8192

    v_cmp_ne_u32_sdwa s[70:71], v115, v117 src0_sel:WORD_1 src1_sel:WORD_1
    v_cmp_ne_u32_sdwa vcc, v115, v119 src0_sel:WORD_1 src1_sel:WORD_1
    v_perm_b32 v115, v116, v115, s45
    s_mov_b32 s54, 71680
    v_alignbyte_b32 v118, v119, v118, 2
    s_waitcnt lgkmcnt(1)
    v_add3_u32 v126, v126, v49, s54

    s_and_b64 vcc, vcc, s[70:71]
    s_cbranch_scc1 L_fix_80
L_back_81:
    s_mov_b64 exec, s[70:71]
    v_alignbyte_b32 v115, v115, v114, 1
    v_perm_b32 v114, v114, v118, s47
    v_subrev_u32 v126, 3, v126
    s_mov_b64 exec, -1

    buffer_store_dwordx2 v[114:115], v126, s[24:27], 0 offen
    v_cmp_ne_u32_sdwa s[70:71], v121, v123 src0_sel:WORD_1 src1_sel:WORD_1
    v_cmp_ne_u32_sdwa vcc, v121, v125 src0_sel:WORD_1 src1_sel:WORD_1
    v_perm_b32 v121, v122, v121, s45
    s_mov_b32 s54, 76800
    v_alignbyte_b32 v124, v125, v124, 2
    s_waitcnt lgkmcnt(0)
    v_add3_u32 v127, v127, v49, s54

    s_and_b64 vcc, vcc, s[70:71]
    s_cbranch_scc1 L_fix_82
L_back_83:
    s_mov_b64 exec, s[70:71]
    v_alignbyte_b32 v121, v121, v120, 1
    v_perm_b32 v120, v120, v124, s47
    v_subrev_u32 v127, 3, v127
    s_mov_b64 exec, -1

    buffer_store_dwordx2 v[120:121], v127, s[24:27], 0 offen
    s_waitcnt vmcnt(16)
    s_mov_b64 exec, s[66:67]
    v_mul_hi_u32_u24 v83, s40, v38
    v_mul_hi_u32_u24 v82, s41, v20
    v_mul_hi_u32_u24 v85, s40, v39
    v_mul_hi_u32_u24 v84, s41, v21
    v_mad_i32_i24 v38, v83, s42, v38
    v_lshl_add_u32 v83, v82, 7, v83
    v_mad_i32_i24 v39, v85, s42, v39
    v_lshl_add_u32 v85, v84, 7, v85
    v_mad_i32_i24 v20, v82, s43, v20
    v_lshlrev_b32 v83, 2, v83
    ds_add_rtn_u32 v102, v83, v104
    v_mad_i32_i24 v21, v84, s43, v21
    v_lshlrev_b32 v85, 2, v85
    ds_add_rtn_u32 v103, v85, v104
    v_lshlrev_b32 v114, 16, v48
    v_and_b32 v115, 0xffff0000, v48
    v_mul_f32 v114, s44, v114
    v_mul_f32 v115, s44, v115
    v_fract_f32 v114, v114
    v_fract_f32 v115, v115
    v_cos_f32 v114, v114
    v_cos_f32 v115, v115
    v_lshlrev_b32 v38, 3, v38
    v_lshlrev_b32 v39, 3, v39
    v_lshl_or_b32 v82, v20, 16, v38
    v_lshl_or_b32 v84, v21, 16, v39
    s_mov_b64 exec, -1
    v_fmaak_f32 v114, v114, v105, 0x4b000c00
    v_fmaak_f32 v115, v115, v105, 0x4b000c00
    v_perm_b32 v83, v83, v114, s46
    v_bfe_u32 v114, v114, 8, 4
    v_perm_b32 v85, v85, v115, s46
    v_bfe_u32 v115, v115, 8, 4
    v_add_u32 v82, v82, v114
    v_add_u32 v84, v84, v115
    s_waitcnt lgkmcnt(0)
    s_barrier

    ds_read_b64 v[108:109], v2
    s_waitcnt lgkmcnt(0)
    v_and_b32 v108, 0xffff, v108
    v_and_b32 v109, 0xffff, v109
    v_mov_b32 v106, v108
    v_mov_b32 v107, v109
    v_add_u32 v111, v108, v109

    buffer_atomic_add_x2 v[106:107], v2, s[20:23], 0 offen sc0
    s_nop 1
    v_add_u32_dpp v111, v111, v111 row_shr:1 row_mask:0xf bank_mask:0xf
    s_nop 1
    v_add_u32_dpp v111, v111, v111 row_shr:2 row_mask:0xf bank_mask:0xf
    s_nop 1
    v_add_u32_dpp v111, v111, v111 row_shr:4 row_mask:0xf bank_mask:0xf
    s_nop 1
    v_add_u32_dpp v111, v111, v111 row_shr:8 row_mask:0xf bank_mask:0xf
    s_nop 1
    v_add_u32_dpp v111, v111, v111 row_bcast:15 row_mask:0xa bank_mask:0xf
    s_nop 1
    v_add_u32_dpp v111, v111, v111 row_bcast:31 row_mask:0xc bank_mask:0xf
    s_mov_b32 exec_lo, 0
    s_brev_b32 exec_hi, 1
    ds_add_rtn_u32 v110, v113, v111
    s_mov_b64 exec, -1

    ds_read_b64 v[114:115], v112 offset:16400
    ds_read_b64 v[116:117], v112 offset:16408
    ds_read_b64 v[118:119], v112 offset:16392

    ds_read_b64 v[120:121], v112 offset:24592
    ds_read_b64 v[122:123], v112 offset:24600
    ds_read_b64 v[124:125], v112 offset:24584

    s_waitcnt lgkmcnt(3)
    v_lshrrev_b32 v126, 16, v115
    ds_read_b32 v126, v126 offset:8192

    s_waitcnt lgkmcnt(1)
    v_lshrrev_b32 v127, 16, v121
    ds_read_b32 v127, v127 offset:8192

    v_cmp_ne_u32_sdwa s[70:71], v115, v117 src0_sel:WORD_1 src1_sel:WORD_1
    v_cmp_ne_u32_sdwa vcc, v115, v119 src0_sel:WORD_1 src1_sel:WORD_1
    v_perm_b32 v115, v116, v115, s45
    s_mov_b32 s54, 81920
    v_alignbyte_b32 v118, v119, v118, 2
    s_waitcnt lgkmcnt(1)
    v_add3_u32 v126, v126, v49, s54

    s_and_b64 vcc, vcc, s[70:71]
    s_cbranch_scc1 L_fix_84
L_back_85:
    s_mov_b64 exec, s[70:71]
    v_alignbyte_b32 v115, v115, v114, 1
    v_perm_b32 v114, v114, v118, s47
    v_subrev_u32 v126, 3, v126
    s_mov_b64 exec, -1

    buffer_store_dwordx2 v[114:115], v126, s[24:27], 0 offen
    v_cmp_ne_u32_sdwa s[70:71], v121, v123 src0_sel:WORD_1 src1_sel:WORD_1
    v_cmp_ne_u32_sdwa vcc, v121, v125 src0_sel:WORD_1 src1_sel:WORD_1
    v_perm_b32 v121, v122, v121, s45
    s_mov_b32 s54, 87040
    v_alignbyte_b32 v124, v125, v124, 2
    s_waitcnt lgkmcnt(0)
    v_add3_u32 v127, v127, v49, s54

    s_andn2_b64 exec, -1, s[68:69]
    v_bfrev_b32 v127, 1
    s_mov_b64 exec, -1
    s_and_b64 vcc, vcc, s[68:69]

    s_and_b64 vcc, vcc, s[70:71]
    s_cbranch_scc1 L_fix_86
L_back_87:
    s_mov_b64 exec, s[70:71]
    v_alignbyte_b32 v121, v121, v120, 1
    v_perm_b32 v120, v120, v124, s47
    v_subrev_u32 v127, 3, v127
    s_mov_b64 exec, -1

    buffer_store_dwordx2 v[120:121], v127, s[24:27], 0 offen
    s_waitcnt lgkmcnt(0)
    v_readlane_b32 s77, v110, 63
    v_mul_u32_u24 v116, 7936, v0
    v_sub_u32 v111, v111, v109
    s_sub_u32 s77, s77, s50
    v_add_u32 v111, s77, v111
    v_sub_u32 v110, v111, v108
    v_lshlrev_b32 v115, 16, v111
    v_lshlrev_b32 v114, 16, v110
    ds_write_b64 v2, v[114:115]
    v_sub_u32 v110, v116, v110
    v_sub_u32 v111, v116, v111
    v_add_u32 v111, s48, v111
    s_lshl_b32 s74, s51, 3
    v_mov_b32 v126, s74
    v_mov_b32 v127, -1

    s_waitcnt lgkmcnt(0)
    s_barrier

    s_mov_b64 exec, 1
    ds_write_b32 v126, v127 offset:16404
    s_mov_b64 exec, -1

    v_lshrrev_b32 v114, 16, v51
    ds_read_b32 v114, v114
    v_lshrrev_b32 v115, 16, v53
    ds_read_b32 v115, v115
    v_lshrrev_b32 v116, 16, v55
    ds_read_b32 v116, v116
    v_lshrrev_b32 v117, 16, v57
    ds_read_b32 v117, v117
    v_lshrrev_b32 v118, 16, v59
    ds_read_b32 v118, v118
    v_lshrrev_b32 v119, 16, v61
    ds_read_b32 v119, v119
    v_lshrrev_b32 v120, 16, v63
    ds_read_b32 v120, v120
    v_lshrrev_b32 v121, 16, v65
    ds_read_b32 v121, v121
    s_waitcnt lgkmcnt(7)
    v_add_u32_sdwa v114, v114, v86 dst_sel:DWORD dst_unused:UNUSED_PAD src0_sel:WORD_1 src1_sel:WORD_0
    v_lshlrev_b32 v114, 3, v114
    ds_write_b64 v114, v[50:51] offset:16400

    s_waitcnt lgkmcnt(7)
    v_add_u32_sdwa v115, v115, v87 dst_sel:DWORD dst_unused:UNUSED_PAD src0_sel:WORD_1 src1_sel:WORD_0
    v_lshlrev_b32 v115, 3, v115
    ds_write_b64 v115, v[52:53] offset:16400

    s_waitcnt lgkmcnt(7)
    v_add_u32_sdwa v116, v116, v88 dst_sel:DWORD dst_unused:UNUSED_PAD src0_sel:WORD_1 src1_sel:WORD_0
    v_lshlrev_b32 v116, 3, v116
    ds_write_b64 v116, v[54:55] offset:16400

    s_waitcnt lgkmcnt(7)
    v_add_u32_sdwa v117, v117, v89 dst_sel:DWORD dst_unused:UNUSED_PAD src0_sel:WORD_1 src1_sel:WORD_0
    v_lshlrev_b32 v117, 3, v117
    ds_write_b64 v117, v[56:57] offset:16400

    s_waitcnt lgkmcnt(7)
    v_add_u32_sdwa v118, v118, v90 dst_sel:DWORD dst_unused:UNUSED_PAD src0_sel:WORD_1 src1_sel:WORD_0
    v_lshlrev_b32 v118, 3, v118
    ds_write_b64 v118, v[58:59] offset:16400

    s_waitcnt lgkmcnt(7)
    v_add_u32_sdwa v119, v119, v91 dst_sel:DWORD dst_unused:UNUSED_PAD src0_sel:WORD_1 src1_sel:WORD_0
    v_lshlrev_b32 v119, 3, v119
    ds_write_b64 v119, v[60:61] offset:16400

    s_waitcnt lgkmcnt(7)
    v_add_u32_sdwa v120, v120, v92 dst_sel:DWORD dst_unused:UNUSED_PAD src0_sel:WORD_1 src1_sel:WORD_0
    v_lshlrev_b32 v120, 3, v120
    ds_write_b64 v120, v[62:63] offset:16400

    s_waitcnt lgkmcnt(7)
    v_add_u32_sdwa v121, v121, v93 dst_sel:DWORD dst_unused:UNUSED_PAD src0_sel:WORD_1 src1_sel:WORD_0
    v_lshlrev_b32 v121, 3, v121
    ds_write_b64 v121, v[64:65] offset:16400

    v_lshrrev_b32 v114, 16, v67
    ds_read_b32 v114, v114
    v_lshrrev_b32 v115, 16, v69
    ds_read_b32 v115, v115
    v_lshrrev_b32 v116, 16, v71
    ds_read_b32 v116, v116
    v_lshrrev_b32 v117, 16, v73
    ds_read_b32 v117, v117
    v_lshrrev_b32 v118, 16, v75
    ds_read_b32 v118, v118
    v_lshrrev_b32 v119, 16, v77
    ds_read_b32 v119, v119
    v_lshrrev_b32 v120, 16, v79
    ds_read_b32 v120, v120
    v_lshrrev_b32 v121, 16, v81
    ds_read_b32 v121, v121
    s_waitcnt lgkmcnt(7)
    v_add_u32_sdwa v114, v114, v94 dst_sel:DWORD dst_unused:UNUSED_PAD src0_sel:WORD_1 src1_sel:WORD_0
    v_lshlrev_b32 v114, 3, v114
    ds_write_b64 v114, v[66:67] offset:16400

    s_waitcnt lgkmcnt(7)
    v_add_u32_sdwa v115, v115, v95 dst_sel:DWORD dst_unused:UNUSED_PAD src0_sel:WORD_1 src1_sel:WORD_0
    v_lshlrev_b32 v115, 3, v115
    ds_write_b64 v115, v[68:69] offset:16400

    s_waitcnt lgkmcnt(7)
    v_add_u32_sdwa v116, v116, v96 dst_sel:DWORD dst_unused:UNUSED_PAD src0_sel:WORD_1 src1_sel:WORD_0
    v_lshlrev_b32 v116, 3, v116
    ds_write_b64 v116, v[70:71] offset:16400

    s_waitcnt lgkmcnt(7)
    v_add_u32_sdwa v117, v117, v97 dst_sel:DWORD dst_unused:UNUSED_PAD src0_sel:WORD_1 src1_sel:WORD_0
    v_lshlrev_b32 v117, 3, v117
    ds_write_b64 v117, v[72:73] offset:16400

    s_waitcnt lgkmcnt(7)
    v_add_u32_sdwa v118, v118, v98 dst_sel:DWORD dst_unused:UNUSED_PAD src0_sel:WORD_1 src1_sel:WORD_0
    v_lshlrev_b32 v118, 3, v118
    ds_write_b64 v118, v[74:75] offset:16400

    s_waitcnt lgkmcnt(7)
    v_add_u32_sdwa v119, v119, v99 dst_sel:DWORD dst_unused:UNUSED_PAD src0_sel:WORD_1 src1_sel:WORD_0
    v_lshlrev_b32 v119, 3, v119
    ds_write_b64 v119, v[76:77] offset:16400

    s_waitcnt lgkmcnt(7)
    v_add_u32_sdwa v120, v120, v100 dst_sel:DWORD dst_unused:UNUSED_PAD src0_sel:WORD_1 src1_sel:WORD_0
    v_lshlrev_b32 v120, 3, v120
    ds_write_b64 v120, v[78:79] offset:16400

    s_waitcnt lgkmcnt(7)
    v_add_u32_sdwa v121, v121, v101 dst_sel:DWORD dst_unused:UNUSED_PAD src0_sel:WORD_1 src1_sel:WORD_0
    v_lshlrev_b32 v121, 3, v121
    ds_write_b64 v121, v[80:81] offset:16400

    s_mov_b64 exec, s[66:67]
    v_lshrrev_b32 v114, 16, v83
    ds_read_b32 v114, v114
    v_lshrrev_b32 v115, 16, v85
    ds_read_b32 v115, v115
    s_waitcnt lgkmcnt(1)
    v_add_u32_sdwa v114, v114, v102 dst_sel:DWORD dst_unused:UNUSED_PAD src0_sel:WORD_1 src1_sel:WORD_0
    v_lshlrev_b32 v114, 3, v114
    ds_write_b64 v114, v[82:83] offset:16400

    s_waitcnt lgkmcnt(1)
    v_add_u32_sdwa v115, v115, v103 dst_sel:DWORD dst_unused:UNUSED_PAD src0_sel:WORD_1 src1_sel:WORD_0
    v_lshlrev_b32 v115, 3, v115
    ds_write_b64 v115, v[84:85] offset:16400

    s_mov_b64 exec, -1
    s_add_u32 s50, s50, s51
    s_add_u32 s49, s49, 1

    s_mov_b32 s52, s51
    s_waitcnt vmcnt(2)
    v_add_u32 v114, v106, v108
    v_add_u32 v115, v107, v109
    v_max_u32 v114, v114, v115
    v_cmp_lt_u32 vcc, s48, v114
    v_min_u32 v106, s48, v106
    v_min_u32 v107, s48, v107
    v_add_u32 v106, v106, v110
    v_add_u32 v107, v107, v111
    v_lshl_add_u32 v106, v106, 2, v106
    v_lshl_add_u32 v107, v107, 2, v107
    ds_write_b64 v2, v[106:107] offset:8192
    s_cbranch_vccz L_noov_88
    ds_write_b32 v113, v104 offset:4
L_noov_88:
    s_sub_u32 s74, s52, 17408
    s_max_i32 s74, s74, 0
    v_cmp_gt_u32 s[68:69], s74, v0
    s_waitcnt lgkmcnt(0)
    s_barrier
    ds_read_b32 v114, v113 offset:4
    s_waitcnt lgkmcnt(0)
    v_readfirstlane_b32 s53, v114
    s_nop 1
    s_cmp_lg_u32 s53, 0
    s_cbranch_scc1 L_slow_89
L_sback_90:

    ds_read_b64 v[114:115], v2 offset:16400
    ds_read_b64 v[116:117], v2 offset:16408
    ds_read_b64 v[118:119], v2 offset:16392

    ds_read_b64 v[120:121], v2 offset:24592
    ds_read_b64 v[122:123], v2 offset:24600
    ds_read_b64 v[124:125], v2 offset:24584

    s_waitcnt lgkmcnt(3)
    v_lshrrev_b32 v126, 16, v115
    ds_read_b32 v126, v126 offset:8192

    s_waitcnt lgkmcnt(1)
    v_lshrrev_b32 v127, 16, v121
    ds_read_b32 v127, v127 offset:8192

    v_cmp_ne_u32_sdwa s[70:71], v115, v117 src0_sel:WORD_1 src1_sel:WORD_1
    v_cmp_ne_u32_sdwa vcc, v115, v119 src0_sel:WORD_1 src1_sel:WORD_1
    v_perm_b32 v115, v116, v115, s45
    s_mov_b32 s54, 0
    v_alignbyte_b32 v118, v119, v118, 2
    s_waitcnt lgkmcnt(1)
    v_add3_u32 v126, v126, v49, s54

    s_and_b64 vcc, vcc, s[70:71]
    s_cbranch_scc1 L_fix_94
L_back_95:
    s_mov_b64 exec, s[70:71]
    v_alignbyte_b32 v115, v115, v114, 1
    v_perm_b32 v114, v114, v118, s47
    v_subrev_u32 v126, 3, v126
    s_mov_b64 exec, -1

    buffer_store_dwordx2 v[114:115], v126, s[24:27], 0 offen
    v_cmp_ne_u32_sdwa s[70:71], v121, v123 src0_sel:WORD_1 src1_sel:WORD_1
    v_cmp_ne_u32_sdwa vcc, v121, v125 src0_sel:WORD_1 src1_sel:WORD_1
    v_perm_b32 v121, v122, v121, s45
    s_mov_b32 s54, 5120
    v_alignbyte_b32 v124, v125, v124, 2
    s_waitcnt lgkmcnt(0)
    v_add3_u32 v127, v127, v49, s54

    s_and_b64 vcc, vcc, s[70:71]
    s_cbranch_scc1 L_fix_96
L_back_97:
    s_mov_b64 exec, s[70:71]
    v_alignbyte_b32 v121, v121, v120, 1
    v_perm_b32 v120, v120, v124, s47
    v_subrev_u32 v127, 3, v127
    s_mov_b64 exec, -1

    buffer_store_dwordx2 v[120:121], v127, s[24:27], 0 offen
    ds_read_b64 v[114:115], v2 offset:32784
    ds_read_b64 v[116:117], v2 offset:32792
    ds_read_b64 v[118:119], v2 offset:32776

    ds_read_b64 v[120:121], v2 offset:40976
    ds_read_b64 v[122:123], v2 offset:40984
    ds_read_b64 v[124:125], v2 offset:40968

    s_waitcnt lgkmcnt(3)
    v_lshrrev_b32 v126, 16, v115
    ds_read_b32 v126, v126 offset:8192

    s_waitcnt lgkmcnt(1)
    v_lshrrev_b32 v127, 16, v121
    ds_read_b32 v127, v127 offset:8192

    v_cmp_ne_u32_sdwa s[70:71], v115, v117 src0_sel:WORD_1 src1_sel:WORD_1
    v_cmp_ne_u32_sdwa vcc, v115, v119 src0_sel:WORD_1 src1_sel:WORD_1
    v_perm_b32 v115, v116, v115, s45
    s_mov_b32 s54, 10240
    v_alignbyte_b32 v118, v119, v118, 2
    s_waitcnt lgkmcnt(1)
    v_add3_u32 v126, v126, v49, s54

    s_and_b64 vcc, vcc, s[70:71]
    s_cbranch_scc1 L_fix_98
L_back_99:
    s_mov_b64 exec, s[70:71]
    v_alignbyte_b32 v115, v115, v114, 1
    v_perm_b32 v114, v114, v118, s47
    v_subrev_u32 v126, 3, v126
    s_mov_b64 exec, -1

    buffer_store_dwordx2 v[114:115], v126, s[24:27], 0 offen
    v_cmp_ne_u32_sdwa s[70:71], v121, v123 src0_sel:WORD_1 src1_sel:WORD_1
    v_cmp_ne_u32_sdwa vcc, v121, v125 src0_sel:WORD_1 src1_sel:WORD_1
    v_perm_b32 v121, v122, v121, s45
    s_mov_b32 s54, 15360
    v_alignbyte_b32 v124, v125, v124, 2
    s_waitcnt lgkmcnt(0)
    v_add3_u32 v127, v127, v49, s54

    s_and_b64 vcc, vcc, s[70:71]
    s_cbranch_scc1 L_fix_100
L_back_101:
    s_mov_b64 exec, s[70:71]
    v_alignbyte_b32 v121, v121, v120, 1
    v_perm_b32 v120, v120, v124, s47
    v_subrev_u32 v127, 3, v127
    s_mov_b64 exec, -1

    buffer_store_dwordx2 v[120:121], v127, s[24:27], 0 offen
    ds_read_b64 v[114:115], v2 offset:49168
    ds_read_b64 v[116:117], v2 offset:49176
    ds_read_b64 v[118:119], v2 offset:49160

    ds_read_b64 v[120:121], v2 offset:57360
    ds_read_b64 v[122:123], v2 offset:57368
    ds_read_b64 v[124:125], v2 offset:57352

    s_waitcnt lgkmcnt(3)
    v_lshrrev_b32 v126, 16, v115
    ds_read_b32 v126, v126 offset:8192

    s_waitcnt lgkmcnt(1)
    v_lshrrev_b32 v127, 16, v121
    ds_read_b32 v127, v127 offset:8192

    v_cmp_ne_u32_sdwa s[70:71], v115, v117 src0_sel:WORD_1 src1_sel:WORD_1
    v_cmp_ne_u32_sdwa vcc, v115, v119 src0_sel:WORD_1 src1_sel:WORD_1
    v_perm_b32 v115, v116, v115, s45
    s_mov_b32 s54, 20480
    v_alignbyte_b32 v118, v119, v118, 2
    s_waitcnt lgkmcnt(1)
    v_add3_u32 v126, v126, v49, s54

    s_and_b64 vcc, vcc, s[70:71]
    s_cbranch_scc1 L_fix_102
L_back_103:
    s_mov_b64 exec, s[70:71]
    v_alignbyte_b32 v115, v115, v114, 1
    v_perm_b32 v114, v114, v118, s47
    v_subrev_u32 v126, 3, v126
    s_mov_b64 exec, -1

    buffer_store_dwordx2 v[114:115], v126, s[24:27], 0 offen
    v_cmp_ne_u32_sdwa s[70:71], v121, v123 src0_sel:WORD_1 src1_sel:WORD_1
    v_cmp_ne_u32_sdwa vcc, v121, v125 src0_sel:WORD_1 src1_sel:WORD_1
    v_perm_b32 v121, v122, v121, s45
    s_mov_b32 s54, 25600
    v_alignbyte_b32 v124, v125, v124, 2
    s_waitcnt lgkmcnt(0)
    v_add3_u32 v127, v127, v49, s54

    s_and_b64 vcc, vcc, s[70:71]
    s_cbranch_scc1 L_fix_104
L_back_105:
    s_mov_b64 exec, s[70:71]
    v_alignbyte_b32 v121, v121, v120, 1
    v_perm_b32 v120, v120, v124, s47
    v_subrev_u32 v127, 3, v127
    s_mov_b64 exec, -1

    buffer_store_dwordx2 v[120:121], v127, s[24:27], 0 offen
    v_add_u32 v112, 65536, v2
    ds_read_b64 v[114:115], v112 offset:16
    ds_read_b64 v[116:117], v112 offset:24
    ds_read_b64 v[118:119], v112 offset:8

    ds_read_b64 v[120:121], v112 offset:8208
    ds_read_b64 v[122:123], v112 offset:8216
    ds_read_b64 v[124:125], v112 offset:8200

    s_waitcnt lgkmcnt(3)
    v_lshrrev_b32 v126, 16, v115
    ds_read_b32 v126, v126 offset:8192

    s_waitcnt lgkmcnt(1)
    v_lshrrev_b32 v127, 16, v121
    ds_read_b32 v127, v127 offset:8192

    v_cmp_ne_u32_sdwa s[70:71], v115, v117 src0_sel:WORD_1 src1_sel:WORD_1
    v_cmp_ne_u32_sdwa vcc, v115, v119 src0_sel:WORD_1 src1_sel:WORD_1
    v_perm_b32 v115, v116, v115, s45
    s_mov_b32 s54, 30720
    v_alignbyte_b32 v118, v119, v118, 2
    s_waitcnt lgkmcnt(1)
    v_add3_u32 v126, v126, v49, s54

    s_and_b64 vcc, vcc, s[70:71]
    s_cbranch_scc1 L_fix_106
L_back_107:
    s_mov_b64 exec, s[70:71]
    v_alignbyte_b32 v115, v115, v114, 1
    v_perm_b32 v114, v114, v118, s47
    v_subrev_u32 v126, 3, v126
    s_mov_b64 exec, -1

    buffer_store_dwordx2 v[114:115], v126, s[24:27], 0 offen
    v_cmp_ne_u32_sdwa s[70:71], v121, v123 src0_sel:WORD_1 src1_sel:WORD_1
    v_cmp_ne_u32_sdwa vcc, v121, v125 src0_sel:WORD_1 src1_sel:WORD_1
    v_perm_b32 v121, v122, v121, s45
    s_mov_b32 s54, 35840
    v_alignbyte_b32 v124, v125, v124, 2
    s_waitcnt lgkmcnt(0)
    v_add3_u32 v127, v127, v49, s54

    s_and_b64 vcc, vcc, s[70:71]
    s_cbranch_scc1 L_fix_108
L_back_109:
    s_mov_b64 exec, s[70:71]
    v_alignbyte_b32 v121, v121, v120, 1
    v_perm_b32 v120, v120, v124, s47
    v_subrev_u32 v127, 3, v127
    s_mov_b64 exec, -1

    buffer_store_dwordx2 v[120:121], v127, s[24:27], 0 offen
    ds_read_b64 v[114:115], v112 offset:16400
    ds_read_b64 v[116:117], v112 offset:16408
    ds_read_b64 v[118:119], v112 offset:16392

    ds_read_b64 v[120:121], v112 offset:24592
    ds_read_b64 v[122:123], v112 offset:24600
    ds_read_b64 v[124:125], v112 offset:24584

    s_waitcnt lgkmcnt(3)
    v_lshrrev_b32 v126, 16, v115
    ds_read_b32 v126, v126 offset:8192

    s_waitcnt lgkmcnt(1)
    v_lshrrev_b32 v127, 16, v121
    ds_read_b32 v127, v127 offset:8192

    v_cmp_ne_u32_sdwa s[70:71], v115, v117 src0_sel:WORD_1 src1_sel:WORD_1
    v_cmp_ne_u32_sdwa vcc, v115, v119 src0_sel:WORD_1 src1_sel:WORD_1
    v_perm_b32 v115, v116, v115, s45
    s_mov_b32 s54, 40960
    v_alignbyte_b32 v118, v119, v118, 2
    s_waitcnt lgkmcnt(1)
    v_add3_u32 v126, v126, v49, s54

    s_and_b64 vcc, vcc, s[70:71]
    s_cbranch_scc1 L_fix_110
L_back_111:
    s_mov_b64 exec, s[70:71]
    v_alignbyte_b32 v115, v115, v114, 1
    v_perm_b32 v114, v114, v118, s47
    v_subrev_u32 v126, 3, v126
    s_mov_b64 exec, -1

    buffer_store_dwordx2 v[114:115], v126, s[24:27], 0 offen
    v_cmp_ne_u32_sdwa s[70:71], v121, v123 src0_sel:WORD_1 src1_sel:WORD_1
    v_cmp_ne_u32_sdwa vcc, v121, v125 src0_sel:WORD_1 src1_sel:WORD_1
    v_perm_b32 v121, v122, v121, s45
    s_mov_b32 s54, 46080
    v_alignbyte_b32 v124, v125, v124, 2
    s_waitcnt lgkmcnt(0)
    v_add3_u32 v127, v127, v49, s54

    s_and_b64 vcc, vcc, s[70:71]
    s_cbranch_scc1 L_fix_112
L_back_113:
    s_mov_b64 exec, s[70:71]
    v_alignbyte_b32 v121, v121, v120, 1
    v_perm_b32 v120, v120, v124, s47
    v_subrev_u32 v127, 3, v127
    s_mov_b64 exec, -1

    buffer_store_dwordx2 v[120:121], v127, s[24:27], 0 offen
    ds_read_b64 v[114:115], v112 offset:32784
    ds_read_b64 v[116:117], v112 offset:32792
    ds_read_b64 v[118:119], v112 offset:32776

    ds_read_b64 v[120:121], v112 offset:40976
    ds_read_b64 v[122:123], v112 offset:40984
    ds_read_b64 v[124:125], v112 offset:40968

    s_waitcnt lgkmcnt(3)
    v_lshrrev_b32 v126, 16, v115
    ds_read_b32 v126, v126 offset:8192

    s_waitcnt lgkmcnt(1)
    v_lshrrev_b32 v127, 16, v121
    ds_read_b32 v127, v127 offset:8192

    v_cmp_ne_u32_sdwa s[70:71], v115, v117 src0_sel:WORD_1 src1_sel:WORD_1
    v_cmp_ne_u32_sdwa vcc, v115, v119 src0_sel:WORD_1 src1_sel:WORD_1
    v_perm_b32 v115, v116, v115, s45
    s_mov_b32 s54, 51200
    v_alignbyte_b32 v118, v119, v118, 2
    s_waitcnt lgkmcnt(1)
    v_add3_u32 v126, v126, v49, s54

    s_and_b64 vcc, vcc, s[70:71]
    s_cbranch_scc1 L_fix_114
L_back_115:
    s_mov_b64 exec, s[70:71]
    v_alignbyte_b32 v115, v115, v114, 1
    v_perm_b32 v114, v114, v118, s47
    v_subrev_u32 v126, 3, v126
    s_mov_b64 exec, -1

    buffer_store_dwordx2 v[114:115], v126, s[24:27], 0 offen
    v_cmp_ne_u32_sdwa s[70:71], v121, v123 src0_sel:WORD_1 src1_sel:WORD_1
    v_cmp_ne_u32_sdwa vcc, v121, v125 src0_sel:WORD_1 src1_sel:WORD_1
    v_perm_b32 v121, v122, v121, s45
    s_mov_b32 s54, 56320
    v_alignbyte_b32 v124, v125, v124, 2
    s_waitcnt lgkmcnt(0)
    v_add3_u32 v127, v127, v49, s54

    s_and_b64 vcc, vcc, s[70:71]
    s_cbranch_scc1 L_fix_116
L_back_117:
    s_mov_b64 exec, s[70:71]
    v_alignbyte_b32 v121, v121, v120, 1
    v_perm_b32 v120, v120, v124, s47
    v_subrev_u32 v127, 3, v127
    s_mov_b64 exec, -1

    buffer_store_dwordx2 v[120:121], v127, s[24:27], 0 offen
    ds_read_b64 v[114:115], v112 offset:49168
    ds_read_b64 v[116:117], v112 offset:49176
    ds_read_b64 v[118:119], v112 offset:49160

    ds_read_b64 v[120:121], v112 offset:57360
    ds_read_b64 v[122:123], v112 offset:57368
    ds_read_b64 v[124:125], v112 offset:57352

    s_waitcnt lgkmcnt(3)
    v_lshrrev_b32 v126, 16, v115
    ds_read_b32 v126, v126 offset:8192

    s_waitcnt lgkmcnt(1)
    v_lshrrev_b32 v127, 16, v121
    ds_read_b32 v127, v127 offset:8192

    v_cmp_ne_u32_sdwa s[70:71], v115, v117 src0_sel:WORD_1 src1_sel:WORD_1
    v_cmp_ne_u32_sdwa vcc, v115, v119 src0_sel:WORD_1 src1_sel:WORD_1
    v_perm_b32 v115, v116, v115, s45
    s_mov_b32 s54, 61440
    v_alignbyte_b32 v118, v119, v118, 2
    s_waitcnt lgkmcnt(1)
    v_add3_u32 v126, v126, v49, s54

    s_and_b64 vcc, vcc, s[70:71]
    s_cbranch_scc1 L_fix_118
L_back_119:
    s_mov_b64 exec, s[70:71]
    v_alignbyte_b32 v115, v115, v114, 1
    v_perm_b32 v114, v114, v118, s47
    v_subrev_u32 v126, 3, v126
    s_mov_b64 exec, -1

    buffer_store_dwordx2 v[114:115], v126, s[24:27], 0 offen
    v_cmp_ne_u32_sdwa s[70:71], v121, v123 src0_sel:WORD_1 src1_sel:WORD_1
    v_cmp_ne_u32_sdwa vcc, v121, v125 src0_sel:WORD_1 src1_sel:WORD_1
    v_perm_b32 v121, v122, v121, s45
    s_mov_b32 s54, 66560
    v_alignbyte_b32 v124, v125, v124, 2
    s_waitcnt lgkmcnt(0)
    v_add3_u32 v127, v127, v49, s54

    s_and_b64 vcc, vcc, s[70:71]
    s_cbranch_scc1 L_fix_120
L_back_121:
    s_mov_b64 exec, s[70:71]
    v_alignbyte_b32 v121, v121, v120, 1
    v_perm_b32 v120, v120, v124, s47
    v_subrev_u32 v127, 3, v127
    s_mov_b64 exec, -1

    buffer_store_dwordx2 v[120:121], v127, s[24:27], 0 offen
    v_add_u32 v112, 131072, v2
    ds_read_b64 v[114:115], v112 offset:16
    ds_read_b64 v[116:117], v112 offset:24
    ds_read_b64 v[118:119], v112 offset:8

    ds_read_b64 v[120:121], v112 offset:8208
    ds_read_b64 v[122:123], v112 offset:8216
    ds_read_b64 v[124:125], v112 offset:8200

    s_waitcnt lgkmcnt(3)
    v_lshrrev_b32 v126, 16, v115
    ds_read_b32 v126, v126 offset:8192

    s_waitcnt lgkmcnt(1)
    v_lshrrev_b32 v127, 16, v121
    ds_read_b32 v127, v127 offset:8192

    v_cmp_ne_u32_sdwa s[70:71], v115, v117 src0_sel:WORD_1 src1_sel:WORD_1
    v_cmp_ne_u32_sdwa vcc, v115, v119 src0_sel:WORD_1 src1_sel:WORD_1
    v_perm_b32 v115, v116, v115, s45
    s_mov_b32 s54, 71680
    v_alignbyte_b32 v118, v119, v118, 2
    s_waitcnt lgkmcnt(1)
    v_add3_u32 v126, v126, v49, s54

    s_and_b64 vcc, vcc, s[70:71]
    s_cbranch_scc1 L_fix_122
L_back_123:
    s_mov_b64 exec, s[70:71]
    v_alignbyte_b32 v115, v115, v114, 1
    v_perm_b32 v114, v114, v118, s47
    v_subrev_u32 v126, 3, v126
    s_mov_b64 exec, -1

    buffer_store_dwordx2 v[114:115], v126, s[24:27], 0 offen
    v_cmp_ne_u32_sdwa s[70:71], v121, v123 src0_sel:WORD_1 src1_sel:WORD_1
    v_cmp_ne_u32_sdwa vcc, v121, v125 src0_sel:WORD_1 src1_sel:WORD_1
    v_perm_b32 v121, v122, v121, s45
    s_mov_b32 s54, 76800
    v_alignbyte_b32 v124, v125, v124, 2
    s_waitcnt lgkmcnt(0)
    v_add3_u32 v127, v127, v49, s54

    s_and_b64 vcc, vcc, s[70:71]
    s_cbranch_scc1 L_fix_124
L_back_125:
    s_mov_b64 exec, s[70:71]
    v_alignbyte_b32 v121, v121, v120, 1
    v_perm_b32 v120, v120, v124, s47
    v_subrev_u32 v127, 3, v127
    s_mov_b64 exec, -1

    buffer_store_dwordx2 v[120:121], v127, s[24:27], 0 offen
    ds_read_b64 v[114:115], v112 offset:16400
    ds_read_b64 v[116:117], v112 offset:16408
    ds_read_b64 v[118:119], v112 offset:16392

    ds_read_b64 v[120:121], v112 offset:24592
    ds_read_b64 v[122:123], v112 offset:24600
    ds_read_b64 v[124:125], v112 offset:24584

    s_waitcnt lgkmcnt(3)
    v_lshrrev_b32 v126, 16, v115
    ds_read_b32 v126, v126 offset:8192

    s_waitcnt lgkmcnt(1)
    v_lshrrev_b32 v127, 16, v121
    ds_read_b32 v127, v127 offset:8192

    v_cmp_ne_u32_sdwa s[70:71], v115, v117 src0_sel:WORD_1 src1_sel:WORD_1
    v_cmp_ne_u32_sdwa vcc, v115, v119 src0_sel:WORD_1 src1_sel:WORD_1
    v_perm_b32 v115, v116, v115, s45
    s_mov_b32 s54, 81920
    v_alignbyte_b32 v118, v119, v118, 2
    s_waitcnt lgkmcnt(1)
    v_add3_u32 v126, v126, v49, s54

    s_and_b64 vcc, vcc, s[70:71]
    s_cbranch_scc1 L_fix_126
L_back_127:
    s_mov_b64 exec, s[70:71]
    v_alignbyte_b32 v115, v115, v114, 1
    v_perm_b32 v114, v114, v118, s47
    v_subrev_u32 v126, 3, v126
    s_mov_b64 exec, -1

    buffer_store_dwordx2 v[114:115], v126, s[24:27], 0 offen
    v_cmp_ne_u32_sdwa s[70:71], v121, v123 src0_sel:WORD_1 src1_sel:WORD_1
    v_cmp_ne_u32_sdwa vcc, v121, v125 src0_sel:WORD_1 src1_sel:WORD_1
    v_perm_b32 v121, v122, v121, s45
    s_mov_b32 s54, 87040
    v_alignbyte_b32 v124, v125, v124, 2
    s_waitcnt lgkmcnt(0)
    v_add3_u32 v127, v127, v49, s54

    s_andn2_b64 exec, -1, s[68:69]
    v_bfrev_b32 v127, 1
    s_mov_b64 exec, -1
    s_and_b64 vcc, vcc, s[68:69]

    s_and_b64 vcc, vcc, s[70:71]
    s_cbranch_scc1 L_fix_128
L_back_129:
    s_mov_b64 exec, s[70:71]
    v_alignbyte_b32 v121, v121, v120, 1
    v_perm_b32 v120, v120, v124, s47
    v_subrev_u32 v127, 3, v127
    s_mov_b64 exec, -1

    buffer_store_dwordx2 v[120:121], v127, s[24:27], 0 offen
L_p1done_2:
    s_endpgm

L_slow_5:
    s_mov_b32 s26, 0
    v_mov_b32 v116, v0
    v_mov_b32 v122, 0
    s_mov_b32 s75, 4960
L_sl_7:
    v_lshlrev_b32 v117, 3, v116
    ds_read_b64 v[114:115], v117 offset:16400
    s_waitcnt lgkmcnt(0)
    v_lshrrev_b32 v118, 16, v115
    ds_read_b32 v119, v118 offset:8192
    v_add_u32 v118, 4, v118
    v_mul_u32_u24 v118, s75, v118
    s_waitcnt lgkmcnt(0)
    v_mad_u32_u24 v119, v116, 5, v119
    v_mov_b32 v120, 1
    v_cmp_gt_u32 s[72:73], s52, v116
    v_cmp_ge_u32 vcc, v119, v118
    s_and_b64 exec, vcc, s[72:73]
    s_cbranch_execz L_s1_8
    buffer_atomic_add v120, v122, s[36:39], 0 offen sc0
    s_waitcnt vmcnt(0)
    v_lshlrev_b32 v120, 3, v120
    buffer_store_dwordx2 v[114:115], v120, s[32:35], 0 offen
L_s1_8:
    s_andn2_b64 exec, s[72:73], vcc
    s_cbranch_execz L_s2_9
    buffer_store_dword v114, v119, s[28:31], 0 offen
    buffer_store_byte v115, v119, s[28:31], 0 offen offset:4
L_s2_9:
    s_mov_b64 exec, -1
    s_waitcnt vmcnt(0)
    v_add_u32 v116, 1024, v116
    s_nop 0
    v_readfirstlane_b32 s76, v116
    s_nop 1
    s_cmp_lt_u32 s76, s52
    s_cbranch_scc1 L_sl_7
    s_branch L_sback_6

L_fix_10:
    s_mov_b64 exec, vcc
    buffer_store_dword v114, v126, s[24:27], 0 offen
    buffer_store_byte v115, v126, s[24:27], 0 offen offset:4
    v_bfrev_b32 v126, 1
    s_branch L_back_11

L_fix_12:
    s_mov_b64 exec, vcc
    buffer_store_dword v120, v127, s[24:27], 0 offen
    buffer_store_byte v121, v127, s[24:27], 0 offen offset:4
    v_bfrev_b32 v127, 1
    s_branch L_back_13

L_fix_14:
    s_mov_b64 exec, vcc
    buffer_store_dword v114, v126, s[24:27], 0 offen
    buffer_store_byte v115, v126, s[24:27], 0 offen offset:4
    v_bfrev_b32 v126, 1
    s_branch L_back_15

L_fix_16:
    s_mov_b64 exec, vcc
    buffer_store_dword v120, v127, s[24:27], 0 offen
    buffer_store_byte v121, v127, s[24:27], 0 offen offset:4
    v_bfrev_b32 v127, 1
    s_branch L_back_17

L_fix_18:
    s_mov_b64 exec, vcc
    buffer_store_dword v114, v126, s[24:27], 0 offen
    buffer_store_byte v115, v126, s[24:27], 0 offen offset:4
    v_bfrev_b32 v126, 1
    s_branch L_back_19

L_fix_20:
    s_mov_b64 exec, vcc
    buffer_store_dword v120, v127, s[24:27], 0 offen
    buffer_store_byte v121, v127, s[24:27], 0 offen offset:4
    v_bfrev_b32 v127, 1
    s_branch L_back_21

L_fix_22:
    s_mov_b64 exec, vcc
    buffer_store_dword v114, v126, s[24:27], 0 offen
    buffer_store_byte v115, v126, s[24:27], 0 offen offset:4
    v_bfrev_b32 v126, 1
    s_branch L_back_23

L_fix_24:
    s_mov_b64 exec, vcc
    buffer_store_dword v120, v127, s[24:27], 0 offen
    buffer_store_byte v121, v127, s[24:27], 0 offen offset:4
    v_bfrev_b32 v127, 1
    s_branch L_back_25

L_fix_26:
    s_mov_b64 exec, vcc
    buffer_store_dword v114, v126, s[24:27], 0 offen
    buffer_store_byte v115, v126, s[24:27], 0 offen offset:4
    v_bfrev_b32 v126, 1
    s_branch L_back_27

L_fix_28:
    s_mov_b64 exec, vcc
    buffer_store_dword v120, v127, s[24:27], 0 offen
    buffer_store_byte v121, v127, s[24:27], 0 offen offset:4
    v_bfrev_b32 v127, 1
    s_branch L_back_29

L_fix_30:
    s_mov_b64 exec, vcc
    buffer_store_dword v114, v126, s[24:27], 0 offen
    buffer_store_byte v115, v126, s[24:27], 0 offen offset:4
    v_bfrev_b32 v126, 1
    s_branch L_back_31

L_fix_32:
    s_mov_b64 exec, vcc
    buffer_store_dword v120, v127, s[24:27], 0 offen
    buffer_store_byte v121, v127, s[24:27], 0 offen offset:4
    v_bfrev_b32 v127, 1
    s_branch L_back_33

L_fix_34:
    s_mov_b64 exec, vcc
    buffer_store_dword v114, v126, s[24:27], 0 offen
    buffer_store_byte v115, v126, s[24:27], 0 offen offset:4
    v_bfrev_b32 v126, 1
    s_branch L_back_35

L_fix_36:
    s_mov_b64 exec, vcc
    buffer_store_dword v120, v127, s[24:27], 0 offen
    buffer_store_byte v121, v127, s[24:27], 0 offen offset:4
    v_bfrev_b32 v127, 1
    s_branch L_back_37

L_fix_38:
    s_mov_b64 exec, vcc
    buffer_store_dword v114, v126, s[24:27], 0 offen
    buffer_store_byte v115, v126, s[24:27], 0 offen offset:4
    v_bfrev_b32 v126, 1
    s_branch L_back_39

L_fix_40:
    s_mov_b64 exec, vcc
    buffer_store_dword v120, v127, s[24:27], 0 offen
    buffer_store_byte v121, v127, s[24:27], 0 offen offset:4
    v_bfrev_b32 v127, 1
    s_branch L_back_41

L_fix_42:
    s_mov_b64 exec, vcc
    buffer_store_dword v114, v126, s[24:27], 0 offen
    buffer_store_byte v115, v126, s[24:27], 0 offen offset:4
    v_bfrev_b32 v126, 1
    s_branch L_back_43

L_fix_44:
    s_mov_b64 exec, vcc
    buffer_store_dword v120, v127, s[24:27], 0 offen
    buffer_store_byte v121, v127, s[24:27], 0 offen offset:4
    v_bfrev_b32 v127, 1
    s_branch L_back_45

L_slow_47:
    s_mov_b32 s26, 0
    v_mov_b32 v116, v0
    v_mov_b32 v122, 0
    s_mov_b32 s75, 4960
L_sl_49:
    v_lshlrev_b32 v117, 3, v116
    ds_read_b64 v[114:115], v117 offset:16400
    s_waitcnt lgkmcnt(0)
    v_lshrrev_b32 v118, 16, v115
    ds_read_b32 v119, v118 offset:8192
    v_add_u32 v118, 4, v118
    v_mul_u32_u24 v118, s75, v118
    s_waitcnt lgkmcnt(0)
    v_mad_u32_u24 v119, v116, 5, v119
    v_mov_b32 v120, 1
    v_cmp_gt_u32 s[72:73], s52, v116
    v_cmp_ge_u32 vcc, v119, v118
    s_and_b64 exec, vcc, s[72:73]
    s_cbranch_execz L_s1_50
    buffer_atomic_add v120, v122, s[36:39], 0 offen sc0
    s_waitcnt vmcnt(0)
    v_lshlrev_b32 v120, 3, v120
    buffer_store_dwordx2 v[114:115], v120, s[32:35], 0 offen
L_s1_50:
    s_andn2_b64 exec, s[72:73], vcc
    s_cbranch_execz L_s2_51
    buffer_store_dword v114, v119, s[28:31], 0 offen
    buffer_store_byte v115, v119, s[28:31], 0 offen offset:4
L_s2_51:
    s_mov_b64 exec, -1
    s_waitcnt vmcnt(0)
    v_add_u32 v116, 1024, v116
    s_nop 0
    v_readfirstlane_b32 s76, v116
    s_nop 1
    s_cmp_lt_u32 s76, s52
    s_cbranch_scc1 L_sl_49
    s_branch L_sback_48

L_fix_52:
    s_mov_b64 exec, vcc
    buffer_store_dword v114, v126, s[24:27], 0 offen
    buffer_store_byte v115, v126, s[24:27], 0 offen offset:4
    v_bfrev_b32 v126, 1
    s_branch L_back_53

L_fix_54:
    s_mov_b64 exec, vcc
    buffer_store_dword v120, v127, s[24:27], 0 offen
    buffer_store_byte v121, v127, s[24:27], 0 offen offset:4
    v_bfrev_b32 v127, 1
    s_branch L_back_55

L_fix_56:
    s_mov_b64 exec, vcc
    buffer_store_dword v114, v126, s[24:27], 0 offen
    buffer_store_byte v115, v126, s[24:27], 0 offen offset:4
    v_bfrev_b32 v126, 1
    s_branch L_back_57

L_fix_58:
    s_mov_b64 exec, vcc
    buffer_store_dword v120, v127, s[24:27], 0 offen
    buffer_store_byte v121, v127, s[24:27], 0 offen offset:4
    v_bfrev_b32 v127, 1
    s_branch L_back_59

L_fix_60:
    s_mov_b64 exec, vcc
    buffer_store_dword v114, v126, s[24:27], 0 offen
    buffer_store_byte v115, v126, s[24:27], 0 offen offset:4
    v_bfrev_b32 v126, 1
    s_branch L_back_61

L_fix_62:
    s_mov_b64 exec, vcc
    buffer_store_dword v120, v127, s[24:27], 0 offen
    buffer_store_byte v121, v127, s[24:27], 0 offen offset:4
    v_bfrev_b32 v127, 1
    s_branch L_back_63

L_fix_64:
    s_mov_b64 exec, vcc
    buffer_store_dword v114, v126, s[24:27], 0 offen
    buffer_store_byte v115, v126, s[24:27], 0 offen offset:4
    v_bfrev_b32 v126, 1
    s_branch L_back_65

L_fix_66:
    s_mov_b64 exec, vcc
    buffer_store_dword v120, v127, s[24:27], 0 offen
    buffer_store_byte v121, v127, s[24:27], 0 offen offset:4
    v_bfrev_b32 v127, 1
    s_branch L_back_67

L_fix_68:
    s_mov_b64 exec, vcc
    buffer_store_dword v114, v126, s[24:27], 0 offen
    buffer_store_byte v115, v126, s[24:27], 0 offen offset:4
    v_bfrev_b32 v126, 1
    s_branch L_back_69

L_fix_70:
    s_mov_b64 exec, vcc
    buffer_store_dword v120, v127, s[24:27], 0 offen
    buffer_store_byte v121, v127, s[24:27], 0 offen offset:4
    v_bfrev_b32 v127, 1
    s_branch L_back_71

L_fix_72:
    s_mov_b64 exec, vcc
    buffer_store_dword v114, v126, s[24:27], 0 offen
    buffer_store_byte v115, v126, s[24:27], 0 offen offset:4
    v_bfrev_b32 v126, 1
    s_branch L_back_73

L_fix_74:
    s_mov_b64 exec, vcc
    buffer_store_dword v120, v127, s[24:27], 0 offen
    buffer_store_byte v121, v127, s[24:27], 0 offen offset:4
    v_bfrev_b32 v127, 1
    s_branch L_back_75

L_fix_76:
    s_mov_b64 exec, vcc
    buffer_store_dword v114, v126, s[24:27], 0 offen
    buffer_store_byte v115, v126, s[24:27], 0 offen offset:4
    v_bfrev_b32 v126, 1
    s_branch L_back_77

L_fix_78:
    s_mov_b64 exec, vcc
    buffer_store_dword v120, v127, s[24:27], 0 offen
    buffer_store_byte v121, v127, s[24:27], 0 offen offset:4
    v_bfrev_b32 v127, 1
    s_branch L_back_79

L_fix_80:
    s_mov_b64 exec, vcc
    buffer_store_dword v114, v126, s[24:27], 0 offen
    buffer_store_byte v115, v126, s[24:27], 0 offen offset:4
    v_bfrev_b32 v126, 1
    s_branch L_back_81

L_fix_82:
    s_mov_b64 exec, vcc
    buffer_store_dword v120, v127, s[24:27], 0 offen
    buffer_store_byte v121, v127, s[24:27], 0 offen offset:4
    v_bfrev_b32 v127, 1
    s_branch L_back_83

L_fix_84:
    s_mov_b64 exec, vcc
    buffer_store_dword v114, v126, s[24:27], 0 offen
    buffer_store_byte v115, v126, s[24:27], 0 offen offset:4
    v_bfrev_b32 v126, 1
    s_branch L_back_85

L_fix_86:
    s_mov_b64 exec, vcc
    buffer_store_dword v120, v127, s[24:27], 0 offen
    buffer_store_byte v121, v127, s[24:27], 0 offen offset:4
    v_bfrev_b32 v127, 1
    s_branch L_back_87

L_slow_89:
    s_mov_b32 s26, 0
    v_mov_b32 v116, v0
    v_mov_b32 v122, 0
    s_mov_b32 s75, 4960
L_sl_91:
    v_lshlrev_b32 v117, 3, v116
    ds_read_b64 v[114:115], v117 offset:16400
    s_waitcnt lgkmcnt(0)
    v_lshrrev_b32 v118, 16, v115
    ds_read_b32 v119, v118 offset:8192
    v_add_u32 v118, 4, v118
    v_mul_u32_u24 v118, s75, v118
    s_waitcnt lgkmcnt(0)
    v_mad_u32_u24 v119, v116, 5, v119
    v_mov_b32 v120, 1
    v_cmp_gt_u32 s[72:73], s52, v116
    v_cmp_ge_u32 vcc, v119, v118
    s_and_b64 exec, vcc, s[72:73]
    s_cbranch_execz L_s1_92
    buffer_atomic_add v120, v122, s[36:39], 0 offen sc0
    s_waitcnt vmcnt(0)
    v_lshlrev_b32 v120, 3, v120
    buffer_store_dwordx2 v[114:115], v120, s[32:35], 0 offen
L_s1_92:
    s_andn2_b64 exec, s[72:73], vcc
    s_cbranch_execz L_s2_93
    buffer_store_dword v114, v119, s[28:31], 0 offen
    buffer_store_byte v115, v119, s[28:31], 0 offen offset:4
L_s2_93:
    s_mov_b64 exec, -1
    s_waitcnt vmcnt(0)
    v_add_u32 v116, 1024, v116
    s_nop 0
    v_readfirstlane_b32 s76, v116
    s_nop 1
    s_cmp_lt_u32 s76, s52
    s_cbranch_scc1 L_sl_91
    s_branch L_sback_90

L_fix_94:
    s_mov_b64 exec, vcc
    buffer_store_dword v114, v126, s[24:27], 0 offen
    buffer_store_byte v115, v126, s[24:27], 0 offen offset:4
    v_bfrev_b32 v126, 1
    s_branch L_back_95

L_fix_96:
    s_mov_b64 exec, vcc
    buffer_store_dword v120, v127, s[24:27], 0 offen
    buffer_store_byte v121, v127, s[24:27], 0 offen offset:4
    v_bfrev_b32 v127, 1
    s_branch L_back_97

L_fix_98:
    s_mov_b64 exec, vcc
    buffer_store_dword v114, v126, s[24:27], 0 offen
    buffer_store_byte v115, v126, s[24:27], 0 offen offset:4
    v_bfrev_b32 v126, 1
    s_branch L_back_99

L_fix_100:
    s_mov_b64 exec, vcc
    buffer_store_dword v120, v127, s[24:27], 0 offen
    buffer_store_byte v121, v127, s[24:27], 0 offen offset:4
    v_bfrev_b32 v127, 1
    s_branch L_back_101

L_fix_102:
    s_mov_b64 exec, vcc
    buffer_store_dword v114, v126, s[24:27], 0 offen
    buffer_store_byte v115, v126, s[24:27], 0 offen offset:4
    v_bfrev_b32 v126, 1
    s_branch L_back_103

L_fix_104:
    s_mov_b64 exec, vcc
    buffer_store_dword v120, v127, s[24:27], 0 offen
    buffer_store_byte v121, v127, s[24:27], 0 offen offset:4
    v_bfrev_b32 v127, 1
    s_branch L_back_105

L_fix_106:
    s_mov_b64 exec, vcc
    buffer_store_dword v114, v126, s[24:27], 0 offen
    buffer_store_byte v115, v126, s[24:27], 0 offen offset:4
    v_bfrev_b32 v126, 1
    s_branch L_back_107

L_fix_108:
    s_mov_b64 exec, vcc
    buffer_store_dword v120, v127, s[24:27], 0 offen
    buffer_store_byte v121, v127, s[24:27], 0 offen offset:4
    v_bfrev_b32 v127, 1
    s_branch L_back_109

L_fix_110:
    s_mov_b64 exec, vcc
    buffer_store_dword v114, v126, s[24:27], 0 offen
    buffer_store_byte v115, v126, s[24:27], 0 offen offset:4
    v_bfrev_b32 v126, 1
    s_branch L_back_111

L_fix_112:
    s_mov_b64 exec, vcc
    buffer_store_dword v120, v127, s[24:27], 0 offen
    buffer_store_byte v121, v127, s[24:27], 0 offen offset:4
    v_bfrev_b32 v127, 1
    s_branch L_back_113

L_fix_114:
    s_mov_b64 exec, vcc
    buffer_store_dword v114, v126, s[24:27], 0 offen
    buffer_store_byte v115, v126, s[24:27], 0 offen offset:4
    v_bfrev_b32 v126, 1
    s_branch L_back_115

L_fix_116:
    s_mov_b64 exec, vcc
    buffer_store_dword v120, v127, s[24:27], 0 offen
    buffer_store_byte v121, v127, s[24:27], 0 offen offset:4
    v_bfrev_b32 v127, 1
    s_branch L_back_117

L_fix_118:
    s_mov_b64 exec, vcc
    buffer_store_dword v114, v126, s[24:27], 0 offen
    buffer_store_byte v115, v126, s[24:27], 0 offen offset:4
    v_bfrev_b32 v126, 1
    s_branch L_back_119

L_fix_120:
    s_mov_b64 exec, vcc
    buffer_store_dword v120, v127, s[24:27], 0 offen
    buffer_store_byte v121, v127, s[24:27], 0 offen offset:4
    v_bfrev_b32 v127, 1
    s_branch L_back_121

L_fix_122:
    s_mov_b64 exec, vcc
    buffer_store_dword v114, v126, s[24:27], 0 offen
    buffer_store_byte v115, v126, s[24:27], 0 offen offset:4
    v_bfrev_b32 v126, 1
    s_branch L_back_123

L_fix_124:
    s_mov_b64 exec, vcc
    buffer_store_dword v120, v127, s[24:27], 0 offen
    buffer_store_byte v121, v127, s[24:27], 0 offen offset:4
    v_bfrev_b32 v127, 1
    s_branch L_back_125

L_fix_126:
    s_mov_b64 exec, vcc
    buffer_store_dword v114, v126, s[24:27], 0 offen
    buffer_store_byte v115, v126, s[24:27], 0 offen offset:4
    v_bfrev_b32 v126, 1
    s_branch L_back_127

L_fix_128:
    s_mov_b64 exec, vcc
    buffer_store_dword v120, v127, s[24:27], 0 offen
    buffer_store_byte v121, v127, s[24:27], 0 offen offset:4
    v_bfrev_b32 v127, 1
    s_branch L_back_129

.globl g2_kernel
.p2align 8
.type g2_kernel,@function
g2_kernel:
    s_cmp_ge_u32 s2, 256
    s_cbranch_scc1 L_p2done_130
    s_load_dwordx2 s[50:51], s[0:1], 0
    s_load_dwordx2 s[6:7], s[0:1], 104
    v_lshrrev_b32 v4, 6, v0
    v_lshlrev_b32 v5, 2, v0
    s_lshr_b32 s41, s2, 2
    s_and_b32 s41, s41, 1
    s_lshr_b32 s40, s2, 3
    s_lshl_b32 s40, s40, 2
    s_and_b32 s3, s2, 3
    s_or_b32 s40, s40, s3
    v_readfirstlane_b32 s4, v4
    v_and_b32 v2, 127, v0
    v_mul_u32_u24 v2, 20, v2
    v_lshlrev_b32 v3, 4, v0
    s_waitcnt lgkmcnt(0)
    s_lshr_b32 s5, s4, 1
    s_and_b32 s43, s4, 1
    s_lshl_b32 s43, s43, 8
    s_mul_i32 s3, s5, 8192
    s_add_u32 s52, s6, s3
    s_addc_u32 s53, s7, 0
    s_mul_i32 s3, s5, 40632320
    s_add_u32 s3, s3, 27262976
    s_add_u32 s48, s6, s3
    s_addc_u32 s49, s7, 0
    s_mul_i32 s42, s41, 8
    s_lshl_b32 s3, s42, 7
    s_add_u32 s3, s3, s40
    s_lshl_b32 s3, s3, 2
    s_load_dword s45, s[52:53], s3

    s_add_u32 s24, s6, 135168
    s_addc_u32 s25, s7, 0
    s_mov_b32 s26, 4096
    s_mov_b32 s27, 0x20000
    buffer_load_dword v114, v5, s[24:27], 0 offen
    s_mov_b32 s12, s50
    s_mov_b32 s13, s51
    s_mov_b32 s14, 0
    s_mov_b32 s15, 0x20000
    s_mul_i32 s54, s42, 400000
    s_add_u32 s14, s54, 61440
    s_min_u32 s14, s14, 6400000
    buffer_load_dwordx4 v[76:79], v3, s[12:15], s54 offen
    s_add_u32 s60, s54, 16384
    buffer_load_dwordx4 v[80:83], v3, s[12:15], s60 offen
    s_add_u32 s60, s54, 32768
    buffer_load_dwordx4 v[84:87], v3, s[12:15], s60 offen
    s_add_u32 s60, s54, 49152
    buffer_load_dwordx4 v[88:91], v3, s[12:15], s60 offen
    s_mov_b32 s96, s50
    s_mov_b32 s97, s51
    s_mov_b32 s98, 6400000
    s_mov_b32 s99, 0x20000
    s_lshr_b32 s3, s2, 3
    s_mul_i32 s3, s3, 98
    v_add_lshl_u32 v113, v0, s3, 7
    v_cmp_gt_u32 vcc, 98, v0
    v_bfrev_b32 v127, 1
    s_add_u32 s62, s54, 122880
    v_cndmask_b32 v113, v127, v113, vcc

    buffer_load_dword v127, v113, s[96:99], s62 offen
    s_mov_b32 s19, 0x20000
    s_mov_b32 s23, 0x20000
    s_mov_b32 s11, 0x20000
    s_mov_b32 s32, 0x4b400000
    s_mov_b32 s33, 0x4b400000
    s_mov_b32 s34, 0xb4c00000
    s_mov_b32 s35, 0xb4bfffff
    s_movk_i32 s36, 0x7ff
    s_mov_b32 s38, 0xffff0000
    s_mov_b32 s46, 0
    s_mov_b32 s47, 66060288
    s_mov_b32 s55, 503316480
    s_mov_b32 s56, 368640
    s_mov_b32 s57, 257163264
    s_mov_b32 s68, 0xff
    s_mov_b32 s69, 0xffff
    s_mov_b32 s70, 0xffffff
    s_mov_b32 s3, 12288
    v_cmp_gt_u32 s[58:59], s3, v3

    s_mov_b32 s28, 0xc0c0400
    s_mov_b32 s29, 0xc0c0401
    s_mov_b32 s30, 0xc0c0402
    s_mov_b32 s31, 0xc0c0403
    s_waitcnt lgkmcnt(0)
    s_min_u32 s45, s45, 3968
    s_lshl_b32 s60, s42, 7
    s_add_u32 s60, s60, s40
    s_mul_i32 s60, s60, 19840
    s_add_u32 s16, s48, s60
    s_addc_u32 s17, s49, 0
    s_mul_i32 s60, s45, 5
    s_add_u32 s60, s60, 3
    s_and_b32 s18, s60, -4

    s_movk_i32 s61, 0
    buffer_load_dwordx4 v[4:7], v2, s[16:19], s61 offen
    buffer_load_dword v104, v2, s[16:19], s61 offen offset:16
    s_movk_i32 s61, 2560
    buffer_load_dwordx4 v[8:11], v2, s[16:19], s61 offen
    buffer_load_dword v105, v2, s[16:19], s61 offen offset:16
    s_movk_i32 s61, 5120
    buffer_load_dwordx4 v[12:15], v2, s[16:19], s61 offen
    buffer_load_dword v106, v2, s[16:19], s61 offen offset:16
    s_movk_i32 s61, 7680
    buffer_load_dwordx4 v[16:19], v2, s[16:19], s61 offen
    buffer_load_dword v107, v2, s[16:19], s61 offen offset:16
    s_movk_i32 s61, 10240
    buffer_load_dwordx4 v[92:95], v2, s[16:19], s61 offen
    buffer_load_dword v110, v2, s[16:19], s61 offen offset:16
    s_movk_i32 s61, 12800
    buffer_load_dwordx4 v[96:99], v2, s[16:19], s61 offen
    buffer_load_dword v111, v2, s[16:19], s61 offen offset:16
    s_movk_i32 s61, 15360
    buffer_load_dwordx4 v[100:103], v2, s[16:19], s61 offen
    buffer_load_dword v112, v2, s[16:19], s61 offen offset:16
    v_mov_b32 v28, 0
    v_mov_b32 v29, 0
    v_mov_b32 v30, 0
    v_mov_b32 v31, 0
    v_add_u32 v32, 61440, v3
    v_add_u32 v33, 65536, v32

    ds_write_b128 v32, v[28:31] offset:0
    ds_write_b128 v32, v[28:31] offset:16384
    ds_write_b128 v32, v[28:31] offset:32768
    ds_write_b128 v32, v[28:31] offset:49152
    ds_write_b128 v33, v[28:31] offset:0
    ds_write_b128 v33, v[28:31] offset:16384
    v_cmp_gt_u32 vcc, 107, v0
    s_mov_b64 exec, vcc
    ds_write_b128 v33, v[28:31] offset:32768
    s_mov_b64 exec, -1
    v_mov_b32 v34, 161456
    ds_write_b64 v34, v[28:29]

    s_waitcnt vmcnt(19)
    s_nop 1
    v_max_u32_dpp v114, v114, v114 row_shr:1 row_mask:0xf bank_mask:0xf
    s_nop 1
    v_max_u32_dpp v114, v114, v114 row_shr:2 row_mask:0xf bank_mask:0xf
    s_nop 1
    v_max_u32_dpp v114, v114, v114 row_shr:4 row_mask:0xf bank_mask:0xf
    s_nop 1
    v_max_u32_dpp v114, v114, v114 row_shr:8 row_mask:0xf bank_mask:0xf
    s_nop 1
    v_max_u32_dpp v114, v114, v114 row_bcast:15 row_mask:0xa bank_mask:0xf
    s_nop 1
    v_max_u32_dpp v114, v114, v114 row_bcast:31 row_mask:0xc bank_mask:0xf
    s_mul_i32 s3, s41, 12800000
    s_mul_i32 s5, s40, 100000
    s_add_u32 s3, s3, s5
    s_add_u32 s3, s3, 1048576

    s_add_u32 s24, s6, s3
    s_addc_u32 s25, s7, 0
    s_mov_b32 s26, 100000
    s_mov_b32 s27, 0x20000
    s_waitcnt lgkmcnt(0)
    s_barrier
    s_mov_b32 exec_lo, 0
    s_brev_b32 exec_hi, 1
    ds_max_u32 v34, v114
    s_mov_b64 exec, -1

    s_waitcnt vmcnt(18)
    ds_write_b128 v3, v[76:79] offset:0
    s_waitcnt vmcnt(17)
    ds_write_b128 v3, v[80:83] offset:16384
    s_waitcnt vmcnt(16)
    ds_write_b128 v3, v[84:87] offset:32768
    s_waitcnt vmcnt(15)
    s_mov_b64 exec, s[58:59]
    ds_write_b128 v3, v[88:91] offset:49152
    s_mov_b64 exec, -1
    s_add_u32 s54, s54, 61440
    s_add_u32 s14, s54, 61440
    s_min_u32 s14, s14, 6400000
    buffer_load_dwordx4 v[76:79], v3, s[12:15], s54 offen
    s_add_u32 s60, s54, 16384
    buffer_load_dwordx4 v[80:83], v3, s[12:15], s60 offen
    s_add_u32 s60, s54, 32768
    buffer_load_dwordx4 v[84:87], v3, s[12:15], s60 offen
    s_add_u32 s60, s54, 49152
    buffer_load_dwordx4 v[88:91], v3, s[12:15], s60 offen
    s_waitcnt lgkmcnt(0)
    s_barrier
    ds_read_b32 v28, v34
    s_waitcnt lgkmcnt(0)
    v_readfirstlane_b32 s3, v28
    s_nop 1
    s_lshr_b32 s3, s3, 7
    s_max_u32 s3, s3, 27
    s_sub_u32 s5, 281, s3
    s_lshl_b32 s5, s5, 23
    v_mov_b32 v1, s5
    s_or_b32 s37, s5, 1024
    s_sub_u32 s3, s3, 4
    s_lshl_b32 s3, s3, 23
    v_mov_b32 v28, 0x3a802008
    v_mul_f32 v28, s3, v28
    s_nop 0
    v_readfirstlane_b32 s39, v28
    s_add_u32 s4, s42, 8

L_batch_131:
    s_mov_b32 s44, s45
    s_sub_u32 s71, s44, s43
    s_mov_b64 s[20:21], s[16:17]
    s_mov_b32 s22, s18
    s_mul_i32 s60, s42, 400000
    s_add_u32 s8, s50, s60
    s_addc_u32 s9, s51, 0
    s_sub_u32 s10, 6400000, s60
    s_add_u32 s5, s42, 1
    s_min_u32 s60, s5, 15
    s_lshl_b32 s60, s60, 7
    s_add_u32 s60, s60, s40
    s_lshl_b32 s60, s60, 2
    s_load_dword s45, s[52:53], s60

    s_waitcnt vmcnt(8)
    v_bfi_b32 v126, s68, v5, v6
    v_alignbyte_b32 v5, v6, v5, 1
    v_bfi_b32 v126, s69, v126, v7
    v_alignbyte_b32 v6, v7, v6, 2
    v_alignbyte_b32 v7, v104, v7, 3
    v_bfi_b32 v104, s70, v126, v104
    s_cmp_lt_i32 s71, 256
    s_cbranch_scc1 L_ufix_133
L_uback_134:

    s_waitcnt vmcnt(6)
    v_bfi_b32 v126, s68, v9, v10
    v_alignbyte_b32 v9, v10, v9, 1
    v_bfi_b32 v126, s69, v126, v11
    v_alignbyte_b32 v10, v11, v10, 2
    v_alignbyte_b32 v11, v105, v11, 3
    v_bfi_b32 v105, s70, v126, v105
    s_cmp_lt_i32 s71, 768
    s_cbranch_scc1 L_ufix_135
L_uback_136:

    s_waitcnt vmcnt(4)
    v_bfi_b32 v126, s68, v13, v14
    v_alignbyte_b32 v13, v14, v13, 1
    v_bfi_b32 v126, s69, v126, v15
    v_alignbyte_b32 v14, v15, v14, 2
    v_alignbyte_b32 v15, v106, v15, 3
    v_bfi_b32 v106, s70, v126, v106
    s_cmp_lt_i32 s71, 1280
    s_cbranch_scc1 L_ufix_137
L_uback_138:

    s_waitcnt vmcnt(2)
    v_bfi_b32 v126, s68, v17, v18
    v_alignbyte_b32 v17, v18, v17, 1
    v_bfi_b32 v126, s69, v126, v19
    v_alignbyte_b32 v18, v19, v18, 2
    v_alignbyte_b32 v19, v107, v19, 3
    v_bfi_b32 v107, s70, v126, v107
    s_cmp_lt_i32 s71, 1792
    s_cbranch_scc1 L_ufix_139
L_uback_140:

    s_waitcnt vmcnt(8)
    v_bfi_b32 v126, s68, v93, v94
    v_mov_b32 v20, v92
    v_alignbyte_b32 v21, v94, v93, 1
    v_bfi_b32 v126, s69, v126, v95
    v_alignbyte_b32 v22, v95, v94, 2
    v_alignbyte_b32 v23, v110, v95, 3
    v_bfi_b32 v108, s70, v126, v110
    s_cmp_lt_i32 s71, 2304
    s_cbranch_scc1 L_ufix_141
L_uback_142:

    s_waitcnt vmcnt(6)
    v_bfi_b32 v126, s68, v97, v98
    v_mov_b32 v24, v96
    v_alignbyte_b32 v25, v98, v97, 1
    v_bfi_b32 v126, s69, v126, v99
    v_alignbyte_b32 v26, v99, v98, 2
    v_alignbyte_b32 v27, v111, v99, 3
    v_bfi_b32 v109, s70, v126, v111
    s_cmp_lt_i32 s71, 2816
    s_cbranch_scc1 L_ufix_143
L_uback_144:

    v_subrev_co_u32 v4, s[72:73], s55, v4
    v_lshlrev_b32_sdwa v114, 3, sext(v4) dst_sel:DWORD dst_unused:UNUSED_PAD src0_sel:DWORD src1_sel:WORD_1

    v_subrev_co_u32 v5, s[74:75], s55, v5
    v_lshlrev_b32_sdwa v115, 3, sext(v5) dst_sel:DWORD dst_unused:UNUSED_PAD src0_sel:DWORD src1_sel:WORD_1

    v_subrev_co_u32 v6, s[76:77], s55, v6
    v_lshlrev_b32_sdwa v116, 3, sext(v6) dst_sel:DWORD dst_unused:UNUSED_PAD src0_sel:DWORD src1_sel:WORD_1

    v_subrev_co_u32 v7, s[78:79], s55, v7
    v_lshlrev_b32_sdwa v117, 3, sext(v7) dst_sel:DWORD dst_unused:UNUSED_PAD src0_sel:DWORD src1_sel:WORD_1

    v_subrev_co_u32 v8, s[80:81], s55, v8
    v_lshlrev_b32_sdwa v118, 3, sext(v8) dst_sel:DWORD dst_unused:UNUSED_PAD src0_sel:DWORD src1_sel:WORD_1

    v_subrev_co_u32 v9, s[82:83], s55, v9
    v_lshlrev_b32_sdwa v119, 3, sext(v9) dst_sel:DWORD dst_unused:UNUSED_PAD src0_sel:DWORD src1_sel:WORD_1

    v_subrev_co_u32 v10, s[84:85], s55, v10
    v_lshlrev_b32_sdwa v120, 3, sext(v10) dst_sel:DWORD dst_unused:UNUSED_PAD src0_sel:DWORD src1_sel:WORD_1

    v_subrev_co_u32 v11, s[86:87], s55, v11
    v_lshlrev_b32_sdwa v121, 3, sext(v11) dst_sel:DWORD dst_unused:UNUSED_PAD src0_sel:DWORD src1_sel:WORD_1

    v_subrev_co_u32 v12, s[88:89], s55, v12
    v_lshlrev_b32_sdwa v122, 3, sext(v12) dst_sel:DWORD dst_unused:UNUSED_PAD src0_sel:DWORD src1_sel:WORD_1

    v_subrev_co_u32 v13, s[90:91], s55, v13
    v_lshlrev_b32_sdwa v123, 3, sext(v13) dst_sel:DWORD dst_unused:UNUSED_PAD src0_sel:DWORD src1_sel:WORD_1

    v_subrev_co_u32 v14, s[92:93], s55, v14
    v_lshlrev_b32_sdwa v124, 3, sext(v14) dst_sel:DWORD dst_unused:UNUSED_PAD src0_sel:DWORD src1_sel:WORD_1

    v_subrev_co_u32 v15, s[94:95], s55, v15
    v_lshlrev_b32_sdwa v125, 3, sext(v15) dst_sel:DWORD dst_unused:UNUSED_PAD src0_sel:DWORD src1_sel:WORD_1

    s_mov_b64 exec, s[72:73]
    ds_read_b64 v[28:29], v114 offset:61440
    s_mov_b64 exec, s[74:75]
    ds_read_b64 v[30:31], v115 offset:61440
    s_mov_b64 exec, s[76:77]
    ds_read_b64 v[32:33], v116 offset:61440
    s_mov_b64 exec, s[78:79]
    ds_read_b64 v[34:35], v117 offset:61440
    s_mov_b64 exec, s[80:81]
    ds_read_b64 v[36:37], v118 offset:61440
    s_mov_b64 exec, s[82:83]
    ds_read_b64 v[38:39], v119 offset:61440
    s_mov_b64 exec, s[84:85]
    ds_read_b64 v[40:41], v120 offset:61440
    s_mov_b64 exec, s[86:87]
    ds_read_b64 v[42:43], v121 offset:61440
    s_mov_b64 exec, s[88:89]
    ds_read_b64 v[44:45], v122 offset:61440
    s_mov_b64 exec, s[90:91]
    ds_read_b64 v[46:47], v123 offset:61440
    s_mov_b64 exec, s[92:93]
    ds_read_b64 v[48:49], v124 offset:61440
    s_mov_b64 exec, s[94:95]
    ds_read_b64 v[50:51], v125 offset:61440
    s_mov_b64 exec, -1
    v_subrev_u32 v114, 0x96000000, v4
    v_cmp_gt_u32 s[72:73], s57, v114
    v_lshlrev_b32_sdwa v114, 3, v114 dst_sel:DWORD dst_unused:UNUSED_PAD src0_sel:DWORD src1_sel:WORD_1

    v_subrev_u32 v115, 0x96000000, v5
    v_cmp_gt_u32 s[74:75], s57, v115
    v_lshlrev_b32_sdwa v115, 3, v115 dst_sel:DWORD dst_unused:UNUSED_PAD src0_sel:DWORD src1_sel:WORD_1

    v_subrev_u32 v116, 0x96000000, v6
    v_cmp_gt_u32 s[76:77], s57, v116
    v_lshlrev_b32_sdwa v116, 3, v116 dst_sel:DWORD dst_unused:UNUSED_PAD src0_sel:DWORD src1_sel:WORD_1

    v_subrev_u32 v117, 0x96000000, v7
    v_cmp_gt_u32 s[78:79], s57, v117
    v_lshlrev_b32_sdwa v117, 3, v117 dst_sel:DWORD dst_unused:UNUSED_PAD src0_sel:DWORD src1_sel:WORD_1

    s_mov_b64 exec, s[72:73]
    buffer_load_dwordx2 v[28:29], v114, s[8:11], s56 offen
    s_mov_b64 exec, s[74:75]
    buffer_load_dwordx2 v[30:31], v115, s[8:11], s56 offen
    s_mov_b64 exec, s[76:77]
    buffer_load_dwordx2 v[32:33], v116, s[8:11], s56 offen
    s_mov_b64 exec, s[78:79]
    buffer_load_dwordx2 v[34:35], v117, s[8:11], s56 offen
    s_mov_b64 exec, -1
    v_subrev_co_u32 v16, s[72:73], s55, v16
    v_lshlrev_b32_sdwa v114, 3, sext(v16) dst_sel:DWORD dst_unused:UNUSED_PAD src0_sel:DWORD src1_sel:WORD_1

    v_subrev_co_u32 v17, s[74:75], s55, v17
    v_lshlrev_b32_sdwa v115, 3, sext(v17) dst_sel:DWORD dst_unused:UNUSED_PAD src0_sel:DWORD src1_sel:WORD_1

    v_subrev_co_u32 v18, s[76:77], s55, v18
    v_lshlrev_b32_sdwa v116, 3, sext(v18) dst_sel:DWORD dst_unused:UNUSED_PAD src0_sel:DWORD src1_sel:WORD_1

    v_subrev_co_u32 v19, s[78:79], s55, v19
    v_lshlrev_b32_sdwa v117, 3, sext(v19) dst_sel:DWORD dst_unused:UNUSED_PAD src0_sel:DWORD src1_sel:WORD_1

    v_subrev_co_u32 v20, s[80:81], s55, v20
    v_lshlrev_b32_sdwa v118, 3, sext(v20) dst_sel:DWORD dst_unused:UNUSED_PAD src0_sel:DWORD src1_sel:WORD_1

    v_subrev_co_u32 v21, s[82:83], s55, v21
    v_lshlrev_b32_sdwa v119, 3, sext(v21) dst_sel:DWORD dst_unused:UNUSED_PAD src0_sel:DWORD src1_sel:WORD_1

    v_subrev_co_u32 v22, s[84:85], s55, v22
    v_lshlrev_b32_sdwa v120, 3, sext(v22) dst_sel:DWORD dst_unused:UNUSED_PAD src0_sel:DWORD src1_sel:WORD_1

    v_subrev_co_u32 v23, s[86:87], s55, v23
    v_lshlrev_b32_sdwa v121, 3, sext(v23) dst_sel:DWORD dst_unused:UNUSED_PAD src0_sel:DWORD src1_sel:WORD_1

    v_subrev_co_u32 v24, s[88:89], s55, v24
    v_lshlrev_b32_sdwa v122, 3, sext(v24) dst_sel:DWORD dst_unused:UNUSED_PAD src0_sel:DWORD src1_sel:WORD_1

    v_subrev_co_u32 v25, s[90:91], s55, v25
    v_lshlrev_b32_sdwa v123, 3, sext(v25) dst_sel:DWORD dst_unused:UNUSED_PAD src0_sel:DWORD src1_sel:WORD_1

    v_subrev_co_u32 v26, s[92:93], s55, v26
    v_lshlrev_b32_sdwa v124, 3, sext(v26) dst_sel:DWORD dst_unused:UNUSED_PAD src0_sel:DWORD src1_sel:WORD_1

    v_subrev_co_u32 v27, s[94:95], s55, v27
    v_lshlrev_b32_sdwa v125, 3, sext(v27) dst_sel:DWORD dst_unused:UNUSED_PAD src0_sel:DWORD src1_sel:WORD_1

    s_mov_b64 exec, s[72:73]
    ds_read_b64 v[52:53], v114 offset:61440
    s_mov_b64 exec, s[74:75]
    ds_read_b64 v[54:55], v115 offset:61440
    s_mov_b64 exec, s[76:77]
    ds_read_b64 v[56:57], v116 offset:61440
    s_mov_b64 exec, s[78:79]
    ds_read_b64 v[58:59], v117 offset:61440
    s_mov_b64 exec, s[80:81]
    ds_read_b64 v[60:61], v118 offset:61440
    s_mov_b64 exec, s[82:83]
    ds_read_b64 v[62:63], v119 offset:61440
    s_mov_b64 exec, s[84:85]
    ds_read_b64 v[64:65], v120 offset:61440
    s_mov_b64 exec, s[86:87]
    ds_read_b64 v[66:67], v121 offset:61440
    s_mov_b64 exec, s[88:89]
    ds_read_b64 v[68:69], v122 offset:61440
    s_mov_b64 exec, s[90:91]
    ds_read_b64 v[70:71], v123 offset:61440
    s_mov_b64 exec, s[92:93]
    ds_read_b64 v[72:73], v124 offset:61440
    s_mov_b64 exec, s[94:95]
    ds_read_b64 v[74:75], v125 offset:61440
    s_mov_b64 exec, -1
    s_waitcnt lgkmcnt(0)
    s_barrier
    s_waitcnt vmcnt(3)
    ds_write_b128 v3, v[76:79] offset:0
    s_waitcnt vmcnt(2)
    ds_write_b128 v3, v[80:83] offset:16384
    s_waitcnt vmcnt(1)
    ds_write_b128 v3, v[84:87] offset:32768
    s_waitcnt vmcnt(0)
    s_mov_b64 exec, s[58:59]
    ds_write_b128 v3, v[88:91] offset:49152
    s_mov_b64 exec, -1
    s_add_u32 s54, s54, 61440
    s_add_u32 s14, s54, 61440
    s_min_u32 s14, s14, 6400000
    buffer_load_dwordx4 v[76:79], v3, s[12:15], s54 offen
    s_add_u32 s60, s54, 16384
    buffer_load_dwordx4 v[80:83], v3, s[12:15], s60 offen
    s_cmp_lt_u32 s5, s4
    s_cselect_b32 s45, s45, 0
    s_min_u32 s63, s5, 15
    s_min_u32 s45, s45, 3968
    s_lshl_b32 s60, s63, 7
    s_add_u32 s60, s60, s40
    s_mul_i32 s60, s60, 19840
    s_add_u32 s16, s48, s60
    s_addc_u32 s17, s49, 0
    s_mul_i32 s60, s45, 5
    s_add_u32 s60, s60, 3
    s_and_b32 s18, s60, -4

    v_subrev_co_u32 v4, s[72:73], s55, v4
    v_lshlrev_b32_sdwa v114, 3, sext(v4) dst_sel:DWORD dst_unused:UNUSED_PAD src0_sel:DWORD src1_sel:WORD_1

    v_subrev_co_u32 v5, s[74:75], s55, v5
    v_lshlrev_b32_sdwa v115, 3, sext(v5) dst_sel:DWORD dst_unused:UNUSED_PAD src0_sel:DWORD src1_sel:WORD_1

    v_subrev_co_u32 v6, s[76:77], s55, v6
    v_lshlrev_b32_sdwa v116, 3, sext(v6) dst_sel:DWORD dst_unused:UNUSED_PAD src0_sel:DWORD src1_sel:WORD_1

    v_subrev_co_u32 v7, s[78:79], s55, v7
    v_lshlrev_b32_sdwa v117, 3, sext(v7) dst_sel:DWORD dst_unused:UNUSED_PAD src0_sel:DWORD src1_sel:WORD_1

    v_subrev_co_u32 v8, s[80:81], s55, v8
    v_lshlrev_b32_sdwa v118, 3, sext(v8) dst_sel:DWORD dst_unused:UNUSED_PAD src0_sel:DWORD src1_sel:WORD_1

    v_subrev_co_u32 v9, s[82:83], s55, v9
    v_lshlrev_b32_sdwa v119, 3, sext(v9) dst_sel:DWORD dst_unused:UNUSED_PAD src0_sel:DWORD src1_sel:WORD_1

    v_subrev_co_u32 v10, s[84:85], s55, v10
    v_lshlrev_b32_sdwa v120, 3, sext(v10) dst_sel:DWORD dst_unused:UNUSED_PAD src0_sel:DWORD src1_sel:WORD_1

    v_subrev_co_u32 v11, s[86:87], s55, v11
    v_lshlrev_b32_sdwa v121, 3, sext(v11) dst_sel:DWORD dst_unused:UNUSED_PAD src0_sel:DWORD src1_sel:WORD_1

    v_subrev_co_u32 v12, s[88:89], s55, v12
    v_lshlrev_b32_sdwa v122, 3, sext(v12) dst_sel:DWORD dst_unused:UNUSED_PAD src0_sel:DWORD src1_sel:WORD_1

    v_subrev_co_u32 v13, s[90:91], s55, v13
    v_lshlrev_b32_sdwa v123, 3, sext(v13) dst_sel:DWORD dst_unused:UNUSED_PAD src0_sel:DWORD src1_sel:WORD_1

    v_subrev_co_u32 v14, s[92:93], s55, v14
    v_lshlrev_b32_sdwa v124, 3, sext(v14) dst_sel:DWORD dst_unused:UNUSED_PAD src0_sel:DWORD src1_sel:WORD_1

    v_subrev_co_u32 v15, s[94:95], s55, v15
    v_lshlrev_b32_sdwa v125, 3, sext(v15) dst_sel:DWORD dst_unused:UNUSED_PAD src0_sel:DWORD src1_sel:WORD_1

    s_waitcnt lgkmcnt(0)
    s_barrier
    s_add_u32 s60, s54, 32768
    buffer_load_dwordx4 v[84:87], v3, s[12:15], s60 offen
    s_add_u32 s60, s54, 49152
    buffer_load_dwordx4 v[88:91], v3, s[12:15], s60 offen
    s_mov_b64 exec, s[72:73]
    ds_read_b64 v[28:29], v114 offset:61440
    s_mov_b64 exec, s[74:75]
    ds_read_b64 v[30:31], v115 offset:61440
    s_mov_b64 exec, s[76:77]
    ds_read_b64 v[32:33], v116 offset:61440
    s_mov_b64 exec, s[78:79]
    ds_read_b64 v[34:35], v117 offset:61440
    s_mov_b64 exec, s[80:81]
    ds_read_b64 v[36:37], v118 offset:61440
    s_mov_b64 exec, s[82:83]
    ds_read_b64 v[38:39], v119 offset:61440
    s_mov_b64 exec, s[84:85]
    ds_read_b64 v[40:41], v120 offset:61440
    s_mov_b64 exec, s[86:87]
    ds_read_b64 v[42:43], v121 offset:61440
    s_mov_b64 exec, s[88:89]
    ds_read_b64 v[44:45], v122 offset:61440
    s_mov_b64 exec, s[90:91]
    ds_read_b64 v[46:47], v123 offset:61440
    s_mov_b64 exec, s[92:93]
    ds_read_b64 v[48:49], v124 offset:61440
    s_mov_b64 exec, s[94:95]
    ds_read_b64 v[50:51], v125 offset:61440
    s_mov_b64 exec, -1
    v_subrev_u32 v114, 0x78000000, v8
    v_cmp_gt_u32 s[72:73], s57, v114
    v_lshlrev_b32_sdwa v114, 3, v114 dst_sel:DWORD dst_unused:UNUSED_PAD src0_sel:DWORD src1_sel:WORD_1

    v_subrev_u32 v115, 0x78000000, v9
    v_cmp_gt_u32 s[74:75], s57, v115
    v_lshlrev_b32_sdwa v115, 3, v115 dst_sel:DWORD dst_unused:UNUSED_PAD src0_sel:DWORD src1_sel:WORD_1

    v_subrev_u32 v116, 0x78000000, v10
    v_cmp_gt_u32 s[76:77], s57, v116
    v_lshlrev_b32_sdwa v116, 3, v116 dst_sel:DWORD dst_unused:UNUSED_PAD src0_sel:DWORD src1_sel:WORD_1

    v_subrev_u32 v117, 0x78000000, v11
    v_cmp_gt_u32 s[78:79], s57, v117
    v_lshlrev_b32_sdwa v117, 3, v117 dst_sel:DWORD dst_unused:UNUSED_PAD src0_sel:DWORD src1_sel:WORD_1

    s_mov_b64 exec, s[72:73]
    buffer_load_dwordx2 v[36:37], v114, s[8:11], s56 offen
    s_mov_b64 exec, s[74:75]
    buffer_load_dwordx2 v[38:39], v115, s[8:11], s56 offen
    s_mov_b64 exec, s[76:77]
    buffer_load_dwordx2 v[40:41], v116, s[8:11], s56 offen
    s_mov_b64 exec, s[78:79]
    buffer_load_dwordx2 v[42:43], v117, s[8:11], s56 offen
    s_mov_b64 exec, -1
    s_movk_i32 s61, 10240
    buffer_load_dwordx4 v[92:95], v2, s[16:19], s61 offen
    buffer_load_dword v110, v2, s[16:19], s61 offen offset:16
    v_subrev_co_u32 v16, s[72:73], s55, v16
    v_lshlrev_b32_sdwa v114, 3, sext(v16) dst_sel:DWORD dst_unused:UNUSED_PAD src0_sel:DWORD src1_sel:WORD_1

    v_subrev_co_u32 v17, s[74:75], s55, v17
    v_lshlrev_b32_sdwa v115, 3, sext(v17) dst_sel:DWORD dst_unused:UNUSED_PAD src0_sel:DWORD src1_sel:WORD_1

    v_subrev_co_u32 v18, s[76:77], s55, v18
    v_lshlrev_b32_sdwa v116, 3, sext(v18) dst_sel:DWORD dst_unused:UNUSED_PAD src0_sel:DWORD src1_sel:WORD_1

    v_subrev_co_u32 v19, s[78:79], s55, v19
    v_lshlrev_b32_sdwa v117, 3, sext(v19) dst_sel:DWORD dst_unused:UNUSED_PAD src0_sel:DWORD src1_sel:WORD_1

    v_subrev_co_u32 v20, s[80:81], s55, v20
    v_lshlrev_b32_sdwa v118, 3, sext(v20) dst_sel:DWORD dst_unused:UNUSED_PAD src0_sel:DWORD src1_sel:WORD_1

    v_subrev_co_u32 v21, s[82:83], s55, v21
    v_lshlrev_b32_sdwa v119, 3, sext(v21) dst_sel:DWORD dst_unused:UNUSED_PAD src0_sel:DWORD src1_sel:WORD_1

    v_subrev_co_u32 v22, s[84:85], s55, v22
    v_lshlrev_b32_sdwa v120, 3, sext(v22) dst_sel:DWORD dst_unused:UNUSED_PAD src0_sel:DWORD src1_sel:WORD_1

    v_subrev_co_u32 v23, s[86:87], s55, v23
    v_lshlrev_b32_sdwa v121, 3, sext(v23) dst_sel:DWORD dst_unused:UNUSED_PAD src0_sel:DWORD src1_sel:WORD_1

    v_subrev_co_u32 v24, s[88:89], s55, v24
    v_lshlrev_b32_sdwa v122, 3, sext(v24) dst_sel:DWORD dst_unused:UNUSED_PAD src0_sel:DWORD src1_sel:WORD_1

    v_subrev_co_u32 v25, s[90:91], s55, v25
    v_lshlrev_b32_sdwa v123, 3, sext(v25) dst_sel:DWORD dst_unused:UNUSED_PAD src0_sel:DWORD src1_sel:WORD_1

    v_subrev_co_u32 v26, s[92:93], s55, v26
    v_lshlrev_b32_sdwa v124, 3, sext(v26) dst_sel:DWORD dst_unused:UNUSED_PAD src0_sel:DWORD src1_sel:WORD_1

    v_subrev_co_u32 v27, s[94:95], s55, v27
    v_lshlrev_b32_sdwa v125, 3, sext(v27) dst_sel:DWORD dst_unused:UNUSED_PAD src0_sel:DWORD src1_sel:WORD_1

    s_mov_b64 exec, s[72:73]
    ds_read_b64 v[52:53], v114 offset:61440
    s_mov_b64 exec, s[74:75]
    ds_read_b64 v[54:55], v115 offset:61440
    s_mov_b64 exec, s[76:77]
    ds_read_b64 v[56:57], v116 offset:61440
    s_mov_b64 exec, s[78:79]
    ds_read_b64 v[58:59], v117 offset:61440
    s_mov_b64 exec, s[80:81]
    ds_read_b64 v[60:61], v118 offset:61440
    s_mov_b64 exec, s[82:83]
    ds_read_b64 v[62:63], v119 offset:61440
    s_mov_b64 exec, s[84:85]
    ds_read_b64 v[64:65], v120 offset:61440
    s_mov_b64 exec, s[86:87]
    ds_read_b64 v[66:67], v121 offset:61440
    s_mov_b64 exec, s[88:89]
    ds_read_b64 v[68:69], v122 offset:61440
    s_mov_b64 exec, s[90:91]
    ds_read_b64 v[70:71], v123 offset:61440
    s_mov_b64 exec, s[92:93]
    ds_read_b64 v[72:73], v124 offset:61440
    s_mov_b64 exec, s[94:95]
    ds_read_b64 v[74:75], v125 offset:61440
    s_mov_b64 exec, -1
    s_waitcnt lgkmcnt(0)
    s_barrier
    s_waitcnt vmcnt(5)
    ds_write_b128 v3, v[76:79] offset:0
    s_waitcnt vmcnt(4)
    ds_write_b128 v3, v[80:83] offset:16384
    s_waitcnt vmcnt(3)
    ds_write_b128 v3, v[84:87] offset:32768
    s_waitcnt vmcnt(2)
    s_mov_b64 exec, s[58:59]
    ds_write_b128 v3, v[88:91] offset:49152
    s_mov_b64 exec, -1
    s_add_u32 s54, s54, 61440
    s_add_u32 s14, s54, 61440
    s_min_u32 s14, s14, 6400000
    buffer_load_dwordx4 v[76:79], v3, s[12:15], s54 offen
    s_add_u32 s60, s54, 16384
    buffer_load_dwordx4 v[80:83], v3, s[12:15], s60 offen
    v_subrev_co_u32 v4, s[72:73], s55, v4
    v_lshlrev_b32_sdwa v114, 3, sext(v4) dst_sel:DWORD dst_unused:UNUSED_PAD src0_sel:DWORD src1_sel:WORD_1

    v_subrev_co_u32 v5, s[74:75], s55, v5
    v_lshlrev_b32_sdwa v115, 3, sext(v5) dst_sel:DWORD dst_unused:UNUSED_PAD src0_sel:DWORD src1_sel:WORD_1

    v_subrev_co_u32 v6, s[76:77], s55, v6
    v_lshlrev_b32_sdwa v116, 3, sext(v6) dst_sel:DWORD dst_unused:UNUSED_PAD src0_sel:DWORD src1_sel:WORD_1

    v_subrev_co_u32 v7, s[78:79], s55, v7
    v_lshlrev_b32_sdwa v117, 3, sext(v7) dst_sel:DWORD dst_unused:UNUSED_PAD src0_sel:DWORD src1_sel:WORD_1

    v_subrev_co_u32 v8, s[80:81], s55, v8
    v_lshlrev_b32_sdwa v118, 3, sext(v8) dst_sel:DWORD dst_unused:UNUSED_PAD src0_sel:DWORD src1_sel:WORD_1

    v_subrev_co_u32 v9, s[82:83], s55, v9
    v_lshlrev_b32_sdwa v119, 3, sext(v9) dst_sel:DWORD dst_unused:UNUSED_PAD src0_sel:DWORD src1_sel:WORD_1

    v_subrev_co_u32 v10, s[84:85], s55, v10
    v_lshlrev_b32_sdwa v120, 3, sext(v10) dst_sel:DWORD dst_unused:UNUSED_PAD src0_sel:DWORD src1_sel:WORD_1

    v_subrev_co_u32 v11, s[86:87], s55, v11
    v_lshlrev_b32_sdwa v121, 3, sext(v11) dst_sel:DWORD dst_unused:UNUSED_PAD src0_sel:DWORD src1_sel:WORD_1

    v_subrev_co_u32 v12, s[88:89], s55, v12
    v_lshlrev_b32_sdwa v122, 3, sext(v12) dst_sel:DWORD dst_unused:UNUSED_PAD src0_sel:DWORD src1_sel:WORD_1

    v_subrev_co_u32 v13, s[90:91], s55, v13
    v_lshlrev_b32_sdwa v123, 3, sext(v13) dst_sel:DWORD dst_unused:UNUSED_PAD src0_sel:DWORD src1_sel:WORD_1

    v_subrev_co_u32 v14, s[92:93], s55, v14
    v_lshlrev_b32_sdwa v124, 3, sext(v14) dst_sel:DWORD dst_unused:UNUSED_PAD src0_sel:DWORD src1_sel:WORD_1

    v_subrev_co_u32 v15, s[94:95], s55, v15
    v_lshlrev_b32_sdwa v125, 3, sext(v15) dst_sel:DWORD dst_unused:UNUSED_PAD src0_sel:DWORD src1_sel:WORD_1

    s_waitcnt lgkmcnt(0)
    s_barrier
    s_add_u32 s60, s54, 32768
    buffer_load_dwordx4 v[84:87], v3, s[12:15], s60 offen
    s_add_u32 s60, s54, 49152
    buffer_load_dwordx4 v[88:91], v3, s[12:15], s60 offen
    s_mov_b64 exec, s[72:73]
    ds_read_b64 v[28:29], v114 offset:61440
    s_mov_b64 exec, s[74:75]
    ds_read_b64 v[30:31], v115 offset:61440
    s_mov_b64 exec, s[76:77]
    ds_read_b64 v[32:33], v116 offset:61440
    s_mov_b64 exec, s[78:79]
    ds_read_b64 v[34:35], v117 offset:61440
    s_mov_b64 exec, s[80:81]
    ds_read_b64 v[36:37], v118 offset:61440
    s_mov_b64 exec, s[82:83]
    ds_read_b64 v[38:39], v119 offset:61440
    s_mov_b64 exec, s[84:85]
    ds_read_b64 v[40:41], v120 offset:61440
    s_mov_b64 exec, s[86:87]
    ds_read_b64 v[42:43], v121 offset:61440
    s_mov_b64 exec, s[88:89]
    ds_read_b64 v[44:45], v122 offset:61440
    s_mov_b64 exec, s[90:91]
    ds_read_b64 v[46:47], v123 offset:61440
    s_mov_b64 exec, s[92:93]
    ds_read_b64 v[48:49], v124 offset:61440
    s_mov_b64 exec, s[94:95]
    ds_read_b64 v[50:51], v125 offset:61440
    s_mov_b64 exec, -1
    v_subrev_u32 v114, 0x5a000000, v12
    v_cmp_gt_u32 s[72:73], s57, v114
    v_lshlrev_b32_sdwa v114, 3, v114 dst_sel:DWORD dst_unused:UNUSED_PAD src0_sel:DWORD src1_sel:WORD_1

    v_subrev_u32 v115, 0x5a000000, v13
    v_cmp_gt_u32 s[74:75], s57, v115
    v_lshlrev_b32_sdwa v115, 3, v115 dst_sel:DWORD dst_unused:UNUSED_PAD src0_sel:DWORD src1_sel:WORD_1

    v_subrev_u32 v116, 0x5a000000, v14
    v_cmp_gt_u32 s[76:77], s57, v116
    v_lshlrev_b32_sdwa v116, 3, v116 dst_sel:DWORD dst_unused:UNUSED_PAD src0_sel:DWORD src1_sel:WORD_1

    v_subrev_u32 v117, 0x5a000000, v15
    v_cmp_gt_u32 s[78:79], s57, v117
    v_lshlrev_b32_sdwa v117, 3, v117 dst_sel:DWORD dst_unused:UNUSED_PAD src0_sel:DWORD src1_sel:WORD_1

    s_mov_b64 exec, s[72:73]
    buffer_load_dwordx2 v[44:45], v114, s[8:11], s56 offen
    s_mov_b64 exec, s[74:75]
    buffer_load_dwordx2 v[46:47], v115, s[8:11], s56 offen
    s_mov_b64 exec, s[76:77]
    buffer_load_dwordx2 v[48:49], v116, s[8:11], s56 offen
    s_mov_b64 exec, s[78:79]
    buffer_load_dwordx2 v[50:51], v117, s[8:11], s56 offen
    s_mov_b64 exec, -1
    v_subrev_co_u32 v16, s[72:73], s55, v16
    v_lshlrev_b32_sdwa v114, 3, sext(v16) dst_sel:DWORD dst_unused:UNUSED_PAD src0_sel:DWORD src1_sel:WORD_1

    v_subrev_co_u32 v17, s[74:75], s55, v17
    v_lshlrev_b32_sdwa v115, 3, sext(v17) dst_sel:DWORD dst_unused:UNUSED_PAD src0_sel:DWORD src1_sel:WORD_1

    v_subrev_co_u32 v18, s[76:77], s55, v18
    v_lshlrev_b32_sdwa v116, 3, sext(v18) dst_sel:DWORD dst_unused:UNUSED_PAD src0_sel:DWORD src1_sel:WORD_1

    v_subrev_co_u32 v19, s[78:79], s55, v19
    v_lshlrev_b32_sdwa v117, 3, sext(v19) dst_sel:DWORD dst_unused:UNUSED_PAD src0_sel:DWORD src1_sel:WORD_1

    v_subrev_co_u32 v20, s[80:81], s55, v20
    v_lshlrev_b32_sdwa v118, 3, sext(v20) dst_sel:DWORD dst_unused:UNUSED_PAD src0_sel:DWORD src1_sel:WORD_1

    v_subrev_co_u32 v21, s[82:83], s55, v21
    v_lshlrev_b32_sdwa v119, 3, sext(v21) dst_sel:DWORD dst_unused:UNUSED_PAD src0_sel:DWORD src1_sel:WORD_1

    v_subrev_co_u32 v22, s[84:85], s55, v22
    v_lshlrev_b32_sdwa v120, 3, sext(v22) dst_sel:DWORD dst_unused:UNUSED_PAD src0_sel:DWORD src1_sel:WORD_1

    v_subrev_co_u32 v23, s[86:87], s55, v23
    v_lshlrev_b32_sdwa v121, 3, sext(v23) dst_sel:DWORD dst_unused:UNUSED_PAD src0_sel:DWORD src1_sel:WORD_1

    v_subrev_co_u32 v24, s[88:89], s55, v24
    v_lshlrev_b32_sdwa v122, 3, sext(v24) dst_sel:DWORD dst_unused:UNUSED_PAD src0_sel:DWORD src1_sel:WORD_1

    v_subrev_co_u32 v25, s[90:91], s55, v25
    v_lshlrev_b32_sdwa v123, 3, sext(v25) dst_sel:DWORD dst_unused:UNUSED_PAD src0_sel:DWORD src1_sel:WORD_1

    v_subrev_co_u32 v26, s[92:93], s55, v26
    v_lshlrev_b32_sdwa v124, 3, sext(v26) dst_sel:DWORD dst_unused:UNUSED_PAD src0_sel:DWORD src1_sel:WORD_1

    v_subrev_co_u32 v27, s[94:95], s55, v27
    v_lshlrev_b32_sdwa v125, 3, sext(v27) dst_sel:DWORD dst_unused:UNUSED_PAD src0_sel:DWORD src1_sel:WORD_1

    s_mov_b64 exec, s[72:73]
    ds_read_b64 v[52:53], v114 offset:61440
    s_mov_b64 exec, s[74:75]
    ds_read_b64 v[54:55], v115 offset:61440
    s_mov_b64 exec, s[76:77]
    ds_read_b64 v[56:57], v116 offset:61440
    s_mov_b64 exec, s[78:79]
    ds_read_b64 v[58:59], v117 offset:61440
    s_mov_b64 exec, s[80:81]
    ds_read_b64 v[60:61], v118 offset:61440
    s_mov_b64 exec, s[82:83]
    ds_read_b64 v[62:63], v119 offset:61440
    s_mov_b64 exec, s[84:85]
    ds_read_b64 v[64:65], v120 offset:61440
    s_mov_b64 exec, s[86:87]
    ds_read_b64 v[66:67], v121 offset:61440
    s_mov_b64 exec, s[88:89]
    ds_read_b64 v[68:69], v122 offset:61440
    s_mov_b64 exec, s[90:91]
    ds_read_b64 v[70:71], v123 offset:61440
    s_mov_b64 exec, s[92:93]
    ds_read_b64 v[72:73], v124 offset:61440
    s_mov_b64 exec, s[94:95]
    ds_read_b64 v[74:75], v125 offset:61440
    s_mov_b64 exec, -1
    s_waitcnt lgkmcnt(0)
    s_barrier
    s_waitcnt vmcnt(3)
    ds_write_b128 v3, v[76:79] offset:0
    s_waitcnt vmcnt(2)
    ds_write_b128 v3, v[80:83] offset:16384
    s_waitcnt vmcnt(1)
    ds_write_b128 v3, v[84:87] offset:32768
    s_waitcnt vmcnt(0)
    s_mov_b64 exec, s[58:59]
    ds_write_b128 v3, v[88:91] offset:49152
    s_mov_b64 exec, -1
    s_add_u32 s54, s54, 61440
    s_add_u32 s14, s54, 61440
    s_min_u32 s14, s14, 6400000
    buffer_load_dwordx4 v[76:79], v3, s[12:15], s54 offen
    s_add_u32 s60, s54, 16384
    buffer_load_dwordx4 v[80:83], v3, s[12:15], s60 offen
    v_subrev_co_u32 v4, s[72:73], s55, v4
    v_lshlrev_b32_sdwa v114, 3, sext(v4) dst_sel:DWORD dst_unused:UNUSED_PAD src0_sel:DWORD src1_sel:WORD_1

    v_subrev_co_u32 v5, s[74:75], s55, v5
    v_lshlrev_b32_sdwa v115, 3, sext(v5) dst_sel:DWORD dst_unused:UNUSED_PAD src0_sel:DWORD src1_sel:WORD_1

    v_subrev_co_u32 v6, s[76:77], s55, v6
    v_lshlrev_b32_sdwa v116, 3, sext(v6) dst_sel:DWORD dst_unused:UNUSED_PAD src0_sel:DWORD src1_sel:WORD_1

    v_subrev_co_u32 v7, s[78:79], s55, v7
    v_lshlrev_b32_sdwa v117, 3, sext(v7) dst_sel:DWORD dst_unused:UNUSED_PAD src0_sel:DWORD src1_sel:WORD_1

    v_subrev_co_u32 v8, s[80:81], s55, v8
    v_lshlrev_b32_sdwa v118, 3, sext(v8) dst_sel:DWORD dst_unused:UNUSED_PAD src0_sel:DWORD src1_sel:WORD_1

    v_subrev_co_u32 v9, s[82:83], s55, v9
    v_lshlrev_b32_sdwa v119, 3, sext(v9) dst_sel:DWORD dst_unused:UNUSED_PAD src0_sel:DWORD src1_sel:WORD_1

    v_subrev_co_u32 v10, s[84:85], s55, v10
    v_lshlrev_b32_sdwa v120, 3, sext(v10) dst_sel:DWORD dst_unused:UNUSED_PAD src0_sel:DWORD src1_sel:WORD_1

    v_subrev_co_u32 v11, s[86:87], s55, v11
    v_lshlrev_b32_sdwa v121, 3, sext(v11) dst_sel:DWORD dst_unused:UNUSED_PAD src0_sel:DWORD src1_sel:WORD_1

    v_subrev_co_u32 v12, s[88:89], s55, v12
    v_lshlrev_b32_sdwa v122, 3, sext(v12) dst_sel:DWORD dst_unused:UNUSED_PAD src0_sel:DWORD src1_sel:WORD_1

    v_subrev_co_u32 v13, s[90:91], s55, v13
    v_lshlrev_b32_sdwa v123, 3, sext(v13) dst_sel:DWORD dst_unused:UNUSED_PAD src0_sel:DWORD src1_sel:WORD_1

    v_subrev_co_u32 v14, s[92:93], s55, v14
    v_lshlrev_b32_sdwa v124, 3, sext(v14) dst_sel:DWORD dst_unused:UNUSED_PAD src0_sel:DWORD src1_sel:WORD_1

    v_subrev_co_u32 v15, s[94:95], s55, v15
    v_lshlrev_b32_sdwa v125, 3, sext(v15) dst_sel:DWORD dst_unused:UNUSED_PAD src0_sel:DWORD src1_sel:WORD_1

    s_waitcnt lgkmcnt(0)
    s_barrier
    s_add_u32 s60, s54, 32768
    buffer_load_dwordx4 v[84:87], v3, s[12:15], s60 offen
    s_add_u32 s60, s54, 49152
    buffer_load_dwordx4 v[88:91], v3, s[12:15], s60 offen
    s_mov_b64 exec, s[72:73]
    ds_read_b64 v[28:29], v114 offset:61440
    s_mov_b64 exec, s[74:75]
    ds_read_b64 v[30:31], v115 offset:61440
    s_mov_b64 exec, s[76:77]
    ds_read_b64 v[32:33], v116 offset:61440
    s_mov_b64 exec, s[78:79]
    ds_read_b64 v[34:35], v117 offset:61440
    s_mov_b64 exec, s[80:81]
    ds_read_b64 v[36:37], v118 offset:61440
    s_mov_b64 exec, s[82:83]
    ds_read_b64 v[38:39], v119 offset:61440
    s_mov_b64 exec, s[84:85]
    ds_read_b64 v[40:41], v120 offset:61440
    s_mov_b64 exec, s[86:87]
    ds_read_b64 v[42:43], v121 offset:61440
    s_mov_b64 exec, s[88:89]
    ds_read_b64 v[44:45], v122 offset:61440
    s_mov_b64 exec, s[90:91]
    ds_read_b64 v[46:47], v123 offset:61440
    s_mov_b64 exec, s[92:93]
    ds_read_b64 v[48:49], v124 offset:61440
    s_mov_b64 exec, s[94:95]
    ds_read_b64 v[50:51], v125 offset:61440
    s_mov_b64 exec, -1
    v_subrev_u32 v114, 0x5a000000, v16
    v_cmp_gt_u32 s[72:73], s57, v114
    v_lshlrev_b32_sdwa v114, 3, v114 dst_sel:DWORD dst_unused:UNUSED_PAD src0_sel:DWORD src1_sel:WORD_1

    v_subrev_u32 v115, 0x5a000000, v17
    v_cmp_gt_u32 s[74:75], s57, v115
    v_lshlrev_b32_sdwa v115, 3, v115 dst_sel:DWORD dst_unused:UNUSED_PAD src0_sel:DWORD src1_sel:WORD_1

    v_subrev_u32 v116, 0x5a000000, v18
    v_cmp_gt_u32 s[76:77], s57, v116
    v_lshlrev_b32_sdwa v116, 3, v116 dst_sel:DWORD dst_unused:UNUSED_PAD src0_sel:DWORD src1_sel:WORD_1

    v_subrev_u32 v117, 0x5a000000, v19
    v_cmp_gt_u32 s[78:79], s57, v117
    v_lshlrev_b32_sdwa v117, 3, v117 dst_sel:DWORD dst_unused:UNUSED_PAD src0_sel:DWORD src1_sel:WORD_1

    s_mov_b64 exec, s[72:73]
    buffer_load_dwordx2 v[52:53], v114, s[8:11], s56 offen
    s_mov_b64 exec, s[74:75]
    buffer_load_dwordx2 v[54:55], v115, s[8:11], s56 offen
    s_mov_b64 exec, s[76:77]
    buffer_load_dwordx2 v[56:57], v116, s[8:11], s56 offen
    s_mov_b64 exec, s[78:79]
    buffer_load_dwordx2 v[58:59], v117, s[8:11], s56 offen
    s_mov_b64 exec, -1
    s_movk_i32 s61, 12800
    buffer_load_dwordx4 v[96:99], v2, s[16:19], s61 offen
    buffer_load_dword v111, v2, s[16:19], s61 offen offset:16
    v_subrev_co_u32 v16, s[72:73], s55, v16
    v_lshlrev_b32_sdwa v114, 3, sext(v16) dst_sel:DWORD dst_unused:UNUSED_PAD src0_sel:DWORD src1_sel:WORD_1

    v_subrev_co_u32 v17, s[74:75], s55, v17
    v_lshlrev_b32_sdwa v115, 3, sext(v17) dst_sel:DWORD dst_unused:UNUSED_PAD src0_sel:DWORD src1_sel:WORD_1

    v_subrev_co_u32 v18, s[76:77], s55, v18
    v_lshlrev_b32_sdwa v116, 3, sext(v18) dst_sel:DWORD dst_unused:UNUSED_PAD src0_sel:DWORD src1_sel:WORD_1

    v_subrev_co_u32 v19, s[78:79], s55, v19
    v_lshlrev_b32_sdwa v117, 3, sext(v19) dst_sel:DWORD dst_unused:UNUSED_PAD src0_sel:DWORD src1_sel:WORD_1

    v_subrev_co_u32 v20, s[80:81], s55, v20
    v_lshlrev_b32_sdwa v118, 3, sext(v20) dst_sel:DWORD dst_unused:UNUSED_PAD src0_sel:DWORD src1_sel:WORD_1

    v_subrev_co_u32 v21, s[82:83], s55, v21
    v_lshlrev_b32_sdwa v119, 3, sext(v21) dst_sel:DWORD dst_unused:UNUSED_PAD src0_sel:DWORD src1_sel:WORD_1

    v_subrev_co_u32 v22, s[84:85], s55, v22
    v_lshlrev_b32_sdwa v120, 3, sext(v22) dst_sel:DWORD dst_unused:UNUSED_PAD src0_sel:DWORD src1_sel:WORD_1

    v_subrev_co_u32 v23, s[86:87], s55, v23
    v_lshlrev_b32_sdwa v121, 3, sext(v23) dst_sel:DWORD dst_unused:UNUSED_PAD src0_sel:DWORD src1_sel:WORD_1

    v_subrev_co_u32 v24, s[88:89], s55, v24
    v_lshlrev_b32_sdwa v122, 3, sext(v24) dst_sel:DWORD dst_unused:UNUSED_PAD src0_sel:DWORD src1_sel:WORD_1

    v_subrev_co_u32 v25, s[90:91], s55, v25
    v_lshlrev_b32_sdwa v123, 3, sext(v25) dst_sel:DWORD dst_unused:UNUSED_PAD src0_sel:DWORD src1_sel:WORD_1

    v_subrev_co_u32 v26, s[92:93], s55, v26
    v_lshlrev_b32_sdwa v124, 3, sext(v26) dst_sel:DWORD dst_unused:UNUSED_PAD src0_sel:DWORD src1_sel:WORD_1

    v_subrev_co_u32 v27, s[94:95], s55, v27
    v_lshlrev_b32_sdwa v125, 3, sext(v27) dst_sel:DWORD dst_unused:UNUSED_PAD src0_sel:DWORD src1_sel:WORD_1

    s_mov_b64 exec, s[72:73]
    ds_read_b64 v[52:53], v114 offset:61440
    s_mov_b64 exec, s[74:75]
    ds_read_b64 v[54:55], v115 offset:61440
    s_mov_b64 exec, s[76:77]
    ds_read_b64 v[56:57], v116 offset:61440
    s_mov_b64 exec, s[78:79]
    ds_read_b64 v[58:59], v117 offset:61440
    s_mov_b64 exec, s[80:81]
    ds_read_b64 v[60:61], v118 offset:61440
    s_mov_b64 exec, s[82:83]
    ds_read_b64 v[62:63], v119 offset:61440
    s_mov_b64 exec, s[84:85]
    ds_read_b64 v[64:65], v120 offset:61440
    s_mov_b64 exec, s[86:87]
    ds_read_b64 v[66:67], v121 offset:61440
    s_mov_b64 exec, s[88:89]
    ds_read_b64 v[68:69], v122 offset:61440
    s_mov_b64 exec, s[90:91]
    ds_read_b64 v[70:71], v123 offset:61440
    s_mov_b64 exec, s[92:93]
    ds_read_b64 v[72:73], v124 offset:61440
    s_mov_b64 exec, s[94:95]
    ds_read_b64 v[74:75], v125 offset:61440
    s_mov_b64 exec, -1
    s_waitcnt lgkmcnt(0)
    s_barrier
    s_waitcnt vmcnt(5)
    ds_write_b128 v3, v[76:79] offset:0
    s_waitcnt vmcnt(4)
    ds_write_b128 v3, v[80:83] offset:16384
    s_waitcnt vmcnt(3)
    ds_write_b128 v3, v[84:87] offset:32768
    s_waitcnt vmcnt(2)
    s_mov_b64 exec, s[58:59]
    ds_write_b128 v3, v[88:91] offset:49152
    s_mov_b64 exec, -1
    s_add_u32 s54, s54, 61440
    s_add_u32 s14, s54, 61440
    s_min_u32 s14, s14, 6400000
    buffer_load_dwordx4 v[76:79], v3, s[12:15], s54 offen
    s_add_u32 s60, s54, 16384
    buffer_load_dwordx4 v[80:83], v3, s[12:15], s60 offen
    v_subrev_co_u32 v4, s[72:73], s55, v4
    v_lshlrev_b32_sdwa v114, 3, sext(v4) dst_sel:DWORD dst_unused:UNUSED_PAD src0_sel:DWORD src1_sel:WORD_1

    v_subrev_co_u32 v5, s[74:75], s55, v5
    v_lshlrev_b32_sdwa v115, 3, sext(v5) dst_sel:DWORD dst_unused:UNUSED_PAD src0_sel:DWORD src1_sel:WORD_1

    v_subrev_co_u32 v6, s[76:77], s55, v6
    v_lshlrev_b32_sdwa v116, 3, sext(v6) dst_sel:DWORD dst_unused:UNUSED_PAD src0_sel:DWORD src1_sel:WORD_1

    v_subrev_co_u32 v7, s[78:79], s55, v7
    v_lshlrev_b32_sdwa v117, 3, sext(v7) dst_sel:DWORD dst_unused:UNUSED_PAD src0_sel:DWORD src1_sel:WORD_1

    v_subrev_co_u32 v8, s[80:81], s55, v8
    v_lshlrev_b32_sdwa v118, 3, sext(v8) dst_sel:DWORD dst_unused:UNUSED_PAD src0_sel:DWORD src1_sel:WORD_1

    v_subrev_co_u32 v9, s[82:83], s55, v9
    v_lshlrev_b32_sdwa v119, 3, sext(v9) dst_sel:DWORD dst_unused:UNUSED_PAD src0_sel:DWORD src1_sel:WORD_1

    v_subrev_co_u32 v10, s[84:85], s55, v10
    v_lshlrev_b32_sdwa v120, 3, sext(v10) dst_sel:DWORD dst_unused:UNUSED_PAD src0_sel:DWORD src1_sel:WORD_1

    v_subrev_co_u32 v11, s[86:87], s55, v11
    v_lshlrev_b32_sdwa v121, 3, sext(v11) dst_sel:DWORD dst_unused:UNUSED_PAD src0_sel:DWORD src1_sel:WORD_1

    v_subrev_co_u32 v12, s[88:89], s55, v12
    v_lshlrev_b32_sdwa v122, 3, sext(v12) dst_sel:DWORD dst_unused:UNUSED_PAD src0_sel:DWORD src1_sel:WORD_1

    v_subrev_co_u32 v13, s[90:91], s55, v13
    v_lshlrev_b32_sdwa v123, 3, sext(v13) dst_sel:DWORD dst_unused:UNUSED_PAD src0_sel:DWORD src1_sel:WORD_1

    v_subrev_co_u32 v14, s[92:93], s55, v14
    v_lshlrev_b32_sdwa v124, 3, sext(v14) dst_sel:DWORD dst_unused:UNUSED_PAD src0_sel:DWORD src1_sel:WORD_1

    v_subrev_co_u32 v15, s[94:95], s55, v15
    v_lshlrev_b32_sdwa v125, 3, sext(v15) dst_sel:DWORD dst_unused:UNUSED_PAD src0_sel:DWORD src1_sel:WORD_1

    s_waitcnt lgkmcnt(0)
    s_barrier
    s_add_u32 s60, s54, 32768
    buffer_load_dwordx4 v[84:87], v3, s[12:15], s60 offen
    s_add_u32 s60, s54, 49152
    buffer_load_dwordx4 v[88:91], v3, s[12:15], s60 offen
    s_mov_b64 exec, s[72:73]
    ds_read_b64 v[28:29], v114 offset:61440
    s_mov_b64 exec, s[74:75]
    ds_read_b64 v[30:31], v115 offset:61440
    s_mov_b64 exec, s[76:77]
    ds_read_b64 v[32:33], v116 offset:61440
    s_mov_b64 exec, s[78:79]
    ds_read_b64 v[34:35], v117 offset:61440
    s_mov_b64 exec, s[80:81]
    ds_read_b64 v[36:37], v118 offset:61440
    s_mov_b64 exec, s[82:83]
    ds_read_b64 v[38:39], v119 offset:61440
    s_mov_b64 exec, s[84:85]
    ds_read_b64 v[40:41], v120 offset:61440
    s_mov_b64 exec, s[86:87]
    ds_read_b64 v[42:43], v121 offset:61440
    s_mov_b64 exec, s[88:89]
    ds_read_b64 v[44:45], v122 offset:61440
    s_mov_b64 exec, s[90:91]
    ds_read_b64 v[46:47], v123 offset:61440
    s_mov_b64 exec, s[92:93]
    ds_read_b64 v[48:49], v124 offset:61440
    s_mov_b64 exec, s[94:95]
    ds_read_b64 v[50:51], v125 offset:61440
    s_mov_b64 exec, -1
    v_subrev_u32 v114, 0x3c000000, v20
    v_cmp_gt_u32 s[72:73], s57, v114
    v_lshlrev_b32_sdwa v114, 3, v114 dst_sel:DWORD dst_unused:UNUSED_PAD src0_sel:DWORD src1_sel:WORD_1

    v_subrev_u32 v115, 0x3c000000, v21
    v_cmp_gt_u32 s[74:75], s57, v115
    v_lshlrev_b32_sdwa v115, 3, v115 dst_sel:DWORD dst_unused:UNUSED_PAD src0_sel:DWORD src1_sel:WORD_1

    v_subrev_u32 v116, 0x3c000000, v22
    v_cmp_gt_u32 s[76:77], s57, v116
    v_lshlrev_b32_sdwa v116, 3, v116 dst_sel:DWORD dst_unused:UNUSED_PAD src0_sel:DWORD src1_sel:WORD_1

    v_subrev_u32 v117, 0x3c000000, v23
    v_cmp_gt_u32 s[78:79], s57, v117
    v_lshlrev_b32_sdwa v117, 3, v117 dst_sel:DWORD dst_unused:UNUSED_PAD src0_sel:DWORD src1_sel:WORD_1

    s_mov_b64 exec, s[72:73]
    buffer_load_dwordx2 v[60:61], v114, s[8:11], s56 offen
    s_mov_b64 exec, s[74:75]
    buffer_load_dwordx2 v[62:63], v115, s[8:11], s56 offen
    s_mov_b64 exec, s[76:77]
    buffer_load_dwordx2 v[64:65], v116, s[8:11], s56 offen
    s_mov_b64 exec, s[78:79]
    buffer_load_dwordx2 v[66:67], v117, s[8:11], s56 offen
    s_mov_b64 exec, -1
    v_subrev_co_u32 v16, s[72:73], s55, v16
    v_lshlrev_b32_sdwa v114, 3, sext(v16) dst_sel:DWORD dst_unused:UNUSED_PAD src0_sel:DWORD src1_sel:WORD_1

    v_subrev_co_u32 v17, s[74:75], s55, v17
    v_lshlrev_b32_sdwa v115, 3, sext(v17) dst_sel:DWORD dst_unused:UNUSED_PAD src0_sel:DWORD src1_sel:WORD_1

    v_subrev_co_u32 v18, s[76:77], s55, v18
    v_lshlrev_b32_sdwa v116, 3, sext(v18) dst_sel:DWORD dst_unused:UNUSED_PAD src0_sel:DWORD src1_sel:WORD_1

    v_subrev_co_u32 v19, s[78:79], s55, v19
    v_lshlrev_b32_sdwa v117, 3, sext(v19) dst_sel:DWORD dst_unused:UNUSED_PAD src0_sel:DWORD src1_sel:WORD_1

    v_subrev_co_u32 v20, s[80:81], s55, v20
    v_lshlrev_b32_sdwa v118, 3, sext(v20) dst_sel:DWORD dst_unused:UNUSED_PAD src0_sel:DWORD src1_sel:WORD_1

    v_subrev_co_u32 v21, s[82:83], s55, v21
    v_lshlrev_b32_sdwa v119, 3, sext(v21) dst_sel:DWORD dst_unused:UNUSED_PAD src0_sel:DWORD src1_sel:WORD_1

    v_subrev_co_u32 v22, s[84:85], s55, v22
    v_lshlrev_b32_sdwa v120, 3, sext(v22) dst_sel:DWORD dst_unused:UNUSED_PAD src0_sel:DWORD src1_sel:WORD_1

    v_subrev_co_u32 v23, s[86:87], s55, v23
    v_lshlrev_b32_sdwa v121, 3, sext(v23) dst_sel:DWORD dst_unused:UNUSED_PAD src0_sel:DWORD src1_sel:WORD_1

    v_subrev_co_u32 v24, s[88:89], s55, v24
    v_lshlrev_b32_sdwa v122, 3, sext(v24) dst_sel:DWORD dst_unused:UNUSED_PAD src0_sel:DWORD src1_sel:WORD_1

    v_subrev_co_u32 v25, s[90:91], s55, v25
    v_lshlrev_b32_sdwa v123, 3, sext(v25) dst_sel:DWORD dst_unused:UNUSED_PAD src0_sel:DWORD src1_sel:WORD_1

    v_subrev_co_u32 v26, s[92:93], s55, v26
    v_lshlrev_b32_sdwa v124, 3, sext(v26) dst_sel:DWORD dst_unused:UNUSED_PAD src0_sel:DWORD src1_sel:WORD_1

    v_subrev_co_u32 v27, s[94:95], s55, v27
    v_lshlrev_b32_sdwa v125, 3, sext(v27) dst_sel:DWORD dst_unused:UNUSED_PAD src0_sel:DWORD src1_sel:WORD_1

    s_mov_b64 exec, s[72:73]
    ds_read_b64 v[52:53], v114 offset:61440
    s_mov_b64 exec, s[74:75]
    ds_read_b64 v[54:55], v115 offset:61440
    s_mov_b64 exec, s[76:77]
    ds_read_b64 v[56:57], v116 offset:61440
    s_mov_b64 exec, s[78:79]
    ds_read_b64 v[58:59], v117 offset:61440
    s_mov_b64 exec, s[80:81]
    ds_read_b64 v[60:61], v118 offset:61440
    s_mov_b64 exec, s[82:83]
    ds_read_b64 v[62:63], v119 offset:61440
    s_mov_b64 exec, s[84:85]
    ds_read_b64 v[64:65], v120 offset:61440
    s_mov_b64 exec, s[86:87]
    ds_read_b64 v[66:67], v121 offset:61440
    s_mov_b64 exec, s[88:89]
    ds_read_b64 v[68:69], v122 offset:61440
    s_mov_b64 exec, s[90:91]
    ds_read_b64 v[70:71], v123 offset:61440
    s_mov_b64 exec, s[92:93]
    ds_read_b64 v[72:73], v124 offset:61440
    s_mov_b64 exec, s[94:95]
    ds_read_b64 v[74:75], v125 offset:61440
    s_mov_b64 exec, -1
    s_waitcnt lgkmcnt(0)
    s_barrier
    s_waitcnt vmcnt(3)
    ds_write_b128 v3, v[76:79] offset:0
    s_waitcnt vmcnt(2)
    ds_write_b128 v3, v[80:83] offset:16384
    s_waitcnt vmcnt(1)
    ds_write_b128 v3, v[84:87] offset:32768
    s_waitcnt vmcnt(0)
    s_mov_b64 exec, s[58:59]
    ds_write_b128 v3, v[88:91] offset:49152
    s_mov_b64 exec, -1
    s_mul_i32 s54, s5, 400000
    s_add_u32 s14, s54, 61440
    s_min_u32 s14, s14, 6400000
    s_cmp_lt_u32 s5, s4
    s_cselect_b32 s14, s14, 0
    buffer_load_dwordx4 v[76:79], v3, s[12:15], s54 offen
    s_add_u32 s60, s54, 16384
    buffer_load_dwordx4 v[80:83], v3, s[12:15], s60 offen
    v_subrev_co_u32 v4, s[72:73], s55, v4
    v_lshlrev_b32_sdwa v114, 3, sext(v4) dst_sel:DWORD dst_unused:UNUSED_PAD src0_sel:DWORD src1_sel:WORD_1

    v_subrev_co_u32 v5, s[74:75], s55, v5
    v_lshlrev_b32_sdwa v115, 3, sext(v5) dst_sel:DWORD dst_unused:UNUSED_PAD src0_sel:DWORD src1_sel:WORD_1

    v_subrev_co_u32 v6, s[76:77], s55, v6
    v_lshlrev_b32_sdwa v116, 3, sext(v6) dst_sel:DWORD dst_unused:UNUSED_PAD src0_sel:DWORD src1_sel:WORD_1

    v_subrev_co_u32 v7, s[78:79], s55, v7
    v_lshlrev_b32_sdwa v117, 3, sext(v7) dst_sel:DWORD dst_unused:UNUSED_PAD src0_sel:DWORD src1_sel:WORD_1

    v_subrev_co_u32 v8, s[80:81], s55, v8
    v_lshlrev_b32_sdwa v118, 3, sext(v8) dst_sel:DWORD dst_unused:UNUSED_PAD src0_sel:DWORD src1_sel:WORD_1

    v_subrev_co_u32 v9, s[82:83], s55, v9
    v_lshlrev_b32_sdwa v119, 3, sext(v9) dst_sel:DWORD dst_unused:UNUSED_PAD src0_sel:DWORD src1_sel:WORD_1

    v_subrev_co_u32 v10, s[84:85], s55, v10
    v_lshlrev_b32_sdwa v120, 3, sext(v10) dst_sel:DWORD dst_unused:UNUSED_PAD src0_sel:DWORD src1_sel:WORD_1

    v_subrev_co_u32 v11, s[86:87], s55, v11
    v_lshlrev_b32_sdwa v121, 3, sext(v11) dst_sel:DWORD dst_unused:UNUSED_PAD src0_sel:DWORD src1_sel:WORD_1

    v_subrev_co_u32 v12, s[88:89], s55, v12
    v_lshlrev_b32_sdwa v122, 3, sext(v12) dst_sel:DWORD dst_unused:UNUSED_PAD src0_sel:DWORD src1_sel:WORD_1

    v_subrev_co_u32 v13, s[90:91], s55, v13
    v_lshlrev_b32_sdwa v123, 3, sext(v13) dst_sel:DWORD dst_unused:UNUSED_PAD src0_sel:DWORD src1_sel:WORD_1

    v_subrev_co_u32 v14, s[92:93], s55, v14
    v_lshlrev_b32_sdwa v124, 3, sext(v14) dst_sel:DWORD dst_unused:UNUSED_PAD src0_sel:DWORD src1_sel:WORD_1

    v_subrev_co_u32 v15, s[94:95], s55, v15
    v_lshlrev_b32_sdwa v125, 3, sext(v15) dst_sel:DWORD dst_unused:UNUSED_PAD src0_sel:DWORD src1_sel:WORD_1

    s_waitcnt lgkmcnt(0)
    s_barrier
    s_add_u32 s60, s54, 32768
    buffer_load_dwordx4 v[84:87], v3, s[12:15], s60 offen
    s_add_u32 s60, s54, 49152
    buffer_load_dwordx4 v[88:91], v3, s[12:15], s60 offen
    s_mov_b64 exec, s[72:73]
    ds_read_b64 v[28:29], v114 offset:61440
    s_mov_b64 exec, s[74:75]
    ds_read_b64 v[30:31], v115 offset:61440
    s_mov_b64 exec, s[76:77]
    ds_read_b64 v[32:33], v116 offset:61440
    s_mov_b64 exec, s[78:79]
    ds_read_b64 v[34:35], v117 offset:61440
    s_mov_b64 exec, s[80:81]
    ds_read_b64 v[36:37], v118 offset:61440
    s_mov_b64 exec, s[82:83]
    ds_read_b64 v[38:39], v119 offset:61440
    s_mov_b64 exec, s[84:85]
    ds_read_b64 v[40:41], v120 offset:61440
    s_mov_b64 exec, s[86:87]
    ds_read_b64 v[42:43], v121 offset:61440
    s_mov_b64 exec, s[88:89]
    ds_read_b64 v[44:45], v122 offset:61440
    s_mov_b64 exec, s[90:91]
    ds_read_b64 v[46:47], v123 offset:61440
    s_mov_b64 exec, s[92:93]
    ds_read_b64 v[48:49], v124 offset:61440
    s_mov_b64 exec, s[94:95]
    ds_read_b64 v[50:51], v125 offset:61440
    s_mov_b64 exec, -1
    v_subrev_u32 v114, 0x1e000000, v24
    v_cmp_gt_u32 s[72:73], s57, v114
    v_lshlrev_b32_sdwa v114, 3, v114 dst_sel:DWORD dst_unused:UNUSED_PAD src0_sel:DWORD src1_sel:WORD_1

    v_subrev_u32 v115, 0x1e000000, v25
    v_cmp_gt_u32 s[74:75], s57, v115
    v_lshlrev_b32_sdwa v115, 3, v115 dst_sel:DWORD dst_unused:UNUSED_PAD src0_sel:DWORD src1_sel:WORD_1

    v_subrev_u32 v116, 0x1e000000, v26
    v_cmp_gt_u32 s[76:77], s57, v116
    v_lshlrev_b32_sdwa v116, 3, v116 dst_sel:DWORD dst_unused:UNUSED_PAD src0_sel:DWORD src1_sel:WORD_1

    v_subrev_u32 v117, 0x1e000000, v27
    v_cmp_gt_u32 s[78:79], s57, v117
    v_lshlrev_b32_sdwa v117, 3, v117 dst_sel:DWORD dst_unused:UNUSED_PAD src0_sel:DWORD src1_sel:WORD_1

    s_mov_b64 exec, s[72:73]
    buffer_load_dwordx2 v[68:69], v114, s[8:11], s56 offen
    s_mov_b64 exec, s[74:75]
    buffer_load_dwordx2 v[70:71], v115, s[8:11], s56 offen
    s_mov_b64 exec, s[76:77]
    buffer_load_dwordx2 v[72:73], v116, s[8:11], s56 offen
    s_mov_b64 exec, s[78:79]
    buffer_load_dwordx2 v[74:75], v117, s[8:11], s56 offen
    s_mov_b64 exec, -1
    v_subrev_co_u32 v16, s[72:73], s55, v16
    v_lshlrev_b32_sdwa v114, 3, sext(v16) dst_sel:DWORD dst_unused:UNUSED_PAD src0_sel:DWORD src1_sel:WORD_1

    v_subrev_co_u32 v17, s[74:75], s55, v17
    v_lshlrev_b32_sdwa v115, 3, sext(v17) dst_sel:DWORD dst_unused:UNUSED_PAD src0_sel:DWORD src1_sel:WORD_1

    v_subrev_co_u32 v18, s[76:77], s55, v18
    v_lshlrev_b32_sdwa v116, 3, sext(v18) dst_sel:DWORD dst_unused:UNUSED_PAD src0_sel:DWORD src1_sel:WORD_1

    v_subrev_co_u32 v19, s[78:79], s55, v19
    v_lshlrev_b32_sdwa v117, 3, sext(v19) dst_sel:DWORD dst_unused:UNUSED_PAD src0_sel:DWORD src1_sel:WORD_1

    v_subrev_co_u32 v20, s[80:81], s55, v20
    v_lshlrev_b32_sdwa v118, 3, sext(v20) dst_sel:DWORD dst_unused:UNUSED_PAD src0_sel:DWORD src1_sel:WORD_1

    v_subrev_co_u32 v21, s[82:83], s55, v21
    v_lshlrev_b32_sdwa v119, 3, sext(v21) dst_sel:DWORD dst_unused:UNUSED_PAD src0_sel:DWORD src1_sel:WORD_1

    v_subrev_co_u32 v22, s[84:85], s55, v22
    v_lshlrev_b32_sdwa v120, 3, sext(v22) dst_sel:DWORD dst_unused:UNUSED_PAD src0_sel:DWORD src1_sel:WORD_1

    v_subrev_co_u32 v23, s[86:87], s55, v23
    v_lshlrev_b32_sdwa v121, 3, sext(v23) dst_sel:DWORD dst_unused:UNUSED_PAD src0_sel:DWORD src1_sel:WORD_1

    v_subrev_co_u32 v24, s[88:89], s55, v24
    v_lshlrev_b32_sdwa v122, 3, sext(v24) dst_sel:DWORD dst_unused:UNUSED_PAD src0_sel:DWORD src1_sel:WORD_1

    v_subrev_co_u32 v25, s[90:91], s55, v25
    v_lshlrev_b32_sdwa v123, 3, sext(v25) dst_sel:DWORD dst_unused:UNUSED_PAD src0_sel:DWORD src1_sel:WORD_1

    v_subrev_co_u32 v26, s[92:93], s55, v26
    v_lshlrev_b32_sdwa v124, 3, sext(v26) dst_sel:DWORD dst_unused:UNUSED_PAD src0_sel:DWORD src1_sel:WORD_1

    v_subrev_co_u32 v27, s[94:95], s55, v27
    v_lshlrev_b32_sdwa v125, 3, sext(v27) dst_sel:DWORD dst_unused:UNUSED_PAD src0_sel:DWORD src1_sel:WORD_1

    s_mov_b64 exec, s[72:73]
    ds_read_b64 v[52:53], v114 offset:61440
    s_mov_b64 exec, s[74:75]
    ds_read_b64 v[54:55], v115 offset:61440
    s_mov_b64 exec, s[76:77]
    ds_read_b64 v[56:57], v116 offset:61440
    s_mov_b64 exec, s[78:79]
    ds_read_b64 v[58:59], v117 offset:61440
    s_mov_b64 exec, s[80:81]
    ds_read_b64 v[60:61], v118 offset:61440
    s_mov_b64 exec, s[82:83]
    ds_read_b64 v[62:63], v119 offset:61440
    s_mov_b64 exec, s[84:85]
    ds_read_b64 v[64:65], v120 offset:61440
    s_mov_b64 exec, s[86:87]
    ds_read_b64 v[66:67], v121 offset:61440
    s_mov_b64 exec, s[88:89]
    ds_read_b64 v[68:69], v122 offset:61440
    s_mov_b64 exec, s[90:91]
    ds_read_b64 v[70:71], v123 offset:61440
    s_mov_b64 exec, s[92:93]
    ds_read_b64 v[72:73], v124 offset:61440
    s_mov_b64 exec, s[94:95]
    ds_read_b64 v[74:75], v125 offset:61440
    s_mov_b64 exec, -1
    s_waitcnt lgkmcnt(0)
    s_barrier
    s_waitcnt vmcnt(3)
    ds_write_b128 v3, v[76:79] offset:0
    s_waitcnt vmcnt(2)
    ds_write_b128 v3, v[80:83] offset:16384
    s_waitcnt vmcnt(1)
    ds_write_b128 v3, v[84:87] offset:32768
    s_waitcnt vmcnt(0)
    s_mov_b64 exec, s[58:59]
    ds_write_b128 v3, v[88:91] offset:49152
    s_mov_b64 exec, -1
    s_add_u32 s54, s54, 61440
    s_add_u32 s14, s54, 61440
    s_min_u32 s14, s14, 6400000
    s_cmp_lt_u32 s5, s4
    s_cselect_b32 s14, s14, 0
    buffer_load_dwordx4 v[76:79], v3, s[12:15], s54 offen
    s_add_u32 s60, s54, 16384
    buffer_load_dwordx4 v[80:83], v3, s[12:15], s60 offen
    s_add_u32 s60, s54, 32768
    buffer_load_dwordx4 v[84:87], v3, s[12:15], s60 offen
    s_add_u32 s60, s54, 49152
    buffer_load_dwordx4 v[88:91], v3, s[12:15], s60 offen
    s_add_u32 s62, s54, 61440
    buffer_load_dword v127, v113, s[96:99], s62 offen
    s_waitcnt vmcnt(29)
    s_cmp_le_i32 s71, 0
    s_cbranch_scc1 L_skip_147
    v_perm_b32 v116, v4, v104, s28
    v_and_b32 v4, 0xfff8, v4
    v_lshlrev_b32 v114, 16, v28
    v_and_or_b32 v116, v116, s36, v1
    v_and_b32 v115, s38, v28
    v_lshlrev_b32 v28, 16, v29
    v_subrev_f32 v116, s37, v116
    v_and_b32 v29, s38, v29
    v_add_u32 v117, 50008, v4
    v_pk_fma_f32 v[114:115], v[114:115], v[116:117], s[32:33] op_sel_hi:[1,0,1]
    v_pk_fma_f32 v[28:29], v[28:29], v[116:117], s[32:33] op_sel_hi:[1,0,1]
    v_lshl_add_u64 v[114:115], v[114:115], 0, s[34:35]
    v_lshl_add_u64 v[28:29], v[28:29], 0, s[34:35]
    ds_add_u64 v4, v[114:115] offset:61440
    ds_add_u64 v117, v[28:29] offset:61440

    v_perm_b32 v120, v5, v104, s29
    v_and_b32 v5, 0xfff8, v5
    v_lshlrev_b32 v118, 16, v30
    v_and_or_b32 v120, v120, s36, v1
    v_and_b32 v119, s38, v30
    v_lshlrev_b32 v30, 16, v31
    v_subrev_f32 v120, s37, v120
    v_and_b32 v31, s38, v31
    v_add_u32 v121, 50008, v5
    v_pk_fma_f32 v[118:119], v[118:119], v[120:121], s[32:33] op_sel_hi:[1,0,1]
    v_pk_fma_f32 v[30:31], v[30:31], v[120:121], s[32:33] op_sel_hi:[1,0,1]
    v_lshl_add_u64 v[118:119], v[118:119], 0, s[34:35]
    v_lshl_add_u64 v[30:31], v[30:31], 0, s[34:35]
    ds_add_u64 v5, v[118:119] offset:61440
    ds_add_u64 v121, v[30:31] offset:61440

    v_perm_b32 v124, v6, v104, s30
    v_and_b32 v6, 0xfff8, v6
    v_lshlrev_b32 v122, 16, v32
    v_and_or_b32 v124, v124, s36, v1
    v_and_b32 v123, s38, v32
    v_lshlrev_b32 v32, 16, v33
    v_subrev_f32 v124, s37, v124
    v_and_b32 v33, s38, v33
    v_add_u32 v125, 50008, v6
    v_pk_fma_f32 v[122:123], v[122:123], v[124:125], s[32:33] op_sel_hi:[1,0,1]
    v_pk_fma_f32 v[32:33], v[32:33], v[124:125], s[32:33] op_sel_hi:[1,0,1]
    v_lshl_add_u64 v[122:123], v[122:123], 0, s[34:35]
    v_lshl_add_u64 v[32:33], v[32:33], 0, s[34:35]
    ds_add_u64 v6, v[122:123] offset:61440
    ds_add_u64 v125, v[32:33] offset:61440

    v_perm_b32 v116, v7, v104, s31
    v_and_b32 v7, 0xfff8, v7
    v_lshlrev_b32 v114, 16, v34
    v_and_or_b32 v116, v116, s36, v1
    v_and_b32 v115, s38, v34
    v_lshlrev_b32 v34, 16, v35
    v_subrev_f32 v116, s37, v116
    v_and_b32 v35, s38, v35
    v_add_u32 v117, 50008, v7
    v_pk_fma_f32 v[114:115], v[114:115], v[116:117], s[32:33] op_sel_hi:[1,0,1]
    v_pk_fma_f32 v[34:35], v[34:35], v[116:117], s[32:33] op_sel_hi:[1,0,1]
    v_lshl_add_u64 v[114:115], v[114:115], 0, s[34:35]
    v_lshl_add_u64 v[34:35], v[34:35], 0, s[34:35]
    ds_add_u64 v7, v[114:115] offset:61440
    ds_add_u64 v117, v[34:35] offset:61440

L_skip_147:
    s_waitcnt vmcnt(29)
    s_cmp_le_i32 s71, 3072
    s_cbranch_scc1 L_nt1_145
    v_bfi_b32 v126, s68, v101, v102
    v_alignbyte_b32 v101, v102, v101, 1
    v_bfi_b32 v126, s69, v126, v103
    v_alignbyte_b32 v102, v103, v102, 2
    v_alignbyte_b32 v103, v112, v103, 3
    v_bfi_b32 v112, s70, v126, v112
    s_cmp_lt_i32 s71, 3328
    s_cbranch_scc1 L_ufix_148
L_uback_149:

    v_cmp_ne_u32 vcc, 0, v100
    v_lshlrev_b32_sdwa v114, 3, v100 dst_sel:DWORD dst_unused:UNUSED_PAD src0_sel:DWORD src1_sel:WORD_1
    s_mov_b64 exec, vcc

    buffer_load_dwordx2 v[28:29], v114, s[8:11], 0 offen
    s_mov_b64 exec, -1
    v_cmp_ne_u32 vcc, 0, v101
    v_lshlrev_b32_sdwa v115, 3, v101 dst_sel:DWORD dst_unused:UNUSED_PAD src0_sel:DWORD src1_sel:WORD_1
    s_mov_b64 exec, vcc

    buffer_load_dwordx2 v[30:31], v115, s[8:11], 0 offen
    s_mov_b64 exec, -1
    v_cmp_ne_u32 vcc, 0, v102
    v_lshlrev_b32_sdwa v116, 3, v102 dst_sel:DWORD dst_unused:UNUSED_PAD src0_sel:DWORD src1_sel:WORD_1
    s_mov_b64 exec, vcc

    buffer_load_dwordx2 v[32:33], v116, s[8:11], 0 offen
    s_mov_b64 exec, -1
    v_cmp_ne_u32 vcc, 0, v103
    v_lshlrev_b32_sdwa v117, 3, v103 dst_sel:DWORD dst_unused:UNUSED_PAD src0_sel:DWORD src1_sel:WORD_1
    s_mov_b64 exec, vcc

    buffer_load_dwordx2 v[34:35], v117, s[8:11], 0 offen
    s_mov_b64 exec, -1
L_nt1_145:
    s_movk_i32 s61, 0
    buffer_load_dwordx4 v[4:7], v2, s[16:19], s61 offen
    buffer_load_dword v104, v2, s[16:19], s61 offen offset:16
    s_waitcnt vmcnt(27)
    s_cmp_le_i32 s71, 512
    s_cbranch_scc1 L_skip_150
    v_perm_b32 v120, v8, v105, s28
    v_and_b32 v8, 0xfff8, v8
    v_lshlrev_b32 v118, 16, v36
    v_and_or_b32 v120, v120, s36, v1
    v_and_b32 v119, s38, v36
    v_lshlrev_b32 v36, 16, v37
    v_subrev_f32 v120, s37, v120
    v_and_b32 v37, s38, v37
    v_add_u32 v121, 50008, v8
    v_pk_fma_f32 v[118:119], v[118:119], v[120:121], s[32:33] op_sel_hi:[1,0,1]
    v_pk_fma_f32 v[36:37], v[36:37], v[120:121], s[32:33] op_sel_hi:[1,0,1]
    v_lshl_add_u64 v[118:119], v[118:119], 0, s[34:35]
    v_lshl_add_u64 v[36:37], v[36:37], 0, s[34:35]
    ds_add_u64 v8, v[118:119] offset:61440
    ds_add_u64 v121, v[36:37] offset:61440

    v_perm_b32 v124, v9, v105, s29
    v_and_b32 v9, 0xfff8, v9
    v_lshlrev_b32 v122, 16, v38
    v_and_or_b32 v124, v124, s36, v1
    v_and_b32 v123, s38, v38
    v_lshlrev_b32 v38, 16, v39
    v_subrev_f32 v124, s37, v124
    v_and_b32 v39, s38, v39
    v_add_u32 v125, 50008, v9
    v_pk_fma_f32 v[122:123], v[122:123], v[124:125], s[32:33] op_sel_hi:[1,0,1]
    v_pk_fma_f32 v[38:39], v[38:39], v[124:125], s[32:33] op_sel_hi:[1,0,1]
    v_lshl_add_u64 v[122:123], v[122:123], 0, s[34:35]
    v_lshl_add_u64 v[38:39], v[38:39], 0, s[34:35]
    ds_add_u64 v9, v[122:123] offset:61440
    ds_add_u64 v125, v[38:39] offset:61440

    v_perm_b32 v116, v10, v105, s30
    v_and_b32 v10, 0xfff8, v10
    v_lshlrev_b32 v114, 16, v40
    v_and_or_b32 v116, v116, s36, v1
    v_and_b32 v115, s38, v40
    v_lshlrev_b32 v40, 16, v41
    v_subrev_f32 v116, s37, v116
    v_and_b32 v41, s38, v41
    v_add_u32 v117, 50008, v10
    v_pk_fma_f32 v[114:115], v[114:115], v[116:117], s[32:33] op_sel_hi:[1,0,1]
    v_pk_fma_f32 v[40:41], v[40:41], v[116:117], s[32:33] op_sel_hi:[1,0,1]
    v_lshl_add_u64 v[114:115], v[114:115], 0, s[34:35]
    v_lshl_add_u64 v[40:41], v[40:41], 0, s[34:35]
    ds_add_u64 v10, v[114:115] offset:61440
    ds_add_u64 v117, v[40:41] offset:61440

    v_perm_b32 v120, v11, v105, s31
    v_and_b32 v11, 0xfff8, v11
    v_lshlrev_b32 v118, 16, v42
    v_and_or_b32 v120, v120, s36, v1
    v_and_b32 v119, s38, v42
    v_lshlrev_b32 v42, 16, v43
    v_subrev_f32 v120, s37, v120
    v_and_b32 v43, s38, v43
    v_add_u32 v121, 50008, v11
    v_pk_fma_f32 v[118:119], v[118:119], v[120:121], s[32:33] op_sel_hi:[1,0,1]
    v_pk_fma_f32 v[42:43], v[42:43], v[120:121], s[32:33] op_sel_hi:[1,0,1]
    v_lshl_add_u64 v[118:119], v[118:119], 0, s[34:35]
    v_lshl_add_u64 v[42:43], v[42:43], 0, s[34:35]
    ds_add_u64 v11, v[118:119] offset:61440
    ds_add_u64 v121, v[42:43] offset:61440

L_skip_150:
    s_movk_i32 s61, 2560
    buffer_load_dwordx4 v[8:11], v2, s[16:19], s61 offen
    buffer_load_dword v105, v2, s[16:19], s61 offen offset:16
    s_waitcnt vmcnt(23)
    s_cmp_le_i32 s71, 1024
    s_cbranch_scc1 L_skip_151
    v_perm_b32 v124, v12, v106, s28
    v_and_b32 v12, 0xfff8, v12
    v_lshlrev_b32 v122, 16, v44
    v_and_or_b32 v124, v124, s36, v1
    v_and_b32 v123, s38, v44
    v_lshlrev_b32 v44, 16, v45
    v_subrev_f32 v124, s37, v124
    v_and_b32 v45, s38, v45
    v_add_u32 v125, 50008, v12
    v_pk_fma_f32 v[122:123], v[122:123], v[124:125], s[32:33] op_sel_hi:[1,0,1]
    v_pk_fma_f32 v[44:45], v[44:45], v[124:125], s[32:33] op_sel_hi:[1,0,1]
    v_lshl_add_u64 v[122:123], v[122:123], 0, s[34:35]
    v_lshl_add_u64 v[44:45], v[44:45], 0, s[34:35]
    ds_add_u64 v12, v[122:123] offset:61440
    ds_add_u64 v125, v[44:45] offset:61440

    v_perm_b32 v116, v13, v106, s29
    v_and_b32 v13, 0xfff8, v13
    v_lshlrev_b32 v114, 16, v46
    v_and_or_b32 v116, v116, s36, v1
    v_and_b32 v115, s38, v46
    v_lshlrev_b32 v46, 16, v47
    v_subrev_f32 v116, s37, v116
    v_and_b32 v47, s38, v47
    v_add_u32 v117, 50008, v13
    v_pk_fma_f32 v[114:115], v[114:115], v[116:117], s[32:33] op_sel_hi:[1,0,1]
    v_pk_fma_f32 v[46:47], v[46:47], v[116:117], s[32:33] op_sel_hi:[1,0,1]
    v_lshl_add_u64 v[114:115], v[114:115], 0, s[34:35]
    v_lshl_add_u64 v[46:47], v[46:47], 0, s[34:35]
    ds_add_u64 v13, v[114:115] offset:61440
    ds_add_u64 v117, v[46:47] offset:61440

    v_perm_b32 v120, v14, v106, s30
    v_and_b32 v14, 0xfff8, v14
    v_lshlrev_b32 v118, 16, v48
    v_and_or_b32 v120, v120, s36, v1
    v_and_b32 v119, s38, v48
    v_lshlrev_b32 v48, 16, v49
    v_subrev_f32 v120, s37, v120
    v_and_b32 v49, s38, v49
    v_add_u32 v121, 50008, v14
    v_pk_fma_f32 v[118:119], v[118:119], v[120:121], s[32:33] op_sel_hi:[1,0,1]
    v_pk_fma_f32 v[48:49], v[48:49], v[120:121], s[32:33] op_sel_hi:[1,0,1]
    v_lshl_add_u64 v[118:119], v[118:119], 0, s[34:35]
    v_lshl_add_u64 v[48:49], v[48:49], 0, s[34:35]
    ds_add_u64 v14, v[118:119] offset:61440
    ds_add_u64 v121, v[48:49] offset:61440

    v_perm_b32 v124, v15, v106, s31
    v_and_b32 v15, 0xfff8, v15
    v_lshlrev_b32 v122, 16, v50
    v_and_or_b32 v124, v124, s36, v1
    v_and_b32 v123, s38, v50
    v_lshlrev_b32 v50, 16, v51
    v_subrev_f32 v124, s37, v124
    v_and_b32 v51, s38, v51
    v_add_u32 v125, 50008, v15
    v_pk_fma_f32 v[122:123], v[122:123], v[124:125], s[32:33] op_sel_hi:[1,0,1]
    v_pk_fma_f32 v[50:51], v[50:51], v[124:125], s[32:33] op_sel_hi:[1,0,1]
    v_lshl_add_u64 v[122:123], v[122:123], 0, s[34:35]
    v_lshl_add_u64 v[50:51], v[50:51], 0, s[34:35]
    ds_add_u64 v15, v[122:123] offset:61440
    ds_add_u64 v125, v[50:51] offset:61440

L_skip_151:
    s_movk_i32 s61, 5120
    buffer_load_dwordx4 v[12:15], v2, s[16:19], s61 offen
    buffer_load_dword v106, v2, s[16:19], s61 offen offset:16
    s_waitcnt vmcnt(21)
    s_cmp_le_i32 s71, 1536
    s_cbranch_scc1 L_skip_152
    v_perm_b32 v116, v16, v107, s28
    v_and_b32 v16, 0xfff8, v16
    v_lshlrev_b32 v114, 16, v52
    v_and_or_b32 v116, v116, s36, v1
    v_and_b32 v115, s38, v52
    v_lshlrev_b32 v52, 16, v53
    v_subrev_f32 v116, s37, v116
    v_and_b32 v53, s38, v53
    v_add_u32 v117, 50008, v16
    v_pk_fma_f32 v[114:115], v[114:115], v[116:117], s[32:33] op_sel_hi:[1,0,1]
    v_pk_fma_f32 v[52:53], v[52:53], v[116:117], s[32:33] op_sel_hi:[1,0,1]
    v_lshl_add_u64 v[114:115], v[114:115], 0, s[34:35]
    v_lshl_add_u64 v[52:53], v[52:53], 0, s[34:35]
    ds_add_u64 v16, v[114:115] offset:61440
    ds_add_u64 v117, v[52:53] offset:61440

    v_perm_b32 v120, v17, v107, s29
    v_and_b32 v17, 0xfff8, v17
    v_lshlrev_b32 v118, 16, v54
    v_and_or_b32 v120, v120, s36, v1
    v_and_b32 v119, s38, v54
    v_lshlrev_b32 v54, 16, v55
    v_subrev_f32 v120, s37, v120
    v_and_b32 v55, s38, v55
    v_add_u32 v121, 50008, v17
    v_pk_fma_f32 v[118:119], v[118:119], v[120:121], s[32:33] op_sel_hi:[1,0,1]
    v_pk_fma_f32 v[54:55], v[54:55], v[120:121], s[32:33] op_sel_hi:[1,0,1]
    v_lshl_add_u64 v[118:119], v[118:119], 0, s[34:35]
    v_lshl_add_u64 v[54:55], v[54:55], 0, s[34:35]
    ds_add_u64 v17, v[118:119] offset:61440
    ds_add_u64 v121, v[54:55] offset:61440

    v_perm_b32 v124, v18, v107, s30
    v_and_b32 v18, 0xfff8, v18
    v_lshlrev_b32 v122, 16, v56
    v_and_or_b32 v124, v124, s36, v1
    v_and_b32 v123, s38, v56
    v_lshlrev_b32 v56, 16, v57
    v_subrev_f32 v124, s37, v124
    v_and_b32 v57, s38, v57
    v_add_u32 v125, 50008, v18
    v_pk_fma_f32 v[122:123], v[122:123], v[124:125], s[32:33] op_sel_hi:[1,0,1]
    v_pk_fma_f32 v[56:57], v[56:57], v[124:125], s[32:33] op_sel_hi:[1,0,1]
    v_lshl_add_u64 v[122:123], v[122:123], 0, s[34:35]
    v_lshl_add_u64 v[56:57], v[56:57], 0, s[34:35]
    ds_add_u64 v18, v[122:123] offset:61440
    ds_add_u64 v125, v[56:57] offset:61440

    v_perm_b32 v116, v19, v107, s31
    v_and_b32 v19, 0xfff8, v19
    v_lshlrev_b32 v114, 16, v58
    v_and_or_b32 v116, v116, s36, v1
    v_and_b32 v115, s38, v58
    v_lshlrev_b32 v58, 16, v59
    v_subrev_f32 v116, s37, v116
    v_and_b32 v59, s38, v59
    v_add_u32 v117, 50008, v19
    v_pk_fma_f32 v[114:115], v[114:115], v[116:117], s[32:33] op_sel_hi:[1,0,1]
    v_pk_fma_f32 v[58:59], v[58:59], v[116:117], s[32:33] op_sel_hi:[1,0,1]
    v_lshl_add_u64 v[114:115], v[114:115], 0, s[34:35]
    v_lshl_add_u64 v[58:59], v[58:59], 0, s[34:35]
    ds_add_u64 v19, v[114:115] offset:61440
    ds_add_u64 v117, v[58:59] offset:61440

L_skip_152:
    s_movk_i32 s61, 7680
    buffer_load_dwordx4 v[16:19], v2, s[16:19], s61 offen
    buffer_load_dword v107, v2, s[16:19], s61 offen offset:16
    s_waitcnt vmcnt(17)
    s_cmp_le_i32 s71, 2048
    s_cbranch_scc1 L_skip_153
    v_perm_b32 v120, v20, v108, s28
    v_and_b32 v20, 0xfff8, v20
    v_lshlrev_b32 v118, 16, v60
    v_and_or_b32 v120, v120, s36, v1
    v_and_b32 v119, s38, v60
    v_lshlrev_b32 v60, 16, v61
    v_subrev_f32 v120, s37, v120
    v_and_b32 v61, s38, v61
    v_add_u32 v121, 50008, v20
    v_pk_fma_f32 v[118:119], v[118:119], v[120:121], s[32:33] op_sel_hi:[1,0,1]
    v_pk_fma_f32 v[60:61], v[60:61], v[120:121], s[32:33] op_sel_hi:[1,0,1]
    v_lshl_add_u64 v[118:119], v[118:119], 0, s[34:35]
    v_lshl_add_u64 v[60:61], v[60:61], 0, s[34:35]
    ds_add_u64 v20, v[118:119] offset:61440
    ds_add_u64 v121, v[60:61] offset:61440

    v_perm_b32 v124, v21, v108, s29
    v_and_b32 v21, 0xfff8, v21
    v_lshlrev_b32 v122, 16, v62
    v_and_or_b32 v124, v124, s36, v1
    v_and_b32 v123, s38, v62
    v_lshlrev_b32 v62, 16, v63
    v_subrev_f32 v124, s37, v124
    v_and_b32 v63, s38, v63
    v_add_u32 v125, 50008, v21
    v_pk_fma_f32 v[122:123], v[122:123], v[124:125], s[32:33] op_sel_hi:[1,0,1]
    v_pk_fma_f32 v[62:63], v[62:63], v[124:125], s[32:33] op_sel_hi:[1,0,1]
    v_lshl_add_u64 v[122:123], v[122:123], 0, s[34:35]
    v_lshl_add_u64 v[62:63], v[62:63], 0, s[34:35]
    ds_add_u64 v21, v[122:123] offset:61440
    ds_add_u64 v125, v[62:63] offset:61440

    v_perm_b32 v116, v22, v108, s30
    v_and_b32 v22, 0xfff8, v22
    v_lshlrev_b32 v114, 16, v64
    v_and_or_b32 v116, v116, s36, v1
    v_and_b32 v115, s38, v64
    v_lshlrev_b32 v64, 16, v65
    v_subrev_f32 v116, s37, v116
    v_and_b32 v65, s38, v65
    v_add_u32 v117, 50008, v22
    v_pk_fma_f32 v[114:115], v[114:115], v[116:117], s[32:33] op_sel_hi:[1,0,1]
    v_pk_fma_f32 v[64:65], v[64:65], v[116:117], s[32:33] op_sel_hi:[1,0,1]
    v_lshl_add_u64 v[114:115], v[114:115], 0, s[34:35]
    v_lshl_add_u64 v[64:65], v[64:65], 0, s[34:35]
    ds_add_u64 v22, v[114:115] offset:61440
    ds_add_u64 v117, v[64:65] offset:61440

    v_perm_b32 v120, v23, v108, s31
    v_and_b32 v23, 0xfff8, v23
    v_lshlrev_b32 v118, 16, v66
    v_and_or_b32 v120, v120, s36, v1
    v_and_b32 v119, s38, v66
    v_lshlrev_b32 v66, 16, v67
    v_subrev_f32 v120, s37, v120
    v_and_b32 v67, s38, v67
    v_add_u32 v121, 50008, v23
    v_pk_fma_f32 v[118:119], v[118:119], v[120:121], s[32:33] op_sel_hi:[1,0,1]
    v_pk_fma_f32 v[66:67], v[66:67], v[120:121], s[32:33] op_sel_hi:[1,0,1]
    v_lshl_add_u64 v[118:119], v[118:119], 0, s[34:35]
    v_lshl_add_u64 v[66:67], v[66:67], 0, s[34:35]
    ds_add_u64 v23, v[118:119] offset:61440
    ds_add_u64 v121, v[66:67] offset:61440

L_skip_153:
    s_waitcnt vmcnt(13)
    s_cmp_le_i32 s71, 2560
    s_cbranch_scc1 L_skip_154
    v_perm_b32 v124, v24, v109, s28
    v_and_b32 v24, 0xfff8, v24
    v_lshlrev_b32 v122, 16, v68
    v_and_or_b32 v124, v124, s36, v1
    v_and_b32 v123, s38, v68
    v_lshlrev_b32 v68, 16, v69
    v_subrev_f32 v124, s37, v124
    v_and_b32 v69, s38, v69
    v_add_u32 v125, 50008, v24
    v_pk_fma_f32 v[122:123], v[122:123], v[124:125], s[32:33] op_sel_hi:[1,0,1]
    v_pk_fma_f32 v[68:69], v[68:69], v[124:125], s[32:33] op_sel_hi:[1,0,1]
    v_lshl_add_u64 v[122:123], v[122:123], 0, s[34:35]
    v_lshl_add_u64 v[68:69], v[68:69], 0, s[34:35]
    ds_add_u64 v24, v[122:123] offset:61440
    ds_add_u64 v125, v[68:69] offset:61440

    v_perm_b32 v116, v25, v109, s29
    v_and_b32 v25, 0xfff8, v25
    v_lshlrev_b32 v114, 16, v70
    v_and_or_b32 v116, v116, s36, v1
    v_and_b32 v115, s38, v70
    v_lshlrev_b32 v70, 16, v71
    v_subrev_f32 v116, s37, v116
    v_and_b32 v71, s38, v71
    v_add_u32 v117, 50008, v25
    v_pk_fma_f32 v[114:115], v[114:115], v[116:117], s[32:33] op_sel_hi:[1,0,1]
    v_pk_fma_f32 v[70:71], v[70:71], v[116:117], s[32:33] op_sel_hi:[1,0,1]
    v_lshl_add_u64 v[114:115], v[114:115], 0, s[34:35]
    v_lshl_add_u64 v[70:71], v[70:71], 0, s[34:35]
    ds_add_u64 v25, v[114:115] offset:61440
    ds_add_u64 v117, v[70:71] offset:61440

    v_perm_b32 v120, v26, v109, s30
    v_and_b32 v26, 0xfff8, v26
    v_lshlrev_b32 v118, 16, v72
    v_and_or_b32 v120, v120, s36, v1
    v_and_b32 v119, s38, v72
    v_lshlrev_b32 v72, 16, v73
    v_subrev_f32 v120, s37, v120
    v_and_b32 v73, s38, v73
    v_add_u32 v121, 50008, v26
    v_pk_fma_f32 v[118:119], v[118:119], v[120:121], s[32:33] op_sel_hi:[1,0,1]
    v_pk_fma_f32 v[72:73], v[72:73], v[120:121], s[32:33] op_sel_hi:[1,0,1]
    v_lshl_add_u64 v[118:119], v[118:119], 0, s[34:35]
    v_lshl_add_u64 v[72:73], v[72:73], 0, s[34:35]
    ds_add_u64 v26, v[118:119] offset:61440
    ds_add_u64 v121, v[72:73] offset:61440

    v_perm_b32 v124, v27, v109, s31
    v_and_b32 v27, 0xfff8, v27
    v_lshlrev_b32 v122, 16, v74
    v_and_or_b32 v124, v124, s36, v1
    v_and_b32 v123, s38, v74
    v_lshlrev_b32 v74, 16, v75
    v_subrev_f32 v124, s37, v124
    v_and_b32 v75, s38, v75
    v_add_u32 v125, 50008, v27
    v_pk_fma_f32 v[122:123], v[122:123], v[124:125], s[32:33] op_sel_hi:[1,0,1]
    v_pk_fma_f32 v[74:75], v[74:75], v[124:125], s[32:33] op_sel_hi:[1,0,1]
    v_lshl_add_u64 v[122:123], v[122:123], 0, s[34:35]
    v_lshl_add_u64 v[74:75], v[74:75], 0, s[34:35]
    ds_add_u64 v27, v[122:123] offset:61440
    ds_add_u64 v125, v[74:75] offset:61440

L_skip_154:
    s_cmp_le_i32 s71, 3072
    s_cbranch_scc1 L_nt2_146
    s_waitcnt vmcnt(8)
    v_cmp_ne_u32 vcc, 0, v100
    s_mov_b64 exec, vcc
    v_perm_b32 v116, v100, v112, s28
    v_and_b32 v100, 0xfff8, v100
    v_lshlrev_b32 v114, 16, v28
    v_and_or_b32 v116, v116, s36, v1
    v_and_b32 v115, s38, v28
    v_lshlrev_b32 v28, 16, v29
    v_subrev_f32 v116, s37, v116
    v_and_b32 v29, s38, v29
    v_add_u32 v117, 50008, v100
    v_pk_fma_f32 v[114:115], v[114:115], v[116:117], s[32:33] op_sel_hi:[1,0,1]
    v_pk_fma_f32 v[28:29], v[28:29], v[116:117], s[32:33] op_sel_hi:[1,0,1]
    v_lshl_add_u64 v[114:115], v[114:115], 0, s[34:35]
    v_lshl_add_u64 v[28:29], v[28:29], 0, s[34:35]
    ds_add_u64 v100, v[114:115] offset:61440
    ds_add_u64 v117, v[28:29] offset:61440

    s_mov_b64 exec, -1
    v_cmp_ne_u32 vcc, 0, v101
    s_mov_b64 exec, vcc
    v_perm_b32 v120, v101, v112, s29
    v_and_b32 v101, 0xfff8, v101
    v_lshlrev_b32 v118, 16, v30
    v_and_or_b32 v120, v120, s36, v1
    v_and_b32 v119, s38, v30
    v_lshlrev_b32 v30, 16, v31
    v_subrev_f32 v120, s37, v120
    v_and_b32 v31, s38, v31
    v_add_u32 v121, 50008, v101
    v_pk_fma_f32 v[118:119], v[118:119], v[120:121], s[32:33] op_sel_hi:[1,0,1]
    v_pk_fma_f32 v[30:31], v[30:31], v[120:121], s[32:33] op_sel_hi:[1,0,1]
    v_lshl_add_u64 v[118:119], v[118:119], 0, s[34:35]
    v_lshl_add_u64 v[30:31], v[30:31], 0, s[34:35]
    ds_add_u64 v101, v[118:119] offset:61440
    ds_add_u64 v121, v[30:31] offset:61440

    s_mov_b64 exec, -1
    v_cmp_ne_u32 vcc, 0, v102
    s_mov_b64 exec, vcc
    v_perm_b32 v124, v102, v112, s30
    v_and_b32 v102, 0xfff8, v102
    v_lshlrev_b32 v122, 16, v32
    v_and_or_b32 v124, v124, s36, v1
    v_and_b32 v123, s38, v32
    v_lshlrev_b32 v32, 16, v33
    v_subrev_f32 v124, s37, v124
    v_and_b32 v33, s38, v33
    v_add_u32 v125, 50008, v102
    v_pk_fma_f32 v[122:123], v[122:123], v[124:125], s[32:33] op_sel_hi:[1,0,1]
    v_pk_fma_f32 v[32:33], v[32:33], v[124:125], s[32:33] op_sel_hi:[1,0,1]
    v_lshl_add_u64 v[122:123], v[122:123], 0, s[34:35]
    v_lshl_add_u64 v[32:33], v[32:33], 0, s[34:35]
    ds_add_u64 v102, v[122:123] offset:61440
    ds_add_u64 v125, v[32:33] offset:61440

    s_mov_b64 exec, -1
    v_cmp_ne_u32 vcc, 0, v103
    s_mov_b64 exec, vcc
    v_perm_b32 v116, v103, v112, s31
    v_and_b32 v103, 0xfff8, v103
    v_lshlrev_b32 v114, 16, v34
    v_and_or_b32 v116, v116, s36, v1
    v_and_b32 v115, s38, v34
    v_lshlrev_b32 v34, 16, v35
    v_subrev_f32 v116, s37, v116
    v_and_b32 v35, s38, v35
    v_add_u32 v117, 50008, v103
    v_pk_fma_f32 v[114:115], v[114:115], v[116:117], s[32:33] op_sel_hi:[1,0,1]
    v_pk_fma_f32 v[34:35], v[34:35], v[116:117], s[32:33] op_sel_hi:[1,0,1]
    v_lshl_add_u64 v[114:115], v[114:115], 0, s[34:35]
    v_lshl_add_u64 v[34:35], v[34:35], 0, s[34:35]
    ds_add_u64 v103, v[114:115] offset:61440
    ds_add_u64 v117, v[34:35] offset:61440

    s_mov_b64 exec, -1
L_nt2_146:
    s_movk_i32 s61, 15360
    buffer_load_dwordx4 v[100:103], v2, s[16:19], s61 offen
    buffer_load_dword v112, v2, s[16:19], s61 offen offset:16
    s_cmp_le_u32 s44, 3584
    s_cbranch_scc1 L_leftend_156
    s_lshr_b32 s63, s43, 2
    s_add_u32 s63, s63, 3584
    v_and_b32 v36, 63, v0
    v_add_u32 v36, s63, v36
L_left_155:
    s_cmp_ge_u32 s63, s44
    s_cbranch_scc1 L_leftend_156
    v_mul_u32_u24 v37, 5, v36
    buffer_load_dword v38, v37, s[20:23], 0 offen
    buffer_load_ubyte v39, v37, s[20:23], 0 offen offset:4
    s_waitcnt vmcnt(1)
    v_lshlrev_b32_sdwa v37, 3, v38 dst_sel:DWORD dst_unused:UNUSED_PAD src0_sel:DWORD src1_sel:WORD_1
    buffer_load_dwordx2 v[40:41], v37, s[8:11], 0 offen
    v_cmp_gt_u32 vcc, s44, v36
    s_waitcnt vmcnt(0)
    s_mov_b64 exec, vcc

    v_perm_b32 v116, v38, v39, s28
    v_and_b32 v38, 0xfff8, v38
    v_lshlrev_b32 v114, 16, v40
    v_and_or_b32 v116, v116, s36, v1
    v_and_b32 v115, s38, v40
    v_lshlrev_b32 v40, 16, v41
    v_subrev_f32 v116, s37, v116
    v_and_b32 v41, s38, v41
    v_add_u32 v117, 50008, v38
    v_pk_fma_f32 v[114:115], v[114:115], v[116:117], s[32:33] op_sel_hi:[1,0,1]
    v_pk_fma_f32 v[40:41], v[40:41], v[116:117], s[32:33] op_sel_hi:[1,0,1]
    v_lshl_add_u64 v[114:115], v[114:115], 0, s[34:35]
    v_lshl_add_u64 v[40:41], v[40:41], 0, s[34:35]
    ds_add_u64 v38, v[114:115] offset:61440
    ds_add_u64 v117, v[40:41] offset:61440

    s_mov_b64 exec, -1
    v_add_u32 v36, 128, v36
    s_add_u32 s63, s63, 128
    s_branch L_left_155
L_leftend_156:

    s_mov_b32 s42, s5
    s_waitcnt lgkmcnt(0)
    s_barrier

    s_cmp_ge_u32 s42, s4
    s_cbranch_scc1 L_bend_157
    s_and_b32 s60, s42, 1
    s_cbranch_scc1 L_batch_131

    v_lshlrev_b32 v56, 3, v0
    v_add_u32 v56, 61448, v56
    v_add_u32 v57, 50008, v56
    v_cmp_gt_u32 vcc, 106, v0

    v_mov_b32 v52, 0
    v_mov_b32 v53, 0
    v_mov_b32 v54, 0
    v_mov_b32 v55, 0
    ds_read_b64 v[28:29], v56 offset:0
    ds_read_b64 v[30:31], v57 offset:0
    ds_read_b64 v[32:33], v56 offset:8192
    ds_read_b64 v[34:35], v57 offset:8192
    ds_read_b64 v[36:37], v56 offset:16384
    ds_read_b64 v[38:39], v57 offset:16384
    ds_read_b64 v[40:41], v56 offset:24576
    ds_read_b64 v[42:43], v57 offset:24576
    ds_read_b64 v[44:45], v56 offset:32768
    ds_read_b64 v[46:47], v57 offset:32768
    ds_read_b64 v[48:49], v56 offset:40960
    ds_read_b64 v[50:51], v57 offset:40960
    s_mov_b64 exec, vcc
    ds_read_b64 v[52:53], v56 offset:49152
    ds_read_b64 v[54:55], v57 offset:49152
    s_mov_b64 exec, -1
    v_mov_b32 v58, 0
    v_mov_b32 v59, 0
    s_waitcnt lgkmcnt(0)
    v_max3_i32 v58, v28, v29, v58
    v_min3_i32 v59, v28, v29, v59
    v_max3_i32 v58, v30, v31, v58
    v_min3_i32 v59, v30, v31, v59
    v_max3_i32 v58, v32, v33, v58
    v_min3_i32 v59, v32, v33, v59
    v_max3_i32 v58, v34, v35, v58
    v_min3_i32 v59, v34, v35, v59
    v_max3_i32 v58, v36, v37, v58
    v_min3_i32 v59, v36, v37, v59
    v_max3_i32 v58, v38, v39, v58
    v_min3_i32 v59, v38, v39, v59
    v_max3_i32 v58, v40, v41, v58
    v_min3_i32 v59, v40, v41, v59
    v_max3_i32 v58, v42, v43, v58
    v_min3_i32 v59, v42, v43, v59
    v_max3_i32 v58, v44, v45, v58
    v_min3_i32 v59, v44, v45, v59
    v_max3_i32 v58, v46, v47, v58
    v_min3_i32 v59, v46, v47, v59
    v_max3_i32 v58, v48, v49, v58
    v_min3_i32 v59, v48, v49, v59
    v_max3_i32 v58, v50, v51, v58
    v_min3_i32 v59, v50, v51, v59
    v_max3_i32 v58, v52, v53, v58
    v_min3_i32 v59, v52, v53, v59
    v_max3_i32 v58, v54, v55, v58
    v_min3_i32 v59, v54, v55, v59
    v_not_b32 v59, v59
    v_max_i32 v58, v58, v59
    v_cmp_lt_i32 vcc, s47, v58
    v_mov_b32 v60, 161460
    v_mov_b32 v61, 1
    s_cbranch_vccz L_nf_159
    ds_write_b32 v60, v61
L_nf_159:
    s_waitcnt lgkmcnt(0)
    s_barrier
    ds_read_b32 v61, v60
    s_waitcnt lgkmcnt(0)
    v_readfirstlane_b32 s61, v61
    s_nop 1
    s_cmp_eq_u32 s61, 0
    s_cbranch_scc1 L_ok_158
    s_barrier
    v_mov_b32 v61, 0
    ds_write_b32 v60, v61

    s_mov_b32 s60, 0
    v_lshlrev_b32 v40, 3, v0
    v_lshlrev_b32 v41, 4, v0
    v_mov_b32 v42, v0
L_fl_160:
    v_cmp_gt_u32 vcc, 6250, v42
    v_add_u32 v43, 50008, v40
    v_mov_b32 v36, 0
    v_mov_b32 v37, 0
    v_mov_b32 v38, 0
    v_mov_b32 v39, 0
    s_cmp_eq_u32 s46, 0
    s_cbranch_scc1 L_nold_161
    buffer_load_dwordx4 v[36:39], v41, s[24:27], 0 offen sc1
    s_waitcnt vmcnt(0)
L_nold_161:
    s_mov_b64 exec, vcc
    ds_read_b64 v[28:29], v40 offset:61448
    ds_read_b64 v[30:31], v43 offset:61448
    s_mov_b64 exec, -1
    s_waitcnt lgkmcnt(0)
    v_ashrrev_i32 v32, 31, v28
    v_ashrrev_i32 v33, 31, v30
    v_sub_u32 v29, v29, v32
    v_sub_u32 v31, v31, v33
    v_cvt_f32_i32 v28, v28
    v_cvt_f32_i32 v29, v29
    v_cvt_f32_i32 v30, v30
    v_cvt_f32_i32 v31, v31
    v_fma_f32 v32, v28, s39, v36
    v_fma_f32 v33, v29, s39, v37
    v_fma_f32 v34, v30, s39, v38
    v_fma_f32 v35, v31, s39, v39
    buffer_store_dwordx4 v[32:35], v41, s[24:27], 0 offen
    v_add_u32 v40, 8192, v40
    v_add_u32 v41, 16384, v41
    v_add_u32 v42, 1024, v42
    s_add_u32 s60, s60, 1
    s_cmp_lt_u32 s60, 7
    s_cbranch_scc1 L_fl_160

    s_waitcnt vmcnt(0)
    s_barrier
    s_mov_b32 s46, 1
    v_mov_b32 v28, 0
    v_mov_b32 v29, 0
    v_mov_b32 v30, 0
    v_mov_b32 v31, 0
    v_add_u32 v32, 61440, v3
    v_add_u32 v33, 65536, v32

    ds_write_b128 v32, v[28:31] offset:0
    ds_write_b128 v32, v[28:31] offset:16384
    ds_write_b128 v32, v[28:31] offset:32768
    ds_write_b128 v32, v[28:31] offset:49152
    ds_write_b128 v33, v[28:31] offset:0
    ds_write_b128 v33, v[28:31] offset:16384
    v_cmp_gt_u32 vcc, 107, v0
    s_mov_b64 exec, vcc
    ds_write_b128 v33, v[28:31] offset:32768
    s_mov_b64 exec, -1
    s_waitcnt lgkmcnt(0)
    s_barrier
L_ok_158:
    s_branch L_batch_131
L_bend_157:

    s_add_u32 s64, s6, 131072
    s_addc_u32 s65, s7, 0
    s_load_dword s44, s[64:65], 0
    s_waitcnt lgkmcnt(0)
    s_cmp_eq_u32 s44, 0
    s_cbranch_scc1 L_ovfend_163
    s_waitcnt vmcnt(0)

    s_add_u32 s16, s6, 352321536
    s_addc_u32 s17, s7, 0
    s_mov_b32 s18, 409600000
    s_mov_b32 s19, 0x20000
    s_mov_b32 s8, s50
    s_mov_b32 s9, s51
    s_mov_b32 s10, 6400000
    s_mov_b32 s11, 0x20000
    s_mov_b32 s42, 0
    s_mul_i32 s45, s41, 8
    s_mov_b32 s54, 50000
    v_mov_b32 v2, v0
L_ovfc_164:

    v_lshlrev_b32 v56, 3, v0
    v_add_u32 v56, 61448, v56
    v_add_u32 v57, 50008, v56
    v_cmp_gt_u32 vcc, 106, v0

    v_mov_b32 v52, 0
    v_mov_b32 v53, 0
    v_mov_b32 v54, 0
    v_mov_b32 v55, 0
    ds_read_b64 v[28:29], v56 offset:0
    ds_read_b64 v[30:31], v57 offset:0
    ds_read_b64 v[32:33], v56 offset:8192
    ds_read_b64 v[34:35], v57 offset:8192
    ds_read_b64 v[36:37], v56 offset:16384
    ds_read_b64 v[38:39], v57 offset:16384
    ds_read_b64 v[40:41], v56 offset:24576
    ds_read_b64 v[42:43], v57 offset:24576
    ds_read_b64 v[44:45], v56 offset:32768
    ds_read_b64 v[46:47], v57 offset:32768
    ds_read_b64 v[48:49], v56 offset:40960
    ds_read_b64 v[50:51], v57 offset:40960
    s_mov_b64 exec, vcc
    ds_read_b64 v[52:53], v56 offset:49152
    ds_read_b64 v[54:55], v57 offset:49152
    s_mov_b64 exec, -1
    v_mov_b32 v58, 0
    v_mov_b32 v59, 0
    s_waitcnt lgkmcnt(0)
    v_max3_i32 v58, v28, v29, v58
    v_min3_i32 v59, v28, v29, v59
    v_max3_i32 v58, v30, v31, v58
    v_min3_i32 v59, v30, v31, v59
    v_max3_i32 v58, v32, v33, v58
    v_min3_i32 v59, v32, v33, v59
    v_max3_i32 v58, v34, v35, v58
    v_min3_i32 v59, v34, v35, v59
    v_max3_i32 v58, v36, v37, v58
    v_min3_i32 v59, v36, v37, v59
    v_max3_i32 v58, v38, v39, v58
    v_min3_i32 v59, v38, v39, v59
    v_max3_i32 v58, v40, v41, v58
    v_min3_i32 v59, v40, v41, v59
    v_max3_i32 v58, v42, v43, v58
    v_min3_i32 v59, v42, v43, v59
    v_max3_i32 v58, v44, v45, v58
    v_min3_i32 v59, v44, v45, v59
    v_max3_i32 v58, v46, v47, v58
    v_min3_i32 v59, v46, v47, v59
    v_max3_i32 v58, v48, v49, v58
    v_min3_i32 v59, v48, v49, v59
    v_max3_i32 v58, v50, v51, v58
    v_min3_i32 v59, v50, v51, v59
    v_max3_i32 v58, v52, v53, v58
    v_min3_i32 v59, v52, v53, v59
    v_max3_i32 v58, v54, v55, v58
    v_min3_i32 v59, v54, v55, v59
    v_not_b32 v59, v59
    v_max_i32 v58, v58, v59
    v_cmp_lt_i32 vcc, s47, v58
    v_mov_b32 v60, 161460
    v_mov_b32 v61, 1
    s_cbranch_vccz L_nf_166
    ds_write_b32 v60, v61
L_nf_166:
    s_waitcnt lgkmcnt(0)
    s_barrier
    ds_read_b32 v61, v60
    s_waitcnt lgkmcnt(0)
    v_readfirstlane_b32 s61, v61
    s_nop 1
    s_cmp_eq_u32 s61, 0
    s_cbranch_scc1 L_ok_165
    s_barrier
    v_mov_b32 v61, 0
    ds_write_b32 v60, v61

    s_mov_b32 s60, 0
    v_lshlrev_b32 v40, 3, v0
    v_lshlrev_b32 v41, 4, v0
    v_mov_b32 v42, v0
L_fl_167:
    v_cmp_gt_u32 vcc, 6250, v42
    v_add_u32 v43, 50008, v40
    v_mov_b32 v36, 0
    v_mov_b32 v37, 0
    v_mov_b32 v38, 0
    v_mov_b32 v39, 0
    s_cmp_eq_u32 s46, 0
    s_cbranch_scc1 L_nold_168
    buffer_load_dwordx4 v[36:39], v41, s[24:27], 0 offen sc1
    s_waitcnt vmcnt(0)
L_nold_168:
    s_mov_b64 exec, vcc
    ds_read_b64 v[28:29], v40 offset:61448
    ds_read_b64 v[30:31], v43 offset:61448
    s_mov_b64 exec, -1
    s_waitcnt lgkmcnt(0)
    v_ashrrev_i32 v32, 31, v28
    v_ashrrev_i32 v33, 31, v30
    v_sub_u32 v29, v29, v32
    v_sub_u32 v31, v31, v33
    v_cvt_f32_i32 v28, v28
    v_cvt_f32_i32 v29, v29
    v_cvt_f32_i32 v30, v30
    v_cvt_f32_i32 v31, v31
    v_fma_f32 v32, v28, s39, v36
    v_fma_f32 v33, v29, s39, v37
    v_fma_f32 v34, v30, s39, v38
    v_fma_f32 v35, v31, s39, v39
    buffer_store_dwordx4 v[32:35], v41, s[24:27], 0 offen
    v_add_u32 v40, 8192, v40
    v_add_u32 v41, 16384, v41
    v_add_u32 v42, 1024, v42
    s_add_u32 s60, s60, 1
    s_cmp_lt_u32 s60, 7
    s_cbranch_scc1 L_fl_167

    s_waitcnt vmcnt(0)
    s_barrier
    s_mov_b32 s46, 1
    v_mov_b32 v28, 0
    v_mov_b32 v29, 0
    v_mov_b32 v30, 0
    v_mov_b32 v31, 0
    v_add_u32 v32, 61440, v3
    v_add_u32 v33, 65536, v32

    ds_write_b128 v32, v[28:31] offset:0
    ds_write_b128 v32, v[28:31] offset:16384
    ds_write_b128 v32, v[28:31] offset:32768
    ds_write_b128 v32, v[28:31] offset:49152
    ds_write_b128 v33, v[28:31] offset:0
    ds_write_b128 v33, v[28:31] offset:16384
    v_cmp_gt_u32 vcc, 107, v0
    s_mov_b64 exec, vcc
    ds_write_b128 v33, v[28:31] offset:32768
    s_mov_b64 exec, -1
    s_waitcnt lgkmcnt(0)
    s_barrier
L_ok_165:
L_ovf_162:
    v_lshlrev_b32 v13, 3, v2
    buffer_load_dwordx2 v[14:15], v13, s[16:19], 0 offen
    s_waitcnt vmcnt(0)
    v_bfe_u32 v18, v15, 18, 7
    v_lshrrev_b32 v19, 25, v15
    v_lshrrev_b32 v13, 16, v14
    v_mad_u32_u24 v13, v19, s54, v13
    v_lshlrev_b32 v13, 3, v13
    buffer_load_dwordx2 v[16:17], v13, s[8:11], 0 offen
    v_subrev_u32 v19, s45, v19
    v_cmp_gt_u32 vcc, s44, v2
    v_cmp_eq_u32 s[72:73], s40, v18
    s_and_b64 vcc, vcc, s[72:73]
    v_cmp_gt_u32 s[72:73], 8, v19
    s_and_b64 vcc, vcc, s[72:73]
    s_waitcnt vmcnt(0)
    s_mov_b64 exec, vcc

    v_perm_b32 v116, v14, v15, s28
    v_and_b32 v14, 0xfff8, v14
    v_lshlrev_b32 v114, 16, v16
    v_and_or_b32 v116, v116, s36, v1
    v_and_b32 v115, s38, v16
    v_lshlrev_b32 v16, 16, v17
    v_subrev_f32 v116, s37, v116
    v_and_b32 v17, s38, v17
    v_add_u32 v117, 50008, v14
    v_pk_fma_f32 v[114:115], v[114:115], v[116:117], s[32:33] op_sel_hi:[1,0,1]
    v_pk_fma_f32 v[16:17], v[16:17], v[116:117], s[32:33] op_sel_hi:[1,0,1]
    v_lshl_add_u64 v[114:115], v[114:115], 0, s[34:35]
    v_lshl_add_u64 v[16:17], v[16:17], 0, s[34:35]
    ds_add_u64 v14, v[114:115] offset:61440
    ds_add_u64 v117, v[16:17] offset:61440

    s_mov_b64 exec, -1
    v_add_u32 v2, 1024, v2
    s_add_u32 s42, s42, 1024
    s_cmp_ge_u32 s42, s44
    s_cbranch_scc1 L_ovfq_169
    s_and_b32 s60, s42, 0x7fff
    s_cbranch_scc1 L_ovf_162
    s_waitcnt lgkmcnt(0)
    s_barrier
    s_branch L_ovfc_164
L_ovfq_169:
    s_waitcnt lgkmcnt(0)
    s_barrier
L_ovfend_163:

    s_mov_b32 s60, 0
    v_lshlrev_b32 v40, 3, v0
    v_lshlrev_b32 v41, 4, v0
    v_mov_b32 v42, v0
L_fl_170:
    v_cmp_gt_u32 vcc, 6250, v42
    v_add_u32 v43, 50008, v40
    v_mov_b32 v36, 0
    v_mov_b32 v37, 0
    v_mov_b32 v38, 0
    v_mov_b32 v39, 0
    s_cmp_eq_u32 s46, 0
    s_cbranch_scc1 L_nold_171
    buffer_load_dwordx4 v[36:39], v41, s[24:27], 0 offen sc1
    s_waitcnt vmcnt(0)
L_nold_171:
    s_mov_b64 exec, vcc
    ds_read_b64 v[28:29], v40 offset:61448
    ds_read_b64 v[30:31], v43 offset:61448
    s_mov_b64 exec, -1
    s_waitcnt lgkmcnt(0)
    v_ashrrev_i32 v32, 31, v28
    v_ashrrev_i32 v33, 31, v30
    v_sub_u32 v29, v29, v32
    v_sub_u32 v31, v31, v33
    v_cvt_f32_i32 v28, v28
    v_cvt_f32_i32 v29, v29
    v_cvt_f32_i32 v30, v30
    v_cvt_f32_i32 v31, v31
    v_fma_f32 v32, v28, s39, v36
    v_fma_f32 v33, v29, s39, v37
    v_fma_f32 v34, v30, s39, v38
    v_fma_f32 v35, v31, s39, v39
    buffer_store_dwordx4 v[32:35], v41, s[24:27], 0 offen
    v_add_u32 v40, 8192, v40
    v_add_u32 v41, 16384, v41
    v_add_u32 v42, 1024, v42
    s_add_u32 s60, s60, 1
    s_cmp_lt_u32 s60, 7
    s_cbranch_scc1 L_fl_170

L_p2done_130:
    s_endpgm

L_ufix_133:
    v_and_b32 v126, 63, v0
    v_lshlrev_b32 v126, 2, v126
    s_sub_i32 s62, s71, 0
    v_cmp_gt_i32 vcc, s62, v126
    s_nop 1
    v_cndmask_b32 v4, 0, v4, vcc
    s_sub_i32 s62, s71, 1
    v_cmp_gt_i32 vcc, s62, v126
    s_nop 1
    v_cndmask_b32 v5, 0, v5, vcc
    s_sub_i32 s62, s71, 2
    v_cmp_gt_i32 vcc, s62, v126
    s_nop 1
    v_cndmask_b32 v6, 0, v6, vcc
    s_sub_i32 s62, s71, 3
    v_cmp_gt_i32 vcc, s62, v126
    s_nop 1
    v_cndmask_b32 v7, 0, v7, vcc
    s_branch L_uback_134
L_ufix_135:
    v_and_b32 v126, 63, v0
    v_lshlrev_b32 v126, 2, v126
    s_sub_i32 s62, s71, 512
    v_cmp_gt_i32 vcc, s62, v126
    s_nop 1
    v_cndmask_b32 v8, 0, v8, vcc
    s_sub_i32 s62, s71, 513
    v_cmp_gt_i32 vcc, s62, v126
    s_nop 1
    v_cndmask_b32 v9, 0, v9, vcc
    s_sub_i32 s62, s71, 514
    v_cmp_gt_i32 vcc, s62, v126
    s_nop 1
    v_cndmask_b32 v10, 0, v10, vcc
    s_sub_i32 s62, s71, 515
    v_cmp_gt_i32 vcc, s62, v126
    s_nop 1
    v_cndmask_b32 v11, 0, v11, vcc
    s_branch L_uback_136
L_ufix_137:
    v_and_b32 v126, 63, v0
    v_lshlrev_b32 v126, 2, v126
    s_sub_i32 s62, s71, 1024
    v_cmp_gt_i32 vcc, s62, v126
    s_nop 1
    v_cndmask_b32 v12, 0, v12, vcc
    s_sub_i32 s62, s71, 1025
    v_cmp_gt_i32 vcc, s62, v126
    s_nop 1
    v_cndmask_b32 v13, 0, v13, vcc
    s_sub_i32 s62, s71, 1026
    v_cmp_gt_i32 vcc, s62, v126
    s_nop 1
    v_cndmask_b32 v14, 0, v14, vcc
    s_sub_i32 s62, s71, 1027
    v_cmp_gt_i32 vcc, s62, v126
    s_nop 1
    v_cndmask_b32 v15, 0, v15, vcc
    s_branch L_uback_138
L_ufix_139:
    v_and_b32 v126, 63, v0
    v_lshlrev_b32 v126, 2, v126
    s_sub_i32 s62, s71, 1536
    v_cmp_gt_i32 vcc, s62, v126
    s_nop 1
    v_cndmask_b32 v16, 0, v16, vcc
    s_sub_i32 s62, s71, 1537
    v_cmp_gt_i32 vcc, s62, v126
    s_nop 1
    v_cndmask_b32 v17, 0, v17, vcc
    s_sub_i32 s62, s71, 1538
    v_cmp_gt_i32 vcc, s62, v126
    s_nop 1
    v_cndmask_b32 v18, 0, v18, vcc
    s_sub_i32 s62, s71, 1539
    v_cmp_gt_i32 vcc, s62, v126
    s_nop 1
    v_cndmask_b32 v19, 0, v19, vcc
    s_branch L_uback_140
L_ufix_141:
    v_and_b32 v126, 63, v0
    v_lshlrev_b32 v126, 2, v126
    s_sub_i32 s62, s71, 2048
    v_cmp_gt_i32 vcc, s62, v126
    s_nop 1
    v_cndmask_b32 v20, 0, v20, vcc
    s_sub_i32 s62, s71, 2049
    v_cmp_gt_i32 vcc, s62, v126
    s_nop 1
    v_cndmask_b32 v21, 0, v21, vcc
    s_sub_i32 s62, s71, 2050
    v_cmp_gt_i32 vcc, s62, v126
    s_nop 1
    v_cndmask_b32 v22, 0, v22, vcc
    s_sub_i32 s62, s71, 2051
    v_cmp_gt_i32 vcc, s62, v126
    s_nop 1
    v_cndmask_b32 v23, 0, v23, vcc
    s_branch L_uback_142
L_ufix_143:
    v_and_b32 v126, 63, v0
    v_lshlrev_b32 v126, 2, v126
    s_sub_i32 s62, s71, 2560
    v_cmp_gt_i32 vcc, s62, v126
    s_nop 1
    v_cndmask_b32 v24, 0, v24, vcc
    s_sub_i32 s62, s71, 2561
    v_cmp_gt_i32 vcc, s62, v126
    s_nop 1
    v_cndmask_b32 v25, 0, v25, vcc
    s_sub_i32 s62, s71, 2562
    v_cmp_gt_i32 vcc, s62, v126
    s_nop 1
    v_cndmask_b32 v26, 0, v26, vcc
    s_sub_i32 s62, s71, 2563
    v_cmp_gt_i32 vcc, s62, v126
    s_nop 1
    v_cndmask_b32 v27, 0, v27, vcc
    s_branch L_uback_144
L_ufix_148:
    v_and_b32 v126, 63, v0
    v_lshlrev_b32 v126, 2, v126
    s_sub_i32 s62, s71, 3072
    v_cmp_gt_i32 vcc, s62, v126
    s_nop 1
    v_cndmask_b32 v100, 0, v100, vcc
    s_sub_i32 s62, s71, 3073
    v_cmp_gt_i32 vcc, s62, v126
    s_nop 1
    v_cndmask_b32 v101, 0, v101, vcc
    s_sub_i32 s62, s71, 3074
    v_cmp_gt_i32 vcc, s62, v126
    s_nop 1
    v_cndmask_b32 v102, 0, v102, vcc
    s_sub_i32 s62, s71, 3075
    v_cmp_gt_i32 vcc, s62, v126
    s_nop 1
    v_cndmask_b32 v103, 0, v103, vcc
    s_branch L_uback_149
.globl standalone__molecular_angular_gemnet__graph_kernel
.p2align 8
.type standalone__molecular_angular_gemnet__graph_kernel,@function
standalone__molecular_angular_gemnet__graph_kernel:
    s_cmp_ge_u32 s2, 3125
    s_cbranch_scc1 L_fdone_172
    s_load_dwordx2 s[4:5], s[0:1], 0
    s_load_dwordx2 s[6:7], s[0:1], 24
    s_load_dwordx2 s[8:9], s[0:1], 40
    s_load_dwordx8 s[12:19], s[0:1], 56
    s_load_dwordx2 s[10:11], s[0:1], 88
    s_load_dwordx2 s[20:21], s[0:1], 104
    s_lshl_b32 s3, s2, 8
    v_add_u32 v0, s3, v0
    v_lshlrev_b32 v1, 4, v0
    v_lshlrev_b32 v2, 3, v0
    v_lshlrev_b32 v3, 1, v0
    s_waitcnt lgkmcnt(0)
    s_load_dwordx4 s[40:43], s[8:9], 0
    s_load_dwordx16 s[44:59], s[12:13], 0
    s_load_dwordx16 s[60:75], s[14:15], 0
    s_load_dwordx8 s[76:83], s[16:17], 0
    s_load_dwordx8 s[84:91], s[18:19], 0

    s_add_u32 s24, s20, 1048576
    s_addc_u32 s25, s21, 0
    s_mov_b32 s26, 25600000
    s_mov_b32 s27, 0x20000
    s_mov_b32 s28, s4
    s_mov_b32 s29, s5
    s_mov_b32 s30, 6400000
    s_mov_b32 s31, 0x20000
    s_mov_b32 s32, s6
    s_mov_b32 s33, s7
    s_mov_b32 s34, 1600000
    s_mov_b32 s35, 0x20000
    s_mov_b32 s36, s10
    s_mov_b32 s37, s11
    s_mov_b32 s38, 6400000
    s_mov_b32 s39, 0x20000
    s_mov_b32 s3, 12800000
    buffer_load_ushort v4, v3, s[32:35], 0 offen
    buffer_load_dwordx4 v[8:11], v1, s[24:27], 0 offen
    buffer_load_dwordx4 v[12:15], v1, s[24:27], s3 offen
    buffer_load_dwordx2 v[6:7], v2, s[28:31], 0 offen
    s_mov_b32 s94, 0xffff0000
    s_mov_b32 s95, 0xc1200000
    s_mov_b32 s96, 0x3fb8aa3b
    s_waitcnt vmcnt(3) lgkmcnt(0)
    v_lshlrev_b32 v4, 16, v4

    s_lshl_b32 s92, s40, 16
    v_subrev_f32 v16, s92, v4
    s_and_b32 s93, s40, s94
    v_subrev_f32 v17, s93, v4
    s_lshl_b32 s92, s41, 16
    v_subrev_f32 v18, s92, v4
    s_and_b32 s93, s41, s94
    v_subrev_f32 v19, s93, v4
    s_lshl_b32 s92, s42, 16
    v_subrev_f32 v20, s92, v4
    s_and_b32 s93, s42, s94
    v_subrev_f32 v21, s93, v4
    s_lshl_b32 s92, s43, 16
    v_subrev_f32 v22, s92, v4
    s_and_b32 s93, s43, s94
    v_subrev_f32 v23, s93, v4
    v_cvt_pk_bf16_f32 v16, v16, v17
    v_and_b32 v17, s94, v16
    v_lshlrev_b32 v16, 16, v16
    v_cvt_pk_bf16_f32 v18, v18, v19
    v_and_b32 v19, s94, v18
    v_lshlrev_b32 v18, 16, v18
    v_cvt_pk_bf16_f32 v20, v20, v21
    v_and_b32 v21, s94, v20
    v_lshlrev_b32 v20, 16, v20
    v_cvt_pk_bf16_f32 v22, v22, v23
    v_and_b32 v23, s94, v22
    v_lshlrev_b32 v22, 16, v22
    v_mul_f32 v16, v16, v16
    v_mul_f32 v17, v17, v17
    v_mul_f32 v18, v18, v18
    v_mul_f32 v19, v19, v19
    v_mul_f32 v20, v20, v20
    v_mul_f32 v21, v21, v21
    v_mul_f32 v22, v22, v22
    v_mul_f32 v23, v23, v23
    v_cvt_pk_bf16_f32 v16, v16, v17
    v_and_b32 v17, s94, v16
    v_lshlrev_b32 v16, 16, v16
    v_cvt_pk_bf16_f32 v18, v18, v19
    v_and_b32 v19, s94, v18
    v_lshlrev_b32 v18, 16, v18
    v_cvt_pk_bf16_f32 v20, v20, v21
    v_and_b32 v21, s94, v20
    v_lshlrev_b32 v20, 16, v20
    v_cvt_pk_bf16_f32 v22, v22, v23
    v_and_b32 v23, s94, v22
    v_lshlrev_b32 v22, 16, v22
    v_mul_f32 v16, s95, v16
    v_mul_f32 v17, s95, v17
    v_mul_f32 v18, s95, v18
    v_mul_f32 v19, s95, v19
    v_mul_f32 v20, s95, v20
    v_mul_f32 v21, s95, v21
    v_mul_f32 v22, s95, v22
    v_mul_f32 v23, s95, v23
    v_cvt_pk_bf16_f32 v16, v16, v17
    v_and_b32 v17, s94, v16
    v_lshlrev_b32 v16, 16, v16
    v_cvt_pk_bf16_f32 v18, v18, v19
    v_and_b32 v19, s94, v18
    v_lshlrev_b32 v18, 16, v18
    v_cvt_pk_bf16_f32 v20, v20, v21
    v_and_b32 v21, s94, v20
    v_lshlrev_b32 v20, 16, v20
    v_cvt_pk_bf16_f32 v22, v22, v23
    v_and_b32 v23, s94, v22
    v_lshlrev_b32 v22, 16, v22
    v_mul_f32 v16, s96, v16
    v_mul_f32 v17, s96, v17
    v_mul_f32 v18, s96, v18
    v_mul_f32 v19, s96, v19
    v_mul_f32 v20, s96, v20
    v_mul_f32 v21, s96, v21
    v_mul_f32 v22, s96, v22
    v_mul_f32 v23, s96, v23
    v_exp_f32 v16, v16
    v_exp_f32 v17, v17
    v_exp_f32 v18, v18
    v_exp_f32 v19, v19
    v_exp_f32 v20, v20
    v_exp_f32 v21, v21
    v_exp_f32 v22, v22
    v_exp_f32 v23, v23
    s_nop 0
    v_cvt_pk_bf16_f32 v16, v16, v17
    v_and_b32 v17, s94, v16
    v_lshlrev_b32 v16, 16, v16
    v_cvt_pk_bf16_f32 v18, v18, v19
    v_and_b32 v19, s94, v18
    v_lshlrev_b32 v18, 16, v18
    v_cvt_pk_bf16_f32 v20, v20, v21
    v_and_b32 v21, s94, v20
    v_lshlrev_b32 v20, 16, v20
    v_cvt_pk_bf16_f32 v22, v22, v23
    v_and_b32 v23, s94, v22
    v_lshlrev_b32 v22, 16, v22
    s_lshl_b32 s92, s60, 16
    v_mul_f32 v24, s92, v16
    s_and_b32 s93, s60, s94
    v_mul_f32 v25, s93, v16
    s_lshl_b32 s92, s61, 16
    v_mul_f32 v26, s92, v16
    s_and_b32 s93, s61, s94
    v_mul_f32 v27, s93, v16
    s_lshl_b32 s92, s62, 16
    v_fmac_f32 v24, s92, v17
    s_and_b32 s93, s62, s94
    v_fmac_f32 v25, s93, v17
    s_lshl_b32 s92, s63, 16
    v_fmac_f32 v26, s92, v17
    s_and_b32 s93, s63, s94
    v_fmac_f32 v27, s93, v17
    s_lshl_b32 s92, s64, 16
    v_fmac_f32 v24, s92, v18
    s_and_b32 s93, s64, s94
    v_fmac_f32 v25, s93, v18
    s_lshl_b32 s92, s65, 16
    v_fmac_f32 v26, s92, v18
    s_and_b32 s93, s65, s94
    v_fmac_f32 v27, s93, v18
    s_lshl_b32 s92, s66, 16
    v_fmac_f32 v24, s92, v19
    s_and_b32 s93, s66, s94
    v_fmac_f32 v25, s93, v19
    s_lshl_b32 s92, s67, 16
    v_fmac_f32 v26, s92, v19
    s_and_b32 s93, s67, s94
    v_fmac_f32 v27, s93, v19
    s_lshl_b32 s92, s68, 16
    v_fmac_f32 v24, s92, v20
    s_and_b32 s93, s68, s94
    v_fmac_f32 v25, s93, v20
    s_lshl_b32 s92, s69, 16
    v_fmac_f32 v26, s92, v20
    s_and_b32 s93, s69, s94
    v_fmac_f32 v27, s93, v20
    s_lshl_b32 s92, s70, 16
    v_fmac_f32 v24, s92, v21
    s_and_b32 s93, s70, s94
    v_fmac_f32 v25, s93, v21
    s_lshl_b32 s92, s71, 16
    v_fmac_f32 v26, s92, v21
    s_and_b32 s93, s71, s94
    v_fmac_f32 v27, s93, v21
    s_lshl_b32 s92, s72, 16
    v_fmac_f32 v24, s92, v22
    s_and_b32 s93, s72, s94
    v_fmac_f32 v25, s93, v22
    s_lshl_b32 s92, s73, 16
    v_fmac_f32 v26, s92, v22
    s_and_b32 s93, s73, s94
    v_fmac_f32 v27, s93, v22
    s_lshl_b32 s92, s74, 16
    v_fmac_f32 v24, s92, v23
    s_and_b32 s93, s74, s94
    v_fmac_f32 v25, s93, v23
    s_lshl_b32 s92, s75, 16
    v_fmac_f32 v26, s92, v23
    s_and_b32 s93, s75, s94
    v_fmac_f32 v27, s93, v23
    s_lshl_b32 s92, s44, 16
    v_mul_f32 v28, s92, v16
    s_and_b32 s93, s44, s94
    v_mul_f32 v29, s93, v16
    s_lshl_b32 s92, s45, 16
    v_mul_f32 v30, s92, v16
    s_and_b32 s93, s45, s94
    v_mul_f32 v31, s93, v16
    s_lshl_b32 s92, s46, 16
    v_fmac_f32 v28, s92, v17
    s_and_b32 s93, s46, s94
    v_fmac_f32 v29, s93, v17
    s_lshl_b32 s92, s47, 16
    v_fmac_f32 v30, s92, v17
    s_and_b32 s93, s47, s94
    v_fmac_f32 v31, s93, v17
    s_lshl_b32 s92, s48, 16
    v_fmac_f32 v28, s92, v18
    s_and_b32 s93, s48, s94
    v_fmac_f32 v29, s93, v18
    s_lshl_b32 s92, s49, 16
    v_fmac_f32 v30, s92, v18
    s_and_b32 s93, s49, s94
    v_fmac_f32 v31, s93, v18
    s_lshl_b32 s92, s50, 16
    v_fmac_f32 v28, s92, v19
    s_and_b32 s93, s50, s94
    v_fmac_f32 v29, s93, v19
    s_lshl_b32 s92, s51, 16
    v_fmac_f32 v30, s92, v19
    s_and_b32 s93, s51, s94
    v_fmac_f32 v31, s93, v19
    s_lshl_b32 s92, s52, 16
    v_fmac_f32 v28, s92, v20
    s_and_b32 s93, s52, s94
    v_fmac_f32 v29, s93, v20
    s_lshl_b32 s92, s53, 16
    v_fmac_f32 v30, s92, v20
    s_and_b32 s93, s53, s94
    v_fmac_f32 v31, s93, v20
    s_lshl_b32 s92, s54, 16
    v_fmac_f32 v28, s92, v21
    s_and_b32 s93, s54, s94
    v_fmac_f32 v29, s93, v21
    s_lshl_b32 s92, s55, 16
    v_fmac_f32 v30, s92, v21
    s_and_b32 s93, s55, s94
    v_fmac_f32 v31, s93, v21
    s_lshl_b32 s92, s56, 16
    v_fmac_f32 v28, s92, v22
    s_and_b32 s93, s56, s94
    v_fmac_f32 v29, s93, v22
    s_lshl_b32 s92, s57, 16
    v_fmac_f32 v30, s92, v22
    s_and_b32 s93, s57, s94
    v_fmac_f32 v31, s93, v22
    s_lshl_b32 s92, s58, 16
    v_fmac_f32 v28, s92, v23
    s_and_b32 s93, s58, s94
    v_fmac_f32 v29, s93, v23
    s_lshl_b32 s92, s59, 16
    v_fmac_f32 v30, s92, v23
    s_and_b32 s93, s59, s94
    v_fmac_f32 v31, s93, v23
    v_cvt_pk_bf16_f32 v28, v28, v29
    v_and_b32 v29, s94, v28
    v_lshlrev_b32 v28, 16, v28
    v_cvt_pk_bf16_f32 v30, v30, v31
    v_and_b32 v31, s94, v30
    v_lshlrev_b32 v30, 16, v30
    s_waitcnt vmcnt(1)
    v_add_f32 v8, v8, v12
    v_add_f32 v9, v9, v13
    v_add_f32 v10, v10, v14
    v_add_f32 v11, v11, v15
    s_lshl_b32 s92, s76, 16
    v_mul_f32 v16, s92, v8
    s_and_b32 s93, s76, s94
    v_mul_f32 v17, s93, v8
    s_lshl_b32 s92, s77, 16
    v_mul_f32 v18, s92, v8
    s_and_b32 s93, s77, s94
    v_mul_f32 v19, s93, v8
    s_lshl_b32 s92, s78, 16
    v_fmac_f32 v16, s92, v9
    s_and_b32 s93, s78, s94
    v_fmac_f32 v17, s93, v9
    s_lshl_b32 s92, s79, 16
    v_fmac_f32 v18, s92, v9
    s_and_b32 s93, s79, s94
    v_fmac_f32 v19, s93, v9
    s_lshl_b32 s92, s80, 16
    v_fmac_f32 v16, s92, v10
    s_and_b32 s93, s80, s94
    v_fmac_f32 v17, s93, v10
    s_lshl_b32 s92, s81, 16
    v_fmac_f32 v18, s92, v10
    s_and_b32 s93, s81, s94
    v_fmac_f32 v19, s93, v10
    s_lshl_b32 s92, s82, 16
    v_fmac_f32 v16, s92, v11
    s_and_b32 s93, s82, s94
    v_fmac_f32 v17, s93, v11
    s_lshl_b32 s92, s83, 16
    v_fmac_f32 v18, s92, v11
    s_and_b32 s93, s83, s94
    v_fmac_f32 v19, s93, v11
    v_mul_f32 v16, v16, v24
    v_mul_f32 v17, v17, v25
    v_mul_f32 v18, v18, v26
    v_mul_f32 v19, v19, v27
    v_cvt_pk_bf16_f32 v16, v16, v17
    v_and_b32 v17, s94, v16
    v_lshlrev_b32 v16, 16, v16
    v_cvt_pk_bf16_f32 v18, v18, v19
    v_and_b32 v19, s94, v18
    v_lshlrev_b32 v18, 16, v18
    s_lshl_b32 s92, s84, 16
    v_mul_f32 v20, s92, v16
    s_and_b32 s93, s84, s94
    v_mul_f32 v21, s93, v16
    s_lshl_b32 s92, s85, 16
    v_mul_f32 v22, s92, v16
    s_and_b32 s93, s85, s94
    v_mul_f32 v23, s93, v16
    s_lshl_b32 s92, s86, 16
    v_fmac_f32 v20, s92, v17
    s_and_b32 s93, s86, s94
    v_fmac_f32 v21, s93, v17
    s_lshl_b32 s92, s87, 16
    v_fmac_f32 v22, s92, v17
    s_and_b32 s93, s87, s94
    v_fmac_f32 v23, s93, v17
    s_lshl_b32 s92, s88, 16
    v_fmac_f32 v20, s92, v18
    s_and_b32 s93, s88, s94
    v_fmac_f32 v21, s93, v18
    s_lshl_b32 s92, s89, 16
    v_fmac_f32 v22, s92, v18
    s_and_b32 s93, s89, s94
    v_fmac_f32 v23, s93, v18
    s_lshl_b32 s92, s90, 16
    v_fmac_f32 v20, s92, v19
    s_and_b32 s93, s90, s94
    v_fmac_f32 v21, s93, v19
    s_lshl_b32 s92, s91, 16
    v_fmac_f32 v22, s92, v19
    s_and_b32 s93, s91, s94
    v_fmac_f32 v23, s93, v19
    v_cvt_pk_bf16_f32 v20, v20, v21
    v_and_b32 v21, s94, v20
    v_lshlrev_b32 v20, 16, v20
    v_cvt_pk_bf16_f32 v22, v22, v23
    v_and_b32 v23, s94, v22
    v_lshlrev_b32 v22, 16, v22
    v_mul_f32 v20, v20, v28
    v_mul_f32 v21, v21, v29
    v_mul_f32 v22, v22, v30
    v_mul_f32 v23, v23, v31
    v_cvt_pk_bf16_f32 v20, v20, v21
    v_and_b32 v21, s94, v20
    v_lshlrev_b32 v20, 16, v20
    v_cvt_pk_bf16_f32 v22, v22, v23
    v_and_b32 v23, s94, v22
    v_lshlrev_b32 v22, 16, v22
    s_waitcnt vmcnt(0)
    v_lshlrev_b32 v8, 16, v6
    v_and_b32 v9, s94, v6
    v_lshlrev_b32 v10, 16, v7
    v_and_b32 v11, s94, v7

    v_add_f32 v8, v8, v20
    v_add_f32 v9, v9, v21
    v_add_f32 v10, v10, v22
    v_add_f32 v11, v11, v23
    v_cvt_pk_bf16_f32 v12, v8, v9
    v_cvt_pk_bf16_f32 v13, v10, v11
    buffer_store_dwordx2 v[12:13], v2, s[36:39], 0 offen
L_fdone_172:
    s_endpgm

.section .rodata,"a"
.p2align 6
.amdhsa_kernel g0_kernel
  .amdhsa_next_free_vgpr 40
  .amdhsa_next_free_sgpr 32
  .amdhsa_accum_offset 40
  .amdhsa_group_segment_fixed_size 0
  .amdhsa_kernarg_size 112
  .amdhsa_user_sgpr_count 2
  .amdhsa_user_sgpr_kernarg_segment_ptr 1
  .amdhsa_system_sgpr_workgroup_id_x 1
.end_amdhsa_kernel
.p2align 6
.amdhsa_kernel g1_kernel
  .amdhsa_next_free_vgpr 128
  .amdhsa_next_free_sgpr 102
  .amdhsa_accum_offset 128
  .amdhsa_group_segment_fixed_size 0
  .amdhsa_kernarg_size 112
  .amdhsa_user_sgpr_count 2
  .amdhsa_user_sgpr_kernarg_segment_ptr 1
  .amdhsa_system_sgpr_workgroup_id_x 1
.end_amdhsa_kernel
.p2align 6
.amdhsa_kernel g2_kernel
  .amdhsa_next_free_vgpr 128
  .amdhsa_next_free_sgpr 102
  .amdhsa_accum_offset 128
  .amdhsa_group_segment_fixed_size 0
  .amdhsa_kernarg_size 112
  .amdhsa_user_sgpr_count 2
  .amdhsa_user_sgpr_kernarg_segment_ptr 1
  .amdhsa_system_sgpr_workgroup_id_x 1
.end_amdhsa_kernel
.p2align 6
.amdhsa_kernel standalone__molecular_angular_gemnet__graph_kernel
  .amdhsa_next_free_vgpr 32
  .amdhsa_next_free_sgpr 100
  .amdhsa_accum_offset 32
  .amdhsa_group_segment_fixed_size 0
  .amdhsa_kernarg_size 112
  .amdhsa_user_sgpr_count 2
  .amdhsa_user_sgpr_kernarg_segment_ptr 1
  .amdhsa_system_sgpr_workgroup_id_x 1
  .amdhsa_float_denorm_mode_32 3
.end_amdhsa_kernel
```

```asm
; @launch kernel=g0_kernel grid=(256,1,1) block=(256,1,1) lds=0
; @launch kernel=g1_kernel grid=(256,1,1) block=(1024,1,1) lds=163840
; @launch kernel=g2_kernel grid=(256,1,1) block=(1024,1,1) lds=150080
; @launch kernel=standalone__molecular_angular_gemnet__graph_kernel grid=(3200,1,1) block=(256,1,1) lds=0
.amdgcn_target "amdgcn-amd-amdhsa--gfx950"
.text
.globl g0_kernel
.p2align 8
.type g0_kernel,@function
g0_kernel:
    s_cmp_ge_u32 s2, 256
    s_cbranch_scc1 L_k0done_1
    s_load_dwordx2 s[4:5], s[0:1], 0
    s_load_dwordx2 s[6:7], s[0:1], 104
    s_mul_i32 s3, s2, 25000
    v_lshlrev_b32 v1, 4, v0
    s_waitcnt lgkmcnt(0)

    s_add_u32 s8, s4, s3
    s_addc_u32 s9, s5, 0
    s_mov_b32 s10, 25000
    s_mov_b32 s11, 0x20000
    s_mov_b32 s12, s6
    s_mov_b32 s13, s7
    s_mov_b32 s14, 131328
    s_mov_b32 s15, 0x20000
    s_add_u32 s16, s6, 135168
    s_addc_u32 s17, s7, 0
    s_mov_b32 s18, 8192
    s_mov_b32 s19, 0x20000
    s_movk_i32 s20, 0
    buffer_load_dwordx4 v[4:7], v1, s[8:11], s20 offen
    s_movk_i32 s20, 4096
    buffer_load_dwordx4 v[8:11], v1, s[8:11], s20 offen
    s_movk_i32 s20, 8192
    buffer_load_dwordx4 v[12:15], v1, s[8:11], s20 offen
    s_movk_i32 s20, 12288
    buffer_load_dwordx4 v[16:19], v1, s[8:11], s20 offen
    s_movk_i32 s20, 16384
    buffer_load_dwordx4 v[20:23], v1, s[8:11], s20 offen
    s_movk_i32 s20, 20480
    buffer_load_dwordx4 v[24:27], v1, s[8:11], s20 offen
    s_movk_i32 s20, 24576
    buffer_load_dwordx4 v[28:31], v1, s[8:11], s20 offen
    s_lshl_b32 s21, s2, 12
    v_add_u32 v2, s21, v1
    v_mov_b32 v32, 0
    v_mov_b32 v33, 0
    v_mov_b32 v34, 0
    v_mov_b32 v35, 0
    buffer_store_dwordx4 v[32:35], v2, s[12:15], 0 offen
    s_mov_b32 s22, 0x7fff7fff
    s_waitcnt vmcnt(1)

    v_and_b32 v4, s22, v4
    v_and_b32 v5, s22, v5
    v_and_b32 v6, s22, v6
    v_and_b32 v7, s22, v7
    v_and_b32 v8, s22, v8
    v_and_b32 v9, s22, v9
    v_and_b32 v10, s22, v10
    v_and_b32 v11, s22, v11
    v_and_b32 v12, s22, v12
    v_and_b32 v13, s22, v13
    v_and_b32 v14, s22, v14
    v_and_b32 v15, s22, v15
    v_and_b32 v16, s22, v16
    v_and_b32 v17, s22, v17
    v_and_b32 v18, s22, v18
    v_and_b32 v19, s22, v19
    v_and_b32 v20, s22, v20
    v_and_b32 v21, s22, v21
    v_and_b32 v22, s22, v22
    v_and_b32 v23, s22, v23
    v_and_b32 v24, s22, v24
    v_and_b32 v25, s22, v25
    v_and_b32 v26, s22, v26
    v_and_b32 v27, s22, v27
    v_and_b32 v28, s22, v28
    v_and_b32 v29, s22, v29
    v_and_b32 v30, s22, v30
    v_and_b32 v31, s22, v31
    v_mov_b32 v37, 0
    v_dot2_f32_bf16 v37, v4, v4, v37
    v_dot2_f32_bf16 v37, v5, v5, v37
    v_dot2_f32_bf16 v37, v6, v6, v37
    v_dot2_f32_bf16 v37, v7, v7, v37
    v_dot2_f32_bf16 v37, v8, v8, v37
    v_dot2_f32_bf16 v37, v9, v9, v37
    v_dot2_f32_bf16 v37, v10, v10, v37
    v_dot2_f32_bf16 v37, v11, v11, v37
    v_dot2_f32_bf16 v37, v12, v12, v37
    v_dot2_f32_bf16 v37, v13, v13, v37
    v_dot2_f32_bf16 v37, v14, v14, v37
    v_dot2_f32_bf16 v37, v15, v15, v37
    v_dot2_f32_bf16 v37, v16, v16, v37
    v_dot2_f32_bf16 v37, v17, v17, v37
    v_dot2_f32_bf16 v37, v18, v18, v37
    v_dot2_f32_bf16 v37, v19, v19, v37
    v_dot2_f32_bf16 v37, v20, v20, v37
    v_dot2_f32_bf16 v37, v21, v21, v37
    v_dot2_f32_bf16 v37, v22, v22, v37
    v_dot2_f32_bf16 v37, v23, v23, v37
    v_dot2_f32_bf16 v37, v24, v24, v37
    v_dot2_f32_bf16 v37, v25, v25, v37
    v_dot2_f32_bf16 v37, v26, v26, v37
    v_dot2_f32_bf16 v37, v27, v27, v37
    v_dot2_f32_bf16 v37, v28, v28, v37
    v_dot2_f32_bf16 v37, v29, v29, v37
    v_dot2_f32_bf16 v37, v30, v30, v37
    v_dot2_f32_bf16 v37, v31, v31, v37
    v_pk_max_u16 v4, v4, v5
    v_pk_max_u16 v4, v4, v6
    v_pk_max_u16 v4, v4, v7
    v_pk_max_u16 v4, v4, v8
    v_pk_max_u16 v4, v4, v9
    v_pk_max_u16 v4, v4, v10
    v_pk_max_u16 v4, v4, v11
    v_pk_max_u16 v4, v4, v12
    v_pk_max_u16 v4, v4, v13
    v_pk_max_u16 v4, v4, v14
    v_pk_max_u16 v4, v4, v15
    v_pk_max_u16 v4, v4, v16
    v_pk_max_u16 v4, v4, v17
    v_pk_max_u16 v4, v4, v18
    v_pk_max_u16 v4, v4, v19
    v_pk_max_u16 v4, v4, v20
    v_pk_max_u16 v4, v4, v21
    v_pk_max_u16 v4, v4, v22
    v_pk_max_u16 v4, v4, v23
    v_pk_max_u16 v4, v4, v24
    v_pk_max_u16 v4, v4, v25
    v_pk_max_u16 v4, v4, v26
    v_pk_max_u16 v4, v4, v27
    v_pk_max_u16 v4, v4, v28
    v_pk_max_u16 v4, v4, v29
    v_pk_max_u16 v4, v4, v30
    v_pk_max_u16 v4, v4, v31
    v_lshrrev_b32 v5, 16, v4
    v_and_b32 v4, 0xffff, v4
    v_max_u32 v4, v4, v5

    s_nop 1
    v_max_u32_dpp v4, v4, v4 row_shr:1 row_mask:0xf bank_mask:0xf
    s_nop 1
    v_max_u32_dpp v4, v4, v4 row_shr:2 row_mask:0xf bank_mask:0xf
    s_nop 1
    v_max_u32_dpp v4, v4, v4 row_shr:4 row_mask:0xf bank_mask:0xf
    s_nop 1
    v_max_u32_dpp v4, v4, v4 row_shr:8 row_mask:0xf bank_mask:0xf
    s_nop 1
    v_max_u32_dpp v4, v4, v4 row_bcast:15 row_mask:0xa bank_mask:0xf
    s_nop 1
    v_max_u32_dpp v4, v4, v4 row_bcast:31 row_mask:0xc bank_mask:0xf
    v_mov_b32 v5, v37
    s_nop 1
    v_add_f32_dpp v5, v5, v5 row_shr:1 row_mask:0xf bank_mask:0xf
    s_nop 1
    v_add_f32_dpp v5, v5, v5 row_shr:2 row_mask:0xf bank_mask:0xf
    s_nop 1
    v_add_f32_dpp v5, v5, v5 row_shr:4 row_mask:0xf bank_mask:0xf
    s_nop 1
    v_add_f32_dpp v5, v5, v5 row_shr:8 row_mask:0xf bank_mask:0xf
    s_nop 1
    v_add_f32_dpp v5, v5, v5 row_bcast:15 row_mask:0xa bank_mask:0xf
    s_nop 1
    v_add_f32_dpp v5, v5, v5 row_bcast:31 row_mask:0xc bank_mask:0xf
    v_lshrrev_b32 v6, 6, v0
    s_lshl_b32 s21, s2, 2
    v_add_lshl_u32 v6, v6, s21, 3
    v_and_b32 v7, 63, v0
    v_cmp_eq_u32 vcc, 63, v7
    s_and_saveexec_b64 s[24:25], vcc
    buffer_store_dwordx2 v[4:5], v6, s[16:19], 0 offen
L_k0done_1:
    s_endpgm

.globl g1_kernel
.p2align 8
.type g1_kernel,@function
g1_kernel:
    s_cmp_ge_u32 s2, 256
    s_cbranch_scc1 L_p1done_2
    s_load_dwordx4 s[80:83], s[0:1], 8
    s_load_dwordx2 s[84:85], s[0:1], 32
    s_load_dwordx2 s[86:87], s[0:1], 48
    s_load_dwordx2 s[6:7], s[0:1], 104
    v_lshlrev_b32 v1, 4, v0
    v_lshlrev_b32 v2, 3, v0
    v_lshlrev_b32 v3, 2, v0
    s_mul_i32 s3, s2, 800000
    s_mul_i32 s4, s2, 400000
    s_waitcnt lgkmcnt(0)
    s_load_dword s88, s[86:87], 0

    s_add_u32 s8, s80, s3
    s_addc_u32 s9, s81, 0
    s_mov_b32 s10, 72960
    s_mov_b32 s11, 0x20000
    s_add_u32 s12, s82, s3
    s_addc_u32 s13, s83, 0
    s_mov_b32 s14, 72960
    s_mov_b32 s15, 0x20000
    s_add_u32 s16, s84, s4
    s_addc_u32 s17, s85, 0
    s_mov_b32 s18, 36480
    s_mov_b32 s19, 0x20000
    s_mov_b32 s56, 0
    s_mov_b32 s61, 0
    s_mov_b32 s57, 16384
    s_mov_b32 s62, 8192
    s_mov_b32 s58, 32768
    s_mov_b32 s63, 16384
    s_mov_b32 s59, 49152
    s_mov_b32 s64, 24576
    s_mov_b32 s60, 65536
    s_mov_b32 s65, 32768
    buffer_load_dwordx4 v[22:25], v1, s[12:15], s56 offen nt
    buffer_load_dwordx4 v[4:7], v1, s[8:11], s56 offen nt
    buffer_load_dwordx2 v[40:41], v2, s[16:19], s61 offen nt
    buffer_load_dwordx4 v[26:29], v1, s[12:15], s57 offen nt
    buffer_load_dwordx4 v[8:11], v1, s[8:11], s57 offen nt
    buffer_load_dwordx2 v[42:43], v2, s[16:19], s62 offen nt
    buffer_load_dwordx4 v[30:33], v1, s[12:15], s58 offen nt
    buffer_load_dwordx4 v[12:15], v1, s[8:11], s58 offen nt
    buffer_load_dwordx2 v[44:45], v2, s[16:19], s63 offen nt
    buffer_load_dwordx4 v[34:37], v1, s[12:15], s59 offen nt
    buffer_load_dwordx4 v[16:19], v1, s[8:11], s59 offen nt
    buffer_load_dwordx2 v[46:47], v2, s[16:19], s64 offen nt
    buffer_load_dwordx2 v[38:39], v2, s[12:15], s60 offen nt
    buffer_load_dwordx2 v[20:21], v2, s[8:11], s60 offen nt
    buffer_load_dword v48, v3, s[16:19], s65 offen nt
    s_and_b32 s5, s2, 7
    s_mul_i32 s3, s5, 8192

    s_add_u32 s20, s6, s3
    s_addc_u32 s21, s7, 0
    s_mov_b32 s22, 8192
    s_mov_b32 s23, 0x20000
    s_mul_i32 s3, s5, 40632320
    s_add_u32 s3, s3, 77848576
    s_add_u32 s24, s6, s3
    s_addc_u32 s25, s7, 0
    s_mov_b32 s26, 40632320
    s_mov_b32 s27, 0x20000
    s_add_u32 s28, s6, s3
    s_addc_u32 s29, s7, 0
    s_mov_b32 s30, 40632320
    s_mov_b32 s31, 0x20000
    s_add_u32 s32, s6, 402907136
    s_addc_u32 s33, s7, 0
    s_mov_b32 s34, 409600000
    s_mov_b32 s35, 0x20000
    s_add_u32 s36, s6, 131072
    s_addc_u32 s37, s7, 0
    s_mov_b32 s38, 4
    s_mov_b32 s39, 0x20000
    s_mov_b32 s40, 687195
    s_mov_b32 s42, -6250
    s_mov_b32 s43, 1942
    s_mov_b32 s45, 0x06050400
    s_mov_b32 s46, 0x05040c00
    s_mov_b32 s47, 0x04020100
    s_mov_b32 s48, 3968
    s_mov_b32 s49, 0
    s_mov_b32 s50, 0
    s_mov_b32 s51, 0
    s_mov_b32 s53, 0
    v_mov_b32 v104, 1
    v_mov_b32 v105, 0x447fc000
    v_mul_u32_u24 v49, 5, v0
    v_mov_b32 v106, 0
    v_mov_b32 v107, 0
    v_mov_b32 v108, 0
    v_mov_b32 v109, 0
    v_mov_b32 v110, 0
    v_mov_b32 v111, 0
    v_mov_b32 v113, 16384
    ds_write_b64 v2, v[106:107]
    v_mov_b32 v114, 0
    v_mov_b32 v115, 0
    v_mov_b32 v116, 0
    v_mov_b32 v117, -1
    s_mov_b64 exec, 1
    ds_write_b128 v113, v[114:117]
    s_mov_b64 exec, -1
    s_waitcnt lgkmcnt(0)
    s_lshl_b32 s88, s88, 16
    v_mov_b32 v114, 0.15915494
    v_mul_f32 v114, s88, v114
    s_nop 0
    v_readfirstlane_b32 s44, v114
    s_barrier

    s_mov_b32 s52, s51
    s_sub_u32 s51, 200000, s50
    s_min_u32 s51, s51, 18240
    s_sub_u32 s75, s51, 16384
    s_lshl_b32 s75, s75, 1
    v_cmp_gt_u32 s[66:67], s75, v3

    s_add_u32 s76, s50, 36480
    s_min_u32 s76, s76, 200000
    s_lshl_b32 s10, s76, 2
    s_lshl_b32 s14, s76, 2
    s_lshl_b32 s18, s76, 1

    s_add_u32 s56, s56, 72960
    s_add_u32 s61, s61, 36480
    s_add_u32 s57, s57, 72960
    s_add_u32 s62, s62, 36480
    s_add_u32 s58, s58, 72960
    s_add_u32 s63, s63, 36480
    s_add_u32 s59, s59, 72960
    s_add_u32 s64, s64, 36480
    s_add_u32 s60, s60, 72960
    s_add_u32 s65, s65, 36480
    s_waitcnt vmcnt(12)
    v_mul_hi_u32_u24 v51, s40, v22
    v_mul_hi_u32_u24 v50, s40, v4
    v_mul_hi_u32_u24 v53, s40, v23
    v_mul_hi_u32_u24 v52, s40, v5
    v_mul_hi_u32_u24 v55, s40, v24
    v_mul_hi_u32_u24 v54, s40, v6
    v_mul_hi_u32_u24 v57, s40, v25
    v_mul_hi_u32_u24 v56, s40, v7
    v_and_b32 v51, -2, v51
    v_mad_u32_u24 v4, v50, s43, v4
    v_and_b32 v50, -4, v50
    v_and_b32 v53, -2, v53
    v_mad_u32_u24 v5, v52, s43, v5
    v_and_b32 v52, -4, v52
    v_and_b32 v55, -2, v55
    v_mad_u32_u24 v6, v54, s43, v6
    v_and_b32 v54, -4, v54
    v_and_b32 v57, -2, v57
    v_mad_u32_u24 v7, v56, s43, v7
    v_and_b32 v56, -4, v56
    v_mad_i32_i24 v22, v51, s42, v22
    v_lshl_add_u32 v51, v50, 5, v51
    v_mad_i32_i24 v23, v53, s42, v23
    v_lshl_add_u32 v53, v52, 5, v53
    v_mad_i32_i24 v24, v55, s42, v24
    v_lshl_add_u32 v55, v54, 5, v55
    v_mad_i32_i24 v25, v57, s42, v25
    v_lshl_add_u32 v57, v56, 5, v57
    v_add_u32 v51, v51, v51
    ds_add_rtn_u32 v86, v51, v104
    v_add_u32 v53, v53, v53
    ds_add_rtn_u32 v87, v53, v104
    v_add_u32 v55, v55, v55
    ds_add_rtn_u32 v88, v55, v104
    v_add_u32 v57, v57, v57
    ds_add_rtn_u32 v89, v57, v104
    v_lshlrev_b32 v114, 16, v40
    v_and_b32 v115, 0xffff0000, v40
    v_lshlrev_b32 v116, 16, v41
    v_and_b32 v117, 0xffff0000, v41
    v_mul_f32 v114, s44, v114
    v_mul_f32 v115, s44, v115
    v_mul_f32 v116, s44, v116
    v_mul_f32 v117, s44, v117
    v_fract_f32 v114, v114
    v_fract_f32 v115, v115
    v_fract_f32 v116, v116
    v_fract_f32 v117, v117
    v_cos_f32 v114, v114
    v_cos_f32 v115, v115
    v_cos_f32 v116, v116
    v_cos_f32 v117, v117
    v_lshlrev_b32 v22, 3, v22
    v_lshlrev_b32 v23, 3, v23
    v_lshlrev_b32 v24, 3, v24
    v_lshlrev_b32 v25, 3, v25
    v_lshl_or_b32 v50, v4, 17, v22
    v_lshl_or_b32 v52, v5, 17, v23
    v_lshl_or_b32 v54, v6, 17, v24
    v_lshl_or_b32 v56, v7, 17, v25
    buffer_load_dwordx4 v[22:25], v1, s[12:15], s56 offen nt
    buffer_load_dwordx4 v[4:7], v1, s[8:11], s56 offen nt
    buffer_load_dwordx2 v[40:41], v2, s[16:19], s61 offen nt
    v_fmaak_f32 v114, v114, v105, 0x4b000c00
    v_fmaak_f32 v115, v115, v105, 0x4b000c00
    v_fmaak_f32 v116, v116, v105, 0x4b000c00
    v_fmaak_f32 v117, v117, v105, 0x4b000c00
    v_perm_b32 v51, v51, v114, s46
    v_bfe_u32 v114, v114, 8, 4
    v_perm_b32 v53, v53, v115, s46
    v_bfe_u32 v115, v115, 8, 4
    v_perm_b32 v55, v55, v116, s46
    v_bfe_u32 v116, v116, 8, 4
    v_perm_b32 v57, v57, v117, s46
    v_bfe_u32 v117, v117, 8, 4
    v_add_u32 v50, v50, v114
    v_add_u32 v52, v52, v115
    v_add_u32 v54, v54, v116
    v_add_u32 v56, v56, v117
    s_waitcnt vmcnt(12)
    v_mul_hi_u32_u24 v59, s40, v26
    v_mul_hi_u32_u24 v58, s40, v8
    v_mul_hi_u32_u24 v61, s40, v27
    v_mul_hi_u32_u24 v60, s40, v9
    v_mul_hi_u32_u24 v63, s40, v28
    v_mul_hi_u32_u24 v62, s40, v10
    v_mul_hi_u32_u24 v65, s40, v29
    v_mul_hi_u32_u24 v64, s40, v11
    v_and_b32 v59, -2, v59
    v_mad_u32_u24 v8, v58, s43, v8
    v_and_b32 v58, -4, v58
    v_and_b32 v61, -2, v61
    v_mad_u32_u24 v9, v60, s43, v9
    v_and_b32 v60, -4, v60
    v_and_b32 v63, -2, v63
    v_mad_u32_u24 v10, v62, s43, v10
    v_and_b32 v62, -4, v62
    v_and_b32 v65, -2, v65
    v_mad_u32_u24 v11, v64, s43, v11
    v_and_b32 v64, -4, v64
    v_mad_i32_i24 v26, v59, s42, v26
    v_lshl_add_u32 v59, v58, 5, v59
    v_mad_i32_i24 v27, v61, s42, v27
    v_lshl_add_u32 v61, v60, 5, v61
    v_mad_i32_i24 v28, v63, s42, v28
    v_lshl_add_u32 v63, v62, 5, v63
    v_mad_i32_i24 v29, v65, s42, v29
    v_lshl_add_u32 v65, v64, 5, v65
    v_add_u32 v59, v59, v59
    ds_add_rtn_u32 v90, v59, v104
    v_add_u32 v61, v61, v61
    ds_add_rtn_u32 v91, v61, v104
    v_add_u32 v63, v63, v63
    ds_add_rtn_u32 v92, v63, v104
    v_add_u32 v65, v65, v65
    ds_add_rtn_u32 v93, v65, v104
    v_lshlrev_b32 v114, 16, v42
    v_and_b32 v115, 0xffff0000, v42
    v_lshlrev_b32 v116, 16, v43
    v_and_b32 v117, 0xffff0000, v43
    v_mul_f32 v114, s44, v114
    v_mul_f32 v115, s44, v115
    v_mul_f32 v116, s44, v116
    v_mul_f32 v117, s44, v117
    v_fract_f32 v114, v114
    v_fract_f32 v115, v115
    v_fract_f32 v116, v116
    v_fract_f32 v117, v117
    v_cos_f32 v114, v114
    v_cos_f32 v115, v115
    v_cos_f32 v116, v116
    v_cos_f32 v117, v117
    v_lshlrev_b32 v26, 3, v26
    v_lshlrev_b32 v27, 3, v27
    v_lshlrev_b32 v28, 3, v28
    v_lshlrev_b32 v29, 3, v29
    v_lshl_or_b32 v58, v8, 17, v26
    v_lshl_or_b32 v60, v9, 17, v27
    v_lshl_or_b32 v62, v10, 17, v28
    v_lshl_or_b32 v64, v11, 17, v29
    v_fmaak_f32 v114, v114, v105, 0x4b000c00
    v_fmaak_f32 v115, v115, v105, 0x4b000c00
    v_fmaak_f32 v116, v116, v105, 0x4b000c00
    v_fmaak_f32 v117, v117, v105, 0x4b000c00
    v_perm_b32 v59, v59, v114, s46
    v_bfe_u32 v114, v114, 8, 4
    v_perm_b32 v61, v61, v115, s46
    v_bfe_u32 v115, v115, 8, 4
    v_perm_b32 v63, v63, v116, s46
    v_bfe_u32 v116, v116, 8, 4
    v_perm_b32 v65, v65, v117, s46
    v_bfe_u32 v117, v117, 8, 4
    v_add_u32 v58, v58, v114
    v_add_u32 v60, v60, v115
    v_add_u32 v62, v62, v116
    v_add_u32 v64, v64, v117
    s_waitcnt vmcnt(9)
    v_mul_hi_u32_u24 v67, s40, v30
    v_mul_hi_u32_u24 v66, s40, v12
    v_mul_hi_u32_u24 v69, s40, v31
    v_mul_hi_u32_u24 v68, s40, v13
    v_mul_hi_u32_u24 v71, s40, v32
    v_mul_hi_u32_u24 v70, s40, v14
    v_mul_hi_u32_u24 v73, s40, v33
    v_mul_hi_u32_u24 v72, s40, v15
    v_and_b32 v67, -2, v67
    v_mad_u32_u24 v12, v66, s43, v12
    v_and_b32 v66, -4, v66
    v_and_b32 v69, -2, v69
    v_mad_u32_u24 v13, v68, s43, v13
    v_and_b32 v68, -4, v68
    v_and_b32 v71, -2, v71
    v_mad_u32_u24 v14, v70, s43, v14
    v_and_b32 v70, -4, v70
    v_and_b32 v73, -2, v73
    v_mad_u32_u24 v15, v72, s43, v15
    v_and_b32 v72, -4, v72
    v_mad_i32_i24 v30, v67, s42, v30
    v_lshl_add_u32 v67, v66, 5, v67
    v_mad_i32_i24 v31, v69, s42, v31
    v_lshl_add_u32 v69, v68, 5, v69
    v_mad_i32_i24 v32, v71, s42, v32
    v_lshl_add_u32 v71, v70, 5, v71
    v_mad_i32_i24 v33, v73, s42, v33
    v_lshl_add_u32 v73, v72, 5, v73
    v_add_u32 v67, v67, v67
    ds_add_rtn_u32 v94, v67, v104
    v_add_u32 v69, v69, v69
    ds_add_rtn_u32 v95, v69, v104
    v_add_u32 v71, v71, v71
    ds_add_rtn_u32 v96, v71, v104
    v_add_u32 v73, v73, v73
    ds_add_rtn_u32 v97, v73, v104
    v_lshlrev_b32 v114, 16, v44
    v_and_b32 v115, 0xffff0000, v44
    v_lshlrev_b32 v116, 16, v45
    v_and_b32 v117, 0xffff0000, v45
    v_mul_f32 v114, s44, v114
    v_mul_f32 v115, s44, v115
    v_mul_f32 v116, s44, v116
    v_mul_f32 v117, s44, v117
    v_fract_f32 v114, v114
    v_fract_f32 v115, v115
    v_fract_f32 v116, v116
    v_fract_f32 v117, v117
    v_cos_f32 v114, v114
    v_cos_f32 v115, v115
    v_cos_f32 v116, v116
    v_cos_f32 v117, v117
    v_lshlrev_b32 v30, 3, v30
    v_lshlrev_b32 v31, 3, v31
    v_lshlrev_b32 v32, 3, v32
    v_lshlrev_b32 v33, 3, v33
    v_lshl_or_b32 v66, v12, 17, v30
    v_lshl_or_b32 v68, v13, 17, v31
    v_lshl_or_b32 v70, v14, 17, v32
    v_lshl_or_b32 v72, v15, 17, v33
    v_fmaak_f32 v114, v114, v105, 0x4b000c00
    v_fmaak_f32 v115, v115, v105, 0x4b000c00
    v_fmaak_f32 v116, v116, v105, 0x4b000c00
    v_fmaak_f32 v117, v117, v105, 0x4b000c00
    v_perm_b32 v67, v67, v114, s46
    v_bfe_u32 v114, v114, 8, 4
    v_perm_b32 v69, v69, v115, s46
    v_bfe_u32 v115, v115, 8, 4
    v_perm_b32 v71, v71, v116, s46
    v_bfe_u32 v116, v116, 8, 4
    v_perm_b32 v73, v73, v117, s46
    v_bfe_u32 v117, v117, 8, 4
    v_add_u32 v66, v66, v114
    v_add_u32 v68, v68, v115
    v_add_u32 v70, v70, v116
    v_add_u32 v72, v72, v117
    s_waitcnt vmcnt(6)
    v_mul_hi_u32_u24 v75, s40, v34
    v_mul_hi_u32_u24 v74, s40, v16
    v_mul_hi_u32_u24 v77, s40, v35
    v_mul_hi_u32_u24 v76, s40, v17
    v_mul_hi_u32_u24 v79, s40, v36
    v_mul_hi_u32_u24 v78, s40, v18
    v_mul_hi_u32_u24 v81, s40, v37
    v_mul_hi_u32_u24 v80, s40, v19
    v_and_b32 v75, -2, v75
    v_mad_u32_u24 v16, v74, s43, v16
    v_and_b32 v74, -4, v74
    v_and_b32 v77, -2, v77
    v_mad_u32_u24 v17, v76, s43, v17
    v_and_b32 v76, -4, v76
    v_and_b32 v79, -2, v79
    v_mad_u32_u24 v18, v78, s43, v18
    v_and_b32 v78, -4, v78
    v_and_b32 v81, -2, v81
    v_mad_u32_u24 v19, v80, s43, v19
    v_and_b32 v80, -4, v80
    v_mad_i32_i24 v34, v75, s42, v34
    v_lshl_add_u32 v75, v74, 5, v75
    v_mad_i32_i24 v35, v77, s42, v35
    v_lshl_add_u32 v77, v76, 5, v77
    v_mad_i32_i24 v36, v79, s42, v36
    v_lshl_add_u32 v79, v78, 5, v79
    v_mad_i32_i24 v37, v81, s42, v37
    v_lshl_add_u32 v81, v80, 5, v81
    v_add_u32 v75, v75, v75
    ds_add_rtn_u32 v98, v75, v104
    v_add_u32 v77, v77, v77
    ds_add_rtn_u32 v99, v77, v104
    v_add_u32 v79, v79, v79
    ds_add_rtn_u32 v100, v79, v104
    v_add_u32 v81, v81, v81
    ds_add_rtn_u32 v101, v81, v104
    v_lshlrev_b32 v114, 16, v46
    v_and_b32 v115, 0xffff0000, v46
    v_lshlrev_b32 v116, 16, v47
    v_and_b32 v117, 0xffff0000, v47
    v_mul_f32 v114, s44, v114
    v_mul_f32 v115, s44, v115
    v_mul_f32 v116, s44, v116
    v_mul_f32 v117, s44, v117
    v_fract_f32 v114, v114
    v_fract_f32 v115, v115
    v_fract_f32 v116, v116
    v_fract_f32 v117, v117
    v_cos_f32 v114, v114
    v_cos_f32 v115, v115
    v_cos_f32 v116, v116
    v_cos_f32 v117, v117
    v_lshlrev_b32 v34, 3, v34
    v_lshlrev_b32 v35, 3, v35
    v_lshlrev_b32 v36, 3, v36
    v_lshlrev_b32 v37, 3, v37
    v_lshl_or_b32 v74, v16, 17, v34
    v_lshl_or_b32 v76, v17, 17, v35
    v_lshl_or_b32 v78, v18, 17, v36
    v_lshl_or_b32 v80, v19, 17, v37
    v_fmaak_f32 v114, v114, v105, 0x4b000c00
    v_fmaak_f32 v115, v115, v105, 0x4b000c00
    v_fmaak_f32 v116, v116, v105, 0x4b000c00
    v_fmaak_f32 v117, v117, v105, 0x4b000c00
    v_perm_b32 v75, v75, v114, s46
    v_bfe_u32 v114, v114, 8, 4
    v_perm_b32 v77, v77, v115, s46
    v_bfe_u32 v115, v115, 8, 4
    v_perm_b32 v79, v79, v116, s46
    v_bfe_u32 v116, v116, 8, 4
    v_perm_b32 v81, v81, v117, s46
    v_bfe_u32 v117, v117, 8, 4
    v_add_u32 v74, v74, v114
    v_add_u32 v76, v76, v115
    v_add_u32 v78, v78, v116
    v_add_u32 v80, v80, v117
    s_waitcnt vmcnt(3)
    s_mov_b64 exec, s[66:67]
    v_mul_hi_u32_u24 v83, s40, v38
    v_mul_hi_u32_u24 v82, s40, v20
    v_mul_hi_u32_u24 v85, s40, v39
    v_mul_hi_u32_u24 v84, s40, v21
    v_and_b32 v83, -2, v83
    v_mad_u32_u24 v20, v82, s43, v20
    v_and_b32 v82, -4, v82
    v_and_b32 v85, -2, v85
    v_mad_u32_u24 v21, v84, s43, v21
    v_and_b32 v84, -4, v84
    v_mad_i32_i24 v38, v83, s42, v38
    v_lshl_add_u32 v83, v82, 5, v83
    v_mad_i32_i24 v39, v85, s42, v39
    v_lshl_add_u32 v85, v84, 5, v85
    v_add_u32 v83, v83, v83
    ds_add_rtn_u32 v102, v83, v104
    v_add_u32 v85, v85, v85
    ds_add_rtn_u32 v103, v85, v104
    v_lshlrev_b32 v114, 16, v48
    v_and_b32 v115, 0xffff0000, v48
    v_mul_f32 v114, s44, v114
    v_mul_f32 v115, s44, v115
    v_fract_f32 v114, v114
    v_fract_f32 v115, v115
    v_cos_f32 v114, v114
    v_cos_f32 v115, v115
    v_lshlrev_b32 v38, 3, v38
    v_lshlrev_b32 v39, 3, v39
    v_lshl_or_b32 v82, v20, 17, v38
    v_lshl_or_b32 v84, v21, 17, v39
    s_mov_b64 exec, -1
    v_fmaak_f32 v114, v114, v105, 0x4b000c00
    v_fmaak_f32 v115, v115, v105, 0x4b000c00
    v_perm_b32 v83, v83, v114, s46
    v_bfe_u32 v114, v114, 8, 4
    v_perm_b32 v85, v85, v115, s46
    v_bfe_u32 v115, v115, 8, 4
    v_add_u32 v82, v82, v114
    v_add_u32 v84, v84, v115
    s_waitcnt lgkmcnt(0)
    s_barrier

    ds_read_b64 v[108:109], v2
    s_waitcnt lgkmcnt(0)
    v_and_b32 v108, 0xffff, v108
    v_and_b32 v109, 0xffff, v109
    v_mov_b32 v106, v108
    v_mov_b32 v107, v109
    v_add_u32 v111, v108, v109

    buffer_atomic_add_x2 v[106:107], v2, s[20:23], 0 offen sc0
    s_nop 1
    v_add_u32_dpp v111, v111, v111 row_shr:1 row_mask:0xf bank_mask:0xf
    s_nop 1
    v_add_u32_dpp v111, v111, v111 row_shr:2 row_mask:0xf bank_mask:0xf
    s_nop 1
    v_add_u32_dpp v111, v111, v111 row_shr:4 row_mask:0xf bank_mask:0xf
    s_nop 1
    v_add_u32_dpp v111, v111, v111 row_shr:8 row_mask:0xf bank_mask:0xf
    s_nop 1
    v_add_u32_dpp v111, v111, v111 row_bcast:15 row_mask:0xa bank_mask:0xf
    s_nop 1
    v_add_u32_dpp v111, v111, v111 row_bcast:31 row_mask:0xc bank_mask:0xf
    s_mov_b32 exec_lo, 0
    s_brev_b32 exec_hi, 1
    ds_add_rtn_u32 v110, v113, v111
    s_mov_b64 exec, -1

    s_waitcnt lgkmcnt(0)
    v_readlane_b32 s77, v110, 63
    v_mul_u32_u24 v116, 7936, v0
    v_sub_u32 v111, v111, v109
    s_sub_u32 s77, s77, s50
    v_add_u32 v111, s77, v111
    v_sub_u32 v110, v111, v108
    v_lshlrev_b32 v115, 16, v111
    v_lshlrev_b32 v114, 16, v110
    ds_write_b64 v2, v[114:115]
    v_sub_u32 v110, v116, v110
    v_sub_u32 v111, v116, v111
    v_add_u32 v111, s48, v111
    s_lshl_b32 s74, s51, 3
    v_mov_b32 v126, s74
    v_mov_b32 v127, -1

    s_waitcnt lgkmcnt(0)
    s_barrier

    s_mov_b64 exec, 1
    ds_write_b32 v126, v127 offset:16404
    s_mov_b64 exec, -1

    v_lshrrev_b32 v114, 16, v51
    ds_read_b32 v114, v114
    v_lshrrev_b32 v115, 16, v53
    ds_read_b32 v115, v115
    v_lshrrev_b32 v116, 16, v55
    ds_read_b32 v116, v116
    v_lshrrev_b32 v117, 16, v57
    ds_read_b32 v117, v117
    v_lshrrev_b32 v118, 16, v59
    ds_read_b32 v118, v118
    v_lshrrev_b32 v119, 16, v61
    ds_read_b32 v119, v119
    v_lshrrev_b32 v120, 16, v63
    ds_read_b32 v120, v120
    v_lshrrev_b32 v121, 16, v65
    ds_read_b32 v121, v121
    s_waitcnt lgkmcnt(7)
    v_add_u32_sdwa v114, v114, v86 dst_sel:DWORD dst_unused:UNUSED_PAD src0_sel:WORD_1 src1_sel:WORD_0
    v_lshlrev_b32 v114, 3, v114
    ds_write_b64 v114, v[50:51] offset:16400

    s_waitcnt lgkmcnt(7)
    v_add_u32_sdwa v115, v115, v87 dst_sel:DWORD dst_unused:UNUSED_PAD src0_sel:WORD_1 src1_sel:WORD_0
    v_lshlrev_b32 v115, 3, v115
    ds_write_b64 v115, v[52:53] offset:16400

    s_waitcnt lgkmcnt(7)
    v_add_u32_sdwa v116, v116, v88 dst_sel:DWORD dst_unused:UNUSED_PAD src0_sel:WORD_1 src1_sel:WORD_0
    v_lshlrev_b32 v116, 3, v116
    ds_write_b64 v116, v[54:55] offset:16400

    s_waitcnt lgkmcnt(7)
    v_add_u32_sdwa v117, v117, v89 dst_sel:DWORD dst_unused:UNUSED_PAD src0_sel:WORD_1 src1_sel:WORD_0
    v_lshlrev_b32 v117, 3, v117
    ds_write_b64 v117, v[56:57] offset:16400

    s_waitcnt lgkmcnt(7)
    v_add_u32_sdwa v118, v118, v90 dst_sel:DWORD dst_unused:UNUSED_PAD src0_sel:WORD_1 src1_sel:WORD_0
    v_lshlrev_b32 v118, 3, v118
    ds_write_b64 v118, v[58:59] offset:16400

    s_waitcnt lgkmcnt(7)
    v_add_u32_sdwa v119, v119, v91 dst_sel:DWORD dst_unused:UNUSED_PAD src0_sel:WORD_1 src1_sel:WORD_0
    v_lshlrev_b32 v119, 3, v119
    ds_write_b64 v119, v[60:61] offset:16400

    s_waitcnt lgkmcnt(7)
    v_add_u32_sdwa v120, v120, v92 dst_sel:DWORD dst_unused:UNUSED_PAD src0_sel:WORD_1 src1_sel:WORD_0
    v_lshlrev_b32 v120, 3, v120
    ds_write_b64 v120, v[62:63] offset:16400

    s_waitcnt lgkmcnt(7)
    v_add_u32_sdwa v121, v121, v93 dst_sel:DWORD dst_unused:UNUSED_PAD src0_sel:WORD_1 src1_sel:WORD_0
    v_lshlrev_b32 v121, 3, v121
    ds_write_b64 v121, v[64:65] offset:16400

    v_lshrrev_b32 v114, 16, v67
    ds_read_b32 v114, v114
    v_lshrrev_b32 v115, 16, v69
    ds_read_b32 v115, v115
    v_lshrrev_b32 v116, 16, v71
    ds_read_b32 v116, v116
    v_lshrrev_b32 v117, 16, v73
    ds_read_b32 v117, v117
    v_lshrrev_b32 v118, 16, v75
    ds_read_b32 v118, v118
    v_lshrrev_b32 v119, 16, v77
    ds_read_b32 v119, v119
    v_lshrrev_b32 v120, 16, v79
    ds_read_b32 v120, v120
    v_lshrrev_b32 v121, 16, v81
    ds_read_b32 v121, v121
    s_waitcnt lgkmcnt(7)
    v_add_u32_sdwa v114, v114, v94 dst_sel:DWORD dst_unused:UNUSED_PAD src0_sel:WORD_1 src1_sel:WORD_0
    v_lshlrev_b32 v114, 3, v114
    ds_write_b64 v114, v[66:67] offset:16400

    s_waitcnt lgkmcnt(7)
    v_add_u32_sdwa v115, v115, v95 dst_sel:DWORD dst_unused:UNUSED_PAD src0_sel:WORD_1 src1_sel:WORD_0
    v_lshlrev_b32 v115, 3, v115
    ds_write_b64 v115, v[68:69] offset:16400

    s_waitcnt lgkmcnt(7)
    v_add_u32_sdwa v116, v116, v96 dst_sel:DWORD dst_unused:UNUSED_PAD src0_sel:WORD_1 src1_sel:WORD_0
    v_lshlrev_b32 v116, 3, v116
    ds_write_b64 v116, v[70:71] offset:16400

    s_waitcnt lgkmcnt(7)
    v_add_u32_sdwa v117, v117, v97 dst_sel:DWORD dst_unused:UNUSED_PAD src0_sel:WORD_1 src1_sel:WORD_0
    v_lshlrev_b32 v117, 3, v117
    ds_write_b64 v117, v[72:73] offset:16400

    s_waitcnt lgkmcnt(7)
    v_add_u32_sdwa v118, v118, v98 dst_sel:DWORD dst_unused:UNUSED_PAD src0_sel:WORD_1 src1_sel:WORD_0
    v_lshlrev_b32 v118, 3, v118
    ds_write_b64 v118, v[74:75] offset:16400

    s_waitcnt lgkmcnt(7)
    v_add_u32_sdwa v119, v119, v99 dst_sel:DWORD dst_unused:UNUSED_PAD src0_sel:WORD_1 src1_sel:WORD_0
    v_lshlrev_b32 v119, 3, v119
    ds_write_b64 v119, v[76:77] offset:16400

    s_waitcnt lgkmcnt(7)
    v_add_u32_sdwa v120, v120, v100 dst_sel:DWORD dst_unused:UNUSED_PAD src0_sel:WORD_1 src1_sel:WORD_0
    v_lshlrev_b32 v120, 3, v120
    ds_write_b64 v120, v[78:79] offset:16400

    s_waitcnt lgkmcnt(7)
    v_add_u32_sdwa v121, v121, v101 dst_sel:DWORD dst_unused:UNUSED_PAD src0_sel:WORD_1 src1_sel:WORD_0
    v_lshlrev_b32 v121, 3, v121
    ds_write_b64 v121, v[80:81] offset:16400

    s_mov_b64 exec, s[66:67]
    v_lshrrev_b32 v114, 16, v83
    ds_read_b32 v114, v114
    v_lshrrev_b32 v115, 16, v85
    ds_read_b32 v115, v115
    s_waitcnt lgkmcnt(1)
    v_add_u32_sdwa v114, v114, v102 dst_sel:DWORD dst_unused:UNUSED_PAD src0_sel:WORD_1 src1_sel:WORD_0
    v_lshlrev_b32 v114, 3, v114
    ds_write_b64 v114, v[82:83] offset:16400

    s_waitcnt lgkmcnt(1)
    v_add_u32_sdwa v115, v115, v103 dst_sel:DWORD dst_unused:UNUSED_PAD src0_sel:WORD_1 src1_sel:WORD_0
    v_lshlrev_b32 v115, 3, v115
    ds_write_b64 v115, v[84:85] offset:16400

    s_mov_b64 exec, -1
    s_add_u32 s50, s50, s51
    s_add_u32 s49, s49, 1

    buffer_load_dwordx4 v[26:29], v1, s[12:15], s57 offen nt
    buffer_load_dwordx4 v[8:11], v1, s[8:11], s57 offen nt
    buffer_load_dwordx2 v[42:43], v2, s[16:19], s62 offen nt
    buffer_load_dwordx4 v[30:33], v1, s[12:15], s58 offen nt
    buffer_load_dwordx4 v[12:15], v1, s[8:11], s58 offen nt
    buffer_load_dwordx2 v[44:45], v2, s[16:19], s63 offen nt
    buffer_load_dwordx4 v[34:37], v1, s[12:15], s59 offen nt
    buffer_load_dwordx4 v[16:19], v1, s[8:11], s59 offen nt
    buffer_load_dwordx2 v[46:47], v2, s[16:19], s64 offen nt
    buffer_load_dwordx2 v[38:39], v2, s[12:15], s60 offen nt
    buffer_load_dwordx2 v[20:21], v2, s[8:11], s60 offen nt
    buffer_load_dword v48, v3, s[16:19], s65 offen nt
L_p1loop_3:
    s_mov_b32 s52, s51
    s_sub_u32 s51, 200000, s50
    s_min_u32 s51, s51, 18240
    s_sub_u32 s75, s51, 16384
    s_lshl_b32 s75, s75, 1
    v_cmp_gt_u32 s[66:67], s75, v3

    s_add_u32 s76, s50, 36480
    s_min_u32 s76, s76, 200000
    s_lshl_b32 s10, s76, 2
    s_lshl_b32 s14, s76, 2
    s_lshl_b32 s18, s76, 1

    s_add_u32 s56, s56, 72960
    s_add_u32 s61, s61, 36480
    s_add_u32 s57, s57, 72960
    s_add_u32 s62, s62, 36480
    s_add_u32 s58, s58, 72960
    s_add_u32 s63, s63, 36480
    s_add_u32 s59, s59, 72960
    s_add_u32 s64, s64, 36480
    s_add_u32 s60, s60, 72960
    s_add_u32 s65, s65, 36480
    s_waitcnt vmcnt(13)
    v_mul_hi_u32_u24 v51, s40, v22
    v_mul_hi_u32_u24 v50, s40, v4
    v_mul_hi_u32_u24 v53, s40, v23
    v_mul_hi_u32_u24 v52, s40, v5
    v_mul_hi_u32_u24 v55, s40, v24
    v_mul_hi_u32_u24 v54, s40, v6
    v_mul_hi_u32_u24 v57, s40, v25
    v_mul_hi_u32_u24 v56, s40, v7
    v_and_b32 v51, -2, v51
    v_mad_u32_u24 v4, v50, s43, v4
    v_and_b32 v50, -4, v50
    v_and_b32 v53, -2, v53
    v_mad_u32_u24 v5, v52, s43, v5
    v_and_b32 v52, -4, v52
    v_and_b32 v55, -2, v55
    v_mad_u32_u24 v6, v54, s43, v6
    v_and_b32 v54, -4, v54
    v_and_b32 v57, -2, v57
    v_mad_u32_u24 v7, v56, s43, v7
    v_and_b32 v56, -4, v56
    v_mad_i32_i24 v22, v51, s42, v22
    v_lshl_add_u32 v51, v50, 5, v51
    v_mad_i32_i24 v23, v53, s42, v23
    v_lshl_add_u32 v53, v52, 5, v53
    v_mad_i32_i24 v24, v55, s42, v24
    v_lshl_add_u32 v55, v54, 5, v55
    v_mad_i32_i24 v25, v57, s42, v25
    v_lshl_add_u32 v57, v56, 5, v57
    v_add_u32 v51, v51, v51
    ds_add_rtn_u32 v86, v51, v104
    v_add_u32 v53, v53, v53
    ds_add_rtn_u32 v87, v53, v104
    v_add_u32 v55, v55, v55
    ds_add_rtn_u32 v88, v55, v104
    v_add_u32 v57, v57, v57
    ds_add_rtn_u32 v89, v57, v104
    v_lshlrev_b32 v114, 16, v40
    v_and_b32 v115, 0xffff0000, v40
    v_lshlrev_b32 v116, 16, v41
    v_and_b32 v117, 0xffff0000, v41
    v_mul_f32 v114, s44, v114
    v_mul_f32 v115, s44, v115
    v_mul_f32 v116, s44, v116
    v_mul_f32 v117, s44, v117
    v_fract_f32 v114, v114
    v_fract_f32 v115, v115
    v_fract_f32 v116, v116
    v_fract_f32 v117, v117
    v_cos_f32 v114, v114
    v_cos_f32 v115, v115
    v_cos_f32 v116, v116
    v_cos_f32 v117, v117
    v_lshlrev_b32 v22, 3, v22
    v_lshlrev_b32 v23, 3, v23
    v_lshlrev_b32 v24, 3, v24
    v_lshlrev_b32 v25, 3, v25
    v_lshl_or_b32 v50, v4, 17, v22
    v_lshl_or_b32 v52, v5, 17, v23
    v_lshl_or_b32 v54, v6, 17, v24
    v_lshl_or_b32 v56, v7, 17, v25
    buffer_load_dwordx4 v[22:25], v1, s[12:15], s56 offen nt
    buffer_load_dwordx4 v[4:7], v1, s[8:11], s56 offen nt
    buffer_load_dwordx2 v[40:41], v2, s[16:19], s61 offen nt
    v_fmaak_f32 v114, v114, v105, 0x4b000c00
    v_fmaak_f32 v115, v115, v105, 0x4b000c00
    v_fmaak_f32 v116, v116, v105, 0x4b000c00
    v_fmaak_f32 v117, v117, v105, 0x4b000c00
    v_perm_b32 v51, v51, v114, s46
    v_bfe_u32 v114, v114, 8, 4
    v_perm_b32 v53, v53, v115, s46
    v_bfe_u32 v115, v115, 8, 4
    v_perm_b32 v55, v55, v116, s46
    v_bfe_u32 v116, v116, 8, 4
    v_perm_b32 v57, v57, v117, s46
    v_bfe_u32 v117, v117, 8, 4
    v_add_u32 v50, v50, v114
    v_add_u32 v52, v52, v115
    v_add_u32 v54, v54, v116
    v_add_u32 v56, v56, v117
    s_waitcnt vmcnt(15)
    v_add_u32 v114, v106, v108
    v_add_u32 v115, v107, v109
    v_max_u32 v114, v114, v115
    v_cmp_lt_u32 vcc, s48, v114
    v_min_u32 v106, s48, v106
    v_min_u32 v107, s48, v107
    v_add_u32 v106, v106, v110
    v_add_u32 v107, v107, v111
    v_lshl_add_u32 v106, v106, 2, v106
    v_lshl_add_u32 v107, v107, 2, v107
    ds_write_b64 v2, v[106:107] offset:8192
    s_cbranch_vccz L_noov_4
    ds_write_b32 v113, v104 offset:4
L_noov_4:
    s_sub_u32 s74, s52, 17408
    s_max_i32 s74, s74, 0
    v_cmp_gt_u32 s[68:69], s74, v0
    s_waitcnt lgkmcnt(0)
    s_barrier
    ds_read_b32 v114, v113 offset:4
    s_waitcnt lgkmcnt(0)
    v_readfirstlane_b32 s53, v114
    s_nop 1
    s_cmp_lg_u32 s53, 0
    s_cbranch_scc1 L_slow_5
L_sback_6:

    ds_read_b64 v[114:115], v2 offset:16400
    ds_read_b64 v[116:117], v2 offset:16408
    ds_read_b64 v[118:119], v2 offset:16392

    ds_read_b64 v[120:121], v2 offset:24592
    ds_read_b64 v[122:123], v2 offset:24600
    ds_read_b64 v[124:125], v2 offset:24584

    s_waitcnt lgkmcnt(3)
    v_lshrrev_b32 v126, 16, v115
    ds_read_b32 v126, v126 offset:8192

    s_waitcnt lgkmcnt(1)
    v_lshrrev_b32 v127, 16, v121
    ds_read_b32 v127, v127 offset:8192

    v_cmp_ne_u32_sdwa s[70:71], v115, v117 src0_sel:WORD_1 src1_sel:WORD_1
    v_cmp_ne_u32_sdwa vcc, v115, v119 src0_sel:WORD_1 src1_sel:WORD_1
    v_perm_b32 v115, v116, v115, s45
    s_mov_b32 s54, 0
    v_alignbyte_b32 v118, v119, v118, 2
    s_waitcnt lgkmcnt(1)
    v_add3_u32 v126, v126, v49, s54

    s_and_b64 vcc, vcc, s[70:71]
    s_cbranch_scc1 L_fix_10
L_back_11:
    s_mov_b64 exec, s[70:71]
    v_alignbyte_b32 v115, v115, v114, 1
    v_perm_b32 v114, v114, v118, s47
    v_subrev_u32 v126, 3, v126
    s_mov_b64 exec, -1

    buffer_store_dwordx2 v[114:115], v126, s[24:27], 0 offen
    v_cmp_ne_u32_sdwa s[70:71], v121, v123 src0_sel:WORD_1 src1_sel:WORD_1
    v_cmp_ne_u32_sdwa vcc, v121, v125 src0_sel:WORD_1 src1_sel:WORD_1
    v_perm_b32 v121, v122, v121, s45
    s_mov_b32 s54, 5120
    v_alignbyte_b32 v124, v125, v124, 2
    s_waitcnt lgkmcnt(0)
    v_add3_u32 v127, v127, v49, s54

    s_and_b64 vcc, vcc, s[70:71]
    s_cbranch_scc1 L_fix_12
L_back_13:
    s_mov_b64 exec, s[70:71]
    v_alignbyte_b32 v121, v121, v120, 1
    v_perm_b32 v120, v120, v124, s47
    v_subrev_u32 v127, 3, v127
    s_mov_b64 exec, -1

    buffer_store_dwordx2 v[120:121], v127, s[24:27], 0 offen
    ds_read_b64 v[114:115], v2 offset:32784
    ds_read_b64 v[116:117], v2 offset:32792
    ds_read_b64 v[118:119], v2 offset:32776

    ds_read_b64 v[120:121], v2 offset:40976
    ds_read_b64 v[122:123], v2 offset:40984
    ds_read_b64 v[124:125], v2 offset:40968

    s_waitcnt lgkmcnt(3)
    v_lshrrev_b32 v126, 16, v115
    ds_read_b32 v126, v126 offset:8192

    s_waitcnt lgkmcnt(1)
    v_lshrrev_b32 v127, 16, v121
    ds_read_b32 v127, v127 offset:8192

    v_cmp_ne_u32_sdwa s[70:71], v115, v117 src0_sel:WORD_1 src1_sel:WORD_1
    v_cmp_ne_u32_sdwa vcc, v115, v119 src0_sel:WORD_1 src1_sel:WORD_1
    v_perm_b32 v115, v116, v115, s45
    s_mov_b32 s54, 10240
    v_alignbyte_b32 v118, v119, v118, 2
    s_waitcnt lgkmcnt(1)
    v_add3_u32 v126, v126, v49, s54

    s_and_b64 vcc, vcc, s[70:71]
    s_cbranch_scc1 L_fix_14
L_back_15:
    s_mov_b64 exec, s[70:71]
    v_alignbyte_b32 v115, v115, v114, 1
    v_perm_b32 v114, v114, v118, s47
    v_subrev_u32 v126, 3, v126
    s_mov_b64 exec, -1

    buffer_store_dwordx2 v[114:115], v126, s[24:27], 0 offen
    v_cmp_ne_u32_sdwa s[70:71], v121, v123 src0_sel:WORD_1 src1_sel:WORD_1
    v_cmp_ne_u32_sdwa vcc, v121, v125 src0_sel:WORD_1 src1_sel:WORD_1
    v_perm_b32 v121, v122, v121, s45
    s_mov_b32 s54, 15360
    v_alignbyte_b32 v124, v125, v124, 2
    s_waitcnt lgkmcnt(0)
    v_add3_u32 v127, v127, v49, s54

    s_and_b64 vcc, vcc, s[70:71]
    s_cbranch_scc1 L_fix_16
L_back_17:
    s_mov_b64 exec, s[70:71]
    v_alignbyte_b32 v121, v121, v120, 1
    v_perm_b32 v120, v120, v124, s47
    v_subrev_u32 v127, 3, v127
    s_mov_b64 exec, -1

    buffer_store_dwordx2 v[120:121], v127, s[24:27], 0 offen
    s_waitcnt vmcnt(16)
    v_mul_hi_u32_u24 v59, s40, v26
    v_mul_hi_u32_u24 v58, s40, v8
    v_mul_hi_u32_u24 v61, s40, v27
    v_mul_hi_u32_u24 v60, s40, v9
    v_mul_hi_u32_u24 v63, s40, v28
    v_mul_hi_u32_u24 v62, s40, v10
    v_mul_hi_u32_u24 v65, s40, v29
    v_mul_hi_u32_u24 v64, s40, v11
    v_and_b32 v59, -2, v59
    v_mad_u32_u24 v8, v58, s43, v8
    v_and_b32 v58, -4, v58
    v_and_b32 v61, -2, v61
    v_mad_u32_u24 v9, v60, s43, v9
    v_and_b32 v60, -4, v60
    v_and_b32 v63, -2, v63
    v_mad_u32_u24 v10, v62, s43, v10
    v_and_b32 v62, -4, v62
    v_and_b32 v65, -2, v65
    v_mad_u32_u24 v11, v64, s43, v11
    v_and_b32 v64, -4, v64
    v_mad_i32_i24 v26, v59, s42, v26
    v_lshl_add_u32 v59, v58, 5, v59
    v_mad_i32_i24 v27, v61, s42, v27
    v_lshl_add_u32 v61, v60, 5, v61
    v_mad_i32_i24 v28, v63, s42, v28
    v_lshl_add_u32 v63, v62, 5, v63
    v_mad_i32_i24 v29, v65, s42, v29
    v_lshl_add_u32 v65, v64, 5, v65
    v_add_u32 v59, v59, v59
    ds_add_rtn_u32 v90, v59, v104
    v_add_u32 v61, v61, v61
    ds_add_rtn_u32 v91, v61, v104
    v_add_u32 v63, v63, v63
    ds_add_rtn_u32 v92, v63, v104
    v_add_u32 v65, v65, v65
    ds_add_rtn_u32 v93, v65, v104
    v_lshlrev_b32 v114, 16, v42
    v_and_b32 v115, 0xffff0000, v42
    v_lshlrev_b32 v116, 16, v43
    v_and_b32 v117, 0xffff0000, v43
    v_mul_f32 v114, s44, v114
    v_mul_f32 v115, s44, v115
    v_mul_f32 v116, s44, v116
    v_mul_f32 v117, s44, v117
    v_fract_f32 v114, v114
    v_fract_f32 v115, v115
    v_fract_f32 v116, v116
    v_fract_f32 v117, v117
    v_cos_f32 v114, v114
    v_cos_f32 v115, v115
    v_cos_f32 v116, v116
    v_cos_f32 v117, v117
    v_lshlrev_b32 v26, 3, v26
    v_lshlrev_b32 v27, 3, v27
    v_lshlrev_b32 v28, 3, v28
    v_lshlrev_b32 v29, 3, v29
    v_lshl_or_b32 v58, v8, 17, v26
    v_lshl_or_b32 v60, v9, 17, v27
    v_lshl_or_b32 v62, v10, 17, v28
    v_lshl_or_b32 v64, v11, 17, v29
    v_fmaak_f32 v114, v114, v105, 0x4b000c00
    v_fmaak_f32 v115, v115, v105, 0x4b000c00
    v_fmaak_f32 v116, v116, v105, 0x4b000c00
    v_fmaak_f32 v117, v117, v105, 0x4b000c00
    v_perm_b32 v59, v59, v114, s46
    v_bfe_u32 v114, v114, 8, 4
    v_perm_b32 v61, v61, v115, s46
    v_bfe_u32 v115, v115, 8, 4
    v_perm_b32 v63, v63, v116, s46
    v_bfe_u32 v116, v116, 8, 4
    v_perm_b32 v65, v65, v117, s46
    v_bfe_u32 v117, v117, 8, 4
    v_add_u32 v58, v58, v114
    v_add_u32 v60, v60, v115
    v_add_u32 v62, v62, v116
    v_add_u32 v64, v64, v117
    ds_read_b64 v[114:115], v2 offset:49168
    ds_read_b64 v[116:117], v2 offset:49176
    ds_read_b64 v[118:119], v2 offset:49160

    ds_read_b64 v[120:121], v2 offset:57360
    ds_read_b64 v[122:123], v2 offset:57368
    ds_read_b64 v[124:125], v2 offset:57352

    s_waitcnt lgkmcnt(3)
    v_lshrrev_b32 v126, 16, v115
    ds_read_b32 v126, v126 offset:8192

    s_waitcnt lgkmcnt(1)
    v_lshrrev_b32 v127, 16, v121
    ds_read_b32 v127, v127 offset:8192

    v_cmp_ne_u32_sdwa s[70:71], v115, v117 src0_sel:WORD_1 src1_sel:WORD_1
    v_cmp_ne_u32_sdwa vcc, v115, v119 src0_sel:WORD_1 src1_sel:WORD_1
    v_perm_b32 v115, v116, v115, s45
    s_mov_b32 s54, 20480
    v_alignbyte_b32 v118, v119, v118, 2
    s_waitcnt lgkmcnt(1)
    v_add3_u32 v126, v126, v49, s54

    s_and_b64 vcc, vcc, s[70:71]
    s_cbranch_scc1 L_fix_18
L_back_19:
    s_mov_b64 exec, s[70:71]
    v_alignbyte_b32 v115, v115, v114, 1
    v_perm_b32 v114, v114, v118, s47
    v_subrev_u32 v126, 3, v126
    s_mov_b64 exec, -1

    buffer_store_dwordx2 v[114:115], v126, s[24:27], 0 offen
    v_cmp_ne_u32_sdwa s[70:71], v121, v123 src0_sel:WORD_1 src1_sel:WORD_1
    v_cmp_ne_u32_sdwa vcc, v121, v125 src0_sel:WORD_1 src1_sel:WORD_1
    v_perm_b32 v121, v122, v121, s45
    s_mov_b32 s54, 25600
    v_alignbyte_b32 v124, v125, v124, 2
    s_waitcnt lgkmcnt(0)
    v_add3_u32 v127, v127, v49, s54

    s_and_b64 vcc, vcc, s[70:71]
    s_cbranch_scc1 L_fix_20
L_back_21:
    s_mov_b64 exec, s[70:71]
    v_alignbyte_b32 v121, v121, v120, 1
    v_perm_b32 v120, v120, v124, s47
    v_subrev_u32 v127, 3, v127
    s_mov_b64 exec, -1

    buffer_store_dwordx2 v[120:121], v127, s[24:27], 0 offen
    v_add_u32 v112, 65536, v2
    ds_read_b64 v[114:115], v112 offset:16
    ds_read_b64 v[116:117], v112 offset:24
    ds_read_b64 v[118:119], v112 offset:8

    ds_read_b64 v[120:121], v112 offset:8208
    ds_read_b64 v[122:123], v112 offset:8216
    ds_read_b64 v[124:125], v112 offset:8200

    s_waitcnt lgkmcnt(3)
    v_lshrrev_b32 v126, 16, v115
    ds_read_b32 v126, v126 offset:8192

    s_waitcnt lgkmcnt(1)
    v_lshrrev_b32 v127, 16, v121
    ds_read_b32 v127, v127 offset:8192

    v_cmp_ne_u32_sdwa s[70:71], v115, v117 src0_sel:WORD_1 src1_sel:WORD_1
    v_cmp_ne_u32_sdwa vcc, v115, v119 src0_sel:WORD_1 src1_sel:WORD_1
    v_perm_b32 v115, v116, v115, s45
    s_mov_b32 s54, 30720
    v_alignbyte_b32 v118, v119, v118, 2
    s_waitcnt lgkmcnt(1)
    v_add3_u32 v126, v126, v49, s54

    s_and_b64 vcc, vcc, s[70:71]
    s_cbranch_scc1 L_fix_22
L_back_23:
    s_mov_b64 exec, s[70:71]
    v_alignbyte_b32 v115, v115, v114, 1
    v_perm_b32 v114, v114, v118, s47
    v_subrev_u32 v126, 3, v126
    s_mov_b64 exec, -1

    buffer_store_dwordx2 v[114:115], v126, s[24:27], 0 offen
    v_cmp_ne_u32_sdwa s[70:71], v121, v123 src0_sel:WORD_1 src1_sel:WORD_1
    v_cmp_ne_u32_sdwa vcc, v121, v125 src0_sel:WORD_1 src1_sel:WORD_1
    v_perm_b32 v121, v122, v121, s45
    s_mov_b32 s54, 35840
    v_alignbyte_b32 v124, v125, v124, 2
    s_waitcnt lgkmcnt(0)
    v_add3_u32 v127, v127, v49, s54

    s_and_b64 vcc, vcc, s[70:71]
    s_cbranch_scc1 L_fix_24
L_back_25:
    s_mov_b64 exec, s[70:71]
    v_alignbyte_b32 v121, v121, v120, 1
    v_perm_b32 v120, v120, v124, s47
    v_subrev_u32 v127, 3, v127
    s_mov_b64 exec, -1

    buffer_store_dwordx2 v[120:121], v127, s[24:27], 0 offen
    s_waitcnt vmcnt(17)
    v_mul_hi_u32_u24 v67, s40, v30
    v_mul_hi_u32_u24 v66, s40, v12
    v_mul_hi_u32_u24 v69, s40, v31
    v_mul_hi_u32_u24 v68, s40, v13
    v_mul_hi_u32_u24 v71, s40, v32
    v_mul_hi_u32_u24 v70, s40, v14
    v_mul_hi_u32_u24 v73, s40, v33
    v_mul_hi_u32_u24 v72, s40, v15
    v_and_b32 v67, -2, v67
    v_mad_u32_u24 v12, v66, s43, v12
    v_and_b32 v66, -4, v66
    v_and_b32 v69, -2, v69
    v_mad_u32_u24 v13, v68, s43, v13
    v_and_b32 v68, -4, v68
    v_and_b32 v71, -2, v71
    v_mad_u32_u24 v14, v70, s43, v14
    v_and_b32 v70, -4, v70
    v_and_b32 v73, -2, v73
    v_mad_u32_u24 v15, v72, s43, v15
    v_and_b32 v72, -4, v72
    v_mad_i32_i24 v30, v67, s42, v30
    v_lshl_add_u32 v67, v66, 5, v67
    v_mad_i32_i24 v31, v69, s42, v31
    v_lshl_add_u32 v69, v68, 5, v69
    v_mad_i32_i24 v32, v71, s42, v32
    v_lshl_add_u32 v71, v70, 5, v71
    v_mad_i32_i24 v33, v73, s42, v33
    v_lshl_add_u32 v73, v72, 5, v73
    v_add_u32 v67, v67, v67
    ds_add_rtn_u32 v94, v67, v104
    v_add_u32 v69, v69, v69
    ds_add_rtn_u32 v95, v69, v104
    v_add_u32 v71, v71, v71
    ds_add_rtn_u32 v96, v71, v104
    v_add_u32 v73, v73, v73
    ds_add_rtn_u32 v97, v73, v104
    v_lshlrev_b32 v114, 16, v44
    v_and_b32 v115, 0xffff0000, v44
    v_lshlrev_b32 v116, 16, v45
    v_and_b32 v117, 0xffff0000, v45
    v_mul_f32 v114, s44, v114
    v_mul_f32 v115, s44, v115
    v_mul_f32 v116, s44, v116
    v_mul_f32 v117, s44, v117
    v_fract_f32 v114, v114
    v_fract_f32 v115, v115
    v_fract_f32 v116, v116
    v_fract_f32 v117, v117
    v_cos_f32 v114, v114
    v_cos_f32 v115, v115
    v_cos_f32 v116, v116
    v_cos_f32 v117, v117
    v_lshlrev_b32 v30, 3, v30
    v_lshlrev_b32 v31, 3, v31
    v_lshlrev_b32 v32, 3, v32
    v_lshlrev_b32 v33, 3, v33
    v_lshl_or_b32 v66, v12, 17, v30
    v_lshl_or_b32 v68, v13, 17, v31
    v_lshl_or_b32 v70, v14, 17, v32
    v_lshl_or_b32 v72, v15, 17, v33
    v_fmaak_f32 v114, v114, v105, 0x4b000c00
    v_fmaak_f32 v115, v115, v105, 0x4b000c00
    v_fmaak_f32 v116, v116, v105, 0x4b000c00
    v_fmaak_f32 v117, v117, v105, 0x4b000c00
    v_perm_b32 v67, v67, v114, s46
    v_bfe_u32 v114, v114, 8, 4
    v_perm_b32 v69, v69, v115, s46
    v_bfe_u32 v115, v115, 8, 4
    v_perm_b32 v71, v71, v116, s46
    v_bfe_u32 v116, v116, 8, 4
    v_perm_b32 v73, v73, v117, s46
    v_bfe_u32 v117, v117, 8, 4
    v_add_u32 v66, v66, v114
    v_add_u32 v68, v68, v115
    v_add_u32 v70, v70, v116
    v_add_u32 v72, v72, v117
    ds_read_b64 v[114:115], v112 offset:16400
    ds_read_b64 v[116:117], v112 offset:16408
    ds_read_b64 v[118:119], v112 offset:16392

    ds_read_b64 v[120:121], v112 offset:24592
    ds_read_b64 v[122:123], v112 offset:24600
    ds_read_b64 v[124:125], v112 offset:24584

    s_waitcnt lgkmcnt(3)
    v_lshrrev_b32 v126, 16, v115
    ds_read_b32 v126, v126 offset:8192

    s_waitcnt lgkmcnt(1)
    v_lshrrev_b32 v127, 16, v121
    ds_read_b32 v127, v127 offset:8192

    v_cmp_ne_u32_sdwa s[70:71], v115, v117 src0_sel:WORD_1 src1_sel:WORD_1
    v_cmp_ne_u32_sdwa vcc, v115, v119 src0_sel:WORD_1 src1_sel:WORD_1
    v_perm_b32 v115, v116, v115, s45
    s_mov_b32 s54, 40960
    v_alignbyte_b32 v118, v119, v118, 2
    s_waitcnt lgkmcnt(1)
    v_add3_u32 v126, v126, v49, s54

    s_and_b64 vcc, vcc, s[70:71]
    s_cbranch_scc1 L_fix_26
L_back_27:
    s_mov_b64 exec, s[70:71]
    v_alignbyte_b32 v115, v115, v114, 1
    v_perm_b32 v114, v114, v118, s47
    v_subrev_u32 v126, 3, v126
    s_mov_b64 exec, -1

    buffer_store_dwordx2 v[114:115], v126, s[24:27], 0 offen
    v_cmp_ne_u32_sdwa s[70:71], v121, v123 src0_sel:WORD_1 src1_sel:WORD_1
    v_cmp_ne_u32_sdwa vcc, v121, v125 src0_sel:WORD_1 src1_sel:WORD_1
    v_perm_b32 v121, v122, v121, s45
    s_mov_b32 s54, 46080
    v_alignbyte_b32 v124, v125, v124, 2
    s_waitcnt lgkmcnt(0)
    v_add3_u32 v127, v127, v49, s54

    s_and_b64 vcc, vcc, s[70:71]
    s_cbranch_scc1 L_fix_28
L_back_29:
    s_mov_b64 exec, s[70:71]
    v_alignbyte_b32 v121, v121, v120, 1
    v_perm_b32 v120, v120, v124, s47
    v_subrev_u32 v127, 3, v127
    s_mov_b64 exec, -1

    buffer_store_dwordx2 v[120:121], v127, s[24:27], 0 offen
    ds_read_b64 v[114:115], v112 offset:32784
    ds_read_b64 v[116:117], v112 offset:32792
    ds_read_b64 v[118:119], v112 offset:32776

    ds_read_b64 v[120:121], v112 offset:40976
    ds_read_b64 v[122:123], v112 offset:40984
    ds_read_b64 v[124:125], v112 offset:40968

    s_waitcnt lgkmcnt(3)
    v_lshrrev_b32 v126, 16, v115
    ds_read_b32 v126, v126 offset:8192

    s_waitcnt lgkmcnt(1)
    v_lshrrev_b32 v127, 16, v121
    ds_read_b32 v127, v127 offset:8192

    v_cmp_ne_u32_sdwa s[70:71], v115, v117 src0_sel:WORD_1 src1_sel:WORD_1
    v_cmp_ne_u32_sdwa vcc, v115, v119 src0_sel:WORD_1 src1_sel:WORD_1
    v_perm_b32 v115, v116, v115, s45
    s_mov_b32 s54, 51200
    v_alignbyte_b32 v118, v119, v118, 2
    s_waitcnt lgkmcnt(1)
    v_add3_u32 v126, v126, v49, s54

    s_and_b64 vcc, vcc, s[70:71]
    s_cbranch_scc1 L_fix_30
L_back_31:
    s_mov_b64 exec, s[70:71]
    v_alignbyte_b32 v115, v115, v114, 1
    v_perm_b32 v114, v114, v118, s47
    v_subrev_u32 v126, 3, v126
    s_mov_b64 exec, -1

    buffer_store_dwordx2 v[114:115], v126, s[24:27], 0 offen
    v_cmp_ne_u32_sdwa s[70:71], v121, v123 src0_sel:WORD_1 src1_sel:WORD_1
    v_cmp_ne_u32_sdwa vcc, v121, v125 src0_sel:WORD_1 src1_sel:WORD_1
    v_perm_b32 v121, v122, v121, s45
    s_mov_b32 s54, 56320
    v_alignbyte_b32 v124, v125, v124, 2
    s_waitcnt lgkmcnt(0)
    v_add3_u32 v127, v127, v49, s54

    s_and_b64 vcc, vcc, s[70:71]
    s_cbranch_scc1 L_fix_32
L_back_33:
    s_mov_b64 exec, s[70:71]
    v_alignbyte_b32 v121, v121, v120, 1
    v_perm_b32 v120, v120, v124, s47
    v_subrev_u32 v127, 3, v127
    s_mov_b64 exec, -1

    buffer_store_dwordx2 v[120:121], v127, s[24:27], 0 offen
    s_waitcnt vmcnt(18)
    v_mul_hi_u32_u24 v75, s40, v34
    v_mul_hi_u32_u24 v74, s40, v16
    v_mul_hi_u32_u24 v77, s40, v35
    v_mul_hi_u32_u24 v76, s40, v17
    v_mul_hi_u32_u24 v79, s40, v36
    v_mul_hi_u32_u24 v78, s40, v18
    v_mul_hi_u32_u24 v81, s40, v37
    v_mul_hi_u32_u24 v80, s40, v19
    v_and_b32 v75, -2, v75
    v_mad_u32_u24 v16, v74, s43, v16
    v_and_b32 v74, -4, v74
    v_and_b32 v77, -2, v77
    v_mad_u32_u24 v17, v76, s43, v17
    v_and_b32 v76, -4, v76
    v_and_b32 v79, -2, v79
    v_mad_u32_u24 v18, v78, s43, v18
    v_and_b32 v78, -4, v78
    v_and_b32 v81, -2, v81
    v_mad_u32_u24 v19, v80, s43, v19
    v_and_b32 v80, -4, v80
    v_mad_i32_i24 v34, v75, s42, v34
    v_lshl_add_u32 v75, v74, 5, v75
    v_mad_i32_i24 v35, v77, s42, v35
    v_lshl_add_u32 v77, v76, 5, v77
    v_mad_i32_i24 v36, v79, s42, v36
    v_lshl_add_u32 v79, v78, 5, v79
    v_mad_i32_i24 v37, v81, s42, v37
    v_lshl_add_u32 v81, v80, 5, v81
    v_add_u32 v75, v75, v75
    ds_add_rtn_u32 v98, v75, v104
    v_add_u32 v77, v77, v77
    ds_add_rtn_u32 v99, v77, v104
    v_add_u32 v79, v79, v79
    ds_add_rtn_u32 v100, v79, v104
    v_add_u32 v81, v81, v81
    ds_add_rtn_u32 v101, v81, v104
    v_lshlrev_b32 v114, 16, v46
    v_and_b32 v115, 0xffff0000, v46
    v_lshlrev_b32 v116, 16, v47
    v_and_b32 v117, 0xffff0000, v47
    v_mul_f32 v114, s44, v114
    v_mul_f32 v115, s44, v115
    v_mul_f32 v116, s44, v116
    v_mul_f32 v117, s44, v117
    v_fract_f32 v114, v114
    v_fract_f32 v115, v115
    v_fract_f32 v116, v116
    v_fract_f32 v117, v117
    v_cos_f32 v114, v114
    v_cos_f32 v115, v115
    v_cos_f32 v116, v116
    v_cos_f32 v117, v117
    v_lshlrev_b32 v34, 3, v34
    v_lshlrev_b32 v35, 3, v35
    v_lshlrev_b32 v36, 3, v36
    v_lshlrev_b32 v37, 3, v37
    v_lshl_or_b32 v74, v16, 17, v34
    v_lshl_or_b32 v76, v17, 17, v35
    v_lshl_or_b32 v78, v18, 17, v36
    v_lshl_or_b32 v80, v19, 17, v37
    v_fmaak_f32 v114, v114, v105, 0x4b000c00
    v_fmaak_f32 v115, v115, v105, 0x4b000c00
    v_fmaak_f32 v116, v116, v105, 0x4b000c00
    v_fmaak_f32 v117, v117, v105, 0x4b000c00
    v_perm_b32 v75, v75, v114, s46
    v_bfe_u32 v114, v114, 8, 4
    v_perm_b32 v77, v77, v115, s46
    v_bfe_u32 v115, v115, 8, 4
    v_perm_b32 v79, v79, v116, s46
    v_bfe_u32 v116, v116, 8, 4
    v_perm_b32 v81, v81, v117, s46
    v_bfe_u32 v117, v117, 8, 4
    v_add_u32 v74, v74, v114
    v_add_u32 v76, v76, v115
    v_add_u32 v78, v78, v116
    v_add_u32 v80, v80, v117
    ds_read_b64 v[114:115], v112 offset:49168
    ds_read_b64 v[116:117], v112 offset:49176
    ds_read_b64 v[118:119], v112 offset:49160

    ds_read_b64 v[120:121], v112 offset:57360
    ds_read_b64 v[122:123], v112 offset:57368
    ds_read_b64 v[124:125], v112 offset:57352

    s_waitcnt lgkmcnt(3)
    v_lshrrev_b32 v126, 16, v115
    ds_read_b32 v126, v126 offset:8192

    s_waitcnt lgkmcnt(1)
    v_lshrrev_b32 v127, 16, v121
    ds_read_b32 v127, v127 offset:8192

    v_cmp_ne_u32_sdwa s[70:71], v115, v117 src0_sel:WORD_1 src1_sel:WORD_1
    v_cmp_ne_u32_sdwa vcc, v115, v119 src0_sel:WORD_1 src1_sel:WORD_1
    v_perm_b32 v115, v116, v115, s45
    s_mov_b32 s54, 61440
    v_alignbyte_b32 v118, v119, v118, 2
    s_waitcnt lgkmcnt(1)
    v_add3_u32 v126, v126, v49, s54

    s_and_b64 vcc, vcc, s[70:71]
    s_cbranch_scc1 L_fix_34
L_back_35:
    s_mov_b64 exec, s[70:71]
    v_alignbyte_b32 v115, v115, v114, 1
    v_perm_b32 v114, v114, v118, s47
    v_subrev_u32 v126, 3, v126
    s_mov_b64 exec, -1

    buffer_store_dwordx2 v[114:115], v126, s[24:27], 0 offen
    v_cmp_ne_u32_sdwa s[70:71], v121, v123 src0_sel:WORD_1 src1_sel:WORD_1
    v_cmp_ne_u32_sdwa vcc, v121, v125 src0_sel:WORD_1 src1_sel:WORD_1
    v_perm_b32 v121, v122, v121, s45
    s_mov_b32 s54, 66560
    v_alignbyte_b32 v124, v125, v124, 2
    s_waitcnt lgkmcnt(0)
    v_add3_u32 v127, v127, v49, s54

    s_and_b64 vcc, vcc, s[70:71]
    s_cbranch_scc1 L_fix_36
L_back_37:
    s_mov_b64 exec, s[70:71]
    v_alignbyte_b32 v121, v121, v120, 1
    v_perm_b32 v120, v120, v124, s47
    v_subrev_u32 v127, 3, v127
    s_mov_b64 exec, -1

    buffer_store_dwordx2 v[120:121], v127, s[24:27], 0 offen
    v_add_u32 v112, 131072, v2
    ds_read_b64 v[114:115], v112 offset:16
    ds_read_b64 v[116:117], v112 offset:24
    ds_read_b64 v[118:119], v112 offset:8

    ds_read_b64 v[120:121], v112 offset:8208
    ds_read_b64 v[122:123], v112 offset:8216
    ds_read_b64 v[124:125], v112 offset:8200

    s_waitcnt lgkmcnt(3)
    v_lshrrev_b32 v126, 16, v115
    ds_read_b32 v126, v126 offset:8192

    s_waitcnt lgkmcnt(1)
    v_lshrrev_b32 v127, 16, v121
    ds_read_b32 v127, v127 offset:8192

    v_cmp_ne_u32_sdwa s[70:71], v115, v117 src0_sel:WORD_1 src1_sel:WORD_1
    v_cmp_ne_u32_sdwa vcc, v115, v119 src0_sel:WORD_1 src1_sel:WORD_1
    v_perm_b32 v115, v116, v115, s45
    s_mov_b32 s54, 71680
    v_alignbyte_b32 v118, v119, v118, 2
    s_waitcnt lgkmcnt(1)
    v_add3_u32 v126, v126, v49, s54

    s_and_b64 vcc, vcc, s[70:71]
    s_cbranch_scc1 L_fix_38
L_back_39:
    s_mov_b64 exec, s[70:71]
    v_alignbyte_b32 v115, v115, v114, 1
    v_perm_b32 v114, v114, v118, s47
    v_subrev_u32 v126, 3, v126
    s_mov_b64 exec, -1

    buffer_store_dwordx2 v[114:115], v126, s[24:27], 0 offen
    v_cmp_ne_u32_sdwa s[70:71], v121, v123 src0_sel:WORD_1 src1_sel:WORD_1
    v_cmp_ne_u32_sdwa vcc, v121, v125 src0_sel:WORD_1 src1_sel:WORD_1
    v_perm_b32 v121, v122, v121, s45
    s_mov_b32 s54, 76800
    v_alignbyte_b32 v124, v125, v124, 2
    s_waitcnt lgkmcnt(0)
    v_add3_u32 v127, v127, v49, s54

    s_and_b64 vcc, vcc, s[70:71]
    s_cbranch_scc1 L_fix_40
L_back_41:
    s_mov_b64 exec, s[70:71]
    v_alignbyte_b32 v121, v121, v120, 1
    v_perm_b32 v120, v120, v124, s47
    v_subrev_u32 v127, 3, v127
    s_mov_b64 exec, -1

    buffer_store_dwordx2 v[120:121], v127, s[24:27], 0 offen
    s_waitcnt vmcnt(19)
    s_mov_b64 exec, s[66:67]
    v_mul_hi_u32_u24 v83, s40, v38
    v_mul_hi_u32_u24 v82, s40, v20
    v_mul_hi_u32_u24 v85, s40, v39
    v_mul_hi_u32_u24 v84, s40, v21
    v_and_b32 v83, -2, v83
    v_mad_u32_u24 v20, v82, s43, v20
    v_and_b32 v82, -4, v82
    v_and_b32 v85, -2, v85
    v_mad_u32_u24 v21, v84, s43, v21
    v_and_b32 v84, -4, v84
    v_mad_i32_i24 v38, v83, s42, v38
    v_lshl_add_u32 v83, v82, 5, v83
    v_mad_i32_i24 v39, v85, s42, v39
    v_lshl_add_u32 v85, v84, 5, v85
    v_add_u32 v83, v83, v83
    ds_add_rtn_u32 v102, v83, v104
    v_add_u32 v85, v85, v85
    ds_add_rtn_u32 v103, v85, v104
    v_lshlrev_b32 v114, 16, v48
    v_and_b32 v115, 0xffff0000, v48
    v_mul_f32 v114, s44, v114
    v_mul_f32 v115, s44, v115
    v_fract_f32 v114, v114
    v_fract_f32 v115, v115
    v_cos_f32 v114, v114
    v_cos_f32 v115, v115
    v_lshlrev_b32 v38, 3, v38
    v_lshlrev_b32 v39, 3, v39
    v_lshl_or_b32 v82, v20, 17, v38
    v_lshl_or_b32 v84, v21, 17, v39
    s_mov_b64 exec, -1
    v_fmaak_f32 v114, v114, v105, 0x4b000c00
    v_fmaak_f32 v115, v115, v105, 0x4b000c00
    v_perm_b32 v83, v83, v114, s46
    v_bfe_u32 v114, v114, 8, 4
    v_perm_b32 v85, v85, v115, s46
    v_bfe_u32 v115, v115, 8, 4
    v_add_u32 v82, v82, v114
    v_add_u32 v84, v84, v115
    s_waitcnt lgkmcnt(0)
    s_barrier

    ds_read_b64 v[108:109], v2
    s_waitcnt lgkmcnt(0)
    v_and_b32 v108, 0xffff, v108
    v_and_b32 v109, 0xffff, v109
    v_mov_b32 v106, v108
    v_mov_b32 v107, v109
    v_add_u32 v111, v108, v109

    buffer_atomic_add_x2 v[106:107], v2, s[20:23], 0 offen sc0
    s_nop 1
    v_add_u32_dpp v111, v111, v111 row_shr:1 row_mask:0xf bank_mask:0xf
    s_nop 1
    v_add_u32_dpp v111, v111, v111 row_shr:2 row_mask:0xf bank_mask:0xf
    s_nop 1
    v_add_u32_dpp v111, v111, v111 row_shr:4 row_mask:0xf bank_mask:0xf
    s_nop 1
    v_add_u32_dpp v111, v111, v111 row_shr:8 row_mask:0xf bank_mask:0xf
    s_nop 1
    v_add_u32_dpp v111, v111, v111 row_bcast:15 row_mask:0xa bank_mask:0xf
    s_nop 1
    v_add_u32_dpp v111, v111, v111 row_bcast:31 row_mask:0xc bank_mask:0xf
    s_mov_b32 exec_lo, 0
    s_brev_b32 exec_hi, 1
    ds_add_rtn_u32 v110, v113, v111
    s_mov_b64 exec, -1

    ds_read_b64 v[114:115], v112 offset:16400
    ds_read_b64 v[116:117], v112 offset:16408
    ds_read_b64 v[118:119], v112 offset:16392

    ds_read_b64 v[120:121], v112 offset:24592
    ds_read_b64 v[122:123], v112 offset:24600
    ds_read_b64 v[124:125], v112 offset:24584

    s_waitcnt lgkmcnt(3)
    v_lshrrev_b32 v126, 16, v115
    ds_read_b32 v126, v126 offset:8192

    s_waitcnt lgkmcnt(1)
    v_lshrrev_b32 v127, 16, v121
    ds_read_b32 v127, v127 offset:8192

    v_cmp_ne_u32_sdwa s[70:71], v115, v117 src0_sel:WORD_1 src1_sel:WORD_1
    v_cmp_ne_u32_sdwa vcc, v115, v119 src0_sel:WORD_1 src1_sel:WORD_1
    v_perm_b32 v115, v116, v115, s45
    s_mov_b32 s54, 81920
    v_alignbyte_b32 v118, v119, v118, 2
    s_waitcnt lgkmcnt(1)
    v_add3_u32 v126, v126, v49, s54

    s_and_b64 vcc, vcc, s[70:71]
    s_cbranch_scc1 L_fix_42
L_back_43:
    s_mov_b64 exec, s[70:71]
    v_alignbyte_b32 v115, v115, v114, 1
    v_perm_b32 v114, v114, v118, s47
    v_subrev_u32 v126, 3, v126
    s_mov_b64 exec, -1

    buffer_store_dwordx2 v[114:115], v126, s[24:27], 0 offen
    v_cmp_ne_u32_sdwa s[70:71], v121, v123 src0_sel:WORD_1 src1_sel:WORD_1
    v_cmp_ne_u32_sdwa vcc, v121, v125 src0_sel:WORD_1 src1_sel:WORD_1
    v_perm_b32 v121, v122, v121, s45
    s_mov_b32 s54, 87040
    v_alignbyte_b32 v124, v125, v124, 2
    s_waitcnt lgkmcnt(0)
    v_add3_u32 v127, v127, v49, s54

    s_andn2_b64 exec, -1, s[68:69]
    v_bfrev_b32 v127, 1
    s_mov_b64 exec, -1
    s_and_b64 vcc, vcc, s[68:69]

    s_and_b64 vcc, vcc, s[70:71]
    s_cbranch_scc1 L_fix_44
L_back_45:
    s_mov_b64 exec, s[70:71]
    v_alignbyte_b32 v121, v121, v120, 1
    v_perm_b32 v120, v120, v124, s47
    v_subrev_u32 v127, 3, v127
    s_mov_b64 exec, -1

    buffer_store_dwordx2 v[120:121], v127, s[24:27], 0 offen
    s_waitcnt lgkmcnt(0)
    v_readlane_b32 s77, v110, 63
    v_mul_u32_u24 v116, 7936, v0
    v_sub_u32 v111, v111, v109
    s_sub_u32 s77, s77, s50
    v_add_u32 v111, s77, v111
    v_sub_u32 v110, v111, v108
    v_lshlrev_b32 v115, 16, v111
    v_lshlrev_b32 v114, 16, v110
    ds_write_b64 v2, v[114:115]
    v_sub_u32 v110, v116, v110
    v_sub_u32 v111, v116, v111
    v_add_u32 v111, s48, v111
    s_lshl_b32 s74, s51, 3
    v_mov_b32 v126, s74
    v_mov_b32 v127, -1

    s_waitcnt lgkmcnt(0)
    s_barrier

    s_mov_b64 exec, 1
    ds_write_b32 v126, v127 offset:16404
    s_mov_b64 exec, -1

    v_lshrrev_b32 v114, 16, v51
    ds_read_b32 v114, v114
    v_lshrrev_b32 v115, 16, v53
    ds_read_b32 v115, v115
    v_lshrrev_b32 v116, 16, v55
    ds_read_b32 v116, v116
    v_lshrrev_b32 v117, 16, v57
    ds_read_b32 v117, v117
    v_lshrrev_b32 v118, 16, v59
    ds_read_b32 v118, v118
    v_lshrrev_b32 v119, 16, v61
    ds_read_b32 v119, v119
    v_lshrrev_b32 v120, 16, v63
    ds_read_b32 v120, v120
    v_lshrrev_b32 v121, 16, v65
    ds_read_b32 v121, v121
    s_waitcnt lgkmcnt(7)
    v_add_u32_sdwa v114, v114, v86 dst_sel:DWORD dst_unused:UNUSED_PAD src0_sel:WORD_1 src1_sel:WORD_0
    v_lshlrev_b32 v114, 3, v114
    ds_write_b64 v114, v[50:51] offset:16400

    s_waitcnt lgkmcnt(7)
    v_add_u32_sdwa v115, v115, v87 dst_sel:DWORD dst_unused:UNUSED_PAD src0_sel:WORD_1 src1_sel:WORD_0
    v_lshlrev_b32 v115, 3, v115
    ds_write_b64 v115, v[52:53] offset:16400

    s_waitcnt lgkmcnt(7)
    v_add_u32_sdwa v116, v116, v88 dst_sel:DWORD dst_unused:UNUSED_PAD src0_sel:WORD_1 src1_sel:WORD_0
    v_lshlrev_b32 v116, 3, v116
    ds_write_b64 v116, v[54:55] offset:16400

    s_waitcnt lgkmcnt(7)
    v_add_u32_sdwa v117, v117, v89 dst_sel:DWORD dst_unused:UNUSED_PAD src0_sel:WORD_1 src1_sel:WORD_0
    v_lshlrev_b32 v117, 3, v117
    ds_write_b64 v117, v[56:57] offset:16400

    s_waitcnt lgkmcnt(7)
    v_add_u32_sdwa v118, v118, v90 dst_sel:DWORD dst_unused:UNUSED_PAD src0_sel:WORD_1 src1_sel:WORD_0
    v_lshlrev_b32 v118, 3, v118
    ds_write_b64 v118, v[58:59] offset:16400

    s_waitcnt lgkmcnt(7)
    v_add_u32_sdwa v119, v119, v91 dst_sel:DWORD dst_unused:UNUSED_PAD src0_sel:WORD_1 src1_sel:WORD_0
    v_lshlrev_b32 v119, 3, v119
    ds_write_b64 v119, v[60:61] offset:16400

    s_waitcnt lgkmcnt(7)
    v_add_u32_sdwa v120, v120, v92 dst_sel:DWORD dst_unused:UNUSED_PAD src0_sel:WORD_1 src1_sel:WORD_0
    v_lshlrev_b32 v120, 3, v120
    ds_write_b64 v120, v[62:63] offset:16400

    s_waitcnt lgkmcnt(7)
    v_add_u32_sdwa v121, v121, v93 dst_sel:DWORD dst_unused:UNUSED_PAD src0_sel:WORD_1 src1_sel:WORD_0
    v_lshlrev_b32 v121, 3, v121
    ds_write_b64 v121, v[64:65] offset:16400

    v_lshrrev_b32 v114, 16, v67
    ds_read_b32 v114, v114
    v_lshrrev_b32 v115, 16, v69
    ds_read_b32 v115, v115
    v_lshrrev_b32 v116, 16, v71
    ds_read_b32 v116, v116
    v_lshrrev_b32 v117, 16, v73
    ds_read_b32 v117, v117
    v_lshrrev_b32 v118, 16, v75
    ds_read_b32 v118, v118
    v_lshrrev_b32 v119, 16, v77
    ds_read_b32 v119, v119
    v_lshrrev_b32 v120, 16, v79
    ds_read_b32 v120, v120
    v_lshrrev_b32 v121, 16, v81
    ds_read_b32 v121, v121
    s_waitcnt lgkmcnt(7)
    v_add_u32_sdwa v114, v114, v94 dst_sel:DWORD dst_unused:UNUSED_PAD src0_sel:WORD_1 src1_sel:WORD_0
    v_lshlrev_b32 v114, 3, v114
    ds_write_b64 v114, v[66:67] offset:16400

    s_waitcnt lgkmcnt(7)
    v_add_u32_sdwa v115, v115, v95 dst_sel:DWORD dst_unused:UNUSED_PAD src0_sel:WORD_1 src1_sel:WORD_0
    v_lshlrev_b32 v115, 3, v115
    ds_write_b64 v115, v[68:69] offset:16400

    s_waitcnt lgkmcnt(7)
    v_add_u32_sdwa v116, v116, v96 dst_sel:DWORD dst_unused:UNUSED_PAD src0_sel:WORD_1 src1_sel:WORD_0
    v_lshlrev_b32 v116, 3, v116
    ds_write_b64 v116, v[70:71] offset:16400

    s_waitcnt lgkmcnt(7)
    v_add_u32_sdwa v117, v117, v97 dst_sel:DWORD dst_unused:UNUSED_PAD src0_sel:WORD_1 src1_sel:WORD_0
    v_lshlrev_b32 v117, 3, v117
    ds_write_b64 v117, v[72:73] offset:16400

    s_waitcnt lgkmcnt(7)
    v_add_u32_sdwa v118, v118, v98 dst_sel:DWORD dst_unused:UNUSED_PAD src0_sel:WORD_1 src1_sel:WORD_0
    v_lshlrev_b32 v118, 3, v118
    ds_write_b64 v118, v[74:75] offset:16400

    s_waitcnt lgkmcnt(7)
    v_add_u32_sdwa v119, v119, v99 dst_sel:DWORD dst_unused:UNUSED_PAD src0_sel:WORD_1 src1_sel:WORD_0
    v_lshlrev_b32 v119, 3, v119
    ds_write_b64 v119, v[76:77] offset:16400

    s_waitcnt lgkmcnt(7)
    v_add_u32_sdwa v120, v120, v100 dst_sel:DWORD dst_unused:UNUSED_PAD src0_sel:WORD_1 src1_sel:WORD_0
    v_lshlrev_b32 v120, 3, v120
    ds_write_b64 v120, v[78:79] offset:16400

    s_waitcnt lgkmcnt(7)
    v_add_u32_sdwa v121, v121, v101 dst_sel:DWORD dst_unused:UNUSED_PAD src0_sel:WORD_1 src1_sel:WORD_0
    v_lshlrev_b32 v121, 3, v121
    ds_write_b64 v121, v[80:81] offset:16400

    s_mov_b64 exec, s[66:67]
    v_lshrrev_b32 v114, 16, v83
    ds_read_b32 v114, v114
    v_lshrrev_b32 v115, 16, v85
    ds_read_b32 v115, v115
    s_waitcnt lgkmcnt(1)
    v_add_u32_sdwa v114, v114, v102 dst_sel:DWORD dst_unused:UNUSED_PAD src0_sel:WORD_1 src1_sel:WORD_0
    v_lshlrev_b32 v114, 3, v114
    ds_write_b64 v114, v[82:83] offset:16400

    s_waitcnt lgkmcnt(1)
    v_add_u32_sdwa v115, v115, v103 dst_sel:DWORD dst_unused:UNUSED_PAD src0_sel:WORD_1 src1_sel:WORD_0
    v_lshlrev_b32 v115, 3, v115
    ds_write_b64 v115, v[84:85] offset:16400

    s_mov_b64 exec, -1
    s_add_u32 s50, s50, s51
    s_add_u32 s49, s49, 1

    buffer_load_dwordx4 v[26:29], v1, s[12:15], s57 offen nt
    buffer_load_dwordx4 v[8:11], v1, s[8:11], s57 offen nt
    buffer_load_dwordx2 v[42:43], v2, s[16:19], s62 offen nt
    buffer_load_dwordx4 v[30:33], v1, s[12:15], s58 offen nt
    buffer_load_dwordx4 v[12:15], v1, s[8:11], s58 offen nt
    buffer_load_dwordx2 v[44:45], v2, s[16:19], s63 offen nt
    buffer_load_dwordx4 v[34:37], v1, s[12:15], s59 offen nt
    buffer_load_dwordx4 v[16:19], v1, s[8:11], s59 offen nt
    buffer_load_dwordx2 v[46:47], v2, s[16:19], s64 offen nt
    buffer_load_dwordx2 v[38:39], v2, s[12:15], s60 offen nt
    buffer_load_dwordx2 v[20:21], v2, s[8:11], s60 offen nt
    buffer_load_dword v48, v3, s[16:19], s65 offen nt
    s_cmp_lt_u32 s49, 10
    s_cbranch_scc1 L_p1loop_3
    s_mov_b32 s52, s51
    s_sub_u32 s51, 200000, s50
    s_min_u32 s51, s51, 18240
    s_sub_u32 s75, s51, 16384
    s_lshl_b32 s75, s75, 1
    v_cmp_gt_u32 s[66:67], s75, v3

    s_waitcnt vmcnt(31)
    v_mul_hi_u32_u24 v51, s40, v22
    v_mul_hi_u32_u24 v50, s40, v4
    v_mul_hi_u32_u24 v53, s40, v23
    v_mul_hi_u32_u24 v52, s40, v5
    v_mul_hi_u32_u24 v55, s40, v24
    v_mul_hi_u32_u24 v54, s40, v6
    v_mul_hi_u32_u24 v57, s40, v25
    v_mul_hi_u32_u24 v56, s40, v7
    v_and_b32 v51, -2, v51
    v_mad_u32_u24 v4, v50, s43, v4
    v_and_b32 v50, -4, v50
    v_and_b32 v53, -2, v53
    v_mad_u32_u24 v5, v52, s43, v5
    v_and_b32 v52, -4, v52
    v_and_b32 v55, -2, v55
    v_mad_u32_u24 v6, v54, s43, v6
    v_and_b32 v54, -4, v54
    v_and_b32 v57, -2, v57
    v_mad_u32_u24 v7, v56, s43, v7
    v_and_b32 v56, -4, v56
    v_mad_i32_i24 v22, v51, s42, v22
    v_lshl_add_u32 v51, v50, 5, v51
    v_mad_i32_i24 v23, v53, s42, v23
    v_lshl_add_u32 v53, v52, 5, v53
    v_mad_i32_i24 v24, v55, s42, v24
    v_lshl_add_u32 v55, v54, 5, v55
    v_mad_i32_i24 v25, v57, s42, v25
    v_lshl_add_u32 v57, v56, 5, v57
    v_add_u32 v51, v51, v51
    ds_add_rtn_u32 v86, v51, v104
    v_add_u32 v53, v53, v53
    ds_add_rtn_u32 v87, v53, v104
    v_add_u32 v55, v55, v55
    ds_add_rtn_u32 v88, v55, v104
    v_add_u32 v57, v57, v57
    ds_add_rtn_u32 v89, v57, v104
    v_lshlrev_b32 v114, 16, v40
    v_and_b32 v115, 0xffff0000, v40
    v_lshlrev_b32 v116, 16, v41
    v_and_b32 v117, 0xffff0000, v41
    v_mul_f32 v114, s44, v114
    v_mul_f32 v115, s44, v115
    v_mul_f32 v116, s44, v116
    v_mul_f32 v117, s44, v117
    v_fract_f32 v114, v114
    v_fract_f32 v115, v115
    v_fract_f32 v116, v116
    v_fract_f32 v117, v117
    v_cos_f32 v114, v114
    v_cos_f32 v115, v115
    v_cos_f32 v116, v116
    v_cos_f32 v117, v117
    v_lshlrev_b32 v22, 3, v22
    v_lshlrev_b32 v23, 3, v23
    v_lshlrev_b32 v24, 3, v24
    v_lshlrev_b32 v25, 3, v25
    v_lshl_or_b32 v50, v4, 17, v22
    v_lshl_or_b32 v52, v5, 17, v23
    v_lshl_or_b32 v54, v6, 17, v24
    v_lshl_or_b32 v56, v7, 17, v25
    v_fmaak_f32 v114, v114, v105, 0x4b000c00
    v_fmaak_f32 v115, v115, v105, 0x4b000c00
    v_fmaak_f32 v116, v116, v105, 0x4b000c00
    v_fmaak_f32 v117, v117, v105, 0x4b000c00
    v_perm_b32 v51, v51, v114, s46
    v_bfe_u32 v114, v114, 8, 4
    v_perm_b32 v53, v53, v115, s46
    v_bfe_u32 v115, v115, 8, 4
    v_perm_b32 v55, v55, v116, s46
    v_bfe_u32 v116, v116, 8, 4
    v_perm_b32 v57, v57, v117, s46
    v_bfe_u32 v117, v117, 8, 4
    v_add_u32 v50, v50, v114
    v_add_u32 v52, v52, v115
    v_add_u32 v54, v54, v116
    v_add_u32 v56, v56, v117
    s_waitcnt vmcnt(14)
    v_add_u32 v114, v106, v108
    v_add_u32 v115, v107, v109
    v_max_u32 v114, v114, v115
    v_cmp_lt_u32 vcc, s48, v114
    v_min_u32 v106, s48, v106
    v_min_u32 v107, s48, v107
    v_add_u32 v106, v106, v110
    v_add_u32 v107, v107, v111
    v_lshl_add_u32 v106, v106, 2, v106
    v_lshl_add_u32 v107, v107, 2, v107
    ds_write_b64 v2, v[106:107] offset:8192
    s_cbranch_vccz L_noov_46
    ds_write_b32 v113, v104 offset:4
L_noov_46:
    s_sub_u32 s74, s52, 17408
    s_max_i32 s74, s74, 0
    v_cmp_gt_u32 s[68:69], s74, v0
    s_waitcnt lgkmcnt(0)
    s_barrier
    ds_read_b32 v114, v113 offset:4
    s_waitcnt lgkmcnt(0)
    v_readfirstlane_b32 s53, v114
    s_nop 1
    s_cmp_lg_u32 s53, 0
    s_cbranch_scc1 L_slow_47
L_sback_48:

    ds_read_b64 v[114:115], v2 offset:16400
    ds_read_b64 v[116:117], v2 offset:16408
    ds_read_b64 v[118:119], v2 offset:16392

    ds_read_b64 v[120:121], v2 offset:24592
    ds_read_b64 v[122:123], v2 offset:24600
    ds_read_b64 v[124:125], v2 offset:24584

    s_waitcnt lgkmcnt(3)
    v_lshrrev_b32 v126, 16, v115
    ds_read_b32 v126, v126 offset:8192

    s_waitcnt lgkmcnt(1)
    v_lshrrev_b32 v127, 16, v121
    ds_read_b32 v127, v127 offset:8192

    v_cmp_ne_u32_sdwa s[70:71], v115, v117 src0_sel:WORD_1 src1_sel:WORD_1
    v_cmp_ne_u32_sdwa vcc, v115, v119 src0_sel:WORD_1 src1_sel:WORD_1
    v_perm_b32 v115, v116, v115, s45
    s_mov_b32 s54, 0
    v_alignbyte_b32 v118, v119, v118, 2
    s_waitcnt lgkmcnt(1)
    v_add3_u32 v126, v126, v49, s54

    s_and_b64 vcc, vcc, s[70:71]
    s_cbranch_scc1 L_fix_52
L_back_53:
    s_mov_b64 exec, s[70:71]
    v_alignbyte_b32 v115, v115, v114, 1
    v_perm_b32 v114, v114, v118, s47
    v_subrev_u32 v126, 3, v126
    s_mov_b64 exec, -1

    buffer_store_dwordx2 v[114:115], v126, s[24:27], 0 offen
    v_cmp_ne_u32_sdwa s[70:71], v121, v123 src0_sel:WORD_1 src1_sel:WORD_1
    v_cmp_ne_u32_sdwa vcc, v121, v125 src0_sel:WORD_1 src1_sel:WORD_1
    v_perm_b32 v121, v122, v121, s45
    s_mov_b32 s54, 5120
    v_alignbyte_b32 v124, v125, v124, 2
    s_waitcnt lgkmcnt(0)
    v_add3_u32 v127, v127, v49, s54

    s_and_b64 vcc, vcc, s[70:71]
    s_cbranch_scc1 L_fix_54
L_back_55:
    s_mov_b64 exec, s[70:71]
    v_alignbyte_b32 v121, v121, v120, 1
    v_perm_b32 v120, v120, v124, s47
    v_subrev_u32 v127, 3, v127
    s_mov_b64 exec, -1

    buffer_store_dwordx2 v[120:121], v127, s[24:27], 0 offen
    ds_read_b64 v[114:115], v2 offset:32784
    ds_read_b64 v[116:117], v2 offset:32792
    ds_read_b64 v[118:119], v2 offset:32776

    ds_read_b64 v[120:121], v2 offset:40976
    ds_read_b64 v[122:123], v2 offset:40984
    ds_read_b64 v[124:125], v2 offset:40968

    s_waitcnt lgkmcnt(3)
    v_lshrrev_b32 v126, 16, v115
    ds_read_b32 v126, v126 offset:8192

    s_waitcnt lgkmcnt(1)
    v_lshrrev_b32 v127, 16, v121
    ds_read_b32 v127, v127 offset:8192

    v_cmp_ne_u32_sdwa s[70:71], v115, v117 src0_sel:WORD_1 src1_sel:WORD_1
    v_cmp_ne_u32_sdwa vcc, v115, v119 src0_sel:WORD_1 src1_sel:WORD_1
    v_perm_b32 v115, v116, v115, s45
    s_mov_b32 s54, 10240
    v_alignbyte_b32 v118, v119, v118, 2
    s_waitcnt lgkmcnt(1)
    v_add3_u32 v126, v126, v49, s54

    s_and_b64 vcc, vcc, s[70:71]
    s_cbranch_scc1 L_fix_56
L_back_57:
    s_mov_b64 exec, s[70:71]
    v_alignbyte_b32 v115, v115, v114, 1
    v_perm_b32 v114, v114, v118, s47
    v_subrev_u32 v126, 3, v126
    s_mov_b64 exec, -1

    buffer_store_dwordx2 v[114:115], v126, s[24:27], 0 offen
    v_cmp_ne_u32_sdwa s[70:71], v121, v123 src0_sel:WORD_1 src1_sel:WORD_1
    v_cmp_ne_u32_sdwa vcc, v121, v125 src0_sel:WORD_1 src1_sel:WORD_1
    v_perm_b32 v121, v122, v121, s45
    s_mov_b32 s54, 15360
    v_alignbyte_b32 v124, v125, v124, 2
    s_waitcnt lgkmcnt(0)
    v_add3_u32 v127, v127, v49, s54

    s_and_b64 vcc, vcc, s[70:71]
    s_cbranch_scc1 L_fix_58
L_back_59:
    s_mov_b64 exec, s[70:71]
    v_alignbyte_b32 v121, v121, v120, 1
    v_perm_b32 v120, v120, v124, s47
    v_subrev_u32 v127, 3, v127
    s_mov_b64 exec, -1

    buffer_store_dwordx2 v[120:121], v127, s[24:27], 0 offen
    s_waitcnt vmcnt(13)
    v_mul_hi_u32_u24 v59, s40, v26
    v_mul_hi_u32_u24 v58, s40, v8
    v_mul_hi_u32_u24 v61, s40, v27
    v_mul_hi_u32_u24 v60, s40, v9
    v_mul_hi_u32_u24 v63, s40, v28
    v_mul_hi_u32_u24 v62, s40, v10
    v_mul_hi_u32_u24 v65, s40, v29
    v_mul_hi_u32_u24 v64, s40, v11
    v_and_b32 v59, -2, v59
    v_mad_u32_u24 v8, v58, s43, v8
    v_and_b32 v58, -4, v58
    v_and_b32 v61, -2, v61
    v_mad_u32_u24 v9, v60, s43, v9
    v_and_b32 v60, -4, v60
    v_and_b32 v63, -2, v63
    v_mad_u32_u24 v10, v62, s43, v10
    v_and_b32 v62, -4, v62
    v_and_b32 v65, -2, v65
    v_mad_u32_u24 v11, v64, s43, v11
    v_and_b32 v64, -4, v64
    v_mad_i32_i24 v26, v59, s42, v26
    v_lshl_add_u32 v59, v58, 5, v59
    v_mad_i32_i24 v27, v61, s42, v27
    v_lshl_add_u32 v61, v60, 5, v61
    v_mad_i32_i24 v28, v63, s42, v28
    v_lshl_add_u32 v63, v62, 5, v63
    v_mad_i32_i24 v29, v65, s42, v29
    v_lshl_add_u32 v65, v64, 5, v65
    v_add_u32 v59, v59, v59
    ds_add_rtn_u32 v90, v59, v104
    v_add_u32 v61, v61, v61
    ds_add_rtn_u32 v91, v61, v104
    v_add_u32 v63, v63, v63
    ds_add_rtn_u32 v92, v63, v104
    v_add_u32 v65, v65, v65
    ds_add_rtn_u32 v93, v65, v104
    v_lshlrev_b32 v114, 16, v42
    v_and_b32 v115, 0xffff0000, v42
    v_lshlrev_b32 v116, 16, v43
    v_and_b32 v117, 0xffff0000, v43
    v_mul_f32 v114, s44, v114
    v_mul_f32 v115, s44, v115
    v_mul_f32 v116, s44, v116
    v_mul_f32 v117, s44, v117
    v_fract_f32 v114, v114
    v_fract_f32 v115, v115
    v_fract_f32 v116, v116
    v_fract_f32 v117, v117
    v_cos_f32 v114, v114
    v_cos_f32 v115, v115
    v_cos_f32 v116, v116
    v_cos_f32 v117, v117
    v_lshlrev_b32 v26, 3, v26
    v_lshlrev_b32 v27, 3, v27
    v_lshlrev_b32 v28, 3, v28
    v_lshlrev_b32 v29, 3, v29
    v_lshl_or_b32 v58, v8, 17, v26
    v_lshl_or_b32 v60, v9, 17, v27
    v_lshl_or_b32 v62, v10, 17, v28
    v_lshl_or_b32 v64, v11, 17, v29
    v_fmaak_f32 v114, v114, v105, 0x4b000c00
    v_fmaak_f32 v115, v115, v105, 0x4b000c00
    v_fmaak_f32 v116, v116, v105, 0x4b000c00
    v_fmaak_f32 v117, v117, v105, 0x4b000c00
    v_perm_b32 v59, v59, v114, s46
    v_bfe_u32 v114, v114, 8, 4
    v_perm_b32 v61, v61, v115, s46
    v_bfe_u32 v115, v115, 8, 4
    v_perm_b32 v63, v63, v116, s46
    v_bfe_u32 v116, v116, 8, 4
    v_perm_b32 v65, v65, v117, s46
    v_bfe_u32 v117, v117, 8, 4
    v_add_u32 v58, v58, v114
    v_add_u32 v60, v60, v115
    v_add_u32 v62, v62, v116
    v_add_u32 v64, v64, v117
    ds_read_b64 v[114:115], v2 offset:49168
    ds_read_b64 v[116:117], v2 offset:49176
    ds_read_b64 v[118:119], v2 offset:49160

    ds_read_b64 v[120:121], v2 offset:57360
    ds_read_b64 v[122:123], v2 offset:57368
    ds_read_b64 v[124:125], v2 offset:57352

    s_waitcnt lgkmcnt(3)
    v_lshrrev_b32 v126, 16, v115
    ds_read_b32 v126, v126 offset:8192

    s_waitcnt lgkmcnt(1)
    v_lshrrev_b32 v127, 16, v121
    ds_read_b32 v127, v127 offset:8192

    v_cmp_ne_u32_sdwa s[70:71], v115, v117 src0_sel:WORD_1 src1_sel:WORD_1
    v_cmp_ne_u32_sdwa vcc, v115, v119 src0_sel:WORD_1 src1_sel:WORD_1
    v_perm_b32 v115, v116, v115, s45
    s_mov_b32 s54, 20480
    v_alignbyte_b32 v118, v119, v118, 2
    s_waitcnt lgkmcnt(1)
    v_add3_u32 v126, v126, v49, s54

    s_and_b64 vcc, vcc, s[70:71]
    s_cbranch_scc1 L_fix_60
L_back_61:
    s_mov_b64 exec, s[70:71]
    v_alignbyte_b32 v115, v115, v114, 1
    v_perm_b32 v114, v114, v118, s47
    v_subrev_u32 v126, 3, v126
    s_mov_b64 exec, -1

    buffer_store_dwordx2 v[114:115], v126, s[24:27], 0 offen
    v_cmp_ne_u32_sdwa s[70:71], v121, v123 src0_sel:WORD_1 src1_sel:WORD_1
    v_cmp_ne_u32_sdwa vcc, v121, v125 src0_sel:WORD_1 src1_sel:WORD_1
    v_perm_b32 v121, v122, v121, s45
    s_mov_b32 s54, 25600
    v_alignbyte_b32 v124, v125, v124, 2
    s_waitcnt lgkmcnt(0)
    v_add3_u32 v127, v127, v49, s54

    s_and_b64 vcc, vcc, s[70:71]
    s_cbranch_scc1 L_fix_62
L_back_63:
    s_mov_b64 exec, s[70:71]
    v_alignbyte_b32 v121, v121, v120, 1
    v_perm_b32 v120, v120, v124, s47
    v_subrev_u32 v127, 3, v127
    s_mov_b64 exec, -1

    buffer_store_dwordx2 v[120:121], v127, s[24:27], 0 offen
    v_add_u32 v112, 65536, v2
    ds_read_b64 v[114:115], v112 offset:16
    ds_read_b64 v[116:117], v112 offset:24
    ds_read_b64 v[118:119], v112 offset:8

    ds_read_b64 v[120:121], v112 offset:8208
    ds_read_b64 v[122:123], v112 offset:8216
    ds_read_b64 v[124:125], v112 offset:8200

    s_waitcnt lgkmcnt(3)
    v_lshrrev_b32 v126, 16, v115
    ds_read_b32 v126, v126 offset:8192

    s_waitcnt lgkmcnt(1)
    v_lshrrev_b32 v127, 16, v121
    ds_read_b32 v127, v127 offset:8192

    v_cmp_ne_u32_sdwa s[70:71], v115, v117 src0_sel:WORD_1 src1_sel:WORD_1
    v_cmp_ne_u32_sdwa vcc, v115, v119 src0_sel:WORD_1 src1_sel:WORD_1
    v_perm_b32 v115, v116, v115, s45
    s_mov_b32 s54, 30720
    v_alignbyte_b32 v118, v119, v118, 2
    s_waitcnt lgkmcnt(1)
    v_add3_u32 v126, v126, v49, s54

    s_and_b64 vcc, vcc, s[70:71]
    s_cbranch_scc1 L_fix_64
L_back_65:
    s_mov_b64 exec, s[70:71]
    v_alignbyte_b32 v115, v115, v114, 1
    v_perm_b32 v114, v114, v118, s47
    v_subrev_u32 v126, 3, v126
    s_mov_b64 exec, -1

    buffer_store_dwordx2 v[114:115], v126, s[24:27], 0 offen
    v_cmp_ne_u32_sdwa s[70:71], v121, v123 src0_sel:WORD_1 src1_sel:WORD_1
    v_cmp_ne_u32_sdwa vcc, v121, v125 src0_sel:WORD_1 src1_sel:WORD_1
    v_perm_b32 v121, v122, v121, s45
    s_mov_b32 s54, 35840
    v_alignbyte_b32 v124, v125, v124, 2
    s_waitcnt lgkmcnt(0)
    v_add3_u32 v127, v127, v49, s54

    s_and_b64 vcc, vcc, s[70:71]
    s_cbranch_scc1 L_fix_66
L_back_67:
    s_mov_b64 exec, s[70:71]
    v_alignbyte_b32 v121, v121, v120, 1
    v_perm_b32 v120, v120, v124, s47
    v_subrev_u32 v127, 3, v127
    s_mov_b64 exec, -1

    buffer_store_dwordx2 v[120:121], v127, s[24:27], 0 offen
    s_waitcnt vmcnt(14)
    v_mul_hi_u32_u24 v67, s40, v30
    v_mul_hi_u32_u24 v66, s40, v12
    v_mul_hi_u32_u24 v69, s40, v31
    v_mul_hi_u32_u24 v68, s40, v13
    v_mul_hi_u32_u24 v71, s40, v32
    v_mul_hi_u32_u24 v70, s40, v14
    v_mul_hi_u32_u24 v73, s40, v33
    v_mul_hi_u32_u24 v72, s40, v15
    v_and_b32 v67, -2, v67
    v_mad_u32_u24 v12, v66, s43, v12
    v_and_b32 v66, -4, v66
    v_and_b32 v69, -2, v69
    v_mad_u32_u24 v13, v68, s43, v13
    v_and_b32 v68, -4, v68
    v_and_b32 v71, -2, v71
    v_mad_u32_u24 v14, v70, s43, v14
    v_and_b32 v70, -4, v70
    v_and_b32 v73, -2, v73
    v_mad_u32_u24 v15, v72, s43, v15
    v_and_b32 v72, -4, v72
    v_mad_i32_i24 v30, v67, s42, v30
    v_lshl_add_u32 v67, v66, 5, v67
    v_mad_i32_i24 v31, v69, s42, v31
    v_lshl_add_u32 v69, v68, 5, v69
    v_mad_i32_i24 v32, v71, s42, v32
    v_lshl_add_u32 v71, v70, 5, v71
    v_mad_i32_i24 v33, v73, s42, v33
    v_lshl_add_u32 v73, v72, 5, v73
    v_add_u32 v67, v67, v67
    ds_add_rtn_u32 v94, v67, v104
    v_add_u32 v69, v69, v69
    ds_add_rtn_u32 v95, v69, v104
    v_add_u32 v71, v71, v71
    ds_add_rtn_u32 v96, v71, v104
    v_add_u32 v73, v73, v73
    ds_add_rtn_u32 v97, v73, v104
    v_lshlrev_b32 v114, 16, v44
    v_and_b32 v115, 0xffff0000, v44
    v_lshlrev_b32 v116, 16, v45
    v_and_b32 v117, 0xffff0000, v45
    v_mul_f32 v114, s44, v114
    v_mul_f32 v115, s44, v115
    v_mul_f32 v116, s44, v116
    v_mul_f32 v117, s44, v117
    v_fract_f32 v114, v114
    v_fract_f32 v115, v115
    v_fract_f32 v116, v116
    v_fract_f32 v117, v117
    v_cos_f32 v114, v114
    v_cos_f32 v115, v115
    v_cos_f32 v116, v116
    v_cos_f32 v117, v117
    v_lshlrev_b32 v30, 3, v30
    v_lshlrev_b32 v31, 3, v31
    v_lshlrev_b32 v32, 3, v32
    v_lshlrev_b32 v33, 3, v33
    v_lshl_or_b32 v66, v12, 17, v30
    v_lshl_or_b32 v68, v13, 17, v31
    v_lshl_or_b32 v70, v14, 17, v32
    v_lshl_or_b32 v72, v15, 17, v33
    v_fmaak_f32 v114, v114, v105, 0x4b000c00
    v_fmaak_f32 v115, v115, v105, 0x4b000c00
    v_fmaak_f32 v116, v116, v105, 0x4b000c00
    v_fmaak_f32 v117, v117, v105, 0x4b000c00
    v_perm_b32 v67, v67, v114, s46
    v_bfe_u32 v114, v114, 8, 4
    v_perm_b32 v69, v69, v115, s46
    v_bfe_u32 v115, v115, 8, 4
    v_perm_b32 v71, v71, v116, s46
    v_bfe_u32 v116, v116, 8, 4
    v_perm_b32 v73, v73, v117, s46
    v_bfe_u32 v117, v117, 8, 4
    v_add_u32 v66, v66, v114
    v_add_u32 v68, v68, v115
    v_add_u32 v70, v70, v116
    v_add_u32 v72, v72, v117
    ds_read_b64 v[114:115], v112 offset:16400
    ds_read_b64 v[116:117], v112 offset:16408
    ds_read_b64 v[118:119], v112 offset:16392

    ds_read_b64 v[120:121], v112 offset:24592
    ds_read_b64 v[122:123], v112 offset:24600
    ds_read_b64 v[124:125], v112 offset:24584

    s_waitcnt lgkmcnt(3)
    v_lshrrev_b32 v126, 16, v115
    ds_read_b32 v126, v126 offset:8192

    s_waitcnt lgkmcnt(1)
    v_lshrrev_b32 v127, 16, v121
    ds_read_b32 v127, v127 offset:8192

    v_cmp_ne_u32_sdwa s[70:71], v115, v117 src0_sel:WORD_1 src1_sel:WORD_1
    v_cmp_ne_u32_sdwa vcc, v115, v119 src0_sel:WORD_1 src1_sel:WORD_1
    v_perm_b32 v115, v116, v115, s45
    s_mov_b32 s54, 40960
    v_alignbyte_b32 v118, v119, v118, 2
    s_waitcnt lgkmcnt(1)
    v_add3_u32 v126, v126, v49, s54

    s_and_b64 vcc, vcc, s[70:71]
    s_cbranch_scc1 L_fix_68
L_back_69:
    s_mov_b64 exec, s[70:71]
    v_alignbyte_b32 v115, v115, v114, 1
    v_perm_b32 v114, v114, v118, s47
    v_subrev_u32 v126, 3, v126
    s_mov_b64 exec, -1

    buffer_store_dwordx2 v[114:115], v126, s[24:27], 0 offen
    v_cmp_ne_u32_sdwa s[70:71], v121, v123 src0_sel:WORD_1 src1_sel:WORD_1
    v_cmp_ne_u32_sdwa vcc, v121, v125 src0_sel:WORD_1 src1_sel:WORD_1
    v_perm_b32 v121, v122, v121, s45
    s_mov_b32 s54, 46080
    v_alignbyte_b32 v124, v125, v124, 2
    s_waitcnt lgkmcnt(0)
    v_add3_u32 v127, v127, v49, s54

    s_and_b64 vcc, vcc, s[70:71]
    s_cbranch_scc1 L_fix_70
L_back_71:
    s_mov_b64 exec, s[70:71]
    v_alignbyte_b32 v121, v121, v120, 1
    v_perm_b32 v120, v120, v124, s47
    v_subrev_u32 v127, 3, v127
    s_mov_b64 exec, -1

    buffer_store_dwordx2 v[120:121], v127, s[24:27], 0 offen
    ds_read_b64 v[114:115], v112 offset:32784
    ds_read_b64 v[116:117], v112 offset:32792
    ds_read_b64 v[118:119], v112 offset:32776

    ds_read_b64 v[120:121], v112 offset:40976
    ds_read_b64 v[122:123], v112 offset:40984
    ds_read_b64 v[124:125], v112 offset:40968

    s_waitcnt lgkmcnt(3)
    v_lshrrev_b32 v126, 16, v115
    ds_read_b32 v126, v126 offset:8192

    s_waitcnt lgkmcnt(1)
    v_lshrrev_b32 v127, 16, v121
    ds_read_b32 v127, v127 offset:8192

    v_cmp_ne_u32_sdwa s[70:71], v115, v117 src0_sel:WORD_1 src1_sel:WORD_1
    v_cmp_ne_u32_sdwa vcc, v115, v119 src0_sel:WORD_1 src1_sel:WORD_1
    v_perm_b32 v115, v116, v115, s45
    s_mov_b32 s54, 51200
    v_alignbyte_b32 v118, v119, v118, 2
    s_waitcnt lgkmcnt(1)
    v_add3_u32 v126, v126, v49, s54

    s_and_b64 vcc, vcc, s[70:71]
    s_cbranch_scc1 L_fix_72
L_back_73:
    s_mov_b64 exec, s[70:71]
    v_alignbyte_b32 v115, v115, v114, 1
    v_perm_b32 v114, v114, v118, s47
    v_subrev_u32 v126, 3, v126
    s_mov_b64 exec, -1

    buffer_store_dwordx2 v[114:115], v126, s[24:27], 0 offen
    v_cmp_ne_u32_sdwa s[70:71], v121, v123 src0_sel:WORD_1 src1_sel:WORD_1
    v_cmp_ne_u32_sdwa vcc, v121, v125 src0_sel:WORD_1 src1_sel:WORD_1
    v_perm_b32 v121, v122, v121, s45
    s_mov_b32 s54, 56320
    v_alignbyte_b32 v124, v125, v124, 2
    s_waitcnt lgkmcnt(0)
    v_add3_u32 v127, v127, v49, s54

    s_and_b64 vcc, vcc, s[70:71]
    s_cbranch_scc1 L_fix_74
L_back_75:
    s_mov_b64 exec, s[70:71]
    v_alignbyte_b32 v121, v121, v120, 1
    v_perm_b32 v120, v120, v124, s47
    v_subrev_u32 v127, 3, v127
    s_mov_b64 exec, -1

    buffer_store_dwordx2 v[120:121], v127, s[24:27], 0 offen
    s_waitcnt vmcnt(15)
    v_mul_hi_u32_u24 v75, s40, v34
    v_mul_hi_u32_u24 v74, s40, v16
    v_mul_hi_u32_u24 v77, s40, v35
    v_mul_hi_u32_u24 v76, s40, v17
    v_mul_hi_u32_u24 v79, s40, v36
    v_mul_hi_u32_u24 v78, s40, v18
    v_mul_hi_u32_u24 v81, s40, v37
    v_mul_hi_u32_u24 v80, s40, v19
    v_and_b32 v75, -2, v75
    v_mad_u32_u24 v16, v74, s43, v16
    v_and_b32 v74, -4, v74
    v_and_b32 v77, -2, v77
    v_mad_u32_u24 v17, v76, s43, v17
    v_and_b32 v76, -4, v76
    v_and_b32 v79, -2, v79
    v_mad_u32_u24 v18, v78, s43, v18
    v_and_b32 v78, -4, v78
    v_and_b32 v81, -2, v81
    v_mad_u32_u24 v19, v80, s43, v19
    v_and_b32 v80, -4, v80
    v_mad_i32_i24 v34, v75, s42, v34
    v_lshl_add_u32 v75, v74, 5, v75
    v_mad_i32_i24 v35, v77, s42, v35
    v_lshl_add_u32 v77, v76, 5, v77
    v_mad_i32_i24 v36, v79, s42, v36
    v_lshl_add_u32 v79, v78, 5, v79
    v_mad_i32_i24 v37, v81, s42, v37
    v_lshl_add_u32 v81, v80, 5, v81
    v_add_u32 v75, v75, v75
    ds_add_rtn_u32 v98, v75, v104
    v_add_u32 v77, v77, v77
    ds_add_rtn_u32 v99, v77, v104
    v_add_u32 v79, v79, v79
    ds_add_rtn_u32 v100, v79, v104
    v_add_u32 v81, v81, v81
    ds_add_rtn_u32 v101, v81, v104
    v_lshlrev_b32 v114, 16, v46
    v_and_b32 v115, 0xffff0000, v46
    v_lshlrev_b32 v116, 16, v47
    v_and_b32 v117, 0xffff0000, v47
    v_mul_f32 v114, s44, v114
    v_mul_f32 v115, s44, v115
    v_mul_f32 v116, s44, v116
    v_mul_f32 v117, s44, v117
    v_fract_f32 v114, v114
    v_fract_f32 v115, v115
    v_fract_f32 v116, v116
    v_fract_f32 v117, v117
    v_cos_f32 v114, v114
    v_cos_f32 v115, v115
    v_cos_f32 v116, v116
    v_cos_f32 v117, v117
    v_lshlrev_b32 v34, 3, v34
    v_lshlrev_b32 v35, 3, v35
    v_lshlrev_b32 v36, 3, v36
    v_lshlrev_b32 v37, 3, v37
    v_lshl_or_b32 v74, v16, 17, v34
    v_lshl_or_b32 v76, v17, 17, v35
    v_lshl_or_b32 v78, v18, 17, v36
    v_lshl_or_b32 v80, v19, 17, v37
    v_fmaak_f32 v114, v114, v105, 0x4b000c00
    v_fmaak_f32 v115, v115, v105, 0x4b000c00
    v_fmaak_f32 v116, v116, v105, 0x4b000c00
    v_fmaak_f32 v117, v117, v105, 0x4b000c00
    v_perm_b32 v75, v75, v114, s46
    v_bfe_u32 v114, v114, 8, 4
    v_perm_b32 v77, v77, v115, s46
    v_bfe_u32 v115, v115, 8, 4
    v_perm_b32 v79, v79, v116, s46
    v_bfe_u32 v116, v116, 8, 4
    v_perm_b32 v81, v81, v117, s46
    v_bfe_u32 v117, v117, 8, 4
    v_add_u32 v74, v74, v114
    v_add_u32 v76, v76, v115
    v_add_u32 v78, v78, v116
    v_add_u32 v80, v80, v117
    ds_read_b64 v[114:115], v112 offset:49168
    ds_read_b64 v[116:117], v112 offset:49176
    ds_read_b64 v[118:119], v112 offset:49160

    ds_read_b64 v[120:121], v112 offset:57360
    ds_read_b64 v[122:123], v112 offset:57368
    ds_read_b64 v[124:125], v112 offset:57352

    s_waitcnt lgkmcnt(3)
    v_lshrrev_b32 v126, 16, v115
    ds_read_b32 v126, v126 offset:8192

    s_waitcnt lgkmcnt(1)
    v_lshrrev_b32 v127, 16, v121
    ds_read_b32 v127, v127 offset:8192

    v_cmp_ne_u32_sdwa s[70:71], v115, v117 src0_sel:WORD_1 src1_sel:WORD_1
    v_cmp_ne_u32_sdwa vcc, v115, v119 src0_sel:WORD_1 src1_sel:WORD_1
    v_perm_b32 v115, v116, v115, s45
    s_mov_b32 s54, 61440
    v_alignbyte_b32 v118, v119, v118, 2
    s_waitcnt lgkmcnt(1)
    v_add3_u32 v126, v126, v49, s54

    s_and_b64 vcc, vcc, s[70:71]
    s_cbranch_scc1 L_fix_76
L_back_77:
    s_mov_b64 exec, s[70:71]
    v_alignbyte_b32 v115, v115, v114, 1
    v_perm_b32 v114, v114, v118, s47
    v_subrev_u32 v126, 3, v126
    s_mov_b64 exec, -1

    buffer_store_dwordx2 v[114:115], v126, s[24:27], 0 offen
    v_cmp_ne_u32_sdwa s[70:71], v121, v123 src0_sel:WORD_1 src1_sel:WORD_1
    v_cmp_ne_u32_sdwa vcc, v121, v125 src0_sel:WORD_1 src1_sel:WORD_1
    v_perm_b32 v121, v122, v121, s45
    s_mov_b32 s54, 66560
    v_alignbyte_b32 v124, v125, v124, 2
    s_waitcnt lgkmcnt(0)
    v_add3_u32 v127, v127, v49, s54

    s_and_b64 vcc, vcc, s[70:71]
    s_cbranch_scc1 L_fix_78
L_back_79:
    s_mov_b64 exec, s[70:71]
    v_alignbyte_b32 v121, v121, v120, 1
    v_perm_b32 v120, v120, v124, s47
    v_subrev_u32 v127, 3, v127
    s_mov_b64 exec, -1

    buffer_store_dwordx2 v[120:121], v127, s[24:27], 0 offen
    v_add_u32 v112, 131072, v2
    ds_read_b64 v[114:115], v112 offset:16
    ds_read_b64 v[116:117], v112 offset:24
    ds_read_b64 v[118:119], v112 offset:8

    ds_read_b64 v[120:121], v112 offset:8208
    ds_read_b64 v[122:123], v112 offset:8216
    ds_read_b64 v[124:125], v112 offset:8200

    s_waitcnt lgkmcnt(3)
    v_lshrrev_b32 v126, 16, v115
    ds_read_b32 v126, v126 offset:8192

    s_waitcnt lgkmcnt(1)
    v_lshrrev_b32 v127, 16, v121
    ds_read_b32 v127, v127 offset:8192

    v_cmp_ne_u32_sdwa s[70:71], v115, v117 src0_sel:WORD_1 src1_sel:WORD_1
    v_cmp_ne_u32_sdwa vcc, v115, v119 src0_sel:WORD_1 src1_sel:WORD_1
    v_perm_b32 v115, v116, v115, s45
    s_mov_b32 s54, 71680
    v_alignbyte_b32 v118, v119, v118, 2
    s_waitcnt lgkmcnt(1)
    v_add3_u32 v126, v126, v49, s54

    s_and_b64 vcc, vcc, s[70:71]
    s_cbranch_scc1 L_fix_80
L_back_81:
    s_mov_b64 exec, s[70:71]
    v_alignbyte_b32 v115, v115, v114, 1
    v_perm_b32 v114, v114, v118, s47
    v_subrev_u32 v126, 3, v126
    s_mov_b64 exec, -1

    buffer_store_dwordx2 v[114:115], v126, s[24:27], 0 offen
    v_cmp_ne_u32_sdwa s[70:71], v121, v123 src0_sel:WORD_1 src1_sel:WORD_1
    v_cmp_ne_u32_sdwa vcc, v121, v125 src0_sel:WORD_1 src1_sel:WORD_1
    v_perm_b32 v121, v122, v121, s45
    s_mov_b32 s54, 76800
    v_alignbyte_b32 v124, v125, v124, 2
    s_waitcnt lgkmcnt(0)
    v_add3_u32 v127, v127, v49, s54

    s_and_b64 vcc, vcc, s[70:71]
    s_cbranch_scc1 L_fix_82
L_back_83:
    s_mov_b64 exec, s[70:71]
    v_alignbyte_b32 v121, v121, v120, 1
    v_perm_b32 v120, v120, v124, s47
    v_subrev_u32 v127, 3, v127
    s_mov_b64 exec, -1

    buffer_store_dwordx2 v[120:121], v127, s[24:27], 0 offen
    s_waitcnt vmcnt(16)
    s_mov_b64 exec, s[66:67]
    v_mul_hi_u32_u24 v83, s40, v38
    v_mul_hi_u32_u24 v82, s40, v20
    v_mul_hi_u32_u24 v85, s40, v39
    v_mul_hi_u32_u24 v84, s40, v21
    v_and_b32 v83, -2, v83
    v_mad_u32_u24 v20, v82, s43, v20
    v_and_b32 v82, -4, v82
    v_and_b32 v85, -2, v85
    v_mad_u32_u24 v21, v84, s43, v21
    v_and_b32 v84, -4, v84
    v_mad_i32_i24 v38, v83, s42, v38
    v_lshl_add_u32 v83, v82, 5, v83
    v_mad_i32_i24 v39, v85, s42, v39
    v_lshl_add_u32 v85, v84, 5, v85
    v_add_u32 v83, v83, v83
    ds_add_rtn_u32 v102, v83, v104
    v_add_u32 v85, v85, v85
    ds_add_rtn_u32 v103, v85, v104
    v_lshlrev_b32 v114, 16, v48
    v_and_b32 v115, 0xffff0000, v48
    v_mul_f32 v114, s44, v114
    v_mul_f32 v115, s44, v115
    v_fract_f32 v114, v114
    v_fract_f32 v115, v115
    v_cos_f32 v114, v114
    v_cos_f32 v115, v115
    v_lshlrev_b32 v38, 3, v38
    v_lshlrev_b32 v39, 3, v39
    v_lshl_or_b32 v82, v20, 17, v38
    v_lshl_or_b32 v84, v21, 17, v39
    s_mov_b64 exec, -1
    v_fmaak_f32 v114, v114, v105, 0x4b000c00
    v_fmaak_f32 v115, v115, v105, 0x4b000c00
    v_perm_b32 v83, v83, v114, s46
    v_bfe_u32 v114, v114, 8, 4
    v_perm_b32 v85, v85, v115, s46
    v_bfe_u32 v115, v115, 8, 4
    v_add_u32 v82, v82, v114
    v_add_u32 v84, v84, v115
    s_waitcnt lgkmcnt(0)
    s_barrier

    ds_read_b64 v[108:109], v2
    s_waitcnt lgkmcnt(0)
    v_and_b32 v108, 0xffff, v108
    v_and_b32 v109, 0xffff, v109
    v_mov_b32 v106, v108
    v_mov_b32 v107, v109
    v_add_u32 v111, v108, v109

    buffer_atomic_add_x2 v[106:107], v2, s[20:23], 0 offen sc0
    s_nop 1
    v_add_u32_dpp v111, v111, v111 row_shr:1 row_mask:0xf bank_mask:0xf
    s_nop 1
    v_add_u32_dpp v111, v111, v111 row_shr:2 row_mask:0xf bank_mask:0xf
    s_nop 1
    v_add_u32_dpp v111, v111, v111 row_shr:4 row_mask:0xf bank_mask:0xf
    s_nop 1
    v_add_u32_dpp v111, v111, v111 row_shr:8 row_mask:0xf bank_mask:0xf
    s_nop 1
    v_add_u32_dpp v111, v111, v111 row_bcast:15 row_mask:0xa bank_mask:0xf
    s_nop 1
    v_add_u32_dpp v111, v111, v111 row_bcast:31 row_mask:0xc bank_mask:0xf
    s_mov_b32 exec_lo, 0
    s_brev_b32 exec_hi, 1
    ds_add_rtn_u32 v110, v113, v111
    s_mov_b64 exec, -1

    ds_read_b64 v[114:115], v112 offset:16400
    ds_read_b64 v[116:117], v112 offset:16408
    ds_read_b64 v[118:119], v112 offset:16392

    ds_read_b64 v[120:121], v112 offset:24592
    ds_read_b64 v[122:123], v112 offset:24600
    ds_read_b64 v[124:125], v112 offset:24584

    s_waitcnt lgkmcnt(3)
    v_lshrrev_b32 v126, 16, v115
    ds_read_b32 v126, v126 offset:8192

    s_waitcnt lgkmcnt(1)
    v_lshrrev_b32 v127, 16, v121
    ds_read_b32 v127, v127 offset:8192

    v_cmp_ne_u32_sdwa s[70:71], v115, v117 src0_sel:WORD_1 src1_sel:WORD_1
    v_cmp_ne_u32_sdwa vcc, v115, v119 src0_sel:WORD_1 src1_sel:WORD_1
    v_perm_b32 v115, v116, v115, s45
    s_mov_b32 s54, 81920
    v_alignbyte_b32 v118, v119, v118, 2
    s_waitcnt lgkmcnt(1)
    v_add3_u32 v126, v126, v49, s54

    s_and_b64 vcc, vcc, s[70:71]
    s_cbranch_scc1 L_fix_84
L_back_85:
    s_mov_b64 exec, s[70:71]
    v_alignbyte_b32 v115, v115, v114, 1
    v_perm_b32 v114, v114, v118, s47
    v_subrev_u32 v126, 3, v126
    s_mov_b64 exec, -1

    buffer_store_dwordx2 v[114:115], v126, s[24:27], 0 offen
    v_cmp_ne_u32_sdwa s[70:71], v121, v123 src0_sel:WORD_1 src1_sel:WORD_1
    v_cmp_ne_u32_sdwa vcc, v121, v125 src0_sel:WORD_1 src1_sel:WORD_1
    v_perm_b32 v121, v122, v121, s45
    s_mov_b32 s54, 87040
    v_alignbyte_b32 v124, v125, v124, 2
    s_waitcnt lgkmcnt(0)
    v_add3_u32 v127, v127, v49, s54

    s_andn2_b64 exec, -1, s[68:69]
    v_bfrev_b32 v127, 1
    s_mov_b64 exec, -1
    s_and_b64 vcc, vcc, s[68:69]

    s_and_b64 vcc, vcc, s[70:71]
    s_cbranch_scc1 L_fix_86
L_back_87:
    s_mov_b64 exec, s[70:71]
    v_alignbyte_b32 v121, v121, v120, 1
    v_perm_b32 v120, v120, v124, s47
    v_subrev_u32 v127, 3, v127
    s_mov_b64 exec, -1

    buffer_store_dwordx2 v[120:121], v127, s[24:27], 0 offen
    s_waitcnt lgkmcnt(0)
    v_readlane_b32 s77, v110, 63
    v_mul_u32_u24 v116, 7936, v0
    v_sub_u32 v111, v111, v109
    s_sub_u32 s77, s77, s50
    v_add_u32 v111, s77, v111
    v_sub_u32 v110, v111, v108
    v_lshlrev_b32 v115, 16, v111
    v_lshlrev_b32 v114, 16, v110
    ds_write_b64 v2, v[114:115]
    v_sub_u32 v110, v116, v110
    v_sub_u32 v111, v116, v111
    v_add_u32 v111, s48, v111
    s_lshl_b32 s74, s51, 3
    v_mov_b32 v126, s74
    v_mov_b32 v127, -1

    s_waitcnt lgkmcnt(0)
    s_barrier

    s_mov_b64 exec, 1
    ds_write_b32 v126, v127 offset:16404
    s_mov_b64 exec, -1

    v_lshrrev_b32 v114, 16, v51
    ds_read_b32 v114, v114
    v_lshrrev_b32 v115, 16, v53
    ds_read_b32 v115, v115
    v_lshrrev_b32 v116, 16, v55
    ds_read_b32 v116, v116
    v_lshrrev_b32 v117, 16, v57
    ds_read_b32 v117, v117
    v_lshrrev_b32 v118, 16, v59
    ds_read_b32 v118, v118
    v_lshrrev_b32 v119, 16, v61
    ds_read_b32 v119, v119
    v_lshrrev_b32 v120, 16, v63
    ds_read_b32 v120, v120
    v_lshrrev_b32 v121, 16, v65
    ds_read_b32 v121, v121
    s_waitcnt lgkmcnt(7)
    v_add_u32_sdwa v114, v114, v86 dst_sel:DWORD dst_unused:UNUSED_PAD src0_sel:WORD_1 src1_sel:WORD_0
    v_lshlrev_b32 v114, 3, v114
    ds_write_b64 v114, v[50:51] offset:16400

    s_waitcnt lgkmcnt(7)
    v_add_u32_sdwa v115, v115, v87 dst_sel:DWORD dst_unused:UNUSED_PAD src0_sel:WORD_1 src1_sel:WORD_0
    v_lshlrev_b32 v115, 3, v115
    ds_write_b64 v115, v[52:53] offset:16400

    s_waitcnt lgkmcnt(7)
    v_add_u32_sdwa v116, v116, v88 dst_sel:DWORD dst_unused:UNUSED_PAD src0_sel:WORD_1 src1_sel:WORD_0
    v_lshlrev_b32 v116, 3, v116
    ds_write_b64 v116, v[54:55] offset:16400

    s_waitcnt lgkmcnt(7)
    v_add_u32_sdwa v117, v117, v89 dst_sel:DWORD dst_unused:UNUSED_PAD src0_sel:WORD_1 src1_sel:WORD_0
    v_lshlrev_b32 v117, 3, v117
    ds_write_b64 v117, v[56:57] offset:16400

    s_waitcnt lgkmcnt(7)
    v_add_u32_sdwa v118, v118, v90 dst_sel:DWORD dst_unused:UNUSED_PAD src0_sel:WORD_1 src1_sel:WORD_0
    v_lshlrev_b32 v118, 3, v118
    ds_write_b64 v118, v[58:59] offset:16400

    s_waitcnt lgkmcnt(7)
    v_add_u32_sdwa v119, v119, v91 dst_sel:DWORD dst_unused:UNUSED_PAD src0_sel:WORD_1 src1_sel:WORD_0
    v_lshlrev_b32 v119, 3, v119
    ds_write_b64 v119, v[60:61] offset:16400

    s_waitcnt lgkmcnt(7)
    v_add_u32_sdwa v120, v120, v92 dst_sel:DWORD dst_unused:UNUSED_PAD src0_sel:WORD_1 src1_sel:WORD_0
    v_lshlrev_b32 v120, 3, v120
    ds_write_b64 v120, v[62:63] offset:16400

    s_waitcnt lgkmcnt(7)
    v_add_u32_sdwa v121, v121, v93 dst_sel:DWORD dst_unused:UNUSED_PAD src0_sel:WORD_1 src1_sel:WORD_0
    v_lshlrev_b32 v121, 3, v121
    ds_write_b64 v121, v[64:65] offset:16400

    v_lshrrev_b32 v114, 16, v67
    ds_read_b32 v114, v114
    v_lshrrev_b32 v115, 16, v69
    ds_read_b32 v115, v115
    v_lshrrev_b32 v116, 16, v71
    ds_read_b32 v116, v116
    v_lshrrev_b32 v117, 16, v73
    ds_read_b32 v117, v117
    v_lshrrev_b32 v118, 16, v75
    ds_read_b32 v118, v118
    v_lshrrev_b32 v119, 16, v77
    ds_read_b32 v119, v119
    v_lshrrev_b32 v120, 16, v79
    ds_read_b32 v120, v120
    v_lshrrev_b32 v121, 16, v81
    ds_read_b32 v121, v121
    s_waitcnt lgkmcnt(7)
    v_add_u32_sdwa v114, v114, v94 dst_sel:DWORD dst_unused:UNUSED_PAD src0_sel:WORD_1 src1_sel:WORD_0
    v_lshlrev_b32 v114, 3, v114
    ds_write_b64 v114, v[66:67] offset:16400

    s_waitcnt lgkmcnt(7)
    v_add_u32_sdwa v115, v115, v95 dst_sel:DWORD dst_unused:UNUSED_PAD src0_sel:WORD_1 src1_sel:WORD_0
    v_lshlrev_b32 v115, 3, v115
    ds_write_b64 v115, v[68:69] offset:16400

    s_waitcnt lgkmcnt(7)
    v_add_u32_sdwa v116, v116, v96 dst_sel:DWORD dst_unused:UNUSED_PAD src0_sel:WORD_1 src1_sel:WORD_0
    v_lshlrev_b32 v116, 3, v116
    ds_write_b64 v116, v[70:71] offset:16400

    s_waitcnt lgkmcnt(7)
    v_add_u32_sdwa v117, v117, v97 dst_sel:DWORD dst_unused:UNUSED_PAD src0_sel:WORD_1 src1_sel:WORD_0
    v_lshlrev_b32 v117, 3, v117
    ds_write_b64 v117, v[72:73] offset:16400

    s_waitcnt lgkmcnt(7)
    v_add_u32_sdwa v118, v118, v98 dst_sel:DWORD dst_unused:UNUSED_PAD src0_sel:WORD_1 src1_sel:WORD_0
    v_lshlrev_b32 v118, 3, v118
    ds_write_b64 v118, v[74:75] offset:16400

    s_waitcnt lgkmcnt(7)
    v_add_u32_sdwa v119, v119, v99 dst_sel:DWORD dst_unused:UNUSED_PAD src0_sel:WORD_1 src1_sel:WORD_0
    v_lshlrev_b32 v119, 3, v119
    ds_write_b64 v119, v[76:77] offset:16400

    s_waitcnt lgkmcnt(7)
    v_add_u32_sdwa v120, v120, v100 dst_sel:DWORD dst_unused:UNUSED_PAD src0_sel:WORD_1 src1_sel:WORD_0
    v_lshlrev_b32 v120, 3, v120
    ds_write_b64 v120, v[78:79] offset:16400

    s_waitcnt lgkmcnt(7)
    v_add_u32_sdwa v121, v121, v101 dst_sel:DWORD dst_unused:UNUSED_PAD src0_sel:WORD_1 src1_sel:WORD_0
    v_lshlrev_b32 v121, 3, v121
    ds_write_b64 v121, v[80:81] offset:16400

    s_mov_b64 exec, s[66:67]
    v_lshrrev_b32 v114, 16, v83
    ds_read_b32 v114, v114
    v_lshrrev_b32 v115, 16, v85
    ds_read_b32 v115, v115
    s_waitcnt lgkmcnt(1)
    v_add_u32_sdwa v114, v114, v102 dst_sel:DWORD dst_unused:UNUSED_PAD src0_sel:WORD_1 src1_sel:WORD_0
    v_lshlrev_b32 v114, 3, v114
    ds_write_b64 v114, v[82:83] offset:16400

    s_waitcnt lgkmcnt(1)
    v_add_u32_sdwa v115, v115, v103 dst_sel:DWORD dst_unused:UNUSED_PAD src0_sel:WORD_1 src1_sel:WORD_0
    v_lshlrev_b32 v115, 3, v115
    ds_write_b64 v115, v[84:85] offset:16400

    s_mov_b64 exec, -1
    s_add_u32 s50, s50, s51
    s_add_u32 s49, s49, 1

    s_mov_b32 s52, s51
    s_waitcnt vmcnt(2)
    v_add_u32 v114, v106, v108
    v_add_u32 v115, v107, v109
    v_max_u32 v114, v114, v115
    v_cmp_lt_u32 vcc, s48, v114
    v_min_u32 v106, s48, v106
    v_min_u32 v107, s48, v107
    v_add_u32 v106, v106, v110
    v_add_u32 v107, v107, v111
    v_lshl_add_u32 v106, v106, 2, v106
    v_lshl_add_u32 v107, v107, 2, v107
    ds_write_b64 v2, v[106:107] offset:8192
    s_cbranch_vccz L_noov_88
    ds_write_b32 v113, v104 offset:4
L_noov_88:
    s_sub_u32 s74, s52, 17408
    s_max_i32 s74, s74, 0
    v_cmp_gt_u32 s[68:69], s74, v0
    s_waitcnt lgkmcnt(0)
    s_barrier
    ds_read_b32 v114, v113 offset:4
    s_waitcnt lgkmcnt(0)
    v_readfirstlane_b32 s53, v114
    s_nop 1
    s_cmp_lg_u32 s53, 0
    s_cbranch_scc1 L_slow_89
L_sback_90:

    ds_read_b64 v[114:115], v2 offset:16400
    ds_read_b64 v[116:117], v2 offset:16408
    ds_read_b64 v[118:119], v2 offset:16392

    ds_read_b64 v[120:121], v2 offset:24592
    ds_read_b64 v[122:123], v2 offset:24600
    ds_read_b64 v[124:125], v2 offset:24584

    s_waitcnt lgkmcnt(3)
    v_lshrrev_b32 v126, 16, v115
    ds_read_b32 v126, v126 offset:8192

    s_waitcnt lgkmcnt(1)
    v_lshrrev_b32 v127, 16, v121
    ds_read_b32 v127, v127 offset:8192

    v_cmp_ne_u32_sdwa s[70:71], v115, v117 src0_sel:WORD_1 src1_sel:WORD_1
    v_cmp_ne_u32_sdwa vcc, v115, v119 src0_sel:WORD_1 src1_sel:WORD_1
    v_perm_b32 v115, v116, v115, s45
    s_mov_b32 s54, 0
    v_alignbyte_b32 v118, v119, v118, 2
    s_waitcnt lgkmcnt(1)
    v_add3_u32 v126, v126, v49, s54

    s_and_b64 vcc, vcc, s[70:71]
    s_cbranch_scc1 L_fix_94
L_back_95:
    s_mov_b64 exec, s[70:71]
    v_alignbyte_b32 v115, v115, v114, 1
    v_perm_b32 v114, v114, v118, s47
    v_subrev_u32 v126, 3, v126
    s_mov_b64 exec, -1

    buffer_store_dwordx2 v[114:115], v126, s[24:27], 0 offen
    v_cmp_ne_u32_sdwa s[70:71], v121, v123 src0_sel:WORD_1 src1_sel:WORD_1
    v_cmp_ne_u32_sdwa vcc, v121, v125 src0_sel:WORD_1 src1_sel:WORD_1
    v_perm_b32 v121, v122, v121, s45
    s_mov_b32 s54, 5120
    v_alignbyte_b32 v124, v125, v124, 2
    s_waitcnt lgkmcnt(0)
    v_add3_u32 v127, v127, v49, s54

    s_and_b64 vcc, vcc, s[70:71]
    s_cbranch_scc1 L_fix_96
L_back_97:
    s_mov_b64 exec, s[70:71]
    v_alignbyte_b32 v121, v121, v120, 1
    v_perm_b32 v120, v120, v124, s47
    v_subrev_u32 v127, 3, v127
    s_mov_b64 exec, -1

    buffer_store_dwordx2 v[120:121], v127, s[24:27], 0 offen
    ds_read_b64 v[114:115], v2 offset:32784
    ds_read_b64 v[116:117], v2 offset:32792
    ds_read_b64 v[118:119], v2 offset:32776

    ds_read_b64 v[120:121], v2 offset:40976
    ds_read_b64 v[122:123], v2 offset:40984
    ds_read_b64 v[124:125], v2 offset:40968

    s_waitcnt lgkmcnt(3)
    v_lshrrev_b32 v126, 16, v115
    ds_read_b32 v126, v126 offset:8192

    s_waitcnt lgkmcnt(1)
    v_lshrrev_b32 v127, 16, v121
    ds_read_b32 v127, v127 offset:8192

    v_cmp_ne_u32_sdwa s[70:71], v115, v117 src0_sel:WORD_1 src1_sel:WORD_1
    v_cmp_ne_u32_sdwa vcc, v115, v119 src0_sel:WORD_1 src1_sel:WORD_1
    v_perm_b32 v115, v116, v115, s45
    s_mov_b32 s54, 10240
    v_alignbyte_b32 v118, v119, v118, 2
    s_waitcnt lgkmcnt(1)
    v_add3_u32 v126, v126, v49, s54

    s_and_b64 vcc, vcc, s[70:71]
    s_cbranch_scc1 L_fix_98
L_back_99:
    s_mov_b64 exec, s[70:71]
    v_alignbyte_b32 v115, v115, v114, 1
    v_perm_b32 v114, v114, v118, s47
    v_subrev_u32 v126, 3, v126
    s_mov_b64 exec, -1

    buffer_store_dwordx2 v[114:115], v126, s[24:27], 0 offen
    v_cmp_ne_u32_sdwa s[70:71], v121, v123 src0_sel:WORD_1 src1_sel:WORD_1
    v_cmp_ne_u32_sdwa vcc, v121, v125 src0_sel:WORD_1 src1_sel:WORD_1
    v_perm_b32 v121, v122, v121, s45
    s_mov_b32 s54, 15360
    v_alignbyte_b32 v124, v125, v124, 2
    s_waitcnt lgkmcnt(0)
    v_add3_u32 v127, v127, v49, s54

    s_and_b64 vcc, vcc, s[70:71]
    s_cbranch_scc1 L_fix_100
L_back_101:
    s_mov_b64 exec, s[70:71]
    v_alignbyte_b32 v121, v121, v120, 1
    v_perm_b32 v120, v120, v124, s47
    v_subrev_u32 v127, 3, v127
    s_mov_b64 exec, -1

    buffer_store_dwordx2 v[120:121], v127, s[24:27], 0 offen
    ds_read_b64 v[114:115], v2 offset:49168
    ds_read_b64 v[116:117], v2 offset:49176
    ds_read_b64 v[118:119], v2 offset:49160

    ds_read_b64 v[120:121], v2 offset:57360
    ds_read_b64 v[122:123], v2 offset:57368
    ds_read_b64 v[124:125], v2 offset:57352

    s_waitcnt lgkmcnt(3)
    v_lshrrev_b32 v126, 16, v115
    ds_read_b32 v126, v126 offset:8192

    s_waitcnt lgkmcnt(1)
    v_lshrrev_b32 v127, 16, v121
    ds_read_b32 v127, v127 offset:8192

    v_cmp_ne_u32_sdwa s[70:71], v115, v117 src0_sel:WORD_1 src1_sel:WORD_1
    v_cmp_ne_u32_sdwa vcc, v115, v119 src0_sel:WORD_1 src1_sel:WORD_1
    v_perm_b32 v115, v116, v115, s45
    s_mov_b32 s54, 20480
    v_alignbyte_b32 v118, v119, v118, 2
    s_waitcnt lgkmcnt(1)
    v_add3_u32 v126, v126, v49, s54

    s_and_b64 vcc, vcc, s[70:71]
    s_cbranch_scc1 L_fix_102
L_back_103:
    s_mov_b64 exec, s[70:71]
    v_alignbyte_b32 v115, v115, v114, 1
    v_perm_b32 v114, v114, v118, s47
    v_subrev_u32 v126, 3, v126
    s_mov_b64 exec, -1

    buffer_store_dwordx2 v[114:115], v126, s[24:27], 0 offen
    v_cmp_ne_u32_sdwa s[70:71], v121, v123 src0_sel:WORD_1 src1_sel:WORD_1
    v_cmp_ne_u32_sdwa vcc, v121, v125 src0_sel:WORD_1 src1_sel:WORD_1
    v_perm_b32 v121, v122, v121, s45
    s_mov_b32 s54, 25600
    v_alignbyte_b32 v124, v125, v124, 2
    s_waitcnt lgkmcnt(0)
    v_add3_u32 v127, v127, v49, s54

    s_and_b64 vcc, vcc, s[70:71]
    s_cbranch_scc1 L_fix_104
L_back_105:
    s_mov_b64 exec, s[70:71]
    v_alignbyte_b32 v121, v121, v120, 1
    v_perm_b32 v120, v120, v124, s47
    v_subrev_u32 v127, 3, v127
    s_mov_b64 exec, -1

    buffer_store_dwordx2 v[120:121], v127, s[24:27], 0 offen
    v_add_u32 v112, 65536, v2
    ds_read_b64 v[114:115], v112 offset:16
    ds_read_b64 v[116:117], v112 offset:24
    ds_read_b64 v[118:119], v112 offset:8

    ds_read_b64 v[120:121], v112 offset:8208
    ds_read_b64 v[122:123], v112 offset:8216
    ds_read_b64 v[124:125], v112 offset:8200

    s_waitcnt lgkmcnt(3)
    v_lshrrev_b32 v126, 16, v115
    ds_read_b32 v126, v126 offset:8192

    s_waitcnt lgkmcnt(1)
    v_lshrrev_b32 v127, 16, v121
    ds_read_b32 v127, v127 offset:8192

    v_cmp_ne_u32_sdwa s[70:71], v115, v117 src0_sel:WORD_1 src1_sel:WORD_1
    v_cmp_ne_u32_sdwa vcc, v115, v119 src0_sel:WORD_1 src1_sel:WORD_1
    v_perm_b32 v115, v116, v115, s45
    s_mov_b32 s54, 30720
    v_alignbyte_b32 v118, v119, v118, 2
    s_waitcnt lgkmcnt(1)
    v_add3_u32 v126, v126, v49, s54

    s_and_b64 vcc, vcc, s[70:71]
    s_cbranch_scc1 L_fix_106
L_back_107:
    s_mov_b64 exec, s[70:71]
    v_alignbyte_b32 v115, v115, v114, 1
    v_perm_b32 v114, v114, v118, s47
    v_subrev_u32 v126, 3, v126
    s_mov_b64 exec, -1

    buffer_store_dwordx2 v[114:115], v126, s[24:27], 0 offen
    v_cmp_ne_u32_sdwa s[70:71], v121, v123 src0_sel:WORD_1 src1_sel:WORD_1
    v_cmp_ne_u32_sdwa vcc, v121, v125 src0_sel:WORD_1 src1_sel:WORD_1
    v_perm_b32 v121, v122, v121, s45
    s_mov_b32 s54, 35840
    v_alignbyte_b32 v124, v125, v124, 2
    s_waitcnt lgkmcnt(0)
    v_add3_u32 v127, v127, v49, s54

    s_and_b64 vcc, vcc, s[70:71]
    s_cbranch_scc1 L_fix_108
L_back_109:
    s_mov_b64 exec, s[70:71]
    v_alignbyte_b32 v121, v121, v120, 1
    v_perm_b32 v120, v120, v124, s47
    v_subrev_u32 v127, 3, v127
    s_mov_b64 exec, -1

    buffer_store_dwordx2 v[120:121], v127, s[24:27], 0 offen
    ds_read_b64 v[114:115], v112 offset:16400
    ds_read_b64 v[116:117], v112 offset:16408
    ds_read_b64 v[118:119], v112 offset:16392

    ds_read_b64 v[120:121], v112 offset:24592
    ds_read_b64 v[122:123], v112 offset:24600
    ds_read_b64 v[124:125], v112 offset:24584

    s_waitcnt lgkmcnt(3)
    v_lshrrev_b32 v126, 16, v115
    ds_read_b32 v126, v126 offset:8192

    s_waitcnt lgkmcnt(1)
    v_lshrrev_b32 v127, 16, v121
    ds_read_b32 v127, v127 offset:8192

    v_cmp_ne_u32_sdwa s[70:71], v115, v117 src0_sel:WORD_1 src1_sel:WORD_1
    v_cmp_ne_u32_sdwa vcc, v115, v119 src0_sel:WORD_1 src1_sel:WORD_1
    v_perm_b32 v115, v116, v115, s45
    s_mov_b32 s54, 40960
    v_alignbyte_b32 v118, v119, v118, 2
    s_waitcnt lgkmcnt(1)
    v_add3_u32 v126, v126, v49, s54

    s_and_b64 vcc, vcc, s[70:71]
    s_cbranch_scc1 L_fix_110
L_back_111:
    s_mov_b64 exec, s[70:71]
    v_alignbyte_b32 v115, v115, v114, 1
    v_perm_b32 v114, v114, v118, s47
    v_subrev_u32 v126, 3, v126
    s_mov_b64 exec, -1

    buffer_store_dwordx2 v[114:115], v126, s[24:27], 0 offen
    v_cmp_ne_u32_sdwa s[70:71], v121, v123 src0_sel:WORD_1 src1_sel:WORD_1
    v_cmp_ne_u32_sdwa vcc, v121, v125 src0_sel:WORD_1 src1_sel:WORD_1
    v_perm_b32 v121, v122, v121, s45
    s_mov_b32 s54, 46080
    v_alignbyte_b32 v124, v125, v124, 2
    s_waitcnt lgkmcnt(0)
    v_add3_u32 v127, v127, v49, s54

    s_and_b64 vcc, vcc, s[70:71]
    s_cbranch_scc1 L_fix_112
L_back_113:
    s_mov_b64 exec, s[70:71]
    v_alignbyte_b32 v121, v121, v120, 1
    v_perm_b32 v120, v120, v124, s47
    v_subrev_u32 v127, 3, v127
    s_mov_b64 exec, -1

    buffer_store_dwordx2 v[120:121], v127, s[24:27], 0 offen
    ds_read_b64 v[114:115], v112 offset:32784
    ds_read_b64 v[116:117], v112 offset:32792
    ds_read_b64 v[118:119], v112 offset:32776

    ds_read_b64 v[120:121], v112 offset:40976
    ds_read_b64 v[122:123], v112 offset:40984
    ds_read_b64 v[124:125], v112 offset:40968

    s_waitcnt lgkmcnt(3)
    v_lshrrev_b32 v126, 16, v115
    ds_read_b32 v126, v126 offset:8192

    s_waitcnt lgkmcnt(1)
    v_lshrrev_b32 v127, 16, v121
    ds_read_b32 v127, v127 offset:8192

    v_cmp_ne_u32_sdwa s[70:71], v115, v117 src0_sel:WORD_1 src1_sel:WORD_1
    v_cmp_ne_u32_sdwa vcc, v115, v119 src0_sel:WORD_1 src1_sel:WORD_1
    v_perm_b32 v115, v116, v115, s45
    s_mov_b32 s54, 51200
    v_alignbyte_b32 v118, v119, v118, 2
    s_waitcnt lgkmcnt(1)
    v_add3_u32 v126, v126, v49, s54

    s_and_b64 vcc, vcc, s[70:71]
    s_cbranch_scc1 L_fix_114
L_back_115:
    s_mov_b64 exec, s[70:71]
    v_alignbyte_b32 v115, v115, v114, 1
    v_perm_b32 v114, v114, v118, s47
    v_subrev_u32 v126, 3, v126
    s_mov_b64 exec, -1

    buffer_store_dwordx2 v[114:115], v126, s[24:27], 0 offen
    v_cmp_ne_u32_sdwa s[70:71], v121, v123 src0_sel:WORD_1 src1_sel:WORD_1
    v_cmp_ne_u32_sdwa vcc, v121, v125 src0_sel:WORD_1 src1_sel:WORD_1
    v_perm_b32 v121, v122, v121, s45
    s_mov_b32 s54, 56320
    v_alignbyte_b32 v124, v125, v124, 2
    s_waitcnt lgkmcnt(0)
    v_add3_u32 v127, v127, v49, s54

    s_and_b64 vcc, vcc, s[70:71]
    s_cbranch_scc1 L_fix_116
L_back_117:
    s_mov_b64 exec, s[70:71]
    v_alignbyte_b32 v121, v121, v120, 1
    v_perm_b32 v120, v120, v124, s47
    v_subrev_u32 v127, 3, v127
    s_mov_b64 exec, -1

    buffer_store_dwordx2 v[120:121], v127, s[24:27], 0 offen
    ds_read_b64 v[114:115], v112 offset:49168
    ds_read_b64 v[116:117], v112 offset:49176
    ds_read_b64 v[118:119], v112 offset:49160

    ds_read_b64 v[120:121], v112 offset:57360
    ds_read_b64 v[122:123], v112 offset:57368
    ds_read_b64 v[124:125], v112 offset:57352

    s_waitcnt lgkmcnt(3)
    v_lshrrev_b32 v126, 16, v115
    ds_read_b32 v126, v126 offset:8192

    s_waitcnt lgkmcnt(1)
    v_lshrrev_b32 v127, 16, v121
    ds_read_b32 v127, v127 offset:8192

    v_cmp_ne_u32_sdwa s[70:71], v115, v117 src0_sel:WORD_1 src1_sel:WORD_1
    v_cmp_ne_u32_sdwa vcc, v115, v119 src0_sel:WORD_1 src1_sel:WORD_1
    v_perm_b32 v115, v116, v115, s45
    s_mov_b32 s54, 61440
    v_alignbyte_b32 v118, v119, v118, 2
    s_waitcnt lgkmcnt(1)
    v_add3_u32 v126, v126, v49, s54

    s_and_b64 vcc, vcc, s[70:71]
    s_cbranch_scc1 L_fix_118
L_back_119:
    s_mov_b64 exec, s[70:71]
    v_alignbyte_b32 v115, v115, v114, 1
    v_perm_b32 v114, v114, v118, s47
    v_subrev_u32 v126, 3, v126
    s_mov_b64 exec, -1

    buffer_store_dwordx2 v[114:115], v126, s[24:27], 0 offen
    v_cmp_ne_u32_sdwa s[70:71], v121, v123 src0_sel:WORD_1 src1_sel:WORD_1
    v_cmp_ne_u32_sdwa vcc, v121, v125 src0_sel:WORD_1 src1_sel:WORD_1
    v_perm_b32 v121, v122, v121, s45
    s_mov_b32 s54, 66560
    v_alignbyte_b32 v124, v125, v124, 2
    s_waitcnt lgkmcnt(0)
    v_add3_u32 v127, v127, v49, s54

    s_and_b64 vcc, vcc, s[70:71]
    s_cbranch_scc1 L_fix_120
L_back_121:
    s_mov_b64 exec, s[70:71]
    v_alignbyte_b32 v121, v121, v120, 1
    v_perm_b32 v120, v120, v124, s47
    v_subrev_u32 v127, 3, v127
    s_mov_b64 exec, -1

    buffer_store_dwordx2 v[120:121], v127, s[24:27], 0 offen
    v_add_u32 v112, 131072, v2
    ds_read_b64 v[114:115], v112 offset:16
    ds_read_b64 v[116:117], v112 offset:24
    ds_read_b64 v[118:119], v112 offset:8

    ds_read_b64 v[120:121], v112 offset:8208
    ds_read_b64 v[122:123], v112 offset:8216
    ds_read_b64 v[124:125], v112 offset:8200

    s_waitcnt lgkmcnt(3)
    v_lshrrev_b32 v126, 16, v115
    ds_read_b32 v126, v126 offset:8192

    s_waitcnt lgkmcnt(1)
    v_lshrrev_b32 v127, 16, v121
    ds_read_b32 v127, v127 offset:8192

    v_cmp_ne_u32_sdwa s[70:71], v115, v117 src0_sel:WORD_1 src1_sel:WORD_1
    v_cmp_ne_u32_sdwa vcc, v115, v119 src0_sel:WORD_1 src1_sel:WORD_1
    v_perm_b32 v115, v116, v115, s45
    s_mov_b32 s54, 71680
    v_alignbyte_b32 v118, v119, v118, 2
    s_waitcnt lgkmcnt(1)
    v_add3_u32 v126, v126, v49, s54

    s_and_b64 vcc, vcc, s[70:71]
    s_cbranch_scc1 L_fix_122
L_back_123:
    s_mov_b64 exec, s[70:71]
    v_alignbyte_b32 v115, v115, v114, 1
    v_perm_b32 v114, v114, v118, s47
    v_subrev_u32 v126, 3, v126
    s_mov_b64 exec, -1

    buffer_store_dwordx2 v[114:115], v126, s[24:27], 0 offen
    v_cmp_ne_u32_sdwa s[70:71], v121, v123 src0_sel:WORD_1 src1_sel:WORD_1
    v_cmp_ne_u32_sdwa vcc, v121, v125 src0_sel:WORD_1 src1_sel:WORD_1
    v_perm_b32 v121, v122, v121, s45
    s_mov_b32 s54, 76800
    v_alignbyte_b32 v124, v125, v124, 2
    s_waitcnt lgkmcnt(0)
    v_add3_u32 v127, v127, v49, s54

    s_and_b64 vcc, vcc, s[70:71]
    s_cbranch_scc1 L_fix_124
L_back_125:
    s_mov_b64 exec, s[70:71]
    v_alignbyte_b32 v121, v121, v120, 1
    v_perm_b32 v120, v120, v124, s47
    v_subrev_u32 v127, 3, v127
    s_mov_b64 exec, -1

    buffer_store_dwordx2 v[120:121], v127, s[24:27], 0 offen
    ds_read_b64 v[114:115], v112 offset:16400
    ds_read_b64 v[116:117], v112 offset:16408
    ds_read_b64 v[118:119], v112 offset:16392

    ds_read_b64 v[120:121], v112 offset:24592
    ds_read_b64 v[122:123], v112 offset:24600
    ds_read_b64 v[124:125], v112 offset:24584

    s_waitcnt lgkmcnt(3)
    v_lshrrev_b32 v126, 16, v115
    ds_read_b32 v126, v126 offset:8192

    s_waitcnt lgkmcnt(1)
    v_lshrrev_b32 v127, 16, v121
    ds_read_b32 v127, v127 offset:8192

    v_cmp_ne_u32_sdwa s[70:71], v115, v117 src0_sel:WORD_1 src1_sel:WORD_1
    v_cmp_ne_u32_sdwa vcc, v115, v119 src0_sel:WORD_1 src1_sel:WORD_1
    v_perm_b32 v115, v116, v115, s45
    s_mov_b32 s54, 81920
    v_alignbyte_b32 v118, v119, v118, 2
    s_waitcnt lgkmcnt(1)
    v_add3_u32 v126, v126, v49, s54

    s_and_b64 vcc, vcc, s[70:71]
    s_cbranch_scc1 L_fix_126
L_back_127:
    s_mov_b64 exec, s[70:71]
    v_alignbyte_b32 v115, v115, v114, 1
    v_perm_b32 v114, v114, v118, s47
    v_subrev_u32 v126, 3, v126
    s_mov_b64 exec, -1

    buffer_store_dwordx2 v[114:115], v126, s[24:27], 0 offen
    v_cmp_ne_u32_sdwa s[70:71], v121, v123 src0_sel:WORD_1 src1_sel:WORD_1
    v_cmp_ne_u32_sdwa vcc, v121, v125 src0_sel:WORD_1 src1_sel:WORD_1
    v_perm_b32 v121, v122, v121, s45
    s_mov_b32 s54, 87040
    v_alignbyte_b32 v124, v125, v124, 2
    s_waitcnt lgkmcnt(0)
    v_add3_u32 v127, v127, v49, s54

    s_andn2_b64 exec, -1, s[68:69]
    v_bfrev_b32 v127, 1
    s_mov_b64 exec, -1
    s_and_b64 vcc, vcc, s[68:69]

    s_and_b64 vcc, vcc, s[70:71]
    s_cbranch_scc1 L_fix_128
L_back_129:
    s_mov_b64 exec, s[70:71]
    v_alignbyte_b32 v121, v121, v120, 1
    v_perm_b32 v120, v120, v124, s47
    v_subrev_u32 v127, 3, v127
    s_mov_b64 exec, -1

    buffer_store_dwordx2 v[120:121], v127, s[24:27], 0 offen
L_p1done_2:
    s_endpgm

L_slow_5:
    s_mov_b32 s26, 0
    v_mov_b32 v116, v0
    v_mov_b32 v122, 0
    s_mov_b32 s75, 4960
L_sl_7:
    v_lshlrev_b32 v117, 3, v116
    ds_read_b64 v[114:115], v117 offset:16400
    s_waitcnt lgkmcnt(0)
    v_lshrrev_b32 v118, 16, v115
    ds_read_b32 v119, v118 offset:8192
    v_add_u32 v118, 4, v118
    v_mul_u32_u24 v118, s75, v118
    s_waitcnt lgkmcnt(0)
    v_mad_u32_u24 v119, v116, 5, v119
    v_mov_b32 v120, 1
    v_cmp_gt_u32 s[72:73], s52, v116
    v_cmp_ge_u32 vcc, v119, v118
    s_and_b64 exec, vcc, s[72:73]
    s_cbranch_execz L_s1_8
    buffer_atomic_add v120, v122, s[36:39], 0 offen sc0
    s_waitcnt vmcnt(0)
    v_lshlrev_b32 v120, 3, v120
    buffer_store_dwordx2 v[114:115], v120, s[32:35], 0 offen
L_s1_8:
    s_andn2_b64 exec, s[72:73], vcc
    s_cbranch_execz L_s2_9
    buffer_store_dword v114, v119, s[28:31], 0 offen
    buffer_store_byte v115, v119, s[28:31], 0 offen offset:4
L_s2_9:
    s_mov_b64 exec, -1
    s_waitcnt vmcnt(0)
    v_add_u32 v116, 1024, v116
    s_nop 0
    v_readfirstlane_b32 s76, v116
    s_nop 1
    s_cmp_lt_u32 s76, s52
    s_cbranch_scc1 L_sl_7
    s_branch L_sback_6

L_fix_10:
    s_mov_b64 exec, vcc
    buffer_store_dword v114, v126, s[24:27], 0 offen
    buffer_store_byte v115, v126, s[24:27], 0 offen offset:4
    v_bfrev_b32 v126, 1
    s_branch L_back_11

L_fix_12:
    s_mov_b64 exec, vcc
    buffer_store_dword v120, v127, s[24:27], 0 offen
    buffer_store_byte v121, v127, s[24:27], 0 offen offset:4
    v_bfrev_b32 v127, 1
    s_branch L_back_13

L_fix_14:
    s_mov_b64 exec, vcc
    buffer_store_dword v114, v126, s[24:27], 0 offen
    buffer_store_byte v115, v126, s[24:27], 0 offen offset:4
    v_bfrev_b32 v126, 1
    s_branch L_back_15

L_fix_16:
    s_mov_b64 exec, vcc
    buffer_store_dword v120, v127, s[24:27], 0 offen
    buffer_store_byte v121, v127, s[24:27], 0 offen offset:4
    v_bfrev_b32 v127, 1
    s_branch L_back_17

L_fix_18:
    s_mov_b64 exec, vcc
    buffer_store_dword v114, v126, s[24:27], 0 offen
    buffer_store_byte v115, v126, s[24:27], 0 offen offset:4
    v_bfrev_b32 v126, 1
    s_branch L_back_19

L_fix_20:
    s_mov_b64 exec, vcc
    buffer_store_dword v120, v127, s[24:27], 0 offen
    buffer_store_byte v121, v127, s[24:27], 0 offen offset:4
    v_bfrev_b32 v127, 1
    s_branch L_back_21

L_fix_22:
    s_mov_b64 exec, vcc
    buffer_store_dword v114, v126, s[24:27], 0 offen
    buffer_store_byte v115, v126, s[24:27], 0 offen offset:4
    v_bfrev_b32 v126, 1
    s_branch L_back_23

L_fix_24:
    s_mov_b64 exec, vcc
    buffer_store_dword v120, v127, s[24:27], 0 offen
    buffer_store_byte v121, v127, s[24:27], 0 offen offset:4
    v_bfrev_b32 v127, 1
    s_branch L_back_25

L_fix_26:
    s_mov_b64 exec, vcc
    buffer_store_dword v114, v126, s[24:27], 0 offen
    buffer_store_byte v115, v126, s[24:27], 0 offen offset:4
    v_bfrev_b32 v126, 1
    s_branch L_back_27

L_fix_28:
    s_mov_b64 exec, vcc
    buffer_store_dword v120, v127, s[24:27], 0 offen
    buffer_store_byte v121, v127, s[24:27], 0 offen offset:4
    v_bfrev_b32 v127, 1
    s_branch L_back_29

L_fix_30:
    s_mov_b64 exec, vcc
    buffer_store_dword v114, v126, s[24:27], 0 offen
    buffer_store_byte v115, v126, s[24:27], 0 offen offset:4
    v_bfrev_b32 v126, 1
    s_branch L_back_31

L_fix_32:
    s_mov_b64 exec, vcc
    buffer_store_dword v120, v127, s[24:27], 0 offen
    buffer_store_byte v121, v127, s[24:27], 0 offen offset:4
    v_bfrev_b32 v127, 1
    s_branch L_back_33

L_fix_34:
    s_mov_b64 exec, vcc
    buffer_store_dword v114, v126, s[24:27], 0 offen
    buffer_store_byte v115, v126, s[24:27], 0 offen offset:4
    v_bfrev_b32 v126, 1
    s_branch L_back_35

L_fix_36:
    s_mov_b64 exec, vcc
    buffer_store_dword v120, v127, s[24:27], 0 offen
    buffer_store_byte v121, v127, s[24:27], 0 offen offset:4
    v_bfrev_b32 v127, 1
    s_branch L_back_37

L_fix_38:
    s_mov_b64 exec, vcc
    buffer_store_dword v114, v126, s[24:27], 0 offen
    buffer_store_byte v115, v126, s[24:27], 0 offen offset:4
    v_bfrev_b32 v126, 1
    s_branch L_back_39

L_fix_40:
    s_mov_b64 exec, vcc
    buffer_store_dword v120, v127, s[24:27], 0 offen
    buffer_store_byte v121, v127, s[24:27], 0 offen offset:4
    v_bfrev_b32 v127, 1
    s_branch L_back_41

L_fix_42:
    s_mov_b64 exec, vcc
    buffer_store_dword v114, v126, s[24:27], 0 offen
    buffer_store_byte v115, v126, s[24:27], 0 offen offset:4
    v_bfrev_b32 v126, 1
    s_branch L_back_43

L_fix_44:
    s_mov_b64 exec, vcc
    buffer_store_dword v120, v127, s[24:27], 0 offen
    buffer_store_byte v121, v127, s[24:27], 0 offen offset:4
    v_bfrev_b32 v127, 1
    s_branch L_back_45

L_slow_47:
    s_mov_b32 s26, 0
    v_mov_b32 v116, v0
    v_mov_b32 v122, 0
    s_mov_b32 s75, 4960
L_sl_49:
    v_lshlrev_b32 v117, 3, v116
    ds_read_b64 v[114:115], v117 offset:16400
    s_waitcnt lgkmcnt(0)
    v_lshrrev_b32 v118, 16, v115
    ds_read_b32 v119, v118 offset:8192
    v_add_u32 v118, 4, v118
    v_mul_u32_u24 v118, s75, v118
    s_waitcnt lgkmcnt(0)
    v_mad_u32_u24 v119, v116, 5, v119
    v_mov_b32 v120, 1
    v_cmp_gt_u32 s[72:73], s52, v116
    v_cmp_ge_u32 vcc, v119, v118
    s_and_b64 exec, vcc, s[72:73]
    s_cbranch_execz L_s1_50
    buffer_atomic_add v120, v122, s[36:39], 0 offen sc0
    s_waitcnt vmcnt(0)
    v_lshlrev_b32 v120, 3, v120
    buffer_store_dwordx2 v[114:115], v120, s[32:35], 0 offen
L_s1_50:
    s_andn2_b64 exec, s[72:73], vcc
    s_cbranch_execz L_s2_51
    buffer_store_dword v114, v119, s[28:31], 0 offen
    buffer_store_byte v115, v119, s[28:31], 0 offen offset:4
L_s2_51:
    s_mov_b64 exec, -1
    s_waitcnt vmcnt(0)
    v_add_u32 v116, 1024, v116
    s_nop 0
    v_readfirstlane_b32 s76, v116
    s_nop 1
    s_cmp_lt_u32 s76, s52
    s_cbranch_scc1 L_sl_49
    s_branch L_sback_48

L_fix_52:
    s_mov_b64 exec, vcc
    buffer_store_dword v114, v126, s[24:27], 0 offen
    buffer_store_byte v115, v126, s[24:27], 0 offen offset:4
    v_bfrev_b32 v126, 1
    s_branch L_back_53

L_fix_54:
    s_mov_b64 exec, vcc
    buffer_store_dword v120, v127, s[24:27], 0 offen
    buffer_store_byte v121, v127, s[24:27], 0 offen offset:4
    v_bfrev_b32 v127, 1
    s_branch L_back_55

L_fix_56:
    s_mov_b64 exec, vcc
    buffer_store_dword v114, v126, s[24:27], 0 offen
    buffer_store_byte v115, v126, s[24:27], 0 offen offset:4
    v_bfrev_b32 v126, 1
    s_branch L_back_57

L_fix_58:
    s_mov_b64 exec, vcc
    buffer_store_dword v120, v127, s[24:27], 0 offen
    buffer_store_byte v121, v127, s[24:27], 0 offen offset:4
    v_bfrev_b32 v127, 1
    s_branch L_back_59

L_fix_60:
    s_mov_b64 exec, vcc
    buffer_store_dword v114, v126, s[24:27], 0 offen
    buffer_store_byte v115, v126, s[24:27], 0 offen offset:4
    v_bfrev_b32 v126, 1
    s_branch L_back_61

L_fix_62:
    s_mov_b64 exec, vcc
    buffer_store_dword v120, v127, s[24:27], 0 offen
    buffer_store_byte v121, v127, s[24:27], 0 offen offset:4
    v_bfrev_b32 v127, 1
    s_branch L_back_63

L_fix_64:
    s_mov_b64 exec, vcc
    buffer_store_dword v114, v126, s[24:27], 0 offen
    buffer_store_byte v115, v126, s[24:27], 0 offen offset:4
    v_bfrev_b32 v126, 1
    s_branch L_back_65

L_fix_66:
    s_mov_b64 exec, vcc
    buffer_store_dword v120, v127, s[24:27], 0 offen
    buffer_store_byte v121, v127, s[24:27], 0 offen offset:4
    v_bfrev_b32 v127, 1
    s_branch L_back_67

L_fix_68:
    s_mov_b64 exec, vcc
    buffer_store_dword v114, v126, s[24:27], 0 offen
    buffer_store_byte v115, v126, s[24:27], 0 offen offset:4
    v_bfrev_b32 v126, 1
    s_branch L_back_69

L_fix_70:
    s_mov_b64 exec, vcc
    buffer_store_dword v120, v127, s[24:27], 0 offen
    buffer_store_byte v121, v127, s[24:27], 0 offen offset:4
    v_bfrev_b32 v127, 1
    s_branch L_back_71

L_fix_72:
    s_mov_b64 exec, vcc
    buffer_store_dword v114, v126, s[24:27], 0 offen
    buffer_store_byte v115, v126, s[24:27], 0 offen offset:4
    v_bfrev_b32 v126, 1
    s_branch L_back_73

L_fix_74:
    s_mov_b64 exec, vcc
    buffer_store_dword v120, v127, s[24:27], 0 offen
    buffer_store_byte v121, v127, s[24:27], 0 offen offset:4
    v_bfrev_b32 v127, 1
    s_branch L_back_75

L_fix_76:
    s_mov_b64 exec, vcc
    buffer_store_dword v114, v126, s[24:27], 0 offen
    buffer_store_byte v115, v126, s[24:27], 0 offen offset:4
    v_bfrev_b32 v126, 1
    s_branch L_back_77

L_fix_78:
    s_mov_b64 exec, vcc
    buffer_store_dword v120, v127, s[24:27], 0 offen
    buffer_store_byte v121, v127, s[24:27], 0 offen offset:4
    v_bfrev_b32 v127, 1
    s_branch L_back_79

L_fix_80:
    s_mov_b64 exec, vcc
    buffer_store_dword v114, v126, s[24:27], 0 offen
    buffer_store_byte v115, v126, s[24:27], 0 offen offset:4
    v_bfrev_b32 v126, 1
    s_branch L_back_81

L_fix_82:
    s_mov_b64 exec, vcc
    buffer_store_dword v120, v127, s[24:27], 0 offen
    buffer_store_byte v121, v127, s[24:27], 0 offen offset:4
    v_bfrev_b32 v127, 1
    s_branch L_back_83

L_fix_84:
    s_mov_b64 exec, vcc
    buffer_store_dword v114, v126, s[24:27], 0 offen
    buffer_store_byte v115, v126, s[24:27], 0 offen offset:4
    v_bfrev_b32 v126, 1
    s_branch L_back_85

L_fix_86:
    s_mov_b64 exec, vcc
    buffer_store_dword v120, v127, s[24:27], 0 offen
    buffer_store_byte v121, v127, s[24:27], 0 offen offset:4
    v_bfrev_b32 v127, 1
    s_branch L_back_87

L_slow_89:
    s_mov_b32 s26, 0
    v_mov_b32 v116, v0
    v_mov_b32 v122, 0
    s_mov_b32 s75, 4960
L_sl_91:
    v_lshlrev_b32 v117, 3, v116
    ds_read_b64 v[114:115], v117 offset:16400
    s_waitcnt lgkmcnt(0)
    v_lshrrev_b32 v118, 16, v115
    ds_read_b32 v119, v118 offset:8192
    v_add_u32 v118, 4, v118
    v_mul_u32_u24 v118, s75, v118
    s_waitcnt lgkmcnt(0)
    v_mad_u32_u24 v119, v116, 5, v119
    v_mov_b32 v120, 1
    v_cmp_gt_u32 s[72:73], s52, v116
    v_cmp_ge_u32 vcc, v119, v118
    s_and_b64 exec, vcc, s[72:73]
    s_cbranch_execz L_s1_92
    buffer_atomic_add v120, v122, s[36:39], 0 offen sc0
    s_waitcnt vmcnt(0)
    v_lshlrev_b32 v120, 3, v120
    buffer_store_dwordx2 v[114:115], v120, s[32:35], 0 offen
L_s1_92:
    s_andn2_b64 exec, s[72:73], vcc
    s_cbranch_execz L_s2_93
    buffer_store_dword v114, v119, s[28:31], 0 offen
    buffer_store_byte v115, v119, s[28:31], 0 offen offset:4
L_s2_93:
    s_mov_b64 exec, -1
    s_waitcnt vmcnt(0)
    v_add_u32 v116, 1024, v116
    s_nop 0
    v_readfirstlane_b32 s76, v116
    s_nop 1
    s_cmp_lt_u32 s76, s52
    s_cbranch_scc1 L_sl_91
    s_branch L_sback_90

L_fix_94:
    s_mov_b64 exec, vcc
    buffer_store_dword v114, v126, s[24:27], 0 offen
    buffer_store_byte v115, v126, s[24:27], 0 offen offset:4
    v_bfrev_b32 v126, 1
    s_branch L_back_95

L_fix_96:
    s_mov_b64 exec, vcc
    buffer_store_dword v120, v127, s[24:27], 0 offen
    buffer_store_byte v121, v127, s[24:27], 0 offen offset:4
    v_bfrev_b32 v127, 1
    s_branch L_back_97

L_fix_98:
    s_mov_b64 exec, vcc
    buffer_store_dword v114, v126, s[24:27], 0 offen
    buffer_store_byte v115, v126, s[24:27], 0 offen offset:4
    v_bfrev_b32 v126, 1
    s_branch L_back_99

L_fix_100:
    s_mov_b64 exec, vcc
    buffer_store_dword v120, v127, s[24:27], 0 offen
    buffer_store_byte v121, v127, s[24:27], 0 offen offset:4
    v_bfrev_b32 v127, 1
    s_branch L_back_101

L_fix_102:
    s_mov_b64 exec, vcc
    buffer_store_dword v114, v126, s[24:27], 0 offen
    buffer_store_byte v115, v126, s[24:27], 0 offen offset:4
    v_bfrev_b32 v126, 1
    s_branch L_back_103

L_fix_104:
    s_mov_b64 exec, vcc
    buffer_store_dword v120, v127, s[24:27], 0 offen
    buffer_store_byte v121, v127, s[24:27], 0 offen offset:4
    v_bfrev_b32 v127, 1
    s_branch L_back_105

L_fix_106:
    s_mov_b64 exec, vcc
    buffer_store_dword v114, v126, s[24:27], 0 offen
    buffer_store_byte v115, v126, s[24:27], 0 offen offset:4
    v_bfrev_b32 v126, 1
    s_branch L_back_107

L_fix_108:
    s_mov_b64 exec, vcc
    buffer_store_dword v120, v127, s[24:27], 0 offen
    buffer_store_byte v121, v127, s[24:27], 0 offen offset:4
    v_bfrev_b32 v127, 1
    s_branch L_back_109

L_fix_110:
    s_mov_b64 exec, vcc
    buffer_store_dword v114, v126, s[24:27], 0 offen
    buffer_store_byte v115, v126, s[24:27], 0 offen offset:4
    v_bfrev_b32 v126, 1
    s_branch L_back_111

L_fix_112:
    s_mov_b64 exec, vcc
    buffer_store_dword v120, v127, s[24:27], 0 offen
    buffer_store_byte v121, v127, s[24:27], 0 offen offset:4
    v_bfrev_b32 v127, 1
    s_branch L_back_113

L_fix_114:
    s_mov_b64 exec, vcc
    buffer_store_dword v114, v126, s[24:27], 0 offen
    buffer_store_byte v115, v126, s[24:27], 0 offen offset:4
    v_bfrev_b32 v126, 1
    s_branch L_back_115

L_fix_116:
    s_mov_b64 exec, vcc
    buffer_store_dword v120, v127, s[24:27], 0 offen
    buffer_store_byte v121, v127, s[24:27], 0 offen offset:4
    v_bfrev_b32 v127, 1
    s_branch L_back_117

L_fix_118:
    s_mov_b64 exec, vcc
    buffer_store_dword v114, v126, s[24:27], 0 offen
    buffer_store_byte v115, v126, s[24:27], 0 offen offset:4
    v_bfrev_b32 v126, 1
    s_branch L_back_119

L_fix_120:
    s_mov_b64 exec, vcc
    buffer_store_dword v120, v127, s[24:27], 0 offen
    buffer_store_byte v121, v127, s[24:27], 0 offen offset:4
    v_bfrev_b32 v127, 1
    s_branch L_back_121

L_fix_122:
    s_mov_b64 exec, vcc
    buffer_store_dword v114, v126, s[24:27], 0 offen
    buffer_store_byte v115, v126, s[24:27], 0 offen offset:4
    v_bfrev_b32 v126, 1
    s_branch L_back_123

L_fix_124:
    s_mov_b64 exec, vcc
    buffer_store_dword v120, v127, s[24:27], 0 offen
    buffer_store_byte v121, v127, s[24:27], 0 offen offset:4
    v_bfrev_b32 v127, 1
    s_branch L_back_125

L_fix_126:
    s_mov_b64 exec, vcc
    buffer_store_dword v114, v126, s[24:27], 0 offen
    buffer_store_byte v115, v126, s[24:27], 0 offen offset:4
    v_bfrev_b32 v126, 1
    s_branch L_back_127

L_fix_128:
    s_mov_b64 exec, vcc
    buffer_store_dword v120, v127, s[24:27], 0 offen
    buffer_store_byte v121, v127, s[24:27], 0 offen offset:4
    v_bfrev_b32 v127, 1
    s_branch L_back_129

.globl g2_kernel
.p2align 8
.type g2_kernel,@function
g2_kernel:
    s_cmp_ge_u32 s2, 256
    s_cbranch_scc1 L_p2done_130
    s_load_dwordx2 s[8:9], s[0:1], 0
    s_load_dwordx2 s[6:7], s[0:1], 104
    v_lshrrev_b32 v4, 6, v0
    v_lshlrev_b32 v5, 3, v0
    s_lshr_b32 s37, s2, 1
    s_and_b32 s37, s37, 3
    s_lshr_b32 s36, s2, 3
    s_lshl_b32 s36, s36, 1
    s_and_b32 s3, s2, 1
    s_or_b32 s36, s36, s3
    v_readfirstlane_b32 s4, v4
    v_and_b32 v2, 127, v0
    v_mul_u32_u24 v2, 20, v2
    v_lshlrev_b32 v3, 4, v0
    s_waitcnt lgkmcnt(0)
    s_lshr_b32 s5, s4, 1
    s_and_b32 s39, s4, 1
    s_lshl_b32 s39, s39, 8
    s_mul_i32 s3, s5, 8192
    s_add_u32 s46, s6, s3
    s_addc_u32 s47, s7, 0
    s_mul_i32 s3, s5, 40632320
    s_add_u32 s3, s3, 77848576
    s_add_u32 s44, s6, s3
    s_addc_u32 s45, s7, 0
    s_mul_i32 s38, s37, 8
    s_add_u32 s4, s38, 8
    s_lshl_b32 s3, s38, 6
    s_add_u32 s3, s3, s36
    s_lshl_b32 s3, s3, 2
    s_load_dword s41, s[46:47], s3
    s_mov_b32 s3, 131072
    s_load_dword s51, s[6:7], s3
    s_mov_b32 s10, 6400000
    s_mov_b32 s11, 0x20000

    s_add_u32 s20, s6, 135168
    s_addc_u32 s21, s7, 0
    s_mov_b32 s22, 8192
    s_mov_b32 s23, 0x20000
    buffer_load_dwordx2 v[118:119], v5, s[20:23], 0 offen
    s_mov_b32 s12, s8
    s_mov_b32 s13, s9
    s_mov_b32 s14, 0
    s_mov_b32 s15, 0x20000
    s_mul_i32 s43, s38, 200000
    s_add_u32 s14, s43, 50000
    buffer_load_dwordx4 v[76:79], v3, s[12:15], s43 offen
    s_add_u32 s52, s43, 16384
    buffer_load_dwordx4 v[80:83], v3, s[12:15], s52 offen
    s_add_u32 s52, s43, 32768
    buffer_load_dwordx4 v[84:87], v3, s[12:15], s52 offen
    s_add_u32 s52, s43, 49152
    v_lshlrev_b32 v125, 2, v0
    buffer_load_dword v88, v125, s[12:15], s52 offen
    s_lshr_b32 s3, s2, 3
    s_mul_i32 s3, s3, 49
    v_add_lshl_u32 v89, v0, s3, 7
    v_cmp_gt_u32 vcc, 49, v0
    v_bfrev_b32 v28, 1
    s_add_u32 s54, s43, 100000
    v_cndmask_b32 v89, v28, v89, vcc

    buffer_load_dword v116, v89, s[8:11], s54 offen
    s_mov_b32 s19, 0x20000
    s_mov_b32 s28, 0x4b404000
    s_mov_b32 s29, 0x4b404000
    s_mov_b32 s30, 0xbfffc000
    s_mov_b32 s31, 0xbfffbfff
    s_mov_b32 s32, 0xffff0000
    s_mov_b32 s35, 0x05040100
    s_mov_b32 s60, 0xff
    s_mov_b32 s61, 0xffff
    s_mov_b32 s62, 0xffffff
    s_movk_i32 s3, 212
    v_cmp_gt_u32 s[48:49], s3, v0

    v_mov_b32 v117, 0
    s_mov_b32 s24, 0xd0c0400
    s_mov_b32 s25, 0xd0c0401
    s_mov_b32 s26, 0xd0c0402
    s_mov_b32 s27, 0xd0c0403
    s_waitcnt lgkmcnt(0)
    s_min_u32 s41, s41, 3968
    s_lshl_b32 s52, s38, 6
    s_add_u32 s52, s52, s36
    s_mul_i32 s52, s52, 19840
    s_add_u32 s16, s44, s52
    s_addc_u32 s17, s45, 0
    s_mul_i32 s52, s41, 5
    s_add_u32 s52, s52, 3
    s_and_b32 s18, s52, -4

    s_movk_i32 s53, 0
    buffer_load_dwordx4 v[4:7], v2, s[16:19], s53 offen
    buffer_load_dword v106, v2, s[16:19], s53 offen offset:16
    s_movk_i32 s53, 2560
    buffer_load_dwordx4 v[8:11], v2, s[16:19], s53 offen
    buffer_load_dword v107, v2, s[16:19], s53 offen offset:16
    s_movk_i32 s53, 5120
    buffer_load_dwordx4 v[12:15], v2, s[16:19], s53 offen
    buffer_load_dword v108, v2, s[16:19], s53 offen offset:16
    s_movk_i32 s53, 7680
    buffer_load_dwordx4 v[90:93], v2, s[16:19], s53 offen
    buffer_load_dword v112, v2, s[16:19], s53 offen offset:16
    s_movk_i32 s53, 10240
    buffer_load_dwordx4 v[94:97], v2, s[16:19], s53 offen
    buffer_load_dword v113, v2, s[16:19], s53 offen offset:16
    s_movk_i32 s53, 12800
    buffer_load_dwordx4 v[98:101], v2, s[16:19], s53 offen
    buffer_load_dword v114, v2, s[16:19], s53 offen offset:16
    s_movk_i32 s53, 15360
    buffer_load_dwordx4 v[102:105], v2, s[16:19], s53 offen
    buffer_load_dword v115, v2, s[16:19], s53 offen offset:16
    v_mov_b32 v28, 0x40004000
    v_mov_b32 v29, 0x40004000
    v_mov_b32 v30, 0x40004000
    v_mov_b32 v31, 0x40004000
    v_add_u32 v32, 50000, v3
    v_add_u32 v33, 65536, v32

    ds_write_b128 v32, v[28:31] offset:0
    ds_write_b128 v32, v[28:31] offset:16384
    ds_write_b128 v32, v[28:31] offset:32768
    ds_write_b128 v32, v[28:31] offset:49152
    ds_write_b128 v33, v[28:31] offset:0
    ds_write_b128 v33, v[28:31] offset:16384
    v_cmp_gt_u32 vcc, 107, v0
    s_mov_b64 exec, vcc
    ds_write_b128 v33, v[28:31] offset:32768
    s_mov_b64 exec, -1
    v_mov_b32 v34, 150016
    v_mov_b32 v36, 0
    v_mov_b32 v37, 0
    v_mov_b32 v38, 0
    v_mov_b32 v39, 0
    ds_write_b128 v34, v[36:39]

    s_waitcnt vmcnt(19)
    s_nop 1
    v_max_u32_dpp v118, v118, v118 row_shr:1 row_mask:0xf bank_mask:0xf
    s_nop 1
    v_max_u32_dpp v118, v118, v118 row_shr:2 row_mask:0xf bank_mask:0xf
    s_nop 1
    v_max_u32_dpp v118, v118, v118 row_shr:4 row_mask:0xf bank_mask:0xf
    s_nop 1
    v_max_u32_dpp v118, v118, v118 row_shr:8 row_mask:0xf bank_mask:0xf
    s_nop 1
    v_max_u32_dpp v118, v118, v118 row_bcast:15 row_mask:0xa bank_mask:0xf
    s_nop 1
    v_max_u32_dpp v118, v118, v118 row_bcast:31 row_mask:0xc bank_mask:0xf
    s_nop 1
    v_add_f32_dpp v119, v119, v119 row_shr:1 row_mask:0xf bank_mask:0xf
    s_nop 1
    v_add_f32_dpp v119, v119, v119 row_shr:2 row_mask:0xf bank_mask:0xf
    s_nop 1
    v_add_f32_dpp v119, v119, v119 row_shr:4 row_mask:0xf bank_mask:0xf
    s_nop 1
    v_add_f32_dpp v119, v119, v119 row_shr:8 row_mask:0xf bank_mask:0xf
    s_nop 1
    v_add_f32_dpp v119, v119, v119 row_bcast:15 row_mask:0xa bank_mask:0xf
    s_nop 1
    v_add_f32_dpp v119, v119, v119 row_bcast:31 row_mask:0xc bank_mask:0xf
    s_waitcnt lgkmcnt(0)
    s_barrier
    s_mov_b32 exec_lo, 0
    s_brev_b32 exec_hi, 1
    ds_max_u32 v34, v118
    ds_add_f32 v34, v119 offset:4
    s_mov_b64 exec, -1

    s_waitcnt vmcnt(18)
    ds_write_b128 v3, v[76:79] offset:0
    s_waitcnt vmcnt(17)
    ds_write_b128 v3, v[80:83] offset:16384
    s_waitcnt vmcnt(16)
    ds_write_b128 v3, v[84:87] offset:32768
    v_lshlrev_b32 v125, 2, v0
    s_waitcnt vmcnt(15)
    s_mov_b64 exec, s[48:49]
    ds_write_b32 v125, v88 offset:49152
    s_mov_b64 exec, -1

    s_add_u32 s43, s43, 50000
    s_add_u32 s14, s43, 50000
    buffer_load_dwordx4 v[76:79], v3, s[12:15], s43 offen
    s_add_u32 s52, s43, 16384
    buffer_load_dwordx4 v[80:83], v3, s[12:15], s52 offen
    s_add_u32 s52, s43, 32768
    buffer_load_dwordx4 v[84:87], v3, s[12:15], s52 offen
    s_add_u32 s52, s43, 49152
    v_lshlrev_b32 v125, 2, v0
    buffer_load_dword v88, v125, s[12:15], s52 offen
    s_waitcnt lgkmcnt(0)
    s_barrier
    ds_read_b64 v[28:29], v34
    s_waitcnt lgkmcnt(0)
    v_lshlrev_b32 v28, 16, v28
    v_mul_f32 v29, 0x34a7c5ac, v29
    v_sqrt_f32 v29, v29
    v_add_f32 v30, v28, v28
    v_mul_f32 v31, 0x41ac0000, v29
    v_mul_f32 v32, 0x42000000, v29
    v_max_f32 v30, v30, v31
    v_cmp_le_f32 vcc, v28, v32
    v_mov_b32 v33, 0x26901d7d
    v_cmp_lt_f32 s[64:65], v33, v29
    v_mov_b32 v33, 0x58635fa9
    s_and_b64 vcc, vcc, s[64:65]
    v_cmp_gt_f32 s[64:65], v33, v29
    v_rcp_f32 v30, v30
    s_and_b64 vcc, vcc, s[64:65]
    s_cbranch_scc0 L_p2slow_131
    s_cmp_lg_u32 s51, 0
    s_cbranch_scc1 L_p2slow_131
    v_mul_f32 v30, 0x41800000, v30
    v_and_b32 v30, s32, v30
    v_mul_f32 v1, 0xcb000400, v30
    v_mul_f32 v31, 0x447fc000, v30
    v_rcp_f32 v31, v31
    v_readfirstlane_b32 s33, v30
    s_nop 0
    v_readfirstlane_b32 s34, v31

L_batch_132:
    s_mov_b32 s40, s41
    s_sub_u32 s42, s40, s39
    s_mul_i32 s50, s38, 200000
    s_add_u32 s5, s38, 1
    s_min_u32 s52, s5, 31
    s_lshl_b32 s52, s52, 6
    s_add_u32 s52, s52, s36
    s_lshl_b32 s52, s52, 2
    s_load_dword s41, s[46:47], s52

    s_waitcnt vmcnt(10)
    v_bfi_b32 v124, s60, v91, v92
    v_mov_b32 v16, v90
    v_alignbyte_b32 v17, v92, v91, 1
    v_bfi_b32 v124, s61, v124, v93
    v_alignbyte_b32 v18, v93, v92, 2
    v_alignbyte_b32 v19, v112, v93, 3
    v_bfi_b32 v109, s62, v124, v112
    s_cmp_lt_i32 s42, 1792
    s_cbranch_scc1 L_ufix_133
L_uback_134:

    v_lshrrev_b32 v52, 14, v16
    v_lshrrev_b32 v54, 14, v17
    v_lshrrev_b32 v56, 14, v18
    v_lshrrev_b32 v58, 14, v19
    v_and_b32 v52, 0xfff8, v52
    v_and_b32 v54, 0xfff8, v54
    v_and_b32 v56, 0xfff8, v56
    v_and_b32 v58, 0xfff8, v58
    s_waitcnt vmcnt(8)
    v_bfi_b32 v124, s60, v95, v96
    v_mov_b32 v20, v94
    v_alignbyte_b32 v21, v96, v95, 1
    v_bfi_b32 v124, s61, v124, v97
    v_alignbyte_b32 v22, v97, v96, 2
    v_alignbyte_b32 v23, v113, v97, 3
    v_bfi_b32 v110, s62, v124, v113
    s_cmp_lt_i32 s42, 2304
    s_cbranch_scc1 L_ufix_135
L_uback_136:

    v_lshrrev_b32 v60, 14, v20
    v_lshrrev_b32 v62, 14, v21
    v_lshrrev_b32 v64, 14, v22
    v_lshrrev_b32 v66, 14, v23
    v_and_b32 v60, 0xfff8, v60
    v_and_b32 v62, 0xfff8, v62
    v_and_b32 v64, 0xfff8, v64
    v_and_b32 v66, 0xfff8, v66
    s_waitcnt vmcnt(6)
    v_bfi_b32 v124, s60, v99, v100
    v_mov_b32 v24, v98
    v_alignbyte_b32 v25, v100, v99, 1
    v_bfi_b32 v124, s61, v124, v101
    v_alignbyte_b32 v26, v101, v100, 2
    v_alignbyte_b32 v27, v114, v101, 3
    v_bfi_b32 v111, s62, v124, v114
    s_cmp_lt_i32 s42, 2816
    s_cbranch_scc1 L_ufix_137
L_uback_138:

    v_lshrrev_b32 v68, 14, v24
    v_lshrrev_b32 v70, 14, v25
    v_lshrrev_b32 v72, 14, v26
    v_lshrrev_b32 v74, 14, v27
    v_and_b32 v68, 0xfff8, v68
    v_and_b32 v70, 0xfff8, v70
    v_and_b32 v72, 0xfff8, v72
    v_and_b32 v74, 0xfff8, v74
    s_waitcnt vmcnt(6)
    v_bfi_b32 v124, s60, v5, v6
    v_alignbyte_b32 v5, v6, v5, 1
    v_bfi_b32 v124, s61, v124, v7
    v_alignbyte_b32 v6, v7, v6, 2
    v_alignbyte_b32 v7, v106, v7, 3
    v_bfi_b32 v106, s62, v124, v106
    s_cmp_lt_i32 s42, 256
    s_cbranch_scc1 L_ufix_139
L_uback_140:

    v_lshrrev_b32 v28, 14, v4
    v_lshrrev_b32 v30, 14, v5
    v_lshrrev_b32 v32, 14, v6
    v_lshrrev_b32 v34, 14, v7
    v_and_b32 v28, 0xfff8, v28
    v_and_b32 v30, 0xfff8, v30
    v_and_b32 v32, 0xfff8, v32
    v_and_b32 v34, 0xfff8, v34
    s_waitcnt vmcnt(4)
    v_bfi_b32 v124, s60, v9, v10
    v_alignbyte_b32 v9, v10, v9, 1
    v_bfi_b32 v124, s61, v124, v11
    v_alignbyte_b32 v10, v11, v10, 2
    v_alignbyte_b32 v11, v107, v11, 3
    v_bfi_b32 v107, s62, v124, v107
    s_cmp_lt_i32 s42, 768
    s_cbranch_scc1 L_ufix_141
L_uback_142:

    v_lshrrev_b32 v36, 14, v8
    v_lshrrev_b32 v38, 14, v9
    v_lshrrev_b32 v40, 14, v10
    v_lshrrev_b32 v42, 14, v11
    v_and_b32 v36, 0xfff8, v36
    v_and_b32 v38, 0xfff8, v38
    v_and_b32 v40, 0xfff8, v40
    v_and_b32 v42, 0xfff8, v42
    s_waitcnt vmcnt(2)
    v_bfi_b32 v124, s60, v13, v14
    v_alignbyte_b32 v13, v14, v13, 1
    v_bfi_b32 v124, s61, v124, v15
    v_alignbyte_b32 v14, v15, v14, 2
    v_alignbyte_b32 v15, v108, v15, 3
    v_bfi_b32 v108, s62, v124, v108
    s_cmp_lt_i32 s42, 1280
    s_cbranch_scc1 L_ufix_143
L_uback_144:

    v_lshrrev_b32 v44, 14, v12
    v_lshrrev_b32 v46, 14, v13
    v_lshrrev_b32 v48, 14, v14
    v_lshrrev_b32 v50, 14, v15
    v_and_b32 v44, 0xfff8, v44
    v_and_b32 v46, 0xfff8, v46
    v_and_b32 v48, 0xfff8, v48
    v_and_b32 v50, 0xfff8, v50
    v_subrev_co_u32 v4, s[64:65], 2.0, v4
    v_subrev_co_u32 v5, s[66:67], 2.0, v5
    v_subrev_co_u32 v6, s[68:69], 2.0, v6
    v_subrev_co_u32 v7, s[70:71], 2.0, v7
    v_subrev_co_u32 v8, s[72:73], 2.0, v8
    v_subrev_co_u32 v9, s[74:75], 2.0, v9
    v_subrev_co_u32 v10, s[76:77], 2.0, v10
    v_subrev_co_u32 v11, s[78:79], 2.0, v11
    v_subrev_co_u32 v12, s[80:81], 2.0, v12
    v_subrev_co_u32 v13, s[82:83], 2.0, v13
    v_subrev_co_u32 v14, s[84:85], 2.0, v14
    v_subrev_co_u32 v15, s[86:87], 2.0, v15
    s_waitcnt lgkmcnt(0)
    s_barrier
    s_mov_b64 exec, s[64:65]
    ds_read_b64 v[28:29], v28
    s_mov_b64 exec, s[66:67]
    ds_read_b64 v[30:31], v30
    s_mov_b64 exec, s[68:69]
    ds_read_b64 v[32:33], v32
    s_mov_b64 exec, s[70:71]
    ds_read_b64 v[34:35], v34
    s_mov_b64 exec, s[72:73]
    ds_read_b64 v[36:37], v36
    s_mov_b64 exec, s[74:75]
    ds_read_b64 v[38:39], v38
    s_mov_b64 exec, s[76:77]
    ds_read_b64 v[40:41], v40
    s_mov_b64 exec, s[78:79]
    ds_read_b64 v[42:43], v42
    s_mov_b64 exec, s[80:81]
    ds_read_b64 v[44:45], v44
    s_mov_b64 exec, s[82:83]
    ds_read_b64 v[46:47], v46
    s_mov_b64 exec, s[84:85]
    ds_read_b64 v[48:49], v48
    s_mov_b64 exec, s[86:87]
    ds_read_b64 v[50:51], v50
    s_mov_b64 exec, -1
    v_subrev_co_u32 v16, s[64:65], 2.0, v16
    v_subrev_co_u32 v17, s[66:67], 2.0, v17
    v_subrev_co_u32 v18, s[68:69], 2.0, v18
    v_subrev_co_u32 v19, s[70:71], 2.0, v19
    v_subrev_co_u32 v20, s[72:73], 2.0, v20
    v_subrev_co_u32 v21, s[74:75], 2.0, v21
    v_subrev_co_u32 v22, s[76:77], 2.0, v22
    v_subrev_co_u32 v23, s[78:79], 2.0, v23
    v_subrev_co_u32 v24, s[80:81], 2.0, v24
    v_subrev_co_u32 v25, s[82:83], 2.0, v25
    v_subrev_co_u32 v26, s[84:85], 2.0, v26
    v_subrev_co_u32 v27, s[86:87], 2.0, v27
    s_mov_b64 exec, s[64:65]
    ds_read_b64 v[52:53], v52
    s_mov_b64 exec, s[66:67]
    ds_read_b64 v[54:55], v54
    s_mov_b64 exec, s[68:69]
    ds_read_b64 v[56:57], v56
    s_mov_b64 exec, s[70:71]
    ds_read_b64 v[58:59], v58
    s_mov_b64 exec, s[72:73]
    ds_read_b64 v[60:61], v60
    s_mov_b64 exec, s[74:75]
    ds_read_b64 v[62:63], v62
    s_mov_b64 exec, s[76:77]
    ds_read_b64 v[64:65], v64
    s_mov_b64 exec, s[78:79]
    ds_read_b64 v[66:67], v66
    s_mov_b64 exec, s[80:81]
    ds_read_b64 v[68:69], v68
    s_mov_b64 exec, s[82:83]
    ds_read_b64 v[70:71], v70
    s_mov_b64 exec, s[84:85]
    ds_read_b64 v[72:73], v72
    s_mov_b64 exec, s[86:87]
    ds_read_b64 v[74:75], v74
    s_mov_b64 exec, -1
    s_waitcnt lgkmcnt(0)
    s_barrier
    s_waitcnt vmcnt(3)
    ds_write_b128 v3, v[76:79] offset:0
    s_waitcnt vmcnt(2)
    ds_write_b128 v3, v[80:83] offset:16384
    s_waitcnt vmcnt(1)
    ds_write_b128 v3, v[84:87] offset:32768
    v_lshlrev_b32 v125, 2, v0
    s_waitcnt vmcnt(0)
    s_mov_b64 exec, s[48:49]
    ds_write_b32 v125, v88 offset:49152
    s_mov_b64 exec, -1

    s_add_u32 s43, s43, 50000
    s_add_u32 s14, s43, 50000
    buffer_load_dwordx4 v[76:79], v3, s[12:15], s43 offen
    s_add_u32 s52, s43, 16384
    buffer_load_dwordx4 v[80:83], v3, s[12:15], s52 offen
    s_cmp_lt_u32 s5, s4
    s_cselect_b32 s41, s41, 0
    s_min_u32 s55, s5, 31
    s_min_u32 s41, s41, 3968
    s_lshl_b32 s52, s55, 6
    s_add_u32 s52, s52, s36
    s_mul_i32 s52, s52, 19840
    s_add_u32 s16, s44, s52
    s_addc_u32 s17, s45, 0
    s_mul_i32 s52, s41, 5
    s_add_u32 s52, s52, 3
    s_and_b32 s18, s52, -4

    v_subrev_co_u32 v4, s[64:65], 2.0, v4
    v_subrev_co_u32 v5, s[66:67], 2.0, v5
    v_subrev_co_u32 v6, s[68:69], 2.0, v6
    v_subrev_co_u32 v7, s[70:71], 2.0, v7
    v_subrev_co_u32 v8, s[72:73], 2.0, v8
    v_subrev_co_u32 v9, s[74:75], 2.0, v9
    v_subrev_co_u32 v10, s[76:77], 2.0, v10
    v_subrev_co_u32 v11, s[78:79], 2.0, v11
    v_subrev_co_u32 v12, s[80:81], 2.0, v12
    v_subrev_co_u32 v13, s[82:83], 2.0, v13
    v_subrev_co_u32 v14, s[84:85], 2.0, v14
    v_subrev_co_u32 v15, s[86:87], 2.0, v15
    s_waitcnt lgkmcnt(0)
    s_barrier
    s_add_u32 s52, s43, 32768
    buffer_load_dwordx4 v[84:87], v3, s[12:15], s52 offen
    s_add_u32 s52, s43, 49152
    v_lshlrev_b32 v125, 2, v0
    buffer_load_dword v88, v125, s[12:15], s52 offen
    s_mov_b64 exec, s[64:65]
    ds_read_b64 v[28:29], v28
    s_mov_b64 exec, s[66:67]
    ds_read_b64 v[30:31], v30
    s_mov_b64 exec, s[68:69]
    ds_read_b64 v[32:33], v32
    s_mov_b64 exec, s[70:71]
    ds_read_b64 v[34:35], v34
    s_mov_b64 exec, s[72:73]
    ds_read_b64 v[36:37], v36
    s_mov_b64 exec, s[74:75]
    ds_read_b64 v[38:39], v38
    s_mov_b64 exec, s[76:77]
    ds_read_b64 v[40:41], v40
    s_mov_b64 exec, s[78:79]
    ds_read_b64 v[42:43], v42
    s_mov_b64 exec, s[80:81]
    ds_read_b64 v[44:45], v44
    s_mov_b64 exec, s[82:83]
    ds_read_b64 v[46:47], v46
    s_mov_b64 exec, s[84:85]
    ds_read_b64 v[48:49], v48
    s_mov_b64 exec, s[86:87]
    ds_read_b64 v[50:51], v50
    s_mov_b64 exec, -1
    s_movk_i32 s53, 7680
    buffer_load_dwordx4 v[90:93], v2, s[16:19], s53 offen
    buffer_load_dword v112, v2, s[16:19], s53 offen offset:16
    v_subrev_co_u32 v16, s[64:65], 2.0, v16
    v_subrev_co_u32 v17, s[66:67], 2.0, v17
    v_subrev_co_u32 v18, s[68:69], 2.0, v18
    v_subrev_co_u32 v19, s[70:71], 2.0, v19
    v_subrev_co_u32 v20, s[72:73], 2.0, v20
    v_subrev_co_u32 v21, s[74:75], 2.0, v21
    v_subrev_co_u32 v22, s[76:77], 2.0, v22
    v_subrev_co_u32 v23, s[78:79], 2.0, v23
    v_subrev_co_u32 v24, s[80:81], 2.0, v24
    v_subrev_co_u32 v25, s[82:83], 2.0, v25
    v_subrev_co_u32 v26, s[84:85], 2.0, v26
    v_subrev_co_u32 v27, s[86:87], 2.0, v27
    s_mov_b64 exec, s[64:65]
    ds_read_b64 v[52:53], v52
    s_mov_b64 exec, s[66:67]
    ds_read_b64 v[54:55], v54
    s_mov_b64 exec, s[68:69]
    ds_read_b64 v[56:57], v56
    s_mov_b64 exec, s[70:71]
    ds_read_b64 v[58:59], v58
    s_mov_b64 exec, s[72:73]
    ds_read_b64 v[60:61], v60
    s_mov_b64 exec, s[74:75]
    ds_read_b64 v[62:63], v62
    s_mov_b64 exec, s[76:77]
    ds_read_b64 v[64:65], v64
    s_mov_b64 exec, s[78:79]
    ds_read_b64 v[66:67], v66
    s_mov_b64 exec, s[80:81]
    ds_read_b64 v[68:69], v68
    s_mov_b64 exec, s[82:83]
    ds_read_b64 v[70:71], v70
    s_mov_b64 exec, s[84:85]
    ds_read_b64 v[72:73], v72
    s_mov_b64 exec, s[86:87]
    ds_read_b64 v[74:75], v74
    s_mov_b64 exec, -1
    s_waitcnt lgkmcnt(0)
    s_barrier
    s_waitcnt vmcnt(5)
    ds_write_b128 v3, v[76:79] offset:0
    s_waitcnt vmcnt(4)
    ds_write_b128 v3, v[80:83] offset:16384
    s_waitcnt vmcnt(3)
    ds_write_b128 v3, v[84:87] offset:32768
    v_lshlrev_b32 v125, 2, v0
    s_waitcnt vmcnt(2)
    s_mov_b64 exec, s[48:49]
    ds_write_b32 v125, v88 offset:49152
    s_mov_b64 exec, -1

    s_add_u32 s43, s43, 50000
    s_add_u32 s14, s43, 50000
    buffer_load_dwordx4 v[76:79], v3, s[12:15], s43 offen
    s_add_u32 s52, s43, 16384
    buffer_load_dwordx4 v[80:83], v3, s[12:15], s52 offen
    v_subrev_co_u32 v4, s[64:65], 2.0, v4
    v_subrev_co_u32 v5, s[66:67], 2.0, v5
    v_subrev_co_u32 v6, s[68:69], 2.0, v6
    v_subrev_co_u32 v7, s[70:71], 2.0, v7
    v_subrev_co_u32 v8, s[72:73], 2.0, v8
    v_subrev_co_u32 v9, s[74:75], 2.0, v9
    v_subrev_co_u32 v10, s[76:77], 2.0, v10
    v_subrev_co_u32 v11, s[78:79], 2.0, v11
    v_subrev_co_u32 v12, s[80:81], 2.0, v12
    v_subrev_co_u32 v13, s[82:83], 2.0, v13
    v_subrev_co_u32 v14, s[84:85], 2.0, v14
    v_subrev_co_u32 v15, s[86:87], 2.0, v15
    s_waitcnt lgkmcnt(0)
    s_barrier
    s_add_u32 s52, s43, 32768
    buffer_load_dwordx4 v[84:87], v3, s[12:15], s52 offen
    s_add_u32 s52, s43, 49152
    v_lshlrev_b32 v125, 2, v0
    buffer_load_dword v88, v125, s[12:15], s52 offen
    s_mov_b64 exec, s[64:65]
    ds_read_b64 v[28:29], v28
    s_mov_b64 exec, s[66:67]
    ds_read_b64 v[30:31], v30
    s_mov_b64 exec, s[68:69]
    ds_read_b64 v[32:33], v32
    s_mov_b64 exec, s[70:71]
    ds_read_b64 v[34:35], v34
    s_mov_b64 exec, s[72:73]
    ds_read_b64 v[36:37], v36
    s_mov_b64 exec, s[74:75]
    ds_read_b64 v[38:39], v38
    s_mov_b64 exec, s[76:77]
    ds_read_b64 v[40:41], v40
    s_mov_b64 exec, s[78:79]
    ds_read_b64 v[42:43], v42
    s_mov_b64 exec, s[80:81]
    ds_read_b64 v[44:45], v44
    s_mov_b64 exec, s[82:83]
    ds_read_b64 v[46:47], v46
    s_mov_b64 exec, s[84:85]
    ds_read_b64 v[48:49], v48
    s_mov_b64 exec, s[86:87]
    ds_read_b64 v[50:51], v50
    s_mov_b64 exec, -1
    s_movk_i32 s53, 10240
    buffer_load_dwordx4 v[94:97], v2, s[16:19], s53 offen
    buffer_load_dword v113, v2, s[16:19], s53 offen offset:16
    v_subrev_co_u32 v16, s[64:65], 2.0, v16
    v_subrev_co_u32 v17, s[66:67], 2.0, v17
    v_subrev_co_u32 v18, s[68:69], 2.0, v18
    v_subrev_co_u32 v19, s[70:71], 2.0, v19
    v_subrev_co_u32 v20, s[72:73], 2.0, v20
    v_subrev_co_u32 v21, s[74:75], 2.0, v21
    v_subrev_co_u32 v22, s[76:77], 2.0, v22
    v_subrev_co_u32 v23, s[78:79], 2.0, v23
    v_subrev_co_u32 v24, s[80:81], 2.0, v24
    v_subrev_co_u32 v25, s[82:83], 2.0, v25
    v_subrev_co_u32 v26, s[84:85], 2.0, v26
    v_subrev_co_u32 v27, s[86:87], 2.0, v27
    s_mov_b64 exec, s[64:65]
    ds_read_b64 v[52:53], v52
    s_mov_b64 exec, s[66:67]
    ds_read_b64 v[54:55], v54
    s_mov_b64 exec, s[68:69]
    ds_read_b64 v[56:57], v56
    s_mov_b64 exec, s[70:71]
    ds_read_b64 v[58:59], v58
    s_mov_b64 exec, s[72:73]
    ds_read_b64 v[60:61], v60
    s_mov_b64 exec, s[74:75]
    ds_read_b64 v[62:63], v62
    s_mov_b64 exec, s[76:77]
    ds_read_b64 v[64:65], v64
    s_mov_b64 exec, s[78:79]
    ds_read_b64 v[66:67], v66
    s_mov_b64 exec, s[80:81]
    ds_read_b64 v[68:69], v68
    s_mov_b64 exec, s[82:83]
    ds_read_b64 v[70:71], v70
    s_mov_b64 exec, s[84:85]
    ds_read_b64 v[72:73], v72
    s_mov_b64 exec, s[86:87]
    ds_read_b64 v[74:75], v74
    s_mov_b64 exec, -1
    s_waitcnt lgkmcnt(0)
    s_barrier
    s_waitcnt vmcnt(5)
    ds_write_b128 v3, v[76:79] offset:0
    s_waitcnt vmcnt(4)
    ds_write_b128 v3, v[80:83] offset:16384
    s_waitcnt vmcnt(3)
    ds_write_b128 v3, v[84:87] offset:32768
    v_lshlrev_b32 v125, 2, v0
    s_waitcnt vmcnt(2)
    s_mov_b64 exec, s[48:49]
    ds_write_b32 v125, v88 offset:49152
    s_mov_b64 exec, -1

    s_add_u32 s43, s43, 50000
    s_add_u32 s14, s43, 50000
    s_cmp_lt_u32 s5, s4
    s_cselect_b32 s14, s14, 0
    buffer_load_dwordx4 v[76:79], v3, s[12:15], s43 offen
    s_add_u32 s52, s43, 16384
    buffer_load_dwordx4 v[80:83], v3, s[12:15], s52 offen
    v_subrev_co_u32 v4, s[64:65], 2.0, v4
    v_subrev_co_u32 v5, s[66:67], 2.0, v5
    v_subrev_co_u32 v6, s[68:69], 2.0, v6
    v_subrev_co_u32 v7, s[70:71], 2.0, v7
    v_subrev_co_u32 v8, s[72:73], 2.0, v8
    v_subrev_co_u32 v9, s[74:75], 2.0, v9
    v_subrev_co_u32 v10, s[76:77], 2.0, v10
    v_subrev_co_u32 v11, s[78:79], 2.0, v11
    v_subrev_co_u32 v12, s[80:81], 2.0, v12
    v_subrev_co_u32 v13, s[82:83], 2.0, v13
    v_subrev_co_u32 v14, s[84:85], 2.0, v14
    v_subrev_co_u32 v15, s[86:87], 2.0, v15
    s_waitcnt lgkmcnt(0)
    s_barrier
    s_add_u32 s52, s43, 32768
    buffer_load_dwordx4 v[84:87], v3, s[12:15], s52 offen
    s_add_u32 s52, s43, 49152
    v_lshlrev_b32 v125, 2, v0
    buffer_load_dword v88, v125, s[12:15], s52 offen
    s_mov_b64 exec, s[64:65]
    ds_read_b64 v[28:29], v28
    s_mov_b64 exec, s[66:67]
    ds_read_b64 v[30:31], v30
    s_mov_b64 exec, s[68:69]
    ds_read_b64 v[32:33], v32
    s_mov_b64 exec, s[70:71]
    ds_read_b64 v[34:35], v34
    s_mov_b64 exec, s[72:73]
    ds_read_b64 v[36:37], v36
    s_mov_b64 exec, s[74:75]
    ds_read_b64 v[38:39], v38
    s_mov_b64 exec, s[76:77]
    ds_read_b64 v[40:41], v40
    s_mov_b64 exec, s[78:79]
    ds_read_b64 v[42:43], v42
    s_mov_b64 exec, s[80:81]
    ds_read_b64 v[44:45], v44
    s_mov_b64 exec, s[82:83]
    ds_read_b64 v[46:47], v46
    s_mov_b64 exec, s[84:85]
    ds_read_b64 v[48:49], v48
    s_mov_b64 exec, s[86:87]
    ds_read_b64 v[50:51], v50
    s_mov_b64 exec, -1
    s_movk_i32 s53, 12800
    buffer_load_dwordx4 v[98:101], v2, s[16:19], s53 offen
    buffer_load_dword v114, v2, s[16:19], s53 offen offset:16
    v_subrev_co_u32 v16, s[64:65], 2.0, v16
    v_subrev_co_u32 v17, s[66:67], 2.0, v17
    v_subrev_co_u32 v18, s[68:69], 2.0, v18
    v_subrev_co_u32 v19, s[70:71], 2.0, v19
    v_subrev_co_u32 v20, s[72:73], 2.0, v20
    v_subrev_co_u32 v21, s[74:75], 2.0, v21
    v_subrev_co_u32 v22, s[76:77], 2.0, v22
    v_subrev_co_u32 v23, s[78:79], 2.0, v23
    v_subrev_co_u32 v24, s[80:81], 2.0, v24
    v_subrev_co_u32 v25, s[82:83], 2.0, v25
    v_subrev_co_u32 v26, s[84:85], 2.0, v26
    v_subrev_co_u32 v27, s[86:87], 2.0, v27
    s_mov_b64 exec, s[64:65]
    ds_read_b64 v[52:53], v52
    s_mov_b64 exec, s[66:67]
    ds_read_b64 v[54:55], v54
    s_mov_b64 exec, s[68:69]
    ds_read_b64 v[56:57], v56
    s_mov_b64 exec, s[70:71]
    ds_read_b64 v[58:59], v58
    s_mov_b64 exec, s[72:73]
    ds_read_b64 v[60:61], v60
    s_mov_b64 exec, s[74:75]
    ds_read_b64 v[62:63], v62
    s_mov_b64 exec, s[76:77]
    ds_read_b64 v[64:65], v64
    s_mov_b64 exec, s[78:79]
    ds_read_b64 v[66:67], v66
    s_mov_b64 exec, s[80:81]
    ds_read_b64 v[68:69], v68
    s_mov_b64 exec, s[82:83]
    ds_read_b64 v[70:71], v70
    s_mov_b64 exec, s[84:85]
    ds_read_b64 v[72:73], v72
    s_mov_b64 exec, s[86:87]
    ds_read_b64 v[74:75], v74
    s_mov_b64 exec, -1
    s_waitcnt lgkmcnt(0)
    s_barrier
    s_waitcnt vmcnt(5)
    ds_write_b128 v3, v[76:79] offset:0
    s_waitcnt vmcnt(4)
    ds_write_b128 v3, v[80:83] offset:16384
    s_waitcnt vmcnt(3)
    ds_write_b128 v3, v[84:87] offset:32768
    v_lshlrev_b32 v125, 2, v0
    s_waitcnt vmcnt(2)
    s_mov_b64 exec, s[48:49]
    ds_write_b32 v125, v88 offset:49152
    s_mov_b64 exec, -1

    s_add_u32 s43, s43, 50000
    s_add_u32 s14, s43, 50000
    s_cmp_lt_u32 s5, s4
    s_cselect_b32 s14, s14, 0
    buffer_load_dwordx4 v[76:79], v3, s[12:15], s43 offen
    s_add_u32 s52, s43, 16384
    buffer_load_dwordx4 v[80:83], v3, s[12:15], s52 offen
    s_add_u32 s52, s43, 32768
    buffer_load_dwordx4 v[84:87], v3, s[12:15], s52 offen
    s_add_u32 s52, s43, 49152
    v_lshlrev_b32 v125, 2, v0
    buffer_load_dword v88, v125, s[12:15], s52 offen
    s_add_u32 s54, s43, 50000
    buffer_load_dword v116, v89, s[8:11], s54 offen
    v_perm_b32 v120, v4, v106, s24
    v_lshlrev_b32 v118, 16, v28
    v_and_b32 v120, 0x4b0007ff, v120
    v_and_b32 v119, s32, v28
    v_lshlrev_b32 v28, 16, v29
    v_fma_f32 v120, v120, s33, v1
    v_and_b32 v29, s32, v29
    v_and_b32 v4, 0x1fff8, v4
    v_pk_fma_f32 v[28:29], v[28:29], v[120:121], s[28:29] op_sel_hi:[1,0,1]
    v_pk_fma_f32 v[118:119], v[118:119], v[120:121], s[28:29] op_sel_hi:[1,0,1]
    v_perm_b32 v29, v29, v28, s35
    v_perm_b32 v28, v119, v118, s35
    v_lshl_add_u64 v[28:29], v[28:29], 0, s[30:31]
    ds_add_rtn_u64 v[28:29], v4, v[28:29] offset:50000

    v_perm_b32 v124, v5, v106, s25
    v_lshlrev_b32 v122, 16, v30
    v_and_b32 v124, 0x4b0007ff, v124
    v_and_b32 v123, s32, v30
    v_lshlrev_b32 v30, 16, v31
    v_fma_f32 v124, v124, s33, v1
    v_and_b32 v31, s32, v31
    v_and_b32 v5, 0x1fff8, v5
    v_pk_fma_f32 v[30:31], v[30:31], v[124:125], s[28:29] op_sel_hi:[1,0,1]
    v_pk_fma_f32 v[122:123], v[122:123], v[124:125], s[28:29] op_sel_hi:[1,0,1]
    v_perm_b32 v31, v31, v30, s35
    v_perm_b32 v30, v123, v122, s35
    v_lshl_add_u64 v[30:31], v[30:31], 0, s[30:31]
    ds_add_rtn_u64 v[30:31], v5, v[30:31] offset:50000

    v_perm_b32 v120, v6, v106, s26
    v_lshlrev_b32 v118, 16, v32
    v_and_b32 v120, 0x4b0007ff, v120
    v_and_b32 v119, s32, v32
    v_lshlrev_b32 v32, 16, v33
    v_fma_f32 v120, v120, s33, v1
    v_and_b32 v33, s32, v33
    v_and_b32 v6, 0x1fff8, v6
    v_pk_fma_f32 v[32:33], v[32:33], v[120:121], s[28:29] op_sel_hi:[1,0,1]
    v_pk_fma_f32 v[118:119], v[118:119], v[120:121], s[28:29] op_sel_hi:[1,0,1]
    v_perm_b32 v33, v33, v32, s35
    v_perm_b32 v32, v119, v118, s35
    v_lshl_add_u64 v[32:33], v[32:33], 0, s[30:31]
    ds_add_rtn_u64 v[32:33], v6, v[32:33] offset:50000

    v_perm_b32 v124, v7, v106, s27
    v_lshlrev_b32 v122, 16, v34
    v_and_b32 v124, 0x4b0007ff, v124
    v_and_b32 v123, s32, v34
    v_lshlrev_b32 v34, 16, v35
    v_fma_f32 v124, v124, s33, v1
    v_and_b32 v35, s32, v35
    v_and_b32 v7, 0x1fff8, v7
    v_pk_fma_f32 v[34:35], v[34:35], v[124:125], s[28:29] op_sel_hi:[1,0,1]
    v_pk_fma_f32 v[122:123], v[122:123], v[124:125], s[28:29] op_sel_hi:[1,0,1]
    v_perm_b32 v35, v35, v34, s35
    v_perm_b32 v34, v123, v122, s35
    v_lshl_add_u64 v[34:35], v[34:35], 0, s[30:31]
    ds_add_rtn_u64 v[34:35], v7, v[34:35] offset:50000

    s_movk_i32 s53, 0
    buffer_load_dwordx4 v[4:7], v2, s[16:19], s53 offen
    buffer_load_dword v106, v2, s[16:19], s53 offen offset:16
    v_perm_b32 v120, v8, v107, s24
    v_lshlrev_b32 v118, 16, v36
    v_and_b32 v120, 0x4b0007ff, v120
    v_and_b32 v119, s32, v36
    v_lshlrev_b32 v36, 16, v37
    v_fma_f32 v120, v120, s33, v1
    v_and_b32 v37, s32, v37
    v_and_b32 v8, 0x1fff8, v8
    v_pk_fma_f32 v[36:37], v[36:37], v[120:121], s[28:29] op_sel_hi:[1,0,1]
    v_pk_fma_f32 v[118:119], v[118:119], v[120:121], s[28:29] op_sel_hi:[1,0,1]
    v_perm_b32 v37, v37, v36, s35
    v_perm_b32 v36, v119, v118, s35
    v_lshl_add_u64 v[36:37], v[36:37], 0, s[30:31]
    ds_add_rtn_u64 v[36:37], v8, v[36:37] offset:50000

    v_perm_b32 v124, v9, v107, s25
    v_lshlrev_b32 v122, 16, v38
    v_and_b32 v124, 0x4b0007ff, v124
    v_and_b32 v123, s32, v38
    v_lshlrev_b32 v38, 16, v39
    v_fma_f32 v124, v124, s33, v1
    v_and_b32 v39, s32, v39
    v_and_b32 v9, 0x1fff8, v9
    v_pk_fma_f32 v[38:39], v[38:39], v[124:125], s[28:29] op_sel_hi:[1,0,1]
    v_pk_fma_f32 v[122:123], v[122:123], v[124:125], s[28:29] op_sel_hi:[1,0,1]
    v_perm_b32 v39, v39, v38, s35
    v_perm_b32 v38, v123, v122, s35
    v_lshl_add_u64 v[38:39], v[38:39], 0, s[30:31]
    ds_add_rtn_u64 v[38:39], v9, v[38:39] offset:50000

    v_perm_b32 v120, v10, v107, s26
    v_lshlrev_b32 v118, 16, v40
    v_and_b32 v120, 0x4b0007ff, v120
    v_and_b32 v119, s32, v40
    v_lshlrev_b32 v40, 16, v41
    v_fma_f32 v120, v120, s33, v1
    v_and_b32 v41, s32, v41
    v_and_b32 v10, 0x1fff8, v10
    v_pk_fma_f32 v[40:41], v[40:41], v[120:121], s[28:29] op_sel_hi:[1,0,1]
    v_pk_fma_f32 v[118:119], v[118:119], v[120:121], s[28:29] op_sel_hi:[1,0,1]
    v_perm_b32 v41, v41, v40, s35
    v_perm_b32 v40, v119, v118, s35
    v_lshl_add_u64 v[40:41], v[40:41], 0, s[30:31]
    ds_add_rtn_u64 v[40:41], v10, v[40:41] offset:50000

    v_perm_b32 v124, v11, v107, s27
    v_lshlrev_b32 v122, 16, v42
    v_and_b32 v124, 0x4b0007ff, v124
    v_and_b32 v123, s32, v42
    v_lshlrev_b32 v42, 16, v43
    v_fma_f32 v124, v124, s33, v1
    v_and_b32 v43, s32, v43
    v_and_b32 v11, 0x1fff8, v11
    v_pk_fma_f32 v[42:43], v[42:43], v[124:125], s[28:29] op_sel_hi:[1,0,1]
    v_pk_fma_f32 v[122:123], v[122:123], v[124:125], s[28:29] op_sel_hi:[1,0,1]
    v_perm_b32 v43, v43, v42, s35
    v_perm_b32 v42, v123, v122, s35
    v_lshl_add_u64 v[42:43], v[42:43], 0, s[30:31]
    ds_add_rtn_u64 v[42:43], v11, v[42:43] offset:50000

    s_movk_i32 s53, 2560
    buffer_load_dwordx4 v[8:11], v2, s[16:19], s53 offen
    buffer_load_dword v107, v2, s[16:19], s53 offen offset:16
    s_waitcnt lgkmcnt(4)
    v_or3_b32 v117, v28, v29, v117
    v_or3_b32 v117, v30, v31, v117
    v_or3_b32 v117, v32, v33, v117
    v_or3_b32 v117, v34, v35, v117
    s_cmp_le_i32 s42, 3072
    s_cbranch_scc1 L_nt1_145
    s_waitcnt vmcnt(27)
    v_bfi_b32 v124, s60, v103, v104
    v_alignbyte_b32 v103, v104, v103, 1
    v_bfi_b32 v124, s61, v124, v105
    v_alignbyte_b32 v104, v105, v104, 2
    v_alignbyte_b32 v105, v115, v105, 3
    v_bfi_b32 v115, s62, v124, v115
    s_cmp_lt_i32 s42, 3328
    s_cbranch_scc1 L_ufix_147
L_uback_148:

    v_lshrrev_b32 v122, 30, v102
    v_bfe_u32 v118, v102, 17, 13
    v_mul_u32_u24 v122, 6250, v122
    v_add_lshl_u32 v118, v118, v122, 3

    v_cmp_ne_u32 vcc, 4, v102
    s_mov_b64 exec, vcc
    buffer_load_dwordx2 v[28:29], v118, s[8:11], s50 offen
    s_mov_b64 exec, -1
    v_lshrrev_b32 v122, 30, v103
    v_bfe_u32 v119, v103, 17, 13
    v_mul_u32_u24 v122, 6250, v122
    v_add_lshl_u32 v119, v119, v122, 3

    v_cmp_ne_u32 vcc, 4, v103
    s_mov_b64 exec, vcc
    buffer_load_dwordx2 v[30:31], v119, s[8:11], s50 offen
    s_mov_b64 exec, -1
    v_lshrrev_b32 v122, 30, v104
    v_bfe_u32 v120, v104, 17, 13
    v_mul_u32_u24 v122, 6250, v122
    v_add_lshl_u32 v120, v120, v122, 3

    v_cmp_ne_u32 vcc, 4, v104
    s_mov_b64 exec, vcc
    buffer_load_dwordx2 v[32:33], v120, s[8:11], s50 offen
    s_mov_b64 exec, -1
    v_lshrrev_b32 v122, 30, v105
    v_bfe_u32 v121, v105, 17, 13
    v_mul_u32_u24 v122, 6250, v122
    v_add_lshl_u32 v121, v121, v122, 3

    v_cmp_ne_u32 vcc, 4, v105
    s_mov_b64 exec, vcc
    buffer_load_dwordx2 v[34:35], v121, s[8:11], s50 offen
    s_mov_b64 exec, -1
L_nt1_145:
    v_perm_b32 v120, v12, v108, s24
    v_lshlrev_b32 v118, 16, v44
    v_and_b32 v120, 0x4b0007ff, v120
    v_and_b32 v119, s32, v44
    v_lshlrev_b32 v44, 16, v45
    v_fma_f32 v120, v120, s33, v1
    v_and_b32 v45, s32, v45
    v_and_b32 v12, 0x1fff8, v12
    v_pk_fma_f32 v[44:45], v[44:45], v[120:121], s[28:29] op_sel_hi:[1,0,1]
    v_pk_fma_f32 v[118:119], v[118:119], v[120:121], s[28:29] op_sel_hi:[1,0,1]
    v_perm_b32 v45, v45, v44, s35
    v_perm_b32 v44, v119, v118, s35
    v_lshl_add_u64 v[44:45], v[44:45], 0, s[30:31]
    ds_add_rtn_u64 v[44:45], v12, v[44:45] offset:50000

    v_perm_b32 v124, v13, v108, s25
    v_lshlrev_b32 v122, 16, v46
    v_and_b32 v124, 0x4b0007ff, v124
    v_and_b32 v123, s32, v46
    v_lshlrev_b32 v46, 16, v47
    v_fma_f32 v124, v124, s33, v1
    v_and_b32 v47, s32, v47
    v_and_b32 v13, 0x1fff8, v13
    v_pk_fma_f32 v[46:47], v[46:47], v[124:125], s[28:29] op_sel_hi:[1,0,1]
    v_pk_fma_f32 v[122:123], v[122:123], v[124:125], s[28:29] op_sel_hi:[1,0,1]
    v_perm_b32 v47, v47, v46, s35
    v_perm_b32 v46, v123, v122, s35
    v_lshl_add_u64 v[46:47], v[46:47], 0, s[30:31]
    ds_add_rtn_u64 v[46:47], v13, v[46:47] offset:50000

    v_perm_b32 v120, v14, v108, s26
    v_lshlrev_b32 v118, 16, v48
    v_and_b32 v120, 0x4b0007ff, v120
    v_and_b32 v119, s32, v48
    v_lshlrev_b32 v48, 16, v49
    v_fma_f32 v120, v120, s33, v1
    v_and_b32 v49, s32, v49
    v_and_b32 v14, 0x1fff8, v14
    v_pk_fma_f32 v[48:49], v[48:49], v[120:121], s[28:29] op_sel_hi:[1,0,1]
    v_pk_fma_f32 v[118:119], v[118:119], v[120:121], s[28:29] op_sel_hi:[1,0,1]
    v_perm_b32 v49, v49, v48, s35
    v_perm_b32 v48, v119, v118, s35
    v_lshl_add_u64 v[48:49], v[48:49], 0, s[30:31]
    ds_add_rtn_u64 v[48:49], v14, v[48:49] offset:50000

    v_perm_b32 v124, v15, v108, s27
    v_lshlrev_b32 v122, 16, v50
    v_and_b32 v124, 0x4b0007ff, v124
    v_and_b32 v123, s32, v50
    v_lshlrev_b32 v50, 16, v51
    v_fma_f32 v124, v124, s33, v1
    v_and_b32 v51, s32, v51
    v_and_b32 v15, 0x1fff8, v15
    v_pk_fma_f32 v[50:51], v[50:51], v[124:125], s[28:29] op_sel_hi:[1,0,1]
    v_pk_fma_f32 v[122:123], v[122:123], v[124:125], s[28:29] op_sel_hi:[1,0,1]
    v_perm_b32 v51, v51, v50, s35
    v_perm_b32 v50, v123, v122, s35
    v_lshl_add_u64 v[50:51], v[50:51], 0, s[30:31]
    ds_add_rtn_u64 v[50:51], v15, v[50:51] offset:50000

    s_movk_i32 s53, 5120
    buffer_load_dwordx4 v[12:15], v2, s[16:19], s53 offen
    buffer_load_dword v108, v2, s[16:19], s53 offen offset:16
    s_waitcnt lgkmcnt(4)
    v_or3_b32 v117, v36, v37, v117
    v_or3_b32 v117, v38, v39, v117
    v_or3_b32 v117, v40, v41, v117
    v_or3_b32 v117, v42, v43, v117
    v_perm_b32 v120, v16, v109, s24
    v_lshlrev_b32 v118, 16, v52
    v_and_b32 v120, 0x4b0007ff, v120
    v_and_b32 v119, s32, v52
    v_lshlrev_b32 v52, 16, v53
    v_fma_f32 v120, v120, s33, v1
    v_and_b32 v53, s32, v53
    v_and_b32 v16, 0x1fff8, v16
    v_pk_fma_f32 v[52:53], v[52:53], v[120:121], s[28:29] op_sel_hi:[1,0,1]
    v_pk_fma_f32 v[118:119], v[118:119], v[120:121], s[28:29] op_sel_hi:[1,0,1]
    v_perm_b32 v53, v53, v52, s35
    v_perm_b32 v52, v119, v118, s35
    v_lshl_add_u64 v[52:53], v[52:53], 0, s[30:31]
    ds_add_rtn_u64 v[52:53], v16, v[52:53] offset:50000

    v_perm_b32 v124, v17, v109, s25
    v_lshlrev_b32 v122, 16, v54
    v_and_b32 v124, 0x4b0007ff, v124
    v_and_b32 v123, s32, v54
    v_lshlrev_b32 v54, 16, v55
    v_fma_f32 v124, v124, s33, v1
    v_and_b32 v55, s32, v55
    v_and_b32 v17, 0x1fff8, v17
    v_pk_fma_f32 v[54:55], v[54:55], v[124:125], s[28:29] op_sel_hi:[1,0,1]
    v_pk_fma_f32 v[122:123], v[122:123], v[124:125], s[28:29] op_sel_hi:[1,0,1]
    v_perm_b32 v55, v55, v54, s35
    v_perm_b32 v54, v123, v122, s35
    v_lshl_add_u64 v[54:55], v[54:55], 0, s[30:31]
    ds_add_rtn_u64 v[54:55], v17, v[54:55] offset:50000

    v_perm_b32 v120, v18, v109, s26
    v_lshlrev_b32 v118, 16, v56
    v_and_b32 v120, 0x4b0007ff, v120
    v_and_b32 v119, s32, v56
    v_lshlrev_b32 v56, 16, v57
    v_fma_f32 v120, v120, s33, v1
    v_and_b32 v57, s32, v57
    v_and_b32 v18, 0x1fff8, v18
    v_pk_fma_f32 v[56:57], v[56:57], v[120:121], s[28:29] op_sel_hi:[1,0,1]
    v_pk_fma_f32 v[118:119], v[118:119], v[120:121], s[28:29] op_sel_hi:[1,0,1]
    v_perm_b32 v57, v57, v56, s35
    v_perm_b32 v56, v119, v118, s35
    v_lshl_add_u64 v[56:57], v[56:57], 0, s[30:31]
    ds_add_rtn_u64 v[56:57], v18, v[56:57] offset:50000

    v_perm_b32 v124, v19, v109, s27
    v_lshlrev_b32 v122, 16, v58
    v_and_b32 v124, 0x4b0007ff, v124
    v_and_b32 v123, s32, v58
    v_lshlrev_b32 v58, 16, v59
    v_fma_f32 v124, v124, s33, v1
    v_and_b32 v59, s32, v59
    v_and_b32 v19, 0x1fff8, v19
    v_pk_fma_f32 v[58:59], v[58:59], v[124:125], s[28:29] op_sel_hi:[1,0,1]
    v_pk_fma_f32 v[122:123], v[122:123], v[124:125], s[28:29] op_sel_hi:[1,0,1]
    v_perm_b32 v59, v59, v58, s35
    v_perm_b32 v58, v123, v122, s35
    v_lshl_add_u64 v[58:59], v[58:59], 0, s[30:31]
    ds_add_rtn_u64 v[58:59], v19, v[58:59] offset:50000

    s_waitcnt lgkmcnt(4)
    v_or3_b32 v117, v44, v45, v117
    v_or3_b32 v117, v46, v47, v117
    v_or3_b32 v117, v48, v49, v117
    v_or3_b32 v117, v50, v51, v117
    v_perm_b32 v120, v20, v110, s24
    v_lshlrev_b32 v118, 16, v60
    v_and_b32 v120, 0x4b0007ff, v120
    v_and_b32 v119, s32, v60
    v_lshlrev_b32 v60, 16, v61
    v_fma_f32 v120, v120, s33, v1
    v_and_b32 v61, s32, v61
    v_and_b32 v20, 0x1fff8, v20
    v_pk_fma_f32 v[60:61], v[60:61], v[120:121], s[28:29] op_sel_hi:[1,0,1]
    v_pk_fma_f32 v[118:119], v[118:119], v[120:121], s[28:29] op_sel_hi:[1,0,1]
    v_perm_b32 v61, v61, v60, s35
    v_perm_b32 v60, v119, v118, s35
    v_lshl_add_u64 v[60:61], v[60:61], 0, s[30:31]
    ds_add_rtn_u64 v[60:61], v20, v[60:61] offset:50000

    v_perm_b32 v124, v21, v110, s25
    v_lshlrev_b32 v122, 16, v62
    v_and_b32 v124, 0x4b0007ff, v124
    v_and_b32 v123, s32, v62
    v_lshlrev_b32 v62, 16, v63
    v_fma_f32 v124, v124, s33, v1
    v_and_b32 v63, s32, v63
    v_and_b32 v21, 0x1fff8, v21
    v_pk_fma_f32 v[62:63], v[62:63], v[124:125], s[28:29] op_sel_hi:[1,0,1]
    v_pk_fma_f32 v[122:123], v[122:123], v[124:125], s[28:29] op_sel_hi:[1,0,1]
    v_perm_b32 v63, v63, v62, s35
    v_perm_b32 v62, v123, v122, s35
    v_lshl_add_u64 v[62:63], v[62:63], 0, s[30:31]
    ds_add_rtn_u64 v[62:63], v21, v[62:63] offset:50000

    v_perm_b32 v120, v22, v110, s26
    v_lshlrev_b32 v118, 16, v64
    v_and_b32 v120, 0x4b0007ff, v120
    v_and_b32 v119, s32, v64
    v_lshlrev_b32 v64, 16, v65
    v_fma_f32 v120, v120, s33, v1
    v_and_b32 v65, s32, v65
    v_and_b32 v22, 0x1fff8, v22
    v_pk_fma_f32 v[64:65], v[64:65], v[120:121], s[28:29] op_sel_hi:[1,0,1]
    v_pk_fma_f32 v[118:119], v[118:119], v[120:121], s[28:29] op_sel_hi:[1,0,1]
    v_perm_b32 v65, v65, v64, s35
    v_perm_b32 v64, v119, v118, s35
    v_lshl_add_u64 v[64:65], v[64:65], 0, s[30:31]
    ds_add_rtn_u64 v[64:65], v22, v[64:65] offset:50000

    v_perm_b32 v124, v23, v110, s27
    v_lshlrev_b32 v122, 16, v66
    v_and_b32 v124, 0x4b0007ff, v124
    v_and_b32 v123, s32, v66
    v_lshlrev_b32 v66, 16, v67
    v_fma_f32 v124, v124, s33, v1
    v_and_b32 v67, s32, v67
    v_and_b32 v23, 0x1fff8, v23
    v_pk_fma_f32 v[66:67], v[66:67], v[124:125], s[28:29] op_sel_hi:[1,0,1]
    v_pk_fma_f32 v[122:123], v[122:123], v[124:125], s[28:29] op_sel_hi:[1,0,1]
    v_perm_b32 v67, v67, v66, s35
    v_perm_b32 v66, v123, v122, s35
    v_lshl_add_u64 v[66:67], v[66:67], 0, s[30:31]
    ds_add_rtn_u64 v[66:67], v23, v[66:67] offset:50000

    s_waitcnt lgkmcnt(4)
    v_or3_b32 v117, v52, v53, v117
    v_or3_b32 v117, v54, v55, v117
    v_or3_b32 v117, v56, v57, v117
    v_or3_b32 v117, v58, v59, v117
    v_perm_b32 v120, v24, v111, s24
    v_lshlrev_b32 v118, 16, v68
    v_and_b32 v120, 0x4b0007ff, v120
    v_and_b32 v119, s32, v68
    v_lshlrev_b32 v68, 16, v69
    v_fma_f32 v120, v120, s33, v1
    v_and_b32 v69, s32, v69
    v_and_b32 v24, 0x1fff8, v24
    v_pk_fma_f32 v[68:69], v[68:69], v[120:121], s[28:29] op_sel_hi:[1,0,1]
    v_pk_fma_f32 v[118:119], v[118:119], v[120:121], s[28:29] op_sel_hi:[1,0,1]
    v_perm_b32 v69, v69, v68, s35
    v_perm_b32 v68, v119, v118, s35
    v_lshl_add_u64 v[68:69], v[68:69], 0, s[30:31]
    ds_add_rtn_u64 v[68:69], v24, v[68:69] offset:50000

    v_perm_b32 v124, v25, v111, s25
    v_lshlrev_b32 v122, 16, v70
    v_and_b32 v124, 0x4b0007ff, v124
    v_and_b32 v123, s32, v70
    v_lshlrev_b32 v70, 16, v71
    v_fma_f32 v124, v124, s33, v1
    v_and_b32 v71, s32, v71
    v_and_b32 v25, 0x1fff8, v25
    v_pk_fma_f32 v[70:71], v[70:71], v[124:125], s[28:29] op_sel_hi:[1,0,1]
    v_pk_fma_f32 v[122:123], v[122:123], v[124:125], s[28:29] op_sel_hi:[1,0,1]
    v_perm_b32 v71, v71, v70, s35
    v_perm_b32 v70, v123, v122, s35
    v_lshl_add_u64 v[70:71], v[70:71], 0, s[30:31]
    ds_add_rtn_u64 v[70:71], v25, v[70:71] offset:50000

    v_perm_b32 v120, v26, v111, s26
    v_lshlrev_b32 v118, 16, v72
    v_and_b32 v120, 0x4b0007ff, v120
    v_and_b32 v119, s32, v72
    v_lshlrev_b32 v72, 16, v73
    v_fma_f32 v120, v120, s33, v1
    v_and_b32 v73, s32, v73
    v_and_b32 v26, 0x1fff8, v26
    v_pk_fma_f32 v[72:73], v[72:73], v[120:121], s[28:29] op_sel_hi:[1,0,1]
    v_pk_fma_f32 v[118:119], v[118:119], v[120:121], s[28:29] op_sel_hi:[1,0,1]
    v_perm_b32 v73, v73, v72, s35
    v_perm_b32 v72, v119, v118, s35
    v_lshl_add_u64 v[72:73], v[72:73], 0, s[30:31]
    ds_add_rtn_u64 v[72:73], v26, v[72:73] offset:50000

    v_perm_b32 v124, v27, v111, s27
    v_lshlrev_b32 v122, 16, v74
    v_and_b32 v124, 0x4b0007ff, v124
    v_and_b32 v123, s32, v74
    v_lshlrev_b32 v74, 16, v75
    v_fma_f32 v124, v124, s33, v1
    v_and_b32 v75, s32, v75
    v_and_b32 v27, 0x1fff8, v27
    v_pk_fma_f32 v[74:75], v[74:75], v[124:125], s[28:29] op_sel_hi:[1,0,1]
    v_pk_fma_f32 v[122:123], v[122:123], v[124:125], s[28:29] op_sel_hi:[1,0,1]
    v_perm_b32 v75, v75, v74, s35
    v_perm_b32 v74, v123, v122, s35
    v_lshl_add_u64 v[74:75], v[74:75], 0, s[30:31]
    ds_add_rtn_u64 v[74:75], v27, v[74:75] offset:50000

    s_waitcnt lgkmcnt(4)
    v_or3_b32 v117, v60, v61, v117
    v_or3_b32 v117, v62, v63, v117
    v_or3_b32 v117, v64, v65, v117
    v_or3_b32 v117, v66, v67, v117
    s_cmp_le_i32 s42, 3072
    s_cbranch_scc1 L_nt2_146
    s_waitcnt vmcnt(2)
    v_cmp_ne_u32 vcc, 4, v102
    s_mov_b64 exec, vcc
    v_perm_b32 v120, v102, v115, s24
    v_lshlrev_b32 v118, 16, v28
    v_and_b32 v120, 0x4b0007ff, v120
    v_and_b32 v119, s32, v28
    v_lshlrev_b32 v28, 16, v29
    v_fma_f32 v120, v120, s33, v1
    v_and_b32 v29, s32, v29
    v_and_b32 v102, 0x1fff8, v102
    v_pk_fma_f32 v[28:29], v[28:29], v[120:121], s[28:29] op_sel_hi:[1,0,1]
    v_pk_fma_f32 v[118:119], v[118:119], v[120:121], s[28:29] op_sel_hi:[1,0,1]
    v_perm_b32 v29, v29, v28, s35
    v_perm_b32 v28, v119, v118, s35
    v_lshl_add_u64 v[28:29], v[28:29], 0, s[30:31]
    ds_add_rtn_u64 v[28:29], v102, v[28:29] offset:50000

    s_mov_b64 exec, -1
    v_cmp_ne_u32 vcc, 4, v103
    s_mov_b64 exec, vcc
    v_perm_b32 v124, v103, v115, s25
    v_lshlrev_b32 v122, 16, v30
    v_and_b32 v124, 0x4b0007ff, v124
    v_and_b32 v123, s32, v30
    v_lshlrev_b32 v30, 16, v31
    v_fma_f32 v124, v124, s33, v1
    v_and_b32 v31, s32, v31
    v_and_b32 v103, 0x1fff8, v103
    v_pk_fma_f32 v[30:31], v[30:31], v[124:125], s[28:29] op_sel_hi:[1,0,1]
    v_pk_fma_f32 v[122:123], v[122:123], v[124:125], s[28:29] op_sel_hi:[1,0,1]
    v_perm_b32 v31, v31, v30, s35
    v_perm_b32 v30, v123, v122, s35
    v_lshl_add_u64 v[30:31], v[30:31], 0, s[30:31]
    ds_add_rtn_u64 v[30:31], v103, v[30:31] offset:50000

    s_mov_b64 exec, -1
    v_cmp_ne_u32 vcc, 4, v104
    s_mov_b64 exec, vcc
    v_perm_b32 v120, v104, v115, s26
    v_lshlrev_b32 v118, 16, v32
    v_and_b32 v120, 0x4b0007ff, v120
    v_and_b32 v119, s32, v32
    v_lshlrev_b32 v32, 16, v33
    v_fma_f32 v120, v120, s33, v1
    v_and_b32 v33, s32, v33
    v_and_b32 v104, 0x1fff8, v104
    v_pk_fma_f32 v[32:33], v[32:33], v[120:121], s[28:29] op_sel_hi:[1,0,1]
    v_pk_fma_f32 v[118:119], v[118:119], v[120:121], s[28:29] op_sel_hi:[1,0,1]
    v_perm_b32 v33, v33, v32, s35
    v_perm_b32 v32, v119, v118, s35
    v_lshl_add_u64 v[32:33], v[32:33], 0, s[30:31]
    ds_add_rtn_u64 v[32:33], v104, v[32:33] offset:50000

    s_mov_b64 exec, -1
    v_cmp_ne_u32 vcc, 4, v105
    s_mov_b64 exec, vcc
    v_perm_b32 v124, v105, v115, s27
    v_lshlrev_b32 v122, 16, v34
    v_and_b32 v124, 0x4b0007ff, v124
    v_and_b32 v123, s32, v34
    v_lshlrev_b32 v34, 16, v35
    v_fma_f32 v124, v124, s33, v1
    v_and_b32 v35, s32, v35
    v_and_b32 v105, 0x1fff8, v105
    v_pk_fma_f32 v[34:35], v[34:35], v[124:125], s[28:29] op_sel_hi:[1,0,1]
    v_pk_fma_f32 v[122:123], v[122:123], v[124:125], s[28:29] op_sel_hi:[1,0,1]
    v_perm_b32 v35, v35, v34, s35
    v_perm_b32 v34, v123, v122, s35
    v_lshl_add_u64 v[34:35], v[34:35], 0, s[30:31]
    ds_add_rtn_u64 v[34:35], v105, v[34:35] offset:50000

    s_mov_b64 exec, -1
    s_waitcnt lgkmcnt(0)
    v_or3_b32 v117, v28, v29, v117
    v_or3_b32 v117, v30, v31, v117
    v_or3_b32 v117, v32, v33, v117
    v_or3_b32 v117, v34, v35, v117
L_nt2_146:
    s_movk_i32 s53, 15360
    buffer_load_dwordx4 v[102:105], v2, s[16:19], s53 offen
    buffer_load_dword v115, v2, s[16:19], s53 offen offset:16
    s_waitcnt lgkmcnt(0)
    v_or3_b32 v117, v68, v69, v117
    v_or3_b32 v117, v70, v71, v117
    v_or3_b32 v117, v72, v73, v117
    v_or3_b32 v117, v74, v75, v117
    s_cmp_le_u32 s40, 3584
    s_cbranch_scc1 L_noleft_149
    s_min_u32 s40, s40, 3968
    s_lshl_b32 s52, s38, 6
    s_add_u32 s52, s52, s36
    s_mul_i32 s52, s52, 19840
    s_add_u32 s20, s44, s52
    s_addc_u32 s21, s45, 0
    s_mul_i32 s52, s40, 5
    s_add_u32 s52, s52, 3
    s_and_b32 s22, s52, -4

    s_lshr_b32 s55, s39, 2
    s_add_u32 s55, s55, 3584
    v_and_b32 v36, 63, v0
    v_add_u32 v36, s55, v36
L_left_150:
    s_cmp_ge_u32 s55, s40
    s_cbranch_scc1 L_leftend_151
    v_mul_u32_u24 v37, 5, v36
    buffer_load_dword v38, v37, s[20:23], 0 offen
    buffer_load_ubyte v39, v37, s[20:23], 0 offen offset:4
    s_waitcnt vmcnt(1)

    v_lshrrev_b32 v42, 30, v38
    v_bfe_u32 v37, v38, 17, 13
    v_mul_u32_u24 v42, 6250, v42
    v_add_lshl_u32 v37, v37, v42, 3

    buffer_load_dwordx2 v[40:41], v37, s[8:11], s50 offen
    v_cmp_gt_u32 vcc, s40, v36
    s_waitcnt vmcnt(0)

    s_mov_b64 exec, vcc
    v_perm_b32 v120, v38, v39, s24
    v_lshlrev_b32 v118, 16, v40
    v_and_b32 v120, 0x4b0007ff, v120
    v_and_b32 v119, s32, v40
    v_lshlrev_b32 v40, 16, v41
    v_fma_f32 v120, v120, s33, v1
    v_and_b32 v41, s32, v41
    v_and_b32 v38, 0x1fff8, v38
    v_pk_fma_f32 v[40:41], v[40:41], v[120:121], s[28:29] op_sel_hi:[1,0,1]
    v_pk_fma_f32 v[118:119], v[118:119], v[120:121], s[28:29] op_sel_hi:[1,0,1]
    v_perm_b32 v41, v41, v40, s35
    v_perm_b32 v40, v119, v118, s35
    v_lshl_add_u64 v[40:41], v[40:41], 0, s[30:31]
    ds_add_rtn_u64 v[40:41], v38, v[40:41] offset:50000

    s_waitcnt lgkmcnt(0)
    v_or3_b32 v117, v40, v41, v117
    s_mov_b64 exec, -1
    v_add_u32 v36, 128, v36
    s_add_u32 s55, s55, 128
    s_branch L_left_150
L_leftend_151:

L_noleft_149:
    s_mov_b32 s38, s5
    s_cmp_lt_u32 s38, s4
    s_cbranch_scc1 L_batch_132
    s_barrier

    s_mul_i32 s3, s37, 6400000
    s_mul_i32 s5, s36, 100000
    s_add_u32 s3, s3, s5
    s_add_u32 s3, s3, 1048576

    s_add_u32 s20, s6, s3
    s_addc_u32 s21, s7, 0
    s_mov_b32 s22, 100000
    s_mov_b32 s23, 0x20000
    v_lshlrev_b32 v68, 3, v0
    v_add_u32 v69, 50008, v68
    v_add_u32 v70, 115544, v68
    v_cmp_gt_u32 vcc, 212, v0
    v_mov_b32 v52, 0
    v_mov_b32 v53, 0

    ds_read_b64 v[28:29], v69 offset:0
    ds_read_b64 v[30:31], v69 offset:8192
    ds_read_b64 v[32:33], v69 offset:16384
    ds_read_b64 v[34:35], v69 offset:24576
    ds_read_b64 v[36:37], v69 offset:32768
    ds_read_b64 v[38:39], v69 offset:40960
    ds_read_b64 v[40:41], v69 offset:49152
    ds_read_b64 v[42:43], v69 offset:57344
    ds_read_b64 v[44:45], v70 offset:0
    ds_read_b64 v[46:47], v70 offset:8192
    ds_read_b64 v[48:49], v70 offset:16384
    ds_read_b64 v[50:51], v70 offset:24576
    s_mov_b64 exec, vcc
    ds_read_b64 v[52:53], v70 offset:32768
    s_mov_b64 exec, -1
    s_waitcnt lgkmcnt(12)
    s_mov_b32 s3, 0
    buffer_store_dwordx2 v[28:29], v68, s[20:23], s3 offen
    s_waitcnt lgkmcnt(11)
    s_mov_b32 s3, 8192
    buffer_store_dwordx2 v[30:31], v68, s[20:23], s3 offen
    s_waitcnt lgkmcnt(10)
    s_mov_b32 s3, 16384
    buffer_store_dwordx2 v[32:33], v68, s[20:23], s3 offen
    s_waitcnt lgkmcnt(9)
    s_mov_b32 s3, 24576
    buffer_store_dwordx2 v[34:35], v68, s[20:23], s3 offen
    s_waitcnt lgkmcnt(8)
    s_mov_b32 s3, 32768
    buffer_store_dwordx2 v[36:37], v68, s[20:23], s3 offen
    s_waitcnt lgkmcnt(7)
    s_mov_b32 s3, 40960
    buffer_store_dwordx2 v[38:39], v68, s[20:23], s3 offen
    s_waitcnt lgkmcnt(6)
    s_mov_b32 s3, 49152
    buffer_store_dwordx2 v[40:41], v68, s[20:23], s3 offen
    s_waitcnt lgkmcnt(5)
    s_mov_b32 s3, 57344
    buffer_store_dwordx2 v[42:43], v68, s[20:23], s3 offen
    s_waitcnt lgkmcnt(4)
    s_mov_b32 s3, 65536
    buffer_store_dwordx2 v[44:45], v68, s[20:23], s3 offen
    s_waitcnt lgkmcnt(3)
    s_mov_b32 s3, 73728
    buffer_store_dwordx2 v[46:47], v68, s[20:23], s3 offen
    s_waitcnt lgkmcnt(2)
    s_mov_b32 s3, 81920
    buffer_store_dwordx2 v[48:49], v68, s[20:23], s3 offen
    s_waitcnt lgkmcnt(1)
    s_mov_b32 s3, 90112
    buffer_store_dwordx2 v[50:51], v68, s[20:23], s3 offen
    s_waitcnt lgkmcnt(0)
    s_mov_b32 s3, 98304
    buffer_store_dwordx2 v[52:53], v68, s[20:23], s3 offen
    v_or3_b32 v117, v28, v29, v117
    v_or3_b32 v117, v30, v31, v117
    v_or3_b32 v117, v32, v33, v117
    v_or3_b32 v117, v34, v35, v117
    v_or3_b32 v117, v36, v37, v117
    v_or3_b32 v117, v38, v39, v117
    v_or3_b32 v117, v40, v41, v117
    v_or3_b32 v117, v42, v43, v117
    v_or3_b32 v117, v44, v45, v117
    v_or3_b32 v117, v46, v47, v117
    v_or3_b32 v117, v48, v49, v117
    v_or3_b32 v117, v50, v51, v117
    v_or3_b32 v117, v52, v53, v117
    v_and_b32 v117, 0x80008000, v117
    v_cmp_ne_u32 vcc, 0, v117
    v_mov_b32 v71, 150024
    v_mov_b32 v72, 1
    s_cbranch_vccz L_nf_152
    ds_write_b32 v71, v72
L_nf_152:
    s_waitcnt lgkmcnt(0)
    s_barrier
    ds_read_b32 v72, v71
    s_waitcnt lgkmcnt(0)
    v_readfirstlane_b32 s3, v72
    s_nop 1
    s_cmp_lg_u32 s3, 0
    s_cbranch_scc1 L_p2slow_131

L_fin_153:
    s_add_u32 s20, s6, 147456
    s_addc_u32 s21, s7, 0
    s_mov_b32 s22, 1024
    s_mov_b32 s23, 0x20000
    s_lshl_b32 s3, s36, 2
    s_add_u32 s3, s3, s37
    s_lshl_b32 s3, s3, 2
    v_lshlrev_b32 v73, 20, v0
    v_mov_b32 v74, s34
    buffer_store_dword v74, v73, s[20:23], s3 offen

L_p2done_130:
    s_endpgm

L_ufix_133:
    v_and_b32 v124, 63, v0
    v_lshlrev_b32 v124, 2, v124
    s_sub_i32 s54, s42, 1536
    v_cmp_le_i32 vcc, s54, v124
    s_mov_b64 exec, vcc
    v_mov_b32 v16, 4
    v_and_b32 v109, 0xffffff00, v109
    s_mov_b64 exec, -1
    s_sub_i32 s54, s42, 1537
    v_cmp_le_i32 vcc, s54, v124
    s_mov_b64 exec, vcc
    v_mov_b32 v17, 4
    v_and_b32 v109, 0xffff00ff, v109
    s_mov_b64 exec, -1
    s_sub_i32 s54, s42, 1538
    v_cmp_le_i32 vcc, s54, v124
    s_mov_b64 exec, vcc
    v_mov_b32 v18, 4
    v_and_b32 v109, 0xff00ffff, v109
    s_mov_b64 exec, -1
    s_sub_i32 s54, s42, 1539
    v_cmp_le_i32 vcc, s54, v124
    s_mov_b64 exec, vcc
    v_mov_b32 v19, 4
    v_and_b32 v109, 0xffffff, v109
    s_mov_b64 exec, -1
    s_branch L_uback_134
L_ufix_135:
    v_and_b32 v124, 63, v0
    v_lshlrev_b32 v124, 2, v124
    s_sub_i32 s54, s42, 2048
    v_cmp_le_i32 vcc, s54, v124
    s_mov_b64 exec, vcc
    v_mov_b32 v20, 4
    v_and_b32 v110, 0xffffff00, v110
    s_mov_b64 exec, -1
    s_sub_i32 s54, s42, 2049
    v_cmp_le_i32 vcc, s54, v124
    s_mov_b64 exec, vcc
    v_mov_b32 v21, 4
    v_and_b32 v110, 0xffff00ff, v110
    s_mov_b64 exec, -1
    s_sub_i32 s54, s42, 2050
    v_cmp_le_i32 vcc, s54, v124
    s_mov_b64 exec, vcc
    v_mov_b32 v22, 4
    v_and_b32 v110, 0xff00ffff, v110
    s_mov_b64 exec, -1
    s_sub_i32 s54, s42, 2051
    v_cmp_le_i32 vcc, s54, v124
    s_mov_b64 exec, vcc
    v_mov_b32 v23, 4
    v_and_b32 v110, 0xffffff, v110
    s_mov_b64 exec, -1
    s_branch L_uback_136
L_ufix_137:
    v_and_b32 v124, 63, v0
    v_lshlrev_b32 v124, 2, v124
    s_sub_i32 s54, s42, 2560
    v_cmp_le_i32 vcc, s54, v124
    s_mov_b64 exec, vcc
    v_mov_b32 v24, 4
    v_and_b32 v111, 0xffffff00, v111
    s_mov_b64 exec, -1
    s_sub_i32 s54, s42, 2561
    v_cmp_le_i32 vcc, s54, v124
    s_mov_b64 exec, vcc
    v_mov_b32 v25, 4
    v_and_b32 v111, 0xffff00ff, v111
    s_mov_b64 exec, -1
    s_sub_i32 s54, s42, 2562
    v_cmp_le_i32 vcc, s54, v124
    s_mov_b64 exec, vcc
    v_mov_b32 v26, 4
    v_and_b32 v111, 0xff00ffff, v111
    s_mov_b64 exec, -1
    s_sub_i32 s54, s42, 2563
    v_cmp_le_i32 vcc, s54, v124
    s_mov_b64 exec, vcc
    v_mov_b32 v27, 4
    v_and_b32 v111, 0xffffff, v111
    s_mov_b64 exec, -1
    s_branch L_uback_138
L_ufix_139:
    v_and_b32 v124, 63, v0
    v_lshlrev_b32 v124, 2, v124
    s_sub_i32 s54, s42, 0
    v_cmp_le_i32 vcc, s54, v124
    s_mov_b64 exec, vcc
    v_mov_b32 v4, 4
    v_and_b32 v106, 0xffffff00, v106
    s_mov_b64 exec, -1
    s_sub_i32 s54, s42, 1
    v_cmp_le_i32 vcc, s54, v124
    s_mov_b64 exec, vcc
    v_mov_b32 v5, 4
    v_and_b32 v106, 0xffff00ff, v106
    s_mov_b64 exec, -1
    s_sub_i32 s54, s42, 2
    v_cmp_le_i32 vcc, s54, v124
    s_mov_b64 exec, vcc
    v_mov_b32 v6, 4
    v_and_b32 v106, 0xff00ffff, v106
    s_mov_b64 exec, -1
    s_sub_i32 s54, s42, 3
    v_cmp_le_i32 vcc, s54, v124
    s_mov_b64 exec, vcc
    v_mov_b32 v7, 4
    v_and_b32 v106, 0xffffff, v106
    s_mov_b64 exec, -1
    s_branch L_uback_140
L_ufix_141:
    v_and_b32 v124, 63, v0
    v_lshlrev_b32 v124, 2, v124
    s_sub_i32 s54, s42, 512
    v_cmp_le_i32 vcc, s54, v124
    s_mov_b64 exec, vcc
    v_mov_b32 v8, 4
    v_and_b32 v107, 0xffffff00, v107
    s_mov_b64 exec, -1
    s_sub_i32 s54, s42, 513
    v_cmp_le_i32 vcc, s54, v124
    s_mov_b64 exec, vcc
    v_mov_b32 v9, 4
    v_and_b32 v107, 0xffff00ff, v107
    s_mov_b64 exec, -1
    s_sub_i32 s54, s42, 514
    v_cmp_le_i32 vcc, s54, v124
    s_mov_b64 exec, vcc
    v_mov_b32 v10, 4
    v_and_b32 v107, 0xff00ffff, v107
    s_mov_b64 exec, -1
    s_sub_i32 s54, s42, 515
    v_cmp_le_i32 vcc, s54, v124
    s_mov_b64 exec, vcc
    v_mov_b32 v11, 4
    v_and_b32 v107, 0xffffff, v107
    s_mov_b64 exec, -1
    s_branch L_uback_142
L_ufix_143:
    v_and_b32 v124, 63, v0
    v_lshlrev_b32 v124, 2, v124
    s_sub_i32 s54, s42, 1024
    v_cmp_le_i32 vcc, s54, v124
    s_mov_b64 exec, vcc
    v_mov_b32 v12, 4
    v_and_b32 v108, 0xffffff00, v108
    s_mov_b64 exec, -1
    s_sub_i32 s54, s42, 1025
    v_cmp_le_i32 vcc, s54, v124
    s_mov_b64 exec, vcc
    v_mov_b32 v13, 4
    v_and_b32 v108, 0xffff00ff, v108
    s_mov_b64 exec, -1
    s_sub_i32 s54, s42, 1026
    v_cmp_le_i32 vcc, s54, v124
    s_mov_b64 exec, vcc
    v_mov_b32 v14, 4
    v_and_b32 v108, 0xff00ffff, v108
    s_mov_b64 exec, -1
    s_sub_i32 s54, s42, 1027
    v_cmp_le_i32 vcc, s54, v124
    s_mov_b64 exec, vcc
    v_mov_b32 v15, 4
    v_and_b32 v108, 0xffffff, v108
    s_mov_b64 exec, -1
    s_branch L_uback_144
L_ufix_147:
    v_and_b32 v124, 63, v0
    v_lshlrev_b32 v124, 2, v124
    s_sub_i32 s54, s42, 3072
    v_cmp_le_i32 vcc, s54, v124
    s_mov_b64 exec, vcc
    v_mov_b32 v102, 4
    v_and_b32 v115, 0xffffff00, v115
    s_mov_b64 exec, -1
    s_sub_i32 s54, s42, 3073
    v_cmp_le_i32 vcc, s54, v124
    s_mov_b64 exec, vcc
    v_mov_b32 v103, 4
    v_and_b32 v115, 0xffff00ff, v115
    s_mov_b64 exec, -1
    s_sub_i32 s54, s42, 3074
    v_cmp_le_i32 vcc, s54, v124
    s_mov_b64 exec, vcc
    v_mov_b32 v104, 4
    v_and_b32 v115, 0xff00ffff, v115
    s_mov_b64 exec, -1
    s_sub_i32 s54, s42, 3075
    v_cmp_le_i32 vcc, s54, v124
    s_mov_b64 exec, vcc
    v_mov_b32 v105, 4
    v_and_b32 v115, 0xffffff, v115
    s_mov_b64 exec, -1
    s_branch L_uback_148
L_p2slow_131:
    s_waitcnt vmcnt(0) lgkmcnt(0)
    s_mov_b32 s51, 1
    s_movk_i32 s43, 6250
    s_mov_b32 s34, 0
L_sweep_154:
    s_barrier

    v_mov_b32 v28, 0x0
    v_mov_b32 v29, 0x0
    v_mov_b32 v30, 0x0
    v_mov_b32 v31, 0x0
    v_add_u32 v32, 50000, v3
    v_add_u32 v33, 65536, v32

    ds_write_b128 v32, v[28:31] offset:0
    ds_write_b128 v32, v[28:31] offset:16384
    ds_write_b128 v32, v[28:31] offset:32768
    ds_write_b128 v32, v[28:31] offset:49152
    ds_write_b128 v33, v[28:31] offset:0
    ds_write_b128 v33, v[28:31] offset:16384
    v_cmp_gt_u32 vcc, 107, v0
    s_mov_b64 exec, vcc
    ds_write_b128 v33, v[28:31] offset:32768
    s_mov_b64 exec, -1
    s_waitcnt lgkmcnt(0)
    s_barrier
    s_sub_u32 s38, s4, 8
L_sbatch_155:
    s_lshl_b32 s52, s38, 6
    s_add_u32 s52, s52, s36
    s_lshl_b32 s52, s52, 2
    s_load_dword s40, s[46:47], s52
    s_mul_i32 s50, s38, 200000
    s_waitcnt lgkmcnt(0)

    s_min_u32 s40, s40, 3968
    s_lshl_b32 s52, s38, 6
    s_add_u32 s52, s52, s36
    s_mul_i32 s52, s52, 19840
    s_add_u32 s20, s44, s52
    s_addc_u32 s21, s45, 0
    s_mul_i32 s52, s40, 5
    s_add_u32 s52, s52, 3
    s_and_b32 s22, s52, -4

    s_lshr_b32 s55, s39, 2
    s_add_u32 s55, s55, 0
    v_and_b32 v36, 63, v0
    v_add_u32 v36, s55, v36
L_left_159:
    s_cmp_ge_u32 s55, s40
    s_cbranch_scc1 L_leftend_160
    v_mul_u32_u24 v37, 5, v36
    buffer_load_dword v38, v37, s[20:23], 0 offen
    buffer_load_ubyte v39, v37, s[20:23], 0 offen offset:4
    s_waitcnt vmcnt(1)

    v_lshrrev_b32 v42, 30, v38
    v_bfe_u32 v37, v38, 17, 13
    v_mul_u32_u24 v42, 6250, v42
    v_add_lshl_u32 v37, v37, v42, 3

    buffer_load_dwordx2 v[40:41], v37, s[8:11], s50 offen
    v_cmp_gt_u32 vcc, s40, v36
    s_waitcnt vmcnt(0)

    v_bfe_u32 v44, v38, 3, 14
    v_subrev_u32 v44, s51, v44
    v_cmp_gt_u32 s[64:65], s43, v44
    s_and_b64 exec, vcc, s[64:65]
    v_lshlrev_b32 v44, 4, v44
    v_and_b32 v38, 7, v38
    v_and_b32 v39, 0xff, v39
    v_lshl_or_b32 v38, v38, 8, v39
    v_cvt_f32_u32 v38, v38
    v_add_f32 v38, 0xc4800000, v38
    v_mul_f32 v38, 0x3a802008, v38
    v_lshlrev_b32 v45, 16, v40
    v_and_b32 v46, s32, v40
    v_lshlrev_b32 v47, 16, v41
    v_and_b32 v48, s32, v41

    v_mul_f32 v45, v45, v38
    ds_add_f32 v44, v45 offset:50000
    v_mul_f32 v46, v46, v38
    ds_add_f32 v44, v46 offset:50004
    v_mul_f32 v47, v47, v38
    ds_add_f32 v44, v47 offset:50008
    v_mul_f32 v48, v48, v38
    ds_add_f32 v44, v48 offset:50012
    s_mov_b64 exec, -1
    v_add_u32 v36, 128, v36
    s_add_u32 s55, s55, 128
    s_branch L_left_159
L_leftend_160:

    s_add_u32 s38, s38, 1
    s_cmp_lt_u32 s38, s4
    s_cbranch_scc1 L_sbatch_155
    s_mov_b32 s3, 131072
    s_load_dword s40, s[6:7], s3

    s_add_u32 s20, s6, 402907136
    s_addc_u32 s21, s7, 0
    s_mov_b32 s22, 409600000
    s_mov_b32 s23, 0x20000
    s_mov_b32 s38, 0
    s_mov_b32 s50, 200000
    v_mov_b32 v36, v0
    s_waitcnt lgkmcnt(0)
L_ovf_156:
    s_cmp_ge_u32 s38, s40
    s_cbranch_scc1 L_ovfend_157
    v_lshlrev_b32 v37, 3, v36
    buffer_load_dwordx2 v[38:39], v37, s[20:23], 0 offen
    s_waitcnt vmcnt(0)

    v_lshrrev_b32 v42, 30, v38
    v_bfe_u32 v37, v38, 17, 13
    v_mul_u32_u24 v42, 6250, v42
    v_add_lshl_u32 v37, v37, v42, 3

    v_bfe_u32 v42, v39, 24, 5
    v_mad_u32_u24 v37, v42, s50, v37
    buffer_load_dwordx2 v[40:41], v37, s[8:11], 0 offen
    v_lshrrev_b32 v42, 3, v42
    v_bfe_u32 v43, v39, 18, 6
    v_cmp_gt_u32 vcc, s40, v36
    v_cmp_eq_u32 s[64:65], s36, v43
    s_and_b64 vcc, vcc, s[64:65]
    v_cmp_eq_u32 s[64:65], s37, v42
    s_and_b64 vcc, vcc, s[64:65]
    s_waitcnt vmcnt(0)

    v_bfe_u32 v44, v38, 3, 14
    v_subrev_u32 v44, s51, v44
    v_cmp_gt_u32 s[64:65], s43, v44
    s_and_b64 exec, vcc, s[64:65]
    v_lshlrev_b32 v44, 4, v44
    v_and_b32 v38, 7, v38
    v_and_b32 v39, 0xff, v39
    v_lshl_or_b32 v38, v38, 8, v39
    v_cvt_f32_u32 v38, v38
    v_add_f32 v38, 0xc4800000, v38
    v_mul_f32 v38, 0x3a802008, v38
    v_lshlrev_b32 v45, 16, v40
    v_and_b32 v46, s32, v40
    v_lshlrev_b32 v47, 16, v41
    v_and_b32 v48, s32, v41

    v_mul_f32 v45, v45, v38
    ds_add_f32 v44, v45 offset:50000
    v_mul_f32 v46, v46, v38
    ds_add_f32 v44, v46 offset:50004
    v_mul_f32 v47, v47, v38
    ds_add_f32 v44, v47 offset:50008
    v_mul_f32 v48, v48, v38
    ds_add_f32 v44, v48 offset:50012
    s_mov_b64 exec, -1
    v_add_u32 v36, 1024, v36
    s_add_u32 s38, s38, 1024
    s_branch L_ovf_156
L_ovfend_157:
    s_waitcnt lgkmcnt(0)
    s_barrier
    s_mul_i32 s3, s37, 800000
    s_mul_i32 s5, s36, 12500
    s_add_u32 s3, s3, s5
    s_add_u32 s3, s3, s51
    s_sub_u32 s3, s3, 1
    s_lshl_b32 s3, s3, 4
    s_add_u32 s3, s3, 26648576

    s_add_u32 s20, s6, s3
    s_addc_u32 s21, s7, 0
    s_mov_b32 s22, 100000
    s_mov_b32 s23, 0x20000
    v_mov_b32 v36, v3
    s_mov_b32 s38, 0
L_wl_158:
    v_min_u32 v37, 100000, v36
    ds_read_b128 v[28:31], v37 offset:50000
    s_waitcnt lgkmcnt(0)
    buffer_store_dwordx4 v[28:31], v36, s[20:23], 0 offen
    s_waitcnt vmcnt(0)
    v_add_u32 v36, 16384, v36
    s_add_u32 s38, s38, 1024
    s_cmp_lt_u32 s38, 6250
    s_cbranch_scc1 L_wl_158
    s_add_u32 s51, s51, 6250
    s_cmp_lt_u32 s51, 12500
    s_cbranch_scc1 L_sweep_154
    s_branch L_fin_153

.globl standalone__molecular_angular_gemnet__graph_kernel
.p2align 8
.type standalone__molecular_angular_gemnet__graph_kernel,@function
standalone__molecular_angular_gemnet__graph_kernel:
    s_cmp_ge_u32 s2, 3200
    s_cbranch_scc1 L_fdone_161
    s_load_dwordx2 s[4:5], s[0:1], 0
    s_load_dwordx2 s[6:7], s[0:1], 24
    s_load_dwordx2 s[8:9], s[0:1], 40
    s_load_dwordx8 s[12:19], s[0:1], 56
    s_load_dwordx2 s[10:11], s[0:1], 88
    s_load_dwordx2 s[20:21], s[0:1], 104
    v_cmp_gt_u32 vcc, 250, v0
    s_mul_i32 s3, s2, 250
    v_add_u32 v0, s3, v0
    v_lshlrev_b32 v1, 4, v0
    v_lshlrev_b32 v2, 3, v0
    v_lshlrev_b32 v3, 1, v0
    s_mov_b64 exec, vcc
    s_mul_hi_u32 s3, s2, 85899346
    s_lshl_b32 s3, s3, 4
    s_add_u32 s3, s3, 147456
    s_waitcnt lgkmcnt(0)
    s_load_dwordx4 s[96:99], s[20:21], s3
    s_load_dwordx4 s[40:43], s[8:9], 0
    s_load_dwordx16 s[44:59], s[12:13], 0
    s_load_dwordx16 s[60:75], s[14:15], 0
    s_load_dwordx8 s[76:83], s[16:17], 0
    s_load_dwordx8 s[84:91], s[18:19], 0

    s_add_u32 s24, s20, 1048576
    s_addc_u32 s25, s21, 0
    s_mov_b32 s26, 76800000
    s_mov_b32 s27, 0x20000
    s_mov_b32 s28, s4
    s_mov_b32 s29, s5
    s_mov_b32 s30, 6400000
    s_mov_b32 s31, 0x20000
    s_mov_b32 s32, s6
    s_mov_b32 s33, s7
    s_mov_b32 s34, 1600000
    s_mov_b32 s35, 0x20000
    s_mov_b32 s36, s10
    s_mov_b32 s37, s11
    s_mov_b32 s38, 6400000
    s_mov_b32 s39, 0x20000
    buffer_load_ushort v4, v3, s[32:35], 0 offen
    buffer_load_dwordx2 v[32:33], v2, s[24:27], 0 offen
    s_mov_b32 s3, 6400000
    buffer_load_dwordx2 v[34:35], v2, s[24:27], s3 offen
    s_mov_b32 s3, 12800000
    buffer_load_dwordx2 v[36:37], v2, s[24:27], s3 offen
    s_mov_b32 s3, 19200000
    buffer_load_dwordx2 v[38:39], v2, s[24:27], s3 offen
    buffer_load_dwordx2 v[6:7], v2, s[28:31], 0 offen
    s_mov_b32 s94, 0xffff0000
    s_mov_b32 s95, 0xc1200000
    s_mov_b32 s22, 0x3fb8aa3b
    s_waitcnt vmcnt(5) lgkmcnt(0)
    v_lshlrev_b32 v4, 16, v4

    s_lshl_b32 s92, s40, 16
    v_subrev_f32 v16, s92, v4
    s_and_b32 s93, s40, s94
    v_subrev_f32 v17, s93, v4
    s_lshl_b32 s92, s41, 16
    v_subrev_f32 v18, s92, v4
    s_and_b32 s93, s41, s94
    v_subrev_f32 v19, s93, v4
    s_lshl_b32 s92, s42, 16
    v_subrev_f32 v20, s92, v4
    s_and_b32 s93, s42, s94
    v_subrev_f32 v21, s93, v4
    s_lshl_b32 s92, s43, 16
    v_subrev_f32 v22, s92, v4
    s_and_b32 s93, s43, s94
    v_subrev_f32 v23, s93, v4
    v_cvt_pk_bf16_f32 v16, v16, v17
    v_and_b32 v17, s94, v16
    v_lshlrev_b32 v16, 16, v16
    v_cvt_pk_bf16_f32 v18, v18, v19
    v_and_b32 v19, s94, v18
    v_lshlrev_b32 v18, 16, v18
    v_cvt_pk_bf16_f32 v20, v20, v21
    v_and_b32 v21, s94, v20
    v_lshlrev_b32 v20, 16, v20
    v_cvt_pk_bf16_f32 v22, v22, v23
    v_and_b32 v23, s94, v22
    v_lshlrev_b32 v22, 16, v22
    v_mul_f32 v16, v16, v16
    v_mul_f32 v17, v17, v17
    v_mul_f32 v18, v18, v18
    v_mul_f32 v19, v19, v19
    v_mul_f32 v20, v20, v20
    v_mul_f32 v21, v21, v21
    v_mul_f32 v22, v22, v22
    v_mul_f32 v23, v23, v23
    v_cvt_pk_bf16_f32 v16, v16, v17
    v_and_b32 v17, s94, v16
    v_lshlrev_b32 v16, 16, v16
    v_cvt_pk_bf16_f32 v18, v18, v19
    v_and_b32 v19, s94, v18
    v_lshlrev_b32 v18, 16, v18
    v_cvt_pk_bf16_f32 v20, v20, v21
    v_and_b32 v21, s94, v20
    v_lshlrev_b32 v20, 16, v20
    v_cvt_pk_bf16_f32 v22, v22, v23
    v_and_b32 v23, s94, v22
    v_lshlrev_b32 v22, 16, v22
    v_mul_f32 v16, s95, v16
    v_mul_f32 v17, s95, v17
    v_mul_f32 v18, s95, v18
    v_mul_f32 v19, s95, v19
    v_mul_f32 v20, s95, v20
    v_mul_f32 v21, s95, v21
    v_mul_f32 v22, s95, v22
    v_mul_f32 v23, s95, v23
    v_cvt_pk_bf16_f32 v16, v16, v17
    v_and_b32 v17, s94, v16
    v_lshlrev_b32 v16, 16, v16
    v_cvt_pk_bf16_f32 v18, v18, v19
    v_and_b32 v19, s94, v18
    v_lshlrev_b32 v18, 16, v18
    v_cvt_pk_bf16_f32 v20, v20, v21
    v_and_b32 v21, s94, v20
    v_lshlrev_b32 v20, 16, v20
    v_cvt_pk_bf16_f32 v22, v22, v23
    v_and_b32 v23, s94, v22
    v_lshlrev_b32 v22, 16, v22
    v_mul_f32 v16, s22, v16
    v_mul_f32 v17, s22, v17
    v_mul_f32 v18, s22, v18
    v_mul_f32 v19, s22, v19
    v_mul_f32 v20, s22, v20
    v_mul_f32 v21, s22, v21
    v_mul_f32 v22, s22, v22
    v_mul_f32 v23, s22, v23
    v_exp_f32 v16, v16
    v_exp_f32 v17, v17
    v_exp_f32 v18, v18
    v_exp_f32 v19, v19
    v_exp_f32 v20, v20
    v_exp_f32 v21, v21
    v_exp_f32 v22, v22
    v_exp_f32 v23, v23
    s_nop 0
    v_cvt_pk_bf16_f32 v16, v16, v17
    v_and_b32 v17, s94, v16
    v_lshlrev_b32 v16, 16, v16
    v_cvt_pk_bf16_f32 v18, v18, v19
    v_and_b32 v19, s94, v18
    v_lshlrev_b32 v18, 16, v18
    v_cvt_pk_bf16_f32 v20, v20, v21
    v_and_b32 v21, s94, v20
    v_lshlrev_b32 v20, 16, v20
    v_cvt_pk_bf16_f32 v22, v22, v23
    v_and_b32 v23, s94, v22
    v_lshlrev_b32 v22, 16, v22
    s_lshl_b32 s92, s60, 16
    v_mul_f32 v24, s92, v16
    s_and_b32 s93, s60, s94
    v_mul_f32 v25, s93, v16
    s_lshl_b32 s92, s61, 16
    v_mul_f32 v26, s92, v16
    s_and_b32 s93, s61, s94
    v_mul_f32 v27, s93, v16
    s_lshl_b32 s92, s62, 16
    v_fmac_f32 v24, s92, v17
    s_and_b32 s93, s62, s94
    v_fmac_f32 v25, s93, v17
    s_lshl_b32 s92, s63, 16
    v_fmac_f32 v26, s92, v17
    s_and_b32 s93, s63, s94
    v_fmac_f32 v27, s93, v17
    s_lshl_b32 s92, s64, 16
    v_fmac_f32 v24, s92, v18
    s_and_b32 s93, s64, s94
    v_fmac_f32 v25, s93, v18
    s_lshl_b32 s92, s65, 16
    v_fmac_f32 v26, s92, v18
    s_and_b32 s93, s65, s94
    v_fmac_f32 v27, s93, v18
    s_lshl_b32 s92, s66, 16
    v_fmac_f32 v24, s92, v19
    s_and_b32 s93, s66, s94
    v_fmac_f32 v25, s93, v19
    s_lshl_b32 s92, s67, 16
    v_fmac_f32 v26, s92, v19
    s_and_b32 s93, s67, s94
    v_fmac_f32 v27, s93, v19
    s_lshl_b32 s92, s68, 16
    v_fmac_f32 v24, s92, v20
    s_and_b32 s93, s68, s94
    v_fmac_f32 v25, s93, v20
    s_lshl_b32 s92, s69, 16
    v_fmac_f32 v26, s92, v20
    s_and_b32 s93, s69, s94
    v_fmac_f32 v27, s93, v20
    s_lshl_b32 s92, s70, 16
    v_fmac_f32 v24, s92, v21
    s_and_b32 s93, s70, s94
    v_fmac_f32 v25, s93, v21
    s_lshl_b32 s92, s71, 16
    v_fmac_f32 v26, s92, v21
    s_and_b32 s93, s71, s94
    v_fmac_f32 v27, s93, v21
    s_lshl_b32 s92, s72, 16
    v_fmac_f32 v24, s92, v22
    s_and_b32 s93, s72, s94
    v_fmac_f32 v25, s93, v22
    s_lshl_b32 s92, s73, 16
    v_fmac_f32 v26, s92, v22
    s_and_b32 s93, s73, s94
    v_fmac_f32 v27, s93, v22
    s_lshl_b32 s92, s74, 16
    v_fmac_f32 v24, s92, v23
    s_and_b32 s93, s74, s94
    v_fmac_f32 v25, s93, v23
    s_lshl_b32 s92, s75, 16
    v_fmac_f32 v26, s92, v23
    s_and_b32 s93, s75, s94
    v_fmac_f32 v27, s93, v23
    s_lshl_b32 s92, s44, 16
    v_mul_f32 v28, s92, v16
    s_and_b32 s93, s44, s94
    v_mul_f32 v29, s93, v16
    s_lshl_b32 s92, s45, 16
    v_mul_f32 v30, s92, v16
    s_and_b32 s93, s45, s94
    v_mul_f32 v31, s93, v16
    s_lshl_b32 s92, s46, 16
    v_fmac_f32 v28, s92, v17
    s_and_b32 s93, s46, s94
    v_fmac_f32 v29, s93, v17
    s_lshl_b32 s92, s47, 16
    v_fmac_f32 v30, s92, v17
    s_and_b32 s93, s47, s94
    v_fmac_f32 v31, s93, v17
    s_lshl_b32 s92, s48, 16
    v_fmac_f32 v28, s92, v18
    s_and_b32 s93, s48, s94
    v_fmac_f32 v29, s93, v18
    s_lshl_b32 s92, s49, 16
    v_fmac_f32 v30, s92, v18
    s_and_b32 s93, s49, s94
    v_fmac_f32 v31, s93, v18
    s_lshl_b32 s92, s50, 16
    v_fmac_f32 v28, s92, v19
    s_and_b32 s93, s50, s94
    v_fmac_f32 v29, s93, v19
    s_lshl_b32 s92, s51, 16
    v_fmac_f32 v30, s92, v19
    s_and_b32 s93, s51, s94
    v_fmac_f32 v31, s93, v19
    s_lshl_b32 s92, s52, 16
    v_fmac_f32 v28, s92, v20
    s_and_b32 s93, s52, s94
    v_fmac_f32 v29, s93, v20
    s_lshl_b32 s92, s53, 16
    v_fmac_f32 v30, s92, v20
    s_and_b32 s93, s53, s94
    v_fmac_f32 v31, s93, v20
    s_lshl_b32 s92, s54, 16
    v_fmac_f32 v28, s92, v21
    s_and_b32 s93, s54, s94
    v_fmac_f32 v29, s93, v21
    s_lshl_b32 s92, s55, 16
    v_fmac_f32 v30, s92, v21
    s_and_b32 s93, s55, s94
    v_fmac_f32 v31, s93, v21
    s_lshl_b32 s92, s56, 16
    v_fmac_f32 v28, s92, v22
    s_and_b32 s93, s56, s94
    v_fmac_f32 v29, s93, v22
    s_lshl_b32 s92, s57, 16
    v_fmac_f32 v30, s92, v22
    s_and_b32 s93, s57, s94
    v_fmac_f32 v31, s93, v22
    s_lshl_b32 s92, s58, 16
    v_fmac_f32 v28, s92, v23
    s_and_b32 s93, s58, s94
    v_fmac_f32 v29, s93, v23
    s_lshl_b32 s92, s59, 16
    v_fmac_f32 v30, s92, v23
    s_and_b32 s93, s59, s94
    v_fmac_f32 v31, s93, v23
    v_cvt_pk_bf16_f32 v28, v28, v29
    v_and_b32 v29, s94, v28
    v_lshlrev_b32 v28, 16, v28
    v_cvt_pk_bf16_f32 v30, v30, v31
    v_and_b32 v31, s94, v30
    v_lshlrev_b32 v30, 16, v30
    s_waitcnt vmcnt(1)
    v_mov_b32 v8, 0
    v_mov_b32 v9, 0
    v_mov_b32 v10, 0
    v_mov_b32 v11, 0
    s_cmp_eq_u32 s96, 0
    s_cbranch_scc1 L_ffl_162
    v_cvt_f32_u32_sdwa v12, v32 dst_sel:DWORD dst_unused:UNUSED_PAD src0_sel:WORD_0
    v_cvt_f32_u32_sdwa v13, v32 dst_sel:DWORD dst_unused:UNUSED_PAD src0_sel:WORD_1
    v_cvt_f32_u32_sdwa v14, v33 dst_sel:DWORD dst_unused:UNUSED_PAD src0_sel:WORD_0
    v_cvt_f32_u32_sdwa v15, v33 dst_sel:DWORD dst_unused:UNUSED_PAD src0_sel:WORD_1
    v_add_f32 v12, 0xc6800000, v12
    v_add_f32 v13, 0xc6800000, v13
    v_add_f32 v14, 0xc6800000, v14
    v_add_f32 v15, 0xc6800000, v15
    v_fmac_f32 v8, s96, v12
    v_fmac_f32 v9, s96, v13
    v_fmac_f32 v10, s96, v14
    v_fmac_f32 v11, s96, v15
L_fbk_163:
    s_cmp_eq_u32 s97, 0
    s_cbranch_scc1 L_ffl_164
    v_cvt_f32_u32_sdwa v12, v34 dst_sel:DWORD dst_unused:UNUSED_PAD src0_sel:WORD_0
    v_cvt_f32_u32_sdwa v13, v34 dst_sel:DWORD dst_unused:UNUSED_PAD src0_sel:WORD_1
    v_cvt_f32_u32_sdwa v14, v35 dst_sel:DWORD dst_unused:UNUSED_PAD src0_sel:WORD_0
    v_cvt_f32_u32_sdwa v15, v35 dst_sel:DWORD dst_unused:UNUSED_PAD src0_sel:WORD_1
    v_add_f32 v12, 0xc6800000, v12
    v_add_f32 v13, 0xc6800000, v13
    v_add_f32 v14, 0xc6800000, v14
    v_add_f32 v15, 0xc6800000, v15
    v_fmac_f32 v8, s97, v12
    v_fmac_f32 v9, s97, v13
    v_fmac_f32 v10, s97, v14
    v_fmac_f32 v11, s97, v15
L_fbk_165:
    s_cmp_eq_u32 s98, 0
    s_cbranch_scc1 L_ffl_166
    v_cvt_f32_u32_sdwa v12, v36 dst_sel:DWORD dst_unused:UNUSED_PAD src0_sel:WORD_0
    v_cvt_f32_u32_sdwa v13, v36 dst_sel:DWORD dst_unused:UNUSED_PAD src0_sel:WORD_1
    v_cvt_f32_u32_sdwa v14, v37 dst_sel:DWORD dst_unused:UNUSED_PAD src0_sel:WORD_0
    v_cvt_f32_u32_sdwa v15, v37 dst_sel:DWORD dst_unused:UNUSED_PAD src0_sel:WORD_1
    v_add_f32 v12, 0xc6800000, v12
    v_add_f32 v13, 0xc6800000, v13
    v_add_f32 v14, 0xc6800000, v14
    v_add_f32 v15, 0xc6800000, v15
    v_fmac_f32 v8, s98, v12
    v_fmac_f32 v9, s98, v13
    v_fmac_f32 v10, s98, v14
    v_fmac_f32 v11, s98, v15
L_fbk_167:
    s_cmp_eq_u32 s99, 0
    s_cbranch_scc1 L_ffl_168
    v_cvt_f32_u32_sdwa v12, v38 dst_sel:DWORD dst_unused:UNUSED_PAD src0_sel:WORD_0
    v_cvt_f32_u32_sdwa v13, v38 dst_sel:DWORD dst_unused:UNUSED_PAD src0_sel:WORD_1
    v_cvt_f32_u32_sdwa v14, v39 dst_sel:DWORD dst_unused:UNUSED_PAD src0_sel:WORD_0
    v_cvt_f32_u32_sdwa v15, v39 dst_sel:DWORD dst_unused:UNUSED_PAD src0_sel:WORD_1
    v_add_f32 v12, 0xc6800000, v12
    v_add_f32 v13, 0xc6800000, v13
    v_add_f32 v14, 0xc6800000, v14
    v_add_f32 v15, 0xc6800000, v15
    v_fmac_f32 v8, s99, v12
    v_fmac_f32 v9, s99, v13
    v_fmac_f32 v10, s99, v14
    v_fmac_f32 v11, s99, v15
L_fbk_169:
    s_lshl_b32 s92, s76, 16
    v_mul_f32 v16, s92, v8
    s_and_b32 s93, s76, s94
    v_mul_f32 v17, s93, v8
    s_lshl_b32 s92, s77, 16
    v_mul_f32 v18, s92, v8
    s_and_b32 s93, s77, s94
    v_mul_f32 v19, s93, v8
    s_lshl_b32 s92, s78, 16
    v_fmac_f32 v16, s92, v9
    s_and_b32 s93, s78, s94
    v_fmac_f32 v17, s93, v9
    s_lshl_b32 s92, s79, 16
    v_fmac_f32 v18, s92, v9
    s_and_b32 s93, s79, s94
    v_fmac_f32 v19, s93, v9
    s_lshl_b32 s92, s80, 16
    v_fmac_f32 v16, s92, v10
    s_and_b32 s93, s80, s94
    v_fmac_f32 v17, s93, v10
    s_lshl_b32 s92, s81, 16
    v_fmac_f32 v18, s92, v10
    s_and_b32 s93, s81, s94
    v_fmac_f32 v19, s93, v10
    s_lshl_b32 s92, s82, 16
    v_fmac_f32 v16, s92, v11
    s_and_b32 s93, s82, s94
    v_fmac_f32 v17, s93, v11
    s_lshl_b32 s92, s83, 16
    v_fmac_f32 v18, s92, v11
    s_and_b32 s93, s83, s94
    v_fmac_f32 v19, s93, v11
    v_mul_f32 v16, v16, v24
    v_mul_f32 v17, v17, v25
    v_mul_f32 v18, v18, v26
    v_mul_f32 v19, v19, v27
    v_cvt_pk_bf16_f32 v16, v16, v17
    v_and_b32 v17, s94, v16
    v_lshlrev_b32 v16, 16, v16
    v_cvt_pk_bf16_f32 v18, v18, v19
    v_and_b32 v19, s94, v18
    v_lshlrev_b32 v18, 16, v18
    s_lshl_b32 s92, s84, 16
    v_mul_f32 v20, s92, v16
    s_and_b32 s93, s84, s94
    v_mul_f32 v21, s93, v16
    s_lshl_b32 s92, s85, 16
    v_mul_f32 v22, s92, v16
    s_and_b32 s93, s85, s94
    v_mul_f32 v23, s93, v16
    s_lshl_b32 s92, s86, 16
    v_fmac_f32 v20, s92, v17
    s_and_b32 s93, s86, s94
    v_fmac_f32 v21, s93, v17
    s_lshl_b32 s92, s87, 16
    v_fmac_f32 v22, s92, v17
    s_and_b32 s93, s87, s94
    v_fmac_f32 v23, s93, v17
    s_lshl_b32 s92, s88, 16
    v_fmac_f32 v20, s92, v18
    s_and_b32 s93, s88, s94
    v_fmac_f32 v21, s93, v18
    s_lshl_b32 s92, s89, 16
    v_fmac_f32 v22, s92, v18
    s_and_b32 s93, s89, s94
    v_fmac_f32 v23, s93, v18
    s_lshl_b32 s92, s90, 16
    v_fmac_f32 v20, s92, v19
    s_and_b32 s93, s90, s94
    v_fmac_f32 v21, s93, v19
    s_lshl_b32 s92, s91, 16
    v_fmac_f32 v22, s92, v19
    s_and_b32 s93, s91, s94
    v_fmac_f32 v23, s93, v19
    v_cvt_pk_bf16_f32 v20, v20, v21
    v_and_b32 v21, s94, v20
    v_lshlrev_b32 v20, 16, v20
    v_cvt_pk_bf16_f32 v22, v22, v23
    v_and_b32 v23, s94, v22
    v_lshlrev_b32 v22, 16, v22
    v_mul_f32 v20, v20, v28
    v_mul_f32 v21, v21, v29
    v_mul_f32 v22, v22, v30
    v_mul_f32 v23, v23, v31
    v_cvt_pk_bf16_f32 v20, v20, v21
    v_and_b32 v21, s94, v20
    v_lshlrev_b32 v20, 16, v20
    v_cvt_pk_bf16_f32 v22, v22, v23
    v_and_b32 v23, s94, v22
    v_lshlrev_b32 v22, 16, v22
    s_waitcnt vmcnt(0)
    v_lshlrev_b32 v8, 16, v6
    v_and_b32 v9, s94, v6
    v_lshlrev_b32 v10, 16, v7
    v_and_b32 v11, s94, v7

    v_add_f32 v8, v8, v20
    v_add_f32 v9, v9, v21
    v_add_f32 v10, v10, v22
    v_add_f32 v11, v11, v23
    v_cvt_pk_bf16_f32 v12, v8, v9
    v_cvt_pk_bf16_f32 v13, v10, v11
    buffer_store_dwordx2 v[12:13], v2, s[36:39], 0 offen
L_fdone_161:
    s_endpgm

L_ffl_162:
    s_mov_b32 s3, 25600000
    buffer_load_dwordx4 v[12:15], v1, s[24:27], s3 offen
    s_waitcnt vmcnt(0)
    v_add_f32 v8, v8, v12
    v_add_f32 v9, v9, v13
    v_add_f32 v10, v10, v14
    v_add_f32 v11, v11, v15
    s_branch L_fbk_163

L_ffl_164:
    s_mov_b32 s3, 38400000
    buffer_load_dwordx4 v[12:15], v1, s[24:27], s3 offen
    s_waitcnt vmcnt(0)
    v_add_f32 v8, v8, v12
    v_add_f32 v9, v9, v13
    v_add_f32 v10, v10, v14
    v_add_f32 v11, v11, v15
    s_branch L_fbk_165

L_ffl_166:
    s_mov_b32 s3, 51200000
    buffer_load_dwordx4 v[12:15], v1, s[24:27], s3 offen
    s_waitcnt vmcnt(0)
    v_add_f32 v8, v8, v12
    v_add_f32 v9, v9, v13
    v_add_f32 v10, v10, v14
    v_add_f32 v11, v11, v15
    s_branch L_fbk_167

L_ffl_168:
    s_mov_b32 s3, 64000000
    buffer_load_dwordx4 v[12:15], v1, s[24:27], s3 offen
    s_waitcnt vmcnt(0)
    v_add_f32 v8, v8, v12
    v_add_f32 v9, v9, v13
    v_add_f32 v10, v10, v14
    v_add_f32 v11, v11, v15
    s_branch L_fbk_169

.section .rodata,"a"
.p2align 6
.amdhsa_kernel g0_kernel
  .amdhsa_next_free_vgpr 40
  .amdhsa_next_free_sgpr 32
  .amdhsa_accum_offset 40
  .amdhsa_group_segment_fixed_size 0
  .amdhsa_kernarg_size 112
  .amdhsa_user_sgpr_count 2
  .amdhsa_user_sgpr_kernarg_segment_ptr 1
  .amdhsa_system_sgpr_workgroup_id_x 1
.end_amdhsa_kernel
.p2align 6
.amdhsa_kernel g1_kernel
  .amdhsa_next_free_vgpr 128
  .amdhsa_next_free_sgpr 102
  .amdhsa_accum_offset 128
  .amdhsa_group_segment_fixed_size 0
  .amdhsa_kernarg_size 112
  .amdhsa_user_sgpr_count 2
  .amdhsa_user_sgpr_kernarg_segment_ptr 1
  .amdhsa_system_sgpr_workgroup_id_x 1
.end_amdhsa_kernel
.p2align 6
.amdhsa_kernel g2_kernel
  .amdhsa_next_free_vgpr 128
  .amdhsa_next_free_sgpr 102
  .amdhsa_accum_offset 128
  .amdhsa_group_segment_fixed_size 0
  .amdhsa_kernarg_size 112
  .amdhsa_user_sgpr_count 2
  .amdhsa_user_sgpr_kernarg_segment_ptr 1
  .amdhsa_system_sgpr_workgroup_id_x 1
  .amdhsa_float_denorm_mode_32 3
.end_amdhsa_kernel
.p2align 6
.amdhsa_kernel standalone__molecular_angular_gemnet__graph_kernel
  .amdhsa_next_free_vgpr 40
  .amdhsa_next_free_sgpr 100
  .amdhsa_accum_offset 40
  .amdhsa_group_segment_fixed_size 0
  .amdhsa_kernarg_size 112
  .amdhsa_user_sgpr_count 2
  .amdhsa_user_sgpr_kernarg_segment_ptr 1
  .amdhsa_system_sgpr_workgroup_id_x 1
  .amdhsa_float_denorm_mode_32 3
.end_amdhsa_kernel
```

```asm
; @launch kernel=g0_kernel grid=(256,1,1) block=(256,1,1) lds=0
; @launch kernel=g1_kernel grid=(256,1,1) block=(1024,1,1) lds=163840
; @launch kernel=g2_kernel grid=(256,1,1) block=(1024,1,1) lds=150064
; @launch kernel=standalone__molecular_angular_gemnet__graph_kernel grid=(3200,1,1) block=(256,1,1) lds=0
.amdgcn_target "amdgcn-amd-amdhsa--gfx950"
.text
.globl g0_kernel
.p2align 8
.type g0_kernel,@function
g0_kernel:
    s_cmp_ge_u32 s2, 256
    s_cbranch_scc1 L_k0done_1
    s_load_dwordx2 s[4:5], s[0:1], 0
    s_load_dwordx2 s[6:7], s[0:1], 104
    s_mul_i32 s3, s2, 25000
    v_lshlrev_b32 v1, 4, v0
    s_waitcnt lgkmcnt(0)

    s_add_u32 s8, s4, s3
    s_addc_u32 s9, s5, 0
    s_mov_b32 s10, 25000
    s_mov_b32 s11, 0x20000
    s_mov_b32 s12, s6
    s_mov_b32 s13, s7
    s_mov_b32 s14, 131328
    s_mov_b32 s15, 0x20000
    s_add_u32 s16, s6, 135168
    s_addc_u32 s17, s7, 0
    s_mov_b32 s18, 8192
    s_mov_b32 s19, 0x20000
    s_movk_i32 s20, 0
    buffer_load_dwordx4 v[4:7], v1, s[8:11], s20 offen
    s_movk_i32 s20, 4096
    buffer_load_dwordx4 v[8:11], v1, s[8:11], s20 offen
    s_movk_i32 s20, 8192
    buffer_load_dwordx4 v[12:15], v1, s[8:11], s20 offen
    s_movk_i32 s20, 12288
    buffer_load_dwordx4 v[16:19], v1, s[8:11], s20 offen
    s_movk_i32 s20, 16384
    buffer_load_dwordx4 v[20:23], v1, s[8:11], s20 offen
    s_movk_i32 s20, 20480
    buffer_load_dwordx4 v[24:27], v1, s[8:11], s20 offen
    s_movk_i32 s20, 24576
    buffer_load_dwordx4 v[28:31], v1, s[8:11], s20 offen
    s_lshl_b32 s21, s2, 12
    v_add_u32 v2, s21, v1
    v_mov_b32 v32, 0
    v_mov_b32 v33, 0
    v_mov_b32 v34, 0
    v_mov_b32 v35, 0
    buffer_store_dwordx4 v[32:35], v2, s[12:15], 0 offen
    s_mov_b32 s22, 0x7fff7fff
    s_waitcnt vmcnt(1)

    v_and_b32 v4, s22, v4
    v_and_b32 v5, s22, v5
    v_and_b32 v6, s22, v6
    v_and_b32 v7, s22, v7
    v_and_b32 v8, s22, v8
    v_and_b32 v9, s22, v9
    v_and_b32 v10, s22, v10
    v_and_b32 v11, s22, v11
    v_and_b32 v12, s22, v12
    v_and_b32 v13, s22, v13
    v_and_b32 v14, s22, v14
    v_and_b32 v15, s22, v15
    v_and_b32 v16, s22, v16
    v_and_b32 v17, s22, v17
    v_and_b32 v18, s22, v18
    v_and_b32 v19, s22, v19
    v_and_b32 v20, s22, v20
    v_and_b32 v21, s22, v21
    v_and_b32 v22, s22, v22
    v_and_b32 v23, s22, v23
    v_and_b32 v24, s22, v24
    v_and_b32 v25, s22, v25
    v_and_b32 v26, s22, v26
    v_and_b32 v27, s22, v27
    v_and_b32 v28, s22, v28
    v_and_b32 v29, s22, v29
    v_and_b32 v30, s22, v30
    v_and_b32 v31, s22, v31
    v_mov_b32 v37, 0
    v_dot2_f32_bf16 v37, v4, v4, v37
    v_dot2_f32_bf16 v37, v5, v5, v37
    v_dot2_f32_bf16 v37, v6, v6, v37
    v_dot2_f32_bf16 v37, v7, v7, v37
    v_dot2_f32_bf16 v37, v8, v8, v37
    v_dot2_f32_bf16 v37, v9, v9, v37
    v_dot2_f32_bf16 v37, v10, v10, v37
    v_dot2_f32_bf16 v37, v11, v11, v37
    v_dot2_f32_bf16 v37, v12, v12, v37
    v_dot2_f32_bf16 v37, v13, v13, v37
    v_dot2_f32_bf16 v37, v14, v14, v37
    v_dot2_f32_bf16 v37, v15, v15, v37
    v_dot2_f32_bf16 v37, v16, v16, v37
    v_dot2_f32_bf16 v37, v17, v17, v37
    v_dot2_f32_bf16 v37, v18, v18, v37
    v_dot2_f32_bf16 v37, v19, v19, v37
    v_dot2_f32_bf16 v37, v20, v20, v37
    v_dot2_f32_bf16 v37, v21, v21, v37
    v_dot2_f32_bf16 v37, v22, v22, v37
    v_dot2_f32_bf16 v37, v23, v23, v37
    v_dot2_f32_bf16 v37, v24, v24, v37
    v_dot2_f32_bf16 v37, v25, v25, v37
    v_dot2_f32_bf16 v37, v26, v26, v37
    v_dot2_f32_bf16 v37, v27, v27, v37
    v_dot2_f32_bf16 v37, v28, v28, v37
    v_dot2_f32_bf16 v37, v29, v29, v37
    v_dot2_f32_bf16 v37, v30, v30, v37
    v_dot2_f32_bf16 v37, v31, v31, v37
    v_pk_max_u16 v4, v4, v5
    v_pk_max_u16 v4, v4, v6
    v_pk_max_u16 v4, v4, v7
    v_pk_max_u16 v4, v4, v8
    v_pk_max_u16 v4, v4, v9
    v_pk_max_u16 v4, v4, v10
    v_pk_max_u16 v4, v4, v11
    v_pk_max_u16 v4, v4, v12
    v_pk_max_u16 v4, v4, v13
    v_pk_max_u16 v4, v4, v14
    v_pk_max_u16 v4, v4, v15
    v_pk_max_u16 v4, v4, v16
    v_pk_max_u16 v4, v4, v17
    v_pk_max_u16 v4, v4, v18
    v_pk_max_u16 v4, v4, v19
    v_pk_max_u16 v4, v4, v20
    v_pk_max_u16 v4, v4, v21
    v_pk_max_u16 v4, v4, v22
    v_pk_max_u16 v4, v4, v23
    v_pk_max_u16 v4, v4, v24
    v_pk_max_u16 v4, v4, v25
    v_pk_max_u16 v4, v4, v26
    v_pk_max_u16 v4, v4, v27
    v_pk_max_u16 v4, v4, v28
    v_pk_max_u16 v4, v4, v29
    v_pk_max_u16 v4, v4, v30
    v_pk_max_u16 v4, v4, v31
    v_lshrrev_b32 v5, 16, v4
    v_and_b32 v4, 0xffff, v4
    v_max_u32 v4, v4, v5

    s_nop 1
    v_max_u32_dpp v4, v4, v4 row_shr:1 row_mask:0xf bank_mask:0xf
    s_nop 1
    v_max_u32_dpp v4, v4, v4 row_shr:2 row_mask:0xf bank_mask:0xf
    s_nop 1
    v_max_u32_dpp v4, v4, v4 row_shr:4 row_mask:0xf bank_mask:0xf
    s_nop 1
    v_max_u32_dpp v4, v4, v4 row_shr:8 row_mask:0xf bank_mask:0xf
    s_nop 1
    v_max_u32_dpp v4, v4, v4 row_bcast:15 row_mask:0xa bank_mask:0xf
    s_nop 1
    v_max_u32_dpp v4, v4, v4 row_bcast:31 row_mask:0xc bank_mask:0xf
    v_mov_b32 v5, v37
    s_nop 1
    v_add_f32_dpp v5, v5, v5 row_shr:1 row_mask:0xf bank_mask:0xf
    s_nop 1
    v_add_f32_dpp v5, v5, v5 row_shr:2 row_mask:0xf bank_mask:0xf
    s_nop 1
    v_add_f32_dpp v5, v5, v5 row_shr:4 row_mask:0xf bank_mask:0xf
    s_nop 1
    v_add_f32_dpp v5, v5, v5 row_shr:8 row_mask:0xf bank_mask:0xf
    s_nop 1
    v_add_f32_dpp v5, v5, v5 row_bcast:15 row_mask:0xa bank_mask:0xf
    s_nop 1
    v_add_f32_dpp v5, v5, v5 row_bcast:31 row_mask:0xc bank_mask:0xf
    v_lshrrev_b32 v6, 6, v0
    s_lshl_b32 s21, s2, 2
    v_add_lshl_u32 v6, v6, s21, 3
    v_and_b32 v7, 63, v0
    v_cmp_eq_u32 vcc, 63, v7
    s_and_saveexec_b64 s[24:25], vcc
    buffer_store_dwordx2 v[4:5], v6, s[16:19], 0 offen
L_k0done_1:
    s_endpgm

.globl g1_kernel
.p2align 8
.type g1_kernel,@function
g1_kernel:
    s_cmp_ge_u32 s2, 256
    s_cbranch_scc1 L_p1done_2
    s_load_dwordx4 s[80:83], s[0:1], 8
    s_load_dwordx2 s[84:85], s[0:1], 32
    s_load_dwordx2 s[86:87], s[0:1], 48
    s_load_dwordx2 s[6:7], s[0:1], 104
    v_lshlrev_b32 v1, 4, v0
    v_lshlrev_b32 v2, 3, v0
    v_lshlrev_b32 v3, 2, v0
    s_waitcnt lgkmcnt(0)
    s_load_dword s88, s[86:87], 0

    s_mov_b32 s8, s80
    s_mov_b32 s9, s81
    s_mov_b32 s10, 0
    s_mov_b32 s11, 0x20000
    s_mov_b32 s12, s82
    s_mov_b32 s13, s83
    s_mov_b32 s14, 0
    s_mov_b32 s15, 0x20000
    s_mov_b32 s16, s84
    s_mov_b32 s17, s85
    s_mov_b32 s18, 0
    s_mov_b32 s19, 0x20000
    s_movk_i32 s49, 18240
    s_mul_i32 s78, s2, 18240
    s_mul_i32 s79, s2, 17600
    s_add_u32 s79, s79, 1638400
    s_cmp_ge_u32 s2, 2560
    s_cmovk_i32 s49, 17600
    s_cselect_b32 s78, s79, s78
    s_cmp_ge_u32 s2, 2816
    s_cmovk_i32 s49, 0
    s_cmovk_i32 s78, 0
    s_add_u32 s77, s49, s78
    s_lshl_b32 s10, s77, 2
    s_lshl_b32 s14, s77, 2
    s_lshl_b32 s18, s77, 1
    s_lshl_b32 s56, s78, 2
    s_lshl_b32 s61, s78, 1

    s_add_u32 s57, s56, 16384
    s_add_u32 s62, s61, 8192
    s_add_u32 s58, s56, 32768
    s_add_u32 s63, s61, 16384
    s_add_u32 s59, s56, 49152
    s_add_u32 s64, s61, 24576
    s_add_u32 s60, s56, 65536
    s_add_u32 s65, s61, 32768
    s_mov_b32 s41, s2
    buffer_load_dwordx4 v[22:25], v1, s[12:15], s56 offen nt
    buffer_load_dwordx4 v[4:7], v1, s[8:11], s56 offen nt
    buffer_load_dwordx2 v[40:41], v2, s[16:19], s61 offen nt
    buffer_load_dwordx4 v[26:29], v1, s[12:15], s57 offen nt
    buffer_load_dwordx4 v[8:11], v1, s[8:11], s57 offen nt
    buffer_load_dwordx2 v[42:43], v2, s[16:19], s62 offen nt
    buffer_load_dwordx4 v[30:33], v1, s[12:15], s58 offen nt
    buffer_load_dwordx4 v[12:15], v1, s[8:11], s58 offen nt
    buffer_load_dwordx2 v[44:45], v2, s[16:19], s63 offen nt
    buffer_load_dwordx4 v[34:37], v1, s[12:15], s59 offen nt
    buffer_load_dwordx4 v[16:19], v1, s[8:11], s59 offen nt
    buffer_load_dwordx2 v[46:47], v2, s[16:19], s64 offen nt
    buffer_load_dwordx2 v[38:39], v2, s[12:15], s60 offen nt
    buffer_load_dwordx2 v[20:21], v2, s[8:11], s60 offen nt
    buffer_load_dword v48, v3, s[16:19], s65 offen nt
    s_and_b32 s5, s2, 7
    s_mul_i32 s3, s5, 8192

    s_add_u32 s20, s6, s3
    s_addc_u32 s21, s7, 0
    s_mov_b32 s22, 8192
    s_mov_b32 s23, 0x20000
    s_mul_i32 s3, s5, 40632320
    s_add_u32 s3, s3, 77848576
    s_add_u32 s24, s6, s3
    s_addc_u32 s25, s7, 0
    s_mov_b32 s26, 40632320
    s_mov_b32 s27, 0x20000
    s_add_u32 s28, s6, s3
    s_addc_u32 s29, s7, 0
    s_mov_b32 s30, 40632320
    s_mov_b32 s31, 0x20000
    s_add_u32 s32, s6, 402907136
    s_addc_u32 s33, s7, 0
    s_mov_b32 s34, 409600000
    s_mov_b32 s35, 0x20000
    s_add_u32 s36, s6, 131072
    s_addc_u32 s37, s7, 0
    s_mov_b32 s38, 256
    s_mov_b32 s39, 0x20000
    s_mov_b32 s40, 687195
    s_mov_b32 s42, -6250
    s_mov_b32 s43, 1942
    s_mov_b32 s45, 0x06050400
    s_mov_b32 s46, 0x05040c00
    s_mov_b32 s47, 0x04020100
    s_mov_b32 s48, 3968
    s_mov_b32 s50, 0
    s_mov_b32 s51, 0
    s_mov_b32 s53, 0
    v_mov_b32 v104, 1
    v_mov_b32 v105, 0x46ff8000
    s_mov_b32 s55, 0x05040100
    v_mul_u32_u24 v49, 5, v0
    v_mov_b32 v106, 0
    v_mov_b32 v107, 0
    v_mov_b32 v108, 0
    v_mov_b32 v109, 0
    v_mov_b32 v110, 0
    v_mov_b32 v111, 0
    v_mov_b32 v113, 16384
    ds_write_b64 v2, v[106:107]
    v_mov_b32 v114, 0
    v_mov_b32 v115, 0
    v_mov_b32 v116, 0
    v_mov_b32 v117, -1
    s_mov_b64 exec, 1
    ds_write_b128 v113, v[114:117]
    s_mov_b64 exec, -1
    s_waitcnt lgkmcnt(0)
    s_lshl_b32 s88, s88, 16
    v_mov_b32 v114, 0.15915494
    v_mul_f32 v114, s88, v114
    s_nop 0
    v_readfirstlane_b32 s44, v114
    s_barrier

    s_mov_b32 s52, s51
    s_mov_b32 s51, s49
    s_sub_u32 s75, s51, 16384
    s_lshl_b32 s75, s75, 1
    v_cmp_gt_u32 s[66:67], s75, v3

    s_waitcnt vmcnt(12)
    v_mul_hi_u32_u24 v51, s40, v22
    v_mul_hi_u32_u24 v50, s40, v4
    v_mul_hi_u32_u24 v53, s40, v23
    v_mul_hi_u32_u24 v52, s40, v5
    v_mul_hi_u32_u24 v55, s40, v24
    v_mul_hi_u32_u24 v54, s40, v6
    v_mul_hi_u32_u24 v57, s40, v25
    v_mul_hi_u32_u24 v56, s40, v7
    v_and_b32 v51, -2, v51
    v_mad_u32_u24 v4, v50, s43, v4
    v_and_b32 v86, -4, v50
    v_and_b32 v53, -2, v53
    v_mad_u32_u24 v5, v52, s43, v5
    v_and_b32 v87, -4, v52
    v_and_b32 v55, -2, v55
    v_mad_u32_u24 v6, v54, s43, v6
    v_and_b32 v88, -4, v54
    v_and_b32 v57, -2, v57
    v_mad_u32_u24 v7, v56, s43, v7
    v_and_b32 v89, -4, v56
    v_mad_i32_i24 v22, v51, s42, v22
    v_lshl_add_u32 v51, v86, 5, v51
    v_mad_i32_i24 v23, v53, s42, v23
    v_lshl_add_u32 v53, v87, 5, v53
    v_mad_i32_i24 v24, v55, s42, v24
    v_lshl_add_u32 v55, v88, 5, v55
    v_mad_i32_i24 v25, v57, s42, v25
    v_lshl_add_u32 v57, v89, 5, v57
    v_add_u32 v51, v51, v51
    ds_add_rtn_u32 v86, v51, v104
    v_add_u32 v53, v53, v53
    ds_add_rtn_u32 v87, v53, v104
    v_add_u32 v55, v55, v55
    ds_add_rtn_u32 v88, v55, v104
    v_add_u32 v57, v57, v57
    ds_add_rtn_u32 v89, v57, v104
    v_lshlrev_b32 v114, 16, v40
    v_and_b32 v115, 0xffff0000, v40
    v_lshlrev_b32 v116, 16, v41
    v_and_b32 v117, 0xffff0000, v41
    v_mul_f32 v114, s44, v114
    v_mul_f32 v115, s44, v115
    v_mul_f32 v116, s44, v116
    v_mul_f32 v117, s44, v117
    v_fract_f32 v114, v114
    v_fract_f32 v115, v115
    v_fract_f32 v116, v116
    v_fract_f32 v117, v117
    v_cos_f32 v114, v114
    v_cos_f32 v115, v115
    v_cos_f32 v116, v116
    v_cos_f32 v117, v117
    v_lshl_or_b32 v50, v50, 14, v22
    v_perm_b32 v51, v51, v4, s46
    v_bfe_u32 v4, v4, 8, 5

    v_lshl_or_b32 v52, v52, 14, v23
    v_perm_b32 v53, v53, v5, s46
    v_bfe_u32 v5, v5, 8, 5

    v_lshl_or_b32 v54, v54, 14, v24
    v_perm_b32 v55, v55, v6, s46
    v_bfe_u32 v6, v6, 8, 5

    v_lshl_or_b32 v56, v56, 14, v25
    v_perm_b32 v57, v57, v7, s46
    v_bfe_u32 v7, v7, 8, 5

    v_fmaak_f32 v114, v114, v105, 0x4b400010
    v_fmaak_f32 v115, v115, v105, 0x4b400010
    v_fmaak_f32 v116, v116, v105, 0x4b400010
    v_fmaak_f32 v117, v117, v105, 0x4b400010
    v_sub_u32 v114, v114, v4
    v_sub_u32 v115, v115, v5
    v_sub_u32 v116, v116, v6
    v_sub_u32 v117, v117, v7
    v_bfi_b32 v114, 31, v4, v114
    v_bfi_b32 v115, 31, v5, v115
    v_bfi_b32 v116, 31, v6, v116
    v_bfi_b32 v117, 31, v7, v117
    v_perm_b32 v50, v50, v114, s55
    v_perm_b32 v52, v52, v115, s55
    v_perm_b32 v54, v54, v116, s55
    v_perm_b32 v56, v56, v117, s55
    v_mov_b32 v108, 1
    v_lshlrev_b32 v109, 20, v0
    buffer_atomic_add v108, v109, s[36:39], 0 offen offset:128 sc0
    s_waitcnt vmcnt(10)
    v_mul_hi_u32_u24 v59, s40, v26
    v_mul_hi_u32_u24 v58, s40, v8
    v_mul_hi_u32_u24 v61, s40, v27
    v_mul_hi_u32_u24 v60, s40, v9
    v_mul_hi_u32_u24 v63, s40, v28
    v_mul_hi_u32_u24 v62, s40, v10
    v_mul_hi_u32_u24 v65, s40, v29
    v_mul_hi_u32_u24 v64, s40, v11
    v_and_b32 v59, -2, v59
    v_mad_u32_u24 v8, v58, s43, v8
    v_and_b32 v90, -4, v58
    v_and_b32 v61, -2, v61
    v_mad_u32_u24 v9, v60, s43, v9
    v_and_b32 v91, -4, v60
    v_and_b32 v63, -2, v63
    v_mad_u32_u24 v10, v62, s43, v10
    v_and_b32 v92, -4, v62
    v_and_b32 v65, -2, v65
    v_mad_u32_u24 v11, v64, s43, v11
    v_and_b32 v93, -4, v64
    v_mad_i32_i24 v26, v59, s42, v26
    v_lshl_add_u32 v59, v90, 5, v59
    v_mad_i32_i24 v27, v61, s42, v27
    v_lshl_add_u32 v61, v91, 5, v61
    v_mad_i32_i24 v28, v63, s42, v28
    v_lshl_add_u32 v63, v92, 5, v63
    v_mad_i32_i24 v29, v65, s42, v29
    v_lshl_add_u32 v65, v93, 5, v65
    v_add_u32 v59, v59, v59
    ds_add_rtn_u32 v90, v59, v104
    v_add_u32 v61, v61, v61
    ds_add_rtn_u32 v91, v61, v104
    v_add_u32 v63, v63, v63
    ds_add_rtn_u32 v92, v63, v104
    v_add_u32 v65, v65, v65
    ds_add_rtn_u32 v93, v65, v104
    v_lshlrev_b32 v114, 16, v42
    v_and_b32 v115, 0xffff0000, v42
    v_lshlrev_b32 v116, 16, v43
    v_and_b32 v117, 0xffff0000, v43
    v_mul_f32 v114, s44, v114
    v_mul_f32 v115, s44, v115
    v_mul_f32 v116, s44, v116
    v_mul_f32 v117, s44, v117
    v_fract_f32 v114, v114
    v_fract_f32 v115, v115
    v_fract_f32 v116, v116
    v_fract_f32 v117, v117
    v_cos_f32 v114, v114
    v_cos_f32 v115, v115
    v_cos_f32 v116, v116
    v_cos_f32 v117, v117
    v_lshl_or_b32 v58, v58, 14, v26
    v_perm_b32 v59, v59, v8, s46
    v_bfe_u32 v8, v8, 8, 5

    v_lshl_or_b32 v60, v60, 14, v27
    v_perm_b32 v61, v61, v9, s46
    v_bfe_u32 v9, v9, 8, 5

    v_lshl_or_b32 v62, v62, 14, v28
    v_perm_b32 v63, v63, v10, s46
    v_bfe_u32 v10, v10, 8, 5

    v_lshl_or_b32 v64, v64, 14, v29
    v_perm_b32 v65, v65, v11, s46
    v_bfe_u32 v11, v11, 8, 5

    v_fmaak_f32 v114, v114, v105, 0x4b400010
    v_fmaak_f32 v115, v115, v105, 0x4b400010
    v_fmaak_f32 v116, v116, v105, 0x4b400010
    v_fmaak_f32 v117, v117, v105, 0x4b400010
    v_sub_u32 v114, v114, v8
    v_sub_u32 v115, v115, v9
    v_sub_u32 v116, v116, v10
    v_sub_u32 v117, v117, v11
    v_bfi_b32 v114, 31, v8, v114
    v_bfi_b32 v115, 31, v9, v115
    v_bfi_b32 v116, 31, v10, v116
    v_bfi_b32 v117, 31, v11, v117
    v_perm_b32 v58, v58, v114, s55
    v_perm_b32 v60, v60, v115, s55
    v_perm_b32 v62, v62, v116, s55
    v_perm_b32 v64, v64, v117, s55
    s_waitcnt vmcnt(7)
    v_mul_hi_u32_u24 v67, s40, v30
    v_mul_hi_u32_u24 v66, s40, v12
    v_mul_hi_u32_u24 v69, s40, v31
    v_mul_hi_u32_u24 v68, s40, v13
    v_mul_hi_u32_u24 v71, s40, v32
    v_mul_hi_u32_u24 v70, s40, v14
    v_mul_hi_u32_u24 v73, s40, v33
    v_mul_hi_u32_u24 v72, s40, v15
    v_and_b32 v67, -2, v67
    v_mad_u32_u24 v12, v66, s43, v12
    v_and_b32 v94, -4, v66
    v_and_b32 v69, -2, v69
    v_mad_u32_u24 v13, v68, s43, v13
    v_and_b32 v95, -4, v68
    v_and_b32 v71, -2, v71
    v_mad_u32_u24 v14, v70, s43, v14
    v_and_b32 v96, -4, v70
    v_and_b32 v73, -2, v73
    v_mad_u32_u24 v15, v72, s43, v15
    v_and_b32 v97, -4, v72
    v_mad_i32_i24 v30, v67, s42, v30
    v_lshl_add_u32 v67, v94, 5, v67
    v_mad_i32_i24 v31, v69, s42, v31
    v_lshl_add_u32 v69, v95, 5, v69
    v_mad_i32_i24 v32, v71, s42, v32
    v_lshl_add_u32 v71, v96, 5, v71
    v_mad_i32_i24 v33, v73, s42, v33
    v_lshl_add_u32 v73, v97, 5, v73
    v_add_u32 v67, v67, v67
    ds_add_rtn_u32 v94, v67, v104
    v_add_u32 v69, v69, v69
    ds_add_rtn_u32 v95, v69, v104
    v_add_u32 v71, v71, v71
    ds_add_rtn_u32 v96, v71, v104
    v_add_u32 v73, v73, v73
    ds_add_rtn_u32 v97, v73, v104
    v_lshlrev_b32 v114, 16, v44
    v_and_b32 v115, 0xffff0000, v44
    v_lshlrev_b32 v116, 16, v45
    v_and_b32 v117, 0xffff0000, v45
    v_mul_f32 v114, s44, v114
    v_mul_f32 v115, s44, v115
    v_mul_f32 v116, s44, v116
    v_mul_f32 v117, s44, v117
    v_fract_f32 v114, v114
    v_fract_f32 v115, v115
    v_fract_f32 v116, v116
    v_fract_f32 v117, v117
    v_cos_f32 v114, v114
    v_cos_f32 v115, v115
    v_cos_f32 v116, v116
    v_cos_f32 v117, v117
    v_lshl_or_b32 v66, v66, 14, v30
    v_perm_b32 v67, v67, v12, s46
    v_bfe_u32 v12, v12, 8, 5

    v_lshl_or_b32 v68, v68, 14, v31
    v_perm_b32 v69, v69, v13, s46
    v_bfe_u32 v13, v13, 8, 5

    v_lshl_or_b32 v70, v70, 14, v32
    v_perm_b32 v71, v71, v14, s46
    v_bfe_u32 v14, v14, 8, 5

    v_lshl_or_b32 v72, v72, 14, v33
    v_perm_b32 v73, v73, v15, s46
    v_bfe_u32 v15, v15, 8, 5

    v_fmaak_f32 v114, v114, v105, 0x4b400010
    v_fmaak_f32 v115, v115, v105, 0x4b400010
    v_fmaak_f32 v116, v116, v105, 0x4b400010
    v_fmaak_f32 v117, v117, v105, 0x4b400010
    v_sub_u32 v114, v114, v12
    v_sub_u32 v115, v115, v13
    v_sub_u32 v116, v116, v14
    v_sub_u32 v117, v117, v15
    v_bfi_b32 v114, 31, v12, v114
    v_bfi_b32 v115, 31, v13, v115
    v_bfi_b32 v116, 31, v14, v116
    v_bfi_b32 v117, 31, v15, v117
    v_perm_b32 v66, v66, v114, s55
    v_perm_b32 v68, v68, v115, s55
    v_perm_b32 v70, v70, v116, s55
    v_perm_b32 v72, v72, v117, s55
    s_waitcnt vmcnt(4)
    v_mul_hi_u32_u24 v75, s40, v34
    v_mul_hi_u32_u24 v74, s40, v16
    v_mul_hi_u32_u24 v77, s40, v35
    v_mul_hi_u32_u24 v76, s40, v17
    v_mul_hi_u32_u24 v79, s40, v36
    v_mul_hi_u32_u24 v78, s40, v18
    v_mul_hi_u32_u24 v81, s40, v37
    v_mul_hi_u32_u24 v80, s40, v19
    v_and_b32 v75, -2, v75
    v_mad_u32_u24 v16, v74, s43, v16
    v_and_b32 v98, -4, v74
    v_and_b32 v77, -2, v77
    v_mad_u32_u24 v17, v76, s43, v17
    v_and_b32 v99, -4, v76
    v_and_b32 v79, -2, v79
    v_mad_u32_u24 v18, v78, s43, v18
    v_and_b32 v100, -4, v78
    v_and_b32 v81, -2, v81
    v_mad_u32_u24 v19, v80, s43, v19
    v_and_b32 v101, -4, v80
    v_mad_i32_i24 v34, v75, s42, v34
    v_lshl_add_u32 v75, v98, 5, v75
    v_mad_i32_i24 v35, v77, s42, v35
    v_lshl_add_u32 v77, v99, 5, v77
    v_mad_i32_i24 v36, v79, s42, v36
    v_lshl_add_u32 v79, v100, 5, v79
    v_mad_i32_i24 v37, v81, s42, v37
    v_lshl_add_u32 v81, v101, 5, v81
    v_add_u32 v75, v75, v75
    ds_add_rtn_u32 v98, v75, v104
    v_add_u32 v77, v77, v77
    ds_add_rtn_u32 v99, v77, v104
    v_add_u32 v79, v79, v79
    ds_add_rtn_u32 v100, v79, v104
    v_add_u32 v81, v81, v81
    ds_add_rtn_u32 v101, v81, v104
    v_lshlrev_b32 v114, 16, v46
    v_and_b32 v115, 0xffff0000, v46
    v_lshlrev_b32 v116, 16, v47
    v_and_b32 v117, 0xffff0000, v47
    v_mul_f32 v114, s44, v114
    v_mul_f32 v115, s44, v115
    v_mul_f32 v116, s44, v116
    v_mul_f32 v117, s44, v117
    v_fract_f32 v114, v114
    v_fract_f32 v115, v115
    v_fract_f32 v116, v116
    v_fract_f32 v117, v117
    v_cos_f32 v114, v114
    v_cos_f32 v115, v115
    v_cos_f32 v116, v116
    v_cos_f32 v117, v117
    v_lshl_or_b32 v74, v74, 14, v34
    v_perm_b32 v75, v75, v16, s46
    v_bfe_u32 v16, v16, 8, 5

    v_lshl_or_b32 v76, v76, 14, v35
    v_perm_b32 v77, v77, v17, s46
    v_bfe_u32 v17, v17, 8, 5

    v_lshl_or_b32 v78, v78, 14, v36
    v_perm_b32 v79, v79, v18, s46
    v_bfe_u32 v18, v18, 8, 5

    v_lshl_or_b32 v80, v80, 14, v37
    v_perm_b32 v81, v81, v19, s46
    v_bfe_u32 v19, v19, 8, 5

    v_fmaak_f32 v114, v114, v105, 0x4b400010
    v_fmaak_f32 v115, v115, v105, 0x4b400010
    v_fmaak_f32 v116, v116, v105, 0x4b400010
    v_fmaak_f32 v117, v117, v105, 0x4b400010
    v_sub_u32 v114, v114, v16
    v_sub_u32 v115, v115, v17
    v_sub_u32 v116, v116, v18
    v_sub_u32 v117, v117, v19
    v_bfi_b32 v114, 31, v16, v114
    v_bfi_b32 v115, 31, v17, v115
    v_bfi_b32 v116, 31, v18, v116
    v_bfi_b32 v117, 31, v19, v117
    v_perm_b32 v74, v74, v114, s55
    v_perm_b32 v76, v76, v115, s55
    v_perm_b32 v78, v78, v116, s55
    v_perm_b32 v80, v80, v117, s55
    s_waitcnt vmcnt(1)
    s_mov_b64 exec, s[66:67]
    v_mul_hi_u32_u24 v83, s40, v38
    v_mul_hi_u32_u24 v82, s40, v20
    v_mul_hi_u32_u24 v85, s40, v39
    v_mul_hi_u32_u24 v84, s40, v21
    v_and_b32 v83, -2, v83
    v_mad_u32_u24 v20, v82, s43, v20
    v_and_b32 v102, -4, v82
    v_and_b32 v85, -2, v85
    v_mad_u32_u24 v21, v84, s43, v21
    v_and_b32 v103, -4, v84
    v_mad_i32_i24 v38, v83, s42, v38
    v_lshl_add_u32 v83, v102, 5, v83
    v_mad_i32_i24 v39, v85, s42, v39
    v_lshl_add_u32 v85, v103, 5, v85
    v_add_u32 v83, v83, v83
    ds_add_rtn_u32 v102, v83, v104
    v_add_u32 v85, v85, v85
    ds_add_rtn_u32 v103, v85, v104
    v_lshlrev_b32 v114, 16, v48
    v_and_b32 v115, 0xffff0000, v48
    v_mul_f32 v114, s44, v114
    v_mul_f32 v115, s44, v115
    v_fract_f32 v114, v114
    v_fract_f32 v115, v115
    v_cos_f32 v114, v114
    v_cos_f32 v115, v115
    v_lshl_or_b32 v82, v82, 14, v38
    v_perm_b32 v83, v83, v20, s46
    v_bfe_u32 v20, v20, 8, 5

    v_lshl_or_b32 v84, v84, 14, v39
    v_perm_b32 v85, v85, v21, s46
    v_bfe_u32 v21, v21, 8, 5

    v_fmaak_f32 v114, v114, v105, 0x4b400010
    v_fmaak_f32 v115, v115, v105, 0x4b400010
    v_sub_u32 v114, v114, v20
    v_sub_u32 v115, v115, v21
    v_bfi_b32 v114, 31, v20, v114
    v_bfi_b32 v115, 31, v21, v115
    v_perm_b32 v82, v82, v114, s55
    v_perm_b32 v84, v84, v115, s55
    s_mov_b64 exec, -1
    v_cmp_eq_u32 vcc, 0, v0
    s_waitcnt vmcnt(0)
    s_mov_b64 exec, vcc
    ds_write_b32 v113, v108 offset:8
    s_mov_b64 exec, -1
    s_waitcnt lgkmcnt(0)
    s_barrier

    ds_read_b32 v114, v113 offset:8
    ds_read_b64 v[108:109], v2
    s_waitcnt lgkmcnt(0)

    v_readfirstlane_b32 s41, v114
    v_and_b32 v108, 0xffff, v108
    v_and_b32 v109, 0xffff, v109
    v_mov_b32 v106, v108
    v_mov_b32 v107, v109
    v_add_u32 v111, v108, v109

    buffer_atomic_add_x2 v[106:107], v2, s[20:23], 0 offen sc0
    s_nop 1
    v_add_u32_dpp v111, v111, v111 row_shr:1 row_mask:0xf bank_mask:0xf
    s_nop 1
    v_add_u32_dpp v111, v111, v111 row_shr:2 row_mask:0xf bank_mask:0xf
    s_nop 1
    v_add_u32_dpp v111, v111, v111 row_shr:4 row_mask:0xf bank_mask:0xf
    s_nop 1
    v_add_u32_dpp v111, v111, v111 row_shr:8 row_mask:0xf bank_mask:0xf
    s_nop 1
    v_add_u32_dpp v111, v111, v111 row_bcast:15 row_mask:0xa bank_mask:0xf
    s_nop 1
    v_add_u32_dpp v111, v111, v111 row_bcast:31 row_mask:0xc bank_mask:0xf
    s_mov_b32 exec_lo, 0
    s_brev_b32 exec_hi, 1
    ds_add_rtn_u32 v110, v113, v111
    s_mov_b64 exec, -1

    s_add_u32 s41, s41, 256
    s_movk_i32 s49, 18240
    s_mul_i32 s78, s41, 18240
    s_mul_i32 s79, s41, 17600
    s_add_u32 s79, s79, 1638400
    s_cmp_ge_u32 s41, 2560
    s_cmovk_i32 s49, 17600
    s_cselect_b32 s78, s79, s78
    s_cmp_ge_u32 s41, 2816
    s_cmovk_i32 s49, 0
    s_cmovk_i32 s78, 0
    s_add_u32 s77, s49, s78
    s_lshl_b32 s10, s77, 2
    s_lshl_b32 s14, s77, 2
    s_lshl_b32 s18, s77, 1
    s_lshl_b32 s56, s78, 2
    s_lshl_b32 s61, s78, 1

    s_add_u32 s57, s56, 16384
    s_add_u32 s62, s61, 8192
    s_add_u32 s58, s56, 32768
    s_add_u32 s63, s61, 16384
    s_add_u32 s59, s56, 49152
    s_add_u32 s64, s61, 24576
    s_add_u32 s60, s56, 65536
    s_add_u32 s65, s61, 32768
    buffer_load_dwordx4 v[22:25], v1, s[12:15], s56 offen nt
    buffer_load_dwordx4 v[4:7], v1, s[8:11], s56 offen nt
    buffer_load_dwordx2 v[40:41], v2, s[16:19], s61 offen nt
    s_waitcnt lgkmcnt(0)
    v_readlane_b32 s77, v110, 63
    v_mul_u32_u24 v116, 7936, v0
    v_sub_u32 v111, v111, v109
    s_sub_u32 s77, s77, s50
    v_add_u32 v111, s77, v111
    v_sub_u32 v110, v111, v108
    v_lshlrev_b32 v115, 16, v111
    v_lshlrev_b32 v114, 16, v110
    ds_write_b64 v2, v[114:115]
    v_sub_u32 v110, v116, v110
    v_sub_u32 v111, v116, v111
    v_add_u32 v111, s48, v111
    s_lshl_b32 s74, s51, 3
    v_mov_b32 v126, s74
    v_mov_b32 v127, -1

    s_waitcnt lgkmcnt(0)
    s_barrier

    s_mov_b64 exec, 1
    ds_write_b32 v126, v127 offset:16404
    s_mov_b64 exec, -1

    v_lshrrev_b32 v114, 16, v51
    ds_read_b32 v114, v114
    v_lshrrev_b32 v115, 16, v53
    ds_read_b32 v115, v115
    v_lshrrev_b32 v116, 16, v55
    ds_read_b32 v116, v116
    v_lshrrev_b32 v117, 16, v57
    ds_read_b32 v117, v117
    v_lshrrev_b32 v118, 16, v59
    ds_read_b32 v118, v118
    v_lshrrev_b32 v119, 16, v61
    ds_read_b32 v119, v119
    v_lshrrev_b32 v120, 16, v63
    ds_read_b32 v120, v120
    v_lshrrev_b32 v121, 16, v65
    ds_read_b32 v121, v121
    s_waitcnt lgkmcnt(7)
    v_add_u32_sdwa v114, v114, v86 dst_sel:DWORD dst_unused:UNUSED_PAD src0_sel:WORD_1 src1_sel:WORD_0
    v_lshlrev_b32 v114, 3, v114
    ds_write_b64 v114, v[50:51] offset:16400

    s_waitcnt lgkmcnt(7)
    v_add_u32_sdwa v115, v115, v87 dst_sel:DWORD dst_unused:UNUSED_PAD src0_sel:WORD_1 src1_sel:WORD_0
    v_lshlrev_b32 v115, 3, v115
    ds_write_b64 v115, v[52:53] offset:16400

    s_waitcnt lgkmcnt(7)
    v_add_u32_sdwa v116, v116, v88 dst_sel:DWORD dst_unused:UNUSED_PAD src0_sel:WORD_1 src1_sel:WORD_0
    v_lshlrev_b32 v116, 3, v116
    ds_write_b64 v116, v[54:55] offset:16400

    s_waitcnt lgkmcnt(7)
    v_add_u32_sdwa v117, v117, v89 dst_sel:DWORD dst_unused:UNUSED_PAD src0_sel:WORD_1 src1_sel:WORD_0
    v_lshlrev_b32 v117, 3, v117
    ds_write_b64 v117, v[56:57] offset:16400

    s_waitcnt lgkmcnt(7)
    v_add_u32_sdwa v118, v118, v90 dst_sel:DWORD dst_unused:UNUSED_PAD src0_sel:WORD_1 src1_sel:WORD_0
    v_lshlrev_b32 v118, 3, v118
    ds_write_b64 v118, v[58:59] offset:16400

    s_waitcnt lgkmcnt(7)
    v_add_u32_sdwa v119, v119, v91 dst_sel:DWORD dst_unused:UNUSED_PAD src0_sel:WORD_1 src1_sel:WORD_0
    v_lshlrev_b32 v119, 3, v119
    ds_write_b64 v119, v[60:61] offset:16400

    s_waitcnt lgkmcnt(7)
    v_add_u32_sdwa v120, v120, v92 dst_sel:DWORD dst_unused:UNUSED_PAD src0_sel:WORD_1 src1_sel:WORD_0
    v_lshlrev_b32 v120, 3, v120
    ds_write_b64 v120, v[62:63] offset:16400

    s_waitcnt lgkmcnt(7)
    v_add_u32_sdwa v121, v121, v93 dst_sel:DWORD dst_unused:UNUSED_PAD src0_sel:WORD_1 src1_sel:WORD_0
    v_lshlrev_b32 v121, 3, v121
    ds_write_b64 v121, v[64:65] offset:16400

    buffer_load_dwordx4 v[26:29], v1, s[12:15], s57 offen nt
    buffer_load_dwordx4 v[8:11], v1, s[8:11], s57 offen nt
    buffer_load_dwordx2 v[42:43], v2, s[16:19], s62 offen nt
    v_lshrrev_b32 v114, 16, v67
    ds_read_b32 v114, v114
    v_lshrrev_b32 v115, 16, v69
    ds_read_b32 v115, v115
    v_lshrrev_b32 v116, 16, v71
    ds_read_b32 v116, v116
    v_lshrrev_b32 v117, 16, v73
    ds_read_b32 v117, v117
    v_lshrrev_b32 v118, 16, v75
    ds_read_b32 v118, v118
    v_lshrrev_b32 v119, 16, v77
    ds_read_b32 v119, v119
    v_lshrrev_b32 v120, 16, v79
    ds_read_b32 v120, v120
    v_lshrrev_b32 v121, 16, v81
    ds_read_b32 v121, v121
    s_waitcnt lgkmcnt(7)
    v_add_u32_sdwa v114, v114, v94 dst_sel:DWORD dst_unused:UNUSED_PAD src0_sel:WORD_1 src1_sel:WORD_0
    v_lshlrev_b32 v114, 3, v114
    ds_write_b64 v114, v[66:67] offset:16400

    s_waitcnt lgkmcnt(7)
    v_add_u32_sdwa v115, v115, v95 dst_sel:DWORD dst_unused:UNUSED_PAD src0_sel:WORD_1 src1_sel:WORD_0
    v_lshlrev_b32 v115, 3, v115
    ds_write_b64 v115, v[68:69] offset:16400

    s_waitcnt lgkmcnt(7)
    v_add_u32_sdwa v116, v116, v96 dst_sel:DWORD dst_unused:UNUSED_PAD src0_sel:WORD_1 src1_sel:WORD_0
    v_lshlrev_b32 v116, 3, v116
    ds_write_b64 v116, v[70:71] offset:16400

    s_waitcnt lgkmcnt(7)
    v_add_u32_sdwa v117, v117, v97 dst_sel:DWORD dst_unused:UNUSED_PAD src0_sel:WORD_1 src1_sel:WORD_0
    v_lshlrev_b32 v117, 3, v117
    ds_write_b64 v117, v[72:73] offset:16400

    s_waitcnt lgkmcnt(7)
    v_add_u32_sdwa v118, v118, v98 dst_sel:DWORD dst_unused:UNUSED_PAD src0_sel:WORD_1 src1_sel:WORD_0
    v_lshlrev_b32 v118, 3, v118
    ds_write_b64 v118, v[74:75] offset:16400

    s_waitcnt lgkmcnt(7)
    v_add_u32_sdwa v119, v119, v99 dst_sel:DWORD dst_unused:UNUSED_PAD src0_sel:WORD_1 src1_sel:WORD_0
    v_lshlrev_b32 v119, 3, v119
    ds_write_b64 v119, v[76:77] offset:16400

    s_waitcnt lgkmcnt(7)
    v_add_u32_sdwa v120, v120, v100 dst_sel:DWORD dst_unused:UNUSED_PAD src0_sel:WORD_1 src1_sel:WORD_0
    v_lshlrev_b32 v120, 3, v120
    ds_write_b64 v120, v[78:79] offset:16400

    s_waitcnt lgkmcnt(7)
    v_add_u32_sdwa v121, v121, v101 dst_sel:DWORD dst_unused:UNUSED_PAD src0_sel:WORD_1 src1_sel:WORD_0
    v_lshlrev_b32 v121, 3, v121
    ds_write_b64 v121, v[80:81] offset:16400

    s_mov_b64 exec, s[66:67]
    v_lshrrev_b32 v114, 16, v83
    ds_read_b32 v114, v114
    v_lshrrev_b32 v115, 16, v85
    ds_read_b32 v115, v115
    s_waitcnt lgkmcnt(1)
    v_add_u32_sdwa v114, v114, v102 dst_sel:DWORD dst_unused:UNUSED_PAD src0_sel:WORD_1 src1_sel:WORD_0
    v_lshlrev_b32 v114, 3, v114
    ds_write_b64 v114, v[82:83] offset:16400

    s_waitcnt lgkmcnt(1)
    v_add_u32_sdwa v115, v115, v103 dst_sel:DWORD dst_unused:UNUSED_PAD src0_sel:WORD_1 src1_sel:WORD_0
    v_lshlrev_b32 v115, 3, v115
    ds_write_b64 v115, v[84:85] offset:16400

    s_mov_b64 exec, -1
    s_add_u32 s50, s50, s51

    buffer_load_dwordx4 v[30:33], v1, s[12:15], s58 offen nt
    buffer_load_dwordx4 v[12:15], v1, s[8:11], s58 offen nt
    buffer_load_dwordx2 v[44:45], v2, s[16:19], s63 offen nt
    buffer_load_dwordx4 v[34:37], v1, s[12:15], s59 offen nt
    buffer_load_dwordx4 v[16:19], v1, s[8:11], s59 offen nt
    buffer_load_dwordx2 v[46:47], v2, s[16:19], s64 offen nt
    buffer_load_dwordx2 v[38:39], v2, s[12:15], s60 offen nt
    buffer_load_dwordx2 v[20:21], v2, s[8:11], s60 offen nt
    buffer_load_dword v48, v3, s[16:19], s65 offen nt
    s_cmp_eq_u32 s49, 0
    s_cbranch_scc1 L_p1epi_4
L_p1loop_3:
    s_mov_b32 s52, s51
    s_mov_b32 s51, s49
    s_sub_u32 s75, s51, 16384
    s_lshl_b32 s75, s75, 1
    v_cmp_gt_u32 s[66:67], s75, v3

    s_waitcnt vmcnt(12)
    v_mul_hi_u32_u24 v51, s40, v22
    v_mul_hi_u32_u24 v50, s40, v4
    v_mul_hi_u32_u24 v53, s40, v23
    v_mul_hi_u32_u24 v52, s40, v5
    v_mul_hi_u32_u24 v55, s40, v24
    v_mul_hi_u32_u24 v54, s40, v6
    v_mul_hi_u32_u24 v57, s40, v25
    v_mul_hi_u32_u24 v56, s40, v7
    v_and_b32 v51, -2, v51
    v_mad_u32_u24 v4, v50, s43, v4
    v_and_b32 v86, -4, v50
    v_and_b32 v53, -2, v53
    v_mad_u32_u24 v5, v52, s43, v5
    v_and_b32 v87, -4, v52
    v_and_b32 v55, -2, v55
    v_mad_u32_u24 v6, v54, s43, v6
    v_and_b32 v88, -4, v54
    v_and_b32 v57, -2, v57
    v_mad_u32_u24 v7, v56, s43, v7
    v_and_b32 v89, -4, v56
    v_mad_i32_i24 v22, v51, s42, v22
    v_lshl_add_u32 v51, v86, 5, v51
    v_mad_i32_i24 v23, v53, s42, v23
    v_lshl_add_u32 v53, v87, 5, v53
    v_mad_i32_i24 v24, v55, s42, v24
    v_lshl_add_u32 v55, v88, 5, v55
    v_mad_i32_i24 v25, v57, s42, v25
    v_lshl_add_u32 v57, v89, 5, v57
    v_add_u32 v51, v51, v51
    ds_add_rtn_u32 v86, v51, v104
    v_add_u32 v53, v53, v53
    ds_add_rtn_u32 v87, v53, v104
    v_add_u32 v55, v55, v55
    ds_add_rtn_u32 v88, v55, v104
    v_add_u32 v57, v57, v57
    ds_add_rtn_u32 v89, v57, v104
    v_lshlrev_b32 v114, 16, v40
    v_and_b32 v115, 0xffff0000, v40
    v_lshlrev_b32 v116, 16, v41
    v_and_b32 v117, 0xffff0000, v41
    v_mul_f32 v114, s44, v114
    v_mul_f32 v115, s44, v115
    v_mul_f32 v116, s44, v116
    v_mul_f32 v117, s44, v117
    v_fract_f32 v114, v114
    v_fract_f32 v115, v115
    v_fract_f32 v116, v116
    v_fract_f32 v117, v117
    v_cos_f32 v114, v114
    v_cos_f32 v115, v115
    v_cos_f32 v116, v116
    v_cos_f32 v117, v117
    v_lshl_or_b32 v50, v50, 14, v22
    v_perm_b32 v51, v51, v4, s46
    v_bfe_u32 v4, v4, 8, 5

    v_lshl_or_b32 v52, v52, 14, v23
    v_perm_b32 v53, v53, v5, s46
    v_bfe_u32 v5, v5, 8, 5

    v_lshl_or_b32 v54, v54, 14, v24
    v_perm_b32 v55, v55, v6, s46
    v_bfe_u32 v6, v6, 8, 5

    v_lshl_or_b32 v56, v56, 14, v25
    v_perm_b32 v57, v57, v7, s46
    v_bfe_u32 v7, v7, 8, 5

    v_fmaak_f32 v114, v114, v105, 0x4b400010
    v_fmaak_f32 v115, v115, v105, 0x4b400010
    v_fmaak_f32 v116, v116, v105, 0x4b400010
    v_fmaak_f32 v117, v117, v105, 0x4b400010
    v_sub_u32 v114, v114, v4
    v_sub_u32 v115, v115, v5
    v_sub_u32 v116, v116, v6
    v_sub_u32 v117, v117, v7
    v_bfi_b32 v114, 31, v4, v114
    v_bfi_b32 v115, 31, v5, v115
    v_bfi_b32 v116, 31, v6, v116
    v_bfi_b32 v117, 31, v7, v117
    v_perm_b32 v50, v50, v114, s55
    v_perm_b32 v52, v52, v115, s55
    v_perm_b32 v54, v54, v116, s55
    v_perm_b32 v56, v56, v117, s55
    s_waitcnt vmcnt(15)
    v_add_u32 v114, v106, v108
    v_add_u32 v115, v107, v109
    v_max_u32 v114, v114, v115
    v_cmp_lt_u32 vcc, s48, v114
    v_min_u32 v106, s48, v106
    v_min_u32 v107, s48, v107
    v_add_u32 v106, v106, v110
    v_add_u32 v107, v107, v111
    v_lshl_add_u32 v106, v106, 2, v106
    v_lshl_add_u32 v107, v107, 2, v107
    ds_write_b64 v2, v[106:107] offset:8192
    s_cbranch_vccz L_noov_5
    ds_write_b32 v113, v104 offset:4
L_noov_5:
    s_sub_u32 s74, s52, 17408
    s_max_i32 s74, s74, 0
    v_cmp_gt_u32 s[68:69], s74, v0
    s_waitcnt lgkmcnt(0)
    s_barrier
    ds_read_b32 v114, v113 offset:4
    s_waitcnt lgkmcnt(0)
    v_readfirstlane_b32 s53, v114
    s_nop 1
    s_cmp_lg_u32 s53, 0
    s_cbranch_scc1 L_slow_6
L_sback_7:

    v_mov_b32 v108, 1
    v_lshlrev_b32 v109, 20, v0
    buffer_atomic_add v108, v109, s[36:39], 0 offen offset:128 sc0
    ds_read_b64 v[114:115], v2 offset:16400
    ds_read_b64 v[116:117], v2 offset:16408
    ds_read_b64 v[118:119], v2 offset:16392

    ds_read_b64 v[120:121], v2 offset:24592
    ds_read_b64 v[122:123], v2 offset:24600
    ds_read_b64 v[124:125], v2 offset:24584

    s_waitcnt lgkmcnt(3)
    v_lshrrev_b32 v126, 16, v115
    ds_read_b32 v126, v126 offset:8192

    s_waitcnt lgkmcnt(1)
    v_lshrrev_b32 v127, 16, v121
    ds_read_b32 v127, v127 offset:8192

    v_cmp_ne_u32_sdwa s[70:71], v115, v117 src0_sel:WORD_1 src1_sel:WORD_1
    v_cmp_ne_u32_sdwa vcc, v115, v119 src0_sel:WORD_1 src1_sel:WORD_1
    v_perm_b32 v115, v116, v115, s45
    s_mov_b32 s54, 0
    v_alignbyte_b32 v118, v119, v118, 2
    s_waitcnt lgkmcnt(1)
    v_add3_u32 v126, v126, v49, s54

    s_and_b64 vcc, vcc, s[70:71]
    s_cbranch_scc1 L_fix_11
L_back_12:
    s_mov_b64 exec, s[70:71]
    v_alignbyte_b32 v115, v115, v114, 1
    v_perm_b32 v114, v114, v118, s47
    v_subrev_u32 v126, 3, v126
    s_mov_b64 exec, -1

    buffer_store_dwordx2 v[114:115], v126, s[24:27], 0 offen
    v_cmp_ne_u32_sdwa s[70:71], v121, v123 src0_sel:WORD_1 src1_sel:WORD_1
    v_cmp_ne_u32_sdwa vcc, v121, v125 src0_sel:WORD_1 src1_sel:WORD_1
    v_perm_b32 v121, v122, v121, s45
    s_mov_b32 s54, 5120
    v_alignbyte_b32 v124, v125, v124, 2
    s_waitcnt lgkmcnt(0)
    v_add3_u32 v127, v127, v49, s54

    s_and_b64 vcc, vcc, s[70:71]
    s_cbranch_scc1 L_fix_13
L_back_14:
    s_mov_b64 exec, s[70:71]
    v_alignbyte_b32 v121, v121, v120, 1
    v_perm_b32 v120, v120, v124, s47
    v_subrev_u32 v127, 3, v127
    s_mov_b64 exec, -1

    buffer_store_dwordx2 v[120:121], v127, s[24:27], 0 offen
    ds_read_b64 v[114:115], v2 offset:32784
    ds_read_b64 v[116:117], v2 offset:32792
    ds_read_b64 v[118:119], v2 offset:32776

    ds_read_b64 v[120:121], v2 offset:40976
    ds_read_b64 v[122:123], v2 offset:40984
    ds_read_b64 v[124:125], v2 offset:40968

    s_waitcnt lgkmcnt(3)
    v_lshrrev_b32 v126, 16, v115
    ds_read_b32 v126, v126 offset:8192

    s_waitcnt lgkmcnt(1)
    v_lshrrev_b32 v127, 16, v121
    ds_read_b32 v127, v127 offset:8192

    v_cmp_ne_u32_sdwa s[70:71], v115, v117 src0_sel:WORD_1 src1_sel:WORD_1
    v_cmp_ne_u32_sdwa vcc, v115, v119 src0_sel:WORD_1 src1_sel:WORD_1
    v_perm_b32 v115, v116, v115, s45
    s_mov_b32 s54, 10240
    v_alignbyte_b32 v118, v119, v118, 2
    s_waitcnt lgkmcnt(1)
    v_add3_u32 v126, v126, v49, s54

    s_and_b64 vcc, vcc, s[70:71]
    s_cbranch_scc1 L_fix_15
L_back_16:
    s_mov_b64 exec, s[70:71]
    v_alignbyte_b32 v115, v115, v114, 1
    v_perm_b32 v114, v114, v118, s47
    v_subrev_u32 v126, 3, v126
    s_mov_b64 exec, -1

    buffer_store_dwordx2 v[114:115], v126, s[24:27], 0 offen
    v_cmp_ne_u32_sdwa s[70:71], v121, v123 src0_sel:WORD_1 src1_sel:WORD_1
    v_cmp_ne_u32_sdwa vcc, v121, v125 src0_sel:WORD_1 src1_sel:WORD_1
    v_perm_b32 v121, v122, v121, s45
    s_mov_b32 s54, 15360
    v_alignbyte_b32 v124, v125, v124, 2
    s_waitcnt lgkmcnt(0)
    v_add3_u32 v127, v127, v49, s54

    s_and_b64 vcc, vcc, s[70:71]
    s_cbranch_scc1 L_fix_17
L_back_18:
    s_mov_b64 exec, s[70:71]
    v_alignbyte_b32 v121, v121, v120, 1
    v_perm_b32 v120, v120, v124, s47
    v_subrev_u32 v127, 3, v127
    s_mov_b64 exec, -1

    buffer_store_dwordx2 v[120:121], v127, s[24:27], 0 offen
    s_waitcnt vmcnt(14)
    v_mul_hi_u32_u24 v59, s40, v26
    v_mul_hi_u32_u24 v58, s40, v8
    v_mul_hi_u32_u24 v61, s40, v27
    v_mul_hi_u32_u24 v60, s40, v9
    v_mul_hi_u32_u24 v63, s40, v28
    v_mul_hi_u32_u24 v62, s40, v10
    v_mul_hi_u32_u24 v65, s40, v29
    v_mul_hi_u32_u24 v64, s40, v11
    v_and_b32 v59, -2, v59
    v_mad_u32_u24 v8, v58, s43, v8
    v_and_b32 v90, -4, v58
    v_and_b32 v61, -2, v61
    v_mad_u32_u24 v9, v60, s43, v9
    v_and_b32 v91, -4, v60
    v_and_b32 v63, -2, v63
    v_mad_u32_u24 v10, v62, s43, v10
    v_and_b32 v92, -4, v62
    v_and_b32 v65, -2, v65
    v_mad_u32_u24 v11, v64, s43, v11
    v_and_b32 v93, -4, v64
    v_mad_i32_i24 v26, v59, s42, v26
    v_lshl_add_u32 v59, v90, 5, v59
    v_mad_i32_i24 v27, v61, s42, v27
    v_lshl_add_u32 v61, v91, 5, v61
    v_mad_i32_i24 v28, v63, s42, v28
    v_lshl_add_u32 v63, v92, 5, v63
    v_mad_i32_i24 v29, v65, s42, v29
    v_lshl_add_u32 v65, v93, 5, v65
    v_add_u32 v59, v59, v59
    ds_add_rtn_u32 v90, v59, v104
    v_add_u32 v61, v61, v61
    ds_add_rtn_u32 v91, v61, v104
    v_add_u32 v63, v63, v63
    ds_add_rtn_u32 v92, v63, v104
    v_add_u32 v65, v65, v65
    ds_add_rtn_u32 v93, v65, v104
    v_lshlrev_b32 v114, 16, v42
    v_and_b32 v115, 0xffff0000, v42
    v_lshlrev_b32 v116, 16, v43
    v_and_b32 v117, 0xffff0000, v43
    v_mul_f32 v114, s44, v114
    v_mul_f32 v115, s44, v115
    v_mul_f32 v116, s44, v116
    v_mul_f32 v117, s44, v117
    v_fract_f32 v114, v114
    v_fract_f32 v115, v115
    v_fract_f32 v116, v116
    v_fract_f32 v117, v117
    v_cos_f32 v114, v114
    v_cos_f32 v115, v115
    v_cos_f32 v116, v116
    v_cos_f32 v117, v117
    v_lshl_or_b32 v58, v58, 14, v26
    v_perm_b32 v59, v59, v8, s46
    v_bfe_u32 v8, v8, 8, 5

    v_lshl_or_b32 v60, v60, 14, v27
    v_perm_b32 v61, v61, v9, s46
    v_bfe_u32 v9, v9, 8, 5

    v_lshl_or_b32 v62, v62, 14, v28
    v_perm_b32 v63, v63, v10, s46
    v_bfe_u32 v10, v10, 8, 5

    v_lshl_or_b32 v64, v64, 14, v29
    v_perm_b32 v65, v65, v11, s46
    v_bfe_u32 v11, v11, 8, 5

    v_fmaak_f32 v114, v114, v105, 0x4b400010
    v_fmaak_f32 v115, v115, v105, 0x4b400010
    v_fmaak_f32 v116, v116, v105, 0x4b400010
    v_fmaak_f32 v117, v117, v105, 0x4b400010
    v_sub_u32 v114, v114, v8
    v_sub_u32 v115, v115, v9
    v_sub_u32 v116, v116, v10
    v_sub_u32 v117, v117, v11
    v_bfi_b32 v114, 31, v8, v114
    v_bfi_b32 v115, 31, v9, v115
    v_bfi_b32 v116, 31, v10, v116
    v_bfi_b32 v117, 31, v11, v117
    v_perm_b32 v58, v58, v114, s55
    v_perm_b32 v60, v60, v115, s55
    v_perm_b32 v62, v62, v116, s55
    v_perm_b32 v64, v64, v117, s55
    ds_read_b64 v[114:115], v2 offset:49168
    ds_read_b64 v[116:117], v2 offset:49176
    ds_read_b64 v[118:119], v2 offset:49160

    ds_read_b64 v[120:121], v2 offset:57360
    ds_read_b64 v[122:123], v2 offset:57368
    ds_read_b64 v[124:125], v2 offset:57352

    s_waitcnt lgkmcnt(3)
    v_lshrrev_b32 v126, 16, v115
    ds_read_b32 v126, v126 offset:8192

    s_waitcnt lgkmcnt(1)
    v_lshrrev_b32 v127, 16, v121
    ds_read_b32 v127, v127 offset:8192

    v_cmp_ne_u32_sdwa s[70:71], v115, v117 src0_sel:WORD_1 src1_sel:WORD_1
    v_cmp_ne_u32_sdwa vcc, v115, v119 src0_sel:WORD_1 src1_sel:WORD_1
    v_perm_b32 v115, v116, v115, s45
    s_mov_b32 s54, 20480
    v_alignbyte_b32 v118, v119, v118, 2
    s_waitcnt lgkmcnt(1)
    v_add3_u32 v126, v126, v49, s54

    s_and_b64 vcc, vcc, s[70:71]
    s_cbranch_scc1 L_fix_19
L_back_20:
    s_mov_b64 exec, s[70:71]
    v_alignbyte_b32 v115, v115, v114, 1
    v_perm_b32 v114, v114, v118, s47
    v_subrev_u32 v126, 3, v126
    s_mov_b64 exec, -1

    buffer_store_dwordx2 v[114:115], v126, s[24:27], 0 offen
    v_cmp_ne_u32_sdwa s[70:71], v121, v123 src0_sel:WORD_1 src1_sel:WORD_1
    v_cmp_ne_u32_sdwa vcc, v121, v125 src0_sel:WORD_1 src1_sel:WORD_1
    v_perm_b32 v121, v122, v121, s45
    s_mov_b32 s54, 25600
    v_alignbyte_b32 v124, v125, v124, 2
    s_waitcnt lgkmcnt(0)
    v_add3_u32 v127, v127, v49, s54

    s_and_b64 vcc, vcc, s[70:71]
    s_cbranch_scc1 L_fix_21
L_back_22:
    s_mov_b64 exec, s[70:71]
    v_alignbyte_b32 v121, v121, v120, 1
    v_perm_b32 v120, v120, v124, s47
    v_subrev_u32 v127, 3, v127
    s_mov_b64 exec, -1

    buffer_store_dwordx2 v[120:121], v127, s[24:27], 0 offen
    v_add_u32 v112, 65536, v2
    ds_read_b64 v[114:115], v112 offset:16
    ds_read_b64 v[116:117], v112 offset:24
    ds_read_b64 v[118:119], v112 offset:8

    ds_read_b64 v[120:121], v112 offset:8208
    ds_read_b64 v[122:123], v112 offset:8216
    ds_read_b64 v[124:125], v112 offset:8200

    s_waitcnt lgkmcnt(3)
    v_lshrrev_b32 v126, 16, v115
    ds_read_b32 v126, v126 offset:8192

    s_waitcnt lgkmcnt(1)
    v_lshrrev_b32 v127, 16, v121
    ds_read_b32 v127, v127 offset:8192

    v_cmp_ne_u32_sdwa s[70:71], v115, v117 src0_sel:WORD_1 src1_sel:WORD_1
    v_cmp_ne_u32_sdwa vcc, v115, v119 src0_sel:WORD_1 src1_sel:WORD_1
    v_perm_b32 v115, v116, v115, s45
    s_mov_b32 s54, 30720
    v_alignbyte_b32 v118, v119, v118, 2
    s_waitcnt lgkmcnt(1)
    v_add3_u32 v126, v126, v49, s54

    s_and_b64 vcc, vcc, s[70:71]
    s_cbranch_scc1 L_fix_23
L_back_24:
    s_mov_b64 exec, s[70:71]
    v_alignbyte_b32 v115, v115, v114, 1
    v_perm_b32 v114, v114, v118, s47
    v_subrev_u32 v126, 3, v126
    s_mov_b64 exec, -1

    buffer_store_dwordx2 v[114:115], v126, s[24:27], 0 offen
    v_cmp_ne_u32_sdwa s[70:71], v121, v123 src0_sel:WORD_1 src1_sel:WORD_1
    v_cmp_ne_u32_sdwa vcc, v121, v125 src0_sel:WORD_1 src1_sel:WORD_1
    v_perm_b32 v121, v122, v121, s45
    s_mov_b32 s54, 35840
    v_alignbyte_b32 v124, v125, v124, 2
    s_waitcnt lgkmcnt(0)
    v_add3_u32 v127, v127, v49, s54

    s_and_b64 vcc, vcc, s[70:71]
    s_cbranch_scc1 L_fix_25
L_back_26:
    s_mov_b64 exec, s[70:71]
    v_alignbyte_b32 v121, v121, v120, 1
    v_perm_b32 v120, v120, v124, s47
    v_subrev_u32 v127, 3, v127
    s_mov_b64 exec, -1

    buffer_store_dwordx2 v[120:121], v127, s[24:27], 0 offen
    s_waitcnt vmcnt(15)
    v_mul_hi_u32_u24 v67, s40, v30
    v_mul_hi_u32_u24 v66, s40, v12
    v_mul_hi_u32_u24 v69, s40, v31
    v_mul_hi_u32_u24 v68, s40, v13
    v_mul_hi_u32_u24 v71, s40, v32
    v_mul_hi_u32_u24 v70, s40, v14
    v_mul_hi_u32_u24 v73, s40, v33
    v_mul_hi_u32_u24 v72, s40, v15
    v_and_b32 v67, -2, v67
    v_mad_u32_u24 v12, v66, s43, v12
    v_and_b32 v94, -4, v66
    v_and_b32 v69, -2, v69
    v_mad_u32_u24 v13, v68, s43, v13
    v_and_b32 v95, -4, v68
    v_and_b32 v71, -2, v71
    v_mad_u32_u24 v14, v70, s43, v14
    v_and_b32 v96, -4, v70
    v_and_b32 v73, -2, v73
    v_mad_u32_u24 v15, v72, s43, v15
    v_and_b32 v97, -4, v72
    v_mad_i32_i24 v30, v67, s42, v30
    v_lshl_add_u32 v67, v94, 5, v67
    v_mad_i32_i24 v31, v69, s42, v31
    v_lshl_add_u32 v69, v95, 5, v69
    v_mad_i32_i24 v32, v71, s42, v32
    v_lshl_add_u32 v71, v96, 5, v71
    v_mad_i32_i24 v33, v73, s42, v33
    v_lshl_add_u32 v73, v97, 5, v73
    v_add_u32 v67, v67, v67
    ds_add_rtn_u32 v94, v67, v104
    v_add_u32 v69, v69, v69
    ds_add_rtn_u32 v95, v69, v104
    v_add_u32 v71, v71, v71
    ds_add_rtn_u32 v96, v71, v104
    v_add_u32 v73, v73, v73
    ds_add_rtn_u32 v97, v73, v104
    v_lshlrev_b32 v114, 16, v44
    v_and_b32 v115, 0xffff0000, v44
    v_lshlrev_b32 v116, 16, v45
    v_and_b32 v117, 0xffff0000, v45
    v_mul_f32 v114, s44, v114
    v_mul_f32 v115, s44, v115
    v_mul_f32 v116, s44, v116
    v_mul_f32 v117, s44, v117
    v_fract_f32 v114, v114
    v_fract_f32 v115, v115
    v_fract_f32 v116, v116
    v_fract_f32 v117, v117
    v_cos_f32 v114, v114
    v_cos_f32 v115, v115
    v_cos_f32 v116, v116
    v_cos_f32 v117, v117
    v_lshl_or_b32 v66, v66, 14, v30
    v_perm_b32 v67, v67, v12, s46
    v_bfe_u32 v12, v12, 8, 5

    v_lshl_or_b32 v68, v68, 14, v31
    v_perm_b32 v69, v69, v13, s46
    v_bfe_u32 v13, v13, 8, 5

    v_lshl_or_b32 v70, v70, 14, v32
    v_perm_b32 v71, v71, v14, s46
    v_bfe_u32 v14, v14, 8, 5

    v_lshl_or_b32 v72, v72, 14, v33
    v_perm_b32 v73, v73, v15, s46
    v_bfe_u32 v15, v15, 8, 5

    v_fmaak_f32 v114, v114, v105, 0x4b400010
    v_fmaak_f32 v115, v115, v105, 0x4b400010
    v_fmaak_f32 v116, v116, v105, 0x4b400010
    v_fmaak_f32 v117, v117, v105, 0x4b400010
    v_sub_u32 v114, v114, v12
    v_sub_u32 v115, v115, v13
    v_sub_u32 v116, v116, v14
    v_sub_u32 v117, v117, v15
    v_bfi_b32 v114, 31, v12, v114
    v_bfi_b32 v115, 31, v13, v115
    v_bfi_b32 v116, 31, v14, v116
    v_bfi_b32 v117, 31, v15, v117
    v_perm_b32 v66, v66, v114, s55
    v_perm_b32 v68, v68, v115, s55
    v_perm_b32 v70, v70, v116, s55
    v_perm_b32 v72, v72, v117, s55
    ds_read_b64 v[114:115], v112 offset:16400
    ds_read_b64 v[116:117], v112 offset:16408
    ds_read_b64 v[118:119], v112 offset:16392

    ds_read_b64 v[120:121], v112 offset:24592
    ds_read_b64 v[122:123], v112 offset:24600
    ds_read_b64 v[124:125], v112 offset:24584

    s_waitcnt lgkmcnt(3)
    v_lshrrev_b32 v126, 16, v115
    ds_read_b32 v126, v126 offset:8192

    s_waitcnt lgkmcnt(1)
    v_lshrrev_b32 v127, 16, v121
    ds_read_b32 v127, v127 offset:8192

    v_cmp_ne_u32_sdwa s[70:71], v115, v117 src0_sel:WORD_1 src1_sel:WORD_1
    v_cmp_ne_u32_sdwa vcc, v115, v119 src0_sel:WORD_1 src1_sel:WORD_1
    v_perm_b32 v115, v116, v115, s45
    s_mov_b32 s54, 40960
    v_alignbyte_b32 v118, v119, v118, 2
    s_waitcnt lgkmcnt(1)
    v_add3_u32 v126, v126, v49, s54

    s_and_b64 vcc, vcc, s[70:71]
    s_cbranch_scc1 L_fix_27
L_back_28:
    s_mov_b64 exec, s[70:71]
    v_alignbyte_b32 v115, v115, v114, 1
    v_perm_b32 v114, v114, v118, s47
    v_subrev_u32 v126, 3, v126
    s_mov_b64 exec, -1

    buffer_store_dwordx2 v[114:115], v126, s[24:27], 0 offen
    v_cmp_ne_u32_sdwa s[70:71], v121, v123 src0_sel:WORD_1 src1_sel:WORD_1
    v_cmp_ne_u32_sdwa vcc, v121, v125 src0_sel:WORD_1 src1_sel:WORD_1
    v_perm_b32 v121, v122, v121, s45
    s_mov_b32 s54, 46080
    v_alignbyte_b32 v124, v125, v124, 2
    s_waitcnt lgkmcnt(0)
    v_add3_u32 v127, v127, v49, s54

    s_and_b64 vcc, vcc, s[70:71]
    s_cbranch_scc1 L_fix_29
L_back_30:
    s_mov_b64 exec, s[70:71]
    v_alignbyte_b32 v121, v121, v120, 1
    v_perm_b32 v120, v120, v124, s47
    v_subrev_u32 v127, 3, v127
    s_mov_b64 exec, -1

    buffer_store_dwordx2 v[120:121], v127, s[24:27], 0 offen
    ds_read_b64 v[114:115], v112 offset:32784
    ds_read_b64 v[116:117], v112 offset:32792
    ds_read_b64 v[118:119], v112 offset:32776

    ds_read_b64 v[120:121], v112 offset:40976
    ds_read_b64 v[122:123], v112 offset:40984
    ds_read_b64 v[124:125], v112 offset:40968

    s_waitcnt lgkmcnt(3)
    v_lshrrev_b32 v126, 16, v115
    ds_read_b32 v126, v126 offset:8192

    s_waitcnt lgkmcnt(1)
    v_lshrrev_b32 v127, 16, v121
    ds_read_b32 v127, v127 offset:8192

    v_cmp_ne_u32_sdwa s[70:71], v115, v117 src0_sel:WORD_1 src1_sel:WORD_1
    v_cmp_ne_u32_sdwa vcc, v115, v119 src0_sel:WORD_1 src1_sel:WORD_1
    v_perm_b32 v115, v116, v115, s45
    s_mov_b32 s54, 51200
    v_alignbyte_b32 v118, v119, v118, 2
    s_waitcnt lgkmcnt(1)
    v_add3_u32 v126, v126, v49, s54

    s_and_b64 vcc, vcc, s[70:71]
    s_cbranch_scc1 L_fix_31
L_back_32:
    s_mov_b64 exec, s[70:71]
    v_alignbyte_b32 v115, v115, v114, 1
    v_perm_b32 v114, v114, v118, s47
    v_subrev_u32 v126, 3, v126
    s_mov_b64 exec, -1

    buffer_store_dwordx2 v[114:115], v126, s[24:27], 0 offen
    v_cmp_ne_u32_sdwa s[70:71], v121, v123 src0_sel:WORD_1 src1_sel:WORD_1
    v_cmp_ne_u32_sdwa vcc, v121, v125 src0_sel:WORD_1 src1_sel:WORD_1
    v_perm_b32 v121, v122, v121, s45
    s_mov_b32 s54, 56320
    v_alignbyte_b32 v124, v125, v124, 2
    s_waitcnt lgkmcnt(0)
    v_add3_u32 v127, v127, v49, s54

    s_and_b64 vcc, vcc, s[70:71]
    s_cbranch_scc1 L_fix_33
L_back_34:
    s_mov_b64 exec, s[70:71]
    v_alignbyte_b32 v121, v121, v120, 1
    v_perm_b32 v120, v120, v124, s47
    v_subrev_u32 v127, 3, v127
    s_mov_b64 exec, -1

    buffer_store_dwordx2 v[120:121], v127, s[24:27], 0 offen
    s_waitcnt vmcnt(16)
    v_mul_hi_u32_u24 v75, s40, v34
    v_mul_hi_u32_u24 v74, s40, v16
    v_mul_hi_u32_u24 v77, s40, v35
    v_mul_hi_u32_u24 v76, s40, v17
    v_mul_hi_u32_u24 v79, s40, v36
    v_mul_hi_u32_u24 v78, s40, v18
    v_mul_hi_u32_u24 v81, s40, v37
    v_mul_hi_u32_u24 v80, s40, v19
    v_and_b32 v75, -2, v75
    v_mad_u32_u24 v16, v74, s43, v16
    v_and_b32 v98, -4, v74
    v_and_b32 v77, -2, v77
    v_mad_u32_u24 v17, v76, s43, v17
    v_and_b32 v99, -4, v76
    v_and_b32 v79, -2, v79
    v_mad_u32_u24 v18, v78, s43, v18
    v_and_b32 v100, -4, v78
    v_and_b32 v81, -2, v81
    v_mad_u32_u24 v19, v80, s43, v19
    v_and_b32 v101, -4, v80
    v_mad_i32_i24 v34, v75, s42, v34
    v_lshl_add_u32 v75, v98, 5, v75
    v_mad_i32_i24 v35, v77, s42, v35
    v_lshl_add_u32 v77, v99, 5, v77
    v_mad_i32_i24 v36, v79, s42, v36
    v_lshl_add_u32 v79, v100, 5, v79
    v_mad_i32_i24 v37, v81, s42, v37
    v_lshl_add_u32 v81, v101, 5, v81
    v_add_u32 v75, v75, v75
    ds_add_rtn_u32 v98, v75, v104
    v_add_u32 v77, v77, v77
    ds_add_rtn_u32 v99, v77, v104
    v_add_u32 v79, v79, v79
    ds_add_rtn_u32 v100, v79, v104
    v_add_u32 v81, v81, v81
    ds_add_rtn_u32 v101, v81, v104
    v_lshlrev_b32 v114, 16, v46
    v_and_b32 v115, 0xffff0000, v46
    v_lshlrev_b32 v116, 16, v47
    v_and_b32 v117, 0xffff0000, v47
    v_mul_f32 v114, s44, v114
    v_mul_f32 v115, s44, v115
    v_mul_f32 v116, s44, v116
    v_mul_f32 v117, s44, v117
    v_fract_f32 v114, v114
    v_fract_f32 v115, v115
    v_fract_f32 v116, v116
    v_fract_f32 v117, v117
    v_cos_f32 v114, v114
    v_cos_f32 v115, v115
    v_cos_f32 v116, v116
    v_cos_f32 v117, v117
    v_lshl_or_b32 v74, v74, 14, v34
    v_perm_b32 v75, v75, v16, s46
    v_bfe_u32 v16, v16, 8, 5

    v_lshl_or_b32 v76, v76, 14, v35
    v_perm_b32 v77, v77, v17, s46
    v_bfe_u32 v17, v17, 8, 5

    v_lshl_or_b32 v78, v78, 14, v36
    v_perm_b32 v79, v79, v18, s46
    v_bfe_u32 v18, v18, 8, 5

    v_lshl_or_b32 v80, v80, 14, v37
    v_perm_b32 v81, v81, v19, s46
    v_bfe_u32 v19, v19, 8, 5

    v_fmaak_f32 v114, v114, v105, 0x4b400010
    v_fmaak_f32 v115, v115, v105, 0x4b400010
    v_fmaak_f32 v116, v116, v105, 0x4b400010
    v_fmaak_f32 v117, v117, v105, 0x4b400010
    v_sub_u32 v114, v114, v16
    v_sub_u32 v115, v115, v17
    v_sub_u32 v116, v116, v18
    v_sub_u32 v117, v117, v19
    v_bfi_b32 v114, 31, v16, v114
    v_bfi_b32 v115, 31, v17, v115
    v_bfi_b32 v116, 31, v18, v116
    v_bfi_b32 v117, 31, v19, v117
    v_perm_b32 v74, v74, v114, s55
    v_perm_b32 v76, v76, v115, s55
    v_perm_b32 v78, v78, v116, s55
    v_perm_b32 v80, v80, v117, s55
    ds_read_b64 v[114:115], v112 offset:49168
    ds_read_b64 v[116:117], v112 offset:49176
    ds_read_b64 v[118:119], v112 offset:49160

    ds_read_b64 v[120:121], v112 offset:57360
    ds_read_b64 v[122:123], v112 offset:57368
    ds_read_b64 v[124:125], v112 offset:57352

    s_waitcnt lgkmcnt(3)
    v_lshrrev_b32 v126, 16, v115
    ds_read_b32 v126, v126 offset:8192

    s_waitcnt lgkmcnt(1)
    v_lshrrev_b32 v127, 16, v121
    ds_read_b32 v127, v127 offset:8192

    v_cmp_ne_u32_sdwa s[70:71], v115, v117 src0_sel:WORD_1 src1_sel:WORD_1
    v_cmp_ne_u32_sdwa vcc, v115, v119 src0_sel:WORD_1 src1_sel:WORD_1
    v_perm_b32 v115, v116, v115, s45
    s_mov_b32 s54, 61440
    v_alignbyte_b32 v118, v119, v118, 2
    s_waitcnt lgkmcnt(1)
    v_add3_u32 v126, v126, v49, s54

    s_and_b64 vcc, vcc, s[70:71]
    s_cbranch_scc1 L_fix_35
L_back_36:
    s_mov_b64 exec, s[70:71]
    v_alignbyte_b32 v115, v115, v114, 1
    v_perm_b32 v114, v114, v118, s47
    v_subrev_u32 v126, 3, v126
    s_mov_b64 exec, -1

    buffer_store_dwordx2 v[114:115], v126, s[24:27], 0 offen
    v_cmp_ne_u32_sdwa s[70:71], v121, v123 src0_sel:WORD_1 src1_sel:WORD_1
    v_cmp_ne_u32_sdwa vcc, v121, v125 src0_sel:WORD_1 src1_sel:WORD_1
    v_perm_b32 v121, v122, v121, s45
    s_mov_b32 s54, 66560
    v_alignbyte_b32 v124, v125, v124, 2
    s_waitcnt lgkmcnt(0)
    v_add3_u32 v127, v127, v49, s54

    s_and_b64 vcc, vcc, s[70:71]
    s_cbranch_scc1 L_fix_37
L_back_38:
    s_mov_b64 exec, s[70:71]
    v_alignbyte_b32 v121, v121, v120, 1
    v_perm_b32 v120, v120, v124, s47
    v_subrev_u32 v127, 3, v127
    s_mov_b64 exec, -1

    buffer_store_dwordx2 v[120:121], v127, s[24:27], 0 offen
    v_add_u32 v112, 131072, v2
    ds_read_b64 v[114:115], v112 offset:16
    ds_read_b64 v[116:117], v112 offset:24
    ds_read_b64 v[118:119], v112 offset:8

    ds_read_b64 v[120:121], v112 offset:8208
    ds_read_b64 v[122:123], v112 offset:8216
    ds_read_b64 v[124:125], v112 offset:8200

    s_waitcnt lgkmcnt(3)
    v_lshrrev_b32 v126, 16, v115
    ds_read_b32 v126, v126 offset:8192

    s_waitcnt lgkmcnt(1)
    v_lshrrev_b32 v127, 16, v121
    ds_read_b32 v127, v127 offset:8192

    v_cmp_ne_u32_sdwa s[70:71], v115, v117 src0_sel:WORD_1 src1_sel:WORD_1
    v_cmp_ne_u32_sdwa vcc, v115, v119 src0_sel:WORD_1 src1_sel:WORD_1
    v_perm_b32 v115, v116, v115, s45
    s_mov_b32 s54, 71680
    v_alignbyte_b32 v118, v119, v118, 2
    s_waitcnt lgkmcnt(1)
    v_add3_u32 v126, v126, v49, s54

    s_and_b64 vcc, vcc, s[70:71]
    s_cbranch_scc1 L_fix_39
L_back_40:
    s_mov_b64 exec, s[70:71]
    v_alignbyte_b32 v115, v115, v114, 1
    v_perm_b32 v114, v114, v118, s47
    v_subrev_u32 v126, 3, v126
    s_mov_b64 exec, -1

    buffer_store_dwordx2 v[114:115], v126, s[24:27], 0 offen
    v_cmp_ne_u32_sdwa s[70:71], v121, v123 src0_sel:WORD_1 src1_sel:WORD_1
    v_cmp_ne_u32_sdwa vcc, v121, v125 src0_sel:WORD_1 src1_sel:WORD_1
    v_perm_b32 v121, v122, v121, s45
    s_mov_b32 s54, 76800
    v_alignbyte_b32 v124, v125, v124, 2
    s_waitcnt lgkmcnt(0)
    v_add3_u32 v127, v127, v49, s54

    s_and_b64 vcc, vcc, s[70:71]
    s_cbranch_scc1 L_fix_41
L_back_42:
    s_mov_b64 exec, s[70:71]
    v_alignbyte_b32 v121, v121, v120, 1
    v_perm_b32 v120, v120, v124, s47
    v_subrev_u32 v127, 3, v127
    s_mov_b64 exec, -1

    buffer_store_dwordx2 v[120:121], v127, s[24:27], 0 offen
    s_waitcnt vmcnt(17)
    s_mov_b64 exec, s[66:67]
    v_mul_hi_u32_u24 v83, s40, v38
    v_mul_hi_u32_u24 v82, s40, v20
    v_mul_hi_u32_u24 v85, s40, v39
    v_mul_hi_u32_u24 v84, s40, v21
    v_and_b32 v83, -2, v83
    v_mad_u32_u24 v20, v82, s43, v20
    v_and_b32 v102, -4, v82
    v_and_b32 v85, -2, v85
    v_mad_u32_u24 v21, v84, s43, v21
    v_and_b32 v103, -4, v84
    v_mad_i32_i24 v38, v83, s42, v38
    v_lshl_add_u32 v83, v102, 5, v83
    v_mad_i32_i24 v39, v85, s42, v39
    v_lshl_add_u32 v85, v103, 5, v85
    v_add_u32 v83, v83, v83
    ds_add_rtn_u32 v102, v83, v104
    v_add_u32 v85, v85, v85
    ds_add_rtn_u32 v103, v85, v104
    v_lshlrev_b32 v114, 16, v48
    v_and_b32 v115, 0xffff0000, v48
    v_mul_f32 v114, s44, v114
    v_mul_f32 v115, s44, v115
    v_fract_f32 v114, v114
    v_fract_f32 v115, v115
    v_cos_f32 v114, v114
    v_cos_f32 v115, v115
    v_lshl_or_b32 v82, v82, 14, v38
    v_perm_b32 v83, v83, v20, s46
    v_bfe_u32 v20, v20, 8, 5

    v_lshl_or_b32 v84, v84, 14, v39
    v_perm_b32 v85, v85, v21, s46
    v_bfe_u32 v21, v21, 8, 5

    v_fmaak_f32 v114, v114, v105, 0x4b400010
    v_fmaak_f32 v115, v115, v105, 0x4b400010
    v_sub_u32 v114, v114, v20
    v_sub_u32 v115, v115, v21
    v_bfi_b32 v114, 31, v20, v114
    v_bfi_b32 v115, 31, v21, v115
    v_perm_b32 v82, v82, v114, s55
    v_perm_b32 v84, v84, v115, s55
    s_mov_b64 exec, -1
    v_cmp_eq_u32 vcc, 0, v0
    s_waitcnt vmcnt(16)
    s_mov_b64 exec, vcc
    ds_write_b32 v113, v108 offset:8
    s_mov_b64 exec, -1
    s_waitcnt lgkmcnt(0)
    s_barrier

    ds_read_b32 v114, v113 offset:8
    ds_read_b64 v[108:109], v2
    s_waitcnt lgkmcnt(0)

    v_readfirstlane_b32 s41, v114
    v_and_b32 v108, 0xffff, v108
    v_and_b32 v109, 0xffff, v109
    v_mov_b32 v106, v108
    v_mov_b32 v107, v109
    v_add_u32 v111, v108, v109

    buffer_atomic_add_x2 v[106:107], v2, s[20:23], 0 offen sc0
    s_nop 1
    v_add_u32_dpp v111, v111, v111 row_shr:1 row_mask:0xf bank_mask:0xf
    s_nop 1
    v_add_u32_dpp v111, v111, v111 row_shr:2 row_mask:0xf bank_mask:0xf
    s_nop 1
    v_add_u32_dpp v111, v111, v111 row_shr:4 row_mask:0xf bank_mask:0xf
    s_nop 1
    v_add_u32_dpp v111, v111, v111 row_shr:8 row_mask:0xf bank_mask:0xf
    s_nop 1
    v_add_u32_dpp v111, v111, v111 row_bcast:15 row_mask:0xa bank_mask:0xf
    s_nop 1
    v_add_u32_dpp v111, v111, v111 row_bcast:31 row_mask:0xc bank_mask:0xf
    s_mov_b32 exec_lo, 0
    s_brev_b32 exec_hi, 1
    ds_add_rtn_u32 v110, v113, v111
    s_mov_b64 exec, -1

    s_add_u32 s41, s41, 256
    s_movk_i32 s49, 18240
    s_mul_i32 s78, s41, 18240
    s_mul_i32 s79, s41, 17600
    s_add_u32 s79, s79, 1638400
    s_cmp_ge_u32 s41, 2560
    s_cmovk_i32 s49, 17600
    s_cselect_b32 s78, s79, s78
    s_cmp_ge_u32 s41, 2816
    s_cmovk_i32 s49, 0
    s_cmovk_i32 s78, 0
    s_add_u32 s77, s49, s78
    s_lshl_b32 s10, s77, 2
    s_lshl_b32 s14, s77, 2
    s_lshl_b32 s18, s77, 1
    s_lshl_b32 s56, s78, 2
    s_lshl_b32 s61, s78, 1

    s_add_u32 s57, s56, 16384
    s_add_u32 s62, s61, 8192
    s_add_u32 s58, s56, 32768
    s_add_u32 s63, s61, 16384
    s_add_u32 s59, s56, 49152
    s_add_u32 s64, s61, 24576
    s_add_u32 s60, s56, 65536
    s_add_u32 s65, s61, 32768
    buffer_load_dwordx4 v[22:25], v1, s[12:15], s56 offen nt
    buffer_load_dwordx4 v[4:7], v1, s[8:11], s56 offen nt
    buffer_load_dwordx2 v[40:41], v2, s[16:19], s61 offen nt
    ds_read_b64 v[114:115], v112 offset:16400
    ds_read_b64 v[116:117], v112 offset:16408
    ds_read_b64 v[118:119], v112 offset:16392

    ds_read_b64 v[120:121], v112 offset:24592
    ds_read_b64 v[122:123], v112 offset:24600
    ds_read_b64 v[124:125], v112 offset:24584

    s_waitcnt lgkmcnt(3)
    v_lshrrev_b32 v126, 16, v115
    ds_read_b32 v126, v126 offset:8192

    s_waitcnt lgkmcnt(1)
    v_lshrrev_b32 v127, 16, v121
    ds_read_b32 v127, v127 offset:8192

    v_cmp_ne_u32_sdwa s[70:71], v115, v117 src0_sel:WORD_1 src1_sel:WORD_1
    v_cmp_ne_u32_sdwa vcc, v115, v119 src0_sel:WORD_1 src1_sel:WORD_1
    v_perm_b32 v115, v116, v115, s45
    s_mov_b32 s54, 81920
    v_alignbyte_b32 v118, v119, v118, 2
    s_waitcnt lgkmcnt(1)
    v_add3_u32 v126, v126, v49, s54

    s_and_b64 vcc, vcc, s[70:71]
    s_cbranch_scc1 L_fix_43
L_back_44:
    s_mov_b64 exec, s[70:71]
    v_alignbyte_b32 v115, v115, v114, 1
    v_perm_b32 v114, v114, v118, s47
    v_subrev_u32 v126, 3, v126
    s_mov_b64 exec, -1

    buffer_store_dwordx2 v[114:115], v126, s[24:27], 0 offen
    v_cmp_ne_u32_sdwa s[70:71], v121, v123 src0_sel:WORD_1 src1_sel:WORD_1
    v_cmp_ne_u32_sdwa vcc, v121, v125 src0_sel:WORD_1 src1_sel:WORD_1
    v_perm_b32 v121, v122, v121, s45
    s_mov_b32 s54, 87040
    v_alignbyte_b32 v124, v125, v124, 2
    s_waitcnt lgkmcnt(0)
    v_add3_u32 v127, v127, v49, s54

    s_andn2_b64 exec, -1, s[68:69]
    v_bfrev_b32 v127, 1
    s_mov_b64 exec, -1
    s_and_b64 vcc, vcc, s[68:69]

    s_and_b64 vcc, vcc, s[70:71]
    s_cbranch_scc1 L_fix_45
L_back_46:
    s_mov_b64 exec, s[70:71]
    v_alignbyte_b32 v121, v121, v120, 1
    v_perm_b32 v120, v120, v124, s47
    v_subrev_u32 v127, 3, v127
    s_mov_b64 exec, -1

    buffer_store_dwordx2 v[120:121], v127, s[24:27], 0 offen
    s_waitcnt lgkmcnt(0)
    v_readlane_b32 s77, v110, 63
    v_mul_u32_u24 v116, 7936, v0
    v_sub_u32 v111, v111, v109
    s_sub_u32 s77, s77, s50
    v_add_u32 v111, s77, v111
    v_sub_u32 v110, v111, v108
    v_lshlrev_b32 v115, 16, v111
    v_lshlrev_b32 v114, 16, v110
    ds_write_b64 v2, v[114:115]
    v_sub_u32 v110, v116, v110
    v_sub_u32 v111, v116, v111
    v_add_u32 v111, s48, v111
    s_lshl_b32 s74, s51, 3
    v_mov_b32 v126, s74
    v_mov_b32 v127, -1

    s_waitcnt lgkmcnt(0)
    s_barrier

    s_mov_b64 exec, 1
    ds_write_b32 v126, v127 offset:16404
    s_mov_b64 exec, -1

    v_lshrrev_b32 v114, 16, v51
    ds_read_b32 v114, v114
    v_lshrrev_b32 v115, 16, v53
    ds_read_b32 v115, v115
    v_lshrrev_b32 v116, 16, v55
    ds_read_b32 v116, v116
    v_lshrrev_b32 v117, 16, v57
    ds_read_b32 v117, v117
    v_lshrrev_b32 v118, 16, v59
    ds_read_b32 v118, v118
    v_lshrrev_b32 v119, 16, v61
    ds_read_b32 v119, v119
    v_lshrrev_b32 v120, 16, v63
    ds_read_b32 v120, v120
    v_lshrrev_b32 v121, 16, v65
    ds_read_b32 v121, v121
    s_waitcnt lgkmcnt(7)
    v_add_u32_sdwa v114, v114, v86 dst_sel:DWORD dst_unused:UNUSED_PAD src0_sel:WORD_1 src1_sel:WORD_0
    v_lshlrev_b32 v114, 3, v114
    ds_write_b64 v114, v[50:51] offset:16400

    s_waitcnt lgkmcnt(7)
    v_add_u32_sdwa v115, v115, v87 dst_sel:DWORD dst_unused:UNUSED_PAD src0_sel:WORD_1 src1_sel:WORD_0
    v_lshlrev_b32 v115, 3, v115
    ds_write_b64 v115, v[52:53] offset:16400

    s_waitcnt lgkmcnt(7)
    v_add_u32_sdwa v116, v116, v88 dst_sel:DWORD dst_unused:UNUSED_PAD src0_sel:WORD_1 src1_sel:WORD_0
    v_lshlrev_b32 v116, 3, v116
    ds_write_b64 v116, v[54:55] offset:16400

    s_waitcnt lgkmcnt(7)
    v_add_u32_sdwa v117, v117, v89 dst_sel:DWORD dst_unused:UNUSED_PAD src0_sel:WORD_1 src1_sel:WORD_0
    v_lshlrev_b32 v117, 3, v117
    ds_write_b64 v117, v[56:57] offset:16400

    s_waitcnt lgkmcnt(7)
    v_add_u32_sdwa v118, v118, v90 dst_sel:DWORD dst_unused:UNUSED_PAD src0_sel:WORD_1 src1_sel:WORD_0
    v_lshlrev_b32 v118, 3, v118
    ds_write_b64 v118, v[58:59] offset:16400

    s_waitcnt lgkmcnt(7)
    v_add_u32_sdwa v119, v119, v91 dst_sel:DWORD dst_unused:UNUSED_PAD src0_sel:WORD_1 src1_sel:WORD_0
    v_lshlrev_b32 v119, 3, v119
    ds_write_b64 v119, v[60:61] offset:16400

    s_waitcnt lgkmcnt(7)
    v_add_u32_sdwa v120, v120, v92 dst_sel:DWORD dst_unused:UNUSED_PAD src0_sel:WORD_1 src1_sel:WORD_0
    v_lshlrev_b32 v120, 3, v120
    ds_write_b64 v120, v[62:63] offset:16400

    s_waitcnt lgkmcnt(7)
    v_add_u32_sdwa v121, v121, v93 dst_sel:DWORD dst_unused:UNUSED_PAD src0_sel:WORD_1 src1_sel:WORD_0
    v_lshlrev_b32 v121, 3, v121
    ds_write_b64 v121, v[64:65] offset:16400

    buffer_load_dwordx4 v[26:29], v1, s[12:15], s57 offen nt
    buffer_load_dwordx4 v[8:11], v1, s[8:11], s57 offen nt
    buffer_load_dwordx2 v[42:43], v2, s[16:19], s62 offen nt
    v_lshrrev_b32 v114, 16, v67
    ds_read_b32 v114, v114
    v_lshrrev_b32 v115, 16, v69
    ds_read_b32 v115, v115
    v_lshrrev_b32 v116, 16, v71
    ds_read_b32 v116, v116
    v_lshrrev_b32 v117, 16, v73
    ds_read_b32 v117, v117
    v_lshrrev_b32 v118, 16, v75
    ds_read_b32 v118, v118
    v_lshrrev_b32 v119, 16, v77
    ds_read_b32 v119, v119
    v_lshrrev_b32 v120, 16, v79
    ds_read_b32 v120, v120
    v_lshrrev_b32 v121, 16, v81
    ds_read_b32 v121, v121
    s_waitcnt lgkmcnt(7)
    v_add_u32_sdwa v114, v114, v94 dst_sel:DWORD dst_unused:UNUSED_PAD src0_sel:WORD_1 src1_sel:WORD_0
    v_lshlrev_b32 v114, 3, v114
    ds_write_b64 v114, v[66:67] offset:16400

    s_waitcnt lgkmcnt(7)
    v_add_u32_sdwa v115, v115, v95 dst_sel:DWORD dst_unused:UNUSED_PAD src0_sel:WORD_1 src1_sel:WORD_0
    v_lshlrev_b32 v115, 3, v115
    ds_write_b64 v115, v[68:69] offset:16400

    s_waitcnt lgkmcnt(7)
    v_add_u32_sdwa v116, v116, v96 dst_sel:DWORD dst_unused:UNUSED_PAD src0_sel:WORD_1 src1_sel:WORD_0
    v_lshlrev_b32 v116, 3, v116
    ds_write_b64 v116, v[70:71] offset:16400

    s_waitcnt lgkmcnt(7)
    v_add_u32_sdwa v117, v117, v97 dst_sel:DWORD dst_unused:UNUSED_PAD src0_sel:WORD_1 src1_sel:WORD_0
    v_lshlrev_b32 v117, 3, v117
    ds_write_b64 v117, v[72:73] offset:16400

    s_waitcnt lgkmcnt(7)
    v_add_u32_sdwa v118, v118, v98 dst_sel:DWORD dst_unused:UNUSED_PAD src0_sel:WORD_1 src1_sel:WORD_0
    v_lshlrev_b32 v118, 3, v118
    ds_write_b64 v118, v[74:75] offset:16400

    s_waitcnt lgkmcnt(7)
    v_add_u32_sdwa v119, v119, v99 dst_sel:DWORD dst_unused:UNUSED_PAD src0_sel:WORD_1 src1_sel:WORD_0
    v_lshlrev_b32 v119, 3, v119
    ds_write_b64 v119, v[76:77] offset:16400

    s_waitcnt lgkmcnt(7)
    v_add_u32_sdwa v120, v120, v100 dst_sel:DWORD dst_unused:UNUSED_PAD src0_sel:WORD_1 src1_sel:WORD_0
    v_lshlrev_b32 v120, 3, v120
    ds_write_b64 v120, v[78:79] offset:16400

    s_waitcnt lgkmcnt(7)
    v_add_u32_sdwa v121, v121, v101 dst_sel:DWORD dst_unused:UNUSED_PAD src0_sel:WORD_1 src1_sel:WORD_0
    v_lshlrev_b32 v121, 3, v121
    ds_write_b64 v121, v[80:81] offset:16400

    s_mov_b64 exec, s[66:67]
    v_lshrrev_b32 v114, 16, v83
    ds_read_b32 v114, v114
    v_lshrrev_b32 v115, 16, v85
    ds_read_b32 v115, v115
    s_waitcnt lgkmcnt(1)
    v_add_u32_sdwa v114, v114, v102 dst_sel:DWORD dst_unused:UNUSED_PAD src0_sel:WORD_1 src1_sel:WORD_0
    v_lshlrev_b32 v114, 3, v114
    ds_write_b64 v114, v[82:83] offset:16400

    s_waitcnt lgkmcnt(1)
    v_add_u32_sdwa v115, v115, v103 dst_sel:DWORD dst_unused:UNUSED_PAD src0_sel:WORD_1 src1_sel:WORD_0
    v_lshlrev_b32 v115, 3, v115
    ds_write_b64 v115, v[84:85] offset:16400

    s_mov_b64 exec, -1
    s_add_u32 s50, s50, s51

    buffer_load_dwordx4 v[30:33], v1, s[12:15], s58 offen nt
    buffer_load_dwordx4 v[12:15], v1, s[8:11], s58 offen nt
    buffer_load_dwordx2 v[44:45], v2, s[16:19], s63 offen nt
    buffer_load_dwordx4 v[34:37], v1, s[12:15], s59 offen nt
    buffer_load_dwordx4 v[16:19], v1, s[8:11], s59 offen nt
    buffer_load_dwordx2 v[46:47], v2, s[16:19], s64 offen nt
    buffer_load_dwordx2 v[38:39], v2, s[12:15], s60 offen nt
    buffer_load_dwordx2 v[20:21], v2, s[8:11], s60 offen nt
    buffer_load_dword v48, v3, s[16:19], s65 offen nt
    s_cmp_lg_u32 s49, 0
    s_cbranch_scc1 L_p1loop_3
L_p1epi_4:
    s_mov_b32 s52, s51
    s_waitcnt vmcnt(15)
    v_add_u32 v114, v106, v108
    v_add_u32 v115, v107, v109
    v_max_u32 v114, v114, v115
    v_cmp_lt_u32 vcc, s48, v114
    v_min_u32 v106, s48, v106
    v_min_u32 v107, s48, v107
    v_add_u32 v106, v106, v110
    v_add_u32 v107, v107, v111
    v_lshl_add_u32 v106, v106, 2, v106
    v_lshl_add_u32 v107, v107, 2, v107
    ds_write_b64 v2, v[106:107] offset:8192
    s_cbranch_vccz L_noov_47
    ds_write_b32 v113, v104 offset:4
L_noov_47:
    s_sub_u32 s74, s52, 17408
    s_max_i32 s74, s74, 0
    v_cmp_gt_u32 s[68:69], s74, v0
    s_waitcnt lgkmcnt(0)
    s_barrier
    ds_read_b32 v114, v113 offset:4
    s_waitcnt lgkmcnt(0)
    v_readfirstlane_b32 s53, v114
    s_nop 1
    s_cmp_lg_u32 s53, 0
    s_cbranch_scc1 L_slow_48
L_sback_49:

    ds_read_b64 v[114:115], v2 offset:16400
    ds_read_b64 v[116:117], v2 offset:16408
    ds_read_b64 v[118:119], v2 offset:16392

    ds_read_b64 v[120:121], v2 offset:24592
    ds_read_b64 v[122:123], v2 offset:24600
    ds_read_b64 v[124:125], v2 offset:24584

    s_waitcnt lgkmcnt(3)
    v_lshrrev_b32 v126, 16, v115
    ds_read_b32 v126, v126 offset:8192

    s_waitcnt lgkmcnt(1)
    v_lshrrev_b32 v127, 16, v121
    ds_read_b32 v127, v127 offset:8192

    v_cmp_ne_u32_sdwa s[70:71], v115, v117 src0_sel:WORD_1 src1_sel:WORD_1
    v_cmp_ne_u32_sdwa vcc, v115, v119 src0_sel:WORD_1 src1_sel:WORD_1
    v_perm_b32 v115, v116, v115, s45
    s_mov_b32 s54, 0
    v_alignbyte_b32 v118, v119, v118, 2
    s_waitcnt lgkmcnt(1)
    v_add3_u32 v126, v126, v49, s54

    s_and_b64 vcc, vcc, s[70:71]
    s_cbranch_scc1 L_fix_53
L_back_54:
    s_mov_b64 exec, s[70:71]
    v_alignbyte_b32 v115, v115, v114, 1
    v_perm_b32 v114, v114, v118, s47
    v_subrev_u32 v126, 3, v126
    s_mov_b64 exec, -1

    buffer_store_dwordx2 v[114:115], v126, s[24:27], 0 offen
    v_cmp_ne_u32_sdwa s[70:71], v121, v123 src0_sel:WORD_1 src1_sel:WORD_1
    v_cmp_ne_u32_sdwa vcc, v121, v125 src0_sel:WORD_1 src1_sel:WORD_1
    v_perm_b32 v121, v122, v121, s45
    s_mov_b32 s54, 5120
    v_alignbyte_b32 v124, v125, v124, 2
    s_waitcnt lgkmcnt(0)
    v_add3_u32 v127, v127, v49, s54

    s_and_b64 vcc, vcc, s[70:71]
    s_cbranch_scc1 L_fix_55
L_back_56:
    s_mov_b64 exec, s[70:71]
    v_alignbyte_b32 v121, v121, v120, 1
    v_perm_b32 v120, v120, v124, s47
    v_subrev_u32 v127, 3, v127
    s_mov_b64 exec, -1

    buffer_store_dwordx2 v[120:121], v127, s[24:27], 0 offen
    ds_read_b64 v[114:115], v2 offset:32784
    ds_read_b64 v[116:117], v2 offset:32792
    ds_read_b64 v[118:119], v2 offset:32776

    ds_read_b64 v[120:121], v2 offset:40976
    ds_read_b64 v[122:123], v2 offset:40984
    ds_read_b64 v[124:125], v2 offset:40968

    s_waitcnt lgkmcnt(3)
    v_lshrrev_b32 v126, 16, v115
    ds_read_b32 v126, v126 offset:8192

    s_waitcnt lgkmcnt(1)
    v_lshrrev_b32 v127, 16, v121
    ds_read_b32 v127, v127 offset:8192

    v_cmp_ne_u32_sdwa s[70:71], v115, v117 src0_sel:WORD_1 src1_sel:WORD_1
    v_cmp_ne_u32_sdwa vcc, v115, v119 src0_sel:WORD_1 src1_sel:WORD_1
    v_perm_b32 v115, v116, v115, s45
    s_mov_b32 s54, 10240
    v_alignbyte_b32 v118, v119, v118, 2
    s_waitcnt lgkmcnt(1)
    v_add3_u32 v126, v126, v49, s54

    s_and_b64 vcc, vcc, s[70:71]
    s_cbranch_scc1 L_fix_57
L_back_58:
    s_mov_b64 exec, s[70:71]
    v_alignbyte_b32 v115, v115, v114, 1
    v_perm_b32 v114, v114, v118, s47
    v_subrev_u32 v126, 3, v126
    s_mov_b64 exec, -1

    buffer_store_dwordx2 v[114:115], v126, s[24:27], 0 offen
    v_cmp_ne_u32_sdwa s[70:71], v121, v123 src0_sel:WORD_1 src1_sel:WORD_1
    v_cmp_ne_u32_sdwa vcc, v121, v125 src0_sel:WORD_1 src1_sel:WORD_1
    v_perm_b32 v121, v122, v121, s45
    s_mov_b32 s54, 15360
    v_alignbyte_b32 v124, v125, v124, 2
    s_waitcnt lgkmcnt(0)
    v_add3_u32 v127, v127, v49, s54

    s_and_b64 vcc, vcc, s[70:71]
    s_cbranch_scc1 L_fix_59
L_back_60:
    s_mov_b64 exec, s[70:71]
    v_alignbyte_b32 v121, v121, v120, 1
    v_perm_b32 v120, v120, v124, s47
    v_subrev_u32 v127, 3, v127
    s_mov_b64 exec, -1

    buffer_store_dwordx2 v[120:121], v127, s[24:27], 0 offen
    ds_read_b64 v[114:115], v2 offset:49168
    ds_read_b64 v[116:117], v2 offset:49176
    ds_read_b64 v[118:119], v2 offset:49160

    ds_read_b64 v[120:121], v2 offset:57360
    ds_read_b64 v[122:123], v2 offset:57368
    ds_read_b64 v[124:125], v2 offset:57352

    s_waitcnt lgkmcnt(3)
    v_lshrrev_b32 v126, 16, v115
    ds_read_b32 v126, v126 offset:8192

    s_waitcnt lgkmcnt(1)
    v_lshrrev_b32 v127, 16, v121
    ds_read_b32 v127, v127 offset:8192

    v_cmp_ne_u32_sdwa s[70:71], v115, v117 src0_sel:WORD_1 src1_sel:WORD_1
    v_cmp_ne_u32_sdwa vcc, v115, v119 src0_sel:WORD_1 src1_sel:WORD_1
    v_perm_b32 v115, v116, v115, s45
    s_mov_b32 s54, 20480
    v_alignbyte_b32 v118, v119, v118, 2
    s_waitcnt lgkmcnt(1)
    v_add3_u32 v126, v126, v49, s54

    s_and_b64 vcc, vcc, s[70:71]
    s_cbranch_scc1 L_fix_61
L_back_62:
    s_mov_b64 exec, s[70:71]
    v_alignbyte_b32 v115, v115, v114, 1
    v_perm_b32 v114, v114, v118, s47
    v_subrev_u32 v126, 3, v126
    s_mov_b64 exec, -1

    buffer_store_dwordx2 v[114:115], v126, s[24:27], 0 offen
    v_cmp_ne_u32_sdwa s[70:71], v121, v123 src0_sel:WORD_1 src1_sel:WORD_1
    v_cmp_ne_u32_sdwa vcc, v121, v125 src0_sel:WORD_1 src1_sel:WORD_1
    v_perm_b32 v121, v122, v121, s45
    s_mov_b32 s54, 25600
    v_alignbyte_b32 v124, v125, v124, 2
    s_waitcnt lgkmcnt(0)
    v_add3_u32 v127, v127, v49, s54

    s_and_b64 vcc, vcc, s[70:71]
    s_cbranch_scc1 L_fix_63
L_back_64:
    s_mov_b64 exec, s[70:71]
    v_alignbyte_b32 v121, v121, v120, 1
    v_perm_b32 v120, v120, v124, s47
    v_subrev_u32 v127, 3, v127
    s_mov_b64 exec, -1

    buffer_store_dwordx2 v[120:121], v127, s[24:27], 0 offen
    v_add_u32 v112, 65536, v2
    ds_read_b64 v[114:115], v112 offset:16
    ds_read_b64 v[116:117], v112 offset:24
    ds_read_b64 v[118:119], v112 offset:8

    ds_read_b64 v[120:121], v112 offset:8208
    ds_read_b64 v[122:123], v112 offset:8216
    ds_read_b64 v[124:125], v112 offset:8200

    s_waitcnt lgkmcnt(3)
    v_lshrrev_b32 v126, 16, v115
    ds_read_b32 v126, v126 offset:8192

    s_waitcnt lgkmcnt(1)
    v_lshrrev_b32 v127, 16, v121
    ds_read_b32 v127, v127 offset:8192

    v_cmp_ne_u32_sdwa s[70:71], v115, v117 src0_sel:WORD_1 src1_sel:WORD_1
    v_cmp_ne_u32_sdwa vcc, v115, v119 src0_sel:WORD_1 src1_sel:WORD_1
    v_perm_b32 v115, v116, v115, s45
    s_mov_b32 s54, 30720
    v_alignbyte_b32 v118, v119, v118, 2
    s_waitcnt lgkmcnt(1)
    v_add3_u32 v126, v126, v49, s54

    s_and_b64 vcc, vcc, s[70:71]
    s_cbranch_scc1 L_fix_65
L_back_66:
    s_mov_b64 exec, s[70:71]
    v_alignbyte_b32 v115, v115, v114, 1
    v_perm_b32 v114, v114, v118, s47
    v_subrev_u32 v126, 3, v126
    s_mov_b64 exec, -1

    buffer_store_dwordx2 v[114:115], v126, s[24:27], 0 offen
    v_cmp_ne_u32_sdwa s[70:71], v121, v123 src0_sel:WORD_1 src1_sel:WORD_1
    v_cmp_ne_u32_sdwa vcc, v121, v125 src0_sel:WORD_1 src1_sel:WORD_1
    v_perm_b32 v121, v122, v121, s45
    s_mov_b32 s54, 35840
    v_alignbyte_b32 v124, v125, v124, 2
    s_waitcnt lgkmcnt(0)
    v_add3_u32 v127, v127, v49, s54

    s_and_b64 vcc, vcc, s[70:71]
    s_cbranch_scc1 L_fix_67
L_back_68:
    s_mov_b64 exec, s[70:71]
    v_alignbyte_b32 v121, v121, v120, 1
    v_perm_b32 v120, v120, v124, s47
    v_subrev_u32 v127, 3, v127
    s_mov_b64 exec, -1

    buffer_store_dwordx2 v[120:121], v127, s[24:27], 0 offen
    ds_read_b64 v[114:115], v112 offset:16400
    ds_read_b64 v[116:117], v112 offset:16408
    ds_read_b64 v[118:119], v112 offset:16392

    ds_read_b64 v[120:121], v112 offset:24592
    ds_read_b64 v[122:123], v112 offset:24600
    ds_read_b64 v[124:125], v112 offset:24584

    s_waitcnt lgkmcnt(3)
    v_lshrrev_b32 v126, 16, v115
    ds_read_b32 v126, v126 offset:8192

    s_waitcnt lgkmcnt(1)
    v_lshrrev_b32 v127, 16, v121
    ds_read_b32 v127, v127 offset:8192

    v_cmp_ne_u32_sdwa s[70:71], v115, v117 src0_sel:WORD_1 src1_sel:WORD_1
    v_cmp_ne_u32_sdwa vcc, v115, v119 src0_sel:WORD_1 src1_sel:WORD_1
    v_perm_b32 v115, v116, v115, s45
    s_mov_b32 s54, 40960
    v_alignbyte_b32 v118, v119, v118, 2
    s_waitcnt lgkmcnt(1)
    v_add3_u32 v126, v126, v49, s54

    s_and_b64 vcc, vcc, s[70:71]
    s_cbranch_scc1 L_fix_69
L_back_70:
    s_mov_b64 exec, s[70:71]
    v_alignbyte_b32 v115, v115, v114, 1
    v_perm_b32 v114, v114, v118, s47
    v_subrev_u32 v126, 3, v126
    s_mov_b64 exec, -1

    buffer_store_dwordx2 v[114:115], v126, s[24:27], 0 offen
    v_cmp_ne_u32_sdwa s[70:71], v121, v123 src0_sel:WORD_1 src1_sel:WORD_1
    v_cmp_ne_u32_sdwa vcc, v121, v125 src0_sel:WORD_1 src1_sel:WORD_1
    v_perm_b32 v121, v122, v121, s45
    s_mov_b32 s54, 46080
    v_alignbyte_b32 v124, v125, v124, 2
    s_waitcnt lgkmcnt(0)
    v_add3_u32 v127, v127, v49, s54

    s_and_b64 vcc, vcc, s[70:71]
    s_cbranch_scc1 L_fix_71
L_back_72:
    s_mov_b64 exec, s[70:71]
    v_alignbyte_b32 v121, v121, v120, 1
    v_perm_b32 v120, v120, v124, s47
    v_subrev_u32 v127, 3, v127
    s_mov_b64 exec, -1

    buffer_store_dwordx2 v[120:121], v127, s[24:27], 0 offen
    ds_read_b64 v[114:115], v112 offset:32784
    ds_read_b64 v[116:117], v112 offset:32792
    ds_read_b64 v[118:119], v112 offset:32776

    ds_read_b64 v[120:121], v112 offset:40976
    ds_read_b64 v[122:123], v112 offset:40984
    ds_read_b64 v[124:125], v112 offset:40968

    s_waitcnt lgkmcnt(3)
    v_lshrrev_b32 v126, 16, v115
    ds_read_b32 v126, v126 offset:8192

    s_waitcnt lgkmcnt(1)
    v_lshrrev_b32 v127, 16, v121
    ds_read_b32 v127, v127 offset:8192

    v_cmp_ne_u32_sdwa s[70:71], v115, v117 src0_sel:WORD_1 src1_sel:WORD_1
    v_cmp_ne_u32_sdwa vcc, v115, v119 src0_sel:WORD_1 src1_sel:WORD_1
    v_perm_b32 v115, v116, v115, s45
    s_mov_b32 s54, 51200
    v_alignbyte_b32 v118, v119, v118, 2
    s_waitcnt lgkmcnt(1)
    v_add3_u32 v126, v126, v49, s54

    s_and_b64 vcc, vcc, s[70:71]
    s_cbranch_scc1 L_fix_73
L_back_74:
    s_mov_b64 exec, s[70:71]
    v_alignbyte_b32 v115, v115, v114, 1
    v_perm_b32 v114, v114, v118, s47
    v_subrev_u32 v126, 3, v126
    s_mov_b64 exec, -1

    buffer_store_dwordx2 v[114:115], v126, s[24:27], 0 offen
    v_cmp_ne_u32_sdwa s[70:71], v121, v123 src0_sel:WORD_1 src1_sel:WORD_1
    v_cmp_ne_u32_sdwa vcc, v121, v125 src0_sel:WORD_1 src1_sel:WORD_1
    v_perm_b32 v121, v122, v121, s45
    s_mov_b32 s54, 56320
    v_alignbyte_b32 v124, v125, v124, 2
    s_waitcnt lgkmcnt(0)
    v_add3_u32 v127, v127, v49, s54

    s_and_b64 vcc, vcc, s[70:71]
    s_cbranch_scc1 L_fix_75
L_back_76:
    s_mov_b64 exec, s[70:71]
    v_alignbyte_b32 v121, v121, v120, 1
    v_perm_b32 v120, v120, v124, s47
    v_subrev_u32 v127, 3, v127
    s_mov_b64 exec, -1

    buffer_store_dwordx2 v[120:121], v127, s[24:27], 0 offen
    ds_read_b64 v[114:115], v112 offset:49168
    ds_read_b64 v[116:117], v112 offset:49176
    ds_read_b64 v[118:119], v112 offset:49160

    ds_read_b64 v[120:121], v112 offset:57360
    ds_read_b64 v[122:123], v112 offset:57368
    ds_read_b64 v[124:125], v112 offset:57352

    s_waitcnt lgkmcnt(3)
    v_lshrrev_b32 v126, 16, v115
    ds_read_b32 v126, v126 offset:8192

    s_waitcnt lgkmcnt(1)
    v_lshrrev_b32 v127, 16, v121
    ds_read_b32 v127, v127 offset:8192

    v_cmp_ne_u32_sdwa s[70:71], v115, v117 src0_sel:WORD_1 src1_sel:WORD_1
    v_cmp_ne_u32_sdwa vcc, v115, v119 src0_sel:WORD_1 src1_sel:WORD_1
    v_perm_b32 v115, v116, v115, s45
    s_mov_b32 s54, 61440
    v_alignbyte_b32 v118, v119, v118, 2
    s_waitcnt lgkmcnt(1)
    v_add3_u32 v126, v126, v49, s54

    s_and_b64 vcc, vcc, s[70:71]
    s_cbranch_scc1 L_fix_77
L_back_78:
    s_mov_b64 exec, s[70:71]
    v_alignbyte_b32 v115, v115, v114, 1
    v_perm_b32 v114, v114, v118, s47
    v_subrev_u32 v126, 3, v126
    s_mov_b64 exec, -1

    buffer_store_dwordx2 v[114:115], v126, s[24:27], 0 offen
    v_cmp_ne_u32_sdwa s[70:71], v121, v123 src0_sel:WORD_1 src1_sel:WORD_1
    v_cmp_ne_u32_sdwa vcc, v121, v125 src0_sel:WORD_1 src1_sel:WORD_1
    v_perm_b32 v121, v122, v121, s45
    s_mov_b32 s54, 66560
    v_alignbyte_b32 v124, v125, v124, 2
    s_waitcnt lgkmcnt(0)
    v_add3_u32 v127, v127, v49, s54

    s_and_b64 vcc, vcc, s[70:71]
    s_cbranch_scc1 L_fix_79
L_back_80:
    s_mov_b64 exec, s[70:71]
    v_alignbyte_b32 v121, v121, v120, 1
    v_perm_b32 v120, v120, v124, s47
    v_subrev_u32 v127, 3, v127
    s_mov_b64 exec, -1

    buffer_store_dwordx2 v[120:121], v127, s[24:27], 0 offen
    v_add_u32 v112, 131072, v2
    ds_read_b64 v[114:115], v112 offset:16
    ds_read_b64 v[116:117], v112 offset:24
    ds_read_b64 v[118:119], v112 offset:8

    ds_read_b64 v[120:121], v112 offset:8208
    ds_read_b64 v[122:123], v112 offset:8216
    ds_read_b64 v[124:125], v112 offset:8200

    s_waitcnt lgkmcnt(3)
    v_lshrrev_b32 v126, 16, v115
    ds_read_b32 v126, v126 offset:8192

    s_waitcnt lgkmcnt(1)
    v_lshrrev_b32 v127, 16, v121
    ds_read_b32 v127, v127 offset:8192

    v_cmp_ne_u32_sdwa s[70:71], v115, v117 src0_sel:WORD_1 src1_sel:WORD_1
    v_cmp_ne_u32_sdwa vcc, v115, v119 src0_sel:WORD_1 src1_sel:WORD_1
    v_perm_b32 v115, v116, v115, s45
    s_mov_b32 s54, 71680
    v_alignbyte_b32 v118, v119, v118, 2
    s_waitcnt lgkmcnt(1)
    v_add3_u32 v126, v126, v49, s54

    s_and_b64 vcc, vcc, s[70:71]
    s_cbranch_scc1 L_fix_81
L_back_82:
    s_mov_b64 exec, s[70:71]
    v_alignbyte_b32 v115, v115, v114, 1
    v_perm_b32 v114, v114, v118, s47
    v_subrev_u32 v126, 3, v126
    s_mov_b64 exec, -1

    buffer_store_dwordx2 v[114:115], v126, s[24:27], 0 offen
    v_cmp_ne_u32_sdwa s[70:71], v121, v123 src0_sel:WORD_1 src1_sel:WORD_1
    v_cmp_ne_u32_sdwa vcc, v121, v125 src0_sel:WORD_1 src1_sel:WORD_1
    v_perm_b32 v121, v122, v121, s45
    s_mov_b32 s54, 76800
    v_alignbyte_b32 v124, v125, v124, 2
    s_waitcnt lgkmcnt(0)
    v_add3_u32 v127, v127, v49, s54

    s_and_b64 vcc, vcc, s[70:71]
    s_cbranch_scc1 L_fix_83
L_back_84:
    s_mov_b64 exec, s[70:71]
    v_alignbyte_b32 v121, v121, v120, 1
    v_perm_b32 v120, v120, v124, s47
    v_subrev_u32 v127, 3, v127
    s_mov_b64 exec, -1

    buffer_store_dwordx2 v[120:121], v127, s[24:27], 0 offen
    ds_read_b64 v[114:115], v112 offset:16400
    ds_read_b64 v[116:117], v112 offset:16408
    ds_read_b64 v[118:119], v112 offset:16392

    ds_read_b64 v[120:121], v112 offset:24592
    ds_read_b64 v[122:123], v112 offset:24600
    ds_read_b64 v[124:125], v112 offset:24584

    s_waitcnt lgkmcnt(3)
    v_lshrrev_b32 v126, 16, v115
    ds_read_b32 v126, v126 offset:8192

    s_waitcnt lgkmcnt(1)
    v_lshrrev_b32 v127, 16, v121
    ds_read_b32 v127, v127 offset:8192

    v_cmp_ne_u32_sdwa s[70:71], v115, v117 src0_sel:WORD_1 src1_sel:WORD_1
    v_cmp_ne_u32_sdwa vcc, v115, v119 src0_sel:WORD_1 src1_sel:WORD_1
    v_perm_b32 v115, v116, v115, s45
    s_mov_b32 s54, 81920
    v_alignbyte_b32 v118, v119, v118, 2
    s_waitcnt lgkmcnt(1)
    v_add3_u32 v126, v126, v49, s54

    s_and_b64 vcc, vcc, s[70:71]
    s_cbranch_scc1 L_fix_85
L_back_86:
    s_mov_b64 exec, s[70:71]
    v_alignbyte_b32 v115, v115, v114, 1
    v_perm_b32 v114, v114, v118, s47
    v_subrev_u32 v126, 3, v126
    s_mov_b64 exec, -1

    buffer_store_dwordx2 v[114:115], v126, s[24:27], 0 offen
    v_cmp_ne_u32_sdwa s[70:71], v121, v123 src0_sel:WORD_1 src1_sel:WORD_1
    v_cmp_ne_u32_sdwa vcc, v121, v125 src0_sel:WORD_1 src1_sel:WORD_1
    v_perm_b32 v121, v122, v121, s45
    s_mov_b32 s54, 87040
    v_alignbyte_b32 v124, v125, v124, 2
    s_waitcnt lgkmcnt(0)
    v_add3_u32 v127, v127, v49, s54

    s_andn2_b64 exec, -1, s[68:69]
    v_bfrev_b32 v127, 1
    s_mov_b64 exec, -1
    s_and_b64 vcc, vcc, s[68:69]

    s_and_b64 vcc, vcc, s[70:71]
    s_cbranch_scc1 L_fix_87
L_back_88:
    s_mov_b64 exec, s[70:71]
    v_alignbyte_b32 v121, v121, v120, 1
    v_perm_b32 v120, v120, v124, s47
    v_subrev_u32 v127, 3, v127
    s_mov_b64 exec, -1

    buffer_store_dwordx2 v[120:121], v127, s[24:27], 0 offen
L_p1done_2:
    s_endpgm

L_slow_6:
    s_mov_b32 s26, 0
    v_mov_b32 v116, v0
    v_mov_b32 v122, 0
    s_mov_b32 s75, 4960
L_sl_8:
    v_lshlrev_b32 v117, 3, v116
    ds_read_b64 v[114:115], v117 offset:16400
    s_waitcnt lgkmcnt(0)
    v_lshrrev_b32 v118, 16, v115
    ds_read_b32 v119, v118 offset:8192
    v_add_u32 v118, 4, v118
    v_mul_u32_u24 v118, s75, v118
    s_waitcnt lgkmcnt(0)
    v_mad_u32_u24 v119, v116, 5, v119
    v_mov_b32 v120, 1
    v_cmp_gt_u32 s[72:73], s52, v116
    v_cmp_ge_u32 vcc, v119, v118
    s_and_b64 exec, vcc, s[72:73]
    s_cbranch_execz L_s1_9
    buffer_atomic_add v120, v122, s[36:39], 0 offen sc0
    s_waitcnt vmcnt(0)
    v_lshlrev_b32 v120, 3, v120
    buffer_store_dwordx2 v[114:115], v120, s[32:35], 0 offen
L_s1_9:
    s_andn2_b64 exec, s[72:73], vcc
    s_cbranch_execz L_s2_10
    buffer_store_dword v114, v119, s[28:31], 0 offen
    buffer_store_byte v115, v119, s[28:31], 0 offen offset:4
L_s2_10:
    s_mov_b64 exec, -1
    s_waitcnt vmcnt(0)
    v_add_u32 v116, 1024, v116
    s_nop 0
    v_readfirstlane_b32 s76, v116
    s_nop 1
    s_cmp_lt_u32 s76, s52
    s_cbranch_scc1 L_sl_8
    s_branch L_sback_7

L_fix_11:
    s_mov_b64 exec, vcc
    buffer_store_dword v114, v126, s[24:27], 0 offen
    buffer_store_byte v115, v126, s[24:27], 0 offen offset:4
    v_bfrev_b32 v126, 1
    s_branch L_back_12

L_fix_13:
    s_mov_b64 exec, vcc
    buffer_store_dword v120, v127, s[24:27], 0 offen
    buffer_store_byte v121, v127, s[24:27], 0 offen offset:4
    v_bfrev_b32 v127, 1
    s_branch L_back_14

L_fix_15:
    s_mov_b64 exec, vcc
    buffer_store_dword v114, v126, s[24:27], 0 offen
    buffer_store_byte v115, v126, s[24:27], 0 offen offset:4
    v_bfrev_b32 v126, 1
    s_branch L_back_16

L_fix_17:
    s_mov_b64 exec, vcc
    buffer_store_dword v120, v127, s[24:27], 0 offen
    buffer_store_byte v121, v127, s[24:27], 0 offen offset:4
    v_bfrev_b32 v127, 1
    s_branch L_back_18

L_fix_19:
    s_mov_b64 exec, vcc
    buffer_store_dword v114, v126, s[24:27], 0 offen
    buffer_store_byte v115, v126, s[24:27], 0 offen offset:4
    v_bfrev_b32 v126, 1
    s_branch L_back_20

L_fix_21:
    s_mov_b64 exec, vcc
    buffer_store_dword v120, v127, s[24:27], 0 offen
    buffer_store_byte v121, v127, s[24:27], 0 offen offset:4
    v_bfrev_b32 v127, 1
    s_branch L_back_22

L_fix_23:
    s_mov_b64 exec, vcc
    buffer_store_dword v114, v126, s[24:27], 0 offen
    buffer_store_byte v115, v126, s[24:27], 0 offen offset:4
    v_bfrev_b32 v126, 1
    s_branch L_back_24

L_fix_25:
    s_mov_b64 exec, vcc
    buffer_store_dword v120, v127, s[24:27], 0 offen
    buffer_store_byte v121, v127, s[24:27], 0 offen offset:4
    v_bfrev_b32 v127, 1
    s_branch L_back_26

L_fix_27:
    s_mov_b64 exec, vcc
    buffer_store_dword v114, v126, s[24:27], 0 offen
    buffer_store_byte v115, v126, s[24:27], 0 offen offset:4
    v_bfrev_b32 v126, 1
    s_branch L_back_28

L_fix_29:
    s_mov_b64 exec, vcc
    buffer_store_dword v120, v127, s[24:27], 0 offen
    buffer_store_byte v121, v127, s[24:27], 0 offen offset:4
    v_bfrev_b32 v127, 1
    s_branch L_back_30

L_fix_31:
    s_mov_b64 exec, vcc
    buffer_store_dword v114, v126, s[24:27], 0 offen
    buffer_store_byte v115, v126, s[24:27], 0 offen offset:4
    v_bfrev_b32 v126, 1
    s_branch L_back_32

L_fix_33:
    s_mov_b64 exec, vcc
    buffer_store_dword v120, v127, s[24:27], 0 offen
    buffer_store_byte v121, v127, s[24:27], 0 offen offset:4
    v_bfrev_b32 v127, 1
    s_branch L_back_34

L_fix_35:
    s_mov_b64 exec, vcc
    buffer_store_dword v114, v126, s[24:27], 0 offen
    buffer_store_byte v115, v126, s[24:27], 0 offen offset:4
    v_bfrev_b32 v126, 1
    s_branch L_back_36

L_fix_37:
    s_mov_b64 exec, vcc
    buffer_store_dword v120, v127, s[24:27], 0 offen
    buffer_store_byte v121, v127, s[24:27], 0 offen offset:4
    v_bfrev_b32 v127, 1
    s_branch L_back_38

L_fix_39:
    s_mov_b64 exec, vcc
    buffer_store_dword v114, v126, s[24:27], 0 offen
    buffer_store_byte v115, v126, s[24:27], 0 offen offset:4
    v_bfrev_b32 v126, 1
    s_branch L_back_40

L_fix_41:
    s_mov_b64 exec, vcc
    buffer_store_dword v120, v127, s[24:27], 0 offen
    buffer_store_byte v121, v127, s[24:27], 0 offen offset:4
    v_bfrev_b32 v127, 1
    s_branch L_back_42

L_fix_43:
    s_mov_b64 exec, vcc
    buffer_store_dword v114, v126, s[24:27], 0 offen
    buffer_store_byte v115, v126, s[24:27], 0 offen offset:4
    v_bfrev_b32 v126, 1
    s_branch L_back_44

L_fix_45:
    s_mov_b64 exec, vcc
    buffer_store_dword v120, v127, s[24:27], 0 offen
    buffer_store_byte v121, v127, s[24:27], 0 offen offset:4
    v_bfrev_b32 v127, 1
    s_branch L_back_46

L_slow_48:
    s_mov_b32 s26, 0
    v_mov_b32 v116, v0
    v_mov_b32 v122, 0
    s_mov_b32 s75, 4960
L_sl_50:
    v_lshlrev_b32 v117, 3, v116
    ds_read_b64 v[114:115], v117 offset:16400
    s_waitcnt lgkmcnt(0)
    v_lshrrev_b32 v118, 16, v115
    ds_read_b32 v119, v118 offset:8192
    v_add_u32 v118, 4, v118
    v_mul_u32_u24 v118, s75, v118
    s_waitcnt lgkmcnt(0)
    v_mad_u32_u24 v119, v116, 5, v119
    v_mov_b32 v120, 1
    v_cmp_gt_u32 s[72:73], s52, v116
    v_cmp_ge_u32 vcc, v119, v118
    s_and_b64 exec, vcc, s[72:73]
    s_cbranch_execz L_s1_51
    buffer_atomic_add v120, v122, s[36:39], 0 offen sc0
    s_waitcnt vmcnt(0)
    v_lshlrev_b32 v120, 3, v120
    buffer_store_dwordx2 v[114:115], v120, s[32:35], 0 offen
L_s1_51:
    s_andn2_b64 exec, s[72:73], vcc
    s_cbranch_execz L_s2_52
    buffer_store_dword v114, v119, s[28:31], 0 offen
    buffer_store_byte v115, v119, s[28:31], 0 offen offset:4
L_s2_52:
    s_mov_b64 exec, -1
    s_waitcnt vmcnt(0)
    v_add_u32 v116, 1024, v116
    s_nop 0
    v_readfirstlane_b32 s76, v116
    s_nop 1
    s_cmp_lt_u32 s76, s52
    s_cbranch_scc1 L_sl_50
    s_branch L_sback_49

L_fix_53:
    s_mov_b64 exec, vcc
    buffer_store_dword v114, v126, s[24:27], 0 offen
    buffer_store_byte v115, v126, s[24:27], 0 offen offset:4
    v_bfrev_b32 v126, 1
    s_branch L_back_54

L_fix_55:
    s_mov_b64 exec, vcc
    buffer_store_dword v120, v127, s[24:27], 0 offen
    buffer_store_byte v121, v127, s[24:27], 0 offen offset:4
    v_bfrev_b32 v127, 1
    s_branch L_back_56

L_fix_57:
    s_mov_b64 exec, vcc
    buffer_store_dword v114, v126, s[24:27], 0 offen
    buffer_store_byte v115, v126, s[24:27], 0 offen offset:4
    v_bfrev_b32 v126, 1
    s_branch L_back_58

L_fix_59:
    s_mov_b64 exec, vcc
    buffer_store_dword v120, v127, s[24:27], 0 offen
    buffer_store_byte v121, v127, s[24:27], 0 offen offset:4
    v_bfrev_b32 v127, 1
    s_branch L_back_60

L_fix_61:
    s_mov_b64 exec, vcc
    buffer_store_dword v114, v126, s[24:27], 0 offen
    buffer_store_byte v115, v126, s[24:27], 0 offen offset:4
    v_bfrev_b32 v126, 1
    s_branch L_back_62

L_fix_63:
    s_mov_b64 exec, vcc
    buffer_store_dword v120, v127, s[24:27], 0 offen
    buffer_store_byte v121, v127, s[24:27], 0 offen offset:4
    v_bfrev_b32 v127, 1
    s_branch L_back_64

L_fix_65:
    s_mov_b64 exec, vcc
    buffer_store_dword v114, v126, s[24:27], 0 offen
    buffer_store_byte v115, v126, s[24:27], 0 offen offset:4
    v_bfrev_b32 v126, 1
    s_branch L_back_66

L_fix_67:
    s_mov_b64 exec, vcc
    buffer_store_dword v120, v127, s[24:27], 0 offen
    buffer_store_byte v121, v127, s[24:27], 0 offen offset:4
    v_bfrev_b32 v127, 1
    s_branch L_back_68

L_fix_69:
    s_mov_b64 exec, vcc
    buffer_store_dword v114, v126, s[24:27], 0 offen
    buffer_store_byte v115, v126, s[24:27], 0 offen offset:4
    v_bfrev_b32 v126, 1
    s_branch L_back_70

L_fix_71:
    s_mov_b64 exec, vcc
    buffer_store_dword v120, v127, s[24:27], 0 offen
    buffer_store_byte v121, v127, s[24:27], 0 offen offset:4
    v_bfrev_b32 v127, 1
    s_branch L_back_72

L_fix_73:
    s_mov_b64 exec, vcc
    buffer_store_dword v114, v126, s[24:27], 0 offen
    buffer_store_byte v115, v126, s[24:27], 0 offen offset:4
    v_bfrev_b32 v126, 1
    s_branch L_back_74

L_fix_75:
    s_mov_b64 exec, vcc
    buffer_store_dword v120, v127, s[24:27], 0 offen
    buffer_store_byte v121, v127, s[24:27], 0 offen offset:4
    v_bfrev_b32 v127, 1
    s_branch L_back_76

L_fix_77:
    s_mov_b64 exec, vcc
    buffer_store_dword v114, v126, s[24:27], 0 offen
    buffer_store_byte v115, v126, s[24:27], 0 offen offset:4
    v_bfrev_b32 v126, 1
    s_branch L_back_78

L_fix_79:
    s_mov_b64 exec, vcc
    buffer_store_dword v120, v127, s[24:27], 0 offen
    buffer_store_byte v121, v127, s[24:27], 0 offen offset:4
    v_bfrev_b32 v127, 1
    s_branch L_back_80

L_fix_81:
    s_mov_b64 exec, vcc
    buffer_store_dword v114, v126, s[24:27], 0 offen
    buffer_store_byte v115, v126, s[24:27], 0 offen offset:4
    v_bfrev_b32 v126, 1
    s_branch L_back_82

L_fix_83:
    s_mov_b64 exec, vcc
    buffer_store_dword v120, v127, s[24:27], 0 offen
    buffer_store_byte v121, v127, s[24:27], 0 offen offset:4
    v_bfrev_b32 v127, 1
    s_branch L_back_84

L_fix_85:
    s_mov_b64 exec, vcc
    buffer_store_dword v114, v126, s[24:27], 0 offen
    buffer_store_byte v115, v126, s[24:27], 0 offen offset:4
    v_bfrev_b32 v126, 1
    s_branch L_back_86

L_fix_87:
    s_mov_b64 exec, vcc
    buffer_store_dword v120, v127, s[24:27], 0 offen
    buffer_store_byte v121, v127, s[24:27], 0 offen offset:4
    v_bfrev_b32 v127, 1
    s_branch L_back_88

.globl g2_kernel
.p2align 8
.type g2_kernel,@function
g2_kernel:
    s_cmp_ge_u32 s2, 256
    s_cbranch_scc1 L_p2done_89
    s_load_dwordx2 s[8:9], s[0:1], 0
    s_load_dwordx2 s[6:7], s[0:1], 104
    v_lshrrev_b32 v4, 6, v0
    v_lshlrev_b32 v5, 3, v0
    s_lshr_b32 s37, s2, 1
    s_and_b32 s37, s37, 3
    s_lshr_b32 s36, s2, 3
    s_lshl_b32 s36, s36, 1
    s_and_b32 s3, s2, 1
    s_or_b32 s36, s36, s3
    v_readfirstlane_b32 s4, v4
    v_and_b32 v2, 127, v0
    v_mul_u32_u24 v2, 20, v2
    v_lshlrev_b32 v3, 4, v0
    s_waitcnt lgkmcnt(0)
    s_lshr_b32 s5, s4, 1
    s_and_b32 s39, s4, 1
    s_lshl_b32 s39, s39, 8
    s_mul_i32 s3, s5, 8192
    s_add_u32 s46, s6, s3
    s_addc_u32 s47, s7, 0
    s_mul_i32 s3, s5, 40632320
    s_add_u32 s3, s3, 77848576
    s_add_u32 s44, s6, s3
    s_addc_u32 s45, s7, 0
    s_mul_i32 s38, s37, 8
    s_add_u32 s4, s38, 8
    s_lshl_b32 s3, s38, 6
    s_add_u32 s3, s3, s36
    s_lshl_b32 s3, s3, 2
    s_load_dword s41, s[46:47], s3
    s_mov_b32 s3, 131072
    s_load_dword s51, s[6:7], s3
    s_mov_b32 s10, 6400000
    s_mov_b32 s11, 0x20000

    s_add_u32 s20, s6, 135168
    s_addc_u32 s21, s7, 0
    s_mov_b32 s22, 8192
    s_mov_b32 s23, 0x20000
    buffer_load_dwordx2 v[116:117], v5, s[20:23], 0 offen
    s_mov_b32 s12, s8
    s_mov_b32 s13, s9
    s_mov_b32 s14, 0
    s_mov_b32 s15, 0x20000
    s_mul_i32 s43, s38, 200000
    s_add_u32 s14, s43, 50000
    buffer_load_dwordx4 v[76:79], v3, s[12:15], s43 offen
    s_add_u32 s52, s43, 16384
    buffer_load_dwordx4 v[80:83], v3, s[12:15], s52 offen
    s_add_u32 s52, s43, 32768
    buffer_load_dwordx4 v[84:87], v3, s[12:15], s52 offen
    s_add_u32 s52, s43, 49152
    v_lshlrev_b32 v123, 2, v0
    buffer_load_dword v88, v123, s[12:15], s52 offen
    s_lshr_b32 s3, s2, 3
    s_mul_i32 s3, s3, 49
    v_add_lshl_u32 v89, v0, s3, 7
    v_cmp_gt_u32 vcc, 49, v0
    v_bfrev_b32 v28, 1
    s_add_u32 s54, s43, 100000
    v_cndmask_b32 v89, v28, v89, vcc

    buffer_load_dword v115, v89, s[8:11], s54 offen
    s_mov_b32 s19, 0x20000
    s_mov_b32 s28, 0x4b404000
    s_mov_b32 s29, 0x4b404000
    s_mov_b32 s30, 0xbfffc000
    s_mov_b32 s31, 0xbfffbfff
    s_mov_b32 s32, 0xffff0000
    s_mov_b32 s35, 0x05040100
    s_movk_i32 s3, 212
    v_cmp_gt_u32 s[48:49], s3, v0

    v_mov_b32 v1, 0
    s_mov_b32 s24, 0xc0c0004
    s_mov_b32 s25, 0xc0c0105
    s_mov_b32 s26, 0xc0c0206
    s_mov_b32 s27, 0xc0c0307
    s_waitcnt lgkmcnt(0)
    s_min_u32 s41, s41, 3968
    s_lshl_b32 s52, s38, 6
    s_add_u32 s52, s52, s36
    s_mul_i32 s52, s52, 19840
    s_add_u32 s16, s44, s52
    s_addc_u32 s17, s45, 0
    s_mul_i32 s52, s41, 5
    s_add_u32 s52, s52, 3
    s_and_b32 s18, s52, -4

    s_movk_i32 s53, 0
    buffer_load_dwordx4 v[4:7], v2, s[16:19], s53 offen
    buffer_load_dword v35, v2, s[16:19], s53 offen offset:16
    s_movk_i32 s53, 2560
    buffer_load_dwordx4 v[8:11], v2, s[16:19], s53 offen
    buffer_load_dword v43, v2, s[16:19], s53 offen offset:16
    s_movk_i32 s53, 5120
    buffer_load_dwordx4 v[90:93], v2, s[16:19], s53 offen
    buffer_load_dword v110, v2, s[16:19], s53 offen offset:16
    s_movk_i32 s53, 7680
    buffer_load_dwordx4 v[94:97], v2, s[16:19], s53 offen
    buffer_load_dword v111, v2, s[16:19], s53 offen offset:16
    s_movk_i32 s53, 10240
    buffer_load_dwordx4 v[98:101], v2, s[16:19], s53 offen
    buffer_load_dword v112, v2, s[16:19], s53 offen offset:16
    s_movk_i32 s53, 12800
    buffer_load_dwordx4 v[102:105], v2, s[16:19], s53 offen
    buffer_load_dword v113, v2, s[16:19], s53 offen offset:16
    s_movk_i32 s53, 15360
    buffer_load_dwordx4 v[106:109], v2, s[16:19], s53 offen
    buffer_load_dword v114, v2, s[16:19], s53 offen offset:16
    v_mov_b32 v28, 0x40004000
    v_mov_b32 v29, 0x40004000
    v_mov_b32 v30, 0x40004000
    v_mov_b32 v31, 0x40004000
    v_add_u32 v32, 50000, v3
    v_add_u32 v33, 65536, v32

    ds_write_b128 v32, v[28:31] offset:0
    ds_write_b128 v32, v[28:31] offset:16384
    ds_write_b128 v32, v[28:31] offset:32768
    ds_write_b128 v32, v[28:31] offset:49152
    ds_write_b128 v33, v[28:31] offset:0
    ds_write_b128 v33, v[28:31] offset:16384
    v_cmp_gt_u32 vcc, 106, v0
    s_mov_b64 exec, vcc
    ds_write_b128 v33, v[28:31] offset:32768
    s_mov_b64 exec, -1
    v_mov_b32 v34, 150000
    v_mov_b32 v36, 0
    v_mov_b32 v37, 0
    v_mov_b32 v38, 0
    v_mov_b32 v39, 0
    ds_write_b128 v34, v[36:39]

    s_waitcnt vmcnt(19)
    s_nop 1
    v_max_u32_dpp v116, v116, v116 row_shr:1 row_mask:0xf bank_mask:0xf
    s_nop 1
    v_max_u32_dpp v116, v116, v116 row_shr:2 row_mask:0xf bank_mask:0xf
    s_nop 1
    v_max_u32_dpp v116, v116, v116 row_shr:4 row_mask:0xf bank_mask:0xf
    s_nop 1
    v_max_u32_dpp v116, v116, v116 row_shr:8 row_mask:0xf bank_mask:0xf
    s_nop 1
    v_max_u32_dpp v116, v116, v116 row_bcast:15 row_mask:0xa bank_mask:0xf
    s_nop 1
    v_max_u32_dpp v116, v116, v116 row_bcast:31 row_mask:0xc bank_mask:0xf
    s_nop 1
    v_add_f32_dpp v117, v117, v117 row_shr:1 row_mask:0xf bank_mask:0xf
    s_nop 1
    v_add_f32_dpp v117, v117, v117 row_shr:2 row_mask:0xf bank_mask:0xf
    s_nop 1
    v_add_f32_dpp v117, v117, v117 row_shr:4 row_mask:0xf bank_mask:0xf
    s_nop 1
    v_add_f32_dpp v117, v117, v117 row_shr:8 row_mask:0xf bank_mask:0xf
    s_nop 1
    v_add_f32_dpp v117, v117, v117 row_bcast:15 row_mask:0xa bank_mask:0xf
    s_nop 1
    v_add_f32_dpp v117, v117, v117 row_bcast:31 row_mask:0xc bank_mask:0xf
    s_waitcnt lgkmcnt(0)
    s_barrier
    s_mov_b32 exec_lo, 0
    s_brev_b32 exec_hi, 1
    ds_max_u32 v34, v116
    ds_add_f32 v34, v117 offset:4
    s_mov_b64 exec, -1

    s_waitcnt vmcnt(18)
    ds_write_b128 v3, v[76:79] offset:0
    s_waitcnt vmcnt(17)
    ds_write_b128 v3, v[80:83] offset:16384
    s_waitcnt vmcnt(16)
    ds_write_b128 v3, v[84:87] offset:32768
    v_lshlrev_b32 v123, 2, v0
    s_waitcnt vmcnt(15)
    s_mov_b64 exec, s[48:49]
    ds_write_b32 v123, v88 offset:49152
    s_mov_b64 exec, -1

    s_add_u32 s43, s43, 50000
    s_add_u32 s14, s43, 50000
    buffer_load_dwordx4 v[76:79], v3, s[12:15], s43 offen
    s_add_u32 s52, s43, 16384
    buffer_load_dwordx4 v[80:83], v3, s[12:15], s52 offen
    s_add_u32 s52, s43, 32768
    buffer_load_dwordx4 v[84:87], v3, s[12:15], s52 offen
    s_add_u32 s52, s43, 49152
    v_lshlrev_b32 v123, 2, v0
    buffer_load_dword v88, v123, s[12:15], s52 offen
    s_waitcnt lgkmcnt(0)
    s_barrier
    ds_read_b64 v[28:29], v34
    s_waitcnt lgkmcnt(0)
    v_lshlrev_b32 v28, 16, v28
    v_mul_f32 v29, 0x34a7c5ac, v29
    v_sqrt_f32 v29, v29
    v_add_f32 v30, v28, v28
    v_mul_f32 v31, 0x41ac0000, v29
    v_mul_f32 v32, 0x42000000, v29
    v_max_f32 v30, v30, v31
    v_cmp_le_f32 vcc, v28, v32
    v_mov_b32 v33, 0x26901d7d
    v_cmp_lt_f32 s[64:65], v33, v29
    v_mov_b32 v33, 0x58635fa9
    s_and_b64 vcc, vcc, s[64:65]
    v_cmp_gt_f32 s[64:65], v33, v29
    v_rcp_f32 v30, v30
    s_and_b64 vcc, vcc, s[64:65]
    s_cbranch_scc0 L_p2slow_90
    s_cmp_lg_u32 s51, 0
    s_cbranch_scc1 L_p2slow_90
    v_mul_f32 v30, 0x3f000000, v30
    v_mul_f32 v31, 0x46ff8000, v30
    v_rcp_f32 v31, v31
    v_readfirstlane_b32 s33, v30
    s_nop 0
    v_readfirstlane_b32 s34, v31

L_batch_91:
    s_mov_b32 s40, s41
    s_sub_u32 s42, s40, s39
    s_mul_i32 s50, s38, 200000
    s_add_u32 s5, s38, 1
    s_min_u32 s52, s5, 31
    s_lshl_b32 s52, s52, 6
    s_add_u32 s52, s52, s36
    s_lshl_b32 s52, s52, 2
    s_load_dword s41, s[46:47], s52

    s_waitcnt vmcnt(12)
    v_perm_b32 v44, v91, v90, s24
    v_perm_b32 v46, v92, v91, s25
    v_perm_b32 v48, v93, v92, s26
    v_perm_b32 v50, v110, v93, s27
    v_mov_b32 v12, v90
    v_alignbyte_b32 v13, v92, v91, 1
    v_alignbyte_b32 v14, v93, v92, 2
    v_alignbyte_b32 v15, v110, v93, 3
    v_lshlrev_b32_sdwa v44, 3, v44 dst_sel:WORD_0 dst_unused:UNUSED_PAD src0_sel:DWORD src1_sel:DWORD
    v_lshlrev_b32_sdwa v46, 3, v46 dst_sel:WORD_0 dst_unused:UNUSED_PAD src0_sel:DWORD src1_sel:DWORD
    v_lshlrev_b32_sdwa v48, 3, v48 dst_sel:WORD_0 dst_unused:UNUSED_PAD src0_sel:DWORD src1_sel:DWORD
    v_lshlrev_b32_sdwa v50, 3, v50 dst_sel:WORD_0 dst_unused:UNUSED_PAD src0_sel:DWORD src1_sel:DWORD
    s_cmp_lt_i32 s42, 1280
    s_cbranch_scc1 L_ufix_92
L_uback_93:

    s_waitcnt vmcnt(10)
    v_perm_b32 v52, v95, v94, s24
    v_perm_b32 v54, v96, v95, s25
    v_perm_b32 v56, v97, v96, s26
    v_perm_b32 v58, v111, v97, s27
    v_mov_b32 v16, v94
    v_alignbyte_b32 v17, v96, v95, 1
    v_alignbyte_b32 v18, v97, v96, 2
    v_alignbyte_b32 v19, v111, v97, 3
    v_lshlrev_b32_sdwa v52, 3, v52 dst_sel:WORD_0 dst_unused:UNUSED_PAD src0_sel:DWORD src1_sel:DWORD
    v_lshlrev_b32_sdwa v54, 3, v54 dst_sel:WORD_0 dst_unused:UNUSED_PAD src0_sel:DWORD src1_sel:DWORD
    v_lshlrev_b32_sdwa v56, 3, v56 dst_sel:WORD_0 dst_unused:UNUSED_PAD src0_sel:DWORD src1_sel:DWORD
    v_lshlrev_b32_sdwa v58, 3, v58 dst_sel:WORD_0 dst_unused:UNUSED_PAD src0_sel:DWORD src1_sel:DWORD
    s_cmp_lt_i32 s42, 1792
    s_cbranch_scc1 L_ufix_94
L_uback_95:

    s_waitcnt vmcnt(8)
    v_perm_b32 v60, v99, v98, s24
    v_perm_b32 v62, v100, v99, s25
    v_perm_b32 v64, v101, v100, s26
    v_perm_b32 v66, v112, v101, s27
    v_mov_b32 v20, v98
    v_alignbyte_b32 v21, v100, v99, 1
    v_alignbyte_b32 v22, v101, v100, 2
    v_alignbyte_b32 v23, v112, v101, 3
    v_lshlrev_b32_sdwa v60, 3, v60 dst_sel:WORD_0 dst_unused:UNUSED_PAD src0_sel:DWORD src1_sel:DWORD
    v_lshlrev_b32_sdwa v62, 3, v62 dst_sel:WORD_0 dst_unused:UNUSED_PAD src0_sel:DWORD src1_sel:DWORD
    v_lshlrev_b32_sdwa v64, 3, v64 dst_sel:WORD_0 dst_unused:UNUSED_PAD src0_sel:DWORD src1_sel:DWORD
    v_lshlrev_b32_sdwa v66, 3, v66 dst_sel:WORD_0 dst_unused:UNUSED_PAD src0_sel:DWORD src1_sel:DWORD
    s_cmp_lt_i32 s42, 2304
    s_cbranch_scc1 L_ufix_96
L_uback_97:

    s_waitcnt vmcnt(6)
    v_perm_b32 v68, v103, v102, s24
    v_perm_b32 v70, v104, v103, s25
    v_perm_b32 v72, v105, v104, s26
    v_perm_b32 v74, v113, v105, s27
    v_mov_b32 v24, v102
    v_alignbyte_b32 v25, v104, v103, 1
    v_alignbyte_b32 v26, v105, v104, 2
    v_alignbyte_b32 v27, v113, v105, 3
    v_lshlrev_b32_sdwa v68, 3, v68 dst_sel:WORD_0 dst_unused:UNUSED_PAD src0_sel:DWORD src1_sel:DWORD
    v_lshlrev_b32_sdwa v70, 3, v70 dst_sel:WORD_0 dst_unused:UNUSED_PAD src0_sel:DWORD src1_sel:DWORD
    v_lshlrev_b32_sdwa v72, 3, v72 dst_sel:WORD_0 dst_unused:UNUSED_PAD src0_sel:DWORD src1_sel:DWORD
    v_lshlrev_b32_sdwa v74, 3, v74 dst_sel:WORD_0 dst_unused:UNUSED_PAD src0_sel:DWORD src1_sel:DWORD
    s_cmp_lt_i32 s42, 2816
    s_cbranch_scc1 L_ufix_98
L_uback_99:

    s_waitcnt vmcnt(4)
    v_perm_b32 v28, v5, v4, s24
    v_perm_b32 v30, v6, v5, s25
    v_perm_b32 v32, v7, v6, s26
    v_perm_b32 v34, v35, v7, s27
    v_alignbyte_b32 v5, v6, v5, 1
    v_alignbyte_b32 v6, v7, v6, 2
    v_alignbyte_b32 v7, v35, v7, 3
    v_lshlrev_b32_sdwa v28, 3, v28 dst_sel:WORD_0 dst_unused:UNUSED_PAD src0_sel:DWORD src1_sel:DWORD
    v_lshlrev_b32_sdwa v30, 3, v30 dst_sel:WORD_0 dst_unused:UNUSED_PAD src0_sel:DWORD src1_sel:DWORD
    v_lshlrev_b32_sdwa v32, 3, v32 dst_sel:WORD_0 dst_unused:UNUSED_PAD src0_sel:DWORD src1_sel:DWORD
    v_lshlrev_b32_sdwa v34, 3, v34 dst_sel:WORD_0 dst_unused:UNUSED_PAD src0_sel:DWORD src1_sel:DWORD
    s_cmp_lt_i32 s42, 256
    s_cbranch_scc1 L_ufix_100
L_uback_101:

    s_waitcnt vmcnt(2)
    v_perm_b32 v36, v9, v8, s24
    v_perm_b32 v38, v10, v9, s25
    v_perm_b32 v40, v11, v10, s26
    v_perm_b32 v42, v43, v11, s27
    v_alignbyte_b32 v9, v10, v9, 1
    v_alignbyte_b32 v10, v11, v10, 2
    v_alignbyte_b32 v11, v43, v11, 3
    v_lshlrev_b32_sdwa v36, 3, v36 dst_sel:WORD_0 dst_unused:UNUSED_PAD src0_sel:DWORD src1_sel:DWORD
    v_lshlrev_b32_sdwa v38, 3, v38 dst_sel:WORD_0 dst_unused:UNUSED_PAD src0_sel:DWORD src1_sel:DWORD
    v_lshlrev_b32_sdwa v40, 3, v40 dst_sel:WORD_0 dst_unused:UNUSED_PAD src0_sel:DWORD src1_sel:DWORD
    v_lshlrev_b32_sdwa v42, 3, v42 dst_sel:WORD_0 dst_unused:UNUSED_PAD src0_sel:DWORD src1_sel:DWORD
    s_cmp_lt_i32 s42, 768
    s_cbranch_scc1 L_ufix_102
L_uback_103:

    v_subrev_co_u32 v4, s[64:65], 2.0, v4
    v_subrev_co_u32 v5, s[66:67], 2.0, v5
    v_subrev_co_u32 v6, s[68:69], 2.0, v6
    v_subrev_co_u32 v7, s[70:71], 2.0, v7
    v_subrev_co_u32 v8, s[72:73], 2.0, v8
    v_subrev_co_u32 v9, s[74:75], 2.0, v9
    v_subrev_co_u32 v10, s[76:77], 2.0, v10
    v_subrev_co_u32 v11, s[78:79], 2.0, v11
    v_subrev_co_u32 v12, s[80:81], 2.0, v12
    v_subrev_co_u32 v13, s[82:83], 2.0, v13
    v_subrev_co_u32 v14, s[84:85], 2.0, v14
    v_subrev_co_u32 v15, s[86:87], 2.0, v15
    s_waitcnt lgkmcnt(0)
    s_barrier
    s_cmp_lt_u32 s5, s4
    s_cselect_b32 s41, s41, 0
    s_min_u32 s55, s5, 31
    s_min_u32 s41, s41, 3968
    s_lshl_b32 s52, s55, 6
    s_add_u32 s52, s52, s36
    s_mul_i32 s52, s52, 19840
    s_add_u32 s16, s44, s52
    s_addc_u32 s17, s45, 0
    s_mul_i32 s52, s41, 5
    s_add_u32 s52, s52, 3
    s_and_b32 s18, s52, -4

    s_mov_b64 exec, s[64:65]
    ds_read_b64 v[28:29], v28
    s_mov_b64 exec, s[66:67]
    ds_read_b64 v[30:31], v30
    s_mov_b64 exec, s[68:69]
    ds_read_b64 v[32:33], v32
    s_mov_b64 exec, s[70:71]
    ds_read_b64 v[34:35], v34
    s_mov_b64 exec, s[72:73]
    ds_read_b64 v[36:37], v36
    s_mov_b64 exec, s[74:75]
    ds_read_b64 v[38:39], v38
    s_mov_b64 exec, s[76:77]
    ds_read_b64 v[40:41], v40
    s_mov_b64 exec, s[78:79]
    ds_read_b64 v[42:43], v42
    s_mov_b64 exec, s[80:81]
    ds_read_b64 v[44:45], v44
    s_mov_b64 exec, s[82:83]
    ds_read_b64 v[46:47], v46
    s_mov_b64 exec, s[84:85]
    ds_read_b64 v[48:49], v48
    s_mov_b64 exec, s[86:87]
    ds_read_b64 v[50:51], v50
    s_mov_b64 exec, -1
    s_movk_i32 s53, 5120
    buffer_load_dwordx4 v[90:93], v2, s[16:19], s53 offen
    buffer_load_dword v110, v2, s[16:19], s53 offen offset:16
    v_subrev_co_u32 v16, s[64:65], 2.0, v16
    v_subrev_co_u32 v17, s[66:67], 2.0, v17
    v_subrev_co_u32 v18, s[68:69], 2.0, v18
    v_subrev_co_u32 v19, s[70:71], 2.0, v19
    v_subrev_co_u32 v20, s[72:73], 2.0, v20
    v_subrev_co_u32 v21, s[74:75], 2.0, v21
    v_subrev_co_u32 v22, s[76:77], 2.0, v22
    v_subrev_co_u32 v23, s[78:79], 2.0, v23
    v_subrev_co_u32 v24, s[80:81], 2.0, v24
    v_subrev_co_u32 v25, s[82:83], 2.0, v25
    v_subrev_co_u32 v26, s[84:85], 2.0, v26
    v_subrev_co_u32 v27, s[86:87], 2.0, v27
    s_mov_b64 exec, s[64:65]
    ds_read_b64 v[52:53], v52
    s_mov_b64 exec, s[66:67]
    ds_read_b64 v[54:55], v54
    s_mov_b64 exec, s[68:69]
    ds_read_b64 v[56:57], v56
    s_mov_b64 exec, s[70:71]
    ds_read_b64 v[58:59], v58
    s_mov_b64 exec, s[72:73]
    ds_read_b64 v[60:61], v60
    s_mov_b64 exec, s[74:75]
    ds_read_b64 v[62:63], v62
    s_mov_b64 exec, s[76:77]
    ds_read_b64 v[64:65], v64
    s_mov_b64 exec, s[78:79]
    ds_read_b64 v[66:67], v66
    s_mov_b64 exec, s[80:81]
    ds_read_b64 v[68:69], v68
    s_mov_b64 exec, s[82:83]
    ds_read_b64 v[70:71], v70
    s_mov_b64 exec, s[84:85]
    ds_read_b64 v[72:73], v72
    s_mov_b64 exec, s[86:87]
    ds_read_b64 v[74:75], v74
    s_mov_b64 exec, -1
    s_waitcnt lgkmcnt(0)
    s_barrier
    s_waitcnt vmcnt(5)
    ds_write_b128 v3, v[76:79] offset:0
    s_waitcnt vmcnt(4)
    ds_write_b128 v3, v[80:83] offset:16384
    s_waitcnt vmcnt(3)
    ds_write_b128 v3, v[84:87] offset:32768
    v_lshlrev_b32 v123, 2, v0
    s_waitcnt vmcnt(2)
    s_mov_b64 exec, s[48:49]
    ds_write_b32 v123, v88 offset:49152
    s_mov_b64 exec, -1

    s_add_u32 s43, s43, 50000
    s_add_u32 s14, s43, 50000
    buffer_load_dwordx4 v[76:79], v3, s[12:15], s43 offen
    s_add_u32 s52, s43, 16384
    buffer_load_dwordx4 v[80:83], v3, s[12:15], s52 offen
    v_subrev_co_u32 v4, s[64:65], 2.0, v4
    v_subrev_co_u32 v5, s[66:67], 2.0, v5
    v_subrev_co_u32 v6, s[68:69], 2.0, v6
    v_subrev_co_u32 v7, s[70:71], 2.0, v7
    v_subrev_co_u32 v8, s[72:73], 2.0, v8
    v_subrev_co_u32 v9, s[74:75], 2.0, v9
    v_subrev_co_u32 v10, s[76:77], 2.0, v10
    v_subrev_co_u32 v11, s[78:79], 2.0, v11
    v_subrev_co_u32 v12, s[80:81], 2.0, v12
    v_subrev_co_u32 v13, s[82:83], 2.0, v13
    v_subrev_co_u32 v14, s[84:85], 2.0, v14
    v_subrev_co_u32 v15, s[86:87], 2.0, v15
    s_waitcnt lgkmcnt(0)
    s_barrier
    s_add_u32 s52, s43, 32768
    buffer_load_dwordx4 v[84:87], v3, s[12:15], s52 offen
    s_add_u32 s52, s43, 49152
    v_lshlrev_b32 v123, 2, v0
    buffer_load_dword v88, v123, s[12:15], s52 offen
    s_mov_b64 exec, s[64:65]
    ds_read_b64 v[28:29], v28
    s_mov_b64 exec, s[66:67]
    ds_read_b64 v[30:31], v30
    s_mov_b64 exec, s[68:69]
    ds_read_b64 v[32:33], v32
    s_mov_b64 exec, s[70:71]
    ds_read_b64 v[34:35], v34
    s_mov_b64 exec, s[72:73]
    ds_read_b64 v[36:37], v36
    s_mov_b64 exec, s[74:75]
    ds_read_b64 v[38:39], v38
    s_mov_b64 exec, s[76:77]
    ds_read_b64 v[40:41], v40
    s_mov_b64 exec, s[78:79]
    ds_read_b64 v[42:43], v42
    s_mov_b64 exec, s[80:81]
    ds_read_b64 v[44:45], v44
    s_mov_b64 exec, s[82:83]
    ds_read_b64 v[46:47], v46
    s_mov_b64 exec, s[84:85]
    ds_read_b64 v[48:49], v48
    s_mov_b64 exec, s[86:87]
    ds_read_b64 v[50:51], v50
    s_mov_b64 exec, -1
    s_movk_i32 s53, 7680
    buffer_load_dwordx4 v[94:97], v2, s[16:19], s53 offen
    buffer_load_dword v111, v2, s[16:19], s53 offen offset:16
    v_subrev_co_u32 v16, s[64:65], 2.0, v16
    v_subrev_co_u32 v17, s[66:67], 2.0, v17
    v_subrev_co_u32 v18, s[68:69], 2.0, v18
    v_subrev_co_u32 v19, s[70:71], 2.0, v19
    v_subrev_co_u32 v20, s[72:73], 2.0, v20
    v_subrev_co_u32 v21, s[74:75], 2.0, v21
    v_subrev_co_u32 v22, s[76:77], 2.0, v22
    v_subrev_co_u32 v23, s[78:79], 2.0, v23
    v_subrev_co_u32 v24, s[80:81], 2.0, v24
    v_subrev_co_u32 v25, s[82:83], 2.0, v25
    v_subrev_co_u32 v26, s[84:85], 2.0, v26
    v_subrev_co_u32 v27, s[86:87], 2.0, v27
    s_mov_b64 exec, s[64:65]
    ds_read_b64 v[52:53], v52
    s_mov_b64 exec, s[66:67]
    ds_read_b64 v[54:55], v54
    s_mov_b64 exec, s[68:69]
    ds_read_b64 v[56:57], v56
    s_mov_b64 exec, s[70:71]
    ds_read_b64 v[58:59], v58
    s_mov_b64 exec, s[72:73]
    ds_read_b64 v[60:61], v60
    s_mov_b64 exec, s[74:75]
    ds_read_b64 v[62:63], v62
    s_mov_b64 exec, s[76:77]
    ds_read_b64 v[64:65], v64
    s_mov_b64 exec, s[78:79]
    ds_read_b64 v[66:67], v66
    s_mov_b64 exec, s[80:81]
    ds_read_b64 v[68:69], v68
    s_mov_b64 exec, s[82:83]
    ds_read_b64 v[70:71], v70
    s_mov_b64 exec, s[84:85]
    ds_read_b64 v[72:73], v72
    s_mov_b64 exec, s[86:87]
    ds_read_b64 v[74:75], v74
    s_mov_b64 exec, -1
    s_waitcnt lgkmcnt(0)
    s_barrier
    s_waitcnt vmcnt(5)
    ds_write_b128 v3, v[76:79] offset:0
    s_waitcnt vmcnt(4)
    ds_write_b128 v3, v[80:83] offset:16384
    s_waitcnt vmcnt(3)
    ds_write_b128 v3, v[84:87] offset:32768
    v_lshlrev_b32 v123, 2, v0
    s_waitcnt vmcnt(2)
    s_mov_b64 exec, s[48:49]
    ds_write_b32 v123, v88 offset:49152
    s_mov_b64 exec, -1

    s_add_u32 s43, s43, 50000
    s_add_u32 s14, s43, 50000
    buffer_load_dwordx4 v[76:79], v3, s[12:15], s43 offen
    s_add_u32 s52, s43, 16384
    buffer_load_dwordx4 v[80:83], v3, s[12:15], s52 offen
    v_subrev_co_u32 v4, s[64:65], 2.0, v4
    v_subrev_co_u32 v5, s[66:67], 2.0, v5
    v_subrev_co_u32 v6, s[68:69], 2.0, v6
    v_subrev_co_u32 v7, s[70:71], 2.0, v7
    v_subrev_co_u32 v8, s[72:73], 2.0, v8
    v_subrev_co_u32 v9, s[74:75], 2.0, v9
    v_subrev_co_u32 v10, s[76:77], 2.0, v10
    v_subrev_co_u32 v11, s[78:79], 2.0, v11
    v_subrev_co_u32 v12, s[80:81], 2.0, v12
    v_subrev_co_u32 v13, s[82:83], 2.0, v13
    v_subrev_co_u32 v14, s[84:85], 2.0, v14
    v_subrev_co_u32 v15, s[86:87], 2.0, v15
    s_waitcnt lgkmcnt(0)
    s_barrier
    s_add_u32 s52, s43, 32768
    buffer_load_dwordx4 v[84:87], v3, s[12:15], s52 offen
    s_add_u32 s52, s43, 49152
    v_lshlrev_b32 v123, 2, v0
    buffer_load_dword v88, v123, s[12:15], s52 offen
    s_mov_b64 exec, s[64:65]
    ds_read_b64 v[28:29], v28
    s_mov_b64 exec, s[66:67]
    ds_read_b64 v[30:31], v30
    s_mov_b64 exec, s[68:69]
    ds_read_b64 v[32:33], v32
    s_mov_b64 exec, s[70:71]
    ds_read_b64 v[34:35], v34
    s_mov_b64 exec, s[72:73]
    ds_read_b64 v[36:37], v36
    s_mov_b64 exec, s[74:75]
    ds_read_b64 v[38:39], v38
    s_mov_b64 exec, s[76:77]
    ds_read_b64 v[40:41], v40
    s_mov_b64 exec, s[78:79]
    ds_read_b64 v[42:43], v42
    s_mov_b64 exec, s[80:81]
    ds_read_b64 v[44:45], v44
    s_mov_b64 exec, s[82:83]
    ds_read_b64 v[46:47], v46
    s_mov_b64 exec, s[84:85]
    ds_read_b64 v[48:49], v48
    s_mov_b64 exec, s[86:87]
    ds_read_b64 v[50:51], v50
    s_mov_b64 exec, -1
    s_movk_i32 s53, 10240
    buffer_load_dwordx4 v[98:101], v2, s[16:19], s53 offen
    buffer_load_dword v112, v2, s[16:19], s53 offen offset:16
    v_subrev_co_u32 v16, s[64:65], 2.0, v16
    v_subrev_co_u32 v17, s[66:67], 2.0, v17
    v_subrev_co_u32 v18, s[68:69], 2.0, v18
    v_subrev_co_u32 v19, s[70:71], 2.0, v19
    v_subrev_co_u32 v20, s[72:73], 2.0, v20
    v_subrev_co_u32 v21, s[74:75], 2.0, v21
    v_subrev_co_u32 v22, s[76:77], 2.0, v22
    v_subrev_co_u32 v23, s[78:79], 2.0, v23
    v_subrev_co_u32 v24, s[80:81], 2.0, v24
    v_subrev_co_u32 v25, s[82:83], 2.0, v25
    v_subrev_co_u32 v26, s[84:85], 2.0, v26
    v_subrev_co_u32 v27, s[86:87], 2.0, v27
    s_mov_b64 exec, s[64:65]
    ds_read_b64 v[52:53], v52
    s_mov_b64 exec, s[66:67]
    ds_read_b64 v[54:55], v54
    s_mov_b64 exec, s[68:69]
    ds_read_b64 v[56:57], v56
    s_mov_b64 exec, s[70:71]
    ds_read_b64 v[58:59], v58
    s_mov_b64 exec, s[72:73]
    ds_read_b64 v[60:61], v60
    s_mov_b64 exec, s[74:75]
    ds_read_b64 v[62:63], v62
    s_mov_b64 exec, s[76:77]
    ds_read_b64 v[64:65], v64
    s_mov_b64 exec, s[78:79]
    ds_read_b64 v[66:67], v66
    s_mov_b64 exec, s[80:81]
    ds_read_b64 v[68:69], v68
    s_mov_b64 exec, s[82:83]
    ds_read_b64 v[70:71], v70
    s_mov_b64 exec, s[84:85]
    ds_read_b64 v[72:73], v72
    s_mov_b64 exec, s[86:87]
    ds_read_b64 v[74:75], v74
    s_mov_b64 exec, -1
    s_waitcnt lgkmcnt(0)
    s_barrier
    s_waitcnt vmcnt(5)
    ds_write_b128 v3, v[76:79] offset:0
    s_waitcnt vmcnt(4)
    ds_write_b128 v3, v[80:83] offset:16384
    s_waitcnt vmcnt(3)
    ds_write_b128 v3, v[84:87] offset:32768
    v_lshlrev_b32 v123, 2, v0
    s_waitcnt vmcnt(2)
    s_mov_b64 exec, s[48:49]
    ds_write_b32 v123, v88 offset:49152
    s_mov_b64 exec, -1

    s_add_u32 s43, s43, 50000
    s_add_u32 s14, s43, 50000
    s_cmp_lt_u32 s5, s4
    s_cselect_b32 s14, s14, 0
    buffer_load_dwordx4 v[76:79], v3, s[12:15], s43 offen
    s_add_u32 s52, s43, 16384
    buffer_load_dwordx4 v[80:83], v3, s[12:15], s52 offen
    v_cmp_gt_u32 s[64:65], 2.0, v4
    v_and_b32 v4, 0x3fffffff, v4
    v_cmp_gt_u32 s[66:67], 2.0, v5
    v_and_b32 v5, 0x3fffffff, v5
    v_cmp_gt_u32 s[68:69], 2.0, v6
    v_and_b32 v6, 0x3fffffff, v6
    v_cmp_gt_u32 s[70:71], 2.0, v7
    v_and_b32 v7, 0x3fffffff, v7
    v_cmp_gt_u32 s[72:73], 2.0, v8
    v_and_b32 v8, 0x3fffffff, v8
    v_cmp_gt_u32 s[74:75], 2.0, v9
    v_and_b32 v9, 0x3fffffff, v9
    v_cmp_gt_u32 s[76:77], 2.0, v10
    v_and_b32 v10, 0x3fffffff, v10
    v_cmp_gt_u32 s[78:79], 2.0, v11
    v_and_b32 v11, 0x3fffffff, v11
    v_cmp_gt_u32 s[80:81], 2.0, v12
    v_and_b32 v12, 0x3fffffff, v12
    v_cmp_gt_u32 s[82:83], 2.0, v13
    v_and_b32 v13, 0x3fffffff, v13
    v_cmp_gt_u32 s[84:85], 2.0, v14
    v_and_b32 v14, 0x3fffffff, v14
    v_cmp_gt_u32 s[86:87], 2.0, v15
    v_and_b32 v15, 0x3fffffff, v15
    s_waitcnt lgkmcnt(0)
    s_barrier
    s_add_u32 s52, s43, 32768
    buffer_load_dwordx4 v[84:87], v3, s[12:15], s52 offen
    s_add_u32 s52, s43, 49152
    v_lshlrev_b32 v123, 2, v0
    buffer_load_dword v88, v123, s[12:15], s52 offen
    s_mov_b64 exec, s[64:65]
    ds_read_b64 v[28:29], v28
    s_mov_b64 exec, s[66:67]
    ds_read_b64 v[30:31], v30
    s_mov_b64 exec, s[68:69]
    ds_read_b64 v[32:33], v32
    s_mov_b64 exec, s[70:71]
    ds_read_b64 v[34:35], v34
    s_mov_b64 exec, s[72:73]
    ds_read_b64 v[36:37], v36
    s_mov_b64 exec, s[74:75]
    ds_read_b64 v[38:39], v38
    s_mov_b64 exec, s[76:77]
    ds_read_b64 v[40:41], v40
    s_mov_b64 exec, s[78:79]
    ds_read_b64 v[42:43], v42
    s_mov_b64 exec, s[80:81]
    ds_read_b64 v[44:45], v44
    s_mov_b64 exec, s[82:83]
    ds_read_b64 v[46:47], v46
    s_mov_b64 exec, s[84:85]
    ds_read_b64 v[48:49], v48
    s_mov_b64 exec, s[86:87]
    ds_read_b64 v[50:51], v50
    s_mov_b64 exec, -1
    s_movk_i32 s53, 12800
    buffer_load_dwordx4 v[102:105], v2, s[16:19], s53 offen
    buffer_load_dword v113, v2, s[16:19], s53 offen offset:16
    v_cmp_gt_u32 s[64:65], 2.0, v16
    v_and_b32 v16, 0x3fffffff, v16
    v_cmp_gt_u32 s[66:67], 2.0, v17
    v_and_b32 v17, 0x3fffffff, v17
    v_cmp_gt_u32 s[68:69], 2.0, v18
    v_and_b32 v18, 0x3fffffff, v18
    v_cmp_gt_u32 s[70:71], 2.0, v19
    v_and_b32 v19, 0x3fffffff, v19
    v_cmp_gt_u32 s[72:73], 2.0, v20
    v_and_b32 v20, 0x3fffffff, v20
    v_cmp_gt_u32 s[74:75], 2.0, v21
    v_and_b32 v21, 0x3fffffff, v21
    v_cmp_gt_u32 s[76:77], 2.0, v22
    v_and_b32 v22, 0x3fffffff, v22
    v_cmp_gt_u32 s[78:79], 2.0, v23
    v_and_b32 v23, 0x3fffffff, v23
    v_cmp_gt_u32 s[80:81], 2.0, v24
    v_and_b32 v24, 0x3fffffff, v24
    v_cmp_gt_u32 s[82:83], 2.0, v25
    v_and_b32 v25, 0x3fffffff, v25
    v_cmp_gt_u32 s[84:85], 2.0, v26
    v_and_b32 v26, 0x3fffffff, v26
    v_cmp_gt_u32 s[86:87], 2.0, v27
    v_and_b32 v27, 0x3fffffff, v27
    s_mov_b64 exec, s[64:65]
    ds_read_b64 v[52:53], v52
    s_mov_b64 exec, s[66:67]
    ds_read_b64 v[54:55], v54
    s_mov_b64 exec, s[68:69]
    ds_read_b64 v[56:57], v56
    s_mov_b64 exec, s[70:71]
    ds_read_b64 v[58:59], v58
    s_mov_b64 exec, s[72:73]
    ds_read_b64 v[60:61], v60
    s_mov_b64 exec, s[74:75]
    ds_read_b64 v[62:63], v62
    s_mov_b64 exec, s[76:77]
    ds_read_b64 v[64:65], v64
    s_mov_b64 exec, s[78:79]
    ds_read_b64 v[66:67], v66
    s_mov_b64 exec, s[80:81]
    ds_read_b64 v[68:69], v68
    s_mov_b64 exec, s[82:83]
    ds_read_b64 v[70:71], v70
    s_mov_b64 exec, s[84:85]
    ds_read_b64 v[72:73], v72
    s_mov_b64 exec, s[86:87]
    ds_read_b64 v[74:75], v74
    s_mov_b64 exec, -1
    s_waitcnt lgkmcnt(0)
    s_barrier
    s_waitcnt vmcnt(5)
    ds_write_b128 v3, v[76:79] offset:0
    s_waitcnt vmcnt(4)
    ds_write_b128 v3, v[80:83] offset:16384
    s_waitcnt vmcnt(3)
    ds_write_b128 v3, v[84:87] offset:32768
    v_lshlrev_b32 v123, 2, v0
    s_waitcnt vmcnt(2)
    s_mov_b64 exec, s[48:49]
    ds_write_b32 v123, v88 offset:49152
    s_mov_b64 exec, -1

    s_add_u32 s43, s43, 50000
    s_add_u32 s14, s43, 50000
    s_cmp_lt_u32 s5, s4
    s_cselect_b32 s14, s14, 0
    buffer_load_dwordx4 v[76:79], v3, s[12:15], s43 offen
    s_add_u32 s52, s43, 16384
    buffer_load_dwordx4 v[80:83], v3, s[12:15], s52 offen
    s_add_u32 s52, s43, 32768
    buffer_load_dwordx4 v[84:87], v3, s[12:15], s52 offen
    s_add_u32 s52, s43, 49152
    v_lshlrev_b32 v123, 2, v0
    buffer_load_dword v88, v123, s[12:15], s52 offen
    s_add_u32 s54, s43, 50000
    buffer_load_dword v115, v89, s[8:11], s54 offen
    v_cvt_f32_i32_sdwa v118, sext(v4) dst_sel:DWORD dst_unused:UNUSED_PAD src0_sel:WORD_0
    v_lshlrev_b32 v116, 16, v28
    v_and_b32 v117, s32, v28
    v_mul_f32 v118, s33, v118
    v_lshlrev_b32 v28, 16, v29
    v_and_b32 v29, s32, v29
    v_lshlrev_b32_sdwa v4, 3, v4 dst_sel:DWORD dst_unused:UNUSED_PAD src0_sel:DWORD src1_sel:WORD_1
    v_pk_fma_f32 v[116:117], v[116:117], v[118:119], s[28:29] op_sel_hi:[1,0,1]
    v_pk_fma_f32 v[28:29], v[28:29], v[118:119], s[28:29] op_sel_hi:[1,0,1]
    v_perm_b32 v116, v117, v116, s35
    v_perm_b32 v117, v29, v28, s35
    v_lshl_add_u64 v[116:117], v[116:117], 0, s[30:31]
    ds_add_rtn_u64 v[28:29], v4, v[116:117] offset:50000

    v_cvt_f32_i32_sdwa v122, sext(v5) dst_sel:DWORD dst_unused:UNUSED_PAD src0_sel:WORD_0
    v_lshlrev_b32 v120, 16, v30
    v_and_b32 v121, s32, v30
    v_mul_f32 v122, s33, v122
    v_lshlrev_b32 v30, 16, v31
    v_and_b32 v31, s32, v31
    v_lshlrev_b32_sdwa v5, 3, v5 dst_sel:DWORD dst_unused:UNUSED_PAD src0_sel:DWORD src1_sel:WORD_1
    v_pk_fma_f32 v[120:121], v[120:121], v[122:123], s[28:29] op_sel_hi:[1,0,1]
    v_pk_fma_f32 v[30:31], v[30:31], v[122:123], s[28:29] op_sel_hi:[1,0,1]
    v_perm_b32 v120, v121, v120, s35
    v_perm_b32 v121, v31, v30, s35
    v_lshl_add_u64 v[120:121], v[120:121], 0, s[30:31]
    ds_add_rtn_u64 v[30:31], v5, v[120:121] offset:50000

    v_cvt_f32_i32_sdwa v118, sext(v6) dst_sel:DWORD dst_unused:UNUSED_PAD src0_sel:WORD_0
    v_lshlrev_b32 v116, 16, v32
    v_and_b32 v117, s32, v32
    v_mul_f32 v118, s33, v118
    v_lshlrev_b32 v32, 16, v33
    v_and_b32 v33, s32, v33
    v_lshlrev_b32_sdwa v6, 3, v6 dst_sel:DWORD dst_unused:UNUSED_PAD src0_sel:DWORD src1_sel:WORD_1
    v_pk_fma_f32 v[116:117], v[116:117], v[118:119], s[28:29] op_sel_hi:[1,0,1]
    v_pk_fma_f32 v[32:33], v[32:33], v[118:119], s[28:29] op_sel_hi:[1,0,1]
    v_perm_b32 v116, v117, v116, s35
    v_perm_b32 v117, v33, v32, s35
    v_lshl_add_u64 v[116:117], v[116:117], 0, s[30:31]
    ds_add_rtn_u64 v[32:33], v6, v[116:117] offset:50000

    v_cvt_f32_i32_sdwa v122, sext(v7) dst_sel:DWORD dst_unused:UNUSED_PAD src0_sel:WORD_0
    v_lshlrev_b32 v120, 16, v34
    v_and_b32 v121, s32, v34
    v_mul_f32 v122, s33, v122
    v_lshlrev_b32 v34, 16, v35
    v_and_b32 v35, s32, v35
    v_lshlrev_b32_sdwa v7, 3, v7 dst_sel:DWORD dst_unused:UNUSED_PAD src0_sel:DWORD src1_sel:WORD_1
    v_pk_fma_f32 v[120:121], v[120:121], v[122:123], s[28:29] op_sel_hi:[1,0,1]
    v_pk_fma_f32 v[34:35], v[34:35], v[122:123], s[28:29] op_sel_hi:[1,0,1]
    v_perm_b32 v120, v121, v120, s35
    v_perm_b32 v121, v35, v34, s35
    v_lshl_add_u64 v[120:121], v[120:121], 0, s[30:31]
    ds_add_rtn_u64 v[34:35], v7, v[120:121] offset:50000

    v_cvt_f32_i32_sdwa v118, sext(v8) dst_sel:DWORD dst_unused:UNUSED_PAD src0_sel:WORD_0
    v_lshlrev_b32 v116, 16, v36
    v_and_b32 v117, s32, v36
    v_mul_f32 v118, s33, v118
    v_lshlrev_b32 v36, 16, v37
    v_and_b32 v37, s32, v37
    v_lshlrev_b32_sdwa v8, 3, v8 dst_sel:DWORD dst_unused:UNUSED_PAD src0_sel:DWORD src1_sel:WORD_1
    v_pk_fma_f32 v[116:117], v[116:117], v[118:119], s[28:29] op_sel_hi:[1,0,1]
    v_pk_fma_f32 v[36:37], v[36:37], v[118:119], s[28:29] op_sel_hi:[1,0,1]
    v_perm_b32 v116, v117, v116, s35
    v_perm_b32 v117, v37, v36, s35
    v_lshl_add_u64 v[116:117], v[116:117], 0, s[30:31]
    ds_add_rtn_u64 v[36:37], v8, v[116:117] offset:50000

    v_cvt_f32_i32_sdwa v122, sext(v9) dst_sel:DWORD dst_unused:UNUSED_PAD src0_sel:WORD_0
    v_lshlrev_b32 v120, 16, v38
    v_and_b32 v121, s32, v38
    v_mul_f32 v122, s33, v122
    v_lshlrev_b32 v38, 16, v39
    v_and_b32 v39, s32, v39
    v_lshlrev_b32_sdwa v9, 3, v9 dst_sel:DWORD dst_unused:UNUSED_PAD src0_sel:DWORD src1_sel:WORD_1
    v_pk_fma_f32 v[120:121], v[120:121], v[122:123], s[28:29] op_sel_hi:[1,0,1]
    v_pk_fma_f32 v[38:39], v[38:39], v[122:123], s[28:29] op_sel_hi:[1,0,1]
    v_perm_b32 v120, v121, v120, s35
    v_perm_b32 v121, v39, v38, s35
    v_lshl_add_u64 v[120:121], v[120:121], 0, s[30:31]
    ds_add_rtn_u64 v[38:39], v9, v[120:121] offset:50000

    v_cvt_f32_i32_sdwa v118, sext(v10) dst_sel:DWORD dst_unused:UNUSED_PAD src0_sel:WORD_0
    v_lshlrev_b32 v116, 16, v40
    v_and_b32 v117, s32, v40
    v_mul_f32 v118, s33, v118
    v_lshlrev_b32 v40, 16, v41
    v_and_b32 v41, s32, v41
    v_lshlrev_b32_sdwa v10, 3, v10 dst_sel:DWORD dst_unused:UNUSED_PAD src0_sel:DWORD src1_sel:WORD_1
    v_pk_fma_f32 v[116:117], v[116:117], v[118:119], s[28:29] op_sel_hi:[1,0,1]
    v_pk_fma_f32 v[40:41], v[40:41], v[118:119], s[28:29] op_sel_hi:[1,0,1]
    v_perm_b32 v116, v117, v116, s35
    v_perm_b32 v117, v41, v40, s35
    v_lshl_add_u64 v[116:117], v[116:117], 0, s[30:31]
    ds_add_rtn_u64 v[40:41], v10, v[116:117] offset:50000

    v_cvt_f32_i32_sdwa v122, sext(v11) dst_sel:DWORD dst_unused:UNUSED_PAD src0_sel:WORD_0
    v_lshlrev_b32 v120, 16, v42
    v_and_b32 v121, s32, v42
    v_mul_f32 v122, s33, v122
    v_lshlrev_b32 v42, 16, v43
    v_and_b32 v43, s32, v43
    v_lshlrev_b32_sdwa v11, 3, v11 dst_sel:DWORD dst_unused:UNUSED_PAD src0_sel:DWORD src1_sel:WORD_1
    v_pk_fma_f32 v[120:121], v[120:121], v[122:123], s[28:29] op_sel_hi:[1,0,1]
    v_pk_fma_f32 v[42:43], v[42:43], v[122:123], s[28:29] op_sel_hi:[1,0,1]
    v_perm_b32 v120, v121, v120, s35
    v_perm_b32 v121, v43, v42, s35
    v_lshl_add_u64 v[120:121], v[120:121], 0, s[30:31]
    ds_add_rtn_u64 v[42:43], v11, v[120:121] offset:50000

    s_waitcnt lgkmcnt(4)
    v_or3_b32 v1, v28, v29, v1
    v_or3_b32 v1, v30, v31, v1
    v_or3_b32 v1, v32, v33, v1
    v_or3_b32 v1, v34, v35, v1
    s_movk_i32 s53, 0
    buffer_load_dwordx4 v[4:7], v2, s[16:19], s53 offen
    buffer_load_dword v35, v2, s[16:19], s53 offen offset:16
    v_cvt_f32_i32_sdwa v118, sext(v12) dst_sel:DWORD dst_unused:UNUSED_PAD src0_sel:WORD_0
    v_lshlrev_b32 v116, 16, v44
    v_and_b32 v117, s32, v44
    v_mul_f32 v118, s33, v118
    v_lshlrev_b32 v44, 16, v45
    v_and_b32 v45, s32, v45
    v_lshlrev_b32_sdwa v12, 3, v12 dst_sel:DWORD dst_unused:UNUSED_PAD src0_sel:DWORD src1_sel:WORD_1
    v_pk_fma_f32 v[116:117], v[116:117], v[118:119], s[28:29] op_sel_hi:[1,0,1]
    v_pk_fma_f32 v[44:45], v[44:45], v[118:119], s[28:29] op_sel_hi:[1,0,1]
    v_perm_b32 v116, v117, v116, s35
    v_perm_b32 v117, v45, v44, s35
    v_lshl_add_u64 v[116:117], v[116:117], 0, s[30:31]
    ds_add_rtn_u64 v[44:45], v12, v[116:117] offset:50000

    v_cvt_f32_i32_sdwa v122, sext(v13) dst_sel:DWORD dst_unused:UNUSED_PAD src0_sel:WORD_0
    v_lshlrev_b32 v120, 16, v46
    v_and_b32 v121, s32, v46
    v_mul_f32 v122, s33, v122
    v_lshlrev_b32 v46, 16, v47
    v_and_b32 v47, s32, v47
    v_lshlrev_b32_sdwa v13, 3, v13 dst_sel:DWORD dst_unused:UNUSED_PAD src0_sel:DWORD src1_sel:WORD_1
    v_pk_fma_f32 v[120:121], v[120:121], v[122:123], s[28:29] op_sel_hi:[1,0,1]
    v_pk_fma_f32 v[46:47], v[46:47], v[122:123], s[28:29] op_sel_hi:[1,0,1]
    v_perm_b32 v120, v121, v120, s35
    v_perm_b32 v121, v47, v46, s35
    v_lshl_add_u64 v[120:121], v[120:121], 0, s[30:31]
    ds_add_rtn_u64 v[46:47], v13, v[120:121] offset:50000

    v_cvt_f32_i32_sdwa v118, sext(v14) dst_sel:DWORD dst_unused:UNUSED_PAD src0_sel:WORD_0
    v_lshlrev_b32 v116, 16, v48
    v_and_b32 v117, s32, v48
    v_mul_f32 v118, s33, v118
    v_lshlrev_b32 v48, 16, v49
    v_and_b32 v49, s32, v49
    v_lshlrev_b32_sdwa v14, 3, v14 dst_sel:DWORD dst_unused:UNUSED_PAD src0_sel:DWORD src1_sel:WORD_1
    v_pk_fma_f32 v[116:117], v[116:117], v[118:119], s[28:29] op_sel_hi:[1,0,1]
    v_pk_fma_f32 v[48:49], v[48:49], v[118:119], s[28:29] op_sel_hi:[1,0,1]
    v_perm_b32 v116, v117, v116, s35
    v_perm_b32 v117, v49, v48, s35
    v_lshl_add_u64 v[116:117], v[116:117], 0, s[30:31]
    ds_add_rtn_u64 v[48:49], v14, v[116:117] offset:50000

    v_cvt_f32_i32_sdwa v122, sext(v15) dst_sel:DWORD dst_unused:UNUSED_PAD src0_sel:WORD_0
    v_lshlrev_b32 v120, 16, v50
    v_and_b32 v121, s32, v50
    v_mul_f32 v122, s33, v122
    v_lshlrev_b32 v50, 16, v51
    v_and_b32 v51, s32, v51
    v_lshlrev_b32_sdwa v15, 3, v15 dst_sel:DWORD dst_unused:UNUSED_PAD src0_sel:DWORD src1_sel:WORD_1
    v_pk_fma_f32 v[120:121], v[120:121], v[122:123], s[28:29] op_sel_hi:[1,0,1]
    v_pk_fma_f32 v[50:51], v[50:51], v[122:123], s[28:29] op_sel_hi:[1,0,1]
    v_perm_b32 v120, v121, v120, s35
    v_perm_b32 v121, v51, v50, s35
    v_lshl_add_u64 v[120:121], v[120:121], 0, s[30:31]
    ds_add_rtn_u64 v[50:51], v15, v[120:121] offset:50000

    s_waitcnt lgkmcnt(4)
    v_or3_b32 v1, v36, v37, v1
    v_or3_b32 v1, v38, v39, v1
    v_or3_b32 v1, v40, v41, v1
    v_or3_b32 v1, v42, v43, v1
    s_movk_i32 s53, 2560
    buffer_load_dwordx4 v[8:11], v2, s[16:19], s53 offen
    buffer_load_dword v43, v2, s[16:19], s53 offen offset:16
    v_cvt_f32_i32_sdwa v118, sext(v16) dst_sel:DWORD dst_unused:UNUSED_PAD src0_sel:WORD_0
    v_lshlrev_b32 v116, 16, v52
    v_and_b32 v117, s32, v52
    v_mul_f32 v118, s33, v118
    v_lshlrev_b32 v52, 16, v53
    v_and_b32 v53, s32, v53
    v_lshlrev_b32_sdwa v16, 3, v16 dst_sel:DWORD dst_unused:UNUSED_PAD src0_sel:DWORD src1_sel:WORD_1
    v_pk_fma_f32 v[116:117], v[116:117], v[118:119], s[28:29] op_sel_hi:[1,0,1]
    v_pk_fma_f32 v[52:53], v[52:53], v[118:119], s[28:29] op_sel_hi:[1,0,1]
    v_perm_b32 v116, v117, v116, s35
    v_perm_b32 v117, v53, v52, s35
    v_lshl_add_u64 v[116:117], v[116:117], 0, s[30:31]
    ds_add_rtn_u64 v[52:53], v16, v[116:117] offset:50000

    v_cvt_f32_i32_sdwa v122, sext(v17) dst_sel:DWORD dst_unused:UNUSED_PAD src0_sel:WORD_0
    v_lshlrev_b32 v120, 16, v54
    v_and_b32 v121, s32, v54
    v_mul_f32 v122, s33, v122
    v_lshlrev_b32 v54, 16, v55
    v_and_b32 v55, s32, v55
    v_lshlrev_b32_sdwa v17, 3, v17 dst_sel:DWORD dst_unused:UNUSED_PAD src0_sel:DWORD src1_sel:WORD_1
    v_pk_fma_f32 v[120:121], v[120:121], v[122:123], s[28:29] op_sel_hi:[1,0,1]
    v_pk_fma_f32 v[54:55], v[54:55], v[122:123], s[28:29] op_sel_hi:[1,0,1]
    v_perm_b32 v120, v121, v120, s35
    v_perm_b32 v121, v55, v54, s35
    v_lshl_add_u64 v[120:121], v[120:121], 0, s[30:31]
    ds_add_rtn_u64 v[54:55], v17, v[120:121] offset:50000

    v_cvt_f32_i32_sdwa v118, sext(v18) dst_sel:DWORD dst_unused:UNUSED_PAD src0_sel:WORD_0
    v_lshlrev_b32 v116, 16, v56
    v_and_b32 v117, s32, v56
    v_mul_f32 v118, s33, v118
    v_lshlrev_b32 v56, 16, v57
    v_and_b32 v57, s32, v57
    v_lshlrev_b32_sdwa v18, 3, v18 dst_sel:DWORD dst_unused:UNUSED_PAD src0_sel:DWORD src1_sel:WORD_1
    v_pk_fma_f32 v[116:117], v[116:117], v[118:119], s[28:29] op_sel_hi:[1,0,1]
    v_pk_fma_f32 v[56:57], v[56:57], v[118:119], s[28:29] op_sel_hi:[1,0,1]
    v_perm_b32 v116, v117, v116, s35
    v_perm_b32 v117, v57, v56, s35
    v_lshl_add_u64 v[116:117], v[116:117], 0, s[30:31]
    ds_add_rtn_u64 v[56:57], v18, v[116:117] offset:50000

    v_cvt_f32_i32_sdwa v122, sext(v19) dst_sel:DWORD dst_unused:UNUSED_PAD src0_sel:WORD_0
    v_lshlrev_b32 v120, 16, v58
    v_and_b32 v121, s32, v58
    v_mul_f32 v122, s33, v122
    v_lshlrev_b32 v58, 16, v59
    v_and_b32 v59, s32, v59
    v_lshlrev_b32_sdwa v19, 3, v19 dst_sel:DWORD dst_unused:UNUSED_PAD src0_sel:DWORD src1_sel:WORD_1
    v_pk_fma_f32 v[120:121], v[120:121], v[122:123], s[28:29] op_sel_hi:[1,0,1]
    v_pk_fma_f32 v[58:59], v[58:59], v[122:123], s[28:29] op_sel_hi:[1,0,1]
    v_perm_b32 v120, v121, v120, s35
    v_perm_b32 v121, v59, v58, s35
    v_lshl_add_u64 v[120:121], v[120:121], 0, s[30:31]
    ds_add_rtn_u64 v[58:59], v19, v[120:121] offset:50000

    s_waitcnt lgkmcnt(4)
    v_or3_b32 v1, v44, v45, v1
    v_or3_b32 v1, v46, v47, v1
    v_or3_b32 v1, v48, v49, v1
    v_or3_b32 v1, v50, v51, v1
    s_cmp_le_i32 s42, 3072
    s_cbranch_scc1 L_nt1_104
    s_waitcnt vmcnt(29)
    v_perm_b32 v116, v107, v106, s24
    v_perm_b32 v118, v108, v107, s25
    v_perm_b32 v120, v109, v108, s26
    v_perm_b32 v122, v114, v109, s27
    v_alignbyte_b32 v107, v108, v107, 1
    v_alignbyte_b32 v108, v109, v108, 2
    v_alignbyte_b32 v109, v114, v109, 3
    v_lshlrev_b32_sdwa v116, 3, v116 dst_sel:WORD_0 dst_unused:UNUSED_PAD src0_sel:DWORD src1_sel:DWORD
    v_lshlrev_b32_sdwa v118, 3, v118 dst_sel:WORD_0 dst_unused:UNUSED_PAD src0_sel:DWORD src1_sel:DWORD
    v_lshlrev_b32_sdwa v120, 3, v120 dst_sel:WORD_0 dst_unused:UNUSED_PAD src0_sel:DWORD src1_sel:DWORD
    v_lshlrev_b32_sdwa v122, 3, v122 dst_sel:WORD_0 dst_unused:UNUSED_PAD src0_sel:DWORD src1_sel:DWORD
    s_cmp_lt_i32 s42, 3328
    s_cbranch_scc1 L_ufix_106
L_uback_107:

    v_lshrrev_b32 v117, 30, v106
    v_cmp_ne_u32 vcc, 0, v106
    v_mul_u32_u24 v117, 50000, v117
    v_and_b32 v106, 0x3fffffff, v106
    v_add_u32 v116, v116, v117
    s_mov_b64 s[64:65], vcc
    s_mov_b64 exec, vcc

    buffer_load_dwordx2 v[44:45], v116, s[8:11], s50 offen
    s_mov_b64 exec, -1
    v_lshrrev_b32 v117, 30, v107
    v_cmp_ne_u32 vcc, 0, v107
    v_mul_u32_u24 v117, 50000, v117
    v_and_b32 v107, 0x3fffffff, v107
    v_add_u32 v118, v118, v117
    s_mov_b64 s[66:67], vcc
    s_mov_b64 exec, vcc

    buffer_load_dwordx2 v[46:47], v118, s[8:11], s50 offen
    s_mov_b64 exec, -1
    v_lshrrev_b32 v117, 30, v108
    v_cmp_ne_u32 vcc, 0, v108
    v_mul_u32_u24 v117, 50000, v117
    v_and_b32 v108, 0x3fffffff, v108
    v_add_u32 v120, v120, v117
    s_mov_b64 s[68:69], vcc
    s_mov_b64 exec, vcc

    buffer_load_dwordx2 v[48:49], v120, s[8:11], s50 offen
    s_mov_b64 exec, -1
    v_lshrrev_b32 v117, 30, v109
    v_cmp_ne_u32 vcc, 0, v109
    v_mul_u32_u24 v117, 50000, v117
    v_and_b32 v109, 0x3fffffff, v109
    v_add_u32 v122, v122, v117
    s_mov_b64 s[70:71], vcc
    s_mov_b64 exec, vcc

    buffer_load_dwordx2 v[50:51], v122, s[8:11], s50 offen
    s_mov_b64 exec, -1
L_nt1_104:
    v_cvt_f32_i32_sdwa v118, sext(v20) dst_sel:DWORD dst_unused:UNUSED_PAD src0_sel:WORD_0
    v_lshlrev_b32 v116, 16, v60
    v_and_b32 v117, s32, v60
    v_mul_f32 v118, s33, v118
    v_lshlrev_b32 v60, 16, v61
    v_and_b32 v61, s32, v61
    v_lshlrev_b32_sdwa v20, 3, v20 dst_sel:DWORD dst_unused:UNUSED_PAD src0_sel:DWORD src1_sel:WORD_1
    v_pk_fma_f32 v[116:117], v[116:117], v[118:119], s[28:29] op_sel_hi:[1,0,1]
    v_pk_fma_f32 v[60:61], v[60:61], v[118:119], s[28:29] op_sel_hi:[1,0,1]
    v_perm_b32 v116, v117, v116, s35
    v_perm_b32 v117, v61, v60, s35
    v_lshl_add_u64 v[116:117], v[116:117], 0, s[30:31]
    ds_add_rtn_u64 v[60:61], v20, v[116:117] offset:50000

    v_cvt_f32_i32_sdwa v122, sext(v21) dst_sel:DWORD dst_unused:UNUSED_PAD src0_sel:WORD_0
    v_lshlrev_b32 v120, 16, v62
    v_and_b32 v121, s32, v62
    v_mul_f32 v122, s33, v122
    v_lshlrev_b32 v62, 16, v63
    v_and_b32 v63, s32, v63
    v_lshlrev_b32_sdwa v21, 3, v21 dst_sel:DWORD dst_unused:UNUSED_PAD src0_sel:DWORD src1_sel:WORD_1
    v_pk_fma_f32 v[120:121], v[120:121], v[122:123], s[28:29] op_sel_hi:[1,0,1]
    v_pk_fma_f32 v[62:63], v[62:63], v[122:123], s[28:29] op_sel_hi:[1,0,1]
    v_perm_b32 v120, v121, v120, s35
    v_perm_b32 v121, v63, v62, s35
    v_lshl_add_u64 v[120:121], v[120:121], 0, s[30:31]
    ds_add_rtn_u64 v[62:63], v21, v[120:121] offset:50000

    v_cvt_f32_i32_sdwa v118, sext(v22) dst_sel:DWORD dst_unused:UNUSED_PAD src0_sel:WORD_0
    v_lshlrev_b32 v116, 16, v64
    v_and_b32 v117, s32, v64
    v_mul_f32 v118, s33, v118
    v_lshlrev_b32 v64, 16, v65
    v_and_b32 v65, s32, v65
    v_lshlrev_b32_sdwa v22, 3, v22 dst_sel:DWORD dst_unused:UNUSED_PAD src0_sel:DWORD src1_sel:WORD_1
    v_pk_fma_f32 v[116:117], v[116:117], v[118:119], s[28:29] op_sel_hi:[1,0,1]
    v_pk_fma_f32 v[64:65], v[64:65], v[118:119], s[28:29] op_sel_hi:[1,0,1]
    v_perm_b32 v116, v117, v116, s35
    v_perm_b32 v117, v65, v64, s35
    v_lshl_add_u64 v[116:117], v[116:117], 0, s[30:31]
    ds_add_rtn_u64 v[64:65], v22, v[116:117] offset:50000

    v_cvt_f32_i32_sdwa v122, sext(v23) dst_sel:DWORD dst_unused:UNUSED_PAD src0_sel:WORD_0
    v_lshlrev_b32 v120, 16, v66
    v_and_b32 v121, s32, v66
    v_mul_f32 v122, s33, v122
    v_lshlrev_b32 v66, 16, v67
    v_and_b32 v67, s32, v67
    v_lshlrev_b32_sdwa v23, 3, v23 dst_sel:DWORD dst_unused:UNUSED_PAD src0_sel:DWORD src1_sel:WORD_1
    v_pk_fma_f32 v[120:121], v[120:121], v[122:123], s[28:29] op_sel_hi:[1,0,1]
    v_pk_fma_f32 v[66:67], v[66:67], v[122:123], s[28:29] op_sel_hi:[1,0,1]
    v_perm_b32 v120, v121, v120, s35
    v_perm_b32 v121, v67, v66, s35
    v_lshl_add_u64 v[120:121], v[120:121], 0, s[30:31]
    ds_add_rtn_u64 v[66:67], v23, v[120:121] offset:50000

    s_waitcnt lgkmcnt(4)
    v_or3_b32 v1, v52, v53, v1
    v_or3_b32 v1, v54, v55, v1
    v_or3_b32 v1, v56, v57, v1
    v_or3_b32 v1, v58, v59, v1
    v_cvt_f32_i32_sdwa v118, sext(v24) dst_sel:DWORD dst_unused:UNUSED_PAD src0_sel:WORD_0
    v_lshlrev_b32 v116, 16, v68
    v_and_b32 v117, s32, v68
    v_mul_f32 v118, s33, v118
    v_lshlrev_b32 v68, 16, v69
    v_and_b32 v69, s32, v69
    v_lshlrev_b32_sdwa v24, 3, v24 dst_sel:DWORD dst_unused:UNUSED_PAD src0_sel:DWORD src1_sel:WORD_1
    v_pk_fma_f32 v[116:117], v[116:117], v[118:119], s[28:29] op_sel_hi:[1,0,1]
    v_pk_fma_f32 v[68:69], v[68:69], v[118:119], s[28:29] op_sel_hi:[1,0,1]
    v_perm_b32 v116, v117, v116, s35
    v_perm_b32 v117, v69, v68, s35
    v_lshl_add_u64 v[116:117], v[116:117], 0, s[30:31]
    ds_add_rtn_u64 v[68:69], v24, v[116:117] offset:50000

    v_cvt_f32_i32_sdwa v122, sext(v25) dst_sel:DWORD dst_unused:UNUSED_PAD src0_sel:WORD_0
    v_lshlrev_b32 v120, 16, v70
    v_and_b32 v121, s32, v70
    v_mul_f32 v122, s33, v122
    v_lshlrev_b32 v70, 16, v71
    v_and_b32 v71, s32, v71
    v_lshlrev_b32_sdwa v25, 3, v25 dst_sel:DWORD dst_unused:UNUSED_PAD src0_sel:DWORD src1_sel:WORD_1
    v_pk_fma_f32 v[120:121], v[120:121], v[122:123], s[28:29] op_sel_hi:[1,0,1]
    v_pk_fma_f32 v[70:71], v[70:71], v[122:123], s[28:29] op_sel_hi:[1,0,1]
    v_perm_b32 v120, v121, v120, s35
    v_perm_b32 v121, v71, v70, s35
    v_lshl_add_u64 v[120:121], v[120:121], 0, s[30:31]
    ds_add_rtn_u64 v[70:71], v25, v[120:121] offset:50000

    v_cvt_f32_i32_sdwa v118, sext(v26) dst_sel:DWORD dst_unused:UNUSED_PAD src0_sel:WORD_0
    v_lshlrev_b32 v116, 16, v72
    v_and_b32 v117, s32, v72
    v_mul_f32 v118, s33, v118
    v_lshlrev_b32 v72, 16, v73
    v_and_b32 v73, s32, v73
    v_lshlrev_b32_sdwa v26, 3, v26 dst_sel:DWORD dst_unused:UNUSED_PAD src0_sel:DWORD src1_sel:WORD_1
    v_pk_fma_f32 v[116:117], v[116:117], v[118:119], s[28:29] op_sel_hi:[1,0,1]
    v_pk_fma_f32 v[72:73], v[72:73], v[118:119], s[28:29] op_sel_hi:[1,0,1]
    v_perm_b32 v116, v117, v116, s35
    v_perm_b32 v117, v73, v72, s35
    v_lshl_add_u64 v[116:117], v[116:117], 0, s[30:31]
    ds_add_rtn_u64 v[72:73], v26, v[116:117] offset:50000

    v_cvt_f32_i32_sdwa v122, sext(v27) dst_sel:DWORD dst_unused:UNUSED_PAD src0_sel:WORD_0
    v_lshlrev_b32 v120, 16, v74
    v_and_b32 v121, s32, v74
    v_mul_f32 v122, s33, v122
    v_lshlrev_b32 v74, 16, v75
    v_and_b32 v75, s32, v75
    v_lshlrev_b32_sdwa v27, 3, v27 dst_sel:DWORD dst_unused:UNUSED_PAD src0_sel:DWORD src1_sel:WORD_1
    v_pk_fma_f32 v[120:121], v[120:121], v[122:123], s[28:29] op_sel_hi:[1,0,1]
    v_pk_fma_f32 v[74:75], v[74:75], v[122:123], s[28:29] op_sel_hi:[1,0,1]
    v_perm_b32 v120, v121, v120, s35
    v_perm_b32 v121, v75, v74, s35
    v_lshl_add_u64 v[120:121], v[120:121], 0, s[30:31]
    ds_add_rtn_u64 v[74:75], v27, v[120:121] offset:50000

    s_waitcnt lgkmcnt(4)
    v_or3_b32 v1, v60, v61, v1
    v_or3_b32 v1, v62, v63, v1
    v_or3_b32 v1, v64, v65, v1
    v_or3_b32 v1, v66, v67, v1
    s_cmp_le_i32 s42, 3072
    s_cbranch_scc1 L_nt2_105
    s_waitcnt vmcnt(0)
    s_mov_b64 exec, s[64:65]
    v_cvt_f32_i32_sdwa v118, sext(v106) dst_sel:DWORD dst_unused:UNUSED_PAD src0_sel:WORD_0
    v_lshlrev_b32 v116, 16, v44
    v_and_b32 v117, s32, v44
    v_mul_f32 v118, s33, v118
    v_lshlrev_b32 v44, 16, v45
    v_and_b32 v45, s32, v45
    v_lshlrev_b32_sdwa v106, 3, v106 dst_sel:DWORD dst_unused:UNUSED_PAD src0_sel:DWORD src1_sel:WORD_1
    v_pk_fma_f32 v[116:117], v[116:117], v[118:119], s[28:29] op_sel_hi:[1,0,1]
    v_pk_fma_f32 v[44:45], v[44:45], v[118:119], s[28:29] op_sel_hi:[1,0,1]
    v_perm_b32 v116, v117, v116, s35
    v_perm_b32 v117, v45, v44, s35
    v_lshl_add_u64 v[116:117], v[116:117], 0, s[30:31]
    ds_add_rtn_u64 v[44:45], v106, v[116:117] offset:50000

    s_mov_b64 exec, s[66:67]
    v_cvt_f32_i32_sdwa v122, sext(v107) dst_sel:DWORD dst_unused:UNUSED_PAD src0_sel:WORD_0
    v_lshlrev_b32 v120, 16, v46
    v_and_b32 v121, s32, v46
    v_mul_f32 v122, s33, v122
    v_lshlrev_b32 v46, 16, v47
    v_and_b32 v47, s32, v47
    v_lshlrev_b32_sdwa v107, 3, v107 dst_sel:DWORD dst_unused:UNUSED_PAD src0_sel:DWORD src1_sel:WORD_1
    v_pk_fma_f32 v[120:121], v[120:121], v[122:123], s[28:29] op_sel_hi:[1,0,1]
    v_pk_fma_f32 v[46:47], v[46:47], v[122:123], s[28:29] op_sel_hi:[1,0,1]
    v_perm_b32 v120, v121, v120, s35
    v_perm_b32 v121, v47, v46, s35
    v_lshl_add_u64 v[120:121], v[120:121], 0, s[30:31]
    ds_add_rtn_u64 v[46:47], v107, v[120:121] offset:50000

    s_mov_b64 exec, s[68:69]
    v_cvt_f32_i32_sdwa v118, sext(v108) dst_sel:DWORD dst_unused:UNUSED_PAD src0_sel:WORD_0
    v_lshlrev_b32 v116, 16, v48
    v_and_b32 v117, s32, v48
    v_mul_f32 v118, s33, v118
    v_lshlrev_b32 v48, 16, v49
    v_and_b32 v49, s32, v49
    v_lshlrev_b32_sdwa v108, 3, v108 dst_sel:DWORD dst_unused:UNUSED_PAD src0_sel:DWORD src1_sel:WORD_1
    v_pk_fma_f32 v[116:117], v[116:117], v[118:119], s[28:29] op_sel_hi:[1,0,1]
    v_pk_fma_f32 v[48:49], v[48:49], v[118:119], s[28:29] op_sel_hi:[1,0,1]
    v_perm_b32 v116, v117, v116, s35
    v_perm_b32 v117, v49, v48, s35
    v_lshl_add_u64 v[116:117], v[116:117], 0, s[30:31]
    ds_add_rtn_u64 v[48:49], v108, v[116:117] offset:50000

    s_mov_b64 exec, s[70:71]
    v_cvt_f32_i32_sdwa v122, sext(v109) dst_sel:DWORD dst_unused:UNUSED_PAD src0_sel:WORD_0
    v_lshlrev_b32 v120, 16, v50
    v_and_b32 v121, s32, v50
    v_mul_f32 v122, s33, v122
    v_lshlrev_b32 v50, 16, v51
    v_and_b32 v51, s32, v51
    v_lshlrev_b32_sdwa v109, 3, v109 dst_sel:DWORD dst_unused:UNUSED_PAD src0_sel:DWORD src1_sel:WORD_1
    v_pk_fma_f32 v[120:121], v[120:121], v[122:123], s[28:29] op_sel_hi:[1,0,1]
    v_pk_fma_f32 v[50:51], v[50:51], v[122:123], s[28:29] op_sel_hi:[1,0,1]
    v_perm_b32 v120, v121, v120, s35
    v_perm_b32 v121, v51, v50, s35
    v_lshl_add_u64 v[120:121], v[120:121], 0, s[30:31]
    ds_add_rtn_u64 v[50:51], v109, v[120:121] offset:50000

    s_mov_b64 exec, -1
    s_waitcnt lgkmcnt(0)
    v_or3_b32 v1, v44, v45, v1
    v_or3_b32 v1, v46, v47, v1
    v_or3_b32 v1, v48, v49, v1
    v_or3_b32 v1, v50, v51, v1
L_nt2_105:
    s_movk_i32 s53, 15360
    buffer_load_dwordx4 v[106:109], v2, s[16:19], s53 offen
    buffer_load_dword v114, v2, s[16:19], s53 offen offset:16
    s_waitcnt lgkmcnt(0)
    v_or3_b32 v1, v68, v69, v1
    v_or3_b32 v1, v70, v71, v1
    v_or3_b32 v1, v72, v73, v1
    v_or3_b32 v1, v74, v75, v1
    s_cmp_le_u32 s40, 3584
    s_cbranch_scc1 L_noleft_108
    s_min_u32 s40, s40, 3968
    s_lshl_b32 s52, s38, 6
    s_add_u32 s52, s52, s36
    s_mul_i32 s52, s52, 19840
    s_add_u32 s20, s44, s52
    s_addc_u32 s21, s45, 0
    s_mul_i32 s52, s40, 5
    s_add_u32 s52, s52, 3
    s_and_b32 s22, s52, -4

    s_lshr_b32 s55, s39, 2
    s_add_u32 s55, s55, 3584
    v_and_b32 v60, 63, v0
    v_add_u32 v60, s55, v60
L_left_109:
    s_cmp_ge_u32 s55, s40
    s_cbranch_scc1 L_leftend_110
    v_mul_u32_u24 v61, 5, v60
    buffer_load_dword v62, v61, s[20:23], 0 offen
    buffer_load_ubyte v63, v61, s[20:23], 0 offen offset:4
    s_waitcnt vmcnt(0)

    v_perm_b32 v61, v63, v62, s24
    v_lshrrev_b32 v66, 30, v62
    v_and_b32 v61, 0x1fff, v61
    v_mul_u32_u24 v66, 6250, v66
    v_add_lshl_u32 v61, v61, v66, 3

    buffer_load_dwordx2 v[64:65], v61, s[8:11], s50 offen
    v_cmp_gt_u32 vcc, s40, v60
    s_waitcnt vmcnt(0)

    s_mov_b64 exec, vcc
    v_and_b32 v62, 0x3fffffff, v62
    v_cvt_f32_i32_sdwa v118, sext(v62) dst_sel:DWORD dst_unused:UNUSED_PAD src0_sel:WORD_0
    v_lshlrev_b32 v116, 16, v64
    v_and_b32 v117, s32, v64
    v_mul_f32 v118, s33, v118
    v_lshlrev_b32 v64, 16, v65
    v_and_b32 v65, s32, v65
    v_lshlrev_b32_sdwa v62, 3, v62 dst_sel:DWORD dst_unused:UNUSED_PAD src0_sel:DWORD src1_sel:WORD_1
    v_pk_fma_f32 v[116:117], v[116:117], v[118:119], s[28:29] op_sel_hi:[1,0,1]
    v_pk_fma_f32 v[64:65], v[64:65], v[118:119], s[28:29] op_sel_hi:[1,0,1]
    v_perm_b32 v116, v117, v116, s35
    v_perm_b32 v117, v65, v64, s35
    v_lshl_add_u64 v[116:117], v[116:117], 0, s[30:31]
    ds_add_rtn_u64 v[64:65], v62, v[116:117] offset:50000

    s_waitcnt lgkmcnt(0)
    v_or3_b32 v1, v64, v65, v1
    s_mov_b64 exec, -1
    v_add_u32 v60, 128, v60
    s_add_u32 s55, s55, 128
    s_branch L_left_109
L_leftend_110:

L_noleft_108:
    s_mov_b32 s38, s5
    s_cmp_lt_u32 s38, s4
    s_cbranch_scc1 L_batch_91
    s_waitcnt vmcnt(0)
    s_barrier

    s_mul_i32 s3, s37, 6400000
    s_mul_i32 s5, s36, 100000
    s_add_u32 s3, s3, s5
    s_add_u32 s3, s3, 1048576

    s_add_u32 s20, s6, s3
    s_addc_u32 s21, s7, 0
    s_mov_b32 s22, 100000
    s_mov_b32 s23, 0x20000
    v_lshlrev_b32 v68, 3, v0
    v_add_u32 v69, 50000, v68
    v_add_u32 v70, 115536, v68
    v_cmp_gt_u32 vcc, 212, v0
    v_mov_b32 v52, 0
    v_mov_b32 v53, 0

    ds_read_b64 v[28:29], v69 offset:0
    ds_read_b64 v[30:31], v69 offset:8192
    ds_read_b64 v[32:33], v69 offset:16384
    ds_read_b64 v[34:35], v69 offset:24576
    ds_read_b64 v[36:37], v69 offset:32768
    ds_read_b64 v[38:39], v69 offset:40960
    ds_read_b64 v[40:41], v69 offset:49152
    ds_read_b64 v[42:43], v69 offset:57344
    ds_read_b64 v[44:45], v70 offset:0
    ds_read_b64 v[46:47], v70 offset:8192
    ds_read_b64 v[48:49], v70 offset:16384
    ds_read_b64 v[50:51], v70 offset:24576
    s_mov_b64 exec, vcc
    ds_read_b64 v[52:53], v70 offset:32768
    s_mov_b64 exec, -1
    s_waitcnt lgkmcnt(12)
    s_mov_b32 s3, 0
    buffer_store_dwordx2 v[28:29], v68, s[20:23], s3 offen
    s_waitcnt lgkmcnt(11)
    s_mov_b32 s3, 8192
    buffer_store_dwordx2 v[30:31], v68, s[20:23], s3 offen
    s_waitcnt lgkmcnt(10)
    s_mov_b32 s3, 16384
    buffer_store_dwordx2 v[32:33], v68, s[20:23], s3 offen
    s_waitcnt lgkmcnt(9)
    s_mov_b32 s3, 24576
    buffer_store_dwordx2 v[34:35], v68, s[20:23], s3 offen
    s_waitcnt lgkmcnt(8)
    s_mov_b32 s3, 32768
    buffer_store_dwordx2 v[36:37], v68, s[20:23], s3 offen
    s_waitcnt lgkmcnt(7)
    s_mov_b32 s3, 40960
    buffer_store_dwordx2 v[38:39], v68, s[20:23], s3 offen
    s_waitcnt lgkmcnt(6)
    s_mov_b32 s3, 49152
    buffer_store_dwordx2 v[40:41], v68, s[20:23], s3 offen
    s_waitcnt lgkmcnt(5)
    s_mov_b32 s3, 57344
    buffer_store_dwordx2 v[42:43], v68, s[20:23], s3 offen
    s_waitcnt lgkmcnt(4)
    s_mov_b32 s3, 65536
    buffer_store_dwordx2 v[44:45], v68, s[20:23], s3 offen
    s_waitcnt lgkmcnt(3)
    s_mov_b32 s3, 73728
    buffer_store_dwordx2 v[46:47], v68, s[20:23], s3 offen
    s_waitcnt lgkmcnt(2)
    s_mov_b32 s3, 81920
    buffer_store_dwordx2 v[48:49], v68, s[20:23], s3 offen
    s_waitcnt lgkmcnt(1)
    s_mov_b32 s3, 90112
    buffer_store_dwordx2 v[50:51], v68, s[20:23], s3 offen
    s_waitcnt lgkmcnt(0)
    s_mov_b32 s3, 98304
    buffer_store_dwordx2 v[52:53], v68, s[20:23], s3 offen
    v_or3_b32 v1, v28, v29, v1
    v_or3_b32 v1, v30, v31, v1
    v_or3_b32 v1, v32, v33, v1
    v_or3_b32 v1, v34, v35, v1
    v_or3_b32 v1, v36, v37, v1
    v_or3_b32 v1, v38, v39, v1
    v_or3_b32 v1, v40, v41, v1
    v_or3_b32 v1, v42, v43, v1
    v_or3_b32 v1, v44, v45, v1
    v_or3_b32 v1, v46, v47, v1
    v_or3_b32 v1, v48, v49, v1
    v_or3_b32 v1, v50, v51, v1
    v_or3_b32 v1, v52, v53, v1
    v_and_b32 v1, 0x80008000, v1
    v_cmp_ne_u32 vcc, 0, v1
    v_mov_b32 v71, 150008
    v_mov_b32 v72, 1
    s_cbranch_vccz L_nf_111
    ds_write_b32 v71, v72
L_nf_111:
    s_waitcnt lgkmcnt(0)
    s_barrier
    ds_read_b32 v72, v71
    s_waitcnt lgkmcnt(0)
    v_readfirstlane_b32 s3, v72
    s_nop 1
    s_cmp_lg_u32 s3, 0
    s_cbranch_scc1 L_p2slow_90

L_fin_112:
    s_add_u32 s20, s6, 147456
    s_addc_u32 s21, s7, 0
    s_mov_b32 s22, 1024
    s_mov_b32 s23, 0x20000
    s_lshl_b32 s3, s36, 2
    s_add_u32 s3, s3, s37
    s_lshl_b32 s3, s3, 2
    v_lshlrev_b32 v73, 20, v0
    v_mov_b32 v74, s34
    buffer_store_dword v74, v73, s[20:23], s3 offen

L_p2done_89:
    s_endpgm

L_ufix_92:
    v_and_b32 v117, 63, v0
    v_lshlrev_b32 v117, 2, v117
    s_sub_i32 s54, s42, 1024
    v_cmp_le_i32 vcc, s54, v117
    s_mov_b64 exec, vcc
    v_mov_b32 v12, 0
    v_mov_b32 v44, 0
    s_mov_b64 exec, -1
    s_sub_i32 s54, s42, 1025
    v_cmp_le_i32 vcc, s54, v117
    s_mov_b64 exec, vcc
    v_mov_b32 v13, 0
    v_mov_b32 v46, 0
    s_mov_b64 exec, -1
    s_sub_i32 s54, s42, 1026
    v_cmp_le_i32 vcc, s54, v117
    s_mov_b64 exec, vcc
    v_mov_b32 v14, 0
    v_mov_b32 v48, 0
    s_mov_b64 exec, -1
    s_sub_i32 s54, s42, 1027
    v_cmp_le_i32 vcc, s54, v117
    s_mov_b64 exec, vcc
    v_mov_b32 v15, 0
    v_mov_b32 v50, 0
    s_mov_b64 exec, -1
    s_branch L_uback_93
L_ufix_94:
    v_and_b32 v117, 63, v0
    v_lshlrev_b32 v117, 2, v117
    s_sub_i32 s54, s42, 1536
    v_cmp_le_i32 vcc, s54, v117
    s_mov_b64 exec, vcc
    v_mov_b32 v16, 0
    v_mov_b32 v52, 0
    s_mov_b64 exec, -1
    s_sub_i32 s54, s42, 1537
    v_cmp_le_i32 vcc, s54, v117
    s_mov_b64 exec, vcc
    v_mov_b32 v17, 0
    v_mov_b32 v54, 0
    s_mov_b64 exec, -1
    s_sub_i32 s54, s42, 1538
    v_cmp_le_i32 vcc, s54, v117
    s_mov_b64 exec, vcc
    v_mov_b32 v18, 0
    v_mov_b32 v56, 0
    s_mov_b64 exec, -1
    s_sub_i32 s54, s42, 1539
    v_cmp_le_i32 vcc, s54, v117
    s_mov_b64 exec, vcc
    v_mov_b32 v19, 0
    v_mov_b32 v58, 0
    s_mov_b64 exec, -1
    s_branch L_uback_95
L_ufix_96:
    v_and_b32 v117, 63, v0
    v_lshlrev_b32 v117, 2, v117
    s_sub_i32 s54, s42, 2048
    v_cmp_le_i32 vcc, s54, v117
    s_mov_b64 exec, vcc
    v_mov_b32 v20, 0
    v_mov_b32 v60, 0
    s_mov_b64 exec, -1
    s_sub_i32 s54, s42, 2049
    v_cmp_le_i32 vcc, s54, v117
    s_mov_b64 exec, vcc
    v_mov_b32 v21, 0
    v_mov_b32 v62, 0
    s_mov_b64 exec, -1
    s_sub_i32 s54, s42, 2050
    v_cmp_le_i32 vcc, s54, v117
    s_mov_b64 exec, vcc
    v_mov_b32 v22, 0
    v_mov_b32 v64, 0
    s_mov_b64 exec, -1
    s_sub_i32 s54, s42, 2051
    v_cmp_le_i32 vcc, s54, v117
    s_mov_b64 exec, vcc
    v_mov_b32 v23, 0
    v_mov_b32 v66, 0
    s_mov_b64 exec, -1
    s_branch L_uback_97
L_ufix_98:
    v_and_b32 v117, 63, v0
    v_lshlrev_b32 v117, 2, v117
    s_sub_i32 s54, s42, 2560
    v_cmp_le_i32 vcc, s54, v117
    s_mov_b64 exec, vcc
    v_mov_b32 v24, 0
    v_mov_b32 v68, 0
    s_mov_b64 exec, -1
    s_sub_i32 s54, s42, 2561
    v_cmp_le_i32 vcc, s54, v117
    s_mov_b64 exec, vcc
    v_mov_b32 v25, 0
    v_mov_b32 v70, 0
    s_mov_b64 exec, -1
    s_sub_i32 s54, s42, 2562
    v_cmp_le_i32 vcc, s54, v117
    s_mov_b64 exec, vcc
    v_mov_b32 v26, 0
    v_mov_b32 v72, 0
    s_mov_b64 exec, -1
    s_sub_i32 s54, s42, 2563
    v_cmp_le_i32 vcc, s54, v117
    s_mov_b64 exec, vcc
    v_mov_b32 v27, 0
    v_mov_b32 v74, 0
    s_mov_b64 exec, -1
    s_branch L_uback_99
L_ufix_100:
    v_and_b32 v117, 63, v0
    v_lshlrev_b32 v117, 2, v117
    s_sub_i32 s54, s42, 0
    v_cmp_le_i32 vcc, s54, v117
    s_mov_b64 exec, vcc
    v_mov_b32 v4, 0
    v_mov_b32 v28, 0
    s_mov_b64 exec, -1
    s_sub_i32 s54, s42, 1
    v_cmp_le_i32 vcc, s54, v117
    s_mov_b64 exec, vcc
    v_mov_b32 v5, 0
    v_mov_b32 v30, 0
    s_mov_b64 exec, -1
    s_sub_i32 s54, s42, 2
    v_cmp_le_i32 vcc, s54, v117
    s_mov_b64 exec, vcc
    v_mov_b32 v6, 0
    v_mov_b32 v32, 0
    s_mov_b64 exec, -1
    s_sub_i32 s54, s42, 3
    v_cmp_le_i32 vcc, s54, v117
    s_mov_b64 exec, vcc
    v_mov_b32 v7, 0
    v_mov_b32 v34, 0
    s_mov_b64 exec, -1
    s_branch L_uback_101
L_ufix_102:
    v_and_b32 v117, 63, v0
    v_lshlrev_b32 v117, 2, v117
    s_sub_i32 s54, s42, 512
    v_cmp_le_i32 vcc, s54, v117
    s_mov_b64 exec, vcc
    v_mov_b32 v8, 0
    v_mov_b32 v36, 0
    s_mov_b64 exec, -1
    s_sub_i32 s54, s42, 513
    v_cmp_le_i32 vcc, s54, v117
    s_mov_b64 exec, vcc
    v_mov_b32 v9, 0
    v_mov_b32 v38, 0
    s_mov_b64 exec, -1
    s_sub_i32 s54, s42, 514
    v_cmp_le_i32 vcc, s54, v117
    s_mov_b64 exec, vcc
    v_mov_b32 v10, 0
    v_mov_b32 v40, 0
    s_mov_b64 exec, -1
    s_sub_i32 s54, s42, 515
    v_cmp_le_i32 vcc, s54, v117
    s_mov_b64 exec, vcc
    v_mov_b32 v11, 0
    v_mov_b32 v42, 0
    s_mov_b64 exec, -1
    s_branch L_uback_103
L_ufix_106:
    v_and_b32 v117, 63, v0
    v_lshlrev_b32 v117, 2, v117
    s_sub_i32 s54, s42, 3072
    v_cmp_le_i32 vcc, s54, v117
    s_mov_b64 exec, vcc
    v_mov_b32 v106, 0
    v_mov_b32 v116, 0
    s_mov_b64 exec, -1
    s_sub_i32 s54, s42, 3073
    v_cmp_le_i32 vcc, s54, v117
    s_mov_b64 exec, vcc
    v_mov_b32 v107, 0
    v_mov_b32 v118, 0
    s_mov_b64 exec, -1
    s_sub_i32 s54, s42, 3074
    v_cmp_le_i32 vcc, s54, v117
    s_mov_b64 exec, vcc
    v_mov_b32 v108, 0
    v_mov_b32 v120, 0
    s_mov_b64 exec, -1
    s_sub_i32 s54, s42, 3075
    v_cmp_le_i32 vcc, s54, v117
    s_mov_b64 exec, vcc
    v_mov_b32 v109, 0
    v_mov_b32 v122, 0
    s_mov_b64 exec, -1
    s_branch L_uback_107
L_p2slow_90:
    s_waitcnt vmcnt(0) lgkmcnt(0)
    s_mov_b32 s51, 0
    s_movk_i32 s43, 6250
    s_mov_b32 s34, 0
L_sweep_113:
    s_barrier

    v_mov_b32 v28, 0x0
    v_mov_b32 v29, 0x0
    v_mov_b32 v30, 0x0
    v_mov_b32 v31, 0x0
    v_add_u32 v32, 50000, v3
    v_add_u32 v33, 65536, v32

    ds_write_b128 v32, v[28:31] offset:0
    ds_write_b128 v32, v[28:31] offset:16384
    ds_write_b128 v32, v[28:31] offset:32768
    ds_write_b128 v32, v[28:31] offset:49152
    ds_write_b128 v33, v[28:31] offset:0
    ds_write_b128 v33, v[28:31] offset:16384
    v_cmp_gt_u32 vcc, 106, v0
    s_mov_b64 exec, vcc
    ds_write_b128 v33, v[28:31] offset:32768
    s_mov_b64 exec, -1
    s_waitcnt lgkmcnt(0)
    s_barrier
    s_sub_u32 s38, s4, 8
L_sbatch_114:
    s_lshl_b32 s52, s38, 6
    s_add_u32 s52, s52, s36
    s_lshl_b32 s52, s52, 2
    s_load_dword s40, s[46:47], s52
    s_mul_i32 s50, s38, 200000
    s_waitcnt lgkmcnt(0)

    s_min_u32 s40, s40, 3968
    s_lshl_b32 s52, s38, 6
    s_add_u32 s52, s52, s36
    s_mul_i32 s52, s52, 19840
    s_add_u32 s20, s44, s52
    s_addc_u32 s21, s45, 0
    s_mul_i32 s52, s40, 5
    s_add_u32 s52, s52, 3
    s_and_b32 s22, s52, -4

    s_lshr_b32 s55, s39, 2
    s_add_u32 s55, s55, 0
    v_and_b32 v36, 63, v0
    v_add_u32 v36, s55, v36
L_left_118:
    s_cmp_ge_u32 s55, s40
    s_cbranch_scc1 L_leftend_119
    v_mul_u32_u24 v37, 5, v36
    buffer_load_dword v38, v37, s[20:23], 0 offen
    buffer_load_ubyte v39, v37, s[20:23], 0 offen offset:4
    s_waitcnt vmcnt(0)

    v_perm_b32 v37, v39, v38, s24
    v_lshrrev_b32 v42, 30, v38
    v_and_b32 v37, 0x1fff, v37
    v_mul_u32_u24 v42, 6250, v42
    v_add_lshl_u32 v37, v37, v42, 3

    buffer_load_dwordx2 v[40:41], v37, s[8:11], s50 offen
    v_cmp_gt_u32 vcc, s40, v36
    s_waitcnt vmcnt(0)

    v_bfe_u32 v44, v38, 16, 14
    v_subrev_u32 v44, s51, v44
    v_cmp_gt_u32 s[64:65], s43, v44
    s_and_b64 exec, vcc, s[64:65]
    v_lshlrev_b32 v44, 4, v44
    v_bfe_i32 v38, v38, 0, 16
    v_cvt_f32_i32 v38, v38
    v_mul_f32 v38, 0x38004020, v38
    v_lshlrev_b32 v45, 16, v40
    v_and_b32 v46, s32, v40
    v_lshlrev_b32 v47, 16, v41
    v_and_b32 v48, s32, v41

    v_mul_f32 v45, v45, v38
    ds_add_f32 v44, v45 offset:50000
    v_mul_f32 v46, v46, v38
    ds_add_f32 v44, v46 offset:50004
    v_mul_f32 v47, v47, v38
    ds_add_f32 v44, v47 offset:50008
    v_mul_f32 v48, v48, v38
    ds_add_f32 v44, v48 offset:50012
    s_mov_b64 exec, -1
    v_add_u32 v36, 128, v36
    s_add_u32 s55, s55, 128
    s_branch L_left_118
L_leftend_119:

    s_add_u32 s38, s38, 1
    s_cmp_lt_u32 s38, s4
    s_cbranch_scc1 L_sbatch_114
    s_mov_b32 s3, 131072
    s_load_dword s40, s[6:7], s3

    s_add_u32 s20, s6, 402907136
    s_addc_u32 s21, s7, 0
    s_mov_b32 s22, 409600000
    s_mov_b32 s23, 0x20000
    s_mov_b32 s38, 0
    s_mov_b32 s50, 200000
    v_mov_b32 v36, v0
    s_waitcnt lgkmcnt(0)
L_ovf_115:
    s_cmp_ge_u32 s38, s40
    s_cbranch_scc1 L_ovfend_116
    v_lshlrev_b32 v37, 3, v36
    buffer_load_dwordx2 v[38:39], v37, s[20:23], 0 offen
    s_waitcnt vmcnt(0)

    v_perm_b32 v37, v39, v38, s24
    v_lshrrev_b32 v42, 30, v38
    v_and_b32 v37, 0x1fff, v37
    v_mul_u32_u24 v42, 6250, v42
    v_add_lshl_u32 v37, v37, v42, 3

    v_bfe_u32 v42, v39, 24, 5
    v_mad_u32_u24 v37, v42, s50, v37
    buffer_load_dwordx2 v[40:41], v37, s[8:11], 0 offen
    v_lshrrev_b32 v42, 3, v42
    v_bfe_u32 v43, v39, 18, 6
    v_cmp_gt_u32 vcc, s40, v36
    v_cmp_eq_u32 s[64:65], s36, v43
    s_and_b64 vcc, vcc, s[64:65]
    v_cmp_eq_u32 s[64:65], s37, v42
    s_and_b64 vcc, vcc, s[64:65]
    s_waitcnt vmcnt(0)

    v_bfe_u32 v44, v38, 16, 14
    v_subrev_u32 v44, s51, v44
    v_cmp_gt_u32 s[64:65], s43, v44
    s_and_b64 exec, vcc, s[64:65]
    v_lshlrev_b32 v44, 4, v44
    v_bfe_i32 v38, v38, 0, 16
    v_cvt_f32_i32 v38, v38
    v_mul_f32 v38, 0x38004020, v38
    v_lshlrev_b32 v45, 16, v40
    v_and_b32 v46, s32, v40
    v_lshlrev_b32 v47, 16, v41
    v_and_b32 v48, s32, v41

    v_mul_f32 v45, v45, v38
    ds_add_f32 v44, v45 offset:50000
    v_mul_f32 v46, v46, v38
    ds_add_f32 v44, v46 offset:50004
    v_mul_f32 v47, v47, v38
    ds_add_f32 v44, v47 offset:50008
    v_mul_f32 v48, v48, v38
    ds_add_f32 v44, v48 offset:50012
    s_mov_b64 exec, -1
    v_add_u32 v36, 1024, v36
    s_add_u32 s38, s38, 1024
    s_branch L_ovf_115
L_ovfend_116:
    s_waitcnt lgkmcnt(0)
    s_barrier
    s_mul_i32 s3, s37, 800000
    s_mul_i32 s5, s36, 12500
    s_add_u32 s3, s3, s5
    s_add_u32 s3, s3, s51
    s_lshl_b32 s3, s3, 4
    s_add_u32 s3, s3, 26648576

    s_add_u32 s20, s6, s3
    s_addc_u32 s21, s7, 0
    s_mov_b32 s22, 100000
    s_mov_b32 s23, 0x20000
    v_mov_b32 v36, v3
    s_mov_b32 s38, 0
L_wl_117:
    v_min_u32 v37, 100000, v36
    ds_read_b128 v[28:31], v37 offset:50000
    s_waitcnt lgkmcnt(0)
    buffer_store_dwordx4 v[28:31], v36, s[20:23], 0 offen
    s_waitcnt vmcnt(0)
    v_add_u32 v36, 16384, v36
    s_add_u32 s38, s38, 1024
    s_cmp_lt_u32 s38, 6250
    s_cbranch_scc1 L_wl_117
    s_add_u32 s51, s51, 6250
    s_cmp_lt_u32 s51, 12500
    s_cbranch_scc1 L_sweep_113
    s_branch L_fin_112

.globl standalone__molecular_angular_gemnet__graph_kernel
.p2align 8
.type standalone__molecular_angular_gemnet__graph_kernel,@function
standalone__molecular_angular_gemnet__graph_kernel:
    s_cmp_ge_u32 s2, 3200
    s_cbranch_scc1 L_fdone_120
    s_load_dwordx2 s[4:5], s[0:1], 0
    s_load_dwordx2 s[6:7], s[0:1], 24
    s_load_dwordx2 s[8:9], s[0:1], 40
    s_load_dwordx8 s[12:19], s[0:1], 56
    s_load_dwordx2 s[10:11], s[0:1], 88
    s_load_dwordx2 s[20:21], s[0:1], 104
    v_cmp_gt_u32 vcc, 250, v0
    s_mul_i32 s3, s2, 250
    v_add_u32 v0, s3, v0
    v_lshlrev_b32 v1, 4, v0
    v_lshlrev_b32 v2, 3, v0
    v_lshlrev_b32 v3, 1, v0
    s_mov_b64 exec, vcc
    s_mul_hi_u32 s3, s2, 85899346
    s_lshl_b32 s3, s3, 4
    s_add_u32 s3, s3, 147456
    s_waitcnt lgkmcnt(0)
    s_load_dwordx4 s[96:99], s[20:21], s3
    s_load_dwordx4 s[40:43], s[8:9], 0
    s_load_dwordx16 s[44:59], s[12:13], 0
    s_load_dwordx16 s[60:75], s[14:15], 0
    s_load_dwordx8 s[76:83], s[16:17], 0
    s_load_dwordx8 s[84:91], s[18:19], 0

    s_add_u32 s24, s20, 1048576
    s_addc_u32 s25, s21, 0
    s_mov_b32 s26, 76800000
    s_mov_b32 s27, 0x20000
    s_mov_b32 s28, s4
    s_mov_b32 s29, s5
    s_mov_b32 s30, 6400000
    s_mov_b32 s31, 0x20000
    s_mov_b32 s32, s6
    s_mov_b32 s33, s7
    s_mov_b32 s34, 1600000
    s_mov_b32 s35, 0x20000
    s_mov_b32 s36, s10
    s_mov_b32 s37, s11
    s_mov_b32 s38, 6400000
    s_mov_b32 s39, 0x20000
    buffer_load_ushort v4, v3, s[32:35], 0 offen
    buffer_load_dwordx2 v[32:33], v2, s[24:27], 0 offen
    s_mov_b32 s3, 6400000
    buffer_load_dwordx2 v[34:35], v2, s[24:27], s3 offen
    s_mov_b32 s3, 12800000
    buffer_load_dwordx2 v[36:37], v2, s[24:27], s3 offen
    s_mov_b32 s3, 19200000
    buffer_load_dwordx2 v[38:39], v2, s[24:27], s3 offen
    buffer_load_dwordx2 v[6:7], v2, s[28:31], 0 offen
    s_mov_b32 s94, 0xffff0000
    s_mov_b32 s95, 0xc1200000
    s_mov_b32 s22, 0x3fb8aa3b
    s_waitcnt vmcnt(5) lgkmcnt(0)
    v_lshlrev_b32 v4, 16, v4

    s_lshl_b32 s92, s40, 16
    v_subrev_f32 v16, s92, v4
    s_and_b32 s93, s40, s94
    v_subrev_f32 v17, s93, v4
    s_lshl_b32 s92, s41, 16
    v_subrev_f32 v18, s92, v4
    s_and_b32 s93, s41, s94
    v_subrev_f32 v19, s93, v4
    s_lshl_b32 s92, s42, 16
    v_subrev_f32 v20, s92, v4
    s_and_b32 s93, s42, s94
    v_subrev_f32 v21, s93, v4
    s_lshl_b32 s92, s43, 16
    v_subrev_f32 v22, s92, v4
    s_and_b32 s93, s43, s94
    v_subrev_f32 v23, s93, v4
    v_cvt_pk_bf16_f32 v16, v16, v17
    v_and_b32 v17, s94, v16
    v_lshlrev_b32 v16, 16, v16
    v_cvt_pk_bf16_f32 v18, v18, v19
    v_and_b32 v19, s94, v18
    v_lshlrev_b32 v18, 16, v18
    v_cvt_pk_bf16_f32 v20, v20, v21
    v_and_b32 v21, s94, v20
    v_lshlrev_b32 v20, 16, v20
    v_cvt_pk_bf16_f32 v22, v22, v23
    v_and_b32 v23, s94, v22
    v_lshlrev_b32 v22, 16, v22
    v_mul_f32 v16, v16, v16
    v_mul_f32 v17, v17, v17
    v_mul_f32 v18, v18, v18
    v_mul_f32 v19, v19, v19
    v_mul_f32 v20, v20, v20
    v_mul_f32 v21, v21, v21
    v_mul_f32 v22, v22, v22
    v_mul_f32 v23, v23, v23
    v_cvt_pk_bf16_f32 v16, v16, v17
    v_and_b32 v17, s94, v16
    v_lshlrev_b32 v16, 16, v16
    v_cvt_pk_bf16_f32 v18, v18, v19
    v_and_b32 v19, s94, v18
    v_lshlrev_b32 v18, 16, v18
    v_cvt_pk_bf16_f32 v20, v20, v21
    v_and_b32 v21, s94, v20
    v_lshlrev_b32 v20, 16, v20
    v_cvt_pk_bf16_f32 v22, v22, v23
    v_and_b32 v23, s94, v22
    v_lshlrev_b32 v22, 16, v22
    v_mul_f32 v16, s95, v16
    v_mul_f32 v17, s95, v17
    v_mul_f32 v18, s95, v18
    v_mul_f32 v19, s95, v19
    v_mul_f32 v20, s95, v20
    v_mul_f32 v21, s95, v21
    v_mul_f32 v22, s95, v22
    v_mul_f32 v23, s95, v23
    v_cvt_pk_bf16_f32 v16, v16, v17
    v_and_b32 v17, s94, v16
    v_lshlrev_b32 v16, 16, v16
    v_cvt_pk_bf16_f32 v18, v18, v19
    v_and_b32 v19, s94, v18
    v_lshlrev_b32 v18, 16, v18
    v_cvt_pk_bf16_f32 v20, v20, v21
    v_and_b32 v21, s94, v20
    v_lshlrev_b32 v20, 16, v20
    v_cvt_pk_bf16_f32 v22, v22, v23
    v_and_b32 v23, s94, v22
    v_lshlrev_b32 v22, 16, v22
    v_mul_f32 v16, s22, v16
    v_mul_f32 v17, s22, v17
    v_mul_f32 v18, s22, v18
    v_mul_f32 v19, s22, v19
    v_mul_f32 v20, s22, v20
    v_mul_f32 v21, s22, v21
    v_mul_f32 v22, s22, v22
    v_mul_f32 v23, s22, v23
    v_exp_f32 v16, v16
    v_exp_f32 v17, v17
    v_exp_f32 v18, v18
    v_exp_f32 v19, v19
    v_exp_f32 v20, v20
    v_exp_f32 v21, v21
    v_exp_f32 v22, v22
    v_exp_f32 v23, v23
    s_nop 0
    v_cvt_pk_bf16_f32 v16, v16, v17
    v_and_b32 v17, s94, v16
    v_lshlrev_b32 v16, 16, v16
    v_cvt_pk_bf16_f32 v18, v18, v19
    v_and_b32 v19, s94, v18
    v_lshlrev_b32 v18, 16, v18
    v_cvt_pk_bf16_f32 v20, v20, v21
    v_and_b32 v21, s94, v20
    v_lshlrev_b32 v20, 16, v20
    v_cvt_pk_bf16_f32 v22, v22, v23
    v_and_b32 v23, s94, v22
    v_lshlrev_b32 v22, 16, v22
    s_lshl_b32 s92, s60, 16
    v_mul_f32 v24, s92, v16
    s_and_b32 s93, s60, s94
    v_mul_f32 v25, s93, v16
    s_lshl_b32 s92, s61, 16
    v_mul_f32 v26, s92, v16
    s_and_b32 s93, s61, s94
    v_mul_f32 v27, s93, v16
    s_lshl_b32 s92, s62, 16
    v_fmac_f32 v24, s92, v17
    s_and_b32 s93, s62, s94
    v_fmac_f32 v25, s93, v17
    s_lshl_b32 s92, s63, 16
    v_fmac_f32 v26, s92, v17
    s_and_b32 s93, s63, s94
    v_fmac_f32 v27, s93, v17
    s_lshl_b32 s92, s64, 16
    v_fmac_f32 v24, s92, v18
    s_and_b32 s93, s64, s94
    v_fmac_f32 v25, s93, v18
    s_lshl_b32 s92, s65, 16
    v_fmac_f32 v26, s92, v18
    s_and_b32 s93, s65, s94
    v_fmac_f32 v27, s93, v18
    s_lshl_b32 s92, s66, 16
    v_fmac_f32 v24, s92, v19
    s_and_b32 s93, s66, s94
    v_fmac_f32 v25, s93, v19
    s_lshl_b32 s92, s67, 16
    v_fmac_f32 v26, s92, v19
    s_and_b32 s93, s67, s94
    v_fmac_f32 v27, s93, v19
    s_lshl_b32 s92, s68, 16
    v_fmac_f32 v24, s92, v20
    s_and_b32 s93, s68, s94
    v_fmac_f32 v25, s93, v20
    s_lshl_b32 s92, s69, 16
    v_fmac_f32 v26, s92, v20
    s_and_b32 s93, s69, s94
    v_fmac_f32 v27, s93, v20
    s_lshl_b32 s92, s70, 16
    v_fmac_f32 v24, s92, v21
    s_and_b32 s93, s70, s94
    v_fmac_f32 v25, s93, v21
    s_lshl_b32 s92, s71, 16
    v_fmac_f32 v26, s92, v21
    s_and_b32 s93, s71, s94
    v_fmac_f32 v27, s93, v21
    s_lshl_b32 s92, s72, 16
    v_fmac_f32 v24, s92, v22
    s_and_b32 s93, s72, s94
    v_fmac_f32 v25, s93, v22
    s_lshl_b32 s92, s73, 16
    v_fmac_f32 v26, s92, v22
    s_and_b32 s93, s73, s94
    v_fmac_f32 v27, s93, v22
    s_lshl_b32 s92, s74, 16
    v_fmac_f32 v24, s92, v23
    s_and_b32 s93, s74, s94
    v_fmac_f32 v25, s93, v23
    s_lshl_b32 s92, s75, 16
    v_fmac_f32 v26, s92, v23
    s_and_b32 s93, s75, s94
    v_fmac_f32 v27, s93, v23
    s_lshl_b32 s92, s44, 16
    v_mul_f32 v28, s92, v16
    s_and_b32 s93, s44, s94
    v_mul_f32 v29, s93, v16
    s_lshl_b32 s92, s45, 16
    v_mul_f32 v30, s92, v16
    s_and_b32 s93, s45, s94
    v_mul_f32 v31, s93, v16
    s_lshl_b32 s92, s46, 16
    v_fmac_f32 v28, s92, v17
    s_and_b32 s93, s46, s94
    v_fmac_f32 v29, s93, v17
    s_lshl_b32 s92, s47, 16
    v_fmac_f32 v30, s92, v17
    s_and_b32 s93, s47, s94
    v_fmac_f32 v31, s93, v17
    s_lshl_b32 s92, s48, 16
    v_fmac_f32 v28, s92, v18
    s_and_b32 s93, s48, s94
    v_fmac_f32 v29, s93, v18
    s_lshl_b32 s92, s49, 16
    v_fmac_f32 v30, s92, v18
    s_and_b32 s93, s49, s94
    v_fmac_f32 v31, s93, v18
    s_lshl_b32 s92, s50, 16
    v_fmac_f32 v28, s92, v19
    s_and_b32 s93, s50, s94
    v_fmac_f32 v29, s93, v19
    s_lshl_b32 s92, s51, 16
    v_fmac_f32 v30, s92, v19
    s_and_b32 s93, s51, s94
    v_fmac_f32 v31, s93, v19
    s_lshl_b32 s92, s52, 16
    v_fmac_f32 v28, s92, v20
    s_and_b32 s93, s52, s94
    v_fmac_f32 v29, s93, v20
    s_lshl_b32 s92, s53, 16
    v_fmac_f32 v30, s92, v20
    s_and_b32 s93, s53, s94
    v_fmac_f32 v31, s93, v20
    s_lshl_b32 s92, s54, 16
    v_fmac_f32 v28, s92, v21
    s_and_b32 s93, s54, s94
    v_fmac_f32 v29, s93, v21
    s_lshl_b32 s92, s55, 16
    v_fmac_f32 v30, s92, v21
    s_and_b32 s93, s55, s94
    v_fmac_f32 v31, s93, v21
    s_lshl_b32 s92, s56, 16
    v_fmac_f32 v28, s92, v22
    s_and_b32 s93, s56, s94
    v_fmac_f32 v29, s93, v22
    s_lshl_b32 s92, s57, 16
    v_fmac_f32 v30, s92, v22
    s_and_b32 s93, s57, s94
    v_fmac_f32 v31, s93, v22
    s_lshl_b32 s92, s58, 16
    v_fmac_f32 v28, s92, v23
    s_and_b32 s93, s58, s94
    v_fmac_f32 v29, s93, v23
    s_lshl_b32 s92, s59, 16
    v_fmac_f32 v30, s92, v23
    s_and_b32 s93, s59, s94
    v_fmac_f32 v31, s93, v23
    v_cvt_pk_bf16_f32 v28, v28, v29
    v_and_b32 v29, s94, v28
    v_lshlrev_b32 v28, 16, v28
    v_cvt_pk_bf16_f32 v30, v30, v31
    v_and_b32 v31, s94, v30
    v_lshlrev_b32 v30, 16, v30
    s_waitcnt vmcnt(1)
    v_mov_b32 v8, 0
    v_mov_b32 v9, 0
    v_mov_b32 v10, 0
    v_mov_b32 v11, 0
    s_cmp_eq_u32 s96, 0
    s_cbranch_scc1 L_ffl_121
    v_cvt_f32_u32_sdwa v12, v32 dst_sel:DWORD dst_unused:UNUSED_PAD src0_sel:WORD_0
    v_cvt_f32_u32_sdwa v13, v32 dst_sel:DWORD dst_unused:UNUSED_PAD src0_sel:WORD_1
    v_cvt_f32_u32_sdwa v14, v33 dst_sel:DWORD dst_unused:UNUSED_PAD src0_sel:WORD_0
    v_cvt_f32_u32_sdwa v15, v33 dst_sel:DWORD dst_unused:UNUSED_PAD src0_sel:WORD_1
    v_add_f32 v12, 0xc6800000, v12
    v_add_f32 v13, 0xc6800000, v13
    v_add_f32 v14, 0xc6800000, v14
    v_add_f32 v15, 0xc6800000, v15
    v_fmac_f32 v8, s96, v12
    v_fmac_f32 v9, s96, v13
    v_fmac_f32 v10, s96, v14
    v_fmac_f32 v11, s96, v15
L_fbk_122:
    s_cmp_eq_u32 s97, 0
    s_cbranch_scc1 L_ffl_123
    v_cvt_f32_u32_sdwa v12, v34 dst_sel:DWORD dst_unused:UNUSED_PAD src0_sel:WORD_0
    v_cvt_f32_u32_sdwa v13, v34 dst_sel:DWORD dst_unused:UNUSED_PAD src0_sel:WORD_1
    v_cvt_f32_u32_sdwa v14, v35 dst_sel:DWORD dst_unused:UNUSED_PAD src0_sel:WORD_0
    v_cvt_f32_u32_sdwa v15, v35 dst_sel:DWORD dst_unused:UNUSED_PAD src0_sel:WORD_1
    v_add_f32 v12, 0xc6800000, v12
    v_add_f32 v13, 0xc6800000, v13
    v_add_f32 v14, 0xc6800000, v14
    v_add_f32 v15, 0xc6800000, v15
    v_fmac_f32 v8, s97, v12
    v_fmac_f32 v9, s97, v13
    v_fmac_f32 v10, s97, v14
    v_fmac_f32 v11, s97, v15
L_fbk_124:
    s_cmp_eq_u32 s98, 0
    s_cbranch_scc1 L_ffl_125
    v_cvt_f32_u32_sdwa v12, v36 dst_sel:DWORD dst_unused:UNUSED_PAD src0_sel:WORD_0
    v_cvt_f32_u32_sdwa v13, v36 dst_sel:DWORD dst_unused:UNUSED_PAD src0_sel:WORD_1
    v_cvt_f32_u32_sdwa v14, v37 dst_sel:DWORD dst_unused:UNUSED_PAD src0_sel:WORD_0
    v_cvt_f32_u32_sdwa v15, v37 dst_sel:DWORD dst_unused:UNUSED_PAD src0_sel:WORD_1
    v_add_f32 v12, 0xc6800000, v12
    v_add_f32 v13, 0xc6800000, v13
    v_add_f32 v14, 0xc6800000, v14
    v_add_f32 v15, 0xc6800000, v15
    v_fmac_f32 v8, s98, v12
    v_fmac_f32 v9, s98, v13
    v_fmac_f32 v10, s98, v14
    v_fmac_f32 v11, s98, v15
L_fbk_126:
    s_cmp_eq_u32 s99, 0
    s_cbranch_scc1 L_ffl_127
    v_cvt_f32_u32_sdwa v12, v38 dst_sel:DWORD dst_unused:UNUSED_PAD src0_sel:WORD_0
    v_cvt_f32_u32_sdwa v13, v38 dst_sel:DWORD dst_unused:UNUSED_PAD src0_sel:WORD_1
    v_cvt_f32_u32_sdwa v14, v39 dst_sel:DWORD dst_unused:UNUSED_PAD src0_sel:WORD_0
    v_cvt_f32_u32_sdwa v15, v39 dst_sel:DWORD dst_unused:UNUSED_PAD src0_sel:WORD_1
    v_add_f32 v12, 0xc6800000, v12
    v_add_f32 v13, 0xc6800000, v13
    v_add_f32 v14, 0xc6800000, v14
    v_add_f32 v15, 0xc6800000, v15
    v_fmac_f32 v8, s99, v12
    v_fmac_f32 v9, s99, v13
    v_fmac_f32 v10, s99, v14
    v_fmac_f32 v11, s99, v15
L_fbk_128:
    s_lshl_b32 s92, s76, 16
    v_mul_f32 v16, s92, v8
    s_and_b32 s93, s76, s94
    v_mul_f32 v17, s93, v8
    s_lshl_b32 s92, s77, 16
    v_mul_f32 v18, s92, v8
    s_and_b32 s93, s77, s94
    v_mul_f32 v19, s93, v8
    s_lshl_b32 s92, s78, 16
    v_fmac_f32 v16, s92, v9
    s_and_b32 s93, s78, s94
    v_fmac_f32 v17, s93, v9
    s_lshl_b32 s92, s79, 16
    v_fmac_f32 v18, s92, v9
    s_and_b32 s93, s79, s94
    v_fmac_f32 v19, s93, v9
    s_lshl_b32 s92, s80, 16
    v_fmac_f32 v16, s92, v10
    s_and_b32 s93, s80, s94
    v_fmac_f32 v17, s93, v10
    s_lshl_b32 s92, s81, 16
    v_fmac_f32 v18, s92, v10
    s_and_b32 s93, s81, s94
    v_fmac_f32 v19, s93, v10
    s_lshl_b32 s92, s82, 16
    v_fmac_f32 v16, s92, v11
    s_and_b32 s93, s82, s94
    v_fmac_f32 v17, s93, v11
    s_lshl_b32 s92, s83, 16
    v_fmac_f32 v18, s92, v11
    s_and_b32 s93, s83, s94
    v_fmac_f32 v19, s93, v11
    v_mul_f32 v16, v16, v24
    v_mul_f32 v17, v17, v25
    v_mul_f32 v18, v18, v26
    v_mul_f32 v19, v19, v27
    v_cvt_pk_bf16_f32 v16, v16, v17
    v_and_b32 v17, s94, v16
    v_lshlrev_b32 v16, 16, v16
    v_cvt_pk_bf16_f32 v18, v18, v19
    v_and_b32 v19, s94, v18
    v_lshlrev_b32 v18, 16, v18
    s_lshl_b32 s92, s84, 16
    v_mul_f32 v20, s92, v16
    s_and_b32 s93, s84, s94
    v_mul_f32 v21, s93, v16
    s_lshl_b32 s92, s85, 16
    v_mul_f32 v22, s92, v16
    s_and_b32 s93, s85, s94
    v_mul_f32 v23, s93, v16
    s_lshl_b32 s92, s86, 16
    v_fmac_f32 v20, s92, v17
    s_and_b32 s93, s86, s94
    v_fmac_f32 v21, s93, v17
    s_lshl_b32 s92, s87, 16
    v_fmac_f32 v22, s92, v17
    s_and_b32 s93, s87, s94
    v_fmac_f32 v23, s93, v17
    s_lshl_b32 s92, s88, 16
    v_fmac_f32 v20, s92, v18
    s_and_b32 s93, s88, s94
    v_fmac_f32 v21, s93, v18
    s_lshl_b32 s92, s89, 16
    v_fmac_f32 v22, s92, v18
    s_and_b32 s93, s89, s94
    v_fmac_f32 v23, s93, v18
    s_lshl_b32 s92, s90, 16
    v_fmac_f32 v20, s92, v19
    s_and_b32 s93, s90, s94
    v_fmac_f32 v21, s93, v19
    s_lshl_b32 s92, s91, 16
    v_fmac_f32 v22, s92, v19
    s_and_b32 s93, s91, s94
    v_fmac_f32 v23, s93, v19
    v_cvt_pk_bf16_f32 v20, v20, v21
    v_and_b32 v21, s94, v20
    v_lshlrev_b32 v20, 16, v20
    v_cvt_pk_bf16_f32 v22, v22, v23
    v_and_b32 v23, s94, v22
    v_lshlrev_b32 v22, 16, v22
    v_mul_f32 v20, v20, v28
    v_mul_f32 v21, v21, v29
    v_mul_f32 v22, v22, v30
    v_mul_f32 v23, v23, v31
    v_cvt_pk_bf16_f32 v20, v20, v21
    v_and_b32 v21, s94, v20
    v_lshlrev_b32 v20, 16, v20
    v_cvt_pk_bf16_f32 v22, v22, v23
    v_and_b32 v23, s94, v22
    v_lshlrev_b32 v22, 16, v22
    s_waitcnt vmcnt(0)
    v_lshlrev_b32 v8, 16, v6
    v_and_b32 v9, s94, v6
    v_lshlrev_b32 v10, 16, v7
    v_and_b32 v11, s94, v7

    v_add_f32 v8, v8, v20
    v_add_f32 v9, v9, v21
    v_add_f32 v10, v10, v22
    v_add_f32 v11, v11, v23
    v_cvt_pk_bf16_f32 v12, v8, v9
    v_cvt_pk_bf16_f32 v13, v10, v11
    buffer_store_dwordx2 v[12:13], v2, s[36:39], 0 offen
L_fdone_120:
    s_endpgm

L_ffl_121:
    s_mov_b32 s3, 25600000
    buffer_load_dwordx4 v[12:15], v1, s[24:27], s3 offen
    s_waitcnt vmcnt(0)
    v_add_f32 v8, v8, v12
    v_add_f32 v9, v9, v13
    v_add_f32 v10, v10, v14
    v_add_f32 v11, v11, v15
    s_branch L_fbk_122

L_ffl_123:
    s_mov_b32 s3, 38400000
    buffer_load_dwordx4 v[12:15], v1, s[24:27], s3 offen
    s_waitcnt vmcnt(0)
    v_add_f32 v8, v8, v12
    v_add_f32 v9, v9, v13
    v_add_f32 v10, v10, v14
    v_add_f32 v11, v11, v15
    s_branch L_fbk_124

L_ffl_125:
    s_mov_b32 s3, 51200000
    buffer_load_dwordx4 v[12:15], v1, s[24:27], s3 offen
    s_waitcnt vmcnt(0)
    v_add_f32 v8, v8, v12
    v_add_f32 v9, v9, v13
    v_add_f32 v10, v10, v14
    v_add_f32 v11, v11, v15
    s_branch L_fbk_126

L_ffl_127:
    s_mov_b32 s3, 64000000
    buffer_load_dwordx4 v[12:15], v1, s[24:27], s3 offen
    s_waitcnt vmcnt(0)
    v_add_f32 v8, v8, v12
    v_add_f32 v9, v9, v13
    v_add_f32 v10, v10, v14
    v_add_f32 v11, v11, v15
    s_branch L_fbk_128

.section .rodata,"a"
.p2align 6
.amdhsa_kernel g0_kernel
  .amdhsa_next_free_vgpr 40
  .amdhsa_next_free_sgpr 32
  .amdhsa_accum_offset 40
  .amdhsa_group_segment_fixed_size 0
  .amdhsa_kernarg_size 112
  .amdhsa_user_sgpr_count 2
  .amdhsa_user_sgpr_kernarg_segment_ptr 1
  .amdhsa_system_sgpr_workgroup_id_x 1
.end_amdhsa_kernel
.p2align 6
.amdhsa_kernel g1_kernel
  .amdhsa_next_free_vgpr 128
  .amdhsa_next_free_sgpr 102
  .amdhsa_accum_offset 128
  .amdhsa_group_segment_fixed_size 0
  .amdhsa_kernarg_size 112
  .amdhsa_user_sgpr_count 2
  .amdhsa_user_sgpr_kernarg_segment_ptr 1
  .amdhsa_system_sgpr_workgroup_id_x 1
.end_amdhsa_kernel
.p2align 6
.amdhsa_kernel g2_kernel
  .amdhsa_next_free_vgpr 128
  .amdhsa_next_free_sgpr 102
  .amdhsa_accum_offset 128
  .amdhsa_group_segment_fixed_size 0
  .amdhsa_kernarg_size 112
  .amdhsa_user_sgpr_count 2
  .amdhsa_user_sgpr_kernarg_segment_ptr 1
  .amdhsa_system_sgpr_workgroup_id_x 1
  .amdhsa_float_denorm_mode_32 3
.end_amdhsa_kernel
.p2align 6
.amdhsa_kernel standalone__molecular_angular_gemnet__graph_kernel
  .amdhsa_next_free_vgpr 40
  .amdhsa_next_free_sgpr 100
  .amdhsa_accum_offset 40
  .amdhsa_group_segment_fixed_size 0
  .amdhsa_kernarg_size 112
  .amdhsa_user_sgpr_count 2
  .amdhsa_user_sgpr_kernarg_segment_ptr 1
  .amdhsa_system_sgpr_workgroup_id_x 1
  .amdhsa_float_denorm_mode_32 3
.end_amdhsa_kernel
```

```asm
; @launch kernel=g0_kernel grid=(256,1,1) block=(256,1,1) lds=0
; @launch kernel=g1_kernel grid=(256,1,1) block=(1024,1,1) lds=163840
; @launch kernel=g2_kernel grid=(256,1,1) block=(1024,1,1) lds=163840
; @launch kernel=standalone__molecular_angular_gemnet__graph_kernel grid=(3200,1,1) block=(256,1,1) lds=0
.amdgcn_target "amdgcn-amd-amdhsa--gfx950"
.text
.globl g0_kernel
.p2align 8
.type g0_kernel,@function
g0_kernel:
    s_cmp_ge_u32 s2, 256
    s_cbranch_scc1 L_k0done_1
    s_load_dwordx2 s[4:5], s[0:1], 0
    s_load_dwordx2 s[6:7], s[0:1], 104
    s_mul_i32 s3, s2, 25000
    v_lshlrev_b32 v1, 4, v0
    s_waitcnt lgkmcnt(0)

    s_add_u32 s8, s4, s3
    s_addc_u32 s9, s5, 0
    s_mov_b32 s10, 25000
    s_mov_b32 s11, 0x20000
    s_mov_b32 s12, s6
    s_mov_b32 s13, s7
    s_mov_b32 s14, 131328
    s_mov_b32 s15, 0x20000
    s_add_u32 s16, s6, 135168
    s_addc_u32 s17, s7, 0
    s_mov_b32 s18, 8192
    s_mov_b32 s19, 0x20000
    s_movk_i32 s20, 0
    buffer_load_dwordx4 v[4:7], v1, s[8:11], s20 offen
    s_movk_i32 s20, 4096
    buffer_load_dwordx4 v[8:11], v1, s[8:11], s20 offen
    s_movk_i32 s20, 8192
    buffer_load_dwordx4 v[12:15], v1, s[8:11], s20 offen
    s_movk_i32 s20, 12288
    buffer_load_dwordx4 v[16:19], v1, s[8:11], s20 offen
    s_movk_i32 s20, 16384
    buffer_load_dwordx4 v[20:23], v1, s[8:11], s20 offen
    s_movk_i32 s20, 20480
    buffer_load_dwordx4 v[24:27], v1, s[8:11], s20 offen
    s_movk_i32 s20, 24576
    buffer_load_dwordx4 v[28:31], v1, s[8:11], s20 offen
    s_lshl_b32 s21, s2, 12
    v_add_u32 v2, s21, v1
    v_mov_b32 v32, 0
    v_mov_b32 v33, 0
    v_mov_b32 v34, 0
    v_mov_b32 v35, 0
    buffer_store_dwordx4 v[32:35], v2, s[12:15], 0 offen
    s_mov_b32 s22, 0x7fff7fff
    s_waitcnt vmcnt(1)

    v_and_b32 v4, s22, v4
    v_and_b32 v5, s22, v5
    v_and_b32 v6, s22, v6
    v_and_b32 v7, s22, v7
    v_and_b32 v8, s22, v8
    v_and_b32 v9, s22, v9
    v_and_b32 v10, s22, v10
    v_and_b32 v11, s22, v11
    v_and_b32 v12, s22, v12
    v_and_b32 v13, s22, v13
    v_and_b32 v14, s22, v14
    v_and_b32 v15, s22, v15
    v_and_b32 v16, s22, v16
    v_and_b32 v17, s22, v17
    v_and_b32 v18, s22, v18
    v_and_b32 v19, s22, v19
    v_and_b32 v20, s22, v20
    v_and_b32 v21, s22, v21
    v_and_b32 v22, s22, v22
    v_and_b32 v23, s22, v23
    v_and_b32 v24, s22, v24
    v_and_b32 v25, s22, v25
    v_and_b32 v26, s22, v26
    v_and_b32 v27, s22, v27
    v_and_b32 v28, s22, v28
    v_and_b32 v29, s22, v29
    v_and_b32 v30, s22, v30
    v_and_b32 v31, s22, v31
    v_mov_b32 v37, 0
    v_dot2_f32_bf16 v37, v4, v4, v37
    v_dot2_f32_bf16 v37, v5, v5, v37
    v_dot2_f32_bf16 v37, v6, v6, v37
    v_dot2_f32_bf16 v37, v7, v7, v37
    v_dot2_f32_bf16 v37, v8, v8, v37
    v_dot2_f32_bf16 v37, v9, v9, v37
    v_dot2_f32_bf16 v37, v10, v10, v37
    v_dot2_f32_bf16 v37, v11, v11, v37
    v_dot2_f32_bf16 v37, v12, v12, v37
    v_dot2_f32_bf16 v37, v13, v13, v37
    v_dot2_f32_bf16 v37, v14, v14, v37
    v_dot2_f32_bf16 v37, v15, v15, v37
    v_dot2_f32_bf16 v37, v16, v16, v37
    v_dot2_f32_bf16 v37, v17, v17, v37
    v_dot2_f32_bf16 v37, v18, v18, v37
    v_dot2_f32_bf16 v37, v19, v19, v37
    v_dot2_f32_bf16 v37, v20, v20, v37
    v_dot2_f32_bf16 v37, v21, v21, v37
    v_dot2_f32_bf16 v37, v22, v22, v37
    v_dot2_f32_bf16 v37, v23, v23, v37
    v_dot2_f32_bf16 v37, v24, v24, v37
    v_dot2_f32_bf16 v37, v25, v25, v37
    v_dot2_f32_bf16 v37, v26, v26, v37
    v_dot2_f32_bf16 v37, v27, v27, v37
    v_dot2_f32_bf16 v37, v28, v28, v37
    v_dot2_f32_bf16 v37, v29, v29, v37
    v_dot2_f32_bf16 v37, v30, v30, v37
    v_dot2_f32_bf16 v37, v31, v31, v37
    v_pk_max_u16 v4, v4, v5
    v_pk_max_u16 v4, v4, v6
    v_pk_max_u16 v4, v4, v7
    v_pk_max_u16 v4, v4, v8
    v_pk_max_u16 v4, v4, v9
    v_pk_max_u16 v4, v4, v10
    v_pk_max_u16 v4, v4, v11
    v_pk_max_u16 v4, v4, v12
    v_pk_max_u16 v4, v4, v13
    v_pk_max_u16 v4, v4, v14
    v_pk_max_u16 v4, v4, v15
    v_pk_max_u16 v4, v4, v16
    v_pk_max_u16 v4, v4, v17
    v_pk_max_u16 v4, v4, v18
    v_pk_max_u16 v4, v4, v19
    v_pk_max_u16 v4, v4, v20
    v_pk_max_u16 v4, v4, v21
    v_pk_max_u16 v4, v4, v22
    v_pk_max_u16 v4, v4, v23
    v_pk_max_u16 v4, v4, v24
    v_pk_max_u16 v4, v4, v25
    v_pk_max_u16 v4, v4, v26
    v_pk_max_u16 v4, v4, v27
    v_pk_max_u16 v4, v4, v28
    v_pk_max_u16 v4, v4, v29
    v_pk_max_u16 v4, v4, v30
    v_pk_max_u16 v4, v4, v31
    v_lshrrev_b32 v5, 16, v4
    v_and_b32 v4, 0xffff, v4
    v_max_u32 v4, v4, v5

    s_nop 1
    v_max_u32_dpp v4, v4, v4 row_shr:1 row_mask:0xf bank_mask:0xf
    s_nop 1
    v_max_u32_dpp v4, v4, v4 row_shr:2 row_mask:0xf bank_mask:0xf
    s_nop 1
    v_max_u32_dpp v4, v4, v4 row_shr:4 row_mask:0xf bank_mask:0xf
    s_nop 1
    v_max_u32_dpp v4, v4, v4 row_shr:8 row_mask:0xf bank_mask:0xf
    s_nop 1
    v_max_u32_dpp v4, v4, v4 row_bcast:15 row_mask:0xa bank_mask:0xf
    s_nop 1
    v_max_u32_dpp v4, v4, v4 row_bcast:31 row_mask:0xc bank_mask:0xf
    v_mov_b32 v5, v37
    s_nop 1
    v_add_f32_dpp v5, v5, v5 row_shr:1 row_mask:0xf bank_mask:0xf
    s_nop 1
    v_add_f32_dpp v5, v5, v5 row_shr:2 row_mask:0xf bank_mask:0xf
    s_nop 1
    v_add_f32_dpp v5, v5, v5 row_shr:4 row_mask:0xf bank_mask:0xf
    s_nop 1
    v_add_f32_dpp v5, v5, v5 row_shr:8 row_mask:0xf bank_mask:0xf
    s_nop 1
    v_add_f32_dpp v5, v5, v5 row_bcast:15 row_mask:0xa bank_mask:0xf
    s_nop 1
    v_add_f32_dpp v5, v5, v5 row_bcast:31 row_mask:0xc bank_mask:0xf
    v_lshrrev_b32 v6, 6, v0
    s_lshl_b32 s21, s2, 2
    v_add_lshl_u32 v6, v6, s21, 3
    v_and_b32 v7, 63, v0
    v_cmp_eq_u32 vcc, 63, v7
    s_and_saveexec_b64 s[24:25], vcc
    buffer_store_dwordx2 v[4:5], v6, s[16:19], 0 offen
L_k0done_1:
    s_endpgm

.globl g1_kernel
.p2align 8
.type g1_kernel,@function
g1_kernel:
    s_cmp_ge_u32 s2, 256
    s_cbranch_scc1 L_p1done_2
    s_load_dwordx4 s[80:83], s[0:1], 8
    s_load_dwordx2 s[84:85], s[0:1], 32
    s_load_dwordx2 s[86:87], s[0:1], 48
    s_load_dwordx2 s[6:7], s[0:1], 104
    v_lshlrev_b32 v1, 4, v0
    v_lshlrev_b32 v2, 3, v0
    v_lshlrev_b32 v3, 2, v0
    s_waitcnt lgkmcnt(0)
    s_load_dword s88, s[86:87], 0

    s_mov_b32 s8, s80
    s_mov_b32 s9, s81
    s_mov_b32 s10, 0
    s_mov_b32 s11, 0x20000
    s_mov_b32 s12, s82
    s_mov_b32 s13, s83
    s_mov_b32 s14, 0
    s_mov_b32 s15, 0x20000
    s_mov_b32 s16, s84
    s_mov_b32 s17, s85
    s_mov_b32 s18, 0
    s_mov_b32 s19, 0x20000
    s_movk_i32 s49, 18240
    s_mul_i32 s78, s2, 18240
    s_mul_i32 s79, s2, 17600
    s_add_u32 s79, s79, 1638400
    s_cmp_ge_u32 s2, 2560
    s_cmovk_i32 s49, 17600
    s_cselect_b32 s78, s79, s78
    s_cmp_ge_u32 s2, 2816
    s_cmovk_i32 s49, 0
    s_cmovk_i32 s78, 0
    s_add_u32 s77, s49, s78
    s_lshl_b32 s10, s77, 2
    s_lshl_b32 s14, s77, 2
    s_lshl_b32 s18, s77, 1
    s_lshl_b32 s56, s78, 2
    s_lshl_b32 s61, s78, 1

    s_add_u32 s57, s56, 16384
    s_add_u32 s62, s61, 8192
    s_add_u32 s58, s56, 32768
    s_add_u32 s63, s61, 16384
    s_add_u32 s59, s56, 49152
    s_add_u32 s64, s61, 24576
    s_add_u32 s60, s56, 65536
    s_add_u32 s65, s61, 32768
    s_mov_b32 s41, s2
    buffer_load_dwordx4 v[22:25], v1, s[12:15], s56 offen nt
    buffer_load_dwordx4 v[4:7], v1, s[8:11], s56 offen nt
    buffer_load_dwordx2 v[40:41], v2, s[16:19], s61 offen nt
    buffer_load_dwordx4 v[26:29], v1, s[12:15], s57 offen nt
    buffer_load_dwordx4 v[8:11], v1, s[8:11], s57 offen nt
    buffer_load_dwordx2 v[42:43], v2, s[16:19], s62 offen nt
    buffer_load_dwordx4 v[30:33], v1, s[12:15], s58 offen nt
    buffer_load_dwordx4 v[12:15], v1, s[8:11], s58 offen nt
    buffer_load_dwordx2 v[44:45], v2, s[16:19], s63 offen nt
    buffer_load_dwordx4 v[34:37], v1, s[12:15], s59 offen nt
    buffer_load_dwordx4 v[16:19], v1, s[8:11], s59 offen nt
    buffer_load_dwordx2 v[46:47], v2, s[16:19], s64 offen nt
    buffer_load_dwordx2 v[38:39], v2, s[12:15], s60 offen nt
    buffer_load_dwordx2 v[20:21], v2, s[8:11], s60 offen nt
    buffer_load_dword v48, v3, s[16:19], s65 offen nt
    s_and_b32 s5, s2, 7
    s_mul_i32 s3, s5, 8192

    s_add_u32 s20, s6, s3
    s_addc_u32 s21, s7, 0
    s_mov_b32 s22, 8192
    s_mov_b32 s23, 0x20000
    s_mul_i32 s3, s5, 40632320
    s_add_u32 s3, s3, 77848576
    s_add_u32 s24, s6, s3
    s_addc_u32 s25, s7, 0
    s_mov_b32 s26, 40632320
    s_mov_b32 s27, 0x20000
    s_add_u32 s28, s6, s3
    s_addc_u32 s29, s7, 0
    s_mov_b32 s30, 40632320
    s_mov_b32 s31, 0x20000
    s_add_u32 s32, s6, 402907136
    s_addc_u32 s33, s7, 0
    s_mov_b32 s34, 409600000
    s_mov_b32 s35, 0x20000
    s_add_u32 s36, s6, 131072
    s_addc_u32 s37, s7, 0
    s_mov_b32 s38, 256
    s_mov_b32 s39, 0x20000
    s_mov_b32 s40, 687195
    s_mov_b32 s42, -6250
    s_mov_b32 s43, 1942
    s_mov_b32 s45, 0x06050400
    s_mov_b32 s46, 0x05040c00
    s_mov_b32 s47, 0x04020100
    s_mov_b32 s48, 3968
    s_mov_b32 s50, 0
    s_mov_b32 s51, 0
    s_mov_b32 s53, 0
    v_mov_b32 v104, 1
    v_mov_b32 v105, 0x46ff8000
    s_mov_b32 s55, 0x05040100
    v_mul_u32_u24 v49, 5, v0
    v_mov_b32 v106, 0
    v_mov_b32 v107, 0
    v_mov_b32 v108, 0
    v_mov_b32 v109, 0
    v_mov_b32 v110, 0
    v_mov_b32 v111, 0
    v_mov_b32 v113, 16384
    ds_write_b64 v2, v[106:107]
    v_mov_b32 v114, 0
    v_mov_b32 v115, 0
    v_mov_b32 v116, 0
    v_mov_b32 v117, -1
    s_mov_b64 exec, 1
    ds_write_b128 v113, v[114:117]
    s_mov_b64 exec, -1
    s_waitcnt lgkmcnt(0)
    s_lshl_b32 s88, s88, 16
    v_mov_b32 v114, 0.15915494
    v_mul_f32 v114, s88, v114
    s_nop 0
    v_readfirstlane_b32 s44, v114
    s_barrier

    s_mov_b32 s52, s51
    s_mov_b32 s51, s49
    s_sub_u32 s75, s51, 16384
    s_lshl_b32 s75, s75, 1
    v_cmp_gt_u32 s[66:67], s75, v3

    s_waitcnt vmcnt(12)
    v_mul_hi_u32_u24 v51, s40, v22
    v_mul_hi_u32_u24 v50, s40, v4
    v_mul_hi_u32_u24 v53, s40, v23
    v_mul_hi_u32_u24 v52, s40, v5
    v_mul_hi_u32_u24 v55, s40, v24
    v_mul_hi_u32_u24 v54, s40, v6
    v_mul_hi_u32_u24 v57, s40, v25
    v_mul_hi_u32_u24 v56, s40, v7
    v_and_b32 v51, -2, v51
    v_mad_u32_u24 v4, v50, s43, v4
    v_and_b32 v86, -4, v50
    v_and_b32 v53, -2, v53
    v_mad_u32_u24 v5, v52, s43, v5
    v_and_b32 v87, -4, v52
    v_and_b32 v55, -2, v55
    v_mad_u32_u24 v6, v54, s43, v6
    v_and_b32 v88, -4, v54
    v_and_b32 v57, -2, v57
    v_mad_u32_u24 v7, v56, s43, v7
    v_and_b32 v89, -4, v56
    v_mad_i32_i24 v22, v51, s42, v22
    v_lshl_add_u32 v51, v86, 5, v51
    v_mad_i32_i24 v23, v53, s42, v23
    v_lshl_add_u32 v53, v87, 5, v53
    v_mad_i32_i24 v24, v55, s42, v24
    v_lshl_add_u32 v55, v88, 5, v55
    v_mad_i32_i24 v25, v57, s42, v25
    v_lshl_add_u32 v57, v89, 5, v57
    v_add_u32 v51, v51, v51
    ds_add_rtn_u32 v86, v51, v104
    v_add_u32 v53, v53, v53
    ds_add_rtn_u32 v87, v53, v104
    v_add_u32 v55, v55, v55
    ds_add_rtn_u32 v88, v55, v104
    v_add_u32 v57, v57, v57
    ds_add_rtn_u32 v89, v57, v104
    v_lshlrev_b32 v114, 16, v40
    v_and_b32 v115, 0xffff0000, v40
    v_lshlrev_b32 v116, 16, v41
    v_and_b32 v117, 0xffff0000, v41
    v_mul_f32 v114, s44, v114
    v_mul_f32 v115, s44, v115
    v_mul_f32 v116, s44, v116
    v_mul_f32 v117, s44, v117
    v_fract_f32 v114, v114
    v_fract_f32 v115, v115
    v_fract_f32 v116, v116
    v_fract_f32 v117, v117
    v_cos_f32 v114, v114
    v_cos_f32 v115, v115
    v_cos_f32 v116, v116
    v_cos_f32 v117, v117
    v_lshl_or_b32 v50, v50, 14, v22
    v_perm_b32 v51, v51, v4, s46
    v_bfe_u32 v4, v4, 8, 5

    v_lshl_or_b32 v52, v52, 14, v23
    v_perm_b32 v53, v53, v5, s46
    v_bfe_u32 v5, v5, 8, 5

    v_lshl_or_b32 v54, v54, 14, v24
    v_perm_b32 v55, v55, v6, s46
    v_bfe_u32 v6, v6, 8, 5

    v_lshl_or_b32 v56, v56, 14, v25
    v_perm_b32 v57, v57, v7, s46
    v_bfe_u32 v7, v7, 8, 5

    v_fmaak_f32 v114, v114, v105, 0x4b400010
    v_fmaak_f32 v115, v115, v105, 0x4b400010
    v_fmaak_f32 v116, v116, v105, 0x4b400010
    v_fmaak_f32 v117, v117, v105, 0x4b400010
    v_sub_u32 v114, v114, v4
    v_sub_u32 v115, v115, v5
    v_sub_u32 v116, v116, v6
    v_sub_u32 v117, v117, v7
    v_bfi_b32 v114, 31, v4, v114
    v_bfi_b32 v115, 31, v5, v115
    v_bfi_b32 v116, 31, v6, v116
    v_bfi_b32 v117, 31, v7, v117
    v_perm_b32 v50, v50, v114, s55
    v_perm_b32 v52, v52, v115, s55
    v_perm_b32 v54, v54, v116, s55
    v_perm_b32 v56, v56, v117, s55
    v_mov_b32 v108, 1
    v_lshlrev_b32 v109, 20, v0
    buffer_atomic_add v108, v109, s[36:39], 0 offen offset:128 sc0
    s_waitcnt vmcnt(10)
    v_mul_hi_u32_u24 v59, s40, v26
    v_mul_hi_u32_u24 v58, s40, v8
    v_mul_hi_u32_u24 v61, s40, v27
    v_mul_hi_u32_u24 v60, s40, v9
    v_mul_hi_u32_u24 v63, s40, v28
    v_mul_hi_u32_u24 v62, s40, v10
    v_mul_hi_u32_u24 v65, s40, v29
    v_mul_hi_u32_u24 v64, s40, v11
    v_and_b32 v59, -2, v59
    v_mad_u32_u24 v8, v58, s43, v8
    v_and_b32 v90, -4, v58
    v_and_b32 v61, -2, v61
    v_mad_u32_u24 v9, v60, s43, v9
    v_and_b32 v91, -4, v60
    v_and_b32 v63, -2, v63
    v_mad_u32_u24 v10, v62, s43, v10
    v_and_b32 v92, -4, v62
    v_and_b32 v65, -2, v65
    v_mad_u32_u24 v11, v64, s43, v11
    v_and_b32 v93, -4, v64
    v_mad_i32_i24 v26, v59, s42, v26
    v_lshl_add_u32 v59, v90, 5, v59
    v_mad_i32_i24 v27, v61, s42, v27
    v_lshl_add_u32 v61, v91, 5, v61
    v_mad_i32_i24 v28, v63, s42, v28
    v_lshl_add_u32 v63, v92, 5, v63
    v_mad_i32_i24 v29, v65, s42, v29
    v_lshl_add_u32 v65, v93, 5, v65
    v_add_u32 v59, v59, v59
    ds_add_rtn_u32 v90, v59, v104
    v_add_u32 v61, v61, v61
    ds_add_rtn_u32 v91, v61, v104
    v_add_u32 v63, v63, v63
    ds_add_rtn_u32 v92, v63, v104
    v_add_u32 v65, v65, v65
    ds_add_rtn_u32 v93, v65, v104
    v_lshlrev_b32 v114, 16, v42
    v_and_b32 v115, 0xffff0000, v42
    v_lshlrev_b32 v116, 16, v43
    v_and_b32 v117, 0xffff0000, v43
    v_mul_f32 v114, s44, v114
    v_mul_f32 v115, s44, v115
    v_mul_f32 v116, s44, v116
    v_mul_f32 v117, s44, v117
    v_fract_f32 v114, v114
    v_fract_f32 v115, v115
    v_fract_f32 v116, v116
    v_fract_f32 v117, v117
    v_cos_f32 v114, v114
    v_cos_f32 v115, v115
    v_cos_f32 v116, v116
    v_cos_f32 v117, v117
    v_lshl_or_b32 v58, v58, 14, v26
    v_perm_b32 v59, v59, v8, s46
    v_bfe_u32 v8, v8, 8, 5

    v_lshl_or_b32 v60, v60, 14, v27
    v_perm_b32 v61, v61, v9, s46
    v_bfe_u32 v9, v9, 8, 5

    v_lshl_or_b32 v62, v62, 14, v28
    v_perm_b32 v63, v63, v10, s46
    v_bfe_u32 v10, v10, 8, 5

    v_lshl_or_b32 v64, v64, 14, v29
    v_perm_b32 v65, v65, v11, s46
    v_bfe_u32 v11, v11, 8, 5

    v_fmaak_f32 v114, v114, v105, 0x4b400010
    v_fmaak_f32 v115, v115, v105, 0x4b400010
    v_fmaak_f32 v116, v116, v105, 0x4b400010
    v_fmaak_f32 v117, v117, v105, 0x4b400010
    v_sub_u32 v114, v114, v8
    v_sub_u32 v115, v115, v9
    v_sub_u32 v116, v116, v10
    v_sub_u32 v117, v117, v11
    v_bfi_b32 v114, 31, v8, v114
    v_bfi_b32 v115, 31, v9, v115
    v_bfi_b32 v116, 31, v10, v116
    v_bfi_b32 v117, 31, v11, v117
    v_perm_b32 v58, v58, v114, s55
    v_perm_b32 v60, v60, v115, s55
    v_perm_b32 v62, v62, v116, s55
    v_perm_b32 v64, v64, v117, s55
    s_waitcnt vmcnt(7)
    v_mul_hi_u32_u24 v67, s40, v30
    v_mul_hi_u32_u24 v66, s40, v12
    v_mul_hi_u32_u24 v69, s40, v31
    v_mul_hi_u32_u24 v68, s40, v13
    v_mul_hi_u32_u24 v71, s40, v32
    v_mul_hi_u32_u24 v70, s40, v14
    v_mul_hi_u32_u24 v73, s40, v33
    v_mul_hi_u32_u24 v72, s40, v15
    v_and_b32 v67, -2, v67
    v_mad_u32_u24 v12, v66, s43, v12
    v_and_b32 v94, -4, v66
    v_and_b32 v69, -2, v69
    v_mad_u32_u24 v13, v68, s43, v13
    v_and_b32 v95, -4, v68
    v_and_b32 v71, -2, v71
    v_mad_u32_u24 v14, v70, s43, v14
    v_and_b32 v96, -4, v70
    v_and_b32 v73, -2, v73
    v_mad_u32_u24 v15, v72, s43, v15
    v_and_b32 v97, -4, v72
    v_mad_i32_i24 v30, v67, s42, v30
    v_lshl_add_u32 v67, v94, 5, v67
    v_mad_i32_i24 v31, v69, s42, v31
    v_lshl_add_u32 v69, v95, 5, v69
    v_mad_i32_i24 v32, v71, s42, v32
    v_lshl_add_u32 v71, v96, 5, v71
    v_mad_i32_i24 v33, v73, s42, v33
    v_lshl_add_u32 v73, v97, 5, v73
    v_add_u32 v67, v67, v67
    ds_add_rtn_u32 v94, v67, v104
    v_add_u32 v69, v69, v69
    ds_add_rtn_u32 v95, v69, v104
    v_add_u32 v71, v71, v71
    ds_add_rtn_u32 v96, v71, v104
    v_add_u32 v73, v73, v73
    ds_add_rtn_u32 v97, v73, v104
    v_lshlrev_b32 v114, 16, v44
    v_and_b32 v115, 0xffff0000, v44
    v_lshlrev_b32 v116, 16, v45
    v_and_b32 v117, 0xffff0000, v45
    v_mul_f32 v114, s44, v114
    v_mul_f32 v115, s44, v115
    v_mul_f32 v116, s44, v116
    v_mul_f32 v117, s44, v117
    v_fract_f32 v114, v114
    v_fract_f32 v115, v115
    v_fract_f32 v116, v116
    v_fract_f32 v117, v117
    v_cos_f32 v114, v114
    v_cos_f32 v115, v115
    v_cos_f32 v116, v116
    v_cos_f32 v117, v117
    v_lshl_or_b32 v66, v66, 14, v30
    v_perm_b32 v67, v67, v12, s46
    v_bfe_u32 v12, v12, 8, 5

    v_lshl_or_b32 v68, v68, 14, v31
    v_perm_b32 v69, v69, v13, s46
    v_bfe_u32 v13, v13, 8, 5

    v_lshl_or_b32 v70, v70, 14, v32
    v_perm_b32 v71, v71, v14, s46
    v_bfe_u32 v14, v14, 8, 5

    v_lshl_or_b32 v72, v72, 14, v33
    v_perm_b32 v73, v73, v15, s46
    v_bfe_u32 v15, v15, 8, 5

    v_fmaak_f32 v114, v114, v105, 0x4b400010
    v_fmaak_f32 v115, v115, v105, 0x4b400010
    v_fmaak_f32 v116, v116, v105, 0x4b400010
    v_fmaak_f32 v117, v117, v105, 0x4b400010
    v_sub_u32 v114, v114, v12
    v_sub_u32 v115, v115, v13
    v_sub_u32 v116, v116, v14
    v_sub_u32 v117, v117, v15
    v_bfi_b32 v114, 31, v12, v114
    v_bfi_b32 v115, 31, v13, v115
    v_bfi_b32 v116, 31, v14, v116
    v_bfi_b32 v117, 31, v15, v117
    v_perm_b32 v66, v66, v114, s55
    v_perm_b32 v68, v68, v115, s55
    v_perm_b32 v70, v70, v116, s55
    v_perm_b32 v72, v72, v117, s55
    s_waitcnt vmcnt(4)
    v_mul_hi_u32_u24 v75, s40, v34
    v_mul_hi_u32_u24 v74, s40, v16
    v_mul_hi_u32_u24 v77, s40, v35
    v_mul_hi_u32_u24 v76, s40, v17
    v_mul_hi_u32_u24 v79, s40, v36
    v_mul_hi_u32_u24 v78, s40, v18
    v_mul_hi_u32_u24 v81, s40, v37
    v_mul_hi_u32_u24 v80, s40, v19
    v_and_b32 v75, -2, v75
    v_mad_u32_u24 v16, v74, s43, v16
    v_and_b32 v98, -4, v74
    v_and_b32 v77, -2, v77
    v_mad_u32_u24 v17, v76, s43, v17
    v_and_b32 v99, -4, v76
    v_and_b32 v79, -2, v79
    v_mad_u32_u24 v18, v78, s43, v18
    v_and_b32 v100, -4, v78
    v_and_b32 v81, -2, v81
    v_mad_u32_u24 v19, v80, s43, v19
    v_and_b32 v101, -4, v80
    v_mad_i32_i24 v34, v75, s42, v34
    v_lshl_add_u32 v75, v98, 5, v75
    v_mad_i32_i24 v35, v77, s42, v35
    v_lshl_add_u32 v77, v99, 5, v77
    v_mad_i32_i24 v36, v79, s42, v36
    v_lshl_add_u32 v79, v100, 5, v79
    v_mad_i32_i24 v37, v81, s42, v37
    v_lshl_add_u32 v81, v101, 5, v81
    v_add_u32 v75, v75, v75
    ds_add_rtn_u32 v98, v75, v104
    v_add_u32 v77, v77, v77
    ds_add_rtn_u32 v99, v77, v104
    v_add_u32 v79, v79, v79
    ds_add_rtn_u32 v100, v79, v104
    v_add_u32 v81, v81, v81
    ds_add_rtn_u32 v101, v81, v104
    v_lshlrev_b32 v114, 16, v46
    v_and_b32 v115, 0xffff0000, v46
    v_lshlrev_b32 v116, 16, v47
    v_and_b32 v117, 0xffff0000, v47
    v_mul_f32 v114, s44, v114
    v_mul_f32 v115, s44, v115
    v_mul_f32 v116, s44, v116
    v_mul_f32 v117, s44, v117
    v_fract_f32 v114, v114
    v_fract_f32 v115, v115
    v_fract_f32 v116, v116
    v_fract_f32 v117, v117
    v_cos_f32 v114, v114
    v_cos_f32 v115, v115
    v_cos_f32 v116, v116
    v_cos_f32 v117, v117
    v_lshl_or_b32 v74, v74, 14, v34
    v_perm_b32 v75, v75, v16, s46
    v_bfe_u32 v16, v16, 8, 5

    v_lshl_or_b32 v76, v76, 14, v35
    v_perm_b32 v77, v77, v17, s46
    v_bfe_u32 v17, v17, 8, 5

    v_lshl_or_b32 v78, v78, 14, v36
    v_perm_b32 v79, v79, v18, s46
    v_bfe_u32 v18, v18, 8, 5

    v_lshl_or_b32 v80, v80, 14, v37
    v_perm_b32 v81, v81, v19, s46
    v_bfe_u32 v19, v19, 8, 5

    v_fmaak_f32 v114, v114, v105, 0x4b400010
    v_fmaak_f32 v115, v115, v105, 0x4b400010
    v_fmaak_f32 v116, v116, v105, 0x4b400010
    v_fmaak_f32 v117, v117, v105, 0x4b400010
    v_sub_u32 v114, v114, v16
    v_sub_u32 v115, v115, v17
    v_sub_u32 v116, v116, v18
    v_sub_u32 v117, v117, v19
    v_bfi_b32 v114, 31, v16, v114
    v_bfi_b32 v115, 31, v17, v115
    v_bfi_b32 v116, 31, v18, v116
    v_bfi_b32 v117, 31, v19, v117
    v_perm_b32 v74, v74, v114, s55
    v_perm_b32 v76, v76, v115, s55
    v_perm_b32 v78, v78, v116, s55
    v_perm_b32 v80, v80, v117, s55
    s_waitcnt vmcnt(1)
    s_mov_b64 exec, s[66:67]
    v_mul_hi_u32_u24 v83, s40, v38
    v_mul_hi_u32_u24 v82, s40, v20
    v_mul_hi_u32_u24 v85, s40, v39
    v_mul_hi_u32_u24 v84, s40, v21
    v_and_b32 v83, -2, v83
    v_mad_u32_u24 v20, v82, s43, v20
    v_and_b32 v102, -4, v82
    v_and_b32 v85, -2, v85
    v_mad_u32_u24 v21, v84, s43, v21
    v_and_b32 v103, -4, v84
    v_mad_i32_i24 v38, v83, s42, v38
    v_lshl_add_u32 v83, v102, 5, v83
    v_mad_i32_i24 v39, v85, s42, v39
    v_lshl_add_u32 v85, v103, 5, v85
    v_add_u32 v83, v83, v83
    ds_add_rtn_u32 v102, v83, v104
    v_add_u32 v85, v85, v85
    ds_add_rtn_u32 v103, v85, v104
    v_lshlrev_b32 v114, 16, v48
    v_and_b32 v115, 0xffff0000, v48
    v_mul_f32 v114, s44, v114
    v_mul_f32 v115, s44, v115
    v_fract_f32 v114, v114
    v_fract_f32 v115, v115
    v_cos_f32 v114, v114
    v_cos_f32 v115, v115
    v_lshl_or_b32 v82, v82, 14, v38
    v_perm_b32 v83, v83, v20, s46
    v_bfe_u32 v20, v20, 8, 5

    v_lshl_or_b32 v84, v84, 14, v39
    v_perm_b32 v85, v85, v21, s46
    v_bfe_u32 v21, v21, 8, 5

    v_fmaak_f32 v114, v114, v105, 0x4b400010
    v_fmaak_f32 v115, v115, v105, 0x4b400010
    v_sub_u32 v114, v114, v20
    v_sub_u32 v115, v115, v21
    v_bfi_b32 v114, 31, v20, v114
    v_bfi_b32 v115, 31, v21, v115
    v_perm_b32 v82, v82, v114, s55
    v_perm_b32 v84, v84, v115, s55
    s_mov_b64 exec, -1
    v_cmp_eq_u32 vcc, 0, v0
    s_waitcnt vmcnt(0)
    s_mov_b64 exec, vcc
    ds_write_b32 v113, v108 offset:8
    s_mov_b64 exec, -1
    s_waitcnt lgkmcnt(0)
    s_barrier

    ds_read_b32 v114, v113 offset:8
    ds_read_b64 v[108:109], v2
    s_waitcnt lgkmcnt(0)

    v_readfirstlane_b32 s41, v114
    v_and_b32 v108, 0xffff, v108
    v_and_b32 v109, 0xffff, v109
    v_add_u32 v106, v108, v108
    v_add_u32 v107, v109, v109
    v_add_u32 v111, v108, v109
    v_med3_u32 v106, v108, 2, v106
    v_med3_u32 v107, v109, 2, v107

    buffer_atomic_add_x2 v[106:107], v2, s[20:23], 0 offen sc0
    s_nop 1
    v_add_u32_dpp v111, v111, v111 row_shr:1 row_mask:0xf bank_mask:0xf
    s_nop 1
    v_add_u32_dpp v111, v111, v111 row_shr:2 row_mask:0xf bank_mask:0xf
    s_nop 1
    v_add_u32_dpp v111, v111, v111 row_shr:4 row_mask:0xf bank_mask:0xf
    s_nop 1
    v_add_u32_dpp v111, v111, v111 row_shr:8 row_mask:0xf bank_mask:0xf
    s_nop 1
    v_add_u32_dpp v111, v111, v111 row_bcast:15 row_mask:0xa bank_mask:0xf
    s_nop 1
    v_add_u32_dpp v111, v111, v111 row_bcast:31 row_mask:0xc bank_mask:0xf
    s_mov_b32 exec_lo, 0
    s_brev_b32 exec_hi, 1
    ds_add_rtn_u32 v110, v113, v111
    s_mov_b64 exec, -1

    s_add_u32 s41, s41, 256
    s_movk_i32 s49, 18240
    s_mul_i32 s78, s41, 18240
    s_mul_i32 s79, s41, 17600
    s_add_u32 s79, s79, 1638400
    s_cmp_ge_u32 s41, 2560
    s_cmovk_i32 s49, 17600
    s_cselect_b32 s78, s79, s78
    s_cmp_ge_u32 s41, 2816
    s_cmovk_i32 s49, 0
    s_cmovk_i32 s78, 0
    s_add_u32 s77, s49, s78
    s_lshl_b32 s10, s77, 2
    s_lshl_b32 s14, s77, 2
    s_lshl_b32 s18, s77, 1
    s_lshl_b32 s56, s78, 2
    s_lshl_b32 s61, s78, 1

    s_add_u32 s57, s56, 16384
    s_add_u32 s62, s61, 8192
    s_add_u32 s58, s56, 32768
    s_add_u32 s63, s61, 16384
    s_add_u32 s59, s56, 49152
    s_add_u32 s64, s61, 24576
    s_add_u32 s60, s56, 65536
    s_add_u32 s65, s61, 32768
    buffer_load_dwordx4 v[22:25], v1, s[12:15], s56 offen nt
    buffer_load_dwordx4 v[4:7], v1, s[8:11], s56 offen nt
    buffer_load_dwordx2 v[40:41], v2, s[16:19], s61 offen nt
    s_waitcnt lgkmcnt(0)
    v_readlane_b32 s77, v110, 63
    v_mul_u32_u24 v116, 7936, v0
    v_sub_u32 v111, v111, v109
    s_sub_u32 s77, s77, s50
    v_add_u32 v111, s77, v111
    v_sub_u32 v110, v111, v108
    v_lshlrev_b32 v115, 16, v111
    v_lshlrev_b32 v114, 16, v110
    ds_write_b64 v2, v[114:115]
    v_sub_u32 v110, v116, v110
    v_sub_u32 v111, v116, v111
    v_add_u32 v111, s48, v111
    s_lshl_b32 s74, s51, 3
    v_mov_b32 v126, s74
    v_mov_b32 v127, -1

    s_waitcnt lgkmcnt(0)
    s_barrier

    s_mov_b64 exec, 1
    ds_write_b32 v126, v127 offset:16404
    s_mov_b64 exec, -1

    v_lshrrev_b32 v114, 16, v51
    ds_read_b32 v114, v114
    v_lshrrev_b32 v115, 16, v53
    ds_read_b32 v115, v115
    v_lshrrev_b32 v116, 16, v55
    ds_read_b32 v116, v116
    v_lshrrev_b32 v117, 16, v57
    ds_read_b32 v117, v117
    v_lshrrev_b32 v118, 16, v59
    ds_read_b32 v118, v118
    v_lshrrev_b32 v119, 16, v61
    ds_read_b32 v119, v119
    v_lshrrev_b32 v120, 16, v63
    ds_read_b32 v120, v120
    v_lshrrev_b32 v121, 16, v65
    ds_read_b32 v121, v121
    s_waitcnt lgkmcnt(7)
    v_add_u32_sdwa v114, v114, v86 dst_sel:DWORD dst_unused:UNUSED_PAD src0_sel:WORD_1 src1_sel:WORD_0
    v_lshlrev_b32 v114, 3, v114
    ds_write_b64 v114, v[50:51] offset:16400

    s_waitcnt lgkmcnt(7)
    v_add_u32_sdwa v115, v115, v87 dst_sel:DWORD dst_unused:UNUSED_PAD src0_sel:WORD_1 src1_sel:WORD_0
    v_lshlrev_b32 v115, 3, v115
    ds_write_b64 v115, v[52:53] offset:16400

    s_waitcnt lgkmcnt(7)
    v_add_u32_sdwa v116, v116, v88 dst_sel:DWORD dst_unused:UNUSED_PAD src0_sel:WORD_1 src1_sel:WORD_0
    v_lshlrev_b32 v116, 3, v116
    ds_write_b64 v116, v[54:55] offset:16400

    s_waitcnt lgkmcnt(7)
    v_add_u32_sdwa v117, v117, v89 dst_sel:DWORD dst_unused:UNUSED_PAD src0_sel:WORD_1 src1_sel:WORD_0
    v_lshlrev_b32 v117, 3, v117
    ds_write_b64 v117, v[56:57] offset:16400

    s_waitcnt lgkmcnt(7)
    v_add_u32_sdwa v118, v118, v90 dst_sel:DWORD dst_unused:UNUSED_PAD src0_sel:WORD_1 src1_sel:WORD_0
    v_lshlrev_b32 v118, 3, v118
    ds_write_b64 v118, v[58:59] offset:16400

    s_waitcnt lgkmcnt(7)
    v_add_u32_sdwa v119, v119, v91 dst_sel:DWORD dst_unused:UNUSED_PAD src0_sel:WORD_1 src1_sel:WORD_0
    v_lshlrev_b32 v119, 3, v119
    ds_write_b64 v119, v[60:61] offset:16400

    s_waitcnt lgkmcnt(7)
    v_add_u32_sdwa v120, v120, v92 dst_sel:DWORD dst_unused:UNUSED_PAD src0_sel:WORD_1 src1_sel:WORD_0
    v_lshlrev_b32 v120, 3, v120
    ds_write_b64 v120, v[62:63] offset:16400

    s_waitcnt lgkmcnt(7)
    v_add_u32_sdwa v121, v121, v93 dst_sel:DWORD dst_unused:UNUSED_PAD src0_sel:WORD_1 src1_sel:WORD_0
    v_lshlrev_b32 v121, 3, v121
    ds_write_b64 v121, v[64:65] offset:16400

    buffer_load_dwordx4 v[26:29], v1, s[12:15], s57 offen nt
    buffer_load_dwordx4 v[8:11], v1, s[8:11], s57 offen nt
    buffer_load_dwordx2 v[42:43], v2, s[16:19], s62 offen nt
    v_lshrrev_b32 v114, 16, v67
    ds_read_b32 v114, v114
    v_lshrrev_b32 v115, 16, v69
    ds_read_b32 v115, v115
    v_lshrrev_b32 v116, 16, v71
    ds_read_b32 v116, v116
    v_lshrrev_b32 v117, 16, v73
    ds_read_b32 v117, v117
    v_lshrrev_b32 v118, 16, v75
    ds_read_b32 v118, v118
    v_lshrrev_b32 v119, 16, v77
    ds_read_b32 v119, v119
    v_lshrrev_b32 v120, 16, v79
    ds_read_b32 v120, v120
    v_lshrrev_b32 v121, 16, v81
    ds_read_b32 v121, v121
    s_waitcnt lgkmcnt(7)
    v_add_u32_sdwa v114, v114, v94 dst_sel:DWORD dst_unused:UNUSED_PAD src0_sel:WORD_1 src1_sel:WORD_0
    v_lshlrev_b32 v114, 3, v114
    ds_write_b64 v114, v[66:67] offset:16400

    s_waitcnt lgkmcnt(7)
    v_add_u32_sdwa v115, v115, v95 dst_sel:DWORD dst_unused:UNUSED_PAD src0_sel:WORD_1 src1_sel:WORD_0
    v_lshlrev_b32 v115, 3, v115
    ds_write_b64 v115, v[68:69] offset:16400

    s_waitcnt lgkmcnt(7)
    v_add_u32_sdwa v116, v116, v96 dst_sel:DWORD dst_unused:UNUSED_PAD src0_sel:WORD_1 src1_sel:WORD_0
    v_lshlrev_b32 v116, 3, v116
    ds_write_b64 v116, v[70:71] offset:16400

    s_waitcnt lgkmcnt(7)
    v_add_u32_sdwa v117, v117, v97 dst_sel:DWORD dst_unused:UNUSED_PAD src0_sel:WORD_1 src1_sel:WORD_0
    v_lshlrev_b32 v117, 3, v117
    ds_write_b64 v117, v[72:73] offset:16400

    s_waitcnt lgkmcnt(7)
    v_add_u32_sdwa v118, v118, v98 dst_sel:DWORD dst_unused:UNUSED_PAD src0_sel:WORD_1 src1_sel:WORD_0
    v_lshlrev_b32 v118, 3, v118
    ds_write_b64 v118, v[74:75] offset:16400

    s_waitcnt lgkmcnt(7)
    v_add_u32_sdwa v119, v119, v99 dst_sel:DWORD dst_unused:UNUSED_PAD src0_sel:WORD_1 src1_sel:WORD_0
    v_lshlrev_b32 v119, 3, v119
    ds_write_b64 v119, v[76:77] offset:16400

    s_waitcnt lgkmcnt(7)
    v_add_u32_sdwa v120, v120, v100 dst_sel:DWORD dst_unused:UNUSED_PAD src0_sel:WORD_1 src1_sel:WORD_0
    v_lshlrev_b32 v120, 3, v120
    ds_write_b64 v120, v[78:79] offset:16400

    s_waitcnt lgkmcnt(7)
    v_add_u32_sdwa v121, v121, v101 dst_sel:DWORD dst_unused:UNUSED_PAD src0_sel:WORD_1 src1_sel:WORD_0
    v_lshlrev_b32 v121, 3, v121
    ds_write_b64 v121, v[80:81] offset:16400

    s_mov_b64 exec, s[66:67]
    v_lshrrev_b32 v114, 16, v83
    ds_read_b32 v114, v114
    v_lshrrev_b32 v115, 16, v85
    ds_read_b32 v115, v115
    s_waitcnt lgkmcnt(1)
    v_add_u32_sdwa v114, v114, v102 dst_sel:DWORD dst_unused:UNUSED_PAD src0_sel:WORD_1 src1_sel:WORD_0
    v_lshlrev_b32 v114, 3, v114
    ds_write_b64 v114, v[82:83] offset:16400

    s_waitcnt lgkmcnt(1)
    v_add_u32_sdwa v115, v115, v103 dst_sel:DWORD dst_unused:UNUSED_PAD src0_sel:WORD_1 src1_sel:WORD_0
    v_lshlrev_b32 v115, 3, v115
    ds_write_b64 v115, v[84:85] offset:16400

    s_mov_b64 exec, -1
    s_add_u32 s50, s50, s51

    buffer_load_dwordx4 v[30:33], v1, s[12:15], s58 offen nt
    buffer_load_dwordx4 v[12:15], v1, s[8:11], s58 offen nt
    buffer_load_dwordx2 v[44:45], v2, s[16:19], s63 offen nt
    buffer_load_dwordx4 v[34:37], v1, s[12:15], s59 offen nt
    buffer_load_dwordx4 v[16:19], v1, s[8:11], s59 offen nt
    buffer_load_dwordx2 v[46:47], v2, s[16:19], s64 offen nt
    buffer_load_dwordx2 v[38:39], v2, s[12:15], s60 offen nt
    buffer_load_dwordx2 v[20:21], v2, s[8:11], s60 offen nt
    buffer_load_dword v48, v3, s[16:19], s65 offen nt
    s_cmp_eq_u32 s49, 0
    s_cbranch_scc1 L_p1epi_4
L_p1loop_3:
    s_mov_b32 s52, s51
    s_mov_b32 s51, s49
    s_sub_u32 s75, s51, 16384
    s_lshl_b32 s75, s75, 1
    v_cmp_gt_u32 s[66:67], s75, v3

    s_waitcnt vmcnt(12)
    v_mul_hi_u32_u24 v51, s40, v22
    v_mul_hi_u32_u24 v50, s40, v4
    v_mul_hi_u32_u24 v53, s40, v23
    v_mul_hi_u32_u24 v52, s40, v5
    v_mul_hi_u32_u24 v55, s40, v24
    v_mul_hi_u32_u24 v54, s40, v6
    v_mul_hi_u32_u24 v57, s40, v25
    v_mul_hi_u32_u24 v56, s40, v7
    v_and_b32 v51, -2, v51
    v_mad_u32_u24 v4, v50, s43, v4
    v_and_b32 v86, -4, v50
    v_and_b32 v53, -2, v53
    v_mad_u32_u24 v5, v52, s43, v5
    v_and_b32 v87, -4, v52
    v_and_b32 v55, -2, v55
    v_mad_u32_u24 v6, v54, s43, v6
    v_and_b32 v88, -4, v54
    v_and_b32 v57, -2, v57
    v_mad_u32_u24 v7, v56, s43, v7
    v_and_b32 v89, -4, v56
    v_mad_i32_i24 v22, v51, s42, v22
    v_lshl_add_u32 v51, v86, 5, v51
    v_mad_i32_i24 v23, v53, s42, v23
    v_lshl_add_u32 v53, v87, 5, v53
    v_mad_i32_i24 v24, v55, s42, v24
    v_lshl_add_u32 v55, v88, 5, v55
    v_mad_i32_i24 v25, v57, s42, v25
    v_lshl_add_u32 v57, v89, 5, v57
    v_add_u32 v51, v51, v51
    ds_add_rtn_u32 v86, v51, v104
    v_add_u32 v53, v53, v53
    ds_add_rtn_u32 v87, v53, v104
    v_add_u32 v55, v55, v55
    ds_add_rtn_u32 v88, v55, v104
    v_add_u32 v57, v57, v57
    ds_add_rtn_u32 v89, v57, v104
    v_lshlrev_b32 v114, 16, v40
    v_and_b32 v115, 0xffff0000, v40
    v_lshlrev_b32 v116, 16, v41
    v_and_b32 v117, 0xffff0000, v41
    v_mul_f32 v114, s44, v114
    v_mul_f32 v115, s44, v115
    v_mul_f32 v116, s44, v116
    v_mul_f32 v117, s44, v117
    v_fract_f32 v114, v114
    v_fract_f32 v115, v115
    v_fract_f32 v116, v116
    v_fract_f32 v117, v117
    v_cos_f32 v114, v114
    v_cos_f32 v115, v115
    v_cos_f32 v116, v116
    v_cos_f32 v117, v117
    v_lshl_or_b32 v50, v50, 14, v22
    v_perm_b32 v51, v51, v4, s46
    v_bfe_u32 v4, v4, 8, 5

    v_lshl_or_b32 v52, v52, 14, v23
    v_perm_b32 v53, v53, v5, s46
    v_bfe_u32 v5, v5, 8, 5

    v_lshl_or_b32 v54, v54, 14, v24
    v_perm_b32 v55, v55, v6, s46
    v_bfe_u32 v6, v6, 8, 5

    v_lshl_or_b32 v56, v56, 14, v25
    v_perm_b32 v57, v57, v7, s46
    v_bfe_u32 v7, v7, 8, 5

    v_fmaak_f32 v114, v114, v105, 0x4b400010
    v_fmaak_f32 v115, v115, v105, 0x4b400010
    v_fmaak_f32 v116, v116, v105, 0x4b400010
    v_fmaak_f32 v117, v117, v105, 0x4b400010
    v_sub_u32 v114, v114, v4
    v_sub_u32 v115, v115, v5
    v_sub_u32 v116, v116, v6
    v_sub_u32 v117, v117, v7
    v_bfi_b32 v114, 31, v4, v114
    v_bfi_b32 v115, 31, v5, v115
    v_bfi_b32 v116, 31, v6, v116
    v_bfi_b32 v117, 31, v7, v117
    v_perm_b32 v50, v50, v114, s55
    v_perm_b32 v52, v52, v115, s55
    v_perm_b32 v54, v54, v116, s55
    v_perm_b32 v56, v56, v117, s55
    s_waitcnt vmcnt(15)
    v_add_u32 v114, v106, v108
    v_add_u32 v115, v107, v109
    v_max_u32 v114, v114, v115
    v_cmp_le_u32 vcc, s48, v114
    v_min_u32 v106, s48, v106
    v_min_u32 v107, s48, v107
    v_add_u32 v106, v106, v110
    v_add_u32 v107, v107, v111
    v_lshl_add_u32 v106, v106, 2, v106
    v_lshl_add_u32 v107, v107, 2, v107
    ds_write_b64 v2, v[106:107] offset:8192
    s_cbranch_vccz L_noov_5
    ds_write_b32 v113, v104 offset:4
L_noov_5:
    s_sub_u32 s74, s52, 17408
    s_max_i32 s74, s74, 0
    v_cmp_gt_u32 s[68:69], s74, v0
    s_waitcnt lgkmcnt(0)
    s_barrier
    ds_read_b32 v114, v113 offset:4
    s_waitcnt lgkmcnt(0)
    v_readfirstlane_b32 s53, v114
    s_nop 1
    s_cmp_lg_u32 s53, 0
    s_cbranch_scc1 L_slow_6
L_sback_7:

    v_mov_b32 v108, 1
    v_lshlrev_b32 v109, 20, v0
    buffer_atomic_add v108, v109, s[36:39], 0 offen offset:128 sc0
    ds_read_b64 v[114:115], v2 offset:16400
    ds_read_b64 v[116:117], v2 offset:16408
    ds_read_b64 v[118:119], v2 offset:16392

    ds_read_b64 v[120:121], v2 offset:24592
    ds_read_b64 v[122:123], v2 offset:24600
    ds_read_b64 v[124:125], v2 offset:24584

    s_waitcnt lgkmcnt(3)
    v_lshrrev_b32 v126, 16, v115
    ds_read_b32 v126, v126 offset:8192

    s_waitcnt lgkmcnt(1)
    v_lshrrev_b32 v127, 16, v121
    ds_read_b32 v127, v127 offset:8192

    v_cmp_ne_u32_sdwa s[70:71], v115, v117 src0_sel:WORD_1 src1_sel:WORD_1
    v_cmp_ne_u32_sdwa vcc, v115, v119 src0_sel:WORD_1 src1_sel:WORD_1
    v_perm_b32 v115, v116, v115, s45
    s_mov_b32 s54, 0
    v_alignbyte_b32 v118, v119, v118, 2
    s_waitcnt lgkmcnt(1)
    v_add3_u32 v126, v126, v49, s54

    s_and_b64 exec, vcc, s[70:71]
    v_and_b32 v115, 0xff, v115
    s_andn2_b64 exec, s[70:71], vcc
    v_alignbyte_b32 v115, v115, v114, 1
    v_perm_b32 v114, v114, v118, s47
    v_subrev_u32 v126, 3, v126
    s_mov_b64 exec, -1

    buffer_store_dwordx2 v[114:115], v126, s[24:27], 0 offen
    v_cmp_ne_u32_sdwa s[70:71], v121, v123 src0_sel:WORD_1 src1_sel:WORD_1
    v_cmp_ne_u32_sdwa vcc, v121, v125 src0_sel:WORD_1 src1_sel:WORD_1
    v_perm_b32 v121, v122, v121, s45
    s_mov_b32 s54, 5120
    v_alignbyte_b32 v124, v125, v124, 2
    s_waitcnt lgkmcnt(0)
    v_add3_u32 v127, v127, v49, s54

    s_and_b64 exec, vcc, s[70:71]
    v_and_b32 v121, 0xff, v121
    s_andn2_b64 exec, s[70:71], vcc
    v_alignbyte_b32 v121, v121, v120, 1
    v_perm_b32 v120, v120, v124, s47
    v_subrev_u32 v127, 3, v127
    s_mov_b64 exec, -1

    buffer_store_dwordx2 v[120:121], v127, s[24:27], 0 offen
    ds_read_b64 v[114:115], v2 offset:32784
    ds_read_b64 v[116:117], v2 offset:32792
    ds_read_b64 v[118:119], v2 offset:32776

    ds_read_b64 v[120:121], v2 offset:40976
    ds_read_b64 v[122:123], v2 offset:40984
    ds_read_b64 v[124:125], v2 offset:40968

    s_waitcnt lgkmcnt(3)
    v_lshrrev_b32 v126, 16, v115
    ds_read_b32 v126, v126 offset:8192

    s_waitcnt lgkmcnt(1)
    v_lshrrev_b32 v127, 16, v121
    ds_read_b32 v127, v127 offset:8192

    v_cmp_ne_u32_sdwa s[70:71], v115, v117 src0_sel:WORD_1 src1_sel:WORD_1
    v_cmp_ne_u32_sdwa vcc, v115, v119 src0_sel:WORD_1 src1_sel:WORD_1
    v_perm_b32 v115, v116, v115, s45
    s_mov_b32 s54, 10240
    v_alignbyte_b32 v118, v119, v118, 2
    s_waitcnt lgkmcnt(1)
    v_add3_u32 v126, v126, v49, s54

    s_and_b64 exec, vcc, s[70:71]
    v_and_b32 v115, 0xff, v115
    s_andn2_b64 exec, s[70:71], vcc
    v_alignbyte_b32 v115, v115, v114, 1
    v_perm_b32 v114, v114, v118, s47
    v_subrev_u32 v126, 3, v126
    s_mov_b64 exec, -1

    buffer_store_dwordx2 v[114:115], v126, s[24:27], 0 offen
    v_cmp_ne_u32_sdwa s[70:71], v121, v123 src0_sel:WORD_1 src1_sel:WORD_1
    v_cmp_ne_u32_sdwa vcc, v121, v125 src0_sel:WORD_1 src1_sel:WORD_1
    v_perm_b32 v121, v122, v121, s45
    s_mov_b32 s54, 15360
    v_alignbyte_b32 v124, v125, v124, 2
    s_waitcnt lgkmcnt(0)
    v_add3_u32 v127, v127, v49, s54

    s_and_b64 exec, vcc, s[70:71]
    v_and_b32 v121, 0xff, v121
    s_andn2_b64 exec, s[70:71], vcc
    v_alignbyte_b32 v121, v121, v120, 1
    v_perm_b32 v120, v120, v124, s47
    v_subrev_u32 v127, 3, v127
    s_mov_b64 exec, -1

    buffer_store_dwordx2 v[120:121], v127, s[24:27], 0 offen
    s_waitcnt vmcnt(14)
    v_mul_hi_u32_u24 v59, s40, v26
    v_mul_hi_u32_u24 v58, s40, v8
    v_mul_hi_u32_u24 v61, s40, v27
    v_mul_hi_u32_u24 v60, s40, v9
    v_mul_hi_u32_u24 v63, s40, v28
    v_mul_hi_u32_u24 v62, s40, v10
    v_mul_hi_u32_u24 v65, s40, v29
    v_mul_hi_u32_u24 v64, s40, v11
    v_and_b32 v59, -2, v59
    v_mad_u32_u24 v8, v58, s43, v8
    v_and_b32 v90, -4, v58
    v_and_b32 v61, -2, v61
    v_mad_u32_u24 v9, v60, s43, v9
    v_and_b32 v91, -4, v60
    v_and_b32 v63, -2, v63
    v_mad_u32_u24 v10, v62, s43, v10
    v_and_b32 v92, -4, v62
    v_and_b32 v65, -2, v65
    v_mad_u32_u24 v11, v64, s43, v11
    v_and_b32 v93, -4, v64
    v_mad_i32_i24 v26, v59, s42, v26
    v_lshl_add_u32 v59, v90, 5, v59
    v_mad_i32_i24 v27, v61, s42, v27
    v_lshl_add_u32 v61, v91, 5, v61
    v_mad_i32_i24 v28, v63, s42, v28
    v_lshl_add_u32 v63, v92, 5, v63
    v_mad_i32_i24 v29, v65, s42, v29
    v_lshl_add_u32 v65, v93, 5, v65
    v_add_u32 v59, v59, v59
    ds_add_rtn_u32 v90, v59, v104
    v_add_u32 v61, v61, v61
    ds_add_rtn_u32 v91, v61, v104
    v_add_u32 v63, v63, v63
    ds_add_rtn_u32 v92, v63, v104
    v_add_u32 v65, v65, v65
    ds_add_rtn_u32 v93, v65, v104
    v_lshlrev_b32 v114, 16, v42
    v_and_b32 v115, 0xffff0000, v42
    v_lshlrev_b32 v116, 16, v43
    v_and_b32 v117, 0xffff0000, v43
    v_mul_f32 v114, s44, v114
    v_mul_f32 v115, s44, v115
    v_mul_f32 v116, s44, v116
    v_mul_f32 v117, s44, v117
    v_fract_f32 v114, v114
    v_fract_f32 v115, v115
    v_fract_f32 v116, v116
    v_fract_f32 v117, v117
    v_cos_f32 v114, v114
    v_cos_f32 v115, v115
    v_cos_f32 v116, v116
    v_cos_f32 v117, v117
    v_lshl_or_b32 v58, v58, 14, v26
    v_perm_b32 v59, v59, v8, s46
    v_bfe_u32 v8, v8, 8, 5

    v_lshl_or_b32 v60, v60, 14, v27
    v_perm_b32 v61, v61, v9, s46
    v_bfe_u32 v9, v9, 8, 5

    v_lshl_or_b32 v62, v62, 14, v28
    v_perm_b32 v63, v63, v10, s46
    v_bfe_u32 v10, v10, 8, 5

    v_lshl_or_b32 v64, v64, 14, v29
    v_perm_b32 v65, v65, v11, s46
    v_bfe_u32 v11, v11, 8, 5

    v_fmaak_f32 v114, v114, v105, 0x4b400010
    v_fmaak_f32 v115, v115, v105, 0x4b400010
    v_fmaak_f32 v116, v116, v105, 0x4b400010
    v_fmaak_f32 v117, v117, v105, 0x4b400010
    v_sub_u32 v114, v114, v8
    v_sub_u32 v115, v115, v9
    v_sub_u32 v116, v116, v10
    v_sub_u32 v117, v117, v11
    v_bfi_b32 v114, 31, v8, v114
    v_bfi_b32 v115, 31, v9, v115
    v_bfi_b32 v116, 31, v10, v116
    v_bfi_b32 v117, 31, v11, v117
    v_perm_b32 v58, v58, v114, s55
    v_perm_b32 v60, v60, v115, s55
    v_perm_b32 v62, v62, v116, s55
    v_perm_b32 v64, v64, v117, s55
    ds_read_b64 v[114:115], v2 offset:49168
    ds_read_b64 v[116:117], v2 offset:49176
    ds_read_b64 v[118:119], v2 offset:49160

    ds_read_b64 v[120:121], v2 offset:57360
    ds_read_b64 v[122:123], v2 offset:57368
    ds_read_b64 v[124:125], v2 offset:57352

    s_waitcnt lgkmcnt(3)
    v_lshrrev_b32 v126, 16, v115
    ds_read_b32 v126, v126 offset:8192

    s_waitcnt lgkmcnt(1)
    v_lshrrev_b32 v127, 16, v121
    ds_read_b32 v127, v127 offset:8192

    v_cmp_ne_u32_sdwa s[70:71], v115, v117 src0_sel:WORD_1 src1_sel:WORD_1
    v_cmp_ne_u32_sdwa vcc, v115, v119 src0_sel:WORD_1 src1_sel:WORD_1
    v_perm_b32 v115, v116, v115, s45
    s_mov_b32 s54, 20480
    v_alignbyte_b32 v118, v119, v118, 2
    s_waitcnt lgkmcnt(1)
    v_add3_u32 v126, v126, v49, s54

    s_and_b64 exec, vcc, s[70:71]
    v_and_b32 v115, 0xff, v115
    s_andn2_b64 exec, s[70:71], vcc
    v_alignbyte_b32 v115, v115, v114, 1
    v_perm_b32 v114, v114, v118, s47
    v_subrev_u32 v126, 3, v126
    s_mov_b64 exec, -1

    buffer_store_dwordx2 v[114:115], v126, s[24:27], 0 offen
    v_cmp_ne_u32_sdwa s[70:71], v121, v123 src0_sel:WORD_1 src1_sel:WORD_1
    v_cmp_ne_u32_sdwa vcc, v121, v125 src0_sel:WORD_1 src1_sel:WORD_1
    v_perm_b32 v121, v122, v121, s45
    s_mov_b32 s54, 25600
    v_alignbyte_b32 v124, v125, v124, 2
    s_waitcnt lgkmcnt(0)
    v_add3_u32 v127, v127, v49, s54

    s_and_b64 exec, vcc, s[70:71]
    v_and_b32 v121, 0xff, v121
    s_andn2_b64 exec, s[70:71], vcc
    v_alignbyte_b32 v121, v121, v120, 1
    v_perm_b32 v120, v120, v124, s47
    v_subrev_u32 v127, 3, v127
    s_mov_b64 exec, -1

    buffer_store_dwordx2 v[120:121], v127, s[24:27], 0 offen
    v_add_u32 v112, 65536, v2
    ds_read_b64 v[114:115], v112 offset:16
    ds_read_b64 v[116:117], v112 offset:24
    ds_read_b64 v[118:119], v112 offset:8

    ds_read_b64 v[120:121], v112 offset:8208
    ds_read_b64 v[122:123], v112 offset:8216
    ds_read_b64 v[124:125], v112 offset:8200

    s_waitcnt lgkmcnt(3)
    v_lshrrev_b32 v126, 16, v115
    ds_read_b32 v126, v126 offset:8192

    s_waitcnt lgkmcnt(1)
    v_lshrrev_b32 v127, 16, v121
    ds_read_b32 v127, v127 offset:8192

    v_cmp_ne_u32_sdwa s[70:71], v115, v117 src0_sel:WORD_1 src1_sel:WORD_1
    v_cmp_ne_u32_sdwa vcc, v115, v119 src0_sel:WORD_1 src1_sel:WORD_1
    v_perm_b32 v115, v116, v115, s45
    s_mov_b32 s54, 30720
    v_alignbyte_b32 v118, v119, v118, 2
    s_waitcnt lgkmcnt(1)
    v_add3_u32 v126, v126, v49, s54

    s_and_b64 exec, vcc, s[70:71]
    v_and_b32 v115, 0xff, v115
    s_andn2_b64 exec, s[70:71], vcc
    v_alignbyte_b32 v115, v115, v114, 1
    v_perm_b32 v114, v114, v118, s47
    v_subrev_u32 v126, 3, v126
    s_mov_b64 exec, -1

    buffer_store_dwordx2 v[114:115], v126, s[24:27], 0 offen
    v_cmp_ne_u32_sdwa s[70:71], v121, v123 src0_sel:WORD_1 src1_sel:WORD_1
    v_cmp_ne_u32_sdwa vcc, v121, v125 src0_sel:WORD_1 src1_sel:WORD_1
    v_perm_b32 v121, v122, v121, s45
    s_mov_b32 s54, 35840
    v_alignbyte_b32 v124, v125, v124, 2
    s_waitcnt lgkmcnt(0)
    v_add3_u32 v127, v127, v49, s54

    s_and_b64 exec, vcc, s[70:71]
    v_and_b32 v121, 0xff, v121
    s_andn2_b64 exec, s[70:71], vcc
    v_alignbyte_b32 v121, v121, v120, 1
    v_perm_b32 v120, v120, v124, s47
    v_subrev_u32 v127, 3, v127
    s_mov_b64 exec, -1

    buffer_store_dwordx2 v[120:121], v127, s[24:27], 0 offen
    s_waitcnt vmcnt(15)
    v_mul_hi_u32_u24 v67, s40, v30
    v_mul_hi_u32_u24 v66, s40, v12
    v_mul_hi_u32_u24 v69, s40, v31
    v_mul_hi_u32_u24 v68, s40, v13
    v_mul_hi_u32_u24 v71, s40, v32
    v_mul_hi_u32_u24 v70, s40, v14
    v_mul_hi_u32_u24 v73, s40, v33
    v_mul_hi_u32_u24 v72, s40, v15
    v_and_b32 v67, -2, v67
    v_mad_u32_u24 v12, v66, s43, v12
    v_and_b32 v94, -4, v66
    v_and_b32 v69, -2, v69
    v_mad_u32_u24 v13, v68, s43, v13
    v_and_b32 v95, -4, v68
    v_and_b32 v71, -2, v71
    v_mad_u32_u24 v14, v70, s43, v14
    v_and_b32 v96, -4, v70
    v_and_b32 v73, -2, v73
    v_mad_u32_u24 v15, v72, s43, v15
    v_and_b32 v97, -4, v72
    v_mad_i32_i24 v30, v67, s42, v30
    v_lshl_add_u32 v67, v94, 5, v67
    v_mad_i32_i24 v31, v69, s42, v31
    v_lshl_add_u32 v69, v95, 5, v69
    v_mad_i32_i24 v32, v71, s42, v32
    v_lshl_add_u32 v71, v96, 5, v71
    v_mad_i32_i24 v33, v73, s42, v33
    v_lshl_add_u32 v73, v97, 5, v73
    v_add_u32 v67, v67, v67
    ds_add_rtn_u32 v94, v67, v104
    v_add_u32 v69, v69, v69
    ds_add_rtn_u32 v95, v69, v104
    v_add_u32 v71, v71, v71
    ds_add_rtn_u32 v96, v71, v104
    v_add_u32 v73, v73, v73
    ds_add_rtn_u32 v97, v73, v104
    v_lshlrev_b32 v114, 16, v44
    v_and_b32 v115, 0xffff0000, v44
    v_lshlrev_b32 v116, 16, v45
    v_and_b32 v117, 0xffff0000, v45
    v_mul_f32 v114, s44, v114
    v_mul_f32 v115, s44, v115
    v_mul_f32 v116, s44, v116
    v_mul_f32 v117, s44, v117
    v_fract_f32 v114, v114
    v_fract_f32 v115, v115
    v_fract_f32 v116, v116
    v_fract_f32 v117, v117
    v_cos_f32 v114, v114
    v_cos_f32 v115, v115
    v_cos_f32 v116, v116
    v_cos_f32 v117, v117
    v_lshl_or_b32 v66, v66, 14, v30
    v_perm_b32 v67, v67, v12, s46
    v_bfe_u32 v12, v12, 8, 5

    v_lshl_or_b32 v68, v68, 14, v31
    v_perm_b32 v69, v69, v13, s46
    v_bfe_u32 v13, v13, 8, 5

    v_lshl_or_b32 v70, v70, 14, v32
    v_perm_b32 v71, v71, v14, s46
    v_bfe_u32 v14, v14, 8, 5

    v_lshl_or_b32 v72, v72, 14, v33
    v_perm_b32 v73, v73, v15, s46
    v_bfe_u32 v15, v15, 8, 5

    v_fmaak_f32 v114, v114, v105, 0x4b400010
    v_fmaak_f32 v115, v115, v105, 0x4b400010
    v_fmaak_f32 v116, v116, v105, 0x4b400010
    v_fmaak_f32 v117, v117, v105, 0x4b400010
    v_sub_u32 v114, v114, v12
    v_sub_u32 v115, v115, v13
    v_sub_u32 v116, v116, v14
    v_sub_u32 v117, v117, v15
    v_bfi_b32 v114, 31, v12, v114
    v_bfi_b32 v115, 31, v13, v115
    v_bfi_b32 v116, 31, v14, v116
    v_bfi_b32 v117, 31, v15, v117
    v_perm_b32 v66, v66, v114, s55
    v_perm_b32 v68, v68, v115, s55
    v_perm_b32 v70, v70, v116, s55
    v_perm_b32 v72, v72, v117, s55
    ds_read_b64 v[114:115], v112 offset:16400
    ds_read_b64 v[116:117], v112 offset:16408
    ds_read_b64 v[118:119], v112 offset:16392

    ds_read_b64 v[120:121], v112 offset:24592
    ds_read_b64 v[122:123], v112 offset:24600
    ds_read_b64 v[124:125], v112 offset:24584

    s_waitcnt lgkmcnt(3)
    v_lshrrev_b32 v126, 16, v115
    ds_read_b32 v126, v126 offset:8192

    s_waitcnt lgkmcnt(1)
    v_lshrrev_b32 v127, 16, v121
    ds_read_b32 v127, v127 offset:8192

    v_cmp_ne_u32_sdwa s[70:71], v115, v117 src0_sel:WORD_1 src1_sel:WORD_1
    v_cmp_ne_u32_sdwa vcc, v115, v119 src0_sel:WORD_1 src1_sel:WORD_1
    v_perm_b32 v115, v116, v115, s45
    s_mov_b32 s54, 40960
    v_alignbyte_b32 v118, v119, v118, 2
    s_waitcnt lgkmcnt(1)
    v_add3_u32 v126, v126, v49, s54

    s_and_b64 exec, vcc, s[70:71]
    v_and_b32 v115, 0xff, v115
    s_andn2_b64 exec, s[70:71], vcc
    v_alignbyte_b32 v115, v115, v114, 1
    v_perm_b32 v114, v114, v118, s47
    v_subrev_u32 v126, 3, v126
    s_mov_b64 exec, -1

    buffer_store_dwordx2 v[114:115], v126, s[24:27], 0 offen
    v_cmp_ne_u32_sdwa s[70:71], v121, v123 src0_sel:WORD_1 src1_sel:WORD_1
    v_cmp_ne_u32_sdwa vcc, v121, v125 src0_sel:WORD_1 src1_sel:WORD_1
    v_perm_b32 v121, v122, v121, s45
    s_mov_b32 s54, 46080
    v_alignbyte_b32 v124, v125, v124, 2
    s_waitcnt lgkmcnt(0)
    v_add3_u32 v127, v127, v49, s54

    s_and_b64 exec, vcc, s[70:71]
    v_and_b32 v121, 0xff, v121
    s_andn2_b64 exec, s[70:71], vcc
    v_alignbyte_b32 v121, v121, v120, 1
    v_perm_b32 v120, v120, v124, s47
    v_subrev_u32 v127, 3, v127
    s_mov_b64 exec, -1

    buffer_store_dwordx2 v[120:121], v127, s[24:27], 0 offen
    ds_read_b64 v[114:115], v112 offset:32784
    ds_read_b64 v[116:117], v112 offset:32792
    ds_read_b64 v[118:119], v112 offset:32776

    ds_read_b64 v[120:121], v112 offset:40976
    ds_read_b64 v[122:123], v112 offset:40984
    ds_read_b64 v[124:125], v112 offset:40968

    s_waitcnt lgkmcnt(3)
    v_lshrrev_b32 v126, 16, v115
    ds_read_b32 v126, v126 offset:8192

    s_waitcnt lgkmcnt(1)
    v_lshrrev_b32 v127, 16, v121
    ds_read_b32 v127, v127 offset:8192

    v_cmp_ne_u32_sdwa s[70:71], v115, v117 src0_sel:WORD_1 src1_sel:WORD_1
    v_cmp_ne_u32_sdwa vcc, v115, v119 src0_sel:WORD_1 src1_sel:WORD_1
    v_perm_b32 v115, v116, v115, s45
    s_mov_b32 s54, 51200
    v_alignbyte_b32 v118, v119, v118, 2
    s_waitcnt lgkmcnt(1)
    v_add3_u32 v126, v126, v49, s54

    s_and_b64 exec, vcc, s[70:71]
    v_and_b32 v115, 0xff, v115
    s_andn2_b64 exec, s[70:71], vcc
    v_alignbyte_b32 v115, v115, v114, 1
    v_perm_b32 v114, v114, v118, s47
    v_subrev_u32 v126, 3, v126
    s_mov_b64 exec, -1

    buffer_store_dwordx2 v[114:115], v126, s[24:27], 0 offen
    v_cmp_ne_u32_sdwa s[70:71], v121, v123 src0_sel:WORD_1 src1_sel:WORD_1
    v_cmp_ne_u32_sdwa vcc, v121, v125 src0_sel:WORD_1 src1_sel:WORD_1
    v_perm_b32 v121, v122, v121, s45
    s_mov_b32 s54, 56320
    v_alignbyte_b32 v124, v125, v124, 2
    s_waitcnt lgkmcnt(0)
    v_add3_u32 v127, v127, v49, s54

    s_and_b64 exec, vcc, s[70:71]
    v_and_b32 v121, 0xff, v121
    s_andn2_b64 exec, s[70:71], vcc
    v_alignbyte_b32 v121, v121, v120, 1
    v_perm_b32 v120, v120, v124, s47
    v_subrev_u32 v127, 3, v127
    s_mov_b64 exec, -1

    buffer_store_dwordx2 v[120:121], v127, s[24:27], 0 offen
    s_waitcnt vmcnt(16)
    v_mul_hi_u32_u24 v75, s40, v34
    v_mul_hi_u32_u24 v74, s40, v16
    v_mul_hi_u32_u24 v77, s40, v35
    v_mul_hi_u32_u24 v76, s40, v17
    v_mul_hi_u32_u24 v79, s40, v36
    v_mul_hi_u32_u24 v78, s40, v18
    v_mul_hi_u32_u24 v81, s40, v37
    v_mul_hi_u32_u24 v80, s40, v19
    v_and_b32 v75, -2, v75
    v_mad_u32_u24 v16, v74, s43, v16
    v_and_b32 v98, -4, v74
    v_and_b32 v77, -2, v77
    v_mad_u32_u24 v17, v76, s43, v17
    v_and_b32 v99, -4, v76
    v_and_b32 v79, -2, v79
    v_mad_u32_u24 v18, v78, s43, v18
    v_and_b32 v100, -4, v78
    v_and_b32 v81, -2, v81
    v_mad_u32_u24 v19, v80, s43, v19
    v_and_b32 v101, -4, v80
    v_mad_i32_i24 v34, v75, s42, v34
    v_lshl_add_u32 v75, v98, 5, v75
    v_mad_i32_i24 v35, v77, s42, v35
    v_lshl_add_u32 v77, v99, 5, v77
    v_mad_i32_i24 v36, v79, s42, v36
    v_lshl_add_u32 v79, v100, 5, v79
    v_mad_i32_i24 v37, v81, s42, v37
    v_lshl_add_u32 v81, v101, 5, v81
    v_add_u32 v75, v75, v75
    ds_add_rtn_u32 v98, v75, v104
    v_add_u32 v77, v77, v77
    ds_add_rtn_u32 v99, v77, v104
    v_add_u32 v79, v79, v79
    ds_add_rtn_u32 v100, v79, v104
    v_add_u32 v81, v81, v81
    ds_add_rtn_u32 v101, v81, v104
    v_lshlrev_b32 v114, 16, v46
    v_and_b32 v115, 0xffff0000, v46
    v_lshlrev_b32 v116, 16, v47
    v_and_b32 v117, 0xffff0000, v47
    v_mul_f32 v114, s44, v114
    v_mul_f32 v115, s44, v115
    v_mul_f32 v116, s44, v116
    v_mul_f32 v117, s44, v117
    v_fract_f32 v114, v114
    v_fract_f32 v115, v115
    v_fract_f32 v116, v116
    v_fract_f32 v117, v117
    v_cos_f32 v114, v114
    v_cos_f32 v115, v115
    v_cos_f32 v116, v116
    v_cos_f32 v117, v117
    v_lshl_or_b32 v74, v74, 14, v34
    v_perm_b32 v75, v75, v16, s46
    v_bfe_u32 v16, v16, 8, 5

    v_lshl_or_b32 v76, v76, 14, v35
    v_perm_b32 v77, v77, v17, s46
    v_bfe_u32 v17, v17, 8, 5

    v_lshl_or_b32 v78, v78, 14, v36
    v_perm_b32 v79, v79, v18, s46
    v_bfe_u32 v18, v18, 8, 5

    v_lshl_or_b32 v80, v80, 14, v37
    v_perm_b32 v81, v81, v19, s46
    v_bfe_u32 v19, v19, 8, 5

    v_fmaak_f32 v114, v114, v105, 0x4b400010
    v_fmaak_f32 v115, v115, v105, 0x4b400010
    v_fmaak_f32 v116, v116, v105, 0x4b400010
    v_fmaak_f32 v117, v117, v105, 0x4b400010
    v_sub_u32 v114, v114, v16
    v_sub_u32 v115, v115, v17
    v_sub_u32 v116, v116, v18
    v_sub_u32 v117, v117, v19
    v_bfi_b32 v114, 31, v16, v114
    v_bfi_b32 v115, 31, v17, v115
    v_bfi_b32 v116, 31, v18, v116
    v_bfi_b32 v117, 31, v19, v117
    v_perm_b32 v74, v74, v114, s55
    v_perm_b32 v76, v76, v115, s55
    v_perm_b32 v78, v78, v116, s55
    v_perm_b32 v80, v80, v117, s55
    ds_read_b64 v[114:115], v112 offset:49168
    ds_read_b64 v[116:117], v112 offset:49176
    ds_read_b64 v[118:119], v112 offset:49160

    ds_read_b64 v[120:121], v112 offset:57360
    ds_read_b64 v[122:123], v112 offset:57368
    ds_read_b64 v[124:125], v112 offset:57352

    s_waitcnt lgkmcnt(3)
    v_lshrrev_b32 v126, 16, v115
    ds_read_b32 v126, v126 offset:8192

    s_waitcnt lgkmcnt(1)
    v_lshrrev_b32 v127, 16, v121
    ds_read_b32 v127, v127 offset:8192

    v_cmp_ne_u32_sdwa s[70:71], v115, v117 src0_sel:WORD_1 src1_sel:WORD_1
    v_cmp_ne_u32_sdwa vcc, v115, v119 src0_sel:WORD_1 src1_sel:WORD_1
    v_perm_b32 v115, v116, v115, s45
    s_mov_b32 s54, 61440
    v_alignbyte_b32 v118, v119, v118, 2
    s_waitcnt lgkmcnt(1)
    v_add3_u32 v126, v126, v49, s54

    s_and_b64 exec, vcc, s[70:71]
    v_and_b32 v115, 0xff, v115
    s_andn2_b64 exec, s[70:71], vcc
    v_alignbyte_b32 v115, v115, v114, 1
    v_perm_b32 v114, v114, v118, s47
    v_subrev_u32 v126, 3, v126
    s_mov_b64 exec, -1

    buffer_store_dwordx2 v[114:115], v126, s[24:27], 0 offen
    v_cmp_ne_u32_sdwa s[70:71], v121, v123 src0_sel:WORD_1 src1_sel:WORD_1
    v_cmp_ne_u32_sdwa vcc, v121, v125 src0_sel:WORD_1 src1_sel:WORD_1
    v_perm_b32 v121, v122, v121, s45
    s_mov_b32 s54, 66560
    v_alignbyte_b32 v124, v125, v124, 2
    s_waitcnt lgkmcnt(0)
    v_add3_u32 v127, v127, v49, s54

    s_and_b64 exec, vcc, s[70:71]
    v_and_b32 v121, 0xff, v121
    s_andn2_b64 exec, s[70:71], vcc
    v_alignbyte_b32 v121, v121, v120, 1
    v_perm_b32 v120, v120, v124, s47
    v_subrev_u32 v127, 3, v127
    s_mov_b64 exec, -1

    buffer_store_dwordx2 v[120:121], v127, s[24:27], 0 offen
    v_add_u32 v112, 131072, v2
    ds_read_b64 v[114:115], v112 offset:16
    ds_read_b64 v[116:117], v112 offset:24
    ds_read_b64 v[118:119], v112 offset:8

    ds_read_b64 v[120:121], v112 offset:8208
    ds_read_b64 v[122:123], v112 offset:8216
    ds_read_b64 v[124:125], v112 offset:8200

    s_waitcnt lgkmcnt(3)
    v_lshrrev_b32 v126, 16, v115
    ds_read_b32 v126, v126 offset:8192

    s_waitcnt lgkmcnt(1)
    v_lshrrev_b32 v127, 16, v121
    ds_read_b32 v127, v127 offset:8192

    v_cmp_ne_u32_sdwa s[70:71], v115, v117 src0_sel:WORD_1 src1_sel:WORD_1
    v_cmp_ne_u32_sdwa vcc, v115, v119 src0_sel:WORD_1 src1_sel:WORD_1
    v_perm_b32 v115, v116, v115, s45
    s_mov_b32 s54, 71680
    v_alignbyte_b32 v118, v119, v118, 2
    s_waitcnt lgkmcnt(1)
    v_add3_u32 v126, v126, v49, s54

    s_and_b64 exec, vcc, s[70:71]
    v_and_b32 v115, 0xff, v115
    s_andn2_b64 exec, s[70:71], vcc
    v_alignbyte_b32 v115, v115, v114, 1
    v_perm_b32 v114, v114, v118, s47
    v_subrev_u32 v126, 3, v126
    s_mov_b64 exec, -1

    buffer_store_dwordx2 v[114:115], v126, s[24:27], 0 offen
    v_cmp_ne_u32_sdwa s[70:71], v121, v123 src0_sel:WORD_1 src1_sel:WORD_1
    v_cmp_ne_u32_sdwa vcc, v121, v125 src0_sel:WORD_1 src1_sel:WORD_1
    v_perm_b32 v121, v122, v121, s45
    s_mov_b32 s54, 76800
    v_alignbyte_b32 v124, v125, v124, 2
    s_waitcnt lgkmcnt(0)
    v_add3_u32 v127, v127, v49, s54

    s_and_b64 exec, vcc, s[70:71]
    v_and_b32 v121, 0xff, v121
    s_andn2_b64 exec, s[70:71], vcc
    v_alignbyte_b32 v121, v121, v120, 1
    v_perm_b32 v120, v120, v124, s47
    v_subrev_u32 v127, 3, v127
    s_mov_b64 exec, -1

    buffer_store_dwordx2 v[120:121], v127, s[24:27], 0 offen
    s_waitcnt vmcnt(17)
    s_mov_b64 exec, s[66:67]
    v_mul_hi_u32_u24 v83, s40, v38
    v_mul_hi_u32_u24 v82, s40, v20
    v_mul_hi_u32_u24 v85, s40, v39
    v_mul_hi_u32_u24 v84, s40, v21
    v_and_b32 v83, -2, v83
    v_mad_u32_u24 v20, v82, s43, v20
    v_and_b32 v102, -4, v82
    v_and_b32 v85, -2, v85
    v_mad_u32_u24 v21, v84, s43, v21
    v_and_b32 v103, -4, v84
    v_mad_i32_i24 v38, v83, s42, v38
    v_lshl_add_u32 v83, v102, 5, v83
    v_mad_i32_i24 v39, v85, s42, v39
    v_lshl_add_u32 v85, v103, 5, v85
    v_add_u32 v83, v83, v83
    ds_add_rtn_u32 v102, v83, v104
    v_add_u32 v85, v85, v85
    ds_add_rtn_u32 v103, v85, v104
    v_lshlrev_b32 v114, 16, v48
    v_and_b32 v115, 0xffff0000, v48
    v_mul_f32 v114, s44, v114
    v_mul_f32 v115, s44, v115
    v_fract_f32 v114, v114
    v_fract_f32 v115, v115
    v_cos_f32 v114, v114
    v_cos_f32 v115, v115
    v_lshl_or_b32 v82, v82, 14, v38
    v_perm_b32 v83, v83, v20, s46
    v_bfe_u32 v20, v20, 8, 5

    v_lshl_or_b32 v84, v84, 14, v39
    v_perm_b32 v85, v85, v21, s46
    v_bfe_u32 v21, v21, 8, 5

    v_fmaak_f32 v114, v114, v105, 0x4b400010
    v_fmaak_f32 v115, v115, v105, 0x4b400010
    v_sub_u32 v114, v114, v20
    v_sub_u32 v115, v115, v21
    v_bfi_b32 v114, 31, v20, v114
    v_bfi_b32 v115, 31, v21, v115
    v_perm_b32 v82, v82, v114, s55
    v_perm_b32 v84, v84, v115, s55
    s_mov_b64 exec, -1
    v_cmp_eq_u32 vcc, 0, v0
    s_waitcnt vmcnt(16)
    s_mov_b64 exec, vcc
    ds_write_b32 v113, v108 offset:8
    s_mov_b64 exec, -1
    s_waitcnt lgkmcnt(0)
    s_barrier

    ds_read_b32 v114, v113 offset:8
    ds_read_b64 v[108:109], v2
    s_waitcnt lgkmcnt(0)

    v_readfirstlane_b32 s41, v114
    v_and_b32 v108, 0xffff, v108
    v_and_b32 v109, 0xffff, v109
    v_add_u32 v106, v108, v108
    v_add_u32 v107, v109, v109
    v_add_u32 v111, v108, v109
    v_med3_u32 v106, v108, 2, v106
    v_med3_u32 v107, v109, 2, v107

    buffer_atomic_add_x2 v[106:107], v2, s[20:23], 0 offen sc0
    s_nop 1
    v_add_u32_dpp v111, v111, v111 row_shr:1 row_mask:0xf bank_mask:0xf
    s_nop 1
    v_add_u32_dpp v111, v111, v111 row_shr:2 row_mask:0xf bank_mask:0xf
    s_nop 1
    v_add_u32_dpp v111, v111, v111 row_shr:4 row_mask:0xf bank_mask:0xf
    s_nop 1
    v_add_u32_dpp v111, v111, v111 row_shr:8 row_mask:0xf bank_mask:0xf
    s_nop 1
    v_add_u32_dpp v111, v111, v111 row_bcast:15 row_mask:0xa bank_mask:0xf
    s_nop 1
    v_add_u32_dpp v111, v111, v111 row_bcast:31 row_mask:0xc bank_mask:0xf
    s_mov_b32 exec_lo, 0
    s_brev_b32 exec_hi, 1
    ds_add_rtn_u32 v110, v113, v111
    s_mov_b64 exec, -1

    s_add_u32 s41, s41, 256
    s_movk_i32 s49, 18240
    s_mul_i32 s78, s41, 18240
    s_mul_i32 s79, s41, 17600
    s_add_u32 s79, s79, 1638400
    s_cmp_ge_u32 s41, 2560
    s_cmovk_i32 s49, 17600
    s_cselect_b32 s78, s79, s78
    s_cmp_ge_u32 s41, 2816
    s_cmovk_i32 s49, 0
    s_cmovk_i32 s78, 0
    s_add_u32 s77, s49, s78
    s_lshl_b32 s10, s77, 2
    s_lshl_b32 s14, s77, 2
    s_lshl_b32 s18, s77, 1
    s_lshl_b32 s56, s78, 2
    s_lshl_b32 s61, s78, 1

    s_add_u32 s57, s56, 16384
    s_add_u32 s62, s61, 8192
    s_add_u32 s58, s56, 32768
    s_add_u32 s63, s61, 16384
    s_add_u32 s59, s56, 49152
    s_add_u32 s64, s61, 24576
    s_add_u32 s60, s56, 65536
    s_add_u32 s65, s61, 32768
    buffer_load_dwordx4 v[22:25], v1, s[12:15], s56 offen nt
    buffer_load_dwordx4 v[4:7], v1, s[8:11], s56 offen nt
    buffer_load_dwordx2 v[40:41], v2, s[16:19], s61 offen nt
    ds_read_b64 v[114:115], v112 offset:16400
    ds_read_b64 v[116:117], v112 offset:16408
    ds_read_b64 v[118:119], v112 offset:16392

    ds_read_b64 v[120:121], v112 offset:24592
    ds_read_b64 v[122:123], v112 offset:24600
    ds_read_b64 v[124:125], v112 offset:24584

    s_waitcnt lgkmcnt(3)
    v_lshrrev_b32 v126, 16, v115
    ds_read_b32 v126, v126 offset:8192

    s_waitcnt lgkmcnt(1)
    v_lshrrev_b32 v127, 16, v121
    ds_read_b32 v127, v127 offset:8192

    v_cmp_ne_u32_sdwa s[70:71], v115, v117 src0_sel:WORD_1 src1_sel:WORD_1
    v_cmp_ne_u32_sdwa vcc, v115, v119 src0_sel:WORD_1 src1_sel:WORD_1
    v_perm_b32 v115, v116, v115, s45
    s_mov_b32 s54, 81920
    v_alignbyte_b32 v118, v119, v118, 2
    s_waitcnt lgkmcnt(1)
    v_add3_u32 v126, v126, v49, s54

    s_and_b64 exec, vcc, s[70:71]
    v_and_b32 v115, 0xff, v115
    s_andn2_b64 exec, s[70:71], vcc
    v_alignbyte_b32 v115, v115, v114, 1
    v_perm_b32 v114, v114, v118, s47
    v_subrev_u32 v126, 3, v126
    s_mov_b64 exec, -1

    buffer_store_dwordx2 v[114:115], v126, s[24:27], 0 offen
    v_cmp_ne_u32_sdwa s[70:71], v121, v123 src0_sel:WORD_1 src1_sel:WORD_1
    v_cmp_ne_u32_sdwa vcc, v121, v125 src0_sel:WORD_1 src1_sel:WORD_1
    v_perm_b32 v121, v122, v121, s45
    s_mov_b32 s54, 87040
    v_alignbyte_b32 v124, v125, v124, 2
    s_waitcnt lgkmcnt(0)
    v_add3_u32 v127, v127, v49, s54

    s_andn2_b64 exec, -1, s[68:69]
    v_bfrev_b32 v127, 1

    s_and_b64 exec, vcc, s[70:71]
    v_and_b32 v121, 0xff, v121
    s_andn2_b64 exec, s[70:71], vcc
    v_alignbyte_b32 v121, v121, v120, 1
    v_perm_b32 v120, v120, v124, s47
    v_subrev_u32 v127, 3, v127
    s_mov_b64 exec, -1

    buffer_store_dwordx2 v[120:121], v127, s[24:27], 0 offen
    s_waitcnt lgkmcnt(0)
    v_readlane_b32 s77, v110, 63
    v_mul_u32_u24 v116, 7936, v0
    v_sub_u32 v111, v111, v109
    s_sub_u32 s77, s77, s50
    v_add_u32 v111, s77, v111
    v_sub_u32 v110, v111, v108
    v_lshlrev_b32 v115, 16, v111
    v_lshlrev_b32 v114, 16, v110
    ds_write_b64 v2, v[114:115]
    v_sub_u32 v110, v116, v110
    v_sub_u32 v111, v116, v111
    v_add_u32 v111, s48, v111
    s_lshl_b32 s74, s51, 3
    v_mov_b32 v126, s74
    v_mov_b32 v127, -1

    s_waitcnt lgkmcnt(0)
    s_barrier

    s_mov_b64 exec, 1
    ds_write_b32 v126, v127 offset:16404
    s_mov_b64 exec, -1

    v_lshrrev_b32 v114, 16, v51
    ds_read_b32 v114, v114
    v_lshrrev_b32 v115, 16, v53
    ds_read_b32 v115, v115
    v_lshrrev_b32 v116, 16, v55
    ds_read_b32 v116, v116
    v_lshrrev_b32 v117, 16, v57
    ds_read_b32 v117, v117
    v_lshrrev_b32 v118, 16, v59
    ds_read_b32 v118, v118
    v_lshrrev_b32 v119, 16, v61
    ds_read_b32 v119, v119
    v_lshrrev_b32 v120, 16, v63
    ds_read_b32 v120, v120
    v_lshrrev_b32 v121, 16, v65
    ds_read_b32 v121, v121
    s_waitcnt lgkmcnt(7)
    v_add_u32_sdwa v114, v114, v86 dst_sel:DWORD dst_unused:UNUSED_PAD src0_sel:WORD_1 src1_sel:WORD_0
    v_lshlrev_b32 v114, 3, v114
    ds_write_b64 v114, v[50:51] offset:16400

    s_waitcnt lgkmcnt(7)
    v_add_u32_sdwa v115, v115, v87 dst_sel:DWORD dst_unused:UNUSED_PAD src0_sel:WORD_1 src1_sel:WORD_0
    v_lshlrev_b32 v115, 3, v115
    ds_write_b64 v115, v[52:53] offset:16400

    s_waitcnt lgkmcnt(7)
    v_add_u32_sdwa v116, v116, v88 dst_sel:DWORD dst_unused:UNUSED_PAD src0_sel:WORD_1 src1_sel:WORD_0
    v_lshlrev_b32 v116, 3, v116
    ds_write_b64 v116, v[54:55] offset:16400

    s_waitcnt lgkmcnt(7)
    v_add_u32_sdwa v117, v117, v89 dst_sel:DWORD dst_unused:UNUSED_PAD src0_sel:WORD_1 src1_sel:WORD_0
    v_lshlrev_b32 v117, 3, v117
    ds_write_b64 v117, v[56:57] offset:16400

    s_waitcnt lgkmcnt(7)
    v_add_u32_sdwa v118, v118, v90 dst_sel:DWORD dst_unused:UNUSED_PAD src0_sel:WORD_1 src1_sel:WORD_0
    v_lshlrev_b32 v118, 3, v118
    ds_write_b64 v118, v[58:59] offset:16400

    s_waitcnt lgkmcnt(7)
    v_add_u32_sdwa v119, v119, v91 dst_sel:DWORD dst_unused:UNUSED_PAD src0_sel:WORD_1 src1_sel:WORD_0
    v_lshlrev_b32 v119, 3, v119
    ds_write_b64 v119, v[60:61] offset:16400

    s_waitcnt lgkmcnt(7)
    v_add_u32_sdwa v120, v120, v92 dst_sel:DWORD dst_unused:UNUSED_PAD src0_sel:WORD_1 src1_sel:WORD_0
    v_lshlrev_b32 v120, 3, v120
    ds_write_b64 v120, v[62:63] offset:16400

    s_waitcnt lgkmcnt(7)
    v_add_u32_sdwa v121, v121, v93 dst_sel:DWORD dst_unused:UNUSED_PAD src0_sel:WORD_1 src1_sel:WORD_0
    v_lshlrev_b32 v121, 3, v121
    ds_write_b64 v121, v[64:65] offset:16400

    buffer_load_dwordx4 v[26:29], v1, s[12:15], s57 offen nt
    buffer_load_dwordx4 v[8:11], v1, s[8:11], s57 offen nt
    buffer_load_dwordx2 v[42:43], v2, s[16:19], s62 offen nt
    v_lshrrev_b32 v114, 16, v67
    ds_read_b32 v114, v114
    v_lshrrev_b32 v115, 16, v69
    ds_read_b32 v115, v115
    v_lshrrev_b32 v116, 16, v71
    ds_read_b32 v116, v116
    v_lshrrev_b32 v117, 16, v73
    ds_read_b32 v117, v117
    v_lshrrev_b32 v118, 16, v75
    ds_read_b32 v118, v118
    v_lshrrev_b32 v119, 16, v77
    ds_read_b32 v119, v119
    v_lshrrev_b32 v120, 16, v79
    ds_read_b32 v120, v120
    v_lshrrev_b32 v121, 16, v81
    ds_read_b32 v121, v121
    s_waitcnt lgkmcnt(7)
    v_add_u32_sdwa v114, v114, v94 dst_sel:DWORD dst_unused:UNUSED_PAD src0_sel:WORD_1 src1_sel:WORD_0
    v_lshlrev_b32 v114, 3, v114
    ds_write_b64 v114, v[66:67] offset:16400

    s_waitcnt lgkmcnt(7)
    v_add_u32_sdwa v115, v115, v95 dst_sel:DWORD dst_unused:UNUSED_PAD src0_sel:WORD_1 src1_sel:WORD_0
    v_lshlrev_b32 v115, 3, v115
    ds_write_b64 v115, v[68:69] offset:16400

    s_waitcnt lgkmcnt(7)
    v_add_u32_sdwa v116, v116, v96 dst_sel:DWORD dst_unused:UNUSED_PAD src0_sel:WORD_1 src1_sel:WORD_0
    v_lshlrev_b32 v116, 3, v116
    ds_write_b64 v116, v[70:71] offset:16400

    s_waitcnt lgkmcnt(7)
    v_add_u32_sdwa v117, v117, v97 dst_sel:DWORD dst_unused:UNUSED_PAD src0_sel:WORD_1 src1_sel:WORD_0
    v_lshlrev_b32 v117, 3, v117
    ds_write_b64 v117, v[72:73] offset:16400

    s_waitcnt lgkmcnt(7)
    v_add_u32_sdwa v118, v118, v98 dst_sel:DWORD dst_unused:UNUSED_PAD src0_sel:WORD_1 src1_sel:WORD_0
    v_lshlrev_b32 v118, 3, v118
    ds_write_b64 v118, v[74:75] offset:16400

    s_waitcnt lgkmcnt(7)
    v_add_u32_sdwa v119, v119, v99 dst_sel:DWORD dst_unused:UNUSED_PAD src0_sel:WORD_1 src1_sel:WORD_0
    v_lshlrev_b32 v119, 3, v119
    ds_write_b64 v119, v[76:77] offset:16400

    s_waitcnt lgkmcnt(7)
    v_add_u32_sdwa v120, v120, v100 dst_sel:DWORD dst_unused:UNUSED_PAD src0_sel:WORD_1 src1_sel:WORD_0
    v_lshlrev_b32 v120, 3, v120
    ds_write_b64 v120, v[78:79] offset:16400

    s_waitcnt lgkmcnt(7)
    v_add_u32_sdwa v121, v121, v101 dst_sel:DWORD dst_unused:UNUSED_PAD src0_sel:WORD_1 src1_sel:WORD_0
    v_lshlrev_b32 v121, 3, v121
    ds_write_b64 v121, v[80:81] offset:16400

    s_mov_b64 exec, s[66:67]
    v_lshrrev_b32 v114, 16, v83
    ds_read_b32 v114, v114
    v_lshrrev_b32 v115, 16, v85
    ds_read_b32 v115, v115
    s_waitcnt lgkmcnt(1)
    v_add_u32_sdwa v114, v114, v102 dst_sel:DWORD dst_unused:UNUSED_PAD src0_sel:WORD_1 src1_sel:WORD_0
    v_lshlrev_b32 v114, 3, v114
    ds_write_b64 v114, v[82:83] offset:16400

    s_waitcnt lgkmcnt(1)
    v_add_u32_sdwa v115, v115, v103 dst_sel:DWORD dst_unused:UNUSED_PAD src0_sel:WORD_1 src1_sel:WORD_0
    v_lshlrev_b32 v115, 3, v115
    ds_write_b64 v115, v[84:85] offset:16400

    s_mov_b64 exec, -1
    s_add_u32 s50, s50, s51

    buffer_load_dwordx4 v[30:33], v1, s[12:15], s58 offen nt
    buffer_load_dwordx4 v[12:15], v1, s[8:11], s58 offen nt
    buffer_load_dwordx2 v[44:45], v2, s[16:19], s63 offen nt
    buffer_load_dwordx4 v[34:37], v1, s[12:15], s59 offen nt
    buffer_load_dwordx4 v[16:19], v1, s[8:11], s59 offen nt
    buffer_load_dwordx2 v[46:47], v2, s[16:19], s64 offen nt
    buffer_load_dwordx2 v[38:39], v2, s[12:15], s60 offen nt
    buffer_load_dwordx2 v[20:21], v2, s[8:11], s60 offen nt
    buffer_load_dword v48, v3, s[16:19], s65 offen nt
    s_cmp_lg_u32 s49, 0
    s_cbranch_scc1 L_p1loop_3
L_p1epi_4:
    s_mov_b32 s52, s51
    s_waitcnt vmcnt(15)
    v_add_u32 v114, v106, v108
    v_add_u32 v115, v107, v109
    v_max_u32 v114, v114, v115
    v_cmp_le_u32 vcc, s48, v114
    v_min_u32 v106, s48, v106
    v_min_u32 v107, s48, v107
    v_add_u32 v106, v106, v110
    v_add_u32 v107, v107, v111
    v_lshl_add_u32 v106, v106, 2, v106
    v_lshl_add_u32 v107, v107, 2, v107
    ds_write_b64 v2, v[106:107] offset:8192
    s_cbranch_vccz L_noov_11
    ds_write_b32 v113, v104 offset:4
L_noov_11:
    s_sub_u32 s74, s52, 17408
    s_max_i32 s74, s74, 0
    v_cmp_gt_u32 s[68:69], s74, v0
    s_waitcnt lgkmcnt(0)
    s_barrier
    ds_read_b32 v114, v113 offset:4
    s_waitcnt lgkmcnt(0)
    v_readfirstlane_b32 s53, v114
    s_nop 1
    s_cmp_lg_u32 s53, 0
    s_cbranch_scc1 L_slow_12
L_sback_13:

    ds_read_b64 v[114:115], v2 offset:16400
    ds_read_b64 v[116:117], v2 offset:16408
    ds_read_b64 v[118:119], v2 offset:16392

    ds_read_b64 v[120:121], v2 offset:24592
    ds_read_b64 v[122:123], v2 offset:24600
    ds_read_b64 v[124:125], v2 offset:24584

    s_waitcnt lgkmcnt(3)
    v_lshrrev_b32 v126, 16, v115
    ds_read_b32 v126, v126 offset:8192

    s_waitcnt lgkmcnt(1)
    v_lshrrev_b32 v127, 16, v121
    ds_read_b32 v127, v127 offset:8192

    v_cmp_ne_u32_sdwa s[70:71], v115, v117 src0_sel:WORD_1 src1_sel:WORD_1
    v_cmp_ne_u32_sdwa vcc, v115, v119 src0_sel:WORD_1 src1_sel:WORD_1
    v_perm_b32 v115, v116, v115, s45
    s_mov_b32 s54, 0
    v_alignbyte_b32 v118, v119, v118, 2
    s_waitcnt lgkmcnt(1)
    v_add3_u32 v126, v126, v49, s54

    s_and_b64 exec, vcc, s[70:71]
    v_and_b32 v115, 0xff, v115
    s_andn2_b64 exec, s[70:71], vcc
    v_alignbyte_b32 v115, v115, v114, 1
    v_perm_b32 v114, v114, v118, s47
    v_subrev_u32 v126, 3, v126
    s_mov_b64 exec, -1

    buffer_store_dwordx2 v[114:115], v126, s[24:27], 0 offen
    v_cmp_ne_u32_sdwa s[70:71], v121, v123 src0_sel:WORD_1 src1_sel:WORD_1
    v_cmp_ne_u32_sdwa vcc, v121, v125 src0_sel:WORD_1 src1_sel:WORD_1
    v_perm_b32 v121, v122, v121, s45
    s_mov_b32 s54, 5120
    v_alignbyte_b32 v124, v125, v124, 2
    s_waitcnt lgkmcnt(0)
    v_add3_u32 v127, v127, v49, s54

    s_and_b64 exec, vcc, s[70:71]
    v_and_b32 v121, 0xff, v121
    s_andn2_b64 exec, s[70:71], vcc
    v_alignbyte_b32 v121, v121, v120, 1
    v_perm_b32 v120, v120, v124, s47
    v_subrev_u32 v127, 3, v127
    s_mov_b64 exec, -1

    buffer_store_dwordx2 v[120:121], v127, s[24:27], 0 offen
    ds_read_b64 v[114:115], v2 offset:32784
    ds_read_b64 v[116:117], v2 offset:32792
    ds_read_b64 v[118:119], v2 offset:32776

    ds_read_b64 v[120:121], v2 offset:40976
    ds_read_b64 v[122:123], v2 offset:40984
    ds_read_b64 v[124:125], v2 offset:40968

    s_waitcnt lgkmcnt(3)
    v_lshrrev_b32 v126, 16, v115
    ds_read_b32 v126, v126 offset:8192

    s_waitcnt lgkmcnt(1)
    v_lshrrev_b32 v127, 16, v121
    ds_read_b32 v127, v127 offset:8192

    v_cmp_ne_u32_sdwa s[70:71], v115, v117 src0_sel:WORD_1 src1_sel:WORD_1
    v_cmp_ne_u32_sdwa vcc, v115, v119 src0_sel:WORD_1 src1_sel:WORD_1
    v_perm_b32 v115, v116, v115, s45
    s_mov_b32 s54, 10240
    v_alignbyte_b32 v118, v119, v118, 2
    s_waitcnt lgkmcnt(1)
    v_add3_u32 v126, v126, v49, s54

    s_and_b64 exec, vcc, s[70:71]
    v_and_b32 v115, 0xff, v115
    s_andn2_b64 exec, s[70:71], vcc
    v_alignbyte_b32 v115, v115, v114, 1
    v_perm_b32 v114, v114, v118, s47
    v_subrev_u32 v126, 3, v126
    s_mov_b64 exec, -1

    buffer_store_dwordx2 v[114:115], v126, s[24:27], 0 offen
    v_cmp_ne_u32_sdwa s[70:71], v121, v123 src0_sel:WORD_1 src1_sel:WORD_1
    v_cmp_ne_u32_sdwa vcc, v121, v125 src0_sel:WORD_1 src1_sel:WORD_1
    v_perm_b32 v121, v122, v121, s45
    s_mov_b32 s54, 15360
    v_alignbyte_b32 v124, v125, v124, 2
    s_waitcnt lgkmcnt(0)
    v_add3_u32 v127, v127, v49, s54

    s_and_b64 exec, vcc, s[70:71]
    v_and_b32 v121, 0xff, v121
    s_andn2_b64 exec, s[70:71], vcc
    v_alignbyte_b32 v121, v121, v120, 1
    v_perm_b32 v120, v120, v124, s47
    v_subrev_u32 v127, 3, v127
    s_mov_b64 exec, -1

    buffer_store_dwordx2 v[120:121], v127, s[24:27], 0 offen
    ds_read_b64 v[114:115], v2 offset:49168
    ds_read_b64 v[116:117], v2 offset:49176
    ds_read_b64 v[118:119], v2 offset:49160

    ds_read_b64 v[120:121], v2 offset:57360
    ds_read_b64 v[122:123], v2 offset:57368
    ds_read_b64 v[124:125], v2 offset:57352

    s_waitcnt lgkmcnt(3)
    v_lshrrev_b32 v126, 16, v115
    ds_read_b32 v126, v126 offset:8192

    s_waitcnt lgkmcnt(1)
    v_lshrrev_b32 v127, 16, v121
    ds_read_b32 v127, v127 offset:8192

    v_cmp_ne_u32_sdwa s[70:71], v115, v117 src0_sel:WORD_1 src1_sel:WORD_1
    v_cmp_ne_u32_sdwa vcc, v115, v119 src0_sel:WORD_1 src1_sel:WORD_1
    v_perm_b32 v115, v116, v115, s45
    s_mov_b32 s54, 20480
    v_alignbyte_b32 v118, v119, v118, 2
    s_waitcnt lgkmcnt(1)
    v_add3_u32 v126, v126, v49, s54

    s_and_b64 exec, vcc, s[70:71]
    v_and_b32 v115, 0xff, v115
    s_andn2_b64 exec, s[70:71], vcc
    v_alignbyte_b32 v115, v115, v114, 1
    v_perm_b32 v114, v114, v118, s47
    v_subrev_u32 v126, 3, v126
    s_mov_b64 exec, -1

    buffer_store_dwordx2 v[114:115], v126, s[24:27], 0 offen
    v_cmp_ne_u32_sdwa s[70:71], v121, v123 src0_sel:WORD_1 src1_sel:WORD_1
    v_cmp_ne_u32_sdwa vcc, v121, v125 src0_sel:WORD_1 src1_sel:WORD_1
    v_perm_b32 v121, v122, v121, s45
    s_mov_b32 s54, 25600
    v_alignbyte_b32 v124, v125, v124, 2
    s_waitcnt lgkmcnt(0)
    v_add3_u32 v127, v127, v49, s54

    s_and_b64 exec, vcc, s[70:71]
    v_and_b32 v121, 0xff, v121
    s_andn2_b64 exec, s[70:71], vcc
    v_alignbyte_b32 v121, v121, v120, 1
    v_perm_b32 v120, v120, v124, s47
    v_subrev_u32 v127, 3, v127
    s_mov_b64 exec, -1

    buffer_store_dwordx2 v[120:121], v127, s[24:27], 0 offen
    v_add_u32 v112, 65536, v2
    ds_read_b64 v[114:115], v112 offset:16
    ds_read_b64 v[116:117], v112 offset:24
    ds_read_b64 v[118:119], v112 offset:8

    ds_read_b64 v[120:121], v112 offset:8208
    ds_read_b64 v[122:123], v112 offset:8216
    ds_read_b64 v[124:125], v112 offset:8200

    s_waitcnt lgkmcnt(3)
    v_lshrrev_b32 v126, 16, v115
    ds_read_b32 v126, v126 offset:8192

    s_waitcnt lgkmcnt(1)
    v_lshrrev_b32 v127, 16, v121
    ds_read_b32 v127, v127 offset:8192

    v_cmp_ne_u32_sdwa s[70:71], v115, v117 src0_sel:WORD_1 src1_sel:WORD_1
    v_cmp_ne_u32_sdwa vcc, v115, v119 src0_sel:WORD_1 src1_sel:WORD_1
    v_perm_b32 v115, v116, v115, s45
    s_mov_b32 s54, 30720
    v_alignbyte_b32 v118, v119, v118, 2
    s_waitcnt lgkmcnt(1)
    v_add3_u32 v126, v126, v49, s54

    s_and_b64 exec, vcc, s[70:71]
    v_and_b32 v115, 0xff, v115
    s_andn2_b64 exec, s[70:71], vcc
    v_alignbyte_b32 v115, v115, v114, 1
    v_perm_b32 v114, v114, v118, s47
    v_subrev_u32 v126, 3, v126
    s_mov_b64 exec, -1

    buffer_store_dwordx2 v[114:115], v126, s[24:27], 0 offen
    v_cmp_ne_u32_sdwa s[70:71], v121, v123 src0_sel:WORD_1 src1_sel:WORD_1
    v_cmp_ne_u32_sdwa vcc, v121, v125 src0_sel:WORD_1 src1_sel:WORD_1
    v_perm_b32 v121, v122, v121, s45
    s_mov_b32 s54, 35840
    v_alignbyte_b32 v124, v125, v124, 2
    s_waitcnt lgkmcnt(0)
    v_add3_u32 v127, v127, v49, s54

    s_and_b64 exec, vcc, s[70:71]
    v_and_b32 v121, 0xff, v121
    s_andn2_b64 exec, s[70:71], vcc
    v_alignbyte_b32 v121, v121, v120, 1
    v_perm_b32 v120, v120, v124, s47
    v_subrev_u32 v127, 3, v127
    s_mov_b64 exec, -1

    buffer_store_dwordx2 v[120:121], v127, s[24:27], 0 offen
    ds_read_b64 v[114:115], v112 offset:16400
    ds_read_b64 v[116:117], v112 offset:16408
    ds_read_b64 v[118:119], v112 offset:16392

    ds_read_b64 v[120:121], v112 offset:24592
    ds_read_b64 v[122:123], v112 offset:24600
    ds_read_b64 v[124:125], v112 offset:24584

    s_waitcnt lgkmcnt(3)
    v_lshrrev_b32 v126, 16, v115
    ds_read_b32 v126, v126 offset:8192

    s_waitcnt lgkmcnt(1)
    v_lshrrev_b32 v127, 16, v121
    ds_read_b32 v127, v127 offset:8192

    v_cmp_ne_u32_sdwa s[70:71], v115, v117 src0_sel:WORD_1 src1_sel:WORD_1
    v_cmp_ne_u32_sdwa vcc, v115, v119 src0_sel:WORD_1 src1_sel:WORD_1
    v_perm_b32 v115, v116, v115, s45
    s_mov_b32 s54, 40960
    v_alignbyte_b32 v118, v119, v118, 2
    s_waitcnt lgkmcnt(1)
    v_add3_u32 v126, v126, v49, s54

    s_and_b64 exec, vcc, s[70:71]
    v_and_b32 v115, 0xff, v115
    s_andn2_b64 exec, s[70:71], vcc
    v_alignbyte_b32 v115, v115, v114, 1
    v_perm_b32 v114, v114, v118, s47
    v_subrev_u32 v126, 3, v126
    s_mov_b64 exec, -1

    buffer_store_dwordx2 v[114:115], v126, s[24:27], 0 offen
    v_cmp_ne_u32_sdwa s[70:71], v121, v123 src0_sel:WORD_1 src1_sel:WORD_1
    v_cmp_ne_u32_sdwa vcc, v121, v125 src0_sel:WORD_1 src1_sel:WORD_1
    v_perm_b32 v121, v122, v121, s45
    s_mov_b32 s54, 46080
    v_alignbyte_b32 v124, v125, v124, 2
    s_waitcnt lgkmcnt(0)
    v_add3_u32 v127, v127, v49, s54

    s_and_b64 exec, vcc, s[70:71]
    v_and_b32 v121, 0xff, v121
    s_andn2_b64 exec, s[70:71], vcc
    v_alignbyte_b32 v121, v121, v120, 1
    v_perm_b32 v120, v120, v124, s47
    v_subrev_u32 v127, 3, v127
    s_mov_b64 exec, -1

    buffer_store_dwordx2 v[120:121], v127, s[24:27], 0 offen
    ds_read_b64 v[114:115], v112 offset:32784
    ds_read_b64 v[116:117], v112 offset:32792
    ds_read_b64 v[118:119], v112 offset:32776

    ds_read_b64 v[120:121], v112 offset:40976
    ds_read_b64 v[122:123], v112 offset:40984
    ds_read_b64 v[124:125], v112 offset:40968

    s_waitcnt lgkmcnt(3)
    v_lshrrev_b32 v126, 16, v115
    ds_read_b32 v126, v126 offset:8192

    s_waitcnt lgkmcnt(1)
    v_lshrrev_b32 v127, 16, v121
    ds_read_b32 v127, v127 offset:8192

    v_cmp_ne_u32_sdwa s[70:71], v115, v117 src0_sel:WORD_1 src1_sel:WORD_1
    v_cmp_ne_u32_sdwa vcc, v115, v119 src0_sel:WORD_1 src1_sel:WORD_1
    v_perm_b32 v115, v116, v115, s45
    s_mov_b32 s54, 51200
    v_alignbyte_b32 v118, v119, v118, 2
    s_waitcnt lgkmcnt(1)
    v_add3_u32 v126, v126, v49, s54

    s_and_b64 exec, vcc, s[70:71]
    v_and_b32 v115, 0xff, v115
    s_andn2_b64 exec, s[70:71], vcc
    v_alignbyte_b32 v115, v115, v114, 1
    v_perm_b32 v114, v114, v118, s47
    v_subrev_u32 v126, 3, v126
    s_mov_b64 exec, -1

    buffer_store_dwordx2 v[114:115], v126, s[24:27], 0 offen
    v_cmp_ne_u32_sdwa s[70:71], v121, v123 src0_sel:WORD_1 src1_sel:WORD_1
    v_cmp_ne_u32_sdwa vcc, v121, v125 src0_sel:WORD_1 src1_sel:WORD_1
    v_perm_b32 v121, v122, v121, s45
    s_mov_b32 s54, 56320
    v_alignbyte_b32 v124, v125, v124, 2
    s_waitcnt lgkmcnt(0)
    v_add3_u32 v127, v127, v49, s54

    s_and_b64 exec, vcc, s[70:71]
    v_and_b32 v121, 0xff, v121
    s_andn2_b64 exec, s[70:71], vcc
    v_alignbyte_b32 v121, v121, v120, 1
    v_perm_b32 v120, v120, v124, s47
    v_subrev_u32 v127, 3, v127
    s_mov_b64 exec, -1

    buffer_store_dwordx2 v[120:121], v127, s[24:27], 0 offen
    ds_read_b64 v[114:115], v112 offset:49168
    ds_read_b64 v[116:117], v112 offset:49176
    ds_read_b64 v[118:119], v112 offset:49160

    ds_read_b64 v[120:121], v112 offset:57360
    ds_read_b64 v[122:123], v112 offset:57368
    ds_read_b64 v[124:125], v112 offset:57352

    s_waitcnt lgkmcnt(3)
    v_lshrrev_b32 v126, 16, v115
    ds_read_b32 v126, v126 offset:8192

    s_waitcnt lgkmcnt(1)
    v_lshrrev_b32 v127, 16, v121
    ds_read_b32 v127, v127 offset:8192

    v_cmp_ne_u32_sdwa s[70:71], v115, v117 src0_sel:WORD_1 src1_sel:WORD_1
    v_cmp_ne_u32_sdwa vcc, v115, v119 src0_sel:WORD_1 src1_sel:WORD_1
    v_perm_b32 v115, v116, v115, s45
    s_mov_b32 s54, 61440
    v_alignbyte_b32 v118, v119, v118, 2
    s_waitcnt lgkmcnt(1)
    v_add3_u32 v126, v126, v49, s54

    s_and_b64 exec, vcc, s[70:71]
    v_and_b32 v115, 0xff, v115
    s_andn2_b64 exec, s[70:71], vcc
    v_alignbyte_b32 v115, v115, v114, 1
    v_perm_b32 v114, v114, v118, s47
    v_subrev_u32 v126, 3, v126
    s_mov_b64 exec, -1

    buffer_store_dwordx2 v[114:115], v126, s[24:27], 0 offen
    v_cmp_ne_u32_sdwa s[70:71], v121, v123 src0_sel:WORD_1 src1_sel:WORD_1
    v_cmp_ne_u32_sdwa vcc, v121, v125 src0_sel:WORD_1 src1_sel:WORD_1
    v_perm_b32 v121, v122, v121, s45
    s_mov_b32 s54, 66560
    v_alignbyte_b32 v124, v125, v124, 2
    s_waitcnt lgkmcnt(0)
    v_add3_u32 v127, v127, v49, s54

    s_and_b64 exec, vcc, s[70:71]
    v_and_b32 v121, 0xff, v121
    s_andn2_b64 exec, s[70:71], vcc
    v_alignbyte_b32 v121, v121, v120, 1
    v_perm_b32 v120, v120, v124, s47
    v_subrev_u32 v127, 3, v127
    s_mov_b64 exec, -1

    buffer_store_dwordx2 v[120:121], v127, s[24:27], 0 offen
    v_add_u32 v112, 131072, v2
    ds_read_b64 v[114:115], v112 offset:16
    ds_read_b64 v[116:117], v112 offset:24
    ds_read_b64 v[118:119], v112 offset:8

    ds_read_b64 v[120:121], v112 offset:8208
    ds_read_b64 v[122:123], v112 offset:8216
    ds_read_b64 v[124:125], v112 offset:8200

    s_waitcnt lgkmcnt(3)
    v_lshrrev_b32 v126, 16, v115
    ds_read_b32 v126, v126 offset:8192

    s_waitcnt lgkmcnt(1)
    v_lshrrev_b32 v127, 16, v121
    ds_read_b32 v127, v127 offset:8192

    v_cmp_ne_u32_sdwa s[70:71], v115, v117 src0_sel:WORD_1 src1_sel:WORD_1
    v_cmp_ne_u32_sdwa vcc, v115, v119 src0_sel:WORD_1 src1_sel:WORD_1
    v_perm_b32 v115, v116, v115, s45
    s_mov_b32 s54, 71680
    v_alignbyte_b32 v118, v119, v118, 2
    s_waitcnt lgkmcnt(1)
    v_add3_u32 v126, v126, v49, s54

    s_and_b64 exec, vcc, s[70:71]
    v_and_b32 v115, 0xff, v115
    s_andn2_b64 exec, s[70:71], vcc
    v_alignbyte_b32 v115, v115, v114, 1
    v_perm_b32 v114, v114, v118, s47
    v_subrev_u32 v126, 3, v126
    s_mov_b64 exec, -1

    buffer_store_dwordx2 v[114:115], v126, s[24:27], 0 offen
    v_cmp_ne_u32_sdwa s[70:71], v121, v123 src0_sel:WORD_1 src1_sel:WORD_1
    v_cmp_ne_u32_sdwa vcc, v121, v125 src0_sel:WORD_1 src1_sel:WORD_1
    v_perm_b32 v121, v122, v121, s45
    s_mov_b32 s54, 76800
    v_alignbyte_b32 v124, v125, v124, 2
    s_waitcnt lgkmcnt(0)
    v_add3_u32 v127, v127, v49, s54

    s_and_b64 exec, vcc, s[70:71]
    v_and_b32 v121, 0xff, v121
    s_andn2_b64 exec, s[70:71], vcc
    v_alignbyte_b32 v121, v121, v120, 1
    v_perm_b32 v120, v120, v124, s47
    v_subrev_u32 v127, 3, v127
    s_mov_b64 exec, -1

    buffer_store_dwordx2 v[120:121], v127, s[24:27], 0 offen
    ds_read_b64 v[114:115], v112 offset:16400
    ds_read_b64 v[116:117], v112 offset:16408
    ds_read_b64 v[118:119], v112 offset:16392

    ds_read_b64 v[120:121], v112 offset:24592
    ds_read_b64 v[122:123], v112 offset:24600
    ds_read_b64 v[124:125], v112 offset:24584

    s_waitcnt lgkmcnt(3)
    v_lshrrev_b32 v126, 16, v115
    ds_read_b32 v126, v126 offset:8192

    s_waitcnt lgkmcnt(1)
    v_lshrrev_b32 v127, 16, v121
    ds_read_b32 v127, v127 offset:8192

    v_cmp_ne_u32_sdwa s[70:71], v115, v117 src0_sel:WORD_1 src1_sel:WORD_1
    v_cmp_ne_u32_sdwa vcc, v115, v119 src0_sel:WORD_1 src1_sel:WORD_1
    v_perm_b32 v115, v116, v115, s45
    s_mov_b32 s54, 81920
    v_alignbyte_b32 v118, v119, v118, 2
    s_waitcnt lgkmcnt(1)
    v_add3_u32 v126, v126, v49, s54

    s_and_b64 exec, vcc, s[70:71]
    v_and_b32 v115, 0xff, v115
    s_andn2_b64 exec, s[70:71], vcc
    v_alignbyte_b32 v115, v115, v114, 1
    v_perm_b32 v114, v114, v118, s47
    v_subrev_u32 v126, 3, v126
    s_mov_b64 exec, -1

    buffer_store_dwordx2 v[114:115], v126, s[24:27], 0 offen
    v_cmp_ne_u32_sdwa s[70:71], v121, v123 src0_sel:WORD_1 src1_sel:WORD_1
    v_cmp_ne_u32_sdwa vcc, v121, v125 src0_sel:WORD_1 src1_sel:WORD_1
    v_perm_b32 v121, v122, v121, s45
    s_mov_b32 s54, 87040
    v_alignbyte_b32 v124, v125, v124, 2
    s_waitcnt lgkmcnt(0)
    v_add3_u32 v127, v127, v49, s54

    s_andn2_b64 exec, -1, s[68:69]
    v_bfrev_b32 v127, 1

    s_and_b64 exec, vcc, s[70:71]
    v_and_b32 v121, 0xff, v121
    s_andn2_b64 exec, s[70:71], vcc
    v_alignbyte_b32 v121, v121, v120, 1
    v_perm_b32 v120, v120, v124, s47
    v_subrev_u32 v127, 3, v127
    s_mov_b64 exec, -1

    buffer_store_dwordx2 v[120:121], v127, s[24:27], 0 offen
L_p1done_2:
    s_endpgm

L_slow_6:
    s_mov_b32 s26, 0
    v_mov_b32 v116, v0
    v_mov_b32 v122, 0
    s_mov_b32 s75, 4960
L_sl_8:
    v_lshlrev_b32 v117, 3, v116
    ds_read_b64 v[114:115], v117 offset:16400
    ds_read_b32 v123, v117 offset:16412
    ds_read_b32 v124, v117 offset:16396
    s_waitcnt lgkmcnt(0)
    v_lshrrev_b32 v118, 16, v115
    ds_read_b32 v119, v118 offset:8192
    v_add_u32 v118, 4, v118
    v_mul_u32_u24 v118, s75, v118
    s_waitcnt lgkmcnt(0)
    v_mad_u32_u24 v119, v116, 5, v119
    v_mov_b32 v120, 1
    v_cmp_gt_u32 s[72:73], s52, v116
    v_cmp_ge_u32 vcc, v119, v118
    s_and_b64 exec, vcc, s[72:73]
    s_cbranch_execz L_s1_9
    buffer_atomic_add v120, v122, s[36:39], 0 offen sc0
    s_waitcnt vmcnt(0)
    v_lshlrev_b32 v120, 3, v120
    buffer_store_dwordx2 v[114:115], v120, s[32:35], 0 offen
L_s1_9:
    s_andn2_b64 exec, s[72:73], vcc
    s_cbranch_execz L_s2_10
    buffer_store_dword v114, v119, s[28:31], 0 offen
    buffer_store_byte v115, v119, s[28:31], 0 offen offset:4
    v_add_u32 v119, 5, v119
    v_cmpx_lt_u32 vcc, v119, v118
    v_cmpx_ne_u32_sdwa vcc, v115, v123 src0_sel:WORD_1 src1_sel:WORD_1
    v_cmpx_ne_u32_sdwa vcc, v115, v124 src0_sel:WORD_1 src1_sel:WORD_1
    s_cbranch_execz L_s2_10
    buffer_store_dword v122, v119, s[28:31], 0 offen
L_s2_10:
    s_mov_b64 exec, -1
    s_waitcnt vmcnt(0)
    v_add_u32 v116, 1024, v116
    s_nop 0
    v_readfirstlane_b32 s76, v116
    s_nop 1
    s_cmp_lt_u32 s76, s52
    s_cbranch_scc1 L_sl_8
    s_branch L_sback_7

L_slow_12:
    s_mov_b32 s26, 0
    v_mov_b32 v116, v0
    v_mov_b32 v122, 0
    s_mov_b32 s75, 4960
L_sl_14:
    v_lshlrev_b32 v117, 3, v116
    ds_read_b64 v[114:115], v117 offset:16400
    ds_read_b32 v123, v117 offset:16412
    ds_read_b32 v124, v117 offset:16396
    s_waitcnt lgkmcnt(0)
    v_lshrrev_b32 v118, 16, v115
    ds_read_b32 v119, v118 offset:8192
    v_add_u32 v118, 4, v118
    v_mul_u32_u24 v118, s75, v118
    s_waitcnt lgkmcnt(0)
    v_mad_u32_u24 v119, v116, 5, v119
    v_mov_b32 v120, 1
    v_cmp_gt_u32 s[72:73], s52, v116
    v_cmp_ge_u32 vcc, v119, v118
    s_and_b64 exec, vcc, s[72:73]
    s_cbranch_execz L_s1_15
    buffer_atomic_add v120, v122, s[36:39], 0 offen sc0
    s_waitcnt vmcnt(0)
    v_lshlrev_b32 v120, 3, v120
    buffer_store_dwordx2 v[114:115], v120, s[32:35], 0 offen
L_s1_15:
    s_andn2_b64 exec, s[72:73], vcc
    s_cbranch_execz L_s2_16
    buffer_store_dword v114, v119, s[28:31], 0 offen
    buffer_store_byte v115, v119, s[28:31], 0 offen offset:4
    v_add_u32 v119, 5, v119
    v_cmpx_lt_u32 vcc, v119, v118
    v_cmpx_ne_u32_sdwa vcc, v115, v123 src0_sel:WORD_1 src1_sel:WORD_1
    v_cmpx_ne_u32_sdwa vcc, v115, v124 src0_sel:WORD_1 src1_sel:WORD_1
    s_cbranch_execz L_s2_16
    buffer_store_dword v122, v119, s[28:31], 0 offen
L_s2_16:
    s_mov_b64 exec, -1
    s_waitcnt vmcnt(0)
    v_add_u32 v116, 1024, v116
    s_nop 0
    v_readfirstlane_b32 s76, v116
    s_nop 1
    s_cmp_lt_u32 s76, s52
    s_cbranch_scc1 L_sl_14
    s_branch L_sback_13

.globl g2_kernel
.p2align 8
.type g2_kernel,@function
g2_kernel:
    s_cmp_ge_u32 s2, 256
    s_cbranch_scc1 L_p2done_17
    s_load_dwordx2 s[8:9], s[0:1], 0
    s_load_dwordx2 s[6:7], s[0:1], 104
    v_lshrrev_b32 v4, 6, v0
    v_lshlrev_b32 v5, 3, v0
    s_lshr_b32 s37, s2, 1
    s_and_b32 s37, s37, 3
    s_lshr_b32 s36, s2, 3
    s_lshl_b32 s36, s36, 1
    s_and_b32 s3, s2, 1
    s_or_b32 s36, s36, s3
    v_readfirstlane_b32 s4, v4
    v_and_b32 v2, 127, v0
    v_mul_u32_u24 v2, 20, v2
    v_lshlrev_b32 v3, 4, v0
    s_waitcnt lgkmcnt(0)
    s_lshr_b32 s5, s4, 1
    s_and_b32 s39, s4, 1
    s_lshl_b32 s39, s39, 8
    s_mul_i32 s3, s5, 8192
    s_add_u32 s46, s6, s3
    s_addc_u32 s47, s7, 0
    s_mul_i32 s3, s5, 40632320
    s_add_u32 s3, s3, 77848576
    s_add_u32 s44, s6, s3
    s_addc_u32 s45, s7, 0
    s_mul_i32 s38, s37, 8
    s_add_u32 s4, s38, 8
    s_lshl_b32 s3, s38, 6
    s_add_u32 s3, s3, s36
    s_lshl_b32 s3, s3, 2
    s_load_dword s41, s[46:47], s3
    s_mov_b32 s3, 131072
    s_load_dword s51, s[6:7], s3
    s_mov_b32 s10, 6400000
    s_mov_b32 s11, 0x20000

    s_add_u32 s20, s6, 135168
    s_addc_u32 s21, s7, 0
    s_mov_b32 s22, 8192
    s_mov_b32 s23, 0x20000
    buffer_load_dwordx2 v[116:117], v5, s[20:23], 0 offen
    s_mov_b32 s12, s8
    s_mov_b32 s13, s9
    s_mov_b32 s14, 0
    s_mov_b32 s15, 0x20000
    s_mul_i32 s43, s38, 200000
    s_add_u32 s14, s43, 50000
    buffer_load_dwordx4 v[76:79], v3, s[12:15], s43 offen
    s_add_u32 s52, s43, 16384
    buffer_load_dwordx4 v[80:83], v3, s[12:15], s52 offen
    s_add_u32 s52, s43, 32768
    buffer_load_dwordx4 v[84:87], v3, s[12:15], s52 offen
    s_add_u32 s52, s43, 49152
    v_lshlrev_b32 v123, 2, v0
    buffer_load_dword v88, v123, s[12:15], s52 offen
    s_lshr_b32 s3, s2, 3
    s_mul_i32 s3, s3, 49
    v_add_lshl_u32 v89, v0, s3, 7
    v_cmp_gt_u32 vcc, 49, v0
    v_bfrev_b32 v28, 1
    s_add_u32 s54, s43, 100000
    v_cndmask_b32 v89, v28, v89, vcc

    buffer_load_dword v115, v89, s[8:11], s54 offen
    s_mov_b32 s19, 0x20000
    s_mov_b32 s28, 0x4b404000
    s_mov_b32 s29, 0x4b404000
    s_mov_b32 s30, 0xbfffc000
    s_mov_b32 s31, 0xbfffbfff
    s_mov_b32 s32, 0xffff0000
    s_mov_b32 s35, 0x05040100
    s_movk_i32 s3, 212
    v_cmp_gt_u32 s[48:49], s3, v0

    v_mov_b32 v1, 0
    s_mov_b32 s24, 0xc0c0004
    s_mov_b32 s25, 0xc0c0105
    s_mov_b32 s26, 0xc0c0206
    s_mov_b32 s27, 0xc0c0307
    s_waitcnt lgkmcnt(0)
    s_min_u32 s41, s41, 3968
    s_lshl_b32 s52, s38, 6
    s_add_u32 s52, s52, s36
    s_mul_i32 s52, s52, 19840
    s_add_u32 s16, s44, s52
    s_addc_u32 s17, s45, 0
    s_mul_i32 s52, s41, 5
    s_add_u32 s52, s52, 3
    s_and_b32 s18, s52, -4

    s_movk_i32 s53, 0
    buffer_load_dwordx4 v[4:7], v2, s[16:19], s53 offen
    buffer_load_dword v35, v2, s[16:19], s53 offen offset:16
    s_movk_i32 s53, 2560
    buffer_load_dwordx4 v[8:11], v2, s[16:19], s53 offen
    buffer_load_dword v43, v2, s[16:19], s53 offen offset:16
    s_movk_i32 s53, 5120
    buffer_load_dwordx4 v[90:93], v2, s[16:19], s53 offen
    buffer_load_dword v110, v2, s[16:19], s53 offen offset:16
    s_movk_i32 s53, 7680
    buffer_load_dwordx4 v[94:97], v2, s[16:19], s53 offen
    buffer_load_dword v111, v2, s[16:19], s53 offen offset:16
    s_movk_i32 s53, 10240
    buffer_load_dwordx4 v[98:101], v2, s[16:19], s53 offen
    buffer_load_dword v112, v2, s[16:19], s53 offen offset:16
    s_movk_i32 s53, 12800
    buffer_load_dwordx4 v[102:105], v2, s[16:19], s53 offen
    buffer_load_dword v113, v2, s[16:19], s53 offen offset:16
    s_movk_i32 s53, 15360
    buffer_load_dwordx4 v[106:109], v2, s[16:19], s53 offen
    buffer_load_dword v114, v2, s[16:19], s53 offen offset:16
    v_mov_b32 v28, 0x40004000
    v_mov_b32 v29, 0x40004000
    v_mov_b32 v30, 0x40004000
    v_mov_b32 v31, 0x40004000
    v_add_u32 v32, 50000, v3
    v_add_u32 v33, 65536, v32

    ds_write_b128 v32, v[28:31] offset:0
    ds_write_b128 v32, v[28:31] offset:16384
    ds_write_b128 v32, v[28:31] offset:32768
    ds_write_b128 v32, v[28:31] offset:49152
    ds_write_b128 v33, v[28:31] offset:0
    ds_write_b128 v33, v[28:31] offset:16384
    v_cmp_gt_u32 vcc, 971, v0
    s_mov_b64 exec, vcc
    ds_write_b128 v33, v[28:31] offset:32768
    s_mov_b64 exec, -1
    s_waitcnt lgkmcnt(0)
    s_barrier
    v_mov_b32 v34, 150016
    v_mov_b32 v36, 0
    v_mov_b32 v37, 0
    v_mov_b32 v38, 0
    v_mov_b32 v39, 0
    ds_write_b128 v34, v[36:39]

    s_waitcnt vmcnt(19)
    s_nop 1
    v_max_u32_dpp v116, v116, v116 row_shr:1 row_mask:0xf bank_mask:0xf
    s_nop 1
    v_max_u32_dpp v116, v116, v116 row_shr:2 row_mask:0xf bank_mask:0xf
    s_nop 1
    v_max_u32_dpp v116, v116, v116 row_shr:4 row_mask:0xf bank_mask:0xf
    s_nop 1
    v_max_u32_dpp v116, v116, v116 row_shr:8 row_mask:0xf bank_mask:0xf
    s_nop 1
    v_max_u32_dpp v116, v116, v116 row_bcast:15 row_mask:0xa bank_mask:0xf
    s_nop 1
    v_max_u32_dpp v116, v116, v116 row_bcast:31 row_mask:0xc bank_mask:0xf
    s_nop 1
    v_add_f32_dpp v117, v117, v117 row_shr:1 row_mask:0xf bank_mask:0xf
    s_nop 1
    v_add_f32_dpp v117, v117, v117 row_shr:2 row_mask:0xf bank_mask:0xf
    s_nop 1
    v_add_f32_dpp v117, v117, v117 row_shr:4 row_mask:0xf bank_mask:0xf
    s_nop 1
    v_add_f32_dpp v117, v117, v117 row_shr:8 row_mask:0xf bank_mask:0xf
    s_nop 1
    v_add_f32_dpp v117, v117, v117 row_bcast:15 row_mask:0xa bank_mask:0xf
    s_nop 1
    v_add_f32_dpp v117, v117, v117 row_bcast:31 row_mask:0xc bank_mask:0xf
    s_waitcnt lgkmcnt(0)
    s_barrier
    s_mov_b32 exec_lo, 0
    s_brev_b32 exec_hi, 1
    ds_max_u32 v34, v116
    ds_add_f32 v34, v117 offset:4
    s_mov_b64 exec, -1

    s_waitcnt vmcnt(18)
    ds_write_b128 v3, v[76:79] offset:0
    s_waitcnt vmcnt(17)
    ds_write_b128 v3, v[80:83] offset:16384
    s_waitcnt vmcnt(16)
    ds_write_b128 v3, v[84:87] offset:32768
    v_lshlrev_b32 v123, 2, v0
    s_waitcnt vmcnt(15)
    s_mov_b64 exec, s[48:49]
    ds_write_b32 v123, v88 offset:49152
    s_mov_b64 exec, -1

    s_add_u32 s43, s43, 50000
    s_add_u32 s14, s43, 50000
    buffer_load_dwordx4 v[76:79], v3, s[12:15], s43 offen
    s_add_u32 s52, s43, 16384
    buffer_load_dwordx4 v[80:83], v3, s[12:15], s52 offen
    s_add_u32 s52, s43, 32768
    buffer_load_dwordx4 v[84:87], v3, s[12:15], s52 offen
    s_add_u32 s52, s43, 49152
    v_lshlrev_b32 v123, 2, v0
    buffer_load_dword v88, v123, s[12:15], s52 offen
    s_waitcnt lgkmcnt(0)
    s_barrier
    ds_read_b64 v[28:29], v34
    s_waitcnt lgkmcnt(0)
    v_lshlrev_b32 v28, 16, v28
    v_mul_f32 v29, 0x34a7c5ac, v29
    v_sqrt_f32 v29, v29
    v_add_f32 v30, v28, v28
    v_mul_f32 v31, 0x41ac0000, v29
    v_mul_f32 v32, 0x42000000, v29
    v_max_f32 v30, v30, v31
    v_cmp_le_f32 vcc, v28, v32
    v_mov_b32 v33, 0x26901d7d
    v_cmp_lt_f32 s[64:65], v33, v29
    v_mov_b32 v33, 0x58635fa9
    s_and_b64 vcc, vcc, s[64:65]
    v_cmp_gt_f32 s[64:65], v33, v29
    v_rcp_f32 v30, v30
    s_and_b64 vcc, vcc, s[64:65]
    s_cbranch_scc0 L_p2slow_18
    s_cmp_lg_u32 s51, 0
    s_cbranch_scc1 L_p2slow_18
    v_mul_f32 v30, 0x3f000000, v30
    v_mul_f32 v31, 0x46ff8000, v30
    v_rcp_f32 v31, v31
    v_readfirstlane_b32 s33, v30
    s_nop 0
    v_readfirstlane_b32 s34, v31

L_batch_19:
    s_mov_b32 s40, s41
    s_sub_u32 s42, s40, s39
    s_mul_i32 s50, s38, 200000
    s_add_u32 s5, s38, 1
    s_min_u32 s52, s5, 31
    s_lshl_b32 s52, s52, 6
    s_add_u32 s52, s52, s36
    s_lshl_b32 s52, s52, 2
    s_load_dword s41, s[46:47], s52

    s_waitcnt vmcnt(12)
    v_perm_b32 v44, v91, v90, s24
    v_perm_b32 v46, v92, v91, s25
    v_perm_b32 v48, v93, v92, s26
    v_perm_b32 v50, v110, v93, s27
    v_mov_b32 v12, v90
    v_alignbyte_b32 v13, v92, v91, 1
    v_alignbyte_b32 v14, v93, v92, 2
    v_alignbyte_b32 v15, v110, v93, 3
    v_lshlrev_b32_sdwa v44, 3, v44 dst_sel:WORD_0 dst_unused:UNUSED_PAD src0_sel:DWORD src1_sel:DWORD
    v_lshlrev_b32_sdwa v46, 3, v46 dst_sel:WORD_0 dst_unused:UNUSED_PAD src0_sel:DWORD src1_sel:DWORD
    v_lshlrev_b32_sdwa v48, 3, v48 dst_sel:WORD_0 dst_unused:UNUSED_PAD src0_sel:DWORD src1_sel:DWORD
    v_lshlrev_b32_sdwa v50, 3, v50 dst_sel:WORD_0 dst_unused:UNUSED_PAD src0_sel:DWORD src1_sel:DWORD
    s_cmp_lt_i32 s42, 1280
    s_cbranch_scc1 L_ufix_20
L_uback_21:

    s_waitcnt vmcnt(10)
    v_perm_b32 v52, v95, v94, s24
    v_perm_b32 v54, v96, v95, s25
    v_perm_b32 v56, v97, v96, s26
    v_perm_b32 v58, v111, v97, s27
    v_mov_b32 v16, v94
    v_alignbyte_b32 v17, v96, v95, 1
    v_alignbyte_b32 v18, v97, v96, 2
    v_alignbyte_b32 v19, v111, v97, 3
    v_lshlrev_b32_sdwa v52, 3, v52 dst_sel:WORD_0 dst_unused:UNUSED_PAD src0_sel:DWORD src1_sel:DWORD
    v_lshlrev_b32_sdwa v54, 3, v54 dst_sel:WORD_0 dst_unused:UNUSED_PAD src0_sel:DWORD src1_sel:DWORD
    v_lshlrev_b32_sdwa v56, 3, v56 dst_sel:WORD_0 dst_unused:UNUSED_PAD src0_sel:DWORD src1_sel:DWORD
    v_lshlrev_b32_sdwa v58, 3, v58 dst_sel:WORD_0 dst_unused:UNUSED_PAD src0_sel:DWORD src1_sel:DWORD
    s_cmp_lt_i32 s42, 1792
    s_cbranch_scc1 L_ufix_22
L_uback_23:

    s_waitcnt vmcnt(8)
    v_perm_b32 v60, v99, v98, s24
    v_perm_b32 v62, v100, v99, s25
    v_perm_b32 v64, v101, v100, s26
    v_perm_b32 v66, v112, v101, s27
    v_mov_b32 v20, v98
    v_alignbyte_b32 v21, v100, v99, 1
    v_alignbyte_b32 v22, v101, v100, 2
    v_alignbyte_b32 v23, v112, v101, 3
    v_lshlrev_b32_sdwa v60, 3, v60 dst_sel:WORD_0 dst_unused:UNUSED_PAD src0_sel:DWORD src1_sel:DWORD
    v_lshlrev_b32_sdwa v62, 3, v62 dst_sel:WORD_0 dst_unused:UNUSED_PAD src0_sel:DWORD src1_sel:DWORD
    v_lshlrev_b32_sdwa v64, 3, v64 dst_sel:WORD_0 dst_unused:UNUSED_PAD src0_sel:DWORD src1_sel:DWORD
    v_lshlrev_b32_sdwa v66, 3, v66 dst_sel:WORD_0 dst_unused:UNUSED_PAD src0_sel:DWORD src1_sel:DWORD
    s_cmp_lt_i32 s42, 2304
    s_cbranch_scc1 L_ufix_24
L_uback_25:

    s_waitcnt vmcnt(6)
    v_perm_b32 v68, v103, v102, s24
    v_perm_b32 v70, v104, v103, s25
    v_perm_b32 v72, v105, v104, s26
    v_perm_b32 v74, v113, v105, s27
    v_mov_b32 v24, v102
    v_alignbyte_b32 v25, v104, v103, 1
    v_alignbyte_b32 v26, v105, v104, 2
    v_alignbyte_b32 v27, v113, v105, 3
    v_lshlrev_b32_sdwa v68, 3, v68 dst_sel:WORD_0 dst_unused:UNUSED_PAD src0_sel:DWORD src1_sel:DWORD
    v_lshlrev_b32_sdwa v70, 3, v70 dst_sel:WORD_0 dst_unused:UNUSED_PAD src0_sel:DWORD src1_sel:DWORD
    v_lshlrev_b32_sdwa v72, 3, v72 dst_sel:WORD_0 dst_unused:UNUSED_PAD src0_sel:DWORD src1_sel:DWORD
    v_lshlrev_b32_sdwa v74, 3, v74 dst_sel:WORD_0 dst_unused:UNUSED_PAD src0_sel:DWORD src1_sel:DWORD
    s_cmp_lt_i32 s42, 2816
    s_cbranch_scc1 L_ufix_26
L_uback_27:

    s_waitcnt vmcnt(4)
    v_perm_b32 v28, v5, v4, s24
    v_perm_b32 v30, v6, v5, s25
    v_perm_b32 v32, v7, v6, s26
    v_perm_b32 v34, v35, v7, s27
    v_alignbyte_b32 v5, v6, v5, 1
    v_alignbyte_b32 v6, v7, v6, 2
    v_alignbyte_b32 v7, v35, v7, 3
    v_lshlrev_b32_sdwa v28, 3, v28 dst_sel:WORD_0 dst_unused:UNUSED_PAD src0_sel:DWORD src1_sel:DWORD
    v_lshlrev_b32_sdwa v30, 3, v30 dst_sel:WORD_0 dst_unused:UNUSED_PAD src0_sel:DWORD src1_sel:DWORD
    v_lshlrev_b32_sdwa v32, 3, v32 dst_sel:WORD_0 dst_unused:UNUSED_PAD src0_sel:DWORD src1_sel:DWORD
    v_lshlrev_b32_sdwa v34, 3, v34 dst_sel:WORD_0 dst_unused:UNUSED_PAD src0_sel:DWORD src1_sel:DWORD
    s_cmp_lt_i32 s42, 256
    s_cbranch_scc1 L_ufix_28
L_uback_29:

    s_waitcnt vmcnt(2)
    v_perm_b32 v36, v9, v8, s24
    v_perm_b32 v38, v10, v9, s25
    v_perm_b32 v40, v11, v10, s26
    v_perm_b32 v42, v43, v11, s27
    v_alignbyte_b32 v9, v10, v9, 1
    v_alignbyte_b32 v10, v11, v10, 2
    v_alignbyte_b32 v11, v43, v11, 3
    v_lshlrev_b32_sdwa v36, 3, v36 dst_sel:WORD_0 dst_unused:UNUSED_PAD src0_sel:DWORD src1_sel:DWORD
    v_lshlrev_b32_sdwa v38, 3, v38 dst_sel:WORD_0 dst_unused:UNUSED_PAD src0_sel:DWORD src1_sel:DWORD
    v_lshlrev_b32_sdwa v40, 3, v40 dst_sel:WORD_0 dst_unused:UNUSED_PAD src0_sel:DWORD src1_sel:DWORD
    v_lshlrev_b32_sdwa v42, 3, v42 dst_sel:WORD_0 dst_unused:UNUSED_PAD src0_sel:DWORD src1_sel:DWORD
    s_cmp_lt_i32 s42, 768
    s_cbranch_scc1 L_ufix_30
L_uback_31:

    v_subrev_co_u32 v4, s[64:65], 2.0, v4
    v_subrev_co_u32 v5, s[66:67], 2.0, v5
    v_subrev_co_u32 v6, s[68:69], 2.0, v6
    v_subrev_co_u32 v7, s[70:71], 2.0, v7
    v_subrev_co_u32 v8, s[72:73], 2.0, v8
    v_subrev_co_u32 v9, s[74:75], 2.0, v9
    v_subrev_co_u32 v10, s[76:77], 2.0, v10
    v_subrev_co_u32 v11, s[78:79], 2.0, v11
    v_subrev_co_u32 v12, s[80:81], 2.0, v12
    v_subrev_co_u32 v13, s[82:83], 2.0, v13
    v_subrev_co_u32 v14, s[84:85], 2.0, v14
    v_subrev_co_u32 v15, s[86:87], 2.0, v15
    s_waitcnt lgkmcnt(0)
    s_barrier
    s_cmp_lt_u32 s5, s4
    s_cselect_b32 s41, s41, 0
    s_min_u32 s55, s5, 31
    s_min_u32 s41, s41, 3968
    s_lshl_b32 s52, s55, 6
    s_add_u32 s52, s52, s36
    s_mul_i32 s52, s52, 19840
    s_add_u32 s16, s44, s52
    s_addc_u32 s17, s45, 0
    s_mul_i32 s52, s41, 5
    s_add_u32 s52, s52, 3
    s_and_b32 s18, s52, -4

    s_mov_b64 exec, s[64:65]
    ds_read_b64 v[28:29], v28
    s_mov_b64 exec, s[66:67]
    ds_read_b64 v[30:31], v30
    s_mov_b64 exec, s[68:69]
    ds_read_b64 v[32:33], v32
    s_mov_b64 exec, s[70:71]
    ds_read_b64 v[34:35], v34
    s_mov_b64 exec, s[72:73]
    ds_read_b64 v[36:37], v36
    s_mov_b64 exec, s[74:75]
    ds_read_b64 v[38:39], v38
    s_mov_b64 exec, s[76:77]
    ds_read_b64 v[40:41], v40
    s_mov_b64 exec, s[78:79]
    ds_read_b64 v[42:43], v42
    s_mov_b64 exec, s[80:81]
    ds_read_b64 v[44:45], v44
    s_mov_b64 exec, s[82:83]
    ds_read_b64 v[46:47], v46
    s_mov_b64 exec, s[84:85]
    ds_read_b64 v[48:49], v48
    s_mov_b64 exec, s[86:87]
    ds_read_b64 v[50:51], v50
    s_mov_b64 exec, -1
    s_movk_i32 s53, 5120
    buffer_load_dwordx4 v[90:93], v2, s[16:19], s53 offen
    buffer_load_dword v110, v2, s[16:19], s53 offen offset:16
    v_subrev_co_u32 v16, s[64:65], 2.0, v16
    v_subrev_co_u32 v17, s[66:67], 2.0, v17
    v_subrev_co_u32 v18, s[68:69], 2.0, v18
    v_subrev_co_u32 v19, s[70:71], 2.0, v19
    v_subrev_co_u32 v20, s[72:73], 2.0, v20
    v_subrev_co_u32 v21, s[74:75], 2.0, v21
    v_subrev_co_u32 v22, s[76:77], 2.0, v22
    v_subrev_co_u32 v23, s[78:79], 2.0, v23
    v_subrev_co_u32 v24, s[80:81], 2.0, v24
    v_subrev_co_u32 v25, s[82:83], 2.0, v25
    v_subrev_co_u32 v26, s[84:85], 2.0, v26
    v_subrev_co_u32 v27, s[86:87], 2.0, v27
    s_mov_b64 exec, s[64:65]
    ds_read_b64 v[52:53], v52
    s_mov_b64 exec, s[66:67]
    ds_read_b64 v[54:55], v54
    s_mov_b64 exec, s[68:69]
    ds_read_b64 v[56:57], v56
    s_mov_b64 exec, s[70:71]
    ds_read_b64 v[58:59], v58
    s_mov_b64 exec, s[72:73]
    ds_read_b64 v[60:61], v60
    s_mov_b64 exec, s[74:75]
    ds_read_b64 v[62:63], v62
    s_mov_b64 exec, s[76:77]
    ds_read_b64 v[64:65], v64
    s_mov_b64 exec, s[78:79]
    ds_read_b64 v[66:67], v66
    s_mov_b64 exec, s[80:81]
    ds_read_b64 v[68:69], v68
    s_mov_b64 exec, s[82:83]
    ds_read_b64 v[70:71], v70
    s_mov_b64 exec, s[84:85]
    ds_read_b64 v[72:73], v72
    s_mov_b64 exec, s[86:87]
    ds_read_b64 v[74:75], v74
    s_mov_b64 exec, -1
    s_waitcnt lgkmcnt(0)
    s_barrier
    s_waitcnt vmcnt(5)
    ds_write_b128 v3, v[76:79] offset:0
    s_waitcnt vmcnt(4)
    ds_write_b128 v3, v[80:83] offset:16384
    s_waitcnt vmcnt(3)
    ds_write_b128 v3, v[84:87] offset:32768
    v_lshlrev_b32 v123, 2, v0
    s_waitcnt vmcnt(2)
    s_mov_b64 exec, s[48:49]
    ds_write_b32 v123, v88 offset:49152
    s_mov_b64 exec, -1

    s_add_u32 s43, s43, 50000
    s_add_u32 s14, s43, 50000
    buffer_load_dwordx4 v[76:79], v3, s[12:15], s43 offen
    s_add_u32 s52, s43, 16384
    buffer_load_dwordx4 v[80:83], v3, s[12:15], s52 offen
    v_subrev_co_u32 v4, s[64:65], 2.0, v4
    v_subrev_co_u32 v5, s[66:67], 2.0, v5
    v_subrev_co_u32 v6, s[68:69], 2.0, v6
    v_subrev_co_u32 v7, s[70:71], 2.0, v7
    v_subrev_co_u32 v8, s[72:73], 2.0, v8
    v_subrev_co_u32 v9, s[74:75], 2.0, v9
    v_subrev_co_u32 v10, s[76:77], 2.0, v10
    v_subrev_co_u32 v11, s[78:79], 2.0, v11
    v_subrev_co_u32 v12, s[80:81], 2.0, v12
    v_subrev_co_u32 v13, s[82:83], 2.0, v13
    v_subrev_co_u32 v14, s[84:85], 2.0, v14
    v_subrev_co_u32 v15, s[86:87], 2.0, v15
    s_waitcnt lgkmcnt(0)
    s_barrier
    s_add_u32 s52, s43, 32768
    buffer_load_dwordx4 v[84:87], v3, s[12:15], s52 offen
    s_add_u32 s52, s43, 49152
    v_lshlrev_b32 v123, 2, v0
    buffer_load_dword v88, v123, s[12:15], s52 offen
    s_mov_b64 exec, s[64:65]
    ds_read_b64 v[28:29], v28
    s_mov_b64 exec, s[66:67]
    ds_read_b64 v[30:31], v30
    s_mov_b64 exec, s[68:69]
    ds_read_b64 v[32:33], v32
    s_mov_b64 exec, s[70:71]
    ds_read_b64 v[34:35], v34
    s_mov_b64 exec, s[72:73]
    ds_read_b64 v[36:37], v36
    s_mov_b64 exec, s[74:75]
    ds_read_b64 v[38:39], v38
    s_mov_b64 exec, s[76:77]
    ds_read_b64 v[40:41], v40
    s_mov_b64 exec, s[78:79]
    ds_read_b64 v[42:43], v42
    s_mov_b64 exec, s[80:81]
    ds_read_b64 v[44:45], v44
    s_mov_b64 exec, s[82:83]
    ds_read_b64 v[46:47], v46
    s_mov_b64 exec, s[84:85]
    ds_read_b64 v[48:49], v48
    s_mov_b64 exec, s[86:87]
    ds_read_b64 v[50:51], v50
    s_mov_b64 exec, -1
    s_movk_i32 s53, 7680
    buffer_load_dwordx4 v[94:97], v2, s[16:19], s53 offen
    buffer_load_dword v111, v2, s[16:19], s53 offen offset:16
    v_subrev_co_u32 v16, s[64:65], 2.0, v16
    v_subrev_co_u32 v17, s[66:67], 2.0, v17
    v_subrev_co_u32 v18, s[68:69], 2.0, v18
    v_subrev_co_u32 v19, s[70:71], 2.0, v19
    v_subrev_co_u32 v20, s[72:73], 2.0, v20
    v_subrev_co_u32 v21, s[74:75], 2.0, v21
    v_subrev_co_u32 v22, s[76:77], 2.0, v22
    v_subrev_co_u32 v23, s[78:79], 2.0, v23
    v_subrev_co_u32 v24, s[80:81], 2.0, v24
    v_subrev_co_u32 v25, s[82:83], 2.0, v25
    v_subrev_co_u32 v26, s[84:85], 2.0, v26
    v_subrev_co_u32 v27, s[86:87], 2.0, v27
    s_mov_b64 exec, s[64:65]
    ds_read_b64 v[52:53], v52
    s_mov_b64 exec, s[66:67]
    ds_read_b64 v[54:55], v54
    s_mov_b64 exec, s[68:69]
    ds_read_b64 v[56:57], v56
    s_mov_b64 exec, s[70:71]
    ds_read_b64 v[58:59], v58
    s_mov_b64 exec, s[72:73]
    ds_read_b64 v[60:61], v60
    s_mov_b64 exec, s[74:75]
    ds_read_b64 v[62:63], v62
    s_mov_b64 exec, s[76:77]
    ds_read_b64 v[64:65], v64
    s_mov_b64 exec, s[78:79]
    ds_read_b64 v[66:67], v66
    s_mov_b64 exec, s[80:81]
    ds_read_b64 v[68:69], v68
    s_mov_b64 exec, s[82:83]
    ds_read_b64 v[70:71], v70
    s_mov_b64 exec, s[84:85]
    ds_read_b64 v[72:73], v72
    s_mov_b64 exec, s[86:87]
    ds_read_b64 v[74:75], v74
    s_mov_b64 exec, -1
    s_waitcnt lgkmcnt(0)
    s_barrier
    s_waitcnt vmcnt(5)
    ds_write_b128 v3, v[76:79] offset:0
    s_waitcnt vmcnt(4)
    ds_write_b128 v3, v[80:83] offset:16384
    s_waitcnt vmcnt(3)
    ds_write_b128 v3, v[84:87] offset:32768
    v_lshlrev_b32 v123, 2, v0
    s_waitcnt vmcnt(2)
    s_mov_b64 exec, s[48:49]
    ds_write_b32 v123, v88 offset:49152
    s_mov_b64 exec, -1

    s_add_u32 s43, s43, 50000
    s_add_u32 s14, s43, 50000
    buffer_load_dwordx4 v[76:79], v3, s[12:15], s43 offen
    s_add_u32 s52, s43, 16384
    buffer_load_dwordx4 v[80:83], v3, s[12:15], s52 offen
    v_subrev_co_u32 v4, s[64:65], 2.0, v4
    v_subrev_co_u32 v5, s[66:67], 2.0, v5
    v_subrev_co_u32 v6, s[68:69], 2.0, v6
    v_subrev_co_u32 v7, s[70:71], 2.0, v7
    v_subrev_co_u32 v8, s[72:73], 2.0, v8
    v_subrev_co_u32 v9, s[74:75], 2.0, v9
    v_subrev_co_u32 v10, s[76:77], 2.0, v10
    v_subrev_co_u32 v11, s[78:79], 2.0, v11
    v_subrev_co_u32 v12, s[80:81], 2.0, v12
    v_subrev_co_u32 v13, s[82:83], 2.0, v13
    v_subrev_co_u32 v14, s[84:85], 2.0, v14
    v_subrev_co_u32 v15, s[86:87], 2.0, v15
    s_waitcnt lgkmcnt(0)
    s_barrier
    s_add_u32 s52, s43, 32768
    buffer_load_dwordx4 v[84:87], v3, s[12:15], s52 offen
    s_add_u32 s52, s43, 49152
    v_lshlrev_b32 v123, 2, v0
    buffer_load_dword v88, v123, s[12:15], s52 offen
    s_mov_b64 exec, s[64:65]
    ds_read_b64 v[28:29], v28
    s_mov_b64 exec, s[66:67]
    ds_read_b64 v[30:31], v30
    s_mov_b64 exec, s[68:69]
    ds_read_b64 v[32:33], v32
    s_mov_b64 exec, s[70:71]
    ds_read_b64 v[34:35], v34
    s_mov_b64 exec, s[72:73]
    ds_read_b64 v[36:37], v36
    s_mov_b64 exec, s[74:75]
    ds_read_b64 v[38:39], v38
    s_mov_b64 exec, s[76:77]
    ds_read_b64 v[40:41], v40
    s_mov_b64 exec, s[78:79]
    ds_read_b64 v[42:43], v42
    s_mov_b64 exec, s[80:81]
    ds_read_b64 v[44:45], v44
    s_mov_b64 exec, s[82:83]
    ds_read_b64 v[46:47], v46
    s_mov_b64 exec, s[84:85]
    ds_read_b64 v[48:49], v48
    s_mov_b64 exec, s[86:87]
    ds_read_b64 v[50:51], v50
    s_mov_b64 exec, -1
    s_movk_i32 s53, 10240
    buffer_load_dwordx4 v[98:101], v2, s[16:19], s53 offen
    buffer_load_dword v112, v2, s[16:19], s53 offen offset:16
    v_subrev_co_u32 v16, s[64:65], 2.0, v16
    v_subrev_co_u32 v17, s[66:67], 2.0, v17
    v_subrev_co_u32 v18, s[68:69], 2.0, v18
    v_subrev_co_u32 v19, s[70:71], 2.0, v19
    v_subrev_co_u32 v20, s[72:73], 2.0, v20
    v_subrev_co_u32 v21, s[74:75], 2.0, v21
    v_subrev_co_u32 v22, s[76:77], 2.0, v22
    v_subrev_co_u32 v23, s[78:79], 2.0, v23
    v_subrev_co_u32 v24, s[80:81], 2.0, v24
    v_subrev_co_u32 v25, s[82:83], 2.0, v25
    v_subrev_co_u32 v26, s[84:85], 2.0, v26
    v_subrev_co_u32 v27, s[86:87], 2.0, v27
    s_mov_b64 exec, s[64:65]
    ds_read_b64 v[52:53], v52
    s_mov_b64 exec, s[66:67]
    ds_read_b64 v[54:55], v54
    s_mov_b64 exec, s[68:69]
    ds_read_b64 v[56:57], v56
    s_mov_b64 exec, s[70:71]
    ds_read_b64 v[58:59], v58
    s_mov_b64 exec, s[72:73]
    ds_read_b64 v[60:61], v60
    s_mov_b64 exec, s[74:75]
    ds_read_b64 v[62:63], v62
    s_mov_b64 exec, s[76:77]
    ds_read_b64 v[64:65], v64
    s_mov_b64 exec, s[78:79]
    ds_read_b64 v[66:67], v66
    s_mov_b64 exec, s[80:81]
    ds_read_b64 v[68:69], v68
    s_mov_b64 exec, s[82:83]
    ds_read_b64 v[70:71], v70
    s_mov_b64 exec, s[84:85]
    ds_read_b64 v[72:73], v72
    s_mov_b64 exec, s[86:87]
    ds_read_b64 v[74:75], v74
    s_mov_b64 exec, -1
    s_waitcnt lgkmcnt(0)
    s_barrier
    s_waitcnt vmcnt(5)
    ds_write_b128 v3, v[76:79] offset:0
    s_waitcnt vmcnt(4)
    ds_write_b128 v3, v[80:83] offset:16384
    s_waitcnt vmcnt(3)
    ds_write_b128 v3, v[84:87] offset:32768
    v_lshlrev_b32 v123, 2, v0
    s_waitcnt vmcnt(2)
    s_mov_b64 exec, s[48:49]
    ds_write_b32 v123, v88 offset:49152
    s_mov_b64 exec, -1

    s_add_u32 s43, s43, 50000
    s_add_u32 s14, s43, 50000
    s_cmp_lt_u32 s5, s4
    s_cselect_b32 s14, s14, 0
    buffer_load_dwordx4 v[76:79], v3, s[12:15], s43 offen
    s_add_u32 s52, s43, 16384
    buffer_load_dwordx4 v[80:83], v3, s[12:15], s52 offen
    v_cmp_gt_u32 s[64:65], 2.0, v4
    v_and_b32 v4, 0x3fffffff, v4
    v_cmp_gt_u32 s[66:67], 2.0, v5
    v_and_b32 v5, 0x3fffffff, v5
    v_cmp_gt_u32 s[68:69], 2.0, v6
    v_and_b32 v6, 0x3fffffff, v6
    v_cmp_gt_u32 s[70:71], 2.0, v7
    v_and_b32 v7, 0x3fffffff, v7
    v_cmp_gt_u32 s[72:73], 2.0, v8
    v_and_b32 v8, 0x3fffffff, v8
    v_cmp_gt_u32 s[74:75], 2.0, v9
    v_and_b32 v9, 0x3fffffff, v9
    v_cmp_gt_u32 s[76:77], 2.0, v10
    v_and_b32 v10, 0x3fffffff, v10
    v_cmp_gt_u32 s[78:79], 2.0, v11
    v_and_b32 v11, 0x3fffffff, v11
    v_cmp_gt_u32 s[80:81], 2.0, v12
    v_and_b32 v12, 0x3fffffff, v12
    v_cmp_gt_u32 s[82:83], 2.0, v13
    v_and_b32 v13, 0x3fffffff, v13
    v_cmp_gt_u32 s[84:85], 2.0, v14
    v_and_b32 v14, 0x3fffffff, v14
    v_cmp_gt_u32 s[86:87], 2.0, v15
    v_and_b32 v15, 0x3fffffff, v15
    s_waitcnt lgkmcnt(0)
    s_barrier
    s_add_u32 s52, s43, 32768
    buffer_load_dwordx4 v[84:87], v3, s[12:15], s52 offen
    s_add_u32 s52, s43, 49152
    v_lshlrev_b32 v123, 2, v0
    buffer_load_dword v88, v123, s[12:15], s52 offen
    s_mov_b64 exec, s[64:65]
    ds_read_b64 v[28:29], v28
    s_mov_b64 exec, s[66:67]
    ds_read_b64 v[30:31], v30
    s_mov_b64 exec, s[68:69]
    ds_read_b64 v[32:33], v32
    s_mov_b64 exec, s[70:71]
    ds_read_b64 v[34:35], v34
    s_mov_b64 exec, s[72:73]
    ds_read_b64 v[36:37], v36
    s_mov_b64 exec, s[74:75]
    ds_read_b64 v[38:39], v38
    s_mov_b64 exec, s[76:77]
    ds_read_b64 v[40:41], v40
    s_mov_b64 exec, s[78:79]
    ds_read_b64 v[42:43], v42
    s_mov_b64 exec, s[80:81]
    ds_read_b64 v[44:45], v44
    s_mov_b64 exec, s[82:83]
    ds_read_b64 v[46:47], v46
    s_mov_b64 exec, s[84:85]
    ds_read_b64 v[48:49], v48
    s_mov_b64 exec, s[86:87]
    ds_read_b64 v[50:51], v50
    s_mov_b64 exec, -1
    s_movk_i32 s53, 12800
    buffer_load_dwordx4 v[102:105], v2, s[16:19], s53 offen
    buffer_load_dword v113, v2, s[16:19], s53 offen offset:16
    v_cmp_gt_u32 s[64:65], 2.0, v16
    v_and_b32 v16, 0x3fffffff, v16
    v_cmp_gt_u32 s[66:67], 2.0, v17
    v_and_b32 v17, 0x3fffffff, v17
    v_cmp_gt_u32 s[68:69], 2.0, v18
    v_and_b32 v18, 0x3fffffff, v18
    v_cmp_gt_u32 s[70:71], 2.0, v19
    v_and_b32 v19, 0x3fffffff, v19
    v_cmp_gt_u32 s[72:73], 2.0, v20
    v_and_b32 v20, 0x3fffffff, v20
    v_cmp_gt_u32 s[74:75], 2.0, v21
    v_and_b32 v21, 0x3fffffff, v21
    v_cmp_gt_u32 s[76:77], 2.0, v22
    v_and_b32 v22, 0x3fffffff, v22
    v_cmp_gt_u32 s[78:79], 2.0, v23
    v_and_b32 v23, 0x3fffffff, v23
    v_cmp_gt_u32 s[80:81], 2.0, v24
    v_and_b32 v24, 0x3fffffff, v24
    v_cmp_gt_u32 s[82:83], 2.0, v25
    v_and_b32 v25, 0x3fffffff, v25
    v_cmp_gt_u32 s[84:85], 2.0, v26
    v_and_b32 v26, 0x3fffffff, v26
    v_cmp_gt_u32 s[86:87], 2.0, v27
    v_and_b32 v27, 0x3fffffff, v27
    s_mov_b64 exec, s[64:65]
    ds_read_b64 v[52:53], v52
    s_mov_b64 exec, s[66:67]
    ds_read_b64 v[54:55], v54
    s_mov_b64 exec, s[68:69]
    ds_read_b64 v[56:57], v56
    s_mov_b64 exec, s[70:71]
    ds_read_b64 v[58:59], v58
    s_mov_b64 exec, s[72:73]
    ds_read_b64 v[60:61], v60
    s_mov_b64 exec, s[74:75]
    ds_read_b64 v[62:63], v62
    s_mov_b64 exec, s[76:77]
    ds_read_b64 v[64:65], v64
    s_mov_b64 exec, s[78:79]
    ds_read_b64 v[66:67], v66
    s_mov_b64 exec, s[80:81]
    ds_read_b64 v[68:69], v68
    s_mov_b64 exec, s[82:83]
    ds_read_b64 v[70:71], v70
    s_mov_b64 exec, s[84:85]
    ds_read_b64 v[72:73], v72
    s_mov_b64 exec, s[86:87]
    ds_read_b64 v[74:75], v74
    s_mov_b64 exec, -1
    s_waitcnt lgkmcnt(0)
    s_barrier
    s_waitcnt vmcnt(5)
    ds_write_b128 v3, v[76:79] offset:0
    s_waitcnt vmcnt(4)
    ds_write_b128 v3, v[80:83] offset:16384
    s_waitcnt vmcnt(3)
    ds_write_b128 v3, v[84:87] offset:32768
    v_lshlrev_b32 v123, 2, v0
    s_waitcnt vmcnt(2)
    s_mov_b64 exec, s[48:49]
    ds_write_b32 v123, v88 offset:49152
    s_mov_b64 exec, -1

    s_add_u32 s43, s43, 50000
    s_add_u32 s14, s43, 50000
    s_cmp_lt_u32 s5, s4
    s_cselect_b32 s14, s14, 0
    buffer_load_dwordx4 v[76:79], v3, s[12:15], s43 offen
    s_add_u32 s52, s43, 16384
    buffer_load_dwordx4 v[80:83], v3, s[12:15], s52 offen
    s_add_u32 s52, s43, 32768
    buffer_load_dwordx4 v[84:87], v3, s[12:15], s52 offen
    s_add_u32 s52, s43, 49152
    v_lshlrev_b32 v123, 2, v0
    buffer_load_dword v88, v123, s[12:15], s52 offen
    s_add_u32 s54, s43, 50000
    buffer_load_dword v115, v89, s[8:11], s54 offen
    v_cvt_f32_i32_sdwa v118, sext(v4) dst_sel:DWORD dst_unused:UNUSED_PAD src0_sel:WORD_0
    v_lshlrev_b32 v116, 16, v28
    v_and_b32 v117, s32, v28
    v_mul_f32 v118, s33, v118
    v_lshlrev_b32 v28, 16, v29
    v_and_b32 v29, s32, v29
    v_lshlrev_b32_sdwa v4, 3, v4 dst_sel:DWORD dst_unused:UNUSED_PAD src0_sel:DWORD src1_sel:WORD_1
    v_pk_fma_f32 v[116:117], v[116:117], v[118:119], s[28:29] op_sel_hi:[1,0,1]
    v_pk_fma_f32 v[28:29], v[28:29], v[118:119], s[28:29] op_sel_hi:[1,0,1]
    v_perm_b32 v116, v117, v116, s35
    v_perm_b32 v117, v29, v28, s35
    v_lshl_add_u64 v[116:117], v[116:117], 0, s[30:31]
    ds_add_rtn_u64 v[28:29], v4, v[116:117] offset:50000

    v_cvt_f32_i32_sdwa v122, sext(v5) dst_sel:DWORD dst_unused:UNUSED_PAD src0_sel:WORD_0
    v_lshlrev_b32 v120, 16, v30
    v_and_b32 v121, s32, v30
    v_mul_f32 v122, s33, v122
    v_lshlrev_b32 v30, 16, v31
    v_and_b32 v31, s32, v31
    v_lshlrev_b32_sdwa v5, 3, v5 dst_sel:DWORD dst_unused:UNUSED_PAD src0_sel:DWORD src1_sel:WORD_1
    v_pk_fma_f32 v[120:121], v[120:121], v[122:123], s[28:29] op_sel_hi:[1,0,1]
    v_pk_fma_f32 v[30:31], v[30:31], v[122:123], s[28:29] op_sel_hi:[1,0,1]
    v_perm_b32 v120, v121, v120, s35
    v_perm_b32 v121, v31, v30, s35
    v_lshl_add_u64 v[120:121], v[120:121], 0, s[30:31]
    ds_add_rtn_u64 v[30:31], v5, v[120:121] offset:50000

    v_cvt_f32_i32_sdwa v118, sext(v6) dst_sel:DWORD dst_unused:UNUSED_PAD src0_sel:WORD_0
    v_lshlrev_b32 v116, 16, v32
    v_and_b32 v117, s32, v32
    v_mul_f32 v118, s33, v118
    v_lshlrev_b32 v32, 16, v33
    v_and_b32 v33, s32, v33
    v_lshlrev_b32_sdwa v6, 3, v6 dst_sel:DWORD dst_unused:UNUSED_PAD src0_sel:DWORD src1_sel:WORD_1
    v_pk_fma_f32 v[116:117], v[116:117], v[118:119], s[28:29] op_sel_hi:[1,0,1]
    v_pk_fma_f32 v[32:33], v[32:33], v[118:119], s[28:29] op_sel_hi:[1,0,1]
    v_perm_b32 v116, v117, v116, s35
    v_perm_b32 v117, v33, v32, s35
    v_lshl_add_u64 v[116:117], v[116:117], 0, s[30:31]
    ds_add_rtn_u64 v[32:33], v6, v[116:117] offset:50000

    v_cvt_f32_i32_sdwa v122, sext(v7) dst_sel:DWORD dst_unused:UNUSED_PAD src0_sel:WORD_0
    v_lshlrev_b32 v120, 16, v34
    v_and_b32 v121, s32, v34
    v_mul_f32 v122, s33, v122
    v_lshlrev_b32 v34, 16, v35
    v_and_b32 v35, s32, v35
    v_lshlrev_b32_sdwa v7, 3, v7 dst_sel:DWORD dst_unused:UNUSED_PAD src0_sel:DWORD src1_sel:WORD_1
    v_pk_fma_f32 v[120:121], v[120:121], v[122:123], s[28:29] op_sel_hi:[1,0,1]
    v_pk_fma_f32 v[34:35], v[34:35], v[122:123], s[28:29] op_sel_hi:[1,0,1]
    v_perm_b32 v120, v121, v120, s35
    v_perm_b32 v121, v35, v34, s35
    v_lshl_add_u64 v[120:121], v[120:121], 0, s[30:31]
    ds_add_rtn_u64 v[34:35], v7, v[120:121] offset:50000

    v_cvt_f32_i32_sdwa v118, sext(v8) dst_sel:DWORD dst_unused:UNUSED_PAD src0_sel:WORD_0
    v_lshlrev_b32 v116, 16, v36
    v_and_b32 v117, s32, v36
    v_mul_f32 v118, s33, v118
    v_lshlrev_b32 v36, 16, v37
    v_and_b32 v37, s32, v37
    v_lshlrev_b32_sdwa v8, 3, v8 dst_sel:DWORD dst_unused:UNUSED_PAD src0_sel:DWORD src1_sel:WORD_1
    v_pk_fma_f32 v[116:117], v[116:117], v[118:119], s[28:29] op_sel_hi:[1,0,1]
    v_pk_fma_f32 v[36:37], v[36:37], v[118:119], s[28:29] op_sel_hi:[1,0,1]
    v_perm_b32 v116, v117, v116, s35
    v_perm_b32 v117, v37, v36, s35
    v_lshl_add_u64 v[116:117], v[116:117], 0, s[30:31]
    ds_add_rtn_u64 v[36:37], v8, v[116:117] offset:50000

    v_cvt_f32_i32_sdwa v122, sext(v9) dst_sel:DWORD dst_unused:UNUSED_PAD src0_sel:WORD_0
    v_lshlrev_b32 v120, 16, v38
    v_and_b32 v121, s32, v38
    v_mul_f32 v122, s33, v122
    v_lshlrev_b32 v38, 16, v39
    v_and_b32 v39, s32, v39
    v_lshlrev_b32_sdwa v9, 3, v9 dst_sel:DWORD dst_unused:UNUSED_PAD src0_sel:DWORD src1_sel:WORD_1
    v_pk_fma_f32 v[120:121], v[120:121], v[122:123], s[28:29] op_sel_hi:[1,0,1]
    v_pk_fma_f32 v[38:39], v[38:39], v[122:123], s[28:29] op_sel_hi:[1,0,1]
    v_perm_b32 v120, v121, v120, s35
    v_perm_b32 v121, v39, v38, s35
    v_lshl_add_u64 v[120:121], v[120:121], 0, s[30:31]
    ds_add_rtn_u64 v[38:39], v9, v[120:121] offset:50000

    v_cvt_f32_i32_sdwa v118, sext(v10) dst_sel:DWORD dst_unused:UNUSED_PAD src0_sel:WORD_0
    v_lshlrev_b32 v116, 16, v40
    v_and_b32 v117, s32, v40
    v_mul_f32 v118, s33, v118
    v_lshlrev_b32 v40, 16, v41
    v_and_b32 v41, s32, v41
    v_lshlrev_b32_sdwa v10, 3, v10 dst_sel:DWORD dst_unused:UNUSED_PAD src0_sel:DWORD src1_sel:WORD_1
    v_pk_fma_f32 v[116:117], v[116:117], v[118:119], s[28:29] op_sel_hi:[1,0,1]
    v_pk_fma_f32 v[40:41], v[40:41], v[118:119], s[28:29] op_sel_hi:[1,0,1]
    v_perm_b32 v116, v117, v116, s35
    v_perm_b32 v117, v41, v40, s35
    v_lshl_add_u64 v[116:117], v[116:117], 0, s[30:31]
    ds_add_rtn_u64 v[40:41], v10, v[116:117] offset:50000

    v_cvt_f32_i32_sdwa v122, sext(v11) dst_sel:DWORD dst_unused:UNUSED_PAD src0_sel:WORD_0
    v_lshlrev_b32 v120, 16, v42
    v_and_b32 v121, s32, v42
    v_mul_f32 v122, s33, v122
    v_lshlrev_b32 v42, 16, v43
    v_and_b32 v43, s32, v43
    v_lshlrev_b32_sdwa v11, 3, v11 dst_sel:DWORD dst_unused:UNUSED_PAD src0_sel:DWORD src1_sel:WORD_1
    v_pk_fma_f32 v[120:121], v[120:121], v[122:123], s[28:29] op_sel_hi:[1,0,1]
    v_pk_fma_f32 v[42:43], v[42:43], v[122:123], s[28:29] op_sel_hi:[1,0,1]
    v_perm_b32 v120, v121, v120, s35
    v_perm_b32 v121, v43, v42, s35
    v_lshl_add_u64 v[120:121], v[120:121], 0, s[30:31]
    ds_add_rtn_u64 v[42:43], v11, v[120:121] offset:50000

    s_waitcnt lgkmcnt(4)
    v_or3_b32 v1, v28, v29, v1
    v_or3_b32 v1, v30, v31, v1
    v_or3_b32 v1, v32, v33, v1
    v_or3_b32 v1, v34, v35, v1
    s_movk_i32 s53, 0
    buffer_load_dwordx4 v[4:7], v2, s[16:19], s53 offen
    buffer_load_dword v35, v2, s[16:19], s53 offen offset:16
    v_cvt_f32_i32_sdwa v118, sext(v12) dst_sel:DWORD dst_unused:UNUSED_PAD src0_sel:WORD_0
    v_lshlrev_b32 v116, 16, v44
    v_and_b32 v117, s32, v44
    v_mul_f32 v118, s33, v118
    v_lshlrev_b32 v44, 16, v45
    v_and_b32 v45, s32, v45
    v_lshlrev_b32_sdwa v12, 3, v12 dst_sel:DWORD dst_unused:UNUSED_PAD src0_sel:DWORD src1_sel:WORD_1
    v_pk_fma_f32 v[116:117], v[116:117], v[118:119], s[28:29] op_sel_hi:[1,0,1]
    v_pk_fma_f32 v[44:45], v[44:45], v[118:119], s[28:29] op_sel_hi:[1,0,1]
    v_perm_b32 v116, v117, v116, s35
    v_perm_b32 v117, v45, v44, s35
    v_lshl_add_u64 v[116:117], v[116:117], 0, s[30:31]
    ds_add_rtn_u64 v[44:45], v12, v[116:117] offset:50000

    v_cvt_f32_i32_sdwa v122, sext(v13) dst_sel:DWORD dst_unused:UNUSED_PAD src0_sel:WORD_0
    v_lshlrev_b32 v120, 16, v46
    v_and_b32 v121, s32, v46
    v_mul_f32 v122, s33, v122
    v_lshlrev_b32 v46, 16, v47
    v_and_b32 v47, s32, v47
    v_lshlrev_b32_sdwa v13, 3, v13 dst_sel:DWORD dst_unused:UNUSED_PAD src0_sel:DWORD src1_sel:WORD_1
    v_pk_fma_f32 v[120:121], v[120:121], v[122:123], s[28:29] op_sel_hi:[1,0,1]
    v_pk_fma_f32 v[46:47], v[46:47], v[122:123], s[28:29] op_sel_hi:[1,0,1]
    v_perm_b32 v120, v121, v120, s35
    v_perm_b32 v121, v47, v46, s35
    v_lshl_add_u64 v[120:121], v[120:121], 0, s[30:31]
    ds_add_rtn_u64 v[46:47], v13, v[120:121] offset:50000

    v_cvt_f32_i32_sdwa v118, sext(v14) dst_sel:DWORD dst_unused:UNUSED_PAD src0_sel:WORD_0
    v_lshlrev_b32 v116, 16, v48
    v_and_b32 v117, s32, v48
    v_mul_f32 v118, s33, v118
    v_lshlrev_b32 v48, 16, v49
    v_and_b32 v49, s32, v49
    v_lshlrev_b32_sdwa v14, 3, v14 dst_sel:DWORD dst_unused:UNUSED_PAD src0_sel:DWORD src1_sel:WORD_1
    v_pk_fma_f32 v[116:117], v[116:117], v[118:119], s[28:29] op_sel_hi:[1,0,1]
    v_pk_fma_f32 v[48:49], v[48:49], v[118:119], s[28:29] op_sel_hi:[1,0,1]
    v_perm_b32 v116, v117, v116, s35
    v_perm_b32 v117, v49, v48, s35
    v_lshl_add_u64 v[116:117], v[116:117], 0, s[30:31]
    ds_add_rtn_u64 v[48:49], v14, v[116:117] offset:50000

    v_cvt_f32_i32_sdwa v122, sext(v15) dst_sel:DWORD dst_unused:UNUSED_PAD src0_sel:WORD_0
    v_lshlrev_b32 v120, 16, v50
    v_and_b32 v121, s32, v50
    v_mul_f32 v122, s33, v122
    v_lshlrev_b32 v50, 16, v51
    v_and_b32 v51, s32, v51
    v_lshlrev_b32_sdwa v15, 3, v15 dst_sel:DWORD dst_unused:UNUSED_PAD src0_sel:DWORD src1_sel:WORD_1
    v_pk_fma_f32 v[120:121], v[120:121], v[122:123], s[28:29] op_sel_hi:[1,0,1]
    v_pk_fma_f32 v[50:51], v[50:51], v[122:123], s[28:29] op_sel_hi:[1,0,1]
    v_perm_b32 v120, v121, v120, s35
    v_perm_b32 v121, v51, v50, s35
    v_lshl_add_u64 v[120:121], v[120:121], 0, s[30:31]
    ds_add_rtn_u64 v[50:51], v15, v[120:121] offset:50000

    s_waitcnt lgkmcnt(4)
    v_or3_b32 v1, v36, v37, v1
    v_or3_b32 v1, v38, v39, v1
    v_or3_b32 v1, v40, v41, v1
    v_or3_b32 v1, v42, v43, v1
    s_movk_i32 s53, 2560
    buffer_load_dwordx4 v[8:11], v2, s[16:19], s53 offen
    buffer_load_dword v43, v2, s[16:19], s53 offen offset:16
    v_cvt_f32_i32_sdwa v118, sext(v16) dst_sel:DWORD dst_unused:UNUSED_PAD src0_sel:WORD_0
    v_lshlrev_b32 v116, 16, v52
    v_and_b32 v117, s32, v52
    v_mul_f32 v118, s33, v118
    v_lshlrev_b32 v52, 16, v53
    v_and_b32 v53, s32, v53
    v_lshlrev_b32_sdwa v16, 3, v16 dst_sel:DWORD dst_unused:UNUSED_PAD src0_sel:DWORD src1_sel:WORD_1
    v_pk_fma_f32 v[116:117], v[116:117], v[118:119], s[28:29] op_sel_hi:[1,0,1]
    v_pk_fma_f32 v[52:53], v[52:53], v[118:119], s[28:29] op_sel_hi:[1,0,1]
    v_perm_b32 v116, v117, v116, s35
    v_perm_b32 v117, v53, v52, s35
    v_lshl_add_u64 v[116:117], v[116:117], 0, s[30:31]
    ds_add_rtn_u64 v[52:53], v16, v[116:117] offset:50000

    v_cvt_f32_i32_sdwa v122, sext(v17) dst_sel:DWORD dst_unused:UNUSED_PAD src0_sel:WORD_0
    v_lshlrev_b32 v120, 16, v54
    v_and_b32 v121, s32, v54
    v_mul_f32 v122, s33, v122
    v_lshlrev_b32 v54, 16, v55
    v_and_b32 v55, s32, v55
    v_lshlrev_b32_sdwa v17, 3, v17 dst_sel:DWORD dst_unused:UNUSED_PAD src0_sel:DWORD src1_sel:WORD_1
    v_pk_fma_f32 v[120:121], v[120:121], v[122:123], s[28:29] op_sel_hi:[1,0,1]
    v_pk_fma_f32 v[54:55], v[54:55], v[122:123], s[28:29] op_sel_hi:[1,0,1]
    v_perm_b32 v120, v121, v120, s35
    v_perm_b32 v121, v55, v54, s35
    v_lshl_add_u64 v[120:121], v[120:121], 0, s[30:31]
    ds_add_rtn_u64 v[54:55], v17, v[120:121] offset:50000

    v_cvt_f32_i32_sdwa v118, sext(v18) dst_sel:DWORD dst_unused:UNUSED_PAD src0_sel:WORD_0
    v_lshlrev_b32 v116, 16, v56
    v_and_b32 v117, s32, v56
    v_mul_f32 v118, s33, v118
    v_lshlrev_b32 v56, 16, v57
    v_and_b32 v57, s32, v57
    v_lshlrev_b32_sdwa v18, 3, v18 dst_sel:DWORD dst_unused:UNUSED_PAD src0_sel:DWORD src1_sel:WORD_1
    v_pk_fma_f32 v[116:117], v[116:117], v[118:119], s[28:29] op_sel_hi:[1,0,1]
    v_pk_fma_f32 v[56:57], v[56:57], v[118:119], s[28:29] op_sel_hi:[1,0,1]
    v_perm_b32 v116, v117, v116, s35
    v_perm_b32 v117, v57, v56, s35
    v_lshl_add_u64 v[116:117], v[116:117], 0, s[30:31]
    ds_add_rtn_u64 v[56:57], v18, v[116:117] offset:50000

    v_cvt_f32_i32_sdwa v122, sext(v19) dst_sel:DWORD dst_unused:UNUSED_PAD src0_sel:WORD_0
    v_lshlrev_b32 v120, 16, v58
    v_and_b32 v121, s32, v58
    v_mul_f32 v122, s33, v122
    v_lshlrev_b32 v58, 16, v59
    v_and_b32 v59, s32, v59
    v_lshlrev_b32_sdwa v19, 3, v19 dst_sel:DWORD dst_unused:UNUSED_PAD src0_sel:DWORD src1_sel:WORD_1
    v_pk_fma_f32 v[120:121], v[120:121], v[122:123], s[28:29] op_sel_hi:[1,0,1]
    v_pk_fma_f32 v[58:59], v[58:59], v[122:123], s[28:29] op_sel_hi:[1,0,1]
    v_perm_b32 v120, v121, v120, s35
    v_perm_b32 v121, v59, v58, s35
    v_lshl_add_u64 v[120:121], v[120:121], 0, s[30:31]
    ds_add_rtn_u64 v[58:59], v19, v[120:121] offset:50000

    s_waitcnt lgkmcnt(4)
    v_or3_b32 v1, v44, v45, v1
    v_or3_b32 v1, v46, v47, v1
    v_or3_b32 v1, v48, v49, v1
    v_or3_b32 v1, v50, v51, v1
    s_cmp_le_i32 s42, 3072
    s_cbranch_scc1 L_nt1_32
    s_waitcnt vmcnt(29)
    v_perm_b32 v116, v107, v106, s24
    v_perm_b32 v118, v108, v107, s25
    v_perm_b32 v120, v109, v108, s26
    v_perm_b32 v122, v114, v109, s27
    v_alignbyte_b32 v107, v108, v107, 1
    v_alignbyte_b32 v108, v109, v108, 2
    v_alignbyte_b32 v109, v114, v109, 3
    v_lshlrev_b32_sdwa v116, 3, v116 dst_sel:WORD_0 dst_unused:UNUSED_PAD src0_sel:DWORD src1_sel:DWORD
    v_lshlrev_b32_sdwa v118, 3, v118 dst_sel:WORD_0 dst_unused:UNUSED_PAD src0_sel:DWORD src1_sel:DWORD
    v_lshlrev_b32_sdwa v120, 3, v120 dst_sel:WORD_0 dst_unused:UNUSED_PAD src0_sel:DWORD src1_sel:DWORD
    v_lshlrev_b32_sdwa v122, 3, v122 dst_sel:WORD_0 dst_unused:UNUSED_PAD src0_sel:DWORD src1_sel:DWORD
    s_cmp_lt_i32 s42, 3328
    s_cbranch_scc1 L_ufix_34
L_uback_35:

    v_lshrrev_b32 v117, 30, v106
    v_cmp_ne_u32 vcc, 0, v106
    v_mul_u32_u24 v117, 50000, v117
    v_and_b32 v106, 0x3fffffff, v106
    v_add_u32 v116, v116, v117
    s_mov_b64 s[64:65], vcc
    s_mov_b64 exec, vcc

    buffer_load_dwordx2 v[44:45], v116, s[8:11], s50 offen
    s_mov_b64 exec, -1
    v_lshrrev_b32 v117, 30, v107
    v_cmp_ne_u32 vcc, 0, v107
    v_mul_u32_u24 v117, 50000, v117
    v_and_b32 v107, 0x3fffffff, v107
    v_add_u32 v118, v118, v117
    s_mov_b64 s[66:67], vcc
    s_mov_b64 exec, vcc

    buffer_load_dwordx2 v[46:47], v118, s[8:11], s50 offen
    s_mov_b64 exec, -1
    v_lshrrev_b32 v117, 30, v108
    v_cmp_ne_u32 vcc, 0, v108
    v_mul_u32_u24 v117, 50000, v117
    v_and_b32 v108, 0x3fffffff, v108
    v_add_u32 v120, v120, v117
    s_mov_b64 s[68:69], vcc
    s_mov_b64 exec, vcc

    buffer_load_dwordx2 v[48:49], v120, s[8:11], s50 offen
    s_mov_b64 exec, -1
    v_lshrrev_b32 v117, 30, v109
    v_cmp_ne_u32 vcc, 0, v109
    v_mul_u32_u24 v117, 50000, v117
    v_and_b32 v109, 0x3fffffff, v109
    v_add_u32 v122, v122, v117
    s_mov_b64 s[70:71], vcc
    s_mov_b64 exec, vcc

    buffer_load_dwordx2 v[50:51], v122, s[8:11], s50 offen
    s_mov_b64 exec, -1
L_nt1_32:
    v_cvt_f32_i32_sdwa v118, sext(v20) dst_sel:DWORD dst_unused:UNUSED_PAD src0_sel:WORD_0
    v_lshlrev_b32 v116, 16, v60
    v_and_b32 v117, s32, v60
    v_mul_f32 v118, s33, v118
    v_lshlrev_b32 v60, 16, v61
    v_and_b32 v61, s32, v61
    v_lshlrev_b32_sdwa v20, 3, v20 dst_sel:DWORD dst_unused:UNUSED_PAD src0_sel:DWORD src1_sel:WORD_1
    v_pk_fma_f32 v[116:117], v[116:117], v[118:119], s[28:29] op_sel_hi:[1,0,1]
    v_pk_fma_f32 v[60:61], v[60:61], v[118:119], s[28:29] op_sel_hi:[1,0,1]
    v_perm_b32 v116, v117, v116, s35
    v_perm_b32 v117, v61, v60, s35
    v_lshl_add_u64 v[116:117], v[116:117], 0, s[30:31]
    ds_add_rtn_u64 v[60:61], v20, v[116:117] offset:50000

    v_cvt_f32_i32_sdwa v122, sext(v21) dst_sel:DWORD dst_unused:UNUSED_PAD src0_sel:WORD_0
    v_lshlrev_b32 v120, 16, v62
    v_and_b32 v121, s32, v62
    v_mul_f32 v122, s33, v122
    v_lshlrev_b32 v62, 16, v63
    v_and_b32 v63, s32, v63
    v_lshlrev_b32_sdwa v21, 3, v21 dst_sel:DWORD dst_unused:UNUSED_PAD src0_sel:DWORD src1_sel:WORD_1
    v_pk_fma_f32 v[120:121], v[120:121], v[122:123], s[28:29] op_sel_hi:[1,0,1]
    v_pk_fma_f32 v[62:63], v[62:63], v[122:123], s[28:29] op_sel_hi:[1,0,1]
    v_perm_b32 v120, v121, v120, s35
    v_perm_b32 v121, v63, v62, s35
    v_lshl_add_u64 v[120:121], v[120:121], 0, s[30:31]
    ds_add_rtn_u64 v[62:63], v21, v[120:121] offset:50000

    v_cvt_f32_i32_sdwa v118, sext(v22) dst_sel:DWORD dst_unused:UNUSED_PAD src0_sel:WORD_0
    v_lshlrev_b32 v116, 16, v64
    v_and_b32 v117, s32, v64
    v_mul_f32 v118, s33, v118
    v_lshlrev_b32 v64, 16, v65
    v_and_b32 v65, s32, v65
    v_lshlrev_b32_sdwa v22, 3, v22 dst_sel:DWORD dst_unused:UNUSED_PAD src0_sel:DWORD src1_sel:WORD_1
    v_pk_fma_f32 v[116:117], v[116:117], v[118:119], s[28:29] op_sel_hi:[1,0,1]
    v_pk_fma_f32 v[64:65], v[64:65], v[118:119], s[28:29] op_sel_hi:[1,0,1]
    v_perm_b32 v116, v117, v116, s35
    v_perm_b32 v117, v65, v64, s35
    v_lshl_add_u64 v[116:117], v[116:117], 0, s[30:31]
    ds_add_rtn_u64 v[64:65], v22, v[116:117] offset:50000

    v_cvt_f32_i32_sdwa v122, sext(v23) dst_sel:DWORD dst_unused:UNUSED_PAD src0_sel:WORD_0
    v_lshlrev_b32 v120, 16, v66
    v_and_b32 v121, s32, v66
    v_mul_f32 v122, s33, v122
    v_lshlrev_b32 v66, 16, v67
    v_and_b32 v67, s32, v67
    v_lshlrev_b32_sdwa v23, 3, v23 dst_sel:DWORD dst_unused:UNUSED_PAD src0_sel:DWORD src1_sel:WORD_1
    v_pk_fma_f32 v[120:121], v[120:121], v[122:123], s[28:29] op_sel_hi:[1,0,1]
    v_pk_fma_f32 v[66:67], v[66:67], v[122:123], s[28:29] op_sel_hi:[1,0,1]
    v_perm_b32 v120, v121, v120, s35
    v_perm_b32 v121, v67, v66, s35
    v_lshl_add_u64 v[120:121], v[120:121], 0, s[30:31]
    ds_add_rtn_u64 v[66:67], v23, v[120:121] offset:50000

    s_waitcnt lgkmcnt(4)
    v_or3_b32 v1, v52, v53, v1
    v_or3_b32 v1, v54, v55, v1
    v_or3_b32 v1, v56, v57, v1
    v_or3_b32 v1, v58, v59, v1
    v_cvt_f32_i32_sdwa v118, sext(v24) dst_sel:DWORD dst_unused:UNUSED_PAD src0_sel:WORD_0
    v_lshlrev_b32 v116, 16, v68
    v_and_b32 v117, s32, v68
    v_mul_f32 v118, s33, v118
    v_lshlrev_b32 v68, 16, v69
    v_and_b32 v69, s32, v69
    v_lshlrev_b32_sdwa v24, 3, v24 dst_sel:DWORD dst_unused:UNUSED_PAD src0_sel:DWORD src1_sel:WORD_1
    v_pk_fma_f32 v[116:117], v[116:117], v[118:119], s[28:29] op_sel_hi:[1,0,1]
    v_pk_fma_f32 v[68:69], v[68:69], v[118:119], s[28:29] op_sel_hi:[1,0,1]
    v_perm_b32 v116, v117, v116, s35
    v_perm_b32 v117, v69, v68, s35
    v_lshl_add_u64 v[116:117], v[116:117], 0, s[30:31]
    ds_add_rtn_u64 v[68:69], v24, v[116:117] offset:50000

    v_cvt_f32_i32_sdwa v122, sext(v25) dst_sel:DWORD dst_unused:UNUSED_PAD src0_sel:WORD_0
    v_lshlrev_b32 v120, 16, v70
    v_and_b32 v121, s32, v70
    v_mul_f32 v122, s33, v122
    v_lshlrev_b32 v70, 16, v71
    v_and_b32 v71, s32, v71
    v_lshlrev_b32_sdwa v25, 3, v25 dst_sel:DWORD dst_unused:UNUSED_PAD src0_sel:DWORD src1_sel:WORD_1
    v_pk_fma_f32 v[120:121], v[120:121], v[122:123], s[28:29] op_sel_hi:[1,0,1]
    v_pk_fma_f32 v[70:71], v[70:71], v[122:123], s[28:29] op_sel_hi:[1,0,1]
    v_perm_b32 v120, v121, v120, s35
    v_perm_b32 v121, v71, v70, s35
    v_lshl_add_u64 v[120:121], v[120:121], 0, s[30:31]
    ds_add_rtn_u64 v[70:71], v25, v[120:121] offset:50000

    v_cvt_f32_i32_sdwa v118, sext(v26) dst_sel:DWORD dst_unused:UNUSED_PAD src0_sel:WORD_0
    v_lshlrev_b32 v116, 16, v72
    v_and_b32 v117, s32, v72
    v_mul_f32 v118, s33, v118
    v_lshlrev_b32 v72, 16, v73
    v_and_b32 v73, s32, v73
    v_lshlrev_b32_sdwa v26, 3, v26 dst_sel:DWORD dst_unused:UNUSED_PAD src0_sel:DWORD src1_sel:WORD_1
    v_pk_fma_f32 v[116:117], v[116:117], v[118:119], s[28:29] op_sel_hi:[1,0,1]
    v_pk_fma_f32 v[72:73], v[72:73], v[118:119], s[28:29] op_sel_hi:[1,0,1]
    v_perm_b32 v116, v117, v116, s35
    v_perm_b32 v117, v73, v72, s35
    v_lshl_add_u64 v[116:117], v[116:117], 0, s[30:31]
    ds_add_rtn_u64 v[72:73], v26, v[116:117] offset:50000

    v_cvt_f32_i32_sdwa v122, sext(v27) dst_sel:DWORD dst_unused:UNUSED_PAD src0_sel:WORD_0
    v_lshlrev_b32 v120, 16, v74
    v_and_b32 v121, s32, v74
    v_mul_f32 v122, s33, v122
    v_lshlrev_b32 v74, 16, v75
    v_and_b32 v75, s32, v75
    v_lshlrev_b32_sdwa v27, 3, v27 dst_sel:DWORD dst_unused:UNUSED_PAD src0_sel:DWORD src1_sel:WORD_1
    v_pk_fma_f32 v[120:121], v[120:121], v[122:123], s[28:29] op_sel_hi:[1,0,1]
    v_pk_fma_f32 v[74:75], v[74:75], v[122:123], s[28:29] op_sel_hi:[1,0,1]
    v_perm_b32 v120, v121, v120, s35
    v_perm_b32 v121, v75, v74, s35
    v_lshl_add_u64 v[120:121], v[120:121], 0, s[30:31]
    ds_add_rtn_u64 v[74:75], v27, v[120:121] offset:50000

    s_waitcnt lgkmcnt(4)
    v_or3_b32 v1, v60, v61, v1
    v_or3_b32 v1, v62, v63, v1
    v_or3_b32 v1, v64, v65, v1
    v_or3_b32 v1, v66, v67, v1
    s_cmp_le_i32 s42, 3072
    s_cbranch_scc1 L_nt2_33
    s_waitcnt vmcnt(0)
    s_mov_b64 exec, s[64:65]
    v_cvt_f32_i32_sdwa v118, sext(v106) dst_sel:DWORD dst_unused:UNUSED_PAD src0_sel:WORD_0
    v_lshlrev_b32 v116, 16, v44
    v_and_b32 v117, s32, v44
    v_mul_f32 v118, s33, v118
    v_lshlrev_b32 v44, 16, v45
    v_and_b32 v45, s32, v45
    v_lshlrev_b32_sdwa v106, 3, v106 dst_sel:DWORD dst_unused:UNUSED_PAD src0_sel:DWORD src1_sel:WORD_1
    v_pk_fma_f32 v[116:117], v[116:117], v[118:119], s[28:29] op_sel_hi:[1,0,1]
    v_pk_fma_f32 v[44:45], v[44:45], v[118:119], s[28:29] op_sel_hi:[1,0,1]
    v_perm_b32 v116, v117, v116, s35
    v_perm_b32 v117, v45, v44, s35
    v_lshl_add_u64 v[116:117], v[116:117], 0, s[30:31]
    ds_add_rtn_u64 v[44:45], v106, v[116:117] offset:50000

    s_mov_b64 exec, s[66:67]
    v_cvt_f32_i32_sdwa v122, sext(v107) dst_sel:DWORD dst_unused:UNUSED_PAD src0_sel:WORD_0
    v_lshlrev_b32 v120, 16, v46
    v_and_b32 v121, s32, v46
    v_mul_f32 v122, s33, v122
    v_lshlrev_b32 v46, 16, v47
    v_and_b32 v47, s32, v47
    v_lshlrev_b32_sdwa v107, 3, v107 dst_sel:DWORD dst_unused:UNUSED_PAD src0_sel:DWORD src1_sel:WORD_1
    v_pk_fma_f32 v[120:121], v[120:121], v[122:123], s[28:29] op_sel_hi:[1,0,1]
    v_pk_fma_f32 v[46:47], v[46:47], v[122:123], s[28:29] op_sel_hi:[1,0,1]
    v_perm_b32 v120, v121, v120, s35
    v_perm_b32 v121, v47, v46, s35
    v_lshl_add_u64 v[120:121], v[120:121], 0, s[30:31]
    ds_add_rtn_u64 v[46:47], v107, v[120:121] offset:50000

    s_mov_b64 exec, s[68:69]
    v_cvt_f32_i32_sdwa v118, sext(v108) dst_sel:DWORD dst_unused:UNUSED_PAD src0_sel:WORD_0
    v_lshlrev_b32 v116, 16, v48
    v_and_b32 v117, s32, v48
    v_mul_f32 v118, s33, v118
    v_lshlrev_b32 v48, 16, v49
    v_and_b32 v49, s32, v49
    v_lshlrev_b32_sdwa v108, 3, v108 dst_sel:DWORD dst_unused:UNUSED_PAD src0_sel:DWORD src1_sel:WORD_1
    v_pk_fma_f32 v[116:117], v[116:117], v[118:119], s[28:29] op_sel_hi:[1,0,1]
    v_pk_fma_f32 v[48:49], v[48:49], v[118:119], s[28:29] op_sel_hi:[1,0,1]
    v_perm_b32 v116, v117, v116, s35
    v_perm_b32 v117, v49, v48, s35
    v_lshl_add_u64 v[116:117], v[116:117], 0, s[30:31]
    ds_add_rtn_u64 v[48:49], v108, v[116:117] offset:50000

    s_mov_b64 exec, s[70:71]
    v_cvt_f32_i32_sdwa v122, sext(v109) dst_sel:DWORD dst_unused:UNUSED_PAD src0_sel:WORD_0
    v_lshlrev_b32 v120, 16, v50
    v_and_b32 v121, s32, v50
    v_mul_f32 v122, s33, v122
    v_lshlrev_b32 v50, 16, v51
    v_and_b32 v51, s32, v51
    v_lshlrev_b32_sdwa v109, 3, v109 dst_sel:DWORD dst_unused:UNUSED_PAD src0_sel:DWORD src1_sel:WORD_1
    v_pk_fma_f32 v[120:121], v[120:121], v[122:123], s[28:29] op_sel_hi:[1,0,1]
    v_pk_fma_f32 v[50:51], v[50:51], v[122:123], s[28:29] op_sel_hi:[1,0,1]
    v_perm_b32 v120, v121, v120, s35
    v_perm_b32 v121, v51, v50, s35
    v_lshl_add_u64 v[120:121], v[120:121], 0, s[30:31]
    ds_add_rtn_u64 v[50:51], v109, v[120:121] offset:50000

    s_mov_b64 exec, -1
    s_waitcnt lgkmcnt(0)
    v_or3_b32 v1, v44, v45, v1
    v_or3_b32 v1, v46, v47, v1
    v_or3_b32 v1, v48, v49, v1
    v_or3_b32 v1, v50, v51, v1
L_nt2_33:
    s_movk_i32 s53, 15360
    buffer_load_dwordx4 v[106:109], v2, s[16:19], s53 offen
    buffer_load_dword v114, v2, s[16:19], s53 offen offset:16
    s_waitcnt lgkmcnt(0)
    v_or3_b32 v1, v68, v69, v1
    v_or3_b32 v1, v70, v71, v1
    v_or3_b32 v1, v72, v73, v1
    v_or3_b32 v1, v74, v75, v1
    s_cmp_le_u32 s40, 3584
    s_cbranch_scc1 L_noleft_36
    s_min_u32 s40, s40, 3968
    s_lshl_b32 s52, s38, 6
    s_add_u32 s52, s52, s36
    s_mul_i32 s52, s52, 19840
    s_add_u32 s20, s44, s52
    s_addc_u32 s21, s45, 0
    s_mul_i32 s52, s40, 5
    s_add_u32 s52, s52, 3
    s_and_b32 s22, s52, -4

    s_lshr_b32 s55, s39, 2
    s_add_u32 s55, s55, 3584
    v_and_b32 v60, 63, v0
    v_add_u32 v60, s55, v60
L_left_37:
    s_cmp_ge_u32 s55, s40
    s_cbranch_scc1 L_leftend_38
    v_mul_u32_u24 v61, 5, v60
    buffer_load_dword v62, v61, s[20:23], 0 offen
    buffer_load_ubyte v63, v61, s[20:23], 0 offen offset:4
    s_waitcnt vmcnt(0)

    v_perm_b32 v61, v63, v62, s24
    v_lshrrev_b32 v66, 30, v62
    v_and_b32 v61, 0x1fff, v61
    v_mul_u32_u24 v66, 6250, v66
    v_add_lshl_u32 v61, v61, v66, 3

    buffer_load_dwordx2 v[64:65], v61, s[8:11], s50 offen
    v_cmp_gt_u32 vcc, s40, v60
    s_waitcnt vmcnt(0)

    s_mov_b64 exec, vcc
    v_and_b32 v62, 0x3fffffff, v62
    v_cvt_f32_i32_sdwa v118, sext(v62) dst_sel:DWORD dst_unused:UNUSED_PAD src0_sel:WORD_0
    v_lshlrev_b32 v116, 16, v64
    v_and_b32 v117, s32, v64
    v_mul_f32 v118, s33, v118
    v_lshlrev_b32 v64, 16, v65
    v_and_b32 v65, s32, v65
    v_lshlrev_b32_sdwa v62, 3, v62 dst_sel:DWORD dst_unused:UNUSED_PAD src0_sel:DWORD src1_sel:WORD_1
    v_pk_fma_f32 v[116:117], v[116:117], v[118:119], s[28:29] op_sel_hi:[1,0,1]
    v_pk_fma_f32 v[64:65], v[64:65], v[118:119], s[28:29] op_sel_hi:[1,0,1]
    v_perm_b32 v116, v117, v116, s35
    v_perm_b32 v117, v65, v64, s35
    v_lshl_add_u64 v[116:117], v[116:117], 0, s[30:31]
    ds_add_rtn_u64 v[64:65], v62, v[116:117] offset:50000

    s_waitcnt lgkmcnt(0)
    v_or3_b32 v1, v64, v65, v1
    s_mov_b64 exec, -1
    v_add_u32 v60, 128, v60
    s_add_u32 s55, s55, 128
    s_branch L_left_37
L_leftend_38:

L_noleft_36:
    s_mov_b32 s38, s5
    s_cmp_lt_u32 s38, s4
    s_cbranch_scc1 L_batch_19
    s_waitcnt vmcnt(0)
    s_barrier

    s_mul_i32 s3, s37, 6400000
    s_mul_i32 s5, s36, 100000
    s_add_u32 s3, s3, s5
    s_add_u32 s3, s3, 1048576

    s_add_u32 s20, s6, s3
    s_addc_u32 s21, s7, 0
    s_mov_b32 s22, 100000
    s_mov_b32 s23, 0x20000
    v_lshlrev_b32 v68, 3, v0
    v_add_u32 v69, 50000, v68
    v_add_u32 v70, 115536, v68
    v_cmp_gt_u32 vcc, 212, v0
    v_mov_b32 v52, 0
    v_mov_b32 v53, 0

    ds_read_b64 v[28:29], v69 offset:0
    ds_read_b64 v[30:31], v69 offset:8192
    ds_read_b64 v[32:33], v69 offset:16384
    ds_read_b64 v[34:35], v69 offset:24576
    ds_read_b64 v[36:37], v69 offset:32768
    ds_read_b64 v[38:39], v69 offset:40960
    ds_read_b64 v[40:41], v69 offset:49152
    ds_read_b64 v[42:43], v69 offset:57344
    ds_read_b64 v[44:45], v70 offset:0
    ds_read_b64 v[46:47], v70 offset:8192
    ds_read_b64 v[48:49], v70 offset:16384
    ds_read_b64 v[50:51], v70 offset:24576
    s_mov_b64 exec, vcc
    ds_read_b64 v[52:53], v70 offset:32768
    s_mov_b64 exec, -1
    s_waitcnt lgkmcnt(12)
    s_mov_b32 s3, 0
    buffer_store_dwordx2 v[28:29], v68, s[20:23], s3 offen
    s_waitcnt lgkmcnt(11)
    s_mov_b32 s3, 8192
    buffer_store_dwordx2 v[30:31], v68, s[20:23], s3 offen
    s_waitcnt lgkmcnt(10)
    s_mov_b32 s3, 16384
    buffer_store_dwordx2 v[32:33], v68, s[20:23], s3 offen
    s_waitcnt lgkmcnt(9)
    s_mov_b32 s3, 24576
    buffer_store_dwordx2 v[34:35], v68, s[20:23], s3 offen
    s_waitcnt lgkmcnt(8)
    s_mov_b32 s3, 32768
    buffer_store_dwordx2 v[36:37], v68, s[20:23], s3 offen
    s_waitcnt lgkmcnt(7)
    s_mov_b32 s3, 40960
    buffer_store_dwordx2 v[38:39], v68, s[20:23], s3 offen
    s_waitcnt lgkmcnt(6)
    s_mov_b32 s3, 49152
    buffer_store_dwordx2 v[40:41], v68, s[20:23], s3 offen
    s_waitcnt lgkmcnt(5)
    s_mov_b32 s3, 57344
    buffer_store_dwordx2 v[42:43], v68, s[20:23], s3 offen
    s_waitcnt lgkmcnt(4)
    s_mov_b32 s3, 65536
    buffer_store_dwordx2 v[44:45], v68, s[20:23], s3 offen
    s_waitcnt lgkmcnt(3)
    s_mov_b32 s3, 73728
    buffer_store_dwordx2 v[46:47], v68, s[20:23], s3 offen
    s_waitcnt lgkmcnt(2)
    s_mov_b32 s3, 81920
    buffer_store_dwordx2 v[48:49], v68, s[20:23], s3 offen
    s_waitcnt lgkmcnt(1)
    s_mov_b32 s3, 90112
    buffer_store_dwordx2 v[50:51], v68, s[20:23], s3 offen
    s_waitcnt lgkmcnt(0)
    s_mov_b32 s3, 98304
    buffer_store_dwordx2 v[52:53], v68, s[20:23], s3 offen
    v_or3_b32 v1, v28, v29, v1
    v_or3_b32 v1, v30, v31, v1
    v_or3_b32 v1, v32, v33, v1
    v_or3_b32 v1, v34, v35, v1
    v_or3_b32 v1, v36, v37, v1
    v_or3_b32 v1, v38, v39, v1
    v_or3_b32 v1, v40, v41, v1
    v_or3_b32 v1, v42, v43, v1
    v_or3_b32 v1, v44, v45, v1
    v_or3_b32 v1, v46, v47, v1
    v_or3_b32 v1, v48, v49, v1
    v_or3_b32 v1, v50, v51, v1
    v_or3_b32 v1, v52, v53, v1
    v_and_b32 v1, 0x80008000, v1
    v_cmp_ne_u32 vcc, 0, v1
    v_mov_b32 v71, 150024
    v_mov_b32 v72, 1
    s_cbranch_vccz L_nf_39
    ds_write_b32 v71, v72
L_nf_39:
    s_waitcnt lgkmcnt(0)
    s_barrier
    ds_read_b32 v72, v71
    s_waitcnt lgkmcnt(0)
    v_readfirstlane_b32 s3, v72
    s_nop 1
    s_cmp_lg_u32 s3, 0
    s_cbranch_scc1 L_p2slow_18

L_fin_40:
    s_add_u32 s20, s6, 147456
    s_addc_u32 s21, s7, 0
    s_mov_b32 s22, 1024
    s_mov_b32 s23, 0x20000
    s_lshl_b32 s3, s36, 2
    s_add_u32 s3, s3, s37
    s_lshl_b32 s3, s3, 2
    v_lshlrev_b32 v73, 20, v0
    v_mov_b32 v74, s34
    buffer_store_dword v74, v73, s[20:23], s3 offen

L_p2done_17:
    s_endpgm

L_ufix_20:
    v_and_b32 v117, 63, v0
    v_lshlrev_b32 v117, 2, v117
    s_sub_i32 s54, s42, 1024
    v_cmp_le_i32 vcc, s54, v117
    s_mov_b64 exec, vcc
    v_mov_b32 v12, 0
    v_mov_b32 v44, 0
    s_mov_b64 exec, -1
    s_sub_i32 s54, s42, 1025
    v_cmp_le_i32 vcc, s54, v117
    s_mov_b64 exec, vcc
    v_mov_b32 v13, 0
    v_mov_b32 v46, 0
    s_mov_b64 exec, -1
    s_sub_i32 s54, s42, 1026
    v_cmp_le_i32 vcc, s54, v117
    s_mov_b64 exec, vcc
    v_mov_b32 v14, 0
    v_mov_b32 v48, 0
    s_mov_b64 exec, -1
    s_sub_i32 s54, s42, 1027
    v_cmp_le_i32 vcc, s54, v117
    s_mov_b64 exec, vcc
    v_mov_b32 v15, 0
    v_mov_b32 v50, 0
    s_mov_b64 exec, -1
    s_branch L_uback_21
L_ufix_22:
    v_and_b32 v117, 63, v0
    v_lshlrev_b32 v117, 2, v117
    s_sub_i32 s54, s42, 1536
    v_cmp_le_i32 vcc, s54, v117
    s_mov_b64 exec, vcc
    v_mov_b32 v16, 0
    v_mov_b32 v52, 0
    s_mov_b64 exec, -1
    s_sub_i32 s54, s42, 1537
    v_cmp_le_i32 vcc, s54, v117
    s_mov_b64 exec, vcc
    v_mov_b32 v17, 0
    v_mov_b32 v54, 0
    s_mov_b64 exec, -1
    s_sub_i32 s54, s42, 1538
    v_cmp_le_i32 vcc, s54, v117
    s_mov_b64 exec, vcc
    v_mov_b32 v18, 0
    v_mov_b32 v56, 0
    s_mov_b64 exec, -1
    s_sub_i32 s54, s42, 1539
    v_cmp_le_i32 vcc, s54, v117
    s_mov_b64 exec, vcc
    v_mov_b32 v19, 0
    v_mov_b32 v58, 0
    s_mov_b64 exec, -1
    s_branch L_uback_23
L_ufix_24:
    v_and_b32 v117, 63, v0
    v_lshlrev_b32 v117, 2, v117
    s_sub_i32 s54, s42, 2048
    v_cmp_le_i32 vcc, s54, v117
    s_mov_b64 exec, vcc
    v_mov_b32 v20, 0
    v_mov_b32 v60, 0
    s_mov_b64 exec, -1
    s_sub_i32 s54, s42, 2049
    v_cmp_le_i32 vcc, s54, v117
    s_mov_b64 exec, vcc
    v_mov_b32 v21, 0
    v_mov_b32 v62, 0
    s_mov_b64 exec, -1
    s_sub_i32 s54, s42, 2050
    v_cmp_le_i32 vcc, s54, v117
    s_mov_b64 exec, vcc
    v_mov_b32 v22, 0
    v_mov_b32 v64, 0
    s_mov_b64 exec, -1
    s_sub_i32 s54, s42, 2051
    v_cmp_le_i32 vcc, s54, v117
    s_mov_b64 exec, vcc
    v_mov_b32 v23, 0
    v_mov_b32 v66, 0
    s_mov_b64 exec, -1
    s_branch L_uback_25
L_ufix_26:
    v_and_b32 v117, 63, v0
    v_lshlrev_b32 v117, 2, v117
    s_sub_i32 s54, s42, 2560
    v_cmp_le_i32 vcc, s54, v117
    s_mov_b64 exec, vcc
    v_mov_b32 v24, 0
    v_mov_b32 v68, 0
    s_mov_b64 exec, -1
    s_sub_i32 s54, s42, 2561
    v_cmp_le_i32 vcc, s54, v117
    s_mov_b64 exec, vcc
    v_mov_b32 v25, 0
    v_mov_b32 v70, 0
    s_mov_b64 exec, -1
    s_sub_i32 s54, s42, 2562
    v_cmp_le_i32 vcc, s54, v117
    s_mov_b64 exec, vcc
    v_mov_b32 v26, 0
    v_mov_b32 v72, 0
    s_mov_b64 exec, -1
    s_sub_i32 s54, s42, 2563
    v_cmp_le_i32 vcc, s54, v117
    s_mov_b64 exec, vcc
    v_mov_b32 v27, 0
    v_mov_b32 v74, 0
    s_mov_b64 exec, -1
    s_branch L_uback_27
L_ufix_28:
    v_and_b32 v117, 63, v0
    v_lshlrev_b32 v117, 2, v117
    s_sub_i32 s54, s42, 0
    v_cmp_le_i32 vcc, s54, v117
    s_mov_b64 exec, vcc
    v_mov_b32 v4, 0
    v_mov_b32 v28, 0
    s_mov_b64 exec, -1
    s_sub_i32 s54, s42, 1
    v_cmp_le_i32 vcc, s54, v117
    s_mov_b64 exec, vcc
    v_mov_b32 v5, 0
    v_mov_b32 v30, 0
    s_mov_b64 exec, -1
    s_sub_i32 s54, s42, 2
    v_cmp_le_i32 vcc, s54, v117
    s_mov_b64 exec, vcc
    v_mov_b32 v6, 0
    v_mov_b32 v32, 0
    s_mov_b64 exec, -1
    s_sub_i32 s54, s42, 3
    v_cmp_le_i32 vcc, s54, v117
    s_mov_b64 exec, vcc
    v_mov_b32 v7, 0
    v_mov_b32 v34, 0
    s_mov_b64 exec, -1
    s_branch L_uback_29
L_ufix_30:
    v_and_b32 v117, 63, v0
    v_lshlrev_b32 v117, 2, v117
    s_sub_i32 s54, s42, 512
    v_cmp_le_i32 vcc, s54, v117
    s_mov_b64 exec, vcc
    v_mov_b32 v8, 0
    v_mov_b32 v36, 0
    s_mov_b64 exec, -1
    s_sub_i32 s54, s42, 513
    v_cmp_le_i32 vcc, s54, v117
    s_mov_b64 exec, vcc
    v_mov_b32 v9, 0
    v_mov_b32 v38, 0
    s_mov_b64 exec, -1
    s_sub_i32 s54, s42, 514
    v_cmp_le_i32 vcc, s54, v117
    s_mov_b64 exec, vcc
    v_mov_b32 v10, 0
    v_mov_b32 v40, 0
    s_mov_b64 exec, -1
    s_sub_i32 s54, s42, 515
    v_cmp_le_i32 vcc, s54, v117
    s_mov_b64 exec, vcc
    v_mov_b32 v11, 0
    v_mov_b32 v42, 0
    s_mov_b64 exec, -1
    s_branch L_uback_31
L_ufix_34:
    v_and_b32 v117, 63, v0
    v_lshlrev_b32 v117, 2, v117
    s_sub_i32 s54, s42, 3072
    v_cmp_le_i32 vcc, s54, v117
    s_mov_b64 exec, vcc
    v_mov_b32 v106, 0
    v_mov_b32 v116, 0
    s_mov_b64 exec, -1
    s_sub_i32 s54, s42, 3073
    v_cmp_le_i32 vcc, s54, v117
    s_mov_b64 exec, vcc
    v_mov_b32 v107, 0
    v_mov_b32 v118, 0
    s_mov_b64 exec, -1
    s_sub_i32 s54, s42, 3074
    v_cmp_le_i32 vcc, s54, v117
    s_mov_b64 exec, vcc
    v_mov_b32 v108, 0
    v_mov_b32 v120, 0
    s_mov_b64 exec, -1
    s_sub_i32 s54, s42, 3075
    v_cmp_le_i32 vcc, s54, v117
    s_mov_b64 exec, vcc
    v_mov_b32 v109, 0
    v_mov_b32 v122, 0
    s_mov_b64 exec, -1
    s_branch L_uback_35
L_p2slow_18:
    s_waitcnt vmcnt(0) lgkmcnt(0)
    s_mov_b32 s51, 0
    s_movk_i32 s43, 6250
    s_mov_b32 s34, 0
L_sweep_41:
    s_barrier

    v_mov_b32 v28, 0x0
    v_mov_b32 v29, 0x0
    v_mov_b32 v30, 0x0
    v_mov_b32 v31, 0x0
    v_add_u32 v32, 50000, v3
    v_add_u32 v33, 65536, v32

    ds_write_b128 v32, v[28:31] offset:0
    ds_write_b128 v32, v[28:31] offset:16384
    ds_write_b128 v32, v[28:31] offset:32768
    ds_write_b128 v32, v[28:31] offset:49152
    ds_write_b128 v33, v[28:31] offset:0
    ds_write_b128 v33, v[28:31] offset:16384
    v_cmp_gt_u32 vcc, 971, v0
    s_mov_b64 exec, vcc
    ds_write_b128 v33, v[28:31] offset:32768
    s_mov_b64 exec, -1
    s_waitcnt lgkmcnt(0)
    s_barrier
    s_sub_u32 s38, s4, 8
L_sbatch_42:
    s_lshl_b32 s52, s38, 6
    s_add_u32 s52, s52, s36
    s_lshl_b32 s52, s52, 2
    s_load_dword s40, s[46:47], s52
    s_mul_i32 s50, s38, 200000
    s_waitcnt lgkmcnt(0)

    s_min_u32 s40, s40, 3968
    s_lshl_b32 s52, s38, 6
    s_add_u32 s52, s52, s36
    s_mul_i32 s52, s52, 19840
    s_add_u32 s20, s44, s52
    s_addc_u32 s21, s45, 0
    s_mul_i32 s52, s40, 5
    s_add_u32 s52, s52, 3
    s_and_b32 s22, s52, -4

    s_lshr_b32 s55, s39, 2
    s_add_u32 s55, s55, 0
    v_and_b32 v36, 63, v0
    v_add_u32 v36, s55, v36
L_left_46:
    s_cmp_ge_u32 s55, s40
    s_cbranch_scc1 L_leftend_47
    v_mul_u32_u24 v37, 5, v36
    buffer_load_dword v38, v37, s[20:23], 0 offen
    buffer_load_ubyte v39, v37, s[20:23], 0 offen offset:4
    s_waitcnt vmcnt(0)

    v_perm_b32 v37, v39, v38, s24
    v_lshrrev_b32 v42, 30, v38
    v_and_b32 v37, 0x1fff, v37
    v_mul_u32_u24 v42, 6250, v42
    v_add_lshl_u32 v37, v37, v42, 3

    buffer_load_dwordx2 v[40:41], v37, s[8:11], s50 offen
    v_cmp_gt_u32 vcc, s40, v36
    s_waitcnt vmcnt(0)

    v_bfe_u32 v44, v38, 16, 14
    v_subrev_u32 v44, s51, v44
    v_cmp_gt_u32 s[64:65], s43, v44
    s_and_b64 exec, vcc, s[64:65]
    v_lshlrev_b32 v45, 8, v38
    v_cmpx_ne_u32 vcc, 0, v45
    v_lshlrev_b32 v44, 4, v44
    v_bfe_i32 v38, v38, 0, 16
    v_cvt_f32_i32 v38, v38
    v_mul_f32 v38, 0x38004020, v38
    v_lshlrev_b32 v45, 16, v40
    v_and_b32 v46, s32, v40
    v_lshlrev_b32 v47, 16, v41
    v_and_b32 v48, s32, v41

    v_mul_f32 v45, v45, v38
    ds_add_f32 v44, v45 offset:50000
    v_mul_f32 v46, v46, v38
    ds_add_f32 v44, v46 offset:50004
    v_mul_f32 v47, v47, v38
    ds_add_f32 v44, v47 offset:50008
    v_mul_f32 v48, v48, v38
    ds_add_f32 v44, v48 offset:50012
    s_mov_b64 exec, -1
    v_add_u32 v36, 128, v36
    s_add_u32 s55, s55, 128
    s_branch L_left_46
L_leftend_47:

    s_add_u32 s38, s38, 1
    s_cmp_lt_u32 s38, s4
    s_cbranch_scc1 L_sbatch_42
    s_mov_b32 s3, 131072
    s_load_dword s40, s[6:7], s3

    s_add_u32 s20, s6, 402907136
    s_addc_u32 s21, s7, 0
    s_mov_b32 s22, 409600000
    s_mov_b32 s23, 0x20000
    s_mov_b32 s38, 0
    s_mov_b32 s50, 200000
    v_mov_b32 v36, v0
    s_waitcnt lgkmcnt(0)
L_ovf_43:
    s_cmp_ge_u32 s38, s40
    s_cbranch_scc1 L_ovfend_44
    v_lshlrev_b32 v37, 3, v36
    buffer_load_dwordx2 v[38:39], v37, s[20:23], 0 offen
    s_waitcnt vmcnt(0)

    v_perm_b32 v37, v39, v38, s24
    v_lshrrev_b32 v42, 30, v38
    v_and_b32 v37, 0x1fff, v37
    v_mul_u32_u24 v42, 6250, v42
    v_add_lshl_u32 v37, v37, v42, 3

    v_bfe_u32 v42, v39, 24, 5
    v_mad_u32_u24 v37, v42, s50, v37
    buffer_load_dwordx2 v[40:41], v37, s[8:11], 0 offen
    v_lshrrev_b32 v42, 3, v42
    v_bfe_u32 v43, v39, 18, 6
    v_cmp_gt_u32 vcc, s40, v36
    v_cmp_eq_u32 s[64:65], s36, v43
    s_and_b64 vcc, vcc, s[64:65]
    v_cmp_eq_u32 s[64:65], s37, v42
    s_and_b64 vcc, vcc, s[64:65]
    s_waitcnt vmcnt(0)

    v_bfe_u32 v44, v38, 16, 14
    v_subrev_u32 v44, s51, v44
    v_cmp_gt_u32 s[64:65], s43, v44
    s_and_b64 exec, vcc, s[64:65]
    v_lshlrev_b32 v45, 8, v38
    v_cmpx_ne_u32 vcc, 0, v45
    v_lshlrev_b32 v44, 4, v44
    v_bfe_i32 v38, v38, 0, 16
    v_cvt_f32_i32 v38, v38
    v_mul_f32 v38, 0x38004020, v38
    v_lshlrev_b32 v45, 16, v40
    v_and_b32 v46, s32, v40
    v_lshlrev_b32 v47, 16, v41
    v_and_b32 v48, s32, v41

    v_mul_f32 v45, v45, v38
    ds_add_f32 v44, v45 offset:50000
    v_mul_f32 v46, v46, v38
    ds_add_f32 v44, v46 offset:50004
    v_mul_f32 v47, v47, v38
    ds_add_f32 v44, v47 offset:50008
    v_mul_f32 v48, v48, v38
    ds_add_f32 v44, v48 offset:50012
    s_mov_b64 exec, -1
    v_add_u32 v36, 1024, v36
    s_add_u32 s38, s38, 1024
    s_branch L_ovf_43
L_ovfend_44:
    s_waitcnt lgkmcnt(0)
    s_barrier
    s_mul_i32 s3, s37, 800000
    s_mul_i32 s5, s36, 12500
    s_add_u32 s3, s3, s5
    s_add_u32 s3, s3, s51
    s_lshl_b32 s3, s3, 4
    s_add_u32 s3, s3, 26648576

    s_add_u32 s20, s6, s3
    s_addc_u32 s21, s7, 0
    s_mov_b32 s22, 100000
    s_mov_b32 s23, 0x20000
    v_mov_b32 v36, v3
    s_mov_b32 s38, 0
L_wl_45:
    v_min_u32 v37, 100000, v36
    ds_read_b128 v[28:31], v37 offset:50000
    s_waitcnt lgkmcnt(0)
    buffer_store_dwordx4 v[28:31], v36, s[20:23], 0 offen
    s_waitcnt vmcnt(0)
    v_add_u32 v36, 16384, v36
    s_add_u32 s38, s38, 1024
    s_cmp_lt_u32 s38, 6250
    s_cbranch_scc1 L_wl_45
    s_add_u32 s51, s51, 6250
    s_cmp_lt_u32 s51, 12500
    s_cbranch_scc1 L_sweep_41
    s_branch L_fin_40

.globl standalone__molecular_angular_gemnet__graph_kernel
.p2align 8
.type standalone__molecular_angular_gemnet__graph_kernel,@function
standalone__molecular_angular_gemnet__graph_kernel:
    s_cmp_ge_u32 s2, 3200
    s_cbranch_scc1 L_fdone_48
    s_load_dwordx2 s[4:5], s[0:1], 0
    s_load_dwordx2 s[6:7], s[0:1], 24
    s_load_dwordx2 s[8:9], s[0:1], 40
    s_load_dwordx8 s[12:19], s[0:1], 56
    s_load_dwordx2 s[10:11], s[0:1], 88
    s_load_dwordx2 s[20:21], s[0:1], 104
    v_cmp_gt_u32 vcc, 250, v0
    s_mul_i32 s3, s2, 250
    v_add_u32 v0, s3, v0
    v_lshlrev_b32 v1, 4, v0
    v_lshlrev_b32 v2, 3, v0
    v_lshlrev_b32 v3, 1, v0
    s_mov_b64 exec, vcc
    s_mul_hi_u32 s3, s2, 85899346
    s_lshl_b32 s3, s3, 4
    s_add_u32 s3, s3, 147456
    s_waitcnt lgkmcnt(0)
    s_load_dwordx4 s[96:99], s[20:21], s3
    s_load_dwordx4 s[40:43], s[8:9], 0
    s_load_dwordx16 s[44:59], s[12:13], 0
    s_load_dwordx16 s[60:75], s[14:15], 0
    s_load_dwordx8 s[76:83], s[16:17], 0
    s_load_dwordx8 s[84:91], s[18:19], 0

    s_add_u32 s24, s20, 1048576
    s_addc_u32 s25, s21, 0
    s_mov_b32 s26, 76800000
    s_mov_b32 s27, 0x20000
    s_mov_b32 s28, s4
    s_mov_b32 s29, s5
    s_mov_b32 s30, 6400000
    s_mov_b32 s31, 0x20000
    s_mov_b32 s32, s6
    s_mov_b32 s33, s7
    s_mov_b32 s34, 1600000
    s_mov_b32 s35, 0x20000
    s_mov_b32 s36, s10
    s_mov_b32 s37, s11
    s_mov_b32 s38, 6400000
    s_mov_b32 s39, 0x20000
    buffer_load_ushort v4, v3, s[32:35], 0 offen
    buffer_load_dwordx2 v[32:33], v2, s[24:27], 0 offen
    s_mov_b32 s3, 6400000
    buffer_load_dwordx2 v[34:35], v2, s[24:27], s3 offen
    s_mov_b32 s3, 12800000
    buffer_load_dwordx2 v[36:37], v2, s[24:27], s3 offen
    s_mov_b32 s3, 19200000
    buffer_load_dwordx2 v[38:39], v2, s[24:27], s3 offen
    buffer_load_dwordx2 v[6:7], v2, s[28:31], 0 offen
    s_mov_b32 s94, 0xffff0000
    s_mov_b32 s95, 0xc1200000
    s_mov_b32 s22, 0x3fb8aa3b
    s_waitcnt vmcnt(5) lgkmcnt(0)
    v_lshlrev_b32 v4, 16, v4

    s_lshl_b32 s92, s40, 16
    v_subrev_f32 v16, s92, v4
    s_and_b32 s93, s40, s94
    v_subrev_f32 v17, s93, v4
    s_lshl_b32 s92, s41, 16
    v_subrev_f32 v18, s92, v4
    s_and_b32 s93, s41, s94
    v_subrev_f32 v19, s93, v4
    s_lshl_b32 s92, s42, 16
    v_subrev_f32 v20, s92, v4
    s_and_b32 s93, s42, s94
    v_subrev_f32 v21, s93, v4
    s_lshl_b32 s92, s43, 16
    v_subrev_f32 v22, s92, v4
    s_and_b32 s93, s43, s94
    v_subrev_f32 v23, s93, v4
    v_cvt_pk_bf16_f32 v16, v16, v17
    v_and_b32 v17, s94, v16
    v_lshlrev_b32 v16, 16, v16
    v_cvt_pk_bf16_f32 v18, v18, v19
    v_and_b32 v19, s94, v18
    v_lshlrev_b32 v18, 16, v18
    v_cvt_pk_bf16_f32 v20, v20, v21
    v_and_b32 v21, s94, v20
    v_lshlrev_b32 v20, 16, v20
    v_cvt_pk_bf16_f32 v22, v22, v23
    v_and_b32 v23, s94, v22
    v_lshlrev_b32 v22, 16, v22
    v_mul_f32 v16, v16, v16
    v_mul_f32 v17, v17, v17
    v_mul_f32 v18, v18, v18
    v_mul_f32 v19, v19, v19
    v_mul_f32 v20, v20, v20
    v_mul_f32 v21, v21, v21
    v_mul_f32 v22, v22, v22
    v_mul_f32 v23, v23, v23
    v_cvt_pk_bf16_f32 v16, v16, v17
    v_and_b32 v17, s94, v16
    v_lshlrev_b32 v16, 16, v16
    v_cvt_pk_bf16_f32 v18, v18, v19
    v_and_b32 v19, s94, v18
    v_lshlrev_b32 v18, 16, v18
    v_cvt_pk_bf16_f32 v20, v20, v21
    v_and_b32 v21, s94, v20
    v_lshlrev_b32 v20, 16, v20
    v_cvt_pk_bf16_f32 v22, v22, v23
    v_and_b32 v23, s94, v22
    v_lshlrev_b32 v22, 16, v22
    v_mul_f32 v16, s95, v16
    v_mul_f32 v17, s95, v17
    v_mul_f32 v18, s95, v18
    v_mul_f32 v19, s95, v19
    v_mul_f32 v20, s95, v20
    v_mul_f32 v21, s95, v21
    v_mul_f32 v22, s95, v22
    v_mul_f32 v23, s95, v23
    v_cvt_pk_bf16_f32 v16, v16, v17
    v_and_b32 v17, s94, v16
    v_lshlrev_b32 v16, 16, v16
    v_cvt_pk_bf16_f32 v18, v18, v19
    v_and_b32 v19, s94, v18
    v_lshlrev_b32 v18, 16, v18
    v_cvt_pk_bf16_f32 v20, v20, v21
    v_and_b32 v21, s94, v20
    v_lshlrev_b32 v20, 16, v20
    v_cvt_pk_bf16_f32 v22, v22, v23
    v_and_b32 v23, s94, v22
    v_lshlrev_b32 v22, 16, v22
    v_mul_f32 v16, s22, v16
    v_mul_f32 v17, s22, v17
    v_mul_f32 v18, s22, v18
    v_mul_f32 v19, s22, v19
    v_mul_f32 v20, s22, v20
    v_mul_f32 v21, s22, v21
    v_mul_f32 v22, s22, v22
    v_mul_f32 v23, s22, v23
    v_exp_f32 v16, v16
    v_exp_f32 v17, v17
    v_exp_f32 v18, v18
    v_exp_f32 v19, v19
    v_exp_f32 v20, v20
    v_exp_f32 v21, v21
    v_exp_f32 v22, v22
    v_exp_f32 v23, v23
    s_nop 0
    v_cvt_pk_bf16_f32 v16, v16, v17
    v_and_b32 v17, s94, v16
    v_lshlrev_b32 v16, 16, v16
    v_cvt_pk_bf16_f32 v18, v18, v19
    v_and_b32 v19, s94, v18
    v_lshlrev_b32 v18, 16, v18
    v_cvt_pk_bf16_f32 v20, v20, v21
    v_and_b32 v21, s94, v20
    v_lshlrev_b32 v20, 16, v20
    v_cvt_pk_bf16_f32 v22, v22, v23
    v_and_b32 v23, s94, v22
    v_lshlrev_b32 v22, 16, v22
    s_lshl_b32 s92, s60, 16
    v_mul_f32 v24, s92, v16
    s_and_b32 s93, s60, s94
    v_mul_f32 v25, s93, v16
    s_lshl_b32 s92, s61, 16
    v_mul_f32 v26, s92, v16
    s_and_b32 s93, s61, s94
    v_mul_f32 v27, s93, v16
    s_lshl_b32 s92, s62, 16
    v_fmac_f32 v24, s92, v17
    s_and_b32 s93, s62, s94
    v_fmac_f32 v25, s93, v17
    s_lshl_b32 s92, s63, 16
    v_fmac_f32 v26, s92, v17
    s_and_b32 s93, s63, s94
    v_fmac_f32 v27, s93, v17
    s_lshl_b32 s92, s64, 16
    v_fmac_f32 v24, s92, v18
    s_and_b32 s93, s64, s94
    v_fmac_f32 v25, s93, v18
    s_lshl_b32 s92, s65, 16
    v_fmac_f32 v26, s92, v18
    s_and_b32 s93, s65, s94
    v_fmac_f32 v27, s93, v18
    s_lshl_b32 s92, s66, 16
    v_fmac_f32 v24, s92, v19
    s_and_b32 s93, s66, s94
    v_fmac_f32 v25, s93, v19
    s_lshl_b32 s92, s67, 16
    v_fmac_f32 v26, s92, v19
    s_and_b32 s93, s67, s94
    v_fmac_f32 v27, s93, v19
    s_lshl_b32 s92, s68, 16
    v_fmac_f32 v24, s92, v20
    s_and_b32 s93, s68, s94
    v_fmac_f32 v25, s93, v20
    s_lshl_b32 s92, s69, 16
    v_fmac_f32 v26, s92, v20
    s_and_b32 s93, s69, s94
    v_fmac_f32 v27, s93, v20
    s_lshl_b32 s92, s70, 16
    v_fmac_f32 v24, s92, v21
    s_and_b32 s93, s70, s94
    v_fmac_f32 v25, s93, v21
    s_lshl_b32 s92, s71, 16
    v_fmac_f32 v26, s92, v21
    s_and_b32 s93, s71, s94
    v_fmac_f32 v27, s93, v21
    s_lshl_b32 s92, s72, 16
    v_fmac_f32 v24, s92, v22
    s_and_b32 s93, s72, s94
    v_fmac_f32 v25, s93, v22
    s_lshl_b32 s92, s73, 16
    v_fmac_f32 v26, s92, v22
    s_and_b32 s93, s73, s94
    v_fmac_f32 v27, s93, v22
    s_lshl_b32 s92, s74, 16
    v_fmac_f32 v24, s92, v23
    s_and_b32 s93, s74, s94
    v_fmac_f32 v25, s93, v23
    s_lshl_b32 s92, s75, 16
    v_fmac_f32 v26, s92, v23
    s_and_b32 s93, s75, s94
    v_fmac_f32 v27, s93, v23
    s_lshl_b32 s92, s44, 16
    v_mul_f32 v28, s92, v16
    s_and_b32 s93, s44, s94
    v_mul_f32 v29, s93, v16
    s_lshl_b32 s92, s45, 16
    v_mul_f32 v30, s92, v16
    s_and_b32 s93, s45, s94
    v_mul_f32 v31, s93, v16
    s_lshl_b32 s92, s46, 16
    v_fmac_f32 v28, s92, v17
    s_and_b32 s93, s46, s94
    v_fmac_f32 v29, s93, v17
    s_lshl_b32 s92, s47, 16
    v_fmac_f32 v30, s92, v17
    s_and_b32 s93, s47, s94
    v_fmac_f32 v31, s93, v17
    s_lshl_b32 s92, s48, 16
    v_fmac_f32 v28, s92, v18
    s_and_b32 s93, s48, s94
    v_fmac_f32 v29, s93, v18
    s_lshl_b32 s92, s49, 16
    v_fmac_f32 v30, s92, v18
    s_and_b32 s93, s49, s94
    v_fmac_f32 v31, s93, v18
    s_lshl_b32 s92, s50, 16
    v_fmac_f32 v28, s92, v19
    s_and_b32 s93, s50, s94
    v_fmac_f32 v29, s93, v19
    s_lshl_b32 s92, s51, 16
    v_fmac_f32 v30, s92, v19
    s_and_b32 s93, s51, s94
    v_fmac_f32 v31, s93, v19
    s_lshl_b32 s92, s52, 16
    v_fmac_f32 v28, s92, v20
    s_and_b32 s93, s52, s94
    v_fmac_f32 v29, s93, v20
    s_lshl_b32 s92, s53, 16
    v_fmac_f32 v30, s92, v20
    s_and_b32 s93, s53, s94
    v_fmac_f32 v31, s93, v20
    s_lshl_b32 s92, s54, 16
    v_fmac_f32 v28, s92, v21
    s_and_b32 s93, s54, s94
    v_fmac_f32 v29, s93, v21
    s_lshl_b32 s92, s55, 16
    v_fmac_f32 v30, s92, v21
    s_and_b32 s93, s55, s94
    v_fmac_f32 v31, s93, v21
    s_lshl_b32 s92, s56, 16
    v_fmac_f32 v28, s92, v22
    s_and_b32 s93, s56, s94
    v_fmac_f32 v29, s93, v22
    s_lshl_b32 s92, s57, 16
    v_fmac_f32 v30, s92, v22
    s_and_b32 s93, s57, s94
    v_fmac_f32 v31, s93, v22
    s_lshl_b32 s92, s58, 16
    v_fmac_f32 v28, s92, v23
    s_and_b32 s93, s58, s94
    v_fmac_f32 v29, s93, v23
    s_lshl_b32 s92, s59, 16
    v_fmac_f32 v30, s92, v23
    s_and_b32 s93, s59, s94
    v_fmac_f32 v31, s93, v23
    v_cvt_pk_bf16_f32 v28, v28, v29
    v_and_b32 v29, s94, v28
    v_lshlrev_b32 v28, 16, v28
    v_cvt_pk_bf16_f32 v30, v30, v31
    v_and_b32 v31, s94, v30
    v_lshlrev_b32 v30, 16, v30
    s_waitcnt vmcnt(1)
    v_mov_b32 v8, 0
    v_mov_b32 v9, 0
    v_mov_b32 v10, 0
    v_mov_b32 v11, 0
    s_cmp_eq_u32 s96, 0
    s_cbranch_scc1 L_ffl_49
    v_cvt_f32_u32_sdwa v12, v32 dst_sel:DWORD dst_unused:UNUSED_PAD src0_sel:WORD_0
    v_cvt_f32_u32_sdwa v13, v32 dst_sel:DWORD dst_unused:UNUSED_PAD src0_sel:WORD_1
    v_cvt_f32_u32_sdwa v14, v33 dst_sel:DWORD dst_unused:UNUSED_PAD src0_sel:WORD_0
    v_cvt_f32_u32_sdwa v15, v33 dst_sel:DWORD dst_unused:UNUSED_PAD src0_sel:WORD_1
    v_add_f32 v12, 0xc6800000, v12
    v_add_f32 v13, 0xc6800000, v13
    v_add_f32 v14, 0xc6800000, v14
    v_add_f32 v15, 0xc6800000, v15
    v_fmac_f32 v8, s96, v12
    v_fmac_f32 v9, s96, v13
    v_fmac_f32 v10, s96, v14
    v_fmac_f32 v11, s96, v15
L_fbk_50:
    s_cmp_eq_u32 s97, 0
    s_cbranch_scc1 L_ffl_51
    v_cvt_f32_u32_sdwa v12, v34 dst_sel:DWORD dst_unused:UNUSED_PAD src0_sel:WORD_0
    v_cvt_f32_u32_sdwa v13, v34 dst_sel:DWORD dst_unused:UNUSED_PAD src0_sel:WORD_1
    v_cvt_f32_u32_sdwa v14, v35 dst_sel:DWORD dst_unused:UNUSED_PAD src0_sel:WORD_0
    v_cvt_f32_u32_sdwa v15, v35 dst_sel:DWORD dst_unused:UNUSED_PAD src0_sel:WORD_1
    v_add_f32 v12, 0xc6800000, v12
    v_add_f32 v13, 0xc6800000, v13
    v_add_f32 v14, 0xc6800000, v14
    v_add_f32 v15, 0xc6800000, v15
    v_fmac_f32 v8, s97, v12
    v_fmac_f32 v9, s97, v13
    v_fmac_f32 v10, s97, v14
    v_fmac_f32 v11, s97, v15
L_fbk_52:
    s_cmp_eq_u32 s98, 0
    s_cbranch_scc1 L_ffl_53
    v_cvt_f32_u32_sdwa v12, v36 dst_sel:DWORD dst_unused:UNUSED_PAD src0_sel:WORD_0
    v_cvt_f32_u32_sdwa v13, v36 dst_sel:DWORD dst_unused:UNUSED_PAD src0_sel:WORD_1
    v_cvt_f32_u32_sdwa v14, v37 dst_sel:DWORD dst_unused:UNUSED_PAD src0_sel:WORD_0
    v_cvt_f32_u32_sdwa v15, v37 dst_sel:DWORD dst_unused:UNUSED_PAD src0_sel:WORD_1
    v_add_f32 v12, 0xc6800000, v12
    v_add_f32 v13, 0xc6800000, v13
    v_add_f32 v14, 0xc6800000, v14
    v_add_f32 v15, 0xc6800000, v15
    v_fmac_f32 v8, s98, v12
    v_fmac_f32 v9, s98, v13
    v_fmac_f32 v10, s98, v14
    v_fmac_f32 v11, s98, v15
L_fbk_54:
    s_cmp_eq_u32 s99, 0
    s_cbranch_scc1 L_ffl_55
    v_cvt_f32_u32_sdwa v12, v38 dst_sel:DWORD dst_unused:UNUSED_PAD src0_sel:WORD_0
    v_cvt_f32_u32_sdwa v13, v38 dst_sel:DWORD dst_unused:UNUSED_PAD src0_sel:WORD_1
    v_cvt_f32_u32_sdwa v14, v39 dst_sel:DWORD dst_unused:UNUSED_PAD src0_sel:WORD_0
    v_cvt_f32_u32_sdwa v15, v39 dst_sel:DWORD dst_unused:UNUSED_PAD src0_sel:WORD_1
    v_add_f32 v12, 0xc6800000, v12
    v_add_f32 v13, 0xc6800000, v13
    v_add_f32 v14, 0xc6800000, v14
    v_add_f32 v15, 0xc6800000, v15
    v_fmac_f32 v8, s99, v12
    v_fmac_f32 v9, s99, v13
    v_fmac_f32 v10, s99, v14
    v_fmac_f32 v11, s99, v15
L_fbk_56:
    s_lshl_b32 s92, s76, 16
    v_mul_f32 v16, s92, v8
    s_and_b32 s93, s76, s94
    v_mul_f32 v17, s93, v8
    s_lshl_b32 s92, s77, 16
    v_mul_f32 v18, s92, v8
    s_and_b32 s93, s77, s94
    v_mul_f32 v19, s93, v8
    s_lshl_b32 s92, s78, 16
    v_fmac_f32 v16, s92, v9
    s_and_b32 s93, s78, s94
    v_fmac_f32 v17, s93, v9
    s_lshl_b32 s92, s79, 16
    v_fmac_f32 v18, s92, v9
    s_and_b32 s93, s79, s94
    v_fmac_f32 v19, s93, v9
    s_lshl_b32 s92, s80, 16
    v_fmac_f32 v16, s92, v10
    s_and_b32 s93, s80, s94
    v_fmac_f32 v17, s93, v10
    s_lshl_b32 s92, s81, 16
    v_fmac_f32 v18, s92, v10
    s_and_b32 s93, s81, s94
    v_fmac_f32 v19, s93, v10
    s_lshl_b32 s92, s82, 16
    v_fmac_f32 v16, s92, v11
    s_and_b32 s93, s82, s94
    v_fmac_f32 v17, s93, v11
    s_lshl_b32 s92, s83, 16
    v_fmac_f32 v18, s92, v11
    s_and_b32 s93, s83, s94
    v_fmac_f32 v19, s93, v11
    v_mul_f32 v16, v16, v24
    v_mul_f32 v17, v17, v25
    v_mul_f32 v18, v18, v26
    v_mul_f32 v19, v19, v27
    v_cvt_pk_bf16_f32 v16, v16, v17
    v_and_b32 v17, s94, v16
    v_lshlrev_b32 v16, 16, v16
    v_cvt_pk_bf16_f32 v18, v18, v19
    v_and_b32 v19, s94, v18
    v_lshlrev_b32 v18, 16, v18
    s_lshl_b32 s92, s84, 16
    v_mul_f32 v20, s92, v16
    s_and_b32 s93, s84, s94
    v_mul_f32 v21, s93, v16
    s_lshl_b32 s92, s85, 16
    v_mul_f32 v22, s92, v16
    s_and_b32 s93, s85, s94
    v_mul_f32 v23, s93, v16
    s_lshl_b32 s92, s86, 16
    v_fmac_f32 v20, s92, v17
    s_and_b32 s93, s86, s94
    v_fmac_f32 v21, s93, v17
    s_lshl_b32 s92, s87, 16
    v_fmac_f32 v22, s92, v17
    s_and_b32 s93, s87, s94
    v_fmac_f32 v23, s93, v17
    s_lshl_b32 s92, s88, 16
    v_fmac_f32 v20, s92, v18
    s_and_b32 s93, s88, s94
    v_fmac_f32 v21, s93, v18
    s_lshl_b32 s92, s89, 16
    v_fmac_f32 v22, s92, v18
    s_and_b32 s93, s89, s94
    v_fmac_f32 v23, s93, v18
    s_lshl_b32 s92, s90, 16
    v_fmac_f32 v20, s92, v19
    s_and_b32 s93, s90, s94
    v_fmac_f32 v21, s93, v19
    s_lshl_b32 s92, s91, 16
    v_fmac_f32 v22, s92, v19
    s_and_b32 s93, s91, s94
    v_fmac_f32 v23, s93, v19
    v_cvt_pk_bf16_f32 v20, v20, v21
    v_and_b32 v21, s94, v20
    v_lshlrev_b32 v20, 16, v20
    v_cvt_pk_bf16_f32 v22, v22, v23
    v_and_b32 v23, s94, v22
    v_lshlrev_b32 v22, 16, v22
    v_mul_f32 v20, v20, v28
    v_mul_f32 v21, v21, v29
    v_mul_f32 v22, v22, v30
    v_mul_f32 v23, v23, v31
    v_cvt_pk_bf16_f32 v20, v20, v21
    v_and_b32 v21, s94, v20
    v_lshlrev_b32 v20, 16, v20
    v_cvt_pk_bf16_f32 v22, v22, v23
    v_and_b32 v23, s94, v22
    v_lshlrev_b32 v22, 16, v22
    s_waitcnt vmcnt(0)
    v_lshlrev_b32 v8, 16, v6
    v_and_b32 v9, s94, v6
    v_lshlrev_b32 v10, 16, v7
    v_and_b32 v11, s94, v7

    v_add_f32 v8, v8, v20
    v_add_f32 v9, v9, v21
    v_add_f32 v10, v10, v22
    v_add_f32 v11, v11, v23
    v_cvt_pk_bf16_f32 v12, v8, v9
    v_cvt_pk_bf16_f32 v13, v10, v11
    buffer_store_dwordx2 v[12:13], v2, s[36:39], 0 offen
L_fdone_48:
    s_endpgm

L_ffl_49:
    s_mov_b32 s3, 25600000
    buffer_load_dwordx4 v[12:15], v1, s[24:27], s3 offen
    s_waitcnt vmcnt(0)
    v_add_f32 v8, v8, v12
    v_add_f32 v9, v9, v13
    v_add_f32 v10, v10, v14
    v_add_f32 v11, v11, v15
    s_branch L_fbk_50

L_ffl_51:
    s_mov_b32 s3, 38400000
    buffer_load_dwordx4 v[12:15], v1, s[24:27], s3 offen
    s_waitcnt vmcnt(0)
    v_add_f32 v8, v8, v12
    v_add_f32 v9, v9, v13
    v_add_f32 v10, v10, v14
    v_add_f32 v11, v11, v15
    s_branch L_fbk_52

L_ffl_53:
    s_mov_b32 s3, 51200000
    buffer_load_dwordx4 v[12:15], v1, s[24:27], s3 offen
    s_waitcnt vmcnt(0)
    v_add_f32 v8, v8, v12
    v_add_f32 v9, v9, v13
    v_add_f32 v10, v10, v14
    v_add_f32 v11, v11, v15
    s_branch L_fbk_54

L_ffl_55:
    s_mov_b32 s3, 64000000
    buffer_load_dwordx4 v[12:15], v1, s[24:27], s3 offen
    s_waitcnt vmcnt(0)
    v_add_f32 v8, v8, v12
    v_add_f32 v9, v9, v13
    v_add_f32 v10, v10, v14
    v_add_f32 v11, v11, v15
    s_branch L_fbk_56

.section .rodata,"a"
.p2align 6
.amdhsa_kernel g0_kernel
  .amdhsa_next_free_vgpr 40
  .amdhsa_next_free_sgpr 32
  .amdhsa_accum_offset 40
  .amdhsa_group_segment_fixed_size 0
  .amdhsa_kernarg_size 112
  .amdhsa_user_sgpr_count 2
  .amdhsa_user_sgpr_kernarg_segment_ptr 1
  .amdhsa_system_sgpr_workgroup_id_x 1
.end_amdhsa_kernel
.p2align 6
.amdhsa_kernel g1_kernel
  .amdhsa_next_free_vgpr 128
  .amdhsa_next_free_sgpr 102
  .amdhsa_accum_offset 128
  .amdhsa_group_segment_fixed_size 0
  .amdhsa_kernarg_size 112
  .amdhsa_user_sgpr_count 2
  .amdhsa_user_sgpr_kernarg_segment_ptr 1
  .amdhsa_system_sgpr_workgroup_id_x 1
.end_amdhsa_kernel
.p2align 6
.amdhsa_kernel g2_kernel
  .amdhsa_next_free_vgpr 128
  .amdhsa_next_free_sgpr 102
  .amdhsa_accum_offset 128
  .amdhsa_group_segment_fixed_size 0
  .amdhsa_kernarg_size 112
  .amdhsa_user_sgpr_count 2
  .amdhsa_user_sgpr_kernarg_segment_ptr 1
  .amdhsa_system_sgpr_workgroup_id_x 1
  .amdhsa_float_denorm_mode_32 3
.end_amdhsa_kernel
.p2align 6
.amdhsa_kernel standalone__molecular_angular_gemnet__graph_kernel
  .amdhsa_next_free_vgpr 40
  .amdhsa_next_free_sgpr 100
  .amdhsa_accum_offset 40
  .amdhsa_group_segment_fixed_size 0
  .amdhsa_kernarg_size 112
  .amdhsa_user_sgpr_count 2
  .amdhsa_user_sgpr_kernarg_segment_ptr 1
  .amdhsa_system_sgpr_workgroup_id_x 1
  .amdhsa_float_denorm_mode_32 3
.end_amdhsa_kernel
```

```asm
; @launch kernel=g0_kernel grid=(256,1,1) block=(256,1,1) lds=0
; @launch kernel=g1_kernel grid=(256,1,1) block=(1024,1,1) lds=163840
; @launch kernel=g2_kernel grid=(256,1,1) block=(1024,1,1) lds=163840
; @launch kernel=standalone__molecular_angular_gemnet__graph_kernel grid=(3200,1,1) block=(256,1,1) lds=0
.amdgcn_target "amdgcn-amd-amdhsa--gfx950"
.text
.globl g0_kernel
.p2align 8
.type g0_kernel,@function
g0_kernel:
    s_cmp_ge_u32 s2, 256
    s_cbranch_scc1 L_k0done_1
    s_load_dwordx2 s[4:5], s[0:1], 0
    s_load_dwordx2 s[6:7], s[0:1], 104
    s_mul_i32 s3, s2, 25000
    v_lshlrev_b32 v1, 4, v0
    s_waitcnt lgkmcnt(0)

    s_add_u32 s8, s4, s3
    s_addc_u32 s9, s5, 0
    s_mov_b32 s10, 25000
    s_mov_b32 s11, 0x20000
    s_mov_b32 s12, s6
    s_mov_b32 s13, s7
    s_mov_b32 s14, 131328
    s_mov_b32 s15, 0x20000
    s_add_u32 s16, s6, 135168
    s_addc_u32 s17, s7, 0
    s_mov_b32 s18, 8192
    s_mov_b32 s19, 0x20000
    s_movk_i32 s20, 0
    buffer_load_dwordx4 v[4:7], v1, s[8:11], s20 offen
    s_movk_i32 s20, 4096
    buffer_load_dwordx4 v[8:11], v1, s[8:11], s20 offen
    s_movk_i32 s20, 8192
    buffer_load_dwordx4 v[12:15], v1, s[8:11], s20 offen
    s_movk_i32 s20, 12288
    buffer_load_dwordx4 v[16:19], v1, s[8:11], s20 offen
    s_movk_i32 s20, 16384
    buffer_load_dwordx4 v[20:23], v1, s[8:11], s20 offen
    s_movk_i32 s20, 20480
    buffer_load_dwordx4 v[24:27], v1, s[8:11], s20 offen
    s_movk_i32 s20, 24576
    buffer_load_dwordx4 v[28:31], v1, s[8:11], s20 offen
    s_lshl_b32 s21, s2, 12
    v_add_u32 v2, s21, v1
    v_mov_b32 v32, 0
    v_mov_b32 v33, 0
    v_mov_b32 v34, 0
    v_mov_b32 v35, 0
    buffer_store_dwordx4 v[32:35], v2, s[12:15], 0 offen
    s_mov_b32 s22, 0x7fff7fff
    s_waitcnt vmcnt(1)

    v_and_b32 v4, s22, v4
    v_and_b32 v5, s22, v5
    v_and_b32 v6, s22, v6
    v_and_b32 v7, s22, v7
    v_and_b32 v8, s22, v8
    v_and_b32 v9, s22, v9
    v_and_b32 v10, s22, v10
    v_and_b32 v11, s22, v11
    v_and_b32 v12, s22, v12
    v_and_b32 v13, s22, v13
    v_and_b32 v14, s22, v14
    v_and_b32 v15, s22, v15
    v_and_b32 v16, s22, v16
    v_and_b32 v17, s22, v17
    v_and_b32 v18, s22, v18
    v_and_b32 v19, s22, v19
    v_and_b32 v20, s22, v20
    v_and_b32 v21, s22, v21
    v_and_b32 v22, s22, v22
    v_and_b32 v23, s22, v23
    v_and_b32 v24, s22, v24
    v_and_b32 v25, s22, v25
    v_and_b32 v26, s22, v26
    v_and_b32 v27, s22, v27
    v_and_b32 v28, s22, v28
    v_and_b32 v29, s22, v29
    v_and_b32 v30, s22, v30
    v_and_b32 v31, s22, v31
    v_mov_b32 v37, 0
    v_dot2_f32_bf16 v37, v4, v4, v37
    v_dot2_f32_bf16 v37, v5, v5, v37
    v_dot2_f32_bf16 v37, v6, v6, v37
    v_dot2_f32_bf16 v37, v7, v7, v37
    v_dot2_f32_bf16 v37, v8, v8, v37
    v_dot2_f32_bf16 v37, v9, v9, v37
    v_dot2_f32_bf16 v37, v10, v10, v37
    v_dot2_f32_bf16 v37, v11, v11, v37
    v_dot2_f32_bf16 v37, v12, v12, v37
    v_dot2_f32_bf16 v37, v13, v13, v37
    v_dot2_f32_bf16 v37, v14, v14, v37
    v_dot2_f32_bf16 v37, v15, v15, v37
    v_dot2_f32_bf16 v37, v16, v16, v37
    v_dot2_f32_bf16 v37, v17, v17, v37
    v_dot2_f32_bf16 v37, v18, v18, v37
    v_dot2_f32_bf16 v37, v19, v19, v37
    v_dot2_f32_bf16 v37, v20, v20, v37
    v_dot2_f32_bf16 v37, v21, v21, v37
    v_dot2_f32_bf16 v37, v22, v22, v37
    v_dot2_f32_bf16 v37, v23, v23, v37
    v_dot2_f32_bf16 v37, v24, v24, v37
    v_dot2_f32_bf16 v37, v25, v25, v37
    v_dot2_f32_bf16 v37, v26, v26, v37
    v_dot2_f32_bf16 v37, v27, v27, v37
    v_dot2_f32_bf16 v37, v28, v28, v37
    v_dot2_f32_bf16 v37, v29, v29, v37
    v_dot2_f32_bf16 v37, v30, v30, v37
    v_dot2_f32_bf16 v37, v31, v31, v37
    v_pk_max_u16 v4, v4, v5
    v_pk_max_u16 v4, v4, v6
    v_pk_max_u16 v4, v4, v7
    v_pk_max_u16 v4, v4, v8
    v_pk_max_u16 v4, v4, v9
    v_pk_max_u16 v4, v4, v10
    v_pk_max_u16 v4, v4, v11
    v_pk_max_u16 v4, v4, v12
    v_pk_max_u16 v4, v4, v13
    v_pk_max_u16 v4, v4, v14
    v_pk_max_u16 v4, v4, v15
    v_pk_max_u16 v4, v4, v16
    v_pk_max_u16 v4, v4, v17
    v_pk_max_u16 v4, v4, v18
    v_pk_max_u16 v4, v4, v19
    v_pk_max_u16 v4, v4, v20
    v_pk_max_u16 v4, v4, v21
    v_pk_max_u16 v4, v4, v22
    v_pk_max_u16 v4, v4, v23
    v_pk_max_u16 v4, v4, v24
    v_pk_max_u16 v4, v4, v25
    v_pk_max_u16 v4, v4, v26
    v_pk_max_u16 v4, v4, v27
    v_pk_max_u16 v4, v4, v28
    v_pk_max_u16 v4, v4, v29
    v_pk_max_u16 v4, v4, v30
    v_pk_max_u16 v4, v4, v31
    v_lshrrev_b32 v5, 16, v4
    v_and_b32 v4, 0xffff, v4
    v_max_u32 v4, v4, v5

    s_nop 1
    v_max_u32_dpp v4, v4, v4 row_shr:1 row_mask:0xf bank_mask:0xf
    s_nop 1
    v_max_u32_dpp v4, v4, v4 row_shr:2 row_mask:0xf bank_mask:0xf
    s_nop 1
    v_max_u32_dpp v4, v4, v4 row_shr:4 row_mask:0xf bank_mask:0xf
    s_nop 1
    v_max_u32_dpp v4, v4, v4 row_shr:8 row_mask:0xf bank_mask:0xf
    s_nop 1
    v_max_u32_dpp v4, v4, v4 row_bcast:15 row_mask:0xa bank_mask:0xf
    s_nop 1
    v_max_u32_dpp v4, v4, v4 row_bcast:31 row_mask:0xc bank_mask:0xf
    v_mov_b32 v5, v37
    s_nop 1
    v_add_f32_dpp v5, v5, v5 row_shr:1 row_mask:0xf bank_mask:0xf
    s_nop 1
    v_add_f32_dpp v5, v5, v5 row_shr:2 row_mask:0xf bank_mask:0xf
    s_nop 1
    v_add_f32_dpp v5, v5, v5 row_shr:4 row_mask:0xf bank_mask:0xf
    s_nop 1
    v_add_f32_dpp v5, v5, v5 row_shr:8 row_mask:0xf bank_mask:0xf
    s_nop 1
    v_add_f32_dpp v5, v5, v5 row_bcast:15 row_mask:0xa bank_mask:0xf
    s_nop 1
    v_add_f32_dpp v5, v5, v5 row_bcast:31 row_mask:0xc bank_mask:0xf
    v_lshrrev_b32 v6, 6, v0
    s_lshl_b32 s21, s2, 2
    v_add_lshl_u32 v6, v6, s21, 3
    v_and_b32 v7, 63, v0
    v_cmp_eq_u32 vcc, 63, v7
    s_and_saveexec_b64 s[24:25], vcc
    buffer_store_dwordx2 v[4:5], v6, s[16:19], 0 offen
L_k0done_1:
    s_endpgm

.globl g1_kernel
.p2align 8
.type g1_kernel,@function
g1_kernel:
    s_cmp_ge_u32 s2, 256
    s_cbranch_scc1 L_p1done_2
    s_load_dwordx4 s[80:83], s[0:1], 8
    s_load_dwordx2 s[84:85], s[0:1], 32
    s_load_dwordx2 s[86:87], s[0:1], 48
    s_load_dwordx2 s[6:7], s[0:1], 104
    v_lshlrev_b32 v1, 4, v0
    v_lshlrev_b32 v2, 3, v0
    s_waitcnt lgkmcnt(0)
    s_load_dword s88, s[86:87], 0

    s_mov_b32 s8, s80
    s_mov_b32 s9, s81
    s_mov_b32 s10, 0
    s_mov_b32 s11, 0x20000
    s_mov_b32 s12, s82
    s_mov_b32 s13, s83
    s_mov_b32 s14, 0
    s_mov_b32 s15, 0x20000
    s_mov_b32 s16, s84
    s_mov_b32 s17, s85
    s_mov_b32 s18, 0
    s_mov_b32 s19, 0x20000
    s_mul_i32 s78, s2, 16000
    s_add_u32 s49, s78, 16000
    s_cmp_ge_u32 s2, 3200
    s_cmovk_i32 s49, 0
    s_cmovk_i32 s78, 0
    s_lshl_b32 s10, s49, 2
    s_lshl_b32 s14, s49, 2
    s_lshl_b32 s18, s49, 1
    s_lshl_b32 s56, s78, 2
    s_lshl_b32 s61, s78, 1

    s_add_u32 s57, s56, 16384
    s_add_u32 s62, s61, 8192
    s_add_u32 s58, s56, 32768
    s_add_u32 s63, s61, 16384
    s_add_u32 s59, s56, 49152
    s_add_u32 s64, s61, 24576
    s_mov_b32 s41, s2
    buffer_load_dwordx4 v[20:23], v1, s[12:15], s56 offen nt
    buffer_load_dwordx4 v[4:7], v1, s[8:11], s56 offen nt
    buffer_load_dwordx2 v[36:37], v2, s[16:19], s61 offen nt
    buffer_load_dwordx4 v[24:27], v1, s[12:15], s57 offen nt
    buffer_load_dwordx4 v[8:11], v1, s[8:11], s57 offen nt
    buffer_load_dwordx2 v[38:39], v2, s[16:19], s62 offen nt
    buffer_load_dwordx4 v[28:31], v1, s[12:15], s58 offen nt
    buffer_load_dwordx4 v[12:15], v1, s[8:11], s58 offen nt
    buffer_load_dwordx2 v[40:41], v2, s[16:19], s63 offen nt
    buffer_load_dwordx4 v[32:35], v1, s[12:15], s59 offen nt
    buffer_load_dwordx4 v[16:19], v1, s[8:11], s59 offen nt
    buffer_load_dwordx2 v[42:43], v2, s[16:19], s64 offen nt
    s_and_b32 s5, s2, 7
    s_mul_i32 s3, s5, 8192

    s_add_u32 s20, s6, s3
    s_addc_u32 s21, s7, 0
    s_mov_b32 s22, 8192
    s_mov_b32 s23, 0x20000
    s_mul_i32 s3, s5, 40632320
    s_add_u32 s3, s3, 77848576
    s_add_u32 s24, s6, s3
    s_addc_u32 s25, s7, 0
    s_mov_b32 s26, 40632320
    s_mov_b32 s27, 0x20000
    s_add_u32 s28, s6, s3
    s_addc_u32 s29, s7, 0
    s_mov_b32 s30, 40632320
    s_mov_b32 s31, 0x20000
    s_add_u32 s32, s6, 402907136
    s_addc_u32 s33, s7, 0
    s_mov_b32 s34, 409600000
    s_mov_b32 s35, 0x20000
    s_add_u32 s36, s6, 131072
    s_addc_u32 s37, s7, 0
    s_mov_b32 s38, 256
    s_mov_b32 s39, 0x20000
    s_mov_b32 s40, 687195
    s_mov_b32 s42, -6250
    s_mov_b32 s43, 1942
    s_mov_b32 s45, 0x06050400
    s_mov_b32 s46, 0x05040c00
    s_mov_b32 s47, 0x04020100
    s_mov_b32 s48, 3968
    s_mov_b32 s50, 0
    s_mov_b32 s53, 0
    v_mov_b32 v104, 1
    v_mov_b32 v105, 0x46ff8000
    s_mov_b32 s55, 0x05040100
    v_mul_u32_u24 v106, 5, v0
    v_mov_b32 v108, 16384
    v_mov_b32 v110, 0
    v_mov_b32 v111, 0
    v_mov_b32 v112, 0
    v_mov_b32 v113, 0
    ds_write_b64 v2, v[110:111]
    v_mov_b32 v114, 0
    v_mov_b32 v115, 0
    v_mov_b32 v116, 0
    v_mov_b32 v117, -1
    v_mov_b32 v118, 144404
    s_movk_i32 s3, 928
    v_cmp_gt_u32 s[66:67], s3, v0
    s_movk_i32 s3, 640
    v_cmp_gt_u32 s[68:69], s3, v0
    s_mov_b64 exec, 1
    ds_write_b128 v108, v[114:117]
    ds_write_b32 v118, v117
    s_mov_b64 exec, -1
    s_waitcnt lgkmcnt(0)
    s_lshl_b32 s88, s88, 16
    v_mov_b32 v110, 0.15915494
    v_mul_f32 v110, s88, v110
    s_nop 0
    v_readfirstlane_b32 s44, v110
    s_barrier

    s_waitcnt vmcnt(9)
    v_mul_hi_u32_u24 v45, s40, v20
    v_mul_hi_u32_u24 v44, s40, v4
    v_mul_hi_u32_u24 v47, s40, v21
    v_mul_hi_u32_u24 v46, s40, v5
    v_mul_hi_u32_u24 v49, s40, v22
    v_mul_hi_u32_u24 v48, s40, v6
    v_mul_hi_u32_u24 v51, s40, v23
    v_mul_hi_u32_u24 v50, s40, v7
    v_and_b32 v45, -2, v45
    v_mad_u32_u24 v4, v44, s43, v4
    v_and_b32 v76, -4, v44
    v_and_b32 v47, -2, v47
    v_mad_u32_u24 v5, v46, s43, v5
    v_and_b32 v77, -4, v46
    v_and_b32 v49, -2, v49
    v_mad_u32_u24 v6, v48, s43, v6
    v_and_b32 v78, -4, v48
    v_and_b32 v51, -2, v51
    v_mad_u32_u24 v7, v50, s43, v7
    v_and_b32 v79, -4, v50
    v_mad_i32_i24 v20, v45, s42, v20
    v_lshl_add_u32 v45, v76, 5, v45
    v_mad_i32_i24 v21, v47, s42, v21
    v_lshl_add_u32 v47, v77, 5, v47
    v_mad_i32_i24 v22, v49, s42, v22
    v_lshl_add_u32 v49, v78, 5, v49
    v_mad_i32_i24 v23, v51, s42, v23
    v_lshl_add_u32 v51, v79, 5, v51
    v_add_u32 v45, v45, v45
    ds_add_rtn_u32 v76, v45, v104
    v_add_u32 v47, v47, v47
    ds_add_rtn_u32 v77, v47, v104
    v_add_u32 v49, v49, v49
    ds_add_rtn_u32 v78, v49, v104
    v_add_u32 v51, v51, v51
    ds_add_rtn_u32 v79, v51, v104
    v_lshlrev_b32 v110, 16, v36
    v_and_b32 v111, 0xffff0000, v36
    v_lshlrev_b32 v112, 16, v37
    v_and_b32 v113, 0xffff0000, v37
    v_mul_f32 v110, s44, v110
    v_mul_f32 v111, s44, v111
    v_mul_f32 v112, s44, v112
    v_mul_f32 v113, s44, v113
    v_fract_f32 v110, v110
    v_fract_f32 v111, v111
    v_fract_f32 v112, v112
    v_fract_f32 v113, v113
    v_cos_f32 v110, v110
    v_cos_f32 v111, v111
    v_cos_f32 v112, v112
    v_cos_f32 v113, v113
    v_lshl_or_b32 v44, v44, 14, v20
    v_perm_b32 v45, v45, v4, s46
    v_bfe_u32 v4, v4, 8, 5

    v_lshl_or_b32 v46, v46, 14, v21
    v_perm_b32 v47, v47, v5, s46
    v_bfe_u32 v5, v5, 8, 5

    v_lshl_or_b32 v48, v48, 14, v22
    v_perm_b32 v49, v49, v6, s46
    v_bfe_u32 v6, v6, 8, 5

    v_lshl_or_b32 v50, v50, 14, v23
    v_perm_b32 v51, v51, v7, s46
    v_bfe_u32 v7, v7, 8, 5

    v_fmaak_f32 v110, v110, v105, 0x4b400010
    v_fmaak_f32 v111, v111, v105, 0x4b400010
    v_fmaak_f32 v112, v112, v105, 0x4b400010
    v_fmaak_f32 v113, v113, v105, 0x4b400010
    v_sub_u32 v110, v110, v4
    v_sub_u32 v111, v111, v5
    v_sub_u32 v112, v112, v6
    v_sub_u32 v113, v113, v7
    v_bfi_b32 v110, 31, v4, v110
    v_bfi_b32 v111, 31, v5, v111
    v_bfi_b32 v112, 31, v6, v112
    v_bfi_b32 v113, 31, v7, v113
    v_perm_b32 v44, v44, v110, s55
    v_perm_b32 v46, v46, v111, s55
    v_perm_b32 v48, v48, v112, s55
    v_perm_b32 v50, v50, v113, s55
    v_mov_b32 v96, 1
    v_lshlrev_b32 v97, 20, v0
    buffer_atomic_add v96, v97, s[36:39], 0 offen offset:128 sc0
    s_waitcnt vmcnt(7)
    v_mul_hi_u32_u24 v53, s40, v24
    v_mul_hi_u32_u24 v52, s40, v8
    v_mul_hi_u32_u24 v55, s40, v25
    v_mul_hi_u32_u24 v54, s40, v9
    v_mul_hi_u32_u24 v57, s40, v26
    v_mul_hi_u32_u24 v56, s40, v10
    v_mul_hi_u32_u24 v59, s40, v27
    v_mul_hi_u32_u24 v58, s40, v11
    v_and_b32 v53, -2, v53
    v_mad_u32_u24 v8, v52, s43, v8
    v_and_b32 v80, -4, v52
    v_and_b32 v55, -2, v55
    v_mad_u32_u24 v9, v54, s43, v9
    v_and_b32 v81, -4, v54
    v_and_b32 v57, -2, v57
    v_mad_u32_u24 v10, v56, s43, v10
    v_and_b32 v82, -4, v56
    v_and_b32 v59, -2, v59
    v_mad_u32_u24 v11, v58, s43, v11
    v_and_b32 v83, -4, v58
    v_mad_i32_i24 v24, v53, s42, v24
    v_lshl_add_u32 v53, v80, 5, v53
    v_mad_i32_i24 v25, v55, s42, v25
    v_lshl_add_u32 v55, v81, 5, v55
    v_mad_i32_i24 v26, v57, s42, v26
    v_lshl_add_u32 v57, v82, 5, v57
    v_mad_i32_i24 v27, v59, s42, v27
    v_lshl_add_u32 v59, v83, 5, v59
    v_add_u32 v53, v53, v53
    ds_add_rtn_u32 v80, v53, v104
    v_add_u32 v55, v55, v55
    ds_add_rtn_u32 v81, v55, v104
    v_add_u32 v57, v57, v57
    ds_add_rtn_u32 v82, v57, v104
    v_add_u32 v59, v59, v59
    ds_add_rtn_u32 v83, v59, v104
    v_lshlrev_b32 v110, 16, v38
    v_and_b32 v111, 0xffff0000, v38
    v_lshlrev_b32 v112, 16, v39
    v_and_b32 v113, 0xffff0000, v39
    v_mul_f32 v110, s44, v110
    v_mul_f32 v111, s44, v111
    v_mul_f32 v112, s44, v112
    v_mul_f32 v113, s44, v113
    v_fract_f32 v110, v110
    v_fract_f32 v111, v111
    v_fract_f32 v112, v112
    v_fract_f32 v113, v113
    v_cos_f32 v110, v110
    v_cos_f32 v111, v111
    v_cos_f32 v112, v112
    v_cos_f32 v113, v113
    v_lshl_or_b32 v52, v52, 14, v24
    v_perm_b32 v53, v53, v8, s46
    v_bfe_u32 v8, v8, 8, 5

    v_lshl_or_b32 v54, v54, 14, v25
    v_perm_b32 v55, v55, v9, s46
    v_bfe_u32 v9, v9, 8, 5

    v_lshl_or_b32 v56, v56, 14, v26
    v_perm_b32 v57, v57, v10, s46
    v_bfe_u32 v10, v10, 8, 5

    v_lshl_or_b32 v58, v58, 14, v27
    v_perm_b32 v59, v59, v11, s46
    v_bfe_u32 v11, v11, 8, 5

    v_fmaak_f32 v110, v110, v105, 0x4b400010
    v_fmaak_f32 v111, v111, v105, 0x4b400010
    v_fmaak_f32 v112, v112, v105, 0x4b400010
    v_fmaak_f32 v113, v113, v105, 0x4b400010
    v_sub_u32 v110, v110, v8
    v_sub_u32 v111, v111, v9
    v_sub_u32 v112, v112, v10
    v_sub_u32 v113, v113, v11
    v_bfi_b32 v110, 31, v8, v110
    v_bfi_b32 v111, 31, v9, v111
    v_bfi_b32 v112, 31, v10, v112
    v_bfi_b32 v113, 31, v11, v113
    v_perm_b32 v52, v52, v110, s55
    v_perm_b32 v54, v54, v111, s55
    v_perm_b32 v56, v56, v112, s55
    v_perm_b32 v58, v58, v113, s55
    s_waitcnt vmcnt(4)
    v_mul_hi_u32_u24 v61, s40, v28
    v_mul_hi_u32_u24 v60, s40, v12
    v_mul_hi_u32_u24 v63, s40, v29
    v_mul_hi_u32_u24 v62, s40, v13
    v_mul_hi_u32_u24 v65, s40, v30
    v_mul_hi_u32_u24 v64, s40, v14
    v_mul_hi_u32_u24 v67, s40, v31
    v_mul_hi_u32_u24 v66, s40, v15
    v_and_b32 v61, -2, v61
    v_mad_u32_u24 v12, v60, s43, v12
    v_and_b32 v84, -4, v60
    v_and_b32 v63, -2, v63
    v_mad_u32_u24 v13, v62, s43, v13
    v_and_b32 v85, -4, v62
    v_and_b32 v65, -2, v65
    v_mad_u32_u24 v14, v64, s43, v14
    v_and_b32 v86, -4, v64
    v_and_b32 v67, -2, v67
    v_mad_u32_u24 v15, v66, s43, v15
    v_and_b32 v87, -4, v66
    v_mad_i32_i24 v28, v61, s42, v28
    v_lshl_add_u32 v61, v84, 5, v61
    v_mad_i32_i24 v29, v63, s42, v29
    v_lshl_add_u32 v63, v85, 5, v63
    v_mad_i32_i24 v30, v65, s42, v30
    v_lshl_add_u32 v65, v86, 5, v65
    v_mad_i32_i24 v31, v67, s42, v31
    v_lshl_add_u32 v67, v87, 5, v67
    v_add_u32 v61, v61, v61
    ds_add_rtn_u32 v84, v61, v104
    v_add_u32 v63, v63, v63
    ds_add_rtn_u32 v85, v63, v104
    v_add_u32 v65, v65, v65
    ds_add_rtn_u32 v86, v65, v104
    v_add_u32 v67, v67, v67
    ds_add_rtn_u32 v87, v67, v104
    v_lshlrev_b32 v110, 16, v40
    v_and_b32 v111, 0xffff0000, v40
    v_lshlrev_b32 v112, 16, v41
    v_and_b32 v113, 0xffff0000, v41
    v_mul_f32 v110, s44, v110
    v_mul_f32 v111, s44, v111
    v_mul_f32 v112, s44, v112
    v_mul_f32 v113, s44, v113
    v_fract_f32 v110, v110
    v_fract_f32 v111, v111
    v_fract_f32 v112, v112
    v_fract_f32 v113, v113
    v_cos_f32 v110, v110
    v_cos_f32 v111, v111
    v_cos_f32 v112, v112
    v_cos_f32 v113, v113
    v_lshl_or_b32 v60, v60, 14, v28
    v_perm_b32 v61, v61, v12, s46
    v_bfe_u32 v12, v12, 8, 5

    v_lshl_or_b32 v62, v62, 14, v29
    v_perm_b32 v63, v63, v13, s46
    v_bfe_u32 v13, v13, 8, 5

    v_lshl_or_b32 v64, v64, 14, v30
    v_perm_b32 v65, v65, v14, s46
    v_bfe_u32 v14, v14, 8, 5

    v_lshl_or_b32 v66, v66, 14, v31
    v_perm_b32 v67, v67, v15, s46
    v_bfe_u32 v15, v15, 8, 5

    v_fmaak_f32 v110, v110, v105, 0x4b400010
    v_fmaak_f32 v111, v111, v105, 0x4b400010
    v_fmaak_f32 v112, v112, v105, 0x4b400010
    v_fmaak_f32 v113, v113, v105, 0x4b400010
    v_sub_u32 v110, v110, v12
    v_sub_u32 v111, v111, v13
    v_sub_u32 v112, v112, v14
    v_sub_u32 v113, v113, v15
    v_bfi_b32 v110, 31, v12, v110
    v_bfi_b32 v111, 31, v13, v111
    v_bfi_b32 v112, 31, v14, v112
    v_bfi_b32 v113, 31, v15, v113
    v_perm_b32 v60, v60, v110, s55
    v_perm_b32 v62, v62, v111, s55
    v_perm_b32 v64, v64, v112, s55
    v_perm_b32 v66, v66, v113, s55
    s_waitcnt vmcnt(1)
    s_mov_b64 exec, s[66:67]
    v_mul_hi_u32_u24 v69, s40, v32
    v_mul_hi_u32_u24 v68, s40, v16
    v_mul_hi_u32_u24 v71, s40, v33
    v_mul_hi_u32_u24 v70, s40, v17
    v_mul_hi_u32_u24 v73, s40, v34
    v_mul_hi_u32_u24 v72, s40, v18
    v_mul_hi_u32_u24 v75, s40, v35
    v_mul_hi_u32_u24 v74, s40, v19
    v_and_b32 v69, -2, v69
    v_mad_u32_u24 v16, v68, s43, v16
    v_and_b32 v88, -4, v68
    v_and_b32 v71, -2, v71
    v_mad_u32_u24 v17, v70, s43, v17
    v_and_b32 v89, -4, v70
    v_and_b32 v73, -2, v73
    v_mad_u32_u24 v18, v72, s43, v18
    v_and_b32 v90, -4, v72
    v_and_b32 v75, -2, v75
    v_mad_u32_u24 v19, v74, s43, v19
    v_and_b32 v91, -4, v74
    v_mad_i32_i24 v32, v69, s42, v32
    v_lshl_add_u32 v69, v88, 5, v69
    v_mad_i32_i24 v33, v71, s42, v33
    v_lshl_add_u32 v71, v89, 5, v71
    v_mad_i32_i24 v34, v73, s42, v34
    v_lshl_add_u32 v73, v90, 5, v73
    v_mad_i32_i24 v35, v75, s42, v35
    v_lshl_add_u32 v75, v91, 5, v75
    v_add_u32 v69, v69, v69
    ds_add_rtn_u32 v88, v69, v104
    v_add_u32 v71, v71, v71
    ds_add_rtn_u32 v89, v71, v104
    v_add_u32 v73, v73, v73
    ds_add_rtn_u32 v90, v73, v104
    v_add_u32 v75, v75, v75
    ds_add_rtn_u32 v91, v75, v104
    v_lshlrev_b32 v110, 16, v42
    v_and_b32 v111, 0xffff0000, v42
    v_lshlrev_b32 v112, 16, v43
    v_and_b32 v113, 0xffff0000, v43
    v_mul_f32 v110, s44, v110
    v_mul_f32 v111, s44, v111
    v_mul_f32 v112, s44, v112
    v_mul_f32 v113, s44, v113
    v_fract_f32 v110, v110
    v_fract_f32 v111, v111
    v_fract_f32 v112, v112
    v_fract_f32 v113, v113
    v_cos_f32 v110, v110
    v_cos_f32 v111, v111
    v_cos_f32 v112, v112
    v_cos_f32 v113, v113
    v_lshl_or_b32 v68, v68, 14, v32
    v_perm_b32 v69, v69, v16, s46
    v_bfe_u32 v16, v16, 8, 5

    v_lshl_or_b32 v70, v70, 14, v33
    v_perm_b32 v71, v71, v17, s46
    v_bfe_u32 v17, v17, 8, 5

    v_lshl_or_b32 v72, v72, 14, v34
    v_perm_b32 v73, v73, v18, s46
    v_bfe_u32 v18, v18, 8, 5

    v_lshl_or_b32 v74, v74, 14, v35
    v_perm_b32 v75, v75, v19, s46
    v_bfe_u32 v19, v19, 8, 5

    v_fmaak_f32 v110, v110, v105, 0x4b400010
    v_fmaak_f32 v111, v111, v105, 0x4b400010
    v_fmaak_f32 v112, v112, v105, 0x4b400010
    v_fmaak_f32 v113, v113, v105, 0x4b400010
    v_sub_u32 v110, v110, v16
    v_sub_u32 v111, v111, v17
    v_sub_u32 v112, v112, v18
    v_sub_u32 v113, v113, v19
    v_bfi_b32 v110, 31, v16, v110
    v_bfi_b32 v111, 31, v17, v111
    v_bfi_b32 v112, 31, v18, v112
    v_bfi_b32 v113, 31, v19, v113
    v_perm_b32 v68, v68, v110, s55
    v_perm_b32 v70, v70, v111, s55
    v_perm_b32 v72, v72, v112, s55
    v_perm_b32 v74, v74, v113, s55
    s_mov_b64 exec, -1
    v_cmp_eq_u32 vcc, 0, v0
    s_waitcnt vmcnt(0)
    s_mov_b64 exec, vcc
    ds_write_b32 v108, v96 offset:8
    s_mov_b64 exec, -1
    s_waitcnt lgkmcnt(0)
    s_barrier

    ds_read_b32 v110, v108 offset:8
    ds_read_b64 v[96:97], v2
    s_waitcnt lgkmcnt(0)

    v_readfirstlane_b32 s41, v110
    v_and_b32 v96, 0xffff, v96
    v_and_b32 v97, 0xffff, v97
    v_add_u32 v92, v96, v96
    v_add_u32 v93, v97, v97
    v_add_u32 v101, v96, v97
    v_med3_u32 v92, v96, 2, v92
    v_med3_u32 v93, v97, 2, v93
    buffer_atomic_add_x2 v[92:93], v2, s[20:23], 0 offen sc0
    s_nop 1
    v_add_u32_dpp v101, v101, v101 row_shr:1 row_mask:0xf bank_mask:0xf
    s_nop 1
    v_add_u32_dpp v101, v101, v101 row_shr:2 row_mask:0xf bank_mask:0xf
    s_nop 1
    v_add_u32_dpp v101, v101, v101 row_shr:4 row_mask:0xf bank_mask:0xf
    s_nop 1
    v_add_u32_dpp v101, v101, v101 row_shr:8 row_mask:0xf bank_mask:0xf
    s_nop 1
    v_add_u32_dpp v101, v101, v101 row_bcast:15 row_mask:0xa bank_mask:0xf
    s_nop 1
    v_add_u32_dpp v101, v101, v101 row_bcast:31 row_mask:0xc bank_mask:0xf
    s_mov_b32 exec_lo, 0
    s_brev_b32 exec_hi, 1
    ds_add_rtn_u32 v100, v108, v101
    s_mov_b64 exec, -1

    s_add_u32 s41, s41, 256
    s_mul_i32 s78, s41, 16000
    s_add_u32 s49, s78, 16000
    s_cmp_ge_u32 s41, 3200
    s_cmovk_i32 s49, 0
    s_cmovk_i32 s78, 0
    s_lshl_b32 s10, s49, 2
    s_lshl_b32 s14, s49, 2
    s_lshl_b32 s18, s49, 1
    s_lshl_b32 s56, s78, 2
    s_lshl_b32 s61, s78, 1

    s_add_u32 s57, s56, 16384
    s_add_u32 s62, s61, 8192
    s_add_u32 s58, s56, 32768
    s_add_u32 s63, s61, 16384
    s_add_u32 s59, s56, 49152
    s_add_u32 s64, s61, 24576
    buffer_load_dwordx4 v[20:23], v1, s[12:15], s56 offen nt
    buffer_load_dwordx4 v[4:7], v1, s[8:11], s56 offen nt
    buffer_load_dwordx2 v[36:37], v2, s[16:19], s61 offen nt
    s_waitcnt lgkmcnt(0)
    v_readlane_b32 s77, v100, 63
    v_mul_u32_u24 v114, 7936, v0
    v_sub_u32 v101, v101, v97
    s_sub_u32 s77, s77, s50
    v_add_u32 v101, s77, v101
    v_sub_u32 v100, v101, v96
    v_lshlrev_b32 v111, 16, v101
    v_lshlrev_b32 v110, 16, v100
    ds_write_b64 v2, v[110:111]
    v_sub_u32 v100, v114, v100
    v_sub_u32 v101, v114, v101
    v_add_u32 v101, s48, v101

    s_waitcnt lgkmcnt(0)
    s_barrier

    v_lshrrev_b32 v110, 16, v45
    ds_read_b32 v110, v110
    v_lshrrev_b32 v111, 16, v47
    ds_read_b32 v111, v111
    v_lshrrev_b32 v112, 16, v49
    ds_read_b32 v112, v112
    v_lshrrev_b32 v113, 16, v51
    ds_read_b32 v113, v113
    v_lshrrev_b32 v114, 16, v53
    ds_read_b32 v114, v114
    v_lshrrev_b32 v115, 16, v55
    ds_read_b32 v115, v115
    v_lshrrev_b32 v116, 16, v57
    ds_read_b32 v116, v116
    v_lshrrev_b32 v117, 16, v59
    ds_read_b32 v117, v117
    s_waitcnt lgkmcnt(7)
    v_add_u32_sdwa v110, v110, v76 dst_sel:DWORD dst_unused:UNUSED_PAD src0_sel:WORD_1 src1_sel:WORD_0
    v_lshlrev_b32 v110, 3, v110
    ds_write_b64 v110, v[44:45] offset:16400

    s_waitcnt lgkmcnt(7)
    v_add_u32_sdwa v111, v111, v77 dst_sel:DWORD dst_unused:UNUSED_PAD src0_sel:WORD_1 src1_sel:WORD_0
    v_lshlrev_b32 v111, 3, v111
    ds_write_b64 v111, v[46:47] offset:16400

    s_waitcnt lgkmcnt(7)
    v_add_u32_sdwa v112, v112, v78 dst_sel:DWORD dst_unused:UNUSED_PAD src0_sel:WORD_1 src1_sel:WORD_0
    v_lshlrev_b32 v112, 3, v112
    ds_write_b64 v112, v[48:49] offset:16400

    s_waitcnt lgkmcnt(7)
    v_add_u32_sdwa v113, v113, v79 dst_sel:DWORD dst_unused:UNUSED_PAD src0_sel:WORD_1 src1_sel:WORD_0
    v_lshlrev_b32 v113, 3, v113
    ds_write_b64 v113, v[50:51] offset:16400

    s_waitcnt lgkmcnt(7)
    v_add_u32_sdwa v114, v114, v80 dst_sel:DWORD dst_unused:UNUSED_PAD src0_sel:WORD_1 src1_sel:WORD_0
    v_lshlrev_b32 v114, 3, v114
    ds_write_b64 v114, v[52:53] offset:16400

    s_waitcnt lgkmcnt(7)
    v_add_u32_sdwa v115, v115, v81 dst_sel:DWORD dst_unused:UNUSED_PAD src0_sel:WORD_1 src1_sel:WORD_0
    v_lshlrev_b32 v115, 3, v115
    ds_write_b64 v115, v[54:55] offset:16400

    s_waitcnt lgkmcnt(7)
    v_add_u32_sdwa v116, v116, v82 dst_sel:DWORD dst_unused:UNUSED_PAD src0_sel:WORD_1 src1_sel:WORD_0
    v_lshlrev_b32 v116, 3, v116
    ds_write_b64 v116, v[56:57] offset:16400

    s_waitcnt lgkmcnt(7)
    v_add_u32_sdwa v117, v117, v83 dst_sel:DWORD dst_unused:UNUSED_PAD src0_sel:WORD_1 src1_sel:WORD_0
    v_lshlrev_b32 v117, 3, v117
    ds_write_b64 v117, v[58:59] offset:16400

    buffer_load_dwordx4 v[24:27], v1, s[12:15], s57 offen nt
    buffer_load_dwordx4 v[8:11], v1, s[8:11], s57 offen nt
    buffer_load_dwordx2 v[38:39], v2, s[16:19], s62 offen nt
    v_lshrrev_b32 v110, 16, v61
    ds_read_b32 v110, v110
    v_lshrrev_b32 v111, 16, v63
    ds_read_b32 v111, v111
    v_lshrrev_b32 v112, 16, v65
    ds_read_b32 v112, v112
    v_lshrrev_b32 v113, 16, v67
    ds_read_b32 v113, v113
    s_waitcnt lgkmcnt(3)
    v_add_u32_sdwa v110, v110, v84 dst_sel:DWORD dst_unused:UNUSED_PAD src0_sel:WORD_1 src1_sel:WORD_0
    v_lshlrev_b32 v110, 3, v110
    ds_write_b64 v110, v[60:61] offset:16400

    s_waitcnt lgkmcnt(3)
    v_add_u32_sdwa v111, v111, v85 dst_sel:DWORD dst_unused:UNUSED_PAD src0_sel:WORD_1 src1_sel:WORD_0
    v_lshlrev_b32 v111, 3, v111
    ds_write_b64 v111, v[62:63] offset:16400

    s_waitcnt lgkmcnt(3)
    v_add_u32_sdwa v112, v112, v86 dst_sel:DWORD dst_unused:UNUSED_PAD src0_sel:WORD_1 src1_sel:WORD_0
    v_lshlrev_b32 v112, 3, v112
    ds_write_b64 v112, v[64:65] offset:16400

    s_waitcnt lgkmcnt(3)
    v_add_u32_sdwa v113, v113, v87 dst_sel:DWORD dst_unused:UNUSED_PAD src0_sel:WORD_1 src1_sel:WORD_0
    v_lshlrev_b32 v113, 3, v113
    ds_write_b64 v113, v[66:67] offset:16400

    s_mov_b64 exec, s[66:67]
    v_lshrrev_b32 v110, 16, v69
    ds_read_b32 v110, v110
    v_lshrrev_b32 v111, 16, v71
    ds_read_b32 v111, v111
    v_lshrrev_b32 v112, 16, v73
    ds_read_b32 v112, v112
    v_lshrrev_b32 v113, 16, v75
    ds_read_b32 v113, v113
    s_waitcnt lgkmcnt(3)
    v_add_u32_sdwa v110, v110, v88 dst_sel:DWORD dst_unused:UNUSED_PAD src0_sel:WORD_1 src1_sel:WORD_0
    v_lshlrev_b32 v110, 3, v110
    ds_write_b64 v110, v[68:69] offset:16400

    s_waitcnt lgkmcnt(3)
    v_add_u32_sdwa v111, v111, v89 dst_sel:DWORD dst_unused:UNUSED_PAD src0_sel:WORD_1 src1_sel:WORD_0
    v_lshlrev_b32 v111, 3, v111
    ds_write_b64 v111, v[70:71] offset:16400

    s_waitcnt lgkmcnt(3)
    v_add_u32_sdwa v112, v112, v90 dst_sel:DWORD dst_unused:UNUSED_PAD src0_sel:WORD_1 src1_sel:WORD_0
    v_lshlrev_b32 v112, 3, v112
    ds_write_b64 v112, v[72:73] offset:16400

    s_waitcnt lgkmcnt(3)
    v_add_u32_sdwa v113, v113, v91 dst_sel:DWORD dst_unused:UNUSED_PAD src0_sel:WORD_1 src1_sel:WORD_0
    v_lshlrev_b32 v113, 3, v113
    ds_write_b64 v113, v[74:75] offset:16400

    s_mov_b64 exec, -1
    s_add_u32 s50, s50, 16000

    buffer_load_dwordx4 v[28:31], v1, s[12:15], s58 offen nt
    buffer_load_dwordx4 v[12:15], v1, s[8:11], s58 offen nt
    buffer_load_dwordx2 v[40:41], v2, s[16:19], s63 offen nt
    buffer_load_dwordx4 v[32:35], v1, s[12:15], s59 offen nt
    buffer_load_dwordx4 v[16:19], v1, s[8:11], s59 offen nt
    buffer_load_dwordx2 v[42:43], v2, s[16:19], s64 offen nt
    s_cmp_eq_u32 s49, 0
    s_cbranch_scc1 L_p1epi_4
L_p1loop_3:
    s_waitcnt vmcnt(9)
    v_mul_hi_u32_u24 v45, s40, v20
    v_mul_hi_u32_u24 v44, s40, v4
    v_mul_hi_u32_u24 v47, s40, v21
    v_mul_hi_u32_u24 v46, s40, v5
    v_mul_hi_u32_u24 v49, s40, v22
    v_mul_hi_u32_u24 v48, s40, v6
    v_mul_hi_u32_u24 v51, s40, v23
    v_mul_hi_u32_u24 v50, s40, v7
    v_and_b32 v45, -2, v45
    v_mad_u32_u24 v4, v44, s43, v4
    v_and_b32 v76, -4, v44
    v_and_b32 v47, -2, v47
    v_mad_u32_u24 v5, v46, s43, v5
    v_and_b32 v77, -4, v46
    v_and_b32 v49, -2, v49
    v_mad_u32_u24 v6, v48, s43, v6
    v_and_b32 v78, -4, v48
    v_and_b32 v51, -2, v51
    v_mad_u32_u24 v7, v50, s43, v7
    v_and_b32 v79, -4, v50
    v_mad_i32_i24 v20, v45, s42, v20
    v_lshl_add_u32 v45, v76, 5, v45
    v_mad_i32_i24 v21, v47, s42, v21
    v_lshl_add_u32 v47, v77, 5, v47
    v_mad_i32_i24 v22, v49, s42, v22
    v_lshl_add_u32 v49, v78, 5, v49
    v_mad_i32_i24 v23, v51, s42, v23
    v_lshl_add_u32 v51, v79, 5, v51
    v_add_u32 v45, v45, v45
    ds_add_rtn_u32 v76, v45, v104
    v_add_u32 v47, v47, v47
    ds_add_rtn_u32 v77, v47, v104
    v_add_u32 v49, v49, v49
    ds_add_rtn_u32 v78, v49, v104
    v_add_u32 v51, v51, v51
    ds_add_rtn_u32 v79, v51, v104
    v_lshlrev_b32 v110, 16, v36
    v_and_b32 v111, 0xffff0000, v36
    v_lshlrev_b32 v112, 16, v37
    v_and_b32 v113, 0xffff0000, v37
    v_mul_f32 v110, s44, v110
    v_mul_f32 v111, s44, v111
    v_mul_f32 v112, s44, v112
    v_mul_f32 v113, s44, v113
    v_fract_f32 v110, v110
    v_fract_f32 v111, v111
    v_fract_f32 v112, v112
    v_fract_f32 v113, v113
    v_cos_f32 v110, v110
    v_cos_f32 v111, v111
    v_cos_f32 v112, v112
    v_cos_f32 v113, v113
    v_lshl_or_b32 v44, v44, 14, v20
    v_perm_b32 v45, v45, v4, s46
    v_bfe_u32 v4, v4, 8, 5

    v_lshl_or_b32 v46, v46, 14, v21
    v_perm_b32 v47, v47, v5, s46
    v_bfe_u32 v5, v5, 8, 5

    v_lshl_or_b32 v48, v48, 14, v22
    v_perm_b32 v49, v49, v6, s46
    v_bfe_u32 v6, v6, 8, 5

    v_lshl_or_b32 v50, v50, 14, v23
    v_perm_b32 v51, v51, v7, s46
    v_bfe_u32 v7, v7, 8, 5

    v_fmaak_f32 v110, v110, v105, 0x4b400010
    v_fmaak_f32 v111, v111, v105, 0x4b400010
    v_fmaak_f32 v112, v112, v105, 0x4b400010
    v_fmaak_f32 v113, v113, v105, 0x4b400010
    v_sub_u32 v110, v110, v4
    v_sub_u32 v111, v111, v5
    v_sub_u32 v112, v112, v6
    v_sub_u32 v113, v113, v7
    v_bfi_b32 v110, 31, v4, v110
    v_bfi_b32 v111, 31, v5, v111
    v_bfi_b32 v112, 31, v6, v112
    v_bfi_b32 v113, 31, v7, v113
    v_perm_b32 v44, v44, v110, s55
    v_perm_b32 v46, v46, v111, s55
    v_perm_b32 v48, v48, v112, s55
    v_perm_b32 v50, v50, v113, s55
    s_waitcnt vmcnt(12)
    v_add_u32 v110, v92, v96
    v_min_u32 v92, s48, v92
    v_add_u32 v111, v93, v97
    v_min_u32 v93, s48, v93
    v_max_u32 v110, v110, v111
    v_add_u32 v92, v92, v100
    v_add_u32 v93, v93, v101
    v_cmp_le_u32 vcc, s48, v110
    v_lshl_add_u32 v92, v92, 2, v92
    v_lshl_add_u32 v93, v93, 2, v93
    ds_write_b64 v2, v[92:93] offset:8192
    s_cbranch_vccz L_noov_5
    ds_write_b32 v108, v104 offset:4
L_noov_5:
    s_waitcnt lgkmcnt(0)
    s_barrier
    ds_read_b32 v110, v108 offset:4
    s_waitcnt lgkmcnt(0)
    v_readfirstlane_b32 s53, v110
    s_nop 1
    s_cmp_lg_u32 s53, 0
    s_cbranch_scc1 L_slow_6
L_sback_7:

    v_mov_b32 v96, 1
    v_lshlrev_b32 v97, 20, v0
    buffer_atomic_add v96, v97, s[36:39], 0 offen offset:128 sc0
    ds_read_b64 v[110:111], v2 offset:16400
    ds_read_b64 v[112:113], v2 offset:16408
    ds_read_b64 v[114:115], v2 offset:16392

    ds_read_b64 v[116:117], v2 offset:24592
    ds_read_b64 v[118:119], v2 offset:24600
    ds_read_b64 v[120:121], v2 offset:24584

    s_waitcnt lgkmcnt(3)
    v_lshrrev_b32 v122, 16, v111
    ds_read_b32 v122, v122 offset:8192

    s_waitcnt lgkmcnt(1)
    v_lshrrev_b32 v123, 16, v117
    ds_read_b32 v123, v123 offset:8192

    v_cmp_ne_u32_sdwa s[70:71], v111, v113 src0_sel:WORD_1 src1_sel:WORD_1
    v_cmp_ne_u32_sdwa vcc, v111, v115 src0_sel:WORD_1 src1_sel:WORD_1
    v_perm_b32 v111, v112, v111, s45
    s_mov_b32 s54, 0
    v_alignbyte_b32 v114, v115, v114, 2
    s_waitcnt lgkmcnt(1)
    v_add3_u32 v122, v122, v106, s54

    s_and_b64 exec, vcc, s[70:71]
    v_and_b32 v111, 0xff, v111
    s_andn2_b64 exec, s[70:71], vcc
    v_alignbyte_b32 v111, v111, v110, 1
    v_perm_b32 v110, v110, v114, s47
    v_subrev_u32 v122, 3, v122
    s_mov_b64 exec, -1

    buffer_store_dwordx2 v[110:111], v122, s[24:27], 0 offen
    v_cmp_ne_u32_sdwa s[70:71], v117, v119 src0_sel:WORD_1 src1_sel:WORD_1
    v_cmp_ne_u32_sdwa vcc, v117, v121 src0_sel:WORD_1 src1_sel:WORD_1
    v_perm_b32 v117, v118, v117, s45
    s_mov_b32 s54, 5120
    v_alignbyte_b32 v120, v121, v120, 2
    s_waitcnt lgkmcnt(0)
    v_add3_u32 v123, v123, v106, s54

    s_and_b64 exec, vcc, s[70:71]
    v_and_b32 v117, 0xff, v117
    s_andn2_b64 exec, s[70:71], vcc
    v_alignbyte_b32 v117, v117, v116, 1
    v_perm_b32 v116, v116, v120, s47
    v_subrev_u32 v123, 3, v123
    s_mov_b64 exec, -1

    buffer_store_dwordx2 v[116:117], v123, s[24:27], 0 offen
    ds_read_b64 v[110:111], v2 offset:32784
    ds_read_b64 v[112:113], v2 offset:32792
    ds_read_b64 v[114:115], v2 offset:32776

    ds_read_b64 v[116:117], v2 offset:40976
    ds_read_b64 v[118:119], v2 offset:40984
    ds_read_b64 v[120:121], v2 offset:40968

    s_waitcnt lgkmcnt(3)
    v_lshrrev_b32 v122, 16, v111
    ds_read_b32 v122, v122 offset:8192

    s_waitcnt lgkmcnt(1)
    v_lshrrev_b32 v123, 16, v117
    ds_read_b32 v123, v123 offset:8192

    v_cmp_ne_u32_sdwa s[70:71], v111, v113 src0_sel:WORD_1 src1_sel:WORD_1
    v_cmp_ne_u32_sdwa vcc, v111, v115 src0_sel:WORD_1 src1_sel:WORD_1
    v_perm_b32 v111, v112, v111, s45
    s_mov_b32 s54, 10240
    v_alignbyte_b32 v114, v115, v114, 2
    s_waitcnt lgkmcnt(1)
    v_add3_u32 v122, v122, v106, s54

    s_and_b64 exec, vcc, s[70:71]
    v_and_b32 v111, 0xff, v111
    s_andn2_b64 exec, s[70:71], vcc
    v_alignbyte_b32 v111, v111, v110, 1
    v_perm_b32 v110, v110, v114, s47
    v_subrev_u32 v122, 3, v122
    s_mov_b64 exec, -1

    buffer_store_dwordx2 v[110:111], v122, s[24:27], 0 offen
    v_cmp_ne_u32_sdwa s[70:71], v117, v119 src0_sel:WORD_1 src1_sel:WORD_1
    v_cmp_ne_u32_sdwa vcc, v117, v121 src0_sel:WORD_1 src1_sel:WORD_1
    v_perm_b32 v117, v118, v117, s45
    s_mov_b32 s54, 15360
    v_alignbyte_b32 v120, v121, v120, 2
    s_waitcnt lgkmcnt(0)
    v_add3_u32 v123, v123, v106, s54

    s_and_b64 exec, vcc, s[70:71]
    v_and_b32 v117, 0xff, v117
    s_andn2_b64 exec, s[70:71], vcc
    v_alignbyte_b32 v117, v117, v116, 1
    v_perm_b32 v116, v116, v120, s47
    v_subrev_u32 v123, 3, v123
    s_mov_b64 exec, -1

    buffer_store_dwordx2 v[116:117], v123, s[24:27], 0 offen
    ds_read_b64 v[110:111], v2 offset:49168
    ds_read_b64 v[112:113], v2 offset:49176
    ds_read_b64 v[114:115], v2 offset:49160

    ds_read_b64 v[116:117], v2 offset:57360
    ds_read_b64 v[118:119], v2 offset:57368
    ds_read_b64 v[120:121], v2 offset:57352

    s_waitcnt lgkmcnt(3)
    v_lshrrev_b32 v122, 16, v111
    ds_read_b32 v122, v122 offset:8192

    s_waitcnt lgkmcnt(1)
    v_lshrrev_b32 v123, 16, v117
    ds_read_b32 v123, v123 offset:8192

    v_cmp_ne_u32_sdwa s[70:71], v111, v113 src0_sel:WORD_1 src1_sel:WORD_1
    v_cmp_ne_u32_sdwa vcc, v111, v115 src0_sel:WORD_1 src1_sel:WORD_1
    v_perm_b32 v111, v112, v111, s45
    s_mov_b32 s54, 20480
    v_alignbyte_b32 v114, v115, v114, 2
    s_waitcnt lgkmcnt(1)
    v_add3_u32 v122, v122, v106, s54

    s_and_b64 exec, vcc, s[70:71]
    v_and_b32 v111, 0xff, v111
    s_andn2_b64 exec, s[70:71], vcc
    v_alignbyte_b32 v111, v111, v110, 1
    v_perm_b32 v110, v110, v114, s47
    v_subrev_u32 v122, 3, v122
    s_mov_b64 exec, -1

    buffer_store_dwordx2 v[110:111], v122, s[24:27], 0 offen
    v_cmp_ne_u32_sdwa s[70:71], v117, v119 src0_sel:WORD_1 src1_sel:WORD_1
    v_cmp_ne_u32_sdwa vcc, v117, v121 src0_sel:WORD_1 src1_sel:WORD_1
    v_perm_b32 v117, v118, v117, s45
    s_mov_b32 s54, 25600
    v_alignbyte_b32 v120, v121, v120, 2
    s_waitcnt lgkmcnt(0)
    v_add3_u32 v123, v123, v106, s54

    s_and_b64 exec, vcc, s[70:71]
    v_and_b32 v117, 0xff, v117
    s_andn2_b64 exec, s[70:71], vcc
    v_alignbyte_b32 v117, v117, v116, 1
    v_perm_b32 v116, v116, v120, s47
    v_subrev_u32 v123, 3, v123
    s_mov_b64 exec, -1

    buffer_store_dwordx2 v[116:117], v123, s[24:27], 0 offen
    s_waitcnt vmcnt(13)
    v_mul_hi_u32_u24 v53, s40, v24
    v_mul_hi_u32_u24 v52, s40, v8
    v_mul_hi_u32_u24 v55, s40, v25
    v_mul_hi_u32_u24 v54, s40, v9
    v_mul_hi_u32_u24 v57, s40, v26
    v_mul_hi_u32_u24 v56, s40, v10
    v_mul_hi_u32_u24 v59, s40, v27
    v_mul_hi_u32_u24 v58, s40, v11
    v_and_b32 v53, -2, v53
    v_mad_u32_u24 v8, v52, s43, v8
    v_and_b32 v80, -4, v52
    v_and_b32 v55, -2, v55
    v_mad_u32_u24 v9, v54, s43, v9
    v_and_b32 v81, -4, v54
    v_and_b32 v57, -2, v57
    v_mad_u32_u24 v10, v56, s43, v10
    v_and_b32 v82, -4, v56
    v_and_b32 v59, -2, v59
    v_mad_u32_u24 v11, v58, s43, v11
    v_and_b32 v83, -4, v58
    v_mad_i32_i24 v24, v53, s42, v24
    v_lshl_add_u32 v53, v80, 5, v53
    v_mad_i32_i24 v25, v55, s42, v25
    v_lshl_add_u32 v55, v81, 5, v55
    v_mad_i32_i24 v26, v57, s42, v26
    v_lshl_add_u32 v57, v82, 5, v57
    v_mad_i32_i24 v27, v59, s42, v27
    v_lshl_add_u32 v59, v83, 5, v59
    v_add_u32 v53, v53, v53
    ds_add_rtn_u32 v80, v53, v104
    v_add_u32 v55, v55, v55
    ds_add_rtn_u32 v81, v55, v104
    v_add_u32 v57, v57, v57
    ds_add_rtn_u32 v82, v57, v104
    v_add_u32 v59, v59, v59
    ds_add_rtn_u32 v83, v59, v104
    v_lshlrev_b32 v110, 16, v38
    v_and_b32 v111, 0xffff0000, v38
    v_lshlrev_b32 v112, 16, v39
    v_and_b32 v113, 0xffff0000, v39
    v_mul_f32 v110, s44, v110
    v_mul_f32 v111, s44, v111
    v_mul_f32 v112, s44, v112
    v_mul_f32 v113, s44, v113
    v_fract_f32 v110, v110
    v_fract_f32 v111, v111
    v_fract_f32 v112, v112
    v_fract_f32 v113, v113
    v_cos_f32 v110, v110
    v_cos_f32 v111, v111
    v_cos_f32 v112, v112
    v_cos_f32 v113, v113
    v_lshl_or_b32 v52, v52, 14, v24
    v_perm_b32 v53, v53, v8, s46
    v_bfe_u32 v8, v8, 8, 5

    v_lshl_or_b32 v54, v54, 14, v25
    v_perm_b32 v55, v55, v9, s46
    v_bfe_u32 v9, v9, 8, 5

    v_lshl_or_b32 v56, v56, 14, v26
    v_perm_b32 v57, v57, v10, s46
    v_bfe_u32 v10, v10, 8, 5

    v_lshl_or_b32 v58, v58, 14, v27
    v_perm_b32 v59, v59, v11, s46
    v_bfe_u32 v11, v11, 8, 5

    v_fmaak_f32 v110, v110, v105, 0x4b400010
    v_fmaak_f32 v111, v111, v105, 0x4b400010
    v_fmaak_f32 v112, v112, v105, 0x4b400010
    v_fmaak_f32 v113, v113, v105, 0x4b400010
    v_sub_u32 v110, v110, v8
    v_sub_u32 v111, v111, v9
    v_sub_u32 v112, v112, v10
    v_sub_u32 v113, v113, v11
    v_bfi_b32 v110, 31, v8, v110
    v_bfi_b32 v111, 31, v9, v111
    v_bfi_b32 v112, 31, v10, v112
    v_bfi_b32 v113, 31, v11, v113
    v_perm_b32 v52, v52, v110, s55
    v_perm_b32 v54, v54, v111, s55
    v_perm_b32 v56, v56, v112, s55
    v_perm_b32 v58, v58, v113, s55
    v_add_u32 v107, 65536, v2
    ds_read_b64 v[110:111], v107 offset:16
    ds_read_b64 v[112:113], v107 offset:24
    ds_read_b64 v[114:115], v107 offset:8

    ds_read_b64 v[116:117], v107 offset:8208
    ds_read_b64 v[118:119], v107 offset:8216
    ds_read_b64 v[120:121], v107 offset:8200

    s_waitcnt lgkmcnt(3)
    v_lshrrev_b32 v122, 16, v111
    ds_read_b32 v122, v122 offset:8192

    s_waitcnt lgkmcnt(1)
    v_lshrrev_b32 v123, 16, v117
    ds_read_b32 v123, v123 offset:8192

    v_cmp_ne_u32_sdwa s[70:71], v111, v113 src0_sel:WORD_1 src1_sel:WORD_1
    v_cmp_ne_u32_sdwa vcc, v111, v115 src0_sel:WORD_1 src1_sel:WORD_1
    v_perm_b32 v111, v112, v111, s45
    s_mov_b32 s54, 30720
    v_alignbyte_b32 v114, v115, v114, 2
    s_waitcnt lgkmcnt(1)
    v_add3_u32 v122, v122, v106, s54

    s_and_b64 exec, vcc, s[70:71]
    v_and_b32 v111, 0xff, v111
    s_andn2_b64 exec, s[70:71], vcc
    v_alignbyte_b32 v111, v111, v110, 1
    v_perm_b32 v110, v110, v114, s47
    v_subrev_u32 v122, 3, v122
    s_mov_b64 exec, -1

    buffer_store_dwordx2 v[110:111], v122, s[24:27], 0 offen
    v_cmp_ne_u32_sdwa s[70:71], v117, v119 src0_sel:WORD_1 src1_sel:WORD_1
    v_cmp_ne_u32_sdwa vcc, v117, v121 src0_sel:WORD_1 src1_sel:WORD_1
    v_perm_b32 v117, v118, v117, s45
    s_mov_b32 s54, 35840
    v_alignbyte_b32 v120, v121, v120, 2
    s_waitcnt lgkmcnt(0)
    v_add3_u32 v123, v123, v106, s54

    s_and_b64 exec, vcc, s[70:71]
    v_and_b32 v117, 0xff, v117
    s_andn2_b64 exec, s[70:71], vcc
    v_alignbyte_b32 v117, v117, v116, 1
    v_perm_b32 v116, v116, v120, s47
    v_subrev_u32 v123, 3, v123
    s_mov_b64 exec, -1

    buffer_store_dwordx2 v[116:117], v123, s[24:27], 0 offen
    ds_read_b64 v[110:111], v107 offset:16400
    ds_read_b64 v[112:113], v107 offset:16408
    ds_read_b64 v[114:115], v107 offset:16392

    ds_read_b64 v[116:117], v107 offset:24592
    ds_read_b64 v[118:119], v107 offset:24600
    ds_read_b64 v[120:121], v107 offset:24584

    s_waitcnt lgkmcnt(3)
    v_lshrrev_b32 v122, 16, v111
    ds_read_b32 v122, v122 offset:8192

    s_waitcnt lgkmcnt(1)
    v_lshrrev_b32 v123, 16, v117
    ds_read_b32 v123, v123 offset:8192

    v_cmp_ne_u32_sdwa s[70:71], v111, v113 src0_sel:WORD_1 src1_sel:WORD_1
    v_cmp_ne_u32_sdwa vcc, v111, v115 src0_sel:WORD_1 src1_sel:WORD_1
    v_perm_b32 v111, v112, v111, s45
    s_mov_b32 s54, 40960
    v_alignbyte_b32 v114, v115, v114, 2
    s_waitcnt lgkmcnt(1)
    v_add3_u32 v122, v122, v106, s54

    s_and_b64 exec, vcc, s[70:71]
    v_and_b32 v111, 0xff, v111
    s_andn2_b64 exec, s[70:71], vcc
    v_alignbyte_b32 v111, v111, v110, 1
    v_perm_b32 v110, v110, v114, s47
    v_subrev_u32 v122, 3, v122
    s_mov_b64 exec, -1

    buffer_store_dwordx2 v[110:111], v122, s[24:27], 0 offen
    v_cmp_ne_u32_sdwa s[70:71], v117, v119 src0_sel:WORD_1 src1_sel:WORD_1
    v_cmp_ne_u32_sdwa vcc, v117, v121 src0_sel:WORD_1 src1_sel:WORD_1
    v_perm_b32 v117, v118, v117, s45
    s_mov_b32 s54, 46080
    v_alignbyte_b32 v120, v121, v120, 2
    s_waitcnt lgkmcnt(0)
    v_add3_u32 v123, v123, v106, s54

    s_and_b64 exec, vcc, s[70:71]
    v_and_b32 v117, 0xff, v117
    s_andn2_b64 exec, s[70:71], vcc
    v_alignbyte_b32 v117, v117, v116, 1
    v_perm_b32 v116, v116, v120, s47
    v_subrev_u32 v123, 3, v123
    s_mov_b64 exec, -1

    buffer_store_dwordx2 v[116:117], v123, s[24:27], 0 offen
    s_waitcnt vmcnt(14)
    v_mul_hi_u32_u24 v61, s40, v28
    v_mul_hi_u32_u24 v60, s40, v12
    v_mul_hi_u32_u24 v63, s40, v29
    v_mul_hi_u32_u24 v62, s40, v13
    v_mul_hi_u32_u24 v65, s40, v30
    v_mul_hi_u32_u24 v64, s40, v14
    v_mul_hi_u32_u24 v67, s40, v31
    v_mul_hi_u32_u24 v66, s40, v15
    v_and_b32 v61, -2, v61
    v_mad_u32_u24 v12, v60, s43, v12
    v_and_b32 v84, -4, v60
    v_and_b32 v63, -2, v63
    v_mad_u32_u24 v13, v62, s43, v13
    v_and_b32 v85, -4, v62
    v_and_b32 v65, -2, v65
    v_mad_u32_u24 v14, v64, s43, v14
    v_and_b32 v86, -4, v64
    v_and_b32 v67, -2, v67
    v_mad_u32_u24 v15, v66, s43, v15
    v_and_b32 v87, -4, v66
    v_mad_i32_i24 v28, v61, s42, v28
    v_lshl_add_u32 v61, v84, 5, v61
    v_mad_i32_i24 v29, v63, s42, v29
    v_lshl_add_u32 v63, v85, 5, v63
    v_mad_i32_i24 v30, v65, s42, v30
    v_lshl_add_u32 v65, v86, 5, v65
    v_mad_i32_i24 v31, v67, s42, v31
    v_lshl_add_u32 v67, v87, 5, v67
    v_add_u32 v61, v61, v61
    ds_add_rtn_u32 v84, v61, v104
    v_add_u32 v63, v63, v63
    ds_add_rtn_u32 v85, v63, v104
    v_add_u32 v65, v65, v65
    ds_add_rtn_u32 v86, v65, v104
    v_add_u32 v67, v67, v67
    ds_add_rtn_u32 v87, v67, v104
    v_lshlrev_b32 v110, 16, v40
    v_and_b32 v111, 0xffff0000, v40
    v_lshlrev_b32 v112, 16, v41
    v_and_b32 v113, 0xffff0000, v41
    v_mul_f32 v110, s44, v110
    v_mul_f32 v111, s44, v111
    v_mul_f32 v112, s44, v112
    v_mul_f32 v113, s44, v113
    v_fract_f32 v110, v110
    v_fract_f32 v111, v111
    v_fract_f32 v112, v112
    v_fract_f32 v113, v113
    v_cos_f32 v110, v110
    v_cos_f32 v111, v111
    v_cos_f32 v112, v112
    v_cos_f32 v113, v113
    v_lshl_or_b32 v60, v60, 14, v28
    v_perm_b32 v61, v61, v12, s46
    v_bfe_u32 v12, v12, 8, 5

    v_lshl_or_b32 v62, v62, 14, v29
    v_perm_b32 v63, v63, v13, s46
    v_bfe_u32 v13, v13, 8, 5

    v_lshl_or_b32 v64, v64, 14, v30
    v_perm_b32 v65, v65, v14, s46
    v_bfe_u32 v14, v14, 8, 5

    v_lshl_or_b32 v66, v66, 14, v31
    v_perm_b32 v67, v67, v15, s46
    v_bfe_u32 v15, v15, 8, 5

    v_fmaak_f32 v110, v110, v105, 0x4b400010
    v_fmaak_f32 v111, v111, v105, 0x4b400010
    v_fmaak_f32 v112, v112, v105, 0x4b400010
    v_fmaak_f32 v113, v113, v105, 0x4b400010
    v_sub_u32 v110, v110, v12
    v_sub_u32 v111, v111, v13
    v_sub_u32 v112, v112, v14
    v_sub_u32 v113, v113, v15
    v_bfi_b32 v110, 31, v12, v110
    v_bfi_b32 v111, 31, v13, v111
    v_bfi_b32 v112, 31, v14, v112
    v_bfi_b32 v113, 31, v15, v113
    v_perm_b32 v60, v60, v110, s55
    v_perm_b32 v62, v62, v111, s55
    v_perm_b32 v64, v64, v112, s55
    v_perm_b32 v66, v66, v113, s55
    ds_read_b64 v[110:111], v107 offset:32784
    ds_read_b64 v[112:113], v107 offset:32792
    ds_read_b64 v[114:115], v107 offset:32776

    ds_read_b64 v[116:117], v107 offset:40976
    ds_read_b64 v[118:119], v107 offset:40984
    ds_read_b64 v[120:121], v107 offset:40968

    s_waitcnt lgkmcnt(3)
    v_lshrrev_b32 v122, 16, v111
    ds_read_b32 v122, v122 offset:8192

    s_waitcnt lgkmcnt(1)
    v_lshrrev_b32 v123, 16, v117
    ds_read_b32 v123, v123 offset:8192

    v_cmp_ne_u32_sdwa s[70:71], v111, v113 src0_sel:WORD_1 src1_sel:WORD_1
    v_cmp_ne_u32_sdwa vcc, v111, v115 src0_sel:WORD_1 src1_sel:WORD_1
    v_perm_b32 v111, v112, v111, s45
    s_mov_b32 s54, 51200
    v_alignbyte_b32 v114, v115, v114, 2
    s_waitcnt lgkmcnt(1)
    v_add3_u32 v122, v122, v106, s54

    s_and_b64 exec, vcc, s[70:71]
    v_and_b32 v111, 0xff, v111
    s_andn2_b64 exec, s[70:71], vcc
    v_alignbyte_b32 v111, v111, v110, 1
    v_perm_b32 v110, v110, v114, s47
    v_subrev_u32 v122, 3, v122
    s_mov_b64 exec, -1

    buffer_store_dwordx2 v[110:111], v122, s[24:27], 0 offen
    v_cmp_ne_u32_sdwa s[70:71], v117, v119 src0_sel:WORD_1 src1_sel:WORD_1
    v_cmp_ne_u32_sdwa vcc, v117, v121 src0_sel:WORD_1 src1_sel:WORD_1
    v_perm_b32 v117, v118, v117, s45
    s_mov_b32 s54, 56320
    v_alignbyte_b32 v120, v121, v120, 2
    s_waitcnt lgkmcnt(0)
    v_add3_u32 v123, v123, v106, s54

    s_and_b64 exec, vcc, s[70:71]
    v_and_b32 v117, 0xff, v117
    s_andn2_b64 exec, s[70:71], vcc
    v_alignbyte_b32 v117, v117, v116, 1
    v_perm_b32 v116, v116, v120, s47
    v_subrev_u32 v123, 3, v123
    s_mov_b64 exec, -1

    buffer_store_dwordx2 v[116:117], v123, s[24:27], 0 offen
    ds_read_b64 v[110:111], v107 offset:49168
    ds_read_b64 v[112:113], v107 offset:49176
    ds_read_b64 v[114:115], v107 offset:49160

    ds_read_b64 v[116:117], v107 offset:57360
    ds_read_b64 v[118:119], v107 offset:57368
    ds_read_b64 v[120:121], v107 offset:57352

    s_waitcnt lgkmcnt(3)
    v_lshrrev_b32 v122, 16, v111
    ds_read_b32 v122, v122 offset:8192

    s_waitcnt lgkmcnt(1)
    v_lshrrev_b32 v123, 16, v117
    ds_read_b32 v123, v123 offset:8192

    v_cmp_ne_u32_sdwa s[70:71], v111, v113 src0_sel:WORD_1 src1_sel:WORD_1
    v_cmp_ne_u32_sdwa vcc, v111, v115 src0_sel:WORD_1 src1_sel:WORD_1
    v_perm_b32 v111, v112, v111, s45
    s_mov_b32 s54, 61440
    v_alignbyte_b32 v114, v115, v114, 2
    s_waitcnt lgkmcnt(1)
    v_add3_u32 v122, v122, v106, s54

    s_and_b64 exec, vcc, s[70:71]
    v_and_b32 v111, 0xff, v111
    s_andn2_b64 exec, s[70:71], vcc
    v_alignbyte_b32 v111, v111, v110, 1
    v_perm_b32 v110, v110, v114, s47
    v_subrev_u32 v122, 3, v122
    s_mov_b64 exec, -1

    buffer_store_dwordx2 v[110:111], v122, s[24:27], 0 offen
    v_cmp_ne_u32_sdwa s[70:71], v117, v119 src0_sel:WORD_1 src1_sel:WORD_1
    v_cmp_ne_u32_sdwa vcc, v117, v121 src0_sel:WORD_1 src1_sel:WORD_1
    v_perm_b32 v117, v118, v117, s45
    s_mov_b32 s54, 66560
    v_alignbyte_b32 v120, v121, v120, 2
    s_waitcnt lgkmcnt(0)
    v_add3_u32 v123, v123, v106, s54

    s_and_b64 exec, vcc, s[70:71]
    v_and_b32 v117, 0xff, v117
    s_andn2_b64 exec, s[70:71], vcc
    v_alignbyte_b32 v117, v117, v116, 1
    v_perm_b32 v116, v116, v120, s47
    v_subrev_u32 v123, 3, v123
    s_mov_b64 exec, -1

    buffer_store_dwordx2 v[116:117], v123, s[24:27], 0 offen
    s_waitcnt vmcnt(15)
    s_mov_b64 exec, s[66:67]
    v_mul_hi_u32_u24 v69, s40, v32
    v_mul_hi_u32_u24 v68, s40, v16
    v_mul_hi_u32_u24 v71, s40, v33
    v_mul_hi_u32_u24 v70, s40, v17
    v_mul_hi_u32_u24 v73, s40, v34
    v_mul_hi_u32_u24 v72, s40, v18
    v_mul_hi_u32_u24 v75, s40, v35
    v_mul_hi_u32_u24 v74, s40, v19
    v_and_b32 v69, -2, v69
    v_mad_u32_u24 v16, v68, s43, v16
    v_and_b32 v88, -4, v68
    v_and_b32 v71, -2, v71
    v_mad_u32_u24 v17, v70, s43, v17
    v_and_b32 v89, -4, v70
    v_and_b32 v73, -2, v73
    v_mad_u32_u24 v18, v72, s43, v18
    v_and_b32 v90, -4, v72
    v_and_b32 v75, -2, v75
    v_mad_u32_u24 v19, v74, s43, v19
    v_and_b32 v91, -4, v74
    v_mad_i32_i24 v32, v69, s42, v32
    v_lshl_add_u32 v69, v88, 5, v69
    v_mad_i32_i24 v33, v71, s42, v33
    v_lshl_add_u32 v71, v89, 5, v71
    v_mad_i32_i24 v34, v73, s42, v34
    v_lshl_add_u32 v73, v90, 5, v73
    v_mad_i32_i24 v35, v75, s42, v35
    v_lshl_add_u32 v75, v91, 5, v75
    v_add_u32 v69, v69, v69
    ds_add_rtn_u32 v88, v69, v104
    v_add_u32 v71, v71, v71
    ds_add_rtn_u32 v89, v71, v104
    v_add_u32 v73, v73, v73
    ds_add_rtn_u32 v90, v73, v104
    v_add_u32 v75, v75, v75
    ds_add_rtn_u32 v91, v75, v104
    v_lshlrev_b32 v110, 16, v42
    v_and_b32 v111, 0xffff0000, v42
    v_lshlrev_b32 v112, 16, v43
    v_and_b32 v113, 0xffff0000, v43
    v_mul_f32 v110, s44, v110
    v_mul_f32 v111, s44, v111
    v_mul_f32 v112, s44, v112
    v_mul_f32 v113, s44, v113
    v_fract_f32 v110, v110
    v_fract_f32 v111, v111
    v_fract_f32 v112, v112
    v_fract_f32 v113, v113
    v_cos_f32 v110, v110
    v_cos_f32 v111, v111
    v_cos_f32 v112, v112
    v_cos_f32 v113, v113
    v_lshl_or_b32 v68, v68, 14, v32
    v_perm_b32 v69, v69, v16, s46
    v_bfe_u32 v16, v16, 8, 5

    v_lshl_or_b32 v70, v70, 14, v33
    v_perm_b32 v71, v71, v17, s46
    v_bfe_u32 v17, v17, 8, 5

    v_lshl_or_b32 v72, v72, 14, v34
    v_perm_b32 v73, v73, v18, s46
    v_bfe_u32 v18, v18, 8, 5

    v_lshl_or_b32 v74, v74, 14, v35
    v_perm_b32 v75, v75, v19, s46
    v_bfe_u32 v19, v19, 8, 5

    v_fmaak_f32 v110, v110, v105, 0x4b400010
    v_fmaak_f32 v111, v111, v105, 0x4b400010
    v_fmaak_f32 v112, v112, v105, 0x4b400010
    v_fmaak_f32 v113, v113, v105, 0x4b400010
    v_sub_u32 v110, v110, v16
    v_sub_u32 v111, v111, v17
    v_sub_u32 v112, v112, v18
    v_sub_u32 v113, v113, v19
    v_bfi_b32 v110, 31, v16, v110
    v_bfi_b32 v111, 31, v17, v111
    v_bfi_b32 v112, 31, v18, v112
    v_bfi_b32 v113, 31, v19, v113
    v_perm_b32 v68, v68, v110, s55
    v_perm_b32 v70, v70, v111, s55
    v_perm_b32 v72, v72, v112, s55
    v_perm_b32 v74, v74, v113, s55
    s_mov_b64 exec, -1
    v_cmp_eq_u32 vcc, 0, v0
    s_waitcnt vmcnt(14)
    s_mov_b64 exec, vcc
    ds_write_b32 v108, v96 offset:8
    s_mov_b64 exec, -1
    s_waitcnt lgkmcnt(0)
    s_barrier

    ds_read_b32 v110, v108 offset:8
    ds_read_b64 v[96:97], v2
    s_waitcnt lgkmcnt(0)

    v_readfirstlane_b32 s41, v110
    v_and_b32 v96, 0xffff, v96
    v_and_b32 v97, 0xffff, v97
    v_add_u32 v92, v96, v96
    v_add_u32 v93, v97, v97
    v_add_u32 v101, v96, v97
    v_med3_u32 v92, v96, 2, v92
    v_med3_u32 v93, v97, 2, v93
    buffer_atomic_add_x2 v[92:93], v2, s[20:23], 0 offen sc0
    s_nop 1
    v_add_u32_dpp v101, v101, v101 row_shr:1 row_mask:0xf bank_mask:0xf
    s_nop 1
    v_add_u32_dpp v101, v101, v101 row_shr:2 row_mask:0xf bank_mask:0xf
    s_nop 1
    v_add_u32_dpp v101, v101, v101 row_shr:4 row_mask:0xf bank_mask:0xf
    s_nop 1
    v_add_u32_dpp v101, v101, v101 row_shr:8 row_mask:0xf bank_mask:0xf
    s_nop 1
    v_add_u32_dpp v101, v101, v101 row_bcast:15 row_mask:0xa bank_mask:0xf
    s_nop 1
    v_add_u32_dpp v101, v101, v101 row_bcast:31 row_mask:0xc bank_mask:0xf
    s_mov_b32 exec_lo, 0
    s_brev_b32 exec_hi, 1
    ds_add_rtn_u32 v100, v108, v101
    s_mov_b64 exec, -1

    s_add_u32 s41, s41, 256
    s_mul_i32 s78, s41, 16000
    s_add_u32 s49, s78, 16000
    s_cmp_ge_u32 s41, 3200
    s_cmovk_i32 s49, 0
    s_cmovk_i32 s78, 0
    s_lshl_b32 s10, s49, 2
    s_lshl_b32 s14, s49, 2
    s_lshl_b32 s18, s49, 1
    s_lshl_b32 s56, s78, 2
    s_lshl_b32 s61, s78, 1

    s_add_u32 s57, s56, 16384
    s_add_u32 s62, s61, 8192
    s_add_u32 s58, s56, 32768
    s_add_u32 s63, s61, 16384
    s_add_u32 s59, s56, 49152
    s_add_u32 s64, s61, 24576
    buffer_load_dwordx4 v[20:23], v1, s[12:15], s56 offen nt
    buffer_load_dwordx4 v[4:7], v1, s[8:11], s56 offen nt
    buffer_load_dwordx2 v[36:37], v2, s[16:19], s61 offen nt
    v_add_u32 v107, 131072, v2
    ds_read_b64 v[110:111], v107 offset:16
    ds_read_b64 v[112:113], v107 offset:24
    ds_read_b64 v[114:115], v107 offset:8

    ds_read_b64 v[116:117], v107 offset:8208
    ds_read_b64 v[118:119], v107 offset:8216
    ds_read_b64 v[120:121], v107 offset:8200

    s_waitcnt lgkmcnt(3)
    v_lshrrev_b32 v122, 16, v111
    ds_read_b32 v122, v122 offset:8192

    s_waitcnt lgkmcnt(1)
    v_lshrrev_b32 v123, 16, v117
    ds_read_b32 v123, v123 offset:8192

    v_cmp_ne_u32_sdwa s[70:71], v111, v113 src0_sel:WORD_1 src1_sel:WORD_1
    v_cmp_ne_u32_sdwa vcc, v111, v115 src0_sel:WORD_1 src1_sel:WORD_1
    v_perm_b32 v111, v112, v111, s45
    s_mov_b32 s54, 71680
    v_alignbyte_b32 v114, v115, v114, 2
    s_waitcnt lgkmcnt(1)
    v_add3_u32 v122, v122, v106, s54

    s_and_b64 exec, vcc, s[70:71]
    v_and_b32 v111, 0xff, v111
    s_andn2_b64 exec, s[70:71], vcc
    v_alignbyte_b32 v111, v111, v110, 1
    v_perm_b32 v110, v110, v114, s47
    v_subrev_u32 v122, 3, v122
    s_mov_b64 exec, -1

    buffer_store_dwordx2 v[110:111], v122, s[24:27], 0 offen
    v_cmp_ne_u32_sdwa s[70:71], v117, v119 src0_sel:WORD_1 src1_sel:WORD_1
    v_cmp_ne_u32_sdwa vcc, v117, v121 src0_sel:WORD_1 src1_sel:WORD_1
    v_perm_b32 v117, v118, v117, s45
    s_mov_b32 s54, 76800
    v_alignbyte_b32 v120, v121, v120, 2
    s_waitcnt lgkmcnt(0)
    v_add3_u32 v123, v123, v106, s54

    s_andn2_b64 exec, -1, s[68:69]
    v_bfrev_b32 v123, 1

    s_and_b64 exec, vcc, s[70:71]
    v_and_b32 v117, 0xff, v117
    s_andn2_b64 exec, s[70:71], vcc
    v_alignbyte_b32 v117, v117, v116, 1
    v_perm_b32 v116, v116, v120, s47
    v_subrev_u32 v123, 3, v123
    s_mov_b64 exec, -1

    buffer_store_dwordx2 v[116:117], v123, s[24:27], 0 offen
    s_waitcnt lgkmcnt(0)
    v_readlane_b32 s77, v100, 63
    v_mul_u32_u24 v114, 7936, v0
    v_sub_u32 v101, v101, v97
    s_sub_u32 s77, s77, s50
    v_add_u32 v101, s77, v101
    v_sub_u32 v100, v101, v96
    v_lshlrev_b32 v111, 16, v101
    v_lshlrev_b32 v110, 16, v100
    ds_write_b64 v2, v[110:111]
    v_sub_u32 v100, v114, v100
    v_sub_u32 v101, v114, v101
    v_add_u32 v101, s48, v101

    s_waitcnt lgkmcnt(0)
    s_barrier

    v_lshrrev_b32 v110, 16, v45
    ds_read_b32 v110, v110
    v_lshrrev_b32 v111, 16, v47
    ds_read_b32 v111, v111
    v_lshrrev_b32 v112, 16, v49
    ds_read_b32 v112, v112
    v_lshrrev_b32 v113, 16, v51
    ds_read_b32 v113, v113
    v_lshrrev_b32 v114, 16, v53
    ds_read_b32 v114, v114
    v_lshrrev_b32 v115, 16, v55
    ds_read_b32 v115, v115
    v_lshrrev_b32 v116, 16, v57
    ds_read_b32 v116, v116
    v_lshrrev_b32 v117, 16, v59
    ds_read_b32 v117, v117
    s_waitcnt lgkmcnt(7)
    v_add_u32_sdwa v110, v110, v76 dst_sel:DWORD dst_unused:UNUSED_PAD src0_sel:WORD_1 src1_sel:WORD_0
    v_lshlrev_b32 v110, 3, v110
    ds_write_b64 v110, v[44:45] offset:16400

    s_waitcnt lgkmcnt(7)
    v_add_u32_sdwa v111, v111, v77 dst_sel:DWORD dst_unused:UNUSED_PAD src0_sel:WORD_1 src1_sel:WORD_0
    v_lshlrev_b32 v111, 3, v111
    ds_write_b64 v111, v[46:47] offset:16400

    s_waitcnt lgkmcnt(7)
    v_add_u32_sdwa v112, v112, v78 dst_sel:DWORD dst_unused:UNUSED_PAD src0_sel:WORD_1 src1_sel:WORD_0
    v_lshlrev_b32 v112, 3, v112
    ds_write_b64 v112, v[48:49] offset:16400

    s_waitcnt lgkmcnt(7)
    v_add_u32_sdwa v113, v113, v79 dst_sel:DWORD dst_unused:UNUSED_PAD src0_sel:WORD_1 src1_sel:WORD_0
    v_lshlrev_b32 v113, 3, v113
    ds_write_b64 v113, v[50:51] offset:16400

    s_waitcnt lgkmcnt(7)
    v_add_u32_sdwa v114, v114, v80 dst_sel:DWORD dst_unused:UNUSED_PAD src0_sel:WORD_1 src1_sel:WORD_0
    v_lshlrev_b32 v114, 3, v114
    ds_write_b64 v114, v[52:53] offset:16400

    s_waitcnt lgkmcnt(7)
    v_add_u32_sdwa v115, v115, v81 dst_sel:DWORD dst_unused:UNUSED_PAD src0_sel:WORD_1 src1_sel:WORD_0
    v_lshlrev_b32 v115, 3, v115
    ds_write_b64 v115, v[54:55] offset:16400

    s_waitcnt lgkmcnt(7)
    v_add_u32_sdwa v116, v116, v82 dst_sel:DWORD dst_unused:UNUSED_PAD src0_sel:WORD_1 src1_sel:WORD_0
    v_lshlrev_b32 v116, 3, v116
    ds_write_b64 v116, v[56:57] offset:16400

    s_waitcnt lgkmcnt(7)
    v_add_u32_sdwa v117, v117, v83 dst_sel:DWORD dst_unused:UNUSED_PAD src0_sel:WORD_1 src1_sel:WORD_0
    v_lshlrev_b32 v117, 3, v117
    ds_write_b64 v117, v[58:59] offset:16400

    buffer_load_dwordx4 v[24:27], v1, s[12:15], s57 offen nt
    buffer_load_dwordx4 v[8:11], v1, s[8:11], s57 offen nt
    buffer_load_dwordx2 v[38:39], v2, s[16:19], s62 offen nt
    v_lshrrev_b32 v110, 16, v61
    ds_read_b32 v110, v110
    v_lshrrev_b32 v111, 16, v63
    ds_read_b32 v111, v111
    v_lshrrev_b32 v112, 16, v65
    ds_read_b32 v112, v112
    v_lshrrev_b32 v113, 16, v67
    ds_read_b32 v113, v113
    s_waitcnt lgkmcnt(3)
    v_add_u32_sdwa v110, v110, v84 dst_sel:DWORD dst_unused:UNUSED_PAD src0_sel:WORD_1 src1_sel:WORD_0
    v_lshlrev_b32 v110, 3, v110
    ds_write_b64 v110, v[60:61] offset:16400

    s_waitcnt lgkmcnt(3)
    v_add_u32_sdwa v111, v111, v85 dst_sel:DWORD dst_unused:UNUSED_PAD src0_sel:WORD_1 src1_sel:WORD_0
    v_lshlrev_b32 v111, 3, v111
    ds_write_b64 v111, v[62:63] offset:16400

    s_waitcnt lgkmcnt(3)
    v_add_u32_sdwa v112, v112, v86 dst_sel:DWORD dst_unused:UNUSED_PAD src0_sel:WORD_1 src1_sel:WORD_0
    v_lshlrev_b32 v112, 3, v112
    ds_write_b64 v112, v[64:65] offset:16400

    s_waitcnt lgkmcnt(3)
    v_add_u32_sdwa v113, v113, v87 dst_sel:DWORD dst_unused:UNUSED_PAD src0_sel:WORD_1 src1_sel:WORD_0
    v_lshlrev_b32 v113, 3, v113
    ds_write_b64 v113, v[66:67] offset:16400

    s_mov_b64 exec, s[66:67]
    v_lshrrev_b32 v110, 16, v69
    ds_read_b32 v110, v110
    v_lshrrev_b32 v111, 16, v71
    ds_read_b32 v111, v111
    v_lshrrev_b32 v112, 16, v73
    ds_read_b32 v112, v112
    v_lshrrev_b32 v113, 16, v75
    ds_read_b32 v113, v113
    s_waitcnt lgkmcnt(3)
    v_add_u32_sdwa v110, v110, v88 dst_sel:DWORD dst_unused:UNUSED_PAD src0_sel:WORD_1 src1_sel:WORD_0
    v_lshlrev_b32 v110, 3, v110
    ds_write_b64 v110, v[68:69] offset:16400

    s_waitcnt lgkmcnt(3)
    v_add_u32_sdwa v111, v111, v89 dst_sel:DWORD dst_unused:UNUSED_PAD src0_sel:WORD_1 src1_sel:WORD_0
    v_lshlrev_b32 v111, 3, v111
    ds_write_b64 v111, v[70:71] offset:16400

    s_waitcnt lgkmcnt(3)
    v_add_u32_sdwa v112, v112, v90 dst_sel:DWORD dst_unused:UNUSED_PAD src0_sel:WORD_1 src1_sel:WORD_0
    v_lshlrev_b32 v112, 3, v112
    ds_write_b64 v112, v[72:73] offset:16400

    s_waitcnt lgkmcnt(3)
    v_add_u32_sdwa v113, v113, v91 dst_sel:DWORD dst_unused:UNUSED_PAD src0_sel:WORD_1 src1_sel:WORD_0
    v_lshlrev_b32 v113, 3, v113
    ds_write_b64 v113, v[74:75] offset:16400

    s_mov_b64 exec, -1
    s_add_u32 s50, s50, 16000

    buffer_load_dwordx4 v[28:31], v1, s[12:15], s58 offen nt
    buffer_load_dwordx4 v[12:15], v1, s[8:11], s58 offen nt
    buffer_load_dwordx2 v[40:41], v2, s[16:19], s63 offen nt
    buffer_load_dwordx4 v[32:35], v1, s[12:15], s59 offen nt
    buffer_load_dwordx4 v[16:19], v1, s[8:11], s59 offen nt
    buffer_load_dwordx2 v[42:43], v2, s[16:19], s64 offen nt
    s_cmp_lg_u32 s49, 0
    s_cbranch_scc1 L_p1loop_3
L_p1epi_4:
    s_waitcnt vmcnt(12)
    v_add_u32 v110, v92, v96
    v_min_u32 v92, s48, v92
    v_add_u32 v111, v93, v97
    v_min_u32 v93, s48, v93
    v_max_u32 v110, v110, v111
    v_add_u32 v92, v92, v100
    v_add_u32 v93, v93, v101
    v_cmp_le_u32 vcc, s48, v110
    v_lshl_add_u32 v92, v92, 2, v92
    v_lshl_add_u32 v93, v93, 2, v93
    ds_write_b64 v2, v[92:93] offset:8192
    s_cbranch_vccz L_noov_11
    ds_write_b32 v108, v104 offset:4
L_noov_11:
    s_waitcnt lgkmcnt(0)
    s_barrier
    ds_read_b32 v110, v108 offset:4
    s_waitcnt lgkmcnt(0)
    v_readfirstlane_b32 s53, v110
    s_nop 1
    s_cmp_lg_u32 s53, 0
    s_cbranch_scc1 L_slow_12
L_sback_13:

    ds_read_b64 v[110:111], v2 offset:16400
    ds_read_b64 v[112:113], v2 offset:16408
    ds_read_b64 v[114:115], v2 offset:16392

    ds_read_b64 v[116:117], v2 offset:24592
    ds_read_b64 v[118:119], v2 offset:24600
    ds_read_b64 v[120:121], v2 offset:24584

    s_waitcnt lgkmcnt(3)
    v_lshrrev_b32 v122, 16, v111
    ds_read_b32 v122, v122 offset:8192

    s_waitcnt lgkmcnt(1)
    v_lshrrev_b32 v123, 16, v117
    ds_read_b32 v123, v123 offset:8192

    v_cmp_ne_u32_sdwa s[70:71], v111, v113 src0_sel:WORD_1 src1_sel:WORD_1
    v_cmp_ne_u32_sdwa vcc, v111, v115 src0_sel:WORD_1 src1_sel:WORD_1
    v_perm_b32 v111, v112, v111, s45
    s_mov_b32 s54, 0
    v_alignbyte_b32 v114, v115, v114, 2
    s_waitcnt lgkmcnt(1)
    v_add3_u32 v122, v122, v106, s54

    s_and_b64 exec, vcc, s[70:71]
    v_and_b32 v111, 0xff, v111
    s_andn2_b64 exec, s[70:71], vcc
    v_alignbyte_b32 v111, v111, v110, 1
    v_perm_b32 v110, v110, v114, s47
    v_subrev_u32 v122, 3, v122
    s_mov_b64 exec, -1

    buffer_store_dwordx2 v[110:111], v122, s[24:27], 0 offen
    v_cmp_ne_u32_sdwa s[70:71], v117, v119 src0_sel:WORD_1 src1_sel:WORD_1
    v_cmp_ne_u32_sdwa vcc, v117, v121 src0_sel:WORD_1 src1_sel:WORD_1
    v_perm_b32 v117, v118, v117, s45
    s_mov_b32 s54, 5120
    v_alignbyte_b32 v120, v121, v120, 2
    s_waitcnt lgkmcnt(0)
    v_add3_u32 v123, v123, v106, s54

    s_and_b64 exec, vcc, s[70:71]
    v_and_b32 v117, 0xff, v117
    s_andn2_b64 exec, s[70:71], vcc
    v_alignbyte_b32 v117, v117, v116, 1
    v_perm_b32 v116, v116, v120, s47
    v_subrev_u32 v123, 3, v123
    s_mov_b64 exec, -1

    buffer_store_dwordx2 v[116:117], v123, s[24:27], 0 offen
    ds_read_b64 v[110:111], v2 offset:32784
    ds_read_b64 v[112:113], v2 offset:32792
    ds_read_b64 v[114:115], v2 offset:32776

    ds_read_b64 v[116:117], v2 offset:40976
    ds_read_b64 v[118:119], v2 offset:40984
    ds_read_b64 v[120:121], v2 offset:40968

    s_waitcnt lgkmcnt(3)
    v_lshrrev_b32 v122, 16, v111
    ds_read_b32 v122, v122 offset:8192

    s_waitcnt lgkmcnt(1)
    v_lshrrev_b32 v123, 16, v117
    ds_read_b32 v123, v123 offset:8192

    v_cmp_ne_u32_sdwa s[70:71], v111, v113 src0_sel:WORD_1 src1_sel:WORD_1
    v_cmp_ne_u32_sdwa vcc, v111, v115 src0_sel:WORD_1 src1_sel:WORD_1
    v_perm_b32 v111, v112, v111, s45
    s_mov_b32 s54, 10240
    v_alignbyte_b32 v114, v115, v114, 2
    s_waitcnt lgkmcnt(1)
    v_add3_u32 v122, v122, v106, s54

    s_and_b64 exec, vcc, s[70:71]
    v_and_b32 v111, 0xff, v111
    s_andn2_b64 exec, s[70:71], vcc
    v_alignbyte_b32 v111, v111, v110, 1
    v_perm_b32 v110, v110, v114, s47
    v_subrev_u32 v122, 3, v122
    s_mov_b64 exec, -1

    buffer_store_dwordx2 v[110:111], v122, s[24:27], 0 offen
    v_cmp_ne_u32_sdwa s[70:71], v117, v119 src0_sel:WORD_1 src1_sel:WORD_1
    v_cmp_ne_u32_sdwa vcc, v117, v121 src0_sel:WORD_1 src1_sel:WORD_1
    v_perm_b32 v117, v118, v117, s45
    s_mov_b32 s54, 15360
    v_alignbyte_b32 v120, v121, v120, 2
    s_waitcnt lgkmcnt(0)
    v_add3_u32 v123, v123, v106, s54

    s_and_b64 exec, vcc, s[70:71]
    v_and_b32 v117, 0xff, v117
    s_andn2_b64 exec, s[70:71], vcc
    v_alignbyte_b32 v117, v117, v116, 1
    v_perm_b32 v116, v116, v120, s47
    v_subrev_u32 v123, 3, v123
    s_mov_b64 exec, -1

    buffer_store_dwordx2 v[116:117], v123, s[24:27], 0 offen
    ds_read_b64 v[110:111], v2 offset:49168
    ds_read_b64 v[112:113], v2 offset:49176
    ds_read_b64 v[114:115], v2 offset:49160

    ds_read_b64 v[116:117], v2 offset:57360
    ds_read_b64 v[118:119], v2 offset:57368
    ds_read_b64 v[120:121], v2 offset:57352

    s_waitcnt lgkmcnt(3)
    v_lshrrev_b32 v122, 16, v111
    ds_read_b32 v122, v122 offset:8192

    s_waitcnt lgkmcnt(1)
    v_lshrrev_b32 v123, 16, v117
    ds_read_b32 v123, v123 offset:8192

    v_cmp_ne_u32_sdwa s[70:71], v111, v113 src0_sel:WORD_1 src1_sel:WORD_1
    v_cmp_ne_u32_sdwa vcc, v111, v115 src0_sel:WORD_1 src1_sel:WORD_1
    v_perm_b32 v111, v112, v111, s45
    s_mov_b32 s54, 20480
    v_alignbyte_b32 v114, v115, v114, 2
    s_waitcnt lgkmcnt(1)
    v_add3_u32 v122, v122, v106, s54

    s_and_b64 exec, vcc, s[70:71]
    v_and_b32 v111, 0xff, v111
    s_andn2_b64 exec, s[70:71], vcc
    v_alignbyte_b32 v111, v111, v110, 1
    v_perm_b32 v110, v110, v114, s47
    v_subrev_u32 v122, 3, v122
    s_mov_b64 exec, -1

    buffer_store_dwordx2 v[110:111], v122, s[24:27], 0 offen
    v_cmp_ne_u32_sdwa s[70:71], v117, v119 src0_sel:WORD_1 src1_sel:WORD_1
    v_cmp_ne_u32_sdwa vcc, v117, v121 src0_sel:WORD_1 src1_sel:WORD_1
    v_perm_b32 v117, v118, v117, s45
    s_mov_b32 s54, 25600
    v_alignbyte_b32 v120, v121, v120, 2
    s_waitcnt lgkmcnt(0)
    v_add3_u32 v123, v123, v106, s54

    s_and_b64 exec, vcc, s[70:71]
    v_and_b32 v117, 0xff, v117
    s_andn2_b64 exec, s[70:71], vcc
    v_alignbyte_b32 v117, v117, v116, 1
    v_perm_b32 v116, v116, v120, s47
    v_subrev_u32 v123, 3, v123
    s_mov_b64 exec, -1

    buffer_store_dwordx2 v[116:117], v123, s[24:27], 0 offen
    v_add_u32 v107, 65536, v2
    ds_read_b64 v[110:111], v107 offset:16
    ds_read_b64 v[112:113], v107 offset:24
    ds_read_b64 v[114:115], v107 offset:8

    ds_read_b64 v[116:117], v107 offset:8208
    ds_read_b64 v[118:119], v107 offset:8216
    ds_read_b64 v[120:121], v107 offset:8200

    s_waitcnt lgkmcnt(3)
    v_lshrrev_b32 v122, 16, v111
    ds_read_b32 v122, v122 offset:8192

    s_waitcnt lgkmcnt(1)
    v_lshrrev_b32 v123, 16, v117
    ds_read_b32 v123, v123 offset:8192

    v_cmp_ne_u32_sdwa s[70:71], v111, v113 src0_sel:WORD_1 src1_sel:WORD_1
    v_cmp_ne_u32_sdwa vcc, v111, v115 src0_sel:WORD_1 src1_sel:WORD_1
    v_perm_b32 v111, v112, v111, s45
    s_mov_b32 s54, 30720
    v_alignbyte_b32 v114, v115, v114, 2
    s_waitcnt lgkmcnt(1)
    v_add3_u32 v122, v122, v106, s54

    s_and_b64 exec, vcc, s[70:71]
    v_and_b32 v111, 0xff, v111
    s_andn2_b64 exec, s[70:71], vcc
    v_alignbyte_b32 v111, v111, v110, 1
    v_perm_b32 v110, v110, v114, s47
    v_subrev_u32 v122, 3, v122
    s_mov_b64 exec, -1

    buffer_store_dwordx2 v[110:111], v122, s[24:27], 0 offen
    v_cmp_ne_u32_sdwa s[70:71], v117, v119 src0_sel:WORD_1 src1_sel:WORD_1
    v_cmp_ne_u32_sdwa vcc, v117, v121 src0_sel:WORD_1 src1_sel:WORD_1
    v_perm_b32 v117, v118, v117, s45
    s_mov_b32 s54, 35840
    v_alignbyte_b32 v120, v121, v120, 2
    s_waitcnt lgkmcnt(0)
    v_add3_u32 v123, v123, v106, s54

    s_and_b64 exec, vcc, s[70:71]
    v_and_b32 v117, 0xff, v117
    s_andn2_b64 exec, s[70:71], vcc
    v_alignbyte_b32 v117, v117, v116, 1
    v_perm_b32 v116, v116, v120, s47
    v_subrev_u32 v123, 3, v123
    s_mov_b64 exec, -1

    buffer_store_dwordx2 v[116:117], v123, s[24:27], 0 offen
    ds_read_b64 v[110:111], v107 offset:16400
    ds_read_b64 v[112:113], v107 offset:16408
    ds_read_b64 v[114:115], v107 offset:16392

    ds_read_b64 v[116:117], v107 offset:24592
    ds_read_b64 v[118:119], v107 offset:24600
    ds_read_b64 v[120:121], v107 offset:24584

    s_waitcnt lgkmcnt(3)
    v_lshrrev_b32 v122, 16, v111
    ds_read_b32 v122, v122 offset:8192

    s_waitcnt lgkmcnt(1)
    v_lshrrev_b32 v123, 16, v117
    ds_read_b32 v123, v123 offset:8192

    v_cmp_ne_u32_sdwa s[70:71], v111, v113 src0_sel:WORD_1 src1_sel:WORD_1
    v_cmp_ne_u32_sdwa vcc, v111, v115 src0_sel:WORD_1 src1_sel:WORD_1
    v_perm_b32 v111, v112, v111, s45
    s_mov_b32 s54, 40960
    v_alignbyte_b32 v114, v115, v114, 2
    s_waitcnt lgkmcnt(1)
    v_add3_u32 v122, v122, v106, s54

    s_and_b64 exec, vcc, s[70:71]
    v_and_b32 v111, 0xff, v111
    s_andn2_b64 exec, s[70:71], vcc
    v_alignbyte_b32 v111, v111, v110, 1
    v_perm_b32 v110, v110, v114, s47
    v_subrev_u32 v122, 3, v122
    s_mov_b64 exec, -1

    buffer_store_dwordx2 v[110:111], v122, s[24:27], 0 offen
    v_cmp_ne_u32_sdwa s[70:71], v117, v119 src0_sel:WORD_1 src1_sel:WORD_1
    v_cmp_ne_u32_sdwa vcc, v117, v121 src0_sel:WORD_1 src1_sel:WORD_1
    v_perm_b32 v117, v118, v117, s45
    s_mov_b32 s54, 46080
    v_alignbyte_b32 v120, v121, v120, 2
    s_waitcnt lgkmcnt(0)
    v_add3_u32 v123, v123, v106, s54

    s_and_b64 exec, vcc, s[70:71]
    v_and_b32 v117, 0xff, v117
    s_andn2_b64 exec, s[70:71], vcc
    v_alignbyte_b32 v117, v117, v116, 1
    v_perm_b32 v116, v116, v120, s47
    v_subrev_u32 v123, 3, v123
    s_mov_b64 exec, -1

    buffer_store_dwordx2 v[116:117], v123, s[24:27], 0 offen
    ds_read_b64 v[110:111], v107 offset:32784
    ds_read_b64 v[112:113], v107 offset:32792
    ds_read_b64 v[114:115], v107 offset:32776

    ds_read_b64 v[116:117], v107 offset:40976
    ds_read_b64 v[118:119], v107 offset:40984
    ds_read_b64 v[120:121], v107 offset:40968

    s_waitcnt lgkmcnt(3)
    v_lshrrev_b32 v122, 16, v111
    ds_read_b32 v122, v122 offset:8192

    s_waitcnt lgkmcnt(1)
    v_lshrrev_b32 v123, 16, v117
    ds_read_b32 v123, v123 offset:8192

    v_cmp_ne_u32_sdwa s[70:71], v111, v113 src0_sel:WORD_1 src1_sel:WORD_1
    v_cmp_ne_u32_sdwa vcc, v111, v115 src0_sel:WORD_1 src1_sel:WORD_1
    v_perm_b32 v111, v112, v111, s45
    s_mov_b32 s54, 51200
    v_alignbyte_b32 v114, v115, v114, 2
    s_waitcnt lgkmcnt(1)
    v_add3_u32 v122, v122, v106, s54

    s_and_b64 exec, vcc, s[70:71]
    v_and_b32 v111, 0xff, v111
    s_andn2_b64 exec, s[70:71], vcc
    v_alignbyte_b32 v111, v111, v110, 1
    v_perm_b32 v110, v110, v114, s47
    v_subrev_u32 v122, 3, v122
    s_mov_b64 exec, -1

    buffer_store_dwordx2 v[110:111], v122, s[24:27], 0 offen
    v_cmp_ne_u32_sdwa s[70:71], v117, v119 src0_sel:WORD_1 src1_sel:WORD_1
    v_cmp_ne_u32_sdwa vcc, v117, v121 src0_sel:WORD_1 src1_sel:WORD_1
    v_perm_b32 v117, v118, v117, s45
    s_mov_b32 s54, 56320
    v_alignbyte_b32 v120, v121, v120, 2
    s_waitcnt lgkmcnt(0)
    v_add3_u32 v123, v123, v106, s54

    s_and_b64 exec, vcc, s[70:71]
    v_and_b32 v117, 0xff, v117
    s_andn2_b64 exec, s[70:71], vcc
    v_alignbyte_b32 v117, v117, v116, 1
    v_perm_b32 v116, v116, v120, s47
    v_subrev_u32 v123, 3, v123
    s_mov_b64 exec, -1

    buffer_store_dwordx2 v[116:117], v123, s[24:27], 0 offen
    ds_read_b64 v[110:111], v107 offset:49168
    ds_read_b64 v[112:113], v107 offset:49176
    ds_read_b64 v[114:115], v107 offset:49160

    ds_read_b64 v[116:117], v107 offset:57360
    ds_read_b64 v[118:119], v107 offset:57368
    ds_read_b64 v[120:121], v107 offset:57352

    s_waitcnt lgkmcnt(3)
    v_lshrrev_b32 v122, 16, v111
    ds_read_b32 v122, v122 offset:8192

    s_waitcnt lgkmcnt(1)
    v_lshrrev_b32 v123, 16, v117
    ds_read_b32 v123, v123 offset:8192

    v_cmp_ne_u32_sdwa s[70:71], v111, v113 src0_sel:WORD_1 src1_sel:WORD_1
    v_cmp_ne_u32_sdwa vcc, v111, v115 src0_sel:WORD_1 src1_sel:WORD_1
    v_perm_b32 v111, v112, v111, s45
    s_mov_b32 s54, 61440
    v_alignbyte_b32 v114, v115, v114, 2
    s_waitcnt lgkmcnt(1)
    v_add3_u32 v122, v122, v106, s54

    s_and_b64 exec, vcc, s[70:71]
    v_and_b32 v111, 0xff, v111
    s_andn2_b64 exec, s[70:71], vcc
    v_alignbyte_b32 v111, v111, v110, 1
    v_perm_b32 v110, v110, v114, s47
    v_subrev_u32 v122, 3, v122
    s_mov_b64 exec, -1

    buffer_store_dwordx2 v[110:111], v122, s[24:27], 0 offen
    v_cmp_ne_u32_sdwa s[70:71], v117, v119 src0_sel:WORD_1 src1_sel:WORD_1
    v_cmp_ne_u32_sdwa vcc, v117, v121 src0_sel:WORD_1 src1_sel:WORD_1
    v_perm_b32 v117, v118, v117, s45
    s_mov_b32 s54, 66560
    v_alignbyte_b32 v120, v121, v120, 2
    s_waitcnt lgkmcnt(0)
    v_add3_u32 v123, v123, v106, s54

    s_and_b64 exec, vcc, s[70:71]
    v_and_b32 v117, 0xff, v117
    s_andn2_b64 exec, s[70:71], vcc
    v_alignbyte_b32 v117, v117, v116, 1
    v_perm_b32 v116, v116, v120, s47
    v_subrev_u32 v123, 3, v123
    s_mov_b64 exec, -1

    buffer_store_dwordx2 v[116:117], v123, s[24:27], 0 offen
    v_add_u32 v107, 131072, v2
    ds_read_b64 v[110:111], v107 offset:16
    ds_read_b64 v[112:113], v107 offset:24
    ds_read_b64 v[114:115], v107 offset:8

    ds_read_b64 v[116:117], v107 offset:8208
    ds_read_b64 v[118:119], v107 offset:8216
    ds_read_b64 v[120:121], v107 offset:8200

    s_waitcnt lgkmcnt(3)
    v_lshrrev_b32 v122, 16, v111
    ds_read_b32 v122, v122 offset:8192

    s_waitcnt lgkmcnt(1)
    v_lshrrev_b32 v123, 16, v117
    ds_read_b32 v123, v123 offset:8192

    v_cmp_ne_u32_sdwa s[70:71], v111, v113 src0_sel:WORD_1 src1_sel:WORD_1
    v_cmp_ne_u32_sdwa vcc, v111, v115 src0_sel:WORD_1 src1_sel:WORD_1
    v_perm_b32 v111, v112, v111, s45
    s_mov_b32 s54, 71680
    v_alignbyte_b32 v114, v115, v114, 2
    s_waitcnt lgkmcnt(1)
    v_add3_u32 v122, v122, v106, s54

    s_and_b64 exec, vcc, s[70:71]
    v_and_b32 v111, 0xff, v111
    s_andn2_b64 exec, s[70:71], vcc
    v_alignbyte_b32 v111, v111, v110, 1
    v_perm_b32 v110, v110, v114, s47
    v_subrev_u32 v122, 3, v122
    s_mov_b64 exec, -1

    buffer_store_dwordx2 v[110:111], v122, s[24:27], 0 offen
    v_cmp_ne_u32_sdwa s[70:71], v117, v119 src0_sel:WORD_1 src1_sel:WORD_1
    v_cmp_ne_u32_sdwa vcc, v117, v121 src0_sel:WORD_1 src1_sel:WORD_1
    v_perm_b32 v117, v118, v117, s45
    s_mov_b32 s54, 76800
    v_alignbyte_b32 v120, v121, v120, 2
    s_waitcnt lgkmcnt(0)
    v_add3_u32 v123, v123, v106, s54

    s_andn2_b64 exec, -1, s[68:69]
    v_bfrev_b32 v123, 1

    s_and_b64 exec, vcc, s[70:71]
    v_and_b32 v117, 0xff, v117
    s_andn2_b64 exec, s[70:71], vcc
    v_alignbyte_b32 v117, v117, v116, 1
    v_perm_b32 v116, v116, v120, s47
    v_subrev_u32 v123, 3, v123
    s_mov_b64 exec, -1

    buffer_store_dwordx2 v[116:117], v123, s[24:27], 0 offen
L_p1done_2:
    s_endpgm

L_slow_6:
    s_mov_b32 s26, 0
    v_mov_b32 v112, v0
    v_mov_b32 v118, 0
    s_mov_b32 s75, 4960
    s_movk_i32 s74, 16000
L_sl_8:
    v_lshlrev_b32 v113, 3, v112
    ds_read_b64 v[110:111], v113 offset:16400
    ds_read_b32 v119, v113 offset:16412
    ds_read_b32 v120, v113 offset:16396
    s_waitcnt lgkmcnt(0)
    v_lshrrev_b32 v114, 16, v111
    ds_read_b32 v115, v114 offset:8192
    v_add_u32 v114, 4, v114
    v_mul_u32_u24 v114, s75, v114
    s_waitcnt lgkmcnt(0)
    v_mad_u32_u24 v115, v112, 5, v115
    v_mov_b32 v116, 1
    v_cmp_gt_u32 s[72:73], s74, v112
    v_cmp_ge_u32 vcc, v115, v114
    s_and_b64 exec, vcc, s[72:73]
    s_cbranch_execz L_s1_9
    buffer_atomic_add v116, v118, s[36:39], 0 offen sc0
    s_waitcnt vmcnt(0)
    v_lshlrev_b32 v116, 3, v116
    buffer_store_dwordx2 v[110:111], v116, s[32:35], 0 offen
L_s1_9:
    s_andn2_b64 exec, s[72:73], vcc
    s_cbranch_execz L_s2_10
    buffer_store_dword v110, v115, s[28:31], 0 offen
    buffer_store_byte v111, v115, s[28:31], 0 offen offset:4
    v_add_u32 v115, 5, v115
    v_cmpx_lt_u32 vcc, v115, v114
    v_cmpx_ne_u32_sdwa vcc, v111, v119 src0_sel:WORD_1 src1_sel:WORD_1
    v_cmpx_ne_u32_sdwa vcc, v111, v120 src0_sel:WORD_1 src1_sel:WORD_1
    s_cbranch_execz L_s2_10
    buffer_store_dword v118, v115, s[28:31], 0 offen
L_s2_10:
    s_mov_b64 exec, -1
    s_waitcnt vmcnt(0)
    v_add_u32 v112, 1024, v112
    s_nop 0
    v_readfirstlane_b32 s76, v112
    s_nop 1
    s_cmp_lt_u32 s76, s74
    s_cbranch_scc1 L_sl_8
    s_branch L_sback_7

L_slow_12:
    s_mov_b32 s26, 0
    v_mov_b32 v112, v0
    v_mov_b32 v118, 0
    s_mov_b32 s75, 4960
    s_movk_i32 s74, 16000
L_sl_14:
    v_lshlrev_b32 v113, 3, v112
    ds_read_b64 v[110:111], v113 offset:16400
    ds_read_b32 v119, v113 offset:16412
    ds_read_b32 v120, v113 offset:16396
    s_waitcnt lgkmcnt(0)
    v_lshrrev_b32 v114, 16, v111
    ds_read_b32 v115, v114 offset:8192
    v_add_u32 v114, 4, v114
    v_mul_u32_u24 v114, s75, v114
    s_waitcnt lgkmcnt(0)
    v_mad_u32_u24 v115, v112, 5, v115
    v_mov_b32 v116, 1
    v_cmp_gt_u32 s[72:73], s74, v112
    v_cmp_ge_u32 vcc, v115, v114
    s_and_b64 exec, vcc, s[72:73]
    s_cbranch_execz L_s1_15
    buffer_atomic_add v116, v118, s[36:39], 0 offen sc0
    s_waitcnt vmcnt(0)
    v_lshlrev_b32 v116, 3, v116
    buffer_store_dwordx2 v[110:111], v116, s[32:35], 0 offen
L_s1_15:
    s_andn2_b64 exec, s[72:73], vcc
    s_cbranch_execz L_s2_16
    buffer_store_dword v110, v115, s[28:31], 0 offen
    buffer_store_byte v111, v115, s[28:31], 0 offen offset:4
    v_add_u32 v115, 5, v115
    v_cmpx_lt_u32 vcc, v115, v114
    v_cmpx_ne_u32_sdwa vcc, v111, v119 src0_sel:WORD_1 src1_sel:WORD_1
    v_cmpx_ne_u32_sdwa vcc, v111, v120 src0_sel:WORD_1 src1_sel:WORD_1
    s_cbranch_execz L_s2_16
    buffer_store_dword v118, v115, s[28:31], 0 offen
L_s2_16:
    s_mov_b64 exec, -1
    s_waitcnt vmcnt(0)
    v_add_u32 v112, 1024, v112
    s_nop 0
    v_readfirstlane_b32 s76, v112
    s_nop 1
    s_cmp_lt_u32 s76, s74
    s_cbranch_scc1 L_sl_14
    s_branch L_sback_13

.globl g2_kernel
.p2align 8
.type g2_kernel,@function
g2_kernel:
    s_cmp_ge_u32 s2, 256
    s_cbranch_scc1 L_p2done_17
    s_load_dwordx2 s[8:9], s[0:1], 0
    s_load_dwordx2 s[6:7], s[0:1], 104
    v_lshrrev_b32 v4, 6, v0
    v_lshlrev_b32 v5, 3, v0
    s_lshr_b32 s37, s2, 1
    s_and_b32 s37, s37, 3
    s_lshr_b32 s36, s2, 3
    s_lshl_b32 s36, s36, 1
    s_and_b32 s3, s2, 1
    s_or_b32 s36, s36, s3
    v_readfirstlane_b32 s4, v4
    v_and_b32 v2, 127, v0
    v_mul_u32_u24 v2, 20, v2
    v_lshlrev_b32 v3, 4, v0
    s_waitcnt lgkmcnt(0)
    s_lshr_b32 s5, s4, 1
    s_and_b32 s39, s4, 1
    s_lshl_b32 s39, s39, 8
    s_mul_i32 s3, s5, 8192
    s_add_u32 s46, s6, s3
    s_addc_u32 s47, s7, 0
    s_mul_i32 s3, s5, 40632320
    s_add_u32 s3, s3, 77848576
    s_add_u32 s44, s6, s3
    s_addc_u32 s45, s7, 0
    s_mul_i32 s38, s37, 8
    s_add_u32 s4, s38, 8
    s_lshl_b32 s3, s38, 6
    s_add_u32 s3, s3, s36
    s_lshl_b32 s3, s3, 2
    s_load_dword s41, s[46:47], s3
    s_mov_b32 s3, 131072
    s_load_dword s51, s[6:7], s3
    s_mov_b32 s10, 6400000
    s_mov_b32 s11, 0x20000

    s_add_u32 s20, s6, 135168
    s_addc_u32 s21, s7, 0
    s_mov_b32 s22, 8192
    s_mov_b32 s23, 0x20000
    buffer_load_dwordx2 v[116:117], v5, s[20:23], 0 offen
    s_mov_b32 s12, s8
    s_mov_b32 s13, s9
    s_mov_b32 s14, 0
    s_mov_b32 s15, 0x20000
    s_mul_i32 s43, s38, 200000
    s_add_u32 s14, s43, 50000
    buffer_load_dwordx4 v[76:79], v3, s[12:15], s43 offen
    s_add_u32 s52, s43, 16384
    buffer_load_dwordx4 v[80:83], v3, s[12:15], s52 offen
    s_add_u32 s52, s43, 32768
    buffer_load_dwordx4 v[84:87], v3, s[12:15], s52 offen
    s_add_u32 s52, s43, 49152
    v_lshlrev_b32 v123, 2, v0
    buffer_load_dword v88, v123, s[12:15], s52 offen
    s_lshr_b32 s3, s2, 3
    s_mul_i32 s3, s3, 49
    v_add_lshl_u32 v89, v0, s3, 7
    v_cmp_gt_u32 vcc, 49, v0
    v_bfrev_b32 v28, 1
    s_add_u32 s54, s43, 100000
    v_cndmask_b32 v89, v28, v89, vcc

    buffer_load_dword v115, v89, s[8:11], s54 offen
    s_mov_b32 s19, 0x20000
    s_mov_b32 s28, 0x4b404000
    s_mov_b32 s29, 0x4b404000
    s_mov_b32 s30, 0xbfffc000
    s_mov_b32 s31, 0xbfffbfff
    s_mov_b32 s32, 0xffff0000
    s_mov_b32 s35, 0x05040100
    s_movk_i32 s3, 212
    v_cmp_gt_u32 s[48:49], s3, v0

    v_mov_b32 v1, 0
    s_mov_b32 s24, 0xc0c0004
    s_mov_b32 s25, 0xc0c0105
    s_mov_b32 s26, 0xc0c0206
    s_mov_b32 s27, 0xc0c0307
    s_waitcnt lgkmcnt(0)
    s_min_u32 s41, s41, 3968
    s_lshl_b32 s52, s38, 6
    s_add_u32 s52, s52, s36
    s_mul_i32 s52, s52, 19840
    s_add_u32 s16, s44, s52
    s_addc_u32 s17, s45, 0
    s_mul_i32 s52, s41, 5
    s_add_u32 s52, s52, 3
    s_and_b32 s18, s52, -4

    s_movk_i32 s53, 0
    buffer_load_dwordx4 v[4:7], v2, s[16:19], s53 offen
    buffer_load_dword v35, v2, s[16:19], s53 offen offset:16
    s_movk_i32 s53, 2560
    buffer_load_dwordx4 v[8:11], v2, s[16:19], s53 offen
    buffer_load_dword v43, v2, s[16:19], s53 offen offset:16
    s_movk_i32 s53, 5120
    buffer_load_dwordx4 v[90:93], v2, s[16:19], s53 offen
    buffer_load_dword v110, v2, s[16:19], s53 offen offset:16
    s_movk_i32 s53, 7680
    buffer_load_dwordx4 v[94:97], v2, s[16:19], s53 offen
    buffer_load_dword v111, v2, s[16:19], s53 offen offset:16
    s_movk_i32 s53, 10240
    buffer_load_dwordx4 v[98:101], v2, s[16:19], s53 offen
    buffer_load_dword v112, v2, s[16:19], s53 offen offset:16
    s_movk_i32 s53, 12800
    buffer_load_dwordx4 v[102:105], v2, s[16:19], s53 offen
    buffer_load_dword v113, v2, s[16:19], s53 offen offset:16
    s_movk_i32 s53, 15360
    buffer_load_dwordx4 v[106:109], v2, s[16:19], s53 offen
    buffer_load_dword v114, v2, s[16:19], s53 offen offset:16
    v_mov_b32 v28, 0x40004000
    v_mov_b32 v29, 0x40004000
    v_mov_b32 v30, 0x40004000
    v_mov_b32 v31, 0x40004000
    v_add_u32 v32, 50000, v3
    v_add_u32 v33, 65536, v32

    ds_write_b128 v32, v[28:31] offset:0
    ds_write_b128 v32, v[28:31] offset:16384
    ds_write_b128 v32, v[28:31] offset:32768
    ds_write_b128 v32, v[28:31] offset:49152
    ds_write_b128 v33, v[28:31] offset:0
    ds_write_b128 v33, v[28:31] offset:16384
    v_cmp_gt_u32 vcc, 971, v0
    s_mov_b64 exec, vcc
    ds_write_b128 v33, v[28:31] offset:32768
    s_mov_b64 exec, -1
    s_waitcnt lgkmcnt(0)
    s_barrier
    v_mov_b32 v34, 150016
    v_mov_b32 v36, 0
    v_mov_b32 v37, 0
    v_mov_b32 v38, 0
    v_mov_b32 v39, 0
    ds_write_b128 v34, v[36:39]

    s_waitcnt vmcnt(19)
    s_nop 1
    v_max_u32_dpp v116, v116, v116 row_shr:1 row_mask:0xf bank_mask:0xf
    s_nop 1
    v_max_u32_dpp v116, v116, v116 row_shr:2 row_mask:0xf bank_mask:0xf
    s_nop 1
    v_max_u32_dpp v116, v116, v116 row_shr:4 row_mask:0xf bank_mask:0xf
    s_nop 1
    v_max_u32_dpp v116, v116, v116 row_shr:8 row_mask:0xf bank_mask:0xf
    s_nop 1
    v_max_u32_dpp v116, v116, v116 row_bcast:15 row_mask:0xa bank_mask:0xf
    s_nop 1
    v_max_u32_dpp v116, v116, v116 row_bcast:31 row_mask:0xc bank_mask:0xf
    s_nop 1
    v_add_f32_dpp v117, v117, v117 row_shr:1 row_mask:0xf bank_mask:0xf
    s_nop 1
    v_add_f32_dpp v117, v117, v117 row_shr:2 row_mask:0xf bank_mask:0xf
    s_nop 1
    v_add_f32_dpp v117, v117, v117 row_shr:4 row_mask:0xf bank_mask:0xf
    s_nop 1
    v_add_f32_dpp v117, v117, v117 row_shr:8 row_mask:0xf bank_mask:0xf
    s_nop 1
    v_add_f32_dpp v117, v117, v117 row_bcast:15 row_mask:0xa bank_mask:0xf
    s_nop 1
    v_add_f32_dpp v117, v117, v117 row_bcast:31 row_mask:0xc bank_mask:0xf
    s_waitcnt lgkmcnt(0)
    s_barrier
    s_mov_b32 exec_lo, 0
    s_brev_b32 exec_hi, 1
    ds_max_u32 v34, v116
    ds_add_f32 v34, v117 offset:4
    s_mov_b64 exec, -1

    s_waitcnt vmcnt(18)
    ds_write_b128 v3, v[76:79] offset:0
    s_waitcnt vmcnt(17)
    ds_write_b128 v3, v[80:83] offset:16384
    s_waitcnt vmcnt(16)
    ds_write_b128 v3, v[84:87] offset:32768
    v_lshlrev_b32 v123, 2, v0
    s_waitcnt vmcnt(15)
    s_mov_b64 exec, s[48:49]
    ds_write_b32 v123, v88 offset:49152
    s_mov_b64 exec, -1

    s_add_u32 s43, s43, 50000
    s_add_u32 s14, s43, 50000
    buffer_load_dwordx4 v[76:79], v3, s[12:15], s43 offen
    s_add_u32 s52, s43, 16384
    buffer_load_dwordx4 v[80:83], v3, s[12:15], s52 offen
    s_add_u32 s52, s43, 32768
    buffer_load_dwordx4 v[84:87], v3, s[12:15], s52 offen
    s_add_u32 s52, s43, 49152
    v_lshlrev_b32 v123, 2, v0
    buffer_load_dword v88, v123, s[12:15], s52 offen
    s_waitcnt lgkmcnt(0)
    s_barrier
    ds_read_b64 v[28:29], v34
    s_waitcnt lgkmcnt(0)
    v_lshlrev_b32 v28, 16, v28
    v_mul_f32 v29, 0x34a7c5ac, v29
    v_sqrt_f32 v29, v29
    v_add_f32 v30, v28, v28
    v_mul_f32 v31, 0x41ac0000, v29
    v_mul_f32 v32, 0x42000000, v29
    v_max_f32 v30, v30, v31
    v_cmp_le_f32 vcc, v28, v32
    v_mov_b32 v33, 0x26901d7d
    v_cmp_lt_f32 s[64:65], v33, v29
    v_mov_b32 v33, 0x58635fa9
    s_and_b64 vcc, vcc, s[64:65]
    v_cmp_gt_f32 s[64:65], v33, v29
    v_rcp_f32 v30, v30
    s_and_b64 vcc, vcc, s[64:65]
    s_cbranch_scc0 L_p2slow_18
    s_cmp_lg_u32 s51, 0
    s_cbranch_scc1 L_p2slow_18
    v_mul_f32 v30, 0x3f000000, v30
    v_mul_f32 v31, 0x46ff8000, v30
    v_rcp_f32 v31, v31
    v_readfirstlane_b32 s33, v30
    s_nop 0
    v_readfirstlane_b32 s34, v31

L_batch_19:
    s_mov_b32 s40, s41
    s_sub_u32 s42, s40, s39
    s_mul_i32 s50, s38, 200000
    s_add_u32 s5, s38, 1
    s_min_u32 s52, s5, 31
    s_lshl_b32 s52, s52, 6
    s_add_u32 s52, s52, s36
    s_lshl_b32 s52, s52, 2
    s_load_dword s41, s[46:47], s52

    s_waitcnt vmcnt(12)
    v_perm_b32 v44, v91, v90, s24
    v_perm_b32 v46, v92, v91, s25
    v_perm_b32 v48, v93, v92, s26
    v_perm_b32 v50, v110, v93, s27
    v_mov_b32 v12, v90
    v_alignbyte_b32 v13, v92, v91, 1
    v_alignbyte_b32 v14, v93, v92, 2
    v_alignbyte_b32 v15, v110, v93, 3
    v_lshlrev_b32_sdwa v44, 3, v44 dst_sel:WORD_0 dst_unused:UNUSED_PAD src0_sel:DWORD src1_sel:DWORD
    v_lshlrev_b32_sdwa v46, 3, v46 dst_sel:WORD_0 dst_unused:UNUSED_PAD src0_sel:DWORD src1_sel:DWORD
    v_lshlrev_b32_sdwa v48, 3, v48 dst_sel:WORD_0 dst_unused:UNUSED_PAD src0_sel:DWORD src1_sel:DWORD
    v_lshlrev_b32_sdwa v50, 3, v50 dst_sel:WORD_0 dst_unused:UNUSED_PAD src0_sel:DWORD src1_sel:DWORD
    s_cmp_lt_i32 s42, 1280
    s_cbranch_scc1 L_ufix_20
L_uback_21:

    s_waitcnt vmcnt(10)
    v_perm_b32 v52, v95, v94, s24
    v_perm_b32 v54, v96, v95, s25
    v_perm_b32 v56, v97, v96, s26
    v_perm_b32 v58, v111, v97, s27
    v_mov_b32 v16, v94
    v_alignbyte_b32 v17, v96, v95, 1
    v_alignbyte_b32 v18, v97, v96, 2
    v_alignbyte_b32 v19, v111, v97, 3
    v_lshlrev_b32_sdwa v52, 3, v52 dst_sel:WORD_0 dst_unused:UNUSED_PAD src0_sel:DWORD src1_sel:DWORD
    v_lshlrev_b32_sdwa v54, 3, v54 dst_sel:WORD_0 dst_unused:UNUSED_PAD src0_sel:DWORD src1_sel:DWORD
    v_lshlrev_b32_sdwa v56, 3, v56 dst_sel:WORD_0 dst_unused:UNUSED_PAD src0_sel:DWORD src1_sel:DWORD
    v_lshlrev_b32_sdwa v58, 3, v58 dst_sel:WORD_0 dst_unused:UNUSED_PAD src0_sel:DWORD src1_sel:DWORD
    s_cmp_lt_i32 s42, 1792
    s_cbranch_scc1 L_ufix_22
L_uback_23:

    s_waitcnt vmcnt(8)
    v_perm_b32 v60, v99, v98, s24
    v_perm_b32 v62, v100, v99, s25
    v_perm_b32 v64, v101, v100, s26
    v_perm_b32 v66, v112, v101, s27
    v_mov_b32 v20, v98
    v_alignbyte_b32 v21, v100, v99, 1
    v_alignbyte_b32 v22, v101, v100, 2
    v_alignbyte_b32 v23, v112, v101, 3
    v_lshlrev_b32_sdwa v60, 3, v60 dst_sel:WORD_0 dst_unused:UNUSED_PAD src0_sel:DWORD src1_sel:DWORD
    v_lshlrev_b32_sdwa v62, 3, v62 dst_sel:WORD_0 dst_unused:UNUSED_PAD src0_sel:DWORD src1_sel:DWORD
    v_lshlrev_b32_sdwa v64, 3, v64 dst_sel:WORD_0 dst_unused:UNUSED_PAD src0_sel:DWORD src1_sel:DWORD
    v_lshlrev_b32_sdwa v66, 3, v66 dst_sel:WORD_0 dst_unused:UNUSED_PAD src0_sel:DWORD src1_sel:DWORD
    s_cmp_lt_i32 s42, 2304
    s_cbranch_scc1 L_ufix_24
L_uback_25:

    s_waitcnt vmcnt(6)
    v_perm_b32 v68, v103, v102, s24
    v_perm_b32 v70, v104, v103, s25
    v_perm_b32 v72, v105, v104, s26
    v_perm_b32 v74, v113, v105, s27
    v_mov_b32 v24, v102
    v_alignbyte_b32 v25, v104, v103, 1
    v_alignbyte_b32 v26, v105, v104, 2
    v_alignbyte_b32 v27, v113, v105, 3
    v_lshlrev_b32_sdwa v68, 3, v68 dst_sel:WORD_0 dst_unused:UNUSED_PAD src0_sel:DWORD src1_sel:DWORD
    v_lshlrev_b32_sdwa v70, 3, v70 dst_sel:WORD_0 dst_unused:UNUSED_PAD src0_sel:DWORD src1_sel:DWORD
    v_lshlrev_b32_sdwa v72, 3, v72 dst_sel:WORD_0 dst_unused:UNUSED_PAD src0_sel:DWORD src1_sel:DWORD
    v_lshlrev_b32_sdwa v74, 3, v74 dst_sel:WORD_0 dst_unused:UNUSED_PAD src0_sel:DWORD src1_sel:DWORD
    s_cmp_lt_i32 s42, 2816
    s_cbranch_scc1 L_ufix_26
L_uback_27:

    s_waitcnt vmcnt(4)
    v_perm_b32 v28, v5, v4, s24
    v_perm_b32 v30, v6, v5, s25
    v_perm_b32 v32, v7, v6, s26
    v_perm_b32 v34, v35, v7, s27
    v_alignbyte_b32 v5, v6, v5, 1
    v_alignbyte_b32 v6, v7, v6, 2
    v_alignbyte_b32 v7, v35, v7, 3
    v_lshlrev_b32_sdwa v28, 3, v28 dst_sel:WORD_0 dst_unused:UNUSED_PAD src0_sel:DWORD src1_sel:DWORD
    v_lshlrev_b32_sdwa v30, 3, v30 dst_sel:WORD_0 dst_unused:UNUSED_PAD src0_sel:DWORD src1_sel:DWORD
    v_lshlrev_b32_sdwa v32, 3, v32 dst_sel:WORD_0 dst_unused:UNUSED_PAD src0_sel:DWORD src1_sel:DWORD
    v_lshlrev_b32_sdwa v34, 3, v34 dst_sel:WORD_0 dst_unused:UNUSED_PAD src0_sel:DWORD src1_sel:DWORD
    s_cmp_lt_i32 s42, 256
    s_cbranch_scc1 L_ufix_28
L_uback_29:

    s_waitcnt vmcnt(2)
    v_perm_b32 v36, v9, v8, s24
    v_perm_b32 v38, v10, v9, s25
    v_perm_b32 v40, v11, v10, s26
    v_perm_b32 v42, v43, v11, s27
    v_alignbyte_b32 v9, v10, v9, 1
    v_alignbyte_b32 v10, v11, v10, 2
    v_alignbyte_b32 v11, v43, v11, 3
    v_lshlrev_b32_sdwa v36, 3, v36 dst_sel:WORD_0 dst_unused:UNUSED_PAD src0_sel:DWORD src1_sel:DWORD
    v_lshlrev_b32_sdwa v38, 3, v38 dst_sel:WORD_0 dst_unused:UNUSED_PAD src0_sel:DWORD src1_sel:DWORD
    v_lshlrev_b32_sdwa v40, 3, v40 dst_sel:WORD_0 dst_unused:UNUSED_PAD src0_sel:DWORD src1_sel:DWORD
    v_lshlrev_b32_sdwa v42, 3, v42 dst_sel:WORD_0 dst_unused:UNUSED_PAD src0_sel:DWORD src1_sel:DWORD
    s_cmp_lt_i32 s42, 768
    s_cbranch_scc1 L_ufix_30
L_uback_31:

    v_subrev_co_u32 v4, s[64:65], 2.0, v4
    v_subrev_co_u32 v5, s[66:67], 2.0, v5
    v_subrev_co_u32 v6, s[68:69], 2.0, v6
    v_subrev_co_u32 v7, s[70:71], 2.0, v7
    v_subrev_co_u32 v8, s[72:73], 2.0, v8
    v_subrev_co_u32 v9, s[74:75], 2.0, v9
    v_subrev_co_u32 v10, s[76:77], 2.0, v10
    v_subrev_co_u32 v11, s[78:79], 2.0, v11
    v_subrev_co_u32 v12, s[80:81], 2.0, v12
    v_subrev_co_u32 v13, s[82:83], 2.0, v13
    v_subrev_co_u32 v14, s[84:85], 2.0, v14
    v_subrev_co_u32 v15, s[86:87], 2.0, v15
    s_waitcnt lgkmcnt(0)
    s_barrier
    s_cmp_lt_u32 s5, s4
    s_cselect_b32 s41, s41, 0
    s_min_u32 s55, s5, 31
    s_min_u32 s41, s41, 3968
    s_lshl_b32 s52, s55, 6
    s_add_u32 s52, s52, s36
    s_mul_i32 s52, s52, 19840
    s_add_u32 s16, s44, s52
    s_addc_u32 s17, s45, 0
    s_mul_i32 s52, s41, 5
    s_add_u32 s52, s52, 3
    s_and_b32 s18, s52, -4

    s_mov_b64 exec, s[64:65]
    ds_read_b64 v[28:29], v28
    s_mov_b64 exec, s[66:67]
    ds_read_b64 v[30:31], v30
    s_mov_b64 exec, s[68:69]
    ds_read_b64 v[32:33], v32
    s_mov_b64 exec, s[70:71]
    ds_read_b64 v[34:35], v34
    s_mov_b64 exec, s[72:73]
    ds_read_b64 v[36:37], v36
    s_mov_b64 exec, s[74:75]
    ds_read_b64 v[38:39], v38
    s_mov_b64 exec, s[76:77]
    ds_read_b64 v[40:41], v40
    s_mov_b64 exec, s[78:79]
    ds_read_b64 v[42:43], v42
    s_mov_b64 exec, s[80:81]
    ds_read_b64 v[44:45], v44
    s_mov_b64 exec, s[82:83]
    ds_read_b64 v[46:47], v46
    s_mov_b64 exec, s[84:85]
    ds_read_b64 v[48:49], v48
    s_mov_b64 exec, s[86:87]
    ds_read_b64 v[50:51], v50
    s_mov_b64 exec, -1
    s_movk_i32 s53, 5120
    buffer_load_dwordx4 v[90:93], v2, s[16:19], s53 offen
    buffer_load_dword v110, v2, s[16:19], s53 offen offset:16
    v_subrev_co_u32 v16, s[64:65], 2.0, v16
    v_subrev_co_u32 v17, s[66:67], 2.0, v17
    v_subrev_co_u32 v18, s[68:69], 2.0, v18
    v_subrev_co_u32 v19, s[70:71], 2.0, v19
    v_subrev_co_u32 v20, s[72:73], 2.0, v20
    v_subrev_co_u32 v21, s[74:75], 2.0, v21
    v_subrev_co_u32 v22, s[76:77], 2.0, v22
    v_subrev_co_u32 v23, s[78:79], 2.0, v23
    v_subrev_co_u32 v24, s[80:81], 2.0, v24
    v_subrev_co_u32 v25, s[82:83], 2.0, v25
    v_subrev_co_u32 v26, s[84:85], 2.0, v26
    v_subrev_co_u32 v27, s[86:87], 2.0, v27
    s_mov_b64 exec, s[64:65]
    ds_read_b64 v[52:53], v52
    s_mov_b64 exec, s[66:67]
    ds_read_b64 v[54:55], v54
    s_mov_b64 exec, s[68:69]
    ds_read_b64 v[56:57], v56
    s_mov_b64 exec, s[70:71]
    ds_read_b64 v[58:59], v58
    s_mov_b64 exec, s[72:73]
    ds_read_b64 v[60:61], v60
    s_mov_b64 exec, s[74:75]
    ds_read_b64 v[62:63], v62
    s_mov_b64 exec, s[76:77]
    ds_read_b64 v[64:65], v64
    s_mov_b64 exec, s[78:79]
    ds_read_b64 v[66:67], v66
    s_mov_b64 exec, s[80:81]
    ds_read_b64 v[68:69], v68
    s_mov_b64 exec, s[82:83]
    ds_read_b64 v[70:71], v70
    s_mov_b64 exec, s[84:85]
    ds_read_b64 v[72:73], v72
    s_mov_b64 exec, s[86:87]
    ds_read_b64 v[74:75], v74
    s_mov_b64 exec, -1
    s_waitcnt lgkmcnt(0)
    s_barrier
    s_waitcnt vmcnt(5)
    ds_write_b128 v3, v[76:79] offset:0
    s_waitcnt vmcnt(4)
    ds_write_b128 v3, v[80:83] offset:16384
    s_waitcnt vmcnt(3)
    ds_write_b128 v3, v[84:87] offset:32768
    v_lshlrev_b32 v123, 2, v0
    s_waitcnt vmcnt(2)
    s_mov_b64 exec, s[48:49]
    ds_write_b32 v123, v88 offset:49152
    s_mov_b64 exec, -1

    s_add_u32 s43, s43, 50000
    s_add_u32 s14, s43, 50000
    buffer_load_dwordx4 v[76:79], v3, s[12:15], s43 offen
    s_add_u32 s52, s43, 16384
    buffer_load_dwordx4 v[80:83], v3, s[12:15], s52 offen
    v_subrev_co_u32 v4, s[64:65], 2.0, v4
    v_subrev_co_u32 v5, s[66:67], 2.0, v5
    v_subrev_co_u32 v6, s[68:69], 2.0, v6
    v_subrev_co_u32 v7, s[70:71], 2.0, v7
    v_subrev_co_u32 v8, s[72:73], 2.0, v8
    v_subrev_co_u32 v9, s[74:75], 2.0, v9
    v_subrev_co_u32 v10, s[76:77], 2.0, v10
    v_subrev_co_u32 v11, s[78:79], 2.0, v11
    v_subrev_co_u32 v12, s[80:81], 2.0, v12
    v_subrev_co_u32 v13, s[82:83], 2.0, v13
    v_subrev_co_u32 v14, s[84:85], 2.0, v14
    v_subrev_co_u32 v15, s[86:87], 2.0, v15
    s_waitcnt lgkmcnt(0)
    s_barrier
    s_add_u32 s52, s43, 32768
    buffer_load_dwordx4 v[84:87], v3, s[12:15], s52 offen
    s_add_u32 s52, s43, 49152
    v_lshlrev_b32 v123, 2, v0
    buffer_load_dword v88, v123, s[12:15], s52 offen
    s_mov_b64 exec, s[64:65]
    ds_read_b64 v[28:29], v28
    s_mov_b64 exec, s[66:67]
    ds_read_b64 v[30:31], v30
    s_mov_b64 exec, s[68:69]
    ds_read_b64 v[32:33], v32
    s_mov_b64 exec, s[70:71]
    ds_read_b64 v[34:35], v34
    s_mov_b64 exec, s[72:73]
    ds_read_b64 v[36:37], v36
    s_mov_b64 exec, s[74:75]
    ds_read_b64 v[38:39], v38
    s_mov_b64 exec, s[76:77]
    ds_read_b64 v[40:41], v40
    s_mov_b64 exec, s[78:79]
    ds_read_b64 v[42:43], v42
    s_mov_b64 exec, s[80:81]
    ds_read_b64 v[44:45], v44
    s_mov_b64 exec, s[82:83]
    ds_read_b64 v[46:47], v46
    s_mov_b64 exec, s[84:85]
    ds_read_b64 v[48:49], v48
    s_mov_b64 exec, s[86:87]
    ds_read_b64 v[50:51], v50
    s_mov_b64 exec, -1
    s_movk_i32 s53, 7680
    buffer_load_dwordx4 v[94:97], v2, s[16:19], s53 offen
    buffer_load_dword v111, v2, s[16:19], s53 offen offset:16
    v_subrev_co_u32 v16, s[64:65], 2.0, v16
    v_subrev_co_u32 v17, s[66:67], 2.0, v17
    v_subrev_co_u32 v18, s[68:69], 2.0, v18
    v_subrev_co_u32 v19, s[70:71], 2.0, v19
    v_subrev_co_u32 v20, s[72:73], 2.0, v20
    v_subrev_co_u32 v21, s[74:75], 2.0, v21
    v_subrev_co_u32 v22, s[76:77], 2.0, v22
    v_subrev_co_u32 v23, s[78:79], 2.0, v23
    v_subrev_co_u32 v24, s[80:81], 2.0, v24
    v_subrev_co_u32 v25, s[82:83], 2.0, v25
    v_subrev_co_u32 v26, s[84:85], 2.0, v26
    v_subrev_co_u32 v27, s[86:87], 2.0, v27
    s_mov_b64 exec, s[64:65]
    ds_read_b64 v[52:53], v52
    s_mov_b64 exec, s[66:67]
    ds_read_b64 v[54:55], v54
    s_mov_b64 exec, s[68:69]
    ds_read_b64 v[56:57], v56
    s_mov_b64 exec, s[70:71]
    ds_read_b64 v[58:59], v58
    s_mov_b64 exec, s[72:73]
    ds_read_b64 v[60:61], v60
    s_mov_b64 exec, s[74:75]
    ds_read_b64 v[62:63], v62
    s_mov_b64 exec, s[76:77]
    ds_read_b64 v[64:65], v64
    s_mov_b64 exec, s[78:79]
    ds_read_b64 v[66:67], v66
    s_mov_b64 exec, s[80:81]
    ds_read_b64 v[68:69], v68
    s_mov_b64 exec, s[82:83]
    ds_read_b64 v[70:71], v70
    s_mov_b64 exec, s[84:85]
    ds_read_b64 v[72:73], v72
    s_mov_b64 exec, s[86:87]
    ds_read_b64 v[74:75], v74
    s_mov_b64 exec, -1
    s_waitcnt lgkmcnt(0)
    s_barrier
    s_waitcnt vmcnt(5)
    ds_write_b128 v3, v[76:79] offset:0
    s_waitcnt vmcnt(4)
    ds_write_b128 v3, v[80:83] offset:16384
    s_waitcnt vmcnt(3)
    ds_write_b128 v3, v[84:87] offset:32768
    v_lshlrev_b32 v123, 2, v0
    s_waitcnt vmcnt(2)
    s_mov_b64 exec, s[48:49]
    ds_write_b32 v123, v88 offset:49152
    s_mov_b64 exec, -1

    s_add_u32 s43, s43, 50000
    s_add_u32 s14, s43, 50000
    buffer_load_dwordx4 v[76:79], v3, s[12:15], s43 offen
    s_add_u32 s52, s43, 16384
    buffer_load_dwordx4 v[80:83], v3, s[12:15], s52 offen
    v_subrev_co_u32 v4, s[64:65], 2.0, v4
    v_subrev_co_u32 v5, s[66:67], 2.0, v5
    v_subrev_co_u32 v6, s[68:69], 2.0, v6
    v_subrev_co_u32 v7, s[70:71], 2.0, v7
    v_subrev_co_u32 v8, s[72:73], 2.0, v8
    v_subrev_co_u32 v9, s[74:75], 2.0, v9
    v_subrev_co_u32 v10, s[76:77], 2.0, v10
    v_subrev_co_u32 v11, s[78:79], 2.0, v11
    v_subrev_co_u32 v12, s[80:81], 2.0, v12
    v_subrev_co_u32 v13, s[82:83], 2.0, v13
    v_subrev_co_u32 v14, s[84:85], 2.0, v14
    v_subrev_co_u32 v15, s[86:87], 2.0, v15
    s_waitcnt lgkmcnt(0)
    s_barrier
    s_add_u32 s52, s43, 32768
    buffer_load_dwordx4 v[84:87], v3, s[12:15], s52 offen
    s_add_u32 s52, s43, 49152
    v_lshlrev_b32 v123, 2, v0
    buffer_load_dword v88, v123, s[12:15], s52 offen
    s_mov_b64 exec, s[64:65]
    ds_read_b64 v[28:29], v28
    s_mov_b64 exec, s[66:67]
    ds_read_b64 v[30:31], v30
    s_mov_b64 exec, s[68:69]
    ds_read_b64 v[32:33], v32
    s_mov_b64 exec, s[70:71]
    ds_read_b64 v[34:35], v34
    s_mov_b64 exec, s[72:73]
    ds_read_b64 v[36:37], v36
    s_mov_b64 exec, s[74:75]
    ds_read_b64 v[38:39], v38
    s_mov_b64 exec, s[76:77]
    ds_read_b64 v[40:41], v40
    s_mov_b64 exec, s[78:79]
    ds_read_b64 v[42:43], v42
    s_mov_b64 exec, s[80:81]
    ds_read_b64 v[44:45], v44
    s_mov_b64 exec, s[82:83]
    ds_read_b64 v[46:47], v46
    s_mov_b64 exec, s[84:85]
    ds_read_b64 v[48:49], v48
    s_mov_b64 exec, s[86:87]
    ds_read_b64 v[50:51], v50
    s_mov_b64 exec, -1
    s_movk_i32 s53, 10240
    buffer_load_dwordx4 v[98:101], v2, s[16:19], s53 offen
    buffer_load_dword v112, v2, s[16:19], s53 offen offset:16
    v_subrev_co_u32 v16, s[64:65], 2.0, v16
    v_subrev_co_u32 v17, s[66:67], 2.0, v17
    v_subrev_co_u32 v18, s[68:69], 2.0, v18
    v_subrev_co_u32 v19, s[70:71], 2.0, v19
    v_subrev_co_u32 v20, s[72:73], 2.0, v20
    v_subrev_co_u32 v21, s[74:75], 2.0, v21
    v_subrev_co_u32 v22, s[76:77], 2.0, v22
    v_subrev_co_u32 v23, s[78:79], 2.0, v23
    v_subrev_co_u32 v24, s[80:81], 2.0, v24
    v_subrev_co_u32 v25, s[82:83], 2.0, v25
    v_subrev_co_u32 v26, s[84:85], 2.0, v26
    v_subrev_co_u32 v27, s[86:87], 2.0, v27
    s_mov_b64 exec, s[64:65]
    ds_read_b64 v[52:53], v52
    s_mov_b64 exec, s[66:67]
    ds_read_b64 v[54:55], v54
    s_mov_b64 exec, s[68:69]
    ds_read_b64 v[56:57], v56
    s_mov_b64 exec, s[70:71]
    ds_read_b64 v[58:59], v58
    s_mov_b64 exec, s[72:73]
    ds_read_b64 v[60:61], v60
    s_mov_b64 exec, s[74:75]
    ds_read_b64 v[62:63], v62
    s_mov_b64 exec, s[76:77]
    ds_read_b64 v[64:65], v64
    s_mov_b64 exec, s[78:79]
    ds_read_b64 v[66:67], v66
    s_mov_b64 exec, s[80:81]
    ds_read_b64 v[68:69], v68
    s_mov_b64 exec, s[82:83]
    ds_read_b64 v[70:71], v70
    s_mov_b64 exec, s[84:85]
    ds_read_b64 v[72:73], v72
    s_mov_b64 exec, s[86:87]
    ds_read_b64 v[74:75], v74
    s_mov_b64 exec, -1
    s_waitcnt lgkmcnt(0)
    s_barrier
    s_waitcnt vmcnt(5)
    ds_write_b128 v3, v[76:79] offset:0
    s_waitcnt vmcnt(4)
    ds_write_b128 v3, v[80:83] offset:16384
    s_waitcnt vmcnt(3)
    ds_write_b128 v3, v[84:87] offset:32768
    v_lshlrev_b32 v123, 2, v0
    s_waitcnt vmcnt(2)
    s_mov_b64 exec, s[48:49]
    ds_write_b32 v123, v88 offset:49152
    s_mov_b64 exec, -1

    s_add_u32 s43, s43, 50000
    s_add_u32 s14, s43, 50000
    s_cmp_lt_u32 s5, s4
    s_cselect_b32 s14, s14, 0
    buffer_load_dwordx4 v[76:79], v3, s[12:15], s43 offen
    s_add_u32 s52, s43, 16384
    buffer_load_dwordx4 v[80:83], v3, s[12:15], s52 offen
    v_cmp_gt_u32 s[64:65], 2.0, v4
    v_and_b32 v4, 0x3fffffff, v4
    v_cmp_gt_u32 s[66:67], 2.0, v5
    v_and_b32 v5, 0x3fffffff, v5
    v_cmp_gt_u32 s[68:69], 2.0, v6
    v_and_b32 v6, 0x3fffffff, v6
    v_cmp_gt_u32 s[70:71], 2.0, v7
    v_and_b32 v7, 0x3fffffff, v7
    v_cmp_gt_u32 s[72:73], 2.0, v8
    v_and_b32 v8, 0x3fffffff, v8
    v_cmp_gt_u32 s[74:75], 2.0, v9
    v_and_b32 v9, 0x3fffffff, v9
    v_cmp_gt_u32 s[76:77], 2.0, v10
    v_and_b32 v10, 0x3fffffff, v10
    v_cmp_gt_u32 s[78:79], 2.0, v11
    v_and_b32 v11, 0x3fffffff, v11
    v_cmp_gt_u32 s[80:81], 2.0, v12
    v_and_b32 v12, 0x3fffffff, v12
    v_cmp_gt_u32 s[82:83], 2.0, v13
    v_and_b32 v13, 0x3fffffff, v13
    v_cmp_gt_u32 s[84:85], 2.0, v14
    v_and_b32 v14, 0x3fffffff, v14
    v_cmp_gt_u32 s[86:87], 2.0, v15
    v_and_b32 v15, 0x3fffffff, v15
    s_waitcnt lgkmcnt(0)
    s_barrier
    s_add_u32 s52, s43, 32768
    buffer_load_dwordx4 v[84:87], v3, s[12:15], s52 offen
    s_add_u32 s52, s43, 49152
    v_lshlrev_b32 v123, 2, v0
    buffer_load_dword v88, v123, s[12:15], s52 offen
    s_mov_b64 exec, s[64:65]
    ds_read_b64 v[28:29], v28
    s_mov_b64 exec, s[66:67]
    ds_read_b64 v[30:31], v30
    s_mov_b64 exec, s[68:69]
    ds_read_b64 v[32:33], v32
    s_mov_b64 exec, s[70:71]
    ds_read_b64 v[34:35], v34
    s_mov_b64 exec, s[72:73]
    ds_read_b64 v[36:37], v36
    s_mov_b64 exec, s[74:75]
    ds_read_b64 v[38:39], v38
    s_mov_b64 exec, s[76:77]
    ds_read_b64 v[40:41], v40
    s_mov_b64 exec, s[78:79]
    ds_read_b64 v[42:43], v42
    s_mov_b64 exec, s[80:81]
    ds_read_b64 v[44:45], v44
    s_mov_b64 exec, s[82:83]
    ds_read_b64 v[46:47], v46
    s_mov_b64 exec, s[84:85]
    ds_read_b64 v[48:49], v48
    s_mov_b64 exec, s[86:87]
    ds_read_b64 v[50:51], v50
    s_mov_b64 exec, -1
    s_movk_i32 s53, 12800
    buffer_load_dwordx4 v[102:105], v2, s[16:19], s53 offen
    buffer_load_dword v113, v2, s[16:19], s53 offen offset:16
    v_cmp_gt_u32 s[64:65], 2.0, v16
    v_and_b32 v16, 0x3fffffff, v16
    v_cmp_gt_u32 s[66:67], 2.0, v17
    v_and_b32 v17, 0x3fffffff, v17
    v_cmp_gt_u32 s[68:69], 2.0, v18
    v_and_b32 v18, 0x3fffffff, v18
    v_cmp_gt_u32 s[70:71], 2.0, v19
    v_and_b32 v19, 0x3fffffff, v19
    v_cmp_gt_u32 s[72:73], 2.0, v20
    v_and_b32 v20, 0x3fffffff, v20
    v_cmp_gt_u32 s[74:75], 2.0, v21
    v_and_b32 v21, 0x3fffffff, v21
    v_cmp_gt_u32 s[76:77], 2.0, v22
    v_and_b32 v22, 0x3fffffff, v22
    v_cmp_gt_u32 s[78:79], 2.0, v23
    v_and_b32 v23, 0x3fffffff, v23
    v_cmp_gt_u32 s[80:81], 2.0, v24
    v_and_b32 v24, 0x3fffffff, v24
    v_cmp_gt_u32 s[82:83], 2.0, v25
    v_and_b32 v25, 0x3fffffff, v25
    v_cmp_gt_u32 s[84:85], 2.0, v26
    v_and_b32 v26, 0x3fffffff, v26
    v_cmp_gt_u32 s[86:87], 2.0, v27
    v_and_b32 v27, 0x3fffffff, v27
    s_mov_b64 exec, s[64:65]
    ds_read_b64 v[52:53], v52
    s_mov_b64 exec, s[66:67]
    ds_read_b64 v[54:55], v54
    s_mov_b64 exec, s[68:69]
    ds_read_b64 v[56:57], v56
    s_mov_b64 exec, s[70:71]
    ds_read_b64 v[58:59], v58
    s_mov_b64 exec, s[72:73]
    ds_read_b64 v[60:61], v60
    s_mov_b64 exec, s[74:75]
    ds_read_b64 v[62:63], v62
    s_mov_b64 exec, s[76:77]
    ds_read_b64 v[64:65], v64
    s_mov_b64 exec, s[78:79]
    ds_read_b64 v[66:67], v66
    s_mov_b64 exec, s[80:81]
    ds_read_b64 v[68:69], v68
    s_mov_b64 exec, s[82:83]
    ds_read_b64 v[70:71], v70
    s_mov_b64 exec, s[84:85]
    ds_read_b64 v[72:73], v72
    s_mov_b64 exec, s[86:87]
    ds_read_b64 v[74:75], v74
    s_mov_b64 exec, -1
    s_waitcnt lgkmcnt(0)
    s_barrier
    s_waitcnt vmcnt(5)
    ds_write_b128 v3, v[76:79] offset:0
    s_waitcnt vmcnt(4)
    ds_write_b128 v3, v[80:83] offset:16384
    s_waitcnt vmcnt(3)
    ds_write_b128 v3, v[84:87] offset:32768
    v_lshlrev_b32 v123, 2, v0
    s_waitcnt vmcnt(2)
    s_mov_b64 exec, s[48:49]
    ds_write_b32 v123, v88 offset:49152
    s_mov_b64 exec, -1

    s_add_u32 s43, s43, 50000
    s_add_u32 s14, s43, 50000
    s_cmp_lt_u32 s5, s4
    s_cselect_b32 s14, s14, 0
    buffer_load_dwordx4 v[76:79], v3, s[12:15], s43 offen
    s_add_u32 s52, s43, 16384
    buffer_load_dwordx4 v[80:83], v3, s[12:15], s52 offen
    s_add_u32 s52, s43, 32768
    buffer_load_dwordx4 v[84:87], v3, s[12:15], s52 offen
    s_add_u32 s52, s43, 49152
    v_lshlrev_b32 v123, 2, v0
    buffer_load_dword v88, v123, s[12:15], s52 offen
    s_add_u32 s54, s43, 50000
    buffer_load_dword v115, v89, s[8:11], s54 offen
    v_cvt_f32_i32_sdwa v118, sext(v4) dst_sel:DWORD dst_unused:UNUSED_PAD src0_sel:WORD_0
    v_lshlrev_b32 v116, 16, v28
    v_and_b32 v117, s32, v28
    v_mul_f32 v118, s33, v118
    v_lshlrev_b32 v28, 16, v29
    v_and_b32 v29, s32, v29
    v_lshlrev_b32_sdwa v4, 3, v4 dst_sel:DWORD dst_unused:UNUSED_PAD src0_sel:DWORD src1_sel:WORD_1
    v_pk_fma_f32 v[116:117], v[116:117], v[118:119], s[28:29] op_sel_hi:[1,0,1]
    v_pk_fma_f32 v[28:29], v[28:29], v[118:119], s[28:29] op_sel_hi:[1,0,1]
    v_perm_b32 v116, v117, v116, s35
    v_perm_b32 v117, v29, v28, s35
    v_lshl_add_u64 v[116:117], v[116:117], 0, s[30:31]
    ds_add_rtn_u64 v[28:29], v4, v[116:117] offset:50000

    v_cvt_f32_i32_sdwa v122, sext(v5) dst_sel:DWORD dst_unused:UNUSED_PAD src0_sel:WORD_0
    v_lshlrev_b32 v120, 16, v30
    v_and_b32 v121, s32, v30
    v_mul_f32 v122, s33, v122
    v_lshlrev_b32 v30, 16, v31
    v_and_b32 v31, s32, v31
    v_lshlrev_b32_sdwa v5, 3, v5 dst_sel:DWORD dst_unused:UNUSED_PAD src0_sel:DWORD src1_sel:WORD_1
    v_pk_fma_f32 v[120:121], v[120:121], v[122:123], s[28:29] op_sel_hi:[1,0,1]
    v_pk_fma_f32 v[30:31], v[30:31], v[122:123], s[28:29] op_sel_hi:[1,0,1]
    v_perm_b32 v120, v121, v120, s35
    v_perm_b32 v121, v31, v30, s35
    v_lshl_add_u64 v[120:121], v[120:121], 0, s[30:31]
    ds_add_rtn_u64 v[30:31], v5, v[120:121] offset:50000

    v_cvt_f32_i32_sdwa v118, sext(v6) dst_sel:DWORD dst_unused:UNUSED_PAD src0_sel:WORD_0
    v_lshlrev_b32 v116, 16, v32
    v_and_b32 v117, s32, v32
    v_mul_f32 v118, s33, v118
    v_lshlrev_b32 v32, 16, v33
    v_and_b32 v33, s32, v33
    v_lshlrev_b32_sdwa v6, 3, v6 dst_sel:DWORD dst_unused:UNUSED_PAD src0_sel:DWORD src1_sel:WORD_1
    v_pk_fma_f32 v[116:117], v[116:117], v[118:119], s[28:29] op_sel_hi:[1,0,1]
    v_pk_fma_f32 v[32:33], v[32:33], v[118:119], s[28:29] op_sel_hi:[1,0,1]
    v_perm_b32 v116, v117, v116, s35
    v_perm_b32 v117, v33, v32, s35
    v_lshl_add_u64 v[116:117], v[116:117], 0, s[30:31]
    ds_add_rtn_u64 v[32:33], v6, v[116:117] offset:50000

    v_cvt_f32_i32_sdwa v122, sext(v7) dst_sel:DWORD dst_unused:UNUSED_PAD src0_sel:WORD_0
    v_lshlrev_b32 v120, 16, v34
    v_and_b32 v121, s32, v34
    v_mul_f32 v122, s33, v122
    v_lshlrev_b32 v34, 16, v35
    v_and_b32 v35, s32, v35
    v_lshlrev_b32_sdwa v7, 3, v7 dst_sel:DWORD dst_unused:UNUSED_PAD src0_sel:DWORD src1_sel:WORD_1
    v_pk_fma_f32 v[120:121], v[120:121], v[122:123], s[28:29] op_sel_hi:[1,0,1]
    v_pk_fma_f32 v[34:35], v[34:35], v[122:123], s[28:29] op_sel_hi:[1,0,1]
    v_perm_b32 v120, v121, v120, s35
    v_perm_b32 v121, v35, v34, s35
    v_lshl_add_u64 v[120:121], v[120:121], 0, s[30:31]
    ds_add_rtn_u64 v[34:35], v7, v[120:121] offset:50000

    v_cvt_f32_i32_sdwa v118, sext(v8) dst_sel:DWORD dst_unused:UNUSED_PAD src0_sel:WORD_0
    v_lshlrev_b32 v116, 16, v36
    v_and_b32 v117, s32, v36
    v_mul_f32 v118, s33, v118
    v_lshlrev_b32 v36, 16, v37
    v_and_b32 v37, s32, v37
    v_lshlrev_b32_sdwa v8, 3, v8 dst_sel:DWORD dst_unused:UNUSED_PAD src0_sel:DWORD src1_sel:WORD_1
    v_pk_fma_f32 v[116:117], v[116:117], v[118:119], s[28:29] op_sel_hi:[1,0,1]
    v_pk_fma_f32 v[36:37], v[36:37], v[118:119], s[28:29] op_sel_hi:[1,0,1]
    v_perm_b32 v116, v117, v116, s35
    v_perm_b32 v117, v37, v36, s35
    v_lshl_add_u64 v[116:117], v[116:117], 0, s[30:31]
    ds_add_rtn_u64 v[36:37], v8, v[116:117] offset:50000

    v_cvt_f32_i32_sdwa v122, sext(v9) dst_sel:DWORD dst_unused:UNUSED_PAD src0_sel:WORD_0
    v_lshlrev_b32 v120, 16, v38
    v_and_b32 v121, s32, v38
    v_mul_f32 v122, s33, v122
    v_lshlrev_b32 v38, 16, v39
    v_and_b32 v39, s32, v39
    v_lshlrev_b32_sdwa v9, 3, v9 dst_sel:DWORD dst_unused:UNUSED_PAD src0_sel:DWORD src1_sel:WORD_1
    v_pk_fma_f32 v[120:121], v[120:121], v[122:123], s[28:29] op_sel_hi:[1,0,1]
    v_pk_fma_f32 v[38:39], v[38:39], v[122:123], s[28:29] op_sel_hi:[1,0,1]
    v_perm_b32 v120, v121, v120, s35
    v_perm_b32 v121, v39, v38, s35
    v_lshl_add_u64 v[120:121], v[120:121], 0, s[30:31]
    ds_add_rtn_u64 v[38:39], v9, v[120:121] offset:50000

    v_cvt_f32_i32_sdwa v118, sext(v10) dst_sel:DWORD dst_unused:UNUSED_PAD src0_sel:WORD_0
    v_lshlrev_b32 v116, 16, v40
    v_and_b32 v117, s32, v40
    v_mul_f32 v118, s33, v118
    v_lshlrev_b32 v40, 16, v41
    v_and_b32 v41, s32, v41
    v_lshlrev_b32_sdwa v10, 3, v10 dst_sel:DWORD dst_unused:UNUSED_PAD src0_sel:DWORD src1_sel:WORD_1
    v_pk_fma_f32 v[116:117], v[116:117], v[118:119], s[28:29] op_sel_hi:[1,0,1]
    v_pk_fma_f32 v[40:41], v[40:41], v[118:119], s[28:29] op_sel_hi:[1,0,1]
    v_perm_b32 v116, v117, v116, s35
    v_perm_b32 v117, v41, v40, s35
    v_lshl_add_u64 v[116:117], v[116:117], 0, s[30:31]
    ds_add_rtn_u64 v[40:41], v10, v[116:117] offset:50000

    v_cvt_f32_i32_sdwa v122, sext(v11) dst_sel:DWORD dst_unused:UNUSED_PAD src0_sel:WORD_0
    v_lshlrev_b32 v120, 16, v42
    v_and_b32 v121, s32, v42
    v_mul_f32 v122, s33, v122
    v_lshlrev_b32 v42, 16, v43
    v_and_b32 v43, s32, v43
    v_lshlrev_b32_sdwa v11, 3, v11 dst_sel:DWORD dst_unused:UNUSED_PAD src0_sel:DWORD src1_sel:WORD_1
    v_pk_fma_f32 v[120:121], v[120:121], v[122:123], s[28:29] op_sel_hi:[1,0,1]
    v_pk_fma_f32 v[42:43], v[42:43], v[122:123], s[28:29] op_sel_hi:[1,0,1]
    v_perm_b32 v120, v121, v120, s35
    v_perm_b32 v121, v43, v42, s35
    v_lshl_add_u64 v[120:121], v[120:121], 0, s[30:31]
    ds_add_rtn_u64 v[42:43], v11, v[120:121] offset:50000

    s_waitcnt lgkmcnt(4)
    v_or3_b32 v1, v28, v29, v1
    v_or3_b32 v1, v30, v31, v1
    v_or3_b32 v1, v32, v33, v1
    v_or3_b32 v1, v34, v35, v1
    s_movk_i32 s53, 0
    buffer_load_dwordx4 v[4:7], v2, s[16:19], s53 offen
    buffer_load_dword v35, v2, s[16:19], s53 offen offset:16
    v_cvt_f32_i32_sdwa v118, sext(v12) dst_sel:DWORD dst_unused:UNUSED_PAD src0_sel:WORD_0
    v_lshlrev_b32 v116, 16, v44
    v_and_b32 v117, s32, v44
    v_mul_f32 v118, s33, v118
    v_lshlrev_b32 v44, 16, v45
    v_and_b32 v45, s32, v45
    v_lshlrev_b32_sdwa v12, 3, v12 dst_sel:DWORD dst_unused:UNUSED_PAD src0_sel:DWORD src1_sel:WORD_1
    v_pk_fma_f32 v[116:117], v[116:117], v[118:119], s[28:29] op_sel_hi:[1,0,1]
    v_pk_fma_f32 v[44:45], v[44:45], v[118:119], s[28:29] op_sel_hi:[1,0,1]
    v_perm_b32 v116, v117, v116, s35
    v_perm_b32 v117, v45, v44, s35
    v_lshl_add_u64 v[116:117], v[116:117], 0, s[30:31]
    ds_add_rtn_u64 v[44:45], v12, v[116:117] offset:50000

    v_cvt_f32_i32_sdwa v122, sext(v13) dst_sel:DWORD dst_unused:UNUSED_PAD src0_sel:WORD_0
    v_lshlrev_b32 v120, 16, v46
    v_and_b32 v121, s32, v46
    v_mul_f32 v122, s33, v122
    v_lshlrev_b32 v46, 16, v47
    v_and_b32 v47, s32, v47
    v_lshlrev_b32_sdwa v13, 3, v13 dst_sel:DWORD dst_unused:UNUSED_PAD src0_sel:DWORD src1_sel:WORD_1
    v_pk_fma_f32 v[120:121], v[120:121], v[122:123], s[28:29] op_sel_hi:[1,0,1]
    v_pk_fma_f32 v[46:47], v[46:47], v[122:123], s[28:29] op_sel_hi:[1,0,1]
    v_perm_b32 v120, v121, v120, s35
    v_perm_b32 v121, v47, v46, s35
    v_lshl_add_u64 v[120:121], v[120:121], 0, s[30:31]
    ds_add_rtn_u64 v[46:47], v13, v[120:121] offset:50000

    v_cvt_f32_i32_sdwa v118, sext(v14) dst_sel:DWORD dst_unused:UNUSED_PAD src0_sel:WORD_0
    v_lshlrev_b32 v116, 16, v48
    v_and_b32 v117, s32, v48
    v_mul_f32 v118, s33, v118
    v_lshlrev_b32 v48, 16, v49
    v_and_b32 v49, s32, v49
    v_lshlrev_b32_sdwa v14, 3, v14 dst_sel:DWORD dst_unused:UNUSED_PAD src0_sel:DWORD src1_sel:WORD_1
    v_pk_fma_f32 v[116:117], v[116:117], v[118:119], s[28:29] op_sel_hi:[1,0,1]
    v_pk_fma_f32 v[48:49], v[48:49], v[118:119], s[28:29] op_sel_hi:[1,0,1]
    v_perm_b32 v116, v117, v116, s35
    v_perm_b32 v117, v49, v48, s35
    v_lshl_add_u64 v[116:117], v[116:117], 0, s[30:31]
    ds_add_rtn_u64 v[48:49], v14, v[116:117] offset:50000

    v_cvt_f32_i32_sdwa v122, sext(v15) dst_sel:DWORD dst_unused:UNUSED_PAD src0_sel:WORD_0
    v_lshlrev_b32 v120, 16, v50
    v_and_b32 v121, s32, v50
    v_mul_f32 v122, s33, v122
    v_lshlrev_b32 v50, 16, v51
    v_and_b32 v51, s32, v51
    v_lshlrev_b32_sdwa v15, 3, v15 dst_sel:DWORD dst_unused:UNUSED_PAD src0_sel:DWORD src1_sel:WORD_1
    v_pk_fma_f32 v[120:121], v[120:121], v[122:123], s[28:29] op_sel_hi:[1,0,1]
    v_pk_fma_f32 v[50:51], v[50:51], v[122:123], s[28:29] op_sel_hi:[1,0,1]
    v_perm_b32 v120, v121, v120, s35
    v_perm_b32 v121, v51, v50, s35
    v_lshl_add_u64 v[120:121], v[120:121], 0, s[30:31]
    ds_add_rtn_u64 v[50:51], v15, v[120:121] offset:50000

    s_waitcnt lgkmcnt(4)
    v_or3_b32 v1, v36, v37, v1
    v_or3_b32 v1, v38, v39, v1
    v_or3_b32 v1, v40, v41, v1
    v_or3_b32 v1, v42, v43, v1
    s_movk_i32 s53, 2560
    buffer_load_dwordx4 v[8:11], v2, s[16:19], s53 offen
    buffer_load_dword v43, v2, s[16:19], s53 offen offset:16
    v_cvt_f32_i32_sdwa v118, sext(v16) dst_sel:DWORD dst_unused:UNUSED_PAD src0_sel:WORD_0
    v_lshlrev_b32 v116, 16, v52
    v_and_b32 v117, s32, v52
    v_mul_f32 v118, s33, v118
    v_lshlrev_b32 v52, 16, v53
    v_and_b32 v53, s32, v53
    v_lshlrev_b32_sdwa v16, 3, v16 dst_sel:DWORD dst_unused:UNUSED_PAD src0_sel:DWORD src1_sel:WORD_1
    v_pk_fma_f32 v[116:117], v[116:117], v[118:119], s[28:29] op_sel_hi:[1,0,1]
    v_pk_fma_f32 v[52:53], v[52:53], v[118:119], s[28:29] op_sel_hi:[1,0,1]
    v_perm_b32 v116, v117, v116, s35
    v_perm_b32 v117, v53, v52, s35
    v_lshl_add_u64 v[116:117], v[116:117], 0, s[30:31]
    ds_add_rtn_u64 v[52:53], v16, v[116:117] offset:50000

    v_cvt_f32_i32_sdwa v122, sext(v17) dst_sel:DWORD dst_unused:UNUSED_PAD src0_sel:WORD_0
    v_lshlrev_b32 v120, 16, v54
    v_and_b32 v121, s32, v54
    v_mul_f32 v122, s33, v122
    v_lshlrev_b32 v54, 16, v55
    v_and_b32 v55, s32, v55
    v_lshlrev_b32_sdwa v17, 3, v17 dst_sel:DWORD dst_unused:UNUSED_PAD src0_sel:DWORD src1_sel:WORD_1
    v_pk_fma_f32 v[120:121], v[120:121], v[122:123], s[28:29] op_sel_hi:[1,0,1]
    v_pk_fma_f32 v[54:55], v[54:55], v[122:123], s[28:29] op_sel_hi:[1,0,1]
    v_perm_b32 v120, v121, v120, s35
    v_perm_b32 v121, v55, v54, s35
    v_lshl_add_u64 v[120:121], v[120:121], 0, s[30:31]
    ds_add_rtn_u64 v[54:55], v17, v[120:121] offset:50000

    v_cvt_f32_i32_sdwa v118, sext(v18) dst_sel:DWORD dst_unused:UNUSED_PAD src0_sel:WORD_0
    v_lshlrev_b32 v116, 16, v56
    v_and_b32 v117, s32, v56
    v_mul_f32 v118, s33, v118
    v_lshlrev_b32 v56, 16, v57
    v_and_b32 v57, s32, v57
    v_lshlrev_b32_sdwa v18, 3, v18 dst_sel:DWORD dst_unused:UNUSED_PAD src0_sel:DWORD src1_sel:WORD_1
    v_pk_fma_f32 v[116:117], v[116:117], v[118:119], s[28:29] op_sel_hi:[1,0,1]
    v_pk_fma_f32 v[56:57], v[56:57], v[118:119], s[28:29] op_sel_hi:[1,0,1]
    v_perm_b32 v116, v117, v116, s35
    v_perm_b32 v117, v57, v56, s35
    v_lshl_add_u64 v[116:117], v[116:117], 0, s[30:31]
    ds_add_rtn_u64 v[56:57], v18, v[116:117] offset:50000

    v_cvt_f32_i32_sdwa v122, sext(v19) dst_sel:DWORD dst_unused:UNUSED_PAD src0_sel:WORD_0
    v_lshlrev_b32 v120, 16, v58
    v_and_b32 v121, s32, v58
    v_mul_f32 v122, s33, v122
    v_lshlrev_b32 v58, 16, v59
    v_and_b32 v59, s32, v59
    v_lshlrev_b32_sdwa v19, 3, v19 dst_sel:DWORD dst_unused:UNUSED_PAD src0_sel:DWORD src1_sel:WORD_1
    v_pk_fma_f32 v[120:121], v[120:121], v[122:123], s[28:29] op_sel_hi:[1,0,1]
    v_pk_fma_f32 v[58:59], v[58:59], v[122:123], s[28:29] op_sel_hi:[1,0,1]
    v_perm_b32 v120, v121, v120, s35
    v_perm_b32 v121, v59, v58, s35
    v_lshl_add_u64 v[120:121], v[120:121], 0, s[30:31]
    ds_add_rtn_u64 v[58:59], v19, v[120:121] offset:50000

    s_waitcnt lgkmcnt(4)
    v_or3_b32 v1, v44, v45, v1
    v_or3_b32 v1, v46, v47, v1
    v_or3_b32 v1, v48, v49, v1
    v_or3_b32 v1, v50, v51, v1
    s_cmp_le_i32 s42, 3072
    s_cbranch_scc1 L_nt1_32
    s_waitcnt vmcnt(29)
    v_perm_b32 v116, v107, v106, s24
    v_perm_b32 v118, v108, v107, s25
    v_perm_b32 v120, v109, v108, s26
    v_perm_b32 v122, v114, v109, s27
    v_alignbyte_b32 v107, v108, v107, 1
    v_alignbyte_b32 v108, v109, v108, 2
    v_alignbyte_b32 v109, v114, v109, 3
    v_lshlrev_b32_sdwa v116, 3, v116 dst_sel:WORD_0 dst_unused:UNUSED_PAD src0_sel:DWORD src1_sel:DWORD
    v_lshlrev_b32_sdwa v118, 3, v118 dst_sel:WORD_0 dst_unused:UNUSED_PAD src0_sel:DWORD src1_sel:DWORD
    v_lshlrev_b32_sdwa v120, 3, v120 dst_sel:WORD_0 dst_unused:UNUSED_PAD src0_sel:DWORD src1_sel:DWORD
    v_lshlrev_b32_sdwa v122, 3, v122 dst_sel:WORD_0 dst_unused:UNUSED_PAD src0_sel:DWORD src1_sel:DWORD
    s_cmp_lt_i32 s42, 3328
    s_cbranch_scc1 L_ufix_34
L_uback_35:

    v_lshrrev_b32 v117, 30, v106
    v_cmp_ne_u32 vcc, 0, v106
    v_mul_u32_u24 v117, 50000, v117
    v_and_b32 v106, 0x3fffffff, v106
    v_add_u32 v116, v116, v117
    s_mov_b64 s[64:65], vcc
    s_mov_b64 exec, vcc

    buffer_load_dwordx2 v[44:45], v116, s[8:11], s50 offen
    s_mov_b64 exec, -1
    v_lshrrev_b32 v117, 30, v107
    v_cmp_ne_u32 vcc, 0, v107
    v_mul_u32_u24 v117, 50000, v117
    v_and_b32 v107, 0x3fffffff, v107
    v_add_u32 v118, v118, v117
    s_mov_b64 s[66:67], vcc
    s_mov_b64 exec, vcc

    buffer_load_dwordx2 v[46:47], v118, s[8:11], s50 offen
    s_mov_b64 exec, -1
    v_lshrrev_b32 v117, 30, v108
    v_cmp_ne_u32 vcc, 0, v108
    v_mul_u32_u24 v117, 50000, v117
    v_and_b32 v108, 0x3fffffff, v108
    v_add_u32 v120, v120, v117
    s_mov_b64 s[68:69], vcc
    s_mov_b64 exec, vcc

    buffer_load_dwordx2 v[48:49], v120, s[8:11], s50 offen
    s_mov_b64 exec, -1
    v_lshrrev_b32 v117, 30, v109
    v_cmp_ne_u32 vcc, 0, v109
    v_mul_u32_u24 v117, 50000, v117
    v_and_b32 v109, 0x3fffffff, v109
    v_add_u32 v122, v122, v117
    s_mov_b64 s[70:71], vcc
    s_mov_b64 exec, vcc

    buffer_load_dwordx2 v[50:51], v122, s[8:11], s50 offen
    s_mov_b64 exec, -1
L_nt1_32:
    v_cvt_f32_i32_sdwa v118, sext(v20) dst_sel:DWORD dst_unused:UNUSED_PAD src0_sel:WORD_0
    v_lshlrev_b32 v116, 16, v60
    v_and_b32 v117, s32, v60
    v_mul_f32 v118, s33, v118
    v_lshlrev_b32 v60, 16, v61
    v_and_b32 v61, s32, v61
    v_lshlrev_b32_sdwa v20, 3, v20 dst_sel:DWORD dst_unused:UNUSED_PAD src0_sel:DWORD src1_sel:WORD_1
    v_pk_fma_f32 v[116:117], v[116:117], v[118:119], s[28:29] op_sel_hi:[1,0,1]
    v_pk_fma_f32 v[60:61], v[60:61], v[118:119], s[28:29] op_sel_hi:[1,0,1]
    v_perm_b32 v116, v117, v116, s35
    v_perm_b32 v117, v61, v60, s35
    v_lshl_add_u64 v[116:117], v[116:117], 0, s[30:31]
    ds_add_rtn_u64 v[60:61], v20, v[116:117] offset:50000

    v_cvt_f32_i32_sdwa v122, sext(v21) dst_sel:DWORD dst_unused:UNUSED_PAD src0_sel:WORD_0
    v_lshlrev_b32 v120, 16, v62
    v_and_b32 v121, s32, v62
    v_mul_f32 v122, s33, v122
    v_lshlrev_b32 v62, 16, v63
    v_and_b32 v63, s32, v63
    v_lshlrev_b32_sdwa v21, 3, v21 dst_sel:DWORD dst_unused:UNUSED_PAD src0_sel:DWORD src1_sel:WORD_1
    v_pk_fma_f32 v[120:121], v[120:121], v[122:123], s[28:29] op_sel_hi:[1,0,1]
    v_pk_fma_f32 v[62:63], v[62:63], v[122:123], s[28:29] op_sel_hi:[1,0,1]
    v_perm_b32 v120, v121, v120, s35
    v_perm_b32 v121, v63, v62, s35
    v_lshl_add_u64 v[120:121], v[120:121], 0, s[30:31]
    ds_add_rtn_u64 v[62:63], v21, v[120:121] offset:50000

    v_cvt_f32_i32_sdwa v118, sext(v22) dst_sel:DWORD dst_unused:UNUSED_PAD src0_sel:WORD_0
    v_lshlrev_b32 v116, 16, v64
    v_and_b32 v117, s32, v64
    v_mul_f32 v118, s33, v118
    v_lshlrev_b32 v64, 16, v65
    v_and_b32 v65, s32, v65
    v_lshlrev_b32_sdwa v22, 3, v22 dst_sel:DWORD dst_unused:UNUSED_PAD src0_sel:DWORD src1_sel:WORD_1
    v_pk_fma_f32 v[116:117], v[116:117], v[118:119], s[28:29] op_sel_hi:[1,0,1]
    v_pk_fma_f32 v[64:65], v[64:65], v[118:119], s[28:29] op_sel_hi:[1,0,1]
    v_perm_b32 v116, v117, v116, s35
    v_perm_b32 v117, v65, v64, s35
    v_lshl_add_u64 v[116:117], v[116:117], 0, s[30:31]
    ds_add_rtn_u64 v[64:65], v22, v[116:117] offset:50000

    v_cvt_f32_i32_sdwa v122, sext(v23) dst_sel:DWORD dst_unused:UNUSED_PAD src0_sel:WORD_0
    v_lshlrev_b32 v120, 16, v66
    v_and_b32 v121, s32, v66
    v_mul_f32 v122, s33, v122
    v_lshlrev_b32 v66, 16, v67
    v_and_b32 v67, s32, v67
    v_lshlrev_b32_sdwa v23, 3, v23 dst_sel:DWORD dst_unused:UNUSED_PAD src0_sel:DWORD src1_sel:WORD_1
    v_pk_fma_f32 v[120:121], v[120:121], v[122:123], s[28:29] op_sel_hi:[1,0,1]
    v_pk_fma_f32 v[66:67], v[66:67], v[122:123], s[28:29] op_sel_hi:[1,0,1]
    v_perm_b32 v120, v121, v120, s35
    v_perm_b32 v121, v67, v66, s35
    v_lshl_add_u64 v[120:121], v[120:121], 0, s[30:31]
    ds_add_rtn_u64 v[66:67], v23, v[120:121] offset:50000

    s_waitcnt lgkmcnt(4)
    v_or3_b32 v1, v52, v53, v1
    v_or3_b32 v1, v54, v55, v1
    v_or3_b32 v1, v56, v57, v1
    v_or3_b32 v1, v58, v59, v1
    v_cvt_f32_i32_sdwa v118, sext(v24) dst_sel:DWORD dst_unused:UNUSED_PAD src0_sel:WORD_0
    v_lshlrev_b32 v116, 16, v68
    v_and_b32 v117, s32, v68
    v_mul_f32 v118, s33, v118
    v_lshlrev_b32 v68, 16, v69
    v_and_b32 v69, s32, v69
    v_lshlrev_b32_sdwa v24, 3, v24 dst_sel:DWORD dst_unused:UNUSED_PAD src0_sel:DWORD src1_sel:WORD_1
    v_pk_fma_f32 v[116:117], v[116:117], v[118:119], s[28:29] op_sel_hi:[1,0,1]
    v_pk_fma_f32 v[68:69], v[68:69], v[118:119], s[28:29] op_sel_hi:[1,0,1]
    v_perm_b32 v116, v117, v116, s35
    v_perm_b32 v117, v69, v68, s35
    v_lshl_add_u64 v[116:117], v[116:117], 0, s[30:31]
    ds_add_rtn_u64 v[68:69], v24, v[116:117] offset:50000

    v_cvt_f32_i32_sdwa v122, sext(v25) dst_sel:DWORD dst_unused:UNUSED_PAD src0_sel:WORD_0
    v_lshlrev_b32 v120, 16, v70
    v_and_b32 v121, s32, v70
    v_mul_f32 v122, s33, v122
    v_lshlrev_b32 v70, 16, v71
    v_and_b32 v71, s32, v71
    v_lshlrev_b32_sdwa v25, 3, v25 dst_sel:DWORD dst_unused:UNUSED_PAD src0_sel:DWORD src1_sel:WORD_1
    v_pk_fma_f32 v[120:121], v[120:121], v[122:123], s[28:29] op_sel_hi:[1,0,1]
    v_pk_fma_f32 v[70:71], v[70:71], v[122:123], s[28:29] op_sel_hi:[1,0,1]
    v_perm_b32 v120, v121, v120, s35
    v_perm_b32 v121, v71, v70, s35
    v_lshl_add_u64 v[120:121], v[120:121], 0, s[30:31]
    ds_add_rtn_u64 v[70:71], v25, v[120:121] offset:50000

    v_cvt_f32_i32_sdwa v118, sext(v26) dst_sel:DWORD dst_unused:UNUSED_PAD src0_sel:WORD_0
    v_lshlrev_b32 v116, 16, v72
    v_and_b32 v117, s32, v72
    v_mul_f32 v118, s33, v118
    v_lshlrev_b32 v72, 16, v73
    v_and_b32 v73, s32, v73
    v_lshlrev_b32_sdwa v26, 3, v26 dst_sel:DWORD dst_unused:UNUSED_PAD src0_sel:DWORD src1_sel:WORD_1
    v_pk_fma_f32 v[116:117], v[116:117], v[118:119], s[28:29] op_sel_hi:[1,0,1]
    v_pk_fma_f32 v[72:73], v[72:73], v[118:119], s[28:29] op_sel_hi:[1,0,1]
    v_perm_b32 v116, v117, v116, s35
    v_perm_b32 v117, v73, v72, s35
    v_lshl_add_u64 v[116:117], v[116:117], 0, s[30:31]
    ds_add_rtn_u64 v[72:73], v26, v[116:117] offset:50000

    v_cvt_f32_i32_sdwa v122, sext(v27) dst_sel:DWORD dst_unused:UNUSED_PAD src0_sel:WORD_0
    v_lshlrev_b32 v120, 16, v74
    v_and_b32 v121, s32, v74
    v_mul_f32 v122, s33, v122
    v_lshlrev_b32 v74, 16, v75
    v_and_b32 v75, s32, v75
    v_lshlrev_b32_sdwa v27, 3, v27 dst_sel:DWORD dst_unused:UNUSED_PAD src0_sel:DWORD src1_sel:WORD_1
    v_pk_fma_f32 v[120:121], v[120:121], v[122:123], s[28:29] op_sel_hi:[1,0,1]
    v_pk_fma_f32 v[74:75], v[74:75], v[122:123], s[28:29] op_sel_hi:[1,0,1]
    v_perm_b32 v120, v121, v120, s35
    v_perm_b32 v121, v75, v74, s35
    v_lshl_add_u64 v[120:121], v[120:121], 0, s[30:31]
    ds_add_rtn_u64 v[74:75], v27, v[120:121] offset:50000

    s_waitcnt lgkmcnt(4)
    v_or3_b32 v1, v60, v61, v1
    v_or3_b32 v1, v62, v63, v1
    v_or3_b32 v1, v64, v65, v1
    v_or3_b32 v1, v66, v67, v1
    s_cmp_le_i32 s42, 3072
    s_cbranch_scc1 L_nt2_33
    s_waitcnt vmcnt(0)
    s_mov_b64 exec, s[64:65]
    v_cvt_f32_i32_sdwa v118, sext(v106) dst_sel:DWORD dst_unused:UNUSED_PAD src0_sel:WORD_0
    v_lshlrev_b32 v116, 16, v44
    v_and_b32 v117, s32, v44
    v_mul_f32 v118, s33, v118
    v_lshlrev_b32 v44, 16, v45
    v_and_b32 v45, s32, v45
    v_lshlrev_b32_sdwa v106, 3, v106 dst_sel:DWORD dst_unused:UNUSED_PAD src0_sel:DWORD src1_sel:WORD_1
    v_pk_fma_f32 v[116:117], v[116:117], v[118:119], s[28:29] op_sel_hi:[1,0,1]
    v_pk_fma_f32 v[44:45], v[44:45], v[118:119], s[28:29] op_sel_hi:[1,0,1]
    v_perm_b32 v116, v117, v116, s35
    v_perm_b32 v117, v45, v44, s35
    v_lshl_add_u64 v[116:117], v[116:117], 0, s[30:31]
    ds_add_rtn_u64 v[44:45], v106, v[116:117] offset:50000

    s_mov_b64 exec, s[66:67]
    v_cvt_f32_i32_sdwa v122, sext(v107) dst_sel:DWORD dst_unused:UNUSED_PAD src0_sel:WORD_0
    v_lshlrev_b32 v120, 16, v46
    v_and_b32 v121, s32, v46
    v_mul_f32 v122, s33, v122
    v_lshlrev_b32 v46, 16, v47
    v_and_b32 v47, s32, v47
    v_lshlrev_b32_sdwa v107, 3, v107 dst_sel:DWORD dst_unused:UNUSED_PAD src0_sel:DWORD src1_sel:WORD_1
    v_pk_fma_f32 v[120:121], v[120:121], v[122:123], s[28:29] op_sel_hi:[1,0,1]
    v_pk_fma_f32 v[46:47], v[46:47], v[122:123], s[28:29] op_sel_hi:[1,0,1]
    v_perm_b32 v120, v121, v120, s35
    v_perm_b32 v121, v47, v46, s35
    v_lshl_add_u64 v[120:121], v[120:121], 0, s[30:31]
    ds_add_rtn_u64 v[46:47], v107, v[120:121] offset:50000

    s_mov_b64 exec, s[68:69]
    v_cvt_f32_i32_sdwa v118, sext(v108) dst_sel:DWORD dst_unused:UNUSED_PAD src0_sel:WORD_0
    v_lshlrev_b32 v116, 16, v48
    v_and_b32 v117, s32, v48
    v_mul_f32 v118, s33, v118
    v_lshlrev_b32 v48, 16, v49
    v_and_b32 v49, s32, v49
    v_lshlrev_b32_sdwa v108, 3, v108 dst_sel:DWORD dst_unused:UNUSED_PAD src0_sel:DWORD src1_sel:WORD_1
    v_pk_fma_f32 v[116:117], v[116:117], v[118:119], s[28:29] op_sel_hi:[1,0,1]
    v_pk_fma_f32 v[48:49], v[48:49], v[118:119], s[28:29] op_sel_hi:[1,0,1]
    v_perm_b32 v116, v117, v116, s35
    v_perm_b32 v117, v49, v48, s35
    v_lshl_add_u64 v[116:117], v[116:117], 0, s[30:31]
    ds_add_rtn_u64 v[48:49], v108, v[116:117] offset:50000

    s_mov_b64 exec, s[70:71]
    v_cvt_f32_i32_sdwa v122, sext(v109) dst_sel:DWORD dst_unused:UNUSED_PAD src0_sel:WORD_0
    v_lshlrev_b32 v120, 16, v50
    v_and_b32 v121, s32, v50
    v_mul_f32 v122, s33, v122
    v_lshlrev_b32 v50, 16, v51
    v_and_b32 v51, s32, v51
    v_lshlrev_b32_sdwa v109, 3, v109 dst_sel:DWORD dst_unused:UNUSED_PAD src0_sel:DWORD src1_sel:WORD_1
    v_pk_fma_f32 v[120:121], v[120:121], v[122:123], s[28:29] op_sel_hi:[1,0,1]
    v_pk_fma_f32 v[50:51], v[50:51], v[122:123], s[28:29] op_sel_hi:[1,0,1]
    v_perm_b32 v120, v121, v120, s35
    v_perm_b32 v121, v51, v50, s35
    v_lshl_add_u64 v[120:121], v[120:121], 0, s[30:31]
    ds_add_rtn_u64 v[50:51], v109, v[120:121] offset:50000

    s_mov_b64 exec, -1
    s_waitcnt lgkmcnt(0)
    v_or3_b32 v1, v44, v45, v1
    v_or3_b32 v1, v46, v47, v1
    v_or3_b32 v1, v48, v49, v1
    v_or3_b32 v1, v50, v51, v1
L_nt2_33:
    s_movk_i32 s53, 15360
    buffer_load_dwordx4 v[106:109], v2, s[16:19], s53 offen
    buffer_load_dword v114, v2, s[16:19], s53 offen offset:16
    s_waitcnt lgkmcnt(0)
    v_or3_b32 v1, v68, v69, v1
    v_or3_b32 v1, v70, v71, v1
    v_or3_b32 v1, v72, v73, v1
    v_or3_b32 v1, v74, v75, v1
    s_cmp_le_u32 s40, 3584
    s_cbranch_scc1 L_noleft_36
    s_min_u32 s40, s40, 3968
    s_lshl_b32 s52, s38, 6
    s_add_u32 s52, s52, s36
    s_mul_i32 s52, s52, 19840
    s_add_u32 s20, s44, s52
    s_addc_u32 s21, s45, 0
    s_mul_i32 s52, s40, 5
    s_add_u32 s52, s52, 3
    s_and_b32 s22, s52, -4

    s_lshr_b32 s55, s39, 2
    s_add_u32 s55, s55, 3584
    v_and_b32 v60, 63, v0
    v_add_u32 v60, s55, v60
L_left_37:
    s_cmp_ge_u32 s55, s40
    s_cbranch_scc1 L_leftend_38
    v_mul_u32_u24 v61, 5, v60
    buffer_load_dword v62, v61, s[20:23], 0 offen
    buffer_load_ubyte v63, v61, s[20:23], 0 offen offset:4
    s_waitcnt vmcnt(0)

    v_perm_b32 v61, v63, v62, s24
    v_lshrrev_b32 v66, 30, v62
    v_and_b32 v61, 0x1fff, v61
    v_mul_u32_u24 v66, 6250, v66
    v_add_lshl_u32 v61, v61, v66, 3

    buffer_load_dwordx2 v[64:65], v61, s[8:11], s50 offen
    v_cmp_gt_u32 vcc, s40, v60
    s_waitcnt vmcnt(0)

    s_mov_b64 exec, vcc
    v_and_b32 v62, 0x3fffffff, v62
    v_cvt_f32_i32_sdwa v118, sext(v62) dst_sel:DWORD dst_unused:UNUSED_PAD src0_sel:WORD_0
    v_lshlrev_b32 v116, 16, v64
    v_and_b32 v117, s32, v64
    v_mul_f32 v118, s33, v118
    v_lshlrev_b32 v64, 16, v65
    v_and_b32 v65, s32, v65
    v_lshlrev_b32_sdwa v62, 3, v62 dst_sel:DWORD dst_unused:UNUSED_PAD src0_sel:DWORD src1_sel:WORD_1
    v_pk_fma_f32 v[116:117], v[116:117], v[118:119], s[28:29] op_sel_hi:[1,0,1]
    v_pk_fma_f32 v[64:65], v[64:65], v[118:119], s[28:29] op_sel_hi:[1,0,1]
    v_perm_b32 v116, v117, v116, s35
    v_perm_b32 v117, v65, v64, s35
    v_lshl_add_u64 v[116:117], v[116:117], 0, s[30:31]
    ds_add_rtn_u64 v[64:65], v62, v[116:117] offset:50000

    s_waitcnt lgkmcnt(0)
    v_or3_b32 v1, v64, v65, v1
    s_mov_b64 exec, -1
    v_add_u32 v60, 128, v60
    s_add_u32 s55, s55, 128
    s_branch L_left_37
L_leftend_38:

L_noleft_36:
    s_mov_b32 s38, s5
    s_cmp_lt_u32 s38, s4
    s_cbranch_scc1 L_batch_19
    s_waitcnt vmcnt(0)
    s_barrier

    s_mul_i32 s3, s37, 6400000
    s_mul_i32 s5, s36, 100000
    s_add_u32 s3, s3, s5
    s_add_u32 s3, s3, 1048576

    s_add_u32 s20, s6, s3
    s_addc_u32 s21, s7, 0
    s_mov_b32 s22, 100000
    s_mov_b32 s23, 0x20000
    v_lshlrev_b32 v68, 3, v0
    v_add_u32 v69, 50000, v68
    v_add_u32 v70, 115536, v68
    v_cmp_gt_u32 vcc, 212, v0
    v_mov_b32 v52, 0
    v_mov_b32 v53, 0

    ds_read_b64 v[28:29], v69 offset:0
    ds_read_b64 v[30:31], v69 offset:8192
    ds_read_b64 v[32:33], v69 offset:16384
    ds_read_b64 v[34:35], v69 offset:24576
    ds_read_b64 v[36:37], v69 offset:32768
    ds_read_b64 v[38:39], v69 offset:40960
    ds_read_b64 v[40:41], v69 offset:49152
    ds_read_b64 v[42:43], v69 offset:57344
    ds_read_b64 v[44:45], v70 offset:0
    ds_read_b64 v[46:47], v70 offset:8192
    ds_read_b64 v[48:49], v70 offset:16384
    ds_read_b64 v[50:51], v70 offset:24576
    s_mov_b64 exec, vcc
    ds_read_b64 v[52:53], v70 offset:32768
    s_mov_b64 exec, -1
    s_waitcnt lgkmcnt(12)
    s_mov_b32 s3, 0
    buffer_store_dwordx2 v[28:29], v68, s[20:23], s3 offen
    s_waitcnt lgkmcnt(11)
    s_mov_b32 s3, 8192
    buffer_store_dwordx2 v[30:31], v68, s[20:23], s3 offen
    s_waitcnt lgkmcnt(10)
    s_mov_b32 s3, 16384
    buffer_store_dwordx2 v[32:33], v68, s[20:23], s3 offen
    s_waitcnt lgkmcnt(9)
    s_mov_b32 s3, 24576
    buffer_store_dwordx2 v[34:35], v68, s[20:23], s3 offen
    s_waitcnt lgkmcnt(8)
    s_mov_b32 s3, 32768
    buffer_store_dwordx2 v[36:37], v68, s[20:23], s3 offen
    s_waitcnt lgkmcnt(7)
    s_mov_b32 s3, 40960
    buffer_store_dwordx2 v[38:39], v68, s[20:23], s3 offen
    s_waitcnt lgkmcnt(6)
    s_mov_b32 s3, 49152
    buffer_store_dwordx2 v[40:41], v68, s[20:23], s3 offen
    s_waitcnt lgkmcnt(5)
    s_mov_b32 s3, 57344
    buffer_store_dwordx2 v[42:43], v68, s[20:23], s3 offen
    s_waitcnt lgkmcnt(4)
    s_mov_b32 s3, 65536
    buffer_store_dwordx2 v[44:45], v68, s[20:23], s3 offen
    s_waitcnt lgkmcnt(3)
    s_mov_b32 s3, 73728
    buffer_store_dwordx2 v[46:47], v68, s[20:23], s3 offen
    s_waitcnt lgkmcnt(2)
    s_mov_b32 s3, 81920
    buffer_store_dwordx2 v[48:49], v68, s[20:23], s3 offen
    s_waitcnt lgkmcnt(1)
    s_mov_b32 s3, 90112
    buffer_store_dwordx2 v[50:51], v68, s[20:23], s3 offen
    s_waitcnt lgkmcnt(0)
    s_mov_b32 s3, 98304
    buffer_store_dwordx2 v[52:53], v68, s[20:23], s3 offen
    v_or3_b32 v1, v28, v29, v1
    v_or3_b32 v1, v30, v31, v1
    v_or3_b32 v1, v32, v33, v1
    v_or3_b32 v1, v34, v35, v1
    v_or3_b32 v1, v36, v37, v1
    v_or3_b32 v1, v38, v39, v1
    v_or3_b32 v1, v40, v41, v1
    v_or3_b32 v1, v42, v43, v1
    v_or3_b32 v1, v44, v45, v1
    v_or3_b32 v1, v46, v47, v1
    v_or3_b32 v1, v48, v49, v1
    v_or3_b32 v1, v50, v51, v1
    v_or3_b32 v1, v52, v53, v1
    v_and_b32 v1, 0x80008000, v1
    v_cmp_ne_u32 vcc, 0, v1
    v_mov_b32 v71, 150024
    v_mov_b32 v72, 1
    s_cbranch_vccz L_nf_39
    ds_write_b32 v71, v72
L_nf_39:
    s_waitcnt lgkmcnt(0)
    s_barrier
    ds_read_b32 v72, v71
    s_waitcnt lgkmcnt(0)
    v_readfirstlane_b32 s3, v72
    s_nop 1
    s_cmp_lg_u32 s3, 0
    s_cbranch_scc1 L_p2slow_18

L_fin_40:
    s_add_u32 s20, s6, 147456
    s_addc_u32 s21, s7, 0
    s_mov_b32 s22, 1024
    s_mov_b32 s23, 0x20000
    s_lshl_b32 s3, s36, 2
    s_add_u32 s3, s3, s37
    s_lshl_b32 s3, s3, 2
    v_lshlrev_b32 v73, 20, v0
    v_mov_b32 v74, s34
    buffer_store_dword v74, v73, s[20:23], s3 offen

L_p2done_17:
    s_endpgm

L_ufix_20:
    v_and_b32 v117, 63, v0
    v_lshlrev_b32 v117, 2, v117
    s_sub_i32 s54, s42, 1024
    v_cmp_le_i32 vcc, s54, v117
    s_mov_b64 exec, vcc
    v_mov_b32 v12, 0
    v_mov_b32 v44, 0
    s_mov_b64 exec, -1
    s_sub_i32 s54, s42, 1025
    v_cmp_le_i32 vcc, s54, v117
    s_mov_b64 exec, vcc
    v_mov_b32 v13, 0
    v_mov_b32 v46, 0
    s_mov_b64 exec, -1
    s_sub_i32 s54, s42, 1026
    v_cmp_le_i32 vcc, s54, v117
    s_mov_b64 exec, vcc
    v_mov_b32 v14, 0
    v_mov_b32 v48, 0
    s_mov_b64 exec, -1
    s_sub_i32 s54, s42, 1027
    v_cmp_le_i32 vcc, s54, v117
    s_mov_b64 exec, vcc
    v_mov_b32 v15, 0
    v_mov_b32 v50, 0
    s_mov_b64 exec, -1
    s_branch L_uback_21
L_ufix_22:
    v_and_b32 v117, 63, v0
    v_lshlrev_b32 v117, 2, v117
    s_sub_i32 s54, s42, 1536
    v_cmp_le_i32 vcc, s54, v117
    s_mov_b64 exec, vcc
    v_mov_b32 v16, 0
    v_mov_b32 v52, 0
    s_mov_b64 exec, -1
    s_sub_i32 s54, s42, 1537
    v_cmp_le_i32 vcc, s54, v117
    s_mov_b64 exec, vcc
    v_mov_b32 v17, 0
    v_mov_b32 v54, 0
    s_mov_b64 exec, -1
    s_sub_i32 s54, s42, 1538
    v_cmp_le_i32 vcc, s54, v117
    s_mov_b64 exec, vcc
    v_mov_b32 v18, 0
    v_mov_b32 v56, 0
    s_mov_b64 exec, -1
    s_sub_i32 s54, s42, 1539
    v_cmp_le_i32 vcc, s54, v117
    s_mov_b64 exec, vcc
    v_mov_b32 v19, 0
    v_mov_b32 v58, 0
    s_mov_b64 exec, -1
    s_branch L_uback_23
L_ufix_24:
    v_and_b32 v117, 63, v0
    v_lshlrev_b32 v117, 2, v117
    s_sub_i32 s54, s42, 2048
    v_cmp_le_i32 vcc, s54, v117
    s_mov_b64 exec, vcc
    v_mov_b32 v20, 0
    v_mov_b32 v60, 0
    s_mov_b64 exec, -1
    s_sub_i32 s54, s42, 2049
    v_cmp_le_i32 vcc, s54, v117
    s_mov_b64 exec, vcc
    v_mov_b32 v21, 0
    v_mov_b32 v62, 0
    s_mov_b64 exec, -1
    s_sub_i32 s54, s42, 2050
    v_cmp_le_i32 vcc, s54, v117
    s_mov_b64 exec, vcc
    v_mov_b32 v22, 0
    v_mov_b32 v64, 0
    s_mov_b64 exec, -1
    s_sub_i32 s54, s42, 2051
    v_cmp_le_i32 vcc, s54, v117
    s_mov_b64 exec, vcc
    v_mov_b32 v23, 0
    v_mov_b32 v66, 0
    s_mov_b64 exec, -1
    s_branch L_uback_25
L_ufix_26:
    v_and_b32 v117, 63, v0
    v_lshlrev_b32 v117, 2, v117
    s_sub_i32 s54, s42, 2560
    v_cmp_le_i32 vcc, s54, v117
    s_mov_b64 exec, vcc
    v_mov_b32 v24, 0
    v_mov_b32 v68, 0
    s_mov_b64 exec, -1
    s_sub_i32 s54, s42, 2561
    v_cmp_le_i32 vcc, s54, v117
    s_mov_b64 exec, vcc
    v_mov_b32 v25, 0
    v_mov_b32 v70, 0
    s_mov_b64 exec, -1
    s_sub_i32 s54, s42, 2562
    v_cmp_le_i32 vcc, s54, v117
    s_mov_b64 exec, vcc
    v_mov_b32 v26, 0
    v_mov_b32 v72, 0
    s_mov_b64 exec, -1
    s_sub_i32 s54, s42, 2563
    v_cmp_le_i32 vcc, s54, v117
    s_mov_b64 exec, vcc
    v_mov_b32 v27, 0
    v_mov_b32 v74, 0
    s_mov_b64 exec, -1
    s_branch L_uback_27
L_ufix_28:
    v_and_b32 v117, 63, v0
    v_lshlrev_b32 v117, 2, v117
    s_sub_i32 s54, s42, 0
    v_cmp_le_i32 vcc, s54, v117
    s_mov_b64 exec, vcc
    v_mov_b32 v4, 0
    v_mov_b32 v28, 0
    s_mov_b64 exec, -1
    s_sub_i32 s54, s42, 1
    v_cmp_le_i32 vcc, s54, v117
    s_mov_b64 exec, vcc
    v_mov_b32 v5, 0
    v_mov_b32 v30, 0
    s_mov_b64 exec, -1
    s_sub_i32 s54, s42, 2
    v_cmp_le_i32 vcc, s54, v117
    s_mov_b64 exec, vcc
    v_mov_b32 v6, 0
    v_mov_b32 v32, 0
    s_mov_b64 exec, -1
    s_sub_i32 s54, s42, 3
    v_cmp_le_i32 vcc, s54, v117
    s_mov_b64 exec, vcc
    v_mov_b32 v7, 0
    v_mov_b32 v34, 0
    s_mov_b64 exec, -1
    s_branch L_uback_29
L_ufix_30:
    v_and_b32 v117, 63, v0
    v_lshlrev_b32 v117, 2, v117
    s_sub_i32 s54, s42, 512
    v_cmp_le_i32 vcc, s54, v117
    s_mov_b64 exec, vcc
    v_mov_b32 v8, 0
    v_mov_b32 v36, 0
    s_mov_b64 exec, -1
    s_sub_i32 s54, s42, 513
    v_cmp_le_i32 vcc, s54, v117
    s_mov_b64 exec, vcc
    v_mov_b32 v9, 0
    v_mov_b32 v38, 0
    s_mov_b64 exec, -1
    s_sub_i32 s54, s42, 514
    v_cmp_le_i32 vcc, s54, v117
    s_mov_b64 exec, vcc
    v_mov_b32 v10, 0
    v_mov_b32 v40, 0
    s_mov_b64 exec, -1
    s_sub_i32 s54, s42, 515
    v_cmp_le_i32 vcc, s54, v117
    s_mov_b64 exec, vcc
    v_mov_b32 v11, 0
    v_mov_b32 v42, 0
    s_mov_b64 exec, -1
    s_branch L_uback_31
L_ufix_34:
    v_and_b32 v117, 63, v0
    v_lshlrev_b32 v117, 2, v117
    s_sub_i32 s54, s42, 3072
    v_cmp_le_i32 vcc, s54, v117
    s_mov_b64 exec, vcc
    v_mov_b32 v106, 0
    v_mov_b32 v116, 0
    s_mov_b64 exec, -1
    s_sub_i32 s54, s42, 3073
    v_cmp_le_i32 vcc, s54, v117
    s_mov_b64 exec, vcc
    v_mov_b32 v107, 0
    v_mov_b32 v118, 0
    s_mov_b64 exec, -1
    s_sub_i32 s54, s42, 3074
    v_cmp_le_i32 vcc, s54, v117
    s_mov_b64 exec, vcc
    v_mov_b32 v108, 0
    v_mov_b32 v120, 0
    s_mov_b64 exec, -1
    s_sub_i32 s54, s42, 3075
    v_cmp_le_i32 vcc, s54, v117
    s_mov_b64 exec, vcc
    v_mov_b32 v109, 0
    v_mov_b32 v122, 0
    s_mov_b64 exec, -1
    s_branch L_uback_35
L_p2slow_18:
    s_waitcnt vmcnt(0) lgkmcnt(0)
    s_mov_b32 s51, 0
    s_movk_i32 s43, 6250
    s_mov_b32 s34, 0
L_sweep_41:
    s_barrier

    v_mov_b32 v28, 0x0
    v_mov_b32 v29, 0x0
    v_mov_b32 v30, 0x0
    v_mov_b32 v31, 0x0
    v_add_u32 v32, 50000, v3
    v_add_u32 v33, 65536, v32

    ds_write_b128 v32, v[28:31] offset:0
    ds_write_b128 v32, v[28:31] offset:16384
    ds_write_b128 v32, v[28:31] offset:32768
    ds_write_b128 v32, v[28:31] offset:49152
    ds_write_b128 v33, v[28:31] offset:0
    ds_write_b128 v33, v[28:31] offset:16384
    v_cmp_gt_u32 vcc, 971, v0
    s_mov_b64 exec, vcc
    ds_write_b128 v33, v[28:31] offset:32768
    s_mov_b64 exec, -1
    s_waitcnt lgkmcnt(0)
    s_barrier
    s_sub_u32 s38, s4, 8
L_sbatch_42:
    s_lshl_b32 s52, s38, 6
    s_add_u32 s52, s52, s36
    s_lshl_b32 s52, s52, 2
    s_load_dword s40, s[46:47], s52
    s_mul_i32 s50, s38, 200000
    s_waitcnt lgkmcnt(0)

    s_min_u32 s40, s40, 3968
    s_lshl_b32 s52, s38, 6
    s_add_u32 s52, s52, s36
    s_mul_i32 s52, s52, 19840
    s_add_u32 s20, s44, s52
    s_addc_u32 s21, s45, 0
    s_mul_i32 s52, s40, 5
    s_add_u32 s52, s52, 3
    s_and_b32 s22, s52, -4

    s_lshr_b32 s55, s39, 2
    s_add_u32 s55, s55, 0
    v_and_b32 v36, 63, v0
    v_add_u32 v36, s55, v36
L_left_46:
    s_cmp_ge_u32 s55, s40
    s_cbranch_scc1 L_leftend_47
    v_mul_u32_u24 v37, 5, v36
    buffer_load_dword v38, v37, s[20:23], 0 offen
    buffer_load_ubyte v39, v37, s[20:23], 0 offen offset:4
    s_waitcnt vmcnt(0)

    v_perm_b32 v37, v39, v38, s24
    v_lshrrev_b32 v42, 30, v38
    v_and_b32 v37, 0x1fff, v37
    v_mul_u32_u24 v42, 6250, v42
    v_add_lshl_u32 v37, v37, v42, 3

    buffer_load_dwordx2 v[40:41], v37, s[8:11], s50 offen
    v_cmp_gt_u32 vcc, s40, v36
    s_waitcnt vmcnt(0)

    v_bfe_u32 v44, v38, 16, 14
    v_subrev_u32 v44, s51, v44
    v_cmp_gt_u32 s[64:65], s43, v44
    s_and_b64 exec, vcc, s[64:65]
    v_lshlrev_b32 v45, 8, v38
    v_cmpx_ne_u32 vcc, 0, v45
    v_lshlrev_b32 v44, 4, v44
    v_bfe_i32 v38, v38, 0, 16
    v_cvt_f32_i32 v38, v38
    v_mul_f32 v38, 0x38004020, v38
    v_lshlrev_b32 v45, 16, v40
    v_and_b32 v46, s32, v40
    v_lshlrev_b32 v47, 16, v41
    v_and_b32 v48, s32, v41

    v_mul_f32 v45, v45, v38
    ds_add_f32 v44, v45 offset:50000
    v_mul_f32 v46, v46, v38
    ds_add_f32 v44, v46 offset:50004
    v_mul_f32 v47, v47, v38
    ds_add_f32 v44, v47 offset:50008
    v_mul_f32 v48, v48, v38
    ds_add_f32 v44, v48 offset:50012
    s_mov_b64 exec, -1
    v_add_u32 v36, 128, v36
    s_add_u32 s55, s55, 128
    s_branch L_left_46
L_leftend_47:

    s_add_u32 s38, s38, 1
    s_cmp_lt_u32 s38, s4
    s_cbranch_scc1 L_sbatch_42
    s_mov_b32 s3, 131072
    s_load_dword s40, s[6:7], s3

    s_add_u32 s20, s6, 402907136
    s_addc_u32 s21, s7, 0
    s_mov_b32 s22, 409600000
    s_mov_b32 s23, 0x20000
    s_mov_b32 s38, 0
    s_mov_b32 s50, 200000
    v_mov_b32 v36, v0
    s_waitcnt lgkmcnt(0)
L_ovf_43:
    s_cmp_ge_u32 s38, s40
    s_cbranch_scc1 L_ovfend_44
    v_lshlrev_b32 v37, 3, v36
    buffer_load_dwordx2 v[38:39], v37, s[20:23], 0 offen
    s_waitcnt vmcnt(0)

    v_perm_b32 v37, v39, v38, s24
    v_lshrrev_b32 v42, 30, v38
    v_and_b32 v37, 0x1fff, v37
    v_mul_u32_u24 v42, 6250, v42
    v_add_lshl_u32 v37, v37, v42, 3

    v_bfe_u32 v42, v39, 24, 5
    v_mad_u32_u24 v37, v42, s50, v37
    buffer_load_dwordx2 v[40:41], v37, s[8:11], 0 offen
    v_lshrrev_b32 v42, 3, v42
    v_bfe_u32 v43, v39, 18, 6
    v_cmp_gt_u32 vcc, s40, v36
    v_cmp_eq_u32 s[64:65], s36, v43
    s_and_b64 vcc, vcc, s[64:65]
    v_cmp_eq_u32 s[64:65], s37, v42
    s_and_b64 vcc, vcc, s[64:65]
    s_waitcnt vmcnt(0)

    v_bfe_u32 v44, v38, 16, 14
    v_subrev_u32 v44, s51, v44
    v_cmp_gt_u32 s[64:65], s43, v44
    s_and_b64 exec, vcc, s[64:65]
    v_lshlrev_b32 v45, 8, v38
    v_cmpx_ne_u32 vcc, 0, v45
    v_lshlrev_b32 v44, 4, v44
    v_bfe_i32 v38, v38, 0, 16
    v_cvt_f32_i32 v38, v38
    v_mul_f32 v38, 0x38004020, v38
    v_lshlrev_b32 v45, 16, v40
    v_and_b32 v46, s32, v40
    v_lshlrev_b32 v47, 16, v41
    v_and_b32 v48, s32, v41

    v_mul_f32 v45, v45, v38
    ds_add_f32 v44, v45 offset:50000
    v_mul_f32 v46, v46, v38
    ds_add_f32 v44, v46 offset:50004
    v_mul_f32 v47, v47, v38
    ds_add_f32 v44, v47 offset:50008
    v_mul_f32 v48, v48, v38
    ds_add_f32 v44, v48 offset:50012
    s_mov_b64 exec, -1
    v_add_u32 v36, 1024, v36
    s_add_u32 s38, s38, 1024
    s_branch L_ovf_43
L_ovfend_44:
    s_waitcnt lgkmcnt(0)
    s_barrier
    s_mul_i32 s3, s37, 800000
    s_mul_i32 s5, s36, 12500
    s_add_u32 s3, s3, s5
    s_add_u32 s3, s3, s51
    s_lshl_b32 s3, s3, 4
    s_add_u32 s3, s3, 26648576

    s_add_u32 s20, s6, s3
    s_addc_u32 s21, s7, 0
    s_mov_b32 s22, 100000
    s_mov_b32 s23, 0x20000
    v_mov_b32 v36, v3
    s_mov_b32 s38, 0
L_wl_45:
    v_min_u32 v37, 100000, v36
    ds_read_b128 v[28:31], v37 offset:50000
    s_waitcnt lgkmcnt(0)
    buffer_store_dwordx4 v[28:31], v36, s[20:23], 0 offen
    s_waitcnt vmcnt(0)
    v_add_u32 v36, 16384, v36
    s_add_u32 s38, s38, 1024
    s_cmp_lt_u32 s38, 6250
    s_cbranch_scc1 L_wl_45
    s_add_u32 s51, s51, 6250
    s_cmp_lt_u32 s51, 12500
    s_cbranch_scc1 L_sweep_41
    s_branch L_fin_40

.globl standalone__molecular_angular_gemnet__graph_kernel
.p2align 8
.type standalone__molecular_angular_gemnet__graph_kernel,@function
standalone__molecular_angular_gemnet__graph_kernel:
    s_cmp_ge_u32 s2, 3200
    s_cbranch_scc1 L_fdone_48
    s_load_dwordx2 s[4:5], s[0:1], 0
    s_load_dwordx2 s[6:7], s[0:1], 24
    s_load_dwordx2 s[8:9], s[0:1], 40
    s_load_dwordx8 s[12:19], s[0:1], 56
    s_load_dwordx2 s[10:11], s[0:1], 88
    s_load_dwordx2 s[20:21], s[0:1], 104
    v_cmp_gt_u32 vcc, 250, v0
    s_mul_i32 s3, s2, 250
    v_add_u32 v0, s3, v0
    v_lshlrev_b32 v1, 4, v0
    v_lshlrev_b32 v2, 3, v0
    v_lshlrev_b32 v3, 1, v0
    s_mov_b64 exec, vcc
    s_mul_hi_u32 s3, s2, 85899346
    s_lshl_b32 s3, s3, 4
    s_add_u32 s3, s3, 147456
    s_waitcnt lgkmcnt(0)
    s_load_dwordx4 s[96:99], s[20:21], s3
    s_load_dwordx4 s[40:43], s[8:9], 0
    s_load_dwordx16 s[44:59], s[12:13], 0
    s_load_dwordx16 s[60:75], s[14:15], 0
    s_load_dwordx8 s[76:83], s[16:17], 0
    s_load_dwordx8 s[84:91], s[18:19], 0

    s_add_u32 s24, s20, 1048576
    s_addc_u32 s25, s21, 0
    s_mov_b32 s26, 76800000
    s_mov_b32 s27, 0x20000
    s_mov_b32 s28, s4
    s_mov_b32 s29, s5
    s_mov_b32 s30, 6400000
    s_mov_b32 s31, 0x20000
    s_mov_b32 s32, s6
    s_mov_b32 s33, s7
    s_mov_b32 s34, 1600000
    s_mov_b32 s35, 0x20000
    s_mov_b32 s36, s10
    s_mov_b32 s37, s11
    s_mov_b32 s38, 6400000
    s_mov_b32 s39, 0x20000
    buffer_load_ushort v4, v3, s[32:35], 0 offen
    buffer_load_dwordx2 v[32:33], v2, s[24:27], 0 offen
    s_mov_b32 s3, 6400000
    buffer_load_dwordx2 v[34:35], v2, s[24:27], s3 offen
    s_mov_b32 s3, 12800000
    buffer_load_dwordx2 v[36:37], v2, s[24:27], s3 offen
    s_mov_b32 s3, 19200000
    buffer_load_dwordx2 v[38:39], v2, s[24:27], s3 offen
    buffer_load_dwordx2 v[6:7], v2, s[28:31], 0 offen
    s_mov_b32 s94, 0xffff0000
    s_mov_b32 s95, 0xc1200000
    s_mov_b32 s22, 0x3fb8aa3b
    s_waitcnt vmcnt(5) lgkmcnt(0)
    v_lshlrev_b32 v4, 16, v4

    s_lshl_b32 s92, s40, 16
    v_subrev_f32 v16, s92, v4
    s_and_b32 s93, s40, s94
    v_subrev_f32 v17, s93, v4
    s_lshl_b32 s92, s41, 16
    v_subrev_f32 v18, s92, v4
    s_and_b32 s93, s41, s94
    v_subrev_f32 v19, s93, v4
    s_lshl_b32 s92, s42, 16
    v_subrev_f32 v20, s92, v4
    s_and_b32 s93, s42, s94
    v_subrev_f32 v21, s93, v4
    s_lshl_b32 s92, s43, 16
    v_subrev_f32 v22, s92, v4
    s_and_b32 s93, s43, s94
    v_subrev_f32 v23, s93, v4
    v_cvt_pk_bf16_f32 v16, v16, v17
    v_and_b32 v17, s94, v16
    v_lshlrev_b32 v16, 16, v16
    v_cvt_pk_bf16_f32 v18, v18, v19
    v_and_b32 v19, s94, v18
    v_lshlrev_b32 v18, 16, v18
    v_cvt_pk_bf16_f32 v20, v20, v21
    v_and_b32 v21, s94, v20
    v_lshlrev_b32 v20, 16, v20
    v_cvt_pk_bf16_f32 v22, v22, v23
    v_and_b32 v23, s94, v22
    v_lshlrev_b32 v22, 16, v22
    v_mul_f32 v16, v16, v16
    v_mul_f32 v17, v17, v17
    v_mul_f32 v18, v18, v18
    v_mul_f32 v19, v19, v19
    v_mul_f32 v20, v20, v20
    v_mul_f32 v21, v21, v21
    v_mul_f32 v22, v22, v22
    v_mul_f32 v23, v23, v23
    v_cvt_pk_bf16_f32 v16, v16, v17
    v_and_b32 v17, s94, v16
    v_lshlrev_b32 v16, 16, v16
    v_cvt_pk_bf16_f32 v18, v18, v19
    v_and_b32 v19, s94, v18
    v_lshlrev_b32 v18, 16, v18
    v_cvt_pk_bf16_f32 v20, v20, v21
    v_and_b32 v21, s94, v20
    v_lshlrev_b32 v20, 16, v20
    v_cvt_pk_bf16_f32 v22, v22, v23
    v_and_b32 v23, s94, v22
    v_lshlrev_b32 v22, 16, v22
    v_mul_f32 v16, s95, v16
    v_mul_f32 v17, s95, v17
    v_mul_f32 v18, s95, v18
    v_mul_f32 v19, s95, v19
    v_mul_f32 v20, s95, v20
    v_mul_f32 v21, s95, v21
    v_mul_f32 v22, s95, v22
    v_mul_f32 v23, s95, v23
    v_cvt_pk_bf16_f32 v16, v16, v17
    v_and_b32 v17, s94, v16
    v_lshlrev_b32 v16, 16, v16
    v_cvt_pk_bf16_f32 v18, v18, v19
    v_and_b32 v19, s94, v18
    v_lshlrev_b32 v18, 16, v18
    v_cvt_pk_bf16_f32 v20, v20, v21
    v_and_b32 v21, s94, v20
    v_lshlrev_b32 v20, 16, v20
    v_cvt_pk_bf16_f32 v22, v22, v23
    v_and_b32 v23, s94, v22
    v_lshlrev_b32 v22, 16, v22
    v_mul_f32 v16, s22, v16
    v_mul_f32 v17, s22, v17
    v_mul_f32 v18, s22, v18
    v_mul_f32 v19, s22, v19
    v_mul_f32 v20, s22, v20
    v_mul_f32 v21, s22, v21
    v_mul_f32 v22, s22, v22
    v_mul_f32 v23, s22, v23
    v_exp_f32 v16, v16
    v_exp_f32 v17, v17
    v_exp_f32 v18, v18
    v_exp_f32 v19, v19
    v_exp_f32 v20, v20
    v_exp_f32 v21, v21
    v_exp_f32 v22, v22
    v_exp_f32 v23, v23
    s_nop 0
    v_cvt_pk_bf16_f32 v16, v16, v17
    v_and_b32 v17, s94, v16
    v_lshlrev_b32 v16, 16, v16
    v_cvt_pk_bf16_f32 v18, v18, v19
    v_and_b32 v19, s94, v18
    v_lshlrev_b32 v18, 16, v18
    v_cvt_pk_bf16_f32 v20, v20, v21
    v_and_b32 v21, s94, v20
    v_lshlrev_b32 v20, 16, v20
    v_cvt_pk_bf16_f32 v22, v22, v23
    v_and_b32 v23, s94, v22
    v_lshlrev_b32 v22, 16, v22
    s_lshl_b32 s92, s60, 16
    v_mul_f32 v24, s92, v16
    s_and_b32 s93, s60, s94
    v_mul_f32 v25, s93, v16
    s_lshl_b32 s92, s61, 16
    v_mul_f32 v26, s92, v16
    s_and_b32 s93, s61, s94
    v_mul_f32 v27, s93, v16
    s_lshl_b32 s92, s62, 16
    v_fmac_f32 v24, s92, v17
    s_and_b32 s93, s62, s94
    v_fmac_f32 v25, s93, v17
    s_lshl_b32 s92, s63, 16
    v_fmac_f32 v26, s92, v17
    s_and_b32 s93, s63, s94
    v_fmac_f32 v27, s93, v17
    s_lshl_b32 s92, s64, 16
    v_fmac_f32 v24, s92, v18
    s_and_b32 s93, s64, s94
    v_fmac_f32 v25, s93, v18
    s_lshl_b32 s92, s65, 16
    v_fmac_f32 v26, s92, v18
    s_and_b32 s93, s65, s94
    v_fmac_f32 v27, s93, v18
    s_lshl_b32 s92, s66, 16
    v_fmac_f32 v24, s92, v19
    s_and_b32 s93, s66, s94
    v_fmac_f32 v25, s93, v19
    s_lshl_b32 s92, s67, 16
    v_fmac_f32 v26, s92, v19
    s_and_b32 s93, s67, s94
    v_fmac_f32 v27, s93, v19
    s_lshl_b32 s92, s68, 16
    v_fmac_f32 v24, s92, v20
    s_and_b32 s93, s68, s94
    v_fmac_f32 v25, s93, v20
    s_lshl_b32 s92, s69, 16
    v_fmac_f32 v26, s92, v20
    s_and_b32 s93, s69, s94
    v_fmac_f32 v27, s93, v20
    s_lshl_b32 s92, s70, 16
    v_fmac_f32 v24, s92, v21
    s_and_b32 s93, s70, s94
    v_fmac_f32 v25, s93, v21
    s_lshl_b32 s92, s71, 16
    v_fmac_f32 v26, s92, v21
    s_and_b32 s93, s71, s94
    v_fmac_f32 v27, s93, v21
    s_lshl_b32 s92, s72, 16
    v_fmac_f32 v24, s92, v22
    s_and_b32 s93, s72, s94
    v_fmac_f32 v25, s93, v22
    s_lshl_b32 s92, s73, 16
    v_fmac_f32 v26, s92, v22
    s_and_b32 s93, s73, s94
    v_fmac_f32 v27, s93, v22
    s_lshl_b32 s92, s74, 16
    v_fmac_f32 v24, s92, v23
    s_and_b32 s93, s74, s94
    v_fmac_f32 v25, s93, v23
    s_lshl_b32 s92, s75, 16
    v_fmac_f32 v26, s92, v23
    s_and_b32 s93, s75, s94
    v_fmac_f32 v27, s93, v23
    s_lshl_b32 s92, s44, 16
    v_mul_f32 v28, s92, v16
    s_and_b32 s93, s44, s94
    v_mul_f32 v29, s93, v16
    s_lshl_b32 s92, s45, 16
    v_mul_f32 v30, s92, v16
    s_and_b32 s93, s45, s94
    v_mul_f32 v31, s93, v16
    s_lshl_b32 s92, s46, 16
    v_fmac_f32 v28, s92, v17
    s_and_b32 s93, s46, s94
    v_fmac_f32 v29, s93, v17
    s_lshl_b32 s92, s47, 16
    v_fmac_f32 v30, s92, v17
    s_and_b32 s93, s47, s94
    v_fmac_f32 v31, s93, v17
    s_lshl_b32 s92, s48, 16
    v_fmac_f32 v28, s92, v18
    s_and_b32 s93, s48, s94
    v_fmac_f32 v29, s93, v18
    s_lshl_b32 s92, s49, 16
    v_fmac_f32 v30, s92, v18
    s_and_b32 s93, s49, s94
    v_fmac_f32 v31, s93, v18
    s_lshl_b32 s92, s50, 16
    v_fmac_f32 v28, s92, v19
    s_and_b32 s93, s50, s94
    v_fmac_f32 v29, s93, v19
    s_lshl_b32 s92, s51, 16
    v_fmac_f32 v30, s92, v19
    s_and_b32 s93, s51, s94
    v_fmac_f32 v31, s93, v19
    s_lshl_b32 s92, s52, 16
    v_fmac_f32 v28, s92, v20
    s_and_b32 s93, s52, s94
    v_fmac_f32 v29, s93, v20
    s_lshl_b32 s92, s53, 16
    v_fmac_f32 v30, s92, v20
    s_and_b32 s93, s53, s94
    v_fmac_f32 v31, s93, v20
    s_lshl_b32 s92, s54, 16
    v_fmac_f32 v28, s92, v21
    s_and_b32 s93, s54, s94
    v_fmac_f32 v29, s93, v21
    s_lshl_b32 s92, s55, 16
    v_fmac_f32 v30, s92, v21
    s_and_b32 s93, s55, s94
    v_fmac_f32 v31, s93, v21
    s_lshl_b32 s92, s56, 16
    v_fmac_f32 v28, s92, v22
    s_and_b32 s93, s56, s94
    v_fmac_f32 v29, s93, v22
    s_lshl_b32 s92, s57, 16
    v_fmac_f32 v30, s92, v22
    s_and_b32 s93, s57, s94
    v_fmac_f32 v31, s93, v22
    s_lshl_b32 s92, s58, 16
    v_fmac_f32 v28, s92, v23
    s_and_b32 s93, s58, s94
    v_fmac_f32 v29, s93, v23
    s_lshl_b32 s92, s59, 16
    v_fmac_f32 v30, s92, v23
    s_and_b32 s93, s59, s94
    v_fmac_f32 v31, s93, v23
    v_cvt_pk_bf16_f32 v28, v28, v29
    v_and_b32 v29, s94, v28
    v_lshlrev_b32 v28, 16, v28
    v_cvt_pk_bf16_f32 v30, v30, v31
    v_and_b32 v31, s94, v30
    v_lshlrev_b32 v30, 16, v30
    s_waitcnt vmcnt(1)
    v_mov_b32 v8, 0
    v_mov_b32 v9, 0
    v_mov_b32 v10, 0
    v_mov_b32 v11, 0
    s_cmp_eq_u32 s96, 0
    s_cbranch_scc1 L_ffl_49
    v_cvt_f32_u32_sdwa v12, v32 dst_sel:DWORD dst_unused:UNUSED_PAD src0_sel:WORD_0
    v_cvt_f32_u32_sdwa v13, v32 dst_sel:DWORD dst_unused:UNUSED_PAD src0_sel:WORD_1
    v_cvt_f32_u32_sdwa v14, v33 dst_sel:DWORD dst_unused:UNUSED_PAD src0_sel:WORD_0
    v_cvt_f32_u32_sdwa v15, v33 dst_sel:DWORD dst_unused:UNUSED_PAD src0_sel:WORD_1
    v_add_f32 v12, 0xc6800000, v12
    v_add_f32 v13, 0xc6800000, v13
    v_add_f32 v14, 0xc6800000, v14
    v_add_f32 v15, 0xc6800000, v15
    v_fmac_f32 v8, s96, v12
    v_fmac_f32 v9, s96, v13
    v_fmac_f32 v10, s96, v14
    v_fmac_f32 v11, s96, v15
L_fbk_50:
    s_cmp_eq_u32 s97, 0
    s_cbranch_scc1 L_ffl_51
    v_cvt_f32_u32_sdwa v12, v34 dst_sel:DWORD dst_unused:UNUSED_PAD src0_sel:WORD_0
    v_cvt_f32_u32_sdwa v13, v34 dst_sel:DWORD dst_unused:UNUSED_PAD src0_sel:WORD_1
    v_cvt_f32_u32_sdwa v14, v35 dst_sel:DWORD dst_unused:UNUSED_PAD src0_sel:WORD_0
    v_cvt_f32_u32_sdwa v15, v35 dst_sel:DWORD dst_unused:UNUSED_PAD src0_sel:WORD_1
    v_add_f32 v12, 0xc6800000, v12
    v_add_f32 v13, 0xc6800000, v13
    v_add_f32 v14, 0xc6800000, v14
    v_add_f32 v15, 0xc6800000, v15
    v_fmac_f32 v8, s97, v12
    v_fmac_f32 v9, s97, v13
    v_fmac_f32 v10, s97, v14
    v_fmac_f32 v11, s97, v15
L_fbk_52:
    s_cmp_eq_u32 s98, 0
    s_cbranch_scc1 L_ffl_53
    v_cvt_f32_u32_sdwa v12, v36 dst_sel:DWORD dst_unused:UNUSED_PAD src0_sel:WORD_0
    v_cvt_f32_u32_sdwa v13, v36 dst_sel:DWORD dst_unused:UNUSED_PAD src0_sel:WORD_1
    v_cvt_f32_u32_sdwa v14, v37 dst_sel:DWORD dst_unused:UNUSED_PAD src0_sel:WORD_0
    v_cvt_f32_u32_sdwa v15, v37 dst_sel:DWORD dst_unused:UNUSED_PAD src0_sel:WORD_1
    v_add_f32 v12, 0xc6800000, v12
    v_add_f32 v13, 0xc6800000, v13
    v_add_f32 v14, 0xc6800000, v14
    v_add_f32 v15, 0xc6800000, v15
    v_fmac_f32 v8, s98, v12
    v_fmac_f32 v9, s98, v13
    v_fmac_f32 v10, s98, v14
    v_fmac_f32 v11, s98, v15
L_fbk_54:
    s_cmp_eq_u32 s99, 0
    s_cbranch_scc1 L_ffl_55
    v_cvt_f32_u32_sdwa v12, v38 dst_sel:DWORD dst_unused:UNUSED_PAD src0_sel:WORD_0
    v_cvt_f32_u32_sdwa v13, v38 dst_sel:DWORD dst_unused:UNUSED_PAD src0_sel:WORD_1
    v_cvt_f32_u32_sdwa v14, v39 dst_sel:DWORD dst_unused:UNUSED_PAD src0_sel:WORD_0
    v_cvt_f32_u32_sdwa v15, v39 dst_sel:DWORD dst_unused:UNUSED_PAD src0_sel:WORD_1
    v_add_f32 v12, 0xc6800000, v12
    v_add_f32 v13, 0xc6800000, v13
    v_add_f32 v14, 0xc6800000, v14
    v_add_f32 v15, 0xc6800000, v15
    v_fmac_f32 v8, s99, v12
    v_fmac_f32 v9, s99, v13
    v_fmac_f32 v10, s99, v14
    v_fmac_f32 v11, s99, v15
L_fbk_56:
    s_lshl_b32 s92, s76, 16
    v_mul_f32 v16, s92, v8
    s_and_b32 s93, s76, s94
    v_mul_f32 v17, s93, v8
    s_lshl_b32 s92, s77, 16
    v_mul_f32 v18, s92, v8
    s_and_b32 s93, s77, s94
    v_mul_f32 v19, s93, v8
    s_lshl_b32 s92, s78, 16
    v_fmac_f32 v16, s92, v9
    s_and_b32 s93, s78, s94
    v_fmac_f32 v17, s93, v9
    s_lshl_b32 s92, s79, 16
    v_fmac_f32 v18, s92, v9
    s_and_b32 s93, s79, s94
    v_fmac_f32 v19, s93, v9
    s_lshl_b32 s92, s80, 16
    v_fmac_f32 v16, s92, v10
    s_and_b32 s93, s80, s94
    v_fmac_f32 v17, s93, v10
    s_lshl_b32 s92, s81, 16
    v_fmac_f32 v18, s92, v10
    s_and_b32 s93, s81, s94
    v_fmac_f32 v19, s93, v10
    s_lshl_b32 s92, s82, 16
    v_fmac_f32 v16, s92, v11
    s_and_b32 s93, s82, s94
    v_fmac_f32 v17, s93, v11
    s_lshl_b32 s92, s83, 16
    v_fmac_f32 v18, s92, v11
    s_and_b32 s93, s83, s94
    v_fmac_f32 v19, s93, v11
    v_mul_f32 v16, v16, v24
    v_mul_f32 v17, v17, v25
    v_mul_f32 v18, v18, v26
    v_mul_f32 v19, v19, v27
    v_cvt_pk_bf16_f32 v16, v16, v17
    v_and_b32 v17, s94, v16
    v_lshlrev_b32 v16, 16, v16
    v_cvt_pk_bf16_f32 v18, v18, v19
    v_and_b32 v19, s94, v18
    v_lshlrev_b32 v18, 16, v18
    s_lshl_b32 s92, s84, 16
    v_mul_f32 v20, s92, v16
    s_and_b32 s93, s84, s94
    v_mul_f32 v21, s93, v16
    s_lshl_b32 s92, s85, 16
    v_mul_f32 v22, s92, v16
    s_and_b32 s93, s85, s94
    v_mul_f32 v23, s93, v16
    s_lshl_b32 s92, s86, 16
    v_fmac_f32 v20, s92, v17
    s_and_b32 s93, s86, s94
    v_fmac_f32 v21, s93, v17
    s_lshl_b32 s92, s87, 16
    v_fmac_f32 v22, s92, v17
    s_and_b32 s93, s87, s94
    v_fmac_f32 v23, s93, v17
    s_lshl_b32 s92, s88, 16
    v_fmac_f32 v20, s92, v18
    s_and_b32 s93, s88, s94
    v_fmac_f32 v21, s93, v18
    s_lshl_b32 s92, s89, 16
    v_fmac_f32 v22, s92, v18
    s_and_b32 s93, s89, s94
    v_fmac_f32 v23, s93, v18
    s_lshl_b32 s92, s90, 16
    v_fmac_f32 v20, s92, v19
    s_and_b32 s93, s90, s94
    v_fmac_f32 v21, s93, v19
    s_lshl_b32 s92, s91, 16
    v_fmac_f32 v22, s92, v19
    s_and_b32 s93, s91, s94
    v_fmac_f32 v23, s93, v19
    v_cvt_pk_bf16_f32 v20, v20, v21
    v_and_b32 v21, s94, v20
    v_lshlrev_b32 v20, 16, v20
    v_cvt_pk_bf16_f32 v22, v22, v23
    v_and_b32 v23, s94, v22
    v_lshlrev_b32 v22, 16, v22
    v_mul_f32 v20, v20, v28
    v_mul_f32 v21, v21, v29
    v_mul_f32 v22, v22, v30
    v_mul_f32 v23, v23, v31
    v_cvt_pk_bf16_f32 v20, v20, v21
    v_and_b32 v21, s94, v20
    v_lshlrev_b32 v20, 16, v20
    v_cvt_pk_bf16_f32 v22, v22, v23
    v_and_b32 v23, s94, v22
    v_lshlrev_b32 v22, 16, v22
    s_waitcnt vmcnt(0)
    v_lshlrev_b32 v8, 16, v6
    v_and_b32 v9, s94, v6
    v_lshlrev_b32 v10, 16, v7
    v_and_b32 v11, s94, v7

    v_add_f32 v8, v8, v20
    v_add_f32 v9, v9, v21
    v_add_f32 v10, v10, v22
    v_add_f32 v11, v11, v23
    v_cvt_pk_bf16_f32 v12, v8, v9
    v_cvt_pk_bf16_f32 v13, v10, v11
    buffer_store_dwordx2 v[12:13], v2, s[36:39], 0 offen
L_fdone_48:
    s_endpgm

L_ffl_49:
    s_mov_b32 s3, 25600000
    buffer_load_dwordx4 v[12:15], v1, s[24:27], s3 offen
    s_waitcnt vmcnt(0)
    v_add_f32 v8, v8, v12
    v_add_f32 v9, v9, v13
    v_add_f32 v10, v10, v14
    v_add_f32 v11, v11, v15
    s_branch L_fbk_50

L_ffl_51:
    s_mov_b32 s3, 38400000
    buffer_load_dwordx4 v[12:15], v1, s[24:27], s3 offen
    s_waitcnt vmcnt(0)
    v_add_f32 v8, v8, v12
    v_add_f32 v9, v9, v13
    v_add_f32 v10, v10, v14
    v_add_f32 v11, v11, v15
    s_branch L_fbk_52

L_ffl_53:
    s_mov_b32 s3, 51200000
    buffer_load_dwordx4 v[12:15], v1, s[24:27], s3 offen
    s_waitcnt vmcnt(0)
    v_add_f32 v8, v8, v12
    v_add_f32 v9, v9, v13
    v_add_f32 v10, v10, v14
    v_add_f32 v11, v11, v15
    s_branch L_fbk_54

L_ffl_55:
    s_mov_b32 s3, 64000000
    buffer_load_dwordx4 v[12:15], v1, s[24:27], s3 offen
    s_waitcnt vmcnt(0)
    v_add_f32 v8, v8, v12
    v_add_f32 v9, v9, v13
    v_add_f32 v10, v10, v14
    v_add_f32 v11, v11, v15
    s_branch L_fbk_56

.section .rodata,"a"
.p2align 6
.amdhsa_kernel g0_kernel
  .amdhsa_next_free_vgpr 40
  .amdhsa_next_free_sgpr 32
  .amdhsa_accum_offset 40
  .amdhsa_group_segment_fixed_size 0
  .amdhsa_kernarg_size 112
  .amdhsa_user_sgpr_count 2
  .amdhsa_user_sgpr_kernarg_segment_ptr 1
  .amdhsa_system_sgpr_workgroup_id_x 1
.end_amdhsa_kernel
.p2align 6
.amdhsa_kernel g1_kernel
  .amdhsa_next_free_vgpr 128
  .amdhsa_next_free_sgpr 102
  .amdhsa_accum_offset 128
  .amdhsa_group_segment_fixed_size 0
  .amdhsa_kernarg_size 112
  .amdhsa_user_sgpr_count 2
  .amdhsa_user_sgpr_kernarg_segment_ptr 1
  .amdhsa_system_sgpr_workgroup_id_x 1
.end_amdhsa_kernel
.p2align 6
.amdhsa_kernel g2_kernel
  .amdhsa_next_free_vgpr 128
  .amdhsa_next_free_sgpr 102
  .amdhsa_accum_offset 128
  .amdhsa_group_segment_fixed_size 0
  .amdhsa_kernarg_size 112
  .amdhsa_user_sgpr_count 2
  .amdhsa_user_sgpr_kernarg_segment_ptr 1
  .amdhsa_system_sgpr_workgroup_id_x 1
  .amdhsa_float_denorm_mode_32 3
.end_amdhsa_kernel
.p2align 6
.amdhsa_kernel standalone__molecular_angular_gemnet__graph_kernel
  .amdhsa_next_free_vgpr 40
  .amdhsa_next_free_sgpr 100
  .amdhsa_accum_offset 40
  .amdhsa_group_segment_fixed_size 0
  .amdhsa_kernarg_size 112
  .amdhsa_user_sgpr_count 2
  .amdhsa_user_sgpr_kernarg_segment_ptr 1
  .amdhsa_system_sgpr_workgroup_id_x 1
  .amdhsa_float_denorm_mode_32 3
.end_amdhsa_kernel
```

```asm
; @launch kernel=g1_kernel grid=(256,1,1) block=(1024,1,1) lds=163840
; @launch kernel=g2_kernel grid=(256,1,1) block=(1024,1,1) lds=163840
; @launch kernel=standalone__molecular_angular_gemnet__graph_kernel grid=(3200,1,1) block=(256,1,1) lds=0
.amdgcn_target "amdgcn-amd-amdhsa--gfx950"
.text
.globl g1_kernel
.p2align 8
.type g1_kernel,@function
g1_kernel:
    s_cmp_ge_u32 s2, 256
    s_cbranch_scc1 L_p1done_1
    s_load_dwordx4 s[80:83], s[0:1], 8
    s_load_dwordx2 s[84:85], s[0:1], 32
    s_load_dwordx2 s[86:87], s[0:1], 48
    s_load_dwordx4 s[4:7], s[0:1], 96
    s_load_dwordx2 s[78:79], s[0:1], 0
    v_lshlrev_b32 v1, 4, v0
    v_lshlrev_b32 v2, 3, v0
    v_lshlrev_b32 v98, 20, v0
    s_mul_i32 s3, s2, 25000
    s_waitcnt lgkmcnt(0)
    s_load_dword s88, s[86:87], 0

    s_mov_b32 s96, s4
    s_mov_b32 s97, s5
    s_mov_b32 s98, 256
    s_mov_b32 s99, 0x20000
    v_readfirstlane_b32 s74, v0
    s_nop 1
    s_or_b32 s74, s74, s2
    s_cbranch_scc1 L_noinit_2

    v_mov_b32 v110, 1
    buffer_atomic_add v110, v98, s[96:99], 0 offen offset:64 sc0
    s_waitcnt vmcnt(0)
    v_readfirstlane_b32 s74, v110
    s_nop 1
    s_cmp_lg_u32 s74, 0
    s_cbranch_scc1 L_zno_4

    s_mov_b32 s92, s6
    s_mov_b32 s93, s7
    s_mov_b32 s94, 65552
    s_mov_b32 s95, 0x20000
    v_mov_b32 v110, 0
    v_mov_b32 v111, 0
    v_mov_b32 v112, 0
    v_mov_b32 v113, 0
L_zl_3:
    buffer_store_dwordx4 v[110:113], v1, s[92:95], s74 offen sc0 sc1
    s_add_u32 s74, s74, 1024
    s_cmp_le_u32 s74, 65536
    s_cbranch_scc1 L_zl_3
    v_mov_b32 v114, 1
    s_waitcnt vmcnt(0)
    buffer_atomic_add v114, v98, s[96:99], 0 offen offset:128
L_zno_4:

L_noinit_2:
    s_add_u32 s20, s78, s3
    s_addc_u32 s21, s79, 0
    s_mov_b32 s22, 25000
    s_mov_b32 s23, 0x20000
    s_movk_i32 s3, 16384
    buffer_load_dwordx4 v[44:47], v1, s[20:23], 0 offen
    buffer_load_dwordx4 v[48:51], v1, s[20:23], s3 offen
    s_mov_b32 s8, s80
    s_mov_b32 s9, s81
    s_mov_b32 s10, 0
    s_mov_b32 s11, 0x20000
    s_mov_b32 s12, s82
    s_mov_b32 s13, s83
    s_mov_b32 s14, 0
    s_mov_b32 s15, 0x20000
    s_mov_b32 s16, s84
    s_mov_b32 s17, s85
    s_mov_b32 s18, 0
    s_mov_b32 s19, 0x20000
    s_mul_i32 s78, s2, 16000
    s_add_u32 s49, s78, 16000
    s_cmp_ge_u32 s2, 3200
    s_cmovk_i32 s49, 0
    s_cmovk_i32 s78, 0
    s_lshl_b32 s10, s49, 2
    s_lshl_b32 s14, s49, 2
    s_lshl_b32 s18, s49, 1
    s_lshl_b32 s56, s78, 2
    s_lshl_b32 s61, s78, 1

    s_add_u32 s57, s56, 16384
    s_add_u32 s62, s61, 8192
    s_add_u32 s58, s56, 32768
    s_add_u32 s63, s61, 16384
    s_add_u32 s59, s56, 49152
    s_add_u32 s64, s61, 24576
    s_mov_b32 s41, s2
    buffer_load_dwordx4 v[20:23], v1, s[12:15], s56 offen nt
    buffer_load_dwordx4 v[4:7], v1, s[8:11], s56 offen nt
    buffer_load_dwordx2 v[36:37], v2, s[16:19], s61 offen nt
    buffer_load_dwordx4 v[24:27], v1, s[12:15], s57 offen nt
    buffer_load_dwordx4 v[8:11], v1, s[8:11], s57 offen nt
    buffer_load_dwordx2 v[38:39], v2, s[16:19], s62 offen nt
    buffer_load_dwordx4 v[28:31], v1, s[12:15], s58 offen nt
    buffer_load_dwordx4 v[12:15], v1, s[8:11], s58 offen nt
    buffer_load_dwordx2 v[40:41], v2, s[16:19], s63 offen nt
    buffer_load_dwordx4 v[32:35], v1, s[12:15], s59 offen nt
    buffer_load_dwordx4 v[16:19], v1, s[8:11], s59 offen nt
    buffer_load_dwordx2 v[42:43], v2, s[16:19], s64 offen nt
    s_and_b32 s5, s2, 7
    s_mul_i32 s3, s5, 8192

    s_add_u32 s20, s6, s3
    s_addc_u32 s21, s7, 0
    s_mov_b32 s22, 8192
    s_mov_b32 s23, 0x20000
    s_mul_i32 s3, s5, 40632320
    s_add_u32 s3, s3, 77848576
    s_add_u32 s24, s6, s3
    s_addc_u32 s25, s7, 0
    s_mov_b32 s26, 40632320
    s_mov_b32 s27, 0x20000
    s_add_u32 s28, s6, s3
    s_addc_u32 s29, s7, 0
    s_mov_b32 s30, 40632320
    s_mov_b32 s31, 0x20000
    s_add_u32 s32, s6, 402907136
    s_addc_u32 s33, s7, 0
    s_mov_b32 s34, 409600000
    s_mov_b32 s35, 0x20000
    s_add_u32 s36, s6, 65536
    s_addc_u32 s37, s7, 0
    s_mov_b32 s38, 4
    s_mov_b32 s39, 0x20000
    s_mov_b32 s40, 687195
    s_mov_b32 s42, -6250
    s_mov_b32 s43, 1942
    s_mov_b32 s45, 0x06050400
    s_mov_b32 s46, 0x05040c00
    s_mov_b32 s47, 0x04020100
    s_mov_b32 s48, 3968
    s_mov_b32 s50, 0
    s_mov_b32 s53, 0
    v_mov_b32 v104, 1
    v_mov_b32 v105, 0x46ff8000
    s_mov_b32 s55, 0x05040100
    v_mul_u32_u24 v106, 5, v0
    v_mov_b32 v108, 16384
    v_mov_b32 v110, 0
    v_mov_b32 v111, 0
    v_mov_b32 v112, 0
    v_mov_b32 v113, 0
    ds_write_b64 v2, v[110:111]
    v_mov_b32 v114, 0
    v_mov_b32 v115, 0
    v_mov_b32 v116, 0
    v_mov_b32 v117, -1
    v_mov_b32 v118, 144404
    s_movk_i32 s3, 928
    v_cmp_gt_u32 s[66:67], s3, v0
    s_movk_i32 s3, 640
    v_cmp_gt_u32 s[68:69], s3, v0
    s_mov_b64 exec, 1
    ds_write_b128 v108, v[114:117]
    ds_write_b32 v118, v117
    s_mov_b64 exec, -1
    s_waitcnt lgkmcnt(0)
    s_lshl_b32 s88, s88, 16
    v_mov_b32 v110, 0.15915494
    v_mul_f32 v110, s88, v110
    s_mov_b32 s3, 0x7fff7fff
    v_readfirstlane_b32 s44, v110

    s_waitcnt vmcnt(12)
    v_and_b32 v44, s3, v44
    v_and_b32 v45, s3, v45
    v_and_b32 v46, s3, v46
    v_and_b32 v47, s3, v47
    v_and_b32 v48, s3, v48
    v_and_b32 v49, s3, v49
    v_and_b32 v50, s3, v50
    v_and_b32 v51, s3, v51
    v_mov_b32 v53, 0
    v_dot2_f32_bf16 v53, v44, v44, v53
    v_dot2_f32_bf16 v53, v45, v45, v53
    v_dot2_f32_bf16 v53, v46, v46, v53
    v_dot2_f32_bf16 v53, v47, v47, v53
    v_dot2_f32_bf16 v53, v48, v48, v53
    v_dot2_f32_bf16 v53, v49, v49, v53
    v_dot2_f32_bf16 v53, v50, v50, v53
    v_dot2_f32_bf16 v53, v51, v51, v53
    v_pk_max_u16 v44, v44, v45
    v_pk_max_u16 v44, v44, v46
    v_pk_max_u16 v44, v44, v47
    v_pk_max_u16 v44, v44, v48
    v_pk_max_u16 v44, v44, v49
    v_pk_max_u16 v44, v44, v50
    v_pk_max_u16 v44, v44, v51
    v_lshrrev_b32 v52, 16, v44
    v_and_b32 v44, 0xffff, v44
    v_max_u32 v52, v52, v44

    s_nop 1
    v_max_u32_dpp v52, v52, v52 row_shr:1 row_mask:0xf bank_mask:0xf
    s_nop 1
    v_max_u32_dpp v52, v52, v52 row_shr:2 row_mask:0xf bank_mask:0xf
    s_nop 1
    v_max_u32_dpp v52, v52, v52 row_shr:4 row_mask:0xf bank_mask:0xf
    s_nop 1
    v_max_u32_dpp v52, v52, v52 row_shr:8 row_mask:0xf bank_mask:0xf
    s_nop 1
    v_max_u32_dpp v52, v52, v52 row_bcast:15 row_mask:0xa bank_mask:0xf
    s_nop 1
    v_max_u32_dpp v52, v52, v52 row_bcast:31 row_mask:0xc bank_mask:0xf
    s_nop 1
    v_add_f32_dpp v53, v53, v53 row_shr:1 row_mask:0xf bank_mask:0xf
    s_nop 1
    v_add_f32_dpp v53, v53, v53 row_shr:2 row_mask:0xf bank_mask:0xf
    s_nop 1
    v_add_f32_dpp v53, v53, v53 row_shr:4 row_mask:0xf bank_mask:0xf
    s_nop 1
    v_add_f32_dpp v53, v53, v53 row_shr:8 row_mask:0xf bank_mask:0xf
    s_nop 1
    v_add_f32_dpp v53, v53, v53 row_bcast:15 row_mask:0xa bank_mask:0xf
    s_nop 1
    v_add_f32_dpp v53, v53, v53 row_bcast:31 row_mask:0xc bank_mask:0xf
    v_lshrrev_b32 v54, 6, v0
    v_lshlrev_b32 v54, 3, v54
    s_mov_b32 exec_lo, 0
    s_brev_b32 exec_hi, 1
    ds_write_b64 v54, v[52:53] offset:16400
    s_mov_b64 exec, -1
    v_and_b32 v54, 15, v0
    v_lshlrev_b32 v54, 3, v54
    s_waitcnt lgkmcnt(0)
    s_barrier
    ds_read_b64 v[52:53], v54 offset:16400
    s_waitcnt lgkmcnt(0)

    s_nop 1
    v_max_u32_dpp v52, v52, v52 row_ror:1 row_mask:0xf bank_mask:0xf
    v_add_f32_dpp v53, v53, v53 row_ror:1 row_mask:0xf bank_mask:0xf

    s_nop 1
    v_max_u32_dpp v52, v52, v52 row_ror:2 row_mask:0xf bank_mask:0xf
    v_add_f32_dpp v53, v53, v53 row_ror:2 row_mask:0xf bank_mask:0xf

    s_nop 1
    v_max_u32_dpp v52, v52, v52 row_ror:4 row_mask:0xf bank_mask:0xf
    v_add_f32_dpp v53, v53, v53 row_ror:4 row_mask:0xf bank_mask:0xf

    s_nop 1
    v_max_u32_dpp v52, v52, v52 row_ror:8 row_mask:0xf bank_mask:0xf
    v_add_f32_dpp v53, v53, v53 row_ror:8 row_mask:0xf bank_mask:0xf

    s_add_u32 s80, s6, 135168
    s_addc_u32 s81, s7, 0
    s_mov_b32 s82, 2048
    s_mov_b32 s83, 0x20000
    s_lshl_b32 s3, s2, 3
    buffer_store_dwordx2 v[52:53], v98, s[80:83], s3 offen
    s_waitcnt vmcnt(10)
    v_mul_hi_u32_u24 v45, s40, v20
    v_mul_hi_u32_u24 v44, s40, v4
    v_mul_hi_u32_u24 v47, s40, v21
    v_mul_hi_u32_u24 v46, s40, v5
    v_mul_hi_u32_u24 v49, s40, v22
    v_mul_hi_u32_u24 v48, s40, v6
    v_mul_hi_u32_u24 v51, s40, v23
    v_mul_hi_u32_u24 v50, s40, v7
    v_and_b32 v45, -2, v45
    v_mad_u32_u24 v4, v44, s43, v4
    v_and_b32 v76, -4, v44
    v_and_b32 v47, -2, v47
    v_mad_u32_u24 v5, v46, s43, v5
    v_and_b32 v77, -4, v46
    v_and_b32 v49, -2, v49
    v_mad_u32_u24 v6, v48, s43, v6
    v_and_b32 v78, -4, v48
    v_and_b32 v51, -2, v51
    v_mad_u32_u24 v7, v50, s43, v7
    v_and_b32 v79, -4, v50
    v_mad_i32_i24 v20, v45, s42, v20
    v_lshl_add_u32 v45, v76, 5, v45
    v_mad_i32_i24 v21, v47, s42, v21
    v_lshl_add_u32 v47, v77, 5, v47
    v_mad_i32_i24 v22, v49, s42, v22
    v_lshl_add_u32 v49, v78, 5, v49
    v_mad_i32_i24 v23, v51, s42, v23
    v_lshl_add_u32 v51, v79, 5, v51
    v_add_u32 v45, v45, v45
    ds_add_rtn_u32 v76, v45, v104
    v_add_u32 v47, v47, v47
    ds_add_rtn_u32 v77, v47, v104
    v_add_u32 v49, v49, v49
    ds_add_rtn_u32 v78, v49, v104
    v_add_u32 v51, v51, v51
    ds_add_rtn_u32 v79, v51, v104
    v_lshlrev_b32 v110, 16, v36
    v_and_b32 v111, 0xffff0000, v36
    v_lshlrev_b32 v112, 16, v37
    v_and_b32 v113, 0xffff0000, v37
    v_mul_f32 v110, s44, v110
    v_mul_f32 v111, s44, v111
    v_mul_f32 v112, s44, v112
    v_mul_f32 v113, s44, v113
    v_fract_f32 v110, v110
    v_fract_f32 v111, v111
    v_fract_f32 v112, v112
    v_fract_f32 v113, v113
    v_cos_f32 v110, v110
    v_cos_f32 v111, v111
    v_cos_f32 v112, v112
    v_cos_f32 v113, v113
    v_lshl_or_b32 v44, v44, 14, v20
    v_perm_b32 v45, v45, v4, s46
    v_bfe_u32 v4, v4, 8, 5

    v_lshl_or_b32 v46, v46, 14, v21
    v_perm_b32 v47, v47, v5, s46
    v_bfe_u32 v5, v5, 8, 5

    v_lshl_or_b32 v48, v48, 14, v22
    v_perm_b32 v49, v49, v6, s46
    v_bfe_u32 v6, v6, 8, 5

    v_lshl_or_b32 v50, v50, 14, v23
    v_perm_b32 v51, v51, v7, s46
    v_bfe_u32 v7, v7, 8, 5

    v_fmaak_f32 v110, v110, v105, 0x4b400010
    v_fmaak_f32 v111, v111, v105, 0x4b400010
    v_fmaak_f32 v112, v112, v105, 0x4b400010
    v_fmaak_f32 v113, v113, v105, 0x4b400010
    v_sub_u32 v110, v110, v4
    v_sub_u32 v111, v111, v5
    v_sub_u32 v112, v112, v6
    v_sub_u32 v113, v113, v7
    v_bfi_b32 v110, 31, v4, v110
    v_bfi_b32 v111, 31, v5, v111
    v_bfi_b32 v112, 31, v6, v112
    v_bfi_b32 v113, 31, v7, v113
    v_perm_b32 v44, v44, v110, s55
    v_perm_b32 v46, v46, v111, s55
    v_perm_b32 v48, v48, v112, s55
    v_perm_b32 v50, v50, v113, s55
    v_mov_b32 v94, 1
    buffer_atomic_add v94, v98, s[96:99], 0 offen sc0
    s_waitcnt vmcnt(8)
    v_mul_hi_u32_u24 v53, s40, v24
    v_mul_hi_u32_u24 v52, s40, v8
    v_mul_hi_u32_u24 v55, s40, v25
    v_mul_hi_u32_u24 v54, s40, v9
    v_mul_hi_u32_u24 v57, s40, v26
    v_mul_hi_u32_u24 v56, s40, v10
    v_mul_hi_u32_u24 v59, s40, v27
    v_mul_hi_u32_u24 v58, s40, v11
    v_and_b32 v53, -2, v53
    v_mad_u32_u24 v8, v52, s43, v8
    v_and_b32 v80, -4, v52
    v_and_b32 v55, -2, v55
    v_mad_u32_u24 v9, v54, s43, v9
    v_and_b32 v81, -4, v54
    v_and_b32 v57, -2, v57
    v_mad_u32_u24 v10, v56, s43, v10
    v_and_b32 v82, -4, v56
    v_and_b32 v59, -2, v59
    v_mad_u32_u24 v11, v58, s43, v11
    v_and_b32 v83, -4, v58
    v_mad_i32_i24 v24, v53, s42, v24
    v_lshl_add_u32 v53, v80, 5, v53
    v_mad_i32_i24 v25, v55, s42, v25
    v_lshl_add_u32 v55, v81, 5, v55
    v_mad_i32_i24 v26, v57, s42, v26
    v_lshl_add_u32 v57, v82, 5, v57
    v_mad_i32_i24 v27, v59, s42, v27
    v_lshl_add_u32 v59, v83, 5, v59
    v_add_u32 v53, v53, v53
    ds_add_rtn_u32 v80, v53, v104
    v_add_u32 v55, v55, v55
    ds_add_rtn_u32 v81, v55, v104
    v_add_u32 v57, v57, v57
    ds_add_rtn_u32 v82, v57, v104
    v_add_u32 v59, v59, v59
    ds_add_rtn_u32 v83, v59, v104
    v_lshlrev_b32 v110, 16, v38
    v_and_b32 v111, 0xffff0000, v38
    v_lshlrev_b32 v112, 16, v39
    v_and_b32 v113, 0xffff0000, v39
    v_mul_f32 v110, s44, v110
    v_mul_f32 v111, s44, v111
    v_mul_f32 v112, s44, v112
    v_mul_f32 v113, s44, v113
    v_fract_f32 v110, v110
    v_fract_f32 v111, v111
    v_fract_f32 v112, v112
    v_fract_f32 v113, v113
    v_cos_f32 v110, v110
    v_cos_f32 v111, v111
    v_cos_f32 v112, v112
    v_cos_f32 v113, v113
    v_lshl_or_b32 v52, v52, 14, v24
    v_perm_b32 v53, v53, v8, s46
    v_bfe_u32 v8, v8, 8, 5

    v_lshl_or_b32 v54, v54, 14, v25
    v_perm_b32 v55, v55, v9, s46
    v_bfe_u32 v9, v9, 8, 5

    v_lshl_or_b32 v56, v56, 14, v26
    v_perm_b32 v57, v57, v10, s46
    v_bfe_u32 v10, v10, 8, 5

    v_lshl_or_b32 v58, v58, 14, v27
    v_perm_b32 v59, v59, v11, s46
    v_bfe_u32 v11, v11, 8, 5

    v_fmaak_f32 v110, v110, v105, 0x4b400010
    v_fmaak_f32 v111, v111, v105, 0x4b400010
    v_fmaak_f32 v112, v112, v105, 0x4b400010
    v_fmaak_f32 v113, v113, v105, 0x4b400010
    v_sub_u32 v110, v110, v8
    v_sub_u32 v111, v111, v9
    v_sub_u32 v112, v112, v10
    v_sub_u32 v113, v113, v11
    v_bfi_b32 v110, 31, v8, v110
    v_bfi_b32 v111, 31, v9, v111
    v_bfi_b32 v112, 31, v10, v112
    v_bfi_b32 v113, 31, v11, v113
    v_perm_b32 v52, v52, v110, s55
    v_perm_b32 v54, v54, v111, s55
    v_perm_b32 v56, v56, v112, s55
    v_perm_b32 v58, v58, v113, s55
    s_waitcnt vmcnt(5)
    v_mul_hi_u32_u24 v61, s40, v28
    v_mul_hi_u32_u24 v60, s40, v12
    v_mul_hi_u32_u24 v63, s40, v29
    v_mul_hi_u32_u24 v62, s40, v13
    v_mul_hi_u32_u24 v65, s40, v30
    v_mul_hi_u32_u24 v64, s40, v14
    v_mul_hi_u32_u24 v67, s40, v31
    v_mul_hi_u32_u24 v66, s40, v15
    v_and_b32 v61, -2, v61
    v_mad_u32_u24 v12, v60, s43, v12
    v_and_b32 v84, -4, v60
    v_and_b32 v63, -2, v63
    v_mad_u32_u24 v13, v62, s43, v13
    v_and_b32 v85, -4, v62
    v_and_b32 v65, -2, v65
    v_mad_u32_u24 v14, v64, s43, v14
    v_and_b32 v86, -4, v64
    v_and_b32 v67, -2, v67
    v_mad_u32_u24 v15, v66, s43, v15
    v_and_b32 v87, -4, v66
    v_mad_i32_i24 v28, v61, s42, v28
    v_lshl_add_u32 v61, v84, 5, v61
    v_mad_i32_i24 v29, v63, s42, v29
    v_lshl_add_u32 v63, v85, 5, v63
    v_mad_i32_i24 v30, v65, s42, v30
    v_lshl_add_u32 v65, v86, 5, v65
    v_mad_i32_i24 v31, v67, s42, v31
    v_lshl_add_u32 v67, v87, 5, v67
    v_add_u32 v61, v61, v61
    ds_add_rtn_u32 v84, v61, v104
    v_add_u32 v63, v63, v63
    ds_add_rtn_u32 v85, v63, v104
    v_add_u32 v65, v65, v65
    ds_add_rtn_u32 v86, v65, v104
    v_add_u32 v67, v67, v67
    ds_add_rtn_u32 v87, v67, v104
    v_lshlrev_b32 v110, 16, v40
    v_and_b32 v111, 0xffff0000, v40
    v_lshlrev_b32 v112, 16, v41
    v_and_b32 v113, 0xffff0000, v41
    v_mul_f32 v110, s44, v110
    v_mul_f32 v111, s44, v111
    v_mul_f32 v112, s44, v112
    v_mul_f32 v113, s44, v113
    v_fract_f32 v110, v110
    v_fract_f32 v111, v111
    v_fract_f32 v112, v112
    v_fract_f32 v113, v113
    v_cos_f32 v110, v110
    v_cos_f32 v111, v111
    v_cos_f32 v112, v112
    v_cos_f32 v113, v113
    v_lshl_or_b32 v60, v60, 14, v28
    v_perm_b32 v61, v61, v12, s46
    v_bfe_u32 v12, v12, 8, 5

    v_lshl_or_b32 v62, v62, 14, v29
    v_perm_b32 v63, v63, v13, s46
    v_bfe_u32 v13, v13, 8, 5

    v_lshl_or_b32 v64, v64, 14, v30
    v_perm_b32 v65, v65, v14, s46
    v_bfe_u32 v14, v14, 8, 5

    v_lshl_or_b32 v66, v66, 14, v31
    v_perm_b32 v67, v67, v15, s46
    v_bfe_u32 v15, v15, 8, 5

    v_fmaak_f32 v110, v110, v105, 0x4b400010
    v_fmaak_f32 v111, v111, v105, 0x4b400010
    v_fmaak_f32 v112, v112, v105, 0x4b400010
    v_fmaak_f32 v113, v113, v105, 0x4b400010
    v_sub_u32 v110, v110, v12
    v_sub_u32 v111, v111, v13
    v_sub_u32 v112, v112, v14
    v_sub_u32 v113, v113, v15
    v_bfi_b32 v110, 31, v12, v110
    v_bfi_b32 v111, 31, v13, v111
    v_bfi_b32 v112, 31, v14, v112
    v_bfi_b32 v113, 31, v15, v113
    v_perm_b32 v60, v60, v110, s55
    v_perm_b32 v62, v62, v111, s55
    v_perm_b32 v64, v64, v112, s55
    v_perm_b32 v66, v66, v113, s55
    v_mov_b32 v95, 0
    buffer_atomic_add v95, v98, s[96:99], 0 offen offset:128 sc0
    s_waitcnt vmcnt(3)
    s_mov_b64 exec, s[66:67]
    v_mul_hi_u32_u24 v69, s40, v32
    v_mul_hi_u32_u24 v68, s40, v16
    v_mul_hi_u32_u24 v71, s40, v33
    v_mul_hi_u32_u24 v70, s40, v17
    v_mul_hi_u32_u24 v73, s40, v34
    v_mul_hi_u32_u24 v72, s40, v18
    v_mul_hi_u32_u24 v75, s40, v35
    v_mul_hi_u32_u24 v74, s40, v19
    v_and_b32 v69, -2, v69
    v_mad_u32_u24 v16, v68, s43, v16
    v_and_b32 v88, -4, v68
    v_and_b32 v71, -2, v71
    v_mad_u32_u24 v17, v70, s43, v17
    v_and_b32 v89, -4, v70
    v_and_b32 v73, -2, v73
    v_mad_u32_u24 v18, v72, s43, v18
    v_and_b32 v90, -4, v72
    v_and_b32 v75, -2, v75
    v_mad_u32_u24 v19, v74, s43, v19
    v_and_b32 v91, -4, v74
    v_mad_i32_i24 v32, v69, s42, v32
    v_lshl_add_u32 v69, v88, 5, v69
    v_mad_i32_i24 v33, v71, s42, v33
    v_lshl_add_u32 v71, v89, 5, v71
    v_mad_i32_i24 v34, v73, s42, v34
    v_lshl_add_u32 v73, v90, 5, v73
    v_mad_i32_i24 v35, v75, s42, v35
    v_lshl_add_u32 v75, v91, 5, v75
    v_add_u32 v69, v69, v69
    ds_add_rtn_u32 v88, v69, v104
    v_add_u32 v71, v71, v71
    ds_add_rtn_u32 v89, v71, v104
    v_add_u32 v73, v73, v73
    ds_add_rtn_u32 v90, v73, v104
    v_add_u32 v75, v75, v75
    ds_add_rtn_u32 v91, v75, v104
    v_lshlrev_b32 v110, 16, v42
    v_and_b32 v111, 0xffff0000, v42
    v_lshlrev_b32 v112, 16, v43
    v_and_b32 v113, 0xffff0000, v43
    v_mul_f32 v110, s44, v110
    v_mul_f32 v111, s44, v111
    v_mul_f32 v112, s44, v112
    v_mul_f32 v113, s44, v113
    v_fract_f32 v110, v110
    v_fract_f32 v111, v111
    v_fract_f32 v112, v112
    v_fract_f32 v113, v113
    v_cos_f32 v110, v110
    v_cos_f32 v111, v111
    v_cos_f32 v112, v112
    v_cos_f32 v113, v113
    v_lshl_or_b32 v68, v68, 14, v32
    v_perm_b32 v69, v69, v16, s46
    v_bfe_u32 v16, v16, 8, 5

    v_lshl_or_b32 v70, v70, 14, v33
    v_perm_b32 v71, v71, v17, s46
    v_bfe_u32 v17, v17, 8, 5

    v_lshl_or_b32 v72, v72, 14, v34
    v_perm_b32 v73, v73, v18, s46
    v_bfe_u32 v18, v18, 8, 5

    v_lshl_or_b32 v74, v74, 14, v35
    v_perm_b32 v75, v75, v19, s46
    v_bfe_u32 v19, v19, 8, 5

    v_fmaak_f32 v110, v110, v105, 0x4b400010
    v_fmaak_f32 v111, v111, v105, 0x4b400010
    v_fmaak_f32 v112, v112, v105, 0x4b400010
    v_fmaak_f32 v113, v113, v105, 0x4b400010
    v_sub_u32 v110, v110, v16
    v_sub_u32 v111, v111, v17
    v_sub_u32 v112, v112, v18
    v_sub_u32 v113, v113, v19
    v_bfi_b32 v110, 31, v16, v110
    v_bfi_b32 v111, 31, v17, v111
    v_bfi_b32 v112, 31, v18, v112
    v_bfi_b32 v113, 31, v19, v113
    v_perm_b32 v68, v68, v110, s55
    v_perm_b32 v70, v70, v111, s55
    v_perm_b32 v72, v72, v112, s55
    v_perm_b32 v74, v74, v113, s55
    s_mov_b64 exec, -1
    s_waitcnt vmcnt(0)
    v_or_b32 v95, v95, v0
    s_nop 0
    v_readfirstlane_b32 s74, v95
    s_nop 1
    s_cmp_lg_u32 s74, 0
    s_cbranch_scc1 L_ready_8

    v_mov_b32 v110, 1
    buffer_atomic_add v110, v98, s[96:99], 0 offen offset:64 sc0
    s_waitcnt vmcnt(0)
    v_readfirstlane_b32 s74, v110
    s_nop 1
    s_cmp_lg_u32 s74, 0
    s_cbranch_scc1 L_zno_10

    s_mov_b32 s92, s6
    s_mov_b32 s93, s7
    s_mov_b32 s94, 65552
    s_mov_b32 s95, 0x20000
    v_mov_b32 v110, 0
    v_mov_b32 v111, 0
    v_mov_b32 v112, 0
    v_mov_b32 v113, 0
L_zl_9:
    buffer_store_dwordx4 v[110:113], v1, s[92:95], s74 offen sc0 sc1
    s_add_u32 s74, s74, 1024
    s_cmp_le_u32 s74, 65536
    s_cbranch_scc1 L_zl_9
    v_mov_b32 v114, 1
    s_waitcnt vmcnt(0)
    buffer_atomic_add v114, v98, s[96:99], 0 offen offset:128
L_zno_10:

L_spin_7:
    v_mov_b32 v95, 0
    buffer_atomic_add v95, v98, s[96:99], 0 offen offset:128 sc0
    s_waitcnt vmcnt(0)
    v_readfirstlane_b32 s74, v95
    s_nop 1
    s_cmp_eq_u32 s74, 0
    s_cbranch_scc1 L_spin_7
L_ready_8:

    v_cmp_eq_u32 vcc, 0, v0
    s_waitcnt vmcnt(1)
    s_mov_b64 exec, vcc
    ds_write_b32 v108, v94 offset:8
    s_mov_b64 exec, -1
    s_waitcnt lgkmcnt(0)
    s_barrier

    ds_read_b32 v110, v108 offset:8
    ds_read_b64 v[94:95], v2
    s_waitcnt lgkmcnt(0)

    v_readfirstlane_b32 s41, v110
    v_and_b32 v94, 0xffff, v94
    v_and_b32 v95, 0xffff, v95
    v_add_u32 v92, v94, v94
    v_add_u32 v93, v95, v95
    v_add_u32 v97, v94, v95
    v_med3_u32 v92, v94, 2, v92
    v_med3_u32 v93, v95, 2, v93
    buffer_atomic_add_x2 v[92:93], v2, s[20:23], 0 offen sc0
    s_nop 1
    v_add_u32_dpp v97, v97, v97 row_shr:1 row_mask:0xf bank_mask:0xf
    s_nop 1
    v_add_u32_dpp v97, v97, v97 row_shr:2 row_mask:0xf bank_mask:0xf
    s_nop 1
    v_add_u32_dpp v97, v97, v97 row_shr:4 row_mask:0xf bank_mask:0xf
    s_nop 1
    v_add_u32_dpp v97, v97, v97 row_shr:8 row_mask:0xf bank_mask:0xf
    s_nop 1
    v_add_u32_dpp v97, v97, v97 row_bcast:15 row_mask:0xa bank_mask:0xf
    s_nop 1
    v_add_u32_dpp v97, v97, v97 row_bcast:31 row_mask:0xc bank_mask:0xf
    s_mov_b32 exec_lo, 0
    s_brev_b32 exec_hi, 1
    ds_add_rtn_u32 v96, v108, v97
    s_mov_b64 exec, -1

    s_add_u32 s41, s41, 256
    s_mul_i32 s78, s41, 16000
    s_add_u32 s49, s78, 16000
    s_cmp_ge_u32 s41, 3200
    s_cmovk_i32 s49, 0
    s_cmovk_i32 s78, 0
    s_lshl_b32 s10, s49, 2
    s_lshl_b32 s14, s49, 2
    s_lshl_b32 s18, s49, 1
    s_lshl_b32 s56, s78, 2
    s_lshl_b32 s61, s78, 1

    s_add_u32 s57, s56, 16384
    s_add_u32 s62, s61, 8192
    s_add_u32 s58, s56, 32768
    s_add_u32 s63, s61, 16384
    s_add_u32 s59, s56, 49152
    s_add_u32 s64, s61, 24576
    buffer_load_dwordx4 v[20:23], v1, s[12:15], s56 offen nt
    buffer_load_dwordx4 v[4:7], v1, s[8:11], s56 offen nt
    buffer_load_dwordx2 v[36:37], v2, s[16:19], s61 offen nt
    s_waitcnt lgkmcnt(0)
    v_readlane_b32 s77, v96, 63
    v_mul_u32_u24 v114, 7936, v0
    v_sub_u32 v97, v97, v95
    s_sub_u32 s77, s77, s50
    v_add_u32 v97, s77, v97
    v_sub_u32 v96, v97, v94
    v_lshlrev_b32 v111, 16, v97
    v_lshlrev_b32 v110, 16, v96
    ds_write_b64 v2, v[110:111]
    v_sub_u32 v96, v114, v96
    v_sub_u32 v97, v114, v97
    v_add_u32 v97, s48, v97

    s_waitcnt lgkmcnt(0)
    s_barrier

    v_lshrrev_b32 v110, 16, v45
    ds_read_b32 v110, v110
    v_lshrrev_b32 v111, 16, v47
    ds_read_b32 v111, v111
    v_lshrrev_b32 v112, 16, v49
    ds_read_b32 v112, v112
    v_lshrrev_b32 v113, 16, v51
    ds_read_b32 v113, v113
    v_lshrrev_b32 v114, 16, v53
    ds_read_b32 v114, v114
    v_lshrrev_b32 v115, 16, v55
    ds_read_b32 v115, v115
    v_lshrrev_b32 v116, 16, v57
    ds_read_b32 v116, v116
    v_lshrrev_b32 v117, 16, v59
    ds_read_b32 v117, v117
    s_waitcnt lgkmcnt(7)
    v_add_u32_sdwa v110, v110, v76 dst_sel:DWORD dst_unused:UNUSED_PAD src0_sel:WORD_1 src1_sel:WORD_0
    v_lshlrev_b32 v110, 3, v110
    ds_write_b64 v110, v[44:45] offset:16400

    s_waitcnt lgkmcnt(7)
    v_add_u32_sdwa v111, v111, v77 dst_sel:DWORD dst_unused:UNUSED_PAD src0_sel:WORD_1 src1_sel:WORD_0
    v_lshlrev_b32 v111, 3, v111
    ds_write_b64 v111, v[46:47] offset:16400

    s_waitcnt lgkmcnt(7)
    v_add_u32_sdwa v112, v112, v78 dst_sel:DWORD dst_unused:UNUSED_PAD src0_sel:WORD_1 src1_sel:WORD_0
    v_lshlrev_b32 v112, 3, v112
    ds_write_b64 v112, v[48:49] offset:16400

    s_waitcnt lgkmcnt(7)
    v_add_u32_sdwa v113, v113, v79 dst_sel:DWORD dst_unused:UNUSED_PAD src0_sel:WORD_1 src1_sel:WORD_0
    v_lshlrev_b32 v113, 3, v113
    ds_write_b64 v113, v[50:51] offset:16400

    s_waitcnt lgkmcnt(7)
    v_add_u32_sdwa v114, v114, v80 dst_sel:DWORD dst_unused:UNUSED_PAD src0_sel:WORD_1 src1_sel:WORD_0
    v_lshlrev_b32 v114, 3, v114
    ds_write_b64 v114, v[52:53] offset:16400

    s_waitcnt lgkmcnt(7)
    v_add_u32_sdwa v115, v115, v81 dst_sel:DWORD dst_unused:UNUSED_PAD src0_sel:WORD_1 src1_sel:WORD_0
    v_lshlrev_b32 v115, 3, v115
    ds_write_b64 v115, v[54:55] offset:16400

    s_waitcnt lgkmcnt(7)
    v_add_u32_sdwa v116, v116, v82 dst_sel:DWORD dst_unused:UNUSED_PAD src0_sel:WORD_1 src1_sel:WORD_0
    v_lshlrev_b32 v116, 3, v116
    ds_write_b64 v116, v[56:57] offset:16400

    s_waitcnt lgkmcnt(7)
    v_add_u32_sdwa v117, v117, v83 dst_sel:DWORD dst_unused:UNUSED_PAD src0_sel:WORD_1 src1_sel:WORD_0
    v_lshlrev_b32 v117, 3, v117
    ds_write_b64 v117, v[58:59] offset:16400

    buffer_load_dwordx4 v[24:27], v1, s[12:15], s57 offen nt
    buffer_load_dwordx4 v[8:11], v1, s[8:11], s57 offen nt
    buffer_load_dwordx2 v[38:39], v2, s[16:19], s62 offen nt
    v_lshrrev_b32 v110, 16, v61
    ds_read_b32 v110, v110
    v_lshrrev_b32 v111, 16, v63
    ds_read_b32 v111, v111
    v_lshrrev_b32 v112, 16, v65
    ds_read_b32 v112, v112
    v_lshrrev_b32 v113, 16, v67
    ds_read_b32 v113, v113
    s_waitcnt lgkmcnt(3)
    v_add_u32_sdwa v110, v110, v84 dst_sel:DWORD dst_unused:UNUSED_PAD src0_sel:WORD_1 src1_sel:WORD_0
    v_lshlrev_b32 v110, 3, v110
    ds_write_b64 v110, v[60:61] offset:16400

    s_waitcnt lgkmcnt(3)
    v_add_u32_sdwa v111, v111, v85 dst_sel:DWORD dst_unused:UNUSED_PAD src0_sel:WORD_1 src1_sel:WORD_0
    v_lshlrev_b32 v111, 3, v111
    ds_write_b64 v111, v[62:63] offset:16400

    s_waitcnt lgkmcnt(3)
    v_add_u32_sdwa v112, v112, v86 dst_sel:DWORD dst_unused:UNUSED_PAD src0_sel:WORD_1 src1_sel:WORD_0
    v_lshlrev_b32 v112, 3, v112
    ds_write_b64 v112, v[64:65] offset:16400

    s_waitcnt lgkmcnt(3)
    v_add_u32_sdwa v113, v113, v87 dst_sel:DWORD dst_unused:UNUSED_PAD src0_sel:WORD_1 src1_sel:WORD_0
    v_lshlrev_b32 v113, 3, v113
    ds_write_b64 v113, v[66:67] offset:16400

    s_mov_b64 exec, s[66:67]
    v_lshrrev_b32 v110, 16, v69
    ds_read_b32 v110, v110
    v_lshrrev_b32 v111, 16, v71
    ds_read_b32 v111, v111
    v_lshrrev_b32 v112, 16, v73
    ds_read_b32 v112, v112
    v_lshrrev_b32 v113, 16, v75
    ds_read_b32 v113, v113
    s_waitcnt lgkmcnt(3)
    v_add_u32_sdwa v110, v110, v88 dst_sel:DWORD dst_unused:UNUSED_PAD src0_sel:WORD_1 src1_sel:WORD_0
    v_lshlrev_b32 v110, 3, v110
    ds_write_b64 v110, v[68:69] offset:16400

    s_waitcnt lgkmcnt(3)
    v_add_u32_sdwa v111, v111, v89 dst_sel:DWORD dst_unused:UNUSED_PAD src0_sel:WORD_1 src1_sel:WORD_0
    v_lshlrev_b32 v111, 3, v111
    ds_write_b64 v111, v[70:71] offset:16400

    s_waitcnt lgkmcnt(3)
    v_add_u32_sdwa v112, v112, v90 dst_sel:DWORD dst_unused:UNUSED_PAD src0_sel:WORD_1 src1_sel:WORD_0
    v_lshlrev_b32 v112, 3, v112
    ds_write_b64 v112, v[72:73] offset:16400

    s_waitcnt lgkmcnt(3)
    v_add_u32_sdwa v113, v113, v91 dst_sel:DWORD dst_unused:UNUSED_PAD src0_sel:WORD_1 src1_sel:WORD_0
    v_lshlrev_b32 v113, 3, v113
    ds_write_b64 v113, v[74:75] offset:16400

    s_mov_b64 exec, -1
    s_add_u32 s50, s50, 16000

    buffer_load_dwordx4 v[28:31], v1, s[12:15], s58 offen nt
    buffer_load_dwordx4 v[12:15], v1, s[8:11], s58 offen nt
    buffer_load_dwordx2 v[40:41], v2, s[16:19], s63 offen nt
    buffer_load_dwordx4 v[32:35], v1, s[12:15], s59 offen nt
    buffer_load_dwordx4 v[16:19], v1, s[8:11], s59 offen nt
    buffer_load_dwordx2 v[42:43], v2, s[16:19], s64 offen nt
    s_cmp_eq_u32 s49, 0
    s_cbranch_scc1 L_p1epi_6
L_p1loop_5:
    s_waitcnt vmcnt(9)
    v_mul_hi_u32_u24 v45, s40, v20
    v_mul_hi_u32_u24 v44, s40, v4
    v_mul_hi_u32_u24 v47, s40, v21
    v_mul_hi_u32_u24 v46, s40, v5
    v_mul_hi_u32_u24 v49, s40, v22
    v_mul_hi_u32_u24 v48, s40, v6
    v_mul_hi_u32_u24 v51, s40, v23
    v_mul_hi_u32_u24 v50, s40, v7
    v_and_b32 v45, -2, v45
    v_mad_u32_u24 v4, v44, s43, v4
    v_and_b32 v76, -4, v44
    v_and_b32 v47, -2, v47
    v_mad_u32_u24 v5, v46, s43, v5
    v_and_b32 v77, -4, v46
    v_and_b32 v49, -2, v49
    v_mad_u32_u24 v6, v48, s43, v6
    v_and_b32 v78, -4, v48
    v_and_b32 v51, -2, v51
    v_mad_u32_u24 v7, v50, s43, v7
    v_and_b32 v79, -4, v50
    v_mad_i32_i24 v20, v45, s42, v20
    v_lshl_add_u32 v45, v76, 5, v45
    v_mad_i32_i24 v21, v47, s42, v21
    v_lshl_add_u32 v47, v77, 5, v47
    v_mad_i32_i24 v22, v49, s42, v22
    v_lshl_add_u32 v49, v78, 5, v49
    v_mad_i32_i24 v23, v51, s42, v23
    v_lshl_add_u32 v51, v79, 5, v51
    v_add_u32 v45, v45, v45
    ds_add_rtn_u32 v76, v45, v104
    v_add_u32 v47, v47, v47
    ds_add_rtn_u32 v77, v47, v104
    v_add_u32 v49, v49, v49
    ds_add_rtn_u32 v78, v49, v104
    v_add_u32 v51, v51, v51
    ds_add_rtn_u32 v79, v51, v104
    v_lshlrev_b32 v110, 16, v36
    v_and_b32 v111, 0xffff0000, v36
    v_lshlrev_b32 v112, 16, v37
    v_and_b32 v113, 0xffff0000, v37
    v_mul_f32 v110, s44, v110
    v_mul_f32 v111, s44, v111
    v_mul_f32 v112, s44, v112
    v_mul_f32 v113, s44, v113
    v_fract_f32 v110, v110
    v_fract_f32 v111, v111
    v_fract_f32 v112, v112
    v_fract_f32 v113, v113
    v_cos_f32 v110, v110
    v_cos_f32 v111, v111
    v_cos_f32 v112, v112
    v_cos_f32 v113, v113
    v_lshl_or_b32 v44, v44, 14, v20
    v_perm_b32 v45, v45, v4, s46
    v_bfe_u32 v4, v4, 8, 5

    v_lshl_or_b32 v46, v46, 14, v21
    v_perm_b32 v47, v47, v5, s46
    v_bfe_u32 v5, v5, 8, 5

    v_lshl_or_b32 v48, v48, 14, v22
    v_perm_b32 v49, v49, v6, s46
    v_bfe_u32 v6, v6, 8, 5

    v_lshl_or_b32 v50, v50, 14, v23
    v_perm_b32 v51, v51, v7, s46
    v_bfe_u32 v7, v7, 8, 5

    v_fmaak_f32 v110, v110, v105, 0x4b400010
    v_fmaak_f32 v111, v111, v105, 0x4b400010
    v_fmaak_f32 v112, v112, v105, 0x4b400010
    v_fmaak_f32 v113, v113, v105, 0x4b400010
    v_sub_u32 v110, v110, v4
    v_sub_u32 v111, v111, v5
    v_sub_u32 v112, v112, v6
    v_sub_u32 v113, v113, v7
    v_bfi_b32 v110, 31, v4, v110
    v_bfi_b32 v111, 31, v5, v111
    v_bfi_b32 v112, 31, v6, v112
    v_bfi_b32 v113, 31, v7, v113
    v_perm_b32 v44, v44, v110, s55
    v_perm_b32 v46, v46, v111, s55
    v_perm_b32 v48, v48, v112, s55
    v_perm_b32 v50, v50, v113, s55
    s_waitcnt vmcnt(12)
    v_add_u32 v110, v92, v94
    v_min_u32 v92, s48, v92
    v_add_u32 v111, v93, v95
    v_min_u32 v93, s48, v93
    v_max_u32 v110, v110, v111
    v_add_u32 v92, v92, v96
    v_add_u32 v93, v93, v97
    v_cmp_le_u32 vcc, s48, v110
    v_lshl_add_u32 v92, v92, 2, v92
    v_lshl_add_u32 v93, v93, 2, v93
    ds_write_b64 v2, v[92:93] offset:8192
    s_cbranch_vccz L_noov_11
    ds_write_b32 v108, v104 offset:4
L_noov_11:
    s_waitcnt lgkmcnt(0)
    s_barrier
    ds_read_b32 v110, v108 offset:4
    s_waitcnt lgkmcnt(0)
    v_readfirstlane_b32 s53, v110
    s_nop 1
    s_cmp_lg_u32 s53, 0
    s_cbranch_scc1 L_slow_12
L_sback_13:

    v_mov_b32 v94, 1
    buffer_atomic_add v94, v98, s[96:99], 0 offen sc0
    ds_read_b64 v[110:111], v2 offset:16400
    ds_read_b64 v[112:113], v2 offset:16408
    ds_read_b64 v[114:115], v2 offset:16392

    ds_read_b64 v[116:117], v2 offset:24592
    ds_read_b64 v[118:119], v2 offset:24600
    ds_read_b64 v[120:121], v2 offset:24584

    s_waitcnt lgkmcnt(3)
    v_lshrrev_b32 v122, 16, v111
    ds_read_b32 v122, v122 offset:8192

    s_waitcnt lgkmcnt(1)
    v_lshrrev_b32 v123, 16, v117
    ds_read_b32 v123, v123 offset:8192

    v_cmp_ne_u32_sdwa s[70:71], v111, v113 src0_sel:WORD_1 src1_sel:WORD_1
    v_cmp_ne_u32_sdwa vcc, v111, v115 src0_sel:WORD_1 src1_sel:WORD_1
    v_perm_b32 v111, v112, v111, s45
    s_mov_b32 s54, 0
    v_alignbyte_b32 v114, v115, v114, 2
    s_waitcnt lgkmcnt(1)
    v_add3_u32 v122, v122, v106, s54

    s_and_b64 exec, vcc, s[70:71]
    v_and_b32 v111, 0xff, v111
    s_andn2_b64 exec, s[70:71], vcc
    v_alignbyte_b32 v111, v111, v110, 1
    v_perm_b32 v110, v110, v114, s47
    v_subrev_u32 v122, 3, v122
    s_mov_b64 exec, -1

    buffer_store_dwordx2 v[110:111], v122, s[24:27], 0 offen
    v_cmp_ne_u32_sdwa s[70:71], v117, v119 src0_sel:WORD_1 src1_sel:WORD_1
    v_cmp_ne_u32_sdwa vcc, v117, v121 src0_sel:WORD_1 src1_sel:WORD_1
    v_perm_b32 v117, v118, v117, s45
    s_mov_b32 s54, 5120
    v_alignbyte_b32 v120, v121, v120, 2
    s_waitcnt lgkmcnt(0)
    v_add3_u32 v123, v123, v106, s54

    s_and_b64 exec, vcc, s[70:71]
    v_and_b32 v117, 0xff, v117
    s_andn2_b64 exec, s[70:71], vcc
    v_alignbyte_b32 v117, v117, v116, 1
    v_perm_b32 v116, v116, v120, s47
    v_subrev_u32 v123, 3, v123
    s_mov_b64 exec, -1

    buffer_store_dwordx2 v[116:117], v123, s[24:27], 0 offen
    ds_read_b64 v[110:111], v2 offset:32784
    ds_read_b64 v[112:113], v2 offset:32792
    ds_read_b64 v[114:115], v2 offset:32776

    ds_read_b64 v[116:117], v2 offset:40976
    ds_read_b64 v[118:119], v2 offset:40984
    ds_read_b64 v[120:121], v2 offset:40968

    s_waitcnt lgkmcnt(3)
    v_lshrrev_b32 v122, 16, v111
    ds_read_b32 v122, v122 offset:8192

    s_waitcnt lgkmcnt(1)
    v_lshrrev_b32 v123, 16, v117
    ds_read_b32 v123, v123 offset:8192

    v_cmp_ne_u32_sdwa s[70:71], v111, v113 src0_sel:WORD_1 src1_sel:WORD_1
    v_cmp_ne_u32_sdwa vcc, v111, v115 src0_sel:WORD_1 src1_sel:WORD_1
    v_perm_b32 v111, v112, v111, s45
    s_mov_b32 s54, 10240
    v_alignbyte_b32 v114, v115, v114, 2
    s_waitcnt lgkmcnt(1)
    v_add3_u32 v122, v122, v106, s54

    s_and_b64 exec, vcc, s[70:71]
    v_and_b32 v111, 0xff, v111
    s_andn2_b64 exec, s[70:71], vcc
    v_alignbyte_b32 v111, v111, v110, 1
    v_perm_b32 v110, v110, v114, s47
    v_subrev_u32 v122, 3, v122
    s_mov_b64 exec, -1

    buffer_store_dwordx2 v[110:111], v122, s[24:27], 0 offen
    v_cmp_ne_u32_sdwa s[70:71], v117, v119 src0_sel:WORD_1 src1_sel:WORD_1
    v_cmp_ne_u32_sdwa vcc, v117, v121 src0_sel:WORD_1 src1_sel:WORD_1
    v_perm_b32 v117, v118, v117, s45
    s_mov_b32 s54, 15360
    v_alignbyte_b32 v120, v121, v120, 2
    s_waitcnt lgkmcnt(0)
    v_add3_u32 v123, v123, v106, s54

    s_and_b64 exec, vcc, s[70:71]
    v_and_b32 v117, 0xff, v117
    s_andn2_b64 exec, s[70:71], vcc
    v_alignbyte_b32 v117, v117, v116, 1
    v_perm_b32 v116, v116, v120, s47
    v_subrev_u32 v123, 3, v123
    s_mov_b64 exec, -1

    buffer_store_dwordx2 v[116:117], v123, s[24:27], 0 offen
    ds_read_b64 v[110:111], v2 offset:49168
    ds_read_b64 v[112:113], v2 offset:49176
    ds_read_b64 v[114:115], v2 offset:49160

    ds_read_b64 v[116:117], v2 offset:57360
    ds_read_b64 v[118:119], v2 offset:57368
    ds_read_b64 v[120:121], v2 offset:57352

    s_waitcnt lgkmcnt(3)
    v_lshrrev_b32 v122, 16, v111
    ds_read_b32 v122, v122 offset:8192

    s_waitcnt lgkmcnt(1)
    v_lshrrev_b32 v123, 16, v117
    ds_read_b32 v123, v123 offset:8192

    v_cmp_ne_u32_sdwa s[70:71], v111, v113 src0_sel:WORD_1 src1_sel:WORD_1
    v_cmp_ne_u32_sdwa vcc, v111, v115 src0_sel:WORD_1 src1_sel:WORD_1
    v_perm_b32 v111, v112, v111, s45
    s_mov_b32 s54, 20480
    v_alignbyte_b32 v114, v115, v114, 2
    s_waitcnt lgkmcnt(1)
    v_add3_u32 v122, v122, v106, s54

    s_and_b64 exec, vcc, s[70:71]
    v_and_b32 v111, 0xff, v111
    s_andn2_b64 exec, s[70:71], vcc
    v_alignbyte_b32 v111, v111, v110, 1
    v_perm_b32 v110, v110, v114, s47
    v_subrev_u32 v122, 3, v122
    s_mov_b64 exec, -1

    buffer_store_dwordx2 v[110:111], v122, s[24:27], 0 offen
    v_cmp_ne_u32_sdwa s[70:71], v117, v119 src0_sel:WORD_1 src1_sel:WORD_1
    v_cmp_ne_u32_sdwa vcc, v117, v121 src0_sel:WORD_1 src1_sel:WORD_1
    v_perm_b32 v117, v118, v117, s45
    s_mov_b32 s54, 25600
    v_alignbyte_b32 v120, v121, v120, 2
    s_waitcnt lgkmcnt(0)
    v_add3_u32 v123, v123, v106, s54

    s_and_b64 exec, vcc, s[70:71]
    v_and_b32 v117, 0xff, v117
    s_andn2_b64 exec, s[70:71], vcc
    v_alignbyte_b32 v117, v117, v116, 1
    v_perm_b32 v116, v116, v120, s47
    v_subrev_u32 v123, 3, v123
    s_mov_b64 exec, -1

    buffer_store_dwordx2 v[116:117], v123, s[24:27], 0 offen
    s_waitcnt vmcnt(13)
    v_mul_hi_u32_u24 v53, s40, v24
    v_mul_hi_u32_u24 v52, s40, v8
    v_mul_hi_u32_u24 v55, s40, v25
    v_mul_hi_u32_u24 v54, s40, v9
    v_mul_hi_u32_u24 v57, s40, v26
    v_mul_hi_u32_u24 v56, s40, v10
    v_mul_hi_u32_u24 v59, s40, v27
    v_mul_hi_u32_u24 v58, s40, v11
    v_and_b32 v53, -2, v53
    v_mad_u32_u24 v8, v52, s43, v8
    v_and_b32 v80, -4, v52
    v_and_b32 v55, -2, v55
    v_mad_u32_u24 v9, v54, s43, v9
    v_and_b32 v81, -4, v54
    v_and_b32 v57, -2, v57
    v_mad_u32_u24 v10, v56, s43, v10
    v_and_b32 v82, -4, v56
    v_and_b32 v59, -2, v59
    v_mad_u32_u24 v11, v58, s43, v11
    v_and_b32 v83, -4, v58
    v_mad_i32_i24 v24, v53, s42, v24
    v_lshl_add_u32 v53, v80, 5, v53
    v_mad_i32_i24 v25, v55, s42, v25
    v_lshl_add_u32 v55, v81, 5, v55
    v_mad_i32_i24 v26, v57, s42, v26
    v_lshl_add_u32 v57, v82, 5, v57
    v_mad_i32_i24 v27, v59, s42, v27
    v_lshl_add_u32 v59, v83, 5, v59
    v_add_u32 v53, v53, v53
    ds_add_rtn_u32 v80, v53, v104
    v_add_u32 v55, v55, v55
    ds_add_rtn_u32 v81, v55, v104
    v_add_u32 v57, v57, v57
    ds_add_rtn_u32 v82, v57, v104
    v_add_u32 v59, v59, v59
    ds_add_rtn_u32 v83, v59, v104
    v_lshlrev_b32 v110, 16, v38
    v_and_b32 v111, 0xffff0000, v38
    v_lshlrev_b32 v112, 16, v39
    v_and_b32 v113, 0xffff0000, v39
    v_mul_f32 v110, s44, v110
    v_mul_f32 v111, s44, v111
    v_mul_f32 v112, s44, v112
    v_mul_f32 v113, s44, v113
    v_fract_f32 v110, v110
    v_fract_f32 v111, v111
    v_fract_f32 v112, v112
    v_fract_f32 v113, v113
    v_cos_f32 v110, v110
    v_cos_f32 v111, v111
    v_cos_f32 v112, v112
    v_cos_f32 v113, v113
    v_lshl_or_b32 v52, v52, 14, v24
    v_perm_b32 v53, v53, v8, s46
    v_bfe_u32 v8, v8, 8, 5

    v_lshl_or_b32 v54, v54, 14, v25
    v_perm_b32 v55, v55, v9, s46
    v_bfe_u32 v9, v9, 8, 5

    v_lshl_or_b32 v56, v56, 14, v26
    v_perm_b32 v57, v57, v10, s46
    v_bfe_u32 v10, v10, 8, 5

    v_lshl_or_b32 v58, v58, 14, v27
    v_perm_b32 v59, v59, v11, s46
    v_bfe_u32 v11, v11, 8, 5

    v_fmaak_f32 v110, v110, v105, 0x4b400010
    v_fmaak_f32 v111, v111, v105, 0x4b400010
    v_fmaak_f32 v112, v112, v105, 0x4b400010
    v_fmaak_f32 v113, v113, v105, 0x4b400010
    v_sub_u32 v110, v110, v8
    v_sub_u32 v111, v111, v9
    v_sub_u32 v112, v112, v10
    v_sub_u32 v113, v113, v11
    v_bfi_b32 v110, 31, v8, v110
    v_bfi_b32 v111, 31, v9, v111
    v_bfi_b32 v112, 31, v10, v112
    v_bfi_b32 v113, 31, v11, v113
    v_perm_b32 v52, v52, v110, s55
    v_perm_b32 v54, v54, v111, s55
    v_perm_b32 v56, v56, v112, s55
    v_perm_b32 v58, v58, v113, s55
    v_add_u32 v107, 65536, v2
    ds_read_b64 v[110:111], v107 offset:16
    ds_read_b64 v[112:113], v107 offset:24
    ds_read_b64 v[114:115], v107 offset:8

    ds_read_b64 v[116:117], v107 offset:8208
    ds_read_b64 v[118:119], v107 offset:8216
    ds_read_b64 v[120:121], v107 offset:8200

    s_waitcnt lgkmcnt(3)
    v_lshrrev_b32 v122, 16, v111
    ds_read_b32 v122, v122 offset:8192

    s_waitcnt lgkmcnt(1)
    v_lshrrev_b32 v123, 16, v117
    ds_read_b32 v123, v123 offset:8192

    v_cmp_ne_u32_sdwa s[70:71], v111, v113 src0_sel:WORD_1 src1_sel:WORD_1
    v_cmp_ne_u32_sdwa vcc, v111, v115 src0_sel:WORD_1 src1_sel:WORD_1
    v_perm_b32 v111, v112, v111, s45
    s_mov_b32 s54, 30720
    v_alignbyte_b32 v114, v115, v114, 2
    s_waitcnt lgkmcnt(1)
    v_add3_u32 v122, v122, v106, s54

    s_and_b64 exec, vcc, s[70:71]
    v_and_b32 v111, 0xff, v111
    s_andn2_b64 exec, s[70:71], vcc
    v_alignbyte_b32 v111, v111, v110, 1
    v_perm_b32 v110, v110, v114, s47
    v_subrev_u32 v122, 3, v122
    s_mov_b64 exec, -1

    buffer_store_dwordx2 v[110:111], v122, s[24:27], 0 offen
    v_cmp_ne_u32_sdwa s[70:71], v117, v119 src0_sel:WORD_1 src1_sel:WORD_1
    v_cmp_ne_u32_sdwa vcc, v117, v121 src0_sel:WORD_1 src1_sel:WORD_1
    v_perm_b32 v117, v118, v117, s45
    s_mov_b32 s54, 35840
    v_alignbyte_b32 v120, v121, v120, 2
    s_waitcnt lgkmcnt(0)
    v_add3_u32 v123, v123, v106, s54

    s_and_b64 exec, vcc, s[70:71]
    v_and_b32 v117, 0xff, v117
    s_andn2_b64 exec, s[70:71], vcc
    v_alignbyte_b32 v117, v117, v116, 1
    v_perm_b32 v116, v116, v120, s47
    v_subrev_u32 v123, 3, v123
    s_mov_b64 exec, -1

    buffer_store_dwordx2 v[116:117], v123, s[24:27], 0 offen
    ds_read_b64 v[110:111], v107 offset:16400
    ds_read_b64 v[112:113], v107 offset:16408
    ds_read_b64 v[114:115], v107 offset:16392

    ds_read_b64 v[116:117], v107 offset:24592
    ds_read_b64 v[118:119], v107 offset:24600
    ds_read_b64 v[120:121], v107 offset:24584

    s_waitcnt lgkmcnt(3)
    v_lshrrev_b32 v122, 16, v111
    ds_read_b32 v122, v122 offset:8192

    s_waitcnt lgkmcnt(1)
    v_lshrrev_b32 v123, 16, v117
    ds_read_b32 v123, v123 offset:8192

    v_cmp_ne_u32_sdwa s[70:71], v111, v113 src0_sel:WORD_1 src1_sel:WORD_1
    v_cmp_ne_u32_sdwa vcc, v111, v115 src0_sel:WORD_1 src1_sel:WORD_1
    v_perm_b32 v111, v112, v111, s45
    s_mov_b32 s54, 40960
    v_alignbyte_b32 v114, v115, v114, 2
    s_waitcnt lgkmcnt(1)
    v_add3_u32 v122, v122, v106, s54

    s_and_b64 exec, vcc, s[70:71]
    v_and_b32 v111, 0xff, v111
    s_andn2_b64 exec, s[70:71], vcc
    v_alignbyte_b32 v111, v111, v110, 1
    v_perm_b32 v110, v110, v114, s47
    v_subrev_u32 v122, 3, v122
    s_mov_b64 exec, -1

    buffer_store_dwordx2 v[110:111], v122, s[24:27], 0 offen
    v_cmp_ne_u32_sdwa s[70:71], v117, v119 src0_sel:WORD_1 src1_sel:WORD_1
    v_cmp_ne_u32_sdwa vcc, v117, v121 src0_sel:WORD_1 src1_sel:WORD_1
    v_perm_b32 v117, v118, v117, s45
    s_mov_b32 s54, 46080
    v_alignbyte_b32 v120, v121, v120, 2
    s_waitcnt lgkmcnt(0)
    v_add3_u32 v123, v123, v106, s54

    s_and_b64 exec, vcc, s[70:71]
    v_and_b32 v117, 0xff, v117
    s_andn2_b64 exec, s[70:71], vcc
    v_alignbyte_b32 v117, v117, v116, 1
    v_perm_b32 v116, v116, v120, s47
    v_subrev_u32 v123, 3, v123
    s_mov_b64 exec, -1

    buffer_store_dwordx2 v[116:117], v123, s[24:27], 0 offen
    s_waitcnt vmcnt(14)
    v_mul_hi_u32_u24 v61, s40, v28
    v_mul_hi_u32_u24 v60, s40, v12
    v_mul_hi_u32_u24 v63, s40, v29
    v_mul_hi_u32_u24 v62, s40, v13
    v_mul_hi_u32_u24 v65, s40, v30
    v_mul_hi_u32_u24 v64, s40, v14
    v_mul_hi_u32_u24 v67, s40, v31
    v_mul_hi_u32_u24 v66, s40, v15
    v_and_b32 v61, -2, v61
    v_mad_u32_u24 v12, v60, s43, v12
    v_and_b32 v84, -4, v60
    v_and_b32 v63, -2, v63
    v_mad_u32_u24 v13, v62, s43, v13
    v_and_b32 v85, -4, v62
    v_and_b32 v65, -2, v65
    v_mad_u32_u24 v14, v64, s43, v14
    v_and_b32 v86, -4, v64
    v_and_b32 v67, -2, v67
    v_mad_u32_u24 v15, v66, s43, v15
    v_and_b32 v87, -4, v66
    v_mad_i32_i24 v28, v61, s42, v28
    v_lshl_add_u32 v61, v84, 5, v61
    v_mad_i32_i24 v29, v63, s42, v29
    v_lshl_add_u32 v63, v85, 5, v63
    v_mad_i32_i24 v30, v65, s42, v30
    v_lshl_add_u32 v65, v86, 5, v65
    v_mad_i32_i24 v31, v67, s42, v31
    v_lshl_add_u32 v67, v87, 5, v67
    v_add_u32 v61, v61, v61
    ds_add_rtn_u32 v84, v61, v104
    v_add_u32 v63, v63, v63
    ds_add_rtn_u32 v85, v63, v104
    v_add_u32 v65, v65, v65
    ds_add_rtn_u32 v86, v65, v104
    v_add_u32 v67, v67, v67
    ds_add_rtn_u32 v87, v67, v104
    v_lshlrev_b32 v110, 16, v40
    v_and_b32 v111, 0xffff0000, v40
    v_lshlrev_b32 v112, 16, v41
    v_and_b32 v113, 0xffff0000, v41
    v_mul_f32 v110, s44, v110
    v_mul_f32 v111, s44, v111
    v_mul_f32 v112, s44, v112
    v_mul_f32 v113, s44, v113
    v_fract_f32 v110, v110
    v_fract_f32 v111, v111
    v_fract_f32 v112, v112
    v_fract_f32 v113, v113
    v_cos_f32 v110, v110
    v_cos_f32 v111, v111
    v_cos_f32 v112, v112
    v_cos_f32 v113, v113
    v_lshl_or_b32 v60, v60, 14, v28
    v_perm_b32 v61, v61, v12, s46
    v_bfe_u32 v12, v12, 8, 5

    v_lshl_or_b32 v62, v62, 14, v29
    v_perm_b32 v63, v63, v13, s46
    v_bfe_u32 v13, v13, 8, 5

    v_lshl_or_b32 v64, v64, 14, v30
    v_perm_b32 v65, v65, v14, s46
    v_bfe_u32 v14, v14, 8, 5

    v_lshl_or_b32 v66, v66, 14, v31
    v_perm_b32 v67, v67, v15, s46
    v_bfe_u32 v15, v15, 8, 5

    v_fmaak_f32 v110, v110, v105, 0x4b400010
    v_fmaak_f32 v111, v111, v105, 0x4b400010
    v_fmaak_f32 v112, v112, v105, 0x4b400010
    v_fmaak_f32 v113, v113, v105, 0x4b400010
    v_sub_u32 v110, v110, v12
    v_sub_u32 v111, v111, v13
    v_sub_u32 v112, v112, v14
    v_sub_u32 v113, v113, v15
    v_bfi_b32 v110, 31, v12, v110
    v_bfi_b32 v111, 31, v13, v111
    v_bfi_b32 v112, 31, v14, v112
    v_bfi_b32 v113, 31, v15, v113
    v_perm_b32 v60, v60, v110, s55
    v_perm_b32 v62, v62, v111, s55
    v_perm_b32 v64, v64, v112, s55
    v_perm_b32 v66, v66, v113, s55
    ds_read_b64 v[110:111], v107 offset:32784
    ds_read_b64 v[112:113], v107 offset:32792
    ds_read_b64 v[114:115], v107 offset:32776

    ds_read_b64 v[116:117], v107 offset:40976
    ds_read_b64 v[118:119], v107 offset:40984
    ds_read_b64 v[120:121], v107 offset:40968

    s_waitcnt lgkmcnt(3)
    v_lshrrev_b32 v122, 16, v111
    ds_read_b32 v122, v122 offset:8192

    s_waitcnt lgkmcnt(1)
    v_lshrrev_b32 v123, 16, v117
    ds_read_b32 v123, v123 offset:8192

    v_cmp_ne_u32_sdwa s[70:71], v111, v113 src0_sel:WORD_1 src1_sel:WORD_1
    v_cmp_ne_u32_sdwa vcc, v111, v115 src0_sel:WORD_1 src1_sel:WORD_1
    v_perm_b32 v111, v112, v111, s45
    s_mov_b32 s54, 51200
    v_alignbyte_b32 v114, v115, v114, 2
    s_waitcnt lgkmcnt(1)
    v_add3_u32 v122, v122, v106, s54

    s_and_b64 exec, vcc, s[70:71]
    v_and_b32 v111, 0xff, v111
    s_andn2_b64 exec, s[70:71], vcc
    v_alignbyte_b32 v111, v111, v110, 1
    v_perm_b32 v110, v110, v114, s47
    v_subrev_u32 v122, 3, v122
    s_mov_b64 exec, -1

    buffer_store_dwordx2 v[110:111], v122, s[24:27], 0 offen
    v_cmp_ne_u32_sdwa s[70:71], v117, v119 src0_sel:WORD_1 src1_sel:WORD_1
    v_cmp_ne_u32_sdwa vcc, v117, v121 src0_sel:WORD_1 src1_sel:WORD_1
    v_perm_b32 v117, v118, v117, s45
    s_mov_b32 s54, 56320
    v_alignbyte_b32 v120, v121, v120, 2
    s_waitcnt lgkmcnt(0)
    v_add3_u32 v123, v123, v106, s54

    s_and_b64 exec, vcc, s[70:71]
    v_and_b32 v117, 0xff, v117
    s_andn2_b64 exec, s[70:71], vcc
    v_alignbyte_b32 v117, v117, v116, 1
    v_perm_b32 v116, v116, v120, s47
    v_subrev_u32 v123, 3, v123
    s_mov_b64 exec, -1

    buffer_store_dwordx2 v[116:117], v123, s[24:27], 0 offen
    ds_read_b64 v[110:111], v107 offset:49168
    ds_read_b64 v[112:113], v107 offset:49176
    ds_read_b64 v[114:115], v107 offset:49160

    ds_read_b64 v[116:117], v107 offset:57360
    ds_read_b64 v[118:119], v107 offset:57368
    ds_read_b64 v[120:121], v107 offset:57352

    s_waitcnt lgkmcnt(3)
    v_lshrrev_b32 v122, 16, v111
    ds_read_b32 v122, v122 offset:8192

    s_waitcnt lgkmcnt(1)
    v_lshrrev_b32 v123, 16, v117
    ds_read_b32 v123, v123 offset:8192

    v_cmp_ne_u32_sdwa s[70:71], v111, v113 src0_sel:WORD_1 src1_sel:WORD_1
    v_cmp_ne_u32_sdwa vcc, v111, v115 src0_sel:WORD_1 src1_sel:WORD_1
    v_perm_b32 v111, v112, v111, s45
    s_mov_b32 s54, 61440
    v_alignbyte_b32 v114, v115, v114, 2
    s_waitcnt lgkmcnt(1)
    v_add3_u32 v122, v122, v106, s54

    s_and_b64 exec, vcc, s[70:71]
    v_and_b32 v111, 0xff, v111
    s_andn2_b64 exec, s[70:71], vcc
    v_alignbyte_b32 v111, v111, v110, 1
    v_perm_b32 v110, v110, v114, s47
    v_subrev_u32 v122, 3, v122
    s_mov_b64 exec, -1

    buffer_store_dwordx2 v[110:111], v122, s[24:27], 0 offen
    v_cmp_ne_u32_sdwa s[70:71], v117, v119 src0_sel:WORD_1 src1_sel:WORD_1
    v_cmp_ne_u32_sdwa vcc, v117, v121 src0_sel:WORD_1 src1_sel:WORD_1
    v_perm_b32 v117, v118, v117, s45
    s_mov_b32 s54, 66560
    v_alignbyte_b32 v120, v121, v120, 2
    s_waitcnt lgkmcnt(0)
    v_add3_u32 v123, v123, v106, s54

    s_and_b64 exec, vcc, s[70:71]
    v_and_b32 v117, 0xff, v117
    s_andn2_b64 exec, s[70:71], vcc
    v_alignbyte_b32 v117, v117, v116, 1
    v_perm_b32 v116, v116, v120, s47
    v_subrev_u32 v123, 3, v123
    s_mov_b64 exec, -1

    buffer_store_dwordx2 v[116:117], v123, s[24:27], 0 offen
    s_waitcnt vmcnt(15)
    s_mov_b64 exec, s[66:67]
    v_mul_hi_u32_u24 v69, s40, v32
    v_mul_hi_u32_u24 v68, s40, v16
    v_mul_hi_u32_u24 v71, s40, v33
    v_mul_hi_u32_u24 v70, s40, v17
    v_mul_hi_u32_u24 v73, s40, v34
    v_mul_hi_u32_u24 v72, s40, v18
    v_mul_hi_u32_u24 v75, s40, v35
    v_mul_hi_u32_u24 v74, s40, v19
    v_and_b32 v69, -2, v69
    v_mad_u32_u24 v16, v68, s43, v16
    v_and_b32 v88, -4, v68
    v_and_b32 v71, -2, v71
    v_mad_u32_u24 v17, v70, s43, v17
    v_and_b32 v89, -4, v70
    v_and_b32 v73, -2, v73
    v_mad_u32_u24 v18, v72, s43, v18
    v_and_b32 v90, -4, v72
    v_and_b32 v75, -2, v75
    v_mad_u32_u24 v19, v74, s43, v19
    v_and_b32 v91, -4, v74
    v_mad_i32_i24 v32, v69, s42, v32
    v_lshl_add_u32 v69, v88, 5, v69
    v_mad_i32_i24 v33, v71, s42, v33
    v_lshl_add_u32 v71, v89, 5, v71
    v_mad_i32_i24 v34, v73, s42, v34
    v_lshl_add_u32 v73, v90, 5, v73
    v_mad_i32_i24 v35, v75, s42, v35
    v_lshl_add_u32 v75, v91, 5, v75
    v_add_u32 v69, v69, v69
    ds_add_rtn_u32 v88, v69, v104
    v_add_u32 v71, v71, v71
    ds_add_rtn_u32 v89, v71, v104
    v_add_u32 v73, v73, v73
    ds_add_rtn_u32 v90, v73, v104
    v_add_u32 v75, v75, v75
    ds_add_rtn_u32 v91, v75, v104
    v_lshlrev_b32 v110, 16, v42
    v_and_b32 v111, 0xffff0000, v42
    v_lshlrev_b32 v112, 16, v43
    v_and_b32 v113, 0xffff0000, v43
    v_mul_f32 v110, s44, v110
    v_mul_f32 v111, s44, v111
    v_mul_f32 v112, s44, v112
    v_mul_f32 v113, s44, v113
    v_fract_f32 v110, v110
    v_fract_f32 v111, v111
    v_fract_f32 v112, v112
    v_fract_f32 v113, v113
    v_cos_f32 v110, v110
    v_cos_f32 v111, v111
    v_cos_f32 v112, v112
    v_cos_f32 v113, v113
    v_lshl_or_b32 v68, v68, 14, v32
    v_perm_b32 v69, v69, v16, s46
    v_bfe_u32 v16, v16, 8, 5

    v_lshl_or_b32 v70, v70, 14, v33
    v_perm_b32 v71, v71, v17, s46
    v_bfe_u32 v17, v17, 8, 5

    v_lshl_or_b32 v72, v72, 14, v34
    v_perm_b32 v73, v73, v18, s46
    v_bfe_u32 v18, v18, 8, 5

    v_lshl_or_b32 v74, v74, 14, v35
    v_perm_b32 v75, v75, v19, s46
    v_bfe_u32 v19, v19, 8, 5

    v_fmaak_f32 v110, v110, v105, 0x4b400010
    v_fmaak_f32 v111, v111, v105, 0x4b400010
    v_fmaak_f32 v112, v112, v105, 0x4b400010
    v_fmaak_f32 v113, v113, v105, 0x4b400010
    v_sub_u32 v110, v110, v16
    v_sub_u32 v111, v111, v17
    v_sub_u32 v112, v112, v18
    v_sub_u32 v113, v113, v19
    v_bfi_b32 v110, 31, v16, v110
    v_bfi_b32 v111, 31, v17, v111
    v_bfi_b32 v112, 31, v18, v112
    v_bfi_b32 v113, 31, v19, v113
    v_perm_b32 v68, v68, v110, s55
    v_perm_b32 v70, v70, v111, s55
    v_perm_b32 v72, v72, v112, s55
    v_perm_b32 v74, v74, v113, s55
    s_mov_b64 exec, -1
    v_cmp_eq_u32 vcc, 0, v0
    s_waitcnt vmcnt(14)
    s_mov_b64 exec, vcc
    ds_write_b32 v108, v94 offset:8
    s_mov_b64 exec, -1
    s_waitcnt lgkmcnt(0)
    s_barrier

    ds_read_b32 v110, v108 offset:8
    ds_read_b64 v[94:95], v2
    s_waitcnt lgkmcnt(0)

    v_readfirstlane_b32 s41, v110
    v_and_b32 v94, 0xffff, v94
    v_and_b32 v95, 0xffff, v95
    v_add_u32 v92, v94, v94
    v_add_u32 v93, v95, v95
    v_add_u32 v97, v94, v95
    v_med3_u32 v92, v94, 2, v92
    v_med3_u32 v93, v95, 2, v93
    buffer_atomic_add_x2 v[92:93], v2, s[20:23], 0 offen sc0
    s_nop 1
    v_add_u32_dpp v97, v97, v97 row_shr:1 row_mask:0xf bank_mask:0xf
    s_nop 1
    v_add_u32_dpp v97, v97, v97 row_shr:2 row_mask:0xf bank_mask:0xf
    s_nop 1
    v_add_u32_dpp v97, v97, v97 row_shr:4 row_mask:0xf bank_mask:0xf
    s_nop 1
    v_add_u32_dpp v97, v97, v97 row_shr:8 row_mask:0xf bank_mask:0xf
    s_nop 1
    v_add_u32_dpp v97, v97, v97 row_bcast:15 row_mask:0xa bank_mask:0xf
    s_nop 1
    v_add_u32_dpp v97, v97, v97 row_bcast:31 row_mask:0xc bank_mask:0xf
    s_mov_b32 exec_lo, 0
    s_brev_b32 exec_hi, 1
    ds_add_rtn_u32 v96, v108, v97
    s_mov_b64 exec, -1

    s_add_u32 s41, s41, 256
    s_mul_i32 s78, s41, 16000
    s_add_u32 s49, s78, 16000
    s_cmp_ge_u32 s41, 3200
    s_cmovk_i32 s49, 0
    s_cmovk_i32 s78, 0
    s_lshl_b32 s10, s49, 2
    s_lshl_b32 s14, s49, 2
    s_lshl_b32 s18, s49, 1
    s_lshl_b32 s56, s78, 2
    s_lshl_b32 s61, s78, 1

    s_add_u32 s57, s56, 16384
    s_add_u32 s62, s61, 8192
    s_add_u32 s58, s56, 32768
    s_add_u32 s63, s61, 16384
    s_add_u32 s59, s56, 49152
    s_add_u32 s64, s61, 24576
    buffer_load_dwordx4 v[20:23], v1, s[12:15], s56 offen nt
    buffer_load_dwordx4 v[4:7], v1, s[8:11], s56 offen nt
    buffer_load_dwordx2 v[36:37], v2, s[16:19], s61 offen nt
    v_add_u32 v107, 131072, v2
    ds_read_b64 v[110:111], v107 offset:16
    ds_read_b64 v[112:113], v107 offset:24
    ds_read_b64 v[114:115], v107 offset:8

    ds_read_b64 v[116:117], v107 offset:8208
    ds_read_b64 v[118:119], v107 offset:8216
    ds_read_b64 v[120:121], v107 offset:8200

    s_waitcnt lgkmcnt(3)
    v_lshrrev_b32 v122, 16, v111
    ds_read_b32 v122, v122 offset:8192

    s_waitcnt lgkmcnt(1)
    v_lshrrev_b32 v123, 16, v117
    ds_read_b32 v123, v123 offset:8192

    v_cmp_ne_u32_sdwa s[70:71], v111, v113 src0_sel:WORD_1 src1_sel:WORD_1
    v_cmp_ne_u32_sdwa vcc, v111, v115 src0_sel:WORD_1 src1_sel:WORD_1
    v_perm_b32 v111, v112, v111, s45
    s_mov_b32 s54, 71680
    v_alignbyte_b32 v114, v115, v114, 2
    s_waitcnt lgkmcnt(1)
    v_add3_u32 v122, v122, v106, s54

    s_and_b64 exec, vcc, s[70:71]
    v_and_b32 v111, 0xff, v111
    s_andn2_b64 exec, s[70:71], vcc
    v_alignbyte_b32 v111, v111, v110, 1
    v_perm_b32 v110, v110, v114, s47
    v_subrev_u32 v122, 3, v122
    s_mov_b64 exec, -1

    buffer_store_dwordx2 v[110:111], v122, s[24:27], 0 offen
    v_cmp_ne_u32_sdwa s[70:71], v117, v119 src0_sel:WORD_1 src1_sel:WORD_1
    v_cmp_ne_u32_sdwa vcc, v117, v121 src0_sel:WORD_1 src1_sel:WORD_1
    v_perm_b32 v117, v118, v117, s45
    s_mov_b32 s54, 76800
    v_alignbyte_b32 v120, v121, v120, 2
    s_waitcnt lgkmcnt(0)
    v_add3_u32 v123, v123, v106, s54

    s_andn2_b64 exec, -1, s[68:69]
    v_bfrev_b32 v123, 1

    s_and_b64 exec, vcc, s[70:71]
    v_and_b32 v117, 0xff, v117
    s_andn2_b64 exec, s[70:71], vcc
    v_alignbyte_b32 v117, v117, v116, 1
    v_perm_b32 v116, v116, v120, s47
    v_subrev_u32 v123, 3, v123
    s_mov_b64 exec, -1

    buffer_store_dwordx2 v[116:117], v123, s[24:27], 0 offen
    s_waitcnt lgkmcnt(0)
    v_readlane_b32 s77, v96, 63
    v_mul_u32_u24 v114, 7936, v0
    v_sub_u32 v97, v97, v95
    s_sub_u32 s77, s77, s50
    v_add_u32 v97, s77, v97
    v_sub_u32 v96, v97, v94
    v_lshlrev_b32 v111, 16, v97
    v_lshlrev_b32 v110, 16, v96
    ds_write_b64 v2, v[110:111]
    v_sub_u32 v96, v114, v96
    v_sub_u32 v97, v114, v97
    v_add_u32 v97, s48, v97

    s_waitcnt lgkmcnt(0)
    s_barrier

    v_lshrrev_b32 v110, 16, v45
    ds_read_b32 v110, v110
    v_lshrrev_b32 v111, 16, v47
    ds_read_b32 v111, v111
    v_lshrrev_b32 v112, 16, v49
    ds_read_b32 v112, v112
    v_lshrrev_b32 v113, 16, v51
    ds_read_b32 v113, v113
    v_lshrrev_b32 v114, 16, v53
    ds_read_b32 v114, v114
    v_lshrrev_b32 v115, 16, v55
    ds_read_b32 v115, v115
    v_lshrrev_b32 v116, 16, v57
    ds_read_b32 v116, v116
    v_lshrrev_b32 v117, 16, v59
    ds_read_b32 v117, v117
    s_waitcnt lgkmcnt(7)
    v_add_u32_sdwa v110, v110, v76 dst_sel:DWORD dst_unused:UNUSED_PAD src0_sel:WORD_1 src1_sel:WORD_0
    v_lshlrev_b32 v110, 3, v110
    ds_write_b64 v110, v[44:45] offset:16400

    s_waitcnt lgkmcnt(7)
    v_add_u32_sdwa v111, v111, v77 dst_sel:DWORD dst_unused:UNUSED_PAD src0_sel:WORD_1 src1_sel:WORD_0
    v_lshlrev_b32 v111, 3, v111
    ds_write_b64 v111, v[46:47] offset:16400

    s_waitcnt lgkmcnt(7)
    v_add_u32_sdwa v112, v112, v78 dst_sel:DWORD dst_unused:UNUSED_PAD src0_sel:WORD_1 src1_sel:WORD_0
    v_lshlrev_b32 v112, 3, v112
    ds_write_b64 v112, v[48:49] offset:16400

    s_waitcnt lgkmcnt(7)
    v_add_u32_sdwa v113, v113, v79 dst_sel:DWORD dst_unused:UNUSED_PAD src0_sel:WORD_1 src1_sel:WORD_0
    v_lshlrev_b32 v113, 3, v113
    ds_write_b64 v113, v[50:51] offset:16400

    s_waitcnt lgkmcnt(7)
    v_add_u32_sdwa v114, v114, v80 dst_sel:DWORD dst_unused:UNUSED_PAD src0_sel:WORD_1 src1_sel:WORD_0
    v_lshlrev_b32 v114, 3, v114
    ds_write_b64 v114, v[52:53] offset:16400

    s_waitcnt lgkmcnt(7)
    v_add_u32_sdwa v115, v115, v81 dst_sel:DWORD dst_unused:UNUSED_PAD src0_sel:WORD_1 src1_sel:WORD_0
    v_lshlrev_b32 v115, 3, v115
    ds_write_b64 v115, v[54:55] offset:16400

    s_waitcnt lgkmcnt(7)
    v_add_u32_sdwa v116, v116, v82 dst_sel:DWORD dst_unused:UNUSED_PAD src0_sel:WORD_1 src1_sel:WORD_0
    v_lshlrev_b32 v116, 3, v116
    ds_write_b64 v116, v[56:57] offset:16400

    s_waitcnt lgkmcnt(7)
    v_add_u32_sdwa v117, v117, v83 dst_sel:DWORD dst_unused:UNUSED_PAD src0_sel:WORD_1 src1_sel:WORD_0
    v_lshlrev_b32 v117, 3, v117
    ds_write_b64 v117, v[58:59] offset:16400

    buffer_load_dwordx4 v[24:27], v1, s[12:15], s57 offen nt
    buffer_load_dwordx4 v[8:11], v1, s[8:11], s57 offen nt
    buffer_load_dwordx2 v[38:39], v2, s[16:19], s62 offen nt
    v_lshrrev_b32 v110, 16, v61
    ds_read_b32 v110, v110
    v_lshrrev_b32 v111, 16, v63
    ds_read_b32 v111, v111
    v_lshrrev_b32 v112, 16, v65
    ds_read_b32 v112, v112
    v_lshrrev_b32 v113, 16, v67
    ds_read_b32 v113, v113
    s_waitcnt lgkmcnt(3)
    v_add_u32_sdwa v110, v110, v84 dst_sel:DWORD dst_unused:UNUSED_PAD src0_sel:WORD_1 src1_sel:WORD_0
    v_lshlrev_b32 v110, 3, v110
    ds_write_b64 v110, v[60:61] offset:16400

    s_waitcnt lgkmcnt(3)
    v_add_u32_sdwa v111, v111, v85 dst_sel:DWORD dst_unused:UNUSED_PAD src0_sel:WORD_1 src1_sel:WORD_0
    v_lshlrev_b32 v111, 3, v111
    ds_write_b64 v111, v[62:63] offset:16400

    s_waitcnt lgkmcnt(3)
    v_add_u32_sdwa v112, v112, v86 dst_sel:DWORD dst_unused:UNUSED_PAD src0_sel:WORD_1 src1_sel:WORD_0
    v_lshlrev_b32 v112, 3, v112
    ds_write_b64 v112, v[64:65] offset:16400

    s_waitcnt lgkmcnt(3)
    v_add_u32_sdwa v113, v113, v87 dst_sel:DWORD dst_unused:UNUSED_PAD src0_sel:WORD_1 src1_sel:WORD_0
    v_lshlrev_b32 v113, 3, v113
    ds_write_b64 v113, v[66:67] offset:16400

    s_mov_b64 exec, s[66:67]
    v_lshrrev_b32 v110, 16, v69
    ds_read_b32 v110, v110
    v_lshrrev_b32 v111, 16, v71
    ds_read_b32 v111, v111
    v_lshrrev_b32 v112, 16, v73
    ds_read_b32 v112, v112
    v_lshrrev_b32 v113, 16, v75
    ds_read_b32 v113, v113
    s_waitcnt lgkmcnt(3)
    v_add_u32_sdwa v110, v110, v88 dst_sel:DWORD dst_unused:UNUSED_PAD src0_sel:WORD_1 src1_sel:WORD_0
    v_lshlrev_b32 v110, 3, v110
    ds_write_b64 v110, v[68:69] offset:16400

    s_waitcnt lgkmcnt(3)
    v_add_u32_sdwa v111, v111, v89 dst_sel:DWORD dst_unused:UNUSED_PAD src0_sel:WORD_1 src1_sel:WORD_0
    v_lshlrev_b32 v111, 3, v111
    ds_write_b64 v111, v[70:71] offset:16400

    s_waitcnt lgkmcnt(3)
    v_add_u32_sdwa v112, v112, v90 dst_sel:DWORD dst_unused:UNUSED_PAD src0_sel:WORD_1 src1_sel:WORD_0
    v_lshlrev_b32 v112, 3, v112
    ds_write_b64 v112, v[72:73] offset:16400

    s_waitcnt lgkmcnt(3)
    v_add_u32_sdwa v113, v113, v91 dst_sel:DWORD dst_unused:UNUSED_PAD src0_sel:WORD_1 src1_sel:WORD_0
    v_lshlrev_b32 v113, 3, v113
    ds_write_b64 v113, v[74:75] offset:16400

    s_mov_b64 exec, -1
    s_add_u32 s50, s50, 16000

    buffer_load_dwordx4 v[28:31], v1, s[12:15], s58 offen nt
    buffer_load_dwordx4 v[12:15], v1, s[8:11], s58 offen nt
    buffer_load_dwordx2 v[40:41], v2, s[16:19], s63 offen nt
    buffer_load_dwordx4 v[32:35], v1, s[12:15], s59 offen nt
    buffer_load_dwordx4 v[16:19], v1, s[8:11], s59 offen nt
    buffer_load_dwordx2 v[42:43], v2, s[16:19], s64 offen nt
    s_cmp_lg_u32 s49, 0
    s_cbranch_scc1 L_p1loop_5
L_p1epi_6:
    s_waitcnt vmcnt(12)
    v_add_u32 v110, v92, v94
    v_min_u32 v92, s48, v92
    v_add_u32 v111, v93, v95
    v_min_u32 v93, s48, v93
    v_max_u32 v110, v110, v111
    v_add_u32 v92, v92, v96
    v_add_u32 v93, v93, v97
    v_cmp_le_u32 vcc, s48, v110
    v_lshl_add_u32 v92, v92, 2, v92
    v_lshl_add_u32 v93, v93, 2, v93
    ds_write_b64 v2, v[92:93] offset:8192
    s_cbranch_vccz L_noov_17
    ds_write_b32 v108, v104 offset:4
L_noov_17:
    s_waitcnt lgkmcnt(0)
    s_barrier
    ds_read_b32 v110, v108 offset:4
    s_waitcnt lgkmcnt(0)
    v_readfirstlane_b32 s53, v110
    s_nop 1
    s_cmp_lg_u32 s53, 0
    s_cbranch_scc1 L_slow_18
L_sback_19:

    ds_read_b64 v[110:111], v2 offset:16400
    ds_read_b64 v[112:113], v2 offset:16408
    ds_read_b64 v[114:115], v2 offset:16392

    ds_read_b64 v[116:117], v2 offset:24592
    ds_read_b64 v[118:119], v2 offset:24600
    ds_read_b64 v[120:121], v2 offset:24584

    s_waitcnt lgkmcnt(3)
    v_lshrrev_b32 v122, 16, v111
    ds_read_b32 v122, v122 offset:8192

    s_waitcnt lgkmcnt(1)
    v_lshrrev_b32 v123, 16, v117
    ds_read_b32 v123, v123 offset:8192

    v_cmp_ne_u32_sdwa s[70:71], v111, v113 src0_sel:WORD_1 src1_sel:WORD_1
    v_cmp_ne_u32_sdwa vcc, v111, v115 src0_sel:WORD_1 src1_sel:WORD_1
    v_perm_b32 v111, v112, v111, s45
    s_mov_b32 s54, 0
    v_alignbyte_b32 v114, v115, v114, 2
    s_waitcnt lgkmcnt(1)
    v_add3_u32 v122, v122, v106, s54

    s_and_b64 exec, vcc, s[70:71]
    v_and_b32 v111, 0xff, v111
    s_andn2_b64 exec, s[70:71], vcc
    v_alignbyte_b32 v111, v111, v110, 1
    v_perm_b32 v110, v110, v114, s47
    v_subrev_u32 v122, 3, v122
    s_mov_b64 exec, -1

    buffer_store_dwordx2 v[110:111], v122, s[24:27], 0 offen
    v_cmp_ne_u32_sdwa s[70:71], v117, v119 src0_sel:WORD_1 src1_sel:WORD_1
    v_cmp_ne_u32_sdwa vcc, v117, v121 src0_sel:WORD_1 src1_sel:WORD_1
    v_perm_b32 v117, v118, v117, s45
    s_mov_b32 s54, 5120
    v_alignbyte_b32 v120, v121, v120, 2
    s_waitcnt lgkmcnt(0)
    v_add3_u32 v123, v123, v106, s54

    s_and_b64 exec, vcc, s[70:71]
    v_and_b32 v117, 0xff, v117
    s_andn2_b64 exec, s[70:71], vcc
    v_alignbyte_b32 v117, v117, v116, 1
    v_perm_b32 v116, v116, v120, s47
    v_subrev_u32 v123, 3, v123
    s_mov_b64 exec, -1

    buffer_store_dwordx2 v[116:117], v123, s[24:27], 0 offen
    ds_read_b64 v[110:111], v2 offset:32784
    ds_read_b64 v[112:113], v2 offset:32792
    ds_read_b64 v[114:115], v2 offset:32776

    ds_read_b64 v[116:117], v2 offset:40976
    ds_read_b64 v[118:119], v2 offset:40984
    ds_read_b64 v[120:121], v2 offset:40968

    s_waitcnt lgkmcnt(3)
    v_lshrrev_b32 v122, 16, v111
    ds_read_b32 v122, v122 offset:8192

    s_waitcnt lgkmcnt(1)
    v_lshrrev_b32 v123, 16, v117
    ds_read_b32 v123, v123 offset:8192

    v_cmp_ne_u32_sdwa s[70:71], v111, v113 src0_sel:WORD_1 src1_sel:WORD_1
    v_cmp_ne_u32_sdwa vcc, v111, v115 src0_sel:WORD_1 src1_sel:WORD_1
    v_perm_b32 v111, v112, v111, s45
    s_mov_b32 s54, 10240
    v_alignbyte_b32 v114, v115, v114, 2
    s_waitcnt lgkmcnt(1)
    v_add3_u32 v122, v122, v106, s54

    s_and_b64 exec, vcc, s[70:71]
    v_and_b32 v111, 0xff, v111
    s_andn2_b64 exec, s[70:71], vcc
    v_alignbyte_b32 v111, v111, v110, 1
    v_perm_b32 v110, v110, v114, s47
    v_subrev_u32 v122, 3, v122
    s_mov_b64 exec, -1

    buffer_store_dwordx2 v[110:111], v122, s[24:27], 0 offen
    v_cmp_ne_u32_sdwa s[70:71], v117, v119 src0_sel:WORD_1 src1_sel:WORD_1
    v_cmp_ne_u32_sdwa vcc, v117, v121 src0_sel:WORD_1 src1_sel:WORD_1
    v_perm_b32 v117, v118, v117, s45
    s_mov_b32 s54, 15360
    v_alignbyte_b32 v120, v121, v120, 2
    s_waitcnt lgkmcnt(0)
    v_add3_u32 v123, v123, v106, s54

    s_and_b64 exec, vcc, s[70:71]
    v_and_b32 v117, 0xff, v117
    s_andn2_b64 exec, s[70:71], vcc
    v_alignbyte_b32 v117, v117, v116, 1
    v_perm_b32 v116, v116, v120, s47
    v_subrev_u32 v123, 3, v123
    s_mov_b64 exec, -1

    buffer_store_dwordx2 v[116:117], v123, s[24:27], 0 offen
    ds_read_b64 v[110:111], v2 offset:49168
    ds_read_b64 v[112:113], v2 offset:49176
    ds_read_b64 v[114:115], v2 offset:49160

    ds_read_b64 v[116:117], v2 offset:57360
    ds_read_b64 v[118:119], v2 offset:57368
    ds_read_b64 v[120:121], v2 offset:57352

    s_waitcnt lgkmcnt(3)
    v_lshrrev_b32 v122, 16, v111
    ds_read_b32 v122, v122 offset:8192

    s_waitcnt lgkmcnt(1)
    v_lshrrev_b32 v123, 16, v117
    ds_read_b32 v123, v123 offset:8192

    v_cmp_ne_u32_sdwa s[70:71], v111, v113 src0_sel:WORD_1 src1_sel:WORD_1
    v_cmp_ne_u32_sdwa vcc, v111, v115 src0_sel:WORD_1 src1_sel:WORD_1
    v_perm_b32 v111, v112, v111, s45
    s_mov_b32 s54, 20480
    v_alignbyte_b32 v114, v115, v114, 2
    s_waitcnt lgkmcnt(1)
    v_add3_u32 v122, v122, v106, s54

    s_and_b64 exec, vcc, s[70:71]
    v_and_b32 v111, 0xff, v111
    s_andn2_b64 exec, s[70:71], vcc
    v_alignbyte_b32 v111, v111, v110, 1
    v_perm_b32 v110, v110, v114, s47
    v_subrev_u32 v122, 3, v122
    s_mov_b64 exec, -1

    buffer_store_dwordx2 v[110:111], v122, s[24:27], 0 offen
    v_cmp_ne_u32_sdwa s[70:71], v117, v119 src0_sel:WORD_1 src1_sel:WORD_1
    v_cmp_ne_u32_sdwa vcc, v117, v121 src0_sel:WORD_1 src1_sel:WORD_1
    v_perm_b32 v117, v118, v117, s45
    s_mov_b32 s54, 25600
    v_alignbyte_b32 v120, v121, v120, 2
    s_waitcnt lgkmcnt(0)
    v_add3_u32 v123, v123, v106, s54

    s_and_b64 exec, vcc, s[70:71]
    v_and_b32 v117, 0xff, v117
    s_andn2_b64 exec, s[70:71], vcc
    v_alignbyte_b32 v117, v117, v116, 1
    v_perm_b32 v116, v116, v120, s47
    v_subrev_u32 v123, 3, v123
    s_mov_b64 exec, -1

    buffer_store_dwordx2 v[116:117], v123, s[24:27], 0 offen
    v_add_u32 v107, 65536, v2
    ds_read_b64 v[110:111], v107 offset:16
    ds_read_b64 v[112:113], v107 offset:24
    ds_read_b64 v[114:115], v107 offset:8

    ds_read_b64 v[116:117], v107 offset:8208
    ds_read_b64 v[118:119], v107 offset:8216
    ds_read_b64 v[120:121], v107 offset:8200

    s_waitcnt lgkmcnt(3)
    v_lshrrev_b32 v122, 16, v111
    ds_read_b32 v122, v122 offset:8192

    s_waitcnt lgkmcnt(1)
    v_lshrrev_b32 v123, 16, v117
    ds_read_b32 v123, v123 offset:8192

    v_cmp_ne_u32_sdwa s[70:71], v111, v113 src0_sel:WORD_1 src1_sel:WORD_1
    v_cmp_ne_u32_sdwa vcc, v111, v115 src0_sel:WORD_1 src1_sel:WORD_1
    v_perm_b32 v111, v112, v111, s45
    s_mov_b32 s54, 30720
    v_alignbyte_b32 v114, v115, v114, 2
    s_waitcnt lgkmcnt(1)
    v_add3_u32 v122, v122, v106, s54

    s_and_b64 exec, vcc, s[70:71]
    v_and_b32 v111, 0xff, v111
    s_andn2_b64 exec, s[70:71], vcc
    v_alignbyte_b32 v111, v111, v110, 1
    v_perm_b32 v110, v110, v114, s47
    v_subrev_u32 v122, 3, v122
    s_mov_b64 exec, -1

    buffer_store_dwordx2 v[110:111], v122, s[24:27], 0 offen
    v_cmp_ne_u32_sdwa s[70:71], v117, v119 src0_sel:WORD_1 src1_sel:WORD_1
    v_cmp_ne_u32_sdwa vcc, v117, v121 src0_sel:WORD_1 src1_sel:WORD_1
    v_perm_b32 v117, v118, v117, s45
    s_mov_b32 s54, 35840
    v_alignbyte_b32 v120, v121, v120, 2
    s_waitcnt lgkmcnt(0)
    v_add3_u32 v123, v123, v106, s54

    s_and_b64 exec, vcc, s[70:71]
    v_and_b32 v117, 0xff, v117
    s_andn2_b64 exec, s[70:71], vcc
    v_alignbyte_b32 v117, v117, v116, 1
    v_perm_b32 v116, v116, v120, s47
    v_subrev_u32 v123, 3, v123
    s_mov_b64 exec, -1

    buffer_store_dwordx2 v[116:117], v123, s[24:27], 0 offen
    ds_read_b64 v[110:111], v107 offset:16400
    ds_read_b64 v[112:113], v107 offset:16408
    ds_read_b64 v[114:115], v107 offset:16392

    ds_read_b64 v[116:117], v107 offset:24592
    ds_read_b64 v[118:119], v107 offset:24600
    ds_read_b64 v[120:121], v107 offset:24584

    s_waitcnt lgkmcnt(3)
    v_lshrrev_b32 v122, 16, v111
    ds_read_b32 v122, v122 offset:8192

    s_waitcnt lgkmcnt(1)
    v_lshrrev_b32 v123, 16, v117
    ds_read_b32 v123, v123 offset:8192

    v_cmp_ne_u32_sdwa s[70:71], v111, v113 src0_sel:WORD_1 src1_sel:WORD_1
    v_cmp_ne_u32_sdwa vcc, v111, v115 src0_sel:WORD_1 src1_sel:WORD_1
    v_perm_b32 v111, v112, v111, s45
    s_mov_b32 s54, 40960
    v_alignbyte_b32 v114, v115, v114, 2
    s_waitcnt lgkmcnt(1)
    v_add3_u32 v122, v122, v106, s54

    s_and_b64 exec, vcc, s[70:71]
    v_and_b32 v111, 0xff, v111
    s_andn2_b64 exec, s[70:71], vcc
    v_alignbyte_b32 v111, v111, v110, 1
    v_perm_b32 v110, v110, v114, s47
    v_subrev_u32 v122, 3, v122
    s_mov_b64 exec, -1

    buffer_store_dwordx2 v[110:111], v122, s[24:27], 0 offen
    v_cmp_ne_u32_sdwa s[70:71], v117, v119 src0_sel:WORD_1 src1_sel:WORD_1
    v_cmp_ne_u32_sdwa vcc, v117, v121 src0_sel:WORD_1 src1_sel:WORD_1
    v_perm_b32 v117, v118, v117, s45
    s_mov_b32 s54, 46080
    v_alignbyte_b32 v120, v121, v120, 2
    s_waitcnt lgkmcnt(0)
    v_add3_u32 v123, v123, v106, s54

    s_and_b64 exec, vcc, s[70:71]
    v_and_b32 v117, 0xff, v117
    s_andn2_b64 exec, s[70:71], vcc
    v_alignbyte_b32 v117, v117, v116, 1
    v_perm_b32 v116, v116, v120, s47
    v_subrev_u32 v123, 3, v123
    s_mov_b64 exec, -1

    buffer_store_dwordx2 v[116:117], v123, s[24:27], 0 offen
    ds_read_b64 v[110:111], v107 offset:32784
    ds_read_b64 v[112:113], v107 offset:32792
    ds_read_b64 v[114:115], v107 offset:32776

    ds_read_b64 v[116:117], v107 offset:40976
    ds_read_b64 v[118:119], v107 offset:40984
    ds_read_b64 v[120:121], v107 offset:40968

    s_waitcnt lgkmcnt(3)
    v_lshrrev_b32 v122, 16, v111
    ds_read_b32 v122, v122 offset:8192

    s_waitcnt lgkmcnt(1)
    v_lshrrev_b32 v123, 16, v117
    ds_read_b32 v123, v123 offset:8192

    v_cmp_ne_u32_sdwa s[70:71], v111, v113 src0_sel:WORD_1 src1_sel:WORD_1
    v_cmp_ne_u32_sdwa vcc, v111, v115 src0_sel:WORD_1 src1_sel:WORD_1
    v_perm_b32 v111, v112, v111, s45
    s_mov_b32 s54, 51200
    v_alignbyte_b32 v114, v115, v114, 2
    s_waitcnt lgkmcnt(1)
    v_add3_u32 v122, v122, v106, s54

    s_and_b64 exec, vcc, s[70:71]
    v_and_b32 v111, 0xff, v111
    s_andn2_b64 exec, s[70:71], vcc
    v_alignbyte_b32 v111, v111, v110, 1
    v_perm_b32 v110, v110, v114, s47
    v_subrev_u32 v122, 3, v122
    s_mov_b64 exec, -1

    buffer_store_dwordx2 v[110:111], v122, s[24:27], 0 offen
    v_cmp_ne_u32_sdwa s[70:71], v117, v119 src0_sel:WORD_1 src1_sel:WORD_1
    v_cmp_ne_u32_sdwa vcc, v117, v121 src0_sel:WORD_1 src1_sel:WORD_1
    v_perm_b32 v117, v118, v117, s45
    s_mov_b32 s54, 56320
    v_alignbyte_b32 v120, v121, v120, 2
    s_waitcnt lgkmcnt(0)
    v_add3_u32 v123, v123, v106, s54

    s_and_b64 exec, vcc, s[70:71]
    v_and_b32 v117, 0xff, v117
    s_andn2_b64 exec, s[70:71], vcc
    v_alignbyte_b32 v117, v117, v116, 1
    v_perm_b32 v116, v116, v120, s47
    v_subrev_u32 v123, 3, v123
    s_mov_b64 exec, -1

    buffer_store_dwordx2 v[116:117], v123, s[24:27], 0 offen
    ds_read_b64 v[110:111], v107 offset:49168
    ds_read_b64 v[112:113], v107 offset:49176
    ds_read_b64 v[114:115], v107 offset:49160

    ds_read_b64 v[116:117], v107 offset:57360
    ds_read_b64 v[118:119], v107 offset:57368
    ds_read_b64 v[120:121], v107 offset:57352

    s_waitcnt lgkmcnt(3)
    v_lshrrev_b32 v122, 16, v111
    ds_read_b32 v122, v122 offset:8192

    s_waitcnt lgkmcnt(1)
    v_lshrrev_b32 v123, 16, v117
    ds_read_b32 v123, v123 offset:8192

    v_cmp_ne_u32_sdwa s[70:71], v111, v113 src0_sel:WORD_1 src1_sel:WORD_1
    v_cmp_ne_u32_sdwa vcc, v111, v115 src0_sel:WORD_1 src1_sel:WORD_1
    v_perm_b32 v111, v112, v111, s45
    s_mov_b32 s54, 61440
    v_alignbyte_b32 v114, v115, v114, 2
    s_waitcnt lgkmcnt(1)
    v_add3_u32 v122, v122, v106, s54

    s_and_b64 exec, vcc, s[70:71]
    v_and_b32 v111, 0xff, v111
    s_andn2_b64 exec, s[70:71], vcc
    v_alignbyte_b32 v111, v111, v110, 1
    v_perm_b32 v110, v110, v114, s47
    v_subrev_u32 v122, 3, v122
    s_mov_b64 exec, -1

    buffer_store_dwordx2 v[110:111], v122, s[24:27], 0 offen
    v_cmp_ne_u32_sdwa s[70:71], v117, v119 src0_sel:WORD_1 src1_sel:WORD_1
    v_cmp_ne_u32_sdwa vcc, v117, v121 src0_sel:WORD_1 src1_sel:WORD_1
    v_perm_b32 v117, v118, v117, s45
    s_mov_b32 s54, 66560
    v_alignbyte_b32 v120, v121, v120, 2
    s_waitcnt lgkmcnt(0)
    v_add3_u32 v123, v123, v106, s54

    s_and_b64 exec, vcc, s[70:71]
    v_and_b32 v117, 0xff, v117
    s_andn2_b64 exec, s[70:71], vcc
    v_alignbyte_b32 v117, v117, v116, 1
    v_perm_b32 v116, v116, v120, s47
    v_subrev_u32 v123, 3, v123
    s_mov_b64 exec, -1

    buffer_store_dwordx2 v[116:117], v123, s[24:27], 0 offen
    v_add_u32 v107, 131072, v2
    ds_read_b64 v[110:111], v107 offset:16
    ds_read_b64 v[112:113], v107 offset:24
    ds_read_b64 v[114:115], v107 offset:8

    ds_read_b64 v[116:117], v107 offset:8208
    ds_read_b64 v[118:119], v107 offset:8216
    ds_read_b64 v[120:121], v107 offset:8200

    s_waitcnt lgkmcnt(3)
    v_lshrrev_b32 v122, 16, v111
    ds_read_b32 v122, v122 offset:8192

    s_waitcnt lgkmcnt(1)
    v_lshrrev_b32 v123, 16, v117
    ds_read_b32 v123, v123 offset:8192

    v_cmp_ne_u32_sdwa s[70:71], v111, v113 src0_sel:WORD_1 src1_sel:WORD_1
    v_cmp_ne_u32_sdwa vcc, v111, v115 src0_sel:WORD_1 src1_sel:WORD_1
    v_perm_b32 v111, v112, v111, s45
    s_mov_b32 s54, 71680
    v_alignbyte_b32 v114, v115, v114, 2
    s_waitcnt lgkmcnt(1)
    v_add3_u32 v122, v122, v106, s54

    s_and_b64 exec, vcc, s[70:71]
    v_and_b32 v111, 0xff, v111
    s_andn2_b64 exec, s[70:71], vcc
    v_alignbyte_b32 v111, v111, v110, 1
    v_perm_b32 v110, v110, v114, s47
    v_subrev_u32 v122, 3, v122
    s_mov_b64 exec, -1

    buffer_store_dwordx2 v[110:111], v122, s[24:27], 0 offen
    v_cmp_ne_u32_sdwa s[70:71], v117, v119 src0_sel:WORD_1 src1_sel:WORD_1
    v_cmp_ne_u32_sdwa vcc, v117, v121 src0_sel:WORD_1 src1_sel:WORD_1
    v_perm_b32 v117, v118, v117, s45
    s_mov_b32 s54, 76800
    v_alignbyte_b32 v120, v121, v120, 2
    s_waitcnt lgkmcnt(0)
    v_add3_u32 v123, v123, v106, s54

    s_andn2_b64 exec, -1, s[68:69]
    v_bfrev_b32 v123, 1

    s_and_b64 exec, vcc, s[70:71]
    v_and_b32 v117, 0xff, v117
    s_andn2_b64 exec, s[70:71], vcc
    v_alignbyte_b32 v117, v117, v116, 1
    v_perm_b32 v116, v116, v120, s47
    v_subrev_u32 v123, 3, v123
    s_mov_b64 exec, -1

    buffer_store_dwordx2 v[116:117], v123, s[24:27], 0 offen
L_p1done_1:
    s_endpgm

L_slow_12:
    s_mov_b32 s26, 0
    v_mov_b32 v112, v0
    v_mov_b32 v118, 0
    s_mov_b32 s75, 4960
    s_movk_i32 s74, 16000
L_sl_14:
    v_lshlrev_b32 v113, 3, v112
    ds_read_b64 v[110:111], v113 offset:16400
    ds_read_b32 v119, v113 offset:16412
    ds_read_b32 v120, v113 offset:16396
    s_waitcnt lgkmcnt(0)
    v_lshrrev_b32 v114, 16, v111
    ds_read_b32 v115, v114 offset:8192
    v_add_u32 v114, 4, v114
    v_mul_u32_u24 v114, s75, v114
    s_waitcnt lgkmcnt(0)
    v_mad_u32_u24 v115, v112, 5, v115
    v_mov_b32 v116, 1
    v_cmp_gt_u32 s[72:73], s74, v112
    v_cmp_ge_u32 vcc, v115, v114
    s_and_b64 exec, vcc, s[72:73]
    s_cbranch_execz L_s1_15
    buffer_atomic_add v116, v118, s[36:39], 0 offen sc0
    s_waitcnt vmcnt(0)
    v_lshlrev_b32 v116, 3, v116
    buffer_store_dwordx2 v[110:111], v116, s[32:35], 0 offen
L_s1_15:
    s_andn2_b64 exec, s[72:73], vcc
    s_cbranch_execz L_s2_16
    buffer_store_dword v110, v115, s[28:31], 0 offen
    buffer_store_byte v111, v115, s[28:31], 0 offen offset:4
    v_add_u32 v115, 5, v115
    v_cmpx_lt_u32 vcc, v115, v114
    v_cmpx_ne_u32_sdwa vcc, v111, v119 src0_sel:WORD_1 src1_sel:WORD_1
    v_cmpx_ne_u32_sdwa vcc, v111, v120 src0_sel:WORD_1 src1_sel:WORD_1
    s_cbranch_execz L_s2_16
    buffer_store_dword v118, v115, s[28:31], 0 offen
L_s2_16:
    s_mov_b64 exec, -1
    s_waitcnt vmcnt(0)
    v_add_u32 v112, 1024, v112
    s_nop 0
    v_readfirstlane_b32 s76, v112
    s_nop 1
    s_cmp_lt_u32 s76, s74
    s_cbranch_scc1 L_sl_14
    s_branch L_sback_13

L_slow_18:
    s_mov_b32 s26, 0
    v_mov_b32 v112, v0
    v_mov_b32 v118, 0
    s_mov_b32 s75, 4960
    s_movk_i32 s74, 16000
L_sl_20:
    v_lshlrev_b32 v113, 3, v112
    ds_read_b64 v[110:111], v113 offset:16400
    ds_read_b32 v119, v113 offset:16412
    ds_read_b32 v120, v113 offset:16396
    s_waitcnt lgkmcnt(0)
    v_lshrrev_b32 v114, 16, v111
    ds_read_b32 v115, v114 offset:8192
    v_add_u32 v114, 4, v114
    v_mul_u32_u24 v114, s75, v114
    s_waitcnt lgkmcnt(0)
    v_mad_u32_u24 v115, v112, 5, v115
    v_mov_b32 v116, 1
    v_cmp_gt_u32 s[72:73], s74, v112
    v_cmp_ge_u32 vcc, v115, v114
    s_and_b64 exec, vcc, s[72:73]
    s_cbranch_execz L_s1_21
    buffer_atomic_add v116, v118, s[36:39], 0 offen sc0
    s_waitcnt vmcnt(0)
    v_lshlrev_b32 v116, 3, v116
    buffer_store_dwordx2 v[110:111], v116, s[32:35], 0 offen
L_s1_21:
    s_andn2_b64 exec, s[72:73], vcc
    s_cbranch_execz L_s2_22
    buffer_store_dword v110, v115, s[28:31], 0 offen
    buffer_store_byte v111, v115, s[28:31], 0 offen offset:4
    v_add_u32 v115, 5, v115
    v_cmpx_lt_u32 vcc, v115, v114
    v_cmpx_ne_u32_sdwa vcc, v111, v119 src0_sel:WORD_1 src1_sel:WORD_1
    v_cmpx_ne_u32_sdwa vcc, v111, v120 src0_sel:WORD_1 src1_sel:WORD_1
    s_cbranch_execz L_s2_22
    buffer_store_dword v118, v115, s[28:31], 0 offen
L_s2_22:
    s_mov_b64 exec, -1
    s_waitcnt vmcnt(0)
    v_add_u32 v112, 1024, v112
    s_nop 0
    v_readfirstlane_b32 s76, v112
    s_nop 1
    s_cmp_lt_u32 s76, s74
    s_cbranch_scc1 L_sl_20
    s_branch L_sback_19

.globl g2_kernel
.p2align 8
.type g2_kernel,@function
g2_kernel:
    s_cmp_ge_u32 s2, 256
    s_cbranch_scc1 L_p2done_23
    s_load_dwordx2 s[8:9], s[0:1], 0
    s_load_dwordx2 s[6:7], s[0:1], 104
    v_lshrrev_b32 v4, 6, v0
    v_lshlrev_b32 v5, 3, v0
    s_lshr_b32 s37, s2, 1
    s_and_b32 s37, s37, 3
    s_lshr_b32 s36, s2, 3
    s_lshl_b32 s36, s36, 1
    s_and_b32 s3, s2, 1
    s_or_b32 s36, s36, s3
    v_readfirstlane_b32 s4, v4
    v_and_b32 v2, 127, v0
    v_mul_u32_u24 v2, 20, v2
    v_lshlrev_b32 v3, 4, v0
    s_waitcnt lgkmcnt(0)
    s_lshr_b32 s5, s4, 1
    s_and_b32 s39, s4, 1
    s_lshl_b32 s39, s39, 8
    s_mul_i32 s3, s5, 8192
    s_add_u32 s46, s6, s3
    s_addc_u32 s47, s7, 0
    s_mul_i32 s3, s5, 40632320
    s_add_u32 s3, s3, 77848576
    s_add_u32 s44, s6, s3
    s_addc_u32 s45, s7, 0
    s_mul_i32 s38, s37, 8
    s_add_u32 s4, s38, 8
    s_lshl_b32 s3, s38, 6
    s_add_u32 s3, s3, s36
    s_lshl_b32 s3, s3, 2
    s_load_dword s41, s[46:47], s3
    s_mov_b32 s3, 65536
    s_load_dword s51, s[6:7], s3
    s_mov_b32 s10, 6400000
    s_mov_b32 s11, 0x20000

    s_add_u32 s20, s6, 135168
    s_addc_u32 s21, s7, 0
    s_mov_b32 s22, 2048
    s_mov_b32 s23, 0x20000
    buffer_load_dwordx2 v[116:117], v5, s[20:23], 0 offen
    s_mov_b32 s12, s8
    s_mov_b32 s13, s9
    s_mov_b32 s14, 0
    s_mov_b32 s15, 0x20000
    s_mul_i32 s43, s38, 200000
    s_add_u32 s14, s43, 50000
    buffer_load_dwordx4 v[76:79], v3, s[12:15], s43 offen
    s_add_u32 s52, s43, 16384
    buffer_load_dwordx4 v[80:83], v3, s[12:15], s52 offen
    s_add_u32 s52, s43, 32768
    buffer_load_dwordx4 v[84:87], v3, s[12:15], s52 offen
    s_add_u32 s52, s43, 49152
    v_lshlrev_b32 v123, 2, v0
    buffer_load_dword v88, v123, s[12:15], s52 offen
    s_lshr_b32 s3, s2, 3
    s_mul_i32 s3, s3, 49
    v_add_lshl_u32 v89, v0, s3, 7
    v_cmp_gt_u32 vcc, 49, v0
    v_bfrev_b32 v28, 1
    s_add_u32 s54, s43, 100000
    v_cndmask_b32 v89, v28, v89, vcc

    buffer_load_dword v115, v89, s[8:11], s54 offen
    s_mov_b32 s19, 0x20000
    s_mov_b32 s28, 0x4b404000
    s_mov_b32 s29, 0x4b404000
    s_mov_b32 s30, 0xbfffc000
    s_mov_b32 s31, 0xbfffbfff
    s_mov_b32 s32, 0xffff0000
    s_mov_b32 s35, 0x05040100
    s_movk_i32 s3, 212
    v_cmp_gt_u32 s[48:49], s3, v0

    v_mov_b32 v1, 0
    s_mov_b32 s24, 0xc0c0004
    s_mov_b32 s25, 0xc0c0105
    s_mov_b32 s26, 0xc0c0206
    s_mov_b32 s27, 0xc0c0307
    s_waitcnt lgkmcnt(0)
    s_min_u32 s41, s41, 3968
    s_lshl_b32 s52, s38, 6
    s_add_u32 s52, s52, s36
    s_mul_i32 s52, s52, 19840
    s_add_u32 s16, s44, s52
    s_addc_u32 s17, s45, 0
    s_mul_i32 s52, s41, 5
    s_add_u32 s52, s52, 3
    s_and_b32 s18, s52, -4

    s_movk_i32 s53, 0
    buffer_load_dwordx4 v[4:7], v2, s[16:19], s53 offen
    buffer_load_dword v35, v2, s[16:19], s53 offen offset:16
    s_movk_i32 s53, 2560
    buffer_load_dwordx4 v[8:11], v2, s[16:19], s53 offen
    buffer_load_dword v43, v2, s[16:19], s53 offen offset:16
    s_movk_i32 s53, 5120
    buffer_load_dwordx4 v[90:93], v2, s[16:19], s53 offen
    buffer_load_dword v110, v2, s[16:19], s53 offen offset:16
    s_movk_i32 s53, 7680
    buffer_load_dwordx4 v[94:97], v2, s[16:19], s53 offen
    buffer_load_dword v111, v2, s[16:19], s53 offen offset:16
    s_movk_i32 s53, 10240
    buffer_load_dwordx4 v[98:101], v2, s[16:19], s53 offen
    buffer_load_dword v112, v2, s[16:19], s53 offen offset:16
    s_movk_i32 s53, 12800
    buffer_load_dwordx4 v[102:105], v2, s[16:19], s53 offen
    buffer_load_dword v113, v2, s[16:19], s53 offen offset:16
    s_movk_i32 s53, 15360
    buffer_load_dwordx4 v[106:109], v2, s[16:19], s53 offen
    buffer_load_dword v114, v2, s[16:19], s53 offen offset:16
    v_mov_b32 v28, 0x40004000
    v_mov_b32 v29, 0x40004000
    v_mov_b32 v30, 0x40004000
    v_mov_b32 v31, 0x40004000
    v_add_u32 v32, 50000, v3
    v_add_u32 v33, 65536, v32

    ds_write_b128 v32, v[28:31] offset:0
    ds_write_b128 v32, v[28:31] offset:16384
    ds_write_b128 v32, v[28:31] offset:32768
    ds_write_b128 v32, v[28:31] offset:49152
    ds_write_b128 v33, v[28:31] offset:0
    ds_write_b128 v33, v[28:31] offset:16384
    v_cmp_gt_u32 vcc, 971, v0
    s_mov_b64 exec, vcc
    ds_write_b128 v33, v[28:31] offset:32768
    s_mov_b64 exec, -1
    s_waitcnt lgkmcnt(0)
    s_barrier
    v_mov_b32 v34, 150016
    v_mov_b32 v36, 0
    v_mov_b32 v37, 0
    v_mov_b32 v38, 0
    v_mov_b32 v39, 0
    ds_write_b128 v34, v[36:39]

    s_waitcnt vmcnt(19)
    s_nop 1
    v_max_u32_dpp v116, v116, v116 row_shr:1 row_mask:0xf bank_mask:0xf
    s_nop 1
    v_max_u32_dpp v116, v116, v116 row_shr:2 row_mask:0xf bank_mask:0xf
    s_nop 1
    v_max_u32_dpp v116, v116, v116 row_shr:4 row_mask:0xf bank_mask:0xf
    s_nop 1
    v_max_u32_dpp v116, v116, v116 row_shr:8 row_mask:0xf bank_mask:0xf
    s_nop 1
    v_max_u32_dpp v116, v116, v116 row_bcast:15 row_mask:0xa bank_mask:0xf
    s_nop 1
    v_max_u32_dpp v116, v116, v116 row_bcast:31 row_mask:0xc bank_mask:0xf
    s_nop 1
    v_add_f32_dpp v117, v117, v117 row_shr:1 row_mask:0xf bank_mask:0xf
    s_nop 1
    v_add_f32_dpp v117, v117, v117 row_shr:2 row_mask:0xf bank_mask:0xf
    s_nop 1
    v_add_f32_dpp v117, v117, v117 row_shr:4 row_mask:0xf bank_mask:0xf
    s_nop 1
    v_add_f32_dpp v117, v117, v117 row_shr:8 row_mask:0xf bank_mask:0xf
    s_nop 1
    v_add_f32_dpp v117, v117, v117 row_bcast:15 row_mask:0xa bank_mask:0xf
    s_nop 1
    v_add_f32_dpp v117, v117, v117 row_bcast:31 row_mask:0xc bank_mask:0xf
    s_waitcnt lgkmcnt(0)
    s_barrier
    s_mov_b32 exec_lo, 0
    s_brev_b32 exec_hi, 1
    ds_max_u32 v34, v116
    ds_add_f32 v34, v117 offset:4
    s_mov_b64 exec, -1

    s_waitcnt vmcnt(18)
    ds_write_b128 v3, v[76:79] offset:0
    s_waitcnt vmcnt(17)
    ds_write_b128 v3, v[80:83] offset:16384
    s_waitcnt vmcnt(16)
    ds_write_b128 v3, v[84:87] offset:32768
    v_lshlrev_b32 v123, 2, v0
    s_waitcnt vmcnt(15)
    s_mov_b64 exec, s[48:49]
    ds_write_b32 v123, v88 offset:49152
    s_mov_b64 exec, -1

    s_add_u32 s43, s43, 50000
    s_add_u32 s14, s43, 50000
    buffer_load_dwordx4 v[76:79], v3, s[12:15], s43 offen
    s_add_u32 s52, s43, 16384
    buffer_load_dwordx4 v[80:83], v3, s[12:15], s52 offen
    s_add_u32 s52, s43, 32768
    buffer_load_dwordx4 v[84:87], v3, s[12:15], s52 offen
    s_add_u32 s52, s43, 49152
    v_lshlrev_b32 v123, 2, v0
    buffer_load_dword v88, v123, s[12:15], s52 offen
    s_waitcnt lgkmcnt(0)
    s_barrier
    ds_read_b64 v[28:29], v34
    s_waitcnt lgkmcnt(0)
    v_lshlrev_b32 v28, 16, v28
    v_mul_f32 v29, 0x34a7c5ac, v29
    v_sqrt_f32 v29, v29
    v_add_f32 v30, v28, v28
    v_mul_f32 v31, 0x41ac0000, v29
    v_mul_f32 v32, 0x42000000, v29
    v_max_f32 v30, v30, v31
    v_cmp_le_f32 vcc, v28, v32
    v_mov_b32 v33, 0x26901d7d
    v_cmp_lt_f32 s[64:65], v33, v29
    v_mov_b32 v33, 0x58635fa9
    s_and_b64 vcc, vcc, s[64:65]
    v_cmp_gt_f32 s[64:65], v33, v29
    v_rcp_f32 v30, v30
    s_and_b64 vcc, vcc, s[64:65]
    s_cbranch_scc0 L_p2slow_24
    s_cmp_lg_u32 s51, 0
    s_cbranch_scc1 L_p2slow_24
    v_mul_f32 v30, 0x3f000000, v30
    v_mul_f32 v31, 0x46ff8000, v30
    v_rcp_f32 v31, v31
    v_readfirstlane_b32 s33, v30
    s_nop 0
    v_readfirstlane_b32 s34, v31

L_batch_25:
    s_mov_b32 s40, s41
    s_sub_u32 s42, s40, s39
    s_mul_i32 s50, s38, 200000
    s_add_u32 s5, s38, 1
    s_min_u32 s52, s5, 31
    s_lshl_b32 s52, s52, 6
    s_add_u32 s52, s52, s36
    s_lshl_b32 s52, s52, 2
    s_load_dword s41, s[46:47], s52

    s_waitcnt vmcnt(12)
    v_perm_b32 v44, v91, v90, s24
    v_perm_b32 v46, v92, v91, s25
    v_perm_b32 v48, v93, v92, s26
    v_perm_b32 v50, v110, v93, s27
    v_mov_b32 v12, v90
    v_alignbyte_b32 v13, v92, v91, 1
    v_alignbyte_b32 v14, v93, v92, 2
    v_alignbyte_b32 v15, v110, v93, 3
    v_lshlrev_b32_sdwa v44, 3, v44 dst_sel:WORD_0 dst_unused:UNUSED_PAD src0_sel:DWORD src1_sel:DWORD
    v_lshlrev_b32_sdwa v46, 3, v46 dst_sel:WORD_0 dst_unused:UNUSED_PAD src0_sel:DWORD src1_sel:DWORD
    v_lshlrev_b32_sdwa v48, 3, v48 dst_sel:WORD_0 dst_unused:UNUSED_PAD src0_sel:DWORD src1_sel:DWORD
    v_lshlrev_b32_sdwa v50, 3, v50 dst_sel:WORD_0 dst_unused:UNUSED_PAD src0_sel:DWORD src1_sel:DWORD
    s_cmp_lt_i32 s42, 1280
    s_cbranch_scc1 L_ufix_26
L_uback_27:

    s_waitcnt vmcnt(10)
    v_perm_b32 v52, v95, v94, s24
    v_perm_b32 v54, v96, v95, s25
    v_perm_b32 v56, v97, v96, s26
    v_perm_b32 v58, v111, v97, s27
    v_mov_b32 v16, v94
    v_alignbyte_b32 v17, v96, v95, 1
    v_alignbyte_b32 v18, v97, v96, 2
    v_alignbyte_b32 v19, v111, v97, 3
    v_lshlrev_b32_sdwa v52, 3, v52 dst_sel:WORD_0 dst_unused:UNUSED_PAD src0_sel:DWORD src1_sel:DWORD
    v_lshlrev_b32_sdwa v54, 3, v54 dst_sel:WORD_0 dst_unused:UNUSED_PAD src0_sel:DWORD src1_sel:DWORD
    v_lshlrev_b32_sdwa v56, 3, v56 dst_sel:WORD_0 dst_unused:UNUSED_PAD src0_sel:DWORD src1_sel:DWORD
    v_lshlrev_b32_sdwa v58, 3, v58 dst_sel:WORD_0 dst_unused:UNUSED_PAD src0_sel:DWORD src1_sel:DWORD
    s_cmp_lt_i32 s42, 1792
    s_cbranch_scc1 L_ufix_28
L_uback_29:

    s_waitcnt vmcnt(8)
    v_perm_b32 v60, v99, v98, s24
    v_perm_b32 v62, v100, v99, s25
    v_perm_b32 v64, v101, v100, s26
    v_perm_b32 v66, v112, v101, s27
    v_mov_b32 v20, v98
    v_alignbyte_b32 v21, v100, v99, 1
    v_alignbyte_b32 v22, v101, v100, 2
    v_alignbyte_b32 v23, v112, v101, 3
    v_lshlrev_b32_sdwa v60, 3, v60 dst_sel:WORD_0 dst_unused:UNUSED_PAD src0_sel:DWORD src1_sel:DWORD
    v_lshlrev_b32_sdwa v62, 3, v62 dst_sel:WORD_0 dst_unused:UNUSED_PAD src0_sel:DWORD src1_sel:DWORD
    v_lshlrev_b32_sdwa v64, 3, v64 dst_sel:WORD_0 dst_unused:UNUSED_PAD src0_sel:DWORD src1_sel:DWORD
    v_lshlrev_b32_sdwa v66, 3, v66 dst_sel:WORD_0 dst_unused:UNUSED_PAD src0_sel:DWORD src1_sel:DWORD
    s_cmp_lt_i32 s42, 2304
    s_cbranch_scc1 L_ufix_30
L_uback_31:

    s_waitcnt vmcnt(6)
    v_perm_b32 v68, v103, v102, s24
    v_perm_b32 v70, v104, v103, s25
    v_perm_b32 v72, v105, v104, s26
    v_perm_b32 v74, v113, v105, s27
    v_mov_b32 v24, v102
    v_alignbyte_b32 v25, v104, v103, 1
    v_alignbyte_b32 v26, v105, v104, 2
    v_alignbyte_b32 v27, v113, v105, 3
    v_lshlrev_b32_sdwa v68, 3, v68 dst_sel:WORD_0 dst_unused:UNUSED_PAD src0_sel:DWORD src1_sel:DWORD
    v_lshlrev_b32_sdwa v70, 3, v70 dst_sel:WORD_0 dst_unused:UNUSED_PAD src0_sel:DWORD src1_sel:DWORD
    v_lshlrev_b32_sdwa v72, 3, v72 dst_sel:WORD_0 dst_unused:UNUSED_PAD src0_sel:DWORD src1_sel:DWORD
    v_lshlrev_b32_sdwa v74, 3, v74 dst_sel:WORD_0 dst_unused:UNUSED_PAD src0_sel:DWORD src1_sel:DWORD
    s_cmp_lt_i32 s42, 2816
    s_cbranch_scc1 L_ufix_32
L_uback_33:

    s_waitcnt vmcnt(4)
    v_perm_b32 v28, v5, v4, s24
    v_perm_b32 v30, v6, v5, s25
    v_perm_b32 v32, v7, v6, s26
    v_perm_b32 v34, v35, v7, s27
    v_alignbyte_b32 v5, v6, v5, 1
    v_alignbyte_b32 v6, v7, v6, 2
    v_alignbyte_b32 v7, v35, v7, 3
    v_lshlrev_b32_sdwa v28, 3, v28 dst_sel:WORD_0 dst_unused:UNUSED_PAD src0_sel:DWORD src1_sel:DWORD
    v_lshlrev_b32_sdwa v30, 3, v30 dst_sel:WORD_0 dst_unused:UNUSED_PAD src0_sel:DWORD src1_sel:DWORD
    v_lshlrev_b32_sdwa v32, 3, v32 dst_sel:WORD_0 dst_unused:UNUSED_PAD src0_sel:DWORD src1_sel:DWORD
    v_lshlrev_b32_sdwa v34, 3, v34 dst_sel:WORD_0 dst_unused:UNUSED_PAD src0_sel:DWORD src1_sel:DWORD
    s_cmp_lt_i32 s42, 256
    s_cbranch_scc1 L_ufix_34
L_uback_35:

    s_waitcnt vmcnt(2)
    v_perm_b32 v36, v9, v8, s24
    v_perm_b32 v38, v10, v9, s25
    v_perm_b32 v40, v11, v10, s26
    v_perm_b32 v42, v43, v11, s27
    v_alignbyte_b32 v9, v10, v9, 1
    v_alignbyte_b32 v10, v11, v10, 2
    v_alignbyte_b32 v11, v43, v11, 3
    v_lshlrev_b32_sdwa v36, 3, v36 dst_sel:WORD_0 dst_unused:UNUSED_PAD src0_sel:DWORD src1_sel:DWORD
    v_lshlrev_b32_sdwa v38, 3, v38 dst_sel:WORD_0 dst_unused:UNUSED_PAD src0_sel:DWORD src1_sel:DWORD
    v_lshlrev_b32_sdwa v40, 3, v40 dst_sel:WORD_0 dst_unused:UNUSED_PAD src0_sel:DWORD src1_sel:DWORD
    v_lshlrev_b32_sdwa v42, 3, v42 dst_sel:WORD_0 dst_unused:UNUSED_PAD src0_sel:DWORD src1_sel:DWORD
    s_cmp_lt_i32 s42, 768
    s_cbranch_scc1 L_ufix_36
L_uback_37:

    v_subrev_co_u32 v4, s[64:65], 2.0, v4
    v_subrev_co_u32 v5, s[66:67], 2.0, v5
    v_subrev_co_u32 v6, s[68:69], 2.0, v6
    v_subrev_co_u32 v7, s[70:71], 2.0, v7
    v_subrev_co_u32 v8, s[72:73], 2.0, v8
    v_subrev_co_u32 v9, s[74:75], 2.0, v9
    v_subrev_co_u32 v10, s[76:77], 2.0, v10
    v_subrev_co_u32 v11, s[78:79], 2.0, v11
    v_subrev_co_u32 v12, s[80:81], 2.0, v12
    v_subrev_co_u32 v13, s[82:83], 2.0, v13
    v_subrev_co_u32 v14, s[84:85], 2.0, v14
    v_subrev_co_u32 v15, s[86:87], 2.0, v15
    s_waitcnt lgkmcnt(0)
    s_barrier
    s_cmp_lt_u32 s5, s4
    s_cselect_b32 s41, s41, 0
    s_min_u32 s55, s5, 31
    s_min_u32 s41, s41, 3968
    s_lshl_b32 s52, s55, 6
    s_add_u32 s52, s52, s36
    s_mul_i32 s52, s52, 19840
    s_add_u32 s16, s44, s52
    s_addc_u32 s17, s45, 0
    s_mul_i32 s52, s41, 5
    s_add_u32 s52, s52, 3
    s_and_b32 s18, s52, -4

    s_mov_b64 exec, s[64:65]
    ds_read_b64 v[28:29], v28
    s_mov_b64 exec, s[66:67]
    ds_read_b64 v[30:31], v30
    s_mov_b64 exec, s[68:69]
    ds_read_b64 v[32:33], v32
    s_mov_b64 exec, s[70:71]
    ds_read_b64 v[34:35], v34
    s_mov_b64 exec, s[72:73]
    ds_read_b64 v[36:37], v36
    s_mov_b64 exec, s[74:75]
    ds_read_b64 v[38:39], v38
    s_mov_b64 exec, s[76:77]
    ds_read_b64 v[40:41], v40
    s_mov_b64 exec, s[78:79]
    ds_read_b64 v[42:43], v42
    s_mov_b64 exec, s[80:81]
    ds_read_b64 v[44:45], v44
    s_mov_b64 exec, s[82:83]
    ds_read_b64 v[46:47], v46
    s_mov_b64 exec, s[84:85]
    ds_read_b64 v[48:49], v48
    s_mov_b64 exec, s[86:87]
    ds_read_b64 v[50:51], v50
    s_mov_b64 exec, -1
    s_movk_i32 s53, 5120
    buffer_load_dwordx4 v[90:93], v2, s[16:19], s53 offen
    buffer_load_dword v110, v2, s[16:19], s53 offen offset:16
    v_subrev_co_u32 v16, s[64:65], 2.0, v16
    v_subrev_co_u32 v17, s[66:67], 2.0, v17
    v_subrev_co_u32 v18, s[68:69], 2.0, v18
    v_subrev_co_u32 v19, s[70:71], 2.0, v19
    v_subrev_co_u32 v20, s[72:73], 2.0, v20
    v_subrev_co_u32 v21, s[74:75], 2.0, v21
    v_subrev_co_u32 v22, s[76:77], 2.0, v22
    v_subrev_co_u32 v23, s[78:79], 2.0, v23
    v_subrev_co_u32 v24, s[80:81], 2.0, v24
    v_subrev_co_u32 v25, s[82:83], 2.0, v25
    v_subrev_co_u32 v26, s[84:85], 2.0, v26
    v_subrev_co_u32 v27, s[86:87], 2.0, v27
    s_mov_b64 exec, s[64:65]
    ds_read_b64 v[52:53], v52
    s_mov_b64 exec, s[66:67]
    ds_read_b64 v[54:55], v54
    s_mov_b64 exec, s[68:69]
    ds_read_b64 v[56:57], v56
    s_mov_b64 exec, s[70:71]
    ds_read_b64 v[58:59], v58
    s_mov_b64 exec, s[72:73]
    ds_read_b64 v[60:61], v60
    s_mov_b64 exec, s[74:75]
    ds_read_b64 v[62:63], v62
    s_mov_b64 exec, s[76:77]
    ds_read_b64 v[64:65], v64
    s_mov_b64 exec, s[78:79]
    ds_read_b64 v[66:67], v66
    s_mov_b64 exec, s[80:81]
    ds_read_b64 v[68:69], v68
    s_mov_b64 exec, s[82:83]
    ds_read_b64 v[70:71], v70
    s_mov_b64 exec, s[84:85]
    ds_read_b64 v[72:73], v72
    s_mov_b64 exec, s[86:87]
    ds_read_b64 v[74:75], v74
    s_mov_b64 exec, -1
    s_waitcnt lgkmcnt(0)
    s_barrier
    s_waitcnt vmcnt(5)
    ds_write_b128 v3, v[76:79] offset:0
    s_waitcnt vmcnt(4)
    ds_write_b128 v3, v[80:83] offset:16384
    s_waitcnt vmcnt(3)
    ds_write_b128 v3, v[84:87] offset:32768
    v_lshlrev_b32 v123, 2, v0
    s_waitcnt vmcnt(2)
    s_mov_b64 exec, s[48:49]
    ds_write_b32 v123, v88 offset:49152
    s_mov_b64 exec, -1

    s_add_u32 s43, s43, 50000
    s_add_u32 s14, s43, 50000
    buffer_load_dwordx4 v[76:79], v3, s[12:15], s43 offen
    s_add_u32 s52, s43, 16384
    buffer_load_dwordx4 v[80:83], v3, s[12:15], s52 offen
    v_subrev_co_u32 v4, s[64:65], 2.0, v4
    v_subrev_co_u32 v5, s[66:67], 2.0, v5
    v_subrev_co_u32 v6, s[68:69], 2.0, v6
    v_subrev_co_u32 v7, s[70:71], 2.0, v7
    v_subrev_co_u32 v8, s[72:73], 2.0, v8
    v_subrev_co_u32 v9, s[74:75], 2.0, v9
    v_subrev_co_u32 v10, s[76:77], 2.0, v10
    v_subrev_co_u32 v11, s[78:79], 2.0, v11
    v_subrev_co_u32 v12, s[80:81], 2.0, v12
    v_subrev_co_u32 v13, s[82:83], 2.0, v13
    v_subrev_co_u32 v14, s[84:85], 2.0, v14
    v_subrev_co_u32 v15, s[86:87], 2.0, v15
    s_waitcnt lgkmcnt(0)
    s_barrier
    s_add_u32 s52, s43, 32768
    buffer_load_dwordx4 v[84:87], v3, s[12:15], s52 offen
    s_add_u32 s52, s43, 49152
    v_lshlrev_b32 v123, 2, v0
    buffer_load_dword v88, v123, s[12:15], s52 offen
    s_mov_b64 exec, s[64:65]
    ds_read_b64 v[28:29], v28
    s_mov_b64 exec, s[66:67]
    ds_read_b64 v[30:31], v30
    s_mov_b64 exec, s[68:69]
    ds_read_b64 v[32:33], v32
    s_mov_b64 exec, s[70:71]
    ds_read_b64 v[34:35], v34
    s_mov_b64 exec, s[72:73]
    ds_read_b64 v[36:37], v36
    s_mov_b64 exec, s[74:75]
    ds_read_b64 v[38:39], v38
    s_mov_b64 exec, s[76:77]
    ds_read_b64 v[40:41], v40
    s_mov_b64 exec, s[78:79]
    ds_read_b64 v[42:43], v42
    s_mov_b64 exec, s[80:81]
    ds_read_b64 v[44:45], v44
    s_mov_b64 exec, s[82:83]
    ds_read_b64 v[46:47], v46
    s_mov_b64 exec, s[84:85]
    ds_read_b64 v[48:49], v48
    s_mov_b64 exec, s[86:87]
    ds_read_b64 v[50:51], v50
    s_mov_b64 exec, -1
    s_movk_i32 s53, 7680
    buffer_load_dwordx4 v[94:97], v2, s[16:19], s53 offen
    buffer_load_dword v111, v2, s[16:19], s53 offen offset:16
    v_subrev_co_u32 v16, s[64:65], 2.0, v16
    v_subrev_co_u32 v17, s[66:67], 2.0, v17
    v_subrev_co_u32 v18, s[68:69], 2.0, v18
    v_subrev_co_u32 v19, s[70:71], 2.0, v19
    v_subrev_co_u32 v20, s[72:73], 2.0, v20
    v_subrev_co_u32 v21, s[74:75], 2.0, v21
    v_subrev_co_u32 v22, s[76:77], 2.0, v22
    v_subrev_co_u32 v23, s[78:79], 2.0, v23
    v_subrev_co_u32 v24, s[80:81], 2.0, v24
    v_subrev_co_u32 v25, s[82:83], 2.0, v25
    v_subrev_co_u32 v26, s[84:85], 2.0, v26
    v_subrev_co_u32 v27, s[86:87], 2.0, v27
    s_mov_b64 exec, s[64:65]
    ds_read_b64 v[52:53], v52
    s_mov_b64 exec, s[66:67]
    ds_read_b64 v[54:55], v54
    s_mov_b64 exec, s[68:69]
    ds_read_b64 v[56:57], v56
    s_mov_b64 exec, s[70:71]
    ds_read_b64 v[58:59], v58
    s_mov_b64 exec, s[72:73]
    ds_read_b64 v[60:61], v60
    s_mov_b64 exec, s[74:75]
    ds_read_b64 v[62:63], v62
    s_mov_b64 exec, s[76:77]
    ds_read_b64 v[64:65], v64
    s_mov_b64 exec, s[78:79]
    ds_read_b64 v[66:67], v66
    s_mov_b64 exec, s[80:81]
    ds_read_b64 v[68:69], v68
    s_mov_b64 exec, s[82:83]
    ds_read_b64 v[70:71], v70
    s_mov_b64 exec, s[84:85]
    ds_read_b64 v[72:73], v72
    s_mov_b64 exec, s[86:87]
    ds_read_b64 v[74:75], v74
    s_mov_b64 exec, -1
    s_waitcnt lgkmcnt(0)
    s_barrier
    s_waitcnt vmcnt(5)
    ds_write_b128 v3, v[76:79] offset:0
    s_waitcnt vmcnt(4)
    ds_write_b128 v3, v[80:83] offset:16384
    s_waitcnt vmcnt(3)
    ds_write_b128 v3, v[84:87] offset:32768
    v_lshlrev_b32 v123, 2, v0
    s_waitcnt vmcnt(2)
    s_mov_b64 exec, s[48:49]
    ds_write_b32 v123, v88 offset:49152
    s_mov_b64 exec, -1

    s_add_u32 s43, s43, 50000
    s_add_u32 s14, s43, 50000
    buffer_load_dwordx4 v[76:79], v3, s[12:15], s43 offen
    s_add_u32 s52, s43, 16384
    buffer_load_dwordx4 v[80:83], v3, s[12:15], s52 offen
    v_subrev_co_u32 v4, s[64:65], 2.0, v4
    v_subrev_co_u32 v5, s[66:67], 2.0, v5
    v_subrev_co_u32 v6, s[68:69], 2.0, v6
    v_subrev_co_u32 v7, s[70:71], 2.0, v7
    v_subrev_co_u32 v8, s[72:73], 2.0, v8
    v_subrev_co_u32 v9, s[74:75], 2.0, v9
    v_subrev_co_u32 v10, s[76:77], 2.0, v10
    v_subrev_co_u32 v11, s[78:79], 2.0, v11
    v_subrev_co_u32 v12, s[80:81], 2.0, v12
    v_subrev_co_u32 v13, s[82:83], 2.0, v13
    v_subrev_co_u32 v14, s[84:85], 2.0, v14
    v_subrev_co_u32 v15, s[86:87], 2.0, v15
    s_waitcnt lgkmcnt(0)
    s_barrier
    s_add_u32 s52, s43, 32768
    buffer_load_dwordx4 v[84:87], v3, s[12:15], s52 offen
    s_add_u32 s52, s43, 49152
    v_lshlrev_b32 v123, 2, v0
    buffer_load_dword v88, v123, s[12:15], s52 offen
    s_mov_b64 exec, s[64:65]
    ds_read_b64 v[28:29], v28
    s_mov_b64 exec, s[66:67]
    ds_read_b64 v[30:31], v30
    s_mov_b64 exec, s[68:69]
    ds_read_b64 v[32:33], v32
    s_mov_b64 exec, s[70:71]
    ds_read_b64 v[34:35], v34
    s_mov_b64 exec, s[72:73]
    ds_read_b64 v[36:37], v36
    s_mov_b64 exec, s[74:75]
    ds_read_b64 v[38:39], v38
    s_mov_b64 exec, s[76:77]
    ds_read_b64 v[40:41], v40
    s_mov_b64 exec, s[78:79]
    ds_read_b64 v[42:43], v42
    s_mov_b64 exec, s[80:81]
    ds_read_b64 v[44:45], v44
    s_mov_b64 exec, s[82:83]
    ds_read_b64 v[46:47], v46
    s_mov_b64 exec, s[84:85]
    ds_read_b64 v[48:49], v48
    s_mov_b64 exec, s[86:87]
    ds_read_b64 v[50:51], v50
    s_mov_b64 exec, -1
    s_movk_i32 s53, 10240
    buffer_load_dwordx4 v[98:101], v2, s[16:19], s53 offen
    buffer_load_dword v112, v2, s[16:19], s53 offen offset:16
    v_subrev_co_u32 v16, s[64:65], 2.0, v16
    v_subrev_co_u32 v17, s[66:67], 2.0, v17
    v_subrev_co_u32 v18, s[68:69], 2.0, v18
    v_subrev_co_u32 v19, s[70:71], 2.0, v19
    v_subrev_co_u32 v20, s[72:73], 2.0, v20
    v_subrev_co_u32 v21, s[74:75], 2.0, v21
    v_subrev_co_u32 v22, s[76:77], 2.0, v22
    v_subrev_co_u32 v23, s[78:79], 2.0, v23
    v_subrev_co_u32 v24, s[80:81], 2.0, v24
    v_subrev_co_u32 v25, s[82:83], 2.0, v25
    v_subrev_co_u32 v26, s[84:85], 2.0, v26
    v_subrev_co_u32 v27, s[86:87], 2.0, v27
    s_mov_b64 exec, s[64:65]
    ds_read_b64 v[52:53], v52
    s_mov_b64 exec, s[66:67]
    ds_read_b64 v[54:55], v54
    s_mov_b64 exec, s[68:69]
    ds_read_b64 v[56:57], v56
    s_mov_b64 exec, s[70:71]
    ds_read_b64 v[58:59], v58
    s_mov_b64 exec, s[72:73]
    ds_read_b64 v[60:61], v60
    s_mov_b64 exec, s[74:75]
    ds_read_b64 v[62:63], v62
    s_mov_b64 exec, s[76:77]
    ds_read_b64 v[64:65], v64
    s_mov_b64 exec, s[78:79]
    ds_read_b64 v[66:67], v66
    s_mov_b64 exec, s[80:81]
    ds_read_b64 v[68:69], v68
    s_mov_b64 exec, s[82:83]
    ds_read_b64 v[70:71], v70
    s_mov_b64 exec, s[84:85]
    ds_read_b64 v[72:73], v72
    s_mov_b64 exec, s[86:87]
    ds_read_b64 v[74:75], v74
    s_mov_b64 exec, -1
    s_waitcnt lgkmcnt(0)
    s_barrier
    s_waitcnt vmcnt(5)
    ds_write_b128 v3, v[76:79] offset:0
    s_waitcnt vmcnt(4)
    ds_write_b128 v3, v[80:83] offset:16384
    s_waitcnt vmcnt(3)
    ds_write_b128 v3, v[84:87] offset:32768
    v_lshlrev_b32 v123, 2, v0
    s_waitcnt vmcnt(2)
    s_mov_b64 exec, s[48:49]
    ds_write_b32 v123, v88 offset:49152
    s_mov_b64 exec, -1

    s_add_u32 s43, s43, 50000
    s_add_u32 s14, s43, 50000
    s_cmp_lt_u32 s5, s4
    s_cselect_b32 s14, s14, 0
    buffer_load_dwordx4 v[76:79], v3, s[12:15], s43 offen
    s_add_u32 s52, s43, 16384
    buffer_load_dwordx4 v[80:83], v3, s[12:15], s52 offen
    v_cmp_gt_u32 s[64:65], 2.0, v4
    v_and_b32 v4, 0x3fffffff, v4
    v_cmp_gt_u32 s[66:67], 2.0, v5
    v_and_b32 v5, 0x3fffffff, v5
    v_cmp_gt_u32 s[68:69], 2.0, v6
    v_and_b32 v6, 0x3fffffff, v6
    v_cmp_gt_u32 s[70:71], 2.0, v7
    v_and_b32 v7, 0x3fffffff, v7
    v_cmp_gt_u32 s[72:73], 2.0, v8
    v_and_b32 v8, 0x3fffffff, v8
    v_cmp_gt_u32 s[74:75], 2.0, v9
    v_and_b32 v9, 0x3fffffff, v9
    v_cmp_gt_u32 s[76:77], 2.0, v10
    v_and_b32 v10, 0x3fffffff, v10
    v_cmp_gt_u32 s[78:79], 2.0, v11
    v_and_b32 v11, 0x3fffffff, v11
    v_cmp_gt_u32 s[80:81], 2.0, v12
    v_and_b32 v12, 0x3fffffff, v12
    v_cmp_gt_u32 s[82:83], 2.0, v13
    v_and_b32 v13, 0x3fffffff, v13
    v_cmp_gt_u32 s[84:85], 2.0, v14
    v_and_b32 v14, 0x3fffffff, v14
    v_cmp_gt_u32 s[86:87], 2.0, v15
    v_and_b32 v15, 0x3fffffff, v15
    s_waitcnt lgkmcnt(0)
    s_barrier
    s_add_u32 s52, s43, 32768
    buffer_load_dwordx4 v[84:87], v3, s[12:15], s52 offen
    s_add_u32 s52, s43, 49152
    v_lshlrev_b32 v123, 2, v0
    buffer_load_dword v88, v123, s[12:15], s52 offen
    s_mov_b64 exec, s[64:65]
    ds_read_b64 v[28:29], v28
    s_mov_b64 exec, s[66:67]
    ds_read_b64 v[30:31], v30
    s_mov_b64 exec, s[68:69]
    ds_read_b64 v[32:33], v32
    s_mov_b64 exec, s[70:71]
    ds_read_b64 v[34:35], v34
    s_mov_b64 exec, s[72:73]
    ds_read_b64 v[36:37], v36
    s_mov_b64 exec, s[74:75]
    ds_read_b64 v[38:39], v38
    s_mov_b64 exec, s[76:77]
    ds_read_b64 v[40:41], v40
    s_mov_b64 exec, s[78:79]
    ds_read_b64 v[42:43], v42
    s_mov_b64 exec, s[80:81]
    ds_read_b64 v[44:45], v44
    s_mov_b64 exec, s[82:83]
    ds_read_b64 v[46:47], v46
    s_mov_b64 exec, s[84:85]
    ds_read_b64 v[48:49], v48
    s_mov_b64 exec, s[86:87]
    ds_read_b64 v[50:51], v50
    s_mov_b64 exec, -1
    s_movk_i32 s53, 12800
    buffer_load_dwordx4 v[102:105], v2, s[16:19], s53 offen
    buffer_load_dword v113, v2, s[16:19], s53 offen offset:16
    v_cmp_gt_u32 s[64:65], 2.0, v16
    v_and_b32 v16, 0x3fffffff, v16
    v_cmp_gt_u32 s[66:67], 2.0, v17
    v_and_b32 v17, 0x3fffffff, v17
    v_cmp_gt_u32 s[68:69], 2.0, v18
    v_and_b32 v18, 0x3fffffff, v18
    v_cmp_gt_u32 s[70:71], 2.0, v19
    v_and_b32 v19, 0x3fffffff, v19
    v_cmp_gt_u32 s[72:73], 2.0, v20
    v_and_b32 v20, 0x3fffffff, v20
    v_cmp_gt_u32 s[74:75], 2.0, v21
    v_and_b32 v21, 0x3fffffff, v21
    v_cmp_gt_u32 s[76:77], 2.0, v22
    v_and_b32 v22, 0x3fffffff, v22
    v_cmp_gt_u32 s[78:79], 2.0, v23
    v_and_b32 v23, 0x3fffffff, v23
    v_cmp_gt_u32 s[80:81], 2.0, v24
    v_and_b32 v24, 0x3fffffff, v24
    v_cmp_gt_u32 s[82:83], 2.0, v25
    v_and_b32 v25, 0x3fffffff, v25
    v_cmp_gt_u32 s[84:85], 2.0, v26
    v_and_b32 v26, 0x3fffffff, v26
    v_cmp_gt_u32 s[86:87], 2.0, v27
    v_and_b32 v27, 0x3fffffff, v27
    s_mov_b64 exec, s[64:65]
    ds_read_b64 v[52:53], v52
    s_mov_b64 exec, s[66:67]
    ds_read_b64 v[54:55], v54
    s_mov_b64 exec, s[68:69]
    ds_read_b64 v[56:57], v56
    s_mov_b64 exec, s[70:71]
    ds_read_b64 v[58:59], v58
    s_mov_b64 exec, s[72:73]
    ds_read_b64 v[60:61], v60
    s_mov_b64 exec, s[74:75]
    ds_read_b64 v[62:63], v62
    s_mov_b64 exec, s[76:77]
    ds_read_b64 v[64:65], v64
    s_mov_b64 exec, s[78:79]
    ds_read_b64 v[66:67], v66
    s_mov_b64 exec, s[80:81]
    ds_read_b64 v[68:69], v68
    s_mov_b64 exec, s[82:83]
    ds_read_b64 v[70:71], v70
    s_mov_b64 exec, s[84:85]
    ds_read_b64 v[72:73], v72
    s_mov_b64 exec, s[86:87]
    ds_read_b64 v[74:75], v74
    s_mov_b64 exec, -1
    s_waitcnt lgkmcnt(0)
    s_barrier
    s_waitcnt vmcnt(5)
    ds_write_b128 v3, v[76:79] offset:0
    s_waitcnt vmcnt(4)
    ds_write_b128 v3, v[80:83] offset:16384
    s_waitcnt vmcnt(3)
    ds_write_b128 v3, v[84:87] offset:32768
    v_lshlrev_b32 v123, 2, v0
    s_waitcnt vmcnt(2)
    s_mov_b64 exec, s[48:49]
    ds_write_b32 v123, v88 offset:49152
    s_mov_b64 exec, -1

    s_add_u32 s43, s43, 50000
    s_add_u32 s14, s43, 50000
    s_cmp_lt_u32 s5, s4
    s_cselect_b32 s14, s14, 0
    buffer_load_dwordx4 v[76:79], v3, s[12:15], s43 offen
    s_add_u32 s52, s43, 16384
    buffer_load_dwordx4 v[80:83], v3, s[12:15], s52 offen
    s_add_u32 s52, s43, 32768
    buffer_load_dwordx4 v[84:87], v3, s[12:15], s52 offen
    s_add_u32 s52, s43, 49152
    v_lshlrev_b32 v123, 2, v0
    buffer_load_dword v88, v123, s[12:15], s52 offen
    s_add_u32 s54, s43, 50000
    buffer_load_dword v115, v89, s[8:11], s54 offen
    v_cvt_f32_i32_sdwa v118, sext(v4) dst_sel:DWORD dst_unused:UNUSED_PAD src0_sel:WORD_0
    v_lshlrev_b32 v116, 16, v28
    v_and_b32 v117, s32, v28
    v_mul_f32 v118, s33, v118
    v_lshlrev_b32 v28, 16, v29
    v_and_b32 v29, s32, v29
    v_lshlrev_b32_sdwa v4, 3, v4 dst_sel:DWORD dst_unused:UNUSED_PAD src0_sel:DWORD src1_sel:WORD_1
    v_pk_fma_f32 v[116:117], v[116:117], v[118:119], s[28:29] op_sel_hi:[1,0,1]
    v_pk_fma_f32 v[28:29], v[28:29], v[118:119], s[28:29] op_sel_hi:[1,0,1]
    v_perm_b32 v116, v117, v116, s35
    v_perm_b32 v117, v29, v28, s35
    v_lshl_add_u64 v[116:117], v[116:117], 0, s[30:31]
    ds_add_rtn_u64 v[28:29], v4, v[116:117] offset:50000

    v_cvt_f32_i32_sdwa v122, sext(v5) dst_sel:DWORD dst_unused:UNUSED_PAD src0_sel:WORD_0
    v_lshlrev_b32 v120, 16, v30
    v_and_b32 v121, s32, v30
    v_mul_f32 v122, s33, v122
    v_lshlrev_b32 v30, 16, v31
    v_and_b32 v31, s32, v31
    v_lshlrev_b32_sdwa v5, 3, v5 dst_sel:DWORD dst_unused:UNUSED_PAD src0_sel:DWORD src1_sel:WORD_1
    v_pk_fma_f32 v[120:121], v[120:121], v[122:123], s[28:29] op_sel_hi:[1,0,1]
    v_pk_fma_f32 v[30:31], v[30:31], v[122:123], s[28:29] op_sel_hi:[1,0,1]
    v_perm_b32 v120, v121, v120, s35
    v_perm_b32 v121, v31, v30, s35
    v_lshl_add_u64 v[120:121], v[120:121], 0, s[30:31]
    ds_add_rtn_u64 v[30:31], v5, v[120:121] offset:50000

    v_cvt_f32_i32_sdwa v118, sext(v6) dst_sel:DWORD dst_unused:UNUSED_PAD src0_sel:WORD_0
    v_lshlrev_b32 v116, 16, v32
    v_and_b32 v117, s32, v32
    v_mul_f32 v118, s33, v118
    v_lshlrev_b32 v32, 16, v33
    v_and_b32 v33, s32, v33
    v_lshlrev_b32_sdwa v6, 3, v6 dst_sel:DWORD dst_unused:UNUSED_PAD src0_sel:DWORD src1_sel:WORD_1
    v_pk_fma_f32 v[116:117], v[116:117], v[118:119], s[28:29] op_sel_hi:[1,0,1]
    v_pk_fma_f32 v[32:33], v[32:33], v[118:119], s[28:29] op_sel_hi:[1,0,1]
    v_perm_b32 v116, v117, v116, s35
    v_perm_b32 v117, v33, v32, s35
    v_lshl_add_u64 v[116:117], v[116:117], 0, s[30:31]
    ds_add_rtn_u64 v[32:33], v6, v[116:117] offset:50000

    v_cvt_f32_i32_sdwa v122, sext(v7) dst_sel:DWORD dst_unused:UNUSED_PAD src0_sel:WORD_0
    v_lshlrev_b32 v120, 16, v34
    v_and_b32 v121, s32, v34
    v_mul_f32 v122, s33, v122
    v_lshlrev_b32 v34, 16, v35
    v_and_b32 v35, s32, v35
    v_lshlrev_b32_sdwa v7, 3, v7 dst_sel:DWORD dst_unused:UNUSED_PAD src0_sel:DWORD src1_sel:WORD_1
    v_pk_fma_f32 v[120:121], v[120:121], v[122:123], s[28:29] op_sel_hi:[1,0,1]
    v_pk_fma_f32 v[34:35], v[34:35], v[122:123], s[28:29] op_sel_hi:[1,0,1]
    v_perm_b32 v120, v121, v120, s35
    v_perm_b32 v121, v35, v34, s35
    v_lshl_add_u64 v[120:121], v[120:121], 0, s[30:31]
    ds_add_rtn_u64 v[34:35], v7, v[120:121] offset:50000

    v_cvt_f32_i32_sdwa v118, sext(v8) dst_sel:DWORD dst_unused:UNUSED_PAD src0_sel:WORD_0
    v_lshlrev_b32 v116, 16, v36
    v_and_b32 v117, s32, v36
    v_mul_f32 v118, s33, v118
    v_lshlrev_b32 v36, 16, v37
    v_and_b32 v37, s32, v37
    v_lshlrev_b32_sdwa v8, 3, v8 dst_sel:DWORD dst_unused:UNUSED_PAD src0_sel:DWORD src1_sel:WORD_1
    v_pk_fma_f32 v[116:117], v[116:117], v[118:119], s[28:29] op_sel_hi:[1,0,1]
    v_pk_fma_f32 v[36:37], v[36:37], v[118:119], s[28:29] op_sel_hi:[1,0,1]
    v_perm_b32 v116, v117, v116, s35
    v_perm_b32 v117, v37, v36, s35
    v_lshl_add_u64 v[116:117], v[116:117], 0, s[30:31]
    ds_add_rtn_u64 v[36:37], v8, v[116:117] offset:50000

    v_cvt_f32_i32_sdwa v122, sext(v9) dst_sel:DWORD dst_unused:UNUSED_PAD src0_sel:WORD_0
    v_lshlrev_b32 v120, 16, v38
    v_and_b32 v121, s32, v38
    v_mul_f32 v122, s33, v122
    v_lshlrev_b32 v38, 16, v39
    v_and_b32 v39, s32, v39
    v_lshlrev_b32_sdwa v9, 3, v9 dst_sel:DWORD dst_unused:UNUSED_PAD src0_sel:DWORD src1_sel:WORD_1
    v_pk_fma_f32 v[120:121], v[120:121], v[122:123], s[28:29] op_sel_hi:[1,0,1]
    v_pk_fma_f32 v[38:39], v[38:39], v[122:123], s[28:29] op_sel_hi:[1,0,1]
    v_perm_b32 v120, v121, v120, s35
    v_perm_b32 v121, v39, v38, s35
    v_lshl_add_u64 v[120:121], v[120:121], 0, s[30:31]
    ds_add_rtn_u64 v[38:39], v9, v[120:121] offset:50000

    v_cvt_f32_i32_sdwa v118, sext(v10) dst_sel:DWORD dst_unused:UNUSED_PAD src0_sel:WORD_0
    v_lshlrev_b32 v116, 16, v40
    v_and_b32 v117, s32, v40
    v_mul_f32 v118, s33, v118
    v_lshlrev_b32 v40, 16, v41
    v_and_b32 v41, s32, v41
    v_lshlrev_b32_sdwa v10, 3, v10 dst_sel:DWORD dst_unused:UNUSED_PAD src0_sel:DWORD src1_sel:WORD_1
    v_pk_fma_f32 v[116:117], v[116:117], v[118:119], s[28:29] op_sel_hi:[1,0,1]
    v_pk_fma_f32 v[40:41], v[40:41], v[118:119], s[28:29] op_sel_hi:[1,0,1]
    v_perm_b32 v116, v117, v116, s35
    v_perm_b32 v117, v41, v40, s35
    v_lshl_add_u64 v[116:117], v[116:117], 0, s[30:31]
    ds_add_rtn_u64 v[40:41], v10, v[116:117] offset:50000

    v_cvt_f32_i32_sdwa v122, sext(v11) dst_sel:DWORD dst_unused:UNUSED_PAD src0_sel:WORD_0
    v_lshlrev_b32 v120, 16, v42
    v_and_b32 v121, s32, v42
    v_mul_f32 v122, s33, v122
    v_lshlrev_b32 v42, 16, v43
    v_and_b32 v43, s32, v43
    v_lshlrev_b32_sdwa v11, 3, v11 dst_sel:DWORD dst_unused:UNUSED_PAD src0_sel:DWORD src1_sel:WORD_1
    v_pk_fma_f32 v[120:121], v[120:121], v[122:123], s[28:29] op_sel_hi:[1,0,1]
    v_pk_fma_f32 v[42:43], v[42:43], v[122:123], s[28:29] op_sel_hi:[1,0,1]
    v_perm_b32 v120, v121, v120, s35
    v_perm_b32 v121, v43, v42, s35
    v_lshl_add_u64 v[120:121], v[120:121], 0, s[30:31]
    ds_add_rtn_u64 v[42:43], v11, v[120:121] offset:50000

    s_waitcnt lgkmcnt(4)
    v_or3_b32 v1, v28, v29, v1
    v_or3_b32 v1, v30, v31, v1
    v_or3_b32 v1, v32, v33, v1
    v_or3_b32 v1, v34, v35, v1
    s_movk_i32 s53, 0
    buffer_load_dwordx4 v[4:7], v2, s[16:19], s53 offen
    buffer_load_dword v35, v2, s[16:19], s53 offen offset:16
    v_cvt_f32_i32_sdwa v118, sext(v12) dst_sel:DWORD dst_unused:UNUSED_PAD src0_sel:WORD_0
    v_lshlrev_b32 v116, 16, v44
    v_and_b32 v117, s32, v44
    v_mul_f32 v118, s33, v118
    v_lshlrev_b32 v44, 16, v45
    v_and_b32 v45, s32, v45
    v_lshlrev_b32_sdwa v12, 3, v12 dst_sel:DWORD dst_unused:UNUSED_PAD src0_sel:DWORD src1_sel:WORD_1
    v_pk_fma_f32 v[116:117], v[116:117], v[118:119], s[28:29] op_sel_hi:[1,0,1]
    v_pk_fma_f32 v[44:45], v[44:45], v[118:119], s[28:29] op_sel_hi:[1,0,1]
    v_perm_b32 v116, v117, v116, s35
    v_perm_b32 v117, v45, v44, s35
    v_lshl_add_u64 v[116:117], v[116:117], 0, s[30:31]
    ds_add_rtn_u64 v[44:45], v12, v[116:117] offset:50000

    v_cvt_f32_i32_sdwa v122, sext(v13) dst_sel:DWORD dst_unused:UNUSED_PAD src0_sel:WORD_0
    v_lshlrev_b32 v120, 16, v46
    v_and_b32 v121, s32, v46
    v_mul_f32 v122, s33, v122
    v_lshlrev_b32 v46, 16, v47
    v_and_b32 v47, s32, v47
    v_lshlrev_b32_sdwa v13, 3, v13 dst_sel:DWORD dst_unused:UNUSED_PAD src0_sel:DWORD src1_sel:WORD_1
    v_pk_fma_f32 v[120:121], v[120:121], v[122:123], s[28:29] op_sel_hi:[1,0,1]
    v_pk_fma_f32 v[46:47], v[46:47], v[122:123], s[28:29] op_sel_hi:[1,0,1]
    v_perm_b32 v120, v121, v120, s35
    v_perm_b32 v121, v47, v46, s35
    v_lshl_add_u64 v[120:121], v[120:121], 0, s[30:31]
    ds_add_rtn_u64 v[46:47], v13, v[120:121] offset:50000

    v_cvt_f32_i32_sdwa v118, sext(v14) dst_sel:DWORD dst_unused:UNUSED_PAD src0_sel:WORD_0
    v_lshlrev_b32 v116, 16, v48
    v_and_b32 v117, s32, v48
    v_mul_f32 v118, s33, v118
    v_lshlrev_b32 v48, 16, v49
    v_and_b32 v49, s32, v49
    v_lshlrev_b32_sdwa v14, 3, v14 dst_sel:DWORD dst_unused:UNUSED_PAD src0_sel:DWORD src1_sel:WORD_1
    v_pk_fma_f32 v[116:117], v[116:117], v[118:119], s[28:29] op_sel_hi:[1,0,1]
    v_pk_fma_f32 v[48:49], v[48:49], v[118:119], s[28:29] op_sel_hi:[1,0,1]
    v_perm_b32 v116, v117, v116, s35
    v_perm_b32 v117, v49, v48, s35
    v_lshl_add_u64 v[116:117], v[116:117], 0, s[30:31]
    ds_add_rtn_u64 v[48:49], v14, v[116:117] offset:50000

    v_cvt_f32_i32_sdwa v122, sext(v15) dst_sel:DWORD dst_unused:UNUSED_PAD src0_sel:WORD_0
    v_lshlrev_b32 v120, 16, v50
    v_and_b32 v121, s32, v50
    v_mul_f32 v122, s33, v122
    v_lshlrev_b32 v50, 16, v51
    v_and_b32 v51, s32, v51
    v_lshlrev_b32_sdwa v15, 3, v15 dst_sel:DWORD dst_unused:UNUSED_PAD src0_sel:DWORD src1_sel:WORD_1
    v_pk_fma_f32 v[120:121], v[120:121], v[122:123], s[28:29] op_sel_hi:[1,0,1]
    v_pk_fma_f32 v[50:51], v[50:51], v[122:123], s[28:29] op_sel_hi:[1,0,1]
    v_perm_b32 v120, v121, v120, s35
    v_perm_b32 v121, v51, v50, s35
    v_lshl_add_u64 v[120:121], v[120:121], 0, s[30:31]
    ds_add_rtn_u64 v[50:51], v15, v[120:121] offset:50000

    s_waitcnt lgkmcnt(4)
    v_or3_b32 v1, v36, v37, v1
    v_or3_b32 v1, v38, v39, v1
    v_or3_b32 v1, v40, v41, v1
    v_or3_b32 v1, v42, v43, v1
    s_movk_i32 s53, 2560
    buffer_load_dwordx4 v[8:11], v2, s[16:19], s53 offen
    buffer_load_dword v43, v2, s[16:19], s53 offen offset:16
    v_cvt_f32_i32_sdwa v118, sext(v16) dst_sel:DWORD dst_unused:UNUSED_PAD src0_sel:WORD_0
    v_lshlrev_b32 v116, 16, v52
    v_and_b32 v117, s32, v52
    v_mul_f32 v118, s33, v118
    v_lshlrev_b32 v52, 16, v53
    v_and_b32 v53, s32, v53
    v_lshlrev_b32_sdwa v16, 3, v16 dst_sel:DWORD dst_unused:UNUSED_PAD src0_sel:DWORD src1_sel:WORD_1
    v_pk_fma_f32 v[116:117], v[116:117], v[118:119], s[28:29] op_sel_hi:[1,0,1]
    v_pk_fma_f32 v[52:53], v[52:53], v[118:119], s[28:29] op_sel_hi:[1,0,1]
    v_perm_b32 v116, v117, v116, s35
    v_perm_b32 v117, v53, v52, s35
    v_lshl_add_u64 v[116:117], v[116:117], 0, s[30:31]
    ds_add_rtn_u64 v[52:53], v16, v[116:117] offset:50000

    v_cvt_f32_i32_sdwa v122, sext(v17) dst_sel:DWORD dst_unused:UNUSED_PAD src0_sel:WORD_0
    v_lshlrev_b32 v120, 16, v54
    v_and_b32 v121, s32, v54
    v_mul_f32 v122, s33, v122
    v_lshlrev_b32 v54, 16, v55
    v_and_b32 v55, s32, v55
    v_lshlrev_b32_sdwa v17, 3, v17 dst_sel:DWORD dst_unused:UNUSED_PAD src0_sel:DWORD src1_sel:WORD_1
    v_pk_fma_f32 v[120:121], v[120:121], v[122:123], s[28:29] op_sel_hi:[1,0,1]
    v_pk_fma_f32 v[54:55], v[54:55], v[122:123], s[28:29] op_sel_hi:[1,0,1]
    v_perm_b32 v120, v121, v120, s35
    v_perm_b32 v121, v55, v54, s35
    v_lshl_add_u64 v[120:121], v[120:121], 0, s[30:31]
    ds_add_rtn_u64 v[54:55], v17, v[120:121] offset:50000

    v_cvt_f32_i32_sdwa v118, sext(v18) dst_sel:DWORD dst_unused:UNUSED_PAD src0_sel:WORD_0
    v_lshlrev_b32 v116, 16, v56
    v_and_b32 v117, s32, v56
    v_mul_f32 v118, s33, v118
    v_lshlrev_b32 v56, 16, v57
    v_and_b32 v57, s32, v57
    v_lshlrev_b32_sdwa v18, 3, v18 dst_sel:DWORD dst_unused:UNUSED_PAD src0_sel:DWORD src1_sel:WORD_1
    v_pk_fma_f32 v[116:117], v[116:117], v[118:119], s[28:29] op_sel_hi:[1,0,1]
    v_pk_fma_f32 v[56:57], v[56:57], v[118:119], s[28:29] op_sel_hi:[1,0,1]
    v_perm_b32 v116, v117, v116, s35
    v_perm_b32 v117, v57, v56, s35
    v_lshl_add_u64 v[116:117], v[116:117], 0, s[30:31]
    ds_add_rtn_u64 v[56:57], v18, v[116:117] offset:50000

    v_cvt_f32_i32_sdwa v122, sext(v19) dst_sel:DWORD dst_unused:UNUSED_PAD src0_sel:WORD_0
    v_lshlrev_b32 v120, 16, v58
    v_and_b32 v121, s32, v58
    v_mul_f32 v122, s33, v122
    v_lshlrev_b32 v58, 16, v59
    v_and_b32 v59, s32, v59
    v_lshlrev_b32_sdwa v19, 3, v19 dst_sel:DWORD dst_unused:UNUSED_PAD src0_sel:DWORD src1_sel:WORD_1
    v_pk_fma_f32 v[120:121], v[120:121], v[122:123], s[28:29] op_sel_hi:[1,0,1]
    v_pk_fma_f32 v[58:59], v[58:59], v[122:123], s[28:29] op_sel_hi:[1,0,1]
    v_perm_b32 v120, v121, v120, s35
    v_perm_b32 v121, v59, v58, s35
    v_lshl_add_u64 v[120:121], v[120:121], 0, s[30:31]
    ds_add_rtn_u64 v[58:59], v19, v[120:121] offset:50000

    s_waitcnt lgkmcnt(4)
    v_or3_b32 v1, v44, v45, v1
    v_or3_b32 v1, v46, v47, v1
    v_or3_b32 v1, v48, v49, v1
    v_or3_b32 v1, v50, v51, v1
    s_cmp_le_i32 s42, 3072
    s_cbranch_scc1 L_nt1_38
    s_waitcnt vmcnt(29)
    v_perm_b32 v116, v107, v106, s24
    v_perm_b32 v118, v108, v107, s25
    v_perm_b32 v120, v109, v108, s26
    v_perm_b32 v122, v114, v109, s27
    v_alignbyte_b32 v107, v108, v107, 1
    v_alignbyte_b32 v108, v109, v108, 2
    v_alignbyte_b32 v109, v114, v109, 3
    v_lshlrev_b32_sdwa v116, 3, v116 dst_sel:WORD_0 dst_unused:UNUSED_PAD src0_sel:DWORD src1_sel:DWORD
    v_lshlrev_b32_sdwa v118, 3, v118 dst_sel:WORD_0 dst_unused:UNUSED_PAD src0_sel:DWORD src1_sel:DWORD
    v_lshlrev_b32_sdwa v120, 3, v120 dst_sel:WORD_0 dst_unused:UNUSED_PAD src0_sel:DWORD src1_sel:DWORD
    v_lshlrev_b32_sdwa v122, 3, v122 dst_sel:WORD_0 dst_unused:UNUSED_PAD src0_sel:DWORD src1_sel:DWORD
    s_cmp_lt_i32 s42, 3328
    s_cbranch_scc1 L_ufix_40
L_uback_41:

    v_lshrrev_b32 v117, 30, v106
    v_cmp_ne_u32 vcc, 0, v106
    v_mul_u32_u24 v117, 50000, v117
    v_and_b32 v106, 0x3fffffff, v106
    v_add_u32 v116, v116, v117
    s_mov_b64 s[64:65], vcc
    s_mov_b64 exec, vcc

    buffer_load_dwordx2 v[44:45], v116, s[8:11], s50 offen
    s_mov_b64 exec, -1
    v_lshrrev_b32 v117, 30, v107
    v_cmp_ne_u32 vcc, 0, v107
    v_mul_u32_u24 v117, 50000, v117
    v_and_b32 v107, 0x3fffffff, v107
    v_add_u32 v118, v118, v117
    s_mov_b64 s[66:67], vcc
    s_mov_b64 exec, vcc

    buffer_load_dwordx2 v[46:47], v118, s[8:11], s50 offen
    s_mov_b64 exec, -1
    v_lshrrev_b32 v117, 30, v108
    v_cmp_ne_u32 vcc, 0, v108
    v_mul_u32_u24 v117, 50000, v117
    v_and_b32 v108, 0x3fffffff, v108
    v_add_u32 v120, v120, v117
    s_mov_b64 s[68:69], vcc
    s_mov_b64 exec, vcc

    buffer_load_dwordx2 v[48:49], v120, s[8:11], s50 offen
    s_mov_b64 exec, -1
    v_lshrrev_b32 v117, 30, v109
    v_cmp_ne_u32 vcc, 0, v109
    v_mul_u32_u24 v117, 50000, v117
    v_and_b32 v109, 0x3fffffff, v109
    v_add_u32 v122, v122, v117
    s_mov_b64 s[70:71], vcc
    s_mov_b64 exec, vcc

    buffer_load_dwordx2 v[50:51], v122, s[8:11], s50 offen
    s_mov_b64 exec, -1
L_nt1_38:
    v_cvt_f32_i32_sdwa v118, sext(v20) dst_sel:DWORD dst_unused:UNUSED_PAD src0_sel:WORD_0
    v_lshlrev_b32 v116, 16, v60
    v_and_b32 v117, s32, v60
    v_mul_f32 v118, s33, v118
    v_lshlrev_b32 v60, 16, v61
    v_and_b32 v61, s32, v61
    v_lshlrev_b32_sdwa v20, 3, v20 dst_sel:DWORD dst_unused:UNUSED_PAD src0_sel:DWORD src1_sel:WORD_1
    v_pk_fma_f32 v[116:117], v[116:117], v[118:119], s[28:29] op_sel_hi:[1,0,1]
    v_pk_fma_f32 v[60:61], v[60:61], v[118:119], s[28:29] op_sel_hi:[1,0,1]
    v_perm_b32 v116, v117, v116, s35
    v_perm_b32 v117, v61, v60, s35
    v_lshl_add_u64 v[116:117], v[116:117], 0, s[30:31]
    ds_add_rtn_u64 v[60:61], v20, v[116:117] offset:50000

    v_cvt_f32_i32_sdwa v122, sext(v21) dst_sel:DWORD dst_unused:UNUSED_PAD src0_sel:WORD_0
    v_lshlrev_b32 v120, 16, v62
    v_and_b32 v121, s32, v62
    v_mul_f32 v122, s33, v122
    v_lshlrev_b32 v62, 16, v63
    v_and_b32 v63, s32, v63
    v_lshlrev_b32_sdwa v21, 3, v21 dst_sel:DWORD dst_unused:UNUSED_PAD src0_sel:DWORD src1_sel:WORD_1
    v_pk_fma_f32 v[120:121], v[120:121], v[122:123], s[28:29] op_sel_hi:[1,0,1]
    v_pk_fma_f32 v[62:63], v[62:63], v[122:123], s[28:29] op_sel_hi:[1,0,1]
    v_perm_b32 v120, v121, v120, s35
    v_perm_b32 v121, v63, v62, s35
    v_lshl_add_u64 v[120:121], v[120:121], 0, s[30:31]
    ds_add_rtn_u64 v[62:63], v21, v[120:121] offset:50000

    v_cvt_f32_i32_sdwa v118, sext(v22) dst_sel:DWORD dst_unused:UNUSED_PAD src0_sel:WORD_0
    v_lshlrev_b32 v116, 16, v64
    v_and_b32 v117, s32, v64
    v_mul_f32 v118, s33, v118
    v_lshlrev_b32 v64, 16, v65
    v_and_b32 v65, s32, v65
    v_lshlrev_b32_sdwa v22, 3, v22 dst_sel:DWORD dst_unused:UNUSED_PAD src0_sel:DWORD src1_sel:WORD_1
    v_pk_fma_f32 v[116:117], v[116:117], v[118:119], s[28:29] op_sel_hi:[1,0,1]
    v_pk_fma_f32 v[64:65], v[64:65], v[118:119], s[28:29] op_sel_hi:[1,0,1]
    v_perm_b32 v116, v117, v116, s35
    v_perm_b32 v117, v65, v64, s35
    v_lshl_add_u64 v[116:117], v[116:117], 0, s[30:31]
    ds_add_rtn_u64 v[64:65], v22, v[116:117] offset:50000

    v_cvt_f32_i32_sdwa v122, sext(v23) dst_sel:DWORD dst_unused:UNUSED_PAD src0_sel:WORD_0
    v_lshlrev_b32 v120, 16, v66
    v_and_b32 v121, s32, v66
    v_mul_f32 v122, s33, v122
    v_lshlrev_b32 v66, 16, v67
    v_and_b32 v67, s32, v67
    v_lshlrev_b32_sdwa v23, 3, v23 dst_sel:DWORD dst_unused:UNUSED_PAD src0_sel:DWORD src1_sel:WORD_1
    v_pk_fma_f32 v[120:121], v[120:121], v[122:123], s[28:29] op_sel_hi:[1,0,1]
    v_pk_fma_f32 v[66:67], v[66:67], v[122:123], s[28:29] op_sel_hi:[1,0,1]
    v_perm_b32 v120, v121, v120, s35
    v_perm_b32 v121, v67, v66, s35
    v_lshl_add_u64 v[120:121], v[120:121], 0, s[30:31]
    ds_add_rtn_u64 v[66:67], v23, v[120:121] offset:50000

    s_waitcnt lgkmcnt(4)
    v_or3_b32 v1, v52, v53, v1
    v_or3_b32 v1, v54, v55, v1
    v_or3_b32 v1, v56, v57, v1
    v_or3_b32 v1, v58, v59, v1
    v_cvt_f32_i32_sdwa v118, sext(v24) dst_sel:DWORD dst_unused:UNUSED_PAD src0_sel:WORD_0
    v_lshlrev_b32 v116, 16, v68
    v_and_b32 v117, s32, v68
    v_mul_f32 v118, s33, v118
    v_lshlrev_b32 v68, 16, v69
    v_and_b32 v69, s32, v69
    v_lshlrev_b32_sdwa v24, 3, v24 dst_sel:DWORD dst_unused:UNUSED_PAD src0_sel:DWORD src1_sel:WORD_1
    v_pk_fma_f32 v[116:117], v[116:117], v[118:119], s[28:29] op_sel_hi:[1,0,1]
    v_pk_fma_f32 v[68:69], v[68:69], v[118:119], s[28:29] op_sel_hi:[1,0,1]
    v_perm_b32 v116, v117, v116, s35
    v_perm_b32 v117, v69, v68, s35
    v_lshl_add_u64 v[116:117], v[116:117], 0, s[30:31]
    ds_add_rtn_u64 v[68:69], v24, v[116:117] offset:50000

    v_cvt_f32_i32_sdwa v122, sext(v25) dst_sel:DWORD dst_unused:UNUSED_PAD src0_sel:WORD_0
    v_lshlrev_b32 v120, 16, v70
    v_and_b32 v121, s32, v70
    v_mul_f32 v122, s33, v122
    v_lshlrev_b32 v70, 16, v71
    v_and_b32 v71, s32, v71
    v_lshlrev_b32_sdwa v25, 3, v25 dst_sel:DWORD dst_unused:UNUSED_PAD src0_sel:DWORD src1_sel:WORD_1
    v_pk_fma_f32 v[120:121], v[120:121], v[122:123], s[28:29] op_sel_hi:[1,0,1]
    v_pk_fma_f32 v[70:71], v[70:71], v[122:123], s[28:29] op_sel_hi:[1,0,1]
    v_perm_b32 v120, v121, v120, s35
    v_perm_b32 v121, v71, v70, s35
    v_lshl_add_u64 v[120:121], v[120:121], 0, s[30:31]
    ds_add_rtn_u64 v[70:71], v25, v[120:121] offset:50000

    v_cvt_f32_i32_sdwa v118, sext(v26) dst_sel:DWORD dst_unused:UNUSED_PAD src0_sel:WORD_0
    v_lshlrev_b32 v116, 16, v72
    v_and_b32 v117, s32, v72
    v_mul_f32 v118, s33, v118
    v_lshlrev_b32 v72, 16, v73
    v_and_b32 v73, s32, v73
    v_lshlrev_b32_sdwa v26, 3, v26 dst_sel:DWORD dst_unused:UNUSED_PAD src0_sel:DWORD src1_sel:WORD_1
    v_pk_fma_f32 v[116:117], v[116:117], v[118:119], s[28:29] op_sel_hi:[1,0,1]
    v_pk_fma_f32 v[72:73], v[72:73], v[118:119], s[28:29] op_sel_hi:[1,0,1]
    v_perm_b32 v116, v117, v116, s35
    v_perm_b32 v117, v73, v72, s35
    v_lshl_add_u64 v[116:117], v[116:117], 0, s[30:31]
    ds_add_rtn_u64 v[72:73], v26, v[116:117] offset:50000

    v_cvt_f32_i32_sdwa v122, sext(v27) dst_sel:DWORD dst_unused:UNUSED_PAD src0_sel:WORD_0
    v_lshlrev_b32 v120, 16, v74
    v_and_b32 v121, s32, v74
    v_mul_f32 v122, s33, v122
    v_lshlrev_b32 v74, 16, v75
    v_and_b32 v75, s32, v75
    v_lshlrev_b32_sdwa v27, 3, v27 dst_sel:DWORD dst_unused:UNUSED_PAD src0_sel:DWORD src1_sel:WORD_1
    v_pk_fma_f32 v[120:121], v[120:121], v[122:123], s[28:29] op_sel_hi:[1,0,1]
    v_pk_fma_f32 v[74:75], v[74:75], v[122:123], s[28:29] op_sel_hi:[1,0,1]
    v_perm_b32 v120, v121, v120, s35
    v_perm_b32 v121, v75, v74, s35
    v_lshl_add_u64 v[120:121], v[120:121], 0, s[30:31]
    ds_add_rtn_u64 v[74:75], v27, v[120:121] offset:50000

    s_waitcnt lgkmcnt(4)
    v_or3_b32 v1, v60, v61, v1
    v_or3_b32 v1, v62, v63, v1
    v_or3_b32 v1, v64, v65, v1
    v_or3_b32 v1, v66, v67, v1
    s_cmp_le_i32 s42, 3072
    s_cbranch_scc1 L_nt2_39
    s_waitcnt vmcnt(0)
    s_mov_b64 exec, s[64:65]
    v_cvt_f32_i32_sdwa v118, sext(v106) dst_sel:DWORD dst_unused:UNUSED_PAD src0_sel:WORD_0
    v_lshlrev_b32 v116, 16, v44
    v_and_b32 v117, s32, v44
    v_mul_f32 v118, s33, v118
    v_lshlrev_b32 v44, 16, v45
    v_and_b32 v45, s32, v45
    v_lshlrev_b32_sdwa v106, 3, v106 dst_sel:DWORD dst_unused:UNUSED_PAD src0_sel:DWORD src1_sel:WORD_1
    v_pk_fma_f32 v[116:117], v[116:117], v[118:119], s[28:29] op_sel_hi:[1,0,1]
    v_pk_fma_f32 v[44:45], v[44:45], v[118:119], s[28:29] op_sel_hi:[1,0,1]
    v_perm_b32 v116, v117, v116, s35
    v_perm_b32 v117, v45, v44, s35
    v_lshl_add_u64 v[116:117], v[116:117], 0, s[30:31]
    ds_add_rtn_u64 v[44:45], v106, v[116:117] offset:50000

    s_mov_b64 exec, s[66:67]
    v_cvt_f32_i32_sdwa v122, sext(v107) dst_sel:DWORD dst_unused:UNUSED_PAD src0_sel:WORD_0
    v_lshlrev_b32 v120, 16, v46
    v_and_b32 v121, s32, v46
    v_mul_f32 v122, s33, v122
    v_lshlrev_b32 v46, 16, v47
    v_and_b32 v47, s32, v47
    v_lshlrev_b32_sdwa v107, 3, v107 dst_sel:DWORD dst_unused:UNUSED_PAD src0_sel:DWORD src1_sel:WORD_1
    v_pk_fma_f32 v[120:121], v[120:121], v[122:123], s[28:29] op_sel_hi:[1,0,1]
    v_pk_fma_f32 v[46:47], v[46:47], v[122:123], s[28:29] op_sel_hi:[1,0,1]
    v_perm_b32 v120, v121, v120, s35
    v_perm_b32 v121, v47, v46, s35
    v_lshl_add_u64 v[120:121], v[120:121], 0, s[30:31]
    ds_add_rtn_u64 v[46:47], v107, v[120:121] offset:50000

    s_mov_b64 exec, s[68:69]
    v_cvt_f32_i32_sdwa v118, sext(v108) dst_sel:DWORD dst_unused:UNUSED_PAD src0_sel:WORD_0
    v_lshlrev_b32 v116, 16, v48
    v_and_b32 v117, s32, v48
    v_mul_f32 v118, s33, v118
    v_lshlrev_b32 v48, 16, v49
    v_and_b32 v49, s32, v49
    v_lshlrev_b32_sdwa v108, 3, v108 dst_sel:DWORD dst_unused:UNUSED_PAD src0_sel:DWORD src1_sel:WORD_1
    v_pk_fma_f32 v[116:117], v[116:117], v[118:119], s[28:29] op_sel_hi:[1,0,1]
    v_pk_fma_f32 v[48:49], v[48:49], v[118:119], s[28:29] op_sel_hi:[1,0,1]
    v_perm_b32 v116, v117, v116, s35
    v_perm_b32 v117, v49, v48, s35
    v_lshl_add_u64 v[116:117], v[116:117], 0, s[30:31]
    ds_add_rtn_u64 v[48:49], v108, v[116:117] offset:50000

    s_mov_b64 exec, s[70:71]
    v_cvt_f32_i32_sdwa v122, sext(v109) dst_sel:DWORD dst_unused:UNUSED_PAD src0_sel:WORD_0
    v_lshlrev_b32 v120, 16, v50
    v_and_b32 v121, s32, v50
    v_mul_f32 v122, s33, v122
    v_lshlrev_b32 v50, 16, v51
    v_and_b32 v51, s32, v51
    v_lshlrev_b32_sdwa v109, 3, v109 dst_sel:DWORD dst_unused:UNUSED_PAD src0_sel:DWORD src1_sel:WORD_1
    v_pk_fma_f32 v[120:121], v[120:121], v[122:123], s[28:29] op_sel_hi:[1,0,1]
    v_pk_fma_f32 v[50:51], v[50:51], v[122:123], s[28:29] op_sel_hi:[1,0,1]
    v_perm_b32 v120, v121, v120, s35
    v_perm_b32 v121, v51, v50, s35
    v_lshl_add_u64 v[120:121], v[120:121], 0, s[30:31]
    ds_add_rtn_u64 v[50:51], v109, v[120:121] offset:50000

    s_mov_b64 exec, -1
    s_waitcnt lgkmcnt(0)
    v_or3_b32 v1, v44, v45, v1
    v_or3_b32 v1, v46, v47, v1
    v_or3_b32 v1, v48, v49, v1
    v_or3_b32 v1, v50, v51, v1
L_nt2_39:
    s_movk_i32 s53, 15360
    buffer_load_dwordx4 v[106:109], v2, s[16:19], s53 offen
    buffer_load_dword v114, v2, s[16:19], s53 offen offset:16
    s_waitcnt lgkmcnt(0)
    v_or3_b32 v1, v68, v69, v1
    v_or3_b32 v1, v70, v71, v1
    v_or3_b32 v1, v72, v73, v1
    v_or3_b32 v1, v74, v75, v1
    s_cmp_le_u32 s40, 3584
    s_cbranch_scc1 L_noleft_42
    s_min_u32 s40, s40, 3968
    s_lshl_b32 s52, s38, 6
    s_add_u32 s52, s52, s36
    s_mul_i32 s52, s52, 19840
    s_add_u32 s20, s44, s52
    s_addc_u32 s21, s45, 0
    s_mul_i32 s52, s40, 5
    s_add_u32 s52, s52, 3
    s_and_b32 s22, s52, -4

    s_lshr_b32 s55, s39, 2
    s_add_u32 s55, s55, 3584
    v_and_b32 v60, 63, v0
    v_add_u32 v60, s55, v60
L_left_43:
    s_cmp_ge_u32 s55, s40
    s_cbranch_scc1 L_leftend_44
    v_mul_u32_u24 v61, 5, v60
    buffer_load_dword v62, v61, s[20:23], 0 offen
    buffer_load_ubyte v63, v61, s[20:23], 0 offen offset:4
    s_waitcnt vmcnt(0)

    v_perm_b32 v61, v63, v62, s24
    v_lshrrev_b32 v66, 30, v62
    v_and_b32 v61, 0x1fff, v61
    v_mul_u32_u24 v66, 6250, v66
    v_add_lshl_u32 v61, v61, v66, 3

    buffer_load_dwordx2 v[64:65], v61, s[8:11], s50 offen
    v_cmp_gt_u32 vcc, s40, v60
    s_waitcnt vmcnt(0)

    s_mov_b64 exec, vcc
    v_and_b32 v62, 0x3fffffff, v62
    v_cvt_f32_i32_sdwa v118, sext(v62) dst_sel:DWORD dst_unused:UNUSED_PAD src0_sel:WORD_0
    v_lshlrev_b32 v116, 16, v64
    v_and_b32 v117, s32, v64
    v_mul_f32 v118, s33, v118
    v_lshlrev_b32 v64, 16, v65
    v_and_b32 v65, s32, v65
    v_lshlrev_b32_sdwa v62, 3, v62 dst_sel:DWORD dst_unused:UNUSED_PAD src0_sel:DWORD src1_sel:WORD_1
    v_pk_fma_f32 v[116:117], v[116:117], v[118:119], s[28:29] op_sel_hi:[1,0,1]
    v_pk_fma_f32 v[64:65], v[64:65], v[118:119], s[28:29] op_sel_hi:[1,0,1]
    v_perm_b32 v116, v117, v116, s35
    v_perm_b32 v117, v65, v64, s35
    v_lshl_add_u64 v[116:117], v[116:117], 0, s[30:31]
    ds_add_rtn_u64 v[64:65], v62, v[116:117] offset:50000

    s_waitcnt lgkmcnt(0)
    v_or3_b32 v1, v64, v65, v1
    s_mov_b64 exec, -1
    v_add_u32 v60, 128, v60
    s_add_u32 s55, s55, 128
    s_branch L_left_43
L_leftend_44:

L_noleft_42:
    s_mov_b32 s38, s5
    s_cmp_lt_u32 s38, s4
    s_cbranch_scc1 L_batch_25
    s_waitcnt vmcnt(0)
    s_barrier

    s_mul_i32 s3, s37, 6400000
    s_mul_i32 s5, s36, 100000
    s_add_u32 s3, s3, s5
    s_add_u32 s3, s3, 1048576

    s_add_u32 s20, s6, s3
    s_addc_u32 s21, s7, 0
    s_mov_b32 s22, 100000
    s_mov_b32 s23, 0x20000
    v_lshlrev_b32 v68, 3, v0
    v_add_u32 v69, 50000, v68
    v_add_u32 v70, 115536, v68
    v_cmp_gt_u32 vcc, 212, v0
    v_mov_b32 v52, 0
    v_mov_b32 v53, 0

    ds_read_b64 v[28:29], v69 offset:0
    ds_read_b64 v[30:31], v69 offset:8192
    ds_read_b64 v[32:33], v69 offset:16384
    ds_read_b64 v[34:35], v69 offset:24576
    ds_read_b64 v[36:37], v69 offset:32768
    ds_read_b64 v[38:39], v69 offset:40960
    ds_read_b64 v[40:41], v69 offset:49152
    ds_read_b64 v[42:43], v69 offset:57344
    ds_read_b64 v[44:45], v70 offset:0
    ds_read_b64 v[46:47], v70 offset:8192
    ds_read_b64 v[48:49], v70 offset:16384
    ds_read_b64 v[50:51], v70 offset:24576
    s_mov_b64 exec, vcc
    ds_read_b64 v[52:53], v70 offset:32768
    s_mov_b64 exec, -1
    s_waitcnt lgkmcnt(12)
    s_mov_b32 s3, 0
    buffer_store_dwordx2 v[28:29], v68, s[20:23], s3 offen
    s_waitcnt lgkmcnt(11)
    s_mov_b32 s3, 8192
    buffer_store_dwordx2 v[30:31], v68, s[20:23], s3 offen
    s_waitcnt lgkmcnt(10)
    s_mov_b32 s3, 16384
    buffer_store_dwordx2 v[32:33], v68, s[20:23], s3 offen
    s_waitcnt lgkmcnt(9)
    s_mov_b32 s3, 24576
    buffer_store_dwordx2 v[34:35], v68, s[20:23], s3 offen
    s_waitcnt lgkmcnt(8)
    s_mov_b32 s3, 32768
    buffer_store_dwordx2 v[36:37], v68, s[20:23], s3 offen
    s_waitcnt lgkmcnt(7)
    s_mov_b32 s3, 40960
    buffer_store_dwordx2 v[38:39], v68, s[20:23], s3 offen
    s_waitcnt lgkmcnt(6)
    s_mov_b32 s3, 49152
    buffer_store_dwordx2 v[40:41], v68, s[20:23], s3 offen
    s_waitcnt lgkmcnt(5)
    s_mov_b32 s3, 57344
    buffer_store_dwordx2 v[42:43], v68, s[20:23], s3 offen
    s_waitcnt lgkmcnt(4)
    s_mov_b32 s3, 65536
    buffer_store_dwordx2 v[44:45], v68, s[20:23], s3 offen
    s_waitcnt lgkmcnt(3)
    s_mov_b32 s3, 73728
    buffer_store_dwordx2 v[46:47], v68, s[20:23], s3 offen
    s_waitcnt lgkmcnt(2)
    s_mov_b32 s3, 81920
    buffer_store_dwordx2 v[48:49], v68, s[20:23], s3 offen
    s_waitcnt lgkmcnt(1)
    s_mov_b32 s3, 90112
    buffer_store_dwordx2 v[50:51], v68, s[20:23], s3 offen
    s_waitcnt lgkmcnt(0)
    s_mov_b32 s3, 98304
    buffer_store_dwordx2 v[52:53], v68, s[20:23], s3 offen
    v_or3_b32 v1, v28, v29, v1
    v_or3_b32 v1, v30, v31, v1
    v_or3_b32 v1, v32, v33, v1
    v_or3_b32 v1, v34, v35, v1
    v_or3_b32 v1, v36, v37, v1
    v_or3_b32 v1, v38, v39, v1
    v_or3_b32 v1, v40, v41, v1
    v_or3_b32 v1, v42, v43, v1
    v_or3_b32 v1, v44, v45, v1
    v_or3_b32 v1, v46, v47, v1
    v_or3_b32 v1, v48, v49, v1
    v_or3_b32 v1, v50, v51, v1
    v_or3_b32 v1, v52, v53, v1
    v_and_b32 v1, 0x80008000, v1
    v_cmp_ne_u32 vcc, 0, v1
    v_mov_b32 v71, 150024
    v_mov_b32 v72, 1
    s_cbranch_vccz L_nf_45
    ds_write_b32 v71, v72
L_nf_45:
    s_waitcnt lgkmcnt(0)
    s_barrier
    ds_read_b32 v72, v71
    s_waitcnt lgkmcnt(0)
    v_readfirstlane_b32 s3, v72
    s_nop 1
    s_cmp_lg_u32 s3, 0
    s_cbranch_scc1 L_p2slow_24

L_fin_46:
    s_add_u32 s20, s6, 147456
    s_addc_u32 s21, s7, 0
    s_mov_b32 s22, 1024
    s_mov_b32 s23, 0x20000
    s_lshl_b32 s3, s36, 2
    s_add_u32 s3, s3, s37
    s_lshl_b32 s3, s3, 2
    v_lshlrev_b32 v73, 20, v0
    v_mov_b32 v74, s34
    buffer_store_dword v74, v73, s[20:23], s3 offen

L_p2done_23:
    s_endpgm

L_ufix_26:
    v_and_b32 v117, 63, v0
    v_lshlrev_b32 v117, 2, v117
    s_sub_i32 s54, s42, 1024
    v_cmp_le_i32 vcc, s54, v117
    s_mov_b64 exec, vcc
    v_mov_b32 v12, 0
    v_mov_b32 v44, 0
    s_mov_b64 exec, -1
    s_sub_i32 s54, s42, 1025
    v_cmp_le_i32 vcc, s54, v117
    s_mov_b64 exec, vcc
    v_mov_b32 v13, 0
    v_mov_b32 v46, 0
    s_mov_b64 exec, -1
    s_sub_i32 s54, s42, 1026
    v_cmp_le_i32 vcc, s54, v117
    s_mov_b64 exec, vcc
    v_mov_b32 v14, 0
    v_mov_b32 v48, 0
    s_mov_b64 exec, -1
    s_sub_i32 s54, s42, 1027
    v_cmp_le_i32 vcc, s54, v117
    s_mov_b64 exec, vcc
    v_mov_b32 v15, 0
    v_mov_b32 v50, 0
    s_mov_b64 exec, -1
    s_branch L_uback_27
L_ufix_28:
    v_and_b32 v117, 63, v0
    v_lshlrev_b32 v117, 2, v117
    s_sub_i32 s54, s42, 1536
    v_cmp_le_i32 vcc, s54, v117
    s_mov_b64 exec, vcc
    v_mov_b32 v16, 0
    v_mov_b32 v52, 0
    s_mov_b64 exec, -1
    s_sub_i32 s54, s42, 1537
    v_cmp_le_i32 vcc, s54, v117
    s_mov_b64 exec, vcc
    v_mov_b32 v17, 0
    v_mov_b32 v54, 0
    s_mov_b64 exec, -1
    s_sub_i32 s54, s42, 1538
    v_cmp_le_i32 vcc, s54, v117
    s_mov_b64 exec, vcc
    v_mov_b32 v18, 0
    v_mov_b32 v56, 0
    s_mov_b64 exec, -1
    s_sub_i32 s54, s42, 1539
    v_cmp_le_i32 vcc, s54, v117
    s_mov_b64 exec, vcc
    v_mov_b32 v19, 0
    v_mov_b32 v58, 0
    s_mov_b64 exec, -1
    s_branch L_uback_29
L_ufix_30:
    v_and_b32 v117, 63, v0
    v_lshlrev_b32 v117, 2, v117
    s_sub_i32 s54, s42, 2048
    v_cmp_le_i32 vcc, s54, v117
    s_mov_b64 exec, vcc
    v_mov_b32 v20, 0
    v_mov_b32 v60, 0
    s_mov_b64 exec, -1
    s_sub_i32 s54, s42, 2049
    v_cmp_le_i32 vcc, s54, v117
    s_mov_b64 exec, vcc
    v_mov_b32 v21, 0
    v_mov_b32 v62, 0
    s_mov_b64 exec, -1
    s_sub_i32 s54, s42, 2050
    v_cmp_le_i32 vcc, s54, v117
    s_mov_b64 exec, vcc
    v_mov_b32 v22, 0
    v_mov_b32 v64, 0
    s_mov_b64 exec, -1
    s_sub_i32 s54, s42, 2051
    v_cmp_le_i32 vcc, s54, v117
    s_mov_b64 exec, vcc
    v_mov_b32 v23, 0
    v_mov_b32 v66, 0
    s_mov_b64 exec, -1
    s_branch L_uback_31
L_ufix_32:
    v_and_b32 v117, 63, v0
    v_lshlrev_b32 v117, 2, v117
    s_sub_i32 s54, s42, 2560
    v_cmp_le_i32 vcc, s54, v117
    s_mov_b64 exec, vcc
    v_mov_b32 v24, 0
    v_mov_b32 v68, 0
    s_mov_b64 exec, -1
    s_sub_i32 s54, s42, 2561
    v_cmp_le_i32 vcc, s54, v117
    s_mov_b64 exec, vcc
    v_mov_b32 v25, 0
    v_mov_b32 v70, 0
    s_mov_b64 exec, -1
    s_sub_i32 s54, s42, 2562
    v_cmp_le_i32 vcc, s54, v117
    s_mov_b64 exec, vcc
    v_mov_b32 v26, 0
    v_mov_b32 v72, 0
    s_mov_b64 exec, -1
    s_sub_i32 s54, s42, 2563
    v_cmp_le_i32 vcc, s54, v117
    s_mov_b64 exec, vcc
    v_mov_b32 v27, 0
    v_mov_b32 v74, 0
    s_mov_b64 exec, -1
    s_branch L_uback_33
L_ufix_34:
    v_and_b32 v117, 63, v0
    v_lshlrev_b32 v117, 2, v117
    s_sub_i32 s54, s42, 0
    v_cmp_le_i32 vcc, s54, v117
    s_mov_b64 exec, vcc
    v_mov_b32 v4, 0
    v_mov_b32 v28, 0
    s_mov_b64 exec, -1
    s_sub_i32 s54, s42, 1
    v_cmp_le_i32 vcc, s54, v117
    s_mov_b64 exec, vcc
    v_mov_b32 v5, 0
    v_mov_b32 v30, 0
    s_mov_b64 exec, -1
    s_sub_i32 s54, s42, 2
    v_cmp_le_i32 vcc, s54, v117
    s_mov_b64 exec, vcc
    v_mov_b32 v6, 0
    v_mov_b32 v32, 0
    s_mov_b64 exec, -1
    s_sub_i32 s54, s42, 3
    v_cmp_le_i32 vcc, s54, v117
    s_mov_b64 exec, vcc
    v_mov_b32 v7, 0
    v_mov_b32 v34, 0
    s_mov_b64 exec, -1
    s_branch L_uback_35
L_ufix_36:
    v_and_b32 v117, 63, v0
    v_lshlrev_b32 v117, 2, v117
    s_sub_i32 s54, s42, 512
    v_cmp_le_i32 vcc, s54, v117
    s_mov_b64 exec, vcc
    v_mov_b32 v8, 0
    v_mov_b32 v36, 0
    s_mov_b64 exec, -1
    s_sub_i32 s54, s42, 513
    v_cmp_le_i32 vcc, s54, v117
    s_mov_b64 exec, vcc
    v_mov_b32 v9, 0
    v_mov_b32 v38, 0
    s_mov_b64 exec, -1
    s_sub_i32 s54, s42, 514
    v_cmp_le_i32 vcc, s54, v117
    s_mov_b64 exec, vcc
    v_mov_b32 v10, 0
    v_mov_b32 v40, 0
    s_mov_b64 exec, -1
    s_sub_i32 s54, s42, 515
    v_cmp_le_i32 vcc, s54, v117
    s_mov_b64 exec, vcc
    v_mov_b32 v11, 0
    v_mov_b32 v42, 0
    s_mov_b64 exec, -1
    s_branch L_uback_37
L_ufix_40:
    v_and_b32 v117, 63, v0
    v_lshlrev_b32 v117, 2, v117
    s_sub_i32 s54, s42, 3072
    v_cmp_le_i32 vcc, s54, v117
    s_mov_b64 exec, vcc
    v_mov_b32 v106, 0
    v_mov_b32 v116, 0
    s_mov_b64 exec, -1
    s_sub_i32 s54, s42, 3073
    v_cmp_le_i32 vcc, s54, v117
    s_mov_b64 exec, vcc
    v_mov_b32 v107, 0
    v_mov_b32 v118, 0
    s_mov_b64 exec, -1
    s_sub_i32 s54, s42, 3074
    v_cmp_le_i32 vcc, s54, v117
    s_mov_b64 exec, vcc
    v_mov_b32 v108, 0
    v_mov_b32 v120, 0
    s_mov_b64 exec, -1
    s_sub_i32 s54, s42, 3075
    v_cmp_le_i32 vcc, s54, v117
    s_mov_b64 exec, vcc
    v_mov_b32 v109, 0
    v_mov_b32 v122, 0
    s_mov_b64 exec, -1
    s_branch L_uback_41
L_p2slow_24:
    s_waitcnt vmcnt(0) lgkmcnt(0)
    s_mov_b32 s51, 0
    s_movk_i32 s43, 6250
    s_mov_b32 s34, 0
L_sweep_47:
    s_barrier

    v_mov_b32 v28, 0x0
    v_mov_b32 v29, 0x0
    v_mov_b32 v30, 0x0
    v_mov_b32 v31, 0x0
    v_add_u32 v32, 50000, v3
    v_add_u32 v33, 65536, v32

    ds_write_b128 v32, v[28:31] offset:0
    ds_write_b128 v32, v[28:31] offset:16384
    ds_write_b128 v32, v[28:31] offset:32768
    ds_write_b128 v32, v[28:31] offset:49152
    ds_write_b128 v33, v[28:31] offset:0
    ds_write_b128 v33, v[28:31] offset:16384
    v_cmp_gt_u32 vcc, 971, v0
    s_mov_b64 exec, vcc
    ds_write_b128 v33, v[28:31] offset:32768
    s_mov_b64 exec, -1
    s_waitcnt lgkmcnt(0)
    s_barrier
    s_sub_u32 s38, s4, 8
L_sbatch_48:
    s_lshl_b32 s52, s38, 6
    s_add_u32 s52, s52, s36
    s_lshl_b32 s52, s52, 2
    s_load_dword s40, s[46:47], s52
    s_mul_i32 s50, s38, 200000
    s_waitcnt lgkmcnt(0)

    s_min_u32 s40, s40, 3968
    s_lshl_b32 s52, s38, 6
    s_add_u32 s52, s52, s36
    s_mul_i32 s52, s52, 19840
    s_add_u32 s20, s44, s52
    s_addc_u32 s21, s45, 0
    s_mul_i32 s52, s40, 5
    s_add_u32 s52, s52, 3
    s_and_b32 s22, s52, -4

    s_lshr_b32 s55, s39, 2
    s_add_u32 s55, s55, 0
    v_and_b32 v36, 63, v0
    v_add_u32 v36, s55, v36
L_left_52:
    s_cmp_ge_u32 s55, s40
    s_cbranch_scc1 L_leftend_53
    v_mul_u32_u24 v37, 5, v36
    buffer_load_dword v38, v37, s[20:23], 0 offen
    buffer_load_ubyte v39, v37, s[20:23], 0 offen offset:4
    s_waitcnt vmcnt(0)

    v_perm_b32 v37, v39, v38, s24
    v_lshrrev_b32 v42, 30, v38
    v_and_b32 v37, 0x1fff, v37
    v_mul_u32_u24 v42, 6250, v42
    v_add_lshl_u32 v37, v37, v42, 3

    buffer_load_dwordx2 v[40:41], v37, s[8:11], s50 offen
    v_cmp_gt_u32 vcc, s40, v36
    s_waitcnt vmcnt(0)

    v_bfe_u32 v44, v38, 16, 14
    v_subrev_u32 v44, s51, v44
    v_cmp_gt_u32 s[64:65], s43, v44
    s_and_b64 exec, vcc, s[64:65]
    v_lshlrev_b32 v45, 8, v38
    v_cmpx_ne_u32 vcc, 0, v45
    v_lshlrev_b32 v44, 4, v44
    v_bfe_i32 v38, v38, 0, 16
    v_cvt_f32_i32 v38, v38
    v_mul_f32 v38, 0x38004020, v38
    v_lshlrev_b32 v45, 16, v40
    v_and_b32 v46, s32, v40
    v_lshlrev_b32 v47, 16, v41
    v_and_b32 v48, s32, v41

    v_mul_f32 v45, v45, v38
    ds_add_f32 v44, v45 offset:50000
    v_mul_f32 v46, v46, v38
    ds_add_f32 v44, v46 offset:50004
    v_mul_f32 v47, v47, v38
    ds_add_f32 v44, v47 offset:50008
    v_mul_f32 v48, v48, v38
    ds_add_f32 v44, v48 offset:50012
    s_mov_b64 exec, -1
    v_add_u32 v36, 128, v36
    s_add_u32 s55, s55, 128
    s_branch L_left_52
L_leftend_53:

    s_add_u32 s38, s38, 1
    s_cmp_lt_u32 s38, s4
    s_cbranch_scc1 L_sbatch_48
    s_mov_b32 s3, 65536
    s_load_dword s40, s[6:7], s3

    s_add_u32 s20, s6, 402907136
    s_addc_u32 s21, s7, 0
    s_mov_b32 s22, 409600000
    s_mov_b32 s23, 0x20000
    s_mov_b32 s38, 0
    s_mov_b32 s50, 200000
    v_mov_b32 v36, v0
    s_waitcnt lgkmcnt(0)
L_ovf_49:
    s_cmp_ge_u32 s38, s40
    s_cbranch_scc1 L_ovfend_50
    v_lshlrev_b32 v37, 3, v36
    buffer_load_dwordx2 v[38:39], v37, s[20:23], 0 offen
    s_waitcnt vmcnt(0)

    v_perm_b32 v37, v39, v38, s24
    v_lshrrev_b32 v42, 30, v38
    v_and_b32 v37, 0x1fff, v37
    v_mul_u32_u24 v42, 6250, v42
    v_add_lshl_u32 v37, v37, v42, 3

    v_bfe_u32 v42, v39, 24, 5
    v_mad_u32_u24 v37, v42, s50, v37
    buffer_load_dwordx2 v[40:41], v37, s[8:11], 0 offen
    v_lshrrev_b32 v42, 3, v42
    v_bfe_u32 v43, v39, 18, 6
    v_cmp_gt_u32 vcc, s40, v36
    v_cmp_eq_u32 s[64:65], s36, v43
    s_and_b64 vcc, vcc, s[64:65]
    v_cmp_eq_u32 s[64:65], s37, v42
    s_and_b64 vcc, vcc, s[64:65]
    s_waitcnt vmcnt(0)

    v_bfe_u32 v44, v38, 16, 14
    v_subrev_u32 v44, s51, v44
    v_cmp_gt_u32 s[64:65], s43, v44
    s_and_b64 exec, vcc, s[64:65]
    v_lshlrev_b32 v45, 8, v38
    v_cmpx_ne_u32 vcc, 0, v45
    v_lshlrev_b32 v44, 4, v44
    v_bfe_i32 v38, v38, 0, 16
    v_cvt_f32_i32 v38, v38
    v_mul_f32 v38, 0x38004020, v38
    v_lshlrev_b32 v45, 16, v40
    v_and_b32 v46, s32, v40
    v_lshlrev_b32 v47, 16, v41
    v_and_b32 v48, s32, v41

    v_mul_f32 v45, v45, v38
    ds_add_f32 v44, v45 offset:50000
    v_mul_f32 v46, v46, v38
    ds_add_f32 v44, v46 offset:50004
    v_mul_f32 v47, v47, v38
    ds_add_f32 v44, v47 offset:50008
    v_mul_f32 v48, v48, v38
    ds_add_f32 v44, v48 offset:50012
    s_mov_b64 exec, -1
    v_add_u32 v36, 1024, v36
    s_add_u32 s38, s38, 1024
    s_branch L_ovf_49
L_ovfend_50:
    s_waitcnt lgkmcnt(0)
    s_barrier
    s_mul_i32 s3, s37, 800000
    s_mul_i32 s5, s36, 12500
    s_add_u32 s3, s3, s5
    s_add_u32 s3, s3, s51
    s_lshl_b32 s3, s3, 4
    s_add_u32 s3, s3, 26648576

    s_add_u32 s20, s6, s3
    s_addc_u32 s21, s7, 0
    s_mov_b32 s22, 100000
    s_mov_b32 s23, 0x20000
    v_mov_b32 v36, v3
    s_mov_b32 s38, 0
L_wl_51:
    v_min_u32 v37, 100000, v36
    ds_read_b128 v[28:31], v37 offset:50000
    s_waitcnt lgkmcnt(0)
    buffer_store_dwordx4 v[28:31], v36, s[20:23], 0 offen
    s_waitcnt vmcnt(0)
    v_add_u32 v36, 16384, v36
    s_add_u32 s38, s38, 1024
    s_cmp_lt_u32 s38, 6250
    s_cbranch_scc1 L_wl_51
    s_add_u32 s51, s51, 6250
    s_cmp_lt_u32 s51, 12500
    s_cbranch_scc1 L_sweep_47
    s_branch L_fin_46

.globl standalone__molecular_angular_gemnet__graph_kernel
.p2align 8
.type standalone__molecular_angular_gemnet__graph_kernel,@function
standalone__molecular_angular_gemnet__graph_kernel:
    s_cmp_ge_u32 s2, 3200
    s_cbranch_scc1 L_fdone_54
    s_load_dwordx2 s[4:5], s[0:1], 0
    s_load_dwordx2 s[6:7], s[0:1], 24
    s_load_dwordx2 s[8:9], s[0:1], 40
    s_load_dwordx8 s[12:19], s[0:1], 56
    s_load_dwordx2 s[10:11], s[0:1], 88
    s_load_dwordx2 s[20:21], s[0:1], 104
    v_cmp_gt_u32 vcc, 250, v0
    s_mul_i32 s3, s2, 250
    v_add_u32 v0, s3, v0
    v_lshlrev_b32 v1, 4, v0
    v_lshlrev_b32 v2, 3, v0
    v_lshlrev_b32 v3, 1, v0
    s_mov_b64 exec, vcc
    s_mul_hi_u32 s3, s2, 85899346
    s_lshl_b32 s3, s3, 4
    s_add_u32 s3, s3, 147456
    s_waitcnt lgkmcnt(0)
    s_load_dwordx4 s[96:99], s[20:21], s3
    s_load_dwordx4 s[40:43], s[8:9], 0
    s_load_dwordx16 s[44:59], s[12:13], 0
    s_load_dwordx16 s[60:75], s[14:15], 0
    s_load_dwordx8 s[76:83], s[16:17], 0
    s_load_dwordx8 s[84:91], s[18:19], 0

    s_add_u32 s24, s20, 1048576
    s_addc_u32 s25, s21, 0
    s_mov_b32 s26, 76800000
    s_mov_b32 s27, 0x20000
    s_mov_b32 s28, s4
    s_mov_b32 s29, s5
    s_mov_b32 s30, 6400000
    s_mov_b32 s31, 0x20000
    s_mov_b32 s32, s6
    s_mov_b32 s33, s7
    s_mov_b32 s34, 1600000
    s_mov_b32 s35, 0x20000
    s_mov_b32 s36, s10
    s_mov_b32 s37, s11
    s_mov_b32 s38, 6400000
    s_mov_b32 s39, 0x20000
    buffer_load_ushort v4, v3, s[32:35], 0 offen
    buffer_load_dwordx2 v[32:33], v2, s[24:27], 0 offen
    s_mov_b32 s3, 6400000
    buffer_load_dwordx2 v[34:35], v2, s[24:27], s3 offen
    s_mov_b32 s3, 12800000
    buffer_load_dwordx2 v[36:37], v2, s[24:27], s3 offen
    s_mov_b32 s3, 19200000
    buffer_load_dwordx2 v[38:39], v2, s[24:27], s3 offen
    buffer_load_dwordx2 v[6:7], v2, s[28:31], 0 offen
    s_mov_b32 s94, 0xffff0000
    s_mov_b32 s95, 0xc1200000
    s_mov_b32 s22, 0x3fb8aa3b
    s_waitcnt vmcnt(5) lgkmcnt(0)
    v_lshlrev_b32 v4, 16, v4

    s_lshl_b32 s92, s40, 16
    v_subrev_f32 v16, s92, v4
    s_and_b32 s93, s40, s94
    v_subrev_f32 v17, s93, v4
    s_lshl_b32 s92, s41, 16
    v_subrev_f32 v18, s92, v4
    s_and_b32 s93, s41, s94
    v_subrev_f32 v19, s93, v4
    s_lshl_b32 s92, s42, 16
    v_subrev_f32 v20, s92, v4
    s_and_b32 s93, s42, s94
    v_subrev_f32 v21, s93, v4
    s_lshl_b32 s92, s43, 16
    v_subrev_f32 v22, s92, v4
    s_and_b32 s93, s43, s94
    v_subrev_f32 v23, s93, v4
    v_cvt_pk_bf16_f32 v16, v16, v17
    v_and_b32 v17, s94, v16
    v_lshlrev_b32 v16, 16, v16
    v_cvt_pk_bf16_f32 v18, v18, v19
    v_and_b32 v19, s94, v18
    v_lshlrev_b32 v18, 16, v18
    v_cvt_pk_bf16_f32 v20, v20, v21
    v_and_b32 v21, s94, v20
    v_lshlrev_b32 v20, 16, v20
    v_cvt_pk_bf16_f32 v22, v22, v23
    v_and_b32 v23, s94, v22
    v_lshlrev_b32 v22, 16, v22
    v_mul_f32 v16, v16, v16
    v_mul_f32 v17, v17, v17
    v_mul_f32 v18, v18, v18
    v_mul_f32 v19, v19, v19
    v_mul_f32 v20, v20, v20
    v_mul_f32 v21, v21, v21
    v_mul_f32 v22, v22, v22
    v_mul_f32 v23, v23, v23
    v_cvt_pk_bf16_f32 v16, v16, v17
    v_and_b32 v17, s94, v16
    v_lshlrev_b32 v16, 16, v16
    v_cvt_pk_bf16_f32 v18, v18, v19
    v_and_b32 v19, s94, v18
    v_lshlrev_b32 v18, 16, v18
    v_cvt_pk_bf16_f32 v20, v20, v21
    v_and_b32 v21, s94, v20
    v_lshlrev_b32 v20, 16, v20
    v_cvt_pk_bf16_f32 v22, v22, v23
    v_and_b32 v23, s94, v22
    v_lshlrev_b32 v22, 16, v22
    v_mul_f32 v16, s95, v16
    v_mul_f32 v17, s95, v17
    v_mul_f32 v18, s95, v18
    v_mul_f32 v19, s95, v19
    v_mul_f32 v20, s95, v20
    v_mul_f32 v21, s95, v21
    v_mul_f32 v22, s95, v22
    v_mul_f32 v23, s95, v23
    v_cvt_pk_bf16_f32 v16, v16, v17
    v_and_b32 v17, s94, v16
    v_lshlrev_b32 v16, 16, v16
    v_cvt_pk_bf16_f32 v18, v18, v19
    v_and_b32 v19, s94, v18
    v_lshlrev_b32 v18, 16, v18
    v_cvt_pk_bf16_f32 v20, v20, v21
    v_and_b32 v21, s94, v20
    v_lshlrev_b32 v20, 16, v20
    v_cvt_pk_bf16_f32 v22, v22, v23
    v_and_b32 v23, s94, v22
    v_lshlrev_b32 v22, 16, v22
    v_mul_f32 v16, s22, v16
    v_mul_f32 v17, s22, v17
    v_mul_f32 v18, s22, v18
    v_mul_f32 v19, s22, v19
    v_mul_f32 v20, s22, v20
    v_mul_f32 v21, s22, v21
    v_mul_f32 v22, s22, v22
    v_mul_f32 v23, s22, v23
    v_exp_f32 v16, v16
    v_exp_f32 v17, v17
    v_exp_f32 v18, v18
    v_exp_f32 v19, v19
    v_exp_f32 v20, v20
    v_exp_f32 v21, v21
    v_exp_f32 v22, v22
    v_exp_f32 v23, v23
    s_nop 0
    v_cvt_pk_bf16_f32 v16, v16, v17
    v_and_b32 v17, s94, v16
    v_lshlrev_b32 v16, 16, v16
    v_cvt_pk_bf16_f32 v18, v18, v19
    v_and_b32 v19, s94, v18
    v_lshlrev_b32 v18, 16, v18
    v_cvt_pk_bf16_f32 v20, v20, v21
    v_and_b32 v21, s94, v20
    v_lshlrev_b32 v20, 16, v20
    v_cvt_pk_bf16_f32 v22, v22, v23
    v_and_b32 v23, s94, v22
    v_lshlrev_b32 v22, 16, v22
    s_lshl_b32 s92, s60, 16
    v_mul_f32 v24, s92, v16
    s_and_b32 s93, s60, s94
    v_mul_f32 v25, s93, v16
    s_lshl_b32 s92, s61, 16
    v_mul_f32 v26, s92, v16
    s_and_b32 s93, s61, s94
    v_mul_f32 v27, s93, v16
    s_lshl_b32 s92, s62, 16
    v_fmac_f32 v24, s92, v17
    s_and_b32 s93, s62, s94
    v_fmac_f32 v25, s93, v17
    s_lshl_b32 s92, s63, 16
    v_fmac_f32 v26, s92, v17
    s_and_b32 s93, s63, s94
    v_fmac_f32 v27, s93, v17
    s_lshl_b32 s92, s64, 16
    v_fmac_f32 v24, s92, v18
    s_and_b32 s93, s64, s94
    v_fmac_f32 v25, s93, v18
    s_lshl_b32 s92, s65, 16
    v_fmac_f32 v26, s92, v18
    s_and_b32 s93, s65, s94
    v_fmac_f32 v27, s93, v18
    s_lshl_b32 s92, s66, 16
    v_fmac_f32 v24, s92, v19
    s_and_b32 s93, s66, s94
    v_fmac_f32 v25, s93, v19
    s_lshl_b32 s92, s67, 16
    v_fmac_f32 v26, s92, v19
    s_and_b32 s93, s67, s94
    v_fmac_f32 v27, s93, v19
    s_lshl_b32 s92, s68, 16
    v_fmac_f32 v24, s92, v20
    s_and_b32 s93, s68, s94
    v_fmac_f32 v25, s93, v20
    s_lshl_b32 s92, s69, 16
    v_fmac_f32 v26, s92, v20
    s_and_b32 s93, s69, s94
    v_fmac_f32 v27, s93, v20
    s_lshl_b32 s92, s70, 16
    v_fmac_f32 v24, s92, v21
    s_and_b32 s93, s70, s94
    v_fmac_f32 v25, s93, v21
    s_lshl_b32 s92, s71, 16
    v_fmac_f32 v26, s92, v21
    s_and_b32 s93, s71, s94
    v_fmac_f32 v27, s93, v21
    s_lshl_b32 s92, s72, 16
    v_fmac_f32 v24, s92, v22
    s_and_b32 s93, s72, s94
    v_fmac_f32 v25, s93, v22
    s_lshl_b32 s92, s73, 16
    v_fmac_f32 v26, s92, v22
    s_and_b32 s93, s73, s94
    v_fmac_f32 v27, s93, v22
    s_lshl_b32 s92, s74, 16
    v_fmac_f32 v24, s92, v23
    s_and_b32 s93, s74, s94
    v_fmac_f32 v25, s93, v23
    s_lshl_b32 s92, s75, 16
    v_fmac_f32 v26, s92, v23
    s_and_b32 s93, s75, s94
    v_fmac_f32 v27, s93, v23
    s_lshl_b32 s92, s44, 16
    v_mul_f32 v28, s92, v16
    s_and_b32 s93, s44, s94
    v_mul_f32 v29, s93, v16
    s_lshl_b32 s92, s45, 16
    v_mul_f32 v30, s92, v16
    s_and_b32 s93, s45, s94
    v_mul_f32 v31, s93, v16
    s_lshl_b32 s92, s46, 16
    v_fmac_f32 v28, s92, v17
    s_and_b32 s93, s46, s94
    v_fmac_f32 v29, s93, v17
    s_lshl_b32 s92, s47, 16
    v_fmac_f32 v30, s92, v17
    s_and_b32 s93, s47, s94
    v_fmac_f32 v31, s93, v17
    s_lshl_b32 s92, s48, 16
    v_fmac_f32 v28, s92, v18
    s_and_b32 s93, s48, s94
    v_fmac_f32 v29, s93, v18
    s_lshl_b32 s92, s49, 16
    v_fmac_f32 v30, s92, v18
    s_and_b32 s93, s49, s94
    v_fmac_f32 v31, s93, v18
    s_lshl_b32 s92, s50, 16
    v_fmac_f32 v28, s92, v19
    s_and_b32 s93, s50, s94
    v_fmac_f32 v29, s93, v19
    s_lshl_b32 s92, s51, 16
    v_fmac_f32 v30, s92, v19
    s_and_b32 s93, s51, s94
    v_fmac_f32 v31, s93, v19
    s_lshl_b32 s92, s52, 16
    v_fmac_f32 v28, s92, v20
    s_and_b32 s93, s52, s94
    v_fmac_f32 v29, s93, v20
    s_lshl_b32 s92, s53, 16
    v_fmac_f32 v30, s92, v20
    s_and_b32 s93, s53, s94
    v_fmac_f32 v31, s93, v20
    s_lshl_b32 s92, s54, 16
    v_fmac_f32 v28, s92, v21
    s_and_b32 s93, s54, s94
    v_fmac_f32 v29, s93, v21
    s_lshl_b32 s92, s55, 16
    v_fmac_f32 v30, s92, v21
    s_and_b32 s93, s55, s94
    v_fmac_f32 v31, s93, v21
    s_lshl_b32 s92, s56, 16
    v_fmac_f32 v28, s92, v22
    s_and_b32 s93, s56, s94
    v_fmac_f32 v29, s93, v22
    s_lshl_b32 s92, s57, 16
    v_fmac_f32 v30, s92, v22
    s_and_b32 s93, s57, s94
    v_fmac_f32 v31, s93, v22
    s_lshl_b32 s92, s58, 16
    v_fmac_f32 v28, s92, v23
    s_and_b32 s93, s58, s94
    v_fmac_f32 v29, s93, v23
    s_lshl_b32 s92, s59, 16
    v_fmac_f32 v30, s92, v23
    s_and_b32 s93, s59, s94
    v_fmac_f32 v31, s93, v23
    v_cvt_pk_bf16_f32 v28, v28, v29
    v_and_b32 v29, s94, v28
    v_lshlrev_b32 v28, 16, v28
    v_cvt_pk_bf16_f32 v30, v30, v31
    v_and_b32 v31, s94, v30
    v_lshlrev_b32 v30, 16, v30
    s_waitcnt vmcnt(1)
    v_mov_b32 v8, 0
    v_mov_b32 v9, 0
    v_mov_b32 v10, 0
    v_mov_b32 v11, 0
    s_cmp_eq_u32 s96, 0
    s_cbranch_scc1 L_ffl_55
    v_cvt_f32_u32_sdwa v12, v32 dst_sel:DWORD dst_unused:UNUSED_PAD src0_sel:WORD_0
    v_cvt_f32_u32_sdwa v13, v32 dst_sel:DWORD dst_unused:UNUSED_PAD src0_sel:WORD_1
    v_cvt_f32_u32_sdwa v14, v33 dst_sel:DWORD dst_unused:UNUSED_PAD src0_sel:WORD_0
    v_cvt_f32_u32_sdwa v15, v33 dst_sel:DWORD dst_unused:UNUSED_PAD src0_sel:WORD_1
    v_add_f32 v12, 0xc6800000, v12
    v_add_f32 v13, 0xc6800000, v13
    v_add_f32 v14, 0xc6800000, v14
    v_add_f32 v15, 0xc6800000, v15
    v_fmac_f32 v8, s96, v12
    v_fmac_f32 v9, s96, v13
    v_fmac_f32 v10, s96, v14
    v_fmac_f32 v11, s96, v15
L_fbk_56:
    s_cmp_eq_u32 s97, 0
    s_cbranch_scc1 L_ffl_57
    v_cvt_f32_u32_sdwa v12, v34 dst_sel:DWORD dst_unused:UNUSED_PAD src0_sel:WORD_0
    v_cvt_f32_u32_sdwa v13, v34 dst_sel:DWORD dst_unused:UNUSED_PAD src0_sel:WORD_1
    v_cvt_f32_u32_sdwa v14, v35 dst_sel:DWORD dst_unused:UNUSED_PAD src0_sel:WORD_0
    v_cvt_f32_u32_sdwa v15, v35 dst_sel:DWORD dst_unused:UNUSED_PAD src0_sel:WORD_1
    v_add_f32 v12, 0xc6800000, v12
    v_add_f32 v13, 0xc6800000, v13
    v_add_f32 v14, 0xc6800000, v14
    v_add_f32 v15, 0xc6800000, v15
    v_fmac_f32 v8, s97, v12
    v_fmac_f32 v9, s97, v13
    v_fmac_f32 v10, s97, v14
    v_fmac_f32 v11, s97, v15
L_fbk_58:
    s_cmp_eq_u32 s98, 0
    s_cbranch_scc1 L_ffl_59
    v_cvt_f32_u32_sdwa v12, v36 dst_sel:DWORD dst_unused:UNUSED_PAD src0_sel:WORD_0
    v_cvt_f32_u32_sdwa v13, v36 dst_sel:DWORD dst_unused:UNUSED_PAD src0_sel:WORD_1
    v_cvt_f32_u32_sdwa v14, v37 dst_sel:DWORD dst_unused:UNUSED_PAD src0_sel:WORD_0
    v_cvt_f32_u32_sdwa v15, v37 dst_sel:DWORD dst_unused:UNUSED_PAD src0_sel:WORD_1
    v_add_f32 v12, 0xc6800000, v12
    v_add_f32 v13, 0xc6800000, v13
    v_add_f32 v14, 0xc6800000, v14
    v_add_f32 v15, 0xc6800000, v15
    v_fmac_f32 v8, s98, v12
    v_fmac_f32 v9, s98, v13
    v_fmac_f32 v10, s98, v14
    v_fmac_f32 v11, s98, v15
L_fbk_60:
    s_cmp_eq_u32 s99, 0
    s_cbranch_scc1 L_ffl_61
    v_cvt_f32_u32_sdwa v12, v38 dst_sel:DWORD dst_unused:UNUSED_PAD src0_sel:WORD_0
    v_cvt_f32_u32_sdwa v13, v38 dst_sel:DWORD dst_unused:UNUSED_PAD src0_sel:WORD_1
    v_cvt_f32_u32_sdwa v14, v39 dst_sel:DWORD dst_unused:UNUSED_PAD src0_sel:WORD_0
    v_cvt_f32_u32_sdwa v15, v39 dst_sel:DWORD dst_unused:UNUSED_PAD src0_sel:WORD_1
    v_add_f32 v12, 0xc6800000, v12
    v_add_f32 v13, 0xc6800000, v13
    v_add_f32 v14, 0xc6800000, v14
    v_add_f32 v15, 0xc6800000, v15
    v_fmac_f32 v8, s99, v12
    v_fmac_f32 v9, s99, v13
    v_fmac_f32 v10, s99, v14
    v_fmac_f32 v11, s99, v15
L_fbk_62:
    s_lshl_b32 s92, s76, 16
    v_mul_f32 v16, s92, v8
    s_and_b32 s93, s76, s94
    v_mul_f32 v17, s93, v8
    s_lshl_b32 s92, s77, 16
    v_mul_f32 v18, s92, v8
    s_and_b32 s93, s77, s94
    v_mul_f32 v19, s93, v8
    s_lshl_b32 s92, s78, 16
    v_fmac_f32 v16, s92, v9
    s_and_b32 s93, s78, s94
    v_fmac_f32 v17, s93, v9
    s_lshl_b32 s92, s79, 16
    v_fmac_f32 v18, s92, v9
    s_and_b32 s93, s79, s94
    v_fmac_f32 v19, s93, v9
    s_lshl_b32 s92, s80, 16
    v_fmac_f32 v16, s92, v10
    s_and_b32 s93, s80, s94
    v_fmac_f32 v17, s93, v10
    s_lshl_b32 s92, s81, 16
    v_fmac_f32 v18, s92, v10
    s_and_b32 s93, s81, s94
    v_fmac_f32 v19, s93, v10
    s_lshl_b32 s92, s82, 16
    v_fmac_f32 v16, s92, v11
    s_and_b32 s93, s82, s94
    v_fmac_f32 v17, s93, v11
    s_lshl_b32 s92, s83, 16
    v_fmac_f32 v18, s92, v11
    s_and_b32 s93, s83, s94
    v_fmac_f32 v19, s93, v11
    v_mul_f32 v16, v16, v24
    v_mul_f32 v17, v17, v25
    v_mul_f32 v18, v18, v26
    v_mul_f32 v19, v19, v27
    v_cvt_pk_bf16_f32 v16, v16, v17
    v_and_b32 v17, s94, v16
    v_lshlrev_b32 v16, 16, v16
    v_cvt_pk_bf16_f32 v18, v18, v19
    v_and_b32 v19, s94, v18
    v_lshlrev_b32 v18, 16, v18
    s_lshl_b32 s92, s84, 16
    v_mul_f32 v20, s92, v16
    s_and_b32 s93, s84, s94
    v_mul_f32 v21, s93, v16
    s_lshl_b32 s92, s85, 16
    v_mul_f32 v22, s92, v16
    s_and_b32 s93, s85, s94
    v_mul_f32 v23, s93, v16
    s_lshl_b32 s92, s86, 16
    v_fmac_f32 v20, s92, v17
    s_and_b32 s93, s86, s94
    v_fmac_f32 v21, s93, v17
    s_lshl_b32 s92, s87, 16
    v_fmac_f32 v22, s92, v17
    s_and_b32 s93, s87, s94
    v_fmac_f32 v23, s93, v17
    s_lshl_b32 s92, s88, 16
    v_fmac_f32 v20, s92, v18
    s_and_b32 s93, s88, s94
    v_fmac_f32 v21, s93, v18
    s_lshl_b32 s92, s89, 16
    v_fmac_f32 v22, s92, v18
    s_and_b32 s93, s89, s94
    v_fmac_f32 v23, s93, v18
    s_lshl_b32 s92, s90, 16
    v_fmac_f32 v20, s92, v19
    s_and_b32 s93, s90, s94
    v_fmac_f32 v21, s93, v19
    s_lshl_b32 s92, s91, 16
    v_fmac_f32 v22, s92, v19
    s_and_b32 s93, s91, s94
    v_fmac_f32 v23, s93, v19
    v_cvt_pk_bf16_f32 v20, v20, v21
    v_and_b32 v21, s94, v20
    v_lshlrev_b32 v20, 16, v20
    v_cvt_pk_bf16_f32 v22, v22, v23
    v_and_b32 v23, s94, v22
    v_lshlrev_b32 v22, 16, v22
    v_mul_f32 v20, v20, v28
    v_mul_f32 v21, v21, v29
    v_mul_f32 v22, v22, v30
    v_mul_f32 v23, v23, v31
    v_cvt_pk_bf16_f32 v20, v20, v21
    v_and_b32 v21, s94, v20
    v_lshlrev_b32 v20, 16, v20
    v_cvt_pk_bf16_f32 v22, v22, v23
    v_and_b32 v23, s94, v22
    v_lshlrev_b32 v22, 16, v22
    s_waitcnt vmcnt(0)
    v_lshlrev_b32 v8, 16, v6
    v_and_b32 v9, s94, v6
    v_lshlrev_b32 v10, 16, v7
    v_and_b32 v11, s94, v7

    v_add_f32 v8, v8, v20
    v_add_f32 v9, v9, v21
    v_add_f32 v10, v10, v22
    v_add_f32 v11, v11, v23
    v_cvt_pk_bf16_f32 v12, v8, v9
    v_cvt_pk_bf16_f32 v13, v10, v11
    buffer_store_dwordx2 v[12:13], v2, s[36:39], 0 offen
L_fdone_54:
    s_endpgm

L_ffl_55:
    s_mov_b32 s3, 25600000
    buffer_load_dwordx4 v[12:15], v1, s[24:27], s3 offen
    s_waitcnt vmcnt(0)
    v_add_f32 v8, v8, v12
    v_add_f32 v9, v9, v13
    v_add_f32 v10, v10, v14
    v_add_f32 v11, v11, v15
    s_branch L_fbk_56

L_ffl_57:
    s_mov_b32 s3, 38400000
    buffer_load_dwordx4 v[12:15], v1, s[24:27], s3 offen
    s_waitcnt vmcnt(0)
    v_add_f32 v8, v8, v12
    v_add_f32 v9, v9, v13
    v_add_f32 v10, v10, v14
    v_add_f32 v11, v11, v15
    s_branch L_fbk_58

L_ffl_59:
    s_mov_b32 s3, 51200000
    buffer_load_dwordx4 v[12:15], v1, s[24:27], s3 offen
    s_waitcnt vmcnt(0)
    v_add_f32 v8, v8, v12
    v_add_f32 v9, v9, v13
    v_add_f32 v10, v10, v14
    v_add_f32 v11, v11, v15
    s_branch L_fbk_60

L_ffl_61:
    s_mov_b32 s3, 64000000
    buffer_load_dwordx4 v[12:15], v1, s[24:27], s3 offen
    s_waitcnt vmcnt(0)
    v_add_f32 v8, v8, v12
    v_add_f32 v9, v9, v13
    v_add_f32 v10, v10, v14
    v_add_f32 v11, v11, v15
    s_branch L_fbk_62

.section .rodata,"a"
.p2align 6
.amdhsa_kernel g1_kernel
  .amdhsa_next_free_vgpr 128
  .amdhsa_next_free_sgpr 102
  .amdhsa_accum_offset 128
  .amdhsa_group_segment_fixed_size 0
  .amdhsa_kernarg_size 112
  .amdhsa_user_sgpr_count 2
  .amdhsa_user_sgpr_kernarg_segment_ptr 1
  .amdhsa_system_sgpr_workgroup_id_x 1
.end_amdhsa_kernel
.p2align 6
.amdhsa_kernel g2_kernel
  .amdhsa_next_free_vgpr 128
  .amdhsa_next_free_sgpr 102
  .amdhsa_accum_offset 128
  .amdhsa_group_segment_fixed_size 0
  .amdhsa_kernarg_size 112
  .amdhsa_user_sgpr_count 2
  .amdhsa_user_sgpr_kernarg_segment_ptr 1
  .amdhsa_system_sgpr_workgroup_id_x 1
  .amdhsa_float_denorm_mode_32 3
.end_amdhsa_kernel
.p2align 6
.amdhsa_kernel standalone__molecular_angular_gemnet__graph_kernel
  .amdhsa_next_free_vgpr 40
  .amdhsa_next_free_sgpr 100
  .amdhsa_accum_offset 40
  .amdhsa_group_segment_fixed_size 0
  .amdhsa_kernarg_size 112
  .amdhsa_user_sgpr_count 2
  .amdhsa_user_sgpr_kernarg_segment_ptr 1
  .amdhsa_system_sgpr_workgroup_id_x 1
  .amdhsa_float_denorm_mode_32 3
.end_amdhsa_kernel
```

```asm
; @launch kernel=g1_kernel grid=(256,1,1) block=(1024,1,1) lds=163840
; @launch kernel=g2_kernel grid=(256,1,1) block=(1024,1,1) lds=163840
; @launch kernel=standalone__molecular_angular_gemnet__graph_kernel grid=(3200,1,1) block=(256,1,1) lds=0
.amdgcn_target "amdgcn-amd-amdhsa--gfx950"
.text
.globl g1_kernel
.p2align 8
.type g1_kernel,@function
g1_kernel:
    s_cmp_ge_u32 s2, 256
    s_cbranch_scc1 L_p1done_1
    s_load_dwordx4 s[80:83], s[0:1], 8
    s_load_dwordx2 s[84:85], s[0:1], 32
    s_load_dwordx2 s[86:87], s[0:1], 48
    s_load_dwordx4 s[4:7], s[0:1], 96
    s_load_dwordx2 s[78:79], s[0:1], 0
    v_lshlrev_b32 v1, 4, v0
    v_lshlrev_b32 v2, 3, v0
    v_lshlrev_b32 v98, 20, v0
    s_mul_i32 s3, s2, 25000
    s_waitcnt lgkmcnt(0)
    s_load_dword s88, s[86:87], 0

    s_mov_b32 s96, s4
    s_mov_b32 s97, s5
    s_mov_b32 s98, 256
    s_mov_b32 s99, 0x20000
    v_readfirstlane_b32 s74, v0
    s_nop 1
    s_or_b32 s74, s74, s2
    s_cbranch_scc1 L_noinit_2

    v_mov_b32 v110, 1
    buffer_atomic_add v110, v98, s[96:99], 0 offen offset:64 sc0
    s_waitcnt vmcnt(0)
    v_readfirstlane_b32 s74, v110
    s_nop 1
    s_cmp_lg_u32 s74, 0
    s_cbranch_scc1 L_zno_4

    s_mov_b32 s92, s6
    s_mov_b32 s93, s7
    s_mov_b32 s94, 65552
    s_mov_b32 s95, 0x20000
    v_mov_b32 v110, 0
    v_mov_b32 v111, 0
    v_mov_b32 v112, 0
    v_mov_b32 v113, 0
L_zl_3:
    buffer_store_dwordx4 v[110:113], v1, s[92:95], s74 offen sc0 sc1
    s_add_u32 s74, s74, 1024
    s_cmp_le_u32 s74, 65536
    s_cbranch_scc1 L_zl_3
    v_mov_b32 v114, 1
    s_waitcnt vmcnt(0)
    buffer_atomic_add v114, v98, s[96:99], 0 offen offset:128
L_zno_4:

L_noinit_2:
    s_add_u32 s20, s78, s3
    s_addc_u32 s21, s79, 0
    s_mov_b32 s22, 25000
    s_mov_b32 s23, 0x20000
    s_movk_i32 s3, 16384
    buffer_load_dwordx4 v[44:47], v1, s[20:23], 0 offen
    buffer_load_dwordx4 v[48:51], v1, s[20:23], s3 offen
    s_mov_b32 s8, s80
    s_mov_b32 s9, s81
    s_mov_b32 s10, 0
    s_mov_b32 s11, 0x20000
    s_mov_b32 s12, s82
    s_mov_b32 s13, s83
    s_mov_b32 s14, 0
    s_mov_b32 s15, 0x20000
    s_mov_b32 s16, s84
    s_mov_b32 s17, s85
    s_mov_b32 s18, 0
    s_mov_b32 s19, 0x20000
    s_lshr_b32 s74, s2, 1
    s_and_b32 s74, s74, 28
    s_lshr_b32 s29, 0x00102010, s74
    s_lshr_b32 s30, 0x44414241, s74
    s_lshr_b32 s41, 0x43221100, s74
    s_and_b32 s29, s29, 15
    s_and_b32 s30, s30, 15
    s_and_b32 s41, s41, 15
    s_lshr_b32 s74, s2, 6
    s_lshl_b32 s74, s74, 3
    s_and_b32 s75, s2, 7
    s_add_u32 s74, s74, s75
    s_mul_i32 s74, s74, 5
    s_add_u32 s41, s41, s74
    s_sub_u32 s74, s30, s29
    s_bfm_b32 s28, s74, s29
    s_lshl_b32 s29, s29, 12
    s_lshl_b32 s30, s30, 12
    s_min_u32 s30, s30, 16000

    s_mul_i32 s78, s41, 16000
    s_add_u32 s49, s78, 16000
    s_cmp_ge_u32 s41, 3200
    s_cmovk_i32 s49, 0
    s_cmovk_i32 s78, 0
    s_lshl_b32 s10, s49, 2
    s_lshl_b32 s14, s49, 2
    s_lshl_b32 s18, s49, 1
    s_lshl_b32 s56, s78, 2
    s_lshl_b32 s61, s78, 1

    s_add_u32 s57, s56, 16384
    s_add_u32 s62, s61, 8192
    s_add_u32 s58, s56, 32768
    s_add_u32 s63, s61, 16384
    s_add_u32 s59, s56, 49152
    s_add_u32 s64, s61, 24576
    s_bitcmp1_b32 s28, 0
    s_cselect_b32 s56, s56, 0x7ff00000
    s_cselect_b32 s61, s61, 0x7ff00000

    s_bitcmp1_b32 s28, 1
    s_cselect_b32 s57, s57, 0x7ff00000
    s_cselect_b32 s62, s62, 0x7ff00000

    s_bitcmp1_b32 s28, 2
    s_cselect_b32 s58, s58, 0x7ff00000
    s_cselect_b32 s63, s63, 0x7ff00000

    s_bitcmp1_b32 s28, 3
    s_cselect_b32 s59, s59, 0x7ff00000
    s_cselect_b32 s64, s64, 0x7ff00000

    buffer_load_dwordx4 v[20:23], v1, s[12:15], s56 offen nt
    buffer_load_dwordx4 v[4:7], v1, s[8:11], s56 offen nt
    buffer_load_dwordx2 v[36:37], v2, s[16:19], s61 offen nt
    buffer_load_dwordx4 v[24:27], v1, s[12:15], s57 offen nt
    buffer_load_dwordx4 v[8:11], v1, s[8:11], s57 offen nt
    buffer_load_dwordx2 v[38:39], v2, s[16:19], s62 offen nt
    buffer_load_dwordx4 v[28:31], v1, s[12:15], s58 offen nt
    buffer_load_dwordx4 v[12:15], v1, s[8:11], s58 offen nt
    buffer_load_dwordx2 v[40:41], v2, s[16:19], s63 offen nt
    buffer_load_dwordx4 v[32:35], v1, s[12:15], s59 offen nt
    buffer_load_dwordx4 v[16:19], v1, s[8:11], s59 offen nt
    buffer_load_dwordx2 v[42:43], v2, s[16:19], s64 offen nt
    s_and_b32 s5, s2, 7
    s_mul_i32 s3, s5, 8192

    s_add_u32 s20, s6, s3
    s_addc_u32 s21, s7, 0
    s_mov_b32 s22, 8192
    s_mov_b32 s23, 0x20000
    s_mul_i32 s3, s5, 40632320
    s_add_u32 s3, s3, 77848576
    s_add_u32 s24, s6, s3
    s_addc_u32 s25, s7, 0
    s_mov_b32 s26, 40632320
    s_mov_b32 s27, 0x20000
    s_add_u32 s32, s6, 402907136
    s_addc_u32 s33, s7, 0
    s_mov_b32 s34, 409600000
    s_mov_b32 s35, 0x20000
    s_add_u32 s36, s6, 65536
    s_addc_u32 s37, s7, 0
    s_mov_b32 s38, 4
    s_mov_b32 s39, 0x20000
    s_mov_b32 s40, 687195
    s_mov_b32 s42, -6250
    s_mov_b32 s43, 1942
    s_mov_b32 s45, 0x06050400
    s_mov_b32 s46, 0x05040c00
    s_mov_b32 s47, 0x04020100
    s_mov_b32 s48, 3968
    s_sub_u32 s50, 0, s29
    v_mov_b32 v104, 1
    v_mov_b32 v105, 0x46ff8000
    s_mov_b32 s55, 0x05040100
    v_mul_u32_u24 v106, 5, v0
    v_mov_b32 v108, 16384
    v_mov_b32 v114, 0
    v_mov_b32 v115, 0
    v_mov_b32 v116, 0
    v_mov_b32 v117, -1
    ds_write_b64 v2, v[114:115]
    s_lshl_b32 s74, s29, 3
    s_lshl_b32 s75, s30, 3
    v_mov_b32 v118, 128000
    v_mov_b32 v119, s74
    v_mov_b32 v120, s75
    s_movk_i32 s3, 928
    v_cmp_gt_u32 s[66:67], s3, v0
    s_movk_i32 s3, 640
    v_cmp_gt_u32 s[68:69], s3, v0
    s_mov_b64 exec, 1
    ds_write_b128 v108, v[114:117]
    ds_write_b32 v118, v117 offset:16404
    ds_write_b32 v119, v117 offset:16396
    ds_write_b32 v120, v117 offset:16404
    s_mov_b64 exec, -1
    s_waitcnt lgkmcnt(0)
    s_lshl_b32 s88, s88, 16
    v_mov_b32 v110, 0.15915494
    v_mul_f32 v110, s88, v110
    s_mov_b32 s3, 0x7fff7fff
    v_readfirstlane_b32 s44, v110

    s_waitcnt vmcnt(12)
    v_and_b32 v44, s3, v44
    v_and_b32 v45, s3, v45
    v_and_b32 v46, s3, v46
    v_and_b32 v47, s3, v47
    v_and_b32 v48, s3, v48
    v_and_b32 v49, s3, v49
    v_and_b32 v50, s3, v50
    v_and_b32 v51, s3, v51
    v_mov_b32 v53, 0
    v_dot2_f32_bf16 v53, v44, v44, v53
    v_dot2_f32_bf16 v53, v45, v45, v53
    v_dot2_f32_bf16 v53, v46, v46, v53
    v_dot2_f32_bf16 v53, v47, v47, v53
    v_dot2_f32_bf16 v53, v48, v48, v53
    v_dot2_f32_bf16 v53, v49, v49, v53
    v_dot2_f32_bf16 v53, v50, v50, v53
    v_dot2_f32_bf16 v53, v51, v51, v53
    v_pk_max_u16 v44, v44, v45
    v_pk_max_u16 v44, v44, v46
    v_pk_max_u16 v44, v44, v47
    v_pk_max_u16 v44, v44, v48
    v_pk_max_u16 v44, v44, v49
    v_pk_max_u16 v44, v44, v50
    v_pk_max_u16 v44, v44, v51
    v_lshrrev_b32 v52, 16, v44
    v_and_b32 v44, 0xffff, v44
    v_max_u32 v52, v52, v44

    s_nop 1
    v_max_u32_dpp v52, v52, v52 row_shr:1 row_mask:0xf bank_mask:0xf
    s_nop 1
    v_max_u32_dpp v52, v52, v52 row_shr:2 row_mask:0xf bank_mask:0xf
    s_nop 1
    v_max_u32_dpp v52, v52, v52 row_shr:4 row_mask:0xf bank_mask:0xf
    s_nop 1
    v_max_u32_dpp v52, v52, v52 row_shr:8 row_mask:0xf bank_mask:0xf
    s_nop 1
    v_max_u32_dpp v52, v52, v52 row_bcast:15 row_mask:0xa bank_mask:0xf
    s_nop 1
    v_max_u32_dpp v52, v52, v52 row_bcast:31 row_mask:0xc bank_mask:0xf
    s_nop 1
    v_add_f32_dpp v53, v53, v53 row_shr:1 row_mask:0xf bank_mask:0xf
    s_nop 1
    v_add_f32_dpp v53, v53, v53 row_shr:2 row_mask:0xf bank_mask:0xf
    s_nop 1
    v_add_f32_dpp v53, v53, v53 row_shr:4 row_mask:0xf bank_mask:0xf
    s_nop 1
    v_add_f32_dpp v53, v53, v53 row_shr:8 row_mask:0xf bank_mask:0xf
    s_nop 1
    v_add_f32_dpp v53, v53, v53 row_bcast:15 row_mask:0xa bank_mask:0xf
    s_nop 1
    v_add_f32_dpp v53, v53, v53 row_bcast:31 row_mask:0xc bank_mask:0xf
    v_lshrrev_b32 v54, 6, v0
    v_lshlrev_b32 v54, 3, v54
    s_mov_b32 exec_lo, 0
    s_brev_b32 exec_hi, 1
    ds_write_b64 v54, v[52:53] offset:8192
    s_mov_b64 exec, -1
    v_and_b32 v54, 15, v0
    v_lshlrev_b32 v54, 3, v54
    s_waitcnt lgkmcnt(0)
    s_barrier
    ds_read_b64 v[52:53], v54 offset:8192
    s_waitcnt lgkmcnt(0)

    s_nop 1
    v_max_u32_dpp v52, v52, v52 row_ror:1 row_mask:0xf bank_mask:0xf
    v_add_f32_dpp v53, v53, v53 row_ror:1 row_mask:0xf bank_mask:0xf

    s_nop 1
    v_max_u32_dpp v52, v52, v52 row_ror:2 row_mask:0xf bank_mask:0xf
    v_add_f32_dpp v53, v53, v53 row_ror:2 row_mask:0xf bank_mask:0xf

    s_nop 1
    v_max_u32_dpp v52, v52, v52 row_ror:4 row_mask:0xf bank_mask:0xf
    v_add_f32_dpp v53, v53, v53 row_ror:4 row_mask:0xf bank_mask:0xf

    s_nop 1
    v_max_u32_dpp v52, v52, v52 row_ror:8 row_mask:0xf bank_mask:0xf
    v_add_f32_dpp v53, v53, v53 row_ror:8 row_mask:0xf bank_mask:0xf

    s_add_u32 s92, s6, 135168
    s_addc_u32 s93, s7, 0
    s_mov_b32 s94, 2048
    s_mov_b32 s95, 0x20000
    s_lshl_b32 s3, s2, 3
    buffer_store_dwordx2 v[52:53], v98, s[92:95], s3 offen
    v_mov_b32 v99, 1
    buffer_atomic_add v99, v98, s[96:99], 0 offen sc0
    v_mov_b32 v100, 0
    buffer_atomic_add v100, v98, s[96:99], 0 offen offset:128 sc0
    s_waitcnt vmcnt(12)
    s_bitcmp0_b32 s28, 0
    s_cbranch_scc1 L_ska_7
    v_mul_hi_u32_u24 v45, s40, v20
    v_mul_hi_u32_u24 v44, s40, v4
    v_mul_hi_u32_u24 v47, s40, v21
    v_mul_hi_u32_u24 v46, s40, v5
    v_mul_hi_u32_u24 v49, s40, v22
    v_mul_hi_u32_u24 v48, s40, v6
    v_mul_hi_u32_u24 v51, s40, v23
    v_mul_hi_u32_u24 v50, s40, v7
    v_and_b32 v45, -2, v45
    v_mad_u32_u24 v4, v44, s43, v4
    v_and_b32 v76, -4, v44
    v_and_b32 v47, -2, v47
    v_mad_u32_u24 v5, v46, s43, v5
    v_and_b32 v77, -4, v46
    v_and_b32 v49, -2, v49
    v_mad_u32_u24 v6, v48, s43, v6
    v_and_b32 v78, -4, v48
    v_and_b32 v51, -2, v51
    v_mad_u32_u24 v7, v50, s43, v7
    v_and_b32 v79, -4, v50
    v_mad_i32_i24 v20, v45, s42, v20
    v_lshl_add_u32 v45, v76, 5, v45
    v_mad_i32_i24 v21, v47, s42, v21
    v_lshl_add_u32 v47, v77, 5, v47
    v_mad_i32_i24 v22, v49, s42, v22
    v_lshl_add_u32 v49, v78, 5, v49
    v_mad_i32_i24 v23, v51, s42, v23
    v_lshl_add_u32 v51, v79, 5, v51
    v_add_u32 v45, v45, v45
    ds_add_rtn_u32 v76, v45, v104
    v_add_u32 v47, v47, v47
    ds_add_rtn_u32 v77, v47, v104
    v_add_u32 v49, v49, v49
    ds_add_rtn_u32 v78, v49, v104
    v_add_u32 v51, v51, v51
    ds_add_rtn_u32 v79, v51, v104
    v_lshlrev_b32 v110, 16, v36
    v_and_b32 v111, 0xffff0000, v36
    v_lshlrev_b32 v112, 16, v37
    v_and_b32 v113, 0xffff0000, v37
    v_mul_f32 v110, s44, v110
    v_mul_f32 v111, s44, v111
    v_mul_f32 v112, s44, v112
    v_mul_f32 v113, s44, v113
    v_fract_f32 v110, v110
    v_fract_f32 v111, v111
    v_fract_f32 v112, v112
    v_fract_f32 v113, v113
    v_cos_f32 v110, v110
    v_cos_f32 v111, v111
    v_cos_f32 v112, v112
    v_cos_f32 v113, v113
    v_lshl_or_b32 v44, v44, 14, v20
    v_perm_b32 v45, v45, v4, s46
    v_bfe_u32 v4, v4, 8, 5

    v_lshl_or_b32 v46, v46, 14, v21
    v_perm_b32 v47, v47, v5, s46
    v_bfe_u32 v5, v5, 8, 5

    v_lshl_or_b32 v48, v48, 14, v22
    v_perm_b32 v49, v49, v6, s46
    v_bfe_u32 v6, v6, 8, 5

    v_lshl_or_b32 v50, v50, 14, v23
    v_perm_b32 v51, v51, v7, s46
    v_bfe_u32 v7, v7, 8, 5

    v_fmaak_f32 v110, v110, v105, 0x4b400010
    v_fmaak_f32 v111, v111, v105, 0x4b400010
    v_fmaak_f32 v112, v112, v105, 0x4b400010
    v_fmaak_f32 v113, v113, v105, 0x4b400010
    v_sub_u32 v110, v110, v4
    v_sub_u32 v111, v111, v5
    v_sub_u32 v112, v112, v6
    v_sub_u32 v113, v113, v7
    v_bfi_b32 v110, 31, v4, v110
    v_bfi_b32 v111, 31, v5, v111
    v_bfi_b32 v112, 31, v6, v112
    v_bfi_b32 v113, 31, v7, v113
    v_perm_b32 v44, v44, v110, s55
    v_perm_b32 v46, v46, v111, s55
    v_perm_b32 v48, v48, v112, s55
    v_perm_b32 v50, v50, v113, s55
L_ska_7:
    s_waitcnt vmcnt(9)
    s_bitcmp0_b32 s28, 1
    s_cbranch_scc1 L_ska_8
    v_mul_hi_u32_u24 v53, s40, v24
    v_mul_hi_u32_u24 v52, s40, v8
    v_mul_hi_u32_u24 v55, s40, v25
    v_mul_hi_u32_u24 v54, s40, v9
    v_mul_hi_u32_u24 v57, s40, v26
    v_mul_hi_u32_u24 v56, s40, v10
    v_mul_hi_u32_u24 v59, s40, v27
    v_mul_hi_u32_u24 v58, s40, v11
    v_and_b32 v53, -2, v53
    v_mad_u32_u24 v8, v52, s43, v8
    v_and_b32 v80, -4, v52
    v_and_b32 v55, -2, v55
    v_mad_u32_u24 v9, v54, s43, v9
    v_and_b32 v81, -4, v54
    v_and_b32 v57, -2, v57
    v_mad_u32_u24 v10, v56, s43, v10
    v_and_b32 v82, -4, v56
    v_and_b32 v59, -2, v59
    v_mad_u32_u24 v11, v58, s43, v11
    v_and_b32 v83, -4, v58
    v_mad_i32_i24 v24, v53, s42, v24
    v_lshl_add_u32 v53, v80, 5, v53
    v_mad_i32_i24 v25, v55, s42, v25
    v_lshl_add_u32 v55, v81, 5, v55
    v_mad_i32_i24 v26, v57, s42, v26
    v_lshl_add_u32 v57, v82, 5, v57
    v_mad_i32_i24 v27, v59, s42, v27
    v_lshl_add_u32 v59, v83, 5, v59
    v_add_u32 v53, v53, v53
    ds_add_rtn_u32 v80, v53, v104
    v_add_u32 v55, v55, v55
    ds_add_rtn_u32 v81, v55, v104
    v_add_u32 v57, v57, v57
    ds_add_rtn_u32 v82, v57, v104
    v_add_u32 v59, v59, v59
    ds_add_rtn_u32 v83, v59, v104
    v_lshlrev_b32 v110, 16, v38
    v_and_b32 v111, 0xffff0000, v38
    v_lshlrev_b32 v112, 16, v39
    v_and_b32 v113, 0xffff0000, v39
    v_mul_f32 v110, s44, v110
    v_mul_f32 v111, s44, v111
    v_mul_f32 v112, s44, v112
    v_mul_f32 v113, s44, v113
    v_fract_f32 v110, v110
    v_fract_f32 v111, v111
    v_fract_f32 v112, v112
    v_fract_f32 v113, v113
    v_cos_f32 v110, v110
    v_cos_f32 v111, v111
    v_cos_f32 v112, v112
    v_cos_f32 v113, v113
    v_lshl_or_b32 v52, v52, 14, v24
    v_perm_b32 v53, v53, v8, s46
    v_bfe_u32 v8, v8, 8, 5

    v_lshl_or_b32 v54, v54, 14, v25
    v_perm_b32 v55, v55, v9, s46
    v_bfe_u32 v9, v9, 8, 5

    v_lshl_or_b32 v56, v56, 14, v26
    v_perm_b32 v57, v57, v10, s46
    v_bfe_u32 v10, v10, 8, 5

    v_lshl_or_b32 v58, v58, 14, v27
    v_perm_b32 v59, v59, v11, s46
    v_bfe_u32 v11, v11, 8, 5

    v_fmaak_f32 v110, v110, v105, 0x4b400010
    v_fmaak_f32 v111, v111, v105, 0x4b400010
    v_fmaak_f32 v112, v112, v105, 0x4b400010
    v_fmaak_f32 v113, v113, v105, 0x4b400010
    v_sub_u32 v110, v110, v8
    v_sub_u32 v111, v111, v9
    v_sub_u32 v112, v112, v10
    v_sub_u32 v113, v113, v11
    v_bfi_b32 v110, 31, v8, v110
    v_bfi_b32 v111, 31, v9, v111
    v_bfi_b32 v112, 31, v10, v112
    v_bfi_b32 v113, 31, v11, v113
    v_perm_b32 v52, v52, v110, s55
    v_perm_b32 v54, v54, v111, s55
    v_perm_b32 v56, v56, v112, s55
    v_perm_b32 v58, v58, v113, s55
L_ska_8:
    s_waitcnt vmcnt(6)
    s_bitcmp0_b32 s28, 2
    s_cbranch_scc1 L_ska_9
    v_mul_hi_u32_u24 v61, s40, v28
    v_mul_hi_u32_u24 v60, s40, v12
    v_mul_hi_u32_u24 v63, s40, v29
    v_mul_hi_u32_u24 v62, s40, v13
    v_mul_hi_u32_u24 v65, s40, v30
    v_mul_hi_u32_u24 v64, s40, v14
    v_mul_hi_u32_u24 v67, s40, v31
    v_mul_hi_u32_u24 v66, s40, v15
    v_and_b32 v61, -2, v61
    v_mad_u32_u24 v12, v60, s43, v12
    v_and_b32 v84, -4, v60
    v_and_b32 v63, -2, v63
    v_mad_u32_u24 v13, v62, s43, v13
    v_and_b32 v85, -4, v62
    v_and_b32 v65, -2, v65
    v_mad_u32_u24 v14, v64, s43, v14
    v_and_b32 v86, -4, v64
    v_and_b32 v67, -2, v67
    v_mad_u32_u24 v15, v66, s43, v15
    v_and_b32 v87, -4, v66
    v_mad_i32_i24 v28, v61, s42, v28
    v_lshl_add_u32 v61, v84, 5, v61
    v_mad_i32_i24 v29, v63, s42, v29
    v_lshl_add_u32 v63, v85, 5, v63
    v_mad_i32_i24 v30, v65, s42, v30
    v_lshl_add_u32 v65, v86, 5, v65
    v_mad_i32_i24 v31, v67, s42, v31
    v_lshl_add_u32 v67, v87, 5, v67
    v_add_u32 v61, v61, v61
    ds_add_rtn_u32 v84, v61, v104
    v_add_u32 v63, v63, v63
    ds_add_rtn_u32 v85, v63, v104
    v_add_u32 v65, v65, v65
    ds_add_rtn_u32 v86, v65, v104
    v_add_u32 v67, v67, v67
    ds_add_rtn_u32 v87, v67, v104
    v_lshlrev_b32 v110, 16, v40
    v_and_b32 v111, 0xffff0000, v40
    v_lshlrev_b32 v112, 16, v41
    v_and_b32 v113, 0xffff0000, v41
    v_mul_f32 v110, s44, v110
    v_mul_f32 v111, s44, v111
    v_mul_f32 v112, s44, v112
    v_mul_f32 v113, s44, v113
    v_fract_f32 v110, v110
    v_fract_f32 v111, v111
    v_fract_f32 v112, v112
    v_fract_f32 v113, v113
    v_cos_f32 v110, v110
    v_cos_f32 v111, v111
    v_cos_f32 v112, v112
    v_cos_f32 v113, v113
    v_lshl_or_b32 v60, v60, 14, v28
    v_perm_b32 v61, v61, v12, s46
    v_bfe_u32 v12, v12, 8, 5

    v_lshl_or_b32 v62, v62, 14, v29
    v_perm_b32 v63, v63, v13, s46
    v_bfe_u32 v13, v13, 8, 5

    v_lshl_or_b32 v64, v64, 14, v30
    v_perm_b32 v65, v65, v14, s46
    v_bfe_u32 v14, v14, 8, 5

    v_lshl_or_b32 v66, v66, 14, v31
    v_perm_b32 v67, v67, v15, s46
    v_bfe_u32 v15, v15, 8, 5

    v_fmaak_f32 v110, v110, v105, 0x4b400010
    v_fmaak_f32 v111, v111, v105, 0x4b400010
    v_fmaak_f32 v112, v112, v105, 0x4b400010
    v_fmaak_f32 v113, v113, v105, 0x4b400010
    v_sub_u32 v110, v110, v12
    v_sub_u32 v111, v111, v13
    v_sub_u32 v112, v112, v14
    v_sub_u32 v113, v113, v15
    v_bfi_b32 v110, 31, v12, v110
    v_bfi_b32 v111, 31, v13, v111
    v_bfi_b32 v112, 31, v14, v112
    v_bfi_b32 v113, 31, v15, v113
    v_perm_b32 v60, v60, v110, s55
    v_perm_b32 v62, v62, v111, s55
    v_perm_b32 v64, v64, v112, s55
    v_perm_b32 v66, v66, v113, s55
L_ska_9:
    s_waitcnt vmcnt(3)
    s_bitcmp0_b32 s28, 3
    s_cbranch_scc1 L_ska_10
    s_mov_b64 exec, s[66:67]
    v_mul_hi_u32_u24 v69, s40, v32
    v_mul_hi_u32_u24 v68, s40, v16
    v_mul_hi_u32_u24 v71, s40, v33
    v_mul_hi_u32_u24 v70, s40, v17
    v_mul_hi_u32_u24 v73, s40, v34
    v_mul_hi_u32_u24 v72, s40, v18
    v_mul_hi_u32_u24 v75, s40, v35
    v_mul_hi_u32_u24 v74, s40, v19
    v_and_b32 v69, -2, v69
    v_mad_u32_u24 v16, v68, s43, v16
    v_and_b32 v88, -4, v68
    v_and_b32 v71, -2, v71
    v_mad_u32_u24 v17, v70, s43, v17
    v_and_b32 v89, -4, v70
    v_and_b32 v73, -2, v73
    v_mad_u32_u24 v18, v72, s43, v18
    v_and_b32 v90, -4, v72
    v_and_b32 v75, -2, v75
    v_mad_u32_u24 v19, v74, s43, v19
    v_and_b32 v91, -4, v74
    v_mad_i32_i24 v32, v69, s42, v32
    v_lshl_add_u32 v69, v88, 5, v69
    v_mad_i32_i24 v33, v71, s42, v33
    v_lshl_add_u32 v71, v89, 5, v71
    v_mad_i32_i24 v34, v73, s42, v34
    v_lshl_add_u32 v73, v90, 5, v73
    v_mad_i32_i24 v35, v75, s42, v35
    v_lshl_add_u32 v75, v91, 5, v75
    v_add_u32 v69, v69, v69
    ds_add_rtn_u32 v88, v69, v104
    v_add_u32 v71, v71, v71
    ds_add_rtn_u32 v89, v71, v104
    v_add_u32 v73, v73, v73
    ds_add_rtn_u32 v90, v73, v104
    v_add_u32 v75, v75, v75
    ds_add_rtn_u32 v91, v75, v104
    v_lshlrev_b32 v110, 16, v42
    v_and_b32 v111, 0xffff0000, v42
    v_lshlrev_b32 v112, 16, v43
    v_and_b32 v113, 0xffff0000, v43
    v_mul_f32 v110, s44, v110
    v_mul_f32 v111, s44, v111
    v_mul_f32 v112, s44, v112
    v_mul_f32 v113, s44, v113
    v_fract_f32 v110, v110
    v_fract_f32 v111, v111
    v_fract_f32 v112, v112
    v_fract_f32 v113, v113
    v_cos_f32 v110, v110
    v_cos_f32 v111, v111
    v_cos_f32 v112, v112
    v_cos_f32 v113, v113
    v_lshl_or_b32 v68, v68, 14, v32
    v_perm_b32 v69, v69, v16, s46
    v_bfe_u32 v16, v16, 8, 5

    v_lshl_or_b32 v70, v70, 14, v33
    v_perm_b32 v71, v71, v17, s46
    v_bfe_u32 v17, v17, 8, 5

    v_lshl_or_b32 v72, v72, 14, v34
    v_perm_b32 v73, v73, v18, s46
    v_bfe_u32 v18, v18, 8, 5

    v_lshl_or_b32 v74, v74, 14, v35
    v_perm_b32 v75, v75, v19, s46
    v_bfe_u32 v19, v19, 8, 5

    v_fmaak_f32 v110, v110, v105, 0x4b400010
    v_fmaak_f32 v111, v111, v105, 0x4b400010
    v_fmaak_f32 v112, v112, v105, 0x4b400010
    v_fmaak_f32 v113, v113, v105, 0x4b400010
    v_sub_u32 v110, v110, v16
    v_sub_u32 v111, v111, v17
    v_sub_u32 v112, v112, v18
    v_sub_u32 v113, v113, v19
    v_bfi_b32 v110, 31, v16, v110
    v_bfi_b32 v111, 31, v17, v111
    v_bfi_b32 v112, 31, v18, v112
    v_bfi_b32 v113, 31, v19, v113
    v_perm_b32 v68, v68, v110, s55
    v_perm_b32 v70, v70, v111, s55
    v_perm_b32 v72, v72, v112, s55
    v_perm_b32 v74, v74, v113, s55
    s_mov_b64 exec, -1
L_ska_10:
    s_waitcnt vmcnt(0)
    v_or_b32 v100, v100, v0
    s_nop 0
    v_readfirstlane_b32 s74, v100
    s_nop 1
    s_cmp_lg_u32 s74, 0
    s_cbranch_scc1 L_ready_12

    v_mov_b32 v110, 1
    buffer_atomic_add v110, v98, s[96:99], 0 offen offset:64 sc0
    s_waitcnt vmcnt(0)
    v_readfirstlane_b32 s74, v110
    s_nop 1
    s_cmp_lg_u32 s74, 0
    s_cbranch_scc1 L_zno_14

    s_mov_b32 s92, s6
    s_mov_b32 s93, s7
    s_mov_b32 s94, 65552
    s_mov_b32 s95, 0x20000
    v_mov_b32 v110, 0
    v_mov_b32 v111, 0
    v_mov_b32 v112, 0
    v_mov_b32 v113, 0
L_zl_13:
    buffer_store_dwordx4 v[110:113], v1, s[92:95], s74 offen sc0 sc1
    s_add_u32 s74, s74, 1024
    s_cmp_le_u32 s74, 65536
    s_cbranch_scc1 L_zl_13
    v_mov_b32 v114, 1
    s_waitcnt vmcnt(0)
    buffer_atomic_add v114, v98, s[96:99], 0 offen offset:128
L_zno_14:

L_spin_11:
    v_mov_b32 v100, 0
    buffer_atomic_add v100, v98, s[96:99], 0 offen offset:128 sc0
    s_waitcnt vmcnt(0)
    v_readfirstlane_b32 s74, v100
    s_nop 1
    s_cmp_eq_u32 s74, 0
    s_cbranch_scc1 L_spin_11
L_ready_12:

    v_cmp_eq_u32 vcc, 0, v0
    s_waitcnt vmcnt(1)
    s_mov_b64 exec, vcc
    ds_write_b32 v108, v99 offset:8
    s_mov_b64 exec, -1
    s_waitcnt lgkmcnt(0)
    s_barrier

    ds_read2_b32 v[110:111], v108 offset0:1 offset1:2
    ds_read_b64 v[94:95], v2
    s_waitcnt lgkmcnt(0)
    v_readfirstlane_b32 s53, v110
    v_readfirstlane_b32 s41, v111

    v_and_b32 v94, 0xffff, v94
    v_and_b32 v95, 0xffff, v95
    v_add_u32 v97, v94, v95
    s_nop 1
    v_add_u32_dpp v97, v97, v97 row_shr:1 row_mask:0xf bank_mask:0xf
    s_nop 1
    v_add_u32_dpp v97, v97, v97 row_shr:2 row_mask:0xf bank_mask:0xf
    s_nop 1
    v_add_u32_dpp v97, v97, v97 row_shr:4 row_mask:0xf bank_mask:0xf
    s_nop 1
    v_add_u32_dpp v97, v97, v97 row_shr:8 row_mask:0xf bank_mask:0xf
    s_nop 1
    v_add_u32_dpp v97, v97, v97 row_bcast:15 row_mask:0xa bank_mask:0xf
    s_nop 1
    v_add_u32_dpp v97, v97, v97 row_bcast:31 row_mask:0xc bank_mask:0xf
    s_mov_b32 exec_lo, 0
    s_brev_b32 exec_hi, 1
    ds_add_rtn_u32 v96, v108, v97
    s_mov_b64 exec, -1

    v_add_u32 v92, v94, v94
    v_add_u32 v93, v95, v95
    v_med3_u32 v92, v94, 2, v92
    v_med3_u32 v93, v95, 2, v93
    buffer_atomic_add_x2 v[92:93], v2, s[20:23], 0 offen sc0
    s_add_u32 s41, s41, 160
    s_mul_i32 s78, s41, 16000
    s_add_u32 s49, s78, 16000
    s_cmp_ge_u32 s41, 3200
    s_cmovk_i32 s49, 0
    s_cmovk_i32 s78, 0
    s_lshl_b32 s10, s49, 2
    s_lshl_b32 s14, s49, 2
    s_lshl_b32 s18, s49, 1
    s_lshl_b32 s56, s78, 2
    s_lshl_b32 s61, s78, 1

    s_add_u32 s57, s56, 16384
    s_add_u32 s62, s61, 8192
    s_add_u32 s58, s56, 32768
    s_add_u32 s63, s61, 16384
    s_add_u32 s59, s56, 49152
    s_add_u32 s64, s61, 24576
    s_waitcnt lgkmcnt(0)
    v_readlane_b32 s77, v96, 63
    v_mul_u32_u24 v114, 7936, v0
    v_sub_u32 v97, v97, v95
    s_sub_u32 s77, s77, s50
    v_add_u32 v97, s77, v97
    v_sub_u32 v96, v97, v94
    v_lshlrev_b32 v111, 16, v97
    v_lshlrev_b32 v110, 16, v96
    ds_write_b64 v2, v[110:111]
    v_sub_u32 v96, v114, v96
    v_sub_u32 v97, v114, v97
    v_add_u32 v97, s48, v97
    s_add_u32 s50, s50, s30

    s_waitcnt lgkmcnt(0)
    s_barrier

    buffer_load_dwordx4 v[20:23], v1, s[12:15], s56 offen nt
    buffer_load_dwordx4 v[4:7], v1, s[8:11], s56 offen nt
    buffer_load_dwordx2 v[36:37], v2, s[16:19], s61 offen nt
    buffer_load_dwordx4 v[24:27], v1, s[12:15], s57 offen nt
    buffer_load_dwordx4 v[8:11], v1, s[8:11], s57 offen nt
    buffer_load_dwordx2 v[38:39], v2, s[16:19], s62 offen nt
    buffer_load_dwordx4 v[28:31], v1, s[12:15], s58 offen nt
    buffer_load_dwordx4 v[12:15], v1, s[8:11], s58 offen nt
    buffer_load_dwordx2 v[40:41], v2, s[16:19], s63 offen nt
    buffer_load_dwordx4 v[32:35], v1, s[12:15], s59 offen nt
    buffer_load_dwordx4 v[16:19], v1, s[8:11], s59 offen nt
    buffer_load_dwordx2 v[42:43], v2, s[16:19], s64 offen nt
    s_bitcmp0_b32 s28, 0
    s_cbranch_scc1 L_skz_15
    v_lshrrev_b32 v110, 16, v45
    ds_read_b32 v110, v110
    v_lshrrev_b32 v111, 16, v47
    ds_read_b32 v111, v111
    v_lshrrev_b32 v112, 16, v49
    ds_read_b32 v112, v112
    v_lshrrev_b32 v113, 16, v51
    ds_read_b32 v113, v113
    s_waitcnt lgkmcnt(3)
    v_add_u32_sdwa v110, v110, v76 dst_sel:DWORD dst_unused:UNUSED_PAD src0_sel:WORD_1 src1_sel:WORD_0
    v_lshlrev_b32 v110, 3, v110
    ds_write_b64 v110, v[44:45] offset:16400

    s_waitcnt lgkmcnt(3)
    v_add_u32_sdwa v111, v111, v77 dst_sel:DWORD dst_unused:UNUSED_PAD src0_sel:WORD_1 src1_sel:WORD_0
    v_lshlrev_b32 v111, 3, v111
    ds_write_b64 v111, v[46:47] offset:16400

    s_waitcnt lgkmcnt(3)
    v_add_u32_sdwa v112, v112, v78 dst_sel:DWORD dst_unused:UNUSED_PAD src0_sel:WORD_1 src1_sel:WORD_0
    v_lshlrev_b32 v112, 3, v112
    ds_write_b64 v112, v[48:49] offset:16400

    s_waitcnt lgkmcnt(3)
    v_add_u32_sdwa v113, v113, v79 dst_sel:DWORD dst_unused:UNUSED_PAD src0_sel:WORD_1 src1_sel:WORD_0
    v_lshlrev_b32 v113, 3, v113
    ds_write_b64 v113, v[50:51] offset:16400

L_skz_15:
    s_bitcmp0_b32 s28, 1
    s_cbranch_scc1 L_skz_16
    v_lshrrev_b32 v110, 16, v53
    ds_read_b32 v110, v110
    v_lshrrev_b32 v111, 16, v55
    ds_read_b32 v111, v111
    v_lshrrev_b32 v112, 16, v57
    ds_read_b32 v112, v112
    v_lshrrev_b32 v113, 16, v59
    ds_read_b32 v113, v113
    s_waitcnt lgkmcnt(3)
    v_add_u32_sdwa v110, v110, v80 dst_sel:DWORD dst_unused:UNUSED_PAD src0_sel:WORD_1 src1_sel:WORD_0
    v_lshlrev_b32 v110, 3, v110
    ds_write_b64 v110, v[52:53] offset:16400

    s_waitcnt lgkmcnt(3)
    v_add_u32_sdwa v111, v111, v81 dst_sel:DWORD dst_unused:UNUSED_PAD src0_sel:WORD_1 src1_sel:WORD_0
    v_lshlrev_b32 v111, 3, v111
    ds_write_b64 v111, v[54:55] offset:16400

    s_waitcnt lgkmcnt(3)
    v_add_u32_sdwa v112, v112, v82 dst_sel:DWORD dst_unused:UNUSED_PAD src0_sel:WORD_1 src1_sel:WORD_0
    v_lshlrev_b32 v112, 3, v112
    ds_write_b64 v112, v[56:57] offset:16400

    s_waitcnt lgkmcnt(3)
    v_add_u32_sdwa v113, v113, v83 dst_sel:DWORD dst_unused:UNUSED_PAD src0_sel:WORD_1 src1_sel:WORD_0
    v_lshlrev_b32 v113, 3, v113
    ds_write_b64 v113, v[58:59] offset:16400

L_skz_16:
    s_bitcmp0_b32 s28, 2
    s_cbranch_scc1 L_skz_17
    v_lshrrev_b32 v110, 16, v61
    ds_read_b32 v110, v110
    v_lshrrev_b32 v111, 16, v63
    ds_read_b32 v111, v111
    v_lshrrev_b32 v112, 16, v65
    ds_read_b32 v112, v112
    v_lshrrev_b32 v113, 16, v67
    ds_read_b32 v113, v113
    s_waitcnt lgkmcnt(3)
    v_add_u32_sdwa v110, v110, v84 dst_sel:DWORD dst_unused:UNUSED_PAD src0_sel:WORD_1 src1_sel:WORD_0
    v_lshlrev_b32 v110, 3, v110
    ds_write_b64 v110, v[60:61] offset:16400

    s_waitcnt lgkmcnt(3)
    v_add_u32_sdwa v111, v111, v85 dst_sel:DWORD dst_unused:UNUSED_PAD src0_sel:WORD_1 src1_sel:WORD_0
    v_lshlrev_b32 v111, 3, v111
    ds_write_b64 v111, v[62:63] offset:16400

    s_waitcnt lgkmcnt(3)
    v_add_u32_sdwa v112, v112, v86 dst_sel:DWORD dst_unused:UNUSED_PAD src0_sel:WORD_1 src1_sel:WORD_0
    v_lshlrev_b32 v112, 3, v112
    ds_write_b64 v112, v[64:65] offset:16400

    s_waitcnt lgkmcnt(3)
    v_add_u32_sdwa v113, v113, v87 dst_sel:DWORD dst_unused:UNUSED_PAD src0_sel:WORD_1 src1_sel:WORD_0
    v_lshlrev_b32 v113, 3, v113
    ds_write_b64 v113, v[66:67] offset:16400

L_skz_17:
    s_bitcmp0_b32 s28, 3
    s_cbranch_scc1 L_skz_18
    s_mov_b64 exec, s[66:67]
    v_lshrrev_b32 v110, 16, v69
    ds_read_b32 v110, v110
    v_lshrrev_b32 v111, 16, v71
    ds_read_b32 v111, v111
    v_lshrrev_b32 v112, 16, v73
    ds_read_b32 v112, v112
    v_lshrrev_b32 v113, 16, v75
    ds_read_b32 v113, v113
    s_waitcnt lgkmcnt(3)
    v_add_u32_sdwa v110, v110, v88 dst_sel:DWORD dst_unused:UNUSED_PAD src0_sel:WORD_1 src1_sel:WORD_0
    v_lshlrev_b32 v110, 3, v110
    ds_write_b64 v110, v[68:69] offset:16400

    s_waitcnt lgkmcnt(3)
    v_add_u32_sdwa v111, v111, v89 dst_sel:DWORD dst_unused:UNUSED_PAD src0_sel:WORD_1 src1_sel:WORD_0
    v_lshlrev_b32 v111, 3, v111
    ds_write_b64 v111, v[70:71] offset:16400

    s_waitcnt lgkmcnt(3)
    v_add_u32_sdwa v112, v112, v90 dst_sel:DWORD dst_unused:UNUSED_PAD src0_sel:WORD_1 src1_sel:WORD_0
    v_lshlrev_b32 v112, 3, v112
    ds_write_b64 v112, v[72:73] offset:16400

    s_waitcnt lgkmcnt(3)
    v_add_u32_sdwa v113, v113, v91 dst_sel:DWORD dst_unused:UNUSED_PAD src0_sel:WORD_1 src1_sel:WORD_0
    v_lshlrev_b32 v113, 3, v113
    ds_write_b64 v113, v[74:75] offset:16400

    s_mov_b64 exec, -1
L_skz_18:
    s_cmp_eq_u32 s49, 0
    s_cbranch_scc1 L_p1epi_6
L_p1loop_5:
    v_mov_b32 v99, 1
    buffer_atomic_add v99, v98, s[96:99], 0 offen sc0
    s_waitcnt vmcnt(10)
    v_mul_hi_u32_u24 v45, s40, v20
    v_mul_hi_u32_u24 v44, s40, v4
    v_mul_hi_u32_u24 v47, s40, v21
    v_mul_hi_u32_u24 v46, s40, v5
    v_mul_hi_u32_u24 v49, s40, v22
    v_mul_hi_u32_u24 v48, s40, v6
    v_mul_hi_u32_u24 v51, s40, v23
    v_mul_hi_u32_u24 v50, s40, v7
    v_and_b32 v45, -2, v45
    v_mad_u32_u24 v4, v44, s43, v4
    v_and_b32 v76, -4, v44
    v_and_b32 v47, -2, v47
    v_mad_u32_u24 v5, v46, s43, v5
    v_and_b32 v77, -4, v46
    v_and_b32 v49, -2, v49
    v_mad_u32_u24 v6, v48, s43, v6
    v_and_b32 v78, -4, v48
    v_and_b32 v51, -2, v51
    v_mad_u32_u24 v7, v50, s43, v7
    v_and_b32 v79, -4, v50
    v_mad_i32_i24 v20, v45, s42, v20
    v_lshl_add_u32 v45, v76, 5, v45
    v_mad_i32_i24 v21, v47, s42, v21
    v_lshl_add_u32 v47, v77, 5, v47
    v_mad_i32_i24 v22, v49, s42, v22
    v_lshl_add_u32 v49, v78, 5, v49
    v_mad_i32_i24 v23, v51, s42, v23
    v_lshl_add_u32 v51, v79, 5, v51
    v_add_u32 v45, v45, v45
    ds_add_rtn_u32 v76, v45, v104
    v_add_u32 v47, v47, v47
    ds_add_rtn_u32 v77, v47, v104
    v_add_u32 v49, v49, v49
    ds_add_rtn_u32 v78, v49, v104
    v_add_u32 v51, v51, v51
    ds_add_rtn_u32 v79, v51, v104
    v_lshlrev_b32 v110, 16, v36
    v_and_b32 v111, 0xffff0000, v36
    v_lshlrev_b32 v112, 16, v37
    v_and_b32 v113, 0xffff0000, v37
    v_mul_f32 v110, s44, v110
    v_mul_f32 v111, s44, v111
    v_mul_f32 v112, s44, v112
    v_mul_f32 v113, s44, v113
    v_fract_f32 v110, v110
    v_fract_f32 v111, v111
    v_fract_f32 v112, v112
    v_fract_f32 v113, v113
    v_cos_f32 v110, v110
    v_cos_f32 v111, v111
    v_cos_f32 v112, v112
    v_cos_f32 v113, v113
    v_lshl_or_b32 v44, v44, 14, v20
    v_perm_b32 v45, v45, v4, s46
    v_bfe_u32 v4, v4, 8, 5

    v_lshl_or_b32 v46, v46, 14, v21
    v_perm_b32 v47, v47, v5, s46
    v_bfe_u32 v5, v5, 8, 5

    v_lshl_or_b32 v48, v48, 14, v22
    v_perm_b32 v49, v49, v6, s46
    v_bfe_u32 v6, v6, 8, 5

    v_lshl_or_b32 v50, v50, 14, v23
    v_perm_b32 v51, v51, v7, s46
    v_bfe_u32 v7, v7, 8, 5

    v_fmaak_f32 v110, v110, v105, 0x4b400010
    v_fmaak_f32 v111, v111, v105, 0x4b400010
    v_fmaak_f32 v112, v112, v105, 0x4b400010
    v_fmaak_f32 v113, v113, v105, 0x4b400010
    v_sub_u32 v110, v110, v4
    v_sub_u32 v111, v111, v5
    v_sub_u32 v112, v112, v6
    v_sub_u32 v113, v113, v7
    v_bfi_b32 v110, 31, v4, v110
    v_bfi_b32 v111, 31, v5, v111
    v_bfi_b32 v112, 31, v6, v112
    v_bfi_b32 v113, 31, v7, v113
    v_perm_b32 v44, v44, v110, s55
    v_perm_b32 v46, v46, v111, s55
    v_perm_b32 v48, v48, v112, s55
    v_perm_b32 v50, v50, v113, s55
    s_waitcnt vmcnt(7)
    v_mul_hi_u32_u24 v53, s40, v24
    v_mul_hi_u32_u24 v52, s40, v8
    v_mul_hi_u32_u24 v55, s40, v25
    v_mul_hi_u32_u24 v54, s40, v9
    v_mul_hi_u32_u24 v57, s40, v26
    v_mul_hi_u32_u24 v56, s40, v10
    v_mul_hi_u32_u24 v59, s40, v27
    v_mul_hi_u32_u24 v58, s40, v11
    v_and_b32 v53, -2, v53
    v_mad_u32_u24 v8, v52, s43, v8
    v_and_b32 v80, -4, v52
    v_and_b32 v55, -2, v55
    v_mad_u32_u24 v9, v54, s43, v9
    v_and_b32 v81, -4, v54
    v_and_b32 v57, -2, v57
    v_mad_u32_u24 v10, v56, s43, v10
    v_and_b32 v82, -4, v56
    v_and_b32 v59, -2, v59
    v_mad_u32_u24 v11, v58, s43, v11
    v_and_b32 v83, -4, v58
    v_mad_i32_i24 v24, v53, s42, v24
    v_lshl_add_u32 v53, v80, 5, v53
    v_mad_i32_i24 v25, v55, s42, v25
    v_lshl_add_u32 v55, v81, 5, v55
    v_mad_i32_i24 v26, v57, s42, v26
    v_lshl_add_u32 v57, v82, 5, v57
    v_mad_i32_i24 v27, v59, s42, v27
    v_lshl_add_u32 v59, v83, 5, v59
    v_add_u32 v53, v53, v53
    ds_add_rtn_u32 v80, v53, v104
    v_add_u32 v55, v55, v55
    ds_add_rtn_u32 v81, v55, v104
    v_add_u32 v57, v57, v57
    ds_add_rtn_u32 v82, v57, v104
    v_add_u32 v59, v59, v59
    ds_add_rtn_u32 v83, v59, v104
    v_lshlrev_b32 v110, 16, v38
    v_and_b32 v111, 0xffff0000, v38
    v_lshlrev_b32 v112, 16, v39
    v_and_b32 v113, 0xffff0000, v39
    v_mul_f32 v110, s44, v110
    v_mul_f32 v111, s44, v111
    v_mul_f32 v112, s44, v112
    v_mul_f32 v113, s44, v113
    v_fract_f32 v110, v110
    v_fract_f32 v111, v111
    v_fract_f32 v112, v112
    v_fract_f32 v113, v113
    v_cos_f32 v110, v110
    v_cos_f32 v111, v111
    v_cos_f32 v112, v112
    v_cos_f32 v113, v113
    v_lshl_or_b32 v52, v52, 14, v24
    v_perm_b32 v53, v53, v8, s46
    v_bfe_u32 v8, v8, 8, 5

    v_lshl_or_b32 v54, v54, 14, v25
    v_perm_b32 v55, v55, v9, s46
    v_bfe_u32 v9, v9, 8, 5

    v_lshl_or_b32 v56, v56, 14, v26
    v_perm_b32 v57, v57, v10, s46
    v_bfe_u32 v10, v10, 8, 5

    v_lshl_or_b32 v58, v58, 14, v27
    v_perm_b32 v59, v59, v11, s46
    v_bfe_u32 v11, v11, 8, 5

    v_fmaak_f32 v110, v110, v105, 0x4b400010
    v_fmaak_f32 v111, v111, v105, 0x4b400010
    v_fmaak_f32 v112, v112, v105, 0x4b400010
    v_fmaak_f32 v113, v113, v105, 0x4b400010
    v_sub_u32 v110, v110, v8
    v_sub_u32 v111, v111, v9
    v_sub_u32 v112, v112, v10
    v_sub_u32 v113, v113, v11
    v_bfi_b32 v110, 31, v8, v110
    v_bfi_b32 v111, 31, v9, v111
    v_bfi_b32 v112, 31, v10, v112
    v_bfi_b32 v113, 31, v11, v113
    v_perm_b32 v52, v52, v110, s55
    v_perm_b32 v54, v54, v111, s55
    v_perm_b32 v56, v56, v112, s55
    v_perm_b32 v58, v58, v113, s55
    s_waitcnt vmcnt(4)
    v_mul_hi_u32_u24 v61, s40, v28
    v_mul_hi_u32_u24 v60, s40, v12
    v_mul_hi_u32_u24 v63, s40, v29
    v_mul_hi_u32_u24 v62, s40, v13
    v_mul_hi_u32_u24 v65, s40, v30
    v_mul_hi_u32_u24 v64, s40, v14
    v_mul_hi_u32_u24 v67, s40, v31
    v_mul_hi_u32_u24 v66, s40, v15
    v_and_b32 v61, -2, v61
    v_mad_u32_u24 v12, v60, s43, v12
    v_and_b32 v84, -4, v60
    v_and_b32 v63, -2, v63
    v_mad_u32_u24 v13, v62, s43, v13
    v_and_b32 v85, -4, v62
    v_and_b32 v65, -2, v65
    v_mad_u32_u24 v14, v64, s43, v14
    v_and_b32 v86, -4, v64
    v_and_b32 v67, -2, v67
    v_mad_u32_u24 v15, v66, s43, v15
    v_and_b32 v87, -4, v66
    v_mad_i32_i24 v28, v61, s42, v28
    v_lshl_add_u32 v61, v84, 5, v61
    v_mad_i32_i24 v29, v63, s42, v29
    v_lshl_add_u32 v63, v85, 5, v63
    v_mad_i32_i24 v30, v65, s42, v30
    v_lshl_add_u32 v65, v86, 5, v65
    v_mad_i32_i24 v31, v67, s42, v31
    v_lshl_add_u32 v67, v87, 5, v67
    v_add_u32 v61, v61, v61
    ds_add_rtn_u32 v84, v61, v104
    v_add_u32 v63, v63, v63
    ds_add_rtn_u32 v85, v63, v104
    v_add_u32 v65, v65, v65
    ds_add_rtn_u32 v86, v65, v104
    v_add_u32 v67, v67, v67
    ds_add_rtn_u32 v87, v67, v104
    v_lshlrev_b32 v110, 16, v40
    v_and_b32 v111, 0xffff0000, v40
    v_lshlrev_b32 v112, 16, v41
    v_and_b32 v113, 0xffff0000, v41
    v_mul_f32 v110, s44, v110
    v_mul_f32 v111, s44, v111
    v_mul_f32 v112, s44, v112
    v_mul_f32 v113, s44, v113
    v_fract_f32 v110, v110
    v_fract_f32 v111, v111
    v_fract_f32 v112, v112
    v_fract_f32 v113, v113
    v_cos_f32 v110, v110
    v_cos_f32 v111, v111
    v_cos_f32 v112, v112
    v_cos_f32 v113, v113
    v_lshl_or_b32 v60, v60, 14, v28
    v_perm_b32 v61, v61, v12, s46
    v_bfe_u32 v12, v12, 8, 5

    v_lshl_or_b32 v62, v62, 14, v29
    v_perm_b32 v63, v63, v13, s46
    v_bfe_u32 v13, v13, 8, 5

    v_lshl_or_b32 v64, v64, 14, v30
    v_perm_b32 v65, v65, v14, s46
    v_bfe_u32 v14, v14, 8, 5

    v_lshl_or_b32 v66, v66, 14, v31
    v_perm_b32 v67, v67, v15, s46
    v_bfe_u32 v15, v15, 8, 5

    v_fmaak_f32 v110, v110, v105, 0x4b400010
    v_fmaak_f32 v111, v111, v105, 0x4b400010
    v_fmaak_f32 v112, v112, v105, 0x4b400010
    v_fmaak_f32 v113, v113, v105, 0x4b400010
    v_sub_u32 v110, v110, v12
    v_sub_u32 v111, v111, v13
    v_sub_u32 v112, v112, v14
    v_sub_u32 v113, v113, v15
    v_bfi_b32 v110, 31, v12, v110
    v_bfi_b32 v111, 31, v13, v111
    v_bfi_b32 v112, 31, v14, v112
    v_bfi_b32 v113, 31, v15, v113
    v_perm_b32 v60, v60, v110, s55
    v_perm_b32 v62, v62, v111, s55
    v_perm_b32 v64, v64, v112, s55
    v_perm_b32 v66, v66, v113, s55
    s_waitcnt vmcnt(1)
    s_mov_b64 exec, s[66:67]
    v_mul_hi_u32_u24 v69, s40, v32
    v_mul_hi_u32_u24 v68, s40, v16
    v_mul_hi_u32_u24 v71, s40, v33
    v_mul_hi_u32_u24 v70, s40, v17
    v_mul_hi_u32_u24 v73, s40, v34
    v_mul_hi_u32_u24 v72, s40, v18
    v_mul_hi_u32_u24 v75, s40, v35
    v_mul_hi_u32_u24 v74, s40, v19
    v_and_b32 v69, -2, v69
    v_mad_u32_u24 v16, v68, s43, v16
    v_and_b32 v88, -4, v68
    v_and_b32 v71, -2, v71
    v_mad_u32_u24 v17, v70, s43, v17
    v_and_b32 v89, -4, v70
    v_and_b32 v73, -2, v73
    v_mad_u32_u24 v18, v72, s43, v18
    v_and_b32 v90, -4, v72
    v_and_b32 v75, -2, v75
    v_mad_u32_u24 v19, v74, s43, v19
    v_and_b32 v91, -4, v74
    v_mad_i32_i24 v32, v69, s42, v32
    v_lshl_add_u32 v69, v88, 5, v69
    v_mad_i32_i24 v33, v71, s42, v33
    v_lshl_add_u32 v71, v89, 5, v71
    v_mad_i32_i24 v34, v73, s42, v34
    v_lshl_add_u32 v73, v90, 5, v73
    v_mad_i32_i24 v35, v75, s42, v35
    v_lshl_add_u32 v75, v91, 5, v75
    v_add_u32 v69, v69, v69
    ds_add_rtn_u32 v88, v69, v104
    v_add_u32 v71, v71, v71
    ds_add_rtn_u32 v89, v71, v104
    v_add_u32 v73, v73, v73
    ds_add_rtn_u32 v90, v73, v104
    v_add_u32 v75, v75, v75
    ds_add_rtn_u32 v91, v75, v104
    v_lshlrev_b32 v110, 16, v42
    v_and_b32 v111, 0xffff0000, v42
    v_lshlrev_b32 v112, 16, v43
    v_and_b32 v113, 0xffff0000, v43
    v_mul_f32 v110, s44, v110
    v_mul_f32 v111, s44, v111
    v_mul_f32 v112, s44, v112
    v_mul_f32 v113, s44, v113
    v_fract_f32 v110, v110
    v_fract_f32 v111, v111
    v_fract_f32 v112, v112
    v_fract_f32 v113, v113
    v_cos_f32 v110, v110
    v_cos_f32 v111, v111
    v_cos_f32 v112, v112
    v_cos_f32 v113, v113
    v_lshl_or_b32 v68, v68, 14, v32
    v_perm_b32 v69, v69, v16, s46
    v_bfe_u32 v16, v16, 8, 5

    v_lshl_or_b32 v70, v70, 14, v33
    v_perm_b32 v71, v71, v17, s46
    v_bfe_u32 v17, v17, 8, 5

    v_lshl_or_b32 v72, v72, 14, v34
    v_perm_b32 v73, v73, v18, s46
    v_bfe_u32 v18, v18, 8, 5

    v_lshl_or_b32 v74, v74, 14, v35
    v_perm_b32 v75, v75, v19, s46
    v_bfe_u32 v19, v19, 8, 5

    v_fmaak_f32 v110, v110, v105, 0x4b400010
    v_fmaak_f32 v111, v111, v105, 0x4b400010
    v_fmaak_f32 v112, v112, v105, 0x4b400010
    v_fmaak_f32 v113, v113, v105, 0x4b400010
    v_sub_u32 v110, v110, v16
    v_sub_u32 v111, v111, v17
    v_sub_u32 v112, v112, v18
    v_sub_u32 v113, v113, v19
    v_bfi_b32 v110, 31, v16, v110
    v_bfi_b32 v111, 31, v17, v111
    v_bfi_b32 v112, 31, v18, v112
    v_bfi_b32 v113, 31, v19, v113
    v_perm_b32 v68, v68, v110, s55
    v_perm_b32 v70, v70, v111, s55
    v_perm_b32 v72, v72, v112, s55
    v_perm_b32 v74, v74, v113, s55
    s_mov_b64 exec, -1
    s_waitcnt vmcnt(13)
    v_add_u32 v110, v92, v94
    v_min_u32 v92, s48, v92
    v_add_u32 v111, v93, v95
    v_min_u32 v93, s48, v93
    v_max_u32 v110, v110, v111
    v_add_u32 v92, v92, v96
    v_add_u32 v93, v93, v97
    v_cmp_le_u32 vcc, s48, v110
    v_lshl_add_u32 v92, v92, 2, v92
    v_lshl_add_u32 v93, v93, 2, v93
    ds_write_b64 v2, v[92:93] offset:8192
    s_cbranch_vccz L_noov_23
    ds_write_b32 v108, v104 offset:4
L_noov_23:

    v_cmp_eq_u32 vcc, 0, v0
    s_waitcnt vmcnt(0)
    s_mov_b64 exec, vcc
    ds_write_b32 v108, v99 offset:8
    s_mov_b64 exec, -1
    s_waitcnt lgkmcnt(0)
    s_barrier

    ds_read2_b32 v[110:111], v108 offset0:1 offset1:2
    ds_read_b64 v[94:95], v2
    s_waitcnt lgkmcnt(0)
    v_readfirstlane_b32 s53, v110
    v_readfirstlane_b32 s41, v111

    v_and_b32 v94, 0xffff, v94
    v_and_b32 v95, 0xffff, v95
    v_add_u32 v97, v94, v95
    s_nop 1
    v_add_u32_dpp v97, v97, v97 row_shr:1 row_mask:0xf bank_mask:0xf
    s_nop 1
    v_add_u32_dpp v97, v97, v97 row_shr:2 row_mask:0xf bank_mask:0xf
    s_nop 1
    v_add_u32_dpp v97, v97, v97 row_shr:4 row_mask:0xf bank_mask:0xf
    s_nop 1
    v_add_u32_dpp v97, v97, v97 row_shr:8 row_mask:0xf bank_mask:0xf
    s_nop 1
    v_add_u32_dpp v97, v97, v97 row_bcast:15 row_mask:0xa bank_mask:0xf
    s_nop 1
    v_add_u32_dpp v97, v97, v97 row_bcast:31 row_mask:0xc bank_mask:0xf
    s_mov_b32 exec_lo, 0
    s_brev_b32 exec_hi, 1
    ds_add_rtn_u32 v96, v108, v97
    s_mov_b64 exec, -1

    s_cmp_lg_u32 s53, 0
    s_cbranch_scc1 L_slow_24
    s_bitcmp0_b32 s28, 0
    s_cbranch_scc1 L_skw_29
    ds_read_b64 v[4:5], v2 offset:16400
    ds_read_b64 v[6:7], v2 offset:16408
    ds_read_b64 v[8:9], v2 offset:16392

    ds_read_b64 v[10:11], v2 offset:24592
    ds_read_b64 v[12:13], v2 offset:24600
    ds_read_b64 v[14:15], v2 offset:24584

    ds_read_b64 v[16:17], v2 offset:32784
    ds_read_b64 v[18:19], v2 offset:32792
    ds_read_b64 v[20:21], v2 offset:32776

    ds_read_b64 v[22:23], v2 offset:40976
    ds_read_b64 v[24:25], v2 offset:40984
    ds_read_b64 v[26:27], v2 offset:40968

    s_waitcnt lgkmcnt(9)
    v_lshrrev_b32 v28, 16, v5
    ds_read_b32 v28, v28 offset:8192

    s_waitcnt lgkmcnt(7)
    v_lshrrev_b32 v29, 16, v11
    ds_read_b32 v29, v29 offset:8192

    s_waitcnt lgkmcnt(5)
    v_lshrrev_b32 v30, 16, v17
    ds_read_b32 v30, v30 offset:8192

    s_waitcnt lgkmcnt(3)
    v_lshrrev_b32 v31, 16, v23
    ds_read_b32 v31, v31 offset:8192

    v_cmp_ne_u32_sdwa s[80:81], v5, v7 src0_sel:WORD_1 src1_sel:WORD_1
    v_cmp_ne_u32_sdwa vcc, v5, v9 src0_sel:WORD_1 src1_sel:WORD_1
    v_perm_b32 v5, v6, v5, s45
    s_mov_b32 s54, 0
    v_alignbyte_b32 v8, v9, v8, 2
    s_waitcnt lgkmcnt(3)
    v_add3_u32 v28, v28, v106, s54

    s_and_b64 exec, vcc, s[80:81]
    v_and_b32 v5, 0xff, v5
    s_andn2_b64 exec, s[80:81], vcc
    v_alignbyte_b32 v5, v5, v4, 1
    v_perm_b32 v4, v4, v8, s47
    v_subrev_u32 v28, 3, v28
    s_mov_b64 exec, -1

    buffer_store_dwordx2 v[4:5], v28, s[24:27], 0 offen
    v_cmp_ne_u32_sdwa s[80:81], v11, v13 src0_sel:WORD_1 src1_sel:WORD_1
    v_cmp_ne_u32_sdwa vcc, v11, v15 src0_sel:WORD_1 src1_sel:WORD_1
    v_perm_b32 v11, v12, v11, s45
    s_mov_b32 s54, 5120
    v_alignbyte_b32 v14, v15, v14, 2
    s_waitcnt lgkmcnt(2)
    v_add3_u32 v29, v29, v106, s54

    s_and_b64 exec, vcc, s[80:81]
    v_and_b32 v11, 0xff, v11
    s_andn2_b64 exec, s[80:81], vcc
    v_alignbyte_b32 v11, v11, v10, 1
    v_perm_b32 v10, v10, v14, s47
    v_subrev_u32 v29, 3, v29
    s_mov_b64 exec, -1

    buffer_store_dwordx2 v[10:11], v29, s[24:27], 0 offen
    v_cmp_ne_u32_sdwa s[80:81], v17, v19 src0_sel:WORD_1 src1_sel:WORD_1
    v_cmp_ne_u32_sdwa vcc, v17, v21 src0_sel:WORD_1 src1_sel:WORD_1
    v_perm_b32 v17, v18, v17, s45
    s_mov_b32 s54, 10240
    v_alignbyte_b32 v20, v21, v20, 2
    s_waitcnt lgkmcnt(1)
    v_add3_u32 v30, v30, v106, s54

    s_and_b64 exec, vcc, s[80:81]
    v_and_b32 v17, 0xff, v17
    s_andn2_b64 exec, s[80:81], vcc
    v_alignbyte_b32 v17, v17, v16, 1
    v_perm_b32 v16, v16, v20, s47
    v_subrev_u32 v30, 3, v30
    s_mov_b64 exec, -1

    buffer_store_dwordx2 v[16:17], v30, s[24:27], 0 offen
    v_cmp_ne_u32_sdwa s[80:81], v23, v25 src0_sel:WORD_1 src1_sel:WORD_1
    v_cmp_ne_u32_sdwa vcc, v23, v27 src0_sel:WORD_1 src1_sel:WORD_1
    v_perm_b32 v23, v24, v23, s45
    s_mov_b32 s54, 15360
    v_alignbyte_b32 v26, v27, v26, 2
    s_waitcnt lgkmcnt(0)
    v_add3_u32 v31, v31, v106, s54

    s_and_b64 exec, vcc, s[80:81]
    v_and_b32 v23, 0xff, v23
    s_andn2_b64 exec, s[80:81], vcc
    v_alignbyte_b32 v23, v23, v22, 1
    v_perm_b32 v22, v22, v26, s47
    v_subrev_u32 v31, 3, v31
    s_mov_b64 exec, -1

    buffer_store_dwordx2 v[22:23], v31, s[24:27], 0 offen
L_skw_29:
    s_bitcmp0_b32 s28, 1
    s_cbranch_scc1 L_skw_30
    v_add_u32 v107, 32768, v2
    ds_read_b64 v[4:5], v107 offset:16400
    ds_read_b64 v[6:7], v107 offset:16408
    ds_read_b64 v[8:9], v107 offset:16392

    ds_read_b64 v[10:11], v107 offset:24592
    ds_read_b64 v[12:13], v107 offset:24600
    ds_read_b64 v[14:15], v107 offset:24584

    ds_read_b64 v[16:17], v107 offset:32784
    ds_read_b64 v[18:19], v107 offset:32792
    ds_read_b64 v[20:21], v107 offset:32776

    ds_read_b64 v[22:23], v107 offset:40976
    ds_read_b64 v[24:25], v107 offset:40984
    ds_read_b64 v[26:27], v107 offset:40968

    s_waitcnt lgkmcnt(9)
    v_lshrrev_b32 v28, 16, v5
    ds_read_b32 v28, v28 offset:8192

    s_waitcnt lgkmcnt(7)
    v_lshrrev_b32 v29, 16, v11
    ds_read_b32 v29, v29 offset:8192

    s_waitcnt lgkmcnt(5)
    v_lshrrev_b32 v30, 16, v17
    ds_read_b32 v30, v30 offset:8192

    s_waitcnt lgkmcnt(3)
    v_lshrrev_b32 v31, 16, v23
    ds_read_b32 v31, v31 offset:8192

    v_cmp_ne_u32_sdwa s[80:81], v5, v7 src0_sel:WORD_1 src1_sel:WORD_1
    v_cmp_ne_u32_sdwa vcc, v5, v9 src0_sel:WORD_1 src1_sel:WORD_1
    v_perm_b32 v5, v6, v5, s45
    s_mov_b32 s54, 20480
    v_alignbyte_b32 v8, v9, v8, 2
    s_waitcnt lgkmcnt(3)
    v_add3_u32 v28, v28, v106, s54

    s_and_b64 exec, vcc, s[80:81]
    v_and_b32 v5, 0xff, v5
    s_andn2_b64 exec, s[80:81], vcc
    v_alignbyte_b32 v5, v5, v4, 1
    v_perm_b32 v4, v4, v8, s47
    v_subrev_u32 v28, 3, v28
    s_mov_b64 exec, -1

    buffer_store_dwordx2 v[4:5], v28, s[24:27], 0 offen
    v_cmp_ne_u32_sdwa s[80:81], v11, v13 src0_sel:WORD_1 src1_sel:WORD_1
    v_cmp_ne_u32_sdwa vcc, v11, v15 src0_sel:WORD_1 src1_sel:WORD_1
    v_perm_b32 v11, v12, v11, s45
    s_mov_b32 s54, 25600
    v_alignbyte_b32 v14, v15, v14, 2
    s_waitcnt lgkmcnt(2)
    v_add3_u32 v29, v29, v106, s54

    s_and_b64 exec, vcc, s[80:81]
    v_and_b32 v11, 0xff, v11
    s_andn2_b64 exec, s[80:81], vcc
    v_alignbyte_b32 v11, v11, v10, 1
    v_perm_b32 v10, v10, v14, s47
    v_subrev_u32 v29, 3, v29
    s_mov_b64 exec, -1

    buffer_store_dwordx2 v[10:11], v29, s[24:27], 0 offen
    v_cmp_ne_u32_sdwa s[80:81], v17, v19 src0_sel:WORD_1 src1_sel:WORD_1
    v_cmp_ne_u32_sdwa vcc, v17, v21 src0_sel:WORD_1 src1_sel:WORD_1
    v_perm_b32 v17, v18, v17, s45
    s_mov_b32 s54, 30720
    v_alignbyte_b32 v20, v21, v20, 2
    s_waitcnt lgkmcnt(1)
    v_add3_u32 v30, v30, v106, s54

    s_and_b64 exec, vcc, s[80:81]
    v_and_b32 v17, 0xff, v17
    s_andn2_b64 exec, s[80:81], vcc
    v_alignbyte_b32 v17, v17, v16, 1
    v_perm_b32 v16, v16, v20, s47
    v_subrev_u32 v30, 3, v30
    s_mov_b64 exec, -1

    buffer_store_dwordx2 v[16:17], v30, s[24:27], 0 offen
    v_cmp_ne_u32_sdwa s[80:81], v23, v25 src0_sel:WORD_1 src1_sel:WORD_1
    v_cmp_ne_u32_sdwa vcc, v23, v27 src0_sel:WORD_1 src1_sel:WORD_1
    v_perm_b32 v23, v24, v23, s45
    s_mov_b32 s54, 35840
    v_alignbyte_b32 v26, v27, v26, 2
    s_waitcnt lgkmcnt(0)
    v_add3_u32 v31, v31, v106, s54

    s_and_b64 exec, vcc, s[80:81]
    v_and_b32 v23, 0xff, v23
    s_andn2_b64 exec, s[80:81], vcc
    v_alignbyte_b32 v23, v23, v22, 1
    v_perm_b32 v22, v22, v26, s47
    v_subrev_u32 v31, 3, v31
    s_mov_b64 exec, -1

    buffer_store_dwordx2 v[22:23], v31, s[24:27], 0 offen
L_skw_30:
    s_bitcmp0_b32 s28, 2
    s_cbranch_scc1 L_skw_31
    v_add_u32 v107, 65536, v2
    ds_read_b64 v[4:5], v107 offset:16400
    ds_read_b64 v[6:7], v107 offset:16408
    ds_read_b64 v[8:9], v107 offset:16392

    ds_read_b64 v[10:11], v107 offset:24592
    ds_read_b64 v[12:13], v107 offset:24600
    ds_read_b64 v[14:15], v107 offset:24584

    ds_read_b64 v[16:17], v107 offset:32784
    ds_read_b64 v[18:19], v107 offset:32792
    ds_read_b64 v[20:21], v107 offset:32776

    ds_read_b64 v[22:23], v107 offset:40976
    ds_read_b64 v[24:25], v107 offset:40984
    ds_read_b64 v[26:27], v107 offset:40968

    s_waitcnt lgkmcnt(9)
    v_lshrrev_b32 v28, 16, v5
    ds_read_b32 v28, v28 offset:8192

    s_waitcnt lgkmcnt(7)
    v_lshrrev_b32 v29, 16, v11
    ds_read_b32 v29, v29 offset:8192

    s_waitcnt lgkmcnt(5)
    v_lshrrev_b32 v30, 16, v17
    ds_read_b32 v30, v30 offset:8192

    s_waitcnt lgkmcnt(3)
    v_lshrrev_b32 v31, 16, v23
    ds_read_b32 v31, v31 offset:8192

    v_cmp_ne_u32_sdwa s[80:81], v5, v7 src0_sel:WORD_1 src1_sel:WORD_1
    v_cmp_ne_u32_sdwa vcc, v5, v9 src0_sel:WORD_1 src1_sel:WORD_1
    v_perm_b32 v5, v6, v5, s45
    s_mov_b32 s54, 40960
    v_alignbyte_b32 v8, v9, v8, 2
    s_waitcnt lgkmcnt(3)
    v_add3_u32 v28, v28, v106, s54

    s_and_b64 exec, vcc, s[80:81]
    v_and_b32 v5, 0xff, v5
    s_andn2_b64 exec, s[80:81], vcc
    v_alignbyte_b32 v5, v5, v4, 1
    v_perm_b32 v4, v4, v8, s47
    v_subrev_u32 v28, 3, v28
    s_mov_b64 exec, -1

    buffer_store_dwordx2 v[4:5], v28, s[24:27], 0 offen
    v_cmp_ne_u32_sdwa s[80:81], v11, v13 src0_sel:WORD_1 src1_sel:WORD_1
    v_cmp_ne_u32_sdwa vcc, v11, v15 src0_sel:WORD_1 src1_sel:WORD_1
    v_perm_b32 v11, v12, v11, s45
    s_mov_b32 s54, 46080
    v_alignbyte_b32 v14, v15, v14, 2
    s_waitcnt lgkmcnt(2)
    v_add3_u32 v29, v29, v106, s54

    s_and_b64 exec, vcc, s[80:81]
    v_and_b32 v11, 0xff, v11
    s_andn2_b64 exec, s[80:81], vcc
    v_alignbyte_b32 v11, v11, v10, 1
    v_perm_b32 v10, v10, v14, s47
    v_subrev_u32 v29, 3, v29
    s_mov_b64 exec, -1

    buffer_store_dwordx2 v[10:11], v29, s[24:27], 0 offen
    v_cmp_ne_u32_sdwa s[80:81], v17, v19 src0_sel:WORD_1 src1_sel:WORD_1
    v_cmp_ne_u32_sdwa vcc, v17, v21 src0_sel:WORD_1 src1_sel:WORD_1
    v_perm_b32 v17, v18, v17, s45
    s_mov_b32 s54, 51200
    v_alignbyte_b32 v20, v21, v20, 2
    s_waitcnt lgkmcnt(1)
    v_add3_u32 v30, v30, v106, s54

    s_and_b64 exec, vcc, s[80:81]
    v_and_b32 v17, 0xff, v17
    s_andn2_b64 exec, s[80:81], vcc
    v_alignbyte_b32 v17, v17, v16, 1
    v_perm_b32 v16, v16, v20, s47
    v_subrev_u32 v30, 3, v30
    s_mov_b64 exec, -1

    buffer_store_dwordx2 v[16:17], v30, s[24:27], 0 offen
    v_cmp_ne_u32_sdwa s[80:81], v23, v25 src0_sel:WORD_1 src1_sel:WORD_1
    v_cmp_ne_u32_sdwa vcc, v23, v27 src0_sel:WORD_1 src1_sel:WORD_1
    v_perm_b32 v23, v24, v23, s45
    s_mov_b32 s54, 56320
    v_alignbyte_b32 v26, v27, v26, 2
    s_waitcnt lgkmcnt(0)
    v_add3_u32 v31, v31, v106, s54

    s_and_b64 exec, vcc, s[80:81]
    v_and_b32 v23, 0xff, v23
    s_andn2_b64 exec, s[80:81], vcc
    v_alignbyte_b32 v23, v23, v22, 1
    v_perm_b32 v22, v22, v26, s47
    v_subrev_u32 v31, 3, v31
    s_mov_b64 exec, -1

    buffer_store_dwordx2 v[22:23], v31, s[24:27], 0 offen
L_skw_31:
    s_bitcmp0_b32 s28, 3
    s_cbranch_scc1 L_skw_32
    v_add_u32 v107, 98304, v2
    ds_read_b64 v[4:5], v107 offset:16400
    ds_read_b64 v[6:7], v107 offset:16408
    ds_read_b64 v[8:9], v107 offset:16392

    ds_read_b64 v[10:11], v107 offset:24592
    ds_read_b64 v[12:13], v107 offset:24600
    ds_read_b64 v[14:15], v107 offset:24584

    ds_read_b64 v[16:17], v107 offset:32784
    ds_read_b64 v[18:19], v107 offset:32792
    ds_read_b64 v[20:21], v107 offset:32776

    ds_read_b64 v[22:23], v107 offset:40976
    ds_read_b64 v[24:25], v107 offset:40984
    ds_read_b64 v[26:27], v107 offset:40968

    s_waitcnt lgkmcnt(9)
    v_lshrrev_b32 v28, 16, v5
    ds_read_b32 v28, v28 offset:8192

    s_waitcnt lgkmcnt(7)
    v_lshrrev_b32 v29, 16, v11
    ds_read_b32 v29, v29 offset:8192

    s_waitcnt lgkmcnt(5)
    v_lshrrev_b32 v30, 16, v17
    ds_read_b32 v30, v30 offset:8192

    s_waitcnt lgkmcnt(3)
    v_lshrrev_b32 v31, 16, v23
    ds_read_b32 v31, v31 offset:8192

    v_cmp_ne_u32_sdwa s[80:81], v5, v7 src0_sel:WORD_1 src1_sel:WORD_1
    v_cmp_ne_u32_sdwa vcc, v5, v9 src0_sel:WORD_1 src1_sel:WORD_1
    v_perm_b32 v5, v6, v5, s45
    s_mov_b32 s54, 61440
    v_alignbyte_b32 v8, v9, v8, 2
    s_waitcnt lgkmcnt(3)
    v_add3_u32 v28, v28, v106, s54

    s_and_b64 exec, vcc, s[80:81]
    v_and_b32 v5, 0xff, v5
    s_andn2_b64 exec, s[80:81], vcc
    v_alignbyte_b32 v5, v5, v4, 1
    v_perm_b32 v4, v4, v8, s47
    v_subrev_u32 v28, 3, v28
    s_mov_b64 exec, -1

    buffer_store_dwordx2 v[4:5], v28, s[24:27], 0 offen
    v_cmp_ne_u32_sdwa s[80:81], v11, v13 src0_sel:WORD_1 src1_sel:WORD_1
    v_cmp_ne_u32_sdwa vcc, v11, v15 src0_sel:WORD_1 src1_sel:WORD_1
    v_perm_b32 v11, v12, v11, s45
    s_mov_b32 s54, 66560
    v_alignbyte_b32 v14, v15, v14, 2
    s_waitcnt lgkmcnt(2)
    v_add3_u32 v29, v29, v106, s54

    s_and_b64 exec, vcc, s[80:81]
    v_and_b32 v11, 0xff, v11
    s_andn2_b64 exec, s[80:81], vcc
    v_alignbyte_b32 v11, v11, v10, 1
    v_perm_b32 v10, v10, v14, s47
    v_subrev_u32 v29, 3, v29
    s_mov_b64 exec, -1

    buffer_store_dwordx2 v[10:11], v29, s[24:27], 0 offen
    v_cmp_ne_u32_sdwa s[80:81], v17, v19 src0_sel:WORD_1 src1_sel:WORD_1
    v_cmp_ne_u32_sdwa vcc, v17, v21 src0_sel:WORD_1 src1_sel:WORD_1
    v_perm_b32 v17, v18, v17, s45
    s_mov_b32 s54, 71680
    v_alignbyte_b32 v20, v21, v20, 2
    s_waitcnt lgkmcnt(1)
    v_add3_u32 v30, v30, v106, s54

    s_and_b64 exec, vcc, s[80:81]
    v_and_b32 v17, 0xff, v17
    s_andn2_b64 exec, s[80:81], vcc
    v_alignbyte_b32 v17, v17, v16, 1
    v_perm_b32 v16, v16, v20, s47
    v_subrev_u32 v30, 3, v30
    s_mov_b64 exec, -1

    buffer_store_dwordx2 v[16:17], v30, s[24:27], 0 offen
    v_cmp_ne_u32_sdwa s[80:81], v23, v25 src0_sel:WORD_1 src1_sel:WORD_1
    v_cmp_ne_u32_sdwa vcc, v23, v27 src0_sel:WORD_1 src1_sel:WORD_1
    v_perm_b32 v23, v24, v23, s45
    s_mov_b32 s54, 76800
    v_alignbyte_b32 v26, v27, v26, 2
    s_waitcnt lgkmcnt(0)
    v_add3_u32 v31, v31, v106, s54

    s_andn2_b64 exec, -1, s[68:69]
    v_bfrev_b32 v31, 1

    s_and_b64 exec, vcc, s[80:81]
    v_and_b32 v23, 0xff, v23
    s_andn2_b64 exec, s[80:81], vcc
    v_alignbyte_b32 v23, v23, v22, 1
    v_perm_b32 v22, v22, v26, s47
    v_subrev_u32 v31, 3, v31
    s_mov_b64 exec, -1

    buffer_store_dwordx2 v[22:23], v31, s[24:27], 0 offen
L_skw_32:
L_sback_25:
    s_mov_b32 s28, 15
    s_mov_b32 s29, 0
    s_movk_i32 s30, 16000

    v_add_u32 v92, v94, v94
    v_add_u32 v93, v95, v95
    v_med3_u32 v92, v94, 2, v92
    v_med3_u32 v93, v95, 2, v93
    buffer_atomic_add_x2 v[92:93], v2, s[20:23], 0 offen sc0
    s_add_u32 s41, s41, 160
    s_mul_i32 s78, s41, 16000
    s_add_u32 s49, s78, 16000
    s_cmp_ge_u32 s41, 3200
    s_cmovk_i32 s49, 0
    s_cmovk_i32 s78, 0
    s_lshl_b32 s10, s49, 2
    s_lshl_b32 s14, s49, 2
    s_lshl_b32 s18, s49, 1
    s_lshl_b32 s56, s78, 2
    s_lshl_b32 s61, s78, 1

    s_add_u32 s57, s56, 16384
    s_add_u32 s62, s61, 8192
    s_add_u32 s58, s56, 32768
    s_add_u32 s63, s61, 16384
    s_add_u32 s59, s56, 49152
    s_add_u32 s64, s61, 24576
    s_waitcnt lgkmcnt(0)
    v_readlane_b32 s77, v96, 63
    v_mul_u32_u24 v114, 7936, v0
    v_sub_u32 v97, v97, v95
    s_sub_u32 s77, s77, s50
    v_add_u32 v97, s77, v97
    v_sub_u32 v96, v97, v94
    v_lshlrev_b32 v111, 16, v97
    v_lshlrev_b32 v110, 16, v96
    ds_write_b64 v2, v[110:111]
    v_sub_u32 v96, v114, v96
    v_sub_u32 v97, v114, v97
    v_add_u32 v97, s48, v97
    s_add_u32 s50, s50, s30

    s_waitcnt lgkmcnt(0)
    s_barrier

    buffer_load_dwordx4 v[20:23], v1, s[12:15], s56 offen nt
    buffer_load_dwordx4 v[4:7], v1, s[8:11], s56 offen nt
    buffer_load_dwordx2 v[36:37], v2, s[16:19], s61 offen nt
    buffer_load_dwordx4 v[24:27], v1, s[12:15], s57 offen nt
    buffer_load_dwordx4 v[8:11], v1, s[8:11], s57 offen nt
    buffer_load_dwordx2 v[38:39], v2, s[16:19], s62 offen nt
    buffer_load_dwordx4 v[28:31], v1, s[12:15], s58 offen nt
    buffer_load_dwordx4 v[12:15], v1, s[8:11], s58 offen nt
    buffer_load_dwordx2 v[40:41], v2, s[16:19], s63 offen nt
    buffer_load_dwordx4 v[32:35], v1, s[12:15], s59 offen nt
    buffer_load_dwordx4 v[16:19], v1, s[8:11], s59 offen nt
    buffer_load_dwordx2 v[42:43], v2, s[16:19], s64 offen nt
    v_lshrrev_b32 v110, 16, v45
    ds_read_b32 v110, v110
    v_lshrrev_b32 v111, 16, v47
    ds_read_b32 v111, v111
    v_lshrrev_b32 v112, 16, v49
    ds_read_b32 v112, v112
    v_lshrrev_b32 v113, 16, v51
    ds_read_b32 v113, v113
    v_lshrrev_b32 v114, 16, v53
    ds_read_b32 v114, v114
    v_lshrrev_b32 v115, 16, v55
    ds_read_b32 v115, v115
    v_lshrrev_b32 v116, 16, v57
    ds_read_b32 v116, v116
    v_lshrrev_b32 v117, 16, v59
    ds_read_b32 v117, v117
    s_waitcnt lgkmcnt(7)
    v_add_u32_sdwa v110, v110, v76 dst_sel:DWORD dst_unused:UNUSED_PAD src0_sel:WORD_1 src1_sel:WORD_0
    v_lshlrev_b32 v110, 3, v110
    ds_write_b64 v110, v[44:45] offset:16400

    s_waitcnt lgkmcnt(7)
    v_add_u32_sdwa v111, v111, v77 dst_sel:DWORD dst_unused:UNUSED_PAD src0_sel:WORD_1 src1_sel:WORD_0
    v_lshlrev_b32 v111, 3, v111
    ds_write_b64 v111, v[46:47] offset:16400

    s_waitcnt lgkmcnt(7)
    v_add_u32_sdwa v112, v112, v78 dst_sel:DWORD dst_unused:UNUSED_PAD src0_sel:WORD_1 src1_sel:WORD_0
    v_lshlrev_b32 v112, 3, v112
    ds_write_b64 v112, v[48:49] offset:16400

    s_waitcnt lgkmcnt(7)
    v_add_u32_sdwa v113, v113, v79 dst_sel:DWORD dst_unused:UNUSED_PAD src0_sel:WORD_1 src1_sel:WORD_0
    v_lshlrev_b32 v113, 3, v113
    ds_write_b64 v113, v[50:51] offset:16400

    s_waitcnt lgkmcnt(7)
    v_add_u32_sdwa v114, v114, v80 dst_sel:DWORD dst_unused:UNUSED_PAD src0_sel:WORD_1 src1_sel:WORD_0
    v_lshlrev_b32 v114, 3, v114
    ds_write_b64 v114, v[52:53] offset:16400

    s_waitcnt lgkmcnt(7)
    v_add_u32_sdwa v115, v115, v81 dst_sel:DWORD dst_unused:UNUSED_PAD src0_sel:WORD_1 src1_sel:WORD_0
    v_lshlrev_b32 v115, 3, v115
    ds_write_b64 v115, v[54:55] offset:16400

    s_waitcnt lgkmcnt(7)
    v_add_u32_sdwa v116, v116, v82 dst_sel:DWORD dst_unused:UNUSED_PAD src0_sel:WORD_1 src1_sel:WORD_0
    v_lshlrev_b32 v116, 3, v116
    ds_write_b64 v116, v[56:57] offset:16400

    s_waitcnt lgkmcnt(7)
    v_add_u32_sdwa v117, v117, v83 dst_sel:DWORD dst_unused:UNUSED_PAD src0_sel:WORD_1 src1_sel:WORD_0
    v_lshlrev_b32 v117, 3, v117
    ds_write_b64 v117, v[58:59] offset:16400

    v_lshrrev_b32 v110, 16, v61
    ds_read_b32 v110, v110
    v_lshrrev_b32 v111, 16, v63
    ds_read_b32 v111, v111
    v_lshrrev_b32 v112, 16, v65
    ds_read_b32 v112, v112
    v_lshrrev_b32 v113, 16, v67
    ds_read_b32 v113, v113
    s_waitcnt lgkmcnt(3)
    v_add_u32_sdwa v110, v110, v84 dst_sel:DWORD dst_unused:UNUSED_PAD src0_sel:WORD_1 src1_sel:WORD_0
    v_lshlrev_b32 v110, 3, v110
    ds_write_b64 v110, v[60:61] offset:16400

    s_waitcnt lgkmcnt(3)
    v_add_u32_sdwa v111, v111, v85 dst_sel:DWORD dst_unused:UNUSED_PAD src0_sel:WORD_1 src1_sel:WORD_0
    v_lshlrev_b32 v111, 3, v111
    ds_write_b64 v111, v[62:63] offset:16400

    s_waitcnt lgkmcnt(3)
    v_add_u32_sdwa v112, v112, v86 dst_sel:DWORD dst_unused:UNUSED_PAD src0_sel:WORD_1 src1_sel:WORD_0
    v_lshlrev_b32 v112, 3, v112
    ds_write_b64 v112, v[64:65] offset:16400

    s_waitcnt lgkmcnt(3)
    v_add_u32_sdwa v113, v113, v87 dst_sel:DWORD dst_unused:UNUSED_PAD src0_sel:WORD_1 src1_sel:WORD_0
    v_lshlrev_b32 v113, 3, v113
    ds_write_b64 v113, v[66:67] offset:16400

    s_mov_b64 exec, s[66:67]
    v_lshrrev_b32 v110, 16, v69
    ds_read_b32 v110, v110
    v_lshrrev_b32 v111, 16, v71
    ds_read_b32 v111, v111
    v_lshrrev_b32 v112, 16, v73
    ds_read_b32 v112, v112
    v_lshrrev_b32 v113, 16, v75
    ds_read_b32 v113, v113
    s_waitcnt lgkmcnt(3)
    v_add_u32_sdwa v110, v110, v88 dst_sel:DWORD dst_unused:UNUSED_PAD src0_sel:WORD_1 src1_sel:WORD_0
    v_lshlrev_b32 v110, 3, v110
    ds_write_b64 v110, v[68:69] offset:16400

    s_waitcnt lgkmcnt(3)
    v_add_u32_sdwa v111, v111, v89 dst_sel:DWORD dst_unused:UNUSED_PAD src0_sel:WORD_1 src1_sel:WORD_0
    v_lshlrev_b32 v111, 3, v111
    ds_write_b64 v111, v[70:71] offset:16400

    s_waitcnt lgkmcnt(3)
    v_add_u32_sdwa v112, v112, v90 dst_sel:DWORD dst_unused:UNUSED_PAD src0_sel:WORD_1 src1_sel:WORD_0
    v_lshlrev_b32 v112, 3, v112
    ds_write_b64 v112, v[72:73] offset:16400

    s_waitcnt lgkmcnt(3)
    v_add_u32_sdwa v113, v113, v91 dst_sel:DWORD dst_unused:UNUSED_PAD src0_sel:WORD_1 src1_sel:WORD_0
    v_lshlrev_b32 v113, 3, v113
    ds_write_b64 v113, v[74:75] offset:16400

    s_mov_b64 exec, -1
    s_cmp_lg_u32 s49, 0
    s_cbranch_scc1 L_p1loop_5
L_p1epi_6:
    s_waitcnt vmcnt(0)
    s_waitcnt vmcnt(12)
    v_add_u32 v110, v92, v94
    v_min_u32 v92, s48, v92
    v_add_u32 v111, v93, v95
    v_min_u32 v93, s48, v93
    v_max_u32 v110, v110, v111
    v_add_u32 v92, v92, v96
    v_add_u32 v93, v93, v97
    v_cmp_le_u32 vcc, s48, v110
    v_lshl_add_u32 v92, v92, 2, v92
    v_lshl_add_u32 v93, v93, 2, v93
    ds_write_b64 v2, v[92:93] offset:8192
    s_cbranch_vccz L_noov_36
    ds_write_b32 v108, v104 offset:4
L_noov_36:

    s_waitcnt lgkmcnt(0)
    s_barrier
    ds_read_b32 v110, v108 offset:4
    s_waitcnt lgkmcnt(0)
    v_readfirstlane_b32 s53, v110
    s_nop 1

    s_cmp_lg_u32 s53, 0
    s_cbranch_scc1 L_slow_37
    s_bitcmp0_b32 s28, 0
    s_cbranch_scc1 L_skw_42
    ds_read_b64 v[4:5], v2 offset:16400
    ds_read_b64 v[6:7], v2 offset:16408
    ds_read_b64 v[8:9], v2 offset:16392

    ds_read_b64 v[10:11], v2 offset:24592
    ds_read_b64 v[12:13], v2 offset:24600
    ds_read_b64 v[14:15], v2 offset:24584

    ds_read_b64 v[16:17], v2 offset:32784
    ds_read_b64 v[18:19], v2 offset:32792
    ds_read_b64 v[20:21], v2 offset:32776

    ds_read_b64 v[22:23], v2 offset:40976
    ds_read_b64 v[24:25], v2 offset:40984
    ds_read_b64 v[26:27], v2 offset:40968

    s_waitcnt lgkmcnt(9)
    v_lshrrev_b32 v28, 16, v5
    ds_read_b32 v28, v28 offset:8192

    s_waitcnt lgkmcnt(7)
    v_lshrrev_b32 v29, 16, v11
    ds_read_b32 v29, v29 offset:8192

    s_waitcnt lgkmcnt(5)
    v_lshrrev_b32 v30, 16, v17
    ds_read_b32 v30, v30 offset:8192

    s_waitcnt lgkmcnt(3)
    v_lshrrev_b32 v31, 16, v23
    ds_read_b32 v31, v31 offset:8192

    v_cmp_ne_u32_sdwa s[80:81], v5, v7 src0_sel:WORD_1 src1_sel:WORD_1
    v_cmp_ne_u32_sdwa vcc, v5, v9 src0_sel:WORD_1 src1_sel:WORD_1
    v_perm_b32 v5, v6, v5, s45
    s_mov_b32 s54, 0
    v_alignbyte_b32 v8, v9, v8, 2
    s_waitcnt lgkmcnt(3)
    v_add3_u32 v28, v28, v106, s54

    s_and_b64 exec, vcc, s[80:81]
    v_and_b32 v5, 0xff, v5
    s_andn2_b64 exec, s[80:81], vcc
    v_alignbyte_b32 v5, v5, v4, 1
    v_perm_b32 v4, v4, v8, s47
    v_subrev_u32 v28, 3, v28
    s_mov_b64 exec, -1

    buffer_store_dwordx2 v[4:5], v28, s[24:27], 0 offen
    v_cmp_ne_u32_sdwa s[80:81], v11, v13 src0_sel:WORD_1 src1_sel:WORD_1
    v_cmp_ne_u32_sdwa vcc, v11, v15 src0_sel:WORD_1 src1_sel:WORD_1
    v_perm_b32 v11, v12, v11, s45
    s_mov_b32 s54, 5120
    v_alignbyte_b32 v14, v15, v14, 2
    s_waitcnt lgkmcnt(2)
    v_add3_u32 v29, v29, v106, s54

    s_and_b64 exec, vcc, s[80:81]
    v_and_b32 v11, 0xff, v11
    s_andn2_b64 exec, s[80:81], vcc
    v_alignbyte_b32 v11, v11, v10, 1
    v_perm_b32 v10, v10, v14, s47
    v_subrev_u32 v29, 3, v29
    s_mov_b64 exec, -1

    buffer_store_dwordx2 v[10:11], v29, s[24:27], 0 offen
    v_cmp_ne_u32_sdwa s[80:81], v17, v19 src0_sel:WORD_1 src1_sel:WORD_1
    v_cmp_ne_u32_sdwa vcc, v17, v21 src0_sel:WORD_1 src1_sel:WORD_1
    v_perm_b32 v17, v18, v17, s45
    s_mov_b32 s54, 10240
    v_alignbyte_b32 v20, v21, v20, 2
    s_waitcnt lgkmcnt(1)
    v_add3_u32 v30, v30, v106, s54

    s_and_b64 exec, vcc, s[80:81]
    v_and_b32 v17, 0xff, v17
    s_andn2_b64 exec, s[80:81], vcc
    v_alignbyte_b32 v17, v17, v16, 1
    v_perm_b32 v16, v16, v20, s47
    v_subrev_u32 v30, 3, v30
    s_mov_b64 exec, -1

    buffer_store_dwordx2 v[16:17], v30, s[24:27], 0 offen
    v_cmp_ne_u32_sdwa s[80:81], v23, v25 src0_sel:WORD_1 src1_sel:WORD_1
    v_cmp_ne_u32_sdwa vcc, v23, v27 src0_sel:WORD_1 src1_sel:WORD_1
    v_perm_b32 v23, v24, v23, s45
    s_mov_b32 s54, 15360
    v_alignbyte_b32 v26, v27, v26, 2
    s_waitcnt lgkmcnt(0)
    v_add3_u32 v31, v31, v106, s54

    s_and_b64 exec, vcc, s[80:81]
    v_and_b32 v23, 0xff, v23
    s_andn2_b64 exec, s[80:81], vcc
    v_alignbyte_b32 v23, v23, v22, 1
    v_perm_b32 v22, v22, v26, s47
    v_subrev_u32 v31, 3, v31
    s_mov_b64 exec, -1

    buffer_store_dwordx2 v[22:23], v31, s[24:27], 0 offen
L_skw_42:
    s_bitcmp0_b32 s28, 1
    s_cbranch_scc1 L_skw_43
    v_add_u32 v107, 32768, v2
    ds_read_b64 v[4:5], v107 offset:16400
    ds_read_b64 v[6:7], v107 offset:16408
    ds_read_b64 v[8:9], v107 offset:16392

    ds_read_b64 v[10:11], v107 offset:24592
    ds_read_b64 v[12:13], v107 offset:24600
    ds_read_b64 v[14:15], v107 offset:24584

    ds_read_b64 v[16:17], v107 offset:32784
    ds_read_b64 v[18:19], v107 offset:32792
    ds_read_b64 v[20:21], v107 offset:32776

    ds_read_b64 v[22:23], v107 offset:40976
    ds_read_b64 v[24:25], v107 offset:40984
    ds_read_b64 v[26:27], v107 offset:40968

    s_waitcnt lgkmcnt(9)
    v_lshrrev_b32 v28, 16, v5
    ds_read_b32 v28, v28 offset:8192

    s_waitcnt lgkmcnt(7)
    v_lshrrev_b32 v29, 16, v11
    ds_read_b32 v29, v29 offset:8192

    s_waitcnt lgkmcnt(5)
    v_lshrrev_b32 v30, 16, v17
    ds_read_b32 v30, v30 offset:8192

    s_waitcnt lgkmcnt(3)
    v_lshrrev_b32 v31, 16, v23
    ds_read_b32 v31, v31 offset:8192

    v_cmp_ne_u32_sdwa s[80:81], v5, v7 src0_sel:WORD_1 src1_sel:WORD_1
    v_cmp_ne_u32_sdwa vcc, v5, v9 src0_sel:WORD_1 src1_sel:WORD_1
    v_perm_b32 v5, v6, v5, s45
    s_mov_b32 s54, 20480
    v_alignbyte_b32 v8, v9, v8, 2
    s_waitcnt lgkmcnt(3)
    v_add3_u32 v28, v28, v106, s54

    s_and_b64 exec, vcc, s[80:81]
    v_and_b32 v5, 0xff, v5
    s_andn2_b64 exec, s[80:81], vcc
    v_alignbyte_b32 v5, v5, v4, 1
    v_perm_b32 v4, v4, v8, s47
    v_subrev_u32 v28, 3, v28
    s_mov_b64 exec, -1

    buffer_store_dwordx2 v[4:5], v28, s[24:27], 0 offen
    v_cmp_ne_u32_sdwa s[80:81], v11, v13 src0_sel:WORD_1 src1_sel:WORD_1
    v_cmp_ne_u32_sdwa vcc, v11, v15 src0_sel:WORD_1 src1_sel:WORD_1
    v_perm_b32 v11, v12, v11, s45
    s_mov_b32 s54, 25600
    v_alignbyte_b32 v14, v15, v14, 2
    s_waitcnt lgkmcnt(2)
    v_add3_u32 v29, v29, v106, s54

    s_and_b64 exec, vcc, s[80:81]
    v_and_b32 v11, 0xff, v11
    s_andn2_b64 exec, s[80:81], vcc
    v_alignbyte_b32 v11, v11, v10, 1
    v_perm_b32 v10, v10, v14, s47
    v_subrev_u32 v29, 3, v29
    s_mov_b64 exec, -1

    buffer_store_dwordx2 v[10:11], v29, s[24:27], 0 offen
    v_cmp_ne_u32_sdwa s[80:81], v17, v19 src0_sel:WORD_1 src1_sel:WORD_1
    v_cmp_ne_u32_sdwa vcc, v17, v21 src0_sel:WORD_1 src1_sel:WORD_1
    v_perm_b32 v17, v18, v17, s45
    s_mov_b32 s54, 30720
    v_alignbyte_b32 v20, v21, v20, 2
    s_waitcnt lgkmcnt(1)
    v_add3_u32 v30, v30, v106, s54

    s_and_b64 exec, vcc, s[80:81]
    v_and_b32 v17, 0xff, v17
    s_andn2_b64 exec, s[80:81], vcc
    v_alignbyte_b32 v17, v17, v16, 1
    v_perm_b32 v16, v16, v20, s47
    v_subrev_u32 v30, 3, v30
    s_mov_b64 exec, -1

    buffer_store_dwordx2 v[16:17], v30, s[24:27], 0 offen
    v_cmp_ne_u32_sdwa s[80:81], v23, v25 src0_sel:WORD_1 src1_sel:WORD_1
    v_cmp_ne_u32_sdwa vcc, v23, v27 src0_sel:WORD_1 src1_sel:WORD_1
    v_perm_b32 v23, v24, v23, s45
    s_mov_b32 s54, 35840
    v_alignbyte_b32 v26, v27, v26, 2
    s_waitcnt lgkmcnt(0)
    v_add3_u32 v31, v31, v106, s54

    s_and_b64 exec, vcc, s[80:81]
    v_and_b32 v23, 0xff, v23
    s_andn2_b64 exec, s[80:81], vcc
    v_alignbyte_b32 v23, v23, v22, 1
    v_perm_b32 v22, v22, v26, s47
    v_subrev_u32 v31, 3, v31
    s_mov_b64 exec, -1

    buffer_store_dwordx2 v[22:23], v31, s[24:27], 0 offen
L_skw_43:
    s_bitcmp0_b32 s28, 2
    s_cbranch_scc1 L_skw_44
    v_add_u32 v107, 65536, v2
    ds_read_b64 v[4:5], v107 offset:16400
    ds_read_b64 v[6:7], v107 offset:16408
    ds_read_b64 v[8:9], v107 offset:16392

    ds_read_b64 v[10:11], v107 offset:24592
    ds_read_b64 v[12:13], v107 offset:24600
    ds_read_b64 v[14:15], v107 offset:24584

    ds_read_b64 v[16:17], v107 offset:32784
    ds_read_b64 v[18:19], v107 offset:32792
    ds_read_b64 v[20:21], v107 offset:32776

    ds_read_b64 v[22:23], v107 offset:40976
    ds_read_b64 v[24:25], v107 offset:40984
    ds_read_b64 v[26:27], v107 offset:40968

    s_waitcnt lgkmcnt(9)
    v_lshrrev_b32 v28, 16, v5
    ds_read_b32 v28, v28 offset:8192

    s_waitcnt lgkmcnt(7)
    v_lshrrev_b32 v29, 16, v11
    ds_read_b32 v29, v29 offset:8192

    s_waitcnt lgkmcnt(5)
    v_lshrrev_b32 v30, 16, v17
    ds_read_b32 v30, v30 offset:8192

    s_waitcnt lgkmcnt(3)
    v_lshrrev_b32 v31, 16, v23
    ds_read_b32 v31, v31 offset:8192

    v_cmp_ne_u32_sdwa s[80:81], v5, v7 src0_sel:WORD_1 src1_sel:WORD_1
    v_cmp_ne_u32_sdwa vcc, v5, v9 src0_sel:WORD_1 src1_sel:WORD_1
    v_perm_b32 v5, v6, v5, s45
    s_mov_b32 s54, 40960
    v_alignbyte_b32 v8, v9, v8, 2
    s_waitcnt lgkmcnt(3)
    v_add3_u32 v28, v28, v106, s54

    s_and_b64 exec, vcc, s[80:81]
    v_and_b32 v5, 0xff, v5
    s_andn2_b64 exec, s[80:81], vcc
    v_alignbyte_b32 v5, v5, v4, 1
    v_perm_b32 v4, v4, v8, s47
    v_subrev_u32 v28, 3, v28
    s_mov_b64 exec, -1

    buffer_store_dwordx2 v[4:5], v28, s[24:27], 0 offen
    v_cmp_ne_u32_sdwa s[80:81], v11, v13 src0_sel:WORD_1 src1_sel:WORD_1
    v_cmp_ne_u32_sdwa vcc, v11, v15 src0_sel:WORD_1 src1_sel:WORD_1
    v_perm_b32 v11, v12, v11, s45
    s_mov_b32 s54, 46080
    v_alignbyte_b32 v14, v15, v14, 2
    s_waitcnt lgkmcnt(2)
    v_add3_u32 v29, v29, v106, s54

    s_and_b64 exec, vcc, s[80:81]
    v_and_b32 v11, 0xff, v11
    s_andn2_b64 exec, s[80:81], vcc
    v_alignbyte_b32 v11, v11, v10, 1
    v_perm_b32 v10, v10, v14, s47
    v_subrev_u32 v29, 3, v29
    s_mov_b64 exec, -1

    buffer_store_dwordx2 v[10:11], v29, s[24:27], 0 offen
    v_cmp_ne_u32_sdwa s[80:81], v17, v19 src0_sel:WORD_1 src1_sel:WORD_1
    v_cmp_ne_u32_sdwa vcc, v17, v21 src0_sel:WORD_1 src1_sel:WORD_1
    v_perm_b32 v17, v18, v17, s45
    s_mov_b32 s54, 51200
    v_alignbyte_b32 v20, v21, v20, 2
    s_waitcnt lgkmcnt(1)
    v_add3_u32 v30, v30, v106, s54

    s_and_b64 exec, vcc, s[80:81]
    v_and_b32 v17, 0xff, v17
    s_andn2_b64 exec, s[80:81], vcc
    v_alignbyte_b32 v17, v17, v16, 1
    v_perm_b32 v16, v16, v20, s47
    v_subrev_u32 v30, 3, v30
    s_mov_b64 exec, -1

    buffer_store_dwordx2 v[16:17], v30, s[24:27], 0 offen
    v_cmp_ne_u32_sdwa s[80:81], v23, v25 src0_sel:WORD_1 src1_sel:WORD_1
    v_cmp_ne_u32_sdwa vcc, v23, v27 src0_sel:WORD_1 src1_sel:WORD_1
    v_perm_b32 v23, v24, v23, s45
    s_mov_b32 s54, 56320
    v_alignbyte_b32 v26, v27, v26, 2
    s_waitcnt lgkmcnt(0)
    v_add3_u32 v31, v31, v106, s54

    s_and_b64 exec, vcc, s[80:81]
    v_and_b32 v23, 0xff, v23
    s_andn2_b64 exec, s[80:81], vcc
    v_alignbyte_b32 v23, v23, v22, 1
    v_perm_b32 v22, v22, v26, s47
    v_subrev_u32 v31, 3, v31
    s_mov_b64 exec, -1

    buffer_store_dwordx2 v[22:23], v31, s[24:27], 0 offen
L_skw_44:
    s_bitcmp0_b32 s28, 3
    s_cbranch_scc1 L_skw_45
    v_add_u32 v107, 98304, v2
    ds_read_b64 v[4:5], v107 offset:16400
    ds_read_b64 v[6:7], v107 offset:16408
    ds_read_b64 v[8:9], v107 offset:16392

    ds_read_b64 v[10:11], v107 offset:24592
    ds_read_b64 v[12:13], v107 offset:24600
    ds_read_b64 v[14:15], v107 offset:24584

    ds_read_b64 v[16:17], v107 offset:32784
    ds_read_b64 v[18:19], v107 offset:32792
    ds_read_b64 v[20:21], v107 offset:32776

    ds_read_b64 v[22:23], v107 offset:40976
    ds_read_b64 v[24:25], v107 offset:40984
    ds_read_b64 v[26:27], v107 offset:40968

    s_waitcnt lgkmcnt(9)
    v_lshrrev_b32 v28, 16, v5
    ds_read_b32 v28, v28 offset:8192

    s_waitcnt lgkmcnt(7)
    v_lshrrev_b32 v29, 16, v11
    ds_read_b32 v29, v29 offset:8192

    s_waitcnt lgkmcnt(5)
    v_lshrrev_b32 v30, 16, v17
    ds_read_b32 v30, v30 offset:8192

    s_waitcnt lgkmcnt(3)
    v_lshrrev_b32 v31, 16, v23
    ds_read_b32 v31, v31 offset:8192

    v_cmp_ne_u32_sdwa s[80:81], v5, v7 src0_sel:WORD_1 src1_sel:WORD_1
    v_cmp_ne_u32_sdwa vcc, v5, v9 src0_sel:WORD_1 src1_sel:WORD_1
    v_perm_b32 v5, v6, v5, s45
    s_mov_b32 s54, 61440
    v_alignbyte_b32 v8, v9, v8, 2
    s_waitcnt lgkmcnt(3)
    v_add3_u32 v28, v28, v106, s54

    s_and_b64 exec, vcc, s[80:81]
    v_and_b32 v5, 0xff, v5
    s_andn2_b64 exec, s[80:81], vcc
    v_alignbyte_b32 v5, v5, v4, 1
    v_perm_b32 v4, v4, v8, s47
    v_subrev_u32 v28, 3, v28
    s_mov_b64 exec, -1

    buffer_store_dwordx2 v[4:5], v28, s[24:27], 0 offen
    v_cmp_ne_u32_sdwa s[80:81], v11, v13 src0_sel:WORD_1 src1_sel:WORD_1
    v_cmp_ne_u32_sdwa vcc, v11, v15 src0_sel:WORD_1 src1_sel:WORD_1
    v_perm_b32 v11, v12, v11, s45
    s_mov_b32 s54, 66560
    v_alignbyte_b32 v14, v15, v14, 2
    s_waitcnt lgkmcnt(2)
    v_add3_u32 v29, v29, v106, s54

    s_and_b64 exec, vcc, s[80:81]
    v_and_b32 v11, 0xff, v11
    s_andn2_b64 exec, s[80:81], vcc
    v_alignbyte_b32 v11, v11, v10, 1
    v_perm_b32 v10, v10, v14, s47
    v_subrev_u32 v29, 3, v29
    s_mov_b64 exec, -1

    buffer_store_dwordx2 v[10:11], v29, s[24:27], 0 offen
    v_cmp_ne_u32_sdwa s[80:81], v17, v19 src0_sel:WORD_1 src1_sel:WORD_1
    v_cmp_ne_u32_sdwa vcc, v17, v21 src0_sel:WORD_1 src1_sel:WORD_1
    v_perm_b32 v17, v18, v17, s45
    s_mov_b32 s54, 71680
    v_alignbyte_b32 v20, v21, v20, 2
    s_waitcnt lgkmcnt(1)
    v_add3_u32 v30, v30, v106, s54

    s_and_b64 exec, vcc, s[80:81]
    v_and_b32 v17, 0xff, v17
    s_andn2_b64 exec, s[80:81], vcc
    v_alignbyte_b32 v17, v17, v16, 1
    v_perm_b32 v16, v16, v20, s47
    v_subrev_u32 v30, 3, v30
    s_mov_b64 exec, -1

    buffer_store_dwordx2 v[16:17], v30, s[24:27], 0 offen
    v_cmp_ne_u32_sdwa s[80:81], v23, v25 src0_sel:WORD_1 src1_sel:WORD_1
    v_cmp_ne_u32_sdwa vcc, v23, v27 src0_sel:WORD_1 src1_sel:WORD_1
    v_perm_b32 v23, v24, v23, s45
    s_mov_b32 s54, 76800
    v_alignbyte_b32 v26, v27, v26, 2
    s_waitcnt lgkmcnt(0)
    v_add3_u32 v31, v31, v106, s54

    s_andn2_b64 exec, -1, s[68:69]
    v_bfrev_b32 v31, 1

    s_and_b64 exec, vcc, s[80:81]
    v_and_b32 v23, 0xff, v23
    s_andn2_b64 exec, s[80:81], vcc
    v_alignbyte_b32 v23, v23, v22, 1
    v_perm_b32 v22, v22, v26, s47
    v_subrev_u32 v31, 3, v31
    s_mov_b64 exec, -1

    buffer_store_dwordx2 v[22:23], v31, s[24:27], 0 offen
L_skw_45:
L_sback_38:
    s_mov_b32 s28, 15
    s_mov_b32 s29, 0
    s_movk_i32 s30, 16000

L_p1done_1:
    s_endpgm

L_slow_24:
    v_add_u32 v6, s29, v0
    v_mov_b32 v12, 0
    s_mov_b32 s75, 4960
L_sl_26:
    v_lshlrev_b32 v7, 3, v6
    ds_read_b64 v[4:5], v7 offset:16400
    ds_read_b32 v13, v7 offset:16412
    ds_read_b32 v14, v7 offset:16396
    s_waitcnt lgkmcnt(0)
    v_lshrrev_b32 v8, 16, v5
    ds_read_b32 v9, v8 offset:8192
    v_add_u32 v8, 4, v8
    v_mul_u32_u24 v8, s75, v8
    s_waitcnt lgkmcnt(0)
    v_mad_u32_u24 v9, v6, 5, v9
    v_cmp_gt_u32 s[72:73], s30, v6
    v_cmp_ge_u32 vcc, v9, v8
    s_and_b64 s[80:81], vcc, s[72:73]
    s_cbranch_scc0 L_s1_27
    s_bcnt1_i32_b64 s76, s[80:81]
    v_mbcnt_lo_u32_b32 v11, s80, 0
    v_mbcnt_hi_u32_b32 v11, s81, v11
    v_mov_b32 v10, s76
    s_mov_b64 exec, 1
    buffer_atomic_add v10, v12, s[36:39], 0 offen sc0
    s_waitcnt vmcnt(0)
    v_readfirstlane_b32 s76, v10
    s_mov_b64 exec, s[80:81]
    s_nop 0
    v_add_lshl_u32 v10, v11, s76, 3
    buffer_store_dwordx2 v[4:5], v10, s[32:35], 0 offen
L_s1_27:
    s_andn2_b64 exec, s[72:73], vcc
    s_cbranch_execz L_s2_28
    buffer_store_dword v4, v9, s[24:27], 0 offen
    buffer_store_byte v5, v9, s[24:27], 0 offen offset:4
    v_add_u32 v9, 5, v9
    v_cmpx_lt_u32 vcc, v9, v8
    v_cmpx_ne_u32_sdwa vcc, v5, v13 src0_sel:WORD_1 src1_sel:WORD_1
    v_cmpx_ne_u32_sdwa vcc, v5, v14 src0_sel:WORD_1 src1_sel:WORD_1
    s_cbranch_execz L_s2_28
    buffer_store_dword v12, v9, s[24:27], 0 offen
L_s2_28:
    s_mov_b64 exec, -1
    v_add_u32 v6, 1024, v6
    s_nop 0
    v_readfirstlane_b32 s76, v6
    s_nop 1
    s_cmp_lt_u32 s76, s30
    s_cbranch_scc1 L_sl_26
    s_branch L_sback_25

L_slow_37:
    v_add_u32 v6, s29, v0
    v_mov_b32 v12, 0
    s_mov_b32 s75, 4960
L_sl_39:
    v_lshlrev_b32 v7, 3, v6
    ds_read_b64 v[4:5], v7 offset:16400
    ds_read_b32 v13, v7 offset:16412
    ds_read_b32 v14, v7 offset:16396
    s_waitcnt lgkmcnt(0)
    v_lshrrev_b32 v8, 16, v5
    ds_read_b32 v9, v8 offset:8192
    v_add_u32 v8, 4, v8
    v_mul_u32_u24 v8, s75, v8
    s_waitcnt lgkmcnt(0)
    v_mad_u32_u24 v9, v6, 5, v9
    v_cmp_gt_u32 s[72:73], s30, v6
    v_cmp_ge_u32 vcc, v9, v8
    s_and_b64 s[80:81], vcc, s[72:73]
    s_cbranch_scc0 L_s1_40
    s_bcnt1_i32_b64 s76, s[80:81]
    v_mbcnt_lo_u32_b32 v11, s80, 0
    v_mbcnt_hi_u32_b32 v11, s81, v11
    v_mov_b32 v10, s76
    s_mov_b64 exec, 1
    buffer_atomic_add v10, v12, s[36:39], 0 offen sc0
    s_waitcnt vmcnt(0)
    v_readfirstlane_b32 s76, v10
    s_mov_b64 exec, s[80:81]
    s_nop 0
    v_add_lshl_u32 v10, v11, s76, 3
    buffer_store_dwordx2 v[4:5], v10, s[32:35], 0 offen
L_s1_40:
    s_andn2_b64 exec, s[72:73], vcc
    s_cbranch_execz L_s2_41
    buffer_store_dword v4, v9, s[24:27], 0 offen
    buffer_store_byte v5, v9, s[24:27], 0 offen offset:4
    v_add_u32 v9, 5, v9
    v_cmpx_lt_u32 vcc, v9, v8
    v_cmpx_ne_u32_sdwa vcc, v5, v13 src0_sel:WORD_1 src1_sel:WORD_1
    v_cmpx_ne_u32_sdwa vcc, v5, v14 src0_sel:WORD_1 src1_sel:WORD_1
    s_cbranch_execz L_s2_41
    buffer_store_dword v12, v9, s[24:27], 0 offen
L_s2_41:
    s_mov_b64 exec, -1
    v_add_u32 v6, 1024, v6
    s_nop 0
    v_readfirstlane_b32 s76, v6
    s_nop 1
    s_cmp_lt_u32 s76, s30
    s_cbranch_scc1 L_sl_39
    s_branch L_sback_38

.globl g2_kernel
.p2align 8
.type g2_kernel,@function
g2_kernel:
    s_cmp_ge_u32 s2, 256
    s_cbranch_scc1 L_p2done_46
    s_load_dwordx2 s[8:9], s[0:1], 0
    s_load_dwordx2 s[6:7], s[0:1], 104
    v_lshrrev_b32 v4, 6, v0
    v_lshlrev_b32 v5, 3, v0
    s_lshr_b32 s37, s2, 1
    s_and_b32 s37, s37, 3
    s_lshr_b32 s36, s2, 3
    s_lshl_b32 s36, s36, 1
    s_and_b32 s3, s2, 1
    s_or_b32 s36, s36, s3
    v_readfirstlane_b32 s4, v4
    v_and_b32 v2, 127, v0
    v_mul_u32_u24 v2, 20, v2
    v_lshlrev_b32 v3, 4, v0
    s_waitcnt lgkmcnt(0)
    s_lshr_b32 s5, s4, 1
    s_and_b32 s39, s4, 1
    s_lshl_b32 s39, s39, 8
    s_mul_i32 s3, s5, 8192
    s_add_u32 s46, s6, s3
    s_addc_u32 s47, s7, 0
    s_mul_i32 s3, s5, 40632320
    s_add_u32 s3, s3, 77848576
    s_add_u32 s44, s6, s3
    s_addc_u32 s45, s7, 0
    s_mul_i32 s38, s37, 8
    s_add_u32 s4, s38, 8
    s_lshl_b32 s3, s38, 6
    s_add_u32 s3, s3, s36
    s_lshl_b32 s3, s3, 2
    s_load_dword s41, s[46:47], s3
    s_mov_b32 s3, 65536
    s_load_dword s51, s[6:7], s3
    s_mov_b32 s10, 6400000
    s_mov_b32 s11, 0x20000

    s_add_u32 s20, s6, 135168
    s_addc_u32 s21, s7, 0
    s_mov_b32 s22, 2048
    s_mov_b32 s23, 0x20000
    buffer_load_dwordx2 v[116:117], v5, s[20:23], 0 offen
    s_mov_b32 s12, s8
    s_mov_b32 s13, s9
    s_mov_b32 s14, 0
    s_mov_b32 s15, 0x20000
    s_mul_i32 s43, s38, 200000
    s_add_u32 s14, s43, 50000
    buffer_load_dwordx4 v[76:79], v3, s[12:15], s43 offen
    s_add_u32 s52, s43, 16384
    buffer_load_dwordx4 v[80:83], v3, s[12:15], s52 offen
    s_add_u32 s52, s43, 32768
    buffer_load_dwordx4 v[84:87], v3, s[12:15], s52 offen
    s_add_u32 s52, s43, 49152
    v_lshlrev_b32 v123, 2, v0
    buffer_load_dword v88, v123, s[12:15], s52 offen
    s_lshr_b32 s3, s2, 3
    s_mul_i32 s3, s3, 49
    v_add_lshl_u32 v89, v0, s3, 7
    v_cmp_gt_u32 vcc, 49, v0
    v_bfrev_b32 v28, 1
    s_add_u32 s54, s43, 100000
    v_cndmask_b32 v89, v28, v89, vcc

    buffer_load_dword v115, v89, s[8:11], s54 offen
    s_mov_b32 s19, 0x20000
    s_mov_b32 s28, 0x4b404000
    s_mov_b32 s29, 0x4b404000
    s_mov_b32 s30, 0xbfffc000
    s_mov_b32 s31, 0xbfffbfff
    s_mov_b32 s32, 0xffff0000
    s_mov_b32 s35, 0x05040100
    s_movk_i32 s3, 212
    v_cmp_gt_u32 s[48:49], s3, v0

    v_mov_b32 v1, 0
    s_mov_b32 s24, 0xc0c0004
    s_mov_b32 s25, 0xc0c0105
    s_mov_b32 s26, 0xc0c0206
    s_mov_b32 s27, 0xc0c0307
    s_waitcnt lgkmcnt(0)
    s_min_u32 s41, s41, 3968
    s_lshl_b32 s52, s38, 6
    s_add_u32 s52, s52, s36
    s_mul_i32 s52, s52, 19840
    s_add_u32 s16, s44, s52
    s_addc_u32 s17, s45, 0
    s_mul_i32 s52, s41, 5
    s_add_u32 s52, s52, 3
    s_and_b32 s18, s52, -4

    s_movk_i32 s53, 0
    buffer_load_dwordx4 v[4:7], v2, s[16:19], s53 offen
    buffer_load_dword v35, v2, s[16:19], s53 offen offset:16
    s_movk_i32 s53, 2560
    buffer_load_dwordx4 v[8:11], v2, s[16:19], s53 offen
    buffer_load_dword v43, v2, s[16:19], s53 offen offset:16
    s_movk_i32 s53, 5120
    buffer_load_dwordx4 v[90:93], v2, s[16:19], s53 offen
    buffer_load_dword v110, v2, s[16:19], s53 offen offset:16
    s_movk_i32 s53, 7680
    buffer_load_dwordx4 v[94:97], v2, s[16:19], s53 offen
    buffer_load_dword v111, v2, s[16:19], s53 offen offset:16
    s_movk_i32 s53, 10240
    buffer_load_dwordx4 v[98:101], v2, s[16:19], s53 offen
    buffer_load_dword v112, v2, s[16:19], s53 offen offset:16
    s_movk_i32 s53, 12800
    buffer_load_dwordx4 v[102:105], v2, s[16:19], s53 offen
    buffer_load_dword v113, v2, s[16:19], s53 offen offset:16
    s_movk_i32 s53, 15360
    buffer_load_dwordx4 v[106:109], v2, s[16:19], s53 offen
    buffer_load_dword v114, v2, s[16:19], s53 offen offset:16
    v_mov_b32 v28, 0x40004000
    v_mov_b32 v29, 0x40004000
    v_mov_b32 v30, 0x40004000
    v_mov_b32 v31, 0x40004000
    v_add_u32 v32, 50000, v3
    v_add_u32 v33, 65536, v32

    ds_write_b128 v32, v[28:31] offset:0
    ds_write_b128 v32, v[28:31] offset:16384
    ds_write_b128 v32, v[28:31] offset:32768
    ds_write_b128 v32, v[28:31] offset:49152
    ds_write_b128 v33, v[28:31] offset:0
    ds_write_b128 v33, v[28:31] offset:16384
    v_cmp_gt_u32 vcc, 971, v0
    s_mov_b64 exec, vcc
    ds_write_b128 v33, v[28:31] offset:32768
    s_mov_b64 exec, -1
    s_waitcnt lgkmcnt(0)
    s_barrier
    v_mov_b32 v34, 150016
    v_mov_b32 v36, 0
    v_mov_b32 v37, 0
    v_mov_b32 v38, 0
    v_mov_b32 v39, 0
    ds_write_b128 v34, v[36:39]

    s_waitcnt vmcnt(19)
    s_nop 1
    v_max_u32_dpp v116, v116, v116 row_shr:1 row_mask:0xf bank_mask:0xf
    s_nop 1
    v_max_u32_dpp v116, v116, v116 row_shr:2 row_mask:0xf bank_mask:0xf
    s_nop 1
    v_max_u32_dpp v116, v116, v116 row_shr:4 row_mask:0xf bank_mask:0xf
    s_nop 1
    v_max_u32_dpp v116, v116, v116 row_shr:8 row_mask:0xf bank_mask:0xf
    s_nop 1
    v_max_u32_dpp v116, v116, v116 row_bcast:15 row_mask:0xa bank_mask:0xf
    s_nop 1
    v_max_u32_dpp v116, v116, v116 row_bcast:31 row_mask:0xc bank_mask:0xf
    s_nop 1
    v_add_f32_dpp v117, v117, v117 row_shr:1 row_mask:0xf bank_mask:0xf
    s_nop 1
    v_add_f32_dpp v117, v117, v117 row_shr:2 row_mask:0xf bank_mask:0xf
    s_nop 1
    v_add_f32_dpp v117, v117, v117 row_shr:4 row_mask:0xf bank_mask:0xf
    s_nop 1
    v_add_f32_dpp v117, v117, v117 row_shr:8 row_mask:0xf bank_mask:0xf
    s_nop 1
    v_add_f32_dpp v117, v117, v117 row_bcast:15 row_mask:0xa bank_mask:0xf
    s_nop 1
    v_add_f32_dpp v117, v117, v117 row_bcast:31 row_mask:0xc bank_mask:0xf
    s_waitcnt lgkmcnt(0)
    s_barrier
    s_mov_b32 exec_lo, 0
    s_brev_b32 exec_hi, 1
    ds_max_u32 v34, v116
    ds_add_f32 v34, v117 offset:4
    s_mov_b64 exec, -1

    s_waitcnt vmcnt(18)
    ds_write_b128 v3, v[76:79] offset:0
    s_waitcnt vmcnt(17)
    ds_write_b128 v3, v[80:83] offset:16384
    s_waitcnt vmcnt(16)
    ds_write_b128 v3, v[84:87] offset:32768
    v_lshlrev_b32 v123, 2, v0
    s_waitcnt vmcnt(15)
    s_mov_b64 exec, s[48:49]
    ds_write_b32 v123, v88 offset:49152
    s_mov_b64 exec, -1

    s_add_u32 s43, s43, 50000
    s_add_u32 s14, s43, 50000
    buffer_load_dwordx4 v[76:79], v3, s[12:15], s43 offen
    s_add_u32 s52, s43, 16384
    buffer_load_dwordx4 v[80:83], v3, s[12:15], s52 offen
    s_add_u32 s52, s43, 32768
    buffer_load_dwordx4 v[84:87], v3, s[12:15], s52 offen
    s_add_u32 s52, s43, 49152
    v_lshlrev_b32 v123, 2, v0
    buffer_load_dword v88, v123, s[12:15], s52 offen
    s_waitcnt lgkmcnt(0)
    s_barrier
    ds_read_b64 v[28:29], v34
    s_waitcnt lgkmcnt(0)
    v_lshlrev_b32 v28, 16, v28
    v_mul_f32 v29, 0x34a7c5ac, v29
    v_sqrt_f32 v29, v29
    v_add_f32 v30, v28, v28
    v_mul_f32 v31, 0x41ac0000, v29
    v_mul_f32 v32, 0x42000000, v29
    v_max_f32 v30, v30, v31
    v_cmp_le_f32 vcc, v28, v32
    v_mov_b32 v33, 0x26901d7d
    v_cmp_lt_f32 s[64:65], v33, v29
    v_mov_b32 v33, 0x58635fa9
    s_and_b64 vcc, vcc, s[64:65]
    v_cmp_gt_f32 s[64:65], v33, v29
    v_rcp_f32 v30, v30
    s_and_b64 vcc, vcc, s[64:65]
    s_cbranch_scc0 L_p2slow_47
    s_cmp_lg_u32 s51, 0
    s_cbranch_scc1 L_p2slow_47
    v_mul_f32 v30, 0x3f000000, v30
    v_mul_f32 v31, 0x46ff8000, v30
    v_rcp_f32 v31, v31
    v_readfirstlane_b32 s33, v30
    s_nop 0
    v_readfirstlane_b32 s34, v31

L_batch_48:
    s_mov_b32 s40, s41
    s_sub_u32 s42, s40, s39
    s_mul_i32 s50, s38, 200000
    s_add_u32 s5, s38, 1
    s_min_u32 s52, s5, 31
    s_lshl_b32 s52, s52, 6
    s_add_u32 s52, s52, s36
    s_lshl_b32 s52, s52, 2
    s_load_dword s41, s[46:47], s52

    s_waitcnt vmcnt(12)
    v_perm_b32 v44, v91, v90, s24
    v_perm_b32 v46, v92, v91, s25
    v_perm_b32 v48, v93, v92, s26
    v_perm_b32 v50, v110, v93, s27
    v_mov_b32 v12, v90
    v_alignbyte_b32 v13, v92, v91, 1
    v_alignbyte_b32 v14, v93, v92, 2
    v_alignbyte_b32 v15, v110, v93, 3
    v_lshlrev_b32_sdwa v44, 3, v44 dst_sel:WORD_0 dst_unused:UNUSED_PAD src0_sel:DWORD src1_sel:DWORD
    v_lshlrev_b32_sdwa v46, 3, v46 dst_sel:WORD_0 dst_unused:UNUSED_PAD src0_sel:DWORD src1_sel:DWORD
    v_lshlrev_b32_sdwa v48, 3, v48 dst_sel:WORD_0 dst_unused:UNUSED_PAD src0_sel:DWORD src1_sel:DWORD
    v_lshlrev_b32_sdwa v50, 3, v50 dst_sel:WORD_0 dst_unused:UNUSED_PAD src0_sel:DWORD src1_sel:DWORD
    s_cmp_lt_i32 s42, 1280
    s_cbranch_scc1 L_ufix_49
L_uback_50:

    s_waitcnt vmcnt(10)
    v_perm_b32 v52, v95, v94, s24
    v_perm_b32 v54, v96, v95, s25
    v_perm_b32 v56, v97, v96, s26
    v_perm_b32 v58, v111, v97, s27
    v_mov_b32 v16, v94
    v_alignbyte_b32 v17, v96, v95, 1
    v_alignbyte_b32 v18, v97, v96, 2
    v_alignbyte_b32 v19, v111, v97, 3
    v_lshlrev_b32_sdwa v52, 3, v52 dst_sel:WORD_0 dst_unused:UNUSED_PAD src0_sel:DWORD src1_sel:DWORD
    v_lshlrev_b32_sdwa v54, 3, v54 dst_sel:WORD_0 dst_unused:UNUSED_PAD src0_sel:DWORD src1_sel:DWORD
    v_lshlrev_b32_sdwa v56, 3, v56 dst_sel:WORD_0 dst_unused:UNUSED_PAD src0_sel:DWORD src1_sel:DWORD
    v_lshlrev_b32_sdwa v58, 3, v58 dst_sel:WORD_0 dst_unused:UNUSED_PAD src0_sel:DWORD src1_sel:DWORD
    s_cmp_lt_i32 s42, 1792
    s_cbranch_scc1 L_ufix_51
L_uback_52:

    s_waitcnt vmcnt(8)
    v_perm_b32 v60, v99, v98, s24
    v_perm_b32 v62, v100, v99, s25
    v_perm_b32 v64, v101, v100, s26
    v_perm_b32 v66, v112, v101, s27
    v_mov_b32 v20, v98
    v_alignbyte_b32 v21, v100, v99, 1
    v_alignbyte_b32 v22, v101, v100, 2
    v_alignbyte_b32 v23, v112, v101, 3
    v_lshlrev_b32_sdwa v60, 3, v60 dst_sel:WORD_0 dst_unused:UNUSED_PAD src0_sel:DWORD src1_sel:DWORD
    v_lshlrev_b32_sdwa v62, 3, v62 dst_sel:WORD_0 dst_unused:UNUSED_PAD src0_sel:DWORD src1_sel:DWORD
    v_lshlrev_b32_sdwa v64, 3, v64 dst_sel:WORD_0 dst_unused:UNUSED_PAD src0_sel:DWORD src1_sel:DWORD
    v_lshlrev_b32_sdwa v66, 3, v66 dst_sel:WORD_0 dst_unused:UNUSED_PAD src0_sel:DWORD src1_sel:DWORD
    s_cmp_lt_i32 s42, 2304
    s_cbranch_scc1 L_ufix_53
L_uback_54:

    s_waitcnt vmcnt(6)
    v_perm_b32 v68, v103, v102, s24
    v_perm_b32 v70, v104, v103, s25
    v_perm_b32 v72, v105, v104, s26
    v_perm_b32 v74, v113, v105, s27
    v_mov_b32 v24, v102
    v_alignbyte_b32 v25, v104, v103, 1
    v_alignbyte_b32 v26, v105, v104, 2
    v_alignbyte_b32 v27, v113, v105, 3
    v_lshlrev_b32_sdwa v68, 3, v68 dst_sel:WORD_0 dst_unused:UNUSED_PAD src0_sel:DWORD src1_sel:DWORD
    v_lshlrev_b32_sdwa v70, 3, v70 dst_sel:WORD_0 dst_unused:UNUSED_PAD src0_sel:DWORD src1_sel:DWORD
    v_lshlrev_b32_sdwa v72, 3, v72 dst_sel:WORD_0 dst_unused:UNUSED_PAD src0_sel:DWORD src1_sel:DWORD
    v_lshlrev_b32_sdwa v74, 3, v74 dst_sel:WORD_0 dst_unused:UNUSED_PAD src0_sel:DWORD src1_sel:DWORD
    s_cmp_lt_i32 s42, 2816
    s_cbranch_scc1 L_ufix_55
L_uback_56:

    s_waitcnt vmcnt(4)
    v_perm_b32 v28, v5, v4, s24
    v_perm_b32 v30, v6, v5, s25
    v_perm_b32 v32, v7, v6, s26
    v_perm_b32 v34, v35, v7, s27
    v_alignbyte_b32 v5, v6, v5, 1
    v_alignbyte_b32 v6, v7, v6, 2
    v_alignbyte_b32 v7, v35, v7, 3
    v_lshlrev_b32_sdwa v28, 3, v28 dst_sel:WORD_0 dst_unused:UNUSED_PAD src0_sel:DWORD src1_sel:DWORD
    v_lshlrev_b32_sdwa v30, 3, v30 dst_sel:WORD_0 dst_unused:UNUSED_PAD src0_sel:DWORD src1_sel:DWORD
    v_lshlrev_b32_sdwa v32, 3, v32 dst_sel:WORD_0 dst_unused:UNUSED_PAD src0_sel:DWORD src1_sel:DWORD
    v_lshlrev_b32_sdwa v34, 3, v34 dst_sel:WORD_0 dst_unused:UNUSED_PAD src0_sel:DWORD src1_sel:DWORD
    s_cmp_lt_i32 s42, 256
    s_cbranch_scc1 L_ufix_57
L_uback_58:

    s_waitcnt vmcnt(2)
    v_perm_b32 v36, v9, v8, s24
    v_perm_b32 v38, v10, v9, s25
    v_perm_b32 v40, v11, v10, s26
    v_perm_b32 v42, v43, v11, s27
    v_alignbyte_b32 v9, v10, v9, 1
    v_alignbyte_b32 v10, v11, v10, 2
    v_alignbyte_b32 v11, v43, v11, 3
    v_lshlrev_b32_sdwa v36, 3, v36 dst_sel:WORD_0 dst_unused:UNUSED_PAD src0_sel:DWORD src1_sel:DWORD
    v_lshlrev_b32_sdwa v38, 3, v38 dst_sel:WORD_0 dst_unused:UNUSED_PAD src0_sel:DWORD src1_sel:DWORD
    v_lshlrev_b32_sdwa v40, 3, v40 dst_sel:WORD_0 dst_unused:UNUSED_PAD src0_sel:DWORD src1_sel:DWORD
    v_lshlrev_b32_sdwa v42, 3, v42 dst_sel:WORD_0 dst_unused:UNUSED_PAD src0_sel:DWORD src1_sel:DWORD
    s_cmp_lt_i32 s42, 768
    s_cbranch_scc1 L_ufix_59
L_uback_60:

    v_subrev_co_u32 v4, s[64:65], 2.0, v4
    v_subrev_co_u32 v5, s[66:67], 2.0, v5
    v_subrev_co_u32 v6, s[68:69], 2.0, v6
    v_subrev_co_u32 v7, s[70:71], 2.0, v7
    v_subrev_co_u32 v8, s[72:73], 2.0, v8
    v_subrev_co_u32 v9, s[74:75], 2.0, v9
    v_subrev_co_u32 v10, s[76:77], 2.0, v10
    v_subrev_co_u32 v11, s[78:79], 2.0, v11
    v_subrev_co_u32 v12, s[80:81], 2.0, v12
    v_subrev_co_u32 v13, s[82:83], 2.0, v13
    v_subrev_co_u32 v14, s[84:85], 2.0, v14
    v_subrev_co_u32 v15, s[86:87], 2.0, v15
    s_waitcnt lgkmcnt(0)
    s_barrier
    s_cmp_lt_u32 s5, s4
    s_cselect_b32 s41, s41, 0
    s_min_u32 s55, s5, 31
    s_min_u32 s41, s41, 3968
    s_lshl_b32 s52, s55, 6
    s_add_u32 s52, s52, s36
    s_mul_i32 s52, s52, 19840
    s_add_u32 s16, s44, s52
    s_addc_u32 s17, s45, 0
    s_mul_i32 s52, s41, 5
    s_add_u32 s52, s52, 3
    s_and_b32 s18, s52, -4

    s_mov_b64 exec, s[64:65]
    ds_read_b64 v[28:29], v28
    s_mov_b64 exec, s[66:67]
    ds_read_b64 v[30:31], v30
    s_mov_b64 exec, s[68:69]
    ds_read_b64 v[32:33], v32
    s_mov_b64 exec, s[70:71]
    ds_read_b64 v[34:35], v34
    s_mov_b64 exec, s[72:73]
    ds_read_b64 v[36:37], v36
    s_mov_b64 exec, s[74:75]
    ds_read_b64 v[38:39], v38
    s_mov_b64 exec, s[76:77]
    ds_read_b64 v[40:41], v40
    s_mov_b64 exec, s[78:79]
    ds_read_b64 v[42:43], v42
    s_mov_b64 exec, s[80:81]
    ds_read_b64 v[44:45], v44
    s_mov_b64 exec, s[82:83]
    ds_read_b64 v[46:47], v46
    s_mov_b64 exec, s[84:85]
    ds_read_b64 v[48:49], v48
    s_mov_b64 exec, s[86:87]
    ds_read_b64 v[50:51], v50
    s_mov_b64 exec, -1
    s_movk_i32 s53, 5120
    buffer_load_dwordx4 v[90:93], v2, s[16:19], s53 offen
    buffer_load_dword v110, v2, s[16:19], s53 offen offset:16
    v_subrev_co_u32 v16, s[64:65], 2.0, v16
    v_subrev_co_u32 v17, s[66:67], 2.0, v17
    v_subrev_co_u32 v18, s[68:69], 2.0, v18
    v_subrev_co_u32 v19, s[70:71], 2.0, v19
    v_subrev_co_u32 v20, s[72:73], 2.0, v20
    v_subrev_co_u32 v21, s[74:75], 2.0, v21
    v_subrev_co_u32 v22, s[76:77], 2.0, v22
    v_subrev_co_u32 v23, s[78:79], 2.0, v23
    v_subrev_co_u32 v24, s[80:81], 2.0, v24
    v_subrev_co_u32 v25, s[82:83], 2.0, v25
    v_subrev_co_u32 v26, s[84:85], 2.0, v26
    v_subrev_co_u32 v27, s[86:87], 2.0, v27
    s_mov_b64 exec, s[64:65]
    ds_read_b64 v[52:53], v52
    s_mov_b64 exec, s[66:67]
    ds_read_b64 v[54:55], v54
    s_mov_b64 exec, s[68:69]
    ds_read_b64 v[56:57], v56
    s_mov_b64 exec, s[70:71]
    ds_read_b64 v[58:59], v58
    s_mov_b64 exec, s[72:73]
    ds_read_b64 v[60:61], v60
    s_mov_b64 exec, s[74:75]
    ds_read_b64 v[62:63], v62
    s_mov_b64 exec, s[76:77]
    ds_read_b64 v[64:65], v64
    s_mov_b64 exec, s[78:79]
    ds_read_b64 v[66:67], v66
    s_mov_b64 exec, s[80:81]
    ds_read_b64 v[68:69], v68
    s_mov_b64 exec, s[82:83]
    ds_read_b64 v[70:71], v70
    s_mov_b64 exec, s[84:85]
    ds_read_b64 v[72:73], v72
    s_mov_b64 exec, s[86:87]
    ds_read_b64 v[74:75], v74
    s_mov_b64 exec, -1
    s_waitcnt lgkmcnt(0)
    s_barrier
    s_waitcnt vmcnt(5)
    ds_write_b128 v3, v[76:79] offset:0
    s_waitcnt vmcnt(4)
    ds_write_b128 v3, v[80:83] offset:16384
    s_waitcnt vmcnt(3)
    ds_write_b128 v3, v[84:87] offset:32768
    v_lshlrev_b32 v123, 2, v0
    s_waitcnt vmcnt(2)
    s_mov_b64 exec, s[48:49]
    ds_write_b32 v123, v88 offset:49152
    s_mov_b64 exec, -1

    s_add_u32 s43, s43, 50000
    s_add_u32 s14, s43, 50000
    buffer_load_dwordx4 v[76:79], v3, s[12:15], s43 offen
    s_add_u32 s52, s43, 16384
    buffer_load_dwordx4 v[80:83], v3, s[12:15], s52 offen
    v_subrev_co_u32 v4, s[64:65], 2.0, v4
    v_subrev_co_u32 v5, s[66:67], 2.0, v5
    v_subrev_co_u32 v6, s[68:69], 2.0, v6
    v_subrev_co_u32 v7, s[70:71], 2.0, v7
    v_subrev_co_u32 v8, s[72:73], 2.0, v8
    v_subrev_co_u32 v9, s[74:75], 2.0, v9
    v_subrev_co_u32 v10, s[76:77], 2.0, v10
    v_subrev_co_u32 v11, s[78:79], 2.0, v11
    v_subrev_co_u32 v12, s[80:81], 2.0, v12
    v_subrev_co_u32 v13, s[82:83], 2.0, v13
    v_subrev_co_u32 v14, s[84:85], 2.0, v14
    v_subrev_co_u32 v15, s[86:87], 2.0, v15
    s_waitcnt lgkmcnt(0)
    s_barrier
    s_add_u32 s52, s43, 32768
    buffer_load_dwordx4 v[84:87], v3, s[12:15], s52 offen
    s_add_u32 s52, s43, 49152
    v_lshlrev_b32 v123, 2, v0
    buffer_load_dword v88, v123, s[12:15], s52 offen
    s_mov_b64 exec, s[64:65]
    ds_read_b64 v[28:29], v28
    s_mov_b64 exec, s[66:67]
    ds_read_b64 v[30:31], v30
    s_mov_b64 exec, s[68:69]
    ds_read_b64 v[32:33], v32
    s_mov_b64 exec, s[70:71]
    ds_read_b64 v[34:35], v34
    s_mov_b64 exec, s[72:73]
    ds_read_b64 v[36:37], v36
    s_mov_b64 exec, s[74:75]
    ds_read_b64 v[38:39], v38
    s_mov_b64 exec, s[76:77]
    ds_read_b64 v[40:41], v40
    s_mov_b64 exec, s[78:79]
    ds_read_b64 v[42:43], v42
    s_mov_b64 exec, s[80:81]
    ds_read_b64 v[44:45], v44
    s_mov_b64 exec, s[82:83]
    ds_read_b64 v[46:47], v46
    s_mov_b64 exec, s[84:85]
    ds_read_b64 v[48:49], v48
    s_mov_b64 exec, s[86:87]
    ds_read_b64 v[50:51], v50
    s_mov_b64 exec, -1
    s_movk_i32 s53, 7680
    buffer_load_dwordx4 v[94:97], v2, s[16:19], s53 offen
    buffer_load_dword v111, v2, s[16:19], s53 offen offset:16
    v_subrev_co_u32 v16, s[64:65], 2.0, v16
    v_subrev_co_u32 v17, s[66:67], 2.0, v17
    v_subrev_co_u32 v18, s[68:69], 2.0, v18
    v_subrev_co_u32 v19, s[70:71], 2.0, v19
    v_subrev_co_u32 v20, s[72:73], 2.0, v20
    v_subrev_co_u32 v21, s[74:75], 2.0, v21
    v_subrev_co_u32 v22, s[76:77], 2.0, v22
    v_subrev_co_u32 v23, s[78:79], 2.0, v23
    v_subrev_co_u32 v24, s[80:81], 2.0, v24
    v_subrev_co_u32 v25, s[82:83], 2.0, v25
    v_subrev_co_u32 v26, s[84:85], 2.0, v26
    v_subrev_co_u32 v27, s[86:87], 2.0, v27
    s_mov_b64 exec, s[64:65]
    ds_read_b64 v[52:53], v52
    s_mov_b64 exec, s[66:67]
    ds_read_b64 v[54:55], v54
    s_mov_b64 exec, s[68:69]
    ds_read_b64 v[56:57], v56
    s_mov_b64 exec, s[70:71]
    ds_read_b64 v[58:59], v58
    s_mov_b64 exec, s[72:73]
    ds_read_b64 v[60:61], v60
    s_mov_b64 exec, s[74:75]
    ds_read_b64 v[62:63], v62
    s_mov_b64 exec, s[76:77]
    ds_read_b64 v[64:65], v64
    s_mov_b64 exec, s[78:79]
    ds_read_b64 v[66:67], v66
    s_mov_b64 exec, s[80:81]
    ds_read_b64 v[68:69], v68
    s_mov_b64 exec, s[82:83]
    ds_read_b64 v[70:71], v70
    s_mov_b64 exec, s[84:85]
    ds_read_b64 v[72:73], v72
    s_mov_b64 exec, s[86:87]
    ds_read_b64 v[74:75], v74
    s_mov_b64 exec, -1
    s_waitcnt lgkmcnt(0)
    s_barrier
    s_waitcnt vmcnt(5)
    ds_write_b128 v3, v[76:79] offset:0
    s_waitcnt vmcnt(4)
    ds_write_b128 v3, v[80:83] offset:16384
    s_waitcnt vmcnt(3)
    ds_write_b128 v3, v[84:87] offset:32768
    v_lshlrev_b32 v123, 2, v0
    s_waitcnt vmcnt(2)
    s_mov_b64 exec, s[48:49]
    ds_write_b32 v123, v88 offset:49152
    s_mov_b64 exec, -1

    s_add_u32 s43, s43, 50000
    s_add_u32 s14, s43, 50000
    buffer_load_dwordx4 v[76:79], v3, s[12:15], s43 offen
    s_add_u32 s52, s43, 16384
    buffer_load_dwordx4 v[80:83], v3, s[12:15], s52 offen
    v_subrev_co_u32 v4, s[64:65], 2.0, v4
    v_subrev_co_u32 v5, s[66:67], 2.0, v5
    v_subrev_co_u32 v6, s[68:69], 2.0, v6
    v_subrev_co_u32 v7, s[70:71], 2.0, v7
    v_subrev_co_u32 v8, s[72:73], 2.0, v8
    v_subrev_co_u32 v9, s[74:75], 2.0, v9
    v_subrev_co_u32 v10, s[76:77], 2.0, v10
    v_subrev_co_u32 v11, s[78:79], 2.0, v11
    v_subrev_co_u32 v12, s[80:81], 2.0, v12
    v_subrev_co_u32 v13, s[82:83], 2.0, v13
    v_subrev_co_u32 v14, s[84:85], 2.0, v14
    v_subrev_co_u32 v15, s[86:87], 2.0, v15
    s_waitcnt lgkmcnt(0)
    s_barrier
    s_add_u32 s52, s43, 32768
    buffer_load_dwordx4 v[84:87], v3, s[12:15], s52 offen
    s_add_u32 s52, s43, 49152
    v_lshlrev_b32 v123, 2, v0
    buffer_load_dword v88, v123, s[12:15], s52 offen
    s_mov_b64 exec, s[64:65]
    ds_read_b64 v[28:29], v28
    s_mov_b64 exec, s[66:67]
    ds_read_b64 v[30:31], v30
    s_mov_b64 exec, s[68:69]
    ds_read_b64 v[32:33], v32
    s_mov_b64 exec, s[70:71]
    ds_read_b64 v[34:35], v34
    s_mov_b64 exec, s[72:73]
    ds_read_b64 v[36:37], v36
    s_mov_b64 exec, s[74:75]
    ds_read_b64 v[38:39], v38
    s_mov_b64 exec, s[76:77]
    ds_read_b64 v[40:41], v40
    s_mov_b64 exec, s[78:79]
    ds_read_b64 v[42:43], v42
    s_mov_b64 exec, s[80:81]
    ds_read_b64 v[44:45], v44
    s_mov_b64 exec, s[82:83]
    ds_read_b64 v[46:47], v46
    s_mov_b64 exec, s[84:85]
    ds_read_b64 v[48:49], v48
    s_mov_b64 exec, s[86:87]
    ds_read_b64 v[50:51], v50
    s_mov_b64 exec, -1
    s_movk_i32 s53, 10240
    buffer_load_dwordx4 v[98:101], v2, s[16:19], s53 offen
    buffer_load_dword v112, v2, s[16:19], s53 offen offset:16
    v_subrev_co_u32 v16, s[64:65], 2.0, v16
    v_subrev_co_u32 v17, s[66:67], 2.0, v17
    v_subrev_co_u32 v18, s[68:69], 2.0, v18
    v_subrev_co_u32 v19, s[70:71], 2.0, v19
    v_subrev_co_u32 v20, s[72:73], 2.0, v20
    v_subrev_co_u32 v21, s[74:75], 2.0, v21
    v_subrev_co_u32 v22, s[76:77], 2.0, v22
    v_subrev_co_u32 v23, s[78:79], 2.0, v23
    v_subrev_co_u32 v24, s[80:81], 2.0, v24
    v_subrev_co_u32 v25, s[82:83], 2.0, v25
    v_subrev_co_u32 v26, s[84:85], 2.0, v26
    v_subrev_co_u32 v27, s[86:87], 2.0, v27
    s_mov_b64 exec, s[64:65]
    ds_read_b64 v[52:53], v52
    s_mov_b64 exec, s[66:67]
    ds_read_b64 v[54:55], v54
    s_mov_b64 exec, s[68:69]
    ds_read_b64 v[56:57], v56
    s_mov_b64 exec, s[70:71]
    ds_read_b64 v[58:59], v58
    s_mov_b64 exec, s[72:73]
    ds_read_b64 v[60:61], v60
    s_mov_b64 exec, s[74:75]
    ds_read_b64 v[62:63], v62
    s_mov_b64 exec, s[76:77]
    ds_read_b64 v[64:65], v64
    s_mov_b64 exec, s[78:79]
    ds_read_b64 v[66:67], v66
    s_mov_b64 exec, s[80:81]
    ds_read_b64 v[68:69], v68
    s_mov_b64 exec, s[82:83]
    ds_read_b64 v[70:71], v70
    s_mov_b64 exec, s[84:85]
    ds_read_b64 v[72:73], v72
    s_mov_b64 exec, s[86:87]
    ds_read_b64 v[74:75], v74
    s_mov_b64 exec, -1
    s_waitcnt lgkmcnt(0)
    s_barrier
    s_waitcnt vmcnt(5)
    ds_write_b128 v3, v[76:79] offset:0
    s_waitcnt vmcnt(4)
    ds_write_b128 v3, v[80:83] offset:16384
    s_waitcnt vmcnt(3)
    ds_write_b128 v3, v[84:87] offset:32768
    v_lshlrev_b32 v123, 2, v0
    s_waitcnt vmcnt(2)
    s_mov_b64 exec, s[48:49]
    ds_write_b32 v123, v88 offset:49152
    s_mov_b64 exec, -1

    s_add_u32 s43, s43, 50000
    s_add_u32 s14, s43, 50000
    s_cmp_lt_u32 s5, s4
    s_cselect_b32 s14, s14, 0
    buffer_load_dwordx4 v[76:79], v3, s[12:15], s43 offen
    s_add_u32 s52, s43, 16384
    buffer_load_dwordx4 v[80:83], v3, s[12:15], s52 offen
    v_cmp_gt_u32 s[64:65], 2.0, v4
    v_and_b32 v4, 0x3fffffff, v4
    v_cmp_gt_u32 s[66:67], 2.0, v5
    v_and_b32 v5, 0x3fffffff, v5
    v_cmp_gt_u32 s[68:69], 2.0, v6
    v_and_b32 v6, 0x3fffffff, v6
    v_cmp_gt_u32 s[70:71], 2.0, v7
    v_and_b32 v7, 0x3fffffff, v7
    v_cmp_gt_u32 s[72:73], 2.0, v8
    v_and_b32 v8, 0x3fffffff, v8
    v_cmp_gt_u32 s[74:75], 2.0, v9
    v_and_b32 v9, 0x3fffffff, v9
    v_cmp_gt_u32 s[76:77], 2.0, v10
    v_and_b32 v10, 0x3fffffff, v10
    v_cmp_gt_u32 s[78:79], 2.0, v11
    v_and_b32 v11, 0x3fffffff, v11
    v_cmp_gt_u32 s[80:81], 2.0, v12
    v_and_b32 v12, 0x3fffffff, v12
    v_cmp_gt_u32 s[82:83], 2.0, v13
    v_and_b32 v13, 0x3fffffff, v13
    v_cmp_gt_u32 s[84:85], 2.0, v14
    v_and_b32 v14, 0x3fffffff, v14
    v_cmp_gt_u32 s[86:87], 2.0, v15
    v_and_b32 v15, 0x3fffffff, v15
    s_waitcnt lgkmcnt(0)
    s_barrier
    s_add_u32 s52, s43, 32768
    buffer_load_dwordx4 v[84:87], v3, s[12:15], s52 offen
    s_add_u32 s52, s43, 49152
    v_lshlrev_b32 v123, 2, v0
    buffer_load_dword v88, v123, s[12:15], s52 offen
    s_mov_b64 exec, s[64:65]
    ds_read_b64 v[28:29], v28
    s_mov_b64 exec, s[66:67]
    ds_read_b64 v[30:31], v30
    s_mov_b64 exec, s[68:69]
    ds_read_b64 v[32:33], v32
    s_mov_b64 exec, s[70:71]
    ds_read_b64 v[34:35], v34
    s_mov_b64 exec, s[72:73]
    ds_read_b64 v[36:37], v36
    s_mov_b64 exec, s[74:75]
    ds_read_b64 v[38:39], v38
    s_mov_b64 exec, s[76:77]
    ds_read_b64 v[40:41], v40
    s_mov_b64 exec, s[78:79]
    ds_read_b64 v[42:43], v42
    s_mov_b64 exec, s[80:81]
    ds_read_b64 v[44:45], v44
    s_mov_b64 exec, s[82:83]
    ds_read_b64 v[46:47], v46
    s_mov_b64 exec, s[84:85]
    ds_read_b64 v[48:49], v48
    s_mov_b64 exec, s[86:87]
    ds_read_b64 v[50:51], v50
    s_mov_b64 exec, -1
    s_movk_i32 s53, 12800
    buffer_load_dwordx4 v[102:105], v2, s[16:19], s53 offen
    buffer_load_dword v113, v2, s[16:19], s53 offen offset:16
    v_cmp_gt_u32 s[64:65], 2.0, v16
    v_and_b32 v16, 0x3fffffff, v16
    v_cmp_gt_u32 s[66:67], 2.0, v17
    v_and_b32 v17, 0x3fffffff, v17
    v_cmp_gt_u32 s[68:69], 2.0, v18
    v_and_b32 v18, 0x3fffffff, v18
    v_cmp_gt_u32 s[70:71], 2.0, v19
    v_and_b32 v19, 0x3fffffff, v19
    v_cmp_gt_u32 s[72:73], 2.0, v20
    v_and_b32 v20, 0x3fffffff, v20
    v_cmp_gt_u32 s[74:75], 2.0, v21
    v_and_b32 v21, 0x3fffffff, v21
    v_cmp_gt_u32 s[76:77], 2.0, v22
    v_and_b32 v22, 0x3fffffff, v22
    v_cmp_gt_u32 s[78:79], 2.0, v23
    v_and_b32 v23, 0x3fffffff, v23
    v_cmp_gt_u32 s[80:81], 2.0, v24
    v_and_b32 v24, 0x3fffffff, v24
    v_cmp_gt_u32 s[82:83], 2.0, v25
    v_and_b32 v25, 0x3fffffff, v25
    v_cmp_gt_u32 s[84:85], 2.0, v26
    v_and_b32 v26, 0x3fffffff, v26
    v_cmp_gt_u32 s[86:87], 2.0, v27
    v_and_b32 v27, 0x3fffffff, v27
    s_mov_b64 exec, s[64:65]
    ds_read_b64 v[52:53], v52
    s_mov_b64 exec, s[66:67]
    ds_read_b64 v[54:55], v54
    s_mov_b64 exec, s[68:69]
    ds_read_b64 v[56:57], v56
    s_mov_b64 exec, s[70:71]
    ds_read_b64 v[58:59], v58
    s_mov_b64 exec, s[72:73]
    ds_read_b64 v[60:61], v60
    s_mov_b64 exec, s[74:75]
    ds_read_b64 v[62:63], v62
    s_mov_b64 exec, s[76:77]
    ds_read_b64 v[64:65], v64
    s_mov_b64 exec, s[78:79]
    ds_read_b64 v[66:67], v66
    s_mov_b64 exec, s[80:81]
    ds_read_b64 v[68:69], v68
    s_mov_b64 exec, s[82:83]
    ds_read_b64 v[70:71], v70
    s_mov_b64 exec, s[84:85]
    ds_read_b64 v[72:73], v72
    s_mov_b64 exec, s[86:87]
    ds_read_b64 v[74:75], v74
    s_mov_b64 exec, -1
    s_waitcnt lgkmcnt(0)
    s_barrier
    s_waitcnt vmcnt(5)
    ds_write_b128 v3, v[76:79] offset:0
    s_waitcnt vmcnt(4)
    ds_write_b128 v3, v[80:83] offset:16384
    s_waitcnt vmcnt(3)
    ds_write_b128 v3, v[84:87] offset:32768
    v_lshlrev_b32 v123, 2, v0
    s_waitcnt vmcnt(2)
    s_mov_b64 exec, s[48:49]
    ds_write_b32 v123, v88 offset:49152
    s_mov_b64 exec, -1

    s_add_u32 s43, s43, 50000
    s_add_u32 s14, s43, 50000
    s_cmp_lt_u32 s5, s4
    s_cselect_b32 s14, s14, 0
    buffer_load_dwordx4 v[76:79], v3, s[12:15], s43 offen
    s_add_u32 s52, s43, 16384
    buffer_load_dwordx4 v[80:83], v3, s[12:15], s52 offen
    s_add_u32 s52, s43, 32768
    buffer_load_dwordx4 v[84:87], v3, s[12:15], s52 offen
    s_add_u32 s52, s43, 49152
    v_lshlrev_b32 v123, 2, v0
    buffer_load_dword v88, v123, s[12:15], s52 offen
    s_add_u32 s54, s43, 50000
    buffer_load_dword v115, v89, s[8:11], s54 offen
    v_cvt_f32_i32_sdwa v118, sext(v4) dst_sel:DWORD dst_unused:UNUSED_PAD src0_sel:WORD_0
    v_lshlrev_b32 v116, 16, v28
    v_and_b32 v117, s32, v28
    v_mul_f32 v118, s33, v118
    v_lshlrev_b32 v28, 16, v29
    v_and_b32 v29, s32, v29
    v_lshlrev_b32_sdwa v4, 3, v4 dst_sel:DWORD dst_unused:UNUSED_PAD src0_sel:DWORD src1_sel:WORD_1
    v_pk_fma_f32 v[116:117], v[116:117], v[118:119], s[28:29] op_sel_hi:[1,0,1]
    v_pk_fma_f32 v[28:29], v[28:29], v[118:119], s[28:29] op_sel_hi:[1,0,1]
    v_perm_b32 v116, v117, v116, s35
    v_perm_b32 v117, v29, v28, s35
    v_lshl_add_u64 v[116:117], v[116:117], 0, s[30:31]
    ds_add_rtn_u64 v[28:29], v4, v[116:117] offset:50000

    v_cvt_f32_i32_sdwa v122, sext(v5) dst_sel:DWORD dst_unused:UNUSED_PAD src0_sel:WORD_0
    v_lshlrev_b32 v120, 16, v30
    v_and_b32 v121, s32, v30
    v_mul_f32 v122, s33, v122
    v_lshlrev_b32 v30, 16, v31
    v_and_b32 v31, s32, v31
    v_lshlrev_b32_sdwa v5, 3, v5 dst_sel:DWORD dst_unused:UNUSED_PAD src0_sel:DWORD src1_sel:WORD_1
    v_pk_fma_f32 v[120:121], v[120:121], v[122:123], s[28:29] op_sel_hi:[1,0,1]
    v_pk_fma_f32 v[30:31], v[30:31], v[122:123], s[28:29] op_sel_hi:[1,0,1]
    v_perm_b32 v120, v121, v120, s35
    v_perm_b32 v121, v31, v30, s35
    v_lshl_add_u64 v[120:121], v[120:121], 0, s[30:31]
    ds_add_rtn_u64 v[30:31], v5, v[120:121] offset:50000

    v_cvt_f32_i32_sdwa v118, sext(v6) dst_sel:DWORD dst_unused:UNUSED_PAD src0_sel:WORD_0
    v_lshlrev_b32 v116, 16, v32
    v_and_b32 v117, s32, v32
    v_mul_f32 v118, s33, v118
    v_lshlrev_b32 v32, 16, v33
    v_and_b32 v33, s32, v33
    v_lshlrev_b32_sdwa v6, 3, v6 dst_sel:DWORD dst_unused:UNUSED_PAD src0_sel:DWORD src1_sel:WORD_1
    v_pk_fma_f32 v[116:117], v[116:117], v[118:119], s[28:29] op_sel_hi:[1,0,1]
    v_pk_fma_f32 v[32:33], v[32:33], v[118:119], s[28:29] op_sel_hi:[1,0,1]
    v_perm_b32 v116, v117, v116, s35
    v_perm_b32 v117, v33, v32, s35
    v_lshl_add_u64 v[116:117], v[116:117], 0, s[30:31]
    ds_add_rtn_u64 v[32:33], v6, v[116:117] offset:50000

    v_cvt_f32_i32_sdwa v122, sext(v7) dst_sel:DWORD dst_unused:UNUSED_PAD src0_sel:WORD_0
    v_lshlrev_b32 v120, 16, v34
    v_and_b32 v121, s32, v34
    v_mul_f32 v122, s33, v122
    v_lshlrev_b32 v34, 16, v35
    v_and_b32 v35, s32, v35
    v_lshlrev_b32_sdwa v7, 3, v7 dst_sel:DWORD dst_unused:UNUSED_PAD src0_sel:DWORD src1_sel:WORD_1
    v_pk_fma_f32 v[120:121], v[120:121], v[122:123], s[28:29] op_sel_hi:[1,0,1]
    v_pk_fma_f32 v[34:35], v[34:35], v[122:123], s[28:29] op_sel_hi:[1,0,1]
    v_perm_b32 v120, v121, v120, s35
    v_perm_b32 v121, v35, v34, s35
    v_lshl_add_u64 v[120:121], v[120:121], 0, s[30:31]
    ds_add_rtn_u64 v[34:35], v7, v[120:121] offset:50000

    v_cvt_f32_i32_sdwa v118, sext(v8) dst_sel:DWORD dst_unused:UNUSED_PAD src0_sel:WORD_0
    v_lshlrev_b32 v116, 16, v36
    v_and_b32 v117, s32, v36
    v_mul_f32 v118, s33, v118
    v_lshlrev_b32 v36, 16, v37
    v_and_b32 v37, s32, v37
    v_lshlrev_b32_sdwa v8, 3, v8 dst_sel:DWORD dst_unused:UNUSED_PAD src0_sel:DWORD src1_sel:WORD_1
    v_pk_fma_f32 v[116:117], v[116:117], v[118:119], s[28:29] op_sel_hi:[1,0,1]
    v_pk_fma_f32 v[36:37], v[36:37], v[118:119], s[28:29] op_sel_hi:[1,0,1]
    v_perm_b32 v116, v117, v116, s35
    v_perm_b32 v117, v37, v36, s35
    v_lshl_add_u64 v[116:117], v[116:117], 0, s[30:31]
    ds_add_rtn_u64 v[36:37], v8, v[116:117] offset:50000

    v_cvt_f32_i32_sdwa v122, sext(v9) dst_sel:DWORD dst_unused:UNUSED_PAD src0_sel:WORD_0
    v_lshlrev_b32 v120, 16, v38
    v_and_b32 v121, s32, v38
    v_mul_f32 v122, s33, v122
    v_lshlrev_b32 v38, 16, v39
    v_and_b32 v39, s32, v39
    v_lshlrev_b32_sdwa v9, 3, v9 dst_sel:DWORD dst_unused:UNUSED_PAD src0_sel:DWORD src1_sel:WORD_1
    v_pk_fma_f32 v[120:121], v[120:121], v[122:123], s[28:29] op_sel_hi:[1,0,1]
    v_pk_fma_f32 v[38:39], v[38:39], v[122:123], s[28:29] op_sel_hi:[1,0,1]
    v_perm_b32 v120, v121, v120, s35
    v_perm_b32 v121, v39, v38, s35
    v_lshl_add_u64 v[120:121], v[120:121], 0, s[30:31]
    ds_add_rtn_u64 v[38:39], v9, v[120:121] offset:50000

    v_cvt_f32_i32_sdwa v118, sext(v10) dst_sel:DWORD dst_unused:UNUSED_PAD src0_sel:WORD_0
    v_lshlrev_b32 v116, 16, v40
    v_and_b32 v117, s32, v40
    v_mul_f32 v118, s33, v118
    v_lshlrev_b32 v40, 16, v41
    v_and_b32 v41, s32, v41
    v_lshlrev_b32_sdwa v10, 3, v10 dst_sel:DWORD dst_unused:UNUSED_PAD src0_sel:DWORD src1_sel:WORD_1
    v_pk_fma_f32 v[116:117], v[116:117], v[118:119], s[28:29] op_sel_hi:[1,0,1]
    v_pk_fma_f32 v[40:41], v[40:41], v[118:119], s[28:29] op_sel_hi:[1,0,1]
    v_perm_b32 v116, v117, v116, s35
    v_perm_b32 v117, v41, v40, s35
    v_lshl_add_u64 v[116:117], v[116:117], 0, s[30:31]
    ds_add_rtn_u64 v[40:41], v10, v[116:117] offset:50000

    v_cvt_f32_i32_sdwa v122, sext(v11) dst_sel:DWORD dst_unused:UNUSED_PAD src0_sel:WORD_0
    v_lshlrev_b32 v120, 16, v42
    v_and_b32 v121, s32, v42
    v_mul_f32 v122, s33, v122
    v_lshlrev_b32 v42, 16, v43
    v_and_b32 v43, s32, v43
    v_lshlrev_b32_sdwa v11, 3, v11 dst_sel:DWORD dst_unused:UNUSED_PAD src0_sel:DWORD src1_sel:WORD_1
    v_pk_fma_f32 v[120:121], v[120:121], v[122:123], s[28:29] op_sel_hi:[1,0,1]
    v_pk_fma_f32 v[42:43], v[42:43], v[122:123], s[28:29] op_sel_hi:[1,0,1]
    v_perm_b32 v120, v121, v120, s35
    v_perm_b32 v121, v43, v42, s35
    v_lshl_add_u64 v[120:121], v[120:121], 0, s[30:31]
    ds_add_rtn_u64 v[42:43], v11, v[120:121] offset:50000

    s_waitcnt lgkmcnt(4)
    v_or3_b32 v1, v28, v29, v1
    v_or3_b32 v1, v30, v31, v1
    v_or3_b32 v1, v32, v33, v1
    v_or3_b32 v1, v34, v35, v1
    s_movk_i32 s53, 0
    buffer_load_dwordx4 v[4:7], v2, s[16:19], s53 offen
    buffer_load_dword v35, v2, s[16:19], s53 offen offset:16
    v_cvt_f32_i32_sdwa v118, sext(v12) dst_sel:DWORD dst_unused:UNUSED_PAD src0_sel:WORD_0
    v_lshlrev_b32 v116, 16, v44
    v_and_b32 v117, s32, v44
    v_mul_f32 v118, s33, v118
    v_lshlrev_b32 v44, 16, v45
    v_and_b32 v45, s32, v45
    v_lshlrev_b32_sdwa v12, 3, v12 dst_sel:DWORD dst_unused:UNUSED_PAD src0_sel:DWORD src1_sel:WORD_1
    v_pk_fma_f32 v[116:117], v[116:117], v[118:119], s[28:29] op_sel_hi:[1,0,1]
    v_pk_fma_f32 v[44:45], v[44:45], v[118:119], s[28:29] op_sel_hi:[1,0,1]
    v_perm_b32 v116, v117, v116, s35
    v_perm_b32 v117, v45, v44, s35
    v_lshl_add_u64 v[116:117], v[116:117], 0, s[30:31]
    ds_add_rtn_u64 v[44:45], v12, v[116:117] offset:50000

    v_cvt_f32_i32_sdwa v122, sext(v13) dst_sel:DWORD dst_unused:UNUSED_PAD src0_sel:WORD_0
    v_lshlrev_b32 v120, 16, v46
    v_and_b32 v121, s32, v46
    v_mul_f32 v122, s33, v122
    v_lshlrev_b32 v46, 16, v47
    v_and_b32 v47, s32, v47
    v_lshlrev_b32_sdwa v13, 3, v13 dst_sel:DWORD dst_unused:UNUSED_PAD src0_sel:DWORD src1_sel:WORD_1
    v_pk_fma_f32 v[120:121], v[120:121], v[122:123], s[28:29] op_sel_hi:[1,0,1]
    v_pk_fma_f32 v[46:47], v[46:47], v[122:123], s[28:29] op_sel_hi:[1,0,1]
    v_perm_b32 v120, v121, v120, s35
    v_perm_b32 v121, v47, v46, s35
    v_lshl_add_u64 v[120:121], v[120:121], 0, s[30:31]
    ds_add_rtn_u64 v[46:47], v13, v[120:121] offset:50000

    v_cvt_f32_i32_sdwa v118, sext(v14) dst_sel:DWORD dst_unused:UNUSED_PAD src0_sel:WORD_0
    v_lshlrev_b32 v116, 16, v48
    v_and_b32 v117, s32, v48
    v_mul_f32 v118, s33, v118
    v_lshlrev_b32 v48, 16, v49
    v_and_b32 v49, s32, v49
    v_lshlrev_b32_sdwa v14, 3, v14 dst_sel:DWORD dst_unused:UNUSED_PAD src0_sel:DWORD src1_sel:WORD_1
    v_pk_fma_f32 v[116:117], v[116:117], v[118:119], s[28:29] op_sel_hi:[1,0,1]
    v_pk_fma_f32 v[48:49], v[48:49], v[118:119], s[28:29] op_sel_hi:[1,0,1]
    v_perm_b32 v116, v117, v116, s35
    v_perm_b32 v117, v49, v48, s35
    v_lshl_add_u64 v[116:117], v[116:117], 0, s[30:31]
    ds_add_rtn_u64 v[48:49], v14, v[116:117] offset:50000

    v_cvt_f32_i32_sdwa v122, sext(v15) dst_sel:DWORD dst_unused:UNUSED_PAD src0_sel:WORD_0
    v_lshlrev_b32 v120, 16, v50
    v_and_b32 v121, s32, v50
    v_mul_f32 v122, s33, v122
    v_lshlrev_b32 v50, 16, v51
    v_and_b32 v51, s32, v51
    v_lshlrev_b32_sdwa v15, 3, v15 dst_sel:DWORD dst_unused:UNUSED_PAD src0_sel:DWORD src1_sel:WORD_1
    v_pk_fma_f32 v[120:121], v[120:121], v[122:123], s[28:29] op_sel_hi:[1,0,1]
    v_pk_fma_f32 v[50:51], v[50:51], v[122:123], s[28:29] op_sel_hi:[1,0,1]
    v_perm_b32 v120, v121, v120, s35
    v_perm_b32 v121, v51, v50, s35
    v_lshl_add_u64 v[120:121], v[120:121], 0, s[30:31]
    ds_add_rtn_u64 v[50:51], v15, v[120:121] offset:50000

    s_waitcnt lgkmcnt(4)
    v_or3_b32 v1, v36, v37, v1
    v_or3_b32 v1, v38, v39, v1
    v_or3_b32 v1, v40, v41, v1
    v_or3_b32 v1, v42, v43, v1
    s_movk_i32 s53, 2560
    buffer_load_dwordx4 v[8:11], v2, s[16:19], s53 offen
    buffer_load_dword v43, v2, s[16:19], s53 offen offset:16
    v_cvt_f32_i32_sdwa v118, sext(v16) dst_sel:DWORD dst_unused:UNUSED_PAD src0_sel:WORD_0
    v_lshlrev_b32 v116, 16, v52
    v_and_b32 v117, s32, v52
    v_mul_f32 v118, s33, v118
    v_lshlrev_b32 v52, 16, v53
    v_and_b32 v53, s32, v53
    v_lshlrev_b32_sdwa v16, 3, v16 dst_sel:DWORD dst_unused:UNUSED_PAD src0_sel:DWORD src1_sel:WORD_1
    v_pk_fma_f32 v[116:117], v[116:117], v[118:119], s[28:29] op_sel_hi:[1,0,1]
    v_pk_fma_f32 v[52:53], v[52:53], v[118:119], s[28:29] op_sel_hi:[1,0,1]
    v_perm_b32 v116, v117, v116, s35
    v_perm_b32 v117, v53, v52, s35
    v_lshl_add_u64 v[116:117], v[116:117], 0, s[30:31]
    ds_add_rtn_u64 v[52:53], v16, v[116:117] offset:50000

    v_cvt_f32_i32_sdwa v122, sext(v17) dst_sel:DWORD dst_unused:UNUSED_PAD src0_sel:WORD_0
    v_lshlrev_b32 v120, 16, v54
    v_and_b32 v121, s32, v54
    v_mul_f32 v122, s33, v122
    v_lshlrev_b32 v54, 16, v55
    v_and_b32 v55, s32, v55
    v_lshlrev_b32_sdwa v17, 3, v17 dst_sel:DWORD dst_unused:UNUSED_PAD src0_sel:DWORD src1_sel:WORD_1
    v_pk_fma_f32 v[120:121], v[120:121], v[122:123], s[28:29] op_sel_hi:[1,0,1]
    v_pk_fma_f32 v[54:55], v[54:55], v[122:123], s[28:29] op_sel_hi:[1,0,1]
    v_perm_b32 v120, v121, v120, s35
    v_perm_b32 v121, v55, v54, s35
    v_lshl_add_u64 v[120:121], v[120:121], 0, s[30:31]
    ds_add_rtn_u64 v[54:55], v17, v[120:121] offset:50000

    v_cvt_f32_i32_sdwa v118, sext(v18) dst_sel:DWORD dst_unused:UNUSED_PAD src0_sel:WORD_0
    v_lshlrev_b32 v116, 16, v56
    v_and_b32 v117, s32, v56
    v_mul_f32 v118, s33, v118
    v_lshlrev_b32 v56, 16, v57
    v_and_b32 v57, s32, v57
    v_lshlrev_b32_sdwa v18, 3, v18 dst_sel:DWORD dst_unused:UNUSED_PAD src0_sel:DWORD src1_sel:WORD_1
    v_pk_fma_f32 v[116:117], v[116:117], v[118:119], s[28:29] op_sel_hi:[1,0,1]
    v_pk_fma_f32 v[56:57], v[56:57], v[118:119], s[28:29] op_sel_hi:[1,0,1]
    v_perm_b32 v116, v117, v116, s35
    v_perm_b32 v117, v57, v56, s35
    v_lshl_add_u64 v[116:117], v[116:117], 0, s[30:31]
    ds_add_rtn_u64 v[56:57], v18, v[116:117] offset:50000

    v_cvt_f32_i32_sdwa v122, sext(v19) dst_sel:DWORD dst_unused:UNUSED_PAD src0_sel:WORD_0
    v_lshlrev_b32 v120, 16, v58
    v_and_b32 v121, s32, v58
    v_mul_f32 v122, s33, v122
    v_lshlrev_b32 v58, 16, v59
    v_and_b32 v59, s32, v59
    v_lshlrev_b32_sdwa v19, 3, v19 dst_sel:DWORD dst_unused:UNUSED_PAD src0_sel:DWORD src1_sel:WORD_1
    v_pk_fma_f32 v[120:121], v[120:121], v[122:123], s[28:29] op_sel_hi:[1,0,1]
    v_pk_fma_f32 v[58:59], v[58:59], v[122:123], s[28:29] op_sel_hi:[1,0,1]
    v_perm_b32 v120, v121, v120, s35
    v_perm_b32 v121, v59, v58, s35
    v_lshl_add_u64 v[120:121], v[120:121], 0, s[30:31]
    ds_add_rtn_u64 v[58:59], v19, v[120:121] offset:50000

    s_waitcnt lgkmcnt(4)
    v_or3_b32 v1, v44, v45, v1
    v_or3_b32 v1, v46, v47, v1
    v_or3_b32 v1, v48, v49, v1
    v_or3_b32 v1, v50, v51, v1
    s_cmp_le_i32 s42, 3072
    s_cbranch_scc1 L_nt1_61
    s_waitcnt vmcnt(29)
    v_perm_b32 v116, v107, v106, s24
    v_perm_b32 v118, v108, v107, s25
    v_perm_b32 v120, v109, v108, s26
    v_perm_b32 v122, v114, v109, s27
    v_alignbyte_b32 v107, v108, v107, 1
    v_alignbyte_b32 v108, v109, v108, 2
    v_alignbyte_b32 v109, v114, v109, 3
    v_lshlrev_b32_sdwa v116, 3, v116 dst_sel:WORD_0 dst_unused:UNUSED_PAD src0_sel:DWORD src1_sel:DWORD
    v_lshlrev_b32_sdwa v118, 3, v118 dst_sel:WORD_0 dst_unused:UNUSED_PAD src0_sel:DWORD src1_sel:DWORD
    v_lshlrev_b32_sdwa v120, 3, v120 dst_sel:WORD_0 dst_unused:UNUSED_PAD src0_sel:DWORD src1_sel:DWORD
    v_lshlrev_b32_sdwa v122, 3, v122 dst_sel:WORD_0 dst_unused:UNUSED_PAD src0_sel:DWORD src1_sel:DWORD
    s_cmp_lt_i32 s42, 3328
    s_cbranch_scc1 L_ufix_63
L_uback_64:

    v_lshrrev_b32 v117, 30, v106
    v_cmp_ne_u32 vcc, 0, v106
    v_mul_u32_u24 v117, 50000, v117
    v_and_b32 v106, 0x3fffffff, v106
    v_add_u32 v116, v116, v117
    s_mov_b64 s[64:65], vcc
    s_mov_b64 exec, vcc

    buffer_load_dwordx2 v[44:45], v116, s[8:11], s50 offen
    s_mov_b64 exec, -1
    v_lshrrev_b32 v117, 30, v107
    v_cmp_ne_u32 vcc, 0, v107
    v_mul_u32_u24 v117, 50000, v117
    v_and_b32 v107, 0x3fffffff, v107
    v_add_u32 v118, v118, v117
    s_mov_b64 s[66:67], vcc
    s_mov_b64 exec, vcc

    buffer_load_dwordx2 v[46:47], v118, s[8:11], s50 offen
    s_mov_b64 exec, -1
    v_lshrrev_b32 v117, 30, v108
    v_cmp_ne_u32 vcc, 0, v108
    v_mul_u32_u24 v117, 50000, v117
    v_and_b32 v108, 0x3fffffff, v108
    v_add_u32 v120, v120, v117
    s_mov_b64 s[68:69], vcc
    s_mov_b64 exec, vcc

    buffer_load_dwordx2 v[48:49], v120, s[8:11], s50 offen
    s_mov_b64 exec, -1
    v_lshrrev_b32 v117, 30, v109
    v_cmp_ne_u32 vcc, 0, v109
    v_mul_u32_u24 v117, 50000, v117
    v_and_b32 v109, 0x3fffffff, v109
    v_add_u32 v122, v122, v117
    s_mov_b64 s[70:71], vcc
    s_mov_b64 exec, vcc

    buffer_load_dwordx2 v[50:51], v122, s[8:11], s50 offen
    s_mov_b64 exec, -1
L_nt1_61:
    v_cvt_f32_i32_sdwa v118, sext(v20) dst_sel:DWORD dst_unused:UNUSED_PAD src0_sel:WORD_0
    v_lshlrev_b32 v116, 16, v60
    v_and_b32 v117, s32, v60
    v_mul_f32 v118, s33, v118
    v_lshlrev_b32 v60, 16, v61
    v_and_b32 v61, s32, v61
    v_lshlrev_b32_sdwa v20, 3, v20 dst_sel:DWORD dst_unused:UNUSED_PAD src0_sel:DWORD src1_sel:WORD_1
    v_pk_fma_f32 v[116:117], v[116:117], v[118:119], s[28:29] op_sel_hi:[1,0,1]
    v_pk_fma_f32 v[60:61], v[60:61], v[118:119], s[28:29] op_sel_hi:[1,0,1]
    v_perm_b32 v116, v117, v116, s35
    v_perm_b32 v117, v61, v60, s35
    v_lshl_add_u64 v[116:117], v[116:117], 0, s[30:31]
    ds_add_rtn_u64 v[60:61], v20, v[116:117] offset:50000

    v_cvt_f32_i32_sdwa v122, sext(v21) dst_sel:DWORD dst_unused:UNUSED_PAD src0_sel:WORD_0
    v_lshlrev_b32 v120, 16, v62
    v_and_b32 v121, s32, v62
    v_mul_f32 v122, s33, v122
    v_lshlrev_b32 v62, 16, v63
    v_and_b32 v63, s32, v63
    v_lshlrev_b32_sdwa v21, 3, v21 dst_sel:DWORD dst_unused:UNUSED_PAD src0_sel:DWORD src1_sel:WORD_1
    v_pk_fma_f32 v[120:121], v[120:121], v[122:123], s[28:29] op_sel_hi:[1,0,1]
    v_pk_fma_f32 v[62:63], v[62:63], v[122:123], s[28:29] op_sel_hi:[1,0,1]
    v_perm_b32 v120, v121, v120, s35
    v_perm_b32 v121, v63, v62, s35
    v_lshl_add_u64 v[120:121], v[120:121], 0, s[30:31]
    ds_add_rtn_u64 v[62:63], v21, v[120:121] offset:50000

    v_cvt_f32_i32_sdwa v118, sext(v22) dst_sel:DWORD dst_unused:UNUSED_PAD src0_sel:WORD_0
    v_lshlrev_b32 v116, 16, v64
    v_and_b32 v117, s32, v64
    v_mul_f32 v118, s33, v118
    v_lshlrev_b32 v64, 16, v65
    v_and_b32 v65, s32, v65
    v_lshlrev_b32_sdwa v22, 3, v22 dst_sel:DWORD dst_unused:UNUSED_PAD src0_sel:DWORD src1_sel:WORD_1
    v_pk_fma_f32 v[116:117], v[116:117], v[118:119], s[28:29] op_sel_hi:[1,0,1]
    v_pk_fma_f32 v[64:65], v[64:65], v[118:119], s[28:29] op_sel_hi:[1,0,1]
    v_perm_b32 v116, v117, v116, s35
    v_perm_b32 v117, v65, v64, s35
    v_lshl_add_u64 v[116:117], v[116:117], 0, s[30:31]
    ds_add_rtn_u64 v[64:65], v22, v[116:117] offset:50000

    v_cvt_f32_i32_sdwa v122, sext(v23) dst_sel:DWORD dst_unused:UNUSED_PAD src0_sel:WORD_0
    v_lshlrev_b32 v120, 16, v66
    v_and_b32 v121, s32, v66
    v_mul_f32 v122, s33, v122
    v_lshlrev_b32 v66, 16, v67
    v_and_b32 v67, s32, v67
    v_lshlrev_b32_sdwa v23, 3, v23 dst_sel:DWORD dst_unused:UNUSED_PAD src0_sel:DWORD src1_sel:WORD_1
    v_pk_fma_f32 v[120:121], v[120:121], v[122:123], s[28:29] op_sel_hi:[1,0,1]
    v_pk_fma_f32 v[66:67], v[66:67], v[122:123], s[28:29] op_sel_hi:[1,0,1]
    v_perm_b32 v120, v121, v120, s35
    v_perm_b32 v121, v67, v66, s35
    v_lshl_add_u64 v[120:121], v[120:121], 0, s[30:31]
    ds_add_rtn_u64 v[66:67], v23, v[120:121] offset:50000

    s_waitcnt lgkmcnt(4)
    v_or3_b32 v1, v52, v53, v1
    v_or3_b32 v1, v54, v55, v1
    v_or3_b32 v1, v56, v57, v1
    v_or3_b32 v1, v58, v59, v1
    v_cvt_f32_i32_sdwa v118, sext(v24) dst_sel:DWORD dst_unused:UNUSED_PAD src0_sel:WORD_0
    v_lshlrev_b32 v116, 16, v68
    v_and_b32 v117, s32, v68
    v_mul_f32 v118, s33, v118
    v_lshlrev_b32 v68, 16, v69
    v_and_b32 v69, s32, v69
    v_lshlrev_b32_sdwa v24, 3, v24 dst_sel:DWORD dst_unused:UNUSED_PAD src0_sel:DWORD src1_sel:WORD_1
    v_pk_fma_f32 v[116:117], v[116:117], v[118:119], s[28:29] op_sel_hi:[1,0,1]
    v_pk_fma_f32 v[68:69], v[68:69], v[118:119], s[28:29] op_sel_hi:[1,0,1]
    v_perm_b32 v116, v117, v116, s35
    v_perm_b32 v117, v69, v68, s35
    v_lshl_add_u64 v[116:117], v[116:117], 0, s[30:31]
    ds_add_rtn_u64 v[68:69], v24, v[116:117] offset:50000

    v_cvt_f32_i32_sdwa v122, sext(v25) dst_sel:DWORD dst_unused:UNUSED_PAD src0_sel:WORD_0
    v_lshlrev_b32 v120, 16, v70
    v_and_b32 v121, s32, v70
    v_mul_f32 v122, s33, v122
    v_lshlrev_b32 v70, 16, v71
    v_and_b32 v71, s32, v71
    v_lshlrev_b32_sdwa v25, 3, v25 dst_sel:DWORD dst_unused:UNUSED_PAD src0_sel:DWORD src1_sel:WORD_1
    v_pk_fma_f32 v[120:121], v[120:121], v[122:123], s[28:29] op_sel_hi:[1,0,1]
    v_pk_fma_f32 v[70:71], v[70:71], v[122:123], s[28:29] op_sel_hi:[1,0,1]
    v_perm_b32 v120, v121, v120, s35
    v_perm_b32 v121, v71, v70, s35
    v_lshl_add_u64 v[120:121], v[120:121], 0, s[30:31]
    ds_add_rtn_u64 v[70:71], v25, v[120:121] offset:50000

    v_cvt_f32_i32_sdwa v118, sext(v26) dst_sel:DWORD dst_unused:UNUSED_PAD src0_sel:WORD_0
    v_lshlrev_b32 v116, 16, v72
    v_and_b32 v117, s32, v72
    v_mul_f32 v118, s33, v118
    v_lshlrev_b32 v72, 16, v73
    v_and_b32 v73, s32, v73
    v_lshlrev_b32_sdwa v26, 3, v26 dst_sel:DWORD dst_unused:UNUSED_PAD src0_sel:DWORD src1_sel:WORD_1
    v_pk_fma_f32 v[116:117], v[116:117], v[118:119], s[28:29] op_sel_hi:[1,0,1]
    v_pk_fma_f32 v[72:73], v[72:73], v[118:119], s[28:29] op_sel_hi:[1,0,1]
    v_perm_b32 v116, v117, v116, s35
    v_perm_b32 v117, v73, v72, s35
    v_lshl_add_u64 v[116:117], v[116:117], 0, s[30:31]
    ds_add_rtn_u64 v[72:73], v26, v[116:117] offset:50000

    v_cvt_f32_i32_sdwa v122, sext(v27) dst_sel:DWORD dst_unused:UNUSED_PAD src0_sel:WORD_0
    v_lshlrev_b32 v120, 16, v74
    v_and_b32 v121, s32, v74
    v_mul_f32 v122, s33, v122
    v_lshlrev_b32 v74, 16, v75
    v_and_b32 v75, s32, v75
    v_lshlrev_b32_sdwa v27, 3, v27 dst_sel:DWORD dst_unused:UNUSED_PAD src0_sel:DWORD src1_sel:WORD_1
    v_pk_fma_f32 v[120:121], v[120:121], v[122:123], s[28:29] op_sel_hi:[1,0,1]
    v_pk_fma_f32 v[74:75], v[74:75], v[122:123], s[28:29] op_sel_hi:[1,0,1]
    v_perm_b32 v120, v121, v120, s35
    v_perm_b32 v121, v75, v74, s35
    v_lshl_add_u64 v[120:121], v[120:121], 0, s[30:31]
    ds_add_rtn_u64 v[74:75], v27, v[120:121] offset:50000

    s_waitcnt lgkmcnt(4)
    v_or3_b32 v1, v60, v61, v1
    v_or3_b32 v1, v62, v63, v1
    v_or3_b32 v1, v64, v65, v1
    v_or3_b32 v1, v66, v67, v1
    s_cmp_le_i32 s42, 3072
    s_cbranch_scc1 L_nt2_62
    s_waitcnt vmcnt(0)
    s_mov_b64 exec, s[64:65]
    v_cvt_f32_i32_sdwa v118, sext(v106) dst_sel:DWORD dst_unused:UNUSED_PAD src0_sel:WORD_0
    v_lshlrev_b32 v116, 16, v44
    v_and_b32 v117, s32, v44
    v_mul_f32 v118, s33, v118
    v_lshlrev_b32 v44, 16, v45
    v_and_b32 v45, s32, v45
    v_lshlrev_b32_sdwa v106, 3, v106 dst_sel:DWORD dst_unused:UNUSED_PAD src0_sel:DWORD src1_sel:WORD_1
    v_pk_fma_f32 v[116:117], v[116:117], v[118:119], s[28:29] op_sel_hi:[1,0,1]
    v_pk_fma_f32 v[44:45], v[44:45], v[118:119], s[28:29] op_sel_hi:[1,0,1]
    v_perm_b32 v116, v117, v116, s35
    v_perm_b32 v117, v45, v44, s35
    v_lshl_add_u64 v[116:117], v[116:117], 0, s[30:31]
    ds_add_rtn_u64 v[44:45], v106, v[116:117] offset:50000

    s_mov_b64 exec, s[66:67]
    v_cvt_f32_i32_sdwa v122, sext(v107) dst_sel:DWORD dst_unused:UNUSED_PAD src0_sel:WORD_0
    v_lshlrev_b32 v120, 16, v46
    v_and_b32 v121, s32, v46
    v_mul_f32 v122, s33, v122
    v_lshlrev_b32 v46, 16, v47
    v_and_b32 v47, s32, v47
    v_lshlrev_b32_sdwa v107, 3, v107 dst_sel:DWORD dst_unused:UNUSED_PAD src0_sel:DWORD src1_sel:WORD_1
    v_pk_fma_f32 v[120:121], v[120:121], v[122:123], s[28:29] op_sel_hi:[1,0,1]
    v_pk_fma_f32 v[46:47], v[46:47], v[122:123], s[28:29] op_sel_hi:[1,0,1]
    v_perm_b32 v120, v121, v120, s35
    v_perm_b32 v121, v47, v46, s35
    v_lshl_add_u64 v[120:121], v[120:121], 0, s[30:31]
    ds_add_rtn_u64 v[46:47], v107, v[120:121] offset:50000

    s_mov_b64 exec, s[68:69]
    v_cvt_f32_i32_sdwa v118, sext(v108) dst_sel:DWORD dst_unused:UNUSED_PAD src0_sel:WORD_0
    v_lshlrev_b32 v116, 16, v48
    v_and_b32 v117, s32, v48
    v_mul_f32 v118, s33, v118
    v_lshlrev_b32 v48, 16, v49
    v_and_b32 v49, s32, v49
    v_lshlrev_b32_sdwa v108, 3, v108 dst_sel:DWORD dst_unused:UNUSED_PAD src0_sel:DWORD src1_sel:WORD_1
    v_pk_fma_f32 v[116:117], v[116:117], v[118:119], s[28:29] op_sel_hi:[1,0,1]
    v_pk_fma_f32 v[48:49], v[48:49], v[118:119], s[28:29] op_sel_hi:[1,0,1]
    v_perm_b32 v116, v117, v116, s35
    v_perm_b32 v117, v49, v48, s35
    v_lshl_add_u64 v[116:117], v[116:117], 0, s[30:31]
    ds_add_rtn_u64 v[48:49], v108, v[116:117] offset:50000

    s_mov_b64 exec, s[70:71]
    v_cvt_f32_i32_sdwa v122, sext(v109) dst_sel:DWORD dst_unused:UNUSED_PAD src0_sel:WORD_0
    v_lshlrev_b32 v120, 16, v50
    v_and_b32 v121, s32, v50
    v_mul_f32 v122, s33, v122
    v_lshlrev_b32 v50, 16, v51
    v_and_b32 v51, s32, v51
    v_lshlrev_b32_sdwa v109, 3, v109 dst_sel:DWORD dst_unused:UNUSED_PAD src0_sel:DWORD src1_sel:WORD_1
    v_pk_fma_f32 v[120:121], v[120:121], v[122:123], s[28:29] op_sel_hi:[1,0,1]
    v_pk_fma_f32 v[50:51], v[50:51], v[122:123], s[28:29] op_sel_hi:[1,0,1]
    v_perm_b32 v120, v121, v120, s35
    v_perm_b32 v121, v51, v50, s35
    v_lshl_add_u64 v[120:121], v[120:121], 0, s[30:31]
    ds_add_rtn_u64 v[50:51], v109, v[120:121] offset:50000

    s_mov_b64 exec, -1
    s_waitcnt lgkmcnt(0)
    v_or3_b32 v1, v44, v45, v1
    v_or3_b32 v1, v46, v47, v1
    v_or3_b32 v1, v48, v49, v1
    v_or3_b32 v1, v50, v51, v1
L_nt2_62:
    s_movk_i32 s53, 15360
    buffer_load_dwordx4 v[106:109], v2, s[16:19], s53 offen
    buffer_load_dword v114, v2, s[16:19], s53 offen offset:16
    s_waitcnt lgkmcnt(0)
    v_or3_b32 v1, v68, v69, v1
    v_or3_b32 v1, v70, v71, v1
    v_or3_b32 v1, v72, v73, v1
    v_or3_b32 v1, v74, v75, v1
    s_cmp_le_u32 s40, 3584
    s_cbranch_scc1 L_noleft_65
    s_min_u32 s40, s40, 3968
    s_lshl_b32 s52, s38, 6
    s_add_u32 s52, s52, s36
    s_mul_i32 s52, s52, 19840
    s_add_u32 s20, s44, s52
    s_addc_u32 s21, s45, 0
    s_mul_i32 s52, s40, 5
    s_add_u32 s52, s52, 3
    s_and_b32 s22, s52, -4

    s_lshr_b32 s55, s39, 2
    s_add_u32 s55, s55, 3584
    v_and_b32 v60, 63, v0
    v_add_u32 v60, s55, v60
L_left_66:
    s_cmp_ge_u32 s55, s40
    s_cbranch_scc1 L_leftend_67
    v_mul_u32_u24 v61, 5, v60
    buffer_load_dword v62, v61, s[20:23], 0 offen
    buffer_load_ubyte v63, v61, s[20:23], 0 offen offset:4
    s_waitcnt vmcnt(0)

    v_perm_b32 v61, v63, v62, s24
    v_lshrrev_b32 v66, 30, v62
    v_and_b32 v61, 0x1fff, v61
    v_mul_u32_u24 v66, 6250, v66
    v_add_lshl_u32 v61, v61, v66, 3

    buffer_load_dwordx2 v[64:65], v61, s[8:11], s50 offen
    v_cmp_gt_u32 vcc, s40, v60
    s_waitcnt vmcnt(0)

    s_mov_b64 exec, vcc
    v_and_b32 v62, 0x3fffffff, v62
    v_cvt_f32_i32_sdwa v118, sext(v62) dst_sel:DWORD dst_unused:UNUSED_PAD src0_sel:WORD_0
    v_lshlrev_b32 v116, 16, v64
    v_and_b32 v117, s32, v64
    v_mul_f32 v118, s33, v118
    v_lshlrev_b32 v64, 16, v65
    v_and_b32 v65, s32, v65
    v_lshlrev_b32_sdwa v62, 3, v62 dst_sel:DWORD dst_unused:UNUSED_PAD src0_sel:DWORD src1_sel:WORD_1
    v_pk_fma_f32 v[116:117], v[116:117], v[118:119], s[28:29] op_sel_hi:[1,0,1]
    v_pk_fma_f32 v[64:65], v[64:65], v[118:119], s[28:29] op_sel_hi:[1,0,1]
    v_perm_b32 v116, v117, v116, s35
    v_perm_b32 v117, v65, v64, s35
    v_lshl_add_u64 v[116:117], v[116:117], 0, s[30:31]
    ds_add_rtn_u64 v[64:65], v62, v[116:117] offset:50000

    s_waitcnt lgkmcnt(0)
    v_or3_b32 v1, v64, v65, v1
    s_mov_b64 exec, -1
    v_add_u32 v60, 128, v60
    s_add_u32 s55, s55, 128
    s_branch L_left_66
L_leftend_67:

L_noleft_65:
    s_mov_b32 s38, s5
    s_cmp_lt_u32 s38, s4
    s_cbranch_scc1 L_batch_48
    s_waitcnt vmcnt(0)
    s_barrier

    s_mul_i32 s3, s37, 6400000
    s_mul_i32 s5, s36, 100000
    s_add_u32 s3, s3, s5
    s_add_u32 s3, s3, 1048576

    s_add_u32 s20, s6, s3
    s_addc_u32 s21, s7, 0
    s_mov_b32 s22, 100000
    s_mov_b32 s23, 0x20000
    v_lshlrev_b32 v68, 3, v0
    v_add_u32 v69, 50000, v68
    v_add_u32 v70, 115536, v68
    v_cmp_gt_u32 vcc, 212, v0
    v_mov_b32 v52, 0
    v_mov_b32 v53, 0

    ds_read_b64 v[28:29], v69 offset:0
    ds_read_b64 v[30:31], v69 offset:8192
    ds_read_b64 v[32:33], v69 offset:16384
    ds_read_b64 v[34:35], v69 offset:24576
    ds_read_b64 v[36:37], v69 offset:32768
    ds_read_b64 v[38:39], v69 offset:40960
    ds_read_b64 v[40:41], v69 offset:49152
    ds_read_b64 v[42:43], v69 offset:57344
    ds_read_b64 v[44:45], v70 offset:0
    ds_read_b64 v[46:47], v70 offset:8192
    ds_read_b64 v[48:49], v70 offset:16384
    ds_read_b64 v[50:51], v70 offset:24576
    s_mov_b64 exec, vcc
    ds_read_b64 v[52:53], v70 offset:32768
    s_mov_b64 exec, -1
    s_waitcnt lgkmcnt(12)
    s_mov_b32 s3, 0
    buffer_store_dwordx2 v[28:29], v68, s[20:23], s3 offen
    s_waitcnt lgkmcnt(11)
    s_mov_b32 s3, 8192
    buffer_store_dwordx2 v[30:31], v68, s[20:23], s3 offen
    s_waitcnt lgkmcnt(10)
    s_mov_b32 s3, 16384
    buffer_store_dwordx2 v[32:33], v68, s[20:23], s3 offen
    s_waitcnt lgkmcnt(9)
    s_mov_b32 s3, 24576
    buffer_store_dwordx2 v[34:35], v68, s[20:23], s3 offen
    s_waitcnt lgkmcnt(8)
    s_mov_b32 s3, 32768
    buffer_store_dwordx2 v[36:37], v68, s[20:23], s3 offen
    s_waitcnt lgkmcnt(7)
    s_mov_b32 s3, 40960
    buffer_store_dwordx2 v[38:39], v68, s[20:23], s3 offen
    s_waitcnt lgkmcnt(6)
    s_mov_b32 s3, 49152
    buffer_store_dwordx2 v[40:41], v68, s[20:23], s3 offen
    s_waitcnt lgkmcnt(5)
    s_mov_b32 s3, 57344
    buffer_store_dwordx2 v[42:43], v68, s[20:23], s3 offen
    s_waitcnt lgkmcnt(4)
    s_mov_b32 s3, 65536
    buffer_store_dwordx2 v[44:45], v68, s[20:23], s3 offen
    s_waitcnt lgkmcnt(3)
    s_mov_b32 s3, 73728
    buffer_store_dwordx2 v[46:47], v68, s[20:23], s3 offen
    s_waitcnt lgkmcnt(2)
    s_mov_b32 s3, 81920
    buffer_store_dwordx2 v[48:49], v68, s[20:23], s3 offen
    s_waitcnt lgkmcnt(1)
    s_mov_b32 s3, 90112
    buffer_store_dwordx2 v[50:51], v68, s[20:23], s3 offen
    s_waitcnt lgkmcnt(0)
    s_mov_b32 s3, 98304
    buffer_store_dwordx2 v[52:53], v68, s[20:23], s3 offen
    v_or3_b32 v1, v28, v29, v1
    v_or3_b32 v1, v30, v31, v1
    v_or3_b32 v1, v32, v33, v1
    v_or3_b32 v1, v34, v35, v1
    v_or3_b32 v1, v36, v37, v1
    v_or3_b32 v1, v38, v39, v1
    v_or3_b32 v1, v40, v41, v1
    v_or3_b32 v1, v42, v43, v1
    v_or3_b32 v1, v44, v45, v1
    v_or3_b32 v1, v46, v47, v1
    v_or3_b32 v1, v48, v49, v1
    v_or3_b32 v1, v50, v51, v1
    v_or3_b32 v1, v52, v53, v1
    v_and_b32 v1, 0x80008000, v1
    v_cmp_ne_u32 vcc, 0, v1
    v_mov_b32 v71, 150024
    v_mov_b32 v72, 1
    s_cbranch_vccz L_nf_68
    ds_write_b32 v71, v72
L_nf_68:
    s_waitcnt lgkmcnt(0)
    s_barrier
    ds_read_b32 v72, v71
    s_waitcnt lgkmcnt(0)
    v_readfirstlane_b32 s3, v72
    s_nop 1
    s_cmp_lg_u32 s3, 0
    s_cbranch_scc1 L_p2slow_47

L_fin_69:
    s_add_u32 s20, s6, 147456
    s_addc_u32 s21, s7, 0
    s_mov_b32 s22, 1024
    s_mov_b32 s23, 0x20000
    s_lshl_b32 s3, s36, 2
    s_add_u32 s3, s3, s37
    s_lshl_b32 s3, s3, 2
    v_lshlrev_b32 v73, 20, v0
    v_mov_b32 v74, s34
    buffer_store_dword v74, v73, s[20:23], s3 offen

L_p2done_46:
    s_endpgm

L_ufix_49:
    v_and_b32 v117, 63, v0
    v_lshlrev_b32 v117, 2, v117
    s_sub_i32 s54, s42, 1024
    v_cmp_le_i32 vcc, s54, v117
    s_mov_b64 exec, vcc
    v_mov_b32 v12, 0
    v_mov_b32 v44, 0
    s_mov_b64 exec, -1
    s_sub_i32 s54, s42, 1025
    v_cmp_le_i32 vcc, s54, v117
    s_mov_b64 exec, vcc
    v_mov_b32 v13, 0
    v_mov_b32 v46, 0
    s_mov_b64 exec, -1
    s_sub_i32 s54, s42, 1026
    v_cmp_le_i32 vcc, s54, v117
    s_mov_b64 exec, vcc
    v_mov_b32 v14, 0
    v_mov_b32 v48, 0
    s_mov_b64 exec, -1
    s_sub_i32 s54, s42, 1027
    v_cmp_le_i32 vcc, s54, v117
    s_mov_b64 exec, vcc
    v_mov_b32 v15, 0
    v_mov_b32 v50, 0
    s_mov_b64 exec, -1
    s_branch L_uback_50
L_ufix_51:
    v_and_b32 v117, 63, v0
    v_lshlrev_b32 v117, 2, v117
    s_sub_i32 s54, s42, 1536
    v_cmp_le_i32 vcc, s54, v117
    s_mov_b64 exec, vcc
    v_mov_b32 v16, 0
    v_mov_b32 v52, 0
    s_mov_b64 exec, -1
    s_sub_i32 s54, s42, 1537
    v_cmp_le_i32 vcc, s54, v117
    s_mov_b64 exec, vcc
    v_mov_b32 v17, 0
    v_mov_b32 v54, 0
    s_mov_b64 exec, -1
    s_sub_i32 s54, s42, 1538
    v_cmp_le_i32 vcc, s54, v117
    s_mov_b64 exec, vcc
    v_mov_b32 v18, 0
    v_mov_b32 v56, 0
    s_mov_b64 exec, -1
    s_sub_i32 s54, s42, 1539
    v_cmp_le_i32 vcc, s54, v117
    s_mov_b64 exec, vcc
    v_mov_b32 v19, 0
    v_mov_b32 v58, 0
    s_mov_b64 exec, -1
    s_branch L_uback_52
L_ufix_53:
    v_and_b32 v117, 63, v0
    v_lshlrev_b32 v117, 2, v117
    s_sub_i32 s54, s42, 2048
    v_cmp_le_i32 vcc, s54, v117
    s_mov_b64 exec, vcc
    v_mov_b32 v20, 0
    v_mov_b32 v60, 0
    s_mov_b64 exec, -1
    s_sub_i32 s54, s42, 2049
    v_cmp_le_i32 vcc, s54, v117
    s_mov_b64 exec, vcc
    v_mov_b32 v21, 0
    v_mov_b32 v62, 0
    s_mov_b64 exec, -1
    s_sub_i32 s54, s42, 2050
    v_cmp_le_i32 vcc, s54, v117
    s_mov_b64 exec, vcc
    v_mov_b32 v22, 0
    v_mov_b32 v64, 0
    s_mov_b64 exec, -1
    s_sub_i32 s54, s42, 2051
    v_cmp_le_i32 vcc, s54, v117
    s_mov_b64 exec, vcc
    v_mov_b32 v23, 0
    v_mov_b32 v66, 0
    s_mov_b64 exec, -1
    s_branch L_uback_54
L_ufix_55:
    v_and_b32 v117, 63, v0
    v_lshlrev_b32 v117, 2, v117
    s_sub_i32 s54, s42, 2560
    v_cmp_le_i32 vcc, s54, v117
    s_mov_b64 exec, vcc
    v_mov_b32 v24, 0
    v_mov_b32 v68, 0
    s_mov_b64 exec, -1
    s_sub_i32 s54, s42, 2561
    v_cmp_le_i32 vcc, s54, v117
    s_mov_b64 exec, vcc
    v_mov_b32 v25, 0
    v_mov_b32 v70, 0
    s_mov_b64 exec, -1
    s_sub_i32 s54, s42, 2562
    v_cmp_le_i32 vcc, s54, v117
    s_mov_b64 exec, vcc
    v_mov_b32 v26, 0
    v_mov_b32 v72, 0
    s_mov_b64 exec, -1
    s_sub_i32 s54, s42, 2563
    v_cmp_le_i32 vcc, s54, v117
    s_mov_b64 exec, vcc
    v_mov_b32 v27, 0
    v_mov_b32 v74, 0
    s_mov_b64 exec, -1
    s_branch L_uback_56
L_ufix_57:
    v_and_b32 v117, 63, v0
    v_lshlrev_b32 v117, 2, v117
    s_sub_i32 s54, s42, 0
    v_cmp_le_i32 vcc, s54, v117
    s_mov_b64 exec, vcc
    v_mov_b32 v4, 0
    v_mov_b32 v28, 0
    s_mov_b64 exec, -1
    s_sub_i32 s54, s42, 1
    v_cmp_le_i32 vcc, s54, v117
    s_mov_b64 exec, vcc
    v_mov_b32 v5, 0
    v_mov_b32 v30, 0
    s_mov_b64 exec, -1
    s_sub_i32 s54, s42, 2
    v_cmp_le_i32 vcc, s54, v117
    s_mov_b64 exec, vcc
    v_mov_b32 v6, 0
    v_mov_b32 v32, 0
    s_mov_b64 exec, -1
    s_sub_i32 s54, s42, 3
    v_cmp_le_i32 vcc, s54, v117
    s_mov_b64 exec, vcc
    v_mov_b32 v7, 0
    v_mov_b32 v34, 0
    s_mov_b64 exec, -1
    s_branch L_uback_58
L_ufix_59:
    v_and_b32 v117, 63, v0
    v_lshlrev_b32 v117, 2, v117
    s_sub_i32 s54, s42, 512
    v_cmp_le_i32 vcc, s54, v117
    s_mov_b64 exec, vcc
    v_mov_b32 v8, 0
    v_mov_b32 v36, 0
    s_mov_b64 exec, -1
    s_sub_i32 s54, s42, 513
    v_cmp_le_i32 vcc, s54, v117
    s_mov_b64 exec, vcc
    v_mov_b32 v9, 0
    v_mov_b32 v38, 0
    s_mov_b64 exec, -1
    s_sub_i32 s54, s42, 514
    v_cmp_le_i32 vcc, s54, v117
    s_mov_b64 exec, vcc
    v_mov_b32 v10, 0
    v_mov_b32 v40, 0
    s_mov_b64 exec, -1
    s_sub_i32 s54, s42, 515
    v_cmp_le_i32 vcc, s54, v117
    s_mov_b64 exec, vcc
    v_mov_b32 v11, 0
    v_mov_b32 v42, 0
    s_mov_b64 exec, -1
    s_branch L_uback_60
L_ufix_63:
    v_and_b32 v117, 63, v0
    v_lshlrev_b32 v117, 2, v117
    s_sub_i32 s54, s42, 3072
    v_cmp_le_i32 vcc, s54, v117
    s_mov_b64 exec, vcc
    v_mov_b32 v106, 0
    v_mov_b32 v116, 0
    s_mov_b64 exec, -1
    s_sub_i32 s54, s42, 3073
    v_cmp_le_i32 vcc, s54, v117
    s_mov_b64 exec, vcc
    v_mov_b32 v107, 0
    v_mov_b32 v118, 0
    s_mov_b64 exec, -1
    s_sub_i32 s54, s42, 3074
    v_cmp_le_i32 vcc, s54, v117
    s_mov_b64 exec, vcc
    v_mov_b32 v108, 0
    v_mov_b32 v120, 0
    s_mov_b64 exec, -1
    s_sub_i32 s54, s42, 3075
    v_cmp_le_i32 vcc, s54, v117
    s_mov_b64 exec, vcc
    v_mov_b32 v109, 0
    v_mov_b32 v122, 0
    s_mov_b64 exec, -1
    s_branch L_uback_64
L_p2slow_47:
    s_waitcnt vmcnt(0) lgkmcnt(0)
    s_mov_b32 s51, 0
    s_movk_i32 s43, 6250
    s_mov_b32 s34, 0
L_sweep_70:
    s_barrier

    v_mov_b32 v28, 0x0
    v_mov_b32 v29, 0x0
    v_mov_b32 v30, 0x0
    v_mov_b32 v31, 0x0
    v_add_u32 v32, 50000, v3
    v_add_u32 v33, 65536, v32

    ds_write_b128 v32, v[28:31] offset:0
    ds_write_b128 v32, v[28:31] offset:16384
    ds_write_b128 v32, v[28:31] offset:32768
    ds_write_b128 v32, v[28:31] offset:49152
    ds_write_b128 v33, v[28:31] offset:0
    ds_write_b128 v33, v[28:31] offset:16384
    v_cmp_gt_u32 vcc, 971, v0
    s_mov_b64 exec, vcc
    ds_write_b128 v33, v[28:31] offset:32768
    s_mov_b64 exec, -1
    s_waitcnt lgkmcnt(0)
    s_barrier
    s_sub_u32 s38, s4, 8
L_sbatch_71:
    s_lshl_b32 s52, s38, 6
    s_add_u32 s52, s52, s36
    s_lshl_b32 s52, s52, 2
    s_load_dword s40, s[46:47], s52
    s_mul_i32 s50, s38, 200000
    s_waitcnt lgkmcnt(0)

    s_min_u32 s40, s40, 3968
    s_lshl_b32 s52, s38, 6
    s_add_u32 s52, s52, s36
    s_mul_i32 s52, s52, 19840
    s_add_u32 s20, s44, s52
    s_addc_u32 s21, s45, 0
    s_mul_i32 s52, s40, 5
    s_add_u32 s52, s52, 3
    s_and_b32 s22, s52, -4

    s_lshr_b32 s55, s39, 2
    s_add_u32 s55, s55, 0
    v_and_b32 v36, 63, v0
    v_add_u32 v36, s55, v36
L_left_75:
    s_cmp_ge_u32 s55, s40
    s_cbranch_scc1 L_leftend_76
    v_mul_u32_u24 v37, 5, v36
    buffer_load_dword v38, v37, s[20:23], 0 offen
    buffer_load_ubyte v39, v37, s[20:23], 0 offen offset:4
    s_waitcnt vmcnt(0)

    v_perm_b32 v37, v39, v38, s24
    v_lshrrev_b32 v42, 30, v38
    v_and_b32 v37, 0x1fff, v37
    v_mul_u32_u24 v42, 6250, v42
    v_add_lshl_u32 v37, v37, v42, 3

    buffer_load_dwordx2 v[40:41], v37, s[8:11], s50 offen
    v_cmp_gt_u32 vcc, s40, v36
    s_waitcnt vmcnt(0)

    v_bfe_u32 v44, v38, 16, 14
    v_subrev_u32 v44, s51, v44
    v_cmp_gt_u32 s[64:65], s43, v44
    s_and_b64 exec, vcc, s[64:65]
    v_lshlrev_b32 v45, 8, v38
    v_cmpx_ne_u32 vcc, 0, v45
    v_lshlrev_b32 v44, 4, v44
    v_bfe_i32 v38, v38, 0, 16
    v_cvt_f32_i32 v38, v38
    v_mul_f32 v38, 0x38004020, v38
    v_lshlrev_b32 v45, 16, v40
    v_and_b32 v46, s32, v40
    v_lshlrev_b32 v47, 16, v41
    v_and_b32 v48, s32, v41

    v_mul_f32 v45, v45, v38
    ds_add_f32 v44, v45 offset:50000
    v_mul_f32 v46, v46, v38
    ds_add_f32 v44, v46 offset:50004
    v_mul_f32 v47, v47, v38
    ds_add_f32 v44, v47 offset:50008
    v_mul_f32 v48, v48, v38
    ds_add_f32 v44, v48 offset:50012
    s_mov_b64 exec, -1
    v_add_u32 v36, 128, v36
    s_add_u32 s55, s55, 128
    s_branch L_left_75
L_leftend_76:

    s_add_u32 s38, s38, 1
    s_cmp_lt_u32 s38, s4
    s_cbranch_scc1 L_sbatch_71
    s_mov_b32 s3, 65536
    s_load_dword s40, s[6:7], s3

    s_add_u32 s20, s6, 402907136
    s_addc_u32 s21, s7, 0
    s_mov_b32 s22, 409600000
    s_mov_b32 s23, 0x20000
    s_mov_b32 s38, 0
    s_mov_b32 s50, 200000
    v_mov_b32 v36, v0
    s_waitcnt lgkmcnt(0)
L_ovf_72:
    s_cmp_ge_u32 s38, s40
    s_cbranch_scc1 L_ovfend_73
    v_lshlrev_b32 v37, 3, v36
    buffer_load_dwordx2 v[38:39], v37, s[20:23], 0 offen
    s_waitcnt vmcnt(0)

    v_perm_b32 v37, v39, v38, s24
    v_lshrrev_b32 v42, 30, v38
    v_and_b32 v37, 0x1fff, v37
    v_mul_u32_u24 v42, 6250, v42
    v_add_lshl_u32 v37, v37, v42, 3

    v_bfe_u32 v42, v39, 24, 5
    v_mad_u32_u24 v37, v42, s50, v37
    buffer_load_dwordx2 v[40:41], v37, s[8:11], 0 offen
    v_lshrrev_b32 v42, 3, v42
    v_bfe_u32 v43, v39, 18, 6
    v_cmp_gt_u32 vcc, s40, v36
    v_cmp_eq_u32 s[64:65], s36, v43
    s_and_b64 vcc, vcc, s[64:65]
    v_cmp_eq_u32 s[64:65], s37, v42
    s_and_b64 vcc, vcc, s[64:65]
    s_waitcnt vmcnt(0)

    v_bfe_u32 v44, v38, 16, 14
    v_subrev_u32 v44, s51, v44
    v_cmp_gt_u32 s[64:65], s43, v44
    s_and_b64 exec, vcc, s[64:65]
    v_lshlrev_b32 v45, 8, v38
    v_cmpx_ne_u32 vcc, 0, v45
    v_lshlrev_b32 v44, 4, v44
    v_bfe_i32 v38, v38, 0, 16
    v_cvt_f32_i32 v38, v38
    v_mul_f32 v38, 0x38004020, v38
    v_lshlrev_b32 v45, 16, v40
    v_and_b32 v46, s32, v40
    v_lshlrev_b32 v47, 16, v41
    v_and_b32 v48, s32, v41

    v_mul_f32 v45, v45, v38
    ds_add_f32 v44, v45 offset:50000
    v_mul_f32 v46, v46, v38
    ds_add_f32 v44, v46 offset:50004
    v_mul_f32 v47, v47, v38
    ds_add_f32 v44, v47 offset:50008
    v_mul_f32 v48, v48, v38
    ds_add_f32 v44, v48 offset:50012
    s_mov_b64 exec, -1
    v_add_u32 v36, 1024, v36
    s_add_u32 s38, s38, 1024
    s_branch L_ovf_72
L_ovfend_73:
    s_waitcnt lgkmcnt(0)
    s_barrier
    s_mul_i32 s3, s37, 800000
    s_mul_i32 s5, s36, 12500
    s_add_u32 s3, s3, s5
    s_add_u32 s3, s3, s51
    s_lshl_b32 s3, s3, 4
    s_add_u32 s3, s3, 26648576

    s_add_u32 s20, s6, s3
    s_addc_u32 s21, s7, 0
    s_mov_b32 s22, 100000
    s_mov_b32 s23, 0x20000
    v_mov_b32 v36, v3
    s_mov_b32 s38, 0
L_wl_74:
    v_min_u32 v37, 100000, v36
    ds_read_b128 v[28:31], v37 offset:50000
    s_waitcnt lgkmcnt(0)
    buffer_store_dwordx4 v[28:31], v36, s[20:23], 0 offen
    s_waitcnt vmcnt(0)
    v_add_u32 v36, 16384, v36
    s_add_u32 s38, s38, 1024
    s_cmp_lt_u32 s38, 6250
    s_cbranch_scc1 L_wl_74
    s_add_u32 s51, s51, 6250
    s_cmp_lt_u32 s51, 12500
    s_cbranch_scc1 L_sweep_70
    s_branch L_fin_69

.globl standalone__molecular_angular_gemnet__graph_kernel
.p2align 8
.type standalone__molecular_angular_gemnet__graph_kernel,@function
standalone__molecular_angular_gemnet__graph_kernel:
    s_cmp_ge_u32 s2, 3200
    s_cbranch_scc1 L_fdone_77
    s_load_dwordx2 s[4:5], s[0:1], 0
    s_load_dwordx2 s[6:7], s[0:1], 24
    s_load_dwordx2 s[8:9], s[0:1], 40
    s_load_dwordx8 s[12:19], s[0:1], 56
    s_load_dwordx2 s[10:11], s[0:1], 88
    s_load_dwordx2 s[20:21], s[0:1], 104
    v_cmp_gt_u32 vcc, 250, v0
    s_mul_i32 s3, s2, 250
    v_add_u32 v0, s3, v0
    v_lshlrev_b32 v1, 4, v0
    v_lshlrev_b32 v2, 3, v0
    v_lshlrev_b32 v3, 1, v0
    s_mov_b64 exec, vcc
    s_mul_hi_u32 s3, s2, 85899346
    s_lshl_b32 s3, s3, 4
    s_add_u32 s3, s3, 147456
    s_waitcnt lgkmcnt(0)
    s_load_dwordx4 s[96:99], s[20:21], s3
    s_load_dwordx4 s[40:43], s[8:9], 0
    s_load_dwordx16 s[44:59], s[12:13], 0
    s_load_dwordx16 s[60:75], s[14:15], 0
    s_load_dwordx8 s[76:83], s[16:17], 0
    s_load_dwordx8 s[84:91], s[18:19], 0

    s_add_u32 s24, s20, 1048576
    s_addc_u32 s25, s21, 0
    s_mov_b32 s26, 76800000
    s_mov_b32 s27, 0x20000
    s_mov_b32 s28, s4
    s_mov_b32 s29, s5
    s_mov_b32 s30, 6400000
    s_mov_b32 s31, 0x20000
    s_mov_b32 s32, s6
    s_mov_b32 s33, s7
    s_mov_b32 s34, 1600000
    s_mov_b32 s35, 0x20000
    s_mov_b32 s36, s10
    s_mov_b32 s37, s11
    s_mov_b32 s38, 6400000
    s_mov_b32 s39, 0x20000
    buffer_load_ushort v4, v3, s[32:35], 0 offen
    buffer_load_dwordx2 v[32:33], v2, s[24:27], 0 offen
    s_mov_b32 s3, 6400000
    buffer_load_dwordx2 v[34:35], v2, s[24:27], s3 offen
    s_mov_b32 s3, 12800000
    buffer_load_dwordx2 v[36:37], v2, s[24:27], s3 offen
    s_mov_b32 s3, 19200000
    buffer_load_dwordx2 v[38:39], v2, s[24:27], s3 offen
    buffer_load_dwordx2 v[6:7], v2, s[28:31], 0 offen
    s_mov_b32 s94, 0xffff0000
    s_mov_b32 s95, 0xc1200000
    s_mov_b32 s22, 0x3fb8aa3b
    s_waitcnt vmcnt(5) lgkmcnt(0)
    v_lshlrev_b32 v4, 16, v4

    s_lshl_b32 s92, s40, 16
    v_subrev_f32 v16, s92, v4
    s_and_b32 s93, s40, s94
    v_subrev_f32 v17, s93, v4
    s_lshl_b32 s92, s41, 16
    v_subrev_f32 v18, s92, v4
    s_and_b32 s93, s41, s94
    v_subrev_f32 v19, s93, v4
    s_lshl_b32 s92, s42, 16
    v_subrev_f32 v20, s92, v4
    s_and_b32 s93, s42, s94
    v_subrev_f32 v21, s93, v4
    s_lshl_b32 s92, s43, 16
    v_subrev_f32 v22, s92, v4
    s_and_b32 s93, s43, s94
    v_subrev_f32 v23, s93, v4
    v_cvt_pk_bf16_f32 v16, v16, v17
    v_and_b32 v17, s94, v16
    v_lshlrev_b32 v16, 16, v16
    v_cvt_pk_bf16_f32 v18, v18, v19
    v_and_b32 v19, s94, v18
    v_lshlrev_b32 v18, 16, v18
    v_cvt_pk_bf16_f32 v20, v20, v21
    v_and_b32 v21, s94, v20
    v_lshlrev_b32 v20, 16, v20
    v_cvt_pk_bf16_f32 v22, v22, v23
    v_and_b32 v23, s94, v22
    v_lshlrev_b32 v22, 16, v22
    v_mul_f32 v16, v16, v16
    v_mul_f32 v17, v17, v17
    v_mul_f32 v18, v18, v18
    v_mul_f32 v19, v19, v19
    v_mul_f32 v20, v20, v20
    v_mul_f32 v21, v21, v21
    v_mul_f32 v22, v22, v22
    v_mul_f32 v23, v23, v23
    v_cvt_pk_bf16_f32 v16, v16, v17
    v_and_b32 v17, s94, v16
    v_lshlrev_b32 v16, 16, v16
    v_cvt_pk_bf16_f32 v18, v18, v19
    v_and_b32 v19, s94, v18
    v_lshlrev_b32 v18, 16, v18
    v_cvt_pk_bf16_f32 v20, v20, v21
    v_and_b32 v21, s94, v20
    v_lshlrev_b32 v20, 16, v20
    v_cvt_pk_bf16_f32 v22, v22, v23
    v_and_b32 v23, s94, v22
    v_lshlrev_b32 v22, 16, v22
    v_mul_f32 v16, s95, v16
    v_mul_f32 v17, s95, v17
    v_mul_f32 v18, s95, v18
    v_mul_f32 v19, s95, v19
    v_mul_f32 v20, s95, v20
    v_mul_f32 v21, s95, v21
    v_mul_f32 v22, s95, v22
    v_mul_f32 v23, s95, v23
    v_cvt_pk_bf16_f32 v16, v16, v17
    v_and_b32 v17, s94, v16
    v_lshlrev_b32 v16, 16, v16
    v_cvt_pk_bf16_f32 v18, v18, v19
    v_and_b32 v19, s94, v18
    v_lshlrev_b32 v18, 16, v18
    v_cvt_pk_bf16_f32 v20, v20, v21
    v_and_b32 v21, s94, v20
    v_lshlrev_b32 v20, 16, v20
    v_cvt_pk_bf16_f32 v22, v22, v23
    v_and_b32 v23, s94, v22
    v_lshlrev_b32 v22, 16, v22
    v_mul_f32 v16, s22, v16
    v_mul_f32 v17, s22, v17
    v_mul_f32 v18, s22, v18
    v_mul_f32 v19, s22, v19
    v_mul_f32 v20, s22, v20
    v_mul_f32 v21, s22, v21
    v_mul_f32 v22, s22, v22
    v_mul_f32 v23, s22, v23
    v_exp_f32 v16, v16
    v_exp_f32 v17, v17
    v_exp_f32 v18, v18
    v_exp_f32 v19, v19
    v_exp_f32 v20, v20
    v_exp_f32 v21, v21
    v_exp_f32 v22, v22
    v_exp_f32 v23, v23
    s_nop 0
    v_cvt_pk_bf16_f32 v16, v16, v17
    v_and_b32 v17, s94, v16
    v_lshlrev_b32 v16, 16, v16
    v_cvt_pk_bf16_f32 v18, v18, v19
    v_and_b32 v19, s94, v18
    v_lshlrev_b32 v18, 16, v18
    v_cvt_pk_bf16_f32 v20, v20, v21
    v_and_b32 v21, s94, v20
    v_lshlrev_b32 v20, 16, v20
    v_cvt_pk_bf16_f32 v22, v22, v23
    v_and_b32 v23, s94, v22
    v_lshlrev_b32 v22, 16, v22
    s_lshl_b32 s92, s60, 16
    v_mul_f32 v24, s92, v16
    s_and_b32 s93, s60, s94
    v_mul_f32 v25, s93, v16
    s_lshl_b32 s92, s61, 16
    v_mul_f32 v26, s92, v16
    s_and_b32 s93, s61, s94
    v_mul_f32 v27, s93, v16
    s_lshl_b32 s92, s62, 16
    v_fmac_f32 v24, s92, v17
    s_and_b32 s93, s62, s94
    v_fmac_f32 v25, s93, v17
    s_lshl_b32 s92, s63, 16
    v_fmac_f32 v26, s92, v17
    s_and_b32 s93, s63, s94
    v_fmac_f32 v27, s93, v17
    s_lshl_b32 s92, s64, 16
    v_fmac_f32 v24, s92, v18
    s_and_b32 s93, s64, s94
    v_fmac_f32 v25, s93, v18
    s_lshl_b32 s92, s65, 16
    v_fmac_f32 v26, s92, v18
    s_and_b32 s93, s65, s94
    v_fmac_f32 v27, s93, v18
    s_lshl_b32 s92, s66, 16
    v_fmac_f32 v24, s92, v19
    s_and_b32 s93, s66, s94
    v_fmac_f32 v25, s93, v19
    s_lshl_b32 s92, s67, 16
    v_fmac_f32 v26, s92, v19
    s_and_b32 s93, s67, s94
    v_fmac_f32 v27, s93, v19
    s_lshl_b32 s92, s68, 16
    v_fmac_f32 v24, s92, v20
    s_and_b32 s93, s68, s94
    v_fmac_f32 v25, s93, v20
    s_lshl_b32 s92, s69, 16
    v_fmac_f32 v26, s92, v20
    s_and_b32 s93, s69, s94
    v_fmac_f32 v27, s93, v20
    s_lshl_b32 s92, s70, 16
    v_fmac_f32 v24, s92, v21
    s_and_b32 s93, s70, s94
    v_fmac_f32 v25, s93, v21
    s_lshl_b32 s92, s71, 16
    v_fmac_f32 v26, s92, v21
    s_and_b32 s93, s71, s94
    v_fmac_f32 v27, s93, v21
    s_lshl_b32 s92, s72, 16
    v_fmac_f32 v24, s92, v22
    s_and_b32 s93, s72, s94
    v_fmac_f32 v25, s93, v22
    s_lshl_b32 s92, s73, 16
    v_fmac_f32 v26, s92, v22
    s_and_b32 s93, s73, s94
    v_fmac_f32 v27, s93, v22
    s_lshl_b32 s92, s74, 16
    v_fmac_f32 v24, s92, v23
    s_and_b32 s93, s74, s94
    v_fmac_f32 v25, s93, v23
    s_lshl_b32 s92, s75, 16
    v_fmac_f32 v26, s92, v23
    s_and_b32 s93, s75, s94
    v_fmac_f32 v27, s93, v23
    s_lshl_b32 s92, s44, 16
    v_mul_f32 v28, s92, v16
    s_and_b32 s93, s44, s94
    v_mul_f32 v29, s93, v16
    s_lshl_b32 s92, s45, 16
    v_mul_f32 v30, s92, v16
    s_and_b32 s93, s45, s94
    v_mul_f32 v31, s93, v16
    s_lshl_b32 s92, s46, 16
    v_fmac_f32 v28, s92, v17
    s_and_b32 s93, s46, s94
    v_fmac_f32 v29, s93, v17
    s_lshl_b32 s92, s47, 16
    v_fmac_f32 v30, s92, v17
    s_and_b32 s93, s47, s94
    v_fmac_f32 v31, s93, v17
    s_lshl_b32 s92, s48, 16
    v_fmac_f32 v28, s92, v18
    s_and_b32 s93, s48, s94
    v_fmac_f32 v29, s93, v18
    s_lshl_b32 s92, s49, 16
    v_fmac_f32 v30, s92, v18
    s_and_b32 s93, s49, s94
    v_fmac_f32 v31, s93, v18
    s_lshl_b32 s92, s50, 16
    v_fmac_f32 v28, s92, v19
    s_and_b32 s93, s50, s94
    v_fmac_f32 v29, s93, v19
    s_lshl_b32 s92, s51, 16
    v_fmac_f32 v30, s92, v19
    s_and_b32 s93, s51, s94
    v_fmac_f32 v31, s93, v19
    s_lshl_b32 s92, s52, 16
    v_fmac_f32 v28, s92, v20
    s_and_b32 s93, s52, s94
    v_fmac_f32 v29, s93, v20
    s_lshl_b32 s92, s53, 16
    v_fmac_f32 v30, s92, v20
    s_and_b32 s93, s53, s94
    v_fmac_f32 v31, s93, v20
    s_lshl_b32 s92, s54, 16
    v_fmac_f32 v28, s92, v21
    s_and_b32 s93, s54, s94
    v_fmac_f32 v29, s93, v21
    s_lshl_b32 s92, s55, 16
    v_fmac_f32 v30, s92, v21
    s_and_b32 s93, s55, s94
    v_fmac_f32 v31, s93, v21
    s_lshl_b32 s92, s56, 16
    v_fmac_f32 v28, s92, v22
    s_and_b32 s93, s56, s94
    v_fmac_f32 v29, s93, v22
    s_lshl_b32 s92, s57, 16
    v_fmac_f32 v30, s92, v22
    s_and_b32 s93, s57, s94
    v_fmac_f32 v31, s93, v22
    s_lshl_b32 s92, s58, 16
    v_fmac_f32 v28, s92, v23
    s_and_b32 s93, s58, s94
    v_fmac_f32 v29, s93, v23
    s_lshl_b32 s92, s59, 16
    v_fmac_f32 v30, s92, v23
    s_and_b32 s93, s59, s94
    v_fmac_f32 v31, s93, v23
    v_cvt_pk_bf16_f32 v28, v28, v29
    v_and_b32 v29, s94, v28
    v_lshlrev_b32 v28, 16, v28
    v_cvt_pk_bf16_f32 v30, v30, v31
    v_and_b32 v31, s94, v30
    v_lshlrev_b32 v30, 16, v30
    s_waitcnt vmcnt(1)
    v_mov_b32 v8, 0
    v_mov_b32 v9, 0
    v_mov_b32 v10, 0
    v_mov_b32 v11, 0
    s_cmp_eq_u32 s96, 0
    s_cbranch_scc1 L_ffl_78
    v_cvt_f32_u32_sdwa v12, v32 dst_sel:DWORD dst_unused:UNUSED_PAD src0_sel:WORD_0
    v_cvt_f32_u32_sdwa v13, v32 dst_sel:DWORD dst_unused:UNUSED_PAD src0_sel:WORD_1
    v_cvt_f32_u32_sdwa v14, v33 dst_sel:DWORD dst_unused:UNUSED_PAD src0_sel:WORD_0
    v_cvt_f32_u32_sdwa v15, v33 dst_sel:DWORD dst_unused:UNUSED_PAD src0_sel:WORD_1
    v_add_f32 v12, 0xc6800000, v12
    v_add_f32 v13, 0xc6800000, v13
    v_add_f32 v14, 0xc6800000, v14
    v_add_f32 v15, 0xc6800000, v15
    v_fmac_f32 v8, s96, v12
    v_fmac_f32 v9, s96, v13
    v_fmac_f32 v10, s96, v14
    v_fmac_f32 v11, s96, v15
L_fbk_79:
    s_cmp_eq_u32 s97, 0
    s_cbranch_scc1 L_ffl_80
    v_cvt_f32_u32_sdwa v12, v34 dst_sel:DWORD dst_unused:UNUSED_PAD src0_sel:WORD_0
    v_cvt_f32_u32_sdwa v13, v34 dst_sel:DWORD dst_unused:UNUSED_PAD src0_sel:WORD_1
    v_cvt_f32_u32_sdwa v14, v35 dst_sel:DWORD dst_unused:UNUSED_PAD src0_sel:WORD_0
    v_cvt_f32_u32_sdwa v15, v35 dst_sel:DWORD dst_unused:UNUSED_PAD src0_sel:WORD_1
    v_add_f32 v12, 0xc6800000, v12
    v_add_f32 v13, 0xc6800000, v13
    v_add_f32 v14, 0xc6800000, v14
    v_add_f32 v15, 0xc6800000, v15
    v_fmac_f32 v8, s97, v12
    v_fmac_f32 v9, s97, v13
    v_fmac_f32 v10, s97, v14
    v_fmac_f32 v11, s97, v15
L_fbk_81:
    s_cmp_eq_u32 s98, 0
    s_cbranch_scc1 L_ffl_82
    v_cvt_f32_u32_sdwa v12, v36 dst_sel:DWORD dst_unused:UNUSED_PAD src0_sel:WORD_0
    v_cvt_f32_u32_sdwa v13, v36 dst_sel:DWORD dst_unused:UNUSED_PAD src0_sel:WORD_1
    v_cvt_f32_u32_sdwa v14, v37 dst_sel:DWORD dst_unused:UNUSED_PAD src0_sel:WORD_0
    v_cvt_f32_u32_sdwa v15, v37 dst_sel:DWORD dst_unused:UNUSED_PAD src0_sel:WORD_1
    v_add_f32 v12, 0xc6800000, v12
    v_add_f32 v13, 0xc6800000, v13
    v_add_f32 v14, 0xc6800000, v14
    v_add_f32 v15, 0xc6800000, v15
    v_fmac_f32 v8, s98, v12
    v_fmac_f32 v9, s98, v13
    v_fmac_f32 v10, s98, v14
    v_fmac_f32 v11, s98, v15
L_fbk_83:
    s_cmp_eq_u32 s99, 0
    s_cbranch_scc1 L_ffl_84
    v_cvt_f32_u32_sdwa v12, v38 dst_sel:DWORD dst_unused:UNUSED_PAD src0_sel:WORD_0
    v_cvt_f32_u32_sdwa v13, v38 dst_sel:DWORD dst_unused:UNUSED_PAD src0_sel:WORD_1
    v_cvt_f32_u32_sdwa v14, v39 dst_sel:DWORD dst_unused:UNUSED_PAD src0_sel:WORD_0
    v_cvt_f32_u32_sdwa v15, v39 dst_sel:DWORD dst_unused:UNUSED_PAD src0_sel:WORD_1
    v_add_f32 v12, 0xc6800000, v12
    v_add_f32 v13, 0xc6800000, v13
    v_add_f32 v14, 0xc6800000, v14
    v_add_f32 v15, 0xc6800000, v15
    v_fmac_f32 v8, s99, v12
    v_fmac_f32 v9, s99, v13
    v_fmac_f32 v10, s99, v14
    v_fmac_f32 v11, s99, v15
L_fbk_85:
    s_lshl_b32 s92, s76, 16
    v_mul_f32 v16, s92, v8
    s_and_b32 s93, s76, s94
    v_mul_f32 v17, s93, v8
    s_lshl_b32 s92, s77, 16
    v_mul_f32 v18, s92, v8
    s_and_b32 s93, s77, s94
    v_mul_f32 v19, s93, v8
    s_lshl_b32 s92, s78, 16
    v_fmac_f32 v16, s92, v9
    s_and_b32 s93, s78, s94
    v_fmac_f32 v17, s93, v9
    s_lshl_b32 s92, s79, 16
    v_fmac_f32 v18, s92, v9
    s_and_b32 s93, s79, s94
    v_fmac_f32 v19, s93, v9
    s_lshl_b32 s92, s80, 16
    v_fmac_f32 v16, s92, v10
    s_and_b32 s93, s80, s94
    v_fmac_f32 v17, s93, v10
    s_lshl_b32 s92, s81, 16
    v_fmac_f32 v18, s92, v10
    s_and_b32 s93, s81, s94
    v_fmac_f32 v19, s93, v10
    s_lshl_b32 s92, s82, 16
    v_fmac_f32 v16, s92, v11
    s_and_b32 s93, s82, s94
    v_fmac_f32 v17, s93, v11
    s_lshl_b32 s92, s83, 16
    v_fmac_f32 v18, s92, v11
    s_and_b32 s93, s83, s94
    v_fmac_f32 v19, s93, v11
    v_mul_f32 v16, v16, v24
    v_mul_f32 v17, v17, v25
    v_mul_f32 v18, v18, v26
    v_mul_f32 v19, v19, v27
    v_cvt_pk_bf16_f32 v16, v16, v17
    v_and_b32 v17, s94, v16
    v_lshlrev_b32 v16, 16, v16
    v_cvt_pk_bf16_f32 v18, v18, v19
    v_and_b32 v19, s94, v18
    v_lshlrev_b32 v18, 16, v18
    s_lshl_b32 s92, s84, 16
    v_mul_f32 v20, s92, v16
    s_and_b32 s93, s84, s94
    v_mul_f32 v21, s93, v16
    s_lshl_b32 s92, s85, 16
    v_mul_f32 v22, s92, v16
    s_and_b32 s93, s85, s94
    v_mul_f32 v23, s93, v16
    s_lshl_b32 s92, s86, 16
    v_fmac_f32 v20, s92, v17
    s_and_b32 s93, s86, s94
    v_fmac_f32 v21, s93, v17
    s_lshl_b32 s92, s87, 16
    v_fmac_f32 v22, s92, v17
    s_and_b32 s93, s87, s94
    v_fmac_f32 v23, s93, v17
    s_lshl_b32 s92, s88, 16
    v_fmac_f32 v20, s92, v18
    s_and_b32 s93, s88, s94
    v_fmac_f32 v21, s93, v18
    s_lshl_b32 s92, s89, 16
    v_fmac_f32 v22, s92, v18
    s_and_b32 s93, s89, s94
    v_fmac_f32 v23, s93, v18
    s_lshl_b32 s92, s90, 16
    v_fmac_f32 v20, s92, v19
    s_and_b32 s93, s90, s94
    v_fmac_f32 v21, s93, v19
    s_lshl_b32 s92, s91, 16
    v_fmac_f32 v22, s92, v19
    s_and_b32 s93, s91, s94
    v_fmac_f32 v23, s93, v19
    v_cvt_pk_bf16_f32 v20, v20, v21
    v_and_b32 v21, s94, v20
    v_lshlrev_b32 v20, 16, v20
    v_cvt_pk_bf16_f32 v22, v22, v23
    v_and_b32 v23, s94, v22
    v_lshlrev_b32 v22, 16, v22
    v_mul_f32 v20, v20, v28
    v_mul_f32 v21, v21, v29
    v_mul_f32 v22, v22, v30
    v_mul_f32 v23, v23, v31
    v_cvt_pk_bf16_f32 v20, v20, v21
    v_and_b32 v21, s94, v20
    v_lshlrev_b32 v20, 16, v20
    v_cvt_pk_bf16_f32 v22, v22, v23
    v_and_b32 v23, s94, v22
    v_lshlrev_b32 v22, 16, v22
    s_waitcnt vmcnt(0)
    v_lshlrev_b32 v8, 16, v6
    v_and_b32 v9, s94, v6
    v_lshlrev_b32 v10, 16, v7
    v_and_b32 v11, s94, v7

    v_add_f32 v8, v8, v20
    v_add_f32 v9, v9, v21
    v_add_f32 v10, v10, v22
    v_add_f32 v11, v11, v23
    v_cvt_pk_bf16_f32 v12, v8, v9
    v_cvt_pk_bf16_f32 v13, v10, v11
    buffer_store_dwordx2 v[12:13], v2, s[36:39], 0 offen
L_fdone_77:
    s_endpgm

L_ffl_78:
    s_mov_b32 s3, 25600000
    buffer_load_dwordx4 v[12:15], v1, s[24:27], s3 offen
    s_waitcnt vmcnt(0)
    v_add_f32 v8, v8, v12
    v_add_f32 v9, v9, v13
    v_add_f32 v10, v10, v14
    v_add_f32 v11, v11, v15
    s_branch L_fbk_79

L_ffl_80:
    s_mov_b32 s3, 38400000
    buffer_load_dwordx4 v[12:15], v1, s[24:27], s3 offen
    s_waitcnt vmcnt(0)
    v_add_f32 v8, v8, v12
    v_add_f32 v9, v9, v13
    v_add_f32 v10, v10, v14
    v_add_f32 v11, v11, v15
    s_branch L_fbk_81

L_ffl_82:
    s_mov_b32 s3, 51200000
    buffer_load_dwordx4 v[12:15], v1, s[24:27], s3 offen
    s_waitcnt vmcnt(0)
    v_add_f32 v8, v8, v12
    v_add_f32 v9, v9, v13
    v_add_f32 v10, v10, v14
    v_add_f32 v11, v11, v15
    s_branch L_fbk_83

L_ffl_84:
    s_mov_b32 s3, 64000000
    buffer_load_dwordx4 v[12:15], v1, s[24:27], s3 offen
    s_waitcnt vmcnt(0)
    v_add_f32 v8, v8, v12
    v_add_f32 v9, v9, v13
    v_add_f32 v10, v10, v14
    v_add_f32 v11, v11, v15
    s_branch L_fbk_85

.section .rodata,"a"
.p2align 6
.amdhsa_kernel g1_kernel
  .amdhsa_next_free_vgpr 128
  .amdhsa_next_free_sgpr 102
  .amdhsa_accum_offset 128
  .amdhsa_group_segment_fixed_size 0
  .amdhsa_kernarg_size 112
  .amdhsa_user_sgpr_count 2
  .amdhsa_user_sgpr_kernarg_segment_ptr 1
  .amdhsa_system_sgpr_workgroup_id_x 1
.end_amdhsa_kernel
.p2align 6
.amdhsa_kernel g2_kernel
  .amdhsa_next_free_vgpr 128
  .amdhsa_next_free_sgpr 102
  .amdhsa_accum_offset 128
  .amdhsa_group_segment_fixed_size 0
  .amdhsa_kernarg_size 112
  .amdhsa_user_sgpr_count 2
  .amdhsa_user_sgpr_kernarg_segment_ptr 1
  .amdhsa_system_sgpr_workgroup_id_x 1
  .amdhsa_float_denorm_mode_32 3
.end_amdhsa_kernel
.p2align 6
.amdhsa_kernel standalone__molecular_angular_gemnet__graph_kernel
  .amdhsa_next_free_vgpr 40
  .amdhsa_next_free_sgpr 100
  .amdhsa_accum_offset 40
  .amdhsa_group_segment_fixed_size 0
  .amdhsa_kernarg_size 112
  .amdhsa_user_sgpr_count 2
  .amdhsa_user_sgpr_kernarg_segment_ptr 1
  .amdhsa_system_sgpr_workgroup_id_x 1
  .amdhsa_float_denorm_mode_32 3
.end_amdhsa_kernel
```

```asm
; @launch kernel=g1_kernel grid=(256,1,1) block=(1024,1,1) lds=163840
; @launch kernel=g2_kernel grid=(256,1,1) block=(1024,1,1) lds=163840
; @launch kernel=standalone__molecular_angular_gemnet__graph_kernel grid=(3200,1,1) block=(256,1,1) lds=0
.amdgcn_target "amdgcn-amd-amdhsa--gfx950"
.text
.globl g1_kernel
.p2align 8
.type g1_kernel,@function
g1_kernel:
    s_cmp_ge_u32 s2, 256
    s_cbranch_scc1 L_p1done_1
    s_load_dwordx4 s[80:83], s[0:1], 8
    s_load_dwordx2 s[84:85], s[0:1], 32
    s_load_dwordx2 s[86:87], s[0:1], 48
    s_load_dwordx4 s[4:7], s[0:1], 96
    s_load_dwordx2 s[78:79], s[0:1], 0
    v_lshlrev_b32 v1, 4, v0
    v_lshlrev_b32 v2, 3, v0
    v_lshlrev_b32 v98, 20, v0
    s_mul_i32 s3, s2, 25000
    s_waitcnt lgkmcnt(0)
    s_load_dword s88, s[86:87], 0

    s_mov_b32 s96, s4
    s_mov_b32 s97, s5
    s_mov_b32 s98, 256
    s_mov_b32 s99, 0x20000
    v_readfirstlane_b32 s74, v0
    s_nop 1
    s_or_b32 s74, s74, s2
    s_cbranch_scc1 L_noinit_2

    v_mov_b32 v110, 1
    buffer_atomic_add v110, v98, s[96:99], 0 offen offset:64 sc0
    s_waitcnt vmcnt(0)
    v_readfirstlane_b32 s74, v110
    s_nop 1
    s_cmp_lg_u32 s74, 0
    s_cbranch_scc1 L_zno_4

    s_mov_b32 s92, s6
    s_mov_b32 s93, s7
    s_mov_b32 s94, 65552
    s_mov_b32 s95, 0x20000
    v_mov_b32 v110, 0
    v_mov_b32 v111, 0
    v_mov_b32 v112, 0
    v_mov_b32 v113, 0
L_zl_3:
    buffer_store_dwordx4 v[110:113], v1, s[92:95], s74 offen sc0 sc1
    s_add_u32 s74, s74, 1024
    s_cmp_le_u32 s74, 65536
    s_cbranch_scc1 L_zl_3
    v_mov_b32 v114, 1
    s_waitcnt vmcnt(0)
    buffer_atomic_add v114, v98, s[96:99], 0 offen offset:128
L_zno_4:

L_noinit_2:
    s_add_u32 s20, s78, s3
    s_addc_u32 s21, s79, 0
    s_mov_b32 s22, 25000
    s_mov_b32 s23, 0x20000
    s_movk_i32 s3, 16384
    buffer_load_dwordx4 v[44:47], v1, s[20:23], 0 offen
    buffer_load_dwordx4 v[48:51], v1, s[20:23], s3 offen
    s_mov_b32 s8, s80
    s_mov_b32 s9, s81
    s_mov_b32 s10, 0
    s_mov_b32 s11, 0x20000
    s_mov_b32 s12, s82
    s_mov_b32 s13, s83
    s_mov_b32 s14, 0
    s_mov_b32 s15, 0x20000
    s_mov_b32 s16, s84
    s_mov_b32 s17, s85
    s_mov_b32 s18, 0
    s_mov_b32 s19, 0x20000
    s_lshr_b32 s74, s2, 1
    s_and_b32 s74, s74, 28
    s_lshr_b32 s29, 0x00102010, s74
    s_lshr_b32 s30, 0x44414241, s74
    s_lshr_b32 s41, 0x43221100, s74
    s_and_b32 s29, s29, 15
    s_and_b32 s30, s30, 15
    s_and_b32 s41, s41, 15
    s_lshr_b32 s74, s2, 6
    s_lshl_b32 s74, s74, 3
    s_and_b32 s75, s2, 7
    s_add_u32 s74, s74, s75
    s_mul_i32 s74, s74, 5
    s_add_u32 s41, s41, s74
    s_sub_u32 s74, s30, s29
    s_bfm_b32 s28, s74, s29
    s_lshl_b32 s29, s29, 12
    s_lshl_b32 s30, s30, 12
    s_min_u32 s30, s30, 16000

    s_mul_i32 s78, s41, 16000
    s_add_u32 s49, s78, 16000
    s_cmp_ge_u32 s41, 3200
    s_cmovk_i32 s49, 0
    s_cmovk_i32 s78, 0
    s_lshl_b32 s10, s49, 2
    s_lshl_b32 s14, s49, 2
    s_lshl_b32 s18, s49, 1
    s_lshl_b32 s56, s78, 2
    s_lshl_b32 s61, s78, 1

    s_add_u32 s57, s56, 16384
    s_add_u32 s62, s61, 8192
    s_add_u32 s58, s56, 32768
    s_add_u32 s63, s61, 16384
    s_add_u32 s59, s56, 49152
    s_add_u32 s64, s61, 24576
    s_bitcmp1_b32 s28, 0
    s_cselect_b32 s56, s56, 0x7ff00000
    s_cselect_b32 s61, s61, 0x7ff00000

    s_bitcmp1_b32 s28, 1
    s_cselect_b32 s57, s57, 0x7ff00000
    s_cselect_b32 s62, s62, 0x7ff00000

    s_bitcmp1_b32 s28, 2
    s_cselect_b32 s58, s58, 0x7ff00000
    s_cselect_b32 s63, s63, 0x7ff00000

    s_bitcmp1_b32 s28, 3
    s_cselect_b32 s59, s59, 0x7ff00000
    s_cselect_b32 s64, s64, 0x7ff00000

    buffer_load_dwordx4 v[20:23], v1, s[12:15], s56 offen nt
    buffer_load_dwordx4 v[4:7], v1, s[8:11], s56 offen nt
    buffer_load_dwordx2 v[36:37], v2, s[16:19], s61 offen nt
    buffer_load_dwordx4 v[24:27], v1, s[12:15], s57 offen nt
    buffer_load_dwordx4 v[8:11], v1, s[8:11], s57 offen nt
    buffer_load_dwordx2 v[38:39], v2, s[16:19], s62 offen nt
    buffer_load_dwordx4 v[28:31], v1, s[12:15], s58 offen nt
    buffer_load_dwordx4 v[12:15], v1, s[8:11], s58 offen nt
    buffer_load_dwordx2 v[40:41], v2, s[16:19], s63 offen nt
    buffer_load_dwordx4 v[32:35], v1, s[12:15], s59 offen nt
    buffer_load_dwordx4 v[16:19], v1, s[8:11], s59 offen nt
    buffer_load_dwordx2 v[42:43], v2, s[16:19], s64 offen nt
    s_and_b32 s5, s2, 7
    s_mul_i32 s3, s5, 8192

    s_add_u32 s20, s6, s3
    s_addc_u32 s21, s7, 0
    s_mov_b32 s22, 8192
    s_mov_b32 s23, 0x20000
    s_mul_i32 s3, s5, 40632320
    s_add_u32 s3, s3, 77848576
    s_add_u32 s24, s6, s3
    s_addc_u32 s25, s7, 0
    s_mov_b32 s26, 40632320
    s_mov_b32 s27, 0x20000
    s_add_u32 s32, s6, 402907136
    s_addc_u32 s33, s7, 0
    s_mov_b32 s34, 409600000
    s_mov_b32 s35, 0x20000
    s_add_u32 s36, s6, 65536
    s_addc_u32 s37, s7, 0
    s_mov_b32 s38, 4
    s_mov_b32 s39, 0x20000
    s_mov_b32 s40, 687195
    s_mov_b32 s42, -6250
    s_mov_b32 s43, 1942
    s_mov_b32 s45, 0x06050400
    s_mov_b32 s46, 0x05040c00
    s_mov_b32 s47, 0x04020100
    s_mov_b32 s48, 3968
    s_sub_u32 s50, 0, s29
    v_mov_b32 v104, 1
    v_mov_b32 v105, 0x46ff8000
    s_mov_b32 s55, 0x05040100
    v_mul_u32_u24 v106, 5, v0
    v_mov_b32 v108, 16384
    v_mov_b32 v114, 0
    v_mov_b32 v115, 0
    v_mov_b32 v116, 0
    v_mov_b32 v117, -1
    ds_write_b64 v2, v[114:115]
    s_lshl_b32 s74, s29, 3
    s_lshl_b32 s75, s30, 3
    v_mov_b32 v118, 128000
    v_mov_b32 v119, s74
    v_mov_b32 v120, s75
    s_movk_i32 s3, 928
    v_cmp_gt_u32 s[66:67], s3, v0
    s_movk_i32 s3, 640
    v_cmp_gt_u32 s[68:69], s3, v0
    s_mov_b64 exec, 1
    ds_write_b128 v108, v[114:117]
    ds_write_b32 v118, v117 offset:16404
    ds_write_b32 v119, v117 offset:16396
    ds_write_b32 v120, v117 offset:16404
    s_mov_b64 exec, -1
    s_waitcnt lgkmcnt(0)
    s_lshl_b32 s88, s88, 16
    v_mov_b32 v110, 0.15915494
    v_mul_f32 v110, s88, v110
    s_mov_b32 s3, 0x7fff7fff
    v_readfirstlane_b32 s44, v110

    s_waitcnt vmcnt(12)
    v_and_b32 v44, s3, v44
    v_and_b32 v45, s3, v45
    v_and_b32 v46, s3, v46
    v_and_b32 v47, s3, v47
    v_and_b32 v48, s3, v48
    v_and_b32 v49, s3, v49
    v_and_b32 v50, s3, v50
    v_and_b32 v51, s3, v51
    v_mov_b32 v53, 0
    v_dot2_f32_bf16 v53, v44, v44, v53
    v_dot2_f32_bf16 v53, v45, v45, v53
    v_dot2_f32_bf16 v53, v46, v46, v53
    v_dot2_f32_bf16 v53, v47, v47, v53
    v_dot2_f32_bf16 v53, v48, v48, v53
    v_dot2_f32_bf16 v53, v49, v49, v53
    v_dot2_f32_bf16 v53, v50, v50, v53
    v_dot2_f32_bf16 v53, v51, v51, v53
    v_pk_max_u16 v44, v44, v45
    v_pk_max_u16 v44, v44, v46
    v_pk_max_u16 v44, v44, v47
    v_pk_max_u16 v44, v44, v48
    v_pk_max_u16 v44, v44, v49
    v_pk_max_u16 v44, v44, v50
    v_pk_max_u16 v44, v44, v51
    v_lshrrev_b32 v52, 16, v44
    v_and_b32 v44, 0xffff, v44
    v_max_u32 v52, v52, v44

    s_nop 1
    v_max_u32_dpp v52, v52, v52 row_shr:1 row_mask:0xf bank_mask:0xf
    s_nop 1
    v_max_u32_dpp v52, v52, v52 row_shr:2 row_mask:0xf bank_mask:0xf
    s_nop 1
    v_max_u32_dpp v52, v52, v52 row_shr:4 row_mask:0xf bank_mask:0xf
    s_nop 1
    v_max_u32_dpp v52, v52, v52 row_shr:8 row_mask:0xf bank_mask:0xf
    s_nop 1
    v_max_u32_dpp v52, v52, v52 row_bcast:15 row_mask:0xa bank_mask:0xf
    s_nop 1
    v_max_u32_dpp v52, v52, v52 row_bcast:31 row_mask:0xc bank_mask:0xf
    s_nop 1
    v_add_f32_dpp v53, v53, v53 row_shr:1 row_mask:0xf bank_mask:0xf
    s_nop 1
    v_add_f32_dpp v53, v53, v53 row_shr:2 row_mask:0xf bank_mask:0xf
    s_nop 1
    v_add_f32_dpp v53, v53, v53 row_shr:4 row_mask:0xf bank_mask:0xf
    s_nop 1
    v_add_f32_dpp v53, v53, v53 row_shr:8 row_mask:0xf bank_mask:0xf
    s_nop 1
    v_add_f32_dpp v53, v53, v53 row_bcast:15 row_mask:0xa bank_mask:0xf
    s_nop 1
    v_add_f32_dpp v53, v53, v53 row_bcast:31 row_mask:0xc bank_mask:0xf
    v_lshrrev_b32 v54, 6, v0
    v_lshlrev_b32 v54, 3, v54
    s_mov_b32 exec_lo, 0
    s_brev_b32 exec_hi, 1
    ds_write_b64 v54, v[52:53] offset:8192
    s_mov_b64 exec, -1
    v_and_b32 v54, 15, v0
    v_lshlrev_b32 v54, 3, v54
    s_waitcnt lgkmcnt(0)
    s_barrier
    ds_read_b64 v[52:53], v54 offset:8192
    s_waitcnt lgkmcnt(0)

    s_nop 1
    v_max_u32_dpp v52, v52, v52 row_ror:1 row_mask:0xf bank_mask:0xf
    v_add_f32_dpp v53, v53, v53 row_ror:1 row_mask:0xf bank_mask:0xf

    s_nop 1
    v_max_u32_dpp v52, v52, v52 row_ror:2 row_mask:0xf bank_mask:0xf
    v_add_f32_dpp v53, v53, v53 row_ror:2 row_mask:0xf bank_mask:0xf

    s_nop 1
    v_max_u32_dpp v52, v52, v52 row_ror:4 row_mask:0xf bank_mask:0xf
    v_add_f32_dpp v53, v53, v53 row_ror:4 row_mask:0xf bank_mask:0xf

    s_nop 1
    v_max_u32_dpp v52, v52, v52 row_ror:8 row_mask:0xf bank_mask:0xf
    v_add_f32_dpp v53, v53, v53 row_ror:8 row_mask:0xf bank_mask:0xf

    s_add_u32 s92, s6, 135168
    s_addc_u32 s93, s7, 0
    s_mov_b32 s94, 2048
    s_mov_b32 s95, 0x20000
    s_lshl_b32 s3, s2, 3
    buffer_store_dwordx2 v[52:53], v98, s[92:95], s3 offen
    v_mov_b32 v99, 1
    buffer_atomic_add v99, v98, s[96:99], 0 offen sc0
    v_mov_b32 v100, 0
    buffer_atomic_add v100, v98, s[96:99], 0 offen offset:128 sc0
    s_waitcnt vmcnt(12)
    s_bitcmp0_b32 s28, 0
    s_cbranch_scc1 L_ska_7
    v_mul_hi_u32_u24 v45, s40, v20
    v_mul_hi_u32_u24 v44, s40, v4
    v_mul_hi_u32_u24 v47, s40, v21
    v_mul_hi_u32_u24 v46, s40, v5
    v_mul_hi_u32_u24 v49, s40, v22
    v_mul_hi_u32_u24 v48, s40, v6
    v_mul_hi_u32_u24 v51, s40, v23
    v_mul_hi_u32_u24 v50, s40, v7
    v_and_b32 v45, -2, v45
    v_mad_u32_u24 v4, v44, s43, v4
    v_and_b32 v76, -4, v44
    v_and_b32 v47, -2, v47
    v_mad_u32_u24 v5, v46, s43, v5
    v_and_b32 v77, -4, v46
    v_and_b32 v49, -2, v49
    v_mad_u32_u24 v6, v48, s43, v6
    v_and_b32 v78, -4, v48
    v_and_b32 v51, -2, v51
    v_mad_u32_u24 v7, v50, s43, v7
    v_and_b32 v79, -4, v50
    v_mad_i32_i24 v20, v45, s42, v20
    v_lshl_add_u32 v45, v76, 5, v45
    v_mad_i32_i24 v21, v47, s42, v21
    v_lshl_add_u32 v47, v77, 5, v47
    v_mad_i32_i24 v22, v49, s42, v22
    v_lshl_add_u32 v49, v78, 5, v49
    v_mad_i32_i24 v23, v51, s42, v23
    v_lshl_add_u32 v51, v79, 5, v51
    v_add_u32 v45, v45, v45
    ds_add_rtn_u32 v76, v45, v104
    v_add_u32 v47, v47, v47
    ds_add_rtn_u32 v77, v47, v104
    v_add_u32 v49, v49, v49
    ds_add_rtn_u32 v78, v49, v104
    v_add_u32 v51, v51, v51
    ds_add_rtn_u32 v79, v51, v104
    v_lshlrev_b32 v110, 16, v36
    v_and_b32 v111, 0xffff0000, v36
    v_lshlrev_b32 v112, 16, v37
    v_and_b32 v113, 0xffff0000, v37
    v_mul_f32 v110, s44, v110
    v_mul_f32 v111, s44, v111
    v_mul_f32 v112, s44, v112
    v_mul_f32 v113, s44, v113
    v_fract_f32 v110, v110
    v_fract_f32 v111, v111
    v_fract_f32 v112, v112
    v_fract_f32 v113, v113
    v_cos_f32 v110, v110
    v_cos_f32 v111, v111
    v_cos_f32 v112, v112
    v_cos_f32 v113, v113
    v_lshl_or_b32 v44, v44, 14, v20
    v_perm_b32 v45, v45, v4, s46
    v_bfe_u32 v4, v4, 8, 5

    v_lshl_or_b32 v46, v46, 14, v21
    v_perm_b32 v47, v47, v5, s46
    v_bfe_u32 v5, v5, 8, 5

    v_lshl_or_b32 v48, v48, 14, v22
    v_perm_b32 v49, v49, v6, s46
    v_bfe_u32 v6, v6, 8, 5

    v_lshl_or_b32 v50, v50, 14, v23
    v_perm_b32 v51, v51, v7, s46
    v_bfe_u32 v7, v7, 8, 5

    v_fmaak_f32 v110, v110, v105, 0x4b400010
    v_fmaak_f32 v111, v111, v105, 0x4b400010
    v_fmaak_f32 v112, v112, v105, 0x4b400010
    v_fmaak_f32 v113, v113, v105, 0x4b400010
    v_sub_u32 v110, v110, v4
    v_sub_u32 v111, v111, v5
    v_sub_u32 v112, v112, v6
    v_sub_u32 v113, v113, v7
    v_bfi_b32 v110, 31, v4, v110
    v_bfi_b32 v111, 31, v5, v111
    v_bfi_b32 v112, 31, v6, v112
    v_bfi_b32 v113, 31, v7, v113
    v_perm_b32 v44, v44, v110, s55
    v_perm_b32 v46, v46, v111, s55
    v_perm_b32 v48, v48, v112, s55
    v_perm_b32 v50, v50, v113, s55
L_ska_7:
    s_waitcnt vmcnt(9)
    s_bitcmp0_b32 s28, 1
    s_cbranch_scc1 L_ska_8
    v_mul_hi_u32_u24 v53, s40, v24
    v_mul_hi_u32_u24 v52, s40, v8
    v_mul_hi_u32_u24 v55, s40, v25
    v_mul_hi_u32_u24 v54, s40, v9
    v_mul_hi_u32_u24 v57, s40, v26
    v_mul_hi_u32_u24 v56, s40, v10
    v_mul_hi_u32_u24 v59, s40, v27
    v_mul_hi_u32_u24 v58, s40, v11
    v_and_b32 v53, -2, v53
    v_mad_u32_u24 v8, v52, s43, v8
    v_and_b32 v80, -4, v52
    v_and_b32 v55, -2, v55
    v_mad_u32_u24 v9, v54, s43, v9
    v_and_b32 v81, -4, v54
    v_and_b32 v57, -2, v57
    v_mad_u32_u24 v10, v56, s43, v10
    v_and_b32 v82, -4, v56
    v_and_b32 v59, -2, v59
    v_mad_u32_u24 v11, v58, s43, v11
    v_and_b32 v83, -4, v58
    v_mad_i32_i24 v24, v53, s42, v24
    v_lshl_add_u32 v53, v80, 5, v53
    v_mad_i32_i24 v25, v55, s42, v25
    v_lshl_add_u32 v55, v81, 5, v55
    v_mad_i32_i24 v26, v57, s42, v26
    v_lshl_add_u32 v57, v82, 5, v57
    v_mad_i32_i24 v27, v59, s42, v27
    v_lshl_add_u32 v59, v83, 5, v59
    v_add_u32 v53, v53, v53
    ds_add_rtn_u32 v80, v53, v104
    v_add_u32 v55, v55, v55
    ds_add_rtn_u32 v81, v55, v104
    v_add_u32 v57, v57, v57
    ds_add_rtn_u32 v82, v57, v104
    v_add_u32 v59, v59, v59
    ds_add_rtn_u32 v83, v59, v104
    v_lshlrev_b32 v110, 16, v38
    v_and_b32 v111, 0xffff0000, v38
    v_lshlrev_b32 v112, 16, v39
    v_and_b32 v113, 0xffff0000, v39
    v_mul_f32 v110, s44, v110
    v_mul_f32 v111, s44, v111
    v_mul_f32 v112, s44, v112
    v_mul_f32 v113, s44, v113
    v_fract_f32 v110, v110
    v_fract_f32 v111, v111
    v_fract_f32 v112, v112
    v_fract_f32 v113, v113
    v_cos_f32 v110, v110
    v_cos_f32 v111, v111
    v_cos_f32 v112, v112
    v_cos_f32 v113, v113
    v_lshl_or_b32 v52, v52, 14, v24
    v_perm_b32 v53, v53, v8, s46
    v_bfe_u32 v8, v8, 8, 5

    v_lshl_or_b32 v54, v54, 14, v25
    v_perm_b32 v55, v55, v9, s46
    v_bfe_u32 v9, v9, 8, 5

    v_lshl_or_b32 v56, v56, 14, v26
    v_perm_b32 v57, v57, v10, s46
    v_bfe_u32 v10, v10, 8, 5

    v_lshl_or_b32 v58, v58, 14, v27
    v_perm_b32 v59, v59, v11, s46
    v_bfe_u32 v11, v11, 8, 5

    v_fmaak_f32 v110, v110, v105, 0x4b400010
    v_fmaak_f32 v111, v111, v105, 0x4b400010
    v_fmaak_f32 v112, v112, v105, 0x4b400010
    v_fmaak_f32 v113, v113, v105, 0x4b400010
    v_sub_u32 v110, v110, v8
    v_sub_u32 v111, v111, v9
    v_sub_u32 v112, v112, v10
    v_sub_u32 v113, v113, v11
    v_bfi_b32 v110, 31, v8, v110
    v_bfi_b32 v111, 31, v9, v111
    v_bfi_b32 v112, 31, v10, v112
    v_bfi_b32 v113, 31, v11, v113
    v_perm_b32 v52, v52, v110, s55
    v_perm_b32 v54, v54, v111, s55
    v_perm_b32 v56, v56, v112, s55
    v_perm_b32 v58, v58, v113, s55
L_ska_8:
    s_waitcnt vmcnt(6)
    s_bitcmp0_b32 s28, 2
    s_cbranch_scc1 L_ska_9
    v_mul_hi_u32_u24 v61, s40, v28
    v_mul_hi_u32_u24 v60, s40, v12
    v_mul_hi_u32_u24 v63, s40, v29
    v_mul_hi_u32_u24 v62, s40, v13
    v_mul_hi_u32_u24 v65, s40, v30
    v_mul_hi_u32_u24 v64, s40, v14
    v_mul_hi_u32_u24 v67, s40, v31
    v_mul_hi_u32_u24 v66, s40, v15
    v_and_b32 v61, -2, v61
    v_mad_u32_u24 v12, v60, s43, v12
    v_and_b32 v84, -4, v60
    v_and_b32 v63, -2, v63
    v_mad_u32_u24 v13, v62, s43, v13
    v_and_b32 v85, -4, v62
    v_and_b32 v65, -2, v65
    v_mad_u32_u24 v14, v64, s43, v14
    v_and_b32 v86, -4, v64
    v_and_b32 v67, -2, v67
    v_mad_u32_u24 v15, v66, s43, v15
    v_and_b32 v87, -4, v66
    v_mad_i32_i24 v28, v61, s42, v28
    v_lshl_add_u32 v61, v84, 5, v61
    v_mad_i32_i24 v29, v63, s42, v29
    v_lshl_add_u32 v63, v85, 5, v63
    v_mad_i32_i24 v30, v65, s42, v30
    v_lshl_add_u32 v65, v86, 5, v65
    v_mad_i32_i24 v31, v67, s42, v31
    v_lshl_add_u32 v67, v87, 5, v67
    v_add_u32 v61, v61, v61
    ds_add_rtn_u32 v84, v61, v104
    v_add_u32 v63, v63, v63
    ds_add_rtn_u32 v85, v63, v104
    v_add_u32 v65, v65, v65
    ds_add_rtn_u32 v86, v65, v104
    v_add_u32 v67, v67, v67
    ds_add_rtn_u32 v87, v67, v104
    v_lshlrev_b32 v110, 16, v40
    v_and_b32 v111, 0xffff0000, v40
    v_lshlrev_b32 v112, 16, v41
    v_and_b32 v113, 0xffff0000, v41
    v_mul_f32 v110, s44, v110
    v_mul_f32 v111, s44, v111
    v_mul_f32 v112, s44, v112
    v_mul_f32 v113, s44, v113
    v_fract_f32 v110, v110
    v_fract_f32 v111, v111
    v_fract_f32 v112, v112
    v_fract_f32 v113, v113
    v_cos_f32 v110, v110
    v_cos_f32 v111, v111
    v_cos_f32 v112, v112
    v_cos_f32 v113, v113
    v_lshl_or_b32 v60, v60, 14, v28
    v_perm_b32 v61, v61, v12, s46
    v_bfe_u32 v12, v12, 8, 5

    v_lshl_or_b32 v62, v62, 14, v29
    v_perm_b32 v63, v63, v13, s46
    v_bfe_u32 v13, v13, 8, 5

    v_lshl_or_b32 v64, v64, 14, v30
    v_perm_b32 v65, v65, v14, s46
    v_bfe_u32 v14, v14, 8, 5

    v_lshl_or_b32 v66, v66, 14, v31
    v_perm_b32 v67, v67, v15, s46
    v_bfe_u32 v15, v15, 8, 5

    v_fmaak_f32 v110, v110, v105, 0x4b400010
    v_fmaak_f32 v111, v111, v105, 0x4b400010
    v_fmaak_f32 v112, v112, v105, 0x4b400010
    v_fmaak_f32 v113, v113, v105, 0x4b400010
    v_sub_u32 v110, v110, v12
    v_sub_u32 v111, v111, v13
    v_sub_u32 v112, v112, v14
    v_sub_u32 v113, v113, v15
    v_bfi_b32 v110, 31, v12, v110
    v_bfi_b32 v111, 31, v13, v111
    v_bfi_b32 v112, 31, v14, v112
    v_bfi_b32 v113, 31, v15, v113
    v_perm_b32 v60, v60, v110, s55
    v_perm_b32 v62, v62, v111, s55
    v_perm_b32 v64, v64, v112, s55
    v_perm_b32 v66, v66, v113, s55
L_ska_9:
    s_waitcnt vmcnt(3)
    s_bitcmp0_b32 s28, 3
    s_cbranch_scc1 L_ska_10
    s_mov_b64 exec, s[66:67]
    v_mul_hi_u32_u24 v69, s40, v32
    v_mul_hi_u32_u24 v68, s40, v16
    v_mul_hi_u32_u24 v71, s40, v33
    v_mul_hi_u32_u24 v70, s40, v17
    v_mul_hi_u32_u24 v73, s40, v34
    v_mul_hi_u32_u24 v72, s40, v18
    v_mul_hi_u32_u24 v75, s40, v35
    v_mul_hi_u32_u24 v74, s40, v19
    v_and_b32 v69, -2, v69
    v_mad_u32_u24 v16, v68, s43, v16
    v_and_b32 v88, -4, v68
    v_and_b32 v71, -2, v71
    v_mad_u32_u24 v17, v70, s43, v17
    v_and_b32 v89, -4, v70
    v_and_b32 v73, -2, v73
    v_mad_u32_u24 v18, v72, s43, v18
    v_and_b32 v90, -4, v72
    v_and_b32 v75, -2, v75
    v_mad_u32_u24 v19, v74, s43, v19
    v_and_b32 v91, -4, v74
    v_mad_i32_i24 v32, v69, s42, v32
    v_lshl_add_u32 v69, v88, 5, v69
    v_mad_i32_i24 v33, v71, s42, v33
    v_lshl_add_u32 v71, v89, 5, v71
    v_mad_i32_i24 v34, v73, s42, v34
    v_lshl_add_u32 v73, v90, 5, v73
    v_mad_i32_i24 v35, v75, s42, v35
    v_lshl_add_u32 v75, v91, 5, v75
    v_add_u32 v69, v69, v69
    ds_add_rtn_u32 v88, v69, v104
    v_add_u32 v71, v71, v71
    ds_add_rtn_u32 v89, v71, v104
    v_add_u32 v73, v73, v73
    ds_add_rtn_u32 v90, v73, v104
    v_add_u32 v75, v75, v75
    ds_add_rtn_u32 v91, v75, v104
    v_lshlrev_b32 v110, 16, v42
    v_and_b32 v111, 0xffff0000, v42
    v_lshlrev_b32 v112, 16, v43
    v_and_b32 v113, 0xffff0000, v43
    v_mul_f32 v110, s44, v110
    v_mul_f32 v111, s44, v111
    v_mul_f32 v112, s44, v112
    v_mul_f32 v113, s44, v113
    v_fract_f32 v110, v110
    v_fract_f32 v111, v111
    v_fract_f32 v112, v112
    v_fract_f32 v113, v113
    v_cos_f32 v110, v110
    v_cos_f32 v111, v111
    v_cos_f32 v112, v112
    v_cos_f32 v113, v113
    v_lshl_or_b32 v68, v68, 14, v32
    v_perm_b32 v69, v69, v16, s46
    v_bfe_u32 v16, v16, 8, 5

    v_lshl_or_b32 v70, v70, 14, v33
    v_perm_b32 v71, v71, v17, s46
    v_bfe_u32 v17, v17, 8, 5

    v_lshl_or_b32 v72, v72, 14, v34
    v_perm_b32 v73, v73, v18, s46
    v_bfe_u32 v18, v18, 8, 5

    v_lshl_or_b32 v74, v74, 14, v35
    v_perm_b32 v75, v75, v19, s46
    v_bfe_u32 v19, v19, 8, 5

    v_fmaak_f32 v110, v110, v105, 0x4b400010
    v_fmaak_f32 v111, v111, v105, 0x4b400010
    v_fmaak_f32 v112, v112, v105, 0x4b400010
    v_fmaak_f32 v113, v113, v105, 0x4b400010
    v_sub_u32 v110, v110, v16
    v_sub_u32 v111, v111, v17
    v_sub_u32 v112, v112, v18
    v_sub_u32 v113, v113, v19
    v_bfi_b32 v110, 31, v16, v110
    v_bfi_b32 v111, 31, v17, v111
    v_bfi_b32 v112, 31, v18, v112
    v_bfi_b32 v113, 31, v19, v113
    v_perm_b32 v68, v68, v110, s55
    v_perm_b32 v70, v70, v111, s55
    v_perm_b32 v72, v72, v112, s55
    v_perm_b32 v74, v74, v113, s55
    s_mov_b64 exec, -1
L_ska_10:
    s_waitcnt vmcnt(0)
    v_or_b32 v100, v100, v0
    s_nop 0
    v_readfirstlane_b32 s74, v100
    s_nop 1
    s_cmp_lg_u32 s74, 0
    s_cbranch_scc1 L_ready_12

    v_mov_b32 v110, 1
    buffer_atomic_add v110, v98, s[96:99], 0 offen offset:64 sc0
    s_waitcnt vmcnt(0)
    v_readfirstlane_b32 s74, v110
    s_nop 1
    s_cmp_lg_u32 s74, 0
    s_cbranch_scc1 L_zno_14

    s_mov_b32 s92, s6
    s_mov_b32 s93, s7
    s_mov_b32 s94, 65552
    s_mov_b32 s95, 0x20000
    v_mov_b32 v110, 0
    v_mov_b32 v111, 0
    v_mov_b32 v112, 0
    v_mov_b32 v113, 0
L_zl_13:
    buffer_store_dwordx4 v[110:113], v1, s[92:95], s74 offen sc0 sc1
    s_add_u32 s74, s74, 1024
    s_cmp_le_u32 s74, 65536
    s_cbranch_scc1 L_zl_13
    v_mov_b32 v114, 1
    s_waitcnt vmcnt(0)
    buffer_atomic_add v114, v98, s[96:99], 0 offen offset:128
L_zno_14:

L_spin_11:
    v_mov_b32 v100, 0
    buffer_atomic_add v100, v98, s[96:99], 0 offen offset:128 sc0
    s_waitcnt vmcnt(0)
    v_readfirstlane_b32 s74, v100
    s_nop 1
    s_cmp_eq_u32 s74, 0
    s_cbranch_scc1 L_spin_11
L_ready_12:

    v_cmp_eq_u32 vcc, 0, v0
    s_waitcnt vmcnt(1)
    s_mov_b64 exec, vcc
    ds_write_b32 v108, v99 offset:8
    s_mov_b64 exec, -1
    s_waitcnt lgkmcnt(0)
    s_barrier

    ds_read2_b32 v[110:111], v108 offset0:1 offset1:2
    ds_read_b64 v[94:95], v2
    s_waitcnt lgkmcnt(0)
    v_readfirstlane_b32 s53, v110
    v_readfirstlane_b32 s41, v111

    v_and_b32 v94, 0xffff, v94
    v_and_b32 v95, 0xffff, v95
    v_add_u32 v97, v94, v95
    s_nop 1
    v_add_u32_dpp v97, v97, v97 row_shr:1 row_mask:0xf bank_mask:0xf
    s_nop 1
    v_add_u32_dpp v97, v97, v97 row_shr:2 row_mask:0xf bank_mask:0xf
    s_nop 1
    v_add_u32_dpp v97, v97, v97 row_shr:4 row_mask:0xf bank_mask:0xf
    s_nop 1
    v_add_u32_dpp v97, v97, v97 row_shr:8 row_mask:0xf bank_mask:0xf
    s_nop 1
    v_add_u32_dpp v97, v97, v97 row_bcast:15 row_mask:0xa bank_mask:0xf
    s_nop 1
    v_add_u32_dpp v97, v97, v97 row_bcast:31 row_mask:0xc bank_mask:0xf
    s_mov_b32 exec_lo, 0
    s_brev_b32 exec_hi, 1
    ds_add_rtn_u32 v96, v108, v97
    s_mov_b64 exec, -1

    v_add_u32 v92, v94, v94
    v_add_u32 v93, v95, v95
    v_med3_u32 v92, v94, 2, v92
    v_med3_u32 v93, v95, 2, v93
    buffer_atomic_add_x2 v[92:93], v2, s[20:23], 0 offen sc0
    s_add_u32 s41, s41, 160
    s_mul_i32 s78, s41, 16000
    s_add_u32 s49, s78, 16000
    s_cmp_ge_u32 s41, 3200
    s_cmovk_i32 s49, 0
    s_cmovk_i32 s78, 0
    s_lshl_b32 s10, s49, 2
    s_lshl_b32 s14, s49, 2
    s_lshl_b32 s18, s49, 1
    s_lshl_b32 s56, s78, 2
    s_lshl_b32 s61, s78, 1

    s_add_u32 s57, s56, 16384
    s_add_u32 s62, s61, 8192
    s_add_u32 s58, s56, 32768
    s_add_u32 s63, s61, 16384
    s_add_u32 s59, s56, 49152
    s_add_u32 s64, s61, 24576
    s_waitcnt lgkmcnt(0)
    v_readlane_b32 s77, v96, 63
    v_mul_u32_u24 v114, 7936, v0
    v_sub_u32 v97, v97, v95
    s_sub_u32 s77, s77, s50
    v_add_u32 v97, s77, v97
    v_sub_u32 v96, v97, v94
    v_lshlrev_b32 v111, 16, v97
    v_lshlrev_b32 v110, 16, v96
    ds_write_b64 v2, v[110:111]
    v_sub_u32 v96, v114, v96
    v_sub_u32 v97, v114, v97
    v_add_u32 v97, s48, v97
    s_add_u32 s50, s50, s30

    s_waitcnt lgkmcnt(0)
    s_barrier

    buffer_load_dwordx4 v[20:23], v1, s[12:15], s56 offen nt
    buffer_load_dwordx4 v[4:7], v1, s[8:11], s56 offen nt
    buffer_load_dwordx2 v[36:37], v2, s[16:19], s61 offen nt
    buffer_load_dwordx4 v[24:27], v1, s[12:15], s57 offen nt
    buffer_load_dwordx4 v[8:11], v1, s[8:11], s57 offen nt
    buffer_load_dwordx2 v[38:39], v2, s[16:19], s62 offen nt
    buffer_load_dwordx4 v[28:31], v1, s[12:15], s58 offen nt
    buffer_load_dwordx4 v[12:15], v1, s[8:11], s58 offen nt
    buffer_load_dwordx2 v[40:41], v2, s[16:19], s63 offen nt
    buffer_load_dwordx4 v[32:35], v1, s[12:15], s59 offen nt
    buffer_load_dwordx4 v[16:19], v1, s[8:11], s59 offen nt
    buffer_load_dwordx2 v[42:43], v2, s[16:19], s64 offen nt
    s_bitcmp0_b32 s28, 0
    s_cbranch_scc1 L_skz_15
    v_lshrrev_b32 v110, 16, v45
    ds_read_b32 v110, v110
    v_lshrrev_b32 v111, 16, v47
    ds_read_b32 v111, v111
    v_lshrrev_b32 v112, 16, v49
    ds_read_b32 v112, v112
    v_lshrrev_b32 v113, 16, v51
    ds_read_b32 v113, v113
    s_waitcnt lgkmcnt(3)
    v_add_u32_sdwa v110, v110, v76 dst_sel:DWORD dst_unused:UNUSED_PAD src0_sel:WORD_1 src1_sel:WORD_0
    v_lshlrev_b32 v110, 3, v110
    ds_write_b64 v110, v[44:45] offset:16400

    s_waitcnt lgkmcnt(3)
    v_add_u32_sdwa v111, v111, v77 dst_sel:DWORD dst_unused:UNUSED_PAD src0_sel:WORD_1 src1_sel:WORD_0
    v_lshlrev_b32 v111, 3, v111
    ds_write_b64 v111, v[46:47] offset:16400

    s_waitcnt lgkmcnt(3)
    v_add_u32_sdwa v112, v112, v78 dst_sel:DWORD dst_unused:UNUSED_PAD src0_sel:WORD_1 src1_sel:WORD_0
    v_lshlrev_b32 v112, 3, v112
    ds_write_b64 v112, v[48:49] offset:16400

    s_waitcnt lgkmcnt(3)
    v_add_u32_sdwa v113, v113, v79 dst_sel:DWORD dst_unused:UNUSED_PAD src0_sel:WORD_1 src1_sel:WORD_0
    v_lshlrev_b32 v113, 3, v113
    ds_write_b64 v113, v[50:51] offset:16400

L_skz_15:
    s_bitcmp0_b32 s28, 1
    s_cbranch_scc1 L_skz_16
    v_lshrrev_b32 v110, 16, v53
    ds_read_b32 v110, v110
    v_lshrrev_b32 v111, 16, v55
    ds_read_b32 v111, v111
    v_lshrrev_b32 v112, 16, v57
    ds_read_b32 v112, v112
    v_lshrrev_b32 v113, 16, v59
    ds_read_b32 v113, v113
    s_waitcnt lgkmcnt(3)
    v_add_u32_sdwa v110, v110, v80 dst_sel:DWORD dst_unused:UNUSED_PAD src0_sel:WORD_1 src1_sel:WORD_0
    v_lshlrev_b32 v110, 3, v110
    ds_write_b64 v110, v[52:53] offset:16400

    s_waitcnt lgkmcnt(3)
    v_add_u32_sdwa v111, v111, v81 dst_sel:DWORD dst_unused:UNUSED_PAD src0_sel:WORD_1 src1_sel:WORD_0
    v_lshlrev_b32 v111, 3, v111
    ds_write_b64 v111, v[54:55] offset:16400

    s_waitcnt lgkmcnt(3)
    v_add_u32_sdwa v112, v112, v82 dst_sel:DWORD dst_unused:UNUSED_PAD src0_sel:WORD_1 src1_sel:WORD_0
    v_lshlrev_b32 v112, 3, v112
    ds_write_b64 v112, v[56:57] offset:16400

    s_waitcnt lgkmcnt(3)
    v_add_u32_sdwa v113, v113, v83 dst_sel:DWORD dst_unused:UNUSED_PAD src0_sel:WORD_1 src1_sel:WORD_0
    v_lshlrev_b32 v113, 3, v113
    ds_write_b64 v113, v[58:59] offset:16400

L_skz_16:
    s_bitcmp0_b32 s28, 2
    s_cbranch_scc1 L_skz_17
    v_lshrrev_b32 v110, 16, v61
    ds_read_b32 v110, v110
    v_lshrrev_b32 v111, 16, v63
    ds_read_b32 v111, v111
    v_lshrrev_b32 v112, 16, v65
    ds_read_b32 v112, v112
    v_lshrrev_b32 v113, 16, v67
    ds_read_b32 v113, v113
    s_waitcnt lgkmcnt(3)
    v_add_u32_sdwa v110, v110, v84 dst_sel:DWORD dst_unused:UNUSED_PAD src0_sel:WORD_1 src1_sel:WORD_0
    v_lshlrev_b32 v110, 3, v110
    ds_write_b64 v110, v[60:61] offset:16400

    s_waitcnt lgkmcnt(3)
    v_add_u32_sdwa v111, v111, v85 dst_sel:DWORD dst_unused:UNUSED_PAD src0_sel:WORD_1 src1_sel:WORD_0
    v_lshlrev_b32 v111, 3, v111
    ds_write_b64 v111, v[62:63] offset:16400

    s_waitcnt lgkmcnt(3)
    v_add_u32_sdwa v112, v112, v86 dst_sel:DWORD dst_unused:UNUSED_PAD src0_sel:WORD_1 src1_sel:WORD_0
    v_lshlrev_b32 v112, 3, v112
    ds_write_b64 v112, v[64:65] offset:16400

    s_waitcnt lgkmcnt(3)
    v_add_u32_sdwa v113, v113, v87 dst_sel:DWORD dst_unused:UNUSED_PAD src0_sel:WORD_1 src1_sel:WORD_0
    v_lshlrev_b32 v113, 3, v113
    ds_write_b64 v113, v[66:67] offset:16400

L_skz_17:
    s_bitcmp0_b32 s28, 3
    s_cbranch_scc1 L_skz_18
    s_mov_b64 exec, s[66:67]
    v_lshrrev_b32 v110, 16, v69
    ds_read_b32 v110, v110
    v_lshrrev_b32 v111, 16, v71
    ds_read_b32 v111, v111
    v_lshrrev_b32 v112, 16, v73
    ds_read_b32 v112, v112
    v_lshrrev_b32 v113, 16, v75
    ds_read_b32 v113, v113
    s_waitcnt lgkmcnt(3)
    v_add_u32_sdwa v110, v110, v88 dst_sel:DWORD dst_unused:UNUSED_PAD src0_sel:WORD_1 src1_sel:WORD_0
    v_lshlrev_b32 v110, 3, v110
    ds_write_b64 v110, v[68:69] offset:16400

    s_waitcnt lgkmcnt(3)
    v_add_u32_sdwa v111, v111, v89 dst_sel:DWORD dst_unused:UNUSED_PAD src0_sel:WORD_1 src1_sel:WORD_0
    v_lshlrev_b32 v111, 3, v111
    ds_write_b64 v111, v[70:71] offset:16400

    s_waitcnt lgkmcnt(3)
    v_add_u32_sdwa v112, v112, v90 dst_sel:DWORD dst_unused:UNUSED_PAD src0_sel:WORD_1 src1_sel:WORD_0
    v_lshlrev_b32 v112, 3, v112
    ds_write_b64 v112, v[72:73] offset:16400

    s_waitcnt lgkmcnt(3)
    v_add_u32_sdwa v113, v113, v91 dst_sel:DWORD dst_unused:UNUSED_PAD src0_sel:WORD_1 src1_sel:WORD_0
    v_lshlrev_b32 v113, 3, v113
    ds_write_b64 v113, v[74:75] offset:16400

    s_mov_b64 exec, -1
L_skz_18:
    s_cmp_eq_u32 s49, 0
    s_cbranch_scc1 L_p1epi_6
L_p1loop_5:
    v_mov_b32 v99, 1
    buffer_atomic_add v99, v98, s[96:99], 0 offen sc0
    s_waitcnt vmcnt(10)
    v_mul_hi_u32_u24 v45, s40, v20
    v_mul_hi_u32_u24 v44, s40, v4
    v_mul_hi_u32_u24 v47, s40, v21
    v_mul_hi_u32_u24 v46, s40, v5
    v_mul_hi_u32_u24 v49, s40, v22
    v_mul_hi_u32_u24 v48, s40, v6
    v_mul_hi_u32_u24 v51, s40, v23
    v_mul_hi_u32_u24 v50, s40, v7
    v_and_b32 v45, -2, v45
    v_mad_u32_u24 v4, v44, s43, v4
    v_and_b32 v76, -4, v44
    v_and_b32 v47, -2, v47
    v_mad_u32_u24 v5, v46, s43, v5
    v_and_b32 v77, -4, v46
    v_and_b32 v49, -2, v49
    v_mad_u32_u24 v6, v48, s43, v6
    v_and_b32 v78, -4, v48
    v_and_b32 v51, -2, v51
    v_mad_u32_u24 v7, v50, s43, v7
    v_and_b32 v79, -4, v50
    v_mad_i32_i24 v20, v45, s42, v20
    v_lshl_add_u32 v45, v76, 5, v45
    v_mad_i32_i24 v21, v47, s42, v21
    v_lshl_add_u32 v47, v77, 5, v47
    v_mad_i32_i24 v22, v49, s42, v22
    v_lshl_add_u32 v49, v78, 5, v49
    v_mad_i32_i24 v23, v51, s42, v23
    v_lshl_add_u32 v51, v79, 5, v51
    v_add_u32 v45, v45, v45
    ds_add_rtn_u32 v76, v45, v104
    v_add_u32 v47, v47, v47
    ds_add_rtn_u32 v77, v47, v104
    v_add_u32 v49, v49, v49
    ds_add_rtn_u32 v78, v49, v104
    v_add_u32 v51, v51, v51
    ds_add_rtn_u32 v79, v51, v104
    v_lshlrev_b32 v110, 16, v36
    v_and_b32 v111, 0xffff0000, v36
    v_lshlrev_b32 v112, 16, v37
    v_and_b32 v113, 0xffff0000, v37
    v_mul_f32 v110, s44, v110
    v_mul_f32 v111, s44, v111
    v_mul_f32 v112, s44, v112
    v_mul_f32 v113, s44, v113
    v_fract_f32 v110, v110
    v_fract_f32 v111, v111
    v_fract_f32 v112, v112
    v_fract_f32 v113, v113
    v_cos_f32 v110, v110
    v_cos_f32 v111, v111
    v_cos_f32 v112, v112
    v_cos_f32 v113, v113
    v_lshl_or_b32 v44, v44, 14, v20
    v_perm_b32 v45, v45, v4, s46
    v_bfe_u32 v4, v4, 8, 5

    v_lshl_or_b32 v46, v46, 14, v21
    v_perm_b32 v47, v47, v5, s46
    v_bfe_u32 v5, v5, 8, 5

    v_lshl_or_b32 v48, v48, 14, v22
    v_perm_b32 v49, v49, v6, s46
    v_bfe_u32 v6, v6, 8, 5

    v_lshl_or_b32 v50, v50, 14, v23
    v_perm_b32 v51, v51, v7, s46
    v_bfe_u32 v7, v7, 8, 5

    v_fmaak_f32 v110, v110, v105, 0x4b400010
    v_fmaak_f32 v111, v111, v105, 0x4b400010
    v_fmaak_f32 v112, v112, v105, 0x4b400010
    v_fmaak_f32 v113, v113, v105, 0x4b400010
    v_sub_u32 v110, v110, v4
    v_sub_u32 v111, v111, v5
    v_sub_u32 v112, v112, v6
    v_sub_u32 v113, v113, v7
    v_bfi_b32 v110, 31, v4, v110
    v_bfi_b32 v111, 31, v5, v111
    v_bfi_b32 v112, 31, v6, v112
    v_bfi_b32 v113, 31, v7, v113
    v_perm_b32 v44, v44, v110, s55
    v_perm_b32 v46, v46, v111, s55
    v_perm_b32 v48, v48, v112, s55
    v_perm_b32 v50, v50, v113, s55
    s_waitcnt vmcnt(7)
    v_mul_hi_u32_u24 v53, s40, v24
    v_mul_hi_u32_u24 v52, s40, v8
    v_mul_hi_u32_u24 v55, s40, v25
    v_mul_hi_u32_u24 v54, s40, v9
    v_mul_hi_u32_u24 v57, s40, v26
    v_mul_hi_u32_u24 v56, s40, v10
    v_mul_hi_u32_u24 v59, s40, v27
    v_mul_hi_u32_u24 v58, s40, v11
    v_and_b32 v53, -2, v53
    v_mad_u32_u24 v8, v52, s43, v8
    v_and_b32 v80, -4, v52
    v_and_b32 v55, -2, v55
    v_mad_u32_u24 v9, v54, s43, v9
    v_and_b32 v81, -4, v54
    v_and_b32 v57, -2, v57
    v_mad_u32_u24 v10, v56, s43, v10
    v_and_b32 v82, -4, v56
    v_and_b32 v59, -2, v59
    v_mad_u32_u24 v11, v58, s43, v11
    v_and_b32 v83, -4, v58
    v_mad_i32_i24 v24, v53, s42, v24
    v_lshl_add_u32 v53, v80, 5, v53
    v_mad_i32_i24 v25, v55, s42, v25
    v_lshl_add_u32 v55, v81, 5, v55
    v_mad_i32_i24 v26, v57, s42, v26
    v_lshl_add_u32 v57, v82, 5, v57
    v_mad_i32_i24 v27, v59, s42, v27
    v_lshl_add_u32 v59, v83, 5, v59
    v_add_u32 v53, v53, v53
    ds_add_rtn_u32 v80, v53, v104
    v_add_u32 v55, v55, v55
    ds_add_rtn_u32 v81, v55, v104
    v_add_u32 v57, v57, v57
    ds_add_rtn_u32 v82, v57, v104
    v_add_u32 v59, v59, v59
    ds_add_rtn_u32 v83, v59, v104
    v_lshlrev_b32 v110, 16, v38
    v_and_b32 v111, 0xffff0000, v38
    v_lshlrev_b32 v112, 16, v39
    v_and_b32 v113, 0xffff0000, v39
    v_mul_f32 v110, s44, v110
    v_mul_f32 v111, s44, v111
    v_mul_f32 v112, s44, v112
    v_mul_f32 v113, s44, v113
    v_fract_f32 v110, v110
    v_fract_f32 v111, v111
    v_fract_f32 v112, v112
    v_fract_f32 v113, v113
    v_cos_f32 v110, v110
    v_cos_f32 v111, v111
    v_cos_f32 v112, v112
    v_cos_f32 v113, v113
    v_lshl_or_b32 v52, v52, 14, v24
    v_perm_b32 v53, v53, v8, s46
    v_bfe_u32 v8, v8, 8, 5

    v_lshl_or_b32 v54, v54, 14, v25
    v_perm_b32 v55, v55, v9, s46
    v_bfe_u32 v9, v9, 8, 5

    v_lshl_or_b32 v56, v56, 14, v26
    v_perm_b32 v57, v57, v10, s46
    v_bfe_u32 v10, v10, 8, 5

    v_lshl_or_b32 v58, v58, 14, v27
    v_perm_b32 v59, v59, v11, s46
    v_bfe_u32 v11, v11, 8, 5

    v_fmaak_f32 v110, v110, v105, 0x4b400010
    v_fmaak_f32 v111, v111, v105, 0x4b400010
    v_fmaak_f32 v112, v112, v105, 0x4b400010
    v_fmaak_f32 v113, v113, v105, 0x4b400010
    v_sub_u32 v110, v110, v8
    v_sub_u32 v111, v111, v9
    v_sub_u32 v112, v112, v10
    v_sub_u32 v113, v113, v11
    v_bfi_b32 v110, 31, v8, v110
    v_bfi_b32 v111, 31, v9, v111
    v_bfi_b32 v112, 31, v10, v112
    v_bfi_b32 v113, 31, v11, v113
    v_perm_b32 v52, v52, v110, s55
    v_perm_b32 v54, v54, v111, s55
    v_perm_b32 v56, v56, v112, s55
    v_perm_b32 v58, v58, v113, s55
    s_waitcnt vmcnt(4)
    v_mul_hi_u32_u24 v61, s40, v28
    v_mul_hi_u32_u24 v60, s40, v12
    v_mul_hi_u32_u24 v63, s40, v29
    v_mul_hi_u32_u24 v62, s40, v13
    v_mul_hi_u32_u24 v65, s40, v30
    v_mul_hi_u32_u24 v64, s40, v14
    v_mul_hi_u32_u24 v67, s40, v31
    v_mul_hi_u32_u24 v66, s40, v15
    v_and_b32 v61, -2, v61
    v_mad_u32_u24 v12, v60, s43, v12
    v_and_b32 v84, -4, v60
    v_and_b32 v63, -2, v63
    v_mad_u32_u24 v13, v62, s43, v13
    v_and_b32 v85, -4, v62
    v_and_b32 v65, -2, v65
    v_mad_u32_u24 v14, v64, s43, v14
    v_and_b32 v86, -4, v64
    v_and_b32 v67, -2, v67
    v_mad_u32_u24 v15, v66, s43, v15
    v_and_b32 v87, -4, v66
    v_mad_i32_i24 v28, v61, s42, v28
    v_lshl_add_u32 v61, v84, 5, v61
    v_mad_i32_i24 v29, v63, s42, v29
    v_lshl_add_u32 v63, v85, 5, v63
    v_mad_i32_i24 v30, v65, s42, v30
    v_lshl_add_u32 v65, v86, 5, v65
    v_mad_i32_i24 v31, v67, s42, v31
    v_lshl_add_u32 v67, v87, 5, v67
    v_add_u32 v61, v61, v61
    ds_add_rtn_u32 v84, v61, v104
    v_add_u32 v63, v63, v63
    ds_add_rtn_u32 v85, v63, v104
    v_add_u32 v65, v65, v65
    ds_add_rtn_u32 v86, v65, v104
    v_add_u32 v67, v67, v67
    ds_add_rtn_u32 v87, v67, v104
    v_lshlrev_b32 v110, 16, v40
    v_and_b32 v111, 0xffff0000, v40
    v_lshlrev_b32 v112, 16, v41
    v_and_b32 v113, 0xffff0000, v41
    v_mul_f32 v110, s44, v110
    v_mul_f32 v111, s44, v111
    v_mul_f32 v112, s44, v112
    v_mul_f32 v113, s44, v113
    v_fract_f32 v110, v110
    v_fract_f32 v111, v111
    v_fract_f32 v112, v112
    v_fract_f32 v113, v113
    v_cos_f32 v110, v110
    v_cos_f32 v111, v111
    v_cos_f32 v112, v112
    v_cos_f32 v113, v113
    v_lshl_or_b32 v60, v60, 14, v28
    v_perm_b32 v61, v61, v12, s46
    v_bfe_u32 v12, v12, 8, 5

    v_lshl_or_b32 v62, v62, 14, v29
    v_perm_b32 v63, v63, v13, s46
    v_bfe_u32 v13, v13, 8, 5

    v_lshl_or_b32 v64, v64, 14, v30
    v_perm_b32 v65, v65, v14, s46
    v_bfe_u32 v14, v14, 8, 5

    v_lshl_or_b32 v66, v66, 14, v31
    v_perm_b32 v67, v67, v15, s46
    v_bfe_u32 v15, v15, 8, 5

    v_fmaak_f32 v110, v110, v105, 0x4b400010
    v_fmaak_f32 v111, v111, v105, 0x4b400010
    v_fmaak_f32 v112, v112, v105, 0x4b400010
    v_fmaak_f32 v113, v113, v105, 0x4b400010
    v_sub_u32 v110, v110, v12
    v_sub_u32 v111, v111, v13
    v_sub_u32 v112, v112, v14
    v_sub_u32 v113, v113, v15
    v_bfi_b32 v110, 31, v12, v110
    v_bfi_b32 v111, 31, v13, v111
    v_bfi_b32 v112, 31, v14, v112
    v_bfi_b32 v113, 31, v15, v113
    v_perm_b32 v60, v60, v110, s55
    v_perm_b32 v62, v62, v111, s55
    v_perm_b32 v64, v64, v112, s55
    v_perm_b32 v66, v66, v113, s55
    s_waitcnt vmcnt(1)
    s_waitcnt vmcnt(0)
    s_waitcnt vmcnt(13)
    v_add_u32 v110, v92, v94
    v_min_u32 v92, s48, v92
    v_add_u32 v111, v93, v95
    v_min_u32 v93, s48, v93
    v_max_u32 v110, v110, v111
    v_add_u32 v92, v92, v96
    v_add_u32 v93, v93, v97
    v_cmp_le_u32 vcc, s48, v110
    v_lshl_add_u32 v92, v92, 2, v92
    v_lshl_add_u32 v93, v93, 2, v93
    ds_write_b64 v2, v[92:93] offset:8192
    s_cbranch_vccz L_noov_22
    ds_write_b32 v108, v104 offset:4
L_noov_22:

    s_waitcnt lgkmcnt(0)
    s_barrier
    ds_read_b32 v110, v108 offset:4
    s_waitcnt lgkmcnt(0)
    v_readfirstlane_b32 s53, v110
    s_nop 1

    s_cmp_lg_u32 s53, 0
    s_cbranch_scc1 L_slow_23
L_sback_24:
    s_bitcmp0_b32 s28, 0
    s_cbranch_scc1 L_skw_28
    ds_read_b64 v[110:111], v2 offset:16400
    ds_read_b64 v[112:113], v2 offset:16408
    ds_read_b64 v[114:115], v2 offset:16392

    ds_read_b64 v[118:119], v2 offset:24592
    ds_read_b64 v[120:121], v2 offset:24600
    ds_read_b64 v[122:123], v2 offset:24584

    s_waitcnt lgkmcnt(3)
    v_lshrrev_b32 v116, 16, v111
    ds_read_b32 v116, v116 offset:8192

    s_waitcnt lgkmcnt(1)
    v_lshrrev_b32 v124, 16, v119
    ds_read_b32 v124, v124 offset:8192

    v_cmp_ne_u32_sdwa s[80:81], v111, v113 src0_sel:WORD_1 src1_sel:WORD_1
    v_cmp_ne_u32_sdwa vcc, v111, v115 src0_sel:WORD_1 src1_sel:WORD_1
    v_alignbyte_b32 v114, v115, v114, 2
    s_mov_b32 s54, -3
    v_alignbyte_b32 v111, v111, v110, 1
    v_perm_b32 v110, v110, v114, s47
    s_waitcnt lgkmcnt(1)
    v_add3_u32 v116, v116, v106, s54
    v_sub_u32 v117, 0, v116
    v_and_b32 v117, 3, v117
    s_mov_b64 exec, s[80:81]
    v_mov_b32 v117, 0
    v_mov_b32 v112, 0
    s_mov_b64 exec, vcc
    v_mov_b32 v117, 3

    s_mov_b64 exec, -1
    v_alignbyte_b32 v110, v111, v110, v117
    v_alignbyte_b32 v111, v112, v111, v117
    v_add_u32 v116, v116, v117

    buffer_store_dwordx2 v[110:111], v116, s[24:27], 0 offen
    v_cmp_ne_u32_sdwa s[80:81], v119, v121 src0_sel:WORD_1 src1_sel:WORD_1
    v_cmp_ne_u32_sdwa vcc, v119, v123 src0_sel:WORD_1 src1_sel:WORD_1
    v_alignbyte_b32 v122, v123, v122, 2
    s_mov_b32 s54, 5117
    v_alignbyte_b32 v119, v119, v118, 1
    v_perm_b32 v118, v118, v122, s47
    s_waitcnt lgkmcnt(0)
    v_add3_u32 v124, v124, v106, s54
    v_sub_u32 v125, 0, v124
    v_and_b32 v125, 3, v125
    s_mov_b64 exec, s[80:81]
    v_mov_b32 v125, 0
    v_mov_b32 v120, 0
    s_mov_b64 exec, vcc
    v_mov_b32 v125, 3

    s_mov_b64 exec, -1
    v_alignbyte_b32 v118, v119, v118, v125
    v_alignbyte_b32 v119, v120, v119, v125
    v_add_u32 v124, v124, v125

    buffer_store_dwordx2 v[118:119], v124, s[24:27], 0 offen
L_skw_28:
    s_bitcmp0_b32 s28, 0
    s_cbranch_scc1 L_skw_29
    ds_read_b64 v[110:111], v2 offset:32784
    ds_read_b64 v[112:113], v2 offset:32792
    ds_read_b64 v[114:115], v2 offset:32776

    ds_read_b64 v[118:119], v2 offset:40976
    ds_read_b64 v[120:121], v2 offset:40984
    ds_read_b64 v[122:123], v2 offset:40968

    s_waitcnt lgkmcnt(3)
    v_lshrrev_b32 v116, 16, v111
    ds_read_b32 v116, v116 offset:8192

    s_waitcnt lgkmcnt(1)
    v_lshrrev_b32 v124, 16, v119
    ds_read_b32 v124, v124 offset:8192

    v_cmp_ne_u32_sdwa s[80:81], v111, v113 src0_sel:WORD_1 src1_sel:WORD_1
    v_cmp_ne_u32_sdwa vcc, v111, v115 src0_sel:WORD_1 src1_sel:WORD_1
    v_alignbyte_b32 v114, v115, v114, 2
    s_mov_b32 s54, 10237
    v_alignbyte_b32 v111, v111, v110, 1
    v_perm_b32 v110, v110, v114, s47
    s_waitcnt lgkmcnt(1)
    v_add3_u32 v116, v116, v106, s54
    v_sub_u32 v117, 0, v116
    v_and_b32 v117, 3, v117
    s_mov_b64 exec, s[80:81]
    v_mov_b32 v117, 0
    v_mov_b32 v112, 0
    s_mov_b64 exec, vcc
    v_mov_b32 v117, 3

    s_mov_b64 exec, -1
    v_alignbyte_b32 v110, v111, v110, v117
    v_alignbyte_b32 v111, v112, v111, v117
    v_add_u32 v116, v116, v117

    buffer_store_dwordx2 v[110:111], v116, s[24:27], 0 offen
    v_cmp_ne_u32_sdwa s[80:81], v119, v121 src0_sel:WORD_1 src1_sel:WORD_1
    v_cmp_ne_u32_sdwa vcc, v119, v123 src0_sel:WORD_1 src1_sel:WORD_1
    v_alignbyte_b32 v122, v123, v122, 2
    s_mov_b32 s54, 15357
    v_alignbyte_b32 v119, v119, v118, 1
    v_perm_b32 v118, v118, v122, s47
    s_waitcnt lgkmcnt(0)
    v_add3_u32 v124, v124, v106, s54
    v_sub_u32 v125, 0, v124
    v_and_b32 v125, 3, v125
    s_mov_b64 exec, s[80:81]
    v_mov_b32 v125, 0
    v_mov_b32 v120, 0
    s_mov_b64 exec, vcc
    v_mov_b32 v125, 3

    s_mov_b64 exec, -1
    v_alignbyte_b32 v118, v119, v118, v125
    v_alignbyte_b32 v119, v120, v119, v125
    v_add_u32 v124, v124, v125

    buffer_store_dwordx2 v[118:119], v124, s[24:27], 0 offen
L_skw_29:
    s_bitcmp0_b32 s28, 1
    s_cbranch_scc1 L_skw_30
    v_add_u32 v107, 32768, v2
    ds_read_b64 v[110:111], v107 offset:16400
    ds_read_b64 v[112:113], v107 offset:16408
    ds_read_b64 v[114:115], v107 offset:16392

    ds_read_b64 v[118:119], v107 offset:24592
    ds_read_b64 v[120:121], v107 offset:24600
    ds_read_b64 v[122:123], v107 offset:24584

    s_waitcnt lgkmcnt(3)
    v_lshrrev_b32 v116, 16, v111
    ds_read_b32 v116, v116 offset:8192

    s_waitcnt lgkmcnt(1)
    v_lshrrev_b32 v124, 16, v119
    ds_read_b32 v124, v124 offset:8192

    v_cmp_ne_u32_sdwa s[80:81], v111, v113 src0_sel:WORD_1 src1_sel:WORD_1
    v_cmp_ne_u32_sdwa vcc, v111, v115 src0_sel:WORD_1 src1_sel:WORD_1
    v_alignbyte_b32 v114, v115, v114, 2
    s_mov_b32 s54, 20477
    v_alignbyte_b32 v111, v111, v110, 1
    v_perm_b32 v110, v110, v114, s47
    s_waitcnt lgkmcnt(1)
    v_add3_u32 v116, v116, v106, s54
    v_sub_u32 v117, 0, v116
    v_and_b32 v117, 3, v117
    s_mov_b64 exec, s[80:81]
    v_mov_b32 v117, 0
    v_mov_b32 v112, 0
    s_mov_b64 exec, vcc
    v_mov_b32 v117, 3

    s_mov_b64 exec, -1
    v_alignbyte_b32 v110, v111, v110, v117
    v_alignbyte_b32 v111, v112, v111, v117
    v_add_u32 v116, v116, v117

    buffer_store_dwordx2 v[110:111], v116, s[24:27], 0 offen
    v_cmp_ne_u32_sdwa s[80:81], v119, v121 src0_sel:WORD_1 src1_sel:WORD_1
    v_cmp_ne_u32_sdwa vcc, v119, v123 src0_sel:WORD_1 src1_sel:WORD_1
    v_alignbyte_b32 v122, v123, v122, 2
    s_mov_b32 s54, 25597
    v_alignbyte_b32 v119, v119, v118, 1
    v_perm_b32 v118, v118, v122, s47
    s_waitcnt lgkmcnt(0)
    v_add3_u32 v124, v124, v106, s54
    v_sub_u32 v125, 0, v124
    v_and_b32 v125, 3, v125
    s_mov_b64 exec, s[80:81]
    v_mov_b32 v125, 0
    v_mov_b32 v120, 0
    s_mov_b64 exec, vcc
    v_mov_b32 v125, 3

    s_mov_b64 exec, -1
    v_alignbyte_b32 v118, v119, v118, v125
    v_alignbyte_b32 v119, v120, v119, v125
    v_add_u32 v124, v124, v125

    buffer_store_dwordx2 v[118:119], v124, s[24:27], 0 offen
L_skw_30:
    s_bitcmp0_b32 s28, 1
    s_cbranch_scc1 L_skw_31
    v_add_u32 v107, 32768, v2
    ds_read_b64 v[110:111], v107 offset:32784
    ds_read_b64 v[112:113], v107 offset:32792
    ds_read_b64 v[114:115], v107 offset:32776

    ds_read_b64 v[118:119], v107 offset:40976
    ds_read_b64 v[120:121], v107 offset:40984
    ds_read_b64 v[122:123], v107 offset:40968

    s_waitcnt lgkmcnt(3)
    v_lshrrev_b32 v116, 16, v111
    ds_read_b32 v116, v116 offset:8192

    s_waitcnt lgkmcnt(1)
    v_lshrrev_b32 v124, 16, v119
    ds_read_b32 v124, v124 offset:8192

    v_cmp_ne_u32_sdwa s[80:81], v111, v113 src0_sel:WORD_1 src1_sel:WORD_1
    v_cmp_ne_u32_sdwa vcc, v111, v115 src0_sel:WORD_1 src1_sel:WORD_1
    v_alignbyte_b32 v114, v115, v114, 2
    s_mov_b32 s54, 30717
    v_alignbyte_b32 v111, v111, v110, 1
    v_perm_b32 v110, v110, v114, s47
    s_waitcnt lgkmcnt(1)
    v_add3_u32 v116, v116, v106, s54
    v_sub_u32 v117, 0, v116
    v_and_b32 v117, 3, v117
    s_mov_b64 exec, s[80:81]
    v_mov_b32 v117, 0
    v_mov_b32 v112, 0
    s_mov_b64 exec, vcc
    v_mov_b32 v117, 3

    s_mov_b64 exec, -1
    v_alignbyte_b32 v110, v111, v110, v117
    v_alignbyte_b32 v111, v112, v111, v117
    v_add_u32 v116, v116, v117

    buffer_store_dwordx2 v[110:111], v116, s[24:27], 0 offen
    v_cmp_ne_u32_sdwa s[80:81], v119, v121 src0_sel:WORD_1 src1_sel:WORD_1
    v_cmp_ne_u32_sdwa vcc, v119, v123 src0_sel:WORD_1 src1_sel:WORD_1
    v_alignbyte_b32 v122, v123, v122, 2
    s_mov_b32 s54, 35837
    v_alignbyte_b32 v119, v119, v118, 1
    v_perm_b32 v118, v118, v122, s47
    s_waitcnt lgkmcnt(0)
    v_add3_u32 v124, v124, v106, s54
    v_sub_u32 v125, 0, v124
    v_and_b32 v125, 3, v125
    s_mov_b64 exec, s[80:81]
    v_mov_b32 v125, 0
    v_mov_b32 v120, 0
    s_mov_b64 exec, vcc
    v_mov_b32 v125, 3

    s_mov_b64 exec, -1
    v_alignbyte_b32 v118, v119, v118, v125
    v_alignbyte_b32 v119, v120, v119, v125
    v_add_u32 v124, v124, v125

    buffer_store_dwordx2 v[118:119], v124, s[24:27], 0 offen
L_skw_31:
    s_mov_b64 exec, s[66:67]
    v_mul_hi_u32_u24 v69, s40, v32
    v_mul_hi_u32_u24 v68, s40, v16
    v_mul_hi_u32_u24 v71, s40, v33
    v_mul_hi_u32_u24 v70, s40, v17
    v_mul_hi_u32_u24 v73, s40, v34
    v_mul_hi_u32_u24 v72, s40, v18
    v_mul_hi_u32_u24 v75, s40, v35
    v_mul_hi_u32_u24 v74, s40, v19
    v_and_b32 v69, -2, v69
    v_mad_u32_u24 v16, v68, s43, v16
    v_and_b32 v88, -4, v68
    v_and_b32 v71, -2, v71
    v_mad_u32_u24 v17, v70, s43, v17
    v_and_b32 v89, -4, v70
    v_and_b32 v73, -2, v73
    v_mad_u32_u24 v18, v72, s43, v18
    v_and_b32 v90, -4, v72
    v_and_b32 v75, -2, v75
    v_mad_u32_u24 v19, v74, s43, v19
    v_and_b32 v91, -4, v74
    v_mad_i32_i24 v32, v69, s42, v32
    v_lshl_add_u32 v69, v88, 5, v69
    v_mad_i32_i24 v33, v71, s42, v33
    v_lshl_add_u32 v71, v89, 5, v71
    v_mad_i32_i24 v34, v73, s42, v34
    v_lshl_add_u32 v73, v90, 5, v73
    v_mad_i32_i24 v35, v75, s42, v35
    v_lshl_add_u32 v75, v91, 5, v75
    v_add_u32 v69, v69, v69
    ds_add_rtn_u32 v88, v69, v104
    v_add_u32 v71, v71, v71
    ds_add_rtn_u32 v89, v71, v104
    v_add_u32 v73, v73, v73
    ds_add_rtn_u32 v90, v73, v104
    v_add_u32 v75, v75, v75
    ds_add_rtn_u32 v91, v75, v104
    v_lshlrev_b32 v110, 16, v42
    v_and_b32 v111, 0xffff0000, v42
    v_lshlrev_b32 v112, 16, v43
    v_and_b32 v113, 0xffff0000, v43
    v_mul_f32 v110, s44, v110
    v_mul_f32 v111, s44, v111
    v_mul_f32 v112, s44, v112
    v_mul_f32 v113, s44, v113
    v_fract_f32 v110, v110
    v_fract_f32 v111, v111
    v_fract_f32 v112, v112
    v_fract_f32 v113, v113
    v_cos_f32 v110, v110
    v_cos_f32 v111, v111
    v_cos_f32 v112, v112
    v_cos_f32 v113, v113
    v_lshl_or_b32 v68, v68, 14, v32
    v_perm_b32 v69, v69, v16, s46
    v_bfe_u32 v16, v16, 8, 5

    v_lshl_or_b32 v70, v70, 14, v33
    v_perm_b32 v71, v71, v17, s46
    v_bfe_u32 v17, v17, 8, 5

    v_lshl_or_b32 v72, v72, 14, v34
    v_perm_b32 v73, v73, v18, s46
    v_bfe_u32 v18, v18, 8, 5

    v_lshl_or_b32 v74, v74, 14, v35
    v_perm_b32 v75, v75, v19, s46
    v_bfe_u32 v19, v19, 8, 5

    v_fmaak_f32 v110, v110, v105, 0x4b400010
    v_fmaak_f32 v111, v111, v105, 0x4b400010
    v_fmaak_f32 v112, v112, v105, 0x4b400010
    v_fmaak_f32 v113, v113, v105, 0x4b400010
    v_sub_u32 v110, v110, v16
    v_sub_u32 v111, v111, v17
    v_sub_u32 v112, v112, v18
    v_sub_u32 v113, v113, v19
    v_bfi_b32 v110, 31, v16, v110
    v_bfi_b32 v111, 31, v17, v111
    v_bfi_b32 v112, 31, v18, v112
    v_bfi_b32 v113, 31, v19, v113
    v_perm_b32 v68, v68, v110, s55
    v_perm_b32 v70, v70, v111, s55
    v_perm_b32 v72, v72, v112, s55
    v_perm_b32 v74, v74, v113, s55
    s_mov_b64 exec, -1
    s_bitcmp0_b32 s28, 2
    s_cbranch_scc1 L_skw_33
    v_add_u32 v107, 65536, v2
    ds_read_b64 v[110:111], v107 offset:16400
    ds_read_b64 v[112:113], v107 offset:16408
    ds_read_b64 v[114:115], v107 offset:16392

    ds_read_b64 v[118:119], v107 offset:24592
    ds_read_b64 v[120:121], v107 offset:24600
    ds_read_b64 v[122:123], v107 offset:24584

    s_waitcnt lgkmcnt(3)
    v_lshrrev_b32 v116, 16, v111
    ds_read_b32 v116, v116 offset:8192

    s_waitcnt lgkmcnt(1)
    v_lshrrev_b32 v124, 16, v119
    ds_read_b32 v124, v124 offset:8192

    v_cmp_ne_u32_sdwa s[80:81], v111, v113 src0_sel:WORD_1 src1_sel:WORD_1
    v_cmp_ne_u32_sdwa vcc, v111, v115 src0_sel:WORD_1 src1_sel:WORD_1
    v_alignbyte_b32 v114, v115, v114, 2
    s_mov_b32 s54, 40957
    v_alignbyte_b32 v111, v111, v110, 1
    v_perm_b32 v110, v110, v114, s47
    s_waitcnt lgkmcnt(1)
    v_add3_u32 v116, v116, v106, s54
    v_sub_u32 v117, 0, v116
    v_and_b32 v117, 3, v117
    s_mov_b64 exec, s[80:81]
    v_mov_b32 v117, 0
    v_mov_b32 v112, 0
    s_mov_b64 exec, vcc
    v_mov_b32 v117, 3

    s_mov_b64 exec, -1
    v_alignbyte_b32 v110, v111, v110, v117
    v_alignbyte_b32 v111, v112, v111, v117
    v_add_u32 v116, v116, v117

    buffer_store_dwordx2 v[110:111], v116, s[24:27], 0 offen
    v_cmp_ne_u32_sdwa s[80:81], v119, v121 src0_sel:WORD_1 src1_sel:WORD_1
    v_cmp_ne_u32_sdwa vcc, v119, v123 src0_sel:WORD_1 src1_sel:WORD_1
    v_alignbyte_b32 v122, v123, v122, 2
    s_mov_b32 s54, 46077
    v_alignbyte_b32 v119, v119, v118, 1
    v_perm_b32 v118, v118, v122, s47
    s_waitcnt lgkmcnt(0)
    v_add3_u32 v124, v124, v106, s54
    v_sub_u32 v125, 0, v124
    v_and_b32 v125, 3, v125
    s_mov_b64 exec, s[80:81]
    v_mov_b32 v125, 0
    v_mov_b32 v120, 0
    s_mov_b64 exec, vcc
    v_mov_b32 v125, 3

    s_mov_b64 exec, -1
    v_alignbyte_b32 v118, v119, v118, v125
    v_alignbyte_b32 v119, v120, v119, v125
    v_add_u32 v124, v124, v125

    buffer_store_dwordx2 v[118:119], v124, s[24:27], 0 offen
L_skw_33:
    s_bitcmp0_b32 s28, 2
    s_cbranch_scc1 L_skw_34
    v_add_u32 v107, 65536, v2
    ds_read_b64 v[110:111], v107 offset:32784
    ds_read_b64 v[112:113], v107 offset:32792
    ds_read_b64 v[114:115], v107 offset:32776

    ds_read_b64 v[118:119], v107 offset:40976
    ds_read_b64 v[120:121], v107 offset:40984
    ds_read_b64 v[122:123], v107 offset:40968

    s_waitcnt lgkmcnt(3)
    v_lshrrev_b32 v116, 16, v111
    ds_read_b32 v116, v116 offset:8192

    s_waitcnt lgkmcnt(1)
    v_lshrrev_b32 v124, 16, v119
    ds_read_b32 v124, v124 offset:8192

    v_cmp_ne_u32_sdwa s[80:81], v111, v113 src0_sel:WORD_1 src1_sel:WORD_1
    v_cmp_ne_u32_sdwa vcc, v111, v115 src0_sel:WORD_1 src1_sel:WORD_1
    v_alignbyte_b32 v114, v115, v114, 2
    s_mov_b32 s54, 51197
    v_alignbyte_b32 v111, v111, v110, 1
    v_perm_b32 v110, v110, v114, s47
    s_waitcnt lgkmcnt(1)
    v_add3_u32 v116, v116, v106, s54
    v_sub_u32 v117, 0, v116
    v_and_b32 v117, 3, v117
    s_mov_b64 exec, s[80:81]
    v_mov_b32 v117, 0
    v_mov_b32 v112, 0
    s_mov_b64 exec, vcc
    v_mov_b32 v117, 3

    s_mov_b64 exec, -1
    v_alignbyte_b32 v110, v111, v110, v117
    v_alignbyte_b32 v111, v112, v111, v117
    v_add_u32 v116, v116, v117

    buffer_store_dwordx2 v[110:111], v116, s[24:27], 0 offen
    v_cmp_ne_u32_sdwa s[80:81], v119, v121 src0_sel:WORD_1 src1_sel:WORD_1
    v_cmp_ne_u32_sdwa vcc, v119, v123 src0_sel:WORD_1 src1_sel:WORD_1
    v_alignbyte_b32 v122, v123, v122, 2
    s_mov_b32 s54, 56317
    v_alignbyte_b32 v119, v119, v118, 1
    v_perm_b32 v118, v118, v122, s47
    s_waitcnt lgkmcnt(0)
    v_add3_u32 v124, v124, v106, s54
    v_sub_u32 v125, 0, v124
    v_and_b32 v125, 3, v125
    s_mov_b64 exec, s[80:81]
    v_mov_b32 v125, 0
    v_mov_b32 v120, 0
    s_mov_b64 exec, vcc
    v_mov_b32 v125, 3

    s_mov_b64 exec, -1
    v_alignbyte_b32 v118, v119, v118, v125
    v_alignbyte_b32 v119, v120, v119, v125
    v_add_u32 v124, v124, v125

    buffer_store_dwordx2 v[118:119], v124, s[24:27], 0 offen
L_skw_34:
    s_bitcmp0_b32 s28, 3
    s_cbranch_scc1 L_skw_35
    v_add_u32 v107, 98304, v2
    ds_read_b64 v[110:111], v107 offset:16400
    ds_read_b64 v[112:113], v107 offset:16408
    ds_read_b64 v[114:115], v107 offset:16392

    ds_read_b64 v[118:119], v107 offset:24592
    ds_read_b64 v[120:121], v107 offset:24600
    ds_read_b64 v[122:123], v107 offset:24584

    s_waitcnt lgkmcnt(3)
    v_lshrrev_b32 v116, 16, v111
    ds_read_b32 v116, v116 offset:8192

    s_waitcnt lgkmcnt(1)
    v_lshrrev_b32 v124, 16, v119
    ds_read_b32 v124, v124 offset:8192

    v_cmp_ne_u32_sdwa s[80:81], v111, v113 src0_sel:WORD_1 src1_sel:WORD_1
    v_cmp_ne_u32_sdwa vcc, v111, v115 src0_sel:WORD_1 src1_sel:WORD_1
    v_alignbyte_b32 v114, v115, v114, 2
    s_mov_b32 s54, 61437
    v_alignbyte_b32 v111, v111, v110, 1
    v_perm_b32 v110, v110, v114, s47
    s_waitcnt lgkmcnt(1)
    v_add3_u32 v116, v116, v106, s54
    v_sub_u32 v117, 0, v116
    v_and_b32 v117, 3, v117
    s_mov_b64 exec, s[80:81]
    v_mov_b32 v117, 0
    v_mov_b32 v112, 0
    s_mov_b64 exec, vcc
    v_mov_b32 v117, 3

    s_mov_b64 exec, -1
    v_alignbyte_b32 v110, v111, v110, v117
    v_alignbyte_b32 v111, v112, v111, v117
    v_add_u32 v116, v116, v117

    buffer_store_dwordx2 v[110:111], v116, s[24:27], 0 offen
    v_cmp_ne_u32_sdwa s[80:81], v119, v121 src0_sel:WORD_1 src1_sel:WORD_1
    v_cmp_ne_u32_sdwa vcc, v119, v123 src0_sel:WORD_1 src1_sel:WORD_1
    v_alignbyte_b32 v122, v123, v122, 2
    s_mov_b32 s54, 66557
    v_alignbyte_b32 v119, v119, v118, 1
    v_perm_b32 v118, v118, v122, s47
    s_waitcnt lgkmcnt(0)
    v_add3_u32 v124, v124, v106, s54
    v_sub_u32 v125, 0, v124
    v_and_b32 v125, 3, v125
    s_mov_b64 exec, s[80:81]
    v_mov_b32 v125, 0
    v_mov_b32 v120, 0
    s_mov_b64 exec, vcc
    v_mov_b32 v125, 3

    s_mov_b64 exec, -1
    v_alignbyte_b32 v118, v119, v118, v125
    v_alignbyte_b32 v119, v120, v119, v125
    v_add_u32 v124, v124, v125

    buffer_store_dwordx2 v[118:119], v124, s[24:27], 0 offen
L_skw_35:
    s_bitcmp0_b32 s28, 3
    s_cbranch_scc1 L_skw_36
    v_add_u32 v107, 98304, v2
    ds_read_b64 v[110:111], v107 offset:32784
    ds_read_b64 v[112:113], v107 offset:32792
    ds_read_b64 v[114:115], v107 offset:32776

    ds_read_b64 v[118:119], v107 offset:40976
    ds_read_b64 v[120:121], v107 offset:40984
    ds_read_b64 v[122:123], v107 offset:40968

    s_waitcnt lgkmcnt(3)
    v_lshrrev_b32 v116, 16, v111
    ds_read_b32 v116, v116 offset:8192

    s_waitcnt lgkmcnt(1)
    v_lshrrev_b32 v124, 16, v119
    ds_read_b32 v124, v124 offset:8192

    v_cmp_ne_u32_sdwa s[80:81], v111, v113 src0_sel:WORD_1 src1_sel:WORD_1
    v_cmp_ne_u32_sdwa vcc, v111, v115 src0_sel:WORD_1 src1_sel:WORD_1
    v_alignbyte_b32 v114, v115, v114, 2
    s_mov_b32 s54, 71677
    v_alignbyte_b32 v111, v111, v110, 1
    v_perm_b32 v110, v110, v114, s47
    s_waitcnt lgkmcnt(1)
    v_add3_u32 v116, v116, v106, s54
    v_sub_u32 v117, 0, v116
    v_and_b32 v117, 3, v117
    s_mov_b64 exec, s[80:81]
    v_mov_b32 v117, 0
    v_mov_b32 v112, 0
    s_mov_b64 exec, vcc
    v_mov_b32 v117, 3

    s_mov_b64 exec, -1
    v_alignbyte_b32 v110, v111, v110, v117
    v_alignbyte_b32 v111, v112, v111, v117
    v_add_u32 v116, v116, v117

    buffer_store_dwordx2 v[110:111], v116, s[24:27], 0 offen
    v_cmp_ne_u32_sdwa s[80:81], v119, v121 src0_sel:WORD_1 src1_sel:WORD_1
    v_cmp_ne_u32_sdwa vcc, v119, v123 src0_sel:WORD_1 src1_sel:WORD_1
    v_alignbyte_b32 v122, v123, v122, 2
    s_mov_b32 s54, 76797
    v_alignbyte_b32 v119, v119, v118, 1
    v_perm_b32 v118, v118, v122, s47
    s_waitcnt lgkmcnt(0)
    v_add3_u32 v124, v124, v106, s54
    v_sub_u32 v125, 0, v124
    v_and_b32 v125, 3, v125
    s_mov_b64 exec, s[80:81]
    v_mov_b32 v125, 0
    v_mov_b32 v120, 0
    s_mov_b64 exec, vcc
    v_mov_b32 v125, 3

    s_andn2_b64 exec, -1, s[68:69]
    v_bfrev_b32 v124, 1
    s_mov_b64 exec, -1
    v_alignbyte_b32 v118, v119, v118, v125
    v_alignbyte_b32 v119, v120, v119, v125
    v_add_u32 v124, v124, v125

    buffer_store_dwordx2 v[118:119], v124, s[24:27], 0 offen
L_skw_36:
    s_mov_b32 s28, 15
    s_mov_b32 s29, 0
    s_movk_i32 s30, 16000

    v_cmp_eq_u32 vcc, 0, v0
    s_mov_b64 exec, vcc
    ds_write_b32 v108, v99 offset:8
    s_mov_b64 exec, -1
    s_waitcnt lgkmcnt(0)
    s_barrier

    ds_read2_b32 v[110:111], v108 offset0:1 offset1:2
    ds_read_b64 v[94:95], v2
    s_waitcnt lgkmcnt(0)
    v_readfirstlane_b32 s53, v110
    v_readfirstlane_b32 s41, v111

    v_and_b32 v94, 0xffff, v94
    v_and_b32 v95, 0xffff, v95
    v_add_u32 v97, v94, v95
    s_nop 1
    v_add_u32_dpp v97, v97, v97 row_shr:1 row_mask:0xf bank_mask:0xf
    s_nop 1
    v_add_u32_dpp v97, v97, v97 row_shr:2 row_mask:0xf bank_mask:0xf
    s_nop 1
    v_add_u32_dpp v97, v97, v97 row_shr:4 row_mask:0xf bank_mask:0xf
    s_nop 1
    v_add_u32_dpp v97, v97, v97 row_shr:8 row_mask:0xf bank_mask:0xf
    s_nop 1
    v_add_u32_dpp v97, v97, v97 row_bcast:15 row_mask:0xa bank_mask:0xf
    s_nop 1
    v_add_u32_dpp v97, v97, v97 row_bcast:31 row_mask:0xc bank_mask:0xf
    s_mov_b32 exec_lo, 0
    s_brev_b32 exec_hi, 1
    ds_add_rtn_u32 v96, v108, v97
    s_mov_b64 exec, -1

    v_add_u32 v92, v94, v94
    v_add_u32 v93, v95, v95
    v_med3_u32 v92, v94, 2, v92
    v_med3_u32 v93, v95, 2, v93
    buffer_atomic_add_x2 v[92:93], v2, s[20:23], 0 offen sc0
    s_add_u32 s41, s41, 160
    s_mul_i32 s78, s41, 16000
    s_add_u32 s49, s78, 16000
    s_cmp_ge_u32 s41, 3200
    s_cmovk_i32 s49, 0
    s_cmovk_i32 s78, 0
    s_lshl_b32 s10, s49, 2
    s_lshl_b32 s14, s49, 2
    s_lshl_b32 s18, s49, 1
    s_lshl_b32 s56, s78, 2
    s_lshl_b32 s61, s78, 1

    s_add_u32 s57, s56, 16384
    s_add_u32 s62, s61, 8192
    s_add_u32 s58, s56, 32768
    s_add_u32 s63, s61, 16384
    s_add_u32 s59, s56, 49152
    s_add_u32 s64, s61, 24576
    s_waitcnt lgkmcnt(0)
    v_readlane_b32 s77, v96, 63
    v_mul_u32_u24 v114, 7936, v0
    v_sub_u32 v97, v97, v95
    s_sub_u32 s77, s77, s50
    v_add_u32 v97, s77, v97
    v_sub_u32 v96, v97, v94
    v_lshlrev_b32 v111, 16, v97
    v_lshlrev_b32 v110, 16, v96
    ds_write_b64 v2, v[110:111]
    v_sub_u32 v96, v114, v96
    v_sub_u32 v97, v114, v97
    v_add_u32 v97, s48, v97
    s_add_u32 s50, s50, s30

    s_waitcnt lgkmcnt(0)
    s_barrier

    buffer_load_dwordx4 v[20:23], v1, s[12:15], s56 offen nt
    buffer_load_dwordx4 v[4:7], v1, s[8:11], s56 offen nt
    buffer_load_dwordx2 v[36:37], v2, s[16:19], s61 offen nt
    buffer_load_dwordx4 v[24:27], v1, s[12:15], s57 offen nt
    buffer_load_dwordx4 v[8:11], v1, s[8:11], s57 offen nt
    buffer_load_dwordx2 v[38:39], v2, s[16:19], s62 offen nt
    buffer_load_dwordx4 v[28:31], v1, s[12:15], s58 offen nt
    buffer_load_dwordx4 v[12:15], v1, s[8:11], s58 offen nt
    buffer_load_dwordx2 v[40:41], v2, s[16:19], s63 offen nt
    buffer_load_dwordx4 v[32:35], v1, s[12:15], s59 offen nt
    buffer_load_dwordx4 v[16:19], v1, s[8:11], s59 offen nt
    buffer_load_dwordx2 v[42:43], v2, s[16:19], s64 offen nt
    v_lshrrev_b32 v110, 16, v45
    ds_read_b32 v110, v110
    v_lshrrev_b32 v111, 16, v47
    ds_read_b32 v111, v111
    v_lshrrev_b32 v112, 16, v49
    ds_read_b32 v112, v112
    v_lshrrev_b32 v113, 16, v51
    ds_read_b32 v113, v113
    v_lshrrev_b32 v114, 16, v53
    ds_read_b32 v114, v114
    v_lshrrev_b32 v115, 16, v55
    ds_read_b32 v115, v115
    v_lshrrev_b32 v116, 16, v57
    ds_read_b32 v116, v116
    v_lshrrev_b32 v117, 16, v59
    ds_read_b32 v117, v117
    s_waitcnt lgkmcnt(7)
    v_add_u32_sdwa v110, v110, v76 dst_sel:DWORD dst_unused:UNUSED_PAD src0_sel:WORD_1 src1_sel:WORD_0
    v_lshlrev_b32 v110, 3, v110
    ds_write_b64 v110, v[44:45] offset:16400

    s_waitcnt lgkmcnt(7)
    v_add_u32_sdwa v111, v111, v77 dst_sel:DWORD dst_unused:UNUSED_PAD src0_sel:WORD_1 src1_sel:WORD_0
    v_lshlrev_b32 v111, 3, v111
    ds_write_b64 v111, v[46:47] offset:16400

    s_waitcnt lgkmcnt(7)
    v_add_u32_sdwa v112, v112, v78 dst_sel:DWORD dst_unused:UNUSED_PAD src0_sel:WORD_1 src1_sel:WORD_0
    v_lshlrev_b32 v112, 3, v112
    ds_write_b64 v112, v[48:49] offset:16400

    s_waitcnt lgkmcnt(7)
    v_add_u32_sdwa v113, v113, v79 dst_sel:DWORD dst_unused:UNUSED_PAD src0_sel:WORD_1 src1_sel:WORD_0
    v_lshlrev_b32 v113, 3, v113
    ds_write_b64 v113, v[50:51] offset:16400

    s_waitcnt lgkmcnt(7)
    v_add_u32_sdwa v114, v114, v80 dst_sel:DWORD dst_unused:UNUSED_PAD src0_sel:WORD_1 src1_sel:WORD_0
    v_lshlrev_b32 v114, 3, v114
    ds_write_b64 v114, v[52:53] offset:16400

    s_waitcnt lgkmcnt(7)
    v_add_u32_sdwa v115, v115, v81 dst_sel:DWORD dst_unused:UNUSED_PAD src0_sel:WORD_1 src1_sel:WORD_0
    v_lshlrev_b32 v115, 3, v115
    ds_write_b64 v115, v[54:55] offset:16400

    s_waitcnt lgkmcnt(7)
    v_add_u32_sdwa v116, v116, v82 dst_sel:DWORD dst_unused:UNUSED_PAD src0_sel:WORD_1 src1_sel:WORD_0
    v_lshlrev_b32 v116, 3, v116
    ds_write_b64 v116, v[56:57] offset:16400

    s_waitcnt lgkmcnt(7)
    v_add_u32_sdwa v117, v117, v83 dst_sel:DWORD dst_unused:UNUSED_PAD src0_sel:WORD_1 src1_sel:WORD_0
    v_lshlrev_b32 v117, 3, v117
    ds_write_b64 v117, v[58:59] offset:16400

    v_lshrrev_b32 v110, 16, v61
    ds_read_b32 v110, v110
    v_lshrrev_b32 v111, 16, v63
    ds_read_b32 v111, v111
    v_lshrrev_b32 v112, 16, v65
    ds_read_b32 v112, v112
    v_lshrrev_b32 v113, 16, v67
    ds_read_b32 v113, v113
    s_waitcnt lgkmcnt(3)
    v_add_u32_sdwa v110, v110, v84 dst_sel:DWORD dst_unused:UNUSED_PAD src0_sel:WORD_1 src1_sel:WORD_0
    v_lshlrev_b32 v110, 3, v110
    ds_write_b64 v110, v[60:61] offset:16400

    s_waitcnt lgkmcnt(3)
    v_add_u32_sdwa v111, v111, v85 dst_sel:DWORD dst_unused:UNUSED_PAD src0_sel:WORD_1 src1_sel:WORD_0
    v_lshlrev_b32 v111, 3, v111
    ds_write_b64 v111, v[62:63] offset:16400

    s_waitcnt lgkmcnt(3)
    v_add_u32_sdwa v112, v112, v86 dst_sel:DWORD dst_unused:UNUSED_PAD src0_sel:WORD_1 src1_sel:WORD_0
    v_lshlrev_b32 v112, 3, v112
    ds_write_b64 v112, v[64:65] offset:16400

    s_waitcnt lgkmcnt(3)
    v_add_u32_sdwa v113, v113, v87 dst_sel:DWORD dst_unused:UNUSED_PAD src0_sel:WORD_1 src1_sel:WORD_0
    v_lshlrev_b32 v113, 3, v113
    ds_write_b64 v113, v[66:67] offset:16400

    s_mov_b64 exec, s[66:67]
    v_lshrrev_b32 v110, 16, v69
    ds_read_b32 v110, v110
    v_lshrrev_b32 v111, 16, v71
    ds_read_b32 v111, v111
    v_lshrrev_b32 v112, 16, v73
    ds_read_b32 v112, v112
    v_lshrrev_b32 v113, 16, v75
    ds_read_b32 v113, v113
    s_waitcnt lgkmcnt(3)
    v_add_u32_sdwa v110, v110, v88 dst_sel:DWORD dst_unused:UNUSED_PAD src0_sel:WORD_1 src1_sel:WORD_0
    v_lshlrev_b32 v110, 3, v110
    ds_write_b64 v110, v[68:69] offset:16400

    s_waitcnt lgkmcnt(3)
    v_add_u32_sdwa v111, v111, v89 dst_sel:DWORD dst_unused:UNUSED_PAD src0_sel:WORD_1 src1_sel:WORD_0
    v_lshlrev_b32 v111, 3, v111
    ds_write_b64 v111, v[70:71] offset:16400

    s_waitcnt lgkmcnt(3)
    v_add_u32_sdwa v112, v112, v90 dst_sel:DWORD dst_unused:UNUSED_PAD src0_sel:WORD_1 src1_sel:WORD_0
    v_lshlrev_b32 v112, 3, v112
    ds_write_b64 v112, v[72:73] offset:16400

    s_waitcnt lgkmcnt(3)
    v_add_u32_sdwa v113, v113, v91 dst_sel:DWORD dst_unused:UNUSED_PAD src0_sel:WORD_1 src1_sel:WORD_0
    v_lshlrev_b32 v113, 3, v113
    ds_write_b64 v113, v[74:75] offset:16400

    s_mov_b64 exec, -1
    s_cmp_lg_u32 s49, 0
    s_cbranch_scc1 L_p1loop_5
L_p1epi_6:
    s_waitcnt vmcnt(0)
    s_waitcnt vmcnt(12)
    v_add_u32 v110, v92, v94
    v_min_u32 v92, s48, v92
    v_add_u32 v111, v93, v95
    v_min_u32 v93, s48, v93
    v_max_u32 v110, v110, v111
    v_add_u32 v92, v92, v96
    v_add_u32 v93, v93, v97
    v_cmp_le_u32 vcc, s48, v110
    v_lshl_add_u32 v92, v92, 2, v92
    v_lshl_add_u32 v93, v93, 2, v93
    ds_write_b64 v2, v[92:93] offset:8192
    s_cbranch_vccz L_noov_40
    ds_write_b32 v108, v104 offset:4
L_noov_40:

    s_waitcnt lgkmcnt(0)
    s_barrier
    ds_read_b32 v110, v108 offset:4
    s_waitcnt lgkmcnt(0)
    v_readfirstlane_b32 s53, v110
    s_nop 1

    s_cmp_lg_u32 s53, 0
    s_cbranch_scc1 L_slow_41
L_sback_42:
    s_bitcmp0_b32 s28, 0
    s_cbranch_scc1 L_skw_46
    ds_read_b64 v[4:5], v2 offset:16400
    ds_read_b64 v[6:7], v2 offset:16408
    ds_read_b64 v[8:9], v2 offset:16392

    ds_read_b64 v[12:13], v2 offset:24592
    ds_read_b64 v[14:15], v2 offset:24600
    ds_read_b64 v[16:17], v2 offset:24584

    ds_read_b64 v[20:21], v2 offset:32784
    ds_read_b64 v[22:23], v2 offset:32792
    ds_read_b64 v[24:25], v2 offset:32776

    ds_read_b64 v[28:29], v2 offset:40976
    ds_read_b64 v[30:31], v2 offset:40984
    ds_read_b64 v[32:33], v2 offset:40968

    s_waitcnt lgkmcnt(9)
    v_lshrrev_b32 v10, 16, v5
    ds_read_b32 v10, v10 offset:8192

    s_waitcnt lgkmcnt(7)
    v_lshrrev_b32 v18, 16, v13
    ds_read_b32 v18, v18 offset:8192

    s_waitcnt lgkmcnt(5)
    v_lshrrev_b32 v26, 16, v21
    ds_read_b32 v26, v26 offset:8192

    s_waitcnt lgkmcnt(3)
    v_lshrrev_b32 v34, 16, v29
    ds_read_b32 v34, v34 offset:8192

    v_cmp_ne_u32_sdwa s[80:81], v5, v7 src0_sel:WORD_1 src1_sel:WORD_1
    v_cmp_ne_u32_sdwa vcc, v5, v9 src0_sel:WORD_1 src1_sel:WORD_1
    v_alignbyte_b32 v8, v9, v8, 2
    s_mov_b32 s54, -3
    v_alignbyte_b32 v5, v5, v4, 1
    v_perm_b32 v4, v4, v8, s47
    s_waitcnt lgkmcnt(3)
    v_add3_u32 v10, v10, v106, s54
    v_sub_u32 v11, 0, v10
    v_and_b32 v11, 3, v11
    s_mov_b64 exec, s[80:81]
    v_mov_b32 v11, 0
    v_mov_b32 v6, 0
    s_mov_b64 exec, vcc
    v_mov_b32 v11, 3

    s_mov_b64 exec, -1
    v_alignbyte_b32 v4, v5, v4, v11
    v_alignbyte_b32 v5, v6, v5, v11
    v_add_u32 v10, v10, v11

    buffer_store_dwordx2 v[4:5], v10, s[24:27], 0 offen
    v_cmp_ne_u32_sdwa s[80:81], v13, v15 src0_sel:WORD_1 src1_sel:WORD_1
    v_cmp_ne_u32_sdwa vcc, v13, v17 src0_sel:WORD_1 src1_sel:WORD_1
    v_alignbyte_b32 v16, v17, v16, 2
    s_mov_b32 s54, 5117
    v_alignbyte_b32 v13, v13, v12, 1
    v_perm_b32 v12, v12, v16, s47
    s_waitcnt lgkmcnt(2)
    v_add3_u32 v18, v18, v106, s54
    v_sub_u32 v19, 0, v18
    v_and_b32 v19, 3, v19
    s_mov_b64 exec, s[80:81]
    v_mov_b32 v19, 0
    v_mov_b32 v14, 0
    s_mov_b64 exec, vcc
    v_mov_b32 v19, 3

    s_mov_b64 exec, -1
    v_alignbyte_b32 v12, v13, v12, v19
    v_alignbyte_b32 v13, v14, v13, v19
    v_add_u32 v18, v18, v19

    buffer_store_dwordx2 v[12:13], v18, s[24:27], 0 offen
    v_cmp_ne_u32_sdwa s[80:81], v21, v23 src0_sel:WORD_1 src1_sel:WORD_1
    v_cmp_ne_u32_sdwa vcc, v21, v25 src0_sel:WORD_1 src1_sel:WORD_1
    v_alignbyte_b32 v24, v25, v24, 2
    s_mov_b32 s54, 10237
    v_alignbyte_b32 v21, v21, v20, 1
    v_perm_b32 v20, v20, v24, s47
    s_waitcnt lgkmcnt(1)
    v_add3_u32 v26, v26, v106, s54
    v_sub_u32 v27, 0, v26
    v_and_b32 v27, 3, v27
    s_mov_b64 exec, s[80:81]
    v_mov_b32 v27, 0
    v_mov_b32 v22, 0
    s_mov_b64 exec, vcc
    v_mov_b32 v27, 3

    s_mov_b64 exec, -1
    v_alignbyte_b32 v20, v21, v20, v27
    v_alignbyte_b32 v21, v22, v21, v27
    v_add_u32 v26, v26, v27

    buffer_store_dwordx2 v[20:21], v26, s[24:27], 0 offen
    v_cmp_ne_u32_sdwa s[80:81], v29, v31 src0_sel:WORD_1 src1_sel:WORD_1
    v_cmp_ne_u32_sdwa vcc, v29, v33 src0_sel:WORD_1 src1_sel:WORD_1
    v_alignbyte_b32 v32, v33, v32, 2
    s_mov_b32 s54, 15357
    v_alignbyte_b32 v29, v29, v28, 1
    v_perm_b32 v28, v28, v32, s47
    s_waitcnt lgkmcnt(0)
    v_add3_u32 v34, v34, v106, s54
    v_sub_u32 v35, 0, v34
    v_and_b32 v35, 3, v35
    s_mov_b64 exec, s[80:81]
    v_mov_b32 v35, 0
    v_mov_b32 v30, 0
    s_mov_b64 exec, vcc
    v_mov_b32 v35, 3

    s_mov_b64 exec, -1
    v_alignbyte_b32 v28, v29, v28, v35
    v_alignbyte_b32 v29, v30, v29, v35
    v_add_u32 v34, v34, v35

    buffer_store_dwordx2 v[28:29], v34, s[24:27], 0 offen
L_skw_46:
    s_bitcmp0_b32 s28, 1
    s_cbranch_scc1 L_skw_47
    v_add_u32 v107, 32768, v2
    ds_read_b64 v[4:5], v107 offset:16400
    ds_read_b64 v[6:7], v107 offset:16408
    ds_read_b64 v[8:9], v107 offset:16392

    ds_read_b64 v[12:13], v107 offset:24592
    ds_read_b64 v[14:15], v107 offset:24600
    ds_read_b64 v[16:17], v107 offset:24584

    ds_read_b64 v[20:21], v107 offset:32784
    ds_read_b64 v[22:23], v107 offset:32792
    ds_read_b64 v[24:25], v107 offset:32776

    ds_read_b64 v[28:29], v107 offset:40976
    ds_read_b64 v[30:31], v107 offset:40984
    ds_read_b64 v[32:33], v107 offset:40968

    s_waitcnt lgkmcnt(9)
    v_lshrrev_b32 v10, 16, v5
    ds_read_b32 v10, v10 offset:8192

    s_waitcnt lgkmcnt(7)
    v_lshrrev_b32 v18, 16, v13
    ds_read_b32 v18, v18 offset:8192

    s_waitcnt lgkmcnt(5)
    v_lshrrev_b32 v26, 16, v21
    ds_read_b32 v26, v26 offset:8192

    s_waitcnt lgkmcnt(3)
    v_lshrrev_b32 v34, 16, v29
    ds_read_b32 v34, v34 offset:8192

    v_cmp_ne_u32_sdwa s[80:81], v5, v7 src0_sel:WORD_1 src1_sel:WORD_1
    v_cmp_ne_u32_sdwa vcc, v5, v9 src0_sel:WORD_1 src1_sel:WORD_1
    v_alignbyte_b32 v8, v9, v8, 2
    s_mov_b32 s54, 20477
    v_alignbyte_b32 v5, v5, v4, 1
    v_perm_b32 v4, v4, v8, s47
    s_waitcnt lgkmcnt(3)
    v_add3_u32 v10, v10, v106, s54
    v_sub_u32 v11, 0, v10
    v_and_b32 v11, 3, v11
    s_mov_b64 exec, s[80:81]
    v_mov_b32 v11, 0
    v_mov_b32 v6, 0
    s_mov_b64 exec, vcc
    v_mov_b32 v11, 3

    s_mov_b64 exec, -1
    v_alignbyte_b32 v4, v5, v4, v11
    v_alignbyte_b32 v5, v6, v5, v11
    v_add_u32 v10, v10, v11

    buffer_store_dwordx2 v[4:5], v10, s[24:27], 0 offen
    v_cmp_ne_u32_sdwa s[80:81], v13, v15 src0_sel:WORD_1 src1_sel:WORD_1
    v_cmp_ne_u32_sdwa vcc, v13, v17 src0_sel:WORD_1 src1_sel:WORD_1
    v_alignbyte_b32 v16, v17, v16, 2
    s_mov_b32 s54, 25597
    v_alignbyte_b32 v13, v13, v12, 1
    v_perm_b32 v12, v12, v16, s47
    s_waitcnt lgkmcnt(2)
    v_add3_u32 v18, v18, v106, s54
    v_sub_u32 v19, 0, v18
    v_and_b32 v19, 3, v19
    s_mov_b64 exec, s[80:81]
    v_mov_b32 v19, 0
    v_mov_b32 v14, 0
    s_mov_b64 exec, vcc
    v_mov_b32 v19, 3

    s_mov_b64 exec, -1
    v_alignbyte_b32 v12, v13, v12, v19
    v_alignbyte_b32 v13, v14, v13, v19
    v_add_u32 v18, v18, v19

    buffer_store_dwordx2 v[12:13], v18, s[24:27], 0 offen
    v_cmp_ne_u32_sdwa s[80:81], v21, v23 src0_sel:WORD_1 src1_sel:WORD_1
    v_cmp_ne_u32_sdwa vcc, v21, v25 src0_sel:WORD_1 src1_sel:WORD_1
    v_alignbyte_b32 v24, v25, v24, 2
    s_mov_b32 s54, 30717
    v_alignbyte_b32 v21, v21, v20, 1
    v_perm_b32 v20, v20, v24, s47
    s_waitcnt lgkmcnt(1)
    v_add3_u32 v26, v26, v106, s54
    v_sub_u32 v27, 0, v26
    v_and_b32 v27, 3, v27
    s_mov_b64 exec, s[80:81]
    v_mov_b32 v27, 0
    v_mov_b32 v22, 0
    s_mov_b64 exec, vcc
    v_mov_b32 v27, 3

    s_mov_b64 exec, -1
    v_alignbyte_b32 v20, v21, v20, v27
    v_alignbyte_b32 v21, v22, v21, v27
    v_add_u32 v26, v26, v27

    buffer_store_dwordx2 v[20:21], v26, s[24:27], 0 offen
    v_cmp_ne_u32_sdwa s[80:81], v29, v31 src0_sel:WORD_1 src1_sel:WORD_1
    v_cmp_ne_u32_sdwa vcc, v29, v33 src0_sel:WORD_1 src1_sel:WORD_1
    v_alignbyte_b32 v32, v33, v32, 2
    s_mov_b32 s54, 35837
    v_alignbyte_b32 v29, v29, v28, 1
    v_perm_b32 v28, v28, v32, s47
    s_waitcnt lgkmcnt(0)
    v_add3_u32 v34, v34, v106, s54
    v_sub_u32 v35, 0, v34
    v_and_b32 v35, 3, v35
    s_mov_b64 exec, s[80:81]
    v_mov_b32 v35, 0
    v_mov_b32 v30, 0
    s_mov_b64 exec, vcc
    v_mov_b32 v35, 3

    s_mov_b64 exec, -1
    v_alignbyte_b32 v28, v29, v28, v35
    v_alignbyte_b32 v29, v30, v29, v35
    v_add_u32 v34, v34, v35

    buffer_store_dwordx2 v[28:29], v34, s[24:27], 0 offen
L_skw_47:
    s_bitcmp0_b32 s28, 2
    s_cbranch_scc1 L_skw_48
    v_add_u32 v107, 65536, v2
    ds_read_b64 v[4:5], v107 offset:16400
    ds_read_b64 v[6:7], v107 offset:16408
    ds_read_b64 v[8:9], v107 offset:16392

    ds_read_b64 v[12:13], v107 offset:24592
    ds_read_b64 v[14:15], v107 offset:24600
    ds_read_b64 v[16:17], v107 offset:24584

    ds_read_b64 v[20:21], v107 offset:32784
    ds_read_b64 v[22:23], v107 offset:32792
    ds_read_b64 v[24:25], v107 offset:32776

    ds_read_b64 v[28:29], v107 offset:40976
    ds_read_b64 v[30:31], v107 offset:40984
    ds_read_b64 v[32:33], v107 offset:40968

    s_waitcnt lgkmcnt(9)
    v_lshrrev_b32 v10, 16, v5
    ds_read_b32 v10, v10 offset:8192

    s_waitcnt lgkmcnt(7)
    v_lshrrev_b32 v18, 16, v13
    ds_read_b32 v18, v18 offset:8192

    s_waitcnt lgkmcnt(5)
    v_lshrrev_b32 v26, 16, v21
    ds_read_b32 v26, v26 offset:8192

    s_waitcnt lgkmcnt(3)
    v_lshrrev_b32 v34, 16, v29
    ds_read_b32 v34, v34 offset:8192

    v_cmp_ne_u32_sdwa s[80:81], v5, v7 src0_sel:WORD_1 src1_sel:WORD_1
    v_cmp_ne_u32_sdwa vcc, v5, v9 src0_sel:WORD_1 src1_sel:WORD_1
    v_alignbyte_b32 v8, v9, v8, 2
    s_mov_b32 s54, 40957
    v_alignbyte_b32 v5, v5, v4, 1
    v_perm_b32 v4, v4, v8, s47
    s_waitcnt lgkmcnt(3)
    v_add3_u32 v10, v10, v106, s54
    v_sub_u32 v11, 0, v10
    v_and_b32 v11, 3, v11
    s_mov_b64 exec, s[80:81]
    v_mov_b32 v11, 0
    v_mov_b32 v6, 0
    s_mov_b64 exec, vcc
    v_mov_b32 v11, 3

    s_mov_b64 exec, -1
    v_alignbyte_b32 v4, v5, v4, v11
    v_alignbyte_b32 v5, v6, v5, v11
    v_add_u32 v10, v10, v11

    buffer_store_dwordx2 v[4:5], v10, s[24:27], 0 offen
    v_cmp_ne_u32_sdwa s[80:81], v13, v15 src0_sel:WORD_1 src1_sel:WORD_1
    v_cmp_ne_u32_sdwa vcc, v13, v17 src0_sel:WORD_1 src1_sel:WORD_1
    v_alignbyte_b32 v16, v17, v16, 2
    s_mov_b32 s54, 46077
    v_alignbyte_b32 v13, v13, v12, 1
    v_perm_b32 v12, v12, v16, s47
    s_waitcnt lgkmcnt(2)
    v_add3_u32 v18, v18, v106, s54
    v_sub_u32 v19, 0, v18
    v_and_b32 v19, 3, v19
    s_mov_b64 exec, s[80:81]
    v_mov_b32 v19, 0
    v_mov_b32 v14, 0
    s_mov_b64 exec, vcc
    v_mov_b32 v19, 3

    s_mov_b64 exec, -1
    v_alignbyte_b32 v12, v13, v12, v19
    v_alignbyte_b32 v13, v14, v13, v19
    v_add_u32 v18, v18, v19

    buffer_store_dwordx2 v[12:13], v18, s[24:27], 0 offen
    v_cmp_ne_u32_sdwa s[80:81], v21, v23 src0_sel:WORD_1 src1_sel:WORD_1
    v_cmp_ne_u32_sdwa vcc, v21, v25 src0_sel:WORD_1 src1_sel:WORD_1
    v_alignbyte_b32 v24, v25, v24, 2
    s_mov_b32 s54, 51197
    v_alignbyte_b32 v21, v21, v20, 1
    v_perm_b32 v20, v20, v24, s47
    s_waitcnt lgkmcnt(1)
    v_add3_u32 v26, v26, v106, s54
    v_sub_u32 v27, 0, v26
    v_and_b32 v27, 3, v27
    s_mov_b64 exec, s[80:81]
    v_mov_b32 v27, 0
    v_mov_b32 v22, 0
    s_mov_b64 exec, vcc
    v_mov_b32 v27, 3

    s_mov_b64 exec, -1
    v_alignbyte_b32 v20, v21, v20, v27
    v_alignbyte_b32 v21, v22, v21, v27
    v_add_u32 v26, v26, v27

    buffer_store_dwordx2 v[20:21], v26, s[24:27], 0 offen
    v_cmp_ne_u32_sdwa s[80:81], v29, v31 src0_sel:WORD_1 src1_sel:WORD_1
    v_cmp_ne_u32_sdwa vcc, v29, v33 src0_sel:WORD_1 src1_sel:WORD_1
    v_alignbyte_b32 v32, v33, v32, 2
    s_mov_b32 s54, 56317
    v_alignbyte_b32 v29, v29, v28, 1
    v_perm_b32 v28, v28, v32, s47
    s_waitcnt lgkmcnt(0)
    v_add3_u32 v34, v34, v106, s54
    v_sub_u32 v35, 0, v34
    v_and_b32 v35, 3, v35
    s_mov_b64 exec, s[80:81]
    v_mov_b32 v35, 0
    v_mov_b32 v30, 0
    s_mov_b64 exec, vcc
    v_mov_b32 v35, 3

    s_mov_b64 exec, -1
    v_alignbyte_b32 v28, v29, v28, v35
    v_alignbyte_b32 v29, v30, v29, v35
    v_add_u32 v34, v34, v35

    buffer_store_dwordx2 v[28:29], v34, s[24:27], 0 offen
L_skw_48:
    s_bitcmp0_b32 s28, 3
    s_cbranch_scc1 L_skw_49
    v_add_u32 v107, 98304, v2
    ds_read_b64 v[4:5], v107 offset:16400
    ds_read_b64 v[6:7], v107 offset:16408
    ds_read_b64 v[8:9], v107 offset:16392

    ds_read_b64 v[12:13], v107 offset:24592
    ds_read_b64 v[14:15], v107 offset:24600
    ds_read_b64 v[16:17], v107 offset:24584

    ds_read_b64 v[20:21], v107 offset:32784
    ds_read_b64 v[22:23], v107 offset:32792
    ds_read_b64 v[24:25], v107 offset:32776

    ds_read_b64 v[28:29], v107 offset:40976
    ds_read_b64 v[30:31], v107 offset:40984
    ds_read_b64 v[32:33], v107 offset:40968

    s_waitcnt lgkmcnt(9)
    v_lshrrev_b32 v10, 16, v5
    ds_read_b32 v10, v10 offset:8192

    s_waitcnt lgkmcnt(7)
    v_lshrrev_b32 v18, 16, v13
    ds_read_b32 v18, v18 offset:8192

    s_waitcnt lgkmcnt(5)
    v_lshrrev_b32 v26, 16, v21
    ds_read_b32 v26, v26 offset:8192

    s_waitcnt lgkmcnt(3)
    v_lshrrev_b32 v34, 16, v29
    ds_read_b32 v34, v34 offset:8192

    v_cmp_ne_u32_sdwa s[80:81], v5, v7 src0_sel:WORD_1 src1_sel:WORD_1
    v_cmp_ne_u32_sdwa vcc, v5, v9 src0_sel:WORD_1 src1_sel:WORD_1
    v_alignbyte_b32 v8, v9, v8, 2
    s_mov_b32 s54, 61437
    v_alignbyte_b32 v5, v5, v4, 1
    v_perm_b32 v4, v4, v8, s47
    s_waitcnt lgkmcnt(3)
    v_add3_u32 v10, v10, v106, s54
    v_sub_u32 v11, 0, v10
    v_and_b32 v11, 3, v11
    s_mov_b64 exec, s[80:81]
    v_mov_b32 v11, 0
    v_mov_b32 v6, 0
    s_mov_b64 exec, vcc
    v_mov_b32 v11, 3

    s_mov_b64 exec, -1
    v_alignbyte_b32 v4, v5, v4, v11
    v_alignbyte_b32 v5, v6, v5, v11
    v_add_u32 v10, v10, v11

    buffer_store_dwordx2 v[4:5], v10, s[24:27], 0 offen
    v_cmp_ne_u32_sdwa s[80:81], v13, v15 src0_sel:WORD_1 src1_sel:WORD_1
    v_cmp_ne_u32_sdwa vcc, v13, v17 src0_sel:WORD_1 src1_sel:WORD_1
    v_alignbyte_b32 v16, v17, v16, 2
    s_mov_b32 s54, 66557
    v_alignbyte_b32 v13, v13, v12, 1
    v_perm_b32 v12, v12, v16, s47
    s_waitcnt lgkmcnt(2)
    v_add3_u32 v18, v18, v106, s54
    v_sub_u32 v19, 0, v18
    v_and_b32 v19, 3, v19
    s_mov_b64 exec, s[80:81]
    v_mov_b32 v19, 0
    v_mov_b32 v14, 0
    s_mov_b64 exec, vcc
    v_mov_b32 v19, 3

    s_mov_b64 exec, -1
    v_alignbyte_b32 v12, v13, v12, v19
    v_alignbyte_b32 v13, v14, v13, v19
    v_add_u32 v18, v18, v19

    buffer_store_dwordx2 v[12:13], v18, s[24:27], 0 offen
    v_cmp_ne_u32_sdwa s[80:81], v21, v23 src0_sel:WORD_1 src1_sel:WORD_1
    v_cmp_ne_u32_sdwa vcc, v21, v25 src0_sel:WORD_1 src1_sel:WORD_1
    v_alignbyte_b32 v24, v25, v24, 2
    s_mov_b32 s54, 71677
    v_alignbyte_b32 v21, v21, v20, 1
    v_perm_b32 v20, v20, v24, s47
    s_waitcnt lgkmcnt(1)
    v_add3_u32 v26, v26, v106, s54
    v_sub_u32 v27, 0, v26
    v_and_b32 v27, 3, v27
    s_mov_b64 exec, s[80:81]
    v_mov_b32 v27, 0
    v_mov_b32 v22, 0
    s_mov_b64 exec, vcc
    v_mov_b32 v27, 3

    s_mov_b64 exec, -1
    v_alignbyte_b32 v20, v21, v20, v27
    v_alignbyte_b32 v21, v22, v21, v27
    v_add_u32 v26, v26, v27

    buffer_store_dwordx2 v[20:21], v26, s[24:27], 0 offen
    v_cmp_ne_u32_sdwa s[80:81], v29, v31 src0_sel:WORD_1 src1_sel:WORD_1
    v_cmp_ne_u32_sdwa vcc, v29, v33 src0_sel:WORD_1 src1_sel:WORD_1
    v_alignbyte_b32 v32, v33, v32, 2
    s_mov_b32 s54, 76797
    v_alignbyte_b32 v29, v29, v28, 1
    v_perm_b32 v28, v28, v32, s47
    s_waitcnt lgkmcnt(0)
    v_add3_u32 v34, v34, v106, s54
    v_sub_u32 v35, 0, v34
    v_and_b32 v35, 3, v35
    s_mov_b64 exec, s[80:81]
    v_mov_b32 v35, 0
    v_mov_b32 v30, 0
    s_mov_b64 exec, vcc
    v_mov_b32 v35, 3

    s_andn2_b64 exec, -1, s[68:69]
    v_bfrev_b32 v34, 1
    s_mov_b64 exec, -1
    v_alignbyte_b32 v28, v29, v28, v35
    v_alignbyte_b32 v29, v30, v29, v35
    v_add_u32 v34, v34, v35

    buffer_store_dwordx2 v[28:29], v34, s[24:27], 0 offen
L_skw_49:
    s_mov_b32 s28, 15
    s_mov_b32 s29, 0
    s_movk_i32 s30, 16000

L_p1done_1:
    s_endpgm

L_slow_23:
    v_add_u32 v112, s29, v0
    v_mov_b32 v118, 0
    s_mov_b32 s75, 4960
L_sl_25:
    v_lshlrev_b32 v113, 3, v112
    ds_read_b64 v[110:111], v113 offset:16400
    ds_read_b32 v119, v113 offset:16412
    ds_read_b32 v120, v113 offset:16396
    s_waitcnt lgkmcnt(0)
    v_lshrrev_b32 v114, 16, v111
    ds_read_b32 v115, v114 offset:8192
    v_add_u32 v114, 4, v114
    v_mul_u32_u24 v114, s75, v114
    s_waitcnt lgkmcnt(0)
    v_mad_u32_u24 v115, v112, 5, v115
    v_cmp_gt_u32 s[72:73], s30, v112
    v_cmp_ge_u32 vcc, v115, v114
    s_and_b64 s[80:81], vcc, s[72:73]
    s_cbranch_scc0 L_s1_26
    s_bcnt1_i32_b64 s76, s[80:81]
    v_mbcnt_lo_u32_b32 v117, s80, 0
    v_mbcnt_hi_u32_b32 v117, s81, v117
    v_mov_b32 v116, s76
    s_mov_b64 exec, 1
    buffer_atomic_add v116, v118, s[36:39], 0 offen sc0
    s_waitcnt vmcnt(0)
    v_readfirstlane_b32 s76, v116
    s_mov_b64 exec, s[80:81]
    s_nop 0
    v_add_lshl_u32 v116, v117, s76, 3
    buffer_store_dwordx2 v[110:111], v116, s[32:35], 0 offen
L_s1_26:
    s_andn2_b64 exec, s[72:73], vcc
    s_cbranch_execz L_s2_27
    buffer_store_dword v110, v115, s[24:27], 0 offen
    buffer_store_byte v111, v115, s[24:27], 0 offen offset:4
    v_add_u32 v115, 5, v115
    v_cmpx_lt_u32 vcc, v115, v114
    v_cmpx_ne_u32_sdwa vcc, v111, v119 src0_sel:WORD_1 src1_sel:WORD_1
    v_cmpx_ne_u32_sdwa vcc, v111, v120 src0_sel:WORD_1 src1_sel:WORD_1
    s_cbranch_execz L_s2_27
    buffer_store_dword v118, v115, s[24:27], 0 offen
L_s2_27:
    s_mov_b64 exec, -1
    v_add_u32 v112, 1024, v112
    s_nop 0
    v_readfirstlane_b32 s76, v112
    s_nop 1
    s_cmp_lt_u32 s76, s30
    s_cbranch_scc1 L_sl_25
    s_mov_b32 s28, 0
    s_branch L_sback_24

L_slow_41:
    v_add_u32 v112, s29, v0
    v_mov_b32 v118, 0
    s_mov_b32 s75, 4960
L_sl_43:
    v_lshlrev_b32 v113, 3, v112
    ds_read_b64 v[110:111], v113 offset:16400
    ds_read_b32 v119, v113 offset:16412
    ds_read_b32 v120, v113 offset:16396
    s_waitcnt lgkmcnt(0)
    v_lshrrev_b32 v114, 16, v111
    ds_read_b32 v115, v114 offset:8192
    v_add_u32 v114, 4, v114
    v_mul_u32_u24 v114, s75, v114
    s_waitcnt lgkmcnt(0)
    v_mad_u32_u24 v115, v112, 5, v115
    v_cmp_gt_u32 s[72:73], s30, v112
    v_cmp_ge_u32 vcc, v115, v114
    s_and_b64 s[80:81], vcc, s[72:73]
    s_cbranch_scc0 L_s1_44
    s_bcnt1_i32_b64 s76, s[80:81]
    v_mbcnt_lo_u32_b32 v117, s80, 0
    v_mbcnt_hi_u32_b32 v117, s81, v117
    v_mov_b32 v116, s76
    s_mov_b64 exec, 1
    buffer_atomic_add v116, v118, s[36:39], 0 offen sc0
    s_waitcnt vmcnt(0)
    v_readfirstlane_b32 s76, v116
    s_mov_b64 exec, s[80:81]
    s_nop 0
    v_add_lshl_u32 v116, v117, s76, 3
    buffer_store_dwordx2 v[110:111], v116, s[32:35], 0 offen
L_s1_44:
    s_andn2_b64 exec, s[72:73], vcc
    s_cbranch_execz L_s2_45
    buffer_store_dword v110, v115, s[24:27], 0 offen
    buffer_store_byte v111, v115, s[24:27], 0 offen offset:4
    v_add_u32 v115, 5, v115
    v_cmpx_lt_u32 vcc, v115, v114
    v_cmpx_ne_u32_sdwa vcc, v111, v119 src0_sel:WORD_1 src1_sel:WORD_1
    v_cmpx_ne_u32_sdwa vcc, v111, v120 src0_sel:WORD_1 src1_sel:WORD_1
    s_cbranch_execz L_s2_45
    buffer_store_dword v118, v115, s[24:27], 0 offen
L_s2_45:
    s_mov_b64 exec, -1
    v_add_u32 v112, 1024, v112
    s_nop 0
    v_readfirstlane_b32 s76, v112
    s_nop 1
    s_cmp_lt_u32 s76, s30
    s_cbranch_scc1 L_sl_43
    s_mov_b32 s28, 0
    s_branch L_sback_42

.globl g2_kernel
.p2align 8
.type g2_kernel,@function
g2_kernel:
    s_cmp_ge_u32 s2, 256
    s_cbranch_scc1 L_p2done_50
    s_load_dwordx2 s[8:9], s[0:1], 0
    s_load_dwordx2 s[6:7], s[0:1], 104
    v_lshrrev_b32 v4, 6, v0
    v_lshlrev_b32 v5, 3, v0
    s_lshr_b32 s37, s2, 1
    s_and_b32 s37, s37, 3
    s_lshr_b32 s36, s2, 3
    s_lshl_b32 s36, s36, 1
    s_and_b32 s3, s2, 1
    s_or_b32 s36, s36, s3
    v_readfirstlane_b32 s4, v4
    v_and_b32 v2, 63, v0
    v_lshrrev_b32 v3, 9, v0
    v_lshl_or_b32 v2, v3, 6, v2
    v_mul_u32_u24 v2, 20, v2
    v_lshlrev_b32 v3, 4, v0
    s_waitcnt lgkmcnt(0)
    s_and_b32 s5, s4, 7
    s_lshr_b32 s39, s4, 3
    s_lshl_b32 s39, s39, 8
    s_mul_i32 s3, s5, 8192
    s_add_u32 s46, s6, s3
    s_addc_u32 s47, s7, 0
    s_mul_i32 s3, s5, 40632320
    s_add_u32 s3, s3, 77848576
    s_add_u32 s44, s6, s3
    s_addc_u32 s45, s7, 0
    s_mul_i32 s38, s37, 8
    s_add_u32 s4, s38, 8
    s_lshl_b32 s3, s38, 6
    s_add_u32 s3, s3, s36
    s_lshl_b32 s3, s3, 2
    s_add_u32 s52, s46, s3
    s_addc_u32 s53, s47, 0

    s_load_dword s88, s[52:53], 0
    s_load_dword s89, s[52:53], 256
    s_load_dword s90, s[52:53], 512
    s_load_dword s91, s[52:53], 768
    s_load_dword s92, s[52:53], 1024
    s_load_dword s93, s[52:53], 1280
    s_load_dword s94, s[52:53], 1536
    s_load_dword s95, s[52:53], 1792
    s_mov_b32 s3, 65536
    s_load_dword s51, s[6:7], s3
    s_mov_b32 s10, 6400000
    s_mov_b32 s11, 0x20000

    s_add_u32 s20, s6, 135168
    s_addc_u32 s21, s7, 0
    s_mov_b32 s22, 2048
    s_mov_b32 s23, 0x20000
    buffer_load_dwordx2 v[116:117], v5, s[20:23], 0 offen
    s_mov_b32 s12, s8
    s_mov_b32 s13, s9
    s_mov_b32 s14, 0
    s_mov_b32 s15, 0x20000
    s_mul_i32 s43, s38, 200000
    s_add_u32 s14, s43, 50000
    buffer_load_dwordx4 v[76:79], v3, s[12:15], s43 offen
    s_add_u32 s52, s43, 16384
    buffer_load_dwordx4 v[80:83], v3, s[12:15], s52 offen
    s_add_u32 s52, s43, 32768
    buffer_load_dwordx4 v[84:87], v3, s[12:15], s52 offen
    s_add_u32 s52, s43, 49152
    v_lshlrev_b32 v119, 2, v0
    buffer_load_dword v88, v119, s[12:15], s52 offen
    s_lshr_b32 s3, s2, 3
    s_mul_i32 s3, s3, 49
    v_add_lshl_u32 v89, v0, s3, 7
    v_cmp_gt_u32 vcc, 49, v0
    v_bfrev_b32 v28, 1
    s_add_u32 s54, s43, 100000
    v_cndmask_b32 v89, v28, v89, vcc

    buffer_load_dword v115, v89, s[8:11], s54 offen
    s_mov_b32 s19, 0x20000
    s_mov_b32 s28, 0x4b404000
    s_mov_b32 s29, 0x4b404000
    s_mov_b32 s30, 0xbfffc000
    s_mov_b32 s31, 0xbfffbfff
    s_mov_b32 s32, 0xffff0000
    s_mov_b32 s35, 0x05040100
    s_movk_i32 s3, 212
    v_cmp_gt_u32 s[48:49], s3, v0

    v_mov_b32 v1, 0
    s_mov_b32 s24, 0xc0c0004
    s_mov_b32 s25, 0xc0c0105
    s_mov_b32 s26, 0xc0c0206
    s_mov_b32 s27, 0xc0c0307
    s_waitcnt lgkmcnt(0)
    s_min_u32 s88, s88, 3968
    s_lshl_b32 s52, s38, 6
    s_add_u32 s52, s52, s36
    s_mul_i32 s52, s52, 19840
    s_add_u32 s16, s44, s52
    s_addc_u32 s17, s45, 0
    s_mul_i32 s52, s88, 5
    s_add_u32 s52, s52, 3
    s_and_b32 s18, s52, -4

    s_movk_i32 s53, 0
    buffer_load_dwordx4 v[4:7], v2, s[16:19], s53 offen
    buffer_load_dword v35, v2, s[16:19], s53 offen offset:16
    s_movk_i32 s53, 2560
    buffer_load_dwordx4 v[8:11], v2, s[16:19], s53 offen
    buffer_load_dword v43, v2, s[16:19], s53 offen offset:16
    s_movk_i32 s53, 5120
    buffer_load_dwordx4 v[90:93], v2, s[16:19], s53 offen
    buffer_load_dword v110, v2, s[16:19], s53 offen offset:16
    s_movk_i32 s53, 7680
    buffer_load_dwordx4 v[94:97], v2, s[16:19], s53 offen
    buffer_load_dword v111, v2, s[16:19], s53 offen offset:16
    s_movk_i32 s53, 10240
    buffer_load_dwordx4 v[98:101], v2, s[16:19], s53 offen
    buffer_load_dword v112, v2, s[16:19], s53 offen offset:16
    s_movk_i32 s53, 12800
    buffer_load_dwordx4 v[102:105], v2, s[16:19], s53 offen
    buffer_load_dword v113, v2, s[16:19], s53 offen offset:16
    s_movk_i32 s53, 15360
    buffer_load_dwordx4 v[106:109], v2, s[16:19], s53 offen
    buffer_load_dword v114, v2, s[16:19], s53 offen offset:16
    v_mov_b32 v28, 0x40004000
    v_mov_b32 v29, 0x40004000
    v_mov_b32 v30, 0x40004000
    v_mov_b32 v31, 0x40004000
    v_add_u32 v32, 50000, v3
    v_add_u32 v33, 65536, v32

    ds_write_b128 v32, v[28:31] offset:0
    ds_write_b128 v32, v[28:31] offset:16384
    ds_write_b128 v32, v[28:31] offset:32768
    ds_write_b128 v32, v[28:31] offset:49152
    ds_write_b128 v33, v[28:31] offset:0
    ds_write_b128 v33, v[28:31] offset:16384
    v_cmp_gt_u32 vcc, 971, v0
    s_mov_b64 exec, vcc
    ds_write_b128 v33, v[28:31] offset:32768
    s_mov_b64 exec, -1
    s_waitcnt lgkmcnt(0)
    s_barrier
    v_mov_b32 v34, 150016
    v_mov_b32 v36, 0
    v_mov_b32 v37, 0
    v_mov_b32 v38, 0
    v_mov_b32 v39, 0
    ds_write_b128 v34, v[36:39]

    s_waitcnt vmcnt(19)
    s_nop 1
    v_max_u32_dpp v116, v116, v116 row_shr:1 row_mask:0xf bank_mask:0xf
    s_nop 1
    v_max_u32_dpp v116, v116, v116 row_shr:2 row_mask:0xf bank_mask:0xf
    s_nop 1
    v_max_u32_dpp v116, v116, v116 row_shr:4 row_mask:0xf bank_mask:0xf
    s_nop 1
    v_max_u32_dpp v116, v116, v116 row_shr:8 row_mask:0xf bank_mask:0xf
    s_nop 1
    v_max_u32_dpp v116, v116, v116 row_bcast:15 row_mask:0xa bank_mask:0xf
    s_nop 1
    v_max_u32_dpp v116, v116, v116 row_bcast:31 row_mask:0xc bank_mask:0xf
    s_nop 1
    v_add_f32_dpp v117, v117, v117 row_shr:1 row_mask:0xf bank_mask:0xf
    s_nop 1
    v_add_f32_dpp v117, v117, v117 row_shr:2 row_mask:0xf bank_mask:0xf
    s_nop 1
    v_add_f32_dpp v117, v117, v117 row_shr:4 row_mask:0xf bank_mask:0xf
    s_nop 1
    v_add_f32_dpp v117, v117, v117 row_shr:8 row_mask:0xf bank_mask:0xf
    s_nop 1
    v_add_f32_dpp v117, v117, v117 row_bcast:15 row_mask:0xa bank_mask:0xf
    s_nop 1
    v_add_f32_dpp v117, v117, v117 row_bcast:31 row_mask:0xc bank_mask:0xf
    s_waitcnt lgkmcnt(0)
    s_barrier
    s_mov_b32 exec_lo, 0
    s_brev_b32 exec_hi, 1
    ds_max_u32 v34, v116
    ds_add_f32 v34, v117 offset:4
    s_mov_b64 exec, -1

    s_waitcnt vmcnt(18)
    ds_write_b128 v3, v[76:79] offset:0
    s_waitcnt vmcnt(17)
    ds_write_b128 v3, v[80:83] offset:16384
    s_waitcnt vmcnt(16)
    ds_write_b128 v3, v[84:87] offset:32768
    v_lshlrev_b32 v119, 2, v0
    s_waitcnt vmcnt(15)
    s_mov_b64 exec, s[48:49]
    ds_write_b32 v119, v88 offset:49152
    s_mov_b64 exec, -1

    s_add_u32 s43, s43, 50000
    s_add_u32 s14, s43, 50000
    buffer_load_dwordx4 v[76:79], v3, s[12:15], s43 offen
    s_add_u32 s52, s43, 16384
    buffer_load_dwordx4 v[80:83], v3, s[12:15], s52 offen
    s_add_u32 s52, s43, 32768
    buffer_load_dwordx4 v[84:87], v3, s[12:15], s52 offen
    s_add_u32 s52, s43, 49152
    v_lshlrev_b32 v119, 2, v0
    buffer_load_dword v88, v119, s[12:15], s52 offen
    s_waitcnt lgkmcnt(0)
    s_barrier
    ds_read_b64 v[28:29], v34
    s_waitcnt lgkmcnt(0)
    v_lshlrev_b32 v28, 16, v28
    v_mul_f32 v29, 0x34a7c5ac, v29
    v_sqrt_f32 v29, v29
    v_add_f32 v30, v28, v28
    v_mul_f32 v31, 0x41ac0000, v29
    v_mul_f32 v32, 0x42000000, v29
    v_max_f32 v30, v30, v31
    v_cmp_le_f32 vcc, v28, v32
    v_mov_b32 v33, 0x26901d7d
    v_cmp_lt_f32 s[64:65], v33, v29
    v_mov_b32 v33, 0x58635fa9
    s_and_b64 vcc, vcc, s[64:65]
    v_cmp_gt_f32 s[64:65], v33, v29
    v_rcp_f32 v30, v30
    s_and_b64 vcc, vcc, s[64:65]
    s_cbranch_scc0 L_p2slow_51
    s_cmp_lg_u32 s51, 0
    s_cbranch_scc1 L_p2slow_51
    v_mul_f32 v30, 0x3f000000, v30
    v_mul_f32 v31, 0x46ff8000, v30
    v_rcp_f32 v31, v31
    v_readfirstlane_b32 s33, v30
    s_nop 0
    v_readfirstlane_b32 s34, v31

L_batch_52:
    s_mov_b32 s40, s88
    s_sub_u32 s42, s40, s39
    s_mul_i32 s50, s38, 200000
    s_add_u32 s5, s38, 1
    s_min_u32 s55, s5, 31

    s_mov_b32 s88, s89
    s_mov_b32 s89, s90
    s_mov_b32 s90, s91
    s_mov_b32 s91, s92
    s_mov_b32 s92, s93
    s_mov_b32 s93, s94
    s_mov_b32 s94, s95
    s_mov_b32 s95, 0
    s_min_u32 s88, s88, 3968
    s_lshl_b32 s52, s55, 6
    s_add_u32 s52, s52, s36
    s_mul_i32 s52, s52, 19840
    s_add_u32 s16, s44, s52
    s_addc_u32 s17, s45, 0
    s_mul_i32 s52, s88, 5
    s_add_u32 s52, s52, 3
    s_and_b32 s18, s52, -4

    s_waitcnt vmcnt(12)
    v_perm_b32 v44, v91, v90, s24
    v_perm_b32 v46, v92, v91, s25
    v_perm_b32 v48, v93, v92, s26
    v_perm_b32 v50, v110, v93, s27
    v_mov_b32 v12, v90
    v_alignbyte_b32 v13, v92, v91, 1
    v_alignbyte_b32 v14, v93, v92, 2
    v_alignbyte_b32 v15, v110, v93, 3
    v_lshlrev_b32_sdwa v44, 3, v44 dst_sel:WORD_0 dst_unused:UNUSED_PAD src0_sel:DWORD src1_sel:DWORD
    v_lshlrev_b32_sdwa v46, 3, v46 dst_sel:WORD_0 dst_unused:UNUSED_PAD src0_sel:DWORD src1_sel:DWORD
    v_lshlrev_b32_sdwa v48, 3, v48 dst_sel:WORD_0 dst_unused:UNUSED_PAD src0_sel:DWORD src1_sel:DWORD
    v_lshlrev_b32_sdwa v50, 3, v50 dst_sel:WORD_0 dst_unused:UNUSED_PAD src0_sel:DWORD src1_sel:DWORD
    s_cmp_lt_i32 s42, 1280
    s_cbranch_scc1 L_ufix_55
L_uback_56:

    s_waitcnt vmcnt(10)
    v_perm_b32 v52, v95, v94, s24
    v_perm_b32 v54, v96, v95, s25
    v_perm_b32 v56, v97, v96, s26
    v_perm_b32 v58, v111, v97, s27
    v_mov_b32 v16, v94
    v_alignbyte_b32 v17, v96, v95, 1
    v_alignbyte_b32 v18, v97, v96, 2
    v_alignbyte_b32 v19, v111, v97, 3
    v_lshlrev_b32_sdwa v52, 3, v52 dst_sel:WORD_0 dst_unused:UNUSED_PAD src0_sel:DWORD src1_sel:DWORD
    v_lshlrev_b32_sdwa v54, 3, v54 dst_sel:WORD_0 dst_unused:UNUSED_PAD src0_sel:DWORD src1_sel:DWORD
    v_lshlrev_b32_sdwa v56, 3, v56 dst_sel:WORD_0 dst_unused:UNUSED_PAD src0_sel:DWORD src1_sel:DWORD
    v_lshlrev_b32_sdwa v58, 3, v58 dst_sel:WORD_0 dst_unused:UNUSED_PAD src0_sel:DWORD src1_sel:DWORD
    s_cmp_lt_i32 s42, 1792
    s_cbranch_scc1 L_ufix_57
L_uback_58:

    s_waitcnt vmcnt(8)
    v_perm_b32 v60, v99, v98, s24
    v_perm_b32 v62, v100, v99, s25
    v_perm_b32 v64, v101, v100, s26
    v_perm_b32 v66, v112, v101, s27
    v_mov_b32 v20, v98
    v_alignbyte_b32 v21, v100, v99, 1
    v_alignbyte_b32 v22, v101, v100, 2
    v_alignbyte_b32 v23, v112, v101, 3
    v_lshlrev_b32_sdwa v60, 3, v60 dst_sel:WORD_0 dst_unused:UNUSED_PAD src0_sel:DWORD src1_sel:DWORD
    v_lshlrev_b32_sdwa v62, 3, v62 dst_sel:WORD_0 dst_unused:UNUSED_PAD src0_sel:DWORD src1_sel:DWORD
    v_lshlrev_b32_sdwa v64, 3, v64 dst_sel:WORD_0 dst_unused:UNUSED_PAD src0_sel:DWORD src1_sel:DWORD
    v_lshlrev_b32_sdwa v66, 3, v66 dst_sel:WORD_0 dst_unused:UNUSED_PAD src0_sel:DWORD src1_sel:DWORD
    s_cmp_lt_i32 s42, 2304
    s_cbranch_scc1 L_ufix_59
L_uback_60:

    s_waitcnt vmcnt(6)
    v_perm_b32 v68, v103, v102, s24
    v_perm_b32 v70, v104, v103, s25
    v_perm_b32 v72, v105, v104, s26
    v_perm_b32 v74, v113, v105, s27
    v_mov_b32 v24, v102
    v_alignbyte_b32 v25, v104, v103, 1
    v_alignbyte_b32 v26, v105, v104, 2
    v_alignbyte_b32 v27, v113, v105, 3
    v_lshlrev_b32_sdwa v68, 3, v68 dst_sel:WORD_0 dst_unused:UNUSED_PAD src0_sel:DWORD src1_sel:DWORD
    v_lshlrev_b32_sdwa v70, 3, v70 dst_sel:WORD_0 dst_unused:UNUSED_PAD src0_sel:DWORD src1_sel:DWORD
    v_lshlrev_b32_sdwa v72, 3, v72 dst_sel:WORD_0 dst_unused:UNUSED_PAD src0_sel:DWORD src1_sel:DWORD
    v_lshlrev_b32_sdwa v74, 3, v74 dst_sel:WORD_0 dst_unused:UNUSED_PAD src0_sel:DWORD src1_sel:DWORD
    s_cmp_lt_i32 s42, 2816
    s_cbranch_scc1 L_ufix_61
L_uback_62:

    s_waitcnt vmcnt(7)
    v_perm_b32 v28, v5, v4, s24
    v_perm_b32 v30, v6, v5, s25
    v_perm_b32 v32, v7, v6, s26
    v_perm_b32 v34, v35, v7, s27
    v_alignbyte_b32 v5, v6, v5, 1
    v_alignbyte_b32 v6, v7, v6, 2
    v_alignbyte_b32 v7, v35, v7, 3
    v_lshlrev_b32_sdwa v28, 3, v28 dst_sel:WORD_0 dst_unused:UNUSED_PAD src0_sel:DWORD src1_sel:DWORD
    v_lshlrev_b32_sdwa v30, 3, v30 dst_sel:WORD_0 dst_unused:UNUSED_PAD src0_sel:DWORD src1_sel:DWORD
    v_lshlrev_b32_sdwa v32, 3, v32 dst_sel:WORD_0 dst_unused:UNUSED_PAD src0_sel:DWORD src1_sel:DWORD
    v_lshlrev_b32_sdwa v34, 3, v34 dst_sel:WORD_0 dst_unused:UNUSED_PAD src0_sel:DWORD src1_sel:DWORD
    s_cmp_lt_i32 s42, 256
    s_cbranch_scc1 L_ufix_63
L_uback_64:

    s_waitcnt vmcnt(0)
    v_perm_b32 v36, v9, v8, s24
    v_perm_b32 v38, v10, v9, s25
    v_perm_b32 v40, v11, v10, s26
    v_perm_b32 v42, v43, v11, s27
    v_alignbyte_b32 v9, v10, v9, 1
    v_alignbyte_b32 v10, v11, v10, 2
    v_alignbyte_b32 v11, v43, v11, 3
    v_lshlrev_b32_sdwa v36, 3, v36 dst_sel:WORD_0 dst_unused:UNUSED_PAD src0_sel:DWORD src1_sel:DWORD
    v_lshlrev_b32_sdwa v38, 3, v38 dst_sel:WORD_0 dst_unused:UNUSED_PAD src0_sel:DWORD src1_sel:DWORD
    v_lshlrev_b32_sdwa v40, 3, v40 dst_sel:WORD_0 dst_unused:UNUSED_PAD src0_sel:DWORD src1_sel:DWORD
    v_lshlrev_b32_sdwa v42, 3, v42 dst_sel:WORD_0 dst_unused:UNUSED_PAD src0_sel:DWORD src1_sel:DWORD
    s_cmp_lt_i32 s42, 768
    s_cbranch_scc1 L_ufix_65
L_uback_66:

    v_subrev_co_u32 v4, s[64:65], 2.0, v4
    v_subrev_co_u32 v5, s[66:67], 2.0, v5
    v_subrev_co_u32 v6, s[68:69], 2.0, v6
    v_subrev_co_u32 v7, s[70:71], 2.0, v7
    v_subrev_co_u32 v8, s[72:73], 2.0, v8
    v_subrev_co_u32 v9, s[74:75], 2.0, v9
    v_subrev_co_u32 v10, s[76:77], 2.0, v10
    v_subrev_co_u32 v11, s[78:79], 2.0, v11
    v_subrev_co_u32 v12, s[80:81], 2.0, v12
    v_subrev_co_u32 v13, s[82:83], 2.0, v13
    v_subrev_co_u32 v14, s[84:85], 2.0, v14
    v_subrev_co_u32 v15, s[86:87], 2.0, v15
    s_mov_b64 exec, s[64:65]
    ds_read_b64 v[28:29], v28
    s_mov_b64 exec, s[66:67]
    ds_read_b64 v[30:31], v30
    s_mov_b64 exec, s[68:69]
    ds_read_b64 v[32:33], v32
    s_mov_b64 exec, s[70:71]
    ds_read_b64 v[34:35], v34
    s_mov_b64 exec, s[72:73]
    ds_read_b64 v[36:37], v36
    s_mov_b64 exec, s[74:75]
    ds_read_b64 v[38:39], v38
    s_mov_b64 exec, s[76:77]
    ds_read_b64 v[40:41], v40
    s_mov_b64 exec, s[78:79]
    ds_read_b64 v[42:43], v42
    s_mov_b64 exec, s[80:81]
    ds_read_b64 v[44:45], v44
    s_mov_b64 exec, s[82:83]
    ds_read_b64 v[46:47], v46
    s_mov_b64 exec, s[84:85]
    ds_read_b64 v[48:49], v48
    s_mov_b64 exec, s[86:87]
    ds_read_b64 v[50:51], v50
    s_mov_b64 exec, -1
    s_movk_i32 s53, 5120
    buffer_load_dwordx4 v[90:93], v2, s[16:19], s53 offen
    buffer_load_dword v110, v2, s[16:19], s53 offen offset:16
    v_subrev_co_u32 v16, s[64:65], 2.0, v16
    v_subrev_co_u32 v17, s[66:67], 2.0, v17
    v_subrev_co_u32 v18, s[68:69], 2.0, v18
    v_subrev_co_u32 v19, s[70:71], 2.0, v19
    v_subrev_co_u32 v20, s[72:73], 2.0, v20
    v_subrev_co_u32 v21, s[74:75], 2.0, v21
    v_subrev_co_u32 v22, s[76:77], 2.0, v22
    v_subrev_co_u32 v23, s[78:79], 2.0, v23
    v_subrev_co_u32 v24, s[80:81], 2.0, v24
    v_subrev_co_u32 v25, s[82:83], 2.0, v25
    v_subrev_co_u32 v26, s[84:85], 2.0, v26
    v_subrev_co_u32 v27, s[86:87], 2.0, v27
    s_mov_b64 exec, s[64:65]
    ds_read_b64 v[52:53], v52
    s_mov_b64 exec, s[66:67]
    ds_read_b64 v[54:55], v54
    s_mov_b64 exec, s[68:69]
    ds_read_b64 v[56:57], v56
    s_mov_b64 exec, s[70:71]
    ds_read_b64 v[58:59], v58
    s_mov_b64 exec, s[72:73]
    ds_read_b64 v[60:61], v60
    s_mov_b64 exec, s[74:75]
    ds_read_b64 v[62:63], v62
    s_mov_b64 exec, s[76:77]
    ds_read_b64 v[64:65], v64
    s_mov_b64 exec, s[78:79]
    ds_read_b64 v[66:67], v66
    s_mov_b64 exec, s[80:81]
    ds_read_b64 v[68:69], v68
    s_mov_b64 exec, s[82:83]
    ds_read_b64 v[70:71], v70
    s_mov_b64 exec, s[84:85]
    ds_read_b64 v[72:73], v72
    s_mov_b64 exec, s[86:87]
    ds_read_b64 v[74:75], v74
    s_mov_b64 exec, -1
    s_waitcnt lgkmcnt(0)
    s_barrier
    s_waitcnt vmcnt(5)
    ds_write_b128 v3, v[76:79] offset:0
    s_waitcnt vmcnt(4)
    ds_write_b128 v3, v[80:83] offset:16384
    s_waitcnt vmcnt(3)
    ds_write_b128 v3, v[84:87] offset:32768
    v_lshlrev_b32 v119, 2, v0
    s_waitcnt vmcnt(2)
    s_mov_b64 exec, s[48:49]
    ds_write_b32 v119, v88 offset:49152
    s_mov_b64 exec, -1

    s_add_u32 s43, s43, 50000
    s_add_u32 s14, s43, 50000
    buffer_load_dwordx4 v[76:79], v3, s[12:15], s43 offen
    s_add_u32 s52, s43, 16384
    buffer_load_dwordx4 v[80:83], v3, s[12:15], s52 offen
    v_subrev_co_u32 v4, s[64:65], 2.0, v4
    v_subrev_co_u32 v5, s[66:67], 2.0, v5
    v_subrev_co_u32 v6, s[68:69], 2.0, v6
    v_subrev_co_u32 v7, s[70:71], 2.0, v7
    v_subrev_co_u32 v8, s[72:73], 2.0, v8
    v_subrev_co_u32 v9, s[74:75], 2.0, v9
    v_subrev_co_u32 v10, s[76:77], 2.0, v10
    v_subrev_co_u32 v11, s[78:79], 2.0, v11
    v_subrev_co_u32 v12, s[80:81], 2.0, v12
    v_subrev_co_u32 v13, s[82:83], 2.0, v13
    v_subrev_co_u32 v14, s[84:85], 2.0, v14
    v_subrev_co_u32 v15, s[86:87], 2.0, v15
    s_waitcnt lgkmcnt(0)
    s_barrier
    s_add_u32 s52, s43, 32768
    buffer_load_dwordx4 v[84:87], v3, s[12:15], s52 offen
    s_add_u32 s52, s43, 49152
    v_lshlrev_b32 v119, 2, v0
    buffer_load_dword v88, v119, s[12:15], s52 offen
    s_mov_b64 exec, s[64:65]
    ds_read_b64 v[28:29], v28
    s_mov_b64 exec, s[66:67]
    ds_read_b64 v[30:31], v30
    s_mov_b64 exec, s[68:69]
    ds_read_b64 v[32:33], v32
    s_mov_b64 exec, s[70:71]
    ds_read_b64 v[34:35], v34
    s_mov_b64 exec, s[72:73]
    ds_read_b64 v[36:37], v36
    s_mov_b64 exec, s[74:75]
    ds_read_b64 v[38:39], v38
    s_mov_b64 exec, s[76:77]
    ds_read_b64 v[40:41], v40
    s_mov_b64 exec, s[78:79]
    ds_read_b64 v[42:43], v42
    s_mov_b64 exec, s[80:81]
    ds_read_b64 v[44:45], v44
    s_mov_b64 exec, s[82:83]
    ds_read_b64 v[46:47], v46
    s_mov_b64 exec, s[84:85]
    ds_read_b64 v[48:49], v48
    s_mov_b64 exec, s[86:87]
    ds_read_b64 v[50:51], v50
    s_mov_b64 exec, -1
    s_cmp_le_i32 s42, 3072
    s_cbranch_scc1 L_nt1_53
    s_waitcnt vmcnt(10)
    v_perm_b32 v120, v107, v106, s24
    v_perm_b32 v122, v108, v107, s25
    v_perm_b32 v124, v109, v108, s26
    v_perm_b32 v126, v114, v109, s27
    v_alignbyte_b32 v107, v108, v107, 1
    v_alignbyte_b32 v108, v109, v108, 2
    v_alignbyte_b32 v109, v114, v109, 3
    v_lshlrev_b32_sdwa v120, 3, v120 dst_sel:WORD_0 dst_unused:UNUSED_PAD src0_sel:DWORD src1_sel:DWORD
    v_lshlrev_b32_sdwa v122, 3, v122 dst_sel:WORD_0 dst_unused:UNUSED_PAD src0_sel:DWORD src1_sel:DWORD
    v_lshlrev_b32_sdwa v124, 3, v124 dst_sel:WORD_0 dst_unused:UNUSED_PAD src0_sel:DWORD src1_sel:DWORD
    v_lshlrev_b32_sdwa v126, 3, v126 dst_sel:WORD_0 dst_unused:UNUSED_PAD src0_sel:DWORD src1_sel:DWORD
    s_cmp_lt_i32 s42, 3328
    s_cbranch_scc1 L_ufix_67
L_uback_68:

    v_lshrrev_b32 v117, 30, v106
    v_and_b32 v106, 0x3fffffff, v106
    v_mul_u32_u24 v117, 50000, v117
    v_cmp_ne_u32 vcc, 0, v106
    v_add_u32 v120, v120, v117
    s_mov_b64 exec, vcc

    buffer_load_dwordx2 v[120:121], v120, s[8:11], s50 offen
    s_mov_b64 exec, -1
    v_lshrrev_b32 v117, 30, v107
    v_and_b32 v107, 0x3fffffff, v107
    v_mul_u32_u24 v117, 50000, v117
    v_cmp_ne_u32 vcc, 0, v107
    v_add_u32 v122, v122, v117
    s_mov_b64 exec, vcc

    buffer_load_dwordx2 v[122:123], v122, s[8:11], s50 offen
    s_mov_b64 exec, -1
    v_lshrrev_b32 v117, 30, v108
    v_and_b32 v108, 0x3fffffff, v108
    v_mul_u32_u24 v117, 50000, v117
    v_cmp_ne_u32 vcc, 0, v108
    v_add_u32 v124, v124, v117
    s_mov_b64 exec, vcc

    buffer_load_dwordx2 v[124:125], v124, s[8:11], s50 offen
    s_mov_b64 exec, -1
    v_lshrrev_b32 v117, 30, v109
    v_and_b32 v109, 0x3fffffff, v109
    v_mul_u32_u24 v117, 50000, v117
    v_cmp_ne_u32 vcc, 0, v109
    v_add_u32 v126, v126, v117
    s_mov_b64 exec, vcc

    buffer_load_dwordx2 v[126:127], v126, s[8:11], s50 offen
    s_mov_b64 exec, -1
L_nt1_53:
    s_movk_i32 s53, 7680
    buffer_load_dwordx4 v[94:97], v2, s[16:19], s53 offen
    buffer_load_dword v111, v2, s[16:19], s53 offen offset:16
    v_subrev_co_u32 v16, s[64:65], 2.0, v16
    v_subrev_co_u32 v17, s[66:67], 2.0, v17
    v_subrev_co_u32 v18, s[68:69], 2.0, v18
    v_subrev_co_u32 v19, s[70:71], 2.0, v19
    v_subrev_co_u32 v20, s[72:73], 2.0, v20
    v_subrev_co_u32 v21, s[74:75], 2.0, v21
    v_subrev_co_u32 v22, s[76:77], 2.0, v22
    v_subrev_co_u32 v23, s[78:79], 2.0, v23
    v_subrev_co_u32 v24, s[80:81], 2.0, v24
    v_subrev_co_u32 v25, s[82:83], 2.0, v25
    v_subrev_co_u32 v26, s[84:85], 2.0, v26
    v_subrev_co_u32 v27, s[86:87], 2.0, v27
    s_mov_b64 exec, s[64:65]
    ds_read_b64 v[52:53], v52
    s_mov_b64 exec, s[66:67]
    ds_read_b64 v[54:55], v54
    s_mov_b64 exec, s[68:69]
    ds_read_b64 v[56:57], v56
    s_mov_b64 exec, s[70:71]
    ds_read_b64 v[58:59], v58
    s_mov_b64 exec, s[72:73]
    ds_read_b64 v[60:61], v60
    s_mov_b64 exec, s[74:75]
    ds_read_b64 v[62:63], v62
    s_mov_b64 exec, s[76:77]
    ds_read_b64 v[64:65], v64
    s_mov_b64 exec, s[78:79]
    ds_read_b64 v[66:67], v66
    s_mov_b64 exec, s[80:81]
    ds_read_b64 v[68:69], v68
    s_mov_b64 exec, s[82:83]
    ds_read_b64 v[70:71], v70
    s_mov_b64 exec, s[84:85]
    ds_read_b64 v[72:73], v72
    s_mov_b64 exec, s[86:87]
    ds_read_b64 v[74:75], v74
    s_mov_b64 exec, -1
    s_waitcnt lgkmcnt(0)
    s_barrier
    s_waitcnt vmcnt(5)
    ds_write_b128 v3, v[76:79] offset:0
    s_waitcnt vmcnt(4)
    ds_write_b128 v3, v[80:83] offset:16384
    s_waitcnt vmcnt(3)
    ds_write_b128 v3, v[84:87] offset:32768
    v_lshlrev_b32 v119, 2, v0
    s_waitcnt vmcnt(2)
    s_mov_b64 exec, s[48:49]
    ds_write_b32 v119, v88 offset:49152
    s_mov_b64 exec, -1

    s_add_u32 s43, s43, 50000
    s_add_u32 s14, s43, 50000
    buffer_load_dwordx4 v[76:79], v3, s[12:15], s43 offen
    s_add_u32 s52, s43, 16384
    buffer_load_dwordx4 v[80:83], v3, s[12:15], s52 offen
    v_subrev_co_u32 v4, s[64:65], 2.0, v4
    v_subrev_co_u32 v5, s[66:67], 2.0, v5
    v_subrev_co_u32 v6, s[68:69], 2.0, v6
    v_subrev_co_u32 v7, s[70:71], 2.0, v7
    v_subrev_co_u32 v8, s[72:73], 2.0, v8
    v_subrev_co_u32 v9, s[74:75], 2.0, v9
    v_subrev_co_u32 v10, s[76:77], 2.0, v10
    v_subrev_co_u32 v11, s[78:79], 2.0, v11
    v_subrev_co_u32 v12, s[80:81], 2.0, v12
    v_subrev_co_u32 v13, s[82:83], 2.0, v13
    v_subrev_co_u32 v14, s[84:85], 2.0, v14
    v_subrev_co_u32 v15, s[86:87], 2.0, v15
    s_waitcnt lgkmcnt(0)
    s_barrier
    s_add_u32 s52, s43, 32768
    buffer_load_dwordx4 v[84:87], v3, s[12:15], s52 offen
    s_add_u32 s52, s43, 49152
    v_lshlrev_b32 v119, 2, v0
    buffer_load_dword v88, v119, s[12:15], s52 offen
    s_mov_b64 exec, s[64:65]
    ds_read_b64 v[28:29], v28
    s_mov_b64 exec, s[66:67]
    ds_read_b64 v[30:31], v30
    s_mov_b64 exec, s[68:69]
    ds_read_b64 v[32:33], v32
    s_mov_b64 exec, s[70:71]
    ds_read_b64 v[34:35], v34
    s_mov_b64 exec, s[72:73]
    ds_read_b64 v[36:37], v36
    s_mov_b64 exec, s[74:75]
    ds_read_b64 v[38:39], v38
    s_mov_b64 exec, s[76:77]
    ds_read_b64 v[40:41], v40
    s_mov_b64 exec, s[78:79]
    ds_read_b64 v[42:43], v42
    s_mov_b64 exec, s[80:81]
    ds_read_b64 v[44:45], v44
    s_mov_b64 exec, s[82:83]
    ds_read_b64 v[46:47], v46
    s_mov_b64 exec, s[84:85]
    ds_read_b64 v[48:49], v48
    s_mov_b64 exec, s[86:87]
    ds_read_b64 v[50:51], v50
    s_mov_b64 exec, -1
    s_movk_i32 s53, 10240
    buffer_load_dwordx4 v[98:101], v2, s[16:19], s53 offen
    buffer_load_dword v112, v2, s[16:19], s53 offen offset:16
    v_subrev_co_u32 v16, s[64:65], 2.0, v16
    v_subrev_co_u32 v17, s[66:67], 2.0, v17
    v_subrev_co_u32 v18, s[68:69], 2.0, v18
    v_subrev_co_u32 v19, s[70:71], 2.0, v19
    v_subrev_co_u32 v20, s[72:73], 2.0, v20
    v_subrev_co_u32 v21, s[74:75], 2.0, v21
    v_subrev_co_u32 v22, s[76:77], 2.0, v22
    v_subrev_co_u32 v23, s[78:79], 2.0, v23
    v_subrev_co_u32 v24, s[80:81], 2.0, v24
    v_subrev_co_u32 v25, s[82:83], 2.0, v25
    v_subrev_co_u32 v26, s[84:85], 2.0, v26
    v_subrev_co_u32 v27, s[86:87], 2.0, v27
    s_mov_b64 exec, s[64:65]
    ds_read_b64 v[52:53], v52
    s_mov_b64 exec, s[66:67]
    ds_read_b64 v[54:55], v54
    s_mov_b64 exec, s[68:69]
    ds_read_b64 v[56:57], v56
    s_mov_b64 exec, s[70:71]
    ds_read_b64 v[58:59], v58
    s_mov_b64 exec, s[72:73]
    ds_read_b64 v[60:61], v60
    s_mov_b64 exec, s[74:75]
    ds_read_b64 v[62:63], v62
    s_mov_b64 exec, s[76:77]
    ds_read_b64 v[64:65], v64
    s_mov_b64 exec, s[78:79]
    ds_read_b64 v[66:67], v66
    s_mov_b64 exec, s[80:81]
    ds_read_b64 v[68:69], v68
    s_mov_b64 exec, s[82:83]
    ds_read_b64 v[70:71], v70
    s_mov_b64 exec, s[84:85]
    ds_read_b64 v[72:73], v72
    s_mov_b64 exec, s[86:87]
    ds_read_b64 v[74:75], v74
    s_mov_b64 exec, -1
    s_cmp_le_i32 s42, 3072
    s_cbranch_scc1 L_nt2_54
    s_waitcnt vmcnt(8)
    v_cmp_ne_u32 s[64:65], 0, v106
    v_cmp_ne_u32 s[66:67], 0, v107
    v_cmp_ne_u32 s[68:69], 0, v108
    v_cmp_ne_u32 s[70:71], 0, v109
    s_mov_b64 exec, s[64:65]
    v_cvt_f32_i32_sdwa v118, sext(v106) dst_sel:DWORD dst_unused:UNUSED_PAD src0_sel:WORD_0
    v_lshlrev_b32 v116, 16, v120
    v_and_b32 v117, s32, v120
    v_mul_f32 v118, s33, v118
    v_lshlrev_b32 v120, 16, v121
    v_and_b32 v121, s32, v121
    v_lshlrev_b32_sdwa v106, 3, v106 dst_sel:DWORD dst_unused:UNUSED_PAD src0_sel:DWORD src1_sel:WORD_1
    v_pk_fma_f32 v[116:117], v[116:117], v[118:119], s[28:29] op_sel_hi:[1,0,1]
    v_pk_fma_f32 v[120:121], v[120:121], v[118:119], s[28:29] op_sel_hi:[1,0,1]
    v_perm_b32 v116, v117, v116, s35
    v_perm_b32 v117, v121, v120, s35
    v_lshl_add_u64 v[116:117], v[116:117], 0, s[30:31]
    ds_add_rtn_u64 v[120:121], v106, v[116:117] offset:50000

    s_mov_b64 exec, s[66:67]
    v_cvt_f32_i32_sdwa v118, sext(v107) dst_sel:DWORD dst_unused:UNUSED_PAD src0_sel:WORD_0
    v_lshlrev_b32 v116, 16, v122
    v_and_b32 v117, s32, v122
    v_mul_f32 v118, s33, v118
    v_lshlrev_b32 v122, 16, v123
    v_and_b32 v123, s32, v123
    v_lshlrev_b32_sdwa v107, 3, v107 dst_sel:DWORD dst_unused:UNUSED_PAD src0_sel:DWORD src1_sel:WORD_1
    v_pk_fma_f32 v[116:117], v[116:117], v[118:119], s[28:29] op_sel_hi:[1,0,1]
    v_pk_fma_f32 v[122:123], v[122:123], v[118:119], s[28:29] op_sel_hi:[1,0,1]
    v_perm_b32 v116, v117, v116, s35
    v_perm_b32 v117, v123, v122, s35
    v_lshl_add_u64 v[116:117], v[116:117], 0, s[30:31]
    ds_add_rtn_u64 v[122:123], v107, v[116:117] offset:50000

    s_mov_b64 exec, s[68:69]
    v_cvt_f32_i32_sdwa v118, sext(v108) dst_sel:DWORD dst_unused:UNUSED_PAD src0_sel:WORD_0
    v_lshlrev_b32 v116, 16, v124
    v_and_b32 v117, s32, v124
    v_mul_f32 v118, s33, v118
    v_lshlrev_b32 v124, 16, v125
    v_and_b32 v125, s32, v125
    v_lshlrev_b32_sdwa v108, 3, v108 dst_sel:DWORD dst_unused:UNUSED_PAD src0_sel:DWORD src1_sel:WORD_1
    v_pk_fma_f32 v[116:117], v[116:117], v[118:119], s[28:29] op_sel_hi:[1,0,1]
    v_pk_fma_f32 v[124:125], v[124:125], v[118:119], s[28:29] op_sel_hi:[1,0,1]
    v_perm_b32 v116, v117, v116, s35
    v_perm_b32 v117, v125, v124, s35
    v_lshl_add_u64 v[116:117], v[116:117], 0, s[30:31]
    ds_add_rtn_u64 v[124:125], v108, v[116:117] offset:50000

    s_mov_b64 exec, s[70:71]
    v_cvt_f32_i32_sdwa v118, sext(v109) dst_sel:DWORD dst_unused:UNUSED_PAD src0_sel:WORD_0
    v_lshlrev_b32 v116, 16, v126
    v_and_b32 v117, s32, v126
    v_mul_f32 v118, s33, v118
    v_lshlrev_b32 v126, 16, v127
    v_and_b32 v127, s32, v127
    v_lshlrev_b32_sdwa v109, 3, v109 dst_sel:DWORD dst_unused:UNUSED_PAD src0_sel:DWORD src1_sel:WORD_1
    v_pk_fma_f32 v[116:117], v[116:117], v[118:119], s[28:29] op_sel_hi:[1,0,1]
    v_pk_fma_f32 v[126:127], v[126:127], v[118:119], s[28:29] op_sel_hi:[1,0,1]
    v_perm_b32 v116, v117, v116, s35
    v_perm_b32 v117, v127, v126, s35
    v_lshl_add_u64 v[116:117], v[116:117], 0, s[30:31]
    ds_add_rtn_u64 v[126:127], v109, v[116:117] offset:50000

    s_waitcnt lgkmcnt(0)
    s_mov_b64 exec, s[64:65]
    v_or3_b32 v1, v120, v121, v1
    s_mov_b64 exec, s[66:67]
    v_or3_b32 v1, v122, v123, v1
    s_mov_b64 exec, s[68:69]
    v_or3_b32 v1, v124, v125, v1
    s_mov_b64 exec, s[70:71]
    v_or3_b32 v1, v126, v127, v1
    s_mov_b64 exec, -1
L_nt2_54:
    s_movk_i32 s53, 15360
    buffer_load_dwordx4 v[106:109], v2, s[16:19], s53 offen
    buffer_load_dword v114, v2, s[16:19], s53 offen offset:16
    s_waitcnt lgkmcnt(0)
    s_barrier
    s_waitcnt vmcnt(7)
    ds_write_b128 v3, v[76:79] offset:0
    s_waitcnt vmcnt(6)
    ds_write_b128 v3, v[80:83] offset:16384
    s_waitcnt vmcnt(5)
    ds_write_b128 v3, v[84:87] offset:32768
    v_lshlrev_b32 v119, 2, v0
    s_waitcnt vmcnt(4)
    s_mov_b64 exec, s[48:49]
    ds_write_b32 v119, v88 offset:49152
    s_mov_b64 exec, -1

    s_add_u32 s43, s43, 50000
    s_add_u32 s14, s43, 50000
    s_cmp_lt_u32 s5, s4
    s_cselect_b32 s14, s14, 0
    buffer_load_dwordx4 v[76:79], v3, s[12:15], s43 offen
    s_add_u32 s52, s43, 16384
    buffer_load_dwordx4 v[80:83], v3, s[12:15], s52 offen
    v_cmp_gt_u32 s[64:65], 2.0, v4
    v_and_b32 v4, 0x3fffffff, v4
    v_cmp_gt_u32 s[66:67], 2.0, v5
    v_and_b32 v5, 0x3fffffff, v5
    v_cmp_gt_u32 s[68:69], 2.0, v6
    v_and_b32 v6, 0x3fffffff, v6
    v_cmp_gt_u32 s[70:71], 2.0, v7
    v_and_b32 v7, 0x3fffffff, v7
    v_cmp_gt_u32 s[72:73], 2.0, v8
    v_and_b32 v8, 0x3fffffff, v8
    v_cmp_gt_u32 s[74:75], 2.0, v9
    v_and_b32 v9, 0x3fffffff, v9
    v_cmp_gt_u32 s[76:77], 2.0, v10
    v_and_b32 v10, 0x3fffffff, v10
    v_cmp_gt_u32 s[78:79], 2.0, v11
    v_and_b32 v11, 0x3fffffff, v11
    v_cmp_gt_u32 s[80:81], 2.0, v12
    v_and_b32 v12, 0x3fffffff, v12
    v_cmp_gt_u32 s[82:83], 2.0, v13
    v_and_b32 v13, 0x3fffffff, v13
    v_cmp_gt_u32 s[84:85], 2.0, v14
    v_and_b32 v14, 0x3fffffff, v14
    v_cmp_gt_u32 s[86:87], 2.0, v15
    v_and_b32 v15, 0x3fffffff, v15
    s_waitcnt lgkmcnt(0)
    s_barrier
    s_add_u32 s52, s43, 32768
    buffer_load_dwordx4 v[84:87], v3, s[12:15], s52 offen
    s_add_u32 s52, s43, 49152
    v_lshlrev_b32 v119, 2, v0
    buffer_load_dword v88, v119, s[12:15], s52 offen
    s_mov_b64 exec, s[64:65]
    ds_read_b64 v[28:29], v28
    s_mov_b64 exec, s[66:67]
    ds_read_b64 v[30:31], v30
    s_mov_b64 exec, s[68:69]
    ds_read_b64 v[32:33], v32
    s_mov_b64 exec, s[70:71]
    ds_read_b64 v[34:35], v34
    s_mov_b64 exec, s[72:73]
    ds_read_b64 v[36:37], v36
    s_mov_b64 exec, s[74:75]
    ds_read_b64 v[38:39], v38
    s_mov_b64 exec, s[76:77]
    ds_read_b64 v[40:41], v40
    s_mov_b64 exec, s[78:79]
    ds_read_b64 v[42:43], v42
    s_mov_b64 exec, s[80:81]
    ds_read_b64 v[44:45], v44
    s_mov_b64 exec, s[82:83]
    ds_read_b64 v[46:47], v46
    s_mov_b64 exec, s[84:85]
    ds_read_b64 v[48:49], v48
    s_mov_b64 exec, s[86:87]
    ds_read_b64 v[50:51], v50
    s_mov_b64 exec, -1
    s_movk_i32 s53, 12800
    buffer_load_dwordx4 v[102:105], v2, s[16:19], s53 offen
    buffer_load_dword v113, v2, s[16:19], s53 offen offset:16
    v_cmp_gt_u32 s[64:65], 2.0, v16
    v_and_b32 v16, 0x3fffffff, v16
    v_cmp_gt_u32 s[66:67], 2.0, v17
    v_and_b32 v17, 0x3fffffff, v17
    v_cmp_gt_u32 s[68:69], 2.0, v18
    v_and_b32 v18, 0x3fffffff, v18
    v_cmp_gt_u32 s[70:71], 2.0, v19
    v_and_b32 v19, 0x3fffffff, v19
    v_cmp_gt_u32 s[72:73], 2.0, v20
    v_and_b32 v20, 0x3fffffff, v20
    v_cmp_gt_u32 s[74:75], 2.0, v21
    v_and_b32 v21, 0x3fffffff, v21
    v_cmp_gt_u32 s[76:77], 2.0, v22
    v_and_b32 v22, 0x3fffffff, v22
    v_cmp_gt_u32 s[78:79], 2.0, v23
    v_and_b32 v23, 0x3fffffff, v23
    v_cmp_gt_u32 s[80:81], 2.0, v24
    v_and_b32 v24, 0x3fffffff, v24
    v_cmp_gt_u32 s[82:83], 2.0, v25
    v_and_b32 v25, 0x3fffffff, v25
    v_cmp_gt_u32 s[84:85], 2.0, v26
    v_and_b32 v26, 0x3fffffff, v26
    v_cmp_gt_u32 s[86:87], 2.0, v27
    v_and_b32 v27, 0x3fffffff, v27
    s_mov_b64 exec, s[64:65]
    ds_read_b64 v[52:53], v52
    s_mov_b64 exec, s[66:67]
    ds_read_b64 v[54:55], v54
    s_mov_b64 exec, s[68:69]
    ds_read_b64 v[56:57], v56
    s_mov_b64 exec, s[70:71]
    ds_read_b64 v[58:59], v58
    s_mov_b64 exec, s[72:73]
    ds_read_b64 v[60:61], v60
    s_mov_b64 exec, s[74:75]
    ds_read_b64 v[62:63], v62
    s_mov_b64 exec, s[76:77]
    ds_read_b64 v[64:65], v64
    s_mov_b64 exec, s[78:79]
    ds_read_b64 v[66:67], v66
    s_mov_b64 exec, s[80:81]
    ds_read_b64 v[68:69], v68
    s_mov_b64 exec, s[82:83]
    ds_read_b64 v[70:71], v70
    s_mov_b64 exec, s[84:85]
    ds_read_b64 v[72:73], v72
    s_mov_b64 exec, s[86:87]
    ds_read_b64 v[74:75], v74
    s_mov_b64 exec, -1
    s_waitcnt lgkmcnt(12)
    v_cvt_f32_i32_sdwa v118, sext(v4) dst_sel:DWORD dst_unused:UNUSED_PAD src0_sel:WORD_0
    v_lshlrev_b32 v116, 16, v28
    v_and_b32 v117, s32, v28
    v_mul_f32 v118, s33, v118
    v_lshlrev_b32 v28, 16, v29
    v_and_b32 v29, s32, v29
    v_lshlrev_b32_sdwa v4, 3, v4 dst_sel:DWORD dst_unused:UNUSED_PAD src0_sel:DWORD src1_sel:WORD_1
    v_pk_fma_f32 v[116:117], v[116:117], v[118:119], s[28:29] op_sel_hi:[1,0,1]
    v_pk_fma_f32 v[28:29], v[28:29], v[118:119], s[28:29] op_sel_hi:[1,0,1]
    v_perm_b32 v116, v117, v116, s35
    v_perm_b32 v117, v29, v28, s35
    v_lshl_add_u64 v[116:117], v[116:117], 0, s[30:31]
    ds_add_rtn_u64 v[28:29], v4, v[116:117] offset:50000

    v_cvt_f32_i32_sdwa v122, sext(v5) dst_sel:DWORD dst_unused:UNUSED_PAD src0_sel:WORD_0
    v_lshlrev_b32 v120, 16, v30
    v_and_b32 v121, s32, v30
    v_mul_f32 v122, s33, v122
    v_lshlrev_b32 v30, 16, v31
    v_and_b32 v31, s32, v31
    v_lshlrev_b32_sdwa v5, 3, v5 dst_sel:DWORD dst_unused:UNUSED_PAD src0_sel:DWORD src1_sel:WORD_1
    v_pk_fma_f32 v[120:121], v[120:121], v[122:123], s[28:29] op_sel_hi:[1,0,1]
    v_pk_fma_f32 v[30:31], v[30:31], v[122:123], s[28:29] op_sel_hi:[1,0,1]
    v_perm_b32 v120, v121, v120, s35
    v_perm_b32 v121, v31, v30, s35
    v_lshl_add_u64 v[120:121], v[120:121], 0, s[30:31]
    ds_add_rtn_u64 v[30:31], v5, v[120:121] offset:50000

    v_cvt_f32_i32_sdwa v126, sext(v6) dst_sel:DWORD dst_unused:UNUSED_PAD src0_sel:WORD_0
    v_lshlrev_b32 v124, 16, v32
    v_and_b32 v125, s32, v32
    v_mul_f32 v126, s33, v126
    v_lshlrev_b32 v32, 16, v33
    v_and_b32 v33, s32, v33
    v_lshlrev_b32_sdwa v6, 3, v6 dst_sel:DWORD dst_unused:UNUSED_PAD src0_sel:DWORD src1_sel:WORD_1
    v_pk_fma_f32 v[124:125], v[124:125], v[126:127], s[28:29] op_sel_hi:[1,0,1]
    v_pk_fma_f32 v[32:33], v[32:33], v[126:127], s[28:29] op_sel_hi:[1,0,1]
    v_perm_b32 v124, v125, v124, s35
    v_perm_b32 v125, v33, v32, s35
    v_lshl_add_u64 v[124:125], v[124:125], 0, s[30:31]
    ds_add_rtn_u64 v[32:33], v6, v[124:125] offset:50000

    v_cvt_f32_i32_sdwa v118, sext(v7) dst_sel:DWORD dst_unused:UNUSED_PAD src0_sel:WORD_0
    v_lshlrev_b32 v116, 16, v34
    v_and_b32 v117, s32, v34
    v_mul_f32 v118, s33, v118
    v_lshlrev_b32 v34, 16, v35
    v_and_b32 v35, s32, v35
    v_lshlrev_b32_sdwa v7, 3, v7 dst_sel:DWORD dst_unused:UNUSED_PAD src0_sel:DWORD src1_sel:WORD_1
    v_pk_fma_f32 v[116:117], v[116:117], v[118:119], s[28:29] op_sel_hi:[1,0,1]
    v_pk_fma_f32 v[34:35], v[34:35], v[118:119], s[28:29] op_sel_hi:[1,0,1]
    v_perm_b32 v116, v117, v116, s35
    v_perm_b32 v117, v35, v34, s35
    v_lshl_add_u64 v[116:117], v[116:117], 0, s[30:31]
    ds_add_rtn_u64 v[34:35], v7, v[116:117] offset:50000

    v_cvt_f32_i32_sdwa v122, sext(v8) dst_sel:DWORD dst_unused:UNUSED_PAD src0_sel:WORD_0
    v_lshlrev_b32 v120, 16, v36
    v_and_b32 v121, s32, v36
    v_mul_f32 v122, s33, v122
    v_lshlrev_b32 v36, 16, v37
    v_and_b32 v37, s32, v37
    v_lshlrev_b32_sdwa v8, 3, v8 dst_sel:DWORD dst_unused:UNUSED_PAD src0_sel:DWORD src1_sel:WORD_1
    v_pk_fma_f32 v[120:121], v[120:121], v[122:123], s[28:29] op_sel_hi:[1,0,1]
    v_pk_fma_f32 v[36:37], v[36:37], v[122:123], s[28:29] op_sel_hi:[1,0,1]
    v_perm_b32 v120, v121, v120, s35
    v_perm_b32 v121, v37, v36, s35
    v_lshl_add_u64 v[120:121], v[120:121], 0, s[30:31]
    ds_add_rtn_u64 v[36:37], v8, v[120:121] offset:50000

    v_cvt_f32_i32_sdwa v126, sext(v9) dst_sel:DWORD dst_unused:UNUSED_PAD src0_sel:WORD_0
    v_lshlrev_b32 v124, 16, v38
    v_and_b32 v125, s32, v38
    v_mul_f32 v126, s33, v126
    v_lshlrev_b32 v38, 16, v39
    v_and_b32 v39, s32, v39
    v_lshlrev_b32_sdwa v9, 3, v9 dst_sel:DWORD dst_unused:UNUSED_PAD src0_sel:DWORD src1_sel:WORD_1
    v_pk_fma_f32 v[124:125], v[124:125], v[126:127], s[28:29] op_sel_hi:[1,0,1]
    v_pk_fma_f32 v[38:39], v[38:39], v[126:127], s[28:29] op_sel_hi:[1,0,1]
    v_perm_b32 v124, v125, v124, s35
    v_perm_b32 v125, v39, v38, s35
    v_lshl_add_u64 v[124:125], v[124:125], 0, s[30:31]
    ds_add_rtn_u64 v[38:39], v9, v[124:125] offset:50000

    v_cvt_f32_i32_sdwa v118, sext(v10) dst_sel:DWORD dst_unused:UNUSED_PAD src0_sel:WORD_0
    v_lshlrev_b32 v116, 16, v40
    v_and_b32 v117, s32, v40
    v_mul_f32 v118, s33, v118
    v_lshlrev_b32 v40, 16, v41
    v_and_b32 v41, s32, v41
    v_lshlrev_b32_sdwa v10, 3, v10 dst_sel:DWORD dst_unused:UNUSED_PAD src0_sel:DWORD src1_sel:WORD_1
    v_pk_fma_f32 v[116:117], v[116:117], v[118:119], s[28:29] op_sel_hi:[1,0,1]
    v_pk_fma_f32 v[40:41], v[40:41], v[118:119], s[28:29] op_sel_hi:[1,0,1]
    v_perm_b32 v116, v117, v116, s35
    v_perm_b32 v117, v41, v40, s35
    v_lshl_add_u64 v[116:117], v[116:117], 0, s[30:31]
    ds_add_rtn_u64 v[40:41], v10, v[116:117] offset:50000

    v_cvt_f32_i32_sdwa v122, sext(v11) dst_sel:DWORD dst_unused:UNUSED_PAD src0_sel:WORD_0
    v_lshlrev_b32 v120, 16, v42
    v_and_b32 v121, s32, v42
    v_mul_f32 v122, s33, v122
    v_lshlrev_b32 v42, 16, v43
    v_and_b32 v43, s32, v43
    v_lshlrev_b32_sdwa v11, 3, v11 dst_sel:DWORD dst_unused:UNUSED_PAD src0_sel:DWORD src1_sel:WORD_1
    v_pk_fma_f32 v[120:121], v[120:121], v[122:123], s[28:29] op_sel_hi:[1,0,1]
    v_pk_fma_f32 v[42:43], v[42:43], v[122:123], s[28:29] op_sel_hi:[1,0,1]
    v_perm_b32 v120, v121, v120, s35
    v_perm_b32 v121, v43, v42, s35
    v_lshl_add_u64 v[120:121], v[120:121], 0, s[30:31]
    ds_add_rtn_u64 v[42:43], v11, v[120:121] offset:50000

    s_waitcnt lgkmcnt(4)
    v_or3_b32 v1, v28, v29, v1
    v_or3_b32 v1, v30, v31, v1
    v_or3_b32 v1, v32, v33, v1
    v_or3_b32 v1, v34, v35, v1
    s_movk_i32 s53, 0
    buffer_load_dwordx4 v[4:7], v2, s[16:19], s53 offen
    buffer_load_dword v35, v2, s[16:19], s53 offen offset:16
    s_barrier
    s_waitcnt vmcnt(7)
    ds_write_b128 v3, v[76:79] offset:0
    s_waitcnt vmcnt(6)
    ds_write_b128 v3, v[80:83] offset:16384
    s_waitcnt vmcnt(5)
    ds_write_b128 v3, v[84:87] offset:32768
    v_lshlrev_b32 v119, 2, v0
    s_waitcnt vmcnt(4)
    s_mov_b64 exec, s[48:49]
    ds_write_b32 v119, v88 offset:49152
    s_mov_b64 exec, -1

    s_add_u32 s43, s43, 50000
    s_add_u32 s14, s43, 50000
    s_cmp_lt_u32 s5, s4
    s_cselect_b32 s14, s14, 0
    buffer_load_dwordx4 v[76:79], v3, s[12:15], s43 offen
    s_add_u32 s52, s43, 16384
    buffer_load_dwordx4 v[80:83], v3, s[12:15], s52 offen
    s_add_u32 s52, s43, 32768
    buffer_load_dwordx4 v[84:87], v3, s[12:15], s52 offen
    s_add_u32 s52, s43, 49152
    v_lshlrev_b32 v119, 2, v0
    buffer_load_dword v88, v119, s[12:15], s52 offen
    s_add_u32 s54, s43, 50000
    buffer_load_dword v115, v89, s[8:11], s54 offen
    v_cvt_f32_i32_sdwa v126, sext(v12) dst_sel:DWORD dst_unused:UNUSED_PAD src0_sel:WORD_0
    v_lshlrev_b32 v124, 16, v44
    v_and_b32 v125, s32, v44
    v_mul_f32 v126, s33, v126
    v_lshlrev_b32 v44, 16, v45
    v_and_b32 v45, s32, v45
    v_lshlrev_b32_sdwa v12, 3, v12 dst_sel:DWORD dst_unused:UNUSED_PAD src0_sel:DWORD src1_sel:WORD_1
    v_pk_fma_f32 v[124:125], v[124:125], v[126:127], s[28:29] op_sel_hi:[1,0,1]
    v_pk_fma_f32 v[44:45], v[44:45], v[126:127], s[28:29] op_sel_hi:[1,0,1]
    v_perm_b32 v124, v125, v124, s35
    v_perm_b32 v125, v45, v44, s35
    v_lshl_add_u64 v[124:125], v[124:125], 0, s[30:31]
    ds_add_rtn_u64 v[44:45], v12, v[124:125] offset:50000

    v_cvt_f32_i32_sdwa v118, sext(v13) dst_sel:DWORD dst_unused:UNUSED_PAD src0_sel:WORD_0
    v_lshlrev_b32 v116, 16, v46
    v_and_b32 v117, s32, v46
    v_mul_f32 v118, s33, v118
    v_lshlrev_b32 v46, 16, v47
    v_and_b32 v47, s32, v47
    v_lshlrev_b32_sdwa v13, 3, v13 dst_sel:DWORD dst_unused:UNUSED_PAD src0_sel:DWORD src1_sel:WORD_1
    v_pk_fma_f32 v[116:117], v[116:117], v[118:119], s[28:29] op_sel_hi:[1,0,1]
    v_pk_fma_f32 v[46:47], v[46:47], v[118:119], s[28:29] op_sel_hi:[1,0,1]
    v_perm_b32 v116, v117, v116, s35
    v_perm_b32 v117, v47, v46, s35
    v_lshl_add_u64 v[116:117], v[116:117], 0, s[30:31]
    ds_add_rtn_u64 v[46:47], v13, v[116:117] offset:50000

    v_cvt_f32_i32_sdwa v122, sext(v14) dst_sel:DWORD dst_unused:UNUSED_PAD src0_sel:WORD_0
    v_lshlrev_b32 v120, 16, v48
    v_and_b32 v121, s32, v48
    v_mul_f32 v122, s33, v122
    v_lshlrev_b32 v48, 16, v49
    v_and_b32 v49, s32, v49
    v_lshlrev_b32_sdwa v14, 3, v14 dst_sel:DWORD dst_unused:UNUSED_PAD src0_sel:DWORD src1_sel:WORD_1
    v_pk_fma_f32 v[120:121], v[120:121], v[122:123], s[28:29] op_sel_hi:[1,0,1]
    v_pk_fma_f32 v[48:49], v[48:49], v[122:123], s[28:29] op_sel_hi:[1,0,1]
    v_perm_b32 v120, v121, v120, s35
    v_perm_b32 v121, v49, v48, s35
    v_lshl_add_u64 v[120:121], v[120:121], 0, s[30:31]
    ds_add_rtn_u64 v[48:49], v14, v[120:121] offset:50000

    v_cvt_f32_i32_sdwa v126, sext(v15) dst_sel:DWORD dst_unused:UNUSED_PAD src0_sel:WORD_0
    v_lshlrev_b32 v124, 16, v50
    v_and_b32 v125, s32, v50
    v_mul_f32 v126, s33, v126
    v_lshlrev_b32 v50, 16, v51
    v_and_b32 v51, s32, v51
    v_lshlrev_b32_sdwa v15, 3, v15 dst_sel:DWORD dst_unused:UNUSED_PAD src0_sel:DWORD src1_sel:WORD_1
    v_pk_fma_f32 v[124:125], v[124:125], v[126:127], s[28:29] op_sel_hi:[1,0,1]
    v_pk_fma_f32 v[50:51], v[50:51], v[126:127], s[28:29] op_sel_hi:[1,0,1]
    v_perm_b32 v124, v125, v124, s35
    v_perm_b32 v125, v51, v50, s35
    v_lshl_add_u64 v[124:125], v[124:125], 0, s[30:31]
    ds_add_rtn_u64 v[50:51], v15, v[124:125] offset:50000

    s_waitcnt lgkmcnt(4)
    v_or3_b32 v1, v36, v37, v1
    v_or3_b32 v1, v38, v39, v1
    v_or3_b32 v1, v40, v41, v1
    v_or3_b32 v1, v42, v43, v1
    s_movk_i32 s53, 2560
    buffer_load_dwordx4 v[8:11], v2, s[16:19], s53 offen
    buffer_load_dword v43, v2, s[16:19], s53 offen offset:16
    v_cvt_f32_i32_sdwa v118, sext(v16) dst_sel:DWORD dst_unused:UNUSED_PAD src0_sel:WORD_0
    v_lshlrev_b32 v116, 16, v52
    v_and_b32 v117, s32, v52
    v_mul_f32 v118, s33, v118
    v_lshlrev_b32 v52, 16, v53
    v_and_b32 v53, s32, v53
    v_lshlrev_b32_sdwa v16, 3, v16 dst_sel:DWORD dst_unused:UNUSED_PAD src0_sel:DWORD src1_sel:WORD_1
    v_pk_fma_f32 v[116:117], v[116:117], v[118:119], s[28:29] op_sel_hi:[1,0,1]
    v_pk_fma_f32 v[52:53], v[52:53], v[118:119], s[28:29] op_sel_hi:[1,0,1]
    v_perm_b32 v116, v117, v116, s35
    v_perm_b32 v117, v53, v52, s35
    v_lshl_add_u64 v[116:117], v[116:117], 0, s[30:31]
    ds_add_rtn_u64 v[52:53], v16, v[116:117] offset:50000

    v_cvt_f32_i32_sdwa v122, sext(v17) dst_sel:DWORD dst_unused:UNUSED_PAD src0_sel:WORD_0
    v_lshlrev_b32 v120, 16, v54
    v_and_b32 v121, s32, v54
    v_mul_f32 v122, s33, v122
    v_lshlrev_b32 v54, 16, v55
    v_and_b32 v55, s32, v55
    v_lshlrev_b32_sdwa v17, 3, v17 dst_sel:DWORD dst_unused:UNUSED_PAD src0_sel:DWORD src1_sel:WORD_1
    v_pk_fma_f32 v[120:121], v[120:121], v[122:123], s[28:29] op_sel_hi:[1,0,1]
    v_pk_fma_f32 v[54:55], v[54:55], v[122:123], s[28:29] op_sel_hi:[1,0,1]
    v_perm_b32 v120, v121, v120, s35
    v_perm_b32 v121, v55, v54, s35
    v_lshl_add_u64 v[120:121], v[120:121], 0, s[30:31]
    ds_add_rtn_u64 v[54:55], v17, v[120:121] offset:50000

    v_cvt_f32_i32_sdwa v126, sext(v18) dst_sel:DWORD dst_unused:UNUSED_PAD src0_sel:WORD_0
    v_lshlrev_b32 v124, 16, v56
    v_and_b32 v125, s32, v56
    v_mul_f32 v126, s33, v126
    v_lshlrev_b32 v56, 16, v57
    v_and_b32 v57, s32, v57
    v_lshlrev_b32_sdwa v18, 3, v18 dst_sel:DWORD dst_unused:UNUSED_PAD src0_sel:DWORD src1_sel:WORD_1
    v_pk_fma_f32 v[124:125], v[124:125], v[126:127], s[28:29] op_sel_hi:[1,0,1]
    v_pk_fma_f32 v[56:57], v[56:57], v[126:127], s[28:29] op_sel_hi:[1,0,1]
    v_perm_b32 v124, v125, v124, s35
    v_perm_b32 v125, v57, v56, s35
    v_lshl_add_u64 v[124:125], v[124:125], 0, s[30:31]
    ds_add_rtn_u64 v[56:57], v18, v[124:125] offset:50000

    v_cvt_f32_i32_sdwa v118, sext(v19) dst_sel:DWORD dst_unused:UNUSED_PAD src0_sel:WORD_0
    v_lshlrev_b32 v116, 16, v58
    v_and_b32 v117, s32, v58
    v_mul_f32 v118, s33, v118
    v_lshlrev_b32 v58, 16, v59
    v_and_b32 v59, s32, v59
    v_lshlrev_b32_sdwa v19, 3, v19 dst_sel:DWORD dst_unused:UNUSED_PAD src0_sel:DWORD src1_sel:WORD_1
    v_pk_fma_f32 v[116:117], v[116:117], v[118:119], s[28:29] op_sel_hi:[1,0,1]
    v_pk_fma_f32 v[58:59], v[58:59], v[118:119], s[28:29] op_sel_hi:[1,0,1]
    v_perm_b32 v116, v117, v116, s35
    v_perm_b32 v117, v59, v58, s35
    v_lshl_add_u64 v[116:117], v[116:117], 0, s[30:31]
    ds_add_rtn_u64 v[58:59], v19, v[116:117] offset:50000

    s_waitcnt lgkmcnt(4)
    v_or3_b32 v1, v44, v45, v1
    v_or3_b32 v1, v46, v47, v1
    v_or3_b32 v1, v48, v49, v1
    v_or3_b32 v1, v50, v51, v1
    v_cvt_f32_i32_sdwa v122, sext(v20) dst_sel:DWORD dst_unused:UNUSED_PAD src0_sel:WORD_0
    v_lshlrev_b32 v120, 16, v60
    v_and_b32 v121, s32, v60
    v_mul_f32 v122, s33, v122
    v_lshlrev_b32 v60, 16, v61
    v_and_b32 v61, s32, v61
    v_lshlrev_b32_sdwa v20, 3, v20 dst_sel:DWORD dst_unused:UNUSED_PAD src0_sel:DWORD src1_sel:WORD_1
    v_pk_fma_f32 v[120:121], v[120:121], v[122:123], s[28:29] op_sel_hi:[1,0,1]
    v_pk_fma_f32 v[60:61], v[60:61], v[122:123], s[28:29] op_sel_hi:[1,0,1]
    v_perm_b32 v120, v121, v120, s35
    v_perm_b32 v121, v61, v60, s35
    v_lshl_add_u64 v[120:121], v[120:121], 0, s[30:31]
    ds_add_rtn_u64 v[60:61], v20, v[120:121] offset:50000

    v_cvt_f32_i32_sdwa v126, sext(v21) dst_sel:DWORD dst_unused:UNUSED_PAD src0_sel:WORD_0
    v_lshlrev_b32 v124, 16, v62
    v_and_b32 v125, s32, v62
    v_mul_f32 v126, s33, v126
    v_lshlrev_b32 v62, 16, v63
    v_and_b32 v63, s32, v63
    v_lshlrev_b32_sdwa v21, 3, v21 dst_sel:DWORD dst_unused:UNUSED_PAD src0_sel:DWORD src1_sel:WORD_1
    v_pk_fma_f32 v[124:125], v[124:125], v[126:127], s[28:29] op_sel_hi:[1,0,1]
    v_pk_fma_f32 v[62:63], v[62:63], v[126:127], s[28:29] op_sel_hi:[1,0,1]
    v_perm_b32 v124, v125, v124, s35
    v_perm_b32 v125, v63, v62, s35
    v_lshl_add_u64 v[124:125], v[124:125], 0, s[30:31]
    ds_add_rtn_u64 v[62:63], v21, v[124:125] offset:50000

    v_cvt_f32_i32_sdwa v118, sext(v22) dst_sel:DWORD dst_unused:UNUSED_PAD src0_sel:WORD_0
    v_lshlrev_b32 v116, 16, v64
    v_and_b32 v117, s32, v64
    v_mul_f32 v118, s33, v118
    v_lshlrev_b32 v64, 16, v65
    v_and_b32 v65, s32, v65
    v_lshlrev_b32_sdwa v22, 3, v22 dst_sel:DWORD dst_unused:UNUSED_PAD src0_sel:DWORD src1_sel:WORD_1
    v_pk_fma_f32 v[116:117], v[116:117], v[118:119], s[28:29] op_sel_hi:[1,0,1]
    v_pk_fma_f32 v[64:65], v[64:65], v[118:119], s[28:29] op_sel_hi:[1,0,1]
    v_perm_b32 v116, v117, v116, s35
    v_perm_b32 v117, v65, v64, s35
    v_lshl_add_u64 v[116:117], v[116:117], 0, s[30:31]
    ds_add_rtn_u64 v[64:65], v22, v[116:117] offset:50000

    v_cvt_f32_i32_sdwa v122, sext(v23) dst_sel:DWORD dst_unused:UNUSED_PAD src0_sel:WORD_0
    v_lshlrev_b32 v120, 16, v66
    v_and_b32 v121, s32, v66
    v_mul_f32 v122, s33, v122
    v_lshlrev_b32 v66, 16, v67
    v_and_b32 v67, s32, v67
    v_lshlrev_b32_sdwa v23, 3, v23 dst_sel:DWORD dst_unused:UNUSED_PAD src0_sel:DWORD src1_sel:WORD_1
    v_pk_fma_f32 v[120:121], v[120:121], v[122:123], s[28:29] op_sel_hi:[1,0,1]
    v_pk_fma_f32 v[66:67], v[66:67], v[122:123], s[28:29] op_sel_hi:[1,0,1]
    v_perm_b32 v120, v121, v120, s35
    v_perm_b32 v121, v67, v66, s35
    v_lshl_add_u64 v[120:121], v[120:121], 0, s[30:31]
    ds_add_rtn_u64 v[66:67], v23, v[120:121] offset:50000

    s_waitcnt lgkmcnt(4)
    v_or3_b32 v1, v52, v53, v1
    v_or3_b32 v1, v54, v55, v1
    v_or3_b32 v1, v56, v57, v1
    v_or3_b32 v1, v58, v59, v1
    s_barrier
    v_cvt_f32_i32_sdwa v126, sext(v24) dst_sel:DWORD dst_unused:UNUSED_PAD src0_sel:WORD_0
    v_lshlrev_b32 v124, 16, v68
    v_and_b32 v125, s32, v68
    v_mul_f32 v126, s33, v126
    v_lshlrev_b32 v68, 16, v69
    v_and_b32 v69, s32, v69
    v_lshlrev_b32_sdwa v24, 3, v24 dst_sel:DWORD dst_unused:UNUSED_PAD src0_sel:DWORD src1_sel:WORD_1
    v_pk_fma_f32 v[124:125], v[124:125], v[126:127], s[28:29] op_sel_hi:[1,0,1]
    v_pk_fma_f32 v[68:69], v[68:69], v[126:127], s[28:29] op_sel_hi:[1,0,1]
    v_perm_b32 v124, v125, v124, s35
    v_perm_b32 v125, v69, v68, s35
    v_lshl_add_u64 v[124:125], v[124:125], 0, s[30:31]
    ds_add_rtn_u64 v[68:69], v24, v[124:125] offset:50000

    v_cvt_f32_i32_sdwa v118, sext(v25) dst_sel:DWORD dst_unused:UNUSED_PAD src0_sel:WORD_0
    v_lshlrev_b32 v116, 16, v70
    v_and_b32 v117, s32, v70
    v_mul_f32 v118, s33, v118
    v_lshlrev_b32 v70, 16, v71
    v_and_b32 v71, s32, v71
    v_lshlrev_b32_sdwa v25, 3, v25 dst_sel:DWORD dst_unused:UNUSED_PAD src0_sel:DWORD src1_sel:WORD_1
    v_pk_fma_f32 v[116:117], v[116:117], v[118:119], s[28:29] op_sel_hi:[1,0,1]
    v_pk_fma_f32 v[70:71], v[70:71], v[118:119], s[28:29] op_sel_hi:[1,0,1]
    v_perm_b32 v116, v117, v116, s35
    v_perm_b32 v117, v71, v70, s35
    v_lshl_add_u64 v[116:117], v[116:117], 0, s[30:31]
    ds_add_rtn_u64 v[70:71], v25, v[116:117] offset:50000

    v_cvt_f32_i32_sdwa v122, sext(v26) dst_sel:DWORD dst_unused:UNUSED_PAD src0_sel:WORD_0
    v_lshlrev_b32 v120, 16, v72
    v_and_b32 v121, s32, v72
    v_mul_f32 v122, s33, v122
    v_lshlrev_b32 v72, 16, v73
    v_and_b32 v73, s32, v73
    v_lshlrev_b32_sdwa v26, 3, v26 dst_sel:DWORD dst_unused:UNUSED_PAD src0_sel:DWORD src1_sel:WORD_1
    v_pk_fma_f32 v[120:121], v[120:121], v[122:123], s[28:29] op_sel_hi:[1,0,1]
    v_pk_fma_f32 v[72:73], v[72:73], v[122:123], s[28:29] op_sel_hi:[1,0,1]
    v_perm_b32 v120, v121, v120, s35
    v_perm_b32 v121, v73, v72, s35
    v_lshl_add_u64 v[120:121], v[120:121], 0, s[30:31]
    ds_add_rtn_u64 v[72:73], v26, v[120:121] offset:50000

    v_cvt_f32_i32_sdwa v126, sext(v27) dst_sel:DWORD dst_unused:UNUSED_PAD src0_sel:WORD_0
    v_lshlrev_b32 v124, 16, v74
    v_and_b32 v125, s32, v74
    v_mul_f32 v126, s33, v126
    v_lshlrev_b32 v74, 16, v75
    v_and_b32 v75, s32, v75
    v_lshlrev_b32_sdwa v27, 3, v27 dst_sel:DWORD dst_unused:UNUSED_PAD src0_sel:DWORD src1_sel:WORD_1
    v_pk_fma_f32 v[124:125], v[124:125], v[126:127], s[28:29] op_sel_hi:[1,0,1]
    v_pk_fma_f32 v[74:75], v[74:75], v[126:127], s[28:29] op_sel_hi:[1,0,1]
    v_perm_b32 v124, v125, v124, s35
    v_perm_b32 v125, v75, v74, s35
    v_lshl_add_u64 v[124:125], v[124:125], 0, s[30:31]
    ds_add_rtn_u64 v[74:75], v27, v[124:125] offset:50000

    s_waitcnt lgkmcnt(4)
    v_or3_b32 v1, v60, v61, v1
    v_or3_b32 v1, v62, v63, v1
    v_or3_b32 v1, v64, v65, v1
    v_or3_b32 v1, v66, v67, v1
    s_waitcnt lgkmcnt(0)
    v_or3_b32 v1, v68, v69, v1
    v_or3_b32 v1, v70, v71, v1
    v_or3_b32 v1, v72, v73, v1
    v_or3_b32 v1, v74, v75, v1
    s_cmp_le_u32 s40, 3584
    s_cbranch_scc1 L_noleft_69
    s_min_u32 s40, s40, 3968
    s_lshl_b32 s52, s38, 6
    s_add_u32 s52, s52, s36
    s_mul_i32 s52, s52, 19840
    s_add_u32 s20, s44, s52
    s_addc_u32 s21, s45, 0
    s_mul_i32 s52, s40, 5
    s_add_u32 s52, s52, 3
    s_and_b32 s22, s52, -4

    s_lshr_b32 s55, s39, 2
    s_add_u32 s55, s55, 3584
    v_and_b32 v60, 63, v0
    v_add_u32 v60, s55, v60
L_left_70:
    s_cmp_ge_u32 s55, s40
    s_cbranch_scc1 L_leftend_71
    v_mul_u32_u24 v61, 5, v60
    buffer_load_dword v62, v61, s[20:23], 0 offen
    buffer_load_ubyte v63, v61, s[20:23], 0 offen offset:4
    s_waitcnt vmcnt(0)

    v_perm_b32 v61, v63, v62, s24
    v_lshrrev_b32 v66, 30, v62
    v_and_b32 v61, 0x1fff, v61
    v_mul_u32_u24 v66, 6250, v66
    v_add_lshl_u32 v61, v61, v66, 3

    buffer_load_dwordx2 v[64:65], v61, s[8:11], s50 offen
    v_cmp_gt_u32 vcc, s40, v60
    s_waitcnt vmcnt(0)

    s_mov_b64 exec, vcc
    v_and_b32 v62, 0x3fffffff, v62
    v_cvt_f32_i32_sdwa v118, sext(v62) dst_sel:DWORD dst_unused:UNUSED_PAD src0_sel:WORD_0
    v_lshlrev_b32 v116, 16, v64
    v_and_b32 v117, s32, v64
    v_mul_f32 v118, s33, v118
    v_lshlrev_b32 v64, 16, v65
    v_and_b32 v65, s32, v65
    v_lshlrev_b32_sdwa v62, 3, v62 dst_sel:DWORD dst_unused:UNUSED_PAD src0_sel:DWORD src1_sel:WORD_1
    v_pk_fma_f32 v[116:117], v[116:117], v[118:119], s[28:29] op_sel_hi:[1,0,1]
    v_pk_fma_f32 v[64:65], v[64:65], v[118:119], s[28:29] op_sel_hi:[1,0,1]
    v_perm_b32 v116, v117, v116, s35
    v_perm_b32 v117, v65, v64, s35
    v_lshl_add_u64 v[116:117], v[116:117], 0, s[30:31]
    ds_add_rtn_u64 v[64:65], v62, v[116:117] offset:50000

    s_waitcnt lgkmcnt(0)
    v_or3_b32 v1, v64, v65, v1
    s_mov_b64 exec, -1
    v_add_u32 v60, 128, v60
    s_add_u32 s55, s55, 128
    s_branch L_left_70
L_leftend_71:

L_noleft_69:
    s_mov_b32 s38, s5
    s_cmp_lt_u32 s38, s4
    s_cbranch_scc1 L_batch_52
    s_waitcnt vmcnt(0)
    s_barrier

    s_mul_i32 s3, s37, 6400000
    s_mul_i32 s5, s36, 100000
    s_add_u32 s3, s3, s5
    s_add_u32 s3, s3, 1048576

    s_add_u32 s20, s6, s3
    s_addc_u32 s21, s7, 0
    s_mov_b32 s22, 100000
    s_mov_b32 s23, 0x20000
    v_lshlrev_b32 v68, 3, v0
    v_add_u32 v69, 50000, v68
    v_add_u32 v70, 115536, v68
    v_cmp_gt_u32 vcc, 212, v0
    v_mov_b32 v52, 0
    v_mov_b32 v53, 0

    ds_read_b64 v[28:29], v69 offset:0
    ds_read_b64 v[30:31], v69 offset:8192
    ds_read_b64 v[32:33], v69 offset:16384
    ds_read_b64 v[34:35], v69 offset:24576
    ds_read_b64 v[36:37], v69 offset:32768
    ds_read_b64 v[38:39], v69 offset:40960
    ds_read_b64 v[40:41], v69 offset:49152
    ds_read_b64 v[42:43], v69 offset:57344
    ds_read_b64 v[44:45], v70 offset:0
    ds_read_b64 v[46:47], v70 offset:8192
    ds_read_b64 v[48:49], v70 offset:16384
    ds_read_b64 v[50:51], v70 offset:24576
    s_mov_b64 exec, vcc
    ds_read_b64 v[52:53], v70 offset:32768
    s_mov_b64 exec, -1
    s_waitcnt lgkmcnt(12)
    s_mov_b32 s3, 0
    buffer_store_dwordx2 v[28:29], v68, s[20:23], s3 offen
    s_waitcnt lgkmcnt(11)
    s_mov_b32 s3, 8192
    buffer_store_dwordx2 v[30:31], v68, s[20:23], s3 offen
    s_waitcnt lgkmcnt(10)
    s_mov_b32 s3, 16384
    buffer_store_dwordx2 v[32:33], v68, s[20:23], s3 offen
    s_waitcnt lgkmcnt(9)
    s_mov_b32 s3, 24576
    buffer_store_dwordx2 v[34:35], v68, s[20:23], s3 offen
    s_waitcnt lgkmcnt(8)
    s_mov_b32 s3, 32768
    buffer_store_dwordx2 v[36:37], v68, s[20:23], s3 offen
    s_waitcnt lgkmcnt(7)
    s_mov_b32 s3, 40960
    buffer_store_dwordx2 v[38:39], v68, s[20:23], s3 offen
    s_waitcnt lgkmcnt(6)
    s_mov_b32 s3, 49152
    buffer_store_dwordx2 v[40:41], v68, s[20:23], s3 offen
    s_waitcnt lgkmcnt(5)
    s_mov_b32 s3, 57344
    buffer_store_dwordx2 v[42:43], v68, s[20:23], s3 offen
    s_waitcnt lgkmcnt(4)
    s_mov_b32 s3, 65536
    buffer_store_dwordx2 v[44:45], v68, s[20:23], s3 offen
    s_waitcnt lgkmcnt(3)
    s_mov_b32 s3, 73728
    buffer_store_dwordx2 v[46:47], v68, s[20:23], s3 offen
    s_waitcnt lgkmcnt(2)
    s_mov_b32 s3, 81920
    buffer_store_dwordx2 v[48:49], v68, s[20:23], s3 offen
    s_waitcnt lgkmcnt(1)
    s_mov_b32 s3, 90112
    buffer_store_dwordx2 v[50:51], v68, s[20:23], s3 offen
    s_waitcnt lgkmcnt(0)
    s_mov_b32 s3, 98304
    buffer_store_dwordx2 v[52:53], v68, s[20:23], s3 offen
    v_or3_b32 v1, v28, v29, v1
    v_or3_b32 v1, v30, v31, v1
    v_or3_b32 v1, v32, v33, v1
    v_or3_b32 v1, v34, v35, v1
    v_or3_b32 v1, v36, v37, v1
    v_or3_b32 v1, v38, v39, v1
    v_or3_b32 v1, v40, v41, v1
    v_or3_b32 v1, v42, v43, v1
    v_or3_b32 v1, v44, v45, v1
    v_or3_b32 v1, v46, v47, v1
    v_or3_b32 v1, v48, v49, v1
    v_or3_b32 v1, v50, v51, v1
    v_or3_b32 v1, v52, v53, v1
    v_and_b32 v1, 0x80008000, v1
    v_cmp_ne_u32 vcc, 0, v1
    v_mov_b32 v71, 150024
    v_mov_b32 v72, 1
    s_cbranch_vccz L_nf_72
    ds_write_b32 v71, v72
L_nf_72:
    s_waitcnt lgkmcnt(0)
    s_barrier
    ds_read_b32 v72, v71
    s_waitcnt lgkmcnt(0)
    v_readfirstlane_b32 s3, v72
    s_nop 1
    s_cmp_lg_u32 s3, 0
    s_cbranch_scc1 L_p2slow_51

L_fin_73:
    s_add_u32 s20, s6, 147456
    s_addc_u32 s21, s7, 0
    s_mov_b32 s22, 1024
    s_mov_b32 s23, 0x20000
    s_lshl_b32 s3, s36, 2
    s_add_u32 s3, s3, s37
    s_lshl_b32 s3, s3, 2
    v_lshlrev_b32 v73, 20, v0
    v_mov_b32 v74, s34
    buffer_store_dword v74, v73, s[20:23], s3 offen

L_p2done_50:
    s_endpgm

L_ufix_55:
    v_and_b32 v117, 63, v0
    v_lshlrev_b32 v117, 2, v117
    s_sub_i32 s54, s42, 1024
    v_cmp_le_i32 vcc, s54, v117
    s_mov_b64 exec, vcc
    v_mov_b32 v12, 0
    v_mov_b32 v44, 0
    s_mov_b64 exec, -1
    s_sub_i32 s54, s42, 1025
    v_cmp_le_i32 vcc, s54, v117
    s_mov_b64 exec, vcc
    v_mov_b32 v13, 0
    v_mov_b32 v46, 0
    s_mov_b64 exec, -1
    s_sub_i32 s54, s42, 1026
    v_cmp_le_i32 vcc, s54, v117
    s_mov_b64 exec, vcc
    v_mov_b32 v14, 0
    v_mov_b32 v48, 0
    s_mov_b64 exec, -1
    s_sub_i32 s54, s42, 1027
    v_cmp_le_i32 vcc, s54, v117
    s_mov_b64 exec, vcc
    v_mov_b32 v15, 0
    v_mov_b32 v50, 0
    s_mov_b64 exec, -1
    s_branch L_uback_56
L_ufix_57:
    v_and_b32 v117, 63, v0
    v_lshlrev_b32 v117, 2, v117
    s_sub_i32 s54, s42, 1536
    v_cmp_le_i32 vcc, s54, v117
    s_mov_b64 exec, vcc
    v_mov_b32 v16, 0
    v_mov_b32 v52, 0
    s_mov_b64 exec, -1
    s_sub_i32 s54, s42, 1537
    v_cmp_le_i32 vcc, s54, v117
    s_mov_b64 exec, vcc
    v_mov_b32 v17, 0
    v_mov_b32 v54, 0
    s_mov_b64 exec, -1
    s_sub_i32 s54, s42, 1538
    v_cmp_le_i32 vcc, s54, v117
    s_mov_b64 exec, vcc
    v_mov_b32 v18, 0
    v_mov_b32 v56, 0
    s_mov_b64 exec, -1
    s_sub_i32 s54, s42, 1539
    v_cmp_le_i32 vcc, s54, v117
    s_mov_b64 exec, vcc
    v_mov_b32 v19, 0
    v_mov_b32 v58, 0
    s_mov_b64 exec, -1
    s_branch L_uback_58
L_ufix_59:
    v_and_b32 v117, 63, v0
    v_lshlrev_b32 v117, 2, v117
    s_sub_i32 s54, s42, 2048
    v_cmp_le_i32 vcc, s54, v117
    s_mov_b64 exec, vcc
    v_mov_b32 v20, 0
    v_mov_b32 v60, 0
    s_mov_b64 exec, -1
    s_sub_i32 s54, s42, 2049
    v_cmp_le_i32 vcc, s54, v117
    s_mov_b64 exec, vcc
    v_mov_b32 v21, 0
    v_mov_b32 v62, 0
    s_mov_b64 exec, -1
    s_sub_i32 s54, s42, 2050
    v_cmp_le_i32 vcc, s54, v117
    s_mov_b64 exec, vcc
    v_mov_b32 v22, 0
    v_mov_b32 v64, 0
    s_mov_b64 exec, -1
    s_sub_i32 s54, s42, 2051
    v_cmp_le_i32 vcc, s54, v117
    s_mov_b64 exec, vcc
    v_mov_b32 v23, 0
    v_mov_b32 v66, 0
    s_mov_b64 exec, -1
    s_branch L_uback_60
L_ufix_61:
    v_and_b32 v117, 63, v0
    v_lshlrev_b32 v117, 2, v117
    s_sub_i32 s54, s42, 2560
    v_cmp_le_i32 vcc, s54, v117
    s_mov_b64 exec, vcc
    v_mov_b32 v24, 0
    v_mov_b32 v68, 0
    s_mov_b64 exec, -1
    s_sub_i32 s54, s42, 2561
    v_cmp_le_i32 vcc, s54, v117
    s_mov_b64 exec, vcc
    v_mov_b32 v25, 0
    v_mov_b32 v70, 0
    s_mov_b64 exec, -1
    s_sub_i32 s54, s42, 2562
    v_cmp_le_i32 vcc, s54, v117
    s_mov_b64 exec, vcc
    v_mov_b32 v26, 0
    v_mov_b32 v72, 0
    s_mov_b64 exec, -1
    s_sub_i32 s54, s42, 2563
    v_cmp_le_i32 vcc, s54, v117
    s_mov_b64 exec, vcc
    v_mov_b32 v27, 0
    v_mov_b32 v74, 0
    s_mov_b64 exec, -1
    s_branch L_uback_62
L_ufix_63:
    v_and_b32 v117, 63, v0
    v_lshlrev_b32 v117, 2, v117
    s_sub_i32 s54, s42, 0
    v_cmp_le_i32 vcc, s54, v117
    s_mov_b64 exec, vcc
    v_mov_b32 v4, 0
    v_mov_b32 v28, 0
    s_mov_b64 exec, -1
    s_sub_i32 s54, s42, 1
    v_cmp_le_i32 vcc, s54, v117
    s_mov_b64 exec, vcc
    v_mov_b32 v5, 0
    v_mov_b32 v30, 0
    s_mov_b64 exec, -1
    s_sub_i32 s54, s42, 2
    v_cmp_le_i32 vcc, s54, v117
    s_mov_b64 exec, vcc
    v_mov_b32 v6, 0
    v_mov_b32 v32, 0
    s_mov_b64 exec, -1
    s_sub_i32 s54, s42, 3
    v_cmp_le_i32 vcc, s54, v117
    s_mov_b64 exec, vcc
    v_mov_b32 v7, 0
    v_mov_b32 v34, 0
    s_mov_b64 exec, -1
    s_branch L_uback_64
L_ufix_65:
    v_and_b32 v117, 63, v0
    v_lshlrev_b32 v117, 2, v117
    s_sub_i32 s54, s42, 512
    v_cmp_le_i32 vcc, s54, v117
    s_mov_b64 exec, vcc
    v_mov_b32 v8, 0
    v_mov_b32 v36, 0
    s_mov_b64 exec, -1
    s_sub_i32 s54, s42, 513
    v_cmp_le_i32 vcc, s54, v117
    s_mov_b64 exec, vcc
    v_mov_b32 v9, 0
    v_mov_b32 v38, 0
    s_mov_b64 exec, -1
    s_sub_i32 s54, s42, 514
    v_cmp_le_i32 vcc, s54, v117
    s_mov_b64 exec, vcc
    v_mov_b32 v10, 0
    v_mov_b32 v40, 0
    s_mov_b64 exec, -1
    s_sub_i32 s54, s42, 515
    v_cmp_le_i32 vcc, s54, v117
    s_mov_b64 exec, vcc
    v_mov_b32 v11, 0
    v_mov_b32 v42, 0
    s_mov_b64 exec, -1
    s_branch L_uback_66
L_ufix_67:
    v_and_b32 v117, 63, v0
    v_lshlrev_b32 v117, 2, v117
    s_sub_i32 s54, s42, 3072
    v_cmp_le_i32 vcc, s54, v117
    s_mov_b64 exec, vcc
    v_mov_b32 v106, 0
    v_mov_b32 v120, 0
    s_mov_b64 exec, -1
    s_sub_i32 s54, s42, 3073
    v_cmp_le_i32 vcc, s54, v117
    s_mov_b64 exec, vcc
    v_mov_b32 v107, 0
    v_mov_b32 v122, 0
    s_mov_b64 exec, -1
    s_sub_i32 s54, s42, 3074
    v_cmp_le_i32 vcc, s54, v117
    s_mov_b64 exec, vcc
    v_mov_b32 v108, 0
    v_mov_b32 v124, 0
    s_mov_b64 exec, -1
    s_sub_i32 s54, s42, 3075
    v_cmp_le_i32 vcc, s54, v117
    s_mov_b64 exec, vcc
    v_mov_b32 v109, 0
    v_mov_b32 v126, 0
    s_mov_b64 exec, -1
    s_branch L_uback_68
L_p2slow_51:
    s_waitcnt vmcnt(0) lgkmcnt(0)
    s_mov_b32 s51, 0
    s_movk_i32 s43, 6250
    s_mov_b32 s34, 0
L_sweep_74:
    s_barrier

    v_mov_b32 v28, 0x0
    v_mov_b32 v29, 0x0
    v_mov_b32 v30, 0x0
    v_mov_b32 v31, 0x0
    v_add_u32 v32, 50000, v3
    v_add_u32 v33, 65536, v32

    ds_write_b128 v32, v[28:31] offset:0
    ds_write_b128 v32, v[28:31] offset:16384
    ds_write_b128 v32, v[28:31] offset:32768
    ds_write_b128 v32, v[28:31] offset:49152
    ds_write_b128 v33, v[28:31] offset:0
    ds_write_b128 v33, v[28:31] offset:16384
    v_cmp_gt_u32 vcc, 971, v0
    s_mov_b64 exec, vcc
    ds_write_b128 v33, v[28:31] offset:32768
    s_mov_b64 exec, -1
    s_waitcnt lgkmcnt(0)
    s_barrier
    s_sub_u32 s38, s4, 8
L_sbatch_75:
    s_lshl_b32 s52, s38, 6
    s_add_u32 s52, s52, s36
    s_lshl_b32 s52, s52, 2
    s_load_dword s40, s[46:47], s52
    s_mul_i32 s50, s38, 200000
    s_waitcnt lgkmcnt(0)

    s_min_u32 s40, s40, 3968
    s_lshl_b32 s52, s38, 6
    s_add_u32 s52, s52, s36
    s_mul_i32 s52, s52, 19840
    s_add_u32 s20, s44, s52
    s_addc_u32 s21, s45, 0
    s_mul_i32 s52, s40, 5
    s_add_u32 s52, s52, 3
    s_and_b32 s22, s52, -4

    s_lshr_b32 s55, s39, 2
    s_add_u32 s55, s55, 0
    v_and_b32 v36, 63, v0
    v_add_u32 v36, s55, v36
L_left_79:
    s_cmp_ge_u32 s55, s40
    s_cbranch_scc1 L_leftend_80
    v_mul_u32_u24 v37, 5, v36
    buffer_load_dword v38, v37, s[20:23], 0 offen
    buffer_load_ubyte v39, v37, s[20:23], 0 offen offset:4
    s_waitcnt vmcnt(0)

    v_perm_b32 v37, v39, v38, s24
    v_lshrrev_b32 v42, 30, v38
    v_and_b32 v37, 0x1fff, v37
    v_mul_u32_u24 v42, 6250, v42
    v_add_lshl_u32 v37, v37, v42, 3

    buffer_load_dwordx2 v[40:41], v37, s[8:11], s50 offen
    v_cmp_gt_u32 vcc, s40, v36
    s_waitcnt vmcnt(0)

    v_bfe_u32 v44, v38, 16, 14
    v_subrev_u32 v44, s51, v44
    v_cmp_gt_u32 s[64:65], s43, v44
    s_and_b64 exec, vcc, s[64:65]
    v_lshlrev_b32 v45, 8, v38
    v_cmpx_ne_u32 vcc, 0, v45
    v_lshlrev_b32 v44, 4, v44
    v_bfe_i32 v38, v38, 0, 16
    v_cvt_f32_i32 v38, v38
    v_mul_f32 v38, 0x38004020, v38
    v_lshlrev_b32 v45, 16, v40
    v_and_b32 v46, s32, v40
    v_lshlrev_b32 v47, 16, v41
    v_and_b32 v48, s32, v41

    v_mul_f32 v45, v45, v38
    ds_add_f32 v44, v45 offset:50000
    v_mul_f32 v46, v46, v38
    ds_add_f32 v44, v46 offset:50004
    v_mul_f32 v47, v47, v38
    ds_add_f32 v44, v47 offset:50008
    v_mul_f32 v48, v48, v38
    ds_add_f32 v44, v48 offset:50012
    s_mov_b64 exec, -1
    v_add_u32 v36, 128, v36
    s_add_u32 s55, s55, 128
    s_branch L_left_79
L_leftend_80:

    s_add_u32 s38, s38, 1
    s_cmp_lt_u32 s38, s4
    s_cbranch_scc1 L_sbatch_75
    s_mov_b32 s3, 65536
    s_load_dword s40, s[6:7], s3

    s_add_u32 s20, s6, 402907136
    s_addc_u32 s21, s7, 0
    s_mov_b32 s22, 409600000
    s_mov_b32 s23, 0x20000
    s_mov_b32 s38, 0
    s_mov_b32 s50, 200000
    v_mov_b32 v36, v0
    s_waitcnt lgkmcnt(0)
L_ovf_76:
    s_cmp_ge_u32 s38, s40
    s_cbranch_scc1 L_ovfend_77
    v_lshlrev_b32 v37, 3, v36
    buffer_load_dwordx2 v[38:39], v37, s[20:23], 0 offen
    s_waitcnt vmcnt(0)

    v_perm_b32 v37, v39, v38, s24
    v_lshrrev_b32 v42, 30, v38
    v_and_b32 v37, 0x1fff, v37
    v_mul_u32_u24 v42, 6250, v42
    v_add_lshl_u32 v37, v37, v42, 3

    v_bfe_u32 v42, v39, 24, 5
    v_mad_u32_u24 v37, v42, s50, v37
    buffer_load_dwordx2 v[40:41], v37, s[8:11], 0 offen
    v_lshrrev_b32 v42, 3, v42
    v_bfe_u32 v43, v39, 18, 6
    v_cmp_gt_u32 vcc, s40, v36
    v_cmp_eq_u32 s[64:65], s36, v43
    s_and_b64 vcc, vcc, s[64:65]
    v_cmp_eq_u32 s[64:65], s37, v42
    s_and_b64 vcc, vcc, s[64:65]
    s_waitcnt vmcnt(0)

    v_bfe_u32 v44, v38, 16, 14
    v_subrev_u32 v44, s51, v44
    v_cmp_gt_u32 s[64:65], s43, v44
    s_and_b64 exec, vcc, s[64:65]
    v_lshlrev_b32 v45, 8, v38
    v_cmpx_ne_u32 vcc, 0, v45
    v_lshlrev_b32 v44, 4, v44
    v_bfe_i32 v38, v38, 0, 16
    v_cvt_f32_i32 v38, v38
    v_mul_f32 v38, 0x38004020, v38
    v_lshlrev_b32 v45, 16, v40
    v_and_b32 v46, s32, v40
    v_lshlrev_b32 v47, 16, v41
    v_and_b32 v48, s32, v41

    v_mul_f32 v45, v45, v38
    ds_add_f32 v44, v45 offset:50000
    v_mul_f32 v46, v46, v38
    ds_add_f32 v44, v46 offset:50004
    v_mul_f32 v47, v47, v38
    ds_add_f32 v44, v47 offset:50008
    v_mul_f32 v48, v48, v38
    ds_add_f32 v44, v48 offset:50012
    s_mov_b64 exec, -1
    v_add_u32 v36, 1024, v36
    s_add_u32 s38, s38, 1024
    s_branch L_ovf_76
L_ovfend_77:
    s_waitcnt lgkmcnt(0)
    s_barrier
    s_mul_i32 s3, s37, 800000
    s_mul_i32 s5, s36, 12500
    s_add_u32 s3, s3, s5
    s_add_u32 s3, s3, s51
    s_lshl_b32 s3, s3, 4
    s_add_u32 s3, s3, 26648576

    s_add_u32 s20, s6, s3
    s_addc_u32 s21, s7, 0
    s_mov_b32 s22, 100000
    s_mov_b32 s23, 0x20000
    v_mov_b32 v36, v3
    s_mov_b32 s38, 0
L_wl_78:
    v_min_u32 v37, 100000, v36
    ds_read_b128 v[28:31], v37 offset:50000
    s_waitcnt lgkmcnt(0)
    buffer_store_dwordx4 v[28:31], v36, s[20:23], 0 offen
    s_waitcnt vmcnt(0)
    v_add_u32 v36, 16384, v36
    s_add_u32 s38, s38, 1024
    s_cmp_lt_u32 s38, 6250
    s_cbranch_scc1 L_wl_78
    s_add_u32 s51, s51, 6250
    s_cmp_lt_u32 s51, 12500
    s_cbranch_scc1 L_sweep_74
    s_branch L_fin_73

.globl standalone__molecular_angular_gemnet__graph_kernel
.p2align 8
.type standalone__molecular_angular_gemnet__graph_kernel,@function
standalone__molecular_angular_gemnet__graph_kernel:
    s_cmp_ge_u32 s2, 3200
    s_cbranch_scc1 L_fdone_81
    s_load_dwordx2 s[4:5], s[0:1], 0
    s_load_dwordx2 s[6:7], s[0:1], 24
    s_load_dwordx2 s[8:9], s[0:1], 40
    s_load_dwordx8 s[12:19], s[0:1], 56
    s_load_dwordx2 s[10:11], s[0:1], 88
    s_load_dwordx2 s[20:21], s[0:1], 104
    v_cmp_gt_u32 vcc, 250, v0
    s_mul_i32 s3, s2, 250
    v_add_u32 v0, s3, v0
    v_lshlrev_b32 v1, 4, v0
    v_lshlrev_b32 v2, 3, v0
    v_lshlrev_b32 v3, 1, v0
    s_mov_b64 exec, vcc
    s_mul_hi_u32 s3, s2, 85899346
    s_lshl_b32 s3, s3, 4
    s_add_u32 s3, s3, 147456
    s_waitcnt lgkmcnt(0)
    s_load_dwordx4 s[96:99], s[20:21], s3
    s_load_dwordx4 s[40:43], s[8:9], 0
    s_load_dwordx16 s[44:59], s[12:13], 0
    s_load_dwordx16 s[60:75], s[14:15], 0
    s_load_dwordx8 s[76:83], s[16:17], 0
    s_load_dwordx8 s[84:91], s[18:19], 0

    s_add_u32 s24, s20, 1048576
    s_addc_u32 s25, s21, 0
    s_mov_b32 s26, 76800000
    s_mov_b32 s27, 0x20000
    s_mov_b32 s28, s4
    s_mov_b32 s29, s5
    s_mov_b32 s30, 6400000
    s_mov_b32 s31, 0x20000
    s_mov_b32 s32, s6
    s_mov_b32 s33, s7
    s_mov_b32 s34, 1600000
    s_mov_b32 s35, 0x20000
    s_mov_b32 s36, s10
    s_mov_b32 s37, s11
    s_mov_b32 s38, 6400000
    s_mov_b32 s39, 0x20000
    buffer_load_ushort v4, v3, s[32:35], 0 offen
    buffer_load_dwordx2 v[32:33], v2, s[24:27], 0 offen
    s_mov_b32 s3, 6400000
    buffer_load_dwordx2 v[34:35], v2, s[24:27], s3 offen
    s_mov_b32 s3, 12800000
    buffer_load_dwordx2 v[36:37], v2, s[24:27], s3 offen
    s_mov_b32 s3, 19200000
    buffer_load_dwordx2 v[38:39], v2, s[24:27], s3 offen
    buffer_load_dwordx2 v[6:7], v2, s[28:31], 0 offen
    s_mov_b32 s94, 0xffff0000
    s_mov_b32 s95, 0xc1200000
    s_mov_b32 s22, 0x3fb8aa3b
    s_waitcnt vmcnt(5) lgkmcnt(0)
    v_lshlrev_b32 v4, 16, v4

    s_lshl_b32 s92, s40, 16
    v_subrev_f32 v16, s92, v4
    s_and_b32 s93, s40, s94
    v_subrev_f32 v17, s93, v4
    s_lshl_b32 s92, s41, 16
    v_subrev_f32 v18, s92, v4
    s_and_b32 s93, s41, s94
    v_subrev_f32 v19, s93, v4
    s_lshl_b32 s92, s42, 16
    v_subrev_f32 v20, s92, v4
    s_and_b32 s93, s42, s94
    v_subrev_f32 v21, s93, v4
    s_lshl_b32 s92, s43, 16
    v_subrev_f32 v22, s92, v4
    s_and_b32 s93, s43, s94
    v_subrev_f32 v23, s93, v4
    v_cvt_pk_bf16_f32 v16, v16, v17
    v_and_b32 v17, s94, v16
    v_lshlrev_b32 v16, 16, v16
    v_cvt_pk_bf16_f32 v18, v18, v19
    v_and_b32 v19, s94, v18
    v_lshlrev_b32 v18, 16, v18
    v_cvt_pk_bf16_f32 v20, v20, v21
    v_and_b32 v21, s94, v20
    v_lshlrev_b32 v20, 16, v20
    v_cvt_pk_bf16_f32 v22, v22, v23
    v_and_b32 v23, s94, v22
    v_lshlrev_b32 v22, 16, v22
    v_mul_f32 v16, v16, v16
    v_mul_f32 v17, v17, v17
    v_mul_f32 v18, v18, v18
    v_mul_f32 v19, v19, v19
    v_mul_f32 v20, v20, v20
    v_mul_f32 v21, v21, v21
    v_mul_f32 v22, v22, v22
    v_mul_f32 v23, v23, v23
    v_cvt_pk_bf16_f32 v16, v16, v17
    v_and_b32 v17, s94, v16
    v_lshlrev_b32 v16, 16, v16
    v_cvt_pk_bf16_f32 v18, v18, v19
    v_and_b32 v19, s94, v18
    v_lshlrev_b32 v18, 16, v18
    v_cvt_pk_bf16_f32 v20, v20, v21
    v_and_b32 v21, s94, v20
    v_lshlrev_b32 v20, 16, v20
    v_cvt_pk_bf16_f32 v22, v22, v23
    v_and_b32 v23, s94, v22
    v_lshlrev_b32 v22, 16, v22
    v_mul_f32 v16, s95, v16
    v_mul_f32 v17, s95, v17
    v_mul_f32 v18, s95, v18
    v_mul_f32 v19, s95, v19
    v_mul_f32 v20, s95, v20
    v_mul_f32 v21, s95, v21
    v_mul_f32 v22, s95, v22
    v_mul_f32 v23, s95, v23
    v_cvt_pk_bf16_f32 v16, v16, v17
    v_and_b32 v17, s94, v16
    v_lshlrev_b32 v16, 16, v16
    v_cvt_pk_bf16_f32 v18, v18, v19
    v_and_b32 v19, s94, v18
    v_lshlrev_b32 v18, 16, v18
    v_cvt_pk_bf16_f32 v20, v20, v21
    v_and_b32 v21, s94, v20
    v_lshlrev_b32 v20, 16, v20
    v_cvt_pk_bf16_f32 v22, v22, v23
    v_and_b32 v23, s94, v22
    v_lshlrev_b32 v22, 16, v22
    v_mul_f32 v16, s22, v16
    v_mul_f32 v17, s22, v17
    v_mul_f32 v18, s22, v18
    v_mul_f32 v19, s22, v19
    v_mul_f32 v20, s22, v20
    v_mul_f32 v21, s22, v21
    v_mul_f32 v22, s22, v22
    v_mul_f32 v23, s22, v23
    v_exp_f32 v16, v16
    v_exp_f32 v17, v17
    v_exp_f32 v18, v18
    v_exp_f32 v19, v19
    v_exp_f32 v20, v20
    v_exp_f32 v21, v21
    v_exp_f32 v22, v22
    v_exp_f32 v23, v23
    s_nop 0
    v_cvt_pk_bf16_f32 v16, v16, v17
    v_and_b32 v17, s94, v16
    v_lshlrev_b32 v16, 16, v16
    v_cvt_pk_bf16_f32 v18, v18, v19
    v_and_b32 v19, s94, v18
    v_lshlrev_b32 v18, 16, v18
    v_cvt_pk_bf16_f32 v20, v20, v21
    v_and_b32 v21, s94, v20
    v_lshlrev_b32 v20, 16, v20
    v_cvt_pk_bf16_f32 v22, v22, v23
    v_and_b32 v23, s94, v22
    v_lshlrev_b32 v22, 16, v22
    s_lshl_b32 s92, s60, 16
    v_mul_f32 v24, s92, v16
    s_and_b32 s93, s60, s94
    v_mul_f32 v25, s93, v16
    s_lshl_b32 s92, s61, 16
    v_mul_f32 v26, s92, v16
    s_and_b32 s93, s61, s94
    v_mul_f32 v27, s93, v16
    s_lshl_b32 s92, s62, 16
    v_fmac_f32 v24, s92, v17
    s_and_b32 s93, s62, s94
    v_fmac_f32 v25, s93, v17
    s_lshl_b32 s92, s63, 16
    v_fmac_f32 v26, s92, v17
    s_and_b32 s93, s63, s94
    v_fmac_f32 v27, s93, v17
    s_lshl_b32 s92, s64, 16
    v_fmac_f32 v24, s92, v18
    s_and_b32 s93, s64, s94
    v_fmac_f32 v25, s93, v18
    s_lshl_b32 s92, s65, 16
    v_fmac_f32 v26, s92, v18
    s_and_b32 s93, s65, s94
    v_fmac_f32 v27, s93, v18
    s_lshl_b32 s92, s66, 16
    v_fmac_f32 v24, s92, v19
    s_and_b32 s93, s66, s94
    v_fmac_f32 v25, s93, v19
    s_lshl_b32 s92, s67, 16
    v_fmac_f32 v26, s92, v19
    s_and_b32 s93, s67, s94
    v_fmac_f32 v27, s93, v19
    s_lshl_b32 s92, s68, 16
    v_fmac_f32 v24, s92, v20
    s_and_b32 s93, s68, s94
    v_fmac_f32 v25, s93, v20
    s_lshl_b32 s92, s69, 16
    v_fmac_f32 v26, s92, v20
    s_and_b32 s93, s69, s94
    v_fmac_f32 v27, s93, v20
    s_lshl_b32 s92, s70, 16
    v_fmac_f32 v24, s92, v21
    s_and_b32 s93, s70, s94
    v_fmac_f32 v25, s93, v21
    s_lshl_b32 s92, s71, 16
    v_fmac_f32 v26, s92, v21
    s_and_b32 s93, s71, s94
    v_fmac_f32 v27, s93, v21
    s_lshl_b32 s92, s72, 16
    v_fmac_f32 v24, s92, v22
    s_and_b32 s93, s72, s94
    v_fmac_f32 v25, s93, v22
    s_lshl_b32 s92, s73, 16
    v_fmac_f32 v26, s92, v22
    s_and_b32 s93, s73, s94
    v_fmac_f32 v27, s93, v22
    s_lshl_b32 s92, s74, 16
    v_fmac_f32 v24, s92, v23
    s_and_b32 s93, s74, s94
    v_fmac_f32 v25, s93, v23
    s_lshl_b32 s92, s75, 16
    v_fmac_f32 v26, s92, v23
    s_and_b32 s93, s75, s94
    v_fmac_f32 v27, s93, v23
    s_lshl_b32 s92, s44, 16
    v_mul_f32 v28, s92, v16
    s_and_b32 s93, s44, s94
    v_mul_f32 v29, s93, v16
    s_lshl_b32 s92, s45, 16
    v_mul_f32 v30, s92, v16
    s_and_b32 s93, s45, s94
    v_mul_f32 v31, s93, v16
    s_lshl_b32 s92, s46, 16
    v_fmac_f32 v28, s92, v17
    s_and_b32 s93, s46, s94
    v_fmac_f32 v29, s93, v17
    s_lshl_b32 s92, s47, 16
    v_fmac_f32 v30, s92, v17
    s_and_b32 s93, s47, s94
    v_fmac_f32 v31, s93, v17
    s_lshl_b32 s92, s48, 16
    v_fmac_f32 v28, s92, v18
    s_and_b32 s93, s48, s94
    v_fmac_f32 v29, s93, v18
    s_lshl_b32 s92, s49, 16
    v_fmac_f32 v30, s92, v18
    s_and_b32 s93, s49, s94
    v_fmac_f32 v31, s93, v18
    s_lshl_b32 s92, s50, 16
    v_fmac_f32 v28, s92, v19
    s_and_b32 s93, s50, s94
    v_fmac_f32 v29, s93, v19
    s_lshl_b32 s92, s51, 16
    v_fmac_f32 v30, s92, v19
    s_and_b32 s93, s51, s94
    v_fmac_f32 v31, s93, v19
    s_lshl_b32 s92, s52, 16
    v_fmac_f32 v28, s92, v20
    s_and_b32 s93, s52, s94
    v_fmac_f32 v29, s93, v20
    s_lshl_b32 s92, s53, 16
    v_fmac_f32 v30, s92, v20
    s_and_b32 s93, s53, s94
    v_fmac_f32 v31, s93, v20
    s_lshl_b32 s92, s54, 16
    v_fmac_f32 v28, s92, v21
    s_and_b32 s93, s54, s94
    v_fmac_f32 v29, s93, v21
    s_lshl_b32 s92, s55, 16
    v_fmac_f32 v30, s92, v21
    s_and_b32 s93, s55, s94
    v_fmac_f32 v31, s93, v21
    s_lshl_b32 s92, s56, 16
    v_fmac_f32 v28, s92, v22
    s_and_b32 s93, s56, s94
    v_fmac_f32 v29, s93, v22
    s_lshl_b32 s92, s57, 16
    v_fmac_f32 v30, s92, v22
    s_and_b32 s93, s57, s94
    v_fmac_f32 v31, s93, v22
    s_lshl_b32 s92, s58, 16
    v_fmac_f32 v28, s92, v23
    s_and_b32 s93, s58, s94
    v_fmac_f32 v29, s93, v23
    s_lshl_b32 s92, s59, 16
    v_fmac_f32 v30, s92, v23
    s_and_b32 s93, s59, s94
    v_fmac_f32 v31, s93, v23
    v_cvt_pk_bf16_f32 v28, v28, v29
    v_and_b32 v29, s94, v28
    v_lshlrev_b32 v28, 16, v28
    v_cvt_pk_bf16_f32 v30, v30, v31
    v_and_b32 v31, s94, v30
    v_lshlrev_b32 v30, 16, v30
    s_waitcnt vmcnt(1)
    v_mov_b32 v8, 0
    v_mov_b32 v9, 0
    v_mov_b32 v10, 0
    v_mov_b32 v11, 0
    s_cmp_eq_u32 s96, 0
    s_cbranch_scc1 L_ffl_82
    v_cvt_f32_u32_sdwa v12, v32 dst_sel:DWORD dst_unused:UNUSED_PAD src0_sel:WORD_0
    v_cvt_f32_u32_sdwa v13, v32 dst_sel:DWORD dst_unused:UNUSED_PAD src0_sel:WORD_1
    v_cvt_f32_u32_sdwa v14, v33 dst_sel:DWORD dst_unused:UNUSED_PAD src0_sel:WORD_0
    v_cvt_f32_u32_sdwa v15, v33 dst_sel:DWORD dst_unused:UNUSED_PAD src0_sel:WORD_1
    v_add_f32 v12, 0xc6800000, v12
    v_add_f32 v13, 0xc6800000, v13
    v_add_f32 v14, 0xc6800000, v14
    v_add_f32 v15, 0xc6800000, v15
    v_fmac_f32 v8, s96, v12
    v_fmac_f32 v9, s96, v13
    v_fmac_f32 v10, s96, v14
    v_fmac_f32 v11, s96, v15
L_fbk_83:
    s_cmp_eq_u32 s97, 0
    s_cbranch_scc1 L_ffl_84
    v_cvt_f32_u32_sdwa v12, v34 dst_sel:DWORD dst_unused:UNUSED_PAD src0_sel:WORD_0
    v_cvt_f32_u32_sdwa v13, v34 dst_sel:DWORD dst_unused:UNUSED_PAD src0_sel:WORD_1
    v_cvt_f32_u32_sdwa v14, v35 dst_sel:DWORD dst_unused:UNUSED_PAD src0_sel:WORD_0
    v_cvt_f32_u32_sdwa v15, v35 dst_sel:DWORD dst_unused:UNUSED_PAD src0_sel:WORD_1
    v_add_f32 v12, 0xc6800000, v12
    v_add_f32 v13, 0xc6800000, v13
    v_add_f32 v14, 0xc6800000, v14
    v_add_f32 v15, 0xc6800000, v15
    v_fmac_f32 v8, s97, v12
    v_fmac_f32 v9, s97, v13
    v_fmac_f32 v10, s97, v14
    v_fmac_f32 v11, s97, v15
L_fbk_85:
    s_cmp_eq_u32 s98, 0
    s_cbranch_scc1 L_ffl_86
    v_cvt_f32_u32_sdwa v12, v36 dst_sel:DWORD dst_unused:UNUSED_PAD src0_sel:WORD_0
    v_cvt_f32_u32_sdwa v13, v36 dst_sel:DWORD dst_unused:UNUSED_PAD src0_sel:WORD_1
    v_cvt_f32_u32_sdwa v14, v37 dst_sel:DWORD dst_unused:UNUSED_PAD src0_sel:WORD_0
    v_cvt_f32_u32_sdwa v15, v37 dst_sel:DWORD dst_unused:UNUSED_PAD src0_sel:WORD_1
    v_add_f32 v12, 0xc6800000, v12
    v_add_f32 v13, 0xc6800000, v13
    v_add_f32 v14, 0xc6800000, v14
    v_add_f32 v15, 0xc6800000, v15
    v_fmac_f32 v8, s98, v12
    v_fmac_f32 v9, s98, v13
    v_fmac_f32 v10, s98, v14
    v_fmac_f32 v11, s98, v15
L_fbk_87:
    s_cmp_eq_u32 s99, 0
    s_cbranch_scc1 L_ffl_88
    v_cvt_f32_u32_sdwa v12, v38 dst_sel:DWORD dst_unused:UNUSED_PAD src0_sel:WORD_0
    v_cvt_f32_u32_sdwa v13, v38 dst_sel:DWORD dst_unused:UNUSED_PAD src0_sel:WORD_1
    v_cvt_f32_u32_sdwa v14, v39 dst_sel:DWORD dst_unused:UNUSED_PAD src0_sel:WORD_0
    v_cvt_f32_u32_sdwa v15, v39 dst_sel:DWORD dst_unused:UNUSED_PAD src0_sel:WORD_1
    v_add_f32 v12, 0xc6800000, v12
    v_add_f32 v13, 0xc6800000, v13
    v_add_f32 v14, 0xc6800000, v14
    v_add_f32 v15, 0xc6800000, v15
    v_fmac_f32 v8, s99, v12
    v_fmac_f32 v9, s99, v13
    v_fmac_f32 v10, s99, v14
    v_fmac_f32 v11, s99, v15
L_fbk_89:
    s_lshl_b32 s92, s76, 16
    v_mul_f32 v16, s92, v8
    s_and_b32 s93, s76, s94
    v_mul_f32 v17, s93, v8
    s_lshl_b32 s92, s77, 16
    v_mul_f32 v18, s92, v8
    s_and_b32 s93, s77, s94
    v_mul_f32 v19, s93, v8
    s_lshl_b32 s92, s78, 16
    v_fmac_f32 v16, s92, v9
    s_and_b32 s93, s78, s94
    v_fmac_f32 v17, s93, v9
    s_lshl_b32 s92, s79, 16
    v_fmac_f32 v18, s92, v9
    s_and_b32 s93, s79, s94
    v_fmac_f32 v19, s93, v9
    s_lshl_b32 s92, s80, 16
    v_fmac_f32 v16, s92, v10
    s_and_b32 s93, s80, s94
    v_fmac_f32 v17, s93, v10
    s_lshl_b32 s92, s81, 16
    v_fmac_f32 v18, s92, v10
    s_and_b32 s93, s81, s94
    v_fmac_f32 v19, s93, v10
    s_lshl_b32 s92, s82, 16
    v_fmac_f32 v16, s92, v11
    s_and_b32 s93, s82, s94
    v_fmac_f32 v17, s93, v11
    s_lshl_b32 s92, s83, 16
    v_fmac_f32 v18, s92, v11
    s_and_b32 s93, s83, s94
    v_fmac_f32 v19, s93, v11
    v_mul_f32 v16, v16, v24
    v_mul_f32 v17, v17, v25
    v_mul_f32 v18, v18, v26
    v_mul_f32 v19, v19, v27
    v_cvt_pk_bf16_f32 v16, v16, v17
    v_and_b32 v17, s94, v16
    v_lshlrev_b32 v16, 16, v16
    v_cvt_pk_bf16_f32 v18, v18, v19
    v_and_b32 v19, s94, v18
    v_lshlrev_b32 v18, 16, v18
    s_lshl_b32 s92, s84, 16
    v_mul_f32 v20, s92, v16
    s_and_b32 s93, s84, s94
    v_mul_f32 v21, s93, v16
    s_lshl_b32 s92, s85, 16
    v_mul_f32 v22, s92, v16
    s_and_b32 s93, s85, s94
    v_mul_f32 v23, s93, v16
    s_lshl_b32 s92, s86, 16
    v_fmac_f32 v20, s92, v17
    s_and_b32 s93, s86, s94
    v_fmac_f32 v21, s93, v17
    s_lshl_b32 s92, s87, 16
    v_fmac_f32 v22, s92, v17
    s_and_b32 s93, s87, s94
    v_fmac_f32 v23, s93, v17
    s_lshl_b32 s92, s88, 16
    v_fmac_f32 v20, s92, v18
    s_and_b32 s93, s88, s94
    v_fmac_f32 v21, s93, v18
    s_lshl_b32 s92, s89, 16
    v_fmac_f32 v22, s92, v18
    s_and_b32 s93, s89, s94
    v_fmac_f32 v23, s93, v18
    s_lshl_b32 s92, s90, 16
    v_fmac_f32 v20, s92, v19
    s_and_b32 s93, s90, s94
    v_fmac_f32 v21, s93, v19
    s_lshl_b32 s92, s91, 16
    v_fmac_f32 v22, s92, v19
    s_and_b32 s93, s91, s94
    v_fmac_f32 v23, s93, v19
    v_cvt_pk_bf16_f32 v20, v20, v21
    v_and_b32 v21, s94, v20
    v_lshlrev_b32 v20, 16, v20
    v_cvt_pk_bf16_f32 v22, v22, v23
    v_and_b32 v23, s94, v22
    v_lshlrev_b32 v22, 16, v22
    v_mul_f32 v20, v20, v28
    v_mul_f32 v21, v21, v29
    v_mul_f32 v22, v22, v30
    v_mul_f32 v23, v23, v31
    v_cvt_pk_bf16_f32 v20, v20, v21
    v_and_b32 v21, s94, v20
    v_lshlrev_b32 v20, 16, v20
    v_cvt_pk_bf16_f32 v22, v22, v23
    v_and_b32 v23, s94, v22
    v_lshlrev_b32 v22, 16, v22
    s_waitcnt vmcnt(0)
    v_lshlrev_b32 v8, 16, v6
    v_and_b32 v9, s94, v6
    v_lshlrev_b32 v10, 16, v7
    v_and_b32 v11, s94, v7

    v_add_f32 v8, v8, v20
    v_add_f32 v9, v9, v21
    v_add_f32 v10, v10, v22
    v_add_f32 v11, v11, v23
    v_cvt_pk_bf16_f32 v12, v8, v9
    v_cvt_pk_bf16_f32 v13, v10, v11
    buffer_store_dwordx2 v[12:13], v2, s[36:39], 0 offen
L_fdone_81:
    s_endpgm

L_ffl_82:
    s_mov_b32 s3, 25600000
    buffer_load_dwordx4 v[12:15], v1, s[24:27], s3 offen
    s_waitcnt vmcnt(0)
    v_add_f32 v8, v8, v12
    v_add_f32 v9, v9, v13
    v_add_f32 v10, v10, v14
    v_add_f32 v11, v11, v15
    s_branch L_fbk_83

L_ffl_84:
    s_mov_b32 s3, 38400000
    buffer_load_dwordx4 v[12:15], v1, s[24:27], s3 offen
    s_waitcnt vmcnt(0)
    v_add_f32 v8, v8, v12
    v_add_f32 v9, v9, v13
    v_add_f32 v10, v10, v14
    v_add_f32 v11, v11, v15
    s_branch L_fbk_85

L_ffl_86:
    s_mov_b32 s3, 51200000
    buffer_load_dwordx4 v[12:15], v1, s[24:27], s3 offen
    s_waitcnt vmcnt(0)
    v_add_f32 v8, v8, v12
    v_add_f32 v9, v9, v13
    v_add_f32 v10, v10, v14
    v_add_f32 v11, v11, v15
    s_branch L_fbk_87

L_ffl_88:
    s_mov_b32 s3, 64000000
    buffer_load_dwordx4 v[12:15], v1, s[24:27], s3 offen
    s_waitcnt vmcnt(0)
    v_add_f32 v8, v8, v12
    v_add_f32 v9, v9, v13
    v_add_f32 v10, v10, v14
    v_add_f32 v11, v11, v15
    s_branch L_fbk_89

.section .rodata,"a"
.p2align 6
.amdhsa_kernel g1_kernel
  .amdhsa_next_free_vgpr 128
  .amdhsa_next_free_sgpr 102
  .amdhsa_accum_offset 128
  .amdhsa_group_segment_fixed_size 0
  .amdhsa_kernarg_size 112
  .amdhsa_user_sgpr_count 2
  .amdhsa_user_sgpr_kernarg_segment_ptr 1
  .amdhsa_system_sgpr_workgroup_id_x 1
.end_amdhsa_kernel
.p2align 6
.amdhsa_kernel g2_kernel
  .amdhsa_next_free_vgpr 128
  .amdhsa_next_free_sgpr 102
  .amdhsa_accum_offset 128
  .amdhsa_group_segment_fixed_size 0
  .amdhsa_kernarg_size 112
  .amdhsa_user_sgpr_count 2
  .amdhsa_user_sgpr_kernarg_segment_ptr 1
  .amdhsa_system_sgpr_workgroup_id_x 1
  .amdhsa_float_denorm_mode_32 3
.end_amdhsa_kernel
.p2align 6
.amdhsa_kernel standalone__molecular_angular_gemnet__graph_kernel
  .amdhsa_next_free_vgpr 40
  .amdhsa_next_free_sgpr 100
  .amdhsa_accum_offset 40
  .amdhsa_group_segment_fixed_size 0
  .amdhsa_kernarg_size 112
  .amdhsa_user_sgpr_count 2
  .amdhsa_user_sgpr_kernarg_segment_ptr 1
  .amdhsa_system_sgpr_workgroup_id_x 1
  .amdhsa_float_denorm_mode_32 3
.end_amdhsa_kernel
```

```asm
; @launch kernel=g1_kernel grid=(256,1,1) block=(1024,1,1) lds=163840
; @launch kernel=g2_kernel grid=(256,1,1) block=(1024,1,1) lds=163840
; @launch kernel=standalone__molecular_angular_gemnet__graph_kernel grid=(3200,1,1) block=(256,1,1) lds=0
.amdgcn_target "amdgcn-amd-amdhsa--gfx950"
.text
.globl g1_kernel
.p2align 8
.type g1_kernel,@function
g1_kernel:
    s_cmp_ge_u32 s2, 256
    s_cbranch_scc1 L_p1done_1
    s_load_dwordx4 s[80:83], s[0:1], 8
    s_load_dwordx2 s[84:85], s[0:1], 32
    s_load_dwordx2 s[86:87], s[0:1], 48
    s_load_dwordx4 s[4:7], s[0:1], 96
    s_load_dwordx2 s[78:79], s[0:1], 0
    v_lshlrev_b32 v1, 4, v0
    v_lshlrev_b32 v2, 3, v0
    v_lshlrev_b32 v98, 20, v0
    s_waitcnt lgkmcnt(0)
    s_load_dword s88, s[86:87], 0

    s_mov_b32 s96, s4
    s_mov_b32 s97, s5
    s_mov_b32 s98, 256
    s_mov_b32 s99, 0x20000
    v_readfirstlane_b32 s74, v0
    s_nop 1
    s_or_b32 s74, s74, s2
    s_cbranch_scc1 L_noinit_2

    v_mov_b32 v110, 1
    buffer_atomic_add v110, v98, s[96:99], 0 offen offset:64 sc0
    s_waitcnt vmcnt(0)
    v_readfirstlane_b32 s74, v110
    s_nop 1
    s_cmp_lg_u32 s74, 0
    s_cbranch_scc1 L_zno_4

    s_mov_b32 s92, s6
    s_mov_b32 s93, s7
    s_mov_b32 s94, 65552
    s_mov_b32 s95, 0x20000
    v_mov_b32 v110, 0
    v_mov_b32 v111, 0
    v_mov_b32 v112, 0
    v_mov_b32 v113, 0
L_zl_3:
    buffer_store_dwordx4 v[110:113], v1, s[92:95], s74 offen sc0 sc1
    s_add_u32 s74, s74, 1024
    s_cmp_le_u32 s74, 65536
    s_cbranch_scc1 L_zl_3
    v_mov_b32 v114, 1
    s_waitcnt vmcnt(0)
    buffer_atomic_add v114, v98, s[96:99], 0 offen offset:128
L_zno_4:

L_noinit_2:
    s_mov_b32 s20, s78
    s_mov_b32 s21, s79
    s_mov_b32 s22, 6400000
    s_mov_b32 s23, 0x20000
    v_mul_u32_u24 v110, 6240, v0
    v_and_b32 v111, 63, v0
    v_and_b32 v112, 0x3c0, v0
    v_lshlrev_b32 v111, 2, v111
    v_lshl_or_b32 v111, v112, 4, v111
    v_lshlrev_b32 v100, 2, v0
    s_lshr_b32 s50, s2, 1
    s_and_b32 s53, s2, 1
    s_mul_i32 s3, s50, 50000
    s_mul_i32 s54, s53, 24576
    s_add_u32 s3, s3, s54

    buffer_load_dwordx4 v[56:59], v110, s[20:23], 0 offen
    s_add_u32 s20, s78, s3
    s_addc_u32 s21, s79, 0
    s_mov_b32 s22, 24576
    s_mov_b32 s23, 0x20000
    s_movk_i32 s3, 16384
    buffer_load_dword v44, v111, s[20:23], 0 offen offset:0
    buffer_load_dword v45, v111, s[20:23], 0 offen offset:256
    buffer_load_dword v46, v111, s[20:23], 0 offen offset:512
    buffer_load_dword v47, v111, s[20:23], 0 offen offset:768
    buffer_load_dword v48, v111, s[20:23], s3 offen offset:0
    buffer_load_dword v49, v111, s[20:23], s3 offen offset:256
    buffer_load_dword v50, v111, s[20:23], s3 offen offset:512
    buffer_load_dword v51, v111, s[20:23], s3 offen offset:768
    s_mul_i32 s22, s53, 25424
    s_movk_i32 s3, 24576

    buffer_load_dword v52, v100, s[20:23], s3 offen
    s_mul_i32 s3, s50, 50048
    s_add_u32 s3, s3, s54
    s_add_u32 s54, s3, 393216

    s_mov_b32 s8, s80
    s_mov_b32 s9, s81
    s_mov_b32 s10, 0
    s_mov_b32 s11, 0x20000
    s_mov_b32 s12, s82
    s_mov_b32 s13, s83
    s_mov_b32 s14, 0
    s_mov_b32 s15, 0x20000
    s_mov_b32 s16, s84
    s_mov_b32 s17, s85
    s_mov_b32 s18, 0
    s_mov_b32 s19, 0x20000
    s_lshr_b32 s74, s2, 1
    s_and_b32 s74, s74, 28
    s_lshr_b32 s29, 0x00102010, s74
    s_lshr_b32 s30, 0x44414241, s74
    s_lshr_b32 s41, 0x43221100, s74
    s_and_b32 s29, s29, 15
    s_and_b32 s30, s30, 15
    s_and_b32 s41, s41, 15
    s_lshr_b32 s74, s2, 6
    s_lshl_b32 s74, s74, 3
    s_and_b32 s75, s2, 7
    s_add_u32 s74, s74, s75
    s_mul_i32 s74, s74, 5
    s_add_u32 s41, s41, s74
    s_sub_u32 s74, s30, s29
    s_bfm_b32 s28, s74, s29
    s_lshl_b32 s29, s29, 12
    s_lshl_b32 s30, s30, 12
    s_min_u32 s30, s30, 16000

    s_mul_i32 s78, s41, 16000
    s_add_u32 s49, s78, 16000
    s_cmp_ge_u32 s41, 3200
    s_cmovk_i32 s49, 0
    s_cmovk_i32 s78, 0
    s_lshl_b32 s10, s49, 2
    s_lshl_b32 s14, s49, 2
    s_lshl_b32 s18, s49, 1
    s_lshl_b32 s56, s78, 2
    s_lshl_b32 s61, s78, 1

    s_add_u32 s57, s56, 16384
    s_add_u32 s62, s61, 8192
    s_add_u32 s58, s56, 32768
    s_add_u32 s63, s61, 16384
    s_add_u32 s59, s56, 49152
    s_add_u32 s64, s61, 24576
    s_bitcmp1_b32 s28, 0
    s_cselect_b32 s56, s56, 0x7ff00000
    s_cselect_b32 s61, s61, 0x7ff00000

    s_bitcmp1_b32 s28, 1
    s_cselect_b32 s57, s57, 0x7ff00000
    s_cselect_b32 s62, s62, 0x7ff00000

    s_bitcmp1_b32 s28, 2
    s_cselect_b32 s58, s58, 0x7ff00000
    s_cselect_b32 s63, s63, 0x7ff00000

    s_bitcmp1_b32 s28, 3
    s_cselect_b32 s59, s59, 0x7ff00000
    s_cselect_b32 s64, s64, 0x7ff00000

    buffer_load_dwordx4 v[20:23], v1, s[12:15], s56 offen nt
    buffer_load_dwordx4 v[4:7], v1, s[8:11], s56 offen nt
    buffer_load_dwordx2 v[36:37], v2, s[16:19], s61 offen nt
    buffer_load_dwordx4 v[24:27], v1, s[12:15], s57 offen nt
    buffer_load_dwordx4 v[8:11], v1, s[8:11], s57 offen nt
    buffer_load_dwordx2 v[38:39], v2, s[16:19], s62 offen nt
    buffer_load_dwordx4 v[28:31], v1, s[12:15], s58 offen nt
    buffer_load_dwordx4 v[12:15], v1, s[8:11], s58 offen nt
    buffer_load_dwordx2 v[40:41], v2, s[16:19], s63 offen nt
    buffer_load_dwordx4 v[32:35], v1, s[12:15], s59 offen nt
    buffer_load_dwordx4 v[16:19], v1, s[8:11], s59 offen nt
    buffer_load_dwordx2 v[42:43], v2, s[16:19], s64 offen nt
    s_and_b32 s5, s2, 7
    s_mul_i32 s3, s5, 8192

    s_add_u32 s20, s6, s3
    s_addc_u32 s21, s7, 0
    s_mov_b32 s22, 8192
    s_mov_b32 s23, 0x20000
    s_mul_i32 s3, s5, 40632320
    s_add_u32 s3, s3, 83599360
    s_add_u32 s24, s6, s3
    s_addc_u32 s25, s7, 0
    s_mov_b32 s26, 40632320
    s_mov_b32 s27, 0x20000
    s_add_u32 s32, s6, 408657920
    s_addc_u32 s33, s7, 0
    s_mov_b32 s34, 409600000
    s_mov_b32 s35, 0x20000
    s_add_u32 s36, s6, 65536
    s_addc_u32 s37, s7, 0
    s_mov_b32 s38, 4
    s_mov_b32 s39, 0x20000
    s_mov_b32 s40, 687195
    s_mov_b32 s42, -6250
    s_mov_b32 s43, 1942
    s_mov_b32 s45, 0x06050400
    s_mov_b32 s46, 0x05040c00
    s_mov_b32 s47, 0x04020100
    s_mov_b32 s48, 3968
    s_sub_u32 s50, 0, s29
    v_mov_b32 v104, 1
    v_mov_b32 v105, 0x46ff8000
    s_mov_b32 s55, 0x05040100
    v_mul_u32_u24 v106, 5, v0
    v_mov_b32 v108, 16384
    v_mov_b32 v114, 0
    v_mov_b32 v115, 0
    v_mov_b32 v116, 0
    v_mov_b32 v117, -1
    ds_write_b64 v2, v[114:115]
    s_lshl_b32 s74, s29, 3
    s_lshl_b32 s75, s30, 3
    v_mov_b32 v118, 128000
    v_mov_b32 v119, s74
    v_mov_b32 v120, s75
    s_movk_i32 s3, 928
    v_cmp_gt_u32 s[66:67], s3, v0
    s_movk_i32 s3, 640
    v_cmp_gt_u32 s[68:69], s3, v0
    s_mov_b64 exec, 1
    ds_write_b128 v108, v[114:117]
    ds_write_b32 v118, v117 offset:16404
    ds_write_b32 v119, v117 offset:16396
    ds_write_b32 v120, v117 offset:16404
    s_mov_b64 exec, -1
    s_waitcnt lgkmcnt(0)
    s_lshl_b32 s88, s88, 16
    v_mov_b32 v110, 0.15915494
    v_mul_f32 v110, s88, v110
    s_mov_b32 s3, 0x7fff7fff
    v_readfirstlane_b32 s44, v110

    s_waitcnt vmcnt(12)
    v_mov_b32 v61, 0
    v_mov_b32 v62, 0
    v_mov_b32 v63, 0
    v_dot2_f32_bf16 v61, v44, v44, v61
    v_dot2_f32_bf16 v61, v45, v45, v61
    v_dot2_f32_bf16 v61, v46, v46, v61
    v_dot2_f32_bf16 v61, v47, v47, v61
    v_dot2_f32_bf16 v61, v48, v48, v61
    v_dot2_f32_bf16 v61, v49, v49, v61
    v_dot2_f32_bf16 v61, v50, v50, v61
    v_dot2_f32_bf16 v61, v51, v51, v61
    v_dot2_f32_bf16 v61, v52, v52, v61
    v_dot2_f32_bf16 v62, v56, v56, v62
    v_dot2_f32_bf16 v62, v57, v57, v62
    v_dot2_f32_bf16 v62, v58, v58, v62
    v_dot2_f32_bf16 v62, v59, v59, v62
    v_and_b32 v60, s3, v44
    v_and_b32 v64, s3, v45
    v_pk_max_u16 v60, v60, v64
    v_and_b32 v64, s3, v46
    v_pk_max_u16 v60, v60, v64
    v_and_b32 v64, s3, v47
    v_pk_max_u16 v60, v60, v64
    v_and_b32 v64, s3, v48
    v_pk_max_u16 v60, v60, v64
    v_and_b32 v64, s3, v49
    v_pk_max_u16 v60, v60, v64
    v_and_b32 v64, s3, v50
    v_pk_max_u16 v60, v60, v64
    v_and_b32 v64, s3, v51
    v_pk_max_u16 v60, v60, v64
    v_and_b32 v64, s3, v52
    v_pk_max_u16 v60, v60, v64
    v_lshrrev_b32 v64, 16, v60
    v_and_b32 v60, 0xffff, v60
    v_max_u32 v60, v60, v64

    s_nop 1
    v_max_u32_dpp v60, v60, v60 row_shr:1 row_mask:0xf bank_mask:0xf
    s_nop 1
    v_max_u32_dpp v60, v60, v60 row_shr:2 row_mask:0xf bank_mask:0xf
    s_nop 1
    v_max_u32_dpp v60, v60, v60 row_shr:4 row_mask:0xf bank_mask:0xf
    s_nop 1
    v_max_u32_dpp v60, v60, v60 row_shr:8 row_mask:0xf bank_mask:0xf
    s_nop 1
    v_max_u32_dpp v60, v60, v60 row_bcast:15 row_mask:0xa bank_mask:0xf
    s_nop 1
    v_max_u32_dpp v60, v60, v60 row_bcast:31 row_mask:0xc bank_mask:0xf
    s_nop 1
    v_add_f32_dpp v61, v61, v61 row_shr:1 row_mask:0xf bank_mask:0xf
    s_nop 1
    v_add_f32_dpp v61, v61, v61 row_shr:2 row_mask:0xf bank_mask:0xf
    s_nop 1
    v_add_f32_dpp v61, v61, v61 row_shr:4 row_mask:0xf bank_mask:0xf
    s_nop 1
    v_add_f32_dpp v61, v61, v61 row_shr:8 row_mask:0xf bank_mask:0xf
    s_nop 1
    v_add_f32_dpp v61, v61, v61 row_bcast:15 row_mask:0xa bank_mask:0xf
    s_nop 1
    v_add_f32_dpp v61, v61, v61 row_bcast:31 row_mask:0xc bank_mask:0xf
    s_nop 1
    v_add_f32_dpp v62, v62, v62 row_shr:1 row_mask:0xf bank_mask:0xf
    s_nop 1
    v_add_f32_dpp v62, v62, v62 row_shr:2 row_mask:0xf bank_mask:0xf
    s_nop 1
    v_add_f32_dpp v62, v62, v62 row_shr:4 row_mask:0xf bank_mask:0xf
    s_nop 1
    v_add_f32_dpp v62, v62, v62 row_shr:8 row_mask:0xf bank_mask:0xf
    s_nop 1
    v_add_f32_dpp v62, v62, v62 row_bcast:15 row_mask:0xa bank_mask:0xf
    s_nop 1
    v_add_f32_dpp v62, v62, v62 row_bcast:31 row_mask:0xc bank_mask:0xf
    v_lshrrev_b32 v64, 6, v0
    v_lshlrev_b32 v64, 4, v64
    s_mov_b32 exec_lo, 0
    s_brev_b32 exec_hi, 1
    ds_write_b128 v64, v[60:63] offset:8192
    s_mov_b64 exec, -1
    v_and_b32 v64, 15, v0
    v_lshlrev_b32 v64, 4, v64
    s_waitcnt lgkmcnt(0)
    s_barrier
    ds_read_b128 v[60:63], v64 offset:8192
    s_waitcnt lgkmcnt(0)

    s_nop 0
    v_max_u32_dpp v60, v60, v60 row_ror:1 row_mask:0xf bank_mask:0xf
    v_add_f32_dpp v61, v61, v61 row_ror:1 row_mask:0xf bank_mask:0xf
    v_add_f32_dpp v62, v62, v62 row_ror:1 row_mask:0xf bank_mask:0xf

    s_nop 0
    v_max_u32_dpp v60, v60, v60 row_ror:2 row_mask:0xf bank_mask:0xf
    v_add_f32_dpp v61, v61, v61 row_ror:2 row_mask:0xf bank_mask:0xf
    v_add_f32_dpp v62, v62, v62 row_ror:2 row_mask:0xf bank_mask:0xf

    s_nop 0
    v_max_u32_dpp v60, v60, v60 row_ror:4 row_mask:0xf bank_mask:0xf
    v_add_f32_dpp v61, v61, v61 row_ror:4 row_mask:0xf bank_mask:0xf
    v_add_f32_dpp v62, v62, v62 row_ror:4 row_mask:0xf bank_mask:0xf

    s_nop 0
    v_max_u32_dpp v60, v60, v60 row_ror:8 row_mask:0xf bank_mask:0xf
    v_add_f32_dpp v61, v61, v61 row_ror:8 row_mask:0xf bank_mask:0xf
    v_add_f32_dpp v62, v62, v62 row_ror:8 row_mask:0xf bank_mask:0xf

    v_rsq_f32 v62, v62
    v_mov_b32 v65, 0x4b400000
    v_mul_f32 v62, 0x4806b64a, v62
    s_nop 0
    v_readfirstlane_b32 s74, v62

    s_add_u32 s92, s6, 135168
    s_addc_u32 s93, s7, 0
    s_mov_b32 s94, 4096
    s_mov_b32 s95, 0x20000
    s_lshl_b32 s3, s2, 4
    buffer_store_dwordx4 v[60:63], v98, s[92:95], s3 offen
    v_lshlrev_b32 v66, 16, v44
    v_and_b32 v44, 0xffff0000, v44
    v_fma_f32 v66, v66, s74, v65
    v_fma_f32 v44, v44, s74, v65
    v_perm_b32 v44, v44, v66, s55

    v_lshlrev_b32 v66, 16, v45
    v_and_b32 v45, 0xffff0000, v45
    v_fma_f32 v66, v66, s74, v65
    v_fma_f32 v45, v45, s74, v65
    v_perm_b32 v45, v45, v66, s55

    v_lshlrev_b32 v66, 16, v46
    v_and_b32 v46, 0xffff0000, v46
    v_fma_f32 v66, v66, s74, v65
    v_fma_f32 v46, v46, s74, v65
    v_perm_b32 v46, v46, v66, s55

    v_lshlrev_b32 v66, 16, v47
    v_and_b32 v47, 0xffff0000, v47
    v_fma_f32 v66, v66, s74, v65
    v_fma_f32 v47, v47, s74, v65
    v_perm_b32 v47, v47, v66, s55

    v_lshlrev_b32 v66, 16, v48
    v_and_b32 v48, 0xffff0000, v48
    v_fma_f32 v66, v66, s74, v65
    v_fma_f32 v48, v48, s74, v65
    v_perm_b32 v48, v48, v66, s55

    v_lshlrev_b32 v66, 16, v49
    v_and_b32 v49, 0xffff0000, v49
    v_fma_f32 v66, v66, s74, v65
    v_fma_f32 v49, v49, s74, v65
    v_perm_b32 v49, v49, v66, s55

    v_lshlrev_b32 v66, 16, v50
    v_and_b32 v50, 0xffff0000, v50
    v_fma_f32 v66, v66, s74, v65
    v_fma_f32 v50, v50, s74, v65
    v_perm_b32 v50, v50, v66, s55

    v_lshlrev_b32 v66, 16, v51
    v_and_b32 v51, 0xffff0000, v51
    v_fma_f32 v66, v66, s74, v65
    v_fma_f32 v51, v51, s74, v65
    v_perm_b32 v51, v51, v66, s55

    v_lshlrev_b32 v66, 16, v52
    v_and_b32 v52, 0xffff0000, v52
    v_fma_f32 v66, v66, s74, v65
    v_fma_f32 v52, v52, s74, v65
    v_perm_b32 v52, v52, v66, s55

    s_add_u32 s92, s6, s54
    s_addc_u32 s93, s7, 0
    s_mov_b32 s94, 24576
    s_mov_b32 s95, 0x20000
    s_movk_i32 s3, 16384
    buffer_store_dwordx4 v[44:47], v1, s[92:95], 0 offen
    buffer_store_dwordx4 v[48:51], v1, s[92:95], s3 offen
    s_mul_i32 s94, s53, 25424
    s_movk_i32 s3, 24576

    buffer_store_dword v52, v100, s[92:95], s3 offen
    s_nop 1
    v_mov_b32 v99, 1
    buffer_atomic_add v99, v98, s[96:99], 0 offen sc0
    v_mov_b32 v100, 0
    buffer_atomic_add v100, v98, s[96:99], 0 offen offset:128 sc0
    s_waitcnt vmcnt(15)
    s_bitcmp0_b32 s28, 0
    s_cbranch_scc1 L_ska_7
    v_mul_hi_u32_u24 v45, s40, v20
    v_mul_hi_u32_u24 v44, s40, v4
    v_mul_hi_u32_u24 v47, s40, v21
    v_mul_hi_u32_u24 v46, s40, v5
    v_mul_hi_u32_u24 v49, s40, v22
    v_mul_hi_u32_u24 v48, s40, v6
    v_mul_hi_u32_u24 v51, s40, v23
    v_mul_hi_u32_u24 v50, s40, v7
    v_and_b32 v45, -2, v45
    v_mad_u32_u24 v4, v44, s43, v4
    v_and_b32 v76, -4, v44
    v_and_b32 v47, -2, v47
    v_mad_u32_u24 v5, v46, s43, v5
    v_and_b32 v77, -4, v46
    v_and_b32 v49, -2, v49
    v_mad_u32_u24 v6, v48, s43, v6
    v_and_b32 v78, -4, v48
    v_and_b32 v51, -2, v51
    v_mad_u32_u24 v7, v50, s43, v7
    v_and_b32 v79, -4, v50
    v_mad_i32_i24 v20, v45, s42, v20
    v_lshl_add_u32 v45, v76, 5, v45
    v_mad_i32_i24 v21, v47, s42, v21
    v_lshl_add_u32 v47, v77, 5, v47
    v_mad_i32_i24 v22, v49, s42, v22
    v_lshl_add_u32 v49, v78, 5, v49
    v_mad_i32_i24 v23, v51, s42, v23
    v_lshl_add_u32 v51, v79, 5, v51
    v_add_u32 v45, v45, v45
    ds_add_rtn_u32 v76, v45, v104
    v_add_u32 v47, v47, v47
    ds_add_rtn_u32 v77, v47, v104
    v_add_u32 v49, v49, v49
    ds_add_rtn_u32 v78, v49, v104
    v_add_u32 v51, v51, v51
    ds_add_rtn_u32 v79, v51, v104
    v_lshlrev_b32 v110, 16, v36
    v_and_b32 v111, 0xffff0000, v36
    v_lshlrev_b32 v112, 16, v37
    v_and_b32 v113, 0xffff0000, v37
    v_mul_f32 v110, s44, v110
    v_mul_f32 v111, s44, v111
    v_mul_f32 v112, s44, v112
    v_mul_f32 v113, s44, v113
    v_fract_f32 v110, v110
    v_fract_f32 v111, v111
    v_fract_f32 v112, v112
    v_fract_f32 v113, v113
    v_cos_f32 v110, v110
    v_cos_f32 v111, v111
    v_cos_f32 v112, v112
    v_cos_f32 v113, v113
    v_lshl_or_b32 v44, v44, 14, v20
    v_perm_b32 v45, v45, v4, s46
    v_bfe_u32 v4, v4, 8, 5

    v_lshl_or_b32 v46, v46, 14, v21
    v_perm_b32 v47, v47, v5, s46
    v_bfe_u32 v5, v5, 8, 5

    v_lshl_or_b32 v48, v48, 14, v22
    v_perm_b32 v49, v49, v6, s46
    v_bfe_u32 v6, v6, 8, 5

    v_lshl_or_b32 v50, v50, 14, v23
    v_perm_b32 v51, v51, v7, s46
    v_bfe_u32 v7, v7, 8, 5

    v_fmaak_f32 v110, v110, v105, 0x4b400010
    v_fmaak_f32 v111, v111, v105, 0x4b400010
    v_fmaak_f32 v112, v112, v105, 0x4b400010
    v_fmaak_f32 v113, v113, v105, 0x4b400010
    v_sub_u32 v110, v110, v4
    v_sub_u32 v111, v111, v5
    v_sub_u32 v112, v112, v6
    v_sub_u32 v113, v113, v7
    v_bfi_b32 v110, 31, v4, v110
    v_bfi_b32 v111, 31, v5, v111
    v_bfi_b32 v112, 31, v6, v112
    v_bfi_b32 v113, 31, v7, v113
    v_perm_b32 v44, v44, v110, s55
    v_perm_b32 v46, v46, v111, s55
    v_perm_b32 v48, v48, v112, s55
    v_perm_b32 v50, v50, v113, s55
L_ska_7:
    s_waitcnt vmcnt(12)
    s_bitcmp0_b32 s28, 1
    s_cbranch_scc1 L_ska_8
    v_mul_hi_u32_u24 v53, s40, v24
    v_mul_hi_u32_u24 v52, s40, v8
    v_mul_hi_u32_u24 v55, s40, v25
    v_mul_hi_u32_u24 v54, s40, v9
    v_mul_hi_u32_u24 v57, s40, v26
    v_mul_hi_u32_u24 v56, s40, v10
    v_mul_hi_u32_u24 v59, s40, v27
    v_mul_hi_u32_u24 v58, s40, v11
    v_and_b32 v53, -2, v53
    v_mad_u32_u24 v8, v52, s43, v8
    v_and_b32 v80, -4, v52
    v_and_b32 v55, -2, v55
    v_mad_u32_u24 v9, v54, s43, v9
    v_and_b32 v81, -4, v54
    v_and_b32 v57, -2, v57
    v_mad_u32_u24 v10, v56, s43, v10
    v_and_b32 v82, -4, v56
    v_and_b32 v59, -2, v59
    v_mad_u32_u24 v11, v58, s43, v11
    v_and_b32 v83, -4, v58
    v_mad_i32_i24 v24, v53, s42, v24
    v_lshl_add_u32 v53, v80, 5, v53
    v_mad_i32_i24 v25, v55, s42, v25
    v_lshl_add_u32 v55, v81, 5, v55
    v_mad_i32_i24 v26, v57, s42, v26
    v_lshl_add_u32 v57, v82, 5, v57
    v_mad_i32_i24 v27, v59, s42, v27
    v_lshl_add_u32 v59, v83, 5, v59
    v_add_u32 v53, v53, v53
    ds_add_rtn_u32 v80, v53, v104
    v_add_u32 v55, v55, v55
    ds_add_rtn_u32 v81, v55, v104
    v_add_u32 v57, v57, v57
    ds_add_rtn_u32 v82, v57, v104
    v_add_u32 v59, v59, v59
    ds_add_rtn_u32 v83, v59, v104
    v_lshlrev_b32 v110, 16, v38
    v_and_b32 v111, 0xffff0000, v38
    v_lshlrev_b32 v112, 16, v39
    v_and_b32 v113, 0xffff0000, v39
    v_mul_f32 v110, s44, v110
    v_mul_f32 v111, s44, v111
    v_mul_f32 v112, s44, v112
    v_mul_f32 v113, s44, v113
    v_fract_f32 v110, v110
    v_fract_f32 v111, v111
    v_fract_f32 v112, v112
    v_fract_f32 v113, v113
    v_cos_f32 v110, v110
    v_cos_f32 v111, v111
    v_cos_f32 v112, v112
    v_cos_f32 v113, v113
    v_lshl_or_b32 v52, v52, 14, v24
    v_perm_b32 v53, v53, v8, s46
    v_bfe_u32 v8, v8, 8, 5

    v_lshl_or_b32 v54, v54, 14, v25
    v_perm_b32 v55, v55, v9, s46
    v_bfe_u32 v9, v9, 8, 5

    v_lshl_or_b32 v56, v56, 14, v26
    v_perm_b32 v57, v57, v10, s46
    v_bfe_u32 v10, v10, 8, 5

    v_lshl_or_b32 v58, v58, 14, v27
    v_perm_b32 v59, v59, v11, s46
    v_bfe_u32 v11, v11, 8, 5

    v_fmaak_f32 v110, v110, v105, 0x4b400010
    v_fmaak_f32 v111, v111, v105, 0x4b400010
    v_fmaak_f32 v112, v112, v105, 0x4b400010
    v_fmaak_f32 v113, v113, v105, 0x4b400010
    v_sub_u32 v110, v110, v8
    v_sub_u32 v111, v111, v9
    v_sub_u32 v112, v112, v10
    v_sub_u32 v113, v113, v11
    v_bfi_b32 v110, 31, v8, v110
    v_bfi_b32 v111, 31, v9, v111
    v_bfi_b32 v112, 31, v10, v112
    v_bfi_b32 v113, 31, v11, v113
    v_perm_b32 v52, v52, v110, s55
    v_perm_b32 v54, v54, v111, s55
    v_perm_b32 v56, v56, v112, s55
    v_perm_b32 v58, v58, v113, s55
L_ska_8:
    s_waitcnt vmcnt(9)
    s_bitcmp0_b32 s28, 2
    s_cbranch_scc1 L_ska_9
    v_mul_hi_u32_u24 v61, s40, v28
    v_mul_hi_u32_u24 v60, s40, v12
    v_mul_hi_u32_u24 v63, s40, v29
    v_mul_hi_u32_u24 v62, s40, v13
    v_mul_hi_u32_u24 v65, s40, v30
    v_mul_hi_u32_u24 v64, s40, v14
    v_mul_hi_u32_u24 v67, s40, v31
    v_mul_hi_u32_u24 v66, s40, v15
    v_and_b32 v61, -2, v61
    v_mad_u32_u24 v12, v60, s43, v12
    v_and_b32 v84, -4, v60
    v_and_b32 v63, -2, v63
    v_mad_u32_u24 v13, v62, s43, v13
    v_and_b32 v85, -4, v62
    v_and_b32 v65, -2, v65
    v_mad_u32_u24 v14, v64, s43, v14
    v_and_b32 v86, -4, v64
    v_and_b32 v67, -2, v67
    v_mad_u32_u24 v15, v66, s43, v15
    v_and_b32 v87, -4, v66
    v_mad_i32_i24 v28, v61, s42, v28
    v_lshl_add_u32 v61, v84, 5, v61
    v_mad_i32_i24 v29, v63, s42, v29
    v_lshl_add_u32 v63, v85, 5, v63
    v_mad_i32_i24 v30, v65, s42, v30
    v_lshl_add_u32 v65, v86, 5, v65
    v_mad_i32_i24 v31, v67, s42, v31
    v_lshl_add_u32 v67, v87, 5, v67
    v_add_u32 v61, v61, v61
    ds_add_rtn_u32 v84, v61, v104
    v_add_u32 v63, v63, v63
    ds_add_rtn_u32 v85, v63, v104
    v_add_u32 v65, v65, v65
    ds_add_rtn_u32 v86, v65, v104
    v_add_u32 v67, v67, v67
    ds_add_rtn_u32 v87, v67, v104
    v_lshlrev_b32 v110, 16, v40
    v_and_b32 v111, 0xffff0000, v40
    v_lshlrev_b32 v112, 16, v41
    v_and_b32 v113, 0xffff0000, v41
    v_mul_f32 v110, s44, v110
    v_mul_f32 v111, s44, v111
    v_mul_f32 v112, s44, v112
    v_mul_f32 v113, s44, v113
    v_fract_f32 v110, v110
    v_fract_f32 v111, v111
    v_fract_f32 v112, v112
    v_fract_f32 v113, v113
    v_cos_f32 v110, v110
    v_cos_f32 v111, v111
    v_cos_f32 v112, v112
    v_cos_f32 v113, v113
    v_lshl_or_b32 v60, v60, 14, v28
    v_perm_b32 v61, v61, v12, s46
    v_bfe_u32 v12, v12, 8, 5

    v_lshl_or_b32 v62, v62, 14, v29
    v_perm_b32 v63, v63, v13, s46
    v_bfe_u32 v13, v13, 8, 5

    v_lshl_or_b32 v64, v64, 14, v30
    v_perm_b32 v65, v65, v14, s46
    v_bfe_u32 v14, v14, 8, 5

    v_lshl_or_b32 v66, v66, 14, v31
    v_perm_b32 v67, v67, v15, s46
    v_bfe_u32 v15, v15, 8, 5

    v_fmaak_f32 v110, v110, v105, 0x4b400010
    v_fmaak_f32 v111, v111, v105, 0x4b400010
    v_fmaak_f32 v112, v112, v105, 0x4b400010
    v_fmaak_f32 v113, v113, v105, 0x4b400010
    v_sub_u32 v110, v110, v12
    v_sub_u32 v111, v111, v13
    v_sub_u32 v112, v112, v14
    v_sub_u32 v113, v113, v15
    v_bfi_b32 v110, 31, v12, v110
    v_bfi_b32 v111, 31, v13, v111
    v_bfi_b32 v112, 31, v14, v112
    v_bfi_b32 v113, 31, v15, v113
    v_perm_b32 v60, v60, v110, s55
    v_perm_b32 v62, v62, v111, s55
    v_perm_b32 v64, v64, v112, s55
    v_perm_b32 v66, v66, v113, s55
L_ska_9:
    s_waitcnt vmcnt(6)
    s_bitcmp0_b32 s28, 3
    s_cbranch_scc1 L_ska_10
    s_mov_b64 exec, s[66:67]
    v_mul_hi_u32_u24 v69, s40, v32
    v_mul_hi_u32_u24 v68, s40, v16
    v_mul_hi_u32_u24 v71, s40, v33
    v_mul_hi_u32_u24 v70, s40, v17
    v_mul_hi_u32_u24 v73, s40, v34
    v_mul_hi_u32_u24 v72, s40, v18
    v_mul_hi_u32_u24 v75, s40, v35
    v_mul_hi_u32_u24 v74, s40, v19
    v_and_b32 v69, -2, v69
    v_mad_u32_u24 v16, v68, s43, v16
    v_and_b32 v88, -4, v68
    v_and_b32 v71, -2, v71
    v_mad_u32_u24 v17, v70, s43, v17
    v_and_b32 v89, -4, v70
    v_and_b32 v73, -2, v73
    v_mad_u32_u24 v18, v72, s43, v18
    v_and_b32 v90, -4, v72
    v_and_b32 v75, -2, v75
    v_mad_u32_u24 v19, v74, s43, v19
    v_and_b32 v91, -4, v74
    v_mad_i32_i24 v32, v69, s42, v32
    v_lshl_add_u32 v69, v88, 5, v69
    v_mad_i32_i24 v33, v71, s42, v33
    v_lshl_add_u32 v71, v89, 5, v71
    v_mad_i32_i24 v34, v73, s42, v34
    v_lshl_add_u32 v73, v90, 5, v73
    v_mad_i32_i24 v35, v75, s42, v35
    v_lshl_add_u32 v75, v91, 5, v75
    v_add_u32 v69, v69, v69
    ds_add_rtn_u32 v88, v69, v104
    v_add_u32 v71, v71, v71
    ds_add_rtn_u32 v89, v71, v104
    v_add_u32 v73, v73, v73
    ds_add_rtn_u32 v90, v73, v104
    v_add_u32 v75, v75, v75
    ds_add_rtn_u32 v91, v75, v104
    v_lshlrev_b32 v110, 16, v42
    v_and_b32 v111, 0xffff0000, v42
    v_lshlrev_b32 v112, 16, v43
    v_and_b32 v113, 0xffff0000, v43
    v_mul_f32 v110, s44, v110
    v_mul_f32 v111, s44, v111
    v_mul_f32 v112, s44, v112
    v_mul_f32 v113, s44, v113
    v_fract_f32 v110, v110
    v_fract_f32 v111, v111
    v_fract_f32 v112, v112
    v_fract_f32 v113, v113
    v_cos_f32 v110, v110
    v_cos_f32 v111, v111
    v_cos_f32 v112, v112
    v_cos_f32 v113, v113
    v_lshl_or_b32 v68, v68, 14, v32
    v_perm_b32 v69, v69, v16, s46
    v_bfe_u32 v16, v16, 8, 5

    v_lshl_or_b32 v70, v70, 14, v33
    v_perm_b32 v71, v71, v17, s46
    v_bfe_u32 v17, v17, 8, 5

    v_lshl_or_b32 v72, v72, 14, v34
    v_perm_b32 v73, v73, v18, s46
    v_bfe_u32 v18, v18, 8, 5

    v_lshl_or_b32 v74, v74, 14, v35
    v_perm_b32 v75, v75, v19, s46
    v_bfe_u32 v19, v19, 8, 5

    v_fmaak_f32 v110, v110, v105, 0x4b400010
    v_fmaak_f32 v111, v111, v105, 0x4b400010
    v_fmaak_f32 v112, v112, v105, 0x4b400010
    v_fmaak_f32 v113, v113, v105, 0x4b400010
    v_sub_u32 v110, v110, v16
    v_sub_u32 v111, v111, v17
    v_sub_u32 v112, v112, v18
    v_sub_u32 v113, v113, v19
    v_bfi_b32 v110, 31, v16, v110
    v_bfi_b32 v111, 31, v17, v111
    v_bfi_b32 v112, 31, v18, v112
    v_bfi_b32 v113, 31, v19, v113
    v_perm_b32 v68, v68, v110, s55
    v_perm_b32 v70, v70, v111, s55
    v_perm_b32 v72, v72, v112, s55
    v_perm_b32 v74, v74, v113, s55
    s_mov_b64 exec, -1
L_ska_10:
    s_waitcnt vmcnt(0)
    v_or_b32 v100, v100, v0
    s_nop 0
    v_readfirstlane_b32 s74, v100
    s_nop 1
    s_cmp_lg_u32 s74, 0
    s_cbranch_scc1 L_ready_12

    v_mov_b32 v110, 1
    buffer_atomic_add v110, v98, s[96:99], 0 offen offset:64 sc0
    s_waitcnt vmcnt(0)
    v_readfirstlane_b32 s74, v110
    s_nop 1
    s_cmp_lg_u32 s74, 0
    s_cbranch_scc1 L_zno_14

    s_mov_b32 s92, s6
    s_mov_b32 s93, s7
    s_mov_b32 s94, 65552
    s_mov_b32 s95, 0x20000
    v_mov_b32 v110, 0
    v_mov_b32 v111, 0
    v_mov_b32 v112, 0
    v_mov_b32 v113, 0
L_zl_13:
    buffer_store_dwordx4 v[110:113], v1, s[92:95], s74 offen sc0 sc1
    s_add_u32 s74, s74, 1024
    s_cmp_le_u32 s74, 65536
    s_cbranch_scc1 L_zl_13
    v_mov_b32 v114, 1
    s_waitcnt vmcnt(0)
    buffer_atomic_add v114, v98, s[96:99], 0 offen offset:128
L_zno_14:

L_spin_11:
    v_mov_b32 v100, 0
    buffer_atomic_add v100, v98, s[96:99], 0 offen offset:128 sc0
    s_waitcnt vmcnt(0)
    v_readfirstlane_b32 s74, v100
    s_nop 1
    s_cmp_eq_u32 s74, 0
    s_cbranch_scc1 L_spin_11
L_ready_12:

    v_cmp_eq_u32 vcc, 0, v0
    s_waitcnt vmcnt(1)
    s_mov_b64 exec, vcc
    ds_write_b32 v108, v99 offset:8
    s_mov_b64 exec, -1
    s_waitcnt lgkmcnt(0)
    s_barrier

    ds_read2_b32 v[110:111], v108 offset0:1 offset1:2
    ds_read_b64 v[94:95], v2
    s_waitcnt lgkmcnt(0)
    v_readfirstlane_b32 s53, v110
    v_readfirstlane_b32 s41, v111

    v_and_b32 v94, 0xffff, v94
    v_and_b32 v95, 0xffff, v95
    v_add_u32 v97, v94, v95
    s_nop 1
    v_add_u32_dpp v97, v97, v97 row_shr:1 row_mask:0xf bank_mask:0xf
    s_nop 1
    v_add_u32_dpp v97, v97, v97 row_shr:2 row_mask:0xf bank_mask:0xf
    s_nop 1
    v_add_u32_dpp v97, v97, v97 row_shr:4 row_mask:0xf bank_mask:0xf
    s_nop 1
    v_add_u32_dpp v97, v97, v97 row_shr:8 row_mask:0xf bank_mask:0xf
    s_nop 1
    v_add_u32_dpp v97, v97, v97 row_bcast:15 row_mask:0xa bank_mask:0xf
    s_nop 1
    v_add_u32_dpp v97, v97, v97 row_bcast:31 row_mask:0xc bank_mask:0xf
    s_mov_b32 exec_lo, 0
    s_brev_b32 exec_hi, 1
    ds_add_rtn_u32 v96, v108, v97
    s_mov_b64 exec, -1

    v_add_u32 v92, v94, v94
    v_add_u32 v93, v95, v95
    v_med3_u32 v92, v94, 2, v92
    v_med3_u32 v93, v95, 2, v93
    buffer_atomic_add_x2 v[92:93], v2, s[20:23], 0 offen sc0
    s_add_u32 s41, s41, 160
    s_mul_i32 s78, s41, 16000
    s_add_u32 s49, s78, 16000
    s_cmp_ge_u32 s41, 3200
    s_cmovk_i32 s49, 0
    s_cmovk_i32 s78, 0
    s_lshl_b32 s10, s49, 2
    s_lshl_b32 s14, s49, 2
    s_lshl_b32 s18, s49, 1
    s_lshl_b32 s56, s78, 2
    s_lshl_b32 s61, s78, 1

    s_add_u32 s57, s56, 16384
    s_add_u32 s62, s61, 8192
    s_add_u32 s58, s56, 32768
    s_add_u32 s63, s61, 16384
    s_add_u32 s59, s56, 49152
    s_add_u32 s64, s61, 24576
    s_waitcnt lgkmcnt(0)
    v_readlane_b32 s77, v96, 63
    v_mul_u32_u24 v114, 7936, v0
    v_sub_u32 v97, v97, v95
    s_sub_u32 s77, s77, s50
    v_add_u32 v97, s77, v97
    v_sub_u32 v96, v97, v94
    v_lshlrev_b32 v111, 16, v97
    v_lshlrev_b32 v110, 16, v96
    ds_write_b64 v2, v[110:111]
    v_sub_u32 v96, v114, v96
    v_sub_u32 v97, v114, v97
    v_add_u32 v97, s48, v97
    s_add_u32 s50, s50, s30

    s_waitcnt lgkmcnt(0)
    s_barrier

    buffer_load_dwordx4 v[20:23], v1, s[12:15], s56 offen nt
    buffer_load_dwordx4 v[4:7], v1, s[8:11], s56 offen nt
    buffer_load_dwordx2 v[36:37], v2, s[16:19], s61 offen nt
    buffer_load_dwordx4 v[24:27], v1, s[12:15], s57 offen nt
    buffer_load_dwordx4 v[8:11], v1, s[8:11], s57 offen nt
    buffer_load_dwordx2 v[38:39], v2, s[16:19], s62 offen nt
    buffer_load_dwordx4 v[28:31], v1, s[12:15], s58 offen nt
    buffer_load_dwordx4 v[12:15], v1, s[8:11], s58 offen nt
    buffer_load_dwordx2 v[40:41], v2, s[16:19], s63 offen nt
    buffer_load_dwordx4 v[32:35], v1, s[12:15], s59 offen nt
    buffer_load_dwordx4 v[16:19], v1, s[8:11], s59 offen nt
    buffer_load_dwordx2 v[42:43], v2, s[16:19], s64 offen nt
    s_bitcmp0_b32 s28, 0
    s_cbranch_scc1 L_skz_15
    v_lshrrev_b32 v110, 16, v45
    ds_read_b32 v110, v110
    v_lshrrev_b32 v111, 16, v47
    ds_read_b32 v111, v111
    v_lshrrev_b32 v112, 16, v49
    ds_read_b32 v112, v112
    v_lshrrev_b32 v113, 16, v51
    ds_read_b32 v113, v113
    s_waitcnt lgkmcnt(3)
    v_add_u32_sdwa v110, v110, v76 dst_sel:DWORD dst_unused:UNUSED_PAD src0_sel:WORD_1 src1_sel:WORD_0
    v_lshlrev_b32 v110, 3, v110
    ds_write_b64 v110, v[44:45] offset:16400

    s_waitcnt lgkmcnt(3)
    v_add_u32_sdwa v111, v111, v77 dst_sel:DWORD dst_unused:UNUSED_PAD src0_sel:WORD_1 src1_sel:WORD_0
    v_lshlrev_b32 v111, 3, v111
    ds_write_b64 v111, v[46:47] offset:16400

    s_waitcnt lgkmcnt(3)
    v_add_u32_sdwa v112, v112, v78 dst_sel:DWORD dst_unused:UNUSED_PAD src0_sel:WORD_1 src1_sel:WORD_0
    v_lshlrev_b32 v112, 3, v112
    ds_write_b64 v112, v[48:49] offset:16400

    s_waitcnt lgkmcnt(3)
    v_add_u32_sdwa v113, v113, v79 dst_sel:DWORD dst_unused:UNUSED_PAD src0_sel:WORD_1 src1_sel:WORD_0
    v_lshlrev_b32 v113, 3, v113
    ds_write_b64 v113, v[50:51] offset:16400

L_skz_15:
    s_bitcmp0_b32 s28, 1
    s_cbranch_scc1 L_skz_16
    v_lshrrev_b32 v110, 16, v53
    ds_read_b32 v110, v110
    v_lshrrev_b32 v111, 16, v55
    ds_read_b32 v111, v111
    v_lshrrev_b32 v112, 16, v57
    ds_read_b32 v112, v112
    v_lshrrev_b32 v113, 16, v59
    ds_read_b32 v113, v113
    s_waitcnt lgkmcnt(3)
    v_add_u32_sdwa v110, v110, v80 dst_sel:DWORD dst_unused:UNUSED_PAD src0_sel:WORD_1 src1_sel:WORD_0
    v_lshlrev_b32 v110, 3, v110
    ds_write_b64 v110, v[52:53] offset:16400

    s_waitcnt lgkmcnt(3)
    v_add_u32_sdwa v111, v111, v81 dst_sel:DWORD dst_unused:UNUSED_PAD src0_sel:WORD_1 src1_sel:WORD_0
    v_lshlrev_b32 v111, 3, v111
    ds_write_b64 v111, v[54:55] offset:16400

    s_waitcnt lgkmcnt(3)
    v_add_u32_sdwa v112, v112, v82 dst_sel:DWORD dst_unused:UNUSED_PAD src0_sel:WORD_1 src1_sel:WORD_0
    v_lshlrev_b32 v112, 3, v112
    ds_write_b64 v112, v[56:57] offset:16400

    s_waitcnt lgkmcnt(3)
    v_add_u32_sdwa v113, v113, v83 dst_sel:DWORD dst_unused:UNUSED_PAD src0_sel:WORD_1 src1_sel:WORD_0
    v_lshlrev_b32 v113, 3, v113
    ds_write_b64 v113, v[58:59] offset:16400

L_skz_16:
    s_bitcmp0_b32 s28, 2
    s_cbranch_scc1 L_skz_17
    v_lshrrev_b32 v110, 16, v61
    ds_read_b32 v110, v110
    v_lshrrev_b32 v111, 16, v63
    ds_read_b32 v111, v111
    v_lshrrev_b32 v112, 16, v65
    ds_read_b32 v112, v112
    v_lshrrev_b32 v113, 16, v67
    ds_read_b32 v113, v113
    s_waitcnt lgkmcnt(3)
    v_add_u32_sdwa v110, v110, v84 dst_sel:DWORD dst_unused:UNUSED_PAD src0_sel:WORD_1 src1_sel:WORD_0
    v_lshlrev_b32 v110, 3, v110
    ds_write_b64 v110, v[60:61] offset:16400

    s_waitcnt lgkmcnt(3)
    v_add_u32_sdwa v111, v111, v85 dst_sel:DWORD dst_unused:UNUSED_PAD src0_sel:WORD_1 src1_sel:WORD_0
    v_lshlrev_b32 v111, 3, v111
    ds_write_b64 v111, v[62:63] offset:16400

    s_waitcnt lgkmcnt(3)
    v_add_u32_sdwa v112, v112, v86 dst_sel:DWORD dst_unused:UNUSED_PAD src0_sel:WORD_1 src1_sel:WORD_0
    v_lshlrev_b32 v112, 3, v112
    ds_write_b64 v112, v[64:65] offset:16400

    s_waitcnt lgkmcnt(3)
    v_add_u32_sdwa v113, v113, v87 dst_sel:DWORD dst_unused:UNUSED_PAD src0_sel:WORD_1 src1_sel:WORD_0
    v_lshlrev_b32 v113, 3, v113
    ds_write_b64 v113, v[66:67] offset:16400

L_skz_17:
    s_bitcmp0_b32 s28, 3
    s_cbranch_scc1 L_skz_18
    s_mov_b64 exec, s[66:67]
    v_lshrrev_b32 v110, 16, v69
    ds_read_b32 v110, v110
    v_lshrrev_b32 v111, 16, v71
    ds_read_b32 v111, v111
    v_lshrrev_b32 v112, 16, v73
    ds_read_b32 v112, v112
    v_lshrrev_b32 v113, 16, v75
    ds_read_b32 v113, v113
    s_waitcnt lgkmcnt(3)
    v_add_u32_sdwa v110, v110, v88 dst_sel:DWORD dst_unused:UNUSED_PAD src0_sel:WORD_1 src1_sel:WORD_0
    v_lshlrev_b32 v110, 3, v110
    ds_write_b64 v110, v[68:69] offset:16400

    s_waitcnt lgkmcnt(3)
    v_add_u32_sdwa v111, v111, v89 dst_sel:DWORD dst_unused:UNUSED_PAD src0_sel:WORD_1 src1_sel:WORD_0
    v_lshlrev_b32 v111, 3, v111
    ds_write_b64 v111, v[70:71] offset:16400

    s_waitcnt lgkmcnt(3)
    v_add_u32_sdwa v112, v112, v90 dst_sel:DWORD dst_unused:UNUSED_PAD src0_sel:WORD_1 src1_sel:WORD_0
    v_lshlrev_b32 v112, 3, v112
    ds_write_b64 v112, v[72:73] offset:16400

    s_waitcnt lgkmcnt(3)
    v_add_u32_sdwa v113, v113, v91 dst_sel:DWORD dst_unused:UNUSED_PAD src0_sel:WORD_1 src1_sel:WORD_0
    v_lshlrev_b32 v113, 3, v113
    ds_write_b64 v113, v[74:75] offset:16400

    s_mov_b64 exec, -1
L_skz_18:
    s_cmp_eq_u32 s49, 0
    s_cbranch_scc1 L_p1epi_6
L_p1loop_5:
    v_mov_b32 v99, 1
    buffer_atomic_add v99, v98, s[96:99], 0 offen sc0
    s_waitcnt vmcnt(10)
    v_mul_hi_u32_u24 v45, s40, v20
    v_mul_hi_u32_u24 v44, s40, v4
    v_mul_hi_u32_u24 v47, s40, v21
    v_mul_hi_u32_u24 v46, s40, v5
    v_mul_hi_u32_u24 v49, s40, v22
    v_mul_hi_u32_u24 v48, s40, v6
    v_mul_hi_u32_u24 v51, s40, v23
    v_mul_hi_u32_u24 v50, s40, v7
    v_and_b32 v45, -2, v45
    v_mad_u32_u24 v4, v44, s43, v4
    v_and_b32 v76, -4, v44
    v_and_b32 v47, -2, v47
    v_mad_u32_u24 v5, v46, s43, v5
    v_and_b32 v77, -4, v46
    v_and_b32 v49, -2, v49
    v_mad_u32_u24 v6, v48, s43, v6
    v_and_b32 v78, -4, v48
    v_and_b32 v51, -2, v51
    v_mad_u32_u24 v7, v50, s43, v7
    v_and_b32 v79, -4, v50
    v_mad_i32_i24 v20, v45, s42, v20
    v_lshl_add_u32 v45, v76, 5, v45
    v_mad_i32_i24 v21, v47, s42, v21
    v_lshl_add_u32 v47, v77, 5, v47
    v_mad_i32_i24 v22, v49, s42, v22
    v_lshl_add_u32 v49, v78, 5, v49
    v_mad_i32_i24 v23, v51, s42, v23
    v_lshl_add_u32 v51, v79, 5, v51
    v_add_u32 v45, v45, v45
    ds_add_rtn_u32 v76, v45, v104
    v_add_u32 v47, v47, v47
    ds_add_rtn_u32 v77, v47, v104
    v_add_u32 v49, v49, v49
    ds_add_rtn_u32 v78, v49, v104
    v_add_u32 v51, v51, v51
    ds_add_rtn_u32 v79, v51, v104
    v_lshlrev_b32 v110, 16, v36
    v_and_b32 v111, 0xffff0000, v36
    v_lshlrev_b32 v112, 16, v37
    v_and_b32 v113, 0xffff0000, v37
    v_mul_f32 v110, s44, v110
    v_mul_f32 v111, s44, v111
    v_mul_f32 v112, s44, v112
    v_mul_f32 v113, s44, v113
    v_fract_f32 v110, v110
    v_fract_f32 v111, v111
    v_fract_f32 v112, v112
    v_fract_f32 v113, v113
    v_cos_f32 v110, v110
    v_cos_f32 v111, v111
    v_cos_f32 v112, v112
    v_cos_f32 v113, v113
    v_lshl_or_b32 v44, v44, 14, v20
    v_perm_b32 v45, v45, v4, s46
    v_bfe_u32 v4, v4, 8, 5

    v_lshl_or_b32 v46, v46, 14, v21
    v_perm_b32 v47, v47, v5, s46
    v_bfe_u32 v5, v5, 8, 5

    v_lshl_or_b32 v48, v48, 14, v22
    v_perm_b32 v49, v49, v6, s46
    v_bfe_u32 v6, v6, 8, 5

    v_lshl_or_b32 v50, v50, 14, v23
    v_perm_b32 v51, v51, v7, s46
    v_bfe_u32 v7, v7, 8, 5

    v_fmaak_f32 v110, v110, v105, 0x4b400010
    v_fmaak_f32 v111, v111, v105, 0x4b400010
    v_fmaak_f32 v112, v112, v105, 0x4b400010
    v_fmaak_f32 v113, v113, v105, 0x4b400010
    v_sub_u32 v110, v110, v4
    v_sub_u32 v111, v111, v5
    v_sub_u32 v112, v112, v6
    v_sub_u32 v113, v113, v7
    v_bfi_b32 v110, 31, v4, v110
    v_bfi_b32 v111, 31, v5, v111
    v_bfi_b32 v112, 31, v6, v112
    v_bfi_b32 v113, 31, v7, v113
    v_perm_b32 v44, v44, v110, s55
    v_perm_b32 v46, v46, v111, s55
    v_perm_b32 v48, v48, v112, s55
    v_perm_b32 v50, v50, v113, s55
    s_waitcnt vmcnt(7)
    v_mul_hi_u32_u24 v53, s40, v24
    v_mul_hi_u32_u24 v52, s40, v8
    v_mul_hi_u32_u24 v55, s40, v25
    v_mul_hi_u32_u24 v54, s40, v9
    v_mul_hi_u32_u24 v57, s40, v26
    v_mul_hi_u32_u24 v56, s40, v10
    v_mul_hi_u32_u24 v59, s40, v27
    v_mul_hi_u32_u24 v58, s40, v11
    v_and_b32 v53, -2, v53
    v_mad_u32_u24 v8, v52, s43, v8
    v_and_b32 v80, -4, v52
    v_and_b32 v55, -2, v55
    v_mad_u32_u24 v9, v54, s43, v9
    v_and_b32 v81, -4, v54
    v_and_b32 v57, -2, v57
    v_mad_u32_u24 v10, v56, s43, v10
    v_and_b32 v82, -4, v56
    v_and_b32 v59, -2, v59
    v_mad_u32_u24 v11, v58, s43, v11
    v_and_b32 v83, -4, v58
    v_mad_i32_i24 v24, v53, s42, v24
    v_lshl_add_u32 v53, v80, 5, v53
    v_mad_i32_i24 v25, v55, s42, v25
    v_lshl_add_u32 v55, v81, 5, v55
    v_mad_i32_i24 v26, v57, s42, v26
    v_lshl_add_u32 v57, v82, 5, v57
    v_mad_i32_i24 v27, v59, s42, v27
    v_lshl_add_u32 v59, v83, 5, v59
    v_add_u32 v53, v53, v53
    ds_add_rtn_u32 v80, v53, v104
    v_add_u32 v55, v55, v55
    ds_add_rtn_u32 v81, v55, v104
    v_add_u32 v57, v57, v57
    ds_add_rtn_u32 v82, v57, v104
    v_add_u32 v59, v59, v59
    ds_add_rtn_u32 v83, v59, v104
    v_lshlrev_b32 v110, 16, v38
    v_and_b32 v111, 0xffff0000, v38
    v_lshlrev_b32 v112, 16, v39
    v_and_b32 v113, 0xffff0000, v39
    v_mul_f32 v110, s44, v110
    v_mul_f32 v111, s44, v111
    v_mul_f32 v112, s44, v112
    v_mul_f32 v113, s44, v113
    v_fract_f32 v110, v110
    v_fract_f32 v111, v111
    v_fract_f32 v112, v112
    v_fract_f32 v113, v113
    v_cos_f32 v110, v110
    v_cos_f32 v111, v111
    v_cos_f32 v112, v112
    v_cos_f32 v113, v113
    v_lshl_or_b32 v52, v52, 14, v24
    v_perm_b32 v53, v53, v8, s46
    v_bfe_u32 v8, v8, 8, 5

    v_lshl_or_b32 v54, v54, 14, v25
    v_perm_b32 v55, v55, v9, s46
    v_bfe_u32 v9, v9, 8, 5

    v_lshl_or_b32 v56, v56, 14, v26
    v_perm_b32 v57, v57, v10, s46
    v_bfe_u32 v10, v10, 8, 5

    v_lshl_or_b32 v58, v58, 14, v27
    v_perm_b32 v59, v59, v11, s46
    v_bfe_u32 v11, v11, 8, 5

    v_fmaak_f32 v110, v110, v105, 0x4b400010
    v_fmaak_f32 v111, v111, v105, 0x4b400010
    v_fmaak_f32 v112, v112, v105, 0x4b400010
    v_fmaak_f32 v113, v113, v105, 0x4b400010
    v_sub_u32 v110, v110, v8
    v_sub_u32 v111, v111, v9
    v_sub_u32 v112, v112, v10
    v_sub_u32 v113, v113, v11
    v_bfi_b32 v110, 31, v8, v110
    v_bfi_b32 v111, 31, v9, v111
    v_bfi_b32 v112, 31, v10, v112
    v_bfi_b32 v113, 31, v11, v113
    v_perm_b32 v52, v52, v110, s55
    v_perm_b32 v54, v54, v111, s55
    v_perm_b32 v56, v56, v112, s55
    v_perm_b32 v58, v58, v113, s55
    s_waitcnt vmcnt(4)
    v_mul_hi_u32_u24 v61, s40, v28
    v_mul_hi_u32_u24 v60, s40, v12
    v_mul_hi_u32_u24 v63, s40, v29
    v_mul_hi_u32_u24 v62, s40, v13
    v_mul_hi_u32_u24 v65, s40, v30
    v_mul_hi_u32_u24 v64, s40, v14
    v_mul_hi_u32_u24 v67, s40, v31
    v_mul_hi_u32_u24 v66, s40, v15
    v_and_b32 v61, -2, v61
    v_mad_u32_u24 v12, v60, s43, v12
    v_and_b32 v84, -4, v60
    v_and_b32 v63, -2, v63
    v_mad_u32_u24 v13, v62, s43, v13
    v_and_b32 v85, -4, v62
    v_and_b32 v65, -2, v65
    v_mad_u32_u24 v14, v64, s43, v14
    v_and_b32 v86, -4, v64
    v_and_b32 v67, -2, v67
    v_mad_u32_u24 v15, v66, s43, v15
    v_and_b32 v87, -4, v66
    v_mad_i32_i24 v28, v61, s42, v28
    v_lshl_add_u32 v61, v84, 5, v61
    v_mad_i32_i24 v29, v63, s42, v29
    v_lshl_add_u32 v63, v85, 5, v63
    v_mad_i32_i24 v30, v65, s42, v30
    v_lshl_add_u32 v65, v86, 5, v65
    v_mad_i32_i24 v31, v67, s42, v31
    v_lshl_add_u32 v67, v87, 5, v67
    v_add_u32 v61, v61, v61
    ds_add_rtn_u32 v84, v61, v104
    v_add_u32 v63, v63, v63
    ds_add_rtn_u32 v85, v63, v104
    v_add_u32 v65, v65, v65
    ds_add_rtn_u32 v86, v65, v104
    v_add_u32 v67, v67, v67
    ds_add_rtn_u32 v87, v67, v104
    v_lshlrev_b32 v110, 16, v40
    v_and_b32 v111, 0xffff0000, v40
    v_lshlrev_b32 v112, 16, v41
    v_and_b32 v113, 0xffff0000, v41
    v_mul_f32 v110, s44, v110
    v_mul_f32 v111, s44, v111
    v_mul_f32 v112, s44, v112
    v_mul_f32 v113, s44, v113
    v_fract_f32 v110, v110
    v_fract_f32 v111, v111
    v_fract_f32 v112, v112
    v_fract_f32 v113, v113
    v_cos_f32 v110, v110
    v_cos_f32 v111, v111
    v_cos_f32 v112, v112
    v_cos_f32 v113, v113
    v_lshl_or_b32 v60, v60, 14, v28
    v_perm_b32 v61, v61, v12, s46
    v_bfe_u32 v12, v12, 8, 5

    v_lshl_or_b32 v62, v62, 14, v29
    v_perm_b32 v63, v63, v13, s46
    v_bfe_u32 v13, v13, 8, 5

    v_lshl_or_b32 v64, v64, 14, v30
    v_perm_b32 v65, v65, v14, s46
    v_bfe_u32 v14, v14, 8, 5

    v_lshl_or_b32 v66, v66, 14, v31
    v_perm_b32 v67, v67, v15, s46
    v_bfe_u32 v15, v15, 8, 5

    v_fmaak_f32 v110, v110, v105, 0x4b400010
    v_fmaak_f32 v111, v111, v105, 0x4b400010
    v_fmaak_f32 v112, v112, v105, 0x4b400010
    v_fmaak_f32 v113, v113, v105, 0x4b400010
    v_sub_u32 v110, v110, v12
    v_sub_u32 v111, v111, v13
    v_sub_u32 v112, v112, v14
    v_sub_u32 v113, v113, v15
    v_bfi_b32 v110, 31, v12, v110
    v_bfi_b32 v111, 31, v13, v111
    v_bfi_b32 v112, 31, v14, v112
    v_bfi_b32 v113, 31, v15, v113
    v_perm_b32 v60, v60, v110, s55
    v_perm_b32 v62, v62, v111, s55
    v_perm_b32 v64, v64, v112, s55
    v_perm_b32 v66, v66, v113, s55
    s_waitcnt vmcnt(1)
    s_waitcnt vmcnt(0)
    v_cmp_eq_u32 vcc, 0, v0
    s_mov_b64 exec, vcc
    ds_write_b32 v108, v99 offset:8
    s_mov_b64 exec, -1
    s_waitcnt vmcnt(10)
    v_add_u32 v110, v92, v94
    v_min_u32 v92, s48, v92
    v_add_u32 v111, v93, v95
    v_min_u32 v93, s48, v93
    v_max_u32 v110, v110, v111
    v_add_u32 v92, v92, v96
    v_add_u32 v93, v93, v97
    v_cmp_le_u32 vcc, s48, v110
    v_lshl_add_u32 v92, v92, 2, v92
    v_lshl_add_u32 v93, v93, 2, v93
    ds_write_b64 v2, v[92:93] offset:8192
    s_cbranch_vccz L_noov_22
    ds_write_b32 v108, v104 offset:4
L_noov_22:

    s_waitcnt lgkmcnt(0)
    s_barrier
    ds_read2_b32 v[110:111], v108 offset0:1 offset1:2
    s_waitcnt lgkmcnt(0)
    v_readfirstlane_b32 s53, v110
    v_readfirstlane_b32 s41, v111
    s_nop 1
    s_add_u32 s41, s41, 160

    s_mul_i32 s78, s41, 16000
    s_add_u32 s49, s78, 16000
    s_cmp_ge_u32 s41, 3200
    s_cmovk_i32 s49, 0
    s_cmovk_i32 s78, 0
    s_lshl_b32 s10, s49, 2
    s_lshl_b32 s14, s49, 2
    s_lshl_b32 s18, s49, 1
    s_lshl_b32 s56, s78, 2
    s_lshl_b32 s61, s78, 1

    s_add_u32 s57, s56, 16384
    s_add_u32 s62, s61, 8192
    s_add_u32 s58, s56, 32768
    s_add_u32 s63, s61, 16384
    s_add_u32 s59, s56, 49152
    s_add_u32 s64, s61, 24576
    s_cmp_lg_u32 s53, 0
    s_cbranch_scc1 L_slow_23
L_sback_24:
    s_bitcmp0_b32 s28, 0
    s_cbranch_scc1 L_skw_28
    ds_read_b64 v[110:111], v2 offset:16400
    ds_read_b64 v[112:113], v2 offset:16408
    ds_read_b64 v[114:115], v2 offset:16392

    ds_read_b64 v[118:119], v2 offset:24592
    ds_read_b64 v[120:121], v2 offset:24600
    ds_read_b64 v[122:123], v2 offset:24584

    s_waitcnt lgkmcnt(3)
    v_lshrrev_b32 v116, 16, v111
    ds_read_b32 v116, v116 offset:8192

    s_waitcnt lgkmcnt(1)
    v_lshrrev_b32 v124, 16, v119
    ds_read_b32 v124, v124 offset:8192

    v_cmp_ne_u32_sdwa s[80:81], v111, v113 src0_sel:WORD_1 src1_sel:WORD_1
    v_cmp_ne_u32_sdwa vcc, v111, v115 src0_sel:WORD_1 src1_sel:WORD_1
    v_alignbyte_b32 v114, v115, v114, 2
    s_mov_b32 s54, -3
    v_alignbyte_b32 v111, v111, v110, 1
    v_perm_b32 v110, v110, v114, s47
    s_waitcnt lgkmcnt(1)
    v_add3_u32 v116, v116, v106, s54
    v_sub_u32 v117, 0, v116
    v_and_b32 v117, 3, v117
    s_mov_b64 exec, s[80:81]
    v_mov_b32 v117, 0
    v_mov_b32 v112, 0
    s_mov_b64 exec, vcc
    v_mov_b32 v117, 3

    s_mov_b64 exec, -1
    v_alignbyte_b32 v110, v111, v110, v117
    v_alignbyte_b32 v111, v112, v111, v117
    v_add_u32 v116, v116, v117

    buffer_store_dwordx2 v[110:111], v116, s[24:27], 0 offen
    v_cmp_ne_u32_sdwa s[80:81], v119, v121 src0_sel:WORD_1 src1_sel:WORD_1
    v_cmp_ne_u32_sdwa vcc, v119, v123 src0_sel:WORD_1 src1_sel:WORD_1
    v_alignbyte_b32 v122, v123, v122, 2
    s_mov_b32 s54, 5117
    v_alignbyte_b32 v119, v119, v118, 1
    v_perm_b32 v118, v118, v122, s47
    s_waitcnt lgkmcnt(0)
    v_add3_u32 v124, v124, v106, s54
    v_sub_u32 v125, 0, v124
    v_and_b32 v125, 3, v125
    s_mov_b64 exec, s[80:81]
    v_mov_b32 v125, 0
    v_mov_b32 v120, 0
    s_mov_b64 exec, vcc
    v_mov_b32 v125, 3

    s_mov_b64 exec, -1
    v_alignbyte_b32 v118, v119, v118, v125
    v_alignbyte_b32 v119, v120, v119, v125
    v_add_u32 v124, v124, v125

    buffer_store_dwordx2 v[118:119], v124, s[24:27], 0 offen
L_skw_28:
    s_bitcmp0_b32 s28, 0
    s_cbranch_scc1 L_skw_29
    ds_read_b64 v[110:111], v2 offset:32784
    ds_read_b64 v[112:113], v2 offset:32792
    ds_read_b64 v[114:115], v2 offset:32776

    ds_read_b64 v[118:119], v2 offset:40976
    ds_read_b64 v[120:121], v2 offset:40984
    ds_read_b64 v[122:123], v2 offset:40968

    s_waitcnt lgkmcnt(3)
    v_lshrrev_b32 v116, 16, v111
    ds_read_b32 v116, v116 offset:8192

    s_waitcnt lgkmcnt(1)
    v_lshrrev_b32 v124, 16, v119
    ds_read_b32 v124, v124 offset:8192

    v_cmp_ne_u32_sdwa s[80:81], v111, v113 src0_sel:WORD_1 src1_sel:WORD_1
    v_cmp_ne_u32_sdwa vcc, v111, v115 src0_sel:WORD_1 src1_sel:WORD_1
    v_alignbyte_b32 v114, v115, v114, 2
    s_mov_b32 s54, 10237
    v_alignbyte_b32 v111, v111, v110, 1
    v_perm_b32 v110, v110, v114, s47
    s_waitcnt lgkmcnt(1)
    v_add3_u32 v116, v116, v106, s54
    v_sub_u32 v117, 0, v116
    v_and_b32 v117, 3, v117
    s_mov_b64 exec, s[80:81]
    v_mov_b32 v117, 0
    v_mov_b32 v112, 0
    s_mov_b64 exec, vcc
    v_mov_b32 v117, 3

    s_mov_b64 exec, -1
    v_alignbyte_b32 v110, v111, v110, v117
    v_alignbyte_b32 v111, v112, v111, v117
    v_add_u32 v116, v116, v117

    buffer_store_dwordx2 v[110:111], v116, s[24:27], 0 offen
    v_cmp_ne_u32_sdwa s[80:81], v119, v121 src0_sel:WORD_1 src1_sel:WORD_1
    v_cmp_ne_u32_sdwa vcc, v119, v123 src0_sel:WORD_1 src1_sel:WORD_1
    v_alignbyte_b32 v122, v123, v122, 2
    s_mov_b32 s54, 15357
    v_alignbyte_b32 v119, v119, v118, 1
    v_perm_b32 v118, v118, v122, s47
    s_waitcnt lgkmcnt(0)
    v_add3_u32 v124, v124, v106, s54
    v_sub_u32 v125, 0, v124
    v_and_b32 v125, 3, v125
    s_mov_b64 exec, s[80:81]
    v_mov_b32 v125, 0
    v_mov_b32 v120, 0
    s_mov_b64 exec, vcc
    v_mov_b32 v125, 3

    s_mov_b64 exec, -1
    v_alignbyte_b32 v118, v119, v118, v125
    v_alignbyte_b32 v119, v120, v119, v125
    v_add_u32 v124, v124, v125

    buffer_store_dwordx2 v[118:119], v124, s[24:27], 0 offen
L_skw_29:
    s_bitcmp0_b32 s28, 1
    s_cbranch_scc1 L_skw_30
    v_add_u32 v107, 32768, v2
    ds_read_b64 v[110:111], v107 offset:16400
    ds_read_b64 v[112:113], v107 offset:16408
    ds_read_b64 v[114:115], v107 offset:16392

    ds_read_b64 v[118:119], v107 offset:24592
    ds_read_b64 v[120:121], v107 offset:24600
    ds_read_b64 v[122:123], v107 offset:24584

    s_waitcnt lgkmcnt(3)
    v_lshrrev_b32 v116, 16, v111
    ds_read_b32 v116, v116 offset:8192

    s_waitcnt lgkmcnt(1)
    v_lshrrev_b32 v124, 16, v119
    ds_read_b32 v124, v124 offset:8192

    v_cmp_ne_u32_sdwa s[80:81], v111, v113 src0_sel:WORD_1 src1_sel:WORD_1
    v_cmp_ne_u32_sdwa vcc, v111, v115 src0_sel:WORD_1 src1_sel:WORD_1
    v_alignbyte_b32 v114, v115, v114, 2
    s_mov_b32 s54, 20477
    v_alignbyte_b32 v111, v111, v110, 1
    v_perm_b32 v110, v110, v114, s47
    s_waitcnt lgkmcnt(1)
    v_add3_u32 v116, v116, v106, s54
    v_sub_u32 v117, 0, v116
    v_and_b32 v117, 3, v117
    s_mov_b64 exec, s[80:81]
    v_mov_b32 v117, 0
    v_mov_b32 v112, 0
    s_mov_b64 exec, vcc
    v_mov_b32 v117, 3

    s_mov_b64 exec, -1
    v_alignbyte_b32 v110, v111, v110, v117
    v_alignbyte_b32 v111, v112, v111, v117
    v_add_u32 v116, v116, v117

    buffer_store_dwordx2 v[110:111], v116, s[24:27], 0 offen
    v_cmp_ne_u32_sdwa s[80:81], v119, v121 src0_sel:WORD_1 src1_sel:WORD_1
    v_cmp_ne_u32_sdwa vcc, v119, v123 src0_sel:WORD_1 src1_sel:WORD_1
    v_alignbyte_b32 v122, v123, v122, 2
    s_mov_b32 s54, 25597
    v_alignbyte_b32 v119, v119, v118, 1
    v_perm_b32 v118, v118, v122, s47
    s_waitcnt lgkmcnt(0)
    v_add3_u32 v124, v124, v106, s54
    v_sub_u32 v125, 0, v124
    v_and_b32 v125, 3, v125
    s_mov_b64 exec, s[80:81]
    v_mov_b32 v125, 0
    v_mov_b32 v120, 0
    s_mov_b64 exec, vcc
    v_mov_b32 v125, 3

    s_mov_b64 exec, -1
    v_alignbyte_b32 v118, v119, v118, v125
    v_alignbyte_b32 v119, v120, v119, v125
    v_add_u32 v124, v124, v125

    buffer_store_dwordx2 v[118:119], v124, s[24:27], 0 offen
L_skw_30:
    s_bitcmp0_b32 s28, 1
    s_cbranch_scc1 L_skw_31
    v_add_u32 v107, 32768, v2
    ds_read_b64 v[110:111], v107 offset:32784
    ds_read_b64 v[112:113], v107 offset:32792
    ds_read_b64 v[114:115], v107 offset:32776

    ds_read_b64 v[118:119], v107 offset:40976
    ds_read_b64 v[120:121], v107 offset:40984
    ds_read_b64 v[122:123], v107 offset:40968

    s_waitcnt lgkmcnt(3)
    v_lshrrev_b32 v116, 16, v111
    ds_read_b32 v116, v116 offset:8192

    s_waitcnt lgkmcnt(1)
    v_lshrrev_b32 v124, 16, v119
    ds_read_b32 v124, v124 offset:8192

    v_cmp_ne_u32_sdwa s[80:81], v111, v113 src0_sel:WORD_1 src1_sel:WORD_1
    v_cmp_ne_u32_sdwa vcc, v111, v115 src0_sel:WORD_1 src1_sel:WORD_1
    v_alignbyte_b32 v114, v115, v114, 2
    s_mov_b32 s54, 30717
    v_alignbyte_b32 v111, v111, v110, 1
    v_perm_b32 v110, v110, v114, s47
    s_waitcnt lgkmcnt(1)
    v_add3_u32 v116, v116, v106, s54
    v_sub_u32 v117, 0, v116
    v_and_b32 v117, 3, v117
    s_mov_b64 exec, s[80:81]
    v_mov_b32 v117, 0
    v_mov_b32 v112, 0
    s_mov_b64 exec, vcc
    v_mov_b32 v117, 3

    s_mov_b64 exec, -1
    v_alignbyte_b32 v110, v111, v110, v117
    v_alignbyte_b32 v111, v112, v111, v117
    v_add_u32 v116, v116, v117

    buffer_store_dwordx2 v[110:111], v116, s[24:27], 0 offen
    v_cmp_ne_u32_sdwa s[80:81], v119, v121 src0_sel:WORD_1 src1_sel:WORD_1
    v_cmp_ne_u32_sdwa vcc, v119, v123 src0_sel:WORD_1 src1_sel:WORD_1
    v_alignbyte_b32 v122, v123, v122, 2
    s_mov_b32 s54, 35837
    v_alignbyte_b32 v119, v119, v118, 1
    v_perm_b32 v118, v118, v122, s47
    s_waitcnt lgkmcnt(0)
    v_add3_u32 v124, v124, v106, s54
    v_sub_u32 v125, 0, v124
    v_and_b32 v125, 3, v125
    s_mov_b64 exec, s[80:81]
    v_mov_b32 v125, 0
    v_mov_b32 v120, 0
    s_mov_b64 exec, vcc
    v_mov_b32 v125, 3

    s_mov_b64 exec, -1
    v_alignbyte_b32 v118, v119, v118, v125
    v_alignbyte_b32 v119, v120, v119, v125
    v_add_u32 v124, v124, v125

    buffer_store_dwordx2 v[118:119], v124, s[24:27], 0 offen
L_skw_31:
    s_mov_b64 exec, s[66:67]
    v_mul_hi_u32_u24 v69, s40, v32
    v_mul_hi_u32_u24 v68, s40, v16
    v_mul_hi_u32_u24 v71, s40, v33
    v_mul_hi_u32_u24 v70, s40, v17
    v_mul_hi_u32_u24 v73, s40, v34
    v_mul_hi_u32_u24 v72, s40, v18
    v_mul_hi_u32_u24 v75, s40, v35
    v_mul_hi_u32_u24 v74, s40, v19
    v_and_b32 v69, -2, v69
    v_mad_u32_u24 v16, v68, s43, v16
    v_and_b32 v88, -4, v68
    v_and_b32 v71, -2, v71
    v_mad_u32_u24 v17, v70, s43, v17
    v_and_b32 v89, -4, v70
    v_and_b32 v73, -2, v73
    v_mad_u32_u24 v18, v72, s43, v18
    v_and_b32 v90, -4, v72
    v_and_b32 v75, -2, v75
    v_mad_u32_u24 v19, v74, s43, v19
    v_and_b32 v91, -4, v74
    v_mad_i32_i24 v32, v69, s42, v32
    v_lshl_add_u32 v69, v88, 5, v69
    v_mad_i32_i24 v33, v71, s42, v33
    v_lshl_add_u32 v71, v89, 5, v71
    v_mad_i32_i24 v34, v73, s42, v34
    v_lshl_add_u32 v73, v90, 5, v73
    v_mad_i32_i24 v35, v75, s42, v35
    v_lshl_add_u32 v75, v91, 5, v75
    v_add_u32 v69, v69, v69
    ds_add_rtn_u32 v88, v69, v104
    v_add_u32 v71, v71, v71
    ds_add_rtn_u32 v89, v71, v104
    v_add_u32 v73, v73, v73
    ds_add_rtn_u32 v90, v73, v104
    v_add_u32 v75, v75, v75
    ds_add_rtn_u32 v91, v75, v104
    v_lshlrev_b32 v110, 16, v42
    v_and_b32 v111, 0xffff0000, v42
    v_lshlrev_b32 v112, 16, v43
    v_and_b32 v113, 0xffff0000, v43
    v_mul_f32 v110, s44, v110
    v_mul_f32 v111, s44, v111
    v_mul_f32 v112, s44, v112
    v_mul_f32 v113, s44, v113
    v_fract_f32 v110, v110
    v_fract_f32 v111, v111
    v_fract_f32 v112, v112
    v_fract_f32 v113, v113
    v_cos_f32 v110, v110
    v_cos_f32 v111, v111
    v_cos_f32 v112, v112
    v_cos_f32 v113, v113
    v_lshl_or_b32 v68, v68, 14, v32
    v_perm_b32 v69, v69, v16, s46
    v_bfe_u32 v16, v16, 8, 5

    v_lshl_or_b32 v70, v70, 14, v33
    v_perm_b32 v71, v71, v17, s46
    v_bfe_u32 v17, v17, 8, 5

    v_lshl_or_b32 v72, v72, 14, v34
    v_perm_b32 v73, v73, v18, s46
    v_bfe_u32 v18, v18, 8, 5

    v_lshl_or_b32 v74, v74, 14, v35
    v_perm_b32 v75, v75, v19, s46
    v_bfe_u32 v19, v19, 8, 5

    v_fmaak_f32 v110, v110, v105, 0x4b400010
    v_fmaak_f32 v111, v111, v105, 0x4b400010
    v_fmaak_f32 v112, v112, v105, 0x4b400010
    v_fmaak_f32 v113, v113, v105, 0x4b400010
    v_sub_u32 v110, v110, v16
    v_sub_u32 v111, v111, v17
    v_sub_u32 v112, v112, v18
    v_sub_u32 v113, v113, v19
    v_bfi_b32 v110, 31, v16, v110
    v_bfi_b32 v111, 31, v17, v111
    v_bfi_b32 v112, 31, v18, v112
    v_bfi_b32 v113, 31, v19, v113
    v_perm_b32 v68, v68, v110, s55
    v_perm_b32 v70, v70, v111, s55
    v_perm_b32 v72, v72, v112, s55
    v_perm_b32 v74, v74, v113, s55
    s_mov_b64 exec, -1
    s_bitcmp0_b32 s28, 2
    s_cbranch_scc1 L_skw_33
    v_add_u32 v107, 65536, v2
    ds_read_b64 v[110:111], v107 offset:16400
    ds_read_b64 v[112:113], v107 offset:16408
    ds_read_b64 v[114:115], v107 offset:16392

    ds_read_b64 v[118:119], v107 offset:24592
    ds_read_b64 v[120:121], v107 offset:24600
    ds_read_b64 v[122:123], v107 offset:24584

    s_waitcnt lgkmcnt(3)
    v_lshrrev_b32 v116, 16, v111
    ds_read_b32 v116, v116 offset:8192

    s_waitcnt lgkmcnt(1)
    v_lshrrev_b32 v124, 16, v119
    ds_read_b32 v124, v124 offset:8192

    v_cmp_ne_u32_sdwa s[80:81], v111, v113 src0_sel:WORD_1 src1_sel:WORD_1
    v_cmp_ne_u32_sdwa vcc, v111, v115 src0_sel:WORD_1 src1_sel:WORD_1
    v_alignbyte_b32 v114, v115, v114, 2
    s_mov_b32 s54, 40957
    v_alignbyte_b32 v111, v111, v110, 1
    v_perm_b32 v110, v110, v114, s47
    s_waitcnt lgkmcnt(1)
    v_add3_u32 v116, v116, v106, s54
    v_sub_u32 v117, 0, v116
    v_and_b32 v117, 3, v117
    s_mov_b64 exec, s[80:81]
    v_mov_b32 v117, 0
    v_mov_b32 v112, 0
    s_mov_b64 exec, vcc
    v_mov_b32 v117, 3

    s_mov_b64 exec, -1
    v_alignbyte_b32 v110, v111, v110, v117
    v_alignbyte_b32 v111, v112, v111, v117
    v_add_u32 v116, v116, v117

    buffer_store_dwordx2 v[110:111], v116, s[24:27], 0 offen
    v_cmp_ne_u32_sdwa s[80:81], v119, v121 src0_sel:WORD_1 src1_sel:WORD_1
    v_cmp_ne_u32_sdwa vcc, v119, v123 src0_sel:WORD_1 src1_sel:WORD_1
    v_alignbyte_b32 v122, v123, v122, 2
    s_mov_b32 s54, 46077
    v_alignbyte_b32 v119, v119, v118, 1
    v_perm_b32 v118, v118, v122, s47
    s_waitcnt lgkmcnt(0)
    v_add3_u32 v124, v124, v106, s54
    v_sub_u32 v125, 0, v124
    v_and_b32 v125, 3, v125
    s_mov_b64 exec, s[80:81]
    v_mov_b32 v125, 0
    v_mov_b32 v120, 0
    s_mov_b64 exec, vcc
    v_mov_b32 v125, 3

    s_mov_b64 exec, -1
    v_alignbyte_b32 v118, v119, v118, v125
    v_alignbyte_b32 v119, v120, v119, v125
    v_add_u32 v124, v124, v125

    buffer_store_dwordx2 v[118:119], v124, s[24:27], 0 offen
L_skw_33:
    s_bitcmp0_b32 s28, 2
    s_cbranch_scc1 L_skw_34
    v_add_u32 v107, 65536, v2
    ds_read_b64 v[110:111], v107 offset:32784
    ds_read_b64 v[112:113], v107 offset:32792
    ds_read_b64 v[114:115], v107 offset:32776

    ds_read_b64 v[118:119], v107 offset:40976
    ds_read_b64 v[120:121], v107 offset:40984
    ds_read_b64 v[122:123], v107 offset:40968

    s_waitcnt lgkmcnt(3)
    v_lshrrev_b32 v116, 16, v111
    ds_read_b32 v116, v116 offset:8192

    s_waitcnt lgkmcnt(1)
    v_lshrrev_b32 v124, 16, v119
    ds_read_b32 v124, v124 offset:8192

    v_cmp_ne_u32_sdwa s[80:81], v111, v113 src0_sel:WORD_1 src1_sel:WORD_1
    v_cmp_ne_u32_sdwa vcc, v111, v115 src0_sel:WORD_1 src1_sel:WORD_1
    v_alignbyte_b32 v114, v115, v114, 2
    s_mov_b32 s54, 51197
    v_alignbyte_b32 v111, v111, v110, 1
    v_perm_b32 v110, v110, v114, s47
    s_waitcnt lgkmcnt(1)
    v_add3_u32 v116, v116, v106, s54
    v_sub_u32 v117, 0, v116
    v_and_b32 v117, 3, v117
    s_mov_b64 exec, s[80:81]
    v_mov_b32 v117, 0
    v_mov_b32 v112, 0
    s_mov_b64 exec, vcc
    v_mov_b32 v117, 3

    s_mov_b64 exec, -1
    v_alignbyte_b32 v110, v111, v110, v117
    v_alignbyte_b32 v111, v112, v111, v117
    v_add_u32 v116, v116, v117

    buffer_store_dwordx2 v[110:111], v116, s[24:27], 0 offen
    v_cmp_ne_u32_sdwa s[80:81], v119, v121 src0_sel:WORD_1 src1_sel:WORD_1
    v_cmp_ne_u32_sdwa vcc, v119, v123 src0_sel:WORD_1 src1_sel:WORD_1
    v_alignbyte_b32 v122, v123, v122, 2
    s_mov_b32 s54, 56317
    v_alignbyte_b32 v119, v119, v118, 1
    v_perm_b32 v118, v118, v122, s47
    s_waitcnt lgkmcnt(0)
    v_add3_u32 v124, v124, v106, s54
    v_sub_u32 v125, 0, v124
    v_and_b32 v125, 3, v125
    s_mov_b64 exec, s[80:81]
    v_mov_b32 v125, 0
    v_mov_b32 v120, 0
    s_mov_b64 exec, vcc
    v_mov_b32 v125, 3

    s_mov_b64 exec, -1
    v_alignbyte_b32 v118, v119, v118, v125
    v_alignbyte_b32 v119, v120, v119, v125
    v_add_u32 v124, v124, v125

    buffer_store_dwordx2 v[118:119], v124, s[24:27], 0 offen
L_skw_34:
    s_bitcmp0_b32 s28, 3
    s_cbranch_scc1 L_skw_35
    v_add_u32 v107, 98304, v2
    ds_read_b64 v[110:111], v107 offset:16400
    ds_read_b64 v[112:113], v107 offset:16408
    ds_read_b64 v[114:115], v107 offset:16392

    ds_read_b64 v[118:119], v107 offset:24592
    ds_read_b64 v[120:121], v107 offset:24600
    ds_read_b64 v[122:123], v107 offset:24584

    s_waitcnt lgkmcnt(3)
    v_lshrrev_b32 v116, 16, v111
    ds_read_b32 v116, v116 offset:8192

    s_waitcnt lgkmcnt(1)
    v_lshrrev_b32 v124, 16, v119
    ds_read_b32 v124, v124 offset:8192

    v_cmp_ne_u32_sdwa s[80:81], v111, v113 src0_sel:WORD_1 src1_sel:WORD_1
    v_cmp_ne_u32_sdwa vcc, v111, v115 src0_sel:WORD_1 src1_sel:WORD_1
    v_alignbyte_b32 v114, v115, v114, 2
    s_mov_b32 s54, 61437
    v_alignbyte_b32 v111, v111, v110, 1
    v_perm_b32 v110, v110, v114, s47
    s_waitcnt lgkmcnt(1)
    v_add3_u32 v116, v116, v106, s54
    v_sub_u32 v117, 0, v116
    v_and_b32 v117, 3, v117
    s_mov_b64 exec, s[80:81]
    v_mov_b32 v117, 0
    v_mov_b32 v112, 0
    s_mov_b64 exec, vcc
    v_mov_b32 v117, 3

    s_mov_b64 exec, -1
    v_alignbyte_b32 v110, v111, v110, v117
    v_alignbyte_b32 v111, v112, v111, v117
    v_add_u32 v116, v116, v117

    buffer_store_dwordx2 v[110:111], v116, s[24:27], 0 offen
    v_cmp_ne_u32_sdwa s[80:81], v119, v121 src0_sel:WORD_1 src1_sel:WORD_1
    v_cmp_ne_u32_sdwa vcc, v119, v123 src0_sel:WORD_1 src1_sel:WORD_1
    v_alignbyte_b32 v122, v123, v122, 2
    s_mov_b32 s54, 66557
    v_alignbyte_b32 v119, v119, v118, 1
    v_perm_b32 v118, v118, v122, s47
    s_waitcnt lgkmcnt(0)
    v_add3_u32 v124, v124, v106, s54
    v_sub_u32 v125, 0, v124
    v_and_b32 v125, 3, v125
    s_mov_b64 exec, s[80:81]
    v_mov_b32 v125, 0
    v_mov_b32 v120, 0
    s_mov_b64 exec, vcc
    v_mov_b32 v125, 3

    s_mov_b64 exec, -1
    v_alignbyte_b32 v118, v119, v118, v125
    v_alignbyte_b32 v119, v120, v119, v125
    v_add_u32 v124, v124, v125

    buffer_store_dwordx2 v[118:119], v124, s[24:27], 0 offen
L_skw_35:
    s_bitcmp0_b32 s28, 3
    s_cbranch_scc1 L_skw_36
    v_add_u32 v107, 98304, v2
    ds_read_b64 v[110:111], v107 offset:32784
    ds_read_b64 v[112:113], v107 offset:32792
    ds_read_b64 v[114:115], v107 offset:32776

    ds_read_b64 v[118:119], v107 offset:40976
    ds_read_b64 v[120:121], v107 offset:40984
    ds_read_b64 v[122:123], v107 offset:40968

    s_waitcnt lgkmcnt(3)
    v_lshrrev_b32 v116, 16, v111
    ds_read_b32 v116, v116 offset:8192

    s_waitcnt lgkmcnt(1)
    v_lshrrev_b32 v124, 16, v119
    ds_read_b32 v124, v124 offset:8192

    v_cmp_ne_u32_sdwa s[80:81], v111, v113 src0_sel:WORD_1 src1_sel:WORD_1
    v_cmp_ne_u32_sdwa vcc, v111, v115 src0_sel:WORD_1 src1_sel:WORD_1
    v_alignbyte_b32 v114, v115, v114, 2
    s_mov_b32 s54, 71677
    v_alignbyte_b32 v111, v111, v110, 1
    v_perm_b32 v110, v110, v114, s47
    s_waitcnt lgkmcnt(1)
    v_add3_u32 v116, v116, v106, s54
    v_sub_u32 v117, 0, v116
    v_and_b32 v117, 3, v117
    s_mov_b64 exec, s[80:81]
    v_mov_b32 v117, 0
    v_mov_b32 v112, 0
    s_mov_b64 exec, vcc
    v_mov_b32 v117, 3

    s_mov_b64 exec, -1
    v_alignbyte_b32 v110, v111, v110, v117
    v_alignbyte_b32 v111, v112, v111, v117
    v_add_u32 v116, v116, v117

    buffer_store_dwordx2 v[110:111], v116, s[24:27], 0 offen
    v_cmp_ne_u32_sdwa s[80:81], v119, v121 src0_sel:WORD_1 src1_sel:WORD_1
    v_cmp_ne_u32_sdwa vcc, v119, v123 src0_sel:WORD_1 src1_sel:WORD_1
    v_alignbyte_b32 v122, v123, v122, 2
    s_mov_b32 s54, 76797
    v_alignbyte_b32 v119, v119, v118, 1
    v_perm_b32 v118, v118, v122, s47
    s_waitcnt lgkmcnt(0)
    v_add3_u32 v124, v124, v106, s54
    v_sub_u32 v125, 0, v124
    v_and_b32 v125, 3, v125
    s_mov_b64 exec, s[80:81]
    v_mov_b32 v125, 0
    v_mov_b32 v120, 0
    s_mov_b64 exec, vcc
    v_mov_b32 v125, 3

    s_andn2_b64 exec, -1, s[68:69]
    v_bfrev_b32 v124, 1
    s_mov_b64 exec, -1
    v_alignbyte_b32 v118, v119, v118, v125
    v_alignbyte_b32 v119, v120, v119, v125
    v_add_u32 v124, v124, v125

    buffer_store_dwordx2 v[118:119], v124, s[24:27], 0 offen
L_skw_36:
    s_mov_b32 s28, 15
    s_mov_b32 s29, 0
    s_movk_i32 s30, 16000

    s_waitcnt lgkmcnt(0)
    s_barrier

    buffer_load_dwordx4 v[20:23], v1, s[12:15], s56 offen nt
    buffer_load_dwordx4 v[4:7], v1, s[8:11], s56 offen nt
    buffer_load_dwordx2 v[36:37], v2, s[16:19], s61 offen nt
    ds_read_b64 v[94:95], v2
    s_waitcnt lgkmcnt(0)
    v_and_b32 v94, 0xffff, v94
    v_and_b32 v95, 0xffff, v95
    v_add_u32 v97, v94, v95
    s_nop 1
    v_add_u32_dpp v97, v97, v97 row_shr:1 row_mask:0xf bank_mask:0xf
    s_nop 1
    v_add_u32_dpp v97, v97, v97 row_shr:2 row_mask:0xf bank_mask:0xf
    s_nop 1
    v_add_u32_dpp v97, v97, v97 row_shr:4 row_mask:0xf bank_mask:0xf
    s_nop 1
    v_add_u32_dpp v97, v97, v97 row_shr:8 row_mask:0xf bank_mask:0xf
    s_nop 1
    v_add_u32_dpp v97, v97, v97 row_bcast:15 row_mask:0xa bank_mask:0xf
    s_nop 1
    v_add_u32_dpp v97, v97, v97 row_bcast:31 row_mask:0xc bank_mask:0xf
    s_mov_b32 exec_lo, 0
    s_brev_b32 exec_hi, 1
    ds_add_rtn_u32 v96, v108, v97
    s_mov_b64 exec, -1

    v_add_u32 v92, v94, v94
    v_add_u32 v93, v95, v95
    v_med3_u32 v92, v94, 2, v92
    v_med3_u32 v93, v95, 2, v93
    buffer_atomic_add_x2 v[92:93], v2, s[20:23], 0 offen sc0
    s_waitcnt lgkmcnt(0)
    v_readlane_b32 s77, v96, 63
    v_mul_u32_u24 v114, 7936, v0
    v_sub_u32 v97, v97, v95
    s_sub_u32 s77, s77, s50
    v_add_u32 v97, s77, v97
    v_sub_u32 v96, v97, v94
    v_lshlrev_b32 v111, 16, v97
    v_lshlrev_b32 v110, 16, v96
    ds_write_b64 v2, v[110:111]
    v_sub_u32 v96, v114, v96
    v_sub_u32 v97, v114, v97
    v_add_u32 v97, s48, v97
    s_add_u32 s50, s50, s30

    s_waitcnt lgkmcnt(0)
    s_barrier

    buffer_load_dwordx4 v[24:27], v1, s[12:15], s57 offen nt
    buffer_load_dwordx4 v[8:11], v1, s[8:11], s57 offen nt
    buffer_load_dwordx2 v[38:39], v2, s[16:19], s62 offen nt
    buffer_load_dwordx4 v[28:31], v1, s[12:15], s58 offen nt
    buffer_load_dwordx4 v[12:15], v1, s[8:11], s58 offen nt
    buffer_load_dwordx2 v[40:41], v2, s[16:19], s63 offen nt
    buffer_load_dwordx4 v[32:35], v1, s[12:15], s59 offen nt
    buffer_load_dwordx4 v[16:19], v1, s[8:11], s59 offen nt
    buffer_load_dwordx2 v[42:43], v2, s[16:19], s64 offen nt
    v_lshrrev_b32 v110, 16, v45
    ds_read_b32 v110, v110
    v_lshrrev_b32 v111, 16, v47
    ds_read_b32 v111, v111
    v_lshrrev_b32 v112, 16, v49
    ds_read_b32 v112, v112
    v_lshrrev_b32 v113, 16, v51
    ds_read_b32 v113, v113
    v_lshrrev_b32 v114, 16, v53
    ds_read_b32 v114, v114
    v_lshrrev_b32 v115, 16, v55
    ds_read_b32 v115, v115
    v_lshrrev_b32 v116, 16, v57
    ds_read_b32 v116, v116
    v_lshrrev_b32 v117, 16, v59
    ds_read_b32 v117, v117
    s_waitcnt lgkmcnt(7)
    v_add_u32_sdwa v110, v110, v76 dst_sel:DWORD dst_unused:UNUSED_PAD src0_sel:WORD_1 src1_sel:WORD_0
    v_lshlrev_b32 v110, 3, v110
    ds_write_b64 v110, v[44:45] offset:16400

    s_waitcnt lgkmcnt(7)
    v_add_u32_sdwa v111, v111, v77 dst_sel:DWORD dst_unused:UNUSED_PAD src0_sel:WORD_1 src1_sel:WORD_0
    v_lshlrev_b32 v111, 3, v111
    ds_write_b64 v111, v[46:47] offset:16400

    s_waitcnt lgkmcnt(7)
    v_add_u32_sdwa v112, v112, v78 dst_sel:DWORD dst_unused:UNUSED_PAD src0_sel:WORD_1 src1_sel:WORD_0
    v_lshlrev_b32 v112, 3, v112
    ds_write_b64 v112, v[48:49] offset:16400

    s_waitcnt lgkmcnt(7)
    v_add_u32_sdwa v113, v113, v79 dst_sel:DWORD dst_unused:UNUSED_PAD src0_sel:WORD_1 src1_sel:WORD_0
    v_lshlrev_b32 v113, 3, v113
    ds_write_b64 v113, v[50:51] offset:16400

    s_waitcnt lgkmcnt(7)
    v_add_u32_sdwa v114, v114, v80 dst_sel:DWORD dst_unused:UNUSED_PAD src0_sel:WORD_1 src1_sel:WORD_0
    v_lshlrev_b32 v114, 3, v114
    ds_write_b64 v114, v[52:53] offset:16400

    s_waitcnt lgkmcnt(7)
    v_add_u32_sdwa v115, v115, v81 dst_sel:DWORD dst_unused:UNUSED_PAD src0_sel:WORD_1 src1_sel:WORD_0
    v_lshlrev_b32 v115, 3, v115
    ds_write_b64 v115, v[54:55] offset:16400

    s_waitcnt lgkmcnt(7)
    v_add_u32_sdwa v116, v116, v82 dst_sel:DWORD dst_unused:UNUSED_PAD src0_sel:WORD_1 src1_sel:WORD_0
    v_lshlrev_b32 v116, 3, v116
    ds_write_b64 v116, v[56:57] offset:16400

    s_waitcnt lgkmcnt(7)
    v_add_u32_sdwa v117, v117, v83 dst_sel:DWORD dst_unused:UNUSED_PAD src0_sel:WORD_1 src1_sel:WORD_0
    v_lshlrev_b32 v117, 3, v117
    ds_write_b64 v117, v[58:59] offset:16400

    v_lshrrev_b32 v110, 16, v61
    ds_read_b32 v110, v110
    v_lshrrev_b32 v111, 16, v63
    ds_read_b32 v111, v111
    v_lshrrev_b32 v112, 16, v65
    ds_read_b32 v112, v112
    v_lshrrev_b32 v113, 16, v67
    ds_read_b32 v113, v113
    s_waitcnt lgkmcnt(3)
    v_add_u32_sdwa v110, v110, v84 dst_sel:DWORD dst_unused:UNUSED_PAD src0_sel:WORD_1 src1_sel:WORD_0
    v_lshlrev_b32 v110, 3, v110
    ds_write_b64 v110, v[60:61] offset:16400

    s_waitcnt lgkmcnt(3)
    v_add_u32_sdwa v111, v111, v85 dst_sel:DWORD dst_unused:UNUSED_PAD src0_sel:WORD_1 src1_sel:WORD_0
    v_lshlrev_b32 v111, 3, v111
    ds_write_b64 v111, v[62:63] offset:16400

    s_waitcnt lgkmcnt(3)
    v_add_u32_sdwa v112, v112, v86 dst_sel:DWORD dst_unused:UNUSED_PAD src0_sel:WORD_1 src1_sel:WORD_0
    v_lshlrev_b32 v112, 3, v112
    ds_write_b64 v112, v[64:65] offset:16400

    s_waitcnt lgkmcnt(3)
    v_add_u32_sdwa v113, v113, v87 dst_sel:DWORD dst_unused:UNUSED_PAD src0_sel:WORD_1 src1_sel:WORD_0
    v_lshlrev_b32 v113, 3, v113
    ds_write_b64 v113, v[66:67] offset:16400

    s_mov_b64 exec, s[66:67]
    v_lshrrev_b32 v110, 16, v69
    ds_read_b32 v110, v110
    v_lshrrev_b32 v111, 16, v71
    ds_read_b32 v111, v111
    v_lshrrev_b32 v112, 16, v73
    ds_read_b32 v112, v112
    v_lshrrev_b32 v113, 16, v75
    ds_read_b32 v113, v113
    s_waitcnt lgkmcnt(3)
    v_add_u32_sdwa v110, v110, v88 dst_sel:DWORD dst_unused:UNUSED_PAD src0_sel:WORD_1 src1_sel:WORD_0
    v_lshlrev_b32 v110, 3, v110
    ds_write_b64 v110, v[68:69] offset:16400

    s_waitcnt lgkmcnt(3)
    v_add_u32_sdwa v111, v111, v89 dst_sel:DWORD dst_unused:UNUSED_PAD src0_sel:WORD_1 src1_sel:WORD_0
    v_lshlrev_b32 v111, 3, v111
    ds_write_b64 v111, v[70:71] offset:16400

    s_waitcnt lgkmcnt(3)
    v_add_u32_sdwa v112, v112, v90 dst_sel:DWORD dst_unused:UNUSED_PAD src0_sel:WORD_1 src1_sel:WORD_0
    v_lshlrev_b32 v112, 3, v112
    ds_write_b64 v112, v[72:73] offset:16400

    s_waitcnt lgkmcnt(3)
    v_add_u32_sdwa v113, v113, v91 dst_sel:DWORD dst_unused:UNUSED_PAD src0_sel:WORD_1 src1_sel:WORD_0
    v_lshlrev_b32 v113, 3, v113
    ds_write_b64 v113, v[74:75] offset:16400

    s_mov_b64 exec, -1
    s_cmp_lg_u32 s49, 0
    s_cbranch_scc1 L_p1loop_5
L_p1epi_6:
    s_waitcnt vmcnt(0)
    s_waitcnt vmcnt(9)
    v_add_u32 v110, v92, v94
    v_min_u32 v92, s48, v92
    v_add_u32 v111, v93, v95
    v_min_u32 v93, s48, v93
    v_max_u32 v110, v110, v111
    v_add_u32 v92, v92, v96
    v_add_u32 v93, v93, v97
    v_cmp_le_u32 vcc, s48, v110
    v_lshl_add_u32 v92, v92, 2, v92
    v_lshl_add_u32 v93, v93, 2, v93
    ds_write_b64 v2, v[92:93] offset:8192
    s_cbranch_vccz L_noov_40
    ds_write_b32 v108, v104 offset:4
L_noov_40:

    s_waitcnt lgkmcnt(0)
    s_barrier
    ds_read_b32 v110, v108 offset:4
    s_waitcnt lgkmcnt(0)
    v_readfirstlane_b32 s53, v110
    s_nop 1

    s_cmp_lg_u32 s53, 0
    s_cbranch_scc1 L_slow_41
L_sback_42:
    s_bitcmp0_b32 s28, 0
    s_cbranch_scc1 L_skw_46
    ds_read_b64 v[4:5], v2 offset:16400
    ds_read_b64 v[6:7], v2 offset:16408
    ds_read_b64 v[8:9], v2 offset:16392

    ds_read_b64 v[12:13], v2 offset:24592
    ds_read_b64 v[14:15], v2 offset:24600
    ds_read_b64 v[16:17], v2 offset:24584

    ds_read_b64 v[20:21], v2 offset:32784
    ds_read_b64 v[22:23], v2 offset:32792
    ds_read_b64 v[24:25], v2 offset:32776

    ds_read_b64 v[28:29], v2 offset:40976
    ds_read_b64 v[30:31], v2 offset:40984
    ds_read_b64 v[32:33], v2 offset:40968

    s_waitcnt lgkmcnt(9)
    v_lshrrev_b32 v10, 16, v5
    ds_read_b32 v10, v10 offset:8192

    s_waitcnt lgkmcnt(7)
    v_lshrrev_b32 v18, 16, v13
    ds_read_b32 v18, v18 offset:8192

    s_waitcnt lgkmcnt(5)
    v_lshrrev_b32 v26, 16, v21
    ds_read_b32 v26, v26 offset:8192

    s_waitcnt lgkmcnt(3)
    v_lshrrev_b32 v34, 16, v29
    ds_read_b32 v34, v34 offset:8192

    v_cmp_ne_u32_sdwa s[80:81], v5, v7 src0_sel:WORD_1 src1_sel:WORD_1
    v_cmp_ne_u32_sdwa vcc, v5, v9 src0_sel:WORD_1 src1_sel:WORD_1
    v_alignbyte_b32 v8, v9, v8, 2
    s_mov_b32 s54, -3
    v_alignbyte_b32 v5, v5, v4, 1
    v_perm_b32 v4, v4, v8, s47
    s_waitcnt lgkmcnt(3)
    v_add3_u32 v10, v10, v106, s54
    v_sub_u32 v11, 0, v10
    v_and_b32 v11, 3, v11
    s_mov_b64 exec, s[80:81]
    v_mov_b32 v11, 0
    v_mov_b32 v6, 0
    s_mov_b64 exec, vcc
    v_mov_b32 v11, 3

    s_mov_b64 exec, -1
    v_alignbyte_b32 v4, v5, v4, v11
    v_alignbyte_b32 v5, v6, v5, v11
    v_add_u32 v10, v10, v11

    buffer_store_dwordx2 v[4:5], v10, s[24:27], 0 offen
    v_cmp_ne_u32_sdwa s[80:81], v13, v15 src0_sel:WORD_1 src1_sel:WORD_1
    v_cmp_ne_u32_sdwa vcc, v13, v17 src0_sel:WORD_1 src1_sel:WORD_1
    v_alignbyte_b32 v16, v17, v16, 2
    s_mov_b32 s54, 5117
    v_alignbyte_b32 v13, v13, v12, 1
    v_perm_b32 v12, v12, v16, s47
    s_waitcnt lgkmcnt(2)
    v_add3_u32 v18, v18, v106, s54
    v_sub_u32 v19, 0, v18
    v_and_b32 v19, 3, v19
    s_mov_b64 exec, s[80:81]
    v_mov_b32 v19, 0
    v_mov_b32 v14, 0
    s_mov_b64 exec, vcc
    v_mov_b32 v19, 3

    s_mov_b64 exec, -1
    v_alignbyte_b32 v12, v13, v12, v19
    v_alignbyte_b32 v13, v14, v13, v19
    v_add_u32 v18, v18, v19

    buffer_store_dwordx2 v[12:13], v18, s[24:27], 0 offen
    v_cmp_ne_u32_sdwa s[80:81], v21, v23 src0_sel:WORD_1 src1_sel:WORD_1
    v_cmp_ne_u32_sdwa vcc, v21, v25 src0_sel:WORD_1 src1_sel:WORD_1
    v_alignbyte_b32 v24, v25, v24, 2
    s_mov_b32 s54, 10237
    v_alignbyte_b32 v21, v21, v20, 1
    v_perm_b32 v20, v20, v24, s47
    s_waitcnt lgkmcnt(1)
    v_add3_u32 v26, v26, v106, s54
    v_sub_u32 v27, 0, v26
    v_and_b32 v27, 3, v27
    s_mov_b64 exec, s[80:81]
    v_mov_b32 v27, 0
    v_mov_b32 v22, 0
    s_mov_b64 exec, vcc
    v_mov_b32 v27, 3

    s_mov_b64 exec, -1
    v_alignbyte_b32 v20, v21, v20, v27
    v_alignbyte_b32 v21, v22, v21, v27
    v_add_u32 v26, v26, v27

    buffer_store_dwordx2 v[20:21], v26, s[24:27], 0 offen
    v_cmp_ne_u32_sdwa s[80:81], v29, v31 src0_sel:WORD_1 src1_sel:WORD_1
    v_cmp_ne_u32_sdwa vcc, v29, v33 src0_sel:WORD_1 src1_sel:WORD_1
    v_alignbyte_b32 v32, v33, v32, 2
    s_mov_b32 s54, 15357
    v_alignbyte_b32 v29, v29, v28, 1
    v_perm_b32 v28, v28, v32, s47
    s_waitcnt lgkmcnt(0)
    v_add3_u32 v34, v34, v106, s54
    v_sub_u32 v35, 0, v34
    v_and_b32 v35, 3, v35
    s_mov_b64 exec, s[80:81]
    v_mov_b32 v35, 0
    v_mov_b32 v30, 0
    s_mov_b64 exec, vcc
    v_mov_b32 v35, 3

    s_mov_b64 exec, -1
    v_alignbyte_b32 v28, v29, v28, v35
    v_alignbyte_b32 v29, v30, v29, v35
    v_add_u32 v34, v34, v35

    buffer_store_dwordx2 v[28:29], v34, s[24:27], 0 offen
L_skw_46:
    s_bitcmp0_b32 s28, 1
    s_cbranch_scc1 L_skw_47
    v_add_u32 v107, 32768, v2
    ds_read_b64 v[4:5], v107 offset:16400
    ds_read_b64 v[6:7], v107 offset:16408
    ds_read_b64 v[8:9], v107 offset:16392

    ds_read_b64 v[12:13], v107 offset:24592
    ds_read_b64 v[14:15], v107 offset:24600
    ds_read_b64 v[16:17], v107 offset:24584

    ds_read_b64 v[20:21], v107 offset:32784
    ds_read_b64 v[22:23], v107 offset:32792
    ds_read_b64 v[24:25], v107 offset:32776

    ds_read_b64 v[28:29], v107 offset:40976
    ds_read_b64 v[30:31], v107 offset:40984
    ds_read_b64 v[32:33], v107 offset:40968

    s_waitcnt lgkmcnt(9)
    v_lshrrev_b32 v10, 16, v5
    ds_read_b32 v10, v10 offset:8192

    s_waitcnt lgkmcnt(7)
    v_lshrrev_b32 v18, 16, v13
    ds_read_b32 v18, v18 offset:8192

    s_waitcnt lgkmcnt(5)
    v_lshrrev_b32 v26, 16, v21
    ds_read_b32 v26, v26 offset:8192

    s_waitcnt lgkmcnt(3)
    v_lshrrev_b32 v34, 16, v29
    ds_read_b32 v34, v34 offset:8192

    v_cmp_ne_u32_sdwa s[80:81], v5, v7 src0_sel:WORD_1 src1_sel:WORD_1
    v_cmp_ne_u32_sdwa vcc, v5, v9 src0_sel:WORD_1 src1_sel:WORD_1
    v_alignbyte_b32 v8, v9, v8, 2
    s_mov_b32 s54, 20477
    v_alignbyte_b32 v5, v5, v4, 1
    v_perm_b32 v4, v4, v8, s47
    s_waitcnt lgkmcnt(3)
    v_add3_u32 v10, v10, v106, s54
    v_sub_u32 v11, 0, v10
    v_and_b32 v11, 3, v11
    s_mov_b64 exec, s[80:81]
    v_mov_b32 v11, 0
    v_mov_b32 v6, 0
    s_mov_b64 exec, vcc
    v_mov_b32 v11, 3

    s_mov_b64 exec, -1
    v_alignbyte_b32 v4, v5, v4, v11
    v_alignbyte_b32 v5, v6, v5, v11
    v_add_u32 v10, v10, v11

    buffer_store_dwordx2 v[4:5], v10, s[24:27], 0 offen
    v_cmp_ne_u32_sdwa s[80:81], v13, v15 src0_sel:WORD_1 src1_sel:WORD_1
    v_cmp_ne_u32_sdwa vcc, v13, v17 src0_sel:WORD_1 src1_sel:WORD_1
    v_alignbyte_b32 v16, v17, v16, 2
    s_mov_b32 s54, 25597
    v_alignbyte_b32 v13, v13, v12, 1
    v_perm_b32 v12, v12, v16, s47
    s_waitcnt lgkmcnt(2)
    v_add3_u32 v18, v18, v106, s54
    v_sub_u32 v19, 0, v18
    v_and_b32 v19, 3, v19
    s_mov_b64 exec, s[80:81]
    v_mov_b32 v19, 0
    v_mov_b32 v14, 0
    s_mov_b64 exec, vcc
    v_mov_b32 v19, 3

    s_mov_b64 exec, -1
    v_alignbyte_b32 v12, v13, v12, v19
    v_alignbyte_b32 v13, v14, v13, v19
    v_add_u32 v18, v18, v19

    buffer_store_dwordx2 v[12:13], v18, s[24:27], 0 offen
    v_cmp_ne_u32_sdwa s[80:81], v21, v23 src0_sel:WORD_1 src1_sel:WORD_1
    v_cmp_ne_u32_sdwa vcc, v21, v25 src0_sel:WORD_1 src1_sel:WORD_1
    v_alignbyte_b32 v24, v25, v24, 2
    s_mov_b32 s54, 30717
    v_alignbyte_b32 v21, v21, v20, 1
    v_perm_b32 v20, v20, v24, s47
    s_waitcnt lgkmcnt(1)
    v_add3_u32 v26, v26, v106, s54
    v_sub_u32 v27, 0, v26
    v_and_b32 v27, 3, v27
    s_mov_b64 exec, s[80:81]
    v_mov_b32 v27, 0
    v_mov_b32 v22, 0
    s_mov_b64 exec, vcc
    v_mov_b32 v27, 3

    s_mov_b64 exec, -1
    v_alignbyte_b32 v20, v21, v20, v27
    v_alignbyte_b32 v21, v22, v21, v27
    v_add_u32 v26, v26, v27

    buffer_store_dwordx2 v[20:21], v26, s[24:27], 0 offen
    v_cmp_ne_u32_sdwa s[80:81], v29, v31 src0_sel:WORD_1 src1_sel:WORD_1
    v_cmp_ne_u32_sdwa vcc, v29, v33 src0_sel:WORD_1 src1_sel:WORD_1
    v_alignbyte_b32 v32, v33, v32, 2
    s_mov_b32 s54, 35837
    v_alignbyte_b32 v29, v29, v28, 1
    v_perm_b32 v28, v28, v32, s47
    s_waitcnt lgkmcnt(0)
    v_add3_u32 v34, v34, v106, s54
    v_sub_u32 v35, 0, v34
    v_and_b32 v35, 3, v35
    s_mov_b64 exec, s[80:81]
    v_mov_b32 v35, 0
    v_mov_b32 v30, 0
    s_mov_b64 exec, vcc
    v_mov_b32 v35, 3

    s_mov_b64 exec, -1
    v_alignbyte_b32 v28, v29, v28, v35
    v_alignbyte_b32 v29, v30, v29, v35
    v_add_u32 v34, v34, v35

    buffer_store_dwordx2 v[28:29], v34, s[24:27], 0 offen
L_skw_47:
    s_bitcmp0_b32 s28, 2
    s_cbranch_scc1 L_skw_48
    v_add_u32 v107, 65536, v2
    ds_read_b64 v[4:5], v107 offset:16400
    ds_read_b64 v[6:7], v107 offset:16408
    ds_read_b64 v[8:9], v107 offset:16392

    ds_read_b64 v[12:13], v107 offset:24592
    ds_read_b64 v[14:15], v107 offset:24600
    ds_read_b64 v[16:17], v107 offset:24584

    ds_read_b64 v[20:21], v107 offset:32784
    ds_read_b64 v[22:23], v107 offset:32792
    ds_read_b64 v[24:25], v107 offset:32776

    ds_read_b64 v[28:29], v107 offset:40976
    ds_read_b64 v[30:31], v107 offset:40984
    ds_read_b64 v[32:33], v107 offset:40968

    s_waitcnt lgkmcnt(9)
    v_lshrrev_b32 v10, 16, v5
    ds_read_b32 v10, v10 offset:8192

    s_waitcnt lgkmcnt(7)
    v_lshrrev_b32 v18, 16, v13
    ds_read_b32 v18, v18 offset:8192

    s_waitcnt lgkmcnt(5)
    v_lshrrev_b32 v26, 16, v21
    ds_read_b32 v26, v26 offset:8192

    s_waitcnt lgkmcnt(3)
    v_lshrrev_b32 v34, 16, v29
    ds_read_b32 v34, v34 offset:8192

    v_cmp_ne_u32_sdwa s[80:81], v5, v7 src0_sel:WORD_1 src1_sel:WORD_1
    v_cmp_ne_u32_sdwa vcc, v5, v9 src0_sel:WORD_1 src1_sel:WORD_1
    v_alignbyte_b32 v8, v9, v8, 2
    s_mov_b32 s54, 40957
    v_alignbyte_b32 v5, v5, v4, 1
    v_perm_b32 v4, v4, v8, s47
    s_waitcnt lgkmcnt(3)
    v_add3_u32 v10, v10, v106, s54
    v_sub_u32 v11, 0, v10
    v_and_b32 v11, 3, v11
    s_mov_b64 exec, s[80:81]
    v_mov_b32 v11, 0
    v_mov_b32 v6, 0
    s_mov_b64 exec, vcc
    v_mov_b32 v11, 3

    s_mov_b64 exec, -1
    v_alignbyte_b32 v4, v5, v4, v11
    v_alignbyte_b32 v5, v6, v5, v11
    v_add_u32 v10, v10, v11

    buffer_store_dwordx2 v[4:5], v10, s[24:27], 0 offen
    v_cmp_ne_u32_sdwa s[80:81], v13, v15 src0_sel:WORD_1 src1_sel:WORD_1
    v_cmp_ne_u32_sdwa vcc, v13, v17 src0_sel:WORD_1 src1_sel:WORD_1
    v_alignbyte_b32 v16, v17, v16, 2
    s_mov_b32 s54, 46077
    v_alignbyte_b32 v13, v13, v12, 1
    v_perm_b32 v12, v12, v16, s47
    s_waitcnt lgkmcnt(2)
    v_add3_u32 v18, v18, v106, s54
    v_sub_u32 v19, 0, v18
    v_and_b32 v19, 3, v19
    s_mov_b64 exec, s[80:81]
    v_mov_b32 v19, 0
    v_mov_b32 v14, 0
    s_mov_b64 exec, vcc
    v_mov_b32 v19, 3

    s_mov_b64 exec, -1
    v_alignbyte_b32 v12, v13, v12, v19
    v_alignbyte_b32 v13, v14, v13, v19
    v_add_u32 v18, v18, v19

    buffer_store_dwordx2 v[12:13], v18, s[24:27], 0 offen
    v_cmp_ne_u32_sdwa s[80:81], v21, v23 src0_sel:WORD_1 src1_sel:WORD_1
    v_cmp_ne_u32_sdwa vcc, v21, v25 src0_sel:WORD_1 src1_sel:WORD_1
    v_alignbyte_b32 v24, v25, v24, 2
    s_mov_b32 s54, 51197
    v_alignbyte_b32 v21, v21, v20, 1
    v_perm_b32 v20, v20, v24, s47
    s_waitcnt lgkmcnt(1)
    v_add3_u32 v26, v26, v106, s54
    v_sub_u32 v27, 0, v26
    v_and_b32 v27, 3, v27
    s_mov_b64 exec, s[80:81]
    v_mov_b32 v27, 0
    v_mov_b32 v22, 0
    s_mov_b64 exec, vcc
    v_mov_b32 v27, 3

    s_mov_b64 exec, -1
    v_alignbyte_b32 v20, v21, v20, v27
    v_alignbyte_b32 v21, v22, v21, v27
    v_add_u32 v26, v26, v27

    buffer_store_dwordx2 v[20:21], v26, s[24:27], 0 offen
    v_cmp_ne_u32_sdwa s[80:81], v29, v31 src0_sel:WORD_1 src1_sel:WORD_1
    v_cmp_ne_u32_sdwa vcc, v29, v33 src0_sel:WORD_1 src1_sel:WORD_1
    v_alignbyte_b32 v32, v33, v32, 2
    s_mov_b32 s54, 56317
    v_alignbyte_b32 v29, v29, v28, 1
    v_perm_b32 v28, v28, v32, s47
    s_waitcnt lgkmcnt(0)
    v_add3_u32 v34, v34, v106, s54
    v_sub_u32 v35, 0, v34
    v_and_b32 v35, 3, v35
    s_mov_b64 exec, s[80:81]
    v_mov_b32 v35, 0
    v_mov_b32 v30, 0
    s_mov_b64 exec, vcc
    v_mov_b32 v35, 3

    s_mov_b64 exec, -1
    v_alignbyte_b32 v28, v29, v28, v35
    v_alignbyte_b32 v29, v30, v29, v35
    v_add_u32 v34, v34, v35

    buffer_store_dwordx2 v[28:29], v34, s[24:27], 0 offen
L_skw_48:
    s_bitcmp0_b32 s28, 3
    s_cbranch_scc1 L_skw_49
    v_add_u32 v107, 98304, v2
    ds_read_b64 v[4:5], v107 offset:16400
    ds_read_b64 v[6:7], v107 offset:16408
    ds_read_b64 v[8:9], v107 offset:16392

    ds_read_b64 v[12:13], v107 offset:24592
    ds_read_b64 v[14:15], v107 offset:24600
    ds_read_b64 v[16:17], v107 offset:24584

    ds_read_b64 v[20:21], v107 offset:32784
    ds_read_b64 v[22:23], v107 offset:32792
    ds_read_b64 v[24:25], v107 offset:32776

    ds_read_b64 v[28:29], v107 offset:40976
    ds_read_b64 v[30:31], v107 offset:40984
    ds_read_b64 v[32:33], v107 offset:40968

    s_waitcnt lgkmcnt(9)
    v_lshrrev_b32 v10, 16, v5
    ds_read_b32 v10, v10 offset:8192

    s_waitcnt lgkmcnt(7)
    v_lshrrev_b32 v18, 16, v13
    ds_read_b32 v18, v18 offset:8192

    s_waitcnt lgkmcnt(5)
    v_lshrrev_b32 v26, 16, v21
    ds_read_b32 v26, v26 offset:8192

    s_waitcnt lgkmcnt(3)
    v_lshrrev_b32 v34, 16, v29
    ds_read_b32 v34, v34 offset:8192

    v_cmp_ne_u32_sdwa s[80:81], v5, v7 src0_sel:WORD_1 src1_sel:WORD_1
    v_cmp_ne_u32_sdwa vcc, v5, v9 src0_sel:WORD_1 src1_sel:WORD_1
    v_alignbyte_b32 v8, v9, v8, 2
    s_mov_b32 s54, 61437
    v_alignbyte_b32 v5, v5, v4, 1
    v_perm_b32 v4, v4, v8, s47
    s_waitcnt lgkmcnt(3)
    v_add3_u32 v10, v10, v106, s54
    v_sub_u32 v11, 0, v10
    v_and_b32 v11, 3, v11
    s_mov_b64 exec, s[80:81]
    v_mov_b32 v11, 0
    v_mov_b32 v6, 0
    s_mov_b64 exec, vcc
    v_mov_b32 v11, 3

    s_mov_b64 exec, -1
    v_alignbyte_b32 v4, v5, v4, v11
    v_alignbyte_b32 v5, v6, v5, v11
    v_add_u32 v10, v10, v11

    buffer_store_dwordx2 v[4:5], v10, s[24:27], 0 offen
    v_cmp_ne_u32_sdwa s[80:81], v13, v15 src0_sel:WORD_1 src1_sel:WORD_1
    v_cmp_ne_u32_sdwa vcc, v13, v17 src0_sel:WORD_1 src1_sel:WORD_1
    v_alignbyte_b32 v16, v17, v16, 2
    s_mov_b32 s54, 66557
    v_alignbyte_b32 v13, v13, v12, 1
    v_perm_b32 v12, v12, v16, s47
    s_waitcnt lgkmcnt(2)
    v_add3_u32 v18, v18, v106, s54
    v_sub_u32 v19, 0, v18
    v_and_b32 v19, 3, v19
    s_mov_b64 exec, s[80:81]
    v_mov_b32 v19, 0
    v_mov_b32 v14, 0
    s_mov_b64 exec, vcc
    v_mov_b32 v19, 3

    s_mov_b64 exec, -1
    v_alignbyte_b32 v12, v13, v12, v19
    v_alignbyte_b32 v13, v14, v13, v19
    v_add_u32 v18, v18, v19

    buffer_store_dwordx2 v[12:13], v18, s[24:27], 0 offen
    v_cmp_ne_u32_sdwa s[80:81], v21, v23 src0_sel:WORD_1 src1_sel:WORD_1
    v_cmp_ne_u32_sdwa vcc, v21, v25 src0_sel:WORD_1 src1_sel:WORD_1
    v_alignbyte_b32 v24, v25, v24, 2
    s_mov_b32 s54, 71677
    v_alignbyte_b32 v21, v21, v20, 1
    v_perm_b32 v20, v20, v24, s47
    s_waitcnt lgkmcnt(1)
    v_add3_u32 v26, v26, v106, s54
    v_sub_u32 v27, 0, v26
    v_and_b32 v27, 3, v27
    s_mov_b64 exec, s[80:81]
    v_mov_b32 v27, 0
    v_mov_b32 v22, 0
    s_mov_b64 exec, vcc
    v_mov_b32 v27, 3

    s_mov_b64 exec, -1
    v_alignbyte_b32 v20, v21, v20, v27
    v_alignbyte_b32 v21, v22, v21, v27
    v_add_u32 v26, v26, v27

    buffer_store_dwordx2 v[20:21], v26, s[24:27], 0 offen
    v_cmp_ne_u32_sdwa s[80:81], v29, v31 src0_sel:WORD_1 src1_sel:WORD_1
    v_cmp_ne_u32_sdwa vcc, v29, v33 src0_sel:WORD_1 src1_sel:WORD_1
    v_alignbyte_b32 v32, v33, v32, 2
    s_mov_b32 s54, 76797
    v_alignbyte_b32 v29, v29, v28, 1
    v_perm_b32 v28, v28, v32, s47
    s_waitcnt lgkmcnt(0)
    v_add3_u32 v34, v34, v106, s54
    v_sub_u32 v35, 0, v34
    v_and_b32 v35, 3, v35
    s_mov_b64 exec, s[80:81]
    v_mov_b32 v35, 0
    v_mov_b32 v30, 0
    s_mov_b64 exec, vcc
    v_mov_b32 v35, 3

    s_andn2_b64 exec, -1, s[68:69]
    v_bfrev_b32 v34, 1
    s_mov_b64 exec, -1
    v_alignbyte_b32 v28, v29, v28, v35
    v_alignbyte_b32 v29, v30, v29, v35
    v_add_u32 v34, v34, v35

    buffer_store_dwordx2 v[28:29], v34, s[24:27], 0 offen
L_skw_49:
    s_mov_b32 s28, 15
    s_mov_b32 s29, 0
    s_movk_i32 s30, 16000

L_p1done_1:
    s_endpgm

L_slow_23:
    v_add_u32 v112, s29, v0
    v_mov_b32 v118, 0
    s_mov_b32 s75, 4960
L_sl_25:
    v_lshlrev_b32 v113, 3, v112
    ds_read_b64 v[110:111], v113 offset:16400
    ds_read_b32 v119, v113 offset:16412
    ds_read_b32 v120, v113 offset:16396
    s_waitcnt lgkmcnt(0)
    v_lshrrev_b32 v114, 16, v111
    ds_read_b32 v115, v114 offset:8192
    v_add_u32 v114, 4, v114
    v_mul_u32_u24 v114, s75, v114
    s_waitcnt lgkmcnt(0)
    v_mad_u32_u24 v115, v112, 5, v115
    v_cmp_gt_u32 s[72:73], s30, v112
    v_cmp_ge_u32 vcc, v115, v114
    s_and_b64 s[80:81], vcc, s[72:73]
    s_cbranch_scc0 L_s1_26
    s_bcnt1_i32_b64 s76, s[80:81]
    v_mbcnt_lo_u32_b32 v117, s80, 0
    v_mbcnt_hi_u32_b32 v117, s81, v117
    v_mov_b32 v116, s76
    s_mov_b64 exec, 1
    buffer_atomic_add v116, v118, s[36:39], 0 offen sc0
    s_waitcnt vmcnt(0)
    v_readfirstlane_b32 s76, v116
    s_mov_b64 exec, s[80:81]
    s_nop 0
    v_add_lshl_u32 v116, v117, s76, 3
    buffer_store_dwordx2 v[110:111], v116, s[32:35], 0 offen
L_s1_26:
    s_andn2_b64 exec, s[72:73], vcc
    s_cbranch_execz L_s2_27
    buffer_store_dword v110, v115, s[24:27], 0 offen
    buffer_store_byte v111, v115, s[24:27], 0 offen offset:4
    v_add_u32 v115, 5, v115
    v_cmpx_lt_u32 vcc, v115, v114
    v_cmpx_ne_u32_sdwa vcc, v111, v119 src0_sel:WORD_1 src1_sel:WORD_1
    v_cmpx_ne_u32_sdwa vcc, v111, v120 src0_sel:WORD_1 src1_sel:WORD_1
    s_cbranch_execz L_s2_27
    buffer_store_dword v118, v115, s[24:27], 0 offen
L_s2_27:
    s_mov_b64 exec, -1
    v_add_u32 v112, 1024, v112
    s_nop 0
    v_readfirstlane_b32 s76, v112
    s_nop 1
    s_cmp_lt_u32 s76, s30
    s_cbranch_scc1 L_sl_25
    s_mov_b32 s28, 0
    s_branch L_sback_24

L_slow_41:
    v_add_u32 v112, s29, v0
    v_mov_b32 v118, 0
    s_mov_b32 s75, 4960
L_sl_43:
    v_lshlrev_b32 v113, 3, v112
    ds_read_b64 v[110:111], v113 offset:16400
    ds_read_b32 v119, v113 offset:16412
    ds_read_b32 v120, v113 offset:16396
    s_waitcnt lgkmcnt(0)
    v_lshrrev_b32 v114, 16, v111
    ds_read_b32 v115, v114 offset:8192
    v_add_u32 v114, 4, v114
    v_mul_u32_u24 v114, s75, v114
    s_waitcnt lgkmcnt(0)
    v_mad_u32_u24 v115, v112, 5, v115
    v_cmp_gt_u32 s[72:73], s30, v112
    v_cmp_ge_u32 vcc, v115, v114
    s_and_b64 s[80:81], vcc, s[72:73]
    s_cbranch_scc0 L_s1_44
    s_bcnt1_i32_b64 s76, s[80:81]
    v_mbcnt_lo_u32_b32 v117, s80, 0
    v_mbcnt_hi_u32_b32 v117, s81, v117
    v_mov_b32 v116, s76
    s_mov_b64 exec, 1
    buffer_atomic_add v116, v118, s[36:39], 0 offen sc0
    s_waitcnt vmcnt(0)
    v_readfirstlane_b32 s76, v116
    s_mov_b64 exec, s[80:81]
    s_nop 0
    v_add_lshl_u32 v116, v117, s76, 3
    buffer_store_dwordx2 v[110:111], v116, s[32:35], 0 offen
L_s1_44:
    s_andn2_b64 exec, s[72:73], vcc
    s_cbranch_execz L_s2_45
    buffer_store_dword v110, v115, s[24:27], 0 offen
    buffer_store_byte v111, v115, s[24:27], 0 offen offset:4
    v_add_u32 v115, 5, v115
    v_cmpx_lt_u32 vcc, v115, v114
    v_cmpx_ne_u32_sdwa vcc, v111, v119 src0_sel:WORD_1 src1_sel:WORD_1
    v_cmpx_ne_u32_sdwa vcc, v111, v120 src0_sel:WORD_1 src1_sel:WORD_1
    s_cbranch_execz L_s2_45
    buffer_store_dword v118, v115, s[24:27], 0 offen
L_s2_45:
    s_mov_b64 exec, -1
    v_add_u32 v112, 1024, v112
    s_nop 0
    v_readfirstlane_b32 s76, v112
    s_nop 1
    s_cmp_lt_u32 s76, s30
    s_cbranch_scc1 L_sl_43
    s_mov_b32 s28, 0
    s_branch L_sback_42

.globl g2_kernel
.p2align 8
.type g2_kernel,@function
g2_kernel:
    s_cmp_ge_u32 s2, 256
    s_cbranch_scc1 L_p2done_50
    s_load_dwordx2 s[8:9], s[0:1], 0
    s_load_dwordx2 s[6:7], s[0:1], 104
    v_lshrrev_b32 v4, 6, v0
    s_lshr_b32 s37, s2, 1
    s_and_b32 s37, s37, 3
    s_lshr_b32 s36, s2, 3
    s_lshl_b32 s36, s36, 1
    s_and_b32 s3, s2, 1
    s_or_b32 s36, s36, s3
    v_readfirstlane_b32 s4, v4
    v_and_b32 v2, 63, v0
    v_lshrrev_b32 v3, 9, v0
    v_lshl_or_b32 v2, v3, 6, v2
    v_mul_u32_u24 v2, 20, v2
    v_lshlrev_b32 v3, 4, v0
    s_waitcnt lgkmcnt(0)
    s_lshl_b32 m0, s4, 10
    s_and_b32 s5, s4, 7
    s_lshr_b32 s39, s4, 3
    s_lshl_b32 s39, s39, 8
    s_mul_i32 s3, s5, 8192
    s_add_u32 s46, s6, s3
    s_addc_u32 s47, s7, 0
    s_mul_i32 s3, s5, 40632320
    s_add_u32 s3, s3, 83599360
    s_add_u32 s44, s6, s3
    s_addc_u32 s45, s7, 0
    s_mul_i32 s38, s37, 8
    s_add_u32 s4, s38, 8
    s_lshl_b32 s3, s38, 6
    s_add_u32 s3, s3, s36
    s_lshl_b32 s3, s3, 2
    s_add_u32 s52, s46, s3
    s_addc_u32 s53, s47, 0

    s_load_dword s88, s[52:53], 0
    s_load_dword s89, s[52:53], 256
    s_load_dword s90, s[52:53], 512
    s_load_dword s91, s[52:53], 768
    s_load_dword s92, s[52:53], 1024
    s_load_dword s93, s[52:53], 1280
    s_load_dword s94, s[52:53], 1536
    s_load_dword s95, s[52:53], 1792
    s_mov_b32 s3, 65536
    s_load_dword s51, s[6:7], s3
    s_mov_b32 s10, 6400000
    s_mov_b32 s11, 0x20000

    s_add_u32 s12, s6, 393216
    s_addc_u32 s13, s7, 0
    s_mov_b32 s14, 0
    s_mov_b32 s15, 0x20000
    s_add_u32 s60, s6, 393216
    s_addc_u32 s61, s7, 0
    s_mov_b32 s62, 6406144
    s_mov_b32 s63, 0x20000
    s_mov_b32 s3, 135176
    s_load_dword s33, s[6:7], s3

    s_mul_i32 s43, s38, 200192
    s_mul_i32 s41, s4, 200192
    s_mul_i32 s50, s38, 200000
    s_add_u32 s14, s43, 50000

    buffer_load_dwordx4 v[76:79], v3, s[12:15], s43 offen
    s_add_u32 s52, s43, 16384
    buffer_load_dwordx4 v[80:83], v3, s[12:15], s52 offen
    s_add_u32 s52, s43, 32768
    buffer_load_dwordx4 v[84:87], v3, s[12:15], s52 offen
    s_add_u32 s52, s43, 49152
    v_lshlrev_b32 v119, 2, v0
    buffer_load_dword v88, v119, s[12:15], s52 offen
    s_add_u32 s20, s6, 135168
    s_addc_u32 s21, s7, 0
    s_mov_b32 s22, 4096
    s_mov_b32 s23, 0x20000
    v_and_b32 v44, 63, v0
    v_lshlrev_b32 v44, 4, v44
    buffer_load_dwordx2 v[120:121], v44, s[20:23], 0 offen offset:0
    buffer_load_dwordx2 v[122:123], v44, s[20:23], 0 offen offset:1024
    buffer_load_dwordx2 v[124:125], v44, s[20:23], 0 offen offset:2048
    buffer_load_dwordx2 v[126:127], v44, s[20:23], 0 offen offset:3072
    s_lshr_b32 s3, s2, 3
    s_mul_i32 s3, s3, 49
    v_add_lshl_u32 v89, v0, s3, 7
    v_cmp_gt_u32 vcc, 49, v0
    v_bfrev_b32 v28, 1
    s_nop 0
    v_cndmask_b32 v89, v28, v89, vcc

    s_mov_b32 s19, 0x20000
    s_mov_b32 s28, 0x4b404000
    s_mov_b32 s29, 0x4b404000
    s_mov_b32 s30, 0xbfffc000
    s_mov_b32 s31, 0xbfffbfff
    s_mov_b32 s32, 0xffff0000
    s_mov_b32 s35, 0x05040100
    s_mov_b32 s97, 0x07060302
    s_mov_b32 s96, 0x40008000
    s_movk_i32 s3, 212
    v_cmp_gt_u32 s[48:49], s3, v0

    v_mov_b32 v1, 0
    s_mov_b32 s24, 0xc0c0004
    s_mov_b32 s25, 0xc0c0105
    s_mov_b32 s26, 0xc0c0206
    s_mov_b32 s27, 0xc0c0307
    s_waitcnt lgkmcnt(0)
    s_min_u32 s88, s88, 3968
    s_lshl_b32 s52, s38, 6
    s_add_u32 s52, s52, s36
    s_mul_i32 s52, s52, 19840
    s_add_u32 s16, s44, s52
    s_addc_u32 s17, s45, 0
    s_mul_i32 s52, s88, 5
    s_add_u32 s52, s52, 3
    s_and_b32 s18, s52, -4

    s_movk_i32 s53, 5120
    buffer_load_dwordx4 v[90:93], v2, s[16:19], s53 offen
    buffer_load_dword v110, v2, s[16:19], s53 offen offset:16
    s_movk_i32 s53, 7680
    buffer_load_dwordx4 v[94:97], v2, s[16:19], s53 offen
    buffer_load_dword v111, v2, s[16:19], s53 offen offset:16
    s_movk_i32 s53, 10240
    buffer_load_dwordx4 v[98:101], v2, s[16:19], s53 offen
    buffer_load_dword v112, v2, s[16:19], s53 offen offset:16
    s_movk_i32 s53, 12800
    buffer_load_dwordx4 v[102:105], v2, s[16:19], s53 offen
    buffer_load_dword v113, v2, s[16:19], s53 offen offset:16
    s_movk_i32 s53, 0
    buffer_load_dwordx4 v[4:7], v2, s[16:19], s53 offen
    buffer_load_dword v35, v2, s[16:19], s53 offen offset:16
    s_movk_i32 s53, 2560
    buffer_load_dwordx4 v[8:11], v2, s[16:19], s53 offen
    buffer_load_dword v43, v2, s[16:19], s53 offen offset:16
    s_movk_i32 s53, 15360
    buffer_load_dwordx4 v[106:109], v2, s[16:19], s53 offen
    buffer_load_dword v114, v2, s[16:19], s53 offen offset:16
    v_mov_b32 v28, 0x40004000
    v_mov_b32 v29, 0x40004000
    v_mov_b32 v30, 0x40004000
    v_mov_b32 v31, 0x40004000
    v_add_u32 v32, 50000, v3
    v_add_u32 v33, 65536, v32

    ds_write_b128 v32, v[28:31] offset:0
    ds_write_b128 v32, v[28:31] offset:16384
    ds_write_b128 v32, v[28:31] offset:32768
    ds_write_b128 v32, v[28:31] offset:49152
    ds_write_b128 v33, v[28:31] offset:0
    ds_write_b128 v33, v[28:31] offset:16384
    v_cmp_gt_u32 vcc, 971, v0
    s_mov_b64 exec, vcc
    ds_write_b128 v33, v[28:31] offset:32768
    s_mov_b64 exec, -1
    s_waitcnt vmcnt(21)
    ds_write_addtid_b32 v76 offset:0
    ds_write_addtid_b32 v77 offset:256
    ds_write_addtid_b32 v78 offset:512
    ds_write_addtid_b32 v79 offset:768
    s_waitcnt vmcnt(20)
    ds_write_addtid_b32 v80 offset:16384
    ds_write_addtid_b32 v81 offset:16640
    ds_write_addtid_b32 v82 offset:16896
    ds_write_addtid_b32 v83 offset:17152
    s_waitcnt vmcnt(19)
    ds_write_addtid_b32 v84 offset:32768
    ds_write_addtid_b32 v85 offset:33024
    ds_write_addtid_b32 v86 offset:33280
    ds_write_addtid_b32 v87 offset:33536
    v_lshlrev_b32 v119, 2, v0
    s_waitcnt vmcnt(18)
    s_mov_b64 exec, s[48:49]
    ds_write_b32 v119, v88 offset:49152
    s_mov_b64 exec, -1
    s_add_u32 s43, s43, 50048
    s_add_u32 s14, s43, 50000
    s_min_u32 s14, s14, s41
    buffer_load_dwordx4 v[76:79], v3, s[12:15], s43 offen
    s_add_u32 s52, s43, 16384
    buffer_load_dwordx4 v[80:83], v3, s[12:15], s52 offen
    s_add_u32 s52, s43, 32768
    buffer_load_dwordx4 v[84:87], v3, s[12:15], s52 offen
    s_add_u32 s52, s43, 49152
    v_lshlrev_b32 v119, 2, v0
    buffer_load_dword v88, v119, s[12:15], s52 offen
    s_add_u32 s54, s43, 50048
    buffer_load_dword v115, v89, s[60:63], s54 offen
    s_add_u32 s54, s50, 0
    buffer_load_dword v115, v89, s[8:11], s54 offen
    s_waitcnt vmcnt(20)
    v_max3_u32 v120, v120, v122, v124
    v_add_f32 v121, v121, v123
    v_add_f32 v125, v125, v127
    v_max_u32 v120, v120, v126
    v_add_f32 v121, v121, v125

    s_nop 1
    v_max_u32_dpp v120, v120, v120 row_shr:1 row_mask:0xf bank_mask:0xf
    s_nop 1
    v_max_u32_dpp v120, v120, v120 row_shr:2 row_mask:0xf bank_mask:0xf
    s_nop 1
    v_max_u32_dpp v120, v120, v120 row_shr:4 row_mask:0xf bank_mask:0xf
    s_nop 1
    v_max_u32_dpp v120, v120, v120 row_shr:8 row_mask:0xf bank_mask:0xf
    s_nop 1
    v_max_u32_dpp v120, v120, v120 row_bcast:15 row_mask:0xa bank_mask:0xf
    s_nop 1
    v_max_u32_dpp v120, v120, v120 row_bcast:31 row_mask:0xc bank_mask:0xf
    s_nop 1
    v_add_f32_dpp v121, v121, v121 row_shr:1 row_mask:0xf bank_mask:0xf
    s_nop 1
    v_add_f32_dpp v121, v121, v121 row_shr:2 row_mask:0xf bank_mask:0xf
    s_nop 1
    v_add_f32_dpp v121, v121, v121 row_shr:4 row_mask:0xf bank_mask:0xf
    s_nop 1
    v_add_f32_dpp v121, v121, v121 row_shr:8 row_mask:0xf bank_mask:0xf
    s_nop 1
    v_add_f32_dpp v121, v121, v121 row_bcast:15 row_mask:0xa bank_mask:0xf
    s_nop 1
    v_add_f32_dpp v121, v121, v121 row_bcast:31 row_mask:0xc bank_mask:0xf
    v_lshlrev_b32 v120, 16, v120
    v_mul_f32 v121, 0x34a7c5ac, v121
    v_sqrt_f32 v121, v121
    v_mul_f32 v120, s33, v120
    v_mul_f32 v121, s33, v121
    v_cmp_gt_f32 vcc, 0x46fde800, v120
    s_mov_b64 s[64:65], vcc
    v_cmp_lt_f32 vcc, 0x44000000, v121
    v_mov_b32 v120, 0x37800000
    v_mul_f32 v120, s33, v120
    s_and_b64 vcc, vcc, s[64:65]
    v_mul_f32 v121, 0x46ff8000, v120
    v_rcp_f32 v121, v121
    v_readfirstlane_b32 s33, v120
    s_waitcnt lgkmcnt(0)
    s_barrier
    v_readfirstlane_b32 s34, v121
    v_mov_b32 v120, 150016
    v_mov_b32 v121, 0
    ds_write_b32 v120, v121 offset:8
    s_bitcmp0_b64 vcc, 63
    s_cbranch_scc1 L_p2slow_51
    s_cmp_lg_u32 s51, 0
    s_cbranch_scc1 L_p2slow_51

    s_mov_b32 s40, s88
    s_sub_u32 s42, s40, s39

    s_add_u32 s55, s38, 1
    s_min_u32 s55, s55, 31
    s_mov_b32 s88, s89
    s_mov_b32 s89, s90
    s_mov_b32 s90, s91
    s_mov_b32 s91, s92
    s_mov_b32 s92, s93
    s_mov_b32 s93, s94
    s_mov_b32 s94, s95
    s_mov_b32 s95, 0
    s_min_u32 s88, s88, 3968
    s_lshl_b32 s52, s55, 6
    s_add_u32 s52, s52, s36
    s_mul_i32 s52, s52, 19840
    s_add_u32 s16, s44, s52
    s_addc_u32 s17, s45, 0
    s_mul_i32 s52, s88, 5
    s_add_u32 s52, s52, 3
    s_and_b32 s18, s52, -4

    s_waitcnt vmcnt(18)
    v_perm_b32 v44, v91, v90, s24
    v_perm_b32 v46, v92, v91, s25
    v_perm_b32 v48, v93, v92, s26
    v_perm_b32 v50, v110, v93, s27
    v_mov_b32 v12, v90
    v_alignbyte_b32 v13, v92, v91, 1
    v_alignbyte_b32 v14, v93, v92, 2
    v_alignbyte_b32 v15, v110, v93, 3
    v_lshlrev_b32_sdwa v44, 3, v44 dst_sel:WORD_0 dst_unused:UNUSED_PAD src0_sel:DWORD src1_sel:DWORD
    v_lshlrev_b32_sdwa v46, 3, v46 dst_sel:WORD_0 dst_unused:UNUSED_PAD src0_sel:DWORD src1_sel:DWORD
    v_lshlrev_b32_sdwa v48, 3, v48 dst_sel:WORD_0 dst_unused:UNUSED_PAD src0_sel:DWORD src1_sel:DWORD
    v_lshlrev_b32_sdwa v50, 3, v50 dst_sel:WORD_0 dst_unused:UNUSED_PAD src0_sel:DWORD src1_sel:DWORD
    s_cmp_lt_i32 s42, 1280
    s_cbranch_scc1 L_ufix_52
L_uback_53:

    v_subrev_co_u32 v12, s[80:81], 2.0, v12
    v_subrev_co_u32 v13, s[82:83], 2.0, v13
    v_subrev_co_u32 v14, s[84:85], 2.0, v14
    v_subrev_co_u32 v15, s[86:87], 2.0, v15
    s_mov_b64 exec, s[80:81]
    ds_read_b64 v[44:45], v44
    s_mov_b64 exec, s[82:83]
    ds_read_b64 v[46:47], v46
    s_mov_b64 exec, s[84:85]
    ds_read_b64 v[48:49], v48
    s_mov_b64 exec, s[86:87]
    ds_read_b64 v[50:51], v50
    s_mov_b64 exec, -1
    s_waitcnt vmcnt(16)
    v_perm_b32 v52, v95, v94, s24
    v_perm_b32 v54, v96, v95, s25
    v_perm_b32 v56, v97, v96, s26
    v_perm_b32 v58, v111, v97, s27
    v_mov_b32 v16, v94
    v_alignbyte_b32 v17, v96, v95, 1
    v_alignbyte_b32 v18, v97, v96, 2
    v_alignbyte_b32 v19, v111, v97, 3
    v_lshlrev_b32_sdwa v52, 3, v52 dst_sel:WORD_0 dst_unused:UNUSED_PAD src0_sel:DWORD src1_sel:DWORD
    v_lshlrev_b32_sdwa v54, 3, v54 dst_sel:WORD_0 dst_unused:UNUSED_PAD src0_sel:DWORD src1_sel:DWORD
    v_lshlrev_b32_sdwa v56, 3, v56 dst_sel:WORD_0 dst_unused:UNUSED_PAD src0_sel:DWORD src1_sel:DWORD
    v_lshlrev_b32_sdwa v58, 3, v58 dst_sel:WORD_0 dst_unused:UNUSED_PAD src0_sel:DWORD src1_sel:DWORD
    s_cmp_lt_i32 s42, 1792
    s_cbranch_scc1 L_ufix_54
L_uback_55:

    v_subrev_co_u32 v16, s[64:65], 2.0, v16
    v_subrev_co_u32 v17, s[66:67], 2.0, v17
    v_subrev_co_u32 v18, s[68:69], 2.0, v18
    v_subrev_co_u32 v19, s[70:71], 2.0, v19
    s_mov_b64 exec, s[64:65]
    ds_read_b64 v[52:53], v52
    s_mov_b64 exec, s[66:67]
    ds_read_b64 v[54:55], v54
    s_mov_b64 exec, s[68:69]
    ds_read_b64 v[56:57], v56
    s_mov_b64 exec, s[70:71]
    ds_read_b64 v[58:59], v58
    s_mov_b64 exec, -1
    s_waitcnt vmcnt(14)
    v_perm_b32 v60, v99, v98, s24
    v_perm_b32 v62, v100, v99, s25
    v_perm_b32 v64, v101, v100, s26
    v_perm_b32 v66, v112, v101, s27
    v_mov_b32 v20, v98
    v_alignbyte_b32 v21, v100, v99, 1
    v_alignbyte_b32 v22, v101, v100, 2
    v_alignbyte_b32 v23, v112, v101, 3
    v_lshlrev_b32_sdwa v60, 3, v60 dst_sel:WORD_0 dst_unused:UNUSED_PAD src0_sel:DWORD src1_sel:DWORD
    v_lshlrev_b32_sdwa v62, 3, v62 dst_sel:WORD_0 dst_unused:UNUSED_PAD src0_sel:DWORD src1_sel:DWORD
    v_lshlrev_b32_sdwa v64, 3, v64 dst_sel:WORD_0 dst_unused:UNUSED_PAD src0_sel:DWORD src1_sel:DWORD
    v_lshlrev_b32_sdwa v66, 3, v66 dst_sel:WORD_0 dst_unused:UNUSED_PAD src0_sel:DWORD src1_sel:DWORD
    s_cmp_lt_i32 s42, 2304
    s_cbranch_scc1 L_ufix_56
L_uback_57:

    v_subrev_co_u32 v20, s[72:73], 2.0, v20
    v_subrev_co_u32 v21, s[74:75], 2.0, v21
    v_subrev_co_u32 v22, s[76:77], 2.0, v22
    v_subrev_co_u32 v23, s[78:79], 2.0, v23
    s_mov_b64 exec, s[72:73]
    ds_read_b64 v[60:61], v60
    s_mov_b64 exec, s[74:75]
    ds_read_b64 v[62:63], v62
    s_mov_b64 exec, s[76:77]
    ds_read_b64 v[64:65], v64
    s_mov_b64 exec, s[78:79]
    ds_read_b64 v[66:67], v66
    s_mov_b64 exec, -1
    s_waitcnt vmcnt(12)
    v_perm_b32 v68, v103, v102, s24
    v_perm_b32 v70, v104, v103, s25
    v_perm_b32 v72, v105, v104, s26
    v_perm_b32 v74, v113, v105, s27
    v_mov_b32 v24, v102
    v_alignbyte_b32 v25, v104, v103, 1
    v_alignbyte_b32 v26, v105, v104, 2
    v_alignbyte_b32 v27, v113, v105, 3
    v_lshlrev_b32_sdwa v68, 3, v68 dst_sel:WORD_0 dst_unused:UNUSED_PAD src0_sel:DWORD src1_sel:DWORD
    v_lshlrev_b32_sdwa v70, 3, v70 dst_sel:WORD_0 dst_unused:UNUSED_PAD src0_sel:DWORD src1_sel:DWORD
    v_lshlrev_b32_sdwa v72, 3, v72 dst_sel:WORD_0 dst_unused:UNUSED_PAD src0_sel:DWORD src1_sel:DWORD
    v_lshlrev_b32_sdwa v74, 3, v74 dst_sel:WORD_0 dst_unused:UNUSED_PAD src0_sel:DWORD src1_sel:DWORD
    s_cmp_lt_i32 s42, 2816
    s_cbranch_scc1 L_ufix_58
L_uback_59:

    v_subrev_co_u32 v24, s[80:81], 2.0, v24
    v_subrev_co_u32 v25, s[82:83], 2.0, v25
    v_subrev_co_u32 v26, s[84:85], 2.0, v26
    v_subrev_co_u32 v27, s[86:87], 2.0, v27
    s_mov_b64 exec, s[80:81]
    ds_read_b64 v[68:69], v68
    s_mov_b64 exec, s[82:83]
    ds_read_b64 v[70:71], v70
    s_mov_b64 exec, s[84:85]
    ds_read_b64 v[72:73], v72
    s_mov_b64 exec, s[86:87]
    ds_read_b64 v[74:75], v74
    s_mov_b64 exec, -1
    s_waitcnt vmcnt(10)
    v_perm_b32 v28, v5, v4, s24
    v_perm_b32 v30, v6, v5, s25
    v_perm_b32 v32, v7, v6, s26
    v_perm_b32 v34, v35, v7, s27
    v_alignbyte_b32 v5, v6, v5, 1
    v_alignbyte_b32 v6, v7, v6, 2
    v_alignbyte_b32 v7, v35, v7, 3
    v_lshlrev_b32_sdwa v28, 3, v28 dst_sel:WORD_0 dst_unused:UNUSED_PAD src0_sel:DWORD src1_sel:DWORD
    v_lshlrev_b32_sdwa v30, 3, v30 dst_sel:WORD_0 dst_unused:UNUSED_PAD src0_sel:DWORD src1_sel:DWORD
    v_lshlrev_b32_sdwa v32, 3, v32 dst_sel:WORD_0 dst_unused:UNUSED_PAD src0_sel:DWORD src1_sel:DWORD
    v_lshlrev_b32_sdwa v34, 3, v34 dst_sel:WORD_0 dst_unused:UNUSED_PAD src0_sel:DWORD src1_sel:DWORD
    s_cmp_lt_i32 s42, 256
    s_cbranch_scc1 L_ufix_60
L_uback_61:

    v_subrev_co_u32 v4, s[64:65], 2.0, v4
    v_subrev_co_u32 v5, s[66:67], 2.0, v5
    v_subrev_co_u32 v6, s[68:69], 2.0, v6
    v_subrev_co_u32 v7, s[70:71], 2.0, v7
    s_mov_b64 exec, s[64:65]
    ds_read_b64 v[28:29], v28
    s_mov_b64 exec, s[66:67]
    ds_read_b64 v[30:31], v30
    s_mov_b64 exec, s[68:69]
    ds_read_b64 v[32:33], v32
    s_mov_b64 exec, s[70:71]
    ds_read_b64 v[34:35], v34
    s_mov_b64 exec, -1
    s_waitcnt vmcnt(8)
    v_perm_b32 v36, v9, v8, s24
    v_perm_b32 v38, v10, v9, s25
    v_perm_b32 v40, v11, v10, s26
    v_perm_b32 v42, v43, v11, s27
    v_alignbyte_b32 v9, v10, v9, 1
    v_alignbyte_b32 v10, v11, v10, 2
    v_alignbyte_b32 v11, v43, v11, 3
    v_lshlrev_b32_sdwa v36, 3, v36 dst_sel:WORD_0 dst_unused:UNUSED_PAD src0_sel:DWORD src1_sel:DWORD
    v_lshlrev_b32_sdwa v38, 3, v38 dst_sel:WORD_0 dst_unused:UNUSED_PAD src0_sel:DWORD src1_sel:DWORD
    v_lshlrev_b32_sdwa v40, 3, v40 dst_sel:WORD_0 dst_unused:UNUSED_PAD src0_sel:DWORD src1_sel:DWORD
    v_lshlrev_b32_sdwa v42, 3, v42 dst_sel:WORD_0 dst_unused:UNUSED_PAD src0_sel:DWORD src1_sel:DWORD
    s_cmp_lt_i32 s42, 768
    s_cbranch_scc1 L_ufix_62
L_uback_63:

    v_subrev_co_u32 v8, s[72:73], 2.0, v8
    v_subrev_co_u32 v9, s[74:75], 2.0, v9
    v_subrev_co_u32 v10, s[76:77], 2.0, v10
    v_subrev_co_u32 v11, s[78:79], 2.0, v11
    s_mov_b64 exec, s[72:73]
    ds_read_b64 v[36:37], v36
    s_mov_b64 exec, s[74:75]
    ds_read_b64 v[38:39], v38
    s_mov_b64 exec, s[76:77]
    ds_read_b64 v[40:41], v40
    s_mov_b64 exec, s[78:79]
    ds_read_b64 v[42:43], v42
    s_mov_b64 exec, -1
L_batch_64:
    s_add_u32 s5, s38, 1

    s_movk_i32 s53, 5120
    buffer_load_dwordx4 v[90:93], v2, s[16:19], s53 offen
    buffer_load_dword v110, v2, s[16:19], s53 offen offset:16
    s_waitcnt lgkmcnt(0)
    s_barrier
    s_waitcnt vmcnt(7)
    ds_write_addtid_b32 v76 offset:0
    ds_write_addtid_b32 v77 offset:256
    ds_write_addtid_b32 v78 offset:512
    ds_write_addtid_b32 v79 offset:768
    s_waitcnt vmcnt(6)
    ds_write_addtid_b32 v80 offset:16384
    ds_write_addtid_b32 v81 offset:16640
    ds_write_addtid_b32 v82 offset:16896
    ds_write_addtid_b32 v83 offset:17152
    s_waitcnt vmcnt(5)
    ds_write_addtid_b32 v84 offset:32768
    ds_write_addtid_b32 v85 offset:33024
    ds_write_addtid_b32 v86 offset:33280
    ds_write_addtid_b32 v87 offset:33536
    v_lshlrev_b32 v119, 2, v0
    s_waitcnt vmcnt(4)
    s_mov_b64 exec, s[48:49]
    ds_write_b32 v119, v88 offset:49152
    s_mov_b64 exec, -1
    s_add_u32 s43, s43, 50048
    s_add_u32 s14, s43, 50000
    s_min_u32 s14, s14, s41
    buffer_load_dwordx4 v[76:79], v3, s[12:15], s43 offen
    s_add_u32 s52, s43, 16384
    buffer_load_dwordx4 v[80:83], v3, s[12:15], s52 offen
    v_subrev_co_u32 v4, s[64:65], 2.0, v4
    v_subrev_co_u32 v5, s[66:67], 2.0, v5
    v_subrev_co_u32 v6, s[68:69], 2.0, v6
    v_subrev_co_u32 v7, s[70:71], 2.0, v7
    v_subrev_co_u32 v8, s[72:73], 2.0, v8
    v_subrev_co_u32 v9, s[74:75], 2.0, v9
    v_subrev_co_u32 v10, s[76:77], 2.0, v10
    v_subrev_co_u32 v11, s[78:79], 2.0, v11
    v_subrev_co_u32 v12, s[80:81], 2.0, v12
    v_subrev_co_u32 v13, s[82:83], 2.0, v13
    v_subrev_co_u32 v14, s[84:85], 2.0, v14
    v_subrev_co_u32 v15, s[86:87], 2.0, v15
    s_waitcnt lgkmcnt(0)
    s_barrier
    s_add_u32 s52, s43, 32768
    buffer_load_dwordx4 v[84:87], v3, s[12:15], s52 offen
    s_add_u32 s52, s43, 49152
    v_lshlrev_b32 v119, 2, v0
    buffer_load_dword v88, v119, s[12:15], s52 offen
    s_mov_b64 exec, s[64:65]
    ds_read_b64 v[28:29], v28
    s_mov_b64 exec, s[66:67]
    ds_read_b64 v[30:31], v30
    s_mov_b64 exec, s[68:69]
    ds_read_b64 v[32:33], v32
    s_mov_b64 exec, s[70:71]
    ds_read_b64 v[34:35], v34
    s_mov_b64 exec, s[72:73]
    ds_read_b64 v[36:37], v36
    s_mov_b64 exec, s[74:75]
    ds_read_b64 v[38:39], v38
    s_mov_b64 exec, s[76:77]
    ds_read_b64 v[40:41], v40
    s_mov_b64 exec, s[78:79]
    ds_read_b64 v[42:43], v42
    s_mov_b64 exec, s[80:81]
    ds_read_b64 v[44:45], v44
    s_mov_b64 exec, s[82:83]
    ds_read_b64 v[46:47], v46
    s_mov_b64 exec, s[84:85]
    ds_read_b64 v[48:49], v48
    s_mov_b64 exec, s[86:87]
    ds_read_b64 v[50:51], v50
    s_mov_b64 exec, -1
    v_subrev_co_u32 v16, s[64:65], 2.0, v16
    v_subrev_co_u32 v17, s[66:67], 2.0, v17
    v_subrev_co_u32 v18, s[68:69], 2.0, v18
    v_subrev_co_u32 v19, s[70:71], 2.0, v19
    v_subrev_co_u32 v20, s[72:73], 2.0, v20
    v_subrev_co_u32 v21, s[74:75], 2.0, v21
    v_subrev_co_u32 v22, s[76:77], 2.0, v22
    v_subrev_co_u32 v23, s[78:79], 2.0, v23
    v_subrev_co_u32 v24, s[80:81], 2.0, v24
    v_subrev_co_u32 v25, s[82:83], 2.0, v25
    v_subrev_co_u32 v26, s[84:85], 2.0, v26
    v_subrev_co_u32 v27, s[86:87], 2.0, v27
    s_mov_b64 exec, s[64:65]
    ds_read_b64 v[52:53], v52
    s_mov_b64 exec, s[66:67]
    ds_read_b64 v[54:55], v54
    s_mov_b64 exec, s[68:69]
    ds_read_b64 v[56:57], v56
    s_mov_b64 exec, s[70:71]
    ds_read_b64 v[58:59], v58
    s_mov_b64 exec, s[72:73]
    ds_read_b64 v[60:61], v60
    s_mov_b64 exec, s[74:75]
    ds_read_b64 v[62:63], v62
    s_mov_b64 exec, s[76:77]
    ds_read_b64 v[64:65], v64
    s_mov_b64 exec, s[78:79]
    ds_read_b64 v[66:67], v66
    s_mov_b64 exec, s[80:81]
    ds_read_b64 v[68:69], v68
    s_mov_b64 exec, s[82:83]
    ds_read_b64 v[70:71], v70
    s_mov_b64 exec, s[84:85]
    ds_read_b64 v[72:73], v72
    s_mov_b64 exec, s[86:87]
    ds_read_b64 v[74:75], v74
    s_mov_b64 exec, -1
    s_cmp_le_i32 s42, 3072
    s_cbranch_scc1 L_nt1_66
    s_waitcnt vmcnt(12)
    v_perm_b32 v120, v107, v106, s24
    v_perm_b32 v122, v108, v107, s25
    v_perm_b32 v124, v109, v108, s26
    v_perm_b32 v126, v114, v109, s27
    v_alignbyte_b32 v107, v108, v107, 1
    v_alignbyte_b32 v108, v109, v108, 2
    v_alignbyte_b32 v109, v114, v109, 3
    v_lshlrev_b32_sdwa v120, 3, v120 dst_sel:WORD_0 dst_unused:UNUSED_PAD src0_sel:DWORD src1_sel:DWORD
    v_lshlrev_b32_sdwa v122, 3, v122 dst_sel:WORD_0 dst_unused:UNUSED_PAD src0_sel:DWORD src1_sel:DWORD
    v_lshlrev_b32_sdwa v124, 3, v124 dst_sel:WORD_0 dst_unused:UNUSED_PAD src0_sel:DWORD src1_sel:DWORD
    v_lshlrev_b32_sdwa v126, 3, v126 dst_sel:WORD_0 dst_unused:UNUSED_PAD src0_sel:DWORD src1_sel:DWORD
    s_cmp_lt_i32 s42, 3328
    s_cbranch_scc1 L_ufix_69
L_uback_70:

    v_lshrrev_b32 v117, 30, v106
    v_and_b32 v106, 0x3fffffff, v106
    v_mul_u32_u24 v117, 50000, v117
    v_cmp_ne_u32 vcc, 0, v106
    v_add_u32 v120, v120, v117
    s_mov_b64 exec, vcc

    buffer_load_dwordx2 v[120:121], v120, s[8:11], s50 offen
    s_mov_b64 exec, -1
    v_lshrrev_b32 v117, 30, v107
    v_and_b32 v107, 0x3fffffff, v107
    v_mul_u32_u24 v117, 50000, v117
    v_cmp_ne_u32 vcc, 0, v107
    v_add_u32 v122, v122, v117
    s_mov_b64 exec, vcc

    buffer_load_dwordx2 v[122:123], v122, s[8:11], s50 offen
    s_mov_b64 exec, -1
    v_lshrrev_b32 v117, 30, v108
    v_and_b32 v108, 0x3fffffff, v108
    v_mul_u32_u24 v117, 50000, v117
    v_cmp_ne_u32 vcc, 0, v108
    v_add_u32 v124, v124, v117
    s_mov_b64 exec, vcc

    buffer_load_dwordx2 v[124:125], v124, s[8:11], s50 offen
    s_mov_b64 exec, -1
    v_lshrrev_b32 v117, 30, v109
    v_and_b32 v109, 0x3fffffff, v109
    v_mul_u32_u24 v117, 50000, v117
    v_cmp_ne_u32 vcc, 0, v109
    v_add_u32 v126, v126, v117
    s_mov_b64 exec, vcc

    buffer_load_dwordx2 v[126:127], v126, s[8:11], s50 offen
    s_mov_b64 exec, -1
L_nt1_66:
    s_movk_i32 s53, 7680
    buffer_load_dwordx4 v[94:97], v2, s[16:19], s53 offen
    buffer_load_dword v111, v2, s[16:19], s53 offen offset:16
    s_waitcnt lgkmcnt(0)
    s_barrier
    s_waitcnt vmcnt(5)
    ds_write_addtid_b32 v76 offset:0
    ds_write_addtid_b32 v77 offset:256
    ds_write_addtid_b32 v78 offset:512
    ds_write_addtid_b32 v79 offset:768
    s_waitcnt vmcnt(4)
    ds_write_addtid_b32 v80 offset:16384
    ds_write_addtid_b32 v81 offset:16640
    ds_write_addtid_b32 v82 offset:16896
    ds_write_addtid_b32 v83 offset:17152
    s_waitcnt vmcnt(3)
    ds_write_addtid_b32 v84 offset:32768
    ds_write_addtid_b32 v85 offset:33024
    ds_write_addtid_b32 v86 offset:33280
    ds_write_addtid_b32 v87 offset:33536
    v_lshlrev_b32 v119, 2, v0
    s_waitcnt vmcnt(2)
    s_mov_b64 exec, s[48:49]
    ds_write_b32 v119, v88 offset:49152
    s_mov_b64 exec, -1
    s_add_u32 s43, s43, 50048
    s_add_u32 s14, s43, 50000
    s_min_u32 s14, s14, s41
    buffer_load_dwordx4 v[76:79], v3, s[12:15], s43 offen
    s_add_u32 s52, s43, 16384
    buffer_load_dwordx4 v[80:83], v3, s[12:15], s52 offen
    v_subrev_co_u32 v4, s[64:65], 2.0, v4
    v_subrev_co_u32 v5, s[66:67], 2.0, v5
    v_subrev_co_u32 v6, s[68:69], 2.0, v6
    v_subrev_co_u32 v7, s[70:71], 2.0, v7
    v_subrev_co_u32 v8, s[72:73], 2.0, v8
    v_subrev_co_u32 v9, s[74:75], 2.0, v9
    v_subrev_co_u32 v10, s[76:77], 2.0, v10
    v_subrev_co_u32 v11, s[78:79], 2.0, v11
    v_subrev_co_u32 v12, s[80:81], 2.0, v12
    v_subrev_co_u32 v13, s[82:83], 2.0, v13
    v_subrev_co_u32 v14, s[84:85], 2.0, v14
    v_subrev_co_u32 v15, s[86:87], 2.0, v15
    s_waitcnt lgkmcnt(0)
    s_barrier
    s_add_u32 s52, s43, 32768
    buffer_load_dwordx4 v[84:87], v3, s[12:15], s52 offen
    s_add_u32 s52, s43, 49152
    v_lshlrev_b32 v119, 2, v0
    buffer_load_dword v88, v119, s[12:15], s52 offen
    s_mov_b64 exec, s[64:65]
    ds_read_b64 v[28:29], v28
    s_mov_b64 exec, s[66:67]
    ds_read_b64 v[30:31], v30
    s_mov_b64 exec, s[68:69]
    ds_read_b64 v[32:33], v32
    s_mov_b64 exec, s[70:71]
    ds_read_b64 v[34:35], v34
    s_mov_b64 exec, s[72:73]
    ds_read_b64 v[36:37], v36
    s_mov_b64 exec, s[74:75]
    ds_read_b64 v[38:39], v38
    s_mov_b64 exec, s[76:77]
    ds_read_b64 v[40:41], v40
    s_mov_b64 exec, s[78:79]
    ds_read_b64 v[42:43], v42
    s_mov_b64 exec, s[80:81]
    ds_read_b64 v[44:45], v44
    s_mov_b64 exec, s[82:83]
    ds_read_b64 v[46:47], v46
    s_mov_b64 exec, s[84:85]
    ds_read_b64 v[48:49], v48
    s_mov_b64 exec, s[86:87]
    ds_read_b64 v[50:51], v50
    s_mov_b64 exec, -1
    v_subrev_co_u32 v16, s[64:65], 2.0, v16
    v_subrev_co_u32 v17, s[66:67], 2.0, v17
    v_subrev_co_u32 v18, s[68:69], 2.0, v18
    v_subrev_co_u32 v19, s[70:71], 2.0, v19
    v_subrev_co_u32 v20, s[72:73], 2.0, v20
    v_subrev_co_u32 v21, s[74:75], 2.0, v21
    v_subrev_co_u32 v22, s[76:77], 2.0, v22
    v_subrev_co_u32 v23, s[78:79], 2.0, v23
    v_subrev_co_u32 v24, s[80:81], 2.0, v24
    v_subrev_co_u32 v25, s[82:83], 2.0, v25
    v_subrev_co_u32 v26, s[84:85], 2.0, v26
    v_subrev_co_u32 v27, s[86:87], 2.0, v27
    s_mov_b64 exec, s[64:65]
    ds_read_b64 v[52:53], v52
    s_mov_b64 exec, s[66:67]
    ds_read_b64 v[54:55], v54
    s_mov_b64 exec, s[68:69]
    ds_read_b64 v[56:57], v56
    s_mov_b64 exec, s[70:71]
    ds_read_b64 v[58:59], v58
    s_mov_b64 exec, s[72:73]
    ds_read_b64 v[60:61], v60
    s_mov_b64 exec, s[74:75]
    ds_read_b64 v[62:63], v62
    s_mov_b64 exec, s[76:77]
    ds_read_b64 v[64:65], v64
    s_mov_b64 exec, s[78:79]
    ds_read_b64 v[66:67], v66
    s_mov_b64 exec, s[80:81]
    ds_read_b64 v[68:69], v68
    s_mov_b64 exec, s[82:83]
    ds_read_b64 v[70:71], v70
    s_mov_b64 exec, s[84:85]
    ds_read_b64 v[72:73], v72
    s_mov_b64 exec, s[86:87]
    ds_read_b64 v[74:75], v74
    s_mov_b64 exec, -1
    s_movk_i32 s53, 10240
    buffer_load_dwordx4 v[98:101], v2, s[16:19], s53 offen
    buffer_load_dword v112, v2, s[16:19], s53 offen offset:16
    s_cmp_le_i32 s42, 3072
    s_cbranch_scc1 L_nt2_67
    s_waitcnt vmcnt(8)
    v_cmp_ne_u32 s[64:65], 0, v106
    v_cmp_ne_u32 s[66:67], 0, v107
    v_cmp_ne_u32 s[68:69], 0, v108
    v_cmp_ne_u32 s[70:71], 0, v109
    s_mov_b64 exec, s[64:65]
    v_cvt_f32_i32_sdwa v118, sext(v106) dst_sel:DWORD dst_unused:UNUSED_PAD src0_sel:WORD_0
    v_lshlrev_b32 v116, 16, v120
    v_and_b32 v117, s32, v120
    v_mul_f32 v118, s33, v118
    v_lshlrev_b32 v120, 16, v121
    v_and_b32 v121, s32, v121
    v_lshlrev_b32_sdwa v106, 3, v106 dst_sel:DWORD dst_unused:UNUSED_PAD src0_sel:DWORD src1_sel:WORD_1
    v_pk_fma_f32 v[116:117], v[116:117], v[118:119], s[28:29] op_sel_hi:[1,0,1]
    v_pk_fma_f32 v[120:121], v[120:121], v[118:119], s[28:29] op_sel_hi:[1,0,1]
    v_perm_b32 v116, v117, v116, s35
    v_perm_b32 v117, v121, v120, s35
    v_lshl_add_u64 v[116:117], v[116:117], 0, s[30:31]
    ds_add_rtn_u64 v[120:121], v106, v[116:117] offset:50000

    s_mov_b64 exec, s[66:67]
    v_cvt_f32_i32_sdwa v118, sext(v107) dst_sel:DWORD dst_unused:UNUSED_PAD src0_sel:WORD_0
    v_lshlrev_b32 v116, 16, v122
    v_and_b32 v117, s32, v122
    v_mul_f32 v118, s33, v118
    v_lshlrev_b32 v122, 16, v123
    v_and_b32 v123, s32, v123
    v_lshlrev_b32_sdwa v107, 3, v107 dst_sel:DWORD dst_unused:UNUSED_PAD src0_sel:DWORD src1_sel:WORD_1
    v_pk_fma_f32 v[116:117], v[116:117], v[118:119], s[28:29] op_sel_hi:[1,0,1]
    v_pk_fma_f32 v[122:123], v[122:123], v[118:119], s[28:29] op_sel_hi:[1,0,1]
    v_perm_b32 v116, v117, v116, s35
    v_perm_b32 v117, v123, v122, s35
    v_lshl_add_u64 v[116:117], v[116:117], 0, s[30:31]
    ds_add_rtn_u64 v[122:123], v107, v[116:117] offset:50000

    s_mov_b64 exec, s[68:69]
    v_cvt_f32_i32_sdwa v118, sext(v108) dst_sel:DWORD dst_unused:UNUSED_PAD src0_sel:WORD_0
    v_lshlrev_b32 v116, 16, v124
    v_and_b32 v117, s32, v124
    v_mul_f32 v118, s33, v118
    v_lshlrev_b32 v124, 16, v125
    v_and_b32 v125, s32, v125
    v_lshlrev_b32_sdwa v108, 3, v108 dst_sel:DWORD dst_unused:UNUSED_PAD src0_sel:DWORD src1_sel:WORD_1
    v_pk_fma_f32 v[116:117], v[116:117], v[118:119], s[28:29] op_sel_hi:[1,0,1]
    v_pk_fma_f32 v[124:125], v[124:125], v[118:119], s[28:29] op_sel_hi:[1,0,1]
    v_perm_b32 v116, v117, v116, s35
    v_perm_b32 v117, v125, v124, s35
    v_lshl_add_u64 v[116:117], v[116:117], 0, s[30:31]
    ds_add_rtn_u64 v[124:125], v108, v[116:117] offset:50000

    s_mov_b64 exec, s[70:71]
    v_cvt_f32_i32_sdwa v118, sext(v109) dst_sel:DWORD dst_unused:UNUSED_PAD src0_sel:WORD_0
    v_lshlrev_b32 v116, 16, v126
    v_and_b32 v117, s32, v126
    v_mul_f32 v118, s33, v118
    v_lshlrev_b32 v126, 16, v127
    v_and_b32 v127, s32, v127
    v_lshlrev_b32_sdwa v109, 3, v109 dst_sel:DWORD dst_unused:UNUSED_PAD src0_sel:DWORD src1_sel:WORD_1
    v_pk_fma_f32 v[116:117], v[116:117], v[118:119], s[28:29] op_sel_hi:[1,0,1]
    v_pk_fma_f32 v[126:127], v[126:127], v[118:119], s[28:29] op_sel_hi:[1,0,1]
    v_perm_b32 v116, v117, v116, s35
    v_perm_b32 v117, v127, v126, s35
    v_lshl_add_u64 v[116:117], v[116:117], 0, s[30:31]
    ds_add_rtn_u64 v[126:127], v109, v[116:117] offset:50000

    s_waitcnt lgkmcnt(0)
    s_mov_b64 exec, s[64:65]
    v_or3_b32 v1, v120, v121, v1
    s_mov_b64 exec, s[66:67]
    v_or3_b32 v1, v122, v123, v1
    s_mov_b64 exec, s[68:69]
    v_or3_b32 v1, v124, v125, v1
    s_mov_b64 exec, s[70:71]
    v_or3_b32 v1, v126, v127, v1
    s_mov_b64 exec, -1
L_nt2_67:
    s_movk_i32 s53, 15360
    buffer_load_dwordx4 v[106:109], v2, s[16:19], s53 offen
    buffer_load_dword v114, v2, s[16:19], s53 offen offset:16
    s_cmp_le_u32 s40, 3584
    s_cbranch_scc1 L_noleft_68
    s_min_u32 s40, s40, 3968
    s_lshl_b32 s52, s38, 6
    s_add_u32 s52, s52, s36
    s_mul_i32 s52, s52, 19840
    s_add_u32 s20, s44, s52
    s_addc_u32 s21, s45, 0
    s_mul_i32 s52, s40, 5
    s_add_u32 s52, s52, 3
    s_and_b32 s22, s52, -4

    s_lshr_b32 s55, s39, 2
    s_add_u32 s55, s55, 3584
    v_and_b32 v120, 63, v0
    v_add_u32 v120, s55, v120
L_left_71:
    s_cmp_ge_u32 s55, s40
    s_cbranch_scc1 L_leftend_72
    v_mul_u32_u24 v121, 5, v120
    buffer_load_dword v122, v121, s[20:23], 0 offen
    buffer_load_ubyte v123, v121, s[20:23], 0 offen offset:4
    s_waitcnt vmcnt(0)

    v_perm_b32 v121, v123, v122, s24
    v_lshrrev_b32 v126, 30, v122
    v_and_b32 v121, 0x1fff, v121
    v_mul_u32_u24 v126, 6250, v126
    v_add_lshl_u32 v121, v121, v126, 3

    buffer_load_dwordx2 v[124:125], v121, s[8:11], s50 offen
    v_cmp_gt_u32 vcc, s40, v120
    s_waitcnt vmcnt(0)

    s_mov_b64 exec, vcc
    v_and_b32 v122, 0x3fffffff, v122
    v_cvt_f32_i32_sdwa v118, sext(v122) dst_sel:DWORD dst_unused:UNUSED_PAD src0_sel:WORD_0
    v_lshlrev_b32 v116, 16, v124
    v_and_b32 v117, s32, v124
    v_mul_f32 v118, s33, v118
    v_lshlrev_b32 v124, 16, v125
    v_and_b32 v125, s32, v125
    v_lshlrev_b32_sdwa v122, 3, v122 dst_sel:DWORD dst_unused:UNUSED_PAD src0_sel:DWORD src1_sel:WORD_1
    v_pk_fma_f32 v[116:117], v[116:117], v[118:119], s[28:29] op_sel_hi:[1,0,1]
    v_pk_fma_f32 v[124:125], v[124:125], v[118:119], s[28:29] op_sel_hi:[1,0,1]
    v_perm_b32 v116, v117, v116, s35
    v_perm_b32 v117, v125, v124, s35
    v_lshl_add_u64 v[116:117], v[116:117], 0, s[30:31]
    ds_add_rtn_u64 v[124:125], v122, v[116:117] offset:50000

    s_waitcnt lgkmcnt(0)
    v_or3_b32 v1, v124, v125, v1
    s_mov_b64 exec, -1
    v_add_u32 v120, 128, v120
    s_add_u32 s55, s55, 128
    s_branch L_left_71
L_leftend_72:

L_noleft_68:
    s_waitcnt lgkmcnt(0)
    s_barrier
    s_waitcnt vmcnt(7)
    ds_write_addtid_b32 v76 offset:0
    ds_write_addtid_b32 v77 offset:256
    ds_write_addtid_b32 v78 offset:512
    ds_write_addtid_b32 v79 offset:768
    s_waitcnt vmcnt(6)
    ds_write_addtid_b32 v80 offset:16384
    ds_write_addtid_b32 v81 offset:16640
    ds_write_addtid_b32 v82 offset:16896
    ds_write_addtid_b32 v83 offset:17152
    s_waitcnt vmcnt(5)
    ds_write_addtid_b32 v84 offset:32768
    ds_write_addtid_b32 v85 offset:33024
    ds_write_addtid_b32 v86 offset:33280
    ds_write_addtid_b32 v87 offset:33536
    v_lshlrev_b32 v119, 2, v0
    s_waitcnt vmcnt(4)
    s_mov_b64 exec, s[48:49]
    ds_write_b32 v119, v88 offset:49152
    s_mov_b64 exec, -1
    s_add_u32 s43, s43, 50048
    s_add_u32 s14, s43, 50000
    s_min_u32 s14, s14, s41
    buffer_load_dwordx4 v[76:79], v3, s[12:15], s43 offen
    s_add_u32 s52, s43, 16384
    buffer_load_dwordx4 v[80:83], v3, s[12:15], s52 offen
    v_cmp_gt_u32 s[64:65], 2.0, v4
    v_and_b32 v4, 0x3fffffff, v4
    v_cmp_gt_u32 s[66:67], 2.0, v5
    v_and_b32 v5, 0x3fffffff, v5
    v_cmp_gt_u32 s[68:69], 2.0, v6
    v_and_b32 v6, 0x3fffffff, v6
    v_cmp_gt_u32 s[70:71], 2.0, v7
    v_and_b32 v7, 0x3fffffff, v7
    v_cmp_gt_u32 s[72:73], 2.0, v8
    v_and_b32 v8, 0x3fffffff, v8
    v_cmp_gt_u32 s[74:75], 2.0, v9
    v_and_b32 v9, 0x3fffffff, v9
    v_cmp_gt_u32 s[76:77], 2.0, v10
    v_and_b32 v10, 0x3fffffff, v10
    v_cmp_gt_u32 s[78:79], 2.0, v11
    v_and_b32 v11, 0x3fffffff, v11
    v_cmp_gt_u32 s[80:81], 2.0, v12
    v_and_b32 v12, 0x3fffffff, v12
    v_cmp_gt_u32 s[82:83], 2.0, v13
    v_and_b32 v13, 0x3fffffff, v13
    v_cmp_gt_u32 s[84:85], 2.0, v14
    v_and_b32 v14, 0x3fffffff, v14
    v_cmp_gt_u32 s[86:87], 2.0, v15
    v_and_b32 v15, 0x3fffffff, v15
    s_waitcnt lgkmcnt(0)
    s_barrier
    s_add_u32 s52, s43, 32768
    buffer_load_dwordx4 v[84:87], v3, s[12:15], s52 offen
    s_add_u32 s52, s43, 49152
    v_lshlrev_b32 v119, 2, v0
    buffer_load_dword v88, v119, s[12:15], s52 offen
    s_mov_b64 exec, s[64:65]
    ds_read_b64 v[28:29], v28
    s_mov_b64 exec, s[66:67]
    ds_read_b64 v[30:31], v30
    s_mov_b64 exec, s[68:69]
    ds_read_b64 v[32:33], v32
    s_mov_b64 exec, s[70:71]
    ds_read_b64 v[34:35], v34
    s_mov_b64 exec, s[72:73]
    ds_read_b64 v[36:37], v36
    s_mov_b64 exec, s[74:75]
    ds_read_b64 v[38:39], v38
    s_mov_b64 exec, s[76:77]
    ds_read_b64 v[40:41], v40
    s_mov_b64 exec, s[78:79]
    ds_read_b64 v[42:43], v42
    s_mov_b64 exec, s[80:81]
    ds_read_b64 v[44:45], v44
    s_mov_b64 exec, s[82:83]
    ds_read_b64 v[46:47], v46
    s_mov_b64 exec, s[84:85]
    ds_read_b64 v[48:49], v48
    s_mov_b64 exec, s[86:87]
    ds_read_b64 v[50:51], v50
    s_mov_b64 exec, -1
    v_cmp_gt_u32 s[64:65], 2.0, v16
    v_and_b32 v16, 0x3fffffff, v16
    v_cmp_gt_u32 s[66:67], 2.0, v17
    v_and_b32 v17, 0x3fffffff, v17
    v_cmp_gt_u32 s[68:69], 2.0, v18
    v_and_b32 v18, 0x3fffffff, v18
    v_cmp_gt_u32 s[70:71], 2.0, v19
    v_and_b32 v19, 0x3fffffff, v19
    v_cmp_gt_u32 s[72:73], 2.0, v20
    v_and_b32 v20, 0x3fffffff, v20
    v_cmp_gt_u32 s[74:75], 2.0, v21
    v_and_b32 v21, 0x3fffffff, v21
    v_cmp_gt_u32 s[76:77], 2.0, v22
    v_and_b32 v22, 0x3fffffff, v22
    v_cmp_gt_u32 s[78:79], 2.0, v23
    v_and_b32 v23, 0x3fffffff, v23
    v_cmp_gt_u32 s[80:81], 2.0, v24
    v_and_b32 v24, 0x3fffffff, v24
    v_cmp_gt_u32 s[82:83], 2.0, v25
    v_and_b32 v25, 0x3fffffff, v25
    v_cmp_gt_u32 s[84:85], 2.0, v26
    v_and_b32 v26, 0x3fffffff, v26
    v_cmp_gt_u32 s[86:87], 2.0, v27
    v_and_b32 v27, 0x3fffffff, v27
    s_mov_b64 exec, s[64:65]
    ds_read_b64 v[52:53], v52
    s_mov_b64 exec, s[66:67]
    ds_read_b64 v[54:55], v54
    s_mov_b64 exec, s[68:69]
    ds_read_b64 v[56:57], v56
    s_mov_b64 exec, s[70:71]
    ds_read_b64 v[58:59], v58
    s_mov_b64 exec, s[72:73]
    ds_read_b64 v[60:61], v60
    s_mov_b64 exec, s[74:75]
    ds_read_b64 v[62:63], v62
    s_mov_b64 exec, s[76:77]
    ds_read_b64 v[64:65], v64
    s_mov_b64 exec, s[78:79]
    ds_read_b64 v[66:67], v66
    s_mov_b64 exec, s[80:81]
    ds_read_b64 v[68:69], v68
    s_mov_b64 exec, s[82:83]
    ds_read_b64 v[70:71], v70
    s_mov_b64 exec, s[84:85]
    ds_read_b64 v[72:73], v72
    s_mov_b64 exec, s[86:87]
    ds_read_b64 v[74:75], v74
    s_mov_b64 exec, -1
    s_movk_i32 s53, 12800
    buffer_load_dwordx4 v[102:105], v2, s[16:19], s53 offen
    buffer_load_dword v113, v2, s[16:19], s53 offen offset:16
    s_cmp_ge_u32 s5, s4
    s_cbranch_scc1 L_bend_65
    s_waitcnt lgkmcnt(15)
    v_mad_i32_i16 v120, v28, v4, s96
    v_mad_i32_i16 v28, v28, v4, s96 op_sel:[1,0,0,0]
    v_mad_i32_i16 v121, v29, v4, s96
    v_mad_i32_i16 v29, v29, v4, s96 op_sel:[1,0,0,0]
    v_lshlrev_b32_sdwa v4, 3, v4 dst_sel:DWORD dst_unused:UNUSED_PAD src0_sel:DWORD src1_sel:WORD_1
    v_perm_b32 v28, v28, v120, s97
    v_perm_b32 v29, v29, v121, s97
    v_lshl_add_u64 v[28:29], v[28:29], 0, s[30:31]

    ds_add_rtn_u64 v[28:29], v4, v[28:29] offset:50000
    v_mad_i32_i16 v122, v30, v5, s96
    v_mad_i32_i16 v30, v30, v5, s96 op_sel:[1,0,0,0]
    v_mad_i32_i16 v123, v31, v5, s96
    v_mad_i32_i16 v31, v31, v5, s96 op_sel:[1,0,0,0]
    v_lshlrev_b32_sdwa v5, 3, v5 dst_sel:DWORD dst_unused:UNUSED_PAD src0_sel:DWORD src1_sel:WORD_1
    v_perm_b32 v30, v30, v122, s97
    v_perm_b32 v31, v31, v123, s97
    v_lshl_add_u64 v[30:31], v[30:31], 0, s[30:31]

    ds_add_rtn_u64 v[30:31], v5, v[30:31] offset:50000
    v_mad_i32_i16 v124, v32, v6, s96
    v_mad_i32_i16 v32, v32, v6, s96 op_sel:[1,0,0,0]
    v_mad_i32_i16 v125, v33, v6, s96
    v_mad_i32_i16 v33, v33, v6, s96 op_sel:[1,0,0,0]
    v_lshlrev_b32_sdwa v6, 3, v6 dst_sel:DWORD dst_unused:UNUSED_PAD src0_sel:DWORD src1_sel:WORD_1
    v_perm_b32 v32, v32, v124, s97
    v_perm_b32 v33, v33, v125, s97
    v_lshl_add_u64 v[32:33], v[32:33], 0, s[30:31]

    ds_add_rtn_u64 v[32:33], v6, v[32:33] offset:50000
    v_mad_i32_i16 v126, v34, v7, s96
    v_mad_i32_i16 v34, v34, v7, s96 op_sel:[1,0,0,0]
    v_mad_i32_i16 v127, v35, v7, s96
    v_mad_i32_i16 v35, v35, v7, s96 op_sel:[1,0,0,0]
    v_lshlrev_b32_sdwa v7, 3, v7 dst_sel:DWORD dst_unused:UNUSED_PAD src0_sel:DWORD src1_sel:WORD_1
    v_perm_b32 v34, v34, v126, s97
    v_perm_b32 v35, v35, v127, s97
    v_lshl_add_u64 v[34:35], v[34:35], 0, s[30:31]

    ds_add_rtn_u64 v[34:35], v7, v[34:35] offset:50000
    v_mad_i32_i16 v120, v36, v8, s96
    v_mad_i32_i16 v36, v36, v8, s96 op_sel:[1,0,0,0]
    v_mad_i32_i16 v121, v37, v8, s96
    v_mad_i32_i16 v37, v37, v8, s96 op_sel:[1,0,0,0]
    v_lshlrev_b32_sdwa v8, 3, v8 dst_sel:DWORD dst_unused:UNUSED_PAD src0_sel:DWORD src1_sel:WORD_1
    v_perm_b32 v36, v36, v120, s97
    v_perm_b32 v37, v37, v121, s97
    v_lshl_add_u64 v[36:37], v[36:37], 0, s[30:31]

    ds_add_rtn_u64 v[36:37], v8, v[36:37] offset:50000
    v_mad_i32_i16 v122, v38, v9, s96
    v_mad_i32_i16 v38, v38, v9, s96 op_sel:[1,0,0,0]
    v_mad_i32_i16 v123, v39, v9, s96
    v_mad_i32_i16 v39, v39, v9, s96 op_sel:[1,0,0,0]
    v_lshlrev_b32_sdwa v9, 3, v9 dst_sel:DWORD dst_unused:UNUSED_PAD src0_sel:DWORD src1_sel:WORD_1
    v_perm_b32 v38, v38, v122, s97
    v_perm_b32 v39, v39, v123, s97
    v_lshl_add_u64 v[38:39], v[38:39], 0, s[30:31]

    ds_add_rtn_u64 v[38:39], v9, v[38:39] offset:50000
    v_mad_i32_i16 v124, v40, v10, s96
    v_mad_i32_i16 v40, v40, v10, s96 op_sel:[1,0,0,0]
    v_mad_i32_i16 v125, v41, v10, s96
    v_mad_i32_i16 v41, v41, v10, s96 op_sel:[1,0,0,0]
    v_lshlrev_b32_sdwa v10, 3, v10 dst_sel:DWORD dst_unused:UNUSED_PAD src0_sel:DWORD src1_sel:WORD_1
    v_perm_b32 v40, v40, v124, s97
    v_perm_b32 v41, v41, v125, s97
    v_lshl_add_u64 v[40:41], v[40:41], 0, s[30:31]

    ds_add_rtn_u64 v[40:41], v10, v[40:41] offset:50000
    v_mad_i32_i16 v126, v42, v11, s96
    v_mad_i32_i16 v42, v42, v11, s96 op_sel:[1,0,0,0]
    v_mad_i32_i16 v127, v43, v11, s96
    v_mad_i32_i16 v43, v43, v11, s96 op_sel:[1,0,0,0]
    v_lshlrev_b32_sdwa v11, 3, v11 dst_sel:DWORD dst_unused:UNUSED_PAD src0_sel:DWORD src1_sel:WORD_1
    v_perm_b32 v42, v42, v126, s97
    v_perm_b32 v43, v43, v127, s97
    v_lshl_add_u64 v[42:43], v[42:43], 0, s[30:31]

    ds_add_rtn_u64 v[42:43], v11, v[42:43] offset:50000
    s_waitcnt lgkmcnt(4)
    v_or3_b32 v1, v28, v29, v1
    v_or3_b32 v1, v30, v31, v1
    v_or3_b32 v1, v32, v33, v1
    v_or3_b32 v1, v34, v35, v1
    s_barrier
    s_waitcnt vmcnt(5)
    ds_write_addtid_b32 v76 offset:0
    ds_write_addtid_b32 v77 offset:256
    ds_write_addtid_b32 v78 offset:512
    ds_write_addtid_b32 v79 offset:768
    s_waitcnt vmcnt(4)
    ds_write_addtid_b32 v80 offset:16384
    ds_write_addtid_b32 v81 offset:16640
    ds_write_addtid_b32 v82 offset:16896
    ds_write_addtid_b32 v83 offset:17152
    s_waitcnt vmcnt(3)
    ds_write_addtid_b32 v84 offset:32768
    ds_write_addtid_b32 v85 offset:33024
    ds_write_addtid_b32 v86 offset:33280
    ds_write_addtid_b32 v87 offset:33536
    v_lshlrev_b32 v119, 2, v0
    s_waitcnt vmcnt(2)
    s_mov_b64 exec, s[48:49]
    ds_write_b32 v119, v88 offset:49152
    s_mov_b64 exec, -1
    s_add_u32 s43, s43, 50048
    s_add_u32 s14, s43, 50000
    s_min_u32 s14, s14, s41
    buffer_load_dwordx4 v[76:79], v3, s[12:15], s43 offen
    s_add_u32 s52, s43, 16384
    buffer_load_dwordx4 v[80:83], v3, s[12:15], s52 offen
    s_add_u32 s52, s43, 32768
    buffer_load_dwordx4 v[84:87], v3, s[12:15], s52 offen
    s_add_u32 s52, s43, 49152
    v_lshlrev_b32 v119, 2, v0
    buffer_load_dword v88, v119, s[12:15], s52 offen
    s_add_u32 s54, s43, 50048
    buffer_load_dword v115, v89, s[60:63], s54 offen
    s_add_u32 s54, s50, 200000
    buffer_load_dword v115, v89, s[8:11], s54 offen
    s_movk_i32 s53, 0
    buffer_load_dwordx4 v[4:7], v2, s[16:19], s53 offen
    buffer_load_dword v35, v2, s[16:19], s53 offen offset:16
    v_mad_i32_i16 v120, v44, v12, s96
    v_mad_i32_i16 v44, v44, v12, s96 op_sel:[1,0,0,0]
    v_mad_i32_i16 v121, v45, v12, s96
    v_mad_i32_i16 v45, v45, v12, s96 op_sel:[1,0,0,0]
    v_lshlrev_b32_sdwa v12, 3, v12 dst_sel:DWORD dst_unused:UNUSED_PAD src0_sel:DWORD src1_sel:WORD_1
    v_perm_b32 v44, v44, v120, s97
    v_perm_b32 v45, v45, v121, s97
    v_lshl_add_u64 v[44:45], v[44:45], 0, s[30:31]

    ds_add_rtn_u64 v[44:45], v12, v[44:45] offset:50000
    v_mad_i32_i16 v122, v46, v13, s96
    v_mad_i32_i16 v46, v46, v13, s96 op_sel:[1,0,0,0]
    v_mad_i32_i16 v123, v47, v13, s96
    v_mad_i32_i16 v47, v47, v13, s96 op_sel:[1,0,0,0]
    v_lshlrev_b32_sdwa v13, 3, v13 dst_sel:DWORD dst_unused:UNUSED_PAD src0_sel:DWORD src1_sel:WORD_1
    v_perm_b32 v46, v46, v122, s97
    v_perm_b32 v47, v47, v123, s97
    v_lshl_add_u64 v[46:47], v[46:47], 0, s[30:31]

    ds_add_rtn_u64 v[46:47], v13, v[46:47] offset:50000
    v_mad_i32_i16 v124, v48, v14, s96
    v_mad_i32_i16 v48, v48, v14, s96 op_sel:[1,0,0,0]
    v_mad_i32_i16 v125, v49, v14, s96
    v_mad_i32_i16 v49, v49, v14, s96 op_sel:[1,0,0,0]
    v_lshlrev_b32_sdwa v14, 3, v14 dst_sel:DWORD dst_unused:UNUSED_PAD src0_sel:DWORD src1_sel:WORD_1
    v_perm_b32 v48, v48, v124, s97
    v_perm_b32 v49, v49, v125, s97
    v_lshl_add_u64 v[48:49], v[48:49], 0, s[30:31]

    ds_add_rtn_u64 v[48:49], v14, v[48:49] offset:50000
    v_mad_i32_i16 v126, v50, v15, s96
    v_mad_i32_i16 v50, v50, v15, s96 op_sel:[1,0,0,0]
    v_mad_i32_i16 v127, v51, v15, s96
    v_mad_i32_i16 v51, v51, v15, s96 op_sel:[1,0,0,0]
    v_lshlrev_b32_sdwa v15, 3, v15 dst_sel:DWORD dst_unused:UNUSED_PAD src0_sel:DWORD src1_sel:WORD_1
    v_perm_b32 v50, v50, v126, s97
    v_perm_b32 v51, v51, v127, s97
    v_lshl_add_u64 v[50:51], v[50:51], 0, s[30:31]

    ds_add_rtn_u64 v[50:51], v15, v[50:51] offset:50000
    s_waitcnt lgkmcnt(15)
    v_or3_b32 v1, v36, v37, v1
    v_or3_b32 v1, v38, v39, v1
    v_or3_b32 v1, v40, v41, v1
    v_or3_b32 v1, v42, v43, v1
    s_movk_i32 s53, 2560
    buffer_load_dwordx4 v[8:11], v2, s[16:19], s53 offen
    buffer_load_dword v43, v2, s[16:19], s53 offen offset:16
    s_mov_b32 s40, s88
    s_sub_u32 s42, s40, s39

    s_add_u32 s55, s38, 2
    s_min_u32 s55, s55, 31
    s_mov_b32 s88, s89
    s_mov_b32 s89, s90
    s_mov_b32 s90, s91
    s_mov_b32 s91, s92
    s_mov_b32 s92, s93
    s_mov_b32 s93, s94
    s_mov_b32 s94, s95
    s_mov_b32 s95, 0
    s_min_u32 s88, s88, 3968
    s_lshl_b32 s52, s55, 6
    s_add_u32 s52, s52, s36
    s_mul_i32 s52, s52, 19840
    s_add_u32 s16, s44, s52
    s_addc_u32 s17, s45, 0
    s_mul_i32 s52, s88, 5
    s_add_u32 s52, s52, 3
    s_and_b32 s18, s52, -4

    v_mad_i32_i16 v120, v52, v16, s96
    v_mad_i32_i16 v52, v52, v16, s96 op_sel:[1,0,0,0]
    v_mad_i32_i16 v121, v53, v16, s96
    v_mad_i32_i16 v53, v53, v16, s96 op_sel:[1,0,0,0]
    v_lshlrev_b32_sdwa v16, 3, v16 dst_sel:DWORD dst_unused:UNUSED_PAD src0_sel:DWORD src1_sel:WORD_1
    v_perm_b32 v52, v52, v120, s97
    v_perm_b32 v53, v53, v121, s97
    v_lshl_add_u64 v[52:53], v[52:53], 0, s[30:31]

    ds_add_rtn_u64 v[52:53], v16, v[52:53] offset:50000
    v_mad_i32_i16 v122, v54, v17, s96
    v_mad_i32_i16 v54, v54, v17, s96 op_sel:[1,0,0,0]
    v_mad_i32_i16 v123, v55, v17, s96
    v_mad_i32_i16 v55, v55, v17, s96 op_sel:[1,0,0,0]
    v_lshlrev_b32_sdwa v17, 3, v17 dst_sel:DWORD dst_unused:UNUSED_PAD src0_sel:DWORD src1_sel:WORD_1
    v_perm_b32 v54, v54, v122, s97
    v_perm_b32 v55, v55, v123, s97
    v_lshl_add_u64 v[54:55], v[54:55], 0, s[30:31]

    ds_add_rtn_u64 v[54:55], v17, v[54:55] offset:50000
    v_mad_i32_i16 v124, v56, v18, s96
    v_mad_i32_i16 v56, v56, v18, s96 op_sel:[1,0,0,0]
    v_mad_i32_i16 v125, v57, v18, s96
    v_mad_i32_i16 v57, v57, v18, s96 op_sel:[1,0,0,0]
    v_lshlrev_b32_sdwa v18, 3, v18 dst_sel:DWORD dst_unused:UNUSED_PAD src0_sel:DWORD src1_sel:WORD_1
    v_perm_b32 v56, v56, v124, s97
    v_perm_b32 v57, v57, v125, s97
    v_lshl_add_u64 v[56:57], v[56:57], 0, s[30:31]

    ds_add_rtn_u64 v[56:57], v18, v[56:57] offset:50000
    v_mad_i32_i16 v126, v58, v19, s96
    v_mad_i32_i16 v58, v58, v19, s96 op_sel:[1,0,0,0]
    v_mad_i32_i16 v127, v59, v19, s96
    v_mad_i32_i16 v59, v59, v19, s96 op_sel:[1,0,0,0]
    v_lshlrev_b32_sdwa v19, 3, v19 dst_sel:DWORD dst_unused:UNUSED_PAD src0_sel:DWORD src1_sel:WORD_1
    v_perm_b32 v58, v58, v126, s97
    v_perm_b32 v59, v59, v127, s97
    v_lshl_add_u64 v[58:59], v[58:59], 0, s[30:31]

    ds_add_rtn_u64 v[58:59], v19, v[58:59] offset:50000
    s_waitcnt lgkmcnt(4)
    v_or3_b32 v1, v44, v45, v1
    v_or3_b32 v1, v46, v47, v1
    v_or3_b32 v1, v48, v49, v1
    v_or3_b32 v1, v50, v51, v1
    s_waitcnt vmcnt(30)
    v_perm_b32 v44, v91, v90, s24
    v_perm_b32 v46, v92, v91, s25
    v_perm_b32 v48, v93, v92, s26
    v_perm_b32 v50, v110, v93, s27
    v_mov_b32 v12, v90
    v_alignbyte_b32 v13, v92, v91, 1
    v_alignbyte_b32 v14, v93, v92, 2
    v_alignbyte_b32 v15, v110, v93, 3
    v_lshlrev_b32_sdwa v44, 3, v44 dst_sel:WORD_0 dst_unused:UNUSED_PAD src0_sel:DWORD src1_sel:DWORD
    v_lshlrev_b32_sdwa v46, 3, v46 dst_sel:WORD_0 dst_unused:UNUSED_PAD src0_sel:DWORD src1_sel:DWORD
    v_lshlrev_b32_sdwa v48, 3, v48 dst_sel:WORD_0 dst_unused:UNUSED_PAD src0_sel:DWORD src1_sel:DWORD
    v_lshlrev_b32_sdwa v50, 3, v50 dst_sel:WORD_0 dst_unused:UNUSED_PAD src0_sel:DWORD src1_sel:DWORD
    s_cmp_lt_i32 s42, 1280
    s_cbranch_scc1 L_ufix_73
L_uback_74:

    s_barrier
    v_subrev_co_u32 v12, s[80:81], 2.0, v12
    v_subrev_co_u32 v13, s[82:83], 2.0, v13
    v_subrev_co_u32 v14, s[84:85], 2.0, v14
    v_subrev_co_u32 v15, s[86:87], 2.0, v15
    s_mov_b64 exec, s[80:81]
    ds_read_b64 v[44:45], v44
    s_mov_b64 exec, s[82:83]
    ds_read_b64 v[46:47], v46
    s_mov_b64 exec, s[84:85]
    ds_read_b64 v[48:49], v48
    s_mov_b64 exec, s[86:87]
    ds_read_b64 v[50:51], v50
    s_mov_b64 exec, -1
    v_mad_i32_i16 v120, v60, v20, s96
    v_mad_i32_i16 v60, v60, v20, s96 op_sel:[1,0,0,0]
    v_mad_i32_i16 v121, v61, v20, s96
    v_mad_i32_i16 v61, v61, v20, s96 op_sel:[1,0,0,0]
    v_lshlrev_b32_sdwa v20, 3, v20 dst_sel:DWORD dst_unused:UNUSED_PAD src0_sel:DWORD src1_sel:WORD_1
    v_perm_b32 v60, v60, v120, s97
    v_perm_b32 v61, v61, v121, s97
    v_lshl_add_u64 v[60:61], v[60:61], 0, s[30:31]

    ds_add_rtn_u64 v[60:61], v20, v[60:61] offset:50000
    v_mad_i32_i16 v122, v62, v21, s96
    v_mad_i32_i16 v62, v62, v21, s96 op_sel:[1,0,0,0]
    v_mad_i32_i16 v123, v63, v21, s96
    v_mad_i32_i16 v63, v63, v21, s96 op_sel:[1,0,0,0]
    v_lshlrev_b32_sdwa v21, 3, v21 dst_sel:DWORD dst_unused:UNUSED_PAD src0_sel:DWORD src1_sel:WORD_1
    v_perm_b32 v62, v62, v122, s97
    v_perm_b32 v63, v63, v123, s97
    v_lshl_add_u64 v[62:63], v[62:63], 0, s[30:31]

    ds_add_rtn_u64 v[62:63], v21, v[62:63] offset:50000
    v_mad_i32_i16 v124, v64, v22, s96
    v_mad_i32_i16 v64, v64, v22, s96 op_sel:[1,0,0,0]
    v_mad_i32_i16 v125, v65, v22, s96
    v_mad_i32_i16 v65, v65, v22, s96 op_sel:[1,0,0,0]
    v_lshlrev_b32_sdwa v22, 3, v22 dst_sel:DWORD dst_unused:UNUSED_PAD src0_sel:DWORD src1_sel:WORD_1
    v_perm_b32 v64, v64, v124, s97
    v_perm_b32 v65, v65, v125, s97
    v_lshl_add_u64 v[64:65], v[64:65], 0, s[30:31]

    ds_add_rtn_u64 v[64:65], v22, v[64:65] offset:50000
    v_mad_i32_i16 v126, v66, v23, s96
    v_mad_i32_i16 v66, v66, v23, s96 op_sel:[1,0,0,0]
    v_mad_i32_i16 v127, v67, v23, s96
    v_mad_i32_i16 v67, v67, v23, s96 op_sel:[1,0,0,0]
    v_lshlrev_b32_sdwa v23, 3, v23 dst_sel:DWORD dst_unused:UNUSED_PAD src0_sel:DWORD src1_sel:WORD_1
    v_perm_b32 v66, v66, v126, s97
    v_perm_b32 v67, v67, v127, s97
    v_lshl_add_u64 v[66:67], v[66:67], 0, s[30:31]

    ds_add_rtn_u64 v[66:67], v23, v[66:67] offset:50000
    s_waitcnt lgkmcnt(8)
    v_or3_b32 v1, v52, v53, v1
    v_or3_b32 v1, v54, v55, v1
    v_or3_b32 v1, v56, v57, v1
    v_or3_b32 v1, v58, v59, v1
    s_waitcnt vmcnt(24)
    v_perm_b32 v52, v95, v94, s24
    v_perm_b32 v54, v96, v95, s25
    v_perm_b32 v56, v97, v96, s26
    v_perm_b32 v58, v111, v97, s27
    v_mov_b32 v16, v94
    v_alignbyte_b32 v17, v96, v95, 1
    v_alignbyte_b32 v18, v97, v96, 2
    v_alignbyte_b32 v19, v111, v97, 3
    v_lshlrev_b32_sdwa v52, 3, v52 dst_sel:WORD_0 dst_unused:UNUSED_PAD src0_sel:DWORD src1_sel:DWORD
    v_lshlrev_b32_sdwa v54, 3, v54 dst_sel:WORD_0 dst_unused:UNUSED_PAD src0_sel:DWORD src1_sel:DWORD
    v_lshlrev_b32_sdwa v56, 3, v56 dst_sel:WORD_0 dst_unused:UNUSED_PAD src0_sel:DWORD src1_sel:DWORD
    v_lshlrev_b32_sdwa v58, 3, v58 dst_sel:WORD_0 dst_unused:UNUSED_PAD src0_sel:DWORD src1_sel:DWORD
    s_cmp_lt_i32 s42, 1792
    s_cbranch_scc1 L_ufix_75
L_uback_76:

    v_subrev_co_u32 v16, s[64:65], 2.0, v16
    v_subrev_co_u32 v17, s[66:67], 2.0, v17
    v_subrev_co_u32 v18, s[68:69], 2.0, v18
    v_subrev_co_u32 v19, s[70:71], 2.0, v19
    s_mov_b64 exec, s[64:65]
    ds_read_b64 v[52:53], v52
    s_mov_b64 exec, s[66:67]
    ds_read_b64 v[54:55], v54
    s_mov_b64 exec, s[68:69]
    ds_read_b64 v[56:57], v56
    s_mov_b64 exec, s[70:71]
    ds_read_b64 v[58:59], v58
    s_mov_b64 exec, -1
    v_mad_i32_i16 v120, v68, v24, s96
    v_mad_i32_i16 v68, v68, v24, s96 op_sel:[1,0,0,0]
    v_mad_i32_i16 v121, v69, v24, s96
    v_mad_i32_i16 v69, v69, v24, s96 op_sel:[1,0,0,0]
    v_lshlrev_b32_sdwa v24, 3, v24 dst_sel:DWORD dst_unused:UNUSED_PAD src0_sel:DWORD src1_sel:WORD_1
    v_perm_b32 v68, v68, v120, s97
    v_perm_b32 v69, v69, v121, s97
    v_lshl_add_u64 v[68:69], v[68:69], 0, s[30:31]

    ds_add_rtn_u64 v[68:69], v24, v[68:69] offset:50000
    v_mad_i32_i16 v122, v70, v25, s96
    v_mad_i32_i16 v70, v70, v25, s96 op_sel:[1,0,0,0]
    v_mad_i32_i16 v123, v71, v25, s96
    v_mad_i32_i16 v71, v71, v25, s96 op_sel:[1,0,0,0]
    v_lshlrev_b32_sdwa v25, 3, v25 dst_sel:DWORD dst_unused:UNUSED_PAD src0_sel:DWORD src1_sel:WORD_1
    v_perm_b32 v70, v70, v122, s97
    v_perm_b32 v71, v71, v123, s97
    v_lshl_add_u64 v[70:71], v[70:71], 0, s[30:31]

    ds_add_rtn_u64 v[70:71], v25, v[70:71] offset:50000
    v_mad_i32_i16 v124, v72, v26, s96
    v_mad_i32_i16 v72, v72, v26, s96 op_sel:[1,0,0,0]
    v_mad_i32_i16 v125, v73, v26, s96
    v_mad_i32_i16 v73, v73, v26, s96 op_sel:[1,0,0,0]
    v_lshlrev_b32_sdwa v26, 3, v26 dst_sel:DWORD dst_unused:UNUSED_PAD src0_sel:DWORD src1_sel:WORD_1
    v_perm_b32 v72, v72, v124, s97
    v_perm_b32 v73, v73, v125, s97
    v_lshl_add_u64 v[72:73], v[72:73], 0, s[30:31]

    ds_add_rtn_u64 v[72:73], v26, v[72:73] offset:50000
    v_mad_i32_i16 v126, v74, v27, s96
    v_mad_i32_i16 v74, v74, v27, s96 op_sel:[1,0,0,0]
    v_mad_i32_i16 v127, v75, v27, s96
    v_mad_i32_i16 v75, v75, v27, s96 op_sel:[1,0,0,0]
    v_lshlrev_b32_sdwa v27, 3, v27 dst_sel:DWORD dst_unused:UNUSED_PAD src0_sel:DWORD src1_sel:WORD_1
    v_perm_b32 v74, v74, v126, s97
    v_perm_b32 v75, v75, v127, s97
    v_lshl_add_u64 v[74:75], v[74:75], 0, s[30:31]

    ds_add_rtn_u64 v[74:75], v27, v[74:75] offset:50000
    s_waitcnt lgkmcnt(8)
    v_or3_b32 v1, v60, v61, v1
    v_or3_b32 v1, v62, v63, v1
    v_or3_b32 v1, v64, v65, v1
    v_or3_b32 v1, v66, v67, v1
    s_waitcnt vmcnt(18)
    v_perm_b32 v60, v99, v98, s24
    v_perm_b32 v62, v100, v99, s25
    v_perm_b32 v64, v101, v100, s26
    v_perm_b32 v66, v112, v101, s27
    v_mov_b32 v20, v98
    v_alignbyte_b32 v21, v100, v99, 1
    v_alignbyte_b32 v22, v101, v100, 2
    v_alignbyte_b32 v23, v112, v101, 3
    v_lshlrev_b32_sdwa v60, 3, v60 dst_sel:WORD_0 dst_unused:UNUSED_PAD src0_sel:DWORD src1_sel:DWORD
    v_lshlrev_b32_sdwa v62, 3, v62 dst_sel:WORD_0 dst_unused:UNUSED_PAD src0_sel:DWORD src1_sel:DWORD
    v_lshlrev_b32_sdwa v64, 3, v64 dst_sel:WORD_0 dst_unused:UNUSED_PAD src0_sel:DWORD src1_sel:DWORD
    v_lshlrev_b32_sdwa v66, 3, v66 dst_sel:WORD_0 dst_unused:UNUSED_PAD src0_sel:DWORD src1_sel:DWORD
    s_cmp_lt_i32 s42, 2304
    s_cbranch_scc1 L_ufix_77
L_uback_78:

    v_subrev_co_u32 v20, s[72:73], 2.0, v20
    v_subrev_co_u32 v21, s[74:75], 2.0, v21
    v_subrev_co_u32 v22, s[76:77], 2.0, v22
    v_subrev_co_u32 v23, s[78:79], 2.0, v23
    s_mov_b64 exec, s[72:73]
    ds_read_b64 v[60:61], v60
    s_mov_b64 exec, s[74:75]
    ds_read_b64 v[62:63], v62
    s_mov_b64 exec, s[76:77]
    ds_read_b64 v[64:65], v64
    s_mov_b64 exec, s[78:79]
    ds_read_b64 v[66:67], v66
    s_mov_b64 exec, -1
    s_waitcnt lgkmcnt(4)
    v_or3_b32 v1, v68, v69, v1
    v_or3_b32 v1, v70, v71, v1
    v_or3_b32 v1, v72, v73, v1
    v_or3_b32 v1, v74, v75, v1
    s_waitcnt vmcnt(10)
    v_perm_b32 v68, v103, v102, s24
    v_perm_b32 v70, v104, v103, s25
    v_perm_b32 v72, v105, v104, s26
    v_perm_b32 v74, v113, v105, s27
    v_mov_b32 v24, v102
    v_alignbyte_b32 v25, v104, v103, 1
    v_alignbyte_b32 v26, v105, v104, 2
    v_alignbyte_b32 v27, v113, v105, 3
    v_lshlrev_b32_sdwa v68, 3, v68 dst_sel:WORD_0 dst_unused:UNUSED_PAD src0_sel:DWORD src1_sel:DWORD
    v_lshlrev_b32_sdwa v70, 3, v70 dst_sel:WORD_0 dst_unused:UNUSED_PAD src0_sel:DWORD src1_sel:DWORD
    v_lshlrev_b32_sdwa v72, 3, v72 dst_sel:WORD_0 dst_unused:UNUSED_PAD src0_sel:DWORD src1_sel:DWORD
    v_lshlrev_b32_sdwa v74, 3, v74 dst_sel:WORD_0 dst_unused:UNUSED_PAD src0_sel:DWORD src1_sel:DWORD
    s_cmp_lt_i32 s42, 2816
    s_cbranch_scc1 L_ufix_79
L_uback_80:

    v_subrev_co_u32 v24, s[80:81], 2.0, v24
    v_subrev_co_u32 v25, s[82:83], 2.0, v25
    v_subrev_co_u32 v26, s[84:85], 2.0, v26
    v_subrev_co_u32 v27, s[86:87], 2.0, v27
    s_mov_b64 exec, s[80:81]
    ds_read_b64 v[68:69], v68
    s_mov_b64 exec, s[82:83]
    ds_read_b64 v[70:71], v70
    s_mov_b64 exec, s[84:85]
    ds_read_b64 v[72:73], v72
    s_mov_b64 exec, s[86:87]
    ds_read_b64 v[74:75], v74
    s_mov_b64 exec, -1
    s_waitcnt vmcnt(2)
    v_perm_b32 v28, v5, v4, s24
    v_perm_b32 v30, v6, v5, s25
    v_perm_b32 v32, v7, v6, s26
    v_perm_b32 v34, v35, v7, s27
    v_alignbyte_b32 v5, v6, v5, 1
    v_alignbyte_b32 v6, v7, v6, 2
    v_alignbyte_b32 v7, v35, v7, 3
    v_lshlrev_b32_sdwa v28, 3, v28 dst_sel:WORD_0 dst_unused:UNUSED_PAD src0_sel:DWORD src1_sel:DWORD
    v_lshlrev_b32_sdwa v30, 3, v30 dst_sel:WORD_0 dst_unused:UNUSED_PAD src0_sel:DWORD src1_sel:DWORD
    v_lshlrev_b32_sdwa v32, 3, v32 dst_sel:WORD_0 dst_unused:UNUSED_PAD src0_sel:DWORD src1_sel:DWORD
    v_lshlrev_b32_sdwa v34, 3, v34 dst_sel:WORD_0 dst_unused:UNUSED_PAD src0_sel:DWORD src1_sel:DWORD
    s_cmp_lt_i32 s42, 256
    s_cbranch_scc1 L_ufix_81
L_uback_82:

    v_subrev_co_u32 v4, s[64:65], 2.0, v4
    v_subrev_co_u32 v5, s[66:67], 2.0, v5
    v_subrev_co_u32 v6, s[68:69], 2.0, v6
    v_subrev_co_u32 v7, s[70:71], 2.0, v7
    s_mov_b64 exec, s[64:65]
    ds_read_b64 v[28:29], v28
    s_mov_b64 exec, s[66:67]
    ds_read_b64 v[30:31], v30
    s_mov_b64 exec, s[68:69]
    ds_read_b64 v[32:33], v32
    s_mov_b64 exec, s[70:71]
    ds_read_b64 v[34:35], v34
    s_mov_b64 exec, -1
    s_waitcnt vmcnt(0)
    v_perm_b32 v36, v9, v8, s24
    v_perm_b32 v38, v10, v9, s25
    v_perm_b32 v40, v11, v10, s26
    v_perm_b32 v42, v43, v11, s27
    v_alignbyte_b32 v9, v10, v9, 1
    v_alignbyte_b32 v10, v11, v10, 2
    v_alignbyte_b32 v11, v43, v11, 3
    v_lshlrev_b32_sdwa v36, 3, v36 dst_sel:WORD_0 dst_unused:UNUSED_PAD src0_sel:DWORD src1_sel:DWORD
    v_lshlrev_b32_sdwa v38, 3, v38 dst_sel:WORD_0 dst_unused:UNUSED_PAD src0_sel:DWORD src1_sel:DWORD
    v_lshlrev_b32_sdwa v40, 3, v40 dst_sel:WORD_0 dst_unused:UNUSED_PAD src0_sel:DWORD src1_sel:DWORD
    v_lshlrev_b32_sdwa v42, 3, v42 dst_sel:WORD_0 dst_unused:UNUSED_PAD src0_sel:DWORD src1_sel:DWORD
    s_cmp_lt_i32 s42, 768
    s_cbranch_scc1 L_ufix_83
L_uback_84:

    v_subrev_co_u32 v8, s[72:73], 2.0, v8
    v_subrev_co_u32 v9, s[74:75], 2.0, v9
    v_subrev_co_u32 v10, s[76:77], 2.0, v10
    v_subrev_co_u32 v11, s[78:79], 2.0, v11
    s_mov_b64 exec, s[72:73]
    ds_read_b64 v[36:37], v36
    s_mov_b64 exec, s[74:75]
    ds_read_b64 v[38:39], v38
    s_mov_b64 exec, s[76:77]
    ds_read_b64 v[40:41], v40
    s_mov_b64 exec, s[78:79]
    ds_read_b64 v[42:43], v42
    s_mov_b64 exec, -1
    s_mov_b32 s38, s5
    s_add_u32 s50, s50, 200000
    s_branch L_batch_64
L_bend_65:

    s_waitcnt lgkmcnt(15)
    v_mad_i32_i16 v120, v28, v4, s96
    v_mad_i32_i16 v28, v28, v4, s96 op_sel:[1,0,0,0]
    v_mad_i32_i16 v121, v29, v4, s96
    v_mad_i32_i16 v29, v29, v4, s96 op_sel:[1,0,0,0]
    v_lshlrev_b32_sdwa v4, 3, v4 dst_sel:DWORD dst_unused:UNUSED_PAD src0_sel:DWORD src1_sel:WORD_1
    v_perm_b32 v28, v28, v120, s97
    v_perm_b32 v29, v29, v121, s97
    v_lshl_add_u64 v[28:29], v[28:29], 0, s[30:31]

    ds_add_rtn_u64 v[28:29], v4, v[28:29] offset:50000
    v_mad_i32_i16 v122, v30, v5, s96
    v_mad_i32_i16 v30, v30, v5, s96 op_sel:[1,0,0,0]
    v_mad_i32_i16 v123, v31, v5, s96
    v_mad_i32_i16 v31, v31, v5, s96 op_sel:[1,0,0,0]
    v_lshlrev_b32_sdwa v5, 3, v5 dst_sel:DWORD dst_unused:UNUSED_PAD src0_sel:DWORD src1_sel:WORD_1
    v_perm_b32 v30, v30, v122, s97
    v_perm_b32 v31, v31, v123, s97
    v_lshl_add_u64 v[30:31], v[30:31], 0, s[30:31]

    ds_add_rtn_u64 v[30:31], v5, v[30:31] offset:50000
    v_mad_i32_i16 v124, v32, v6, s96
    v_mad_i32_i16 v32, v32, v6, s96 op_sel:[1,0,0,0]
    v_mad_i32_i16 v125, v33, v6, s96
    v_mad_i32_i16 v33, v33, v6, s96 op_sel:[1,0,0,0]
    v_lshlrev_b32_sdwa v6, 3, v6 dst_sel:DWORD dst_unused:UNUSED_PAD src0_sel:DWORD src1_sel:WORD_1
    v_perm_b32 v32, v32, v124, s97
    v_perm_b32 v33, v33, v125, s97
    v_lshl_add_u64 v[32:33], v[32:33], 0, s[30:31]

    ds_add_rtn_u64 v[32:33], v6, v[32:33] offset:50000
    v_mad_i32_i16 v126, v34, v7, s96
    v_mad_i32_i16 v34, v34, v7, s96 op_sel:[1,0,0,0]
    v_mad_i32_i16 v127, v35, v7, s96
    v_mad_i32_i16 v35, v35, v7, s96 op_sel:[1,0,0,0]
    v_lshlrev_b32_sdwa v7, 3, v7 dst_sel:DWORD dst_unused:UNUSED_PAD src0_sel:DWORD src1_sel:WORD_1
    v_perm_b32 v34, v34, v126, s97
    v_perm_b32 v35, v35, v127, s97
    v_lshl_add_u64 v[34:35], v[34:35], 0, s[30:31]

    ds_add_rtn_u64 v[34:35], v7, v[34:35] offset:50000
    v_mad_i32_i16 v120, v36, v8, s96
    v_mad_i32_i16 v36, v36, v8, s96 op_sel:[1,0,0,0]
    v_mad_i32_i16 v121, v37, v8, s96
    v_mad_i32_i16 v37, v37, v8, s96 op_sel:[1,0,0,0]
    v_lshlrev_b32_sdwa v8, 3, v8 dst_sel:DWORD dst_unused:UNUSED_PAD src0_sel:DWORD src1_sel:WORD_1
    v_perm_b32 v36, v36, v120, s97
    v_perm_b32 v37, v37, v121, s97
    v_lshl_add_u64 v[36:37], v[36:37], 0, s[30:31]

    ds_add_rtn_u64 v[36:37], v8, v[36:37] offset:50000
    v_mad_i32_i16 v122, v38, v9, s96
    v_mad_i32_i16 v38, v38, v9, s96 op_sel:[1,0,0,0]
    v_mad_i32_i16 v123, v39, v9, s96
    v_mad_i32_i16 v39, v39, v9, s96 op_sel:[1,0,0,0]
    v_lshlrev_b32_sdwa v9, 3, v9 dst_sel:DWORD dst_unused:UNUSED_PAD src0_sel:DWORD src1_sel:WORD_1
    v_perm_b32 v38, v38, v122, s97
    v_perm_b32 v39, v39, v123, s97
    v_lshl_add_u64 v[38:39], v[38:39], 0, s[30:31]

    ds_add_rtn_u64 v[38:39], v9, v[38:39] offset:50000
    v_mad_i32_i16 v124, v40, v10, s96
    v_mad_i32_i16 v40, v40, v10, s96 op_sel:[1,0,0,0]
    v_mad_i32_i16 v125, v41, v10, s96
    v_mad_i32_i16 v41, v41, v10, s96 op_sel:[1,0,0,0]
    v_lshlrev_b32_sdwa v10, 3, v10 dst_sel:DWORD dst_unused:UNUSED_PAD src0_sel:DWORD src1_sel:WORD_1
    v_perm_b32 v40, v40, v124, s97
    v_perm_b32 v41, v41, v125, s97
    v_lshl_add_u64 v[40:41], v[40:41], 0, s[30:31]

    ds_add_rtn_u64 v[40:41], v10, v[40:41] offset:50000
    v_mad_i32_i16 v126, v42, v11, s96
    v_mad_i32_i16 v42, v42, v11, s96 op_sel:[1,0,0,0]
    v_mad_i32_i16 v127, v43, v11, s96
    v_mad_i32_i16 v43, v43, v11, s96 op_sel:[1,0,0,0]
    v_lshlrev_b32_sdwa v11, 3, v11 dst_sel:DWORD dst_unused:UNUSED_PAD src0_sel:DWORD src1_sel:WORD_1
    v_perm_b32 v42, v42, v126, s97
    v_perm_b32 v43, v43, v127, s97
    v_lshl_add_u64 v[42:43], v[42:43], 0, s[30:31]

    ds_add_rtn_u64 v[42:43], v11, v[42:43] offset:50000
    s_waitcnt lgkmcnt(4)
    v_or3_b32 v1, v28, v29, v1
    v_or3_b32 v1, v30, v31, v1
    v_or3_b32 v1, v32, v33, v1
    v_or3_b32 v1, v34, v35, v1
    v_mad_i32_i16 v120, v44, v12, s96
    v_mad_i32_i16 v44, v44, v12, s96 op_sel:[1,0,0,0]
    v_mad_i32_i16 v121, v45, v12, s96
    v_mad_i32_i16 v45, v45, v12, s96 op_sel:[1,0,0,0]
    v_lshlrev_b32_sdwa v12, 3, v12 dst_sel:DWORD dst_unused:UNUSED_PAD src0_sel:DWORD src1_sel:WORD_1
    v_perm_b32 v44, v44, v120, s97
    v_perm_b32 v45, v45, v121, s97
    v_lshl_add_u64 v[44:45], v[44:45], 0, s[30:31]

    ds_add_rtn_u64 v[44:45], v12, v[44:45] offset:50000
    v_mad_i32_i16 v122, v46, v13, s96
    v_mad_i32_i16 v46, v46, v13, s96 op_sel:[1,0,0,0]
    v_mad_i32_i16 v123, v47, v13, s96
    v_mad_i32_i16 v47, v47, v13, s96 op_sel:[1,0,0,0]
    v_lshlrev_b32_sdwa v13, 3, v13 dst_sel:DWORD dst_unused:UNUSED_PAD src0_sel:DWORD src1_sel:WORD_1
    v_perm_b32 v46, v46, v122, s97
    v_perm_b32 v47, v47, v123, s97
    v_lshl_add_u64 v[46:47], v[46:47], 0, s[30:31]

    ds_add_rtn_u64 v[46:47], v13, v[46:47] offset:50000
    v_mad_i32_i16 v124, v48, v14, s96
    v_mad_i32_i16 v48, v48, v14, s96 op_sel:[1,0,0,0]
    v_mad_i32_i16 v125, v49, v14, s96
    v_mad_i32_i16 v49, v49, v14, s96 op_sel:[1,0,0,0]
    v_lshlrev_b32_sdwa v14, 3, v14 dst_sel:DWORD dst_unused:UNUSED_PAD src0_sel:DWORD src1_sel:WORD_1
    v_perm_b32 v48, v48, v124, s97
    v_perm_b32 v49, v49, v125, s97
    v_lshl_add_u64 v[48:49], v[48:49], 0, s[30:31]

    ds_add_rtn_u64 v[48:49], v14, v[48:49] offset:50000
    v_mad_i32_i16 v126, v50, v15, s96
    v_mad_i32_i16 v50, v50, v15, s96 op_sel:[1,0,0,0]
    v_mad_i32_i16 v127, v51, v15, s96
    v_mad_i32_i16 v51, v51, v15, s96 op_sel:[1,0,0,0]
    v_lshlrev_b32_sdwa v15, 3, v15 dst_sel:DWORD dst_unused:UNUSED_PAD src0_sel:DWORD src1_sel:WORD_1
    v_perm_b32 v50, v50, v126, s97
    v_perm_b32 v51, v51, v127, s97
    v_lshl_add_u64 v[50:51], v[50:51], 0, s[30:31]

    ds_add_rtn_u64 v[50:51], v15, v[50:51] offset:50000
    s_waitcnt lgkmcnt(4)
    v_or3_b32 v1, v36, v37, v1
    v_or3_b32 v1, v38, v39, v1
    v_or3_b32 v1, v40, v41, v1
    v_or3_b32 v1, v42, v43, v1
    v_mad_i32_i16 v120, v52, v16, s96
    v_mad_i32_i16 v52, v52, v16, s96 op_sel:[1,0,0,0]
    v_mad_i32_i16 v121, v53, v16, s96
    v_mad_i32_i16 v53, v53, v16, s96 op_sel:[1,0,0,0]
    v_lshlrev_b32_sdwa v16, 3, v16 dst_sel:DWORD dst_unused:UNUSED_PAD src0_sel:DWORD src1_sel:WORD_1
    v_perm_b32 v52, v52, v120, s97
    v_perm_b32 v53, v53, v121, s97
    v_lshl_add_u64 v[52:53], v[52:53], 0, s[30:31]

    ds_add_rtn_u64 v[52:53], v16, v[52:53] offset:50000
    v_mad_i32_i16 v122, v54, v17, s96
    v_mad_i32_i16 v54, v54, v17, s96 op_sel:[1,0,0,0]
    v_mad_i32_i16 v123, v55, v17, s96
    v_mad_i32_i16 v55, v55, v17, s96 op_sel:[1,0,0,0]
    v_lshlrev_b32_sdwa v17, 3, v17 dst_sel:DWORD dst_unused:UNUSED_PAD src0_sel:DWORD src1_sel:WORD_1
    v_perm_b32 v54, v54, v122, s97
    v_perm_b32 v55, v55, v123, s97
    v_lshl_add_u64 v[54:55], v[54:55], 0, s[30:31]

    ds_add_rtn_u64 v[54:55], v17, v[54:55] offset:50000
    v_mad_i32_i16 v124, v56, v18, s96
    v_mad_i32_i16 v56, v56, v18, s96 op_sel:[1,0,0,0]
    v_mad_i32_i16 v125, v57, v18, s96
    v_mad_i32_i16 v57, v57, v18, s96 op_sel:[1,0,0,0]
    v_lshlrev_b32_sdwa v18, 3, v18 dst_sel:DWORD dst_unused:UNUSED_PAD src0_sel:DWORD src1_sel:WORD_1
    v_perm_b32 v56, v56, v124, s97
    v_perm_b32 v57, v57, v125, s97
    v_lshl_add_u64 v[56:57], v[56:57], 0, s[30:31]

    ds_add_rtn_u64 v[56:57], v18, v[56:57] offset:50000
    v_mad_i32_i16 v126, v58, v19, s96
    v_mad_i32_i16 v58, v58, v19, s96 op_sel:[1,0,0,0]
    v_mad_i32_i16 v127, v59, v19, s96
    v_mad_i32_i16 v59, v59, v19, s96 op_sel:[1,0,0,0]
    v_lshlrev_b32_sdwa v19, 3, v19 dst_sel:DWORD dst_unused:UNUSED_PAD src0_sel:DWORD src1_sel:WORD_1
    v_perm_b32 v58, v58, v126, s97
    v_perm_b32 v59, v59, v127, s97
    v_lshl_add_u64 v[58:59], v[58:59], 0, s[30:31]

    ds_add_rtn_u64 v[58:59], v19, v[58:59] offset:50000
    s_waitcnt lgkmcnt(4)
    v_or3_b32 v1, v44, v45, v1
    v_or3_b32 v1, v46, v47, v1
    v_or3_b32 v1, v48, v49, v1
    v_or3_b32 v1, v50, v51, v1
    v_mad_i32_i16 v120, v60, v20, s96
    v_mad_i32_i16 v60, v60, v20, s96 op_sel:[1,0,0,0]
    v_mad_i32_i16 v121, v61, v20, s96
    v_mad_i32_i16 v61, v61, v20, s96 op_sel:[1,0,0,0]
    v_lshlrev_b32_sdwa v20, 3, v20 dst_sel:DWORD dst_unused:UNUSED_PAD src0_sel:DWORD src1_sel:WORD_1
    v_perm_b32 v60, v60, v120, s97
    v_perm_b32 v61, v61, v121, s97
    v_lshl_add_u64 v[60:61], v[60:61], 0, s[30:31]

    ds_add_rtn_u64 v[60:61], v20, v[60:61] offset:50000
    v_mad_i32_i16 v122, v62, v21, s96
    v_mad_i32_i16 v62, v62, v21, s96 op_sel:[1,0,0,0]
    v_mad_i32_i16 v123, v63, v21, s96
    v_mad_i32_i16 v63, v63, v21, s96 op_sel:[1,0,0,0]
    v_lshlrev_b32_sdwa v21, 3, v21 dst_sel:DWORD dst_unused:UNUSED_PAD src0_sel:DWORD src1_sel:WORD_1
    v_perm_b32 v62, v62, v122, s97
    v_perm_b32 v63, v63, v123, s97
    v_lshl_add_u64 v[62:63], v[62:63], 0, s[30:31]

    ds_add_rtn_u64 v[62:63], v21, v[62:63] offset:50000
    v_mad_i32_i16 v124, v64, v22, s96
    v_mad_i32_i16 v64, v64, v22, s96 op_sel:[1,0,0,0]
    v_mad_i32_i16 v125, v65, v22, s96
    v_mad_i32_i16 v65, v65, v22, s96 op_sel:[1,0,0,0]
    v_lshlrev_b32_sdwa v22, 3, v22 dst_sel:DWORD dst_unused:UNUSED_PAD src0_sel:DWORD src1_sel:WORD_1
    v_perm_b32 v64, v64, v124, s97
    v_perm_b32 v65, v65, v125, s97
    v_lshl_add_u64 v[64:65], v[64:65], 0, s[30:31]

    ds_add_rtn_u64 v[64:65], v22, v[64:65] offset:50000
    v_mad_i32_i16 v126, v66, v23, s96
    v_mad_i32_i16 v66, v66, v23, s96 op_sel:[1,0,0,0]
    v_mad_i32_i16 v127, v67, v23, s96
    v_mad_i32_i16 v67, v67, v23, s96 op_sel:[1,0,0,0]
    v_lshlrev_b32_sdwa v23, 3, v23 dst_sel:DWORD dst_unused:UNUSED_PAD src0_sel:DWORD src1_sel:WORD_1
    v_perm_b32 v66, v66, v126, s97
    v_perm_b32 v67, v67, v127, s97
    v_lshl_add_u64 v[66:67], v[66:67], 0, s[30:31]

    ds_add_rtn_u64 v[66:67], v23, v[66:67] offset:50000
    s_waitcnt lgkmcnt(4)
    v_or3_b32 v1, v52, v53, v1
    v_or3_b32 v1, v54, v55, v1
    v_or3_b32 v1, v56, v57, v1
    v_or3_b32 v1, v58, v59, v1
    v_mad_i32_i16 v120, v68, v24, s96
    v_mad_i32_i16 v68, v68, v24, s96 op_sel:[1,0,0,0]
    v_mad_i32_i16 v121, v69, v24, s96
    v_mad_i32_i16 v69, v69, v24, s96 op_sel:[1,0,0,0]
    v_lshlrev_b32_sdwa v24, 3, v24 dst_sel:DWORD dst_unused:UNUSED_PAD src0_sel:DWORD src1_sel:WORD_1
    v_perm_b32 v68, v68, v120, s97
    v_perm_b32 v69, v69, v121, s97
    v_lshl_add_u64 v[68:69], v[68:69], 0, s[30:31]

    ds_add_rtn_u64 v[68:69], v24, v[68:69] offset:50000
    v_mad_i32_i16 v122, v70, v25, s96
    v_mad_i32_i16 v70, v70, v25, s96 op_sel:[1,0,0,0]
    v_mad_i32_i16 v123, v71, v25, s96
    v_mad_i32_i16 v71, v71, v25, s96 op_sel:[1,0,0,0]
    v_lshlrev_b32_sdwa v25, 3, v25 dst_sel:DWORD dst_unused:UNUSED_PAD src0_sel:DWORD src1_sel:WORD_1
    v_perm_b32 v70, v70, v122, s97
    v_perm_b32 v71, v71, v123, s97
    v_lshl_add_u64 v[70:71], v[70:71], 0, s[30:31]

    ds_add_rtn_u64 v[70:71], v25, v[70:71] offset:50000
    v_mad_i32_i16 v124, v72, v26, s96
    v_mad_i32_i16 v72, v72, v26, s96 op_sel:[1,0,0,0]
    v_mad_i32_i16 v125, v73, v26, s96
    v_mad_i32_i16 v73, v73, v26, s96 op_sel:[1,0,0,0]
    v_lshlrev_b32_sdwa v26, 3, v26 dst_sel:DWORD dst_unused:UNUSED_PAD src0_sel:DWORD src1_sel:WORD_1
    v_perm_b32 v72, v72, v124, s97
    v_perm_b32 v73, v73, v125, s97
    v_lshl_add_u64 v[72:73], v[72:73], 0, s[30:31]

    ds_add_rtn_u64 v[72:73], v26, v[72:73] offset:50000
    v_mad_i32_i16 v126, v74, v27, s96
    v_mad_i32_i16 v74, v74, v27, s96 op_sel:[1,0,0,0]
    v_mad_i32_i16 v127, v75, v27, s96
    v_mad_i32_i16 v75, v75, v27, s96 op_sel:[1,0,0,0]
    v_lshlrev_b32_sdwa v27, 3, v27 dst_sel:DWORD dst_unused:UNUSED_PAD src0_sel:DWORD src1_sel:WORD_1
    v_perm_b32 v74, v74, v126, s97
    v_perm_b32 v75, v75, v127, s97
    v_lshl_add_u64 v[74:75], v[74:75], 0, s[30:31]

    ds_add_rtn_u64 v[74:75], v27, v[74:75] offset:50000
    s_waitcnt lgkmcnt(4)
    v_or3_b32 v1, v60, v61, v1
    v_or3_b32 v1, v62, v63, v1
    v_or3_b32 v1, v64, v65, v1
    v_or3_b32 v1, v66, v67, v1
    s_waitcnt lgkmcnt(0)
    v_or3_b32 v1, v68, v69, v1
    v_or3_b32 v1, v70, v71, v1
    v_or3_b32 v1, v72, v73, v1
    v_or3_b32 v1, v74, v75, v1
    s_barrier
    s_mul_i32 s3, s37, 6400000
    s_mul_i32 s5, s36, 100000
    s_add_u32 s3, s3, s5
    s_add_u32 s3, s3, 6799360

    s_add_u32 s20, s6, s3
    s_addc_u32 s21, s7, 0
    s_mov_b32 s22, 100000
    s_mov_b32 s23, 0x20000
    v_lshlrev_b32 v68, 3, v0
    v_add_u32 v69, 50000, v68
    v_add_u32 v70, 115536, v68
    v_cmp_gt_u32 vcc, 212, v0
    v_mov_b32 v52, 0
    v_mov_b32 v53, 0

    ds_read_b64 v[28:29], v69 offset:0
    ds_read_b64 v[30:31], v69 offset:8192
    ds_read_b64 v[32:33], v69 offset:16384
    ds_read_b64 v[34:35], v69 offset:24576
    ds_read_b64 v[36:37], v69 offset:32768
    ds_read_b64 v[38:39], v69 offset:40960
    ds_read_b64 v[40:41], v69 offset:49152
    ds_read_b64 v[42:43], v69 offset:57344
    ds_read_b64 v[44:45], v70 offset:0
    ds_read_b64 v[46:47], v70 offset:8192
    ds_read_b64 v[48:49], v70 offset:16384
    ds_read_b64 v[50:51], v70 offset:24576
    s_mov_b64 exec, vcc
    ds_read_b64 v[52:53], v70 offset:32768
    s_mov_b64 exec, -1
    s_waitcnt lgkmcnt(12)
    s_mov_b32 s3, 0
    buffer_store_dwordx2 v[28:29], v68, s[20:23], s3 offen
    s_waitcnt lgkmcnt(11)
    s_mov_b32 s3, 8192
    buffer_store_dwordx2 v[30:31], v68, s[20:23], s3 offen
    s_waitcnt lgkmcnt(10)
    s_mov_b32 s3, 16384
    buffer_store_dwordx2 v[32:33], v68, s[20:23], s3 offen
    s_waitcnt lgkmcnt(9)
    s_mov_b32 s3, 24576
    buffer_store_dwordx2 v[34:35], v68, s[20:23], s3 offen
    s_waitcnt lgkmcnt(8)
    s_mov_b32 s3, 32768
    buffer_store_dwordx2 v[36:37], v68, s[20:23], s3 offen
    s_waitcnt lgkmcnt(7)
    s_mov_b32 s3, 40960
    buffer_store_dwordx2 v[38:39], v68, s[20:23], s3 offen
    s_waitcnt lgkmcnt(6)
    s_mov_b32 s3, 49152
    buffer_store_dwordx2 v[40:41], v68, s[20:23], s3 offen
    s_waitcnt lgkmcnt(5)
    s_mov_b32 s3, 57344
    buffer_store_dwordx2 v[42:43], v68, s[20:23], s3 offen
    s_waitcnt lgkmcnt(4)
    s_mov_b32 s3, 65536
    buffer_store_dwordx2 v[44:45], v68, s[20:23], s3 offen
    s_waitcnt lgkmcnt(3)
    s_mov_b32 s3, 73728
    buffer_store_dwordx2 v[46:47], v68, s[20:23], s3 offen
    s_waitcnt lgkmcnt(2)
    s_mov_b32 s3, 81920
    buffer_store_dwordx2 v[48:49], v68, s[20:23], s3 offen
    s_waitcnt lgkmcnt(1)
    s_mov_b32 s3, 90112
    buffer_store_dwordx2 v[50:51], v68, s[20:23], s3 offen
    s_waitcnt lgkmcnt(0)
    s_mov_b32 s3, 98304
    buffer_store_dwordx2 v[52:53], v68, s[20:23], s3 offen
    v_or3_b32 v1, v28, v29, v1
    v_or3_b32 v1, v30, v31, v1
    v_or3_b32 v1, v32, v33, v1
    v_or3_b32 v1, v34, v35, v1
    v_or3_b32 v1, v36, v37, v1
    v_or3_b32 v1, v38, v39, v1
    v_or3_b32 v1, v40, v41, v1
    v_or3_b32 v1, v42, v43, v1
    v_or3_b32 v1, v44, v45, v1
    v_or3_b32 v1, v46, v47, v1
    v_or3_b32 v1, v48, v49, v1
    v_or3_b32 v1, v50, v51, v1
    v_or3_b32 v1, v52, v53, v1
    v_and_b32 v1, 0x80008000, v1
    v_cmp_ne_u32 vcc, 0, v1
    v_mov_b32 v71, 150024
    v_mov_b32 v72, 1
    s_cbranch_vccz L_nf_85
    ds_write_b32 v71, v72
L_nf_85:
    s_waitcnt lgkmcnt(0)
    s_barrier
    ds_read_b32 v72, v71
    s_waitcnt lgkmcnt(0)
    v_readfirstlane_b32 s3, v72
    s_nop 1
    s_cmp_lg_u32 s3, 0
    s_cbranch_scc1 L_p2slow_51

L_fin_86:
    s_add_u32 s20, s6, 147456
    s_addc_u32 s21, s7, 0
    s_mov_b32 s22, 1024
    s_mov_b32 s23, 0x20000
    s_lshl_b32 s3, s36, 2
    s_add_u32 s3, s3, s37
    s_lshl_b32 s3, s3, 2
    v_lshlrev_b32 v73, 20, v0
    v_mov_b32 v74, s34
    buffer_store_dword v74, v73, s[20:23], s3 offen

L_p2done_50:
    s_endpgm

L_ufix_52:
    v_and_b32 v117, 63, v0
    v_lshlrev_b32 v117, 2, v117
    s_sub_i32 s54, s42, 1024
    v_cmp_le_i32 vcc, s54, v117
    s_mov_b64 exec, vcc
    v_mov_b32 v12, 0
    v_mov_b32 v44, 0
    s_mov_b64 exec, -1
    s_sub_i32 s54, s42, 1025
    v_cmp_le_i32 vcc, s54, v117
    s_mov_b64 exec, vcc
    v_mov_b32 v13, 0
    v_mov_b32 v46, 0
    s_mov_b64 exec, -1
    s_sub_i32 s54, s42, 1026
    v_cmp_le_i32 vcc, s54, v117
    s_mov_b64 exec, vcc
    v_mov_b32 v14, 0
    v_mov_b32 v48, 0
    s_mov_b64 exec, -1
    s_sub_i32 s54, s42, 1027
    v_cmp_le_i32 vcc, s54, v117
    s_mov_b64 exec, vcc
    v_mov_b32 v15, 0
    v_mov_b32 v50, 0
    s_mov_b64 exec, -1
    s_branch L_uback_53
L_ufix_54:
    v_and_b32 v117, 63, v0
    v_lshlrev_b32 v117, 2, v117
    s_sub_i32 s54, s42, 1536
    v_cmp_le_i32 vcc, s54, v117
    s_mov_b64 exec, vcc
    v_mov_b32 v16, 0
    v_mov_b32 v52, 0
    s_mov_b64 exec, -1
    s_sub_i32 s54, s42, 1537
    v_cmp_le_i32 vcc, s54, v117
    s_mov_b64 exec, vcc
    v_mov_b32 v17, 0
    v_mov_b32 v54, 0
    s_mov_b64 exec, -1
    s_sub_i32 s54, s42, 1538
    v_cmp_le_i32 vcc, s54, v117
    s_mov_b64 exec, vcc
    v_mov_b32 v18, 0
    v_mov_b32 v56, 0
    s_mov_b64 exec, -1
    s_sub_i32 s54, s42, 1539
    v_cmp_le_i32 vcc, s54, v117
    s_mov_b64 exec, vcc
    v_mov_b32 v19, 0
    v_mov_b32 v58, 0
    s_mov_b64 exec, -1
    s_branch L_uback_55
L_ufix_56:
    v_and_b32 v117, 63, v0
    v_lshlrev_b32 v117, 2, v117
    s_sub_i32 s54, s42, 2048
    v_cmp_le_i32 vcc, s54, v117
    s_mov_b64 exec, vcc
    v_mov_b32 v20, 0
    v_mov_b32 v60, 0
    s_mov_b64 exec, -1
    s_sub_i32 s54, s42, 2049
    v_cmp_le_i32 vcc, s54, v117
    s_mov_b64 exec, vcc
    v_mov_b32 v21, 0
    v_mov_b32 v62, 0
    s_mov_b64 exec, -1
    s_sub_i32 s54, s42, 2050
    v_cmp_le_i32 vcc, s54, v117
    s_mov_b64 exec, vcc
    v_mov_b32 v22, 0
    v_mov_b32 v64, 0
    s_mov_b64 exec, -1
    s_sub_i32 s54, s42, 2051
    v_cmp_le_i32 vcc, s54, v117
    s_mov_b64 exec, vcc
    v_mov_b32 v23, 0
    v_mov_b32 v66, 0
    s_mov_b64 exec, -1
    s_branch L_uback_57
L_ufix_58:
    v_and_b32 v117, 63, v0
    v_lshlrev_b32 v117, 2, v117
    s_sub_i32 s54, s42, 2560
    v_cmp_le_i32 vcc, s54, v117
    s_mov_b64 exec, vcc
    v_mov_b32 v24, 0
    v_mov_b32 v68, 0
    s_mov_b64 exec, -1
    s_sub_i32 s54, s42, 2561
    v_cmp_le_i32 vcc, s54, v117
    s_mov_b64 exec, vcc
    v_mov_b32 v25, 0
    v_mov_b32 v70, 0
    s_mov_b64 exec, -1
    s_sub_i32 s54, s42, 2562
    v_cmp_le_i32 vcc, s54, v117
    s_mov_b64 exec, vcc
    v_mov_b32 v26, 0
    v_mov_b32 v72, 0
    s_mov_b64 exec, -1
    s_sub_i32 s54, s42, 2563
    v_cmp_le_i32 vcc, s54, v117
    s_mov_b64 exec, vcc
    v_mov_b32 v27, 0
    v_mov_b32 v74, 0
    s_mov_b64 exec, -1
    s_branch L_uback_59
L_ufix_60:
    v_and_b32 v117, 63, v0
    v_lshlrev_b32 v117, 2, v117
    s_sub_i32 s54, s42, 0
    v_cmp_le_i32 vcc, s54, v117
    s_mov_b64 exec, vcc
    v_mov_b32 v4, 0
    v_mov_b32 v28, 0
    s_mov_b64 exec, -1
    s_sub_i32 s54, s42, 1
    v_cmp_le_i32 vcc, s54, v117
    s_mov_b64 exec, vcc
    v_mov_b32 v5, 0
    v_mov_b32 v30, 0
    s_mov_b64 exec, -1
    s_sub_i32 s54, s42, 2
    v_cmp_le_i32 vcc, s54, v117
    s_mov_b64 exec, vcc
    v_mov_b32 v6, 0
    v_mov_b32 v32, 0
    s_mov_b64 exec, -1
    s_sub_i32 s54, s42, 3
    v_cmp_le_i32 vcc, s54, v117
    s_mov_b64 exec, vcc
    v_mov_b32 v7, 0
    v_mov_b32 v34, 0
    s_mov_b64 exec, -1
    s_branch L_uback_61
L_ufix_62:
    v_and_b32 v117, 63, v0
    v_lshlrev_b32 v117, 2, v117
    s_sub_i32 s54, s42, 512
    v_cmp_le_i32 vcc, s54, v117
    s_mov_b64 exec, vcc
    v_mov_b32 v8, 0
    v_mov_b32 v36, 0
    s_mov_b64 exec, -1
    s_sub_i32 s54, s42, 513
    v_cmp_le_i32 vcc, s54, v117
    s_mov_b64 exec, vcc
    v_mov_b32 v9, 0
    v_mov_b32 v38, 0
    s_mov_b64 exec, -1
    s_sub_i32 s54, s42, 514
    v_cmp_le_i32 vcc, s54, v117
    s_mov_b64 exec, vcc
    v_mov_b32 v10, 0
    v_mov_b32 v40, 0
    s_mov_b64 exec, -1
    s_sub_i32 s54, s42, 515
    v_cmp_le_i32 vcc, s54, v117
    s_mov_b64 exec, vcc
    v_mov_b32 v11, 0
    v_mov_b32 v42, 0
    s_mov_b64 exec, -1
    s_branch L_uback_63
L_ufix_69:
    v_and_b32 v117, 63, v0
    v_lshlrev_b32 v117, 2, v117
    s_sub_i32 s54, s42, 3072
    v_cmp_le_i32 vcc, s54, v117
    s_mov_b64 exec, vcc
    v_mov_b32 v106, 0
    v_mov_b32 v120, 0
    s_mov_b64 exec, -1
    s_sub_i32 s54, s42, 3073
    v_cmp_le_i32 vcc, s54, v117
    s_mov_b64 exec, vcc
    v_mov_b32 v107, 0
    v_mov_b32 v122, 0
    s_mov_b64 exec, -1
    s_sub_i32 s54, s42, 3074
    v_cmp_le_i32 vcc, s54, v117
    s_mov_b64 exec, vcc
    v_mov_b32 v108, 0
    v_mov_b32 v124, 0
    s_mov_b64 exec, -1
    s_sub_i32 s54, s42, 3075
    v_cmp_le_i32 vcc, s54, v117
    s_mov_b64 exec, vcc
    v_mov_b32 v109, 0
    v_mov_b32 v126, 0
    s_mov_b64 exec, -1
    s_branch L_uback_70
L_ufix_73:
    v_and_b32 v117, 63, v0
    v_lshlrev_b32 v117, 2, v117
    s_sub_i32 s54, s42, 1024
    v_cmp_le_i32 vcc, s54, v117
    s_mov_b64 exec, vcc
    v_mov_b32 v12, 0
    v_mov_b32 v44, 0
    s_mov_b64 exec, -1
    s_sub_i32 s54, s42, 1025
    v_cmp_le_i32 vcc, s54, v117
    s_mov_b64 exec, vcc
    v_mov_b32 v13, 0
    v_mov_b32 v46, 0
    s_mov_b64 exec, -1
    s_sub_i32 s54, s42, 1026
    v_cmp_le_i32 vcc, s54, v117
    s_mov_b64 exec, vcc
    v_mov_b32 v14, 0
    v_mov_b32 v48, 0
    s_mov_b64 exec, -1
    s_sub_i32 s54, s42, 1027
    v_cmp_le_i32 vcc, s54, v117
    s_mov_b64 exec, vcc
    v_mov_b32 v15, 0
    v_mov_b32 v50, 0
    s_mov_b64 exec, -1
    s_branch L_uback_74
L_ufix_75:
    v_and_b32 v117, 63, v0
    v_lshlrev_b32 v117, 2, v117
    s_sub_i32 s54, s42, 1536
    v_cmp_le_i32 vcc, s54, v117
    s_mov_b64 exec, vcc
    v_mov_b32 v16, 0
    v_mov_b32 v52, 0
    s_mov_b64 exec, -1
    s_sub_i32 s54, s42, 1537
    v_cmp_le_i32 vcc, s54, v117
    s_mov_b64 exec, vcc
    v_mov_b32 v17, 0
    v_mov_b32 v54, 0
    s_mov_b64 exec, -1
    s_sub_i32 s54, s42, 1538
    v_cmp_le_i32 vcc, s54, v117
    s_mov_b64 exec, vcc
    v_mov_b32 v18, 0
    v_mov_b32 v56, 0
    s_mov_b64 exec, -1
    s_sub_i32 s54, s42, 1539
    v_cmp_le_i32 vcc, s54, v117
    s_mov_b64 exec, vcc
    v_mov_b32 v19, 0
    v_mov_b32 v58, 0
    s_mov_b64 exec, -1
    s_branch L_uback_76
L_ufix_77:
    v_and_b32 v117, 63, v0
    v_lshlrev_b32 v117, 2, v117
    s_sub_i32 s54, s42, 2048
    v_cmp_le_i32 vcc, s54, v117
    s_mov_b64 exec, vcc
    v_mov_b32 v20, 0
    v_mov_b32 v60, 0
    s_mov_b64 exec, -1
    s_sub_i32 s54, s42, 2049
    v_cmp_le_i32 vcc, s54, v117
    s_mov_b64 exec, vcc
    v_mov_b32 v21, 0
    v_mov_b32 v62, 0
    s_mov_b64 exec, -1
    s_sub_i32 s54, s42, 2050
    v_cmp_le_i32 vcc, s54, v117
    s_mov_b64 exec, vcc
    v_mov_b32 v22, 0
    v_mov_b32 v64, 0
    s_mov_b64 exec, -1
    s_sub_i32 s54, s42, 2051
    v_cmp_le_i32 vcc, s54, v117
    s_mov_b64 exec, vcc
    v_mov_b32 v23, 0
    v_mov_b32 v66, 0
    s_mov_b64 exec, -1
    s_branch L_uback_78
L_ufix_79:
    v_and_b32 v117, 63, v0
    v_lshlrev_b32 v117, 2, v117
    s_sub_i32 s54, s42, 2560
    v_cmp_le_i32 vcc, s54, v117
    s_mov_b64 exec, vcc
    v_mov_b32 v24, 0
    v_mov_b32 v68, 0
    s_mov_b64 exec, -1
    s_sub_i32 s54, s42, 2561
    v_cmp_le_i32 vcc, s54, v117
    s_mov_b64 exec, vcc
    v_mov_b32 v25, 0
    v_mov_b32 v70, 0
    s_mov_b64 exec, -1
    s_sub_i32 s54, s42, 2562
    v_cmp_le_i32 vcc, s54, v117
    s_mov_b64 exec, vcc
    v_mov_b32 v26, 0
    v_mov_b32 v72, 0
    s_mov_b64 exec, -1
    s_sub_i32 s54, s42, 2563
    v_cmp_le_i32 vcc, s54, v117
    s_mov_b64 exec, vcc
    v_mov_b32 v27, 0
    v_mov_b32 v74, 0
    s_mov_b64 exec, -1
    s_branch L_uback_80
L_ufix_81:
    v_and_b32 v117, 63, v0
    v_lshlrev_b32 v117, 2, v117
    s_sub_i32 s54, s42, 0
    v_cmp_le_i32 vcc, s54, v117
    s_mov_b64 exec, vcc
    v_mov_b32 v4, 0
    v_mov_b32 v28, 0
    s_mov_b64 exec, -1
    s_sub_i32 s54, s42, 1
    v_cmp_le_i32 vcc, s54, v117
    s_mov_b64 exec, vcc
    v_mov_b32 v5, 0
    v_mov_b32 v30, 0
    s_mov_b64 exec, -1
    s_sub_i32 s54, s42, 2
    v_cmp_le_i32 vcc, s54, v117
    s_mov_b64 exec, vcc
    v_mov_b32 v6, 0
    v_mov_b32 v32, 0
    s_mov_b64 exec, -1
    s_sub_i32 s54, s42, 3
    v_cmp_le_i32 vcc, s54, v117
    s_mov_b64 exec, vcc
    v_mov_b32 v7, 0
    v_mov_b32 v34, 0
    s_mov_b64 exec, -1
    s_branch L_uback_82
L_ufix_83:
    v_and_b32 v117, 63, v0
    v_lshlrev_b32 v117, 2, v117
    s_sub_i32 s54, s42, 512
    v_cmp_le_i32 vcc, s54, v117
    s_mov_b64 exec, vcc
    v_mov_b32 v8, 0
    v_mov_b32 v36, 0
    s_mov_b64 exec, -1
    s_sub_i32 s54, s42, 513
    v_cmp_le_i32 vcc, s54, v117
    s_mov_b64 exec, vcc
    v_mov_b32 v9, 0
    v_mov_b32 v38, 0
    s_mov_b64 exec, -1
    s_sub_i32 s54, s42, 514
    v_cmp_le_i32 vcc, s54, v117
    s_mov_b64 exec, vcc
    v_mov_b32 v10, 0
    v_mov_b32 v40, 0
    s_mov_b64 exec, -1
    s_sub_i32 s54, s42, 515
    v_cmp_le_i32 vcc, s54, v117
    s_mov_b64 exec, vcc
    v_mov_b32 v11, 0
    v_mov_b32 v42, 0
    s_mov_b64 exec, -1
    s_branch L_uback_84
L_p2slow_51:
    s_waitcnt vmcnt(0) lgkmcnt(0)
    s_mov_b32 s51, 0
    s_movk_i32 s43, 6250
    s_mov_b32 s34, 0
L_sweep_87:
    s_barrier

    v_mov_b32 v28, 0x0
    v_mov_b32 v29, 0x0
    v_mov_b32 v30, 0x0
    v_mov_b32 v31, 0x0
    v_add_u32 v32, 50000, v3
    v_add_u32 v33, 65536, v32

    ds_write_b128 v32, v[28:31] offset:0
    ds_write_b128 v32, v[28:31] offset:16384
    ds_write_b128 v32, v[28:31] offset:32768
    ds_write_b128 v32, v[28:31] offset:49152
    ds_write_b128 v33, v[28:31] offset:0
    ds_write_b128 v33, v[28:31] offset:16384
    v_cmp_gt_u32 vcc, 971, v0
    s_mov_b64 exec, vcc
    ds_write_b128 v33, v[28:31] offset:32768
    s_mov_b64 exec, -1
    s_waitcnt lgkmcnt(0)
    s_barrier
    s_sub_u32 s38, s4, 8
L_sbatch_88:
    s_lshl_b32 s52, s38, 6
    s_add_u32 s52, s52, s36
    s_lshl_b32 s52, s52, 2
    s_load_dword s40, s[46:47], s52
    s_mul_i32 s50, s38, 200000
    s_waitcnt lgkmcnt(0)

    s_min_u32 s40, s40, 3968
    s_lshl_b32 s52, s38, 6
    s_add_u32 s52, s52, s36
    s_mul_i32 s52, s52, 19840
    s_add_u32 s20, s44, s52
    s_addc_u32 s21, s45, 0
    s_mul_i32 s52, s40, 5
    s_add_u32 s52, s52, 3
    s_and_b32 s22, s52, -4

    s_lshr_b32 s55, s39, 2
    s_add_u32 s55, s55, 0
    v_and_b32 v36, 63, v0
    v_add_u32 v36, s55, v36
L_left_92:
    s_cmp_ge_u32 s55, s40
    s_cbranch_scc1 L_leftend_93
    v_mul_u32_u24 v37, 5, v36
    buffer_load_dword v38, v37, s[20:23], 0 offen
    buffer_load_ubyte v39, v37, s[20:23], 0 offen offset:4
    s_waitcnt vmcnt(0)

    v_perm_b32 v37, v39, v38, s24
    v_lshrrev_b32 v42, 30, v38
    v_and_b32 v37, 0x1fff, v37
    v_mul_u32_u24 v42, 6250, v42
    v_add_lshl_u32 v37, v37, v42, 3

    buffer_load_dwordx2 v[40:41], v37, s[8:11], s50 offen
    v_cmp_gt_u32 vcc, s40, v36
    s_waitcnt vmcnt(0)

    v_bfe_u32 v44, v38, 16, 14
    v_subrev_u32 v44, s51, v44
    v_cmp_gt_u32 s[64:65], s43, v44
    s_and_b64 exec, vcc, s[64:65]
    v_lshlrev_b32 v45, 8, v38
    v_cmpx_ne_u32 vcc, 0, v45
    v_lshlrev_b32 v44, 4, v44
    v_bfe_i32 v38, v38, 0, 16
    v_cvt_f32_i32 v38, v38
    v_mul_f32 v38, 0x38004020, v38
    v_lshlrev_b32 v45, 16, v40
    v_and_b32 v46, s32, v40
    v_lshlrev_b32 v47, 16, v41
    v_and_b32 v48, s32, v41

    v_mul_f32 v45, v45, v38
    ds_add_f32 v44, v45 offset:50000
    v_mul_f32 v46, v46, v38
    ds_add_f32 v44, v46 offset:50004
    v_mul_f32 v47, v47, v38
    ds_add_f32 v44, v47 offset:50008
    v_mul_f32 v48, v48, v38
    ds_add_f32 v44, v48 offset:50012
    s_mov_b64 exec, -1
    v_add_u32 v36, 128, v36
    s_add_u32 s55, s55, 128
    s_branch L_left_92
L_leftend_93:

    s_add_u32 s38, s38, 1
    s_cmp_lt_u32 s38, s4
    s_cbranch_scc1 L_sbatch_88
    s_mov_b32 s3, 65536
    s_load_dword s40, s[6:7], s3

    s_add_u32 s20, s6, 408657920
    s_addc_u32 s21, s7, 0
    s_mov_b32 s22, 409600000
    s_mov_b32 s23, 0x20000
    s_mov_b32 s38, 0
    s_mov_b32 s50, 200000
    v_mov_b32 v36, v0
    s_waitcnt lgkmcnt(0)
L_ovf_89:
    s_cmp_ge_u32 s38, s40
    s_cbranch_scc1 L_ovfend_90
    v_lshlrev_b32 v37, 3, v36
    buffer_load_dwordx2 v[38:39], v37, s[20:23], 0 offen
    s_waitcnt vmcnt(0)

    v_perm_b32 v37, v39, v38, s24
    v_lshrrev_b32 v42, 30, v38
    v_and_b32 v37, 0x1fff, v37
    v_mul_u32_u24 v42, 6250, v42
    v_add_lshl_u32 v37, v37, v42, 3

    v_bfe_u32 v42, v39, 24, 5
    v_mad_u32_u24 v37, v42, s50, v37
    buffer_load_dwordx2 v[40:41], v37, s[8:11], 0 offen
    v_lshrrev_b32 v42, 3, v42
    v_bfe_u32 v43, v39, 18, 6
    v_cmp_gt_u32 vcc, s40, v36
    v_cmp_eq_u32 s[64:65], s36, v43
    s_and_b64 vcc, vcc, s[64:65]
    v_cmp_eq_u32 s[64:65], s37, v42
    s_and_b64 vcc, vcc, s[64:65]
    s_waitcnt vmcnt(0)

    v_bfe_u32 v44, v38, 16, 14
    v_subrev_u32 v44, s51, v44
    v_cmp_gt_u32 s[64:65], s43, v44
    s_and_b64 exec, vcc, s[64:65]
    v_lshlrev_b32 v45, 8, v38
    v_cmpx_ne_u32 vcc, 0, v45
    v_lshlrev_b32 v44, 4, v44
    v_bfe_i32 v38, v38, 0, 16
    v_cvt_f32_i32 v38, v38
    v_mul_f32 v38, 0x38004020, v38
    v_lshlrev_b32 v45, 16, v40
    v_and_b32 v46, s32, v40
    v_lshlrev_b32 v47, 16, v41
    v_and_b32 v48, s32, v41

    v_mul_f32 v45, v45, v38
    ds_add_f32 v44, v45 offset:50000
    v_mul_f32 v46, v46, v38
    ds_add_f32 v44, v46 offset:50004
    v_mul_f32 v47, v47, v38
    ds_add_f32 v44, v47 offset:50008
    v_mul_f32 v48, v48, v38
    ds_add_f32 v44, v48 offset:50012
    s_mov_b64 exec, -1
    v_add_u32 v36, 1024, v36
    s_add_u32 s38, s38, 1024
    s_branch L_ovf_89
L_ovfend_90:
    s_waitcnt lgkmcnt(0)
    s_barrier
    s_mul_i32 s3, s37, 800000
    s_mul_i32 s5, s36, 12500
    s_add_u32 s3, s3, s5
    s_add_u32 s3, s3, s51
    s_lshl_b32 s3, s3, 4
    s_add_u32 s3, s3, 32399360

    s_add_u32 s20, s6, s3
    s_addc_u32 s21, s7, 0
    s_mov_b32 s22, 100000
    s_mov_b32 s23, 0x20000
    v_mov_b32 v36, v3
    s_mov_b32 s38, 0
L_wl_91:
    v_min_u32 v37, 100000, v36
    ds_read_b128 v[28:31], v37 offset:50000
    s_waitcnt lgkmcnt(0)
    buffer_store_dwordx4 v[28:31], v36, s[20:23], 0 offen
    s_waitcnt vmcnt(0)
    v_add_u32 v36, 16384, v36
    s_add_u32 s38, s38, 1024
    s_cmp_lt_u32 s38, 6250
    s_cbranch_scc1 L_wl_91
    s_add_u32 s51, s51, 6250
    s_cmp_lt_u32 s51, 12500
    s_cbranch_scc1 L_sweep_87
    s_branch L_fin_86

.globl standalone__molecular_angular_gemnet__graph_kernel
.p2align 8
.type standalone__molecular_angular_gemnet__graph_kernel,@function
standalone__molecular_angular_gemnet__graph_kernel:
    s_cmp_ge_u32 s2, 3200
    s_cbranch_scc1 L_fdone_94
    s_load_dwordx2 s[4:5], s[0:1], 0
    s_load_dwordx2 s[6:7], s[0:1], 24
    s_load_dwordx2 s[8:9], s[0:1], 40
    s_load_dwordx8 s[12:19], s[0:1], 56
    s_load_dwordx2 s[10:11], s[0:1], 88
    s_load_dwordx2 s[20:21], s[0:1], 104
    v_cmp_gt_u32 vcc, 250, v0
    s_mul_i32 s3, s2, 250
    v_add_u32 v0, s3, v0
    v_lshlrev_b32 v1, 4, v0
    v_lshlrev_b32 v2, 3, v0
    v_lshlrev_b32 v3, 1, v0
    s_mov_b64 exec, vcc
    s_mul_hi_u32 s3, s2, 85899346
    s_lshl_b32 s3, s3, 4
    s_add_u32 s3, s3, 147456
    s_waitcnt lgkmcnt(0)
    s_load_dwordx4 s[96:99], s[20:21], s3
    s_load_dwordx4 s[40:43], s[8:9], 0
    s_load_dwordx16 s[44:59], s[12:13], 0
    s_load_dwordx16 s[60:75], s[14:15], 0
    s_load_dwordx8 s[76:83], s[16:17], 0
    s_load_dwordx8 s[84:91], s[18:19], 0

    s_add_u32 s24, s20, 6799360
    s_addc_u32 s25, s21, 0
    s_mov_b32 s26, 76800000
    s_mov_b32 s27, 0x20000
    s_mov_b32 s28, s4
    s_mov_b32 s29, s5
    s_mov_b32 s30, 6400000
    s_mov_b32 s31, 0x20000
    s_mov_b32 s32, s6
    s_mov_b32 s33, s7
    s_mov_b32 s34, 1600000
    s_mov_b32 s35, 0x20000
    s_mov_b32 s36, s10
    s_mov_b32 s37, s11
    s_mov_b32 s38, 6400000
    s_mov_b32 s39, 0x20000
    buffer_load_ushort v4, v3, s[32:35], 0 offen
    buffer_load_dwordx2 v[32:33], v2, s[24:27], 0 offen
    s_mov_b32 s3, 6400000
    buffer_load_dwordx2 v[34:35], v2, s[24:27], s3 offen
    s_mov_b32 s3, 12800000
    buffer_load_dwordx2 v[36:37], v2, s[24:27], s3 offen
    s_mov_b32 s3, 19200000
    buffer_load_dwordx2 v[38:39], v2, s[24:27], s3 offen
    buffer_load_dwordx2 v[6:7], v2, s[28:31], 0 offen
    s_mov_b32 s94, 0xffff0000
    s_mov_b32 s95, 0xc1200000
    s_mov_b32 s22, 0x3fb8aa3b
    s_waitcnt vmcnt(5) lgkmcnt(0)
    v_lshlrev_b32 v4, 16, v4

    s_lshl_b32 s92, s40, 16
    v_subrev_f32 v16, s92, v4
    s_and_b32 s93, s40, s94
    v_subrev_f32 v17, s93, v4
    s_lshl_b32 s92, s41, 16
    v_subrev_f32 v18, s92, v4
    s_and_b32 s93, s41, s94
    v_subrev_f32 v19, s93, v4
    s_lshl_b32 s92, s42, 16
    v_subrev_f32 v20, s92, v4
    s_and_b32 s93, s42, s94
    v_subrev_f32 v21, s93, v4
    s_lshl_b32 s92, s43, 16
    v_subrev_f32 v22, s92, v4
    s_and_b32 s93, s43, s94
    v_subrev_f32 v23, s93, v4
    v_cvt_pk_bf16_f32 v16, v16, v17
    v_and_b32 v17, s94, v16
    v_lshlrev_b32 v16, 16, v16
    v_cvt_pk_bf16_f32 v18, v18, v19
    v_and_b32 v19, s94, v18
    v_lshlrev_b32 v18, 16, v18
    v_cvt_pk_bf16_f32 v20, v20, v21
    v_and_b32 v21, s94, v20
    v_lshlrev_b32 v20, 16, v20
    v_cvt_pk_bf16_f32 v22, v22, v23
    v_and_b32 v23, s94, v22
    v_lshlrev_b32 v22, 16, v22
    v_mul_f32 v16, v16, v16
    v_mul_f32 v17, v17, v17
    v_mul_f32 v18, v18, v18
    v_mul_f32 v19, v19, v19
    v_mul_f32 v20, v20, v20
    v_mul_f32 v21, v21, v21
    v_mul_f32 v22, v22, v22
    v_mul_f32 v23, v23, v23
    v_cvt_pk_bf16_f32 v16, v16, v17
    v_and_b32 v17, s94, v16
    v_lshlrev_b32 v16, 16, v16
    v_cvt_pk_bf16_f32 v18, v18, v19
    v_and_b32 v19, s94, v18
    v_lshlrev_b32 v18, 16, v18
    v_cvt_pk_bf16_f32 v20, v20, v21
    v_and_b32 v21, s94, v20
    v_lshlrev_b32 v20, 16, v20
    v_cvt_pk_bf16_f32 v22, v22, v23
    v_and_b32 v23, s94, v22
    v_lshlrev_b32 v22, 16, v22
    v_mul_f32 v16, s95, v16
    v_mul_f32 v17, s95, v17
    v_mul_f32 v18, s95, v18
    v_mul_f32 v19, s95, v19
    v_mul_f32 v20, s95, v20
    v_mul_f32 v21, s95, v21
    v_mul_f32 v22, s95, v22
    v_mul_f32 v23, s95, v23
    v_cvt_pk_bf16_f32 v16, v16, v17
    v_and_b32 v17, s94, v16
    v_lshlrev_b32 v16, 16, v16
    v_cvt_pk_bf16_f32 v18, v18, v19
    v_and_b32 v19, s94, v18
    v_lshlrev_b32 v18, 16, v18
    v_cvt_pk_bf16_f32 v20, v20, v21
    v_and_b32 v21, s94, v20
    v_lshlrev_b32 v20, 16, v20
    v_cvt_pk_bf16_f32 v22, v22, v23
    v_and_b32 v23, s94, v22
    v_lshlrev_b32 v22, 16, v22
    v_mul_f32 v16, s22, v16
    v_mul_f32 v17, s22, v17
    v_mul_f32 v18, s22, v18
    v_mul_f32 v19, s22, v19
    v_mul_f32 v20, s22, v20
    v_mul_f32 v21, s22, v21
    v_mul_f32 v22, s22, v22
    v_mul_f32 v23, s22, v23
    v_exp_f32 v16, v16
    v_exp_f32 v17, v17
    v_exp_f32 v18, v18
    v_exp_f32 v19, v19
    v_exp_f32 v20, v20
    v_exp_f32 v21, v21
    v_exp_f32 v22, v22
    v_exp_f32 v23, v23
    s_nop 0
    v_cvt_pk_bf16_f32 v16, v16, v17
    v_and_b32 v17, s94, v16
    v_lshlrev_b32 v16, 16, v16
    v_cvt_pk_bf16_f32 v18, v18, v19
    v_and_b32 v19, s94, v18
    v_lshlrev_b32 v18, 16, v18
    v_cvt_pk_bf16_f32 v20, v20, v21
    v_and_b32 v21, s94, v20
    v_lshlrev_b32 v20, 16, v20
    v_cvt_pk_bf16_f32 v22, v22, v23
    v_and_b32 v23, s94, v22
    v_lshlrev_b32 v22, 16, v22
    s_lshl_b32 s92, s60, 16
    v_mul_f32 v24, s92, v16
    s_and_b32 s93, s60, s94
    v_mul_f32 v25, s93, v16
    s_lshl_b32 s92, s61, 16
    v_mul_f32 v26, s92, v16
    s_and_b32 s93, s61, s94
    v_mul_f32 v27, s93, v16
    s_lshl_b32 s92, s62, 16
    v_fmac_f32 v24, s92, v17
    s_and_b32 s93, s62, s94
    v_fmac_f32 v25, s93, v17
    s_lshl_b32 s92, s63, 16
    v_fmac_f32 v26, s92, v17
    s_and_b32 s93, s63, s94
    v_fmac_f32 v27, s93, v17
    s_lshl_b32 s92, s64, 16
    v_fmac_f32 v24, s92, v18
    s_and_b32 s93, s64, s94
    v_fmac_f32 v25, s93, v18
    s_lshl_b32 s92, s65, 16
    v_fmac_f32 v26, s92, v18
    s_and_b32 s93, s65, s94
    v_fmac_f32 v27, s93, v18
    s_lshl_b32 s92, s66, 16
    v_fmac_f32 v24, s92, v19
    s_and_b32 s93, s66, s94
    v_fmac_f32 v25, s93, v19
    s_lshl_b32 s92, s67, 16
    v_fmac_f32 v26, s92, v19
    s_and_b32 s93, s67, s94
    v_fmac_f32 v27, s93, v19
    s_lshl_b32 s92, s68, 16
    v_fmac_f32 v24, s92, v20
    s_and_b32 s93, s68, s94
    v_fmac_f32 v25, s93, v20
    s_lshl_b32 s92, s69, 16
    v_fmac_f32 v26, s92, v20
    s_and_b32 s93, s69, s94
    v_fmac_f32 v27, s93, v20
    s_lshl_b32 s92, s70, 16
    v_fmac_f32 v24, s92, v21
    s_and_b32 s93, s70, s94
    v_fmac_f32 v25, s93, v21
    s_lshl_b32 s92, s71, 16
    v_fmac_f32 v26, s92, v21
    s_and_b32 s93, s71, s94
    v_fmac_f32 v27, s93, v21
    s_lshl_b32 s92, s72, 16
    v_fmac_f32 v24, s92, v22
    s_and_b32 s93, s72, s94
    v_fmac_f32 v25, s93, v22
    s_lshl_b32 s92, s73, 16
    v_fmac_f32 v26, s92, v22
    s_and_b32 s93, s73, s94
    v_fmac_f32 v27, s93, v22
    s_lshl_b32 s92, s74, 16
    v_fmac_f32 v24, s92, v23
    s_and_b32 s93, s74, s94
    v_fmac_f32 v25, s93, v23
    s_lshl_b32 s92, s75, 16
    v_fmac_f32 v26, s92, v23
    s_and_b32 s93, s75, s94
    v_fmac_f32 v27, s93, v23
    s_lshl_b32 s92, s44, 16
    v_mul_f32 v28, s92, v16
    s_and_b32 s93, s44, s94
    v_mul_f32 v29, s93, v16
    s_lshl_b32 s92, s45, 16
    v_mul_f32 v30, s92, v16
    s_and_b32 s93, s45, s94
    v_mul_f32 v31, s93, v16
    s_lshl_b32 s92, s46, 16
    v_fmac_f32 v28, s92, v17
    s_and_b32 s93, s46, s94
    v_fmac_f32 v29, s93, v17
    s_lshl_b32 s92, s47, 16
    v_fmac_f32 v30, s92, v17
    s_and_b32 s93, s47, s94
    v_fmac_f32 v31, s93, v17
    s_lshl_b32 s92, s48, 16
    v_fmac_f32 v28, s92, v18
    s_and_b32 s93, s48, s94
    v_fmac_f32 v29, s93, v18
    s_lshl_b32 s92, s49, 16
    v_fmac_f32 v30, s92, v18
    s_and_b32 s93, s49, s94
    v_fmac_f32 v31, s93, v18
    s_lshl_b32 s92, s50, 16
    v_fmac_f32 v28, s92, v19
    s_and_b32 s93, s50, s94
    v_fmac_f32 v29, s93, v19
    s_lshl_b32 s92, s51, 16
    v_fmac_f32 v30, s92, v19
    s_and_b32 s93, s51, s94
    v_fmac_f32 v31, s93, v19
    s_lshl_b32 s92, s52, 16
    v_fmac_f32 v28, s92, v20
    s_and_b32 s93, s52, s94
    v_fmac_f32 v29, s93, v20
    s_lshl_b32 s92, s53, 16
    v_fmac_f32 v30, s92, v20
    s_and_b32 s93, s53, s94
    v_fmac_f32 v31, s93, v20
    s_lshl_b32 s92, s54, 16
    v_fmac_f32 v28, s92, v21
    s_and_b32 s93, s54, s94
    v_fmac_f32 v29, s93, v21
    s_lshl_b32 s92, s55, 16
    v_fmac_f32 v30, s92, v21
    s_and_b32 s93, s55, s94
    v_fmac_f32 v31, s93, v21
    s_lshl_b32 s92, s56, 16
    v_fmac_f32 v28, s92, v22
    s_and_b32 s93, s56, s94
    v_fmac_f32 v29, s93, v22
    s_lshl_b32 s92, s57, 16
    v_fmac_f32 v30, s92, v22
    s_and_b32 s93, s57, s94
    v_fmac_f32 v31, s93, v22
    s_lshl_b32 s92, s58, 16
    v_fmac_f32 v28, s92, v23
    s_and_b32 s93, s58, s94
    v_fmac_f32 v29, s93, v23
    s_lshl_b32 s92, s59, 16
    v_fmac_f32 v30, s92, v23
    s_and_b32 s93, s59, s94
    v_fmac_f32 v31, s93, v23
    v_cvt_pk_bf16_f32 v28, v28, v29
    v_and_b32 v29, s94, v28
    v_lshlrev_b32 v28, 16, v28
    v_cvt_pk_bf16_f32 v30, v30, v31
    v_and_b32 v31, s94, v30
    v_lshlrev_b32 v30, 16, v30
    s_waitcnt vmcnt(1)
    v_mov_b32 v8, 0
    v_mov_b32 v9, 0
    v_mov_b32 v10, 0
    v_mov_b32 v11, 0
    s_cmp_eq_u32 s96, 0
    s_cbranch_scc1 L_ffl_95
    v_cvt_f32_u32_sdwa v12, v32 dst_sel:DWORD dst_unused:UNUSED_PAD src0_sel:WORD_0
    v_cvt_f32_u32_sdwa v13, v32 dst_sel:DWORD dst_unused:UNUSED_PAD src0_sel:WORD_1
    v_cvt_f32_u32_sdwa v14, v33 dst_sel:DWORD dst_unused:UNUSED_PAD src0_sel:WORD_0
    v_cvt_f32_u32_sdwa v15, v33 dst_sel:DWORD dst_unused:UNUSED_PAD src0_sel:WORD_1
    v_add_f32 v12, 0xc6800000, v12
    v_add_f32 v13, 0xc6800000, v13
    v_add_f32 v14, 0xc6800000, v14
    v_add_f32 v15, 0xc6800000, v15
    v_fmac_f32 v8, s96, v12
    v_fmac_f32 v9, s96, v13
    v_fmac_f32 v10, s96, v14
    v_fmac_f32 v11, s96, v15
L_fbk_96:
    s_cmp_eq_u32 s97, 0
    s_cbranch_scc1 L_ffl_97
    v_cvt_f32_u32_sdwa v12, v34 dst_sel:DWORD dst_unused:UNUSED_PAD src0_sel:WORD_0
    v_cvt_f32_u32_sdwa v13, v34 dst_sel:DWORD dst_unused:UNUSED_PAD src0_sel:WORD_1
    v_cvt_f32_u32_sdwa v14, v35 dst_sel:DWORD dst_unused:UNUSED_PAD src0_sel:WORD_0
    v_cvt_f32_u32_sdwa v15, v35 dst_sel:DWORD dst_unused:UNUSED_PAD src0_sel:WORD_1
    v_add_f32 v12, 0xc6800000, v12
    v_add_f32 v13, 0xc6800000, v13
    v_add_f32 v14, 0xc6800000, v14
    v_add_f32 v15, 0xc6800000, v15
    v_fmac_f32 v8, s97, v12
    v_fmac_f32 v9, s97, v13
    v_fmac_f32 v10, s97, v14
    v_fmac_f32 v11, s97, v15
L_fbk_98:
    s_cmp_eq_u32 s98, 0
    s_cbranch_scc1 L_ffl_99
    v_cvt_f32_u32_sdwa v12, v36 dst_sel:DWORD dst_unused:UNUSED_PAD src0_sel:WORD_0
    v_cvt_f32_u32_sdwa v13, v36 dst_sel:DWORD dst_unused:UNUSED_PAD src0_sel:WORD_1
    v_cvt_f32_u32_sdwa v14, v37 dst_sel:DWORD dst_unused:UNUSED_PAD src0_sel:WORD_0
    v_cvt_f32_u32_sdwa v15, v37 dst_sel:DWORD dst_unused:UNUSED_PAD src0_sel:WORD_1
    v_add_f32 v12, 0xc6800000, v12
    v_add_f32 v13, 0xc6800000, v13
    v_add_f32 v14, 0xc6800000, v14
    v_add_f32 v15, 0xc6800000, v15
    v_fmac_f32 v8, s98, v12
    v_fmac_f32 v9, s98, v13
    v_fmac_f32 v10, s98, v14
    v_fmac_f32 v11, s98, v15
L_fbk_100:
    s_cmp_eq_u32 s99, 0
    s_cbranch_scc1 L_ffl_101
    v_cvt_f32_u32_sdwa v12, v38 dst_sel:DWORD dst_unused:UNUSED_PAD src0_sel:WORD_0
    v_cvt_f32_u32_sdwa v13, v38 dst_sel:DWORD dst_unused:UNUSED_PAD src0_sel:WORD_1
    v_cvt_f32_u32_sdwa v14, v39 dst_sel:DWORD dst_unused:UNUSED_PAD src0_sel:WORD_0
    v_cvt_f32_u32_sdwa v15, v39 dst_sel:DWORD dst_unused:UNUSED_PAD src0_sel:WORD_1
    v_add_f32 v12, 0xc6800000, v12
    v_add_f32 v13, 0xc6800000, v13
    v_add_f32 v14, 0xc6800000, v14
    v_add_f32 v15, 0xc6800000, v15
    v_fmac_f32 v8, s99, v12
    v_fmac_f32 v9, s99, v13
    v_fmac_f32 v10, s99, v14
    v_fmac_f32 v11, s99, v15
L_fbk_102:
    s_lshl_b32 s92, s76, 16
    v_mul_f32 v16, s92, v8
    s_and_b32 s93, s76, s94
    v_mul_f32 v17, s93, v8
    s_lshl_b32 s92, s77, 16
    v_mul_f32 v18, s92, v8
    s_and_b32 s93, s77, s94
    v_mul_f32 v19, s93, v8
    s_lshl_b32 s92, s78, 16
    v_fmac_f32 v16, s92, v9
    s_and_b32 s93, s78, s94
    v_fmac_f32 v17, s93, v9
    s_lshl_b32 s92, s79, 16
    v_fmac_f32 v18, s92, v9
    s_and_b32 s93, s79, s94
    v_fmac_f32 v19, s93, v9
    s_lshl_b32 s92, s80, 16
    v_fmac_f32 v16, s92, v10
    s_and_b32 s93, s80, s94
    v_fmac_f32 v17, s93, v10
    s_lshl_b32 s92, s81, 16
    v_fmac_f32 v18, s92, v10
    s_and_b32 s93, s81, s94
    v_fmac_f32 v19, s93, v10
    s_lshl_b32 s92, s82, 16
    v_fmac_f32 v16, s92, v11
    s_and_b32 s93, s82, s94
    v_fmac_f32 v17, s93, v11
    s_lshl_b32 s92, s83, 16
    v_fmac_f32 v18, s92, v11
    s_and_b32 s93, s83, s94
    v_fmac_f32 v19, s93, v11
    v_mul_f32 v16, v16, v24
    v_mul_f32 v17, v17, v25
    v_mul_f32 v18, v18, v26
    v_mul_f32 v19, v19, v27
    v_cvt_pk_bf16_f32 v16, v16, v17
    v_and_b32 v17, s94, v16
    v_lshlrev_b32 v16, 16, v16
    v_cvt_pk_bf16_f32 v18, v18, v19
    v_and_b32 v19, s94, v18
    v_lshlrev_b32 v18, 16, v18
    s_lshl_b32 s92, s84, 16
    v_mul_f32 v20, s92, v16
    s_and_b32 s93, s84, s94
    v_mul_f32 v21, s93, v16
    s_lshl_b32 s92, s85, 16
    v_mul_f32 v22, s92, v16
    s_and_b32 s93, s85, s94
    v_mul_f32 v23, s93, v16
    s_lshl_b32 s92, s86, 16
    v_fmac_f32 v20, s92, v17
    s_and_b32 s93, s86, s94
    v_fmac_f32 v21, s93, v17
    s_lshl_b32 s92, s87, 16
    v_fmac_f32 v22, s92, v17
    s_and_b32 s93, s87, s94
    v_fmac_f32 v23, s93, v17
    s_lshl_b32 s92, s88, 16
    v_fmac_f32 v20, s92, v18
    s_and_b32 s93, s88, s94
    v_fmac_f32 v21, s93, v18
    s_lshl_b32 s92, s89, 16
    v_fmac_f32 v22, s92, v18
    s_and_b32 s93, s89, s94
    v_fmac_f32 v23, s93, v18
    s_lshl_b32 s92, s90, 16
    v_fmac_f32 v20, s92, v19
    s_and_b32 s93, s90, s94
    v_fmac_f32 v21, s93, v19
    s_lshl_b32 s92, s91, 16
    v_fmac_f32 v22, s92, v19
    s_and_b32 s93, s91, s94
    v_fmac_f32 v23, s93, v19
    v_cvt_pk_bf16_f32 v20, v20, v21
    v_and_b32 v21, s94, v20
    v_lshlrev_b32 v20, 16, v20
    v_cvt_pk_bf16_f32 v22, v22, v23
    v_and_b32 v23, s94, v22
    v_lshlrev_b32 v22, 16, v22
    v_mul_f32 v20, v20, v28
    v_mul_f32 v21, v21, v29
    v_mul_f32 v22, v22, v30
    v_mul_f32 v23, v23, v31
    v_cvt_pk_bf16_f32 v20, v20, v21
    v_and_b32 v21, s94, v20
    v_lshlrev_b32 v20, 16, v20
    v_cvt_pk_bf16_f32 v22, v22, v23
    v_and_b32 v23, s94, v22
    v_lshlrev_b32 v22, 16, v22
    s_waitcnt vmcnt(0)
    v_lshlrev_b32 v8, 16, v6
    v_and_b32 v9, s94, v6
    v_lshlrev_b32 v10, 16, v7
    v_and_b32 v11, s94, v7

    v_add_f32 v8, v8, v20
    v_add_f32 v9, v9, v21
    v_add_f32 v10, v10, v22
    v_add_f32 v11, v11, v23
    v_cvt_pk_bf16_f32 v12, v8, v9
    v_cvt_pk_bf16_f32 v13, v10, v11
    buffer_store_dwordx2 v[12:13], v2, s[36:39], 0 offen
L_fdone_94:
    s_endpgm

L_ffl_95:
    s_mov_b32 s3, 25600000
    buffer_load_dwordx4 v[12:15], v1, s[24:27], s3 offen
    s_waitcnt vmcnt(0)
    v_add_f32 v8, v8, v12
    v_add_f32 v9, v9, v13
    v_add_f32 v10, v10, v14
    v_add_f32 v11, v11, v15
    s_branch L_fbk_96

L_ffl_97:
    s_mov_b32 s3, 38400000
    buffer_load_dwordx4 v[12:15], v1, s[24:27], s3 offen
    s_waitcnt vmcnt(0)
    v_add_f32 v8, v8, v12
    v_add_f32 v9, v9, v13
    v_add_f32 v10, v10, v14
    v_add_f32 v11, v11, v15
    s_branch L_fbk_98

L_ffl_99:
    s_mov_b32 s3, 51200000
    buffer_load_dwordx4 v[12:15], v1, s[24:27], s3 offen
    s_waitcnt vmcnt(0)
    v_add_f32 v8, v8, v12
    v_add_f32 v9, v9, v13
    v_add_f32 v10, v10, v14
    v_add_f32 v11, v11, v15
    s_branch L_fbk_100

L_ffl_101:
    s_mov_b32 s3, 64000000
    buffer_load_dwordx4 v[12:15], v1, s[24:27], s3 offen
    s_waitcnt vmcnt(0)
    v_add_f32 v8, v8, v12
    v_add_f32 v9, v9, v13
    v_add_f32 v10, v10, v14
    v_add_f32 v11, v11, v15
    s_branch L_fbk_102

.section .rodata,"a"
.p2align 6
.amdhsa_kernel g1_kernel
  .amdhsa_next_free_vgpr 128
  .amdhsa_next_free_sgpr 102
  .amdhsa_accum_offset 128
  .amdhsa_group_segment_fixed_size 0
  .amdhsa_kernarg_size 112
  .amdhsa_user_sgpr_count 2
  .amdhsa_user_sgpr_kernarg_segment_ptr 1
  .amdhsa_system_sgpr_workgroup_id_x 1
.end_amdhsa_kernel
.p2align 6
.amdhsa_kernel g2_kernel
  .amdhsa_next_free_vgpr 128
  .amdhsa_next_free_sgpr 102
  .amdhsa_accum_offset 128
  .amdhsa_group_segment_fixed_size 0
  .amdhsa_kernarg_size 112
  .amdhsa_user_sgpr_count 2
  .amdhsa_user_sgpr_kernarg_segment_ptr 1
  .amdhsa_system_sgpr_workgroup_id_x 1
  .amdhsa_float_denorm_mode_32 3
.end_amdhsa_kernel
.p2align 6
.amdhsa_kernel standalone__molecular_angular_gemnet__graph_kernel
  .amdhsa_next_free_vgpr 40
  .amdhsa_next_free_sgpr 100
  .amdhsa_accum_offset 40
  .amdhsa_group_segment_fixed_size 0
  .amdhsa_kernarg_size 112
  .amdhsa_user_sgpr_count 2
  .amdhsa_user_sgpr_kernarg_segment_ptr 1
  .amdhsa_system_sgpr_workgroup_id_x 1
  .amdhsa_float_denorm_mode_32 3
.end_amdhsa_kernel
```

```asm
; @launch kernel=g1_kernel grid=(256,1,1) block=(1024,1,1) lds=163840
; @launch kernel=g2_kernel grid=(256,1,1) block=(1024,1,1) lds=163840
; @launch kernel=standalone__molecular_angular_gemnet__graph_kernel grid=(1600,1,1) block=(256,1,1) lds=0
.amdgcn_target "amdgcn-amd-amdhsa--gfx950"
.text
.globl g1_kernel
.p2align 8
.type g1_kernel,@function
g1_kernel:
    s_cmp_ge_u32 s2, 256
    s_cbranch_scc1 L_p1done_1
    s_load_dwordx4 s[80:83], s[0:1], 8
    s_load_dwordx2 s[84:85], s[0:1], 32
    s_load_dwordx2 s[86:87], s[0:1], 48
    s_load_dwordx4 s[4:7], s[0:1], 96
    s_load_dwordx2 s[78:79], s[0:1], 0
    v_lshlrev_b32 v1, 4, v0
    v_lshlrev_b32 v2, 3, v0
    v_lshlrev_b32 v98, 20, v0
    s_waitcnt lgkmcnt(0)
    s_load_dword s88, s[86:87], 0

    s_mov_b32 s96, s4
    s_mov_b32 s97, s5
    s_mov_b32 s98, 256
    s_mov_b32 s99, 0x20000
    v_readfirstlane_b32 s74, v0
    s_nop 1
    s_or_b32 s74, s74, s2
    s_cbranch_scc1 L_noinit_2

    v_mov_b32 v110, 1
    buffer_atomic_add v110, v98, s[96:99], 0 offen offset:64 sc0
    s_waitcnt vmcnt(0)
    v_readfirstlane_b32 s74, v110
    s_nop 1
    s_cmp_lg_u32 s74, 0
    s_cbranch_scc1 L_zno_4

    s_mov_b32 s92, s6
    s_mov_b32 s93, s7
    s_mov_b32 s94, 65552
    s_mov_b32 s95, 0x20000
    v_mov_b32 v110, 0
    v_mov_b32 v111, 0
    v_mov_b32 v112, 0
    v_mov_b32 v113, 0
L_zl_3:
    buffer_store_dwordx4 v[110:113], v1, s[92:95], s74 offen sc0 sc1
    s_add_u32 s74, s74, 1024
    s_cmp_le_u32 s74, 65536
    s_cbranch_scc1 L_zl_3
    v_mov_b32 v114, 1
    s_waitcnt vmcnt(0)
    buffer_atomic_add v114, v98, s[96:99], 0 offen offset:128
L_zno_4:

L_noinit_2:
    s_mov_b32 s20, s78
    s_mov_b32 s21, s79
    s_mov_b32 s22, 6400000
    s_mov_b32 s23, 0x20000
    v_mul_u32_u24 v110, 6240, v0
    v_and_b32 v111, 63, v0
    v_and_b32 v112, 0x3c0, v0
    v_lshlrev_b32 v111, 2, v111
    v_lshl_or_b32 v111, v112, 4, v111
    v_lshlrev_b32 v100, 2, v0
    s_lshr_b32 s50, s2, 1
    s_and_b32 s53, s2, 1
    s_mul_i32 s3, s50, 50000
    s_mul_i32 s54, s53, 24576
    s_add_u32 s3, s3, s54

    buffer_load_dwordx4 v[56:59], v110, s[20:23], 0 offen
    s_add_u32 s20, s78, s3
    s_addc_u32 s21, s79, 0
    s_mov_b32 s22, 24576
    s_mov_b32 s23, 0x20000
    s_movk_i32 s3, 16384
    buffer_load_dword v44, v111, s[20:23], 0 offen offset:0
    buffer_load_dword v45, v111, s[20:23], 0 offen offset:256
    buffer_load_dword v46, v111, s[20:23], 0 offen offset:512
    buffer_load_dword v47, v111, s[20:23], 0 offen offset:768
    buffer_load_dword v48, v111, s[20:23], s3 offen offset:0
    buffer_load_dword v49, v111, s[20:23], s3 offen offset:256
    buffer_load_dword v50, v111, s[20:23], s3 offen offset:512
    buffer_load_dword v51, v111, s[20:23], s3 offen offset:768
    s_mul_i32 s22, s53, 25424
    s_movk_i32 s3, 24576

    buffer_load_dword v52, v100, s[20:23], s3 offen
    s_mul_i32 s3, s50, 50048
    s_add_u32 s3, s3, s54
    s_add_u32 s54, s3, 393216

    s_mov_b32 s8, s80
    s_mov_b32 s9, s81
    s_mov_b32 s10, 0
    s_mov_b32 s11, 0x20000
    s_mov_b32 s12, s82
    s_mov_b32 s13, s83
    s_mov_b32 s14, 0
    s_mov_b32 s15, 0x20000
    s_mov_b32 s16, s84
    s_mov_b32 s17, s85
    s_mov_b32 s18, 0
    s_mov_b32 s19, 0x20000
    s_lshr_b32 s74, s2, 1
    s_and_b32 s74, s74, 28
    s_lshr_b32 s29, 0x00102010, s74
    s_lshr_b32 s30, 0x44414241, s74
    s_lshr_b32 s41, 0x43221100, s74
    s_and_b32 s29, s29, 15
    s_and_b32 s30, s30, 15
    s_and_b32 s41, s41, 15
    s_lshr_b32 s74, s2, 6
    s_lshl_b32 s74, s74, 3
    s_and_b32 s75, s2, 7
    s_add_u32 s74, s74, s75
    s_mul_i32 s74, s74, 5
    s_add_u32 s41, s41, s74
    s_sub_u32 s74, s30, s29
    s_bfm_b32 s28, s74, s29
    s_lshl_b32 s29, s29, 12
    s_lshl_b32 s30, s30, 12
    s_min_u32 s30, s30, 16000

    s_mul_i32 s78, s41, 16000
    s_add_u32 s49, s78, 16000
    s_cmp_ge_u32 s41, 3200
    s_cmovk_i32 s49, 0
    s_cmovk_i32 s78, 0
    s_lshl_b32 s10, s49, 2
    s_lshl_b32 s14, s49, 2
    s_lshl_b32 s18, s49, 1
    s_lshl_b32 s56, s78, 2
    s_lshl_b32 s61, s78, 1

    s_add_u32 s57, s56, 16384
    s_add_u32 s62, s61, 8192
    s_add_u32 s58, s56, 32768
    s_add_u32 s63, s61, 16384
    s_add_u32 s59, s56, 49152
    s_add_u32 s64, s61, 24576
    s_bitcmp1_b32 s28, 0
    s_cselect_b32 s56, s56, 0x7ff00000
    s_cselect_b32 s61, s61, 0x7ff00000

    s_bitcmp1_b32 s28, 1
    s_cselect_b32 s57, s57, 0x7ff00000
    s_cselect_b32 s62, s62, 0x7ff00000

    s_bitcmp1_b32 s28, 2
    s_cselect_b32 s58, s58, 0x7ff00000
    s_cselect_b32 s63, s63, 0x7ff00000

    s_bitcmp1_b32 s28, 3
    s_cselect_b32 s59, s59, 0x7ff00000
    s_cselect_b32 s64, s64, 0x7ff00000

    buffer_load_dwordx4 v[20:23], v1, s[12:15], s56 offen nt
    buffer_load_dwordx4 v[4:7], v1, s[8:11], s56 offen nt
    buffer_load_dwordx2 v[36:37], v2, s[16:19], s61 offen nt
    buffer_load_dwordx4 v[24:27], v1, s[12:15], s57 offen nt
    buffer_load_dwordx4 v[8:11], v1, s[8:11], s57 offen nt
    buffer_load_dwordx2 v[38:39], v2, s[16:19], s62 offen nt
    buffer_load_dwordx4 v[28:31], v1, s[12:15], s58 offen nt
    buffer_load_dwordx4 v[12:15], v1, s[8:11], s58 offen nt
    buffer_load_dwordx2 v[40:41], v2, s[16:19], s63 offen nt
    buffer_load_dwordx4 v[32:35], v1, s[12:15], s59 offen nt
    buffer_load_dwordx4 v[16:19], v1, s[8:11], s59 offen nt
    buffer_load_dwordx2 v[42:43], v2, s[16:19], s64 offen nt
    s_and_b32 s5, s2, 7
    s_mul_i32 s3, s5, 8192

    s_add_u32 s20, s6, s3
    s_addc_u32 s21, s7, 0
    s_mov_b32 s22, 8192
    s_mov_b32 s23, 0x20000
    s_mul_i32 s3, s5, 40632320
    s_add_u32 s3, s3, 83599360
    s_add_u32 s24, s6, s3
    s_addc_u32 s25, s7, 0
    s_mov_b32 s26, 40632320
    s_mov_b32 s27, 0x20000
    s_add_u32 s32, s6, 408657920
    s_addc_u32 s33, s7, 0
    s_mov_b32 s34, 409600000
    s_mov_b32 s35, 0x20000
    s_add_u32 s36, s6, 65536
    s_addc_u32 s37, s7, 0
    s_mov_b32 s38, 4
    s_mov_b32 s39, 0x20000
    s_mov_b32 s40, 687195
    s_mov_b32 s42, -6250
    s_mov_b32 s43, 1942
    s_mov_b32 s45, 0x06050400
    s_mov_b32 s46, 0x05040c00
    s_mov_b32 s47, 0x04020100
    s_mov_b32 s48, 3968
    s_sub_u32 s50, 0, s29
    v_mov_b32 v104, 1
    v_mov_b32 v105, 0x46ff8000
    s_mov_b32 s55, 0x05040100
    v_mul_u32_u24 v106, 5, v0
    v_mov_b32 v108, 16384
    v_mov_b32 v114, 0
    v_mov_b32 v115, 0
    v_mov_b32 v116, 0
    v_mov_b32 v117, -1
    ds_write_b64 v2, v[114:115]
    s_lshl_b32 s74, s29, 3
    s_lshl_b32 s75, s30, 3
    v_mov_b32 v118, 128000
    v_mov_b32 v119, s74
    v_mov_b32 v120, s75
    s_movk_i32 s3, 928
    v_cmp_gt_u32 s[66:67], s3, v0
    s_movk_i32 s3, 640
    v_cmp_gt_u32 s[68:69], s3, v0
    s_mov_b64 exec, 1
    ds_write_b128 v108, v[114:117]
    ds_write_b32 v118, v117 offset:16404
    ds_write_b32 v119, v117 offset:16396
    ds_write_b32 v120, v117 offset:16404
    s_mov_b64 exec, -1
    s_waitcnt lgkmcnt(0)
    s_lshl_b32 s88, s88, 16
    v_mov_b32 v110, 0.15915494
    v_mul_f32 v110, s88, v110
    s_mov_b32 s3, 0x7fff7fff
    v_readfirstlane_b32 s44, v110

    s_waitcnt vmcnt(12)
    v_mov_b32 v61, 0
    v_mov_b32 v62, 0
    v_mov_b32 v63, 0
    v_dot2_f32_bf16 v61, v44, v44, v61
    v_dot2_f32_bf16 v61, v45, v45, v61
    v_dot2_f32_bf16 v61, v46, v46, v61
    v_dot2_f32_bf16 v61, v47, v47, v61
    v_dot2_f32_bf16 v61, v48, v48, v61
    v_dot2_f32_bf16 v61, v49, v49, v61
    v_dot2_f32_bf16 v61, v50, v50, v61
    v_dot2_f32_bf16 v61, v51, v51, v61
    v_dot2_f32_bf16 v61, v52, v52, v61
    v_dot2_f32_bf16 v62, v56, v56, v62
    v_dot2_f32_bf16 v62, v57, v57, v62
    v_dot2_f32_bf16 v62, v58, v58, v62
    v_dot2_f32_bf16 v62, v59, v59, v62
    v_and_b32 v60, s3, v44
    v_and_b32 v64, s3, v45
    v_pk_max_u16 v60, v60, v64
    v_and_b32 v64, s3, v46
    v_pk_max_u16 v60, v60, v64
    v_and_b32 v64, s3, v47
    v_pk_max_u16 v60, v60, v64
    v_and_b32 v64, s3, v48
    v_pk_max_u16 v60, v60, v64
    v_and_b32 v64, s3, v49
    v_pk_max_u16 v60, v60, v64
    v_and_b32 v64, s3, v50
    v_pk_max_u16 v60, v60, v64
    v_and_b32 v64, s3, v51
    v_pk_max_u16 v60, v60, v64
    v_and_b32 v64, s3, v52
    v_pk_max_u16 v60, v60, v64
    v_lshrrev_b32 v64, 16, v60
    v_and_b32 v60, 0xffff, v60
    v_max_u32 v60, v60, v64

    s_nop 1
    v_max_u32_dpp v60, v60, v60 row_shr:1 row_mask:0xf bank_mask:0xf
    s_nop 1
    v_max_u32_dpp v60, v60, v60 row_shr:2 row_mask:0xf bank_mask:0xf
    s_nop 1
    v_max_u32_dpp v60, v60, v60 row_shr:4 row_mask:0xf bank_mask:0xf
    s_nop 1
    v_max_u32_dpp v60, v60, v60 row_shr:8 row_mask:0xf bank_mask:0xf
    s_nop 1
    v_max_u32_dpp v60, v60, v60 row_bcast:15 row_mask:0xa bank_mask:0xf
    s_nop 1
    v_max_u32_dpp v60, v60, v60 row_bcast:31 row_mask:0xc bank_mask:0xf
    s_nop 1
    v_add_f32_dpp v61, v61, v61 row_shr:1 row_mask:0xf bank_mask:0xf
    s_nop 1
    v_add_f32_dpp v61, v61, v61 row_shr:2 row_mask:0xf bank_mask:0xf
    s_nop 1
    v_add_f32_dpp v61, v61, v61 row_shr:4 row_mask:0xf bank_mask:0xf
    s_nop 1
    v_add_f32_dpp v61, v61, v61 row_shr:8 row_mask:0xf bank_mask:0xf
    s_nop 1
    v_add_f32_dpp v61, v61, v61 row_bcast:15 row_mask:0xa bank_mask:0xf
    s_nop 1
    v_add_f32_dpp v61, v61, v61 row_bcast:31 row_mask:0xc bank_mask:0xf
    s_nop 1
    v_add_f32_dpp v62, v62, v62 row_shr:1 row_mask:0xf bank_mask:0xf
    s_nop 1
    v_add_f32_dpp v62, v62, v62 row_shr:2 row_mask:0xf bank_mask:0xf
    s_nop 1
    v_add_f32_dpp v62, v62, v62 row_shr:4 row_mask:0xf bank_mask:0xf
    s_nop 1
    v_add_f32_dpp v62, v62, v62 row_shr:8 row_mask:0xf bank_mask:0xf
    s_nop 1
    v_add_f32_dpp v62, v62, v62 row_bcast:15 row_mask:0xa bank_mask:0xf
    s_nop 1
    v_add_f32_dpp v62, v62, v62 row_bcast:31 row_mask:0xc bank_mask:0xf
    v_lshrrev_b32 v64, 6, v0
    v_lshlrev_b32 v64, 4, v64
    s_mov_b32 exec_lo, 0
    s_brev_b32 exec_hi, 1
    ds_write_b128 v64, v[60:63] offset:8192
    s_mov_b64 exec, -1
    v_and_b32 v64, 15, v0
    v_lshlrev_b32 v64, 4, v64
    s_waitcnt lgkmcnt(0)
    s_barrier
    ds_read_b128 v[60:63], v64 offset:8192
    s_waitcnt lgkmcnt(0)

    s_nop 0
    v_max_u32_dpp v60, v60, v60 row_ror:1 row_mask:0xf bank_mask:0xf
    v_add_f32_dpp v61, v61, v61 row_ror:1 row_mask:0xf bank_mask:0xf
    v_add_f32_dpp v62, v62, v62 row_ror:1 row_mask:0xf bank_mask:0xf

    s_nop 0
    v_max_u32_dpp v60, v60, v60 row_ror:2 row_mask:0xf bank_mask:0xf
    v_add_f32_dpp v61, v61, v61 row_ror:2 row_mask:0xf bank_mask:0xf
    v_add_f32_dpp v62, v62, v62 row_ror:2 row_mask:0xf bank_mask:0xf

    s_nop 0
    v_max_u32_dpp v60, v60, v60 row_ror:4 row_mask:0xf bank_mask:0xf
    v_add_f32_dpp v61, v61, v61 row_ror:4 row_mask:0xf bank_mask:0xf
    v_add_f32_dpp v62, v62, v62 row_ror:4 row_mask:0xf bank_mask:0xf

    s_nop 0
    v_max_u32_dpp v60, v60, v60 row_ror:8 row_mask:0xf bank_mask:0xf
    v_add_f32_dpp v61, v61, v61 row_ror:8 row_mask:0xf bank_mask:0xf
    v_add_f32_dpp v62, v62, v62 row_ror:8 row_mask:0xf bank_mask:0xf

    v_rsq_f32 v62, v62
    v_mov_b32 v65, 0x4b400000
    v_mul_f32 v62, 0x4806b64a, v62
    s_nop 0
    v_readfirstlane_b32 s74, v62

    s_add_u32 s92, s6, 135168
    s_addc_u32 s93, s7, 0
    s_mov_b32 s94, 4096
    s_mov_b32 s95, 0x20000
    s_lshl_b32 s3, s2, 4
    buffer_store_dwordx4 v[60:63], v98, s[92:95], s3 offen
    v_lshlrev_b32 v66, 16, v44
    v_and_b32 v44, 0xffff0000, v44
    v_fma_f32 v66, v66, s74, v65
    v_fma_f32 v44, v44, s74, v65
    v_perm_b32 v44, v44, v66, s55

    v_lshlrev_b32 v66, 16, v45
    v_and_b32 v45, 0xffff0000, v45
    v_fma_f32 v66, v66, s74, v65
    v_fma_f32 v45, v45, s74, v65
    v_perm_b32 v45, v45, v66, s55

    v_lshlrev_b32 v66, 16, v46
    v_and_b32 v46, 0xffff0000, v46
    v_fma_f32 v66, v66, s74, v65
    v_fma_f32 v46, v46, s74, v65
    v_perm_b32 v46, v46, v66, s55

    v_lshlrev_b32 v66, 16, v47
    v_and_b32 v47, 0xffff0000, v47
    v_fma_f32 v66, v66, s74, v65
    v_fma_f32 v47, v47, s74, v65
    v_perm_b32 v47, v47, v66, s55

    v_lshlrev_b32 v66, 16, v48
    v_and_b32 v48, 0xffff0000, v48
    v_fma_f32 v66, v66, s74, v65
    v_fma_f32 v48, v48, s74, v65
    v_perm_b32 v48, v48, v66, s55

    v_lshlrev_b32 v66, 16, v49
    v_and_b32 v49, 0xffff0000, v49
    v_fma_f32 v66, v66, s74, v65
    v_fma_f32 v49, v49, s74, v65
    v_perm_b32 v49, v49, v66, s55

    v_lshlrev_b32 v66, 16, v50
    v_and_b32 v50, 0xffff0000, v50
    v_fma_f32 v66, v66, s74, v65
    v_fma_f32 v50, v50, s74, v65
    v_perm_b32 v50, v50, v66, s55

    v_lshlrev_b32 v66, 16, v51
    v_and_b32 v51, 0xffff0000, v51
    v_fma_f32 v66, v66, s74, v65
    v_fma_f32 v51, v51, s74, v65
    v_perm_b32 v51, v51, v66, s55

    v_lshlrev_b32 v66, 16, v52
    v_and_b32 v52, 0xffff0000, v52
    v_fma_f32 v66, v66, s74, v65
    v_fma_f32 v52, v52, s74, v65
    v_perm_b32 v52, v52, v66, s55

    s_add_u32 s92, s6, s54
    s_addc_u32 s93, s7, 0
    s_mov_b32 s94, 24576
    s_mov_b32 s95, 0x20000
    s_movk_i32 s3, 16384
    buffer_store_dwordx4 v[44:47], v1, s[92:95], 0 offen
    buffer_store_dwordx4 v[48:51], v1, s[92:95], s3 offen
    s_mul_i32 s94, s53, 25424
    s_movk_i32 s3, 24576

    buffer_store_dword v52, v100, s[92:95], s3 offen
    s_nop 1
    v_mov_b32 v99, 1
    buffer_atomic_add v99, v98, s[96:99], 0 offen sc0
    v_mov_b32 v100, 0
    buffer_atomic_add v100, v98, s[96:99], 0 offen offset:128 sc0
    s_waitcnt vmcnt(15)
    s_bitcmp0_b32 s28, 0
    s_cbranch_scc1 L_ska_7
    v_mul_hi_u32_u24 v45, s40, v20
    v_mul_hi_u32_u24 v44, s40, v4
    v_mul_hi_u32_u24 v47, s40, v21
    v_mul_hi_u32_u24 v46, s40, v5
    v_mul_hi_u32_u24 v49, s40, v22
    v_mul_hi_u32_u24 v48, s40, v6
    v_mul_hi_u32_u24 v51, s40, v23
    v_mul_hi_u32_u24 v50, s40, v7
    v_and_b32 v45, -2, v45
    v_mad_u32_u24 v4, v44, s43, v4
    v_and_b32 v76, -4, v44
    v_and_b32 v47, -2, v47
    v_mad_u32_u24 v5, v46, s43, v5
    v_and_b32 v77, -4, v46
    v_and_b32 v49, -2, v49
    v_mad_u32_u24 v6, v48, s43, v6
    v_and_b32 v78, -4, v48
    v_and_b32 v51, -2, v51
    v_mad_u32_u24 v7, v50, s43, v7
    v_and_b32 v79, -4, v50
    v_mad_i32_i24 v20, v45, s42, v20
    v_lshl_add_u32 v45, v76, 5, v45
    v_mad_i32_i24 v21, v47, s42, v21
    v_lshl_add_u32 v47, v77, 5, v47
    v_mad_i32_i24 v22, v49, s42, v22
    v_lshl_add_u32 v49, v78, 5, v49
    v_mad_i32_i24 v23, v51, s42, v23
    v_lshl_add_u32 v51, v79, 5, v51
    v_add_u32 v45, v45, v45
    ds_add_rtn_u32 v76, v45, v104
    v_add_u32 v47, v47, v47
    ds_add_rtn_u32 v77, v47, v104
    v_add_u32 v49, v49, v49
    ds_add_rtn_u32 v78, v49, v104
    v_add_u32 v51, v51, v51
    ds_add_rtn_u32 v79, v51, v104
    v_lshlrev_b32 v110, 16, v36
    v_and_b32 v111, 0xffff0000, v36
    v_lshlrev_b32 v112, 16, v37
    v_and_b32 v113, 0xffff0000, v37
    v_mul_f32 v110, s44, v110
    v_mul_f32 v111, s44, v111
    v_mul_f32 v112, s44, v112
    v_mul_f32 v113, s44, v113
    v_fract_f32 v110, v110
    v_fract_f32 v111, v111
    v_fract_f32 v112, v112
    v_fract_f32 v113, v113
    v_cos_f32 v110, v110
    v_cos_f32 v111, v111
    v_cos_f32 v112, v112
    v_cos_f32 v113, v113
    v_lshl_or_b32 v44, v44, 14, v20
    v_perm_b32 v45, v45, v4, s46
    v_bfe_u32 v4, v4, 8, 5

    v_lshl_or_b32 v46, v46, 14, v21
    v_perm_b32 v47, v47, v5, s46
    v_bfe_u32 v5, v5, 8, 5

    v_lshl_or_b32 v48, v48, 14, v22
    v_perm_b32 v49, v49, v6, s46
    v_bfe_u32 v6, v6, 8, 5

    v_lshl_or_b32 v50, v50, 14, v23
    v_perm_b32 v51, v51, v7, s46
    v_bfe_u32 v7, v7, 8, 5

    v_fmaak_f32 v110, v110, v105, 0x4b400010
    v_fmaak_f32 v111, v111, v105, 0x4b400010
    v_fmaak_f32 v112, v112, v105, 0x4b400010
    v_fmaak_f32 v113, v113, v105, 0x4b400010
    v_sub_u32 v110, v110, v4
    v_sub_u32 v111, v111, v5
    v_sub_u32 v112, v112, v6
    v_sub_u32 v113, v113, v7
    v_bfi_b32 v110, 31, v4, v110
    v_bfi_b32 v111, 31, v5, v111
    v_bfi_b32 v112, 31, v6, v112
    v_bfi_b32 v113, 31, v7, v113
    v_perm_b32 v44, v44, v110, s55
    v_perm_b32 v46, v46, v111, s55
    v_perm_b32 v48, v48, v112, s55
    v_perm_b32 v50, v50, v113, s55
L_ska_7:
    s_waitcnt vmcnt(12)
    s_bitcmp0_b32 s28, 1
    s_cbranch_scc1 L_ska_8
    v_mul_hi_u32_u24 v53, s40, v24
    v_mul_hi_u32_u24 v52, s40, v8
    v_mul_hi_u32_u24 v55, s40, v25
    v_mul_hi_u32_u24 v54, s40, v9
    v_mul_hi_u32_u24 v57, s40, v26
    v_mul_hi_u32_u24 v56, s40, v10
    v_mul_hi_u32_u24 v59, s40, v27
    v_mul_hi_u32_u24 v58, s40, v11
    v_and_b32 v53, -2, v53
    v_mad_u32_u24 v8, v52, s43, v8
    v_and_b32 v80, -4, v52
    v_and_b32 v55, -2, v55
    v_mad_u32_u24 v9, v54, s43, v9
    v_and_b32 v81, -4, v54
    v_and_b32 v57, -2, v57
    v_mad_u32_u24 v10, v56, s43, v10
    v_and_b32 v82, -4, v56
    v_and_b32 v59, -2, v59
    v_mad_u32_u24 v11, v58, s43, v11
    v_and_b32 v83, -4, v58
    v_mad_i32_i24 v24, v53, s42, v24
    v_lshl_add_u32 v53, v80, 5, v53
    v_mad_i32_i24 v25, v55, s42, v25
    v_lshl_add_u32 v55, v81, 5, v55
    v_mad_i32_i24 v26, v57, s42, v26
    v_lshl_add_u32 v57, v82, 5, v57
    v_mad_i32_i24 v27, v59, s42, v27
    v_lshl_add_u32 v59, v83, 5, v59
    v_add_u32 v53, v53, v53
    ds_add_rtn_u32 v80, v53, v104
    v_add_u32 v55, v55, v55
    ds_add_rtn_u32 v81, v55, v104
    v_add_u32 v57, v57, v57
    ds_add_rtn_u32 v82, v57, v104
    v_add_u32 v59, v59, v59
    ds_add_rtn_u32 v83, v59, v104
    v_lshlrev_b32 v110, 16, v38
    v_and_b32 v111, 0xffff0000, v38
    v_lshlrev_b32 v112, 16, v39
    v_and_b32 v113, 0xffff0000, v39
    v_mul_f32 v110, s44, v110
    v_mul_f32 v111, s44, v111
    v_mul_f32 v112, s44, v112
    v_mul_f32 v113, s44, v113
    v_fract_f32 v110, v110
    v_fract_f32 v111, v111
    v_fract_f32 v112, v112
    v_fract_f32 v113, v113
    v_cos_f32 v110, v110
    v_cos_f32 v111, v111
    v_cos_f32 v112, v112
    v_cos_f32 v113, v113
    v_lshl_or_b32 v52, v52, 14, v24
    v_perm_b32 v53, v53, v8, s46
    v_bfe_u32 v8, v8, 8, 5

    v_lshl_or_b32 v54, v54, 14, v25
    v_perm_b32 v55, v55, v9, s46
    v_bfe_u32 v9, v9, 8, 5

    v_lshl_or_b32 v56, v56, 14, v26
    v_perm_b32 v57, v57, v10, s46
    v_bfe_u32 v10, v10, 8, 5

    v_lshl_or_b32 v58, v58, 14, v27
    v_perm_b32 v59, v59, v11, s46
    v_bfe_u32 v11, v11, 8, 5

    v_fmaak_f32 v110, v110, v105, 0x4b400010
    v_fmaak_f32 v111, v111, v105, 0x4b400010
    v_fmaak_f32 v112, v112, v105, 0x4b400010
    v_fmaak_f32 v113, v113, v105, 0x4b400010
    v_sub_u32 v110, v110, v8
    v_sub_u32 v111, v111, v9
    v_sub_u32 v112, v112, v10
    v_sub_u32 v113, v113, v11
    v_bfi_b32 v110, 31, v8, v110
    v_bfi_b32 v111, 31, v9, v111
    v_bfi_b32 v112, 31, v10, v112
    v_bfi_b32 v113, 31, v11, v113
    v_perm_b32 v52, v52, v110, s55
    v_perm_b32 v54, v54, v111, s55
    v_perm_b32 v56, v56, v112, s55
    v_perm_b32 v58, v58, v113, s55
L_ska_8:
    s_waitcnt vmcnt(9)
    s_bitcmp0_b32 s28, 2
    s_cbranch_scc1 L_ska_9
    v_mul_hi_u32_u24 v61, s40, v28
    v_mul_hi_u32_u24 v60, s40, v12
    v_mul_hi_u32_u24 v63, s40, v29
    v_mul_hi_u32_u24 v62, s40, v13
    v_mul_hi_u32_u24 v65, s40, v30
    v_mul_hi_u32_u24 v64, s40, v14
    v_mul_hi_u32_u24 v67, s40, v31
    v_mul_hi_u32_u24 v66, s40, v15
    v_and_b32 v61, -2, v61
    v_mad_u32_u24 v12, v60, s43, v12
    v_and_b32 v84, -4, v60
    v_and_b32 v63, -2, v63
    v_mad_u32_u24 v13, v62, s43, v13
    v_and_b32 v85, -4, v62
    v_and_b32 v65, -2, v65
    v_mad_u32_u24 v14, v64, s43, v14
    v_and_b32 v86, -4, v64
    v_and_b32 v67, -2, v67
    v_mad_u32_u24 v15, v66, s43, v15
    v_and_b32 v87, -4, v66
    v_mad_i32_i24 v28, v61, s42, v28
    v_lshl_add_u32 v61, v84, 5, v61
    v_mad_i32_i24 v29, v63, s42, v29
    v_lshl_add_u32 v63, v85, 5, v63
    v_mad_i32_i24 v30, v65, s42, v30
    v_lshl_add_u32 v65, v86, 5, v65
    v_mad_i32_i24 v31, v67, s42, v31
    v_lshl_add_u32 v67, v87, 5, v67
    v_add_u32 v61, v61, v61
    ds_add_rtn_u32 v84, v61, v104
    v_add_u32 v63, v63, v63
    ds_add_rtn_u32 v85, v63, v104
    v_add_u32 v65, v65, v65
    ds_add_rtn_u32 v86, v65, v104
    v_add_u32 v67, v67, v67
    ds_add_rtn_u32 v87, v67, v104
    v_lshlrev_b32 v110, 16, v40
    v_and_b32 v111, 0xffff0000, v40
    v_lshlrev_b32 v112, 16, v41
    v_and_b32 v113, 0xffff0000, v41
    v_mul_f32 v110, s44, v110
    v_mul_f32 v111, s44, v111
    v_mul_f32 v112, s44, v112
    v_mul_f32 v113, s44, v113
    v_fract_f32 v110, v110
    v_fract_f32 v111, v111
    v_fract_f32 v112, v112
    v_fract_f32 v113, v113
    v_cos_f32 v110, v110
    v_cos_f32 v111, v111
    v_cos_f32 v112, v112
    v_cos_f32 v113, v113
    v_lshl_or_b32 v60, v60, 14, v28
    v_perm_b32 v61, v61, v12, s46
    v_bfe_u32 v12, v12, 8, 5

    v_lshl_or_b32 v62, v62, 14, v29
    v_perm_b32 v63, v63, v13, s46
    v_bfe_u32 v13, v13, 8, 5

    v_lshl_or_b32 v64, v64, 14, v30
    v_perm_b32 v65, v65, v14, s46
    v_bfe_u32 v14, v14, 8, 5

    v_lshl_or_b32 v66, v66, 14, v31
    v_perm_b32 v67, v67, v15, s46
    v_bfe_u32 v15, v15, 8, 5

    v_fmaak_f32 v110, v110, v105, 0x4b400010
    v_fmaak_f32 v111, v111, v105, 0x4b400010
    v_fmaak_f32 v112, v112, v105, 0x4b400010
    v_fmaak_f32 v113, v113, v105, 0x4b400010
    v_sub_u32 v110, v110, v12
    v_sub_u32 v111, v111, v13
    v_sub_u32 v112, v112, v14
    v_sub_u32 v113, v113, v15
    v_bfi_b32 v110, 31, v12, v110
    v_bfi_b32 v111, 31, v13, v111
    v_bfi_b32 v112, 31, v14, v112
    v_bfi_b32 v113, 31, v15, v113
    v_perm_b32 v60, v60, v110, s55
    v_perm_b32 v62, v62, v111, s55
    v_perm_b32 v64, v64, v112, s55
    v_perm_b32 v66, v66, v113, s55
L_ska_9:
    s_waitcnt vmcnt(6)
    s_bitcmp0_b32 s28, 3
    s_cbranch_scc1 L_ska_10
    s_mov_b64 exec, s[66:67]
    v_mul_hi_u32_u24 v69, s40, v32
    v_mul_hi_u32_u24 v68, s40, v16
    v_mul_hi_u32_u24 v71, s40, v33
    v_mul_hi_u32_u24 v70, s40, v17
    v_mul_hi_u32_u24 v73, s40, v34
    v_mul_hi_u32_u24 v72, s40, v18
    v_mul_hi_u32_u24 v75, s40, v35
    v_mul_hi_u32_u24 v74, s40, v19
    v_and_b32 v69, -2, v69
    v_mad_u32_u24 v16, v68, s43, v16
    v_and_b32 v88, -4, v68
    v_and_b32 v71, -2, v71
    v_mad_u32_u24 v17, v70, s43, v17
    v_and_b32 v89, -4, v70
    v_and_b32 v73, -2, v73
    v_mad_u32_u24 v18, v72, s43, v18
    v_and_b32 v90, -4, v72
    v_and_b32 v75, -2, v75
    v_mad_u32_u24 v19, v74, s43, v19
    v_and_b32 v91, -4, v74
    v_mad_i32_i24 v32, v69, s42, v32
    v_lshl_add_u32 v69, v88, 5, v69
    v_mad_i32_i24 v33, v71, s42, v33
    v_lshl_add_u32 v71, v89, 5, v71
    v_mad_i32_i24 v34, v73, s42, v34
    v_lshl_add_u32 v73, v90, 5, v73
    v_mad_i32_i24 v35, v75, s42, v35
    v_lshl_add_u32 v75, v91, 5, v75
    v_add_u32 v69, v69, v69
    ds_add_rtn_u32 v88, v69, v104
    v_add_u32 v71, v71, v71
    ds_add_rtn_u32 v89, v71, v104
    v_add_u32 v73, v73, v73
    ds_add_rtn_u32 v90, v73, v104
    v_add_u32 v75, v75, v75
    ds_add_rtn_u32 v91, v75, v104
    v_lshlrev_b32 v110, 16, v42
    v_and_b32 v111, 0xffff0000, v42
    v_lshlrev_b32 v112, 16, v43
    v_and_b32 v113, 0xffff0000, v43
    v_mul_f32 v110, s44, v110
    v_mul_f32 v111, s44, v111
    v_mul_f32 v112, s44, v112
    v_mul_f32 v113, s44, v113
    v_fract_f32 v110, v110
    v_fract_f32 v111, v111
    v_fract_f32 v112, v112
    v_fract_f32 v113, v113
    v_cos_f32 v110, v110
    v_cos_f32 v111, v111
    v_cos_f32 v112, v112
    v_cos_f32 v113, v113
    v_lshl_or_b32 v68, v68, 14, v32
    v_perm_b32 v69, v69, v16, s46
    v_bfe_u32 v16, v16, 8, 5

    v_lshl_or_b32 v70, v70, 14, v33
    v_perm_b32 v71, v71, v17, s46
    v_bfe_u32 v17, v17, 8, 5

    v_lshl_or_b32 v72, v72, 14, v34
    v_perm_b32 v73, v73, v18, s46
    v_bfe_u32 v18, v18, 8, 5

    v_lshl_or_b32 v74, v74, 14, v35
    v_perm_b32 v75, v75, v19, s46
    v_bfe_u32 v19, v19, 8, 5

    v_fmaak_f32 v110, v110, v105, 0x4b400010
    v_fmaak_f32 v111, v111, v105, 0x4b400010
    v_fmaak_f32 v112, v112, v105, 0x4b400010
    v_fmaak_f32 v113, v113, v105, 0x4b400010
    v_sub_u32 v110, v110, v16
    v_sub_u32 v111, v111, v17
    v_sub_u32 v112, v112, v18
    v_sub_u32 v113, v113, v19
    v_bfi_b32 v110, 31, v16, v110
    v_bfi_b32 v111, 31, v17, v111
    v_bfi_b32 v112, 31, v18, v112
    v_bfi_b32 v113, 31, v19, v113
    v_perm_b32 v68, v68, v110, s55
    v_perm_b32 v70, v70, v111, s55
    v_perm_b32 v72, v72, v112, s55
    v_perm_b32 v74, v74, v113, s55
    s_mov_b64 exec, -1
L_ska_10:
    s_waitcnt vmcnt(0)
    v_or_b32 v100, v100, v0
    s_nop 0
    v_readfirstlane_b32 s74, v100
    s_nop 1
    s_cmp_lg_u32 s74, 0
    s_cbranch_scc1 L_ready_12

    v_mov_b32 v110, 1
    buffer_atomic_add v110, v98, s[96:99], 0 offen offset:64 sc0
    s_waitcnt vmcnt(0)
    v_readfirstlane_b32 s74, v110
    s_nop 1
    s_cmp_lg_u32 s74, 0
    s_cbranch_scc1 L_zno_14

    s_mov_b32 s92, s6
    s_mov_b32 s93, s7
    s_mov_b32 s94, 65552
    s_mov_b32 s95, 0x20000
    v_mov_b32 v110, 0
    v_mov_b32 v111, 0
    v_mov_b32 v112, 0
    v_mov_b32 v113, 0
L_zl_13:
    buffer_store_dwordx4 v[110:113], v1, s[92:95], s74 offen sc0 sc1
    s_add_u32 s74, s74, 1024
    s_cmp_le_u32 s74, 65536
    s_cbranch_scc1 L_zl_13
    v_mov_b32 v114, 1
    s_waitcnt vmcnt(0)
    buffer_atomic_add v114, v98, s[96:99], 0 offen offset:128
L_zno_14:

L_spin_11:
    v_mov_b32 v100, 0
    buffer_atomic_add v100, v98, s[96:99], 0 offen offset:128 sc0
    s_waitcnt vmcnt(0)
    v_readfirstlane_b32 s74, v100
    s_nop 1
    s_cmp_eq_u32 s74, 0
    s_cbranch_scc1 L_spin_11
L_ready_12:

    v_cmp_eq_u32 vcc, 0, v0
    s_waitcnt vmcnt(1)
    s_mov_b64 exec, vcc
    ds_write_b32 v108, v99 offset:8
    s_mov_b64 exec, -1
    s_waitcnt lgkmcnt(0)
    s_barrier

    ds_read2_b32 v[110:111], v108 offset0:1 offset1:2
    ds_read_b64 v[94:95], v2
    s_waitcnt lgkmcnt(0)
    v_readfirstlane_b32 s53, v110
    v_readfirstlane_b32 s41, v111

    v_and_b32 v94, 0xffff, v94
    v_and_b32 v95, 0xffff, v95
    v_add_u32 v97, v94, v95
    s_nop 1
    v_add_u32_dpp v97, v97, v97 row_shr:1 row_mask:0xf bank_mask:0xf
    s_nop 1
    v_add_u32_dpp v97, v97, v97 row_shr:2 row_mask:0xf bank_mask:0xf
    s_nop 1
    v_add_u32_dpp v97, v97, v97 row_shr:4 row_mask:0xf bank_mask:0xf
    s_nop 1
    v_add_u32_dpp v97, v97, v97 row_shr:8 row_mask:0xf bank_mask:0xf
    s_nop 1
    v_add_u32_dpp v97, v97, v97 row_bcast:15 row_mask:0xa bank_mask:0xf
    s_nop 1
    v_add_u32_dpp v97, v97, v97 row_bcast:31 row_mask:0xc bank_mask:0xf
    s_mov_b32 exec_lo, 0
    s_brev_b32 exec_hi, 1
    ds_add_rtn_u32 v96, v108, v97
    s_mov_b64 exec, -1

    v_add_u32 v92, v94, v94
    v_add_u32 v93, v95, v95
    v_med3_u32 v92, v94, 2, v92
    v_med3_u32 v93, v95, 2, v93
    buffer_atomic_add_x2 v[92:93], v2, s[20:23], 0 offen sc0
    s_add_u32 s41, s41, 160
    s_mul_i32 s78, s41, 16000
    s_add_u32 s49, s78, 16000
    s_cmp_ge_u32 s41, 3200
    s_cmovk_i32 s49, 0
    s_cmovk_i32 s78, 0
    s_lshl_b32 s10, s49, 2
    s_lshl_b32 s14, s49, 2
    s_lshl_b32 s18, s49, 1
    s_lshl_b32 s56, s78, 2
    s_lshl_b32 s61, s78, 1

    s_add_u32 s57, s56, 16384
    s_add_u32 s62, s61, 8192
    s_add_u32 s58, s56, 32768
    s_add_u32 s63, s61, 16384
    s_add_u32 s59, s56, 49152
    s_add_u32 s64, s61, 24576
    s_waitcnt lgkmcnt(0)
    v_readlane_b32 s77, v96, 63
    v_mul_u32_u24 v114, 7936, v0
    v_sub_u32 v97, v97, v95
    s_sub_u32 s77, s77, s50
    v_add_u32 v97, s77, v97
    v_sub_u32 v96, v97, v94
    v_lshlrev_b32 v111, 16, v97
    v_lshlrev_b32 v110, 16, v96
    ds_write_b64 v2, v[110:111]
    v_sub_u32 v96, v114, v96
    v_sub_u32 v97, v114, v97
    v_add_u32 v97, s48, v97
    s_add_u32 s50, s50, s30

    s_waitcnt lgkmcnt(0)
    s_barrier

    buffer_load_dwordx4 v[20:23], v1, s[12:15], s56 offen nt
    buffer_load_dwordx4 v[4:7], v1, s[8:11], s56 offen nt
    buffer_load_dwordx2 v[36:37], v2, s[16:19], s61 offen nt
    buffer_load_dwordx4 v[24:27], v1, s[12:15], s57 offen nt
    buffer_load_dwordx4 v[8:11], v1, s[8:11], s57 offen nt
    buffer_load_dwordx2 v[38:39], v2, s[16:19], s62 offen nt
    buffer_load_dwordx4 v[28:31], v1, s[12:15], s58 offen nt
    buffer_load_dwordx4 v[12:15], v1, s[8:11], s58 offen nt
    buffer_load_dwordx2 v[40:41], v2, s[16:19], s63 offen nt
    buffer_load_dwordx4 v[32:35], v1, s[12:15], s59 offen nt
    buffer_load_dwordx4 v[16:19], v1, s[8:11], s59 offen nt
    buffer_load_dwordx2 v[42:43], v2, s[16:19], s64 offen nt
    s_bitcmp0_b32 s28, 0
    s_cbranch_scc1 L_skz_15
    v_lshrrev_b32 v110, 16, v45
    ds_read_b32 v110, v110
    v_lshrrev_b32 v111, 16, v47
    ds_read_b32 v111, v111
    v_lshrrev_b32 v112, 16, v49
    ds_read_b32 v112, v112
    v_lshrrev_b32 v113, 16, v51
    ds_read_b32 v113, v113
    s_waitcnt lgkmcnt(3)
    v_add_u32_sdwa v110, v110, v76 dst_sel:DWORD dst_unused:UNUSED_PAD src0_sel:WORD_1 src1_sel:WORD_0
    v_lshlrev_b32 v110, 3, v110
    ds_write_b64 v110, v[44:45] offset:16400

    s_waitcnt lgkmcnt(3)
    v_add_u32_sdwa v111, v111, v77 dst_sel:DWORD dst_unused:UNUSED_PAD src0_sel:WORD_1 src1_sel:WORD_0
    v_lshlrev_b32 v111, 3, v111
    ds_write_b64 v111, v[46:47] offset:16400

    s_waitcnt lgkmcnt(3)
    v_add_u32_sdwa v112, v112, v78 dst_sel:DWORD dst_unused:UNUSED_PAD src0_sel:WORD_1 src1_sel:WORD_0
    v_lshlrev_b32 v112, 3, v112
    ds_write_b64 v112, v[48:49] offset:16400

    s_waitcnt lgkmcnt(3)
    v_add_u32_sdwa v113, v113, v79 dst_sel:DWORD dst_unused:UNUSED_PAD src0_sel:WORD_1 src1_sel:WORD_0
    v_lshlrev_b32 v113, 3, v113
    ds_write_b64 v113, v[50:51] offset:16400

L_skz_15:
    s_bitcmp0_b32 s28, 1
    s_cbranch_scc1 L_skz_16
    v_lshrrev_b32 v110, 16, v53
    ds_read_b32 v110, v110
    v_lshrrev_b32 v111, 16, v55
    ds_read_b32 v111, v111
    v_lshrrev_b32 v112, 16, v57
    ds_read_b32 v112, v112
    v_lshrrev_b32 v113, 16, v59
    ds_read_b32 v113, v113
    s_waitcnt lgkmcnt(3)
    v_add_u32_sdwa v110, v110, v80 dst_sel:DWORD dst_unused:UNUSED_PAD src0_sel:WORD_1 src1_sel:WORD_0
    v_lshlrev_b32 v110, 3, v110
    ds_write_b64 v110, v[52:53] offset:16400

    s_waitcnt lgkmcnt(3)
    v_add_u32_sdwa v111, v111, v81 dst_sel:DWORD dst_unused:UNUSED_PAD src0_sel:WORD_1 src1_sel:WORD_0
    v_lshlrev_b32 v111, 3, v111
    ds_write_b64 v111, v[54:55] offset:16400

    s_waitcnt lgkmcnt(3)
    v_add_u32_sdwa v112, v112, v82 dst_sel:DWORD dst_unused:UNUSED_PAD src0_sel:WORD_1 src1_sel:WORD_0
    v_lshlrev_b32 v112, 3, v112
    ds_write_b64 v112, v[56:57] offset:16400

    s_waitcnt lgkmcnt(3)
    v_add_u32_sdwa v113, v113, v83 dst_sel:DWORD dst_unused:UNUSED_PAD src0_sel:WORD_1 src1_sel:WORD_0
    v_lshlrev_b32 v113, 3, v113
    ds_write_b64 v113, v[58:59] offset:16400

L_skz_16:
    s_bitcmp0_b32 s28, 2
    s_cbranch_scc1 L_skz_17
    v_lshrrev_b32 v110, 16, v61
    ds_read_b32 v110, v110
    v_lshrrev_b32 v111, 16, v63
    ds_read_b32 v111, v111
    v_lshrrev_b32 v112, 16, v65
    ds_read_b32 v112, v112
    v_lshrrev_b32 v113, 16, v67
    ds_read_b32 v113, v113
    s_waitcnt lgkmcnt(3)
    v_add_u32_sdwa v110, v110, v84 dst_sel:DWORD dst_unused:UNUSED_PAD src0_sel:WORD_1 src1_sel:WORD_0
    v_lshlrev_b32 v110, 3, v110
    ds_write_b64 v110, v[60:61] offset:16400

    s_waitcnt lgkmcnt(3)
    v_add_u32_sdwa v111, v111, v85 dst_sel:DWORD dst_unused:UNUSED_PAD src0_sel:WORD_1 src1_sel:WORD_0
    v_lshlrev_b32 v111, 3, v111
    ds_write_b64 v111, v[62:63] offset:16400

    s_waitcnt lgkmcnt(3)
    v_add_u32_sdwa v112, v112, v86 dst_sel:DWORD dst_unused:UNUSED_PAD src0_sel:WORD_1 src1_sel:WORD_0
    v_lshlrev_b32 v112, 3, v112
    ds_write_b64 v112, v[64:65] offset:16400

    s_waitcnt lgkmcnt(3)
    v_add_u32_sdwa v113, v113, v87 dst_sel:DWORD dst_unused:UNUSED_PAD src0_sel:WORD_1 src1_sel:WORD_0
    v_lshlrev_b32 v113, 3, v113
    ds_write_b64 v113, v[66:67] offset:16400

L_skz_17:
    s_bitcmp0_b32 s28, 3
    s_cbranch_scc1 L_skz_18
    s_mov_b64 exec, s[66:67]
    v_lshrrev_b32 v110, 16, v69
    ds_read_b32 v110, v110
    v_lshrrev_b32 v111, 16, v71
    ds_read_b32 v111, v111
    v_lshrrev_b32 v112, 16, v73
    ds_read_b32 v112, v112
    v_lshrrev_b32 v113, 16, v75
    ds_read_b32 v113, v113
    s_waitcnt lgkmcnt(3)
    v_add_u32_sdwa v110, v110, v88 dst_sel:DWORD dst_unused:UNUSED_PAD src0_sel:WORD_1 src1_sel:WORD_0
    v_lshlrev_b32 v110, 3, v110
    ds_write_b64 v110, v[68:69] offset:16400

    s_waitcnt lgkmcnt(3)
    v_add_u32_sdwa v111, v111, v89 dst_sel:DWORD dst_unused:UNUSED_PAD src0_sel:WORD_1 src1_sel:WORD_0
    v_lshlrev_b32 v111, 3, v111
    ds_write_b64 v111, v[70:71] offset:16400

    s_waitcnt lgkmcnt(3)
    v_add_u32_sdwa v112, v112, v90 dst_sel:DWORD dst_unused:UNUSED_PAD src0_sel:WORD_1 src1_sel:WORD_0
    v_lshlrev_b32 v112, 3, v112
    ds_write_b64 v112, v[72:73] offset:16400

    s_waitcnt lgkmcnt(3)
    v_add_u32_sdwa v113, v113, v91 dst_sel:DWORD dst_unused:UNUSED_PAD src0_sel:WORD_1 src1_sel:WORD_0
    v_lshlrev_b32 v113, 3, v113
    ds_write_b64 v113, v[74:75] offset:16400

    s_mov_b64 exec, -1
L_skz_18:
    s_cmp_eq_u32 s49, 0
    s_cbranch_scc1 L_p1epi_6
L_p1loop_5:
    v_mov_b32 v99, 1
    buffer_atomic_add v99, v98, s[96:99], 0 offen sc0
    s_waitcnt vmcnt(10)
    v_mul_hi_u32_u24 v45, s40, v20
    v_mul_hi_u32_u24 v44, s40, v4
    v_mul_hi_u32_u24 v47, s40, v21
    v_mul_hi_u32_u24 v46, s40, v5
    v_mul_hi_u32_u24 v49, s40, v22
    v_mul_hi_u32_u24 v48, s40, v6
    v_mul_hi_u32_u24 v51, s40, v23
    v_mul_hi_u32_u24 v50, s40, v7
    v_and_b32 v45, -2, v45
    v_mad_u32_u24 v4, v44, s43, v4
    v_and_b32 v76, -4, v44
    v_and_b32 v47, -2, v47
    v_mad_u32_u24 v5, v46, s43, v5
    v_and_b32 v77, -4, v46
    v_and_b32 v49, -2, v49
    v_mad_u32_u24 v6, v48, s43, v6
    v_and_b32 v78, -4, v48
    v_and_b32 v51, -2, v51
    v_mad_u32_u24 v7, v50, s43, v7
    v_and_b32 v79, -4, v50
    v_mad_i32_i24 v20, v45, s42, v20
    v_lshl_add_u32 v45, v76, 5, v45
    v_mad_i32_i24 v21, v47, s42, v21
    v_lshl_add_u32 v47, v77, 5, v47
    v_mad_i32_i24 v22, v49, s42, v22
    v_lshl_add_u32 v49, v78, 5, v49
    v_mad_i32_i24 v23, v51, s42, v23
    v_lshl_add_u32 v51, v79, 5, v51
    v_add_u32 v45, v45, v45
    ds_add_rtn_u32 v76, v45, v104
    v_add_u32 v47, v47, v47
    ds_add_rtn_u32 v77, v47, v104
    v_add_u32 v49, v49, v49
    ds_add_rtn_u32 v78, v49, v104
    v_add_u32 v51, v51, v51
    ds_add_rtn_u32 v79, v51, v104
    v_lshlrev_b32 v110, 16, v36
    v_and_b32 v111, 0xffff0000, v36
    v_lshlrev_b32 v112, 16, v37
    v_and_b32 v113, 0xffff0000, v37
    v_mul_f32 v110, s44, v110
    v_mul_f32 v111, s44, v111
    v_mul_f32 v112, s44, v112
    v_mul_f32 v113, s44, v113
    v_fract_f32 v110, v110
    v_fract_f32 v111, v111
    v_fract_f32 v112, v112
    v_fract_f32 v113, v113
    v_cos_f32 v110, v110
    v_cos_f32 v111, v111
    v_cos_f32 v112, v112
    v_cos_f32 v113, v113
    v_lshl_or_b32 v44, v44, 14, v20
    v_perm_b32 v45, v45, v4, s46
    v_bfe_u32 v4, v4, 8, 5

    v_lshl_or_b32 v46, v46, 14, v21
    v_perm_b32 v47, v47, v5, s46
    v_bfe_u32 v5, v5, 8, 5

    v_lshl_or_b32 v48, v48, 14, v22
    v_perm_b32 v49, v49, v6, s46
    v_bfe_u32 v6, v6, 8, 5

    v_lshl_or_b32 v50, v50, 14, v23
    v_perm_b32 v51, v51, v7, s46
    v_bfe_u32 v7, v7, 8, 5

    v_fmaak_f32 v110, v110, v105, 0x4b400010
    v_fmaak_f32 v111, v111, v105, 0x4b400010
    v_fmaak_f32 v112, v112, v105, 0x4b400010
    v_fmaak_f32 v113, v113, v105, 0x4b400010
    v_sub_u32 v110, v110, v4
    v_sub_u32 v111, v111, v5
    v_sub_u32 v112, v112, v6
    v_sub_u32 v113, v113, v7
    v_bfi_b32 v110, 31, v4, v110
    v_bfi_b32 v111, 31, v5, v111
    v_bfi_b32 v112, 31, v6, v112
    v_bfi_b32 v113, 31, v7, v113
    v_perm_b32 v44, v44, v110, s55
    v_perm_b32 v46, v46, v111, s55
    v_perm_b32 v48, v48, v112, s55
    v_perm_b32 v50, v50, v113, s55
    s_waitcnt vmcnt(7)
    v_mul_hi_u32_u24 v53, s40, v24
    v_mul_hi_u32_u24 v52, s40, v8
    v_mul_hi_u32_u24 v55, s40, v25
    v_mul_hi_u32_u24 v54, s40, v9
    v_mul_hi_u32_u24 v57, s40, v26
    v_mul_hi_u32_u24 v56, s40, v10
    v_mul_hi_u32_u24 v59, s40, v27
    v_mul_hi_u32_u24 v58, s40, v11
    v_and_b32 v53, -2, v53
    v_mad_u32_u24 v8, v52, s43, v8
    v_and_b32 v80, -4, v52
    v_and_b32 v55, -2, v55
    v_mad_u32_u24 v9, v54, s43, v9
    v_and_b32 v81, -4, v54
    v_and_b32 v57, -2, v57
    v_mad_u32_u24 v10, v56, s43, v10
    v_and_b32 v82, -4, v56
    v_and_b32 v59, -2, v59
    v_mad_u32_u24 v11, v58, s43, v11
    v_and_b32 v83, -4, v58
    v_mad_i32_i24 v24, v53, s42, v24
    v_lshl_add_u32 v53, v80, 5, v53
    v_mad_i32_i24 v25, v55, s42, v25
    v_lshl_add_u32 v55, v81, 5, v55
    v_mad_i32_i24 v26, v57, s42, v26
    v_lshl_add_u32 v57, v82, 5, v57
    v_mad_i32_i24 v27, v59, s42, v27
    v_lshl_add_u32 v59, v83, 5, v59
    v_add_u32 v53, v53, v53
    ds_add_rtn_u32 v80, v53, v104
    v_add_u32 v55, v55, v55
    ds_add_rtn_u32 v81, v55, v104
    v_add_u32 v57, v57, v57
    ds_add_rtn_u32 v82, v57, v104
    v_add_u32 v59, v59, v59
    ds_add_rtn_u32 v83, v59, v104
    v_lshlrev_b32 v110, 16, v38
    v_and_b32 v111, 0xffff0000, v38
    v_lshlrev_b32 v112, 16, v39
    v_and_b32 v113, 0xffff0000, v39
    v_mul_f32 v110, s44, v110
    v_mul_f32 v111, s44, v111
    v_mul_f32 v112, s44, v112
    v_mul_f32 v113, s44, v113
    v_fract_f32 v110, v110
    v_fract_f32 v111, v111
    v_fract_f32 v112, v112
    v_fract_f32 v113, v113
    v_cos_f32 v110, v110
    v_cos_f32 v111, v111
    v_cos_f32 v112, v112
    v_cos_f32 v113, v113
    v_lshl_or_b32 v52, v52, 14, v24
    v_perm_b32 v53, v53, v8, s46
    v_bfe_u32 v8, v8, 8, 5

    v_lshl_or_b32 v54, v54, 14, v25
    v_perm_b32 v55, v55, v9, s46
    v_bfe_u32 v9, v9, 8, 5

    v_lshl_or_b32 v56, v56, 14, v26
    v_perm_b32 v57, v57, v10, s46
    v_bfe_u32 v10, v10, 8, 5

    v_lshl_or_b32 v58, v58, 14, v27
    v_perm_b32 v59, v59, v11, s46
    v_bfe_u32 v11, v11, 8, 5

    v_fmaak_f32 v110, v110, v105, 0x4b400010
    v_fmaak_f32 v111, v111, v105, 0x4b400010
    v_fmaak_f32 v112, v112, v105, 0x4b400010
    v_fmaak_f32 v113, v113, v105, 0x4b400010
    v_sub_u32 v110, v110, v8
    v_sub_u32 v111, v111, v9
    v_sub_u32 v112, v112, v10
    v_sub_u32 v113, v113, v11
    v_bfi_b32 v110, 31, v8, v110
    v_bfi_b32 v111, 31, v9, v111
    v_bfi_b32 v112, 31, v10, v112
    v_bfi_b32 v113, 31, v11, v113
    v_perm_b32 v52, v52, v110, s55
    v_perm_b32 v54, v54, v111, s55
    v_perm_b32 v56, v56, v112, s55
    v_perm_b32 v58, v58, v113, s55
    s_waitcnt vmcnt(4)
    v_mul_hi_u32_u24 v61, s40, v28
    v_mul_hi_u32_u24 v60, s40, v12
    v_mul_hi_u32_u24 v63, s40, v29
    v_mul_hi_u32_u24 v62, s40, v13
    v_mul_hi_u32_u24 v65, s40, v30
    v_mul_hi_u32_u24 v64, s40, v14
    v_mul_hi_u32_u24 v67, s40, v31
    v_mul_hi_u32_u24 v66, s40, v15
    v_and_b32 v61, -2, v61
    v_mad_u32_u24 v12, v60, s43, v12
    v_and_b32 v84, -4, v60
    v_and_b32 v63, -2, v63
    v_mad_u32_u24 v13, v62, s43, v13
    v_and_b32 v85, -4, v62
    v_and_b32 v65, -2, v65
    v_mad_u32_u24 v14, v64, s43, v14
    v_and_b32 v86, -4, v64
    v_and_b32 v67, -2, v67
    v_mad_u32_u24 v15, v66, s43, v15
    v_and_b32 v87, -4, v66
    v_mad_i32_i24 v28, v61, s42, v28
    v_lshl_add_u32 v61, v84, 5, v61
    v_mad_i32_i24 v29, v63, s42, v29
    v_lshl_add_u32 v63, v85, 5, v63
    v_mad_i32_i24 v30, v65, s42, v30
    v_lshl_add_u32 v65, v86, 5, v65
    v_mad_i32_i24 v31, v67, s42, v31
    v_lshl_add_u32 v67, v87, 5, v67
    v_add_u32 v61, v61, v61
    ds_add_rtn_u32 v84, v61, v104
    v_add_u32 v63, v63, v63
    ds_add_rtn_u32 v85, v63, v104
    v_add_u32 v65, v65, v65
    ds_add_rtn_u32 v86, v65, v104
    v_add_u32 v67, v67, v67
    ds_add_rtn_u32 v87, v67, v104
    v_lshlrev_b32 v110, 16, v40
    v_and_b32 v111, 0xffff0000, v40
    v_lshlrev_b32 v112, 16, v41
    v_and_b32 v113, 0xffff0000, v41
    v_mul_f32 v110, s44, v110
    v_mul_f32 v111, s44, v111
    v_mul_f32 v112, s44, v112
    v_mul_f32 v113, s44, v113
    v_fract_f32 v110, v110
    v_fract_f32 v111, v111
    v_fract_f32 v112, v112
    v_fract_f32 v113, v113
    v_cos_f32 v110, v110
    v_cos_f32 v111, v111
    v_cos_f32 v112, v112
    v_cos_f32 v113, v113
    v_lshl_or_b32 v60, v60, 14, v28
    v_perm_b32 v61, v61, v12, s46
    v_bfe_u32 v12, v12, 8, 5

    v_lshl_or_b32 v62, v62, 14, v29
    v_perm_b32 v63, v63, v13, s46
    v_bfe_u32 v13, v13, 8, 5

    v_lshl_or_b32 v64, v64, 14, v30
    v_perm_b32 v65, v65, v14, s46
    v_bfe_u32 v14, v14, 8, 5

    v_lshl_or_b32 v66, v66, 14, v31
    v_perm_b32 v67, v67, v15, s46
    v_bfe_u32 v15, v15, 8, 5

    v_fmaak_f32 v110, v110, v105, 0x4b400010
    v_fmaak_f32 v111, v111, v105, 0x4b400010
    v_fmaak_f32 v112, v112, v105, 0x4b400010
    v_fmaak_f32 v113, v113, v105, 0x4b400010
    v_sub_u32 v110, v110, v12
    v_sub_u32 v111, v111, v13
    v_sub_u32 v112, v112, v14
    v_sub_u32 v113, v113, v15
    v_bfi_b32 v110, 31, v12, v110
    v_bfi_b32 v111, 31, v13, v111
    v_bfi_b32 v112, 31, v14, v112
    v_bfi_b32 v113, 31, v15, v113
    v_perm_b32 v60, v60, v110, s55
    v_perm_b32 v62, v62, v111, s55
    v_perm_b32 v64, v64, v112, s55
    v_perm_b32 v66, v66, v113, s55
    s_waitcnt vmcnt(1)
    s_waitcnt vmcnt(0)
    v_cmp_eq_u32 vcc, 0, v0
    s_mov_b64 exec, vcc
    ds_write_b32 v108, v99 offset:8
    s_mov_b64 exec, -1
    s_waitcnt vmcnt(10)
    v_add_u32 v110, v92, v94
    v_min_u32 v92, s48, v92
    v_add_u32 v111, v93, v95
    v_min_u32 v93, s48, v93
    v_max_u32 v110, v110, v111
    v_add_u32 v92, v92, v96
    v_add_u32 v93, v93, v97
    v_cmp_le_u32 vcc, s48, v110
    v_lshl_add_u32 v92, v92, 2, v92
    v_lshl_add_u32 v93, v93, 2, v93
    ds_write_b64 v2, v[92:93] offset:8192
    s_cbranch_vccz L_noov_22
    ds_write_b32 v108, v104 offset:4
L_noov_22:

    s_waitcnt lgkmcnt(0)
    s_barrier
    ds_read2_b32 v[110:111], v108 offset0:1 offset1:2
    s_waitcnt lgkmcnt(0)
    v_readfirstlane_b32 s53, v110
    v_readfirstlane_b32 s41, v111
    s_nop 1
    s_add_u32 s41, s41, 160

    s_mul_i32 s78, s41, 16000
    s_add_u32 s49, s78, 16000
    s_cmp_ge_u32 s41, 3200
    s_cmovk_i32 s49, 0
    s_cmovk_i32 s78, 0
    s_lshl_b32 s10, s49, 2
    s_lshl_b32 s14, s49, 2
    s_lshl_b32 s18, s49, 1
    s_lshl_b32 s56, s78, 2
    s_lshl_b32 s61, s78, 1

    s_add_u32 s57, s56, 16384
    s_add_u32 s62, s61, 8192
    s_add_u32 s58, s56, 32768
    s_add_u32 s63, s61, 16384
    s_add_u32 s59, s56, 49152
    s_add_u32 s64, s61, 24576
    s_cmp_lg_u32 s53, 0
    s_cbranch_scc1 L_slow_23
L_sback_24:
    s_bitcmp0_b32 s28, 0
    s_cbranch_scc1 L_skw_28
    ds_read_b64 v[110:111], v2 offset:16400
    ds_read_b64 v[112:113], v2 offset:16408
    ds_read_b64 v[114:115], v2 offset:16392

    ds_read_b64 v[118:119], v2 offset:24592
    ds_read_b64 v[120:121], v2 offset:24600
    ds_read_b64 v[122:123], v2 offset:24584

    s_waitcnt lgkmcnt(3)
    v_lshrrev_b32 v116, 16, v111
    ds_read_b32 v116, v116 offset:8192

    s_waitcnt lgkmcnt(1)
    v_lshrrev_b32 v124, 16, v119
    ds_read_b32 v124, v124 offset:8192

    v_cmp_ne_u32_sdwa s[80:81], v111, v113 src0_sel:WORD_1 src1_sel:WORD_1
    v_cmp_ne_u32_sdwa vcc, v111, v115 src0_sel:WORD_1 src1_sel:WORD_1
    v_alignbyte_b32 v114, v115, v114, 2
    s_mov_b32 s54, -3
    v_alignbyte_b32 v111, v111, v110, 1
    v_perm_b32 v110, v110, v114, s47
    s_waitcnt lgkmcnt(1)
    v_add3_u32 v116, v116, v106, s54
    v_sub_u32 v117, 0, v116
    v_and_b32 v117, 3, v117
    s_mov_b64 exec, s[80:81]
    v_mov_b32 v117, 0
    v_mov_b32 v112, 0
    s_mov_b64 exec, vcc
    v_mov_b32 v117, 3

    s_mov_b64 exec, -1
    v_alignbyte_b32 v110, v111, v110, v117
    v_alignbyte_b32 v111, v112, v111, v117
    v_add_u32 v116, v116, v117

    buffer_store_dwordx2 v[110:111], v116, s[24:27], 0 offen
    v_cmp_ne_u32_sdwa s[80:81], v119, v121 src0_sel:WORD_1 src1_sel:WORD_1
    v_cmp_ne_u32_sdwa vcc, v119, v123 src0_sel:WORD_1 src1_sel:WORD_1
    v_alignbyte_b32 v122, v123, v122, 2
    s_mov_b32 s54, 5117
    v_alignbyte_b32 v119, v119, v118, 1
    v_perm_b32 v118, v118, v122, s47
    s_waitcnt lgkmcnt(0)
    v_add3_u32 v124, v124, v106, s54
    v_sub_u32 v125, 0, v124
    v_and_b32 v125, 3, v125
    s_mov_b64 exec, s[80:81]
    v_mov_b32 v125, 0
    v_mov_b32 v120, 0
    s_mov_b64 exec, vcc
    v_mov_b32 v125, 3

    s_mov_b64 exec, -1
    v_alignbyte_b32 v118, v119, v118, v125
    v_alignbyte_b32 v119, v120, v119, v125
    v_add_u32 v124, v124, v125

    buffer_store_dwordx2 v[118:119], v124, s[24:27], 0 offen
L_skw_28:
    s_bitcmp0_b32 s28, 0
    s_cbranch_scc1 L_skw_29
    ds_read_b64 v[110:111], v2 offset:32784
    ds_read_b64 v[112:113], v2 offset:32792
    ds_read_b64 v[114:115], v2 offset:32776

    ds_read_b64 v[118:119], v2 offset:40976
    ds_read_b64 v[120:121], v2 offset:40984
    ds_read_b64 v[122:123], v2 offset:40968

    s_waitcnt lgkmcnt(3)
    v_lshrrev_b32 v116, 16, v111
    ds_read_b32 v116, v116 offset:8192

    s_waitcnt lgkmcnt(1)
    v_lshrrev_b32 v124, 16, v119
    ds_read_b32 v124, v124 offset:8192

    v_cmp_ne_u32_sdwa s[80:81], v111, v113 src0_sel:WORD_1 src1_sel:WORD_1
    v_cmp_ne_u32_sdwa vcc, v111, v115 src0_sel:WORD_1 src1_sel:WORD_1
    v_alignbyte_b32 v114, v115, v114, 2
    s_mov_b32 s54, 10237
    v_alignbyte_b32 v111, v111, v110, 1
    v_perm_b32 v110, v110, v114, s47
    s_waitcnt lgkmcnt(1)
    v_add3_u32 v116, v116, v106, s54
    v_sub_u32 v117, 0, v116
    v_and_b32 v117, 3, v117
    s_mov_b64 exec, s[80:81]
    v_mov_b32 v117, 0
    v_mov_b32 v112, 0
    s_mov_b64 exec, vcc
    v_mov_b32 v117, 3

    s_mov_b64 exec, -1
    v_alignbyte_b32 v110, v111, v110, v117
    v_alignbyte_b32 v111, v112, v111, v117
    v_add_u32 v116, v116, v117

    buffer_store_dwordx2 v[110:111], v116, s[24:27], 0 offen
    v_cmp_ne_u32_sdwa s[80:81], v119, v121 src0_sel:WORD_1 src1_sel:WORD_1
    v_cmp_ne_u32_sdwa vcc, v119, v123 src0_sel:WORD_1 src1_sel:WORD_1
    v_alignbyte_b32 v122, v123, v122, 2
    s_mov_b32 s54, 15357
    v_alignbyte_b32 v119, v119, v118, 1
    v_perm_b32 v118, v118, v122, s47
    s_waitcnt lgkmcnt(0)
    v_add3_u32 v124, v124, v106, s54
    v_sub_u32 v125, 0, v124
    v_and_b32 v125, 3, v125
    s_mov_b64 exec, s[80:81]
    v_mov_b32 v125, 0
    v_mov_b32 v120, 0
    s_mov_b64 exec, vcc
    v_mov_b32 v125, 3

    s_mov_b64 exec, -1
    v_alignbyte_b32 v118, v119, v118, v125
    v_alignbyte_b32 v119, v120, v119, v125
    v_add_u32 v124, v124, v125

    buffer_store_dwordx2 v[118:119], v124, s[24:27], 0 offen
L_skw_29:
    s_bitcmp0_b32 s28, 1
    s_cbranch_scc1 L_skw_30
    v_add_u32 v107, 32768, v2
    ds_read_b64 v[110:111], v107 offset:16400
    ds_read_b64 v[112:113], v107 offset:16408
    ds_read_b64 v[114:115], v107 offset:16392

    ds_read_b64 v[118:119], v107 offset:24592
    ds_read_b64 v[120:121], v107 offset:24600
    ds_read_b64 v[122:123], v107 offset:24584

    s_waitcnt lgkmcnt(3)
    v_lshrrev_b32 v116, 16, v111
    ds_read_b32 v116, v116 offset:8192

    s_waitcnt lgkmcnt(1)
    v_lshrrev_b32 v124, 16, v119
    ds_read_b32 v124, v124 offset:8192

    v_cmp_ne_u32_sdwa s[80:81], v111, v113 src0_sel:WORD_1 src1_sel:WORD_1
    v_cmp_ne_u32_sdwa vcc, v111, v115 src0_sel:WORD_1 src1_sel:WORD_1
    v_alignbyte_b32 v114, v115, v114, 2
    s_mov_b32 s54, 20477
    v_alignbyte_b32 v111, v111, v110, 1
    v_perm_b32 v110, v110, v114, s47
    s_waitcnt lgkmcnt(1)
    v_add3_u32 v116, v116, v106, s54
    v_sub_u32 v117, 0, v116
    v_and_b32 v117, 3, v117
    s_mov_b64 exec, s[80:81]
    v_mov_b32 v117, 0
    v_mov_b32 v112, 0
    s_mov_b64 exec, vcc
    v_mov_b32 v117, 3

    s_mov_b64 exec, -1
    v_alignbyte_b32 v110, v111, v110, v117
    v_alignbyte_b32 v111, v112, v111, v117
    v_add_u32 v116, v116, v117

    buffer_store_dwordx2 v[110:111], v116, s[24:27], 0 offen
    v_cmp_ne_u32_sdwa s[80:81], v119, v121 src0_sel:WORD_1 src1_sel:WORD_1
    v_cmp_ne_u32_sdwa vcc, v119, v123 src0_sel:WORD_1 src1_sel:WORD_1
    v_alignbyte_b32 v122, v123, v122, 2
    s_mov_b32 s54, 25597
    v_alignbyte_b32 v119, v119, v118, 1
    v_perm_b32 v118, v118, v122, s47
    s_waitcnt lgkmcnt(0)
    v_add3_u32 v124, v124, v106, s54
    v_sub_u32 v125, 0, v124
    v_and_b32 v125, 3, v125
    s_mov_b64 exec, s[80:81]
    v_mov_b32 v125, 0
    v_mov_b32 v120, 0
    s_mov_b64 exec, vcc
    v_mov_b32 v125, 3

    s_mov_b64 exec, -1
    v_alignbyte_b32 v118, v119, v118, v125
    v_alignbyte_b32 v119, v120, v119, v125
    v_add_u32 v124, v124, v125

    buffer_store_dwordx2 v[118:119], v124, s[24:27], 0 offen
L_skw_30:
    s_bitcmp0_b32 s28, 1
    s_cbranch_scc1 L_skw_31
    v_add_u32 v107, 32768, v2
    ds_read_b64 v[110:111], v107 offset:32784
    ds_read_b64 v[112:113], v107 offset:32792
    ds_read_b64 v[114:115], v107 offset:32776

    ds_read_b64 v[118:119], v107 offset:40976
    ds_read_b64 v[120:121], v107 offset:40984
    ds_read_b64 v[122:123], v107 offset:40968

    s_waitcnt lgkmcnt(3)
    v_lshrrev_b32 v116, 16, v111
    ds_read_b32 v116, v116 offset:8192

    s_waitcnt lgkmcnt(1)
    v_lshrrev_b32 v124, 16, v119
    ds_read_b32 v124, v124 offset:8192

    v_cmp_ne_u32_sdwa s[80:81], v111, v113 src0_sel:WORD_1 src1_sel:WORD_1
    v_cmp_ne_u32_sdwa vcc, v111, v115 src0_sel:WORD_1 src1_sel:WORD_1
    v_alignbyte_b32 v114, v115, v114, 2
    s_mov_b32 s54, 30717
    v_alignbyte_b32 v111, v111, v110, 1
    v_perm_b32 v110, v110, v114, s47
    s_waitcnt lgkmcnt(1)
    v_add3_u32 v116, v116, v106, s54
    v_sub_u32 v117, 0, v116
    v_and_b32 v117, 3, v117
    s_mov_b64 exec, s[80:81]
    v_mov_b32 v117, 0
    v_mov_b32 v112, 0
    s_mov_b64 exec, vcc
    v_mov_b32 v117, 3

    s_mov_b64 exec, -1
    v_alignbyte_b32 v110, v111, v110, v117
    v_alignbyte_b32 v111, v112, v111, v117
    v_add_u32 v116, v116, v117

    buffer_store_dwordx2 v[110:111], v116, s[24:27], 0 offen
    v_cmp_ne_u32_sdwa s[80:81], v119, v121 src0_sel:WORD_1 src1_sel:WORD_1
    v_cmp_ne_u32_sdwa vcc, v119, v123 src0_sel:WORD_1 src1_sel:WORD_1
    v_alignbyte_b32 v122, v123, v122, 2
    s_mov_b32 s54, 35837
    v_alignbyte_b32 v119, v119, v118, 1
    v_perm_b32 v118, v118, v122, s47
    s_waitcnt lgkmcnt(0)
    v_add3_u32 v124, v124, v106, s54
    v_sub_u32 v125, 0, v124
    v_and_b32 v125, 3, v125
    s_mov_b64 exec, s[80:81]
    v_mov_b32 v125, 0
    v_mov_b32 v120, 0
    s_mov_b64 exec, vcc
    v_mov_b32 v125, 3

    s_mov_b64 exec, -1
    v_alignbyte_b32 v118, v119, v118, v125
    v_alignbyte_b32 v119, v120, v119, v125
    v_add_u32 v124, v124, v125

    buffer_store_dwordx2 v[118:119], v124, s[24:27], 0 offen
L_skw_31:
    s_mov_b64 exec, s[66:67]
    v_mul_hi_u32_u24 v69, s40, v32
    v_mul_hi_u32_u24 v68, s40, v16
    v_mul_hi_u32_u24 v71, s40, v33
    v_mul_hi_u32_u24 v70, s40, v17
    v_mul_hi_u32_u24 v73, s40, v34
    v_mul_hi_u32_u24 v72, s40, v18
    v_mul_hi_u32_u24 v75, s40, v35
    v_mul_hi_u32_u24 v74, s40, v19
    v_and_b32 v69, -2, v69
    v_mad_u32_u24 v16, v68, s43, v16
    v_and_b32 v88, -4, v68
    v_and_b32 v71, -2, v71
    v_mad_u32_u24 v17, v70, s43, v17
    v_and_b32 v89, -4, v70
    v_and_b32 v73, -2, v73
    v_mad_u32_u24 v18, v72, s43, v18
    v_and_b32 v90, -4, v72
    v_and_b32 v75, -2, v75
    v_mad_u32_u24 v19, v74, s43, v19
    v_and_b32 v91, -4, v74
    v_mad_i32_i24 v32, v69, s42, v32
    v_lshl_add_u32 v69, v88, 5, v69
    v_mad_i32_i24 v33, v71, s42, v33
    v_lshl_add_u32 v71, v89, 5, v71
    v_mad_i32_i24 v34, v73, s42, v34
    v_lshl_add_u32 v73, v90, 5, v73
    v_mad_i32_i24 v35, v75, s42, v35
    v_lshl_add_u32 v75, v91, 5, v75
    v_add_u32 v69, v69, v69
    ds_add_rtn_u32 v88, v69, v104
    v_add_u32 v71, v71, v71
    ds_add_rtn_u32 v89, v71, v104
    v_add_u32 v73, v73, v73
    ds_add_rtn_u32 v90, v73, v104
    v_add_u32 v75, v75, v75
    ds_add_rtn_u32 v91, v75, v104
    v_lshlrev_b32 v110, 16, v42
    v_and_b32 v111, 0xffff0000, v42
    v_lshlrev_b32 v112, 16, v43
    v_and_b32 v113, 0xffff0000, v43
    v_mul_f32 v110, s44, v110
    v_mul_f32 v111, s44, v111
    v_mul_f32 v112, s44, v112
    v_mul_f32 v113, s44, v113
    v_fract_f32 v110, v110
    v_fract_f32 v111, v111
    v_fract_f32 v112, v112
    v_fract_f32 v113, v113
    v_cos_f32 v110, v110
    v_cos_f32 v111, v111
    v_cos_f32 v112, v112
    v_cos_f32 v113, v113
    v_lshl_or_b32 v68, v68, 14, v32
    v_perm_b32 v69, v69, v16, s46
    v_bfe_u32 v16, v16, 8, 5

    v_lshl_or_b32 v70, v70, 14, v33
    v_perm_b32 v71, v71, v17, s46
    v_bfe_u32 v17, v17, 8, 5

    v_lshl_or_b32 v72, v72, 14, v34
    v_perm_b32 v73, v73, v18, s46
    v_bfe_u32 v18, v18, 8, 5

    v_lshl_or_b32 v74, v74, 14, v35
    v_perm_b32 v75, v75, v19, s46
    v_bfe_u32 v19, v19, 8, 5

    v_fmaak_f32 v110, v110, v105, 0x4b400010
    v_fmaak_f32 v111, v111, v105, 0x4b400010
    v_fmaak_f32 v112, v112, v105, 0x4b400010
    v_fmaak_f32 v113, v113, v105, 0x4b400010
    v_sub_u32 v110, v110, v16
    v_sub_u32 v111, v111, v17
    v_sub_u32 v112, v112, v18
    v_sub_u32 v113, v113, v19
    v_bfi_b32 v110, 31, v16, v110
    v_bfi_b32 v111, 31, v17, v111
    v_bfi_b32 v112, 31, v18, v112
    v_bfi_b32 v113, 31, v19, v113
    v_perm_b32 v68, v68, v110, s55
    v_perm_b32 v70, v70, v111, s55
    v_perm_b32 v72, v72, v112, s55
    v_perm_b32 v74, v74, v113, s55
    s_mov_b64 exec, -1
    s_bitcmp0_b32 s28, 2
    s_cbranch_scc1 L_skw_33
    v_add_u32 v107, 65536, v2
    ds_read_b64 v[110:111], v107 offset:16400
    ds_read_b64 v[112:113], v107 offset:16408
    ds_read_b64 v[114:115], v107 offset:16392

    ds_read_b64 v[118:119], v107 offset:24592
    ds_read_b64 v[120:121], v107 offset:24600
    ds_read_b64 v[122:123], v107 offset:24584

    s_waitcnt lgkmcnt(3)
    v_lshrrev_b32 v116, 16, v111
    ds_read_b32 v116, v116 offset:8192

    s_waitcnt lgkmcnt(1)
    v_lshrrev_b32 v124, 16, v119
    ds_read_b32 v124, v124 offset:8192

    v_cmp_ne_u32_sdwa s[80:81], v111, v113 src0_sel:WORD_1 src1_sel:WORD_1
    v_cmp_ne_u32_sdwa vcc, v111, v115 src0_sel:WORD_1 src1_sel:WORD_1
    v_alignbyte_b32 v114, v115, v114, 2
    s_mov_b32 s54, 40957
    v_alignbyte_b32 v111, v111, v110, 1
    v_perm_b32 v110, v110, v114, s47
    s_waitcnt lgkmcnt(1)
    v_add3_u32 v116, v116, v106, s54
    v_sub_u32 v117, 0, v116
    v_and_b32 v117, 3, v117
    s_mov_b64 exec, s[80:81]
    v_mov_b32 v117, 0
    v_mov_b32 v112, 0
    s_mov_b64 exec, vcc
    v_mov_b32 v117, 3

    s_mov_b64 exec, -1
    v_alignbyte_b32 v110, v111, v110, v117
    v_alignbyte_b32 v111, v112, v111, v117
    v_add_u32 v116, v116, v117

    buffer_store_dwordx2 v[110:111], v116, s[24:27], 0 offen
    v_cmp_ne_u32_sdwa s[80:81], v119, v121 src0_sel:WORD_1 src1_sel:WORD_1
    v_cmp_ne_u32_sdwa vcc, v119, v123 src0_sel:WORD_1 src1_sel:WORD_1
    v_alignbyte_b32 v122, v123, v122, 2
    s_mov_b32 s54, 46077
    v_alignbyte_b32 v119, v119, v118, 1
    v_perm_b32 v118, v118, v122, s47
    s_waitcnt lgkmcnt(0)
    v_add3_u32 v124, v124, v106, s54
    v_sub_u32 v125, 0, v124
    v_and_b32 v125, 3, v125
    s_mov_b64 exec, s[80:81]
    v_mov_b32 v125, 0
    v_mov_b32 v120, 0
    s_mov_b64 exec, vcc
    v_mov_b32 v125, 3

    s_mov_b64 exec, -1
    v_alignbyte_b32 v118, v119, v118, v125
    v_alignbyte_b32 v119, v120, v119, v125
    v_add_u32 v124, v124, v125

    buffer_store_dwordx2 v[118:119], v124, s[24:27], 0 offen
L_skw_33:
    s_bitcmp0_b32 s28, 2
    s_cbranch_scc1 L_skw_34
    v_add_u32 v107, 65536, v2
    ds_read_b64 v[110:111], v107 offset:32784
    ds_read_b64 v[112:113], v107 offset:32792
    ds_read_b64 v[114:115], v107 offset:32776

    ds_read_b64 v[118:119], v107 offset:40976
    ds_read_b64 v[120:121], v107 offset:40984
    ds_read_b64 v[122:123], v107 offset:40968

    s_waitcnt lgkmcnt(3)
    v_lshrrev_b32 v116, 16, v111
    ds_read_b32 v116, v116 offset:8192

    s_waitcnt lgkmcnt(1)
    v_lshrrev_b32 v124, 16, v119
    ds_read_b32 v124, v124 offset:8192

    v_cmp_ne_u32_sdwa s[80:81], v111, v113 src0_sel:WORD_1 src1_sel:WORD_1
    v_cmp_ne_u32_sdwa vcc, v111, v115 src0_sel:WORD_1 src1_sel:WORD_1
    v_alignbyte_b32 v114, v115, v114, 2
    s_mov_b32 s54, 51197
    v_alignbyte_b32 v111, v111, v110, 1
    v_perm_b32 v110, v110, v114, s47
    s_waitcnt lgkmcnt(1)
    v_add3_u32 v116, v116, v106, s54
    v_sub_u32 v117, 0, v116
    v_and_b32 v117, 3, v117
    s_mov_b64 exec, s[80:81]
    v_mov_b32 v117, 0
    v_mov_b32 v112, 0
    s_mov_b64 exec, vcc
    v_mov_b32 v117, 3

    s_mov_b64 exec, -1
    v_alignbyte_b32 v110, v111, v110, v117
    v_alignbyte_b32 v111, v112, v111, v117
    v_add_u32 v116, v116, v117

    buffer_store_dwordx2 v[110:111], v116, s[24:27], 0 offen
    v_cmp_ne_u32_sdwa s[80:81], v119, v121 src0_sel:WORD_1 src1_sel:WORD_1
    v_cmp_ne_u32_sdwa vcc, v119, v123 src0_sel:WORD_1 src1_sel:WORD_1
    v_alignbyte_b32 v122, v123, v122, 2
    s_mov_b32 s54, 56317
    v_alignbyte_b32 v119, v119, v118, 1
    v_perm_b32 v118, v118, v122, s47
    s_waitcnt lgkmcnt(0)
    v_add3_u32 v124, v124, v106, s54
    v_sub_u32 v125, 0, v124
    v_and_b32 v125, 3, v125
    s_mov_b64 exec, s[80:81]
    v_mov_b32 v125, 0
    v_mov_b32 v120, 0
    s_mov_b64 exec, vcc
    v_mov_b32 v125, 3

    s_mov_b64 exec, -1
    v_alignbyte_b32 v118, v119, v118, v125
    v_alignbyte_b32 v119, v120, v119, v125
    v_add_u32 v124, v124, v125

    buffer_store_dwordx2 v[118:119], v124, s[24:27], 0 offen
L_skw_34:
    s_bitcmp0_b32 s28, 3
    s_cbranch_scc1 L_skw_35
    v_add_u32 v107, 98304, v2
    ds_read_b64 v[110:111], v107 offset:16400
    ds_read_b64 v[112:113], v107 offset:16408
    ds_read_b64 v[114:115], v107 offset:16392

    ds_read_b64 v[118:119], v107 offset:24592
    ds_read_b64 v[120:121], v107 offset:24600
    ds_read_b64 v[122:123], v107 offset:24584

    s_waitcnt lgkmcnt(3)
    v_lshrrev_b32 v116, 16, v111
    ds_read_b32 v116, v116 offset:8192

    s_waitcnt lgkmcnt(1)
    v_lshrrev_b32 v124, 16, v119
    ds_read_b32 v124, v124 offset:8192

    v_cmp_ne_u32_sdwa s[80:81], v111, v113 src0_sel:WORD_1 src1_sel:WORD_1
    v_cmp_ne_u32_sdwa vcc, v111, v115 src0_sel:WORD_1 src1_sel:WORD_1
    v_alignbyte_b32 v114, v115, v114, 2
    s_mov_b32 s54, 61437
    v_alignbyte_b32 v111, v111, v110, 1
    v_perm_b32 v110, v110, v114, s47
    s_waitcnt lgkmcnt(1)
    v_add3_u32 v116, v116, v106, s54
    v_sub_u32 v117, 0, v116
    v_and_b32 v117, 3, v117
    s_mov_b64 exec, s[80:81]
    v_mov_b32 v117, 0
    v_mov_b32 v112, 0
    s_mov_b64 exec, vcc
    v_mov_b32 v117, 3

    s_mov_b64 exec, -1
    v_alignbyte_b32 v110, v111, v110, v117
    v_alignbyte_b32 v111, v112, v111, v117
    v_add_u32 v116, v116, v117

    buffer_store_dwordx2 v[110:111], v116, s[24:27], 0 offen
    v_cmp_ne_u32_sdwa s[80:81], v119, v121 src0_sel:WORD_1 src1_sel:WORD_1
    v_cmp_ne_u32_sdwa vcc, v119, v123 src0_sel:WORD_1 src1_sel:WORD_1
    v_alignbyte_b32 v122, v123, v122, 2
    s_mov_b32 s54, 66557
    v_alignbyte_b32 v119, v119, v118, 1
    v_perm_b32 v118, v118, v122, s47
    s_waitcnt lgkmcnt(0)
    v_add3_u32 v124, v124, v106, s54
    v_sub_u32 v125, 0, v124
    v_and_b32 v125, 3, v125
    s_mov_b64 exec, s[80:81]
    v_mov_b32 v125, 0
    v_mov_b32 v120, 0
    s_mov_b64 exec, vcc
    v_mov_b32 v125, 3

    s_mov_b64 exec, -1
    v_alignbyte_b32 v118, v119, v118, v125
    v_alignbyte_b32 v119, v120, v119, v125
    v_add_u32 v124, v124, v125

    buffer_store_dwordx2 v[118:119], v124, s[24:27], 0 offen
L_skw_35:
    s_bitcmp0_b32 s28, 3
    s_cbranch_scc1 L_skw_36
    v_add_u32 v107, 98304, v2
    ds_read_b64 v[110:111], v107 offset:32784
    ds_read_b64 v[112:113], v107 offset:32792
    ds_read_b64 v[114:115], v107 offset:32776

    ds_read_b64 v[118:119], v107 offset:40976
    ds_read_b64 v[120:121], v107 offset:40984
    ds_read_b64 v[122:123], v107 offset:40968

    s_waitcnt lgkmcnt(3)
    v_lshrrev_b32 v116, 16, v111
    ds_read_b32 v116, v116 offset:8192

    s_waitcnt lgkmcnt(1)
    v_lshrrev_b32 v124, 16, v119
    ds_read_b32 v124, v124 offset:8192

    v_cmp_ne_u32_sdwa s[80:81], v111, v113 src0_sel:WORD_1 src1_sel:WORD_1
    v_cmp_ne_u32_sdwa vcc, v111, v115 src0_sel:WORD_1 src1_sel:WORD_1
    v_alignbyte_b32 v114, v115, v114, 2
    s_mov_b32 s54, 71677
    v_alignbyte_b32 v111, v111, v110, 1
    v_perm_b32 v110, v110, v114, s47
    s_waitcnt lgkmcnt(1)
    v_add3_u32 v116, v116, v106, s54
    v_sub_u32 v117, 0, v116
    v_and_b32 v117, 3, v117
    s_mov_b64 exec, s[80:81]
    v_mov_b32 v117, 0
    v_mov_b32 v112, 0
    s_mov_b64 exec, vcc
    v_mov_b32 v117, 3

    s_mov_b64 exec, -1
    v_alignbyte_b32 v110, v111, v110, v117
    v_alignbyte_b32 v111, v112, v111, v117
    v_add_u32 v116, v116, v117

    buffer_store_dwordx2 v[110:111], v116, s[24:27], 0 offen
    v_cmp_ne_u32_sdwa s[80:81], v119, v121 src0_sel:WORD_1 src1_sel:WORD_1
    v_cmp_ne_u32_sdwa vcc, v119, v123 src0_sel:WORD_1 src1_sel:WORD_1
    v_alignbyte_b32 v122, v123, v122, 2
    s_mov_b32 s54, 76797
    v_alignbyte_b32 v119, v119, v118, 1
    v_perm_b32 v118, v118, v122, s47
    s_waitcnt lgkmcnt(0)
    v_add3_u32 v124, v124, v106, s54
    v_sub_u32 v125, 0, v124
    v_and_b32 v125, 3, v125
    s_mov_b64 exec, s[80:81]
    v_mov_b32 v125, 0
    v_mov_b32 v120, 0
    s_mov_b64 exec, vcc
    v_mov_b32 v125, 3

    s_andn2_b64 exec, -1, s[68:69]
    v_bfrev_b32 v124, 1
    s_mov_b64 exec, -1
    v_alignbyte_b32 v118, v119, v118, v125
    v_alignbyte_b32 v119, v120, v119, v125
    v_add_u32 v124, v124, v125

    buffer_store_dwordx2 v[118:119], v124, s[24:27], 0 offen
L_skw_36:
    s_mov_b32 s28, 15
    s_mov_b32 s29, 0
    s_movk_i32 s30, 16000

    s_waitcnt lgkmcnt(0)
    s_barrier

    buffer_load_dwordx4 v[20:23], v1, s[12:15], s56 offen nt
    buffer_load_dwordx4 v[4:7], v1, s[8:11], s56 offen nt
    buffer_load_dwordx2 v[36:37], v2, s[16:19], s61 offen nt
    ds_read_b64 v[94:95], v2
    s_waitcnt lgkmcnt(0)
    v_and_b32 v94, 0xffff, v94
    v_and_b32 v95, 0xffff, v95
    v_add_u32 v97, v94, v95
    s_nop 1
    v_add_u32_dpp v97, v97, v97 row_shr:1 row_mask:0xf bank_mask:0xf
    s_nop 1
    v_add_u32_dpp v97, v97, v97 row_shr:2 row_mask:0xf bank_mask:0xf
    s_nop 1
    v_add_u32_dpp v97, v97, v97 row_shr:4 row_mask:0xf bank_mask:0xf
    s_nop 1
    v_add_u32_dpp v97, v97, v97 row_shr:8 row_mask:0xf bank_mask:0xf
    s_nop 1
    v_add_u32_dpp v97, v97, v97 row_bcast:15 row_mask:0xa bank_mask:0xf
    s_nop 1
    v_add_u32_dpp v97, v97, v97 row_bcast:31 row_mask:0xc bank_mask:0xf
    s_mov_b32 exec_lo, 0
    s_brev_b32 exec_hi, 1
    ds_add_rtn_u32 v96, v108, v97
    s_mov_b64 exec, -1

    v_add_u32 v92, v94, v94
    v_add_u32 v93, v95, v95
    v_med3_u32 v92, v94, 2, v92
    v_med3_u32 v93, v95, 2, v93
    buffer_atomic_add_x2 v[92:93], v2, s[20:23], 0 offen sc0
    s_waitcnt lgkmcnt(0)
    v_readlane_b32 s77, v96, 63
    v_mul_u32_u24 v114, 7936, v0
    v_sub_u32 v97, v97, v95
    s_sub_u32 s77, s77, s50
    v_add_u32 v97, s77, v97
    v_sub_u32 v96, v97, v94
    v_lshlrev_b32 v111, 16, v97
    v_lshlrev_b32 v110, 16, v96
    ds_write_b64 v2, v[110:111]
    v_sub_u32 v96, v114, v96
    v_sub_u32 v97, v114, v97
    v_add_u32 v97, s48, v97
    s_add_u32 s50, s50, s30

    s_waitcnt lgkmcnt(0)
    s_barrier

    buffer_load_dwordx4 v[24:27], v1, s[12:15], s57 offen nt
    buffer_load_dwordx4 v[8:11], v1, s[8:11], s57 offen nt
    buffer_load_dwordx2 v[38:39], v2, s[16:19], s62 offen nt
    buffer_load_dwordx4 v[28:31], v1, s[12:15], s58 offen nt
    buffer_load_dwordx4 v[12:15], v1, s[8:11], s58 offen nt
    buffer_load_dwordx2 v[40:41], v2, s[16:19], s63 offen nt
    buffer_load_dwordx4 v[32:35], v1, s[12:15], s59 offen nt
    buffer_load_dwordx4 v[16:19], v1, s[8:11], s59 offen nt
    buffer_load_dwordx2 v[42:43], v2, s[16:19], s64 offen nt
    v_lshrrev_b32 v110, 16, v45
    ds_read_b32 v110, v110
    v_lshrrev_b32 v111, 16, v47
    ds_read_b32 v111, v111
    v_lshrrev_b32 v112, 16, v49
    ds_read_b32 v112, v112
    v_lshrrev_b32 v113, 16, v51
    ds_read_b32 v113, v113
    v_lshrrev_b32 v114, 16, v53
    ds_read_b32 v114, v114
    v_lshrrev_b32 v115, 16, v55
    ds_read_b32 v115, v115
    v_lshrrev_b32 v116, 16, v57
    ds_read_b32 v116, v116
    v_lshrrev_b32 v117, 16, v59
    ds_read_b32 v117, v117
    s_waitcnt lgkmcnt(7)
    v_add_u32_sdwa v110, v110, v76 dst_sel:DWORD dst_unused:UNUSED_PAD src0_sel:WORD_1 src1_sel:WORD_0
    v_lshlrev_b32 v110, 3, v110
    ds_write_b64 v110, v[44:45] offset:16400

    s_waitcnt lgkmcnt(7)
    v_add_u32_sdwa v111, v111, v77 dst_sel:DWORD dst_unused:UNUSED_PAD src0_sel:WORD_1 src1_sel:WORD_0
    v_lshlrev_b32 v111, 3, v111
    ds_write_b64 v111, v[46:47] offset:16400

    s_waitcnt lgkmcnt(7)
    v_add_u32_sdwa v112, v112, v78 dst_sel:DWORD dst_unused:UNUSED_PAD src0_sel:WORD_1 src1_sel:WORD_0
    v_lshlrev_b32 v112, 3, v112
    ds_write_b64 v112, v[48:49] offset:16400

    s_waitcnt lgkmcnt(7)
    v_add_u32_sdwa v113, v113, v79 dst_sel:DWORD dst_unused:UNUSED_PAD src0_sel:WORD_1 src1_sel:WORD_0
    v_lshlrev_b32 v113, 3, v113
    ds_write_b64 v113, v[50:51] offset:16400

    s_waitcnt lgkmcnt(7)
    v_add_u32_sdwa v114, v114, v80 dst_sel:DWORD dst_unused:UNUSED_PAD src0_sel:WORD_1 src1_sel:WORD_0
    v_lshlrev_b32 v114, 3, v114
    ds_write_b64 v114, v[52:53] offset:16400

    s_waitcnt lgkmcnt(7)
    v_add_u32_sdwa v115, v115, v81 dst_sel:DWORD dst_unused:UNUSED_PAD src0_sel:WORD_1 src1_sel:WORD_0
    v_lshlrev_b32 v115, 3, v115
    ds_write_b64 v115, v[54:55] offset:16400

    s_waitcnt lgkmcnt(7)
    v_add_u32_sdwa v116, v116, v82 dst_sel:DWORD dst_unused:UNUSED_PAD src0_sel:WORD_1 src1_sel:WORD_0
    v_lshlrev_b32 v116, 3, v116
    ds_write_b64 v116, v[56:57] offset:16400

    s_waitcnt lgkmcnt(7)
    v_add_u32_sdwa v117, v117, v83 dst_sel:DWORD dst_unused:UNUSED_PAD src0_sel:WORD_1 src1_sel:WORD_0
    v_lshlrev_b32 v117, 3, v117
    ds_write_b64 v117, v[58:59] offset:16400

    v_lshrrev_b32 v110, 16, v61
    ds_read_b32 v110, v110
    v_lshrrev_b32 v111, 16, v63
    ds_read_b32 v111, v111
    v_lshrrev_b32 v112, 16, v65
    ds_read_b32 v112, v112
    v_lshrrev_b32 v113, 16, v67
    ds_read_b32 v113, v113
    s_waitcnt lgkmcnt(3)
    v_add_u32_sdwa v110, v110, v84 dst_sel:DWORD dst_unused:UNUSED_PAD src0_sel:WORD_1 src1_sel:WORD_0
    v_lshlrev_b32 v110, 3, v110
    ds_write_b64 v110, v[60:61] offset:16400

    s_waitcnt lgkmcnt(3)
    v_add_u32_sdwa v111, v111, v85 dst_sel:DWORD dst_unused:UNUSED_PAD src0_sel:WORD_1 src1_sel:WORD_0
    v_lshlrev_b32 v111, 3, v111
    ds_write_b64 v111, v[62:63] offset:16400

    s_waitcnt lgkmcnt(3)
    v_add_u32_sdwa v112, v112, v86 dst_sel:DWORD dst_unused:UNUSED_PAD src0_sel:WORD_1 src1_sel:WORD_0
    v_lshlrev_b32 v112, 3, v112
    ds_write_b64 v112, v[64:65] offset:16400

    s_waitcnt lgkmcnt(3)
    v_add_u32_sdwa v113, v113, v87 dst_sel:DWORD dst_unused:UNUSED_PAD src0_sel:WORD_1 src1_sel:WORD_0
    v_lshlrev_b32 v113, 3, v113
    ds_write_b64 v113, v[66:67] offset:16400

    s_mov_b64 exec, s[66:67]
    v_lshrrev_b32 v110, 16, v69
    ds_read_b32 v110, v110
    v_lshrrev_b32 v111, 16, v71
    ds_read_b32 v111, v111
    v_lshrrev_b32 v112, 16, v73
    ds_read_b32 v112, v112
    v_lshrrev_b32 v113, 16, v75
    ds_read_b32 v113, v113
    s_waitcnt lgkmcnt(3)
    v_add_u32_sdwa v110, v110, v88 dst_sel:DWORD dst_unused:UNUSED_PAD src0_sel:WORD_1 src1_sel:WORD_0
    v_lshlrev_b32 v110, 3, v110
    ds_write_b64 v110, v[68:69] offset:16400

    s_waitcnt lgkmcnt(3)
    v_add_u32_sdwa v111, v111, v89 dst_sel:DWORD dst_unused:UNUSED_PAD src0_sel:WORD_1 src1_sel:WORD_0
    v_lshlrev_b32 v111, 3, v111
    ds_write_b64 v111, v[70:71] offset:16400

    s_waitcnt lgkmcnt(3)
    v_add_u32_sdwa v112, v112, v90 dst_sel:DWORD dst_unused:UNUSED_PAD src0_sel:WORD_1 src1_sel:WORD_0
    v_lshlrev_b32 v112, 3, v112
    ds_write_b64 v112, v[72:73] offset:16400

    s_waitcnt lgkmcnt(3)
    v_add_u32_sdwa v113, v113, v91 dst_sel:DWORD dst_unused:UNUSED_PAD src0_sel:WORD_1 src1_sel:WORD_0
    v_lshlrev_b32 v113, 3, v113
    ds_write_b64 v113, v[74:75] offset:16400

    s_mov_b64 exec, -1
    s_cmp_lg_u32 s49, 0
    s_cbranch_scc1 L_p1loop_5
L_p1epi_6:
    s_waitcnt vmcnt(0)
    s_waitcnt vmcnt(9)
    v_add_u32 v110, v92, v94
    v_min_u32 v92, s48, v92
    v_add_u32 v111, v93, v95
    v_min_u32 v93, s48, v93
    v_max_u32 v110, v110, v111
    v_add_u32 v92, v92, v96
    v_add_u32 v93, v93, v97
    v_cmp_le_u32 vcc, s48, v110
    v_lshl_add_u32 v92, v92, 2, v92
    v_lshl_add_u32 v93, v93, 2, v93
    ds_write_b64 v2, v[92:93] offset:8192
    s_cbranch_vccz L_noov_40
    ds_write_b32 v108, v104 offset:4
L_noov_40:

    s_waitcnt lgkmcnt(0)
    s_barrier
    ds_read_b32 v110, v108 offset:4
    s_waitcnt lgkmcnt(0)
    v_readfirstlane_b32 s53, v110
    s_nop 1

    s_cmp_lg_u32 s53, 0
    s_cbranch_scc1 L_slow_41
L_sback_42:
    s_bitcmp0_b32 s28, 0
    s_cbranch_scc1 L_skw_46
    ds_read_b64 v[4:5], v2 offset:16400
    ds_read_b64 v[6:7], v2 offset:16408
    ds_read_b64 v[8:9], v2 offset:16392

    ds_read_b64 v[12:13], v2 offset:24592
    ds_read_b64 v[14:15], v2 offset:24600
    ds_read_b64 v[16:17], v2 offset:24584

    ds_read_b64 v[20:21], v2 offset:32784
    ds_read_b64 v[22:23], v2 offset:32792
    ds_read_b64 v[24:25], v2 offset:32776

    ds_read_b64 v[28:29], v2 offset:40976
    ds_read_b64 v[30:31], v2 offset:40984
    ds_read_b64 v[32:33], v2 offset:40968

    s_waitcnt lgkmcnt(9)
    v_lshrrev_b32 v10, 16, v5
    ds_read_b32 v10, v10 offset:8192

    s_waitcnt lgkmcnt(7)
    v_lshrrev_b32 v18, 16, v13
    ds_read_b32 v18, v18 offset:8192

    s_waitcnt lgkmcnt(5)
    v_lshrrev_b32 v26, 16, v21
    ds_read_b32 v26, v26 offset:8192

    s_waitcnt lgkmcnt(3)
    v_lshrrev_b32 v34, 16, v29
    ds_read_b32 v34, v34 offset:8192

    v_cmp_ne_u32_sdwa s[80:81], v5, v7 src0_sel:WORD_1 src1_sel:WORD_1
    v_cmp_ne_u32_sdwa vcc, v5, v9 src0_sel:WORD_1 src1_sel:WORD_1
    v_alignbyte_b32 v8, v9, v8, 2
    s_mov_b32 s54, -3
    v_alignbyte_b32 v5, v5, v4, 1
    v_perm_b32 v4, v4, v8, s47
    s_waitcnt lgkmcnt(3)
    v_add3_u32 v10, v10, v106, s54
    v_sub_u32 v11, 0, v10
    v_and_b32 v11, 3, v11
    s_mov_b64 exec, s[80:81]
    v_mov_b32 v11, 0
    v_mov_b32 v6, 0
    s_mov_b64 exec, vcc
    v_mov_b32 v11, 3

    s_mov_b64 exec, -1
    v_alignbyte_b32 v4, v5, v4, v11
    v_alignbyte_b32 v5, v6, v5, v11
    v_add_u32 v10, v10, v11

    buffer_store_dwordx2 v[4:5], v10, s[24:27], 0 offen
    v_cmp_ne_u32_sdwa s[80:81], v13, v15 src0_sel:WORD_1 src1_sel:WORD_1
    v_cmp_ne_u32_sdwa vcc, v13, v17 src0_sel:WORD_1 src1_sel:WORD_1
    v_alignbyte_b32 v16, v17, v16, 2
    s_mov_b32 s54, 5117
    v_alignbyte_b32 v13, v13, v12, 1
    v_perm_b32 v12, v12, v16, s47
    s_waitcnt lgkmcnt(2)
    v_add3_u32 v18, v18, v106, s54
    v_sub_u32 v19, 0, v18
    v_and_b32 v19, 3, v19
    s_mov_b64 exec, s[80:81]
    v_mov_b32 v19, 0
    v_mov_b32 v14, 0
    s_mov_b64 exec, vcc
    v_mov_b32 v19, 3

    s_mov_b64 exec, -1
    v_alignbyte_b32 v12, v13, v12, v19
    v_alignbyte_b32 v13, v14, v13, v19
    v_add_u32 v18, v18, v19

    buffer_store_dwordx2 v[12:13], v18, s[24:27], 0 offen
    v_cmp_ne_u32_sdwa s[80:81], v21, v23 src0_sel:WORD_1 src1_sel:WORD_1
    v_cmp_ne_u32_sdwa vcc, v21, v25 src0_sel:WORD_1 src1_sel:WORD_1
    v_alignbyte_b32 v24, v25, v24, 2
    s_mov_b32 s54, 10237
    v_alignbyte_b32 v21, v21, v20, 1
    v_perm_b32 v20, v20, v24, s47
    s_waitcnt lgkmcnt(1)
    v_add3_u32 v26, v26, v106, s54
    v_sub_u32 v27, 0, v26
    v_and_b32 v27, 3, v27
    s_mov_b64 exec, s[80:81]
    v_mov_b32 v27, 0
    v_mov_b32 v22, 0
    s_mov_b64 exec, vcc
    v_mov_b32 v27, 3

    s_mov_b64 exec, -1
    v_alignbyte_b32 v20, v21, v20, v27
    v_alignbyte_b32 v21, v22, v21, v27
    v_add_u32 v26, v26, v27

    buffer_store_dwordx2 v[20:21], v26, s[24:27], 0 offen
    v_cmp_ne_u32_sdwa s[80:81], v29, v31 src0_sel:WORD_1 src1_sel:WORD_1
    v_cmp_ne_u32_sdwa vcc, v29, v33 src0_sel:WORD_1 src1_sel:WORD_1
    v_alignbyte_b32 v32, v33, v32, 2
    s_mov_b32 s54, 15357
    v_alignbyte_b32 v29, v29, v28, 1
    v_perm_b32 v28, v28, v32, s47
    s_waitcnt lgkmcnt(0)
    v_add3_u32 v34, v34, v106, s54
    v_sub_u32 v35, 0, v34
    v_and_b32 v35, 3, v35
    s_mov_b64 exec, s[80:81]
    v_mov_b32 v35, 0
    v_mov_b32 v30, 0
    s_mov_b64 exec, vcc
    v_mov_b32 v35, 3

    s_mov_b64 exec, -1
    v_alignbyte_b32 v28, v29, v28, v35
    v_alignbyte_b32 v29, v30, v29, v35
    v_add_u32 v34, v34, v35

    buffer_store_dwordx2 v[28:29], v34, s[24:27], 0 offen
L_skw_46:
    s_bitcmp0_b32 s28, 1
    s_cbranch_scc1 L_skw_47
    v_add_u32 v107, 32768, v2
    ds_read_b64 v[4:5], v107 offset:16400
    ds_read_b64 v[6:7], v107 offset:16408
    ds_read_b64 v[8:9], v107 offset:16392

    ds_read_b64 v[12:13], v107 offset:24592
    ds_read_b64 v[14:15], v107 offset:24600
    ds_read_b64 v[16:17], v107 offset:24584

    ds_read_b64 v[20:21], v107 offset:32784
    ds_read_b64 v[22:23], v107 offset:32792
    ds_read_b64 v[24:25], v107 offset:32776

    ds_read_b64 v[28:29], v107 offset:40976
    ds_read_b64 v[30:31], v107 offset:40984
    ds_read_b64 v[32:33], v107 offset:40968

    s_waitcnt lgkmcnt(9)
    v_lshrrev_b32 v10, 16, v5
    ds_read_b32 v10, v10 offset:8192

    s_waitcnt lgkmcnt(7)
    v_lshrrev_b32 v18, 16, v13
    ds_read_b32 v18, v18 offset:8192

    s_waitcnt lgkmcnt(5)
    v_lshrrev_b32 v26, 16, v21
    ds_read_b32 v26, v26 offset:8192

    s_waitcnt lgkmcnt(3)
    v_lshrrev_b32 v34, 16, v29
    ds_read_b32 v34, v34 offset:8192

    v_cmp_ne_u32_sdwa s[80:81], v5, v7 src0_sel:WORD_1 src1_sel:WORD_1
    v_cmp_ne_u32_sdwa vcc, v5, v9 src0_sel:WORD_1 src1_sel:WORD_1
    v_alignbyte_b32 v8, v9, v8, 2
    s_mov_b32 s54, 20477
    v_alignbyte_b32 v5, v5, v4, 1
    v_perm_b32 v4, v4, v8, s47
    s_waitcnt lgkmcnt(3)
    v_add3_u32 v10, v10, v106, s54
    v_sub_u32 v11, 0, v10
    v_and_b32 v11, 3, v11
    s_mov_b64 exec, s[80:81]
    v_mov_b32 v11, 0
    v_mov_b32 v6, 0
    s_mov_b64 exec, vcc
    v_mov_b32 v11, 3

    s_mov_b64 exec, -1
    v_alignbyte_b32 v4, v5, v4, v11
    v_alignbyte_b32 v5, v6, v5, v11
    v_add_u32 v10, v10, v11

    buffer_store_dwordx2 v[4:5], v10, s[24:27], 0 offen
    v_cmp_ne_u32_sdwa s[80:81], v13, v15 src0_sel:WORD_1 src1_sel:WORD_1
    v_cmp_ne_u32_sdwa vcc, v13, v17 src0_sel:WORD_1 src1_sel:WORD_1
    v_alignbyte_b32 v16, v17, v16, 2
    s_mov_b32 s54, 25597
    v_alignbyte_b32 v13, v13, v12, 1
    v_perm_b32 v12, v12, v16, s47
    s_waitcnt lgkmcnt(2)
    v_add3_u32 v18, v18, v106, s54
    v_sub_u32 v19, 0, v18
    v_and_b32 v19, 3, v19
    s_mov_b64 exec, s[80:81]
    v_mov_b32 v19, 0
    v_mov_b32 v14, 0
    s_mov_b64 exec, vcc
    v_mov_b32 v19, 3

    s_mov_b64 exec, -1
    v_alignbyte_b32 v12, v13, v12, v19
    v_alignbyte_b32 v13, v14, v13, v19
    v_add_u32 v18, v18, v19

    buffer_store_dwordx2 v[12:13], v18, s[24:27], 0 offen
    v_cmp_ne_u32_sdwa s[80:81], v21, v23 src0_sel:WORD_1 src1_sel:WORD_1
    v_cmp_ne_u32_sdwa vcc, v21, v25 src0_sel:WORD_1 src1_sel:WORD_1
    v_alignbyte_b32 v24, v25, v24, 2
    s_mov_b32 s54, 30717
    v_alignbyte_b32 v21, v21, v20, 1
    v_perm_b32 v20, v20, v24, s47
    s_waitcnt lgkmcnt(1)
    v_add3_u32 v26, v26, v106, s54
    v_sub_u32 v27, 0, v26
    v_and_b32 v27, 3, v27
    s_mov_b64 exec, s[80:81]
    v_mov_b32 v27, 0
    v_mov_b32 v22, 0
    s_mov_b64 exec, vcc
    v_mov_b32 v27, 3

    s_mov_b64 exec, -1
    v_alignbyte_b32 v20, v21, v20, v27
    v_alignbyte_b32 v21, v22, v21, v27
    v_add_u32 v26, v26, v27

    buffer_store_dwordx2 v[20:21], v26, s[24:27], 0 offen
    v_cmp_ne_u32_sdwa s[80:81], v29, v31 src0_sel:WORD_1 src1_sel:WORD_1
    v_cmp_ne_u32_sdwa vcc, v29, v33 src0_sel:WORD_1 src1_sel:WORD_1
    v_alignbyte_b32 v32, v33, v32, 2
    s_mov_b32 s54, 35837
    v_alignbyte_b32 v29, v29, v28, 1
    v_perm_b32 v28, v28, v32, s47
    s_waitcnt lgkmcnt(0)
    v_add3_u32 v34, v34, v106, s54
    v_sub_u32 v35, 0, v34
    v_and_b32 v35, 3, v35
    s_mov_b64 exec, s[80:81]
    v_mov_b32 v35, 0
    v_mov_b32 v30, 0
    s_mov_b64 exec, vcc
    v_mov_b32 v35, 3

    s_mov_b64 exec, -1
    v_alignbyte_b32 v28, v29, v28, v35
    v_alignbyte_b32 v29, v30, v29, v35
    v_add_u32 v34, v34, v35

    buffer_store_dwordx2 v[28:29], v34, s[24:27], 0 offen
L_skw_47:
    s_bitcmp0_b32 s28, 2
    s_cbranch_scc1 L_skw_48
    v_add_u32 v107, 65536, v2
    ds_read_b64 v[4:5], v107 offset:16400
    ds_read_b64 v[6:7], v107 offset:16408
    ds_read_b64 v[8:9], v107 offset:16392

    ds_read_b64 v[12:13], v107 offset:24592
    ds_read_b64 v[14:15], v107 offset:24600
    ds_read_b64 v[16:17], v107 offset:24584

    ds_read_b64 v[20:21], v107 offset:32784
    ds_read_b64 v[22:23], v107 offset:32792
    ds_read_b64 v[24:25], v107 offset:32776

    ds_read_b64 v[28:29], v107 offset:40976
    ds_read_b64 v[30:31], v107 offset:40984
    ds_read_b64 v[32:33], v107 offset:40968

    s_waitcnt lgkmcnt(9)
    v_lshrrev_b32 v10, 16, v5
    ds_read_b32 v10, v10 offset:8192

    s_waitcnt lgkmcnt(7)
    v_lshrrev_b32 v18, 16, v13
    ds_read_b32 v18, v18 offset:8192

    s_waitcnt lgkmcnt(5)
    v_lshrrev_b32 v26, 16, v21
    ds_read_b32 v26, v26 offset:8192

    s_waitcnt lgkmcnt(3)
    v_lshrrev_b32 v34, 16, v29
    ds_read_b32 v34, v34 offset:8192

    v_cmp_ne_u32_sdwa s[80:81], v5, v7 src0_sel:WORD_1 src1_sel:WORD_1
    v_cmp_ne_u32_sdwa vcc, v5, v9 src0_sel:WORD_1 src1_sel:WORD_1
    v_alignbyte_b32 v8, v9, v8, 2
    s_mov_b32 s54, 40957
    v_alignbyte_b32 v5, v5, v4, 1
    v_perm_b32 v4, v4, v8, s47
    s_waitcnt lgkmcnt(3)
    v_add3_u32 v10, v10, v106, s54
    v_sub_u32 v11, 0, v10
    v_and_b32 v11, 3, v11
    s_mov_b64 exec, s[80:81]
    v_mov_b32 v11, 0
    v_mov_b32 v6, 0
    s_mov_b64 exec, vcc
    v_mov_b32 v11, 3

    s_mov_b64 exec, -1
    v_alignbyte_b32 v4, v5, v4, v11
    v_alignbyte_b32 v5, v6, v5, v11
    v_add_u32 v10, v10, v11

    buffer_store_dwordx2 v[4:5], v10, s[24:27], 0 offen
    v_cmp_ne_u32_sdwa s[80:81], v13, v15 src0_sel:WORD_1 src1_sel:WORD_1
    v_cmp_ne_u32_sdwa vcc, v13, v17 src0_sel:WORD_1 src1_sel:WORD_1
    v_alignbyte_b32 v16, v17, v16, 2
    s_mov_b32 s54, 46077
    v_alignbyte_b32 v13, v13, v12, 1
    v_perm_b32 v12, v12, v16, s47
    s_waitcnt lgkmcnt(2)
    v_add3_u32 v18, v18, v106, s54
    v_sub_u32 v19, 0, v18
    v_and_b32 v19, 3, v19
    s_mov_b64 exec, s[80:81]
    v_mov_b32 v19, 0
    v_mov_b32 v14, 0
    s_mov_b64 exec, vcc
    v_mov_b32 v19, 3

    s_mov_b64 exec, -1
    v_alignbyte_b32 v12, v13, v12, v19
    v_alignbyte_b32 v13, v14, v13, v19
    v_add_u32 v18, v18, v19

    buffer_store_dwordx2 v[12:13], v18, s[24:27], 0 offen
    v_cmp_ne_u32_sdwa s[80:81], v21, v23 src0_sel:WORD_1 src1_sel:WORD_1
    v_cmp_ne_u32_sdwa vcc, v21, v25 src0_sel:WORD_1 src1_sel:WORD_1
    v_alignbyte_b32 v24, v25, v24, 2
    s_mov_b32 s54, 51197
    v_alignbyte_b32 v21, v21, v20, 1
    v_perm_b32 v20, v20, v24, s47
    s_waitcnt lgkmcnt(1)
    v_add3_u32 v26, v26, v106, s54
    v_sub_u32 v27, 0, v26
    v_and_b32 v27, 3, v27
    s_mov_b64 exec, s[80:81]
    v_mov_b32 v27, 0
    v_mov_b32 v22, 0
    s_mov_b64 exec, vcc
    v_mov_b32 v27, 3

    s_mov_b64 exec, -1
    v_alignbyte_b32 v20, v21, v20, v27
    v_alignbyte_b32 v21, v22, v21, v27
    v_add_u32 v26, v26, v27

    buffer_store_dwordx2 v[20:21], v26, s[24:27], 0 offen
    v_cmp_ne_u32_sdwa s[80:81], v29, v31 src0_sel:WORD_1 src1_sel:WORD_1
    v_cmp_ne_u32_sdwa vcc, v29, v33 src0_sel:WORD_1 src1_sel:WORD_1
    v_alignbyte_b32 v32, v33, v32, 2
    s_mov_b32 s54, 56317
    v_alignbyte_b32 v29, v29, v28, 1
    v_perm_b32 v28, v28, v32, s47
    s_waitcnt lgkmcnt(0)
    v_add3_u32 v34, v34, v106, s54
    v_sub_u32 v35, 0, v34
    v_and_b32 v35, 3, v35
    s_mov_b64 exec, s[80:81]
    v_mov_b32 v35, 0
    v_mov_b32 v30, 0
    s_mov_b64 exec, vcc
    v_mov_b32 v35, 3

    s_mov_b64 exec, -1
    v_alignbyte_b32 v28, v29, v28, v35
    v_alignbyte_b32 v29, v30, v29, v35
    v_add_u32 v34, v34, v35

    buffer_store_dwordx2 v[28:29], v34, s[24:27], 0 offen
L_skw_48:
    s_bitcmp0_b32 s28, 3
    s_cbranch_scc1 L_skw_49
    v_add_u32 v107, 98304, v2
    ds_read_b64 v[4:5], v107 offset:16400
    ds_read_b64 v[6:7], v107 offset:16408
    ds_read_b64 v[8:9], v107 offset:16392

    ds_read_b64 v[12:13], v107 offset:24592
    ds_read_b64 v[14:15], v107 offset:24600
    ds_read_b64 v[16:17], v107 offset:24584

    ds_read_b64 v[20:21], v107 offset:32784
    ds_read_b64 v[22:23], v107 offset:32792
    ds_read_b64 v[24:25], v107 offset:32776

    ds_read_b64 v[28:29], v107 offset:40976
    ds_read_b64 v[30:31], v107 offset:40984
    ds_read_b64 v[32:33], v107 offset:40968

    s_waitcnt lgkmcnt(9)
    v_lshrrev_b32 v10, 16, v5
    ds_read_b32 v10, v10 offset:8192

    s_waitcnt lgkmcnt(7)
    v_lshrrev_b32 v18, 16, v13
    ds_read_b32 v18, v18 offset:8192

    s_waitcnt lgkmcnt(5)
    v_lshrrev_b32 v26, 16, v21
    ds_read_b32 v26, v26 offset:8192

    s_waitcnt lgkmcnt(3)
    v_lshrrev_b32 v34, 16, v29
    ds_read_b32 v34, v34 offset:8192

    v_cmp_ne_u32_sdwa s[80:81], v5, v7 src0_sel:WORD_1 src1_sel:WORD_1
    v_cmp_ne_u32_sdwa vcc, v5, v9 src0_sel:WORD_1 src1_sel:WORD_1
    v_alignbyte_b32 v8, v9, v8, 2
    s_mov_b32 s54, 61437
    v_alignbyte_b32 v5, v5, v4, 1
    v_perm_b32 v4, v4, v8, s47
    s_waitcnt lgkmcnt(3)
    v_add3_u32 v10, v10, v106, s54
    v_sub_u32 v11, 0, v10
    v_and_b32 v11, 3, v11
    s_mov_b64 exec, s[80:81]
    v_mov_b32 v11, 0
    v_mov_b32 v6, 0
    s_mov_b64 exec, vcc
    v_mov_b32 v11, 3

    s_mov_b64 exec, -1
    v_alignbyte_b32 v4, v5, v4, v11
    v_alignbyte_b32 v5, v6, v5, v11
    v_add_u32 v10, v10, v11

    buffer_store_dwordx2 v[4:5], v10, s[24:27], 0 offen
    v_cmp_ne_u32_sdwa s[80:81], v13, v15 src0_sel:WORD_1 src1_sel:WORD_1
    v_cmp_ne_u32_sdwa vcc, v13, v17 src0_sel:WORD_1 src1_sel:WORD_1
    v_alignbyte_b32 v16, v17, v16, 2
    s_mov_b32 s54, 66557
    v_alignbyte_b32 v13, v13, v12, 1
    v_perm_b32 v12, v12, v16, s47
    s_waitcnt lgkmcnt(2)
    v_add3_u32 v18, v18, v106, s54
    v_sub_u32 v19, 0, v18
    v_and_b32 v19, 3, v19
    s_mov_b64 exec, s[80:81]
    v_mov_b32 v19, 0
    v_mov_b32 v14, 0
    s_mov_b64 exec, vcc
    v_mov_b32 v19, 3

    s_mov_b64 exec, -1
    v_alignbyte_b32 v12, v13, v12, v19
    v_alignbyte_b32 v13, v14, v13, v19
    v_add_u32 v18, v18, v19

    buffer_store_dwordx2 v[12:13], v18, s[24:27], 0 offen
    v_cmp_ne_u32_sdwa s[80:81], v21, v23 src0_sel:WORD_1 src1_sel:WORD_1
    v_cmp_ne_u32_sdwa vcc, v21, v25 src0_sel:WORD_1 src1_sel:WORD_1
    v_alignbyte_b32 v24, v25, v24, 2
    s_mov_b32 s54, 71677
    v_alignbyte_b32 v21, v21, v20, 1
    v_perm_b32 v20, v20, v24, s47
    s_waitcnt lgkmcnt(1)
    v_add3_u32 v26, v26, v106, s54
    v_sub_u32 v27, 0, v26
    v_and_b32 v27, 3, v27
    s_mov_b64 exec, s[80:81]
    v_mov_b32 v27, 0
    v_mov_b32 v22, 0
    s_mov_b64 exec, vcc
    v_mov_b32 v27, 3

    s_mov_b64 exec, -1
    v_alignbyte_b32 v20, v21, v20, v27
    v_alignbyte_b32 v21, v22, v21, v27
    v_add_u32 v26, v26, v27

    buffer_store_dwordx2 v[20:21], v26, s[24:27], 0 offen
    v_cmp_ne_u32_sdwa s[80:81], v29, v31 src0_sel:WORD_1 src1_sel:WORD_1
    v_cmp_ne_u32_sdwa vcc, v29, v33 src0_sel:WORD_1 src1_sel:WORD_1
    v_alignbyte_b32 v32, v33, v32, 2
    s_mov_b32 s54, 76797
    v_alignbyte_b32 v29, v29, v28, 1
    v_perm_b32 v28, v28, v32, s47
    s_waitcnt lgkmcnt(0)
    v_add3_u32 v34, v34, v106, s54
    v_sub_u32 v35, 0, v34
    v_and_b32 v35, 3, v35
    s_mov_b64 exec, s[80:81]
    v_mov_b32 v35, 0
    v_mov_b32 v30, 0
    s_mov_b64 exec, vcc
    v_mov_b32 v35, 3

    s_andn2_b64 exec, -1, s[68:69]
    v_bfrev_b32 v34, 1
    s_mov_b64 exec, -1
    v_alignbyte_b32 v28, v29, v28, v35
    v_alignbyte_b32 v29, v30, v29, v35
    v_add_u32 v34, v34, v35

    buffer_store_dwordx2 v[28:29], v34, s[24:27], 0 offen
L_skw_49:
    s_mov_b32 s28, 15
    s_mov_b32 s29, 0
    s_movk_i32 s30, 16000

L_p1done_1:
    s_endpgm

L_slow_23:
    v_add_u32 v112, s29, v0
    v_mov_b32 v118, 0
    s_mov_b32 s75, 4960
L_sl_25:
    v_lshlrev_b32 v113, 3, v112
    ds_read_b64 v[110:111], v113 offset:16400
    ds_read_b32 v119, v113 offset:16412
    ds_read_b32 v120, v113 offset:16396
    s_waitcnt lgkmcnt(0)
    v_lshrrev_b32 v114, 16, v111
    ds_read_b32 v115, v114 offset:8192
    v_add_u32 v114, 4, v114
    v_mul_u32_u24 v114, s75, v114
    s_waitcnt lgkmcnt(0)
    v_mad_u32_u24 v115, v112, 5, v115
    v_cmp_gt_u32 s[72:73], s30, v112
    v_cmp_ge_u32 vcc, v115, v114
    s_and_b64 s[80:81], vcc, s[72:73]
    s_cbranch_scc0 L_s1_26
    s_bcnt1_i32_b64 s76, s[80:81]
    v_mbcnt_lo_u32_b32 v117, s80, 0
    v_mbcnt_hi_u32_b32 v117, s81, v117
    v_mov_b32 v116, s76
    s_mov_b64 exec, 1
    buffer_atomic_add v116, v118, s[36:39], 0 offen sc0
    s_waitcnt vmcnt(0)
    v_readfirstlane_b32 s76, v116
    s_mov_b64 exec, s[80:81]
    s_nop 0
    v_add_lshl_u32 v116, v117, s76, 3
    buffer_store_dwordx2 v[110:111], v116, s[32:35], 0 offen
L_s1_26:
    s_andn2_b64 exec, s[72:73], vcc
    s_cbranch_execz L_s2_27
    buffer_store_dword v110, v115, s[24:27], 0 offen
    buffer_store_byte v111, v115, s[24:27], 0 offen offset:4
    v_add_u32 v115, 5, v115
    v_cmpx_lt_u32 vcc, v115, v114
    v_cmpx_ne_u32_sdwa vcc, v111, v119 src0_sel:WORD_1 src1_sel:WORD_1
    v_cmpx_ne_u32_sdwa vcc, v111, v120 src0_sel:WORD_1 src1_sel:WORD_1
    s_cbranch_execz L_s2_27
    buffer_store_dword v118, v115, s[24:27], 0 offen
L_s2_27:
    s_mov_b64 exec, -1
    v_add_u32 v112, 1024, v112
    s_nop 0
    v_readfirstlane_b32 s76, v112
    s_nop 1
    s_cmp_lt_u32 s76, s30
    s_cbranch_scc1 L_sl_25
    s_mov_b32 s28, 0
    s_branch L_sback_24

L_slow_41:
    v_add_u32 v112, s29, v0
    v_mov_b32 v118, 0
    s_mov_b32 s75, 4960
L_sl_43:
    v_lshlrev_b32 v113, 3, v112
    ds_read_b64 v[110:111], v113 offset:16400
    ds_read_b32 v119, v113 offset:16412
    ds_read_b32 v120, v113 offset:16396
    s_waitcnt lgkmcnt(0)
    v_lshrrev_b32 v114, 16, v111
    ds_read_b32 v115, v114 offset:8192
    v_add_u32 v114, 4, v114
    v_mul_u32_u24 v114, s75, v114
    s_waitcnt lgkmcnt(0)
    v_mad_u32_u24 v115, v112, 5, v115
    v_cmp_gt_u32 s[72:73], s30, v112
    v_cmp_ge_u32 vcc, v115, v114
    s_and_b64 s[80:81], vcc, s[72:73]
    s_cbranch_scc0 L_s1_44
    s_bcnt1_i32_b64 s76, s[80:81]
    v_mbcnt_lo_u32_b32 v117, s80, 0
    v_mbcnt_hi_u32_b32 v117, s81, v117
    v_mov_b32 v116, s76
    s_mov_b64 exec, 1
    buffer_atomic_add v116, v118, s[36:39], 0 offen sc0
    s_waitcnt vmcnt(0)
    v_readfirstlane_b32 s76, v116
    s_mov_b64 exec, s[80:81]
    s_nop 0
    v_add_lshl_u32 v116, v117, s76, 3
    buffer_store_dwordx2 v[110:111], v116, s[32:35], 0 offen
L_s1_44:
    s_andn2_b64 exec, s[72:73], vcc
    s_cbranch_execz L_s2_45
    buffer_store_dword v110, v115, s[24:27], 0 offen
    buffer_store_byte v111, v115, s[24:27], 0 offen offset:4
    v_add_u32 v115, 5, v115
    v_cmpx_lt_u32 vcc, v115, v114
    v_cmpx_ne_u32_sdwa vcc, v111, v119 src0_sel:WORD_1 src1_sel:WORD_1
    v_cmpx_ne_u32_sdwa vcc, v111, v120 src0_sel:WORD_1 src1_sel:WORD_1
    s_cbranch_execz L_s2_45
    buffer_store_dword v118, v115, s[24:27], 0 offen
L_s2_45:
    s_mov_b64 exec, -1
    v_add_u32 v112, 1024, v112
    s_nop 0
    v_readfirstlane_b32 s76, v112
    s_nop 1
    s_cmp_lt_u32 s76, s30
    s_cbranch_scc1 L_sl_43
    s_mov_b32 s28, 0
    s_branch L_sback_42

.globl g2_kernel
.p2align 8
.type g2_kernel,@function
g2_kernel:
    s_cmp_ge_u32 s2, 256
    s_cbranch_scc1 L_p2done_50
    s_load_dwordx2 s[8:9], s[0:1], 0
    s_load_dwordx2 s[6:7], s[0:1], 104
    v_lshrrev_b32 v4, 6, v0
    s_lshr_b32 s37, s2, 1
    s_and_b32 s37, s37, 3
    s_lshr_b32 s36, s2, 3
    s_lshl_b32 s36, s36, 1
    s_and_b32 s3, s2, 1
    s_or_b32 s36, s36, s3
    v_readfirstlane_b32 s4, v4
    v_and_b32 v2, 63, v0
    v_lshrrev_b32 v3, 9, v0
    v_lshl_or_b32 v2, v3, 6, v2
    v_mul_u32_u24 v2, 20, v2
    v_lshlrev_b32 v3, 4, v0
    s_waitcnt lgkmcnt(0)
    s_lshl_b32 m0, s4, 10
    s_and_b32 s5, s4, 7
    s_lshr_b32 s39, s4, 3
    s_lshl_b32 s39, s39, 8
    s_mul_i32 s3, s5, 8192
    s_add_u32 s46, s6, s3
    s_addc_u32 s47, s7, 0
    s_mul_i32 s3, s5, 40632320
    s_add_u32 s3, s3, 83599360
    s_add_u32 s44, s6, s3
    s_addc_u32 s45, s7, 0
    s_mul_i32 s38, s37, 8
    s_add_u32 s4, s38, 8
    s_lshl_b32 s3, s38, 6
    s_add_u32 s3, s3, s36
    s_lshl_b32 s3, s3, 2
    s_add_u32 s52, s46, s3
    s_addc_u32 s53, s47, 0

    s_load_dword s88, s[52:53], 0
    s_load_dword s89, s[52:53], 256
    s_load_dword s90, s[52:53], 512
    s_load_dword s91, s[52:53], 768
    s_load_dword s92, s[52:53], 1024
    s_load_dword s93, s[52:53], 1280
    s_load_dword s94, s[52:53], 1536
    s_load_dword s95, s[52:53], 1792
    s_mov_b32 s3, 65536
    s_load_dword s51, s[6:7], s3
    s_mov_b32 s10, 6400000
    s_mov_b32 s11, 0x20000

    s_add_u32 s12, s6, 393216
    s_addc_u32 s13, s7, 0
    s_mov_b32 s14, 0
    s_mov_b32 s15, 0x20000
    s_add_u32 s60, s6, 393216
    s_addc_u32 s61, s7, 0
    s_mov_b32 s62, 6406144
    s_mov_b32 s63, 0x20000
    s_mov_b32 s3, 135176
    s_load_dword s33, s[6:7], s3

    s_mul_i32 s43, s38, 200192
    s_mul_i32 s41, s4, 200192
    s_mul_i32 s50, s38, 200000
    s_add_u32 s14, s43, 50000

    buffer_load_dwordx4 v[76:79], v3, s[12:15], s43 offen
    s_add_u32 s52, s43, 16384
    buffer_load_dwordx4 v[80:83], v3, s[12:15], s52 offen
    s_add_u32 s52, s43, 32768
    buffer_load_dwordx4 v[84:87], v3, s[12:15], s52 offen
    s_add_u32 s52, s43, 49152
    v_lshlrev_b32 v119, 2, v0
    buffer_load_dword v88, v119, s[12:15], s52 offen
    s_add_u32 s20, s6, 135168
    s_addc_u32 s21, s7, 0
    s_mov_b32 s22, 4096
    s_mov_b32 s23, 0x20000
    v_and_b32 v44, 63, v0
    v_lshlrev_b32 v44, 4, v44
    buffer_load_dwordx2 v[120:121], v44, s[20:23], 0 offen offset:0
    buffer_load_dwordx2 v[122:123], v44, s[20:23], 0 offen offset:1024
    buffer_load_dwordx2 v[124:125], v44, s[20:23], 0 offen offset:2048
    buffer_load_dwordx2 v[126:127], v44, s[20:23], 0 offen offset:3072
    s_lshr_b32 s3, s2, 3
    s_mul_i32 s3, s3, 49
    v_add_lshl_u32 v89, v0, s3, 7
    v_cmp_gt_u32 vcc, 49, v0
    v_bfrev_b32 v28, 1
    s_nop 0
    v_cndmask_b32 v89, v28, v89, vcc

    s_mov_b32 s19, 0x20000
    s_mov_b32 s28, 0x4b404000
    s_mov_b32 s29, 0x4b404000
    s_mov_b32 s30, 0xbfffc000
    s_mov_b32 s31, 0xbfffbfff
    s_mov_b32 s32, 0xffff0000
    s_mov_b32 s35, 0x05040100
    s_mov_b32 s97, 0x07060302
    s_mov_b32 s96, 0x40008000
    s_movk_i32 s3, 212
    v_cmp_gt_u32 s[48:49], s3, v0

    v_mov_b32 v1, 0
    s_mov_b32 s24, 0xc0c0004
    s_mov_b32 s25, 0xc0c0105
    s_mov_b32 s26, 0xc0c0206
    s_mov_b32 s27, 0xc0c0307
    s_waitcnt lgkmcnt(0)
    s_min_u32 s88, s88, 3968
    s_lshl_b32 s52, s38, 6
    s_add_u32 s52, s52, s36
    s_mul_i32 s52, s52, 19840
    s_add_u32 s16, s44, s52
    s_addc_u32 s17, s45, 0
    s_mul_i32 s52, s88, 5
    s_add_u32 s52, s52, 3
    s_and_b32 s18, s52, -4

    s_movk_i32 s53, 5120
    buffer_load_dwordx4 v[90:93], v2, s[16:19], s53 offen
    buffer_load_dword v110, v2, s[16:19], s53 offen offset:16
    s_movk_i32 s53, 7680
    buffer_load_dwordx4 v[94:97], v2, s[16:19], s53 offen
    buffer_load_dword v111, v2, s[16:19], s53 offen offset:16
    s_movk_i32 s53, 10240
    buffer_load_dwordx4 v[98:101], v2, s[16:19], s53 offen
    buffer_load_dword v112, v2, s[16:19], s53 offen offset:16
    s_movk_i32 s53, 12800
    buffer_load_dwordx4 v[102:105], v2, s[16:19], s53 offen
    buffer_load_dword v113, v2, s[16:19], s53 offen offset:16
    s_movk_i32 s53, 0
    buffer_load_dwordx4 v[4:7], v2, s[16:19], s53 offen
    buffer_load_dword v35, v2, s[16:19], s53 offen offset:16
    s_movk_i32 s53, 2560
    buffer_load_dwordx4 v[8:11], v2, s[16:19], s53 offen
    buffer_load_dword v43, v2, s[16:19], s53 offen offset:16
    s_movk_i32 s53, 15360
    buffer_load_dwordx4 v[106:109], v2, s[16:19], s53 offen
    buffer_load_dword v114, v2, s[16:19], s53 offen offset:16
    v_mov_b32 v28, 0x40004000
    v_mov_b32 v29, 0x40004000
    v_mov_b32 v30, 0x40004000
    v_mov_b32 v31, 0x40004000
    v_add_u32 v32, 50000, v3
    v_add_u32 v33, 65536, v32

    ds_write_b128 v32, v[28:31] offset:0
    ds_write_b128 v32, v[28:31] offset:16384
    ds_write_b128 v32, v[28:31] offset:32768
    ds_write_b128 v32, v[28:31] offset:49152
    ds_write_b128 v33, v[28:31] offset:0
    ds_write_b128 v33, v[28:31] offset:16384
    v_cmp_gt_u32 vcc, 971, v0
    s_mov_b64 exec, vcc
    ds_write_b128 v33, v[28:31] offset:32768
    s_mov_b64 exec, -1
    s_waitcnt vmcnt(21)
    ds_write_addtid_b32 v76 offset:0
    ds_write_addtid_b32 v77 offset:256
    ds_write_addtid_b32 v78 offset:512
    ds_write_addtid_b32 v79 offset:768
    s_waitcnt vmcnt(20)
    ds_write_addtid_b32 v80 offset:16384
    ds_write_addtid_b32 v81 offset:16640
    ds_write_addtid_b32 v82 offset:16896
    ds_write_addtid_b32 v83 offset:17152
    s_waitcnt vmcnt(19)
    ds_write_addtid_b32 v84 offset:32768
    ds_write_addtid_b32 v85 offset:33024
    ds_write_addtid_b32 v86 offset:33280
    ds_write_addtid_b32 v87 offset:33536
    v_lshlrev_b32 v119, 2, v0
    s_waitcnt vmcnt(18)
    s_mov_b64 exec, s[48:49]
    ds_write_b32 v119, v88 offset:49152
    s_mov_b64 exec, -1
    s_add_u32 s43, s43, 50048
    s_add_u32 s14, s43, 50000
    s_min_u32 s14, s14, s41
    buffer_load_dwordx4 v[76:79], v3, s[12:15], s43 offen
    s_add_u32 s52, s43, 16384
    buffer_load_dwordx4 v[80:83], v3, s[12:15], s52 offen
    s_add_u32 s52, s43, 32768
    buffer_load_dwordx4 v[84:87], v3, s[12:15], s52 offen
    s_add_u32 s52, s43, 49152
    v_lshlrev_b32 v119, 2, v0
    buffer_load_dword v88, v119, s[12:15], s52 offen
    s_add_u32 s54, s43, 50048
    buffer_load_dword v115, v89, s[60:63], s54 offen
    s_add_u32 s54, s50, 0
    buffer_load_dword v115, v89, s[8:11], s54 offen
    s_waitcnt vmcnt(20)
    v_max3_u32 v120, v120, v122, v124
    v_add_f32 v121, v121, v123
    v_add_f32 v125, v125, v127
    v_max_u32 v120, v120, v126
    v_add_f32 v121, v121, v125

    s_nop 1
    v_max_u32_dpp v120, v120, v120 row_shr:1 row_mask:0xf bank_mask:0xf
    s_nop 1
    v_max_u32_dpp v120, v120, v120 row_shr:2 row_mask:0xf bank_mask:0xf
    s_nop 1
    v_max_u32_dpp v120, v120, v120 row_shr:4 row_mask:0xf bank_mask:0xf
    s_nop 1
    v_max_u32_dpp v120, v120, v120 row_shr:8 row_mask:0xf bank_mask:0xf
    s_nop 1
    v_max_u32_dpp v120, v120, v120 row_bcast:15 row_mask:0xa bank_mask:0xf
    s_nop 1
    v_max_u32_dpp v120, v120, v120 row_bcast:31 row_mask:0xc bank_mask:0xf
    s_nop 1
    v_add_f32_dpp v121, v121, v121 row_shr:1 row_mask:0xf bank_mask:0xf
    s_nop 1
    v_add_f32_dpp v121, v121, v121 row_shr:2 row_mask:0xf bank_mask:0xf
    s_nop 1
    v_add_f32_dpp v121, v121, v121 row_shr:4 row_mask:0xf bank_mask:0xf
    s_nop 1
    v_add_f32_dpp v121, v121, v121 row_shr:8 row_mask:0xf bank_mask:0xf
    s_nop 1
    v_add_f32_dpp v121, v121, v121 row_bcast:15 row_mask:0xa bank_mask:0xf
    s_nop 1
    v_add_f32_dpp v121, v121, v121 row_bcast:31 row_mask:0xc bank_mask:0xf
    v_lshlrev_b32 v120, 16, v120
    v_mul_f32 v121, 0x34a7c5ac, v121
    v_sqrt_f32 v121, v121
    v_mul_f32 v120, s33, v120
    v_mul_f32 v121, s33, v121
    v_cmp_gt_f32 vcc, 0x46fde800, v120
    s_mov_b64 s[64:65], vcc
    v_cmp_lt_f32 vcc, 0x44000000, v121
    v_mov_b32 v120, 0x37800000
    v_mul_f32 v120, s33, v120
    s_and_b64 vcc, vcc, s[64:65]
    v_mul_f32 v121, 0x46ff8000, v120
    v_rcp_f32 v121, v121
    v_readfirstlane_b32 s33, v120
    s_waitcnt lgkmcnt(0)
    s_barrier
    v_readfirstlane_b32 s34, v121
    v_mov_b32 v120, 150016
    v_mov_b32 v121, 0
    ds_write_b32 v120, v121 offset:8
    s_bitcmp0_b64 vcc, 63
    s_cbranch_scc1 L_p2slow_51
    s_cmp_lg_u32 s51, 0
    s_cbranch_scc1 L_p2slow_51

    s_mov_b32 s40, s88
    s_sub_u32 s42, s40, s39

    s_add_u32 s55, s38, 1
    s_min_u32 s55, s55, 31
    s_mov_b32 s88, s89
    s_mov_b32 s89, s90
    s_mov_b32 s90, s91
    s_mov_b32 s91, s92
    s_mov_b32 s92, s93
    s_mov_b32 s93, s94
    s_mov_b32 s94, s95
    s_mov_b32 s95, 0
    s_min_u32 s88, s88, 3968
    s_lshl_b32 s52, s55, 6
    s_add_u32 s52, s52, s36
    s_mul_i32 s52, s52, 19840
    s_add_u32 s16, s44, s52
    s_addc_u32 s17, s45, 0
    s_mul_i32 s52, s88, 5
    s_add_u32 s52, s52, 3
    s_and_b32 s18, s52, -4

    s_waitcnt vmcnt(18)
    v_perm_b32 v44, v91, v90, s24
    v_perm_b32 v46, v92, v91, s25
    v_perm_b32 v48, v93, v92, s26
    v_perm_b32 v50, v110, v93, s27
    v_mov_b32 v12, v90
    v_alignbyte_b32 v13, v92, v91, 1
    v_alignbyte_b32 v14, v93, v92, 2
    v_alignbyte_b32 v15, v110, v93, 3
    v_lshlrev_b32_sdwa v44, 3, v44 dst_sel:WORD_0 dst_unused:UNUSED_PAD src0_sel:DWORD src1_sel:DWORD
    v_lshlrev_b32_sdwa v46, 3, v46 dst_sel:WORD_0 dst_unused:UNUSED_PAD src0_sel:DWORD src1_sel:DWORD
    v_lshlrev_b32_sdwa v48, 3, v48 dst_sel:WORD_0 dst_unused:UNUSED_PAD src0_sel:DWORD src1_sel:DWORD
    v_lshlrev_b32_sdwa v50, 3, v50 dst_sel:WORD_0 dst_unused:UNUSED_PAD src0_sel:DWORD src1_sel:DWORD
    s_cmp_lt_i32 s42, 1280
    s_cbranch_scc1 L_ufix_52
L_uback_53:

    v_subrev_co_u32 v12, s[80:81], 2.0, v12
    v_subrev_co_u32 v13, s[82:83], 2.0, v13
    v_subrev_co_u32 v14, s[84:85], 2.0, v14
    v_subrev_co_u32 v15, s[86:87], 2.0, v15
    s_mov_b64 exec, s[80:81]
    ds_read_b64 v[44:45], v44
    s_mov_b64 exec, s[82:83]
    ds_read_b64 v[46:47], v46
    s_mov_b64 exec, s[84:85]
    ds_read_b64 v[48:49], v48
    s_mov_b64 exec, s[86:87]
    ds_read_b64 v[50:51], v50
    s_mov_b64 exec, -1
    s_waitcnt vmcnt(16)
    v_perm_b32 v52, v95, v94, s24
    v_perm_b32 v54, v96, v95, s25
    v_perm_b32 v56, v97, v96, s26
    v_perm_b32 v58, v111, v97, s27
    v_mov_b32 v16, v94
    v_alignbyte_b32 v17, v96, v95, 1
    v_alignbyte_b32 v18, v97, v96, 2
    v_alignbyte_b32 v19, v111, v97, 3
    v_lshlrev_b32_sdwa v52, 3, v52 dst_sel:WORD_0 dst_unused:UNUSED_PAD src0_sel:DWORD src1_sel:DWORD
    v_lshlrev_b32_sdwa v54, 3, v54 dst_sel:WORD_0 dst_unused:UNUSED_PAD src0_sel:DWORD src1_sel:DWORD
    v_lshlrev_b32_sdwa v56, 3, v56 dst_sel:WORD_0 dst_unused:UNUSED_PAD src0_sel:DWORD src1_sel:DWORD
    v_lshlrev_b32_sdwa v58, 3, v58 dst_sel:WORD_0 dst_unused:UNUSED_PAD src0_sel:DWORD src1_sel:DWORD
    s_cmp_lt_i32 s42, 1792
    s_cbranch_scc1 L_ufix_54
L_uback_55:

    v_subrev_co_u32 v16, s[64:65], 2.0, v16
    v_subrev_co_u32 v17, s[66:67], 2.0, v17
    v_subrev_co_u32 v18, s[68:69], 2.0, v18
    v_subrev_co_u32 v19, s[70:71], 2.0, v19
    s_mov_b64 exec, s[64:65]
    ds_read_b64 v[52:53], v52
    s_mov_b64 exec, s[66:67]
    ds_read_b64 v[54:55], v54
    s_mov_b64 exec, s[68:69]
    ds_read_b64 v[56:57], v56
    s_mov_b64 exec, s[70:71]
    ds_read_b64 v[58:59], v58
    s_mov_b64 exec, -1
    s_waitcnt vmcnt(14)
    v_perm_b32 v60, v99, v98, s24
    v_perm_b32 v62, v100, v99, s25
    v_perm_b32 v64, v101, v100, s26
    v_perm_b32 v66, v112, v101, s27
    v_mov_b32 v20, v98
    v_alignbyte_b32 v21, v100, v99, 1
    v_alignbyte_b32 v22, v101, v100, 2
    v_alignbyte_b32 v23, v112, v101, 3
    v_lshlrev_b32_sdwa v60, 3, v60 dst_sel:WORD_0 dst_unused:UNUSED_PAD src0_sel:DWORD src1_sel:DWORD
    v_lshlrev_b32_sdwa v62, 3, v62 dst_sel:WORD_0 dst_unused:UNUSED_PAD src0_sel:DWORD src1_sel:DWORD
    v_lshlrev_b32_sdwa v64, 3, v64 dst_sel:WORD_0 dst_unused:UNUSED_PAD src0_sel:DWORD src1_sel:DWORD
    v_lshlrev_b32_sdwa v66, 3, v66 dst_sel:WORD_0 dst_unused:UNUSED_PAD src0_sel:DWORD src1_sel:DWORD
    s_cmp_lt_i32 s42, 2304
    s_cbranch_scc1 L_ufix_56
L_uback_57:

    v_subrev_co_u32 v20, s[72:73], 2.0, v20
    v_subrev_co_u32 v21, s[74:75], 2.0, v21
    v_subrev_co_u32 v22, s[76:77], 2.0, v22
    v_subrev_co_u32 v23, s[78:79], 2.0, v23
    s_mov_b64 exec, s[72:73]
    ds_read_b64 v[60:61], v60
    s_mov_b64 exec, s[74:75]
    ds_read_b64 v[62:63], v62
    s_mov_b64 exec, s[76:77]
    ds_read_b64 v[64:65], v64
    s_mov_b64 exec, s[78:79]
    ds_read_b64 v[66:67], v66
    s_mov_b64 exec, -1
    s_waitcnt vmcnt(12)
    v_perm_b32 v68, v103, v102, s24
    v_perm_b32 v70, v104, v103, s25
    v_perm_b32 v72, v105, v104, s26
    v_perm_b32 v74, v113, v105, s27
    v_mov_b32 v24, v102
    v_alignbyte_b32 v25, v104, v103, 1
    v_alignbyte_b32 v26, v105, v104, 2
    v_alignbyte_b32 v27, v113, v105, 3
    v_lshlrev_b32_sdwa v68, 3, v68 dst_sel:WORD_0 dst_unused:UNUSED_PAD src0_sel:DWORD src1_sel:DWORD
    v_lshlrev_b32_sdwa v70, 3, v70 dst_sel:WORD_0 dst_unused:UNUSED_PAD src0_sel:DWORD src1_sel:DWORD
    v_lshlrev_b32_sdwa v72, 3, v72 dst_sel:WORD_0 dst_unused:UNUSED_PAD src0_sel:DWORD src1_sel:DWORD
    v_lshlrev_b32_sdwa v74, 3, v74 dst_sel:WORD_0 dst_unused:UNUSED_PAD src0_sel:DWORD src1_sel:DWORD
    s_cmp_lt_i32 s42, 2816
    s_cbranch_scc1 L_ufix_58
L_uback_59:

    v_subrev_co_u32 v24, s[80:81], 2.0, v24
    v_subrev_co_u32 v25, s[82:83], 2.0, v25
    v_subrev_co_u32 v26, s[84:85], 2.0, v26
    v_subrev_co_u32 v27, s[86:87], 2.0, v27
    s_mov_b64 exec, s[80:81]
    ds_read_b64 v[68:69], v68
    s_mov_b64 exec, s[82:83]
    ds_read_b64 v[70:71], v70
    s_mov_b64 exec, s[84:85]
    ds_read_b64 v[72:73], v72
    s_mov_b64 exec, s[86:87]
    ds_read_b64 v[74:75], v74
    s_mov_b64 exec, -1
    s_waitcnt vmcnt(10)
    v_perm_b32 v28, v5, v4, s24
    v_perm_b32 v30, v6, v5, s25
    v_perm_b32 v32, v7, v6, s26
    v_perm_b32 v34, v35, v7, s27
    v_alignbyte_b32 v5, v6, v5, 1
    v_alignbyte_b32 v6, v7, v6, 2
    v_alignbyte_b32 v7, v35, v7, 3
    v_lshlrev_b32_sdwa v28, 3, v28 dst_sel:WORD_0 dst_unused:UNUSED_PAD src0_sel:DWORD src1_sel:DWORD
    v_lshlrev_b32_sdwa v30, 3, v30 dst_sel:WORD_0 dst_unused:UNUSED_PAD src0_sel:DWORD src1_sel:DWORD
    v_lshlrev_b32_sdwa v32, 3, v32 dst_sel:WORD_0 dst_unused:UNUSED_PAD src0_sel:DWORD src1_sel:DWORD
    v_lshlrev_b32_sdwa v34, 3, v34 dst_sel:WORD_0 dst_unused:UNUSED_PAD src0_sel:DWORD src1_sel:DWORD
    s_cmp_lt_i32 s42, 256
    s_cbranch_scc1 L_ufix_60
L_uback_61:

    v_subrev_co_u32 v4, s[64:65], 2.0, v4
    v_subrev_co_u32 v5, s[66:67], 2.0, v5
    v_subrev_co_u32 v6, s[68:69], 2.0, v6
    v_subrev_co_u32 v7, s[70:71], 2.0, v7
    s_mov_b64 exec, s[64:65]
    ds_read_b64 v[28:29], v28
    s_mov_b64 exec, s[66:67]
    ds_read_b64 v[30:31], v30
    s_mov_b64 exec, s[68:69]
    ds_read_b64 v[32:33], v32
    s_mov_b64 exec, s[70:71]
    ds_read_b64 v[34:35], v34
    s_mov_b64 exec, -1
    s_waitcnt vmcnt(8)
    v_perm_b32 v36, v9, v8, s24
    v_perm_b32 v38, v10, v9, s25
    v_perm_b32 v40, v11, v10, s26
    v_perm_b32 v42, v43, v11, s27
    v_alignbyte_b32 v9, v10, v9, 1
    v_alignbyte_b32 v10, v11, v10, 2
    v_alignbyte_b32 v11, v43, v11, 3
    v_lshlrev_b32_sdwa v36, 3, v36 dst_sel:WORD_0 dst_unused:UNUSED_PAD src0_sel:DWORD src1_sel:DWORD
    v_lshlrev_b32_sdwa v38, 3, v38 dst_sel:WORD_0 dst_unused:UNUSED_PAD src0_sel:DWORD src1_sel:DWORD
    v_lshlrev_b32_sdwa v40, 3, v40 dst_sel:WORD_0 dst_unused:UNUSED_PAD src0_sel:DWORD src1_sel:DWORD
    v_lshlrev_b32_sdwa v42, 3, v42 dst_sel:WORD_0 dst_unused:UNUSED_PAD src0_sel:DWORD src1_sel:DWORD
    s_cmp_lt_i32 s42, 768
    s_cbranch_scc1 L_ufix_62
L_uback_63:

    v_subrev_co_u32 v8, s[72:73], 2.0, v8
    v_subrev_co_u32 v9, s[74:75], 2.0, v9
    v_subrev_co_u32 v10, s[76:77], 2.0, v10
    v_subrev_co_u32 v11, s[78:79], 2.0, v11
    s_mov_b64 exec, s[72:73]
    ds_read_b64 v[36:37], v36
    s_mov_b64 exec, s[74:75]
    ds_read_b64 v[38:39], v38
    s_mov_b64 exec, s[76:77]
    ds_read_b64 v[40:41], v40
    s_mov_b64 exec, s[78:79]
    ds_read_b64 v[42:43], v42
    s_mov_b64 exec, -1
L_batch_64:
    s_add_u32 s5, s38, 1

    s_movk_i32 s53, 5120
    buffer_load_dwordx4 v[90:93], v2, s[16:19], s53 offen
    buffer_load_dword v110, v2, s[16:19], s53 offen offset:16
    s_waitcnt lgkmcnt(0)
    s_barrier
    s_waitcnt vmcnt(7)
    ds_write_addtid_b32 v76 offset:0
    ds_write_addtid_b32 v77 offset:256
    ds_write_addtid_b32 v78 offset:512
    ds_write_addtid_b32 v79 offset:768
    s_waitcnt vmcnt(6)
    ds_write_addtid_b32 v80 offset:16384
    ds_write_addtid_b32 v81 offset:16640
    ds_write_addtid_b32 v82 offset:16896
    ds_write_addtid_b32 v83 offset:17152
    s_waitcnt vmcnt(5)
    ds_write_addtid_b32 v84 offset:32768
    ds_write_addtid_b32 v85 offset:33024
    ds_write_addtid_b32 v86 offset:33280
    ds_write_addtid_b32 v87 offset:33536
    v_lshlrev_b32 v119, 2, v0
    s_waitcnt vmcnt(4)
    s_mov_b64 exec, s[48:49]
    ds_write_b32 v119, v88 offset:49152
    s_mov_b64 exec, -1
    s_add_u32 s43, s43, 50048
    s_add_u32 s14, s43, 50000
    s_min_u32 s14, s14, s41
    buffer_load_dwordx4 v[76:79], v3, s[12:15], s43 offen
    s_add_u32 s52, s43, 16384
    buffer_load_dwordx4 v[80:83], v3, s[12:15], s52 offen
    v_subrev_co_u32 v4, s[64:65], 2.0, v4
    v_subrev_co_u32 v5, s[66:67], 2.0, v5
    v_subrev_co_u32 v6, s[68:69], 2.0, v6
    v_subrev_co_u32 v7, s[70:71], 2.0, v7
    v_subrev_co_u32 v8, s[72:73], 2.0, v8
    v_subrev_co_u32 v9, s[74:75], 2.0, v9
    v_subrev_co_u32 v10, s[76:77], 2.0, v10
    v_subrev_co_u32 v11, s[78:79], 2.0, v11
    v_subrev_co_u32 v12, s[80:81], 2.0, v12
    v_subrev_co_u32 v13, s[82:83], 2.0, v13
    v_subrev_co_u32 v14, s[84:85], 2.0, v14
    v_subrev_co_u32 v15, s[86:87], 2.0, v15
    s_waitcnt lgkmcnt(0)
    s_barrier
    s_add_u32 s52, s43, 32768
    buffer_load_dwordx4 v[84:87], v3, s[12:15], s52 offen
    s_add_u32 s52, s43, 49152
    v_lshlrev_b32 v119, 2, v0
    buffer_load_dword v88, v119, s[12:15], s52 offen
    s_mov_b64 exec, s[64:65]
    ds_read_b64 v[28:29], v28
    s_mov_b64 exec, s[66:67]
    ds_read_b64 v[30:31], v30
    s_mov_b64 exec, s[68:69]
    ds_read_b64 v[32:33], v32
    s_mov_b64 exec, s[70:71]
    ds_read_b64 v[34:35], v34
    s_mov_b64 exec, s[72:73]
    ds_read_b64 v[36:37], v36
    s_mov_b64 exec, s[74:75]
    ds_read_b64 v[38:39], v38
    s_mov_b64 exec, s[76:77]
    ds_read_b64 v[40:41], v40
    s_mov_b64 exec, s[78:79]
    ds_read_b64 v[42:43], v42
    s_mov_b64 exec, s[80:81]
    ds_read_b64 v[44:45], v44
    s_mov_b64 exec, s[82:83]
    ds_read_b64 v[46:47], v46
    s_mov_b64 exec, s[84:85]
    ds_read_b64 v[48:49], v48
    s_mov_b64 exec, s[86:87]
    ds_read_b64 v[50:51], v50
    s_mov_b64 exec, -1
    v_subrev_co_u32 v16, s[64:65], 2.0, v16
    v_subrev_co_u32 v17, s[66:67], 2.0, v17
    v_subrev_co_u32 v18, s[68:69], 2.0, v18
    v_subrev_co_u32 v19, s[70:71], 2.0, v19
    v_subrev_co_u32 v20, s[72:73], 2.0, v20
    v_subrev_co_u32 v21, s[74:75], 2.0, v21
    v_subrev_co_u32 v22, s[76:77], 2.0, v22
    v_subrev_co_u32 v23, s[78:79], 2.0, v23
    v_subrev_co_u32 v24, s[80:81], 2.0, v24
    v_subrev_co_u32 v25, s[82:83], 2.0, v25
    v_subrev_co_u32 v26, s[84:85], 2.0, v26
    v_subrev_co_u32 v27, s[86:87], 2.0, v27
    s_mov_b64 exec, s[64:65]
    ds_read_b64 v[52:53], v52
    s_mov_b64 exec, s[66:67]
    ds_read_b64 v[54:55], v54
    s_mov_b64 exec, s[68:69]
    ds_read_b64 v[56:57], v56
    s_mov_b64 exec, s[70:71]
    ds_read_b64 v[58:59], v58
    s_mov_b64 exec, s[72:73]
    ds_read_b64 v[60:61], v60
    s_mov_b64 exec, s[74:75]
    ds_read_b64 v[62:63], v62
    s_mov_b64 exec, s[76:77]
    ds_read_b64 v[64:65], v64
    s_mov_b64 exec, s[78:79]
    ds_read_b64 v[66:67], v66
    s_mov_b64 exec, s[80:81]
    ds_read_b64 v[68:69], v68
    s_mov_b64 exec, s[82:83]
    ds_read_b64 v[70:71], v70
    s_mov_b64 exec, s[84:85]
    ds_read_b64 v[72:73], v72
    s_mov_b64 exec, s[86:87]
    ds_read_b64 v[74:75], v74
    s_mov_b64 exec, -1
    s_cmp_le_i32 s42, 3072
    s_cbranch_scc1 L_nt1_66
    s_waitcnt vmcnt(12)
    v_perm_b32 v120, v107, v106, s24
    v_perm_b32 v122, v108, v107, s25
    v_perm_b32 v124, v109, v108, s26
    v_perm_b32 v126, v114, v109, s27
    v_alignbyte_b32 v107, v108, v107, 1
    v_alignbyte_b32 v108, v109, v108, 2
    v_alignbyte_b32 v109, v114, v109, 3
    v_lshlrev_b32_sdwa v120, 3, v120 dst_sel:WORD_0 dst_unused:UNUSED_PAD src0_sel:DWORD src1_sel:DWORD
    v_lshlrev_b32_sdwa v122, 3, v122 dst_sel:WORD_0 dst_unused:UNUSED_PAD src0_sel:DWORD src1_sel:DWORD
    v_lshlrev_b32_sdwa v124, 3, v124 dst_sel:WORD_0 dst_unused:UNUSED_PAD src0_sel:DWORD src1_sel:DWORD
    v_lshlrev_b32_sdwa v126, 3, v126 dst_sel:WORD_0 dst_unused:UNUSED_PAD src0_sel:DWORD src1_sel:DWORD
    s_cmp_lt_i32 s42, 3328
    s_cbranch_scc1 L_ufix_69
L_uback_70:

    v_lshrrev_b32 v117, 30, v106
    v_and_b32 v106, 0x3fffffff, v106
    v_mul_u32_u24 v117, 50000, v117
    v_cmp_ne_u32 vcc, 0, v106
    v_add_u32 v120, v120, v117
    s_mov_b64 exec, vcc

    buffer_load_dwordx2 v[120:121], v120, s[8:11], s50 offen
    s_mov_b64 exec, -1
    v_lshrrev_b32 v117, 30, v107
    v_and_b32 v107, 0x3fffffff, v107
    v_mul_u32_u24 v117, 50000, v117
    v_cmp_ne_u32 vcc, 0, v107
    v_add_u32 v122, v122, v117
    s_mov_b64 exec, vcc

    buffer_load_dwordx2 v[122:123], v122, s[8:11], s50 offen
    s_mov_b64 exec, -1
    v_lshrrev_b32 v117, 30, v108
    v_and_b32 v108, 0x3fffffff, v108
    v_mul_u32_u24 v117, 50000, v117
    v_cmp_ne_u32 vcc, 0, v108
    v_add_u32 v124, v124, v117
    s_mov_b64 exec, vcc

    buffer_load_dwordx2 v[124:125], v124, s[8:11], s50 offen
    s_mov_b64 exec, -1
    v_lshrrev_b32 v117, 30, v109
    v_and_b32 v109, 0x3fffffff, v109
    v_mul_u32_u24 v117, 50000, v117
    v_cmp_ne_u32 vcc, 0, v109
    v_add_u32 v126, v126, v117
    s_mov_b64 exec, vcc

    buffer_load_dwordx2 v[126:127], v126, s[8:11], s50 offen
    s_mov_b64 exec, -1
L_nt1_66:
    s_movk_i32 s53, 7680
    buffer_load_dwordx4 v[94:97], v2, s[16:19], s53 offen
    buffer_load_dword v111, v2, s[16:19], s53 offen offset:16
    s_waitcnt lgkmcnt(0)
    s_barrier
    s_waitcnt vmcnt(5)
    ds_write_addtid_b32 v76 offset:0
    ds_write_addtid_b32 v77 offset:256
    ds_write_addtid_b32 v78 offset:512
    ds_write_addtid_b32 v79 offset:768
    s_waitcnt vmcnt(4)
    ds_write_addtid_b32 v80 offset:16384
    ds_write_addtid_b32 v81 offset:16640
    ds_write_addtid_b32 v82 offset:16896
    ds_write_addtid_b32 v83 offset:17152
    s_waitcnt vmcnt(3)
    ds_write_addtid_b32 v84 offset:32768
    ds_write_addtid_b32 v85 offset:33024
    ds_write_addtid_b32 v86 offset:33280
    ds_write_addtid_b32 v87 offset:33536
    v_lshlrev_b32 v119, 2, v0
    s_waitcnt vmcnt(2)
    s_mov_b64 exec, s[48:49]
    ds_write_b32 v119, v88 offset:49152
    s_mov_b64 exec, -1
    s_add_u32 s43, s43, 50048
    s_add_u32 s14, s43, 50000
    s_min_u32 s14, s14, s41
    buffer_load_dwordx4 v[76:79], v3, s[12:15], s43 offen
    s_add_u32 s52, s43, 16384
    buffer_load_dwordx4 v[80:83], v3, s[12:15], s52 offen
    v_subrev_co_u32 v4, s[64:65], 2.0, v4
    v_subrev_co_u32 v5, s[66:67], 2.0, v5
    v_subrev_co_u32 v6, s[68:69], 2.0, v6
    v_subrev_co_u32 v7, s[70:71], 2.0, v7
    v_subrev_co_u32 v8, s[72:73], 2.0, v8
    v_subrev_co_u32 v9, s[74:75], 2.0, v9
    v_subrev_co_u32 v10, s[76:77], 2.0, v10
    v_subrev_co_u32 v11, s[78:79], 2.0, v11
    v_subrev_co_u32 v12, s[80:81], 2.0, v12
    v_subrev_co_u32 v13, s[82:83], 2.0, v13
    v_subrev_co_u32 v14, s[84:85], 2.0, v14
    v_subrev_co_u32 v15, s[86:87], 2.0, v15
    s_waitcnt lgkmcnt(0)
    s_barrier
    s_add_u32 s52, s43, 32768
    buffer_load_dwordx4 v[84:87], v3, s[12:15], s52 offen
    s_add_u32 s52, s43, 49152
    v_lshlrev_b32 v119, 2, v0
    buffer_load_dword v88, v119, s[12:15], s52 offen
    s_mov_b64 exec, s[64:65]
    ds_read_b64 v[28:29], v28
    s_mov_b64 exec, s[66:67]
    ds_read_b64 v[30:31], v30
    s_mov_b64 exec, s[68:69]
    ds_read_b64 v[32:33], v32
    s_mov_b64 exec, s[70:71]
    ds_read_b64 v[34:35], v34
    s_mov_b64 exec, s[72:73]
    ds_read_b64 v[36:37], v36
    s_mov_b64 exec, s[74:75]
    ds_read_b64 v[38:39], v38
    s_mov_b64 exec, s[76:77]
    ds_read_b64 v[40:41], v40
    s_mov_b64 exec, s[78:79]
    ds_read_b64 v[42:43], v42
    s_mov_b64 exec, s[80:81]
    ds_read_b64 v[44:45], v44
    s_mov_b64 exec, s[82:83]
    ds_read_b64 v[46:47], v46
    s_mov_b64 exec, s[84:85]
    ds_read_b64 v[48:49], v48
    s_mov_b64 exec, s[86:87]
    ds_read_b64 v[50:51], v50
    s_mov_b64 exec, -1
    v_subrev_co_u32 v16, s[64:65], 2.0, v16
    v_subrev_co_u32 v17, s[66:67], 2.0, v17
    v_subrev_co_u32 v18, s[68:69], 2.0, v18
    v_subrev_co_u32 v19, s[70:71], 2.0, v19
    v_subrev_co_u32 v20, s[72:73], 2.0, v20
    v_subrev_co_u32 v21, s[74:75], 2.0, v21
    v_subrev_co_u32 v22, s[76:77], 2.0, v22
    v_subrev_co_u32 v23, s[78:79], 2.0, v23
    v_subrev_co_u32 v24, s[80:81], 2.0, v24
    v_subrev_co_u32 v25, s[82:83], 2.0, v25
    v_subrev_co_u32 v26, s[84:85], 2.0, v26
    v_subrev_co_u32 v27, s[86:87], 2.0, v27
    s_mov_b64 exec, s[64:65]
    ds_read_b64 v[52:53], v52
    s_mov_b64 exec, s[66:67]
    ds_read_b64 v[54:55], v54
    s_mov_b64 exec, s[68:69]
    ds_read_b64 v[56:57], v56
    s_mov_b64 exec, s[70:71]
    ds_read_b64 v[58:59], v58
    s_mov_b64 exec, s[72:73]
    ds_read_b64 v[60:61], v60
    s_mov_b64 exec, s[74:75]
    ds_read_b64 v[62:63], v62
    s_mov_b64 exec, s[76:77]
    ds_read_b64 v[64:65], v64
    s_mov_b64 exec, s[78:79]
    ds_read_b64 v[66:67], v66
    s_mov_b64 exec, s[80:81]
    ds_read_b64 v[68:69], v68
    s_mov_b64 exec, s[82:83]
    ds_read_b64 v[70:71], v70
    s_mov_b64 exec, s[84:85]
    ds_read_b64 v[72:73], v72
    s_mov_b64 exec, s[86:87]
    ds_read_b64 v[74:75], v74
    s_mov_b64 exec, -1
    s_movk_i32 s53, 10240
    buffer_load_dwordx4 v[98:101], v2, s[16:19], s53 offen
    buffer_load_dword v112, v2, s[16:19], s53 offen offset:16
    s_cmp_le_i32 s42, 3072
    s_cbranch_scc1 L_nt2_67
    s_waitcnt vmcnt(8)
    v_cmp_ne_u32 s[64:65], 0, v106
    v_cmp_ne_u32 s[66:67], 0, v107
    v_cmp_ne_u32 s[68:69], 0, v108
    v_cmp_ne_u32 s[70:71], 0, v109
    s_mov_b64 exec, s[64:65]
    v_cvt_f32_i32_sdwa v118, sext(v106) dst_sel:DWORD dst_unused:UNUSED_PAD src0_sel:WORD_0
    v_lshlrev_b32 v116, 16, v120
    v_and_b32 v117, s32, v120
    v_mul_f32 v118, s33, v118
    v_lshlrev_b32 v120, 16, v121
    v_and_b32 v121, s32, v121
    v_lshlrev_b32_sdwa v106, 3, v106 dst_sel:DWORD dst_unused:UNUSED_PAD src0_sel:DWORD src1_sel:WORD_1
    v_pk_fma_f32 v[116:117], v[116:117], v[118:119], s[28:29] op_sel_hi:[1,0,1]
    v_pk_fma_f32 v[120:121], v[120:121], v[118:119], s[28:29] op_sel_hi:[1,0,1]
    v_perm_b32 v116, v117, v116, s35
    v_perm_b32 v117, v121, v120, s35
    v_lshl_add_u64 v[116:117], v[116:117], 0, s[30:31]
    ds_add_rtn_u64 v[120:121], v106, v[116:117] offset:50000

    s_mov_b64 exec, s[66:67]
    v_cvt_f32_i32_sdwa v118, sext(v107) dst_sel:DWORD dst_unused:UNUSED_PAD src0_sel:WORD_0
    v_lshlrev_b32 v116, 16, v122
    v_and_b32 v117, s32, v122
    v_mul_f32 v118, s33, v118
    v_lshlrev_b32 v122, 16, v123
    v_and_b32 v123, s32, v123
    v_lshlrev_b32_sdwa v107, 3, v107 dst_sel:DWORD dst_unused:UNUSED_PAD src0_sel:DWORD src1_sel:WORD_1
    v_pk_fma_f32 v[116:117], v[116:117], v[118:119], s[28:29] op_sel_hi:[1,0,1]
    v_pk_fma_f32 v[122:123], v[122:123], v[118:119], s[28:29] op_sel_hi:[1,0,1]
    v_perm_b32 v116, v117, v116, s35
    v_perm_b32 v117, v123, v122, s35
    v_lshl_add_u64 v[116:117], v[116:117], 0, s[30:31]
    ds_add_rtn_u64 v[122:123], v107, v[116:117] offset:50000

    s_mov_b64 exec, s[68:69]
    v_cvt_f32_i32_sdwa v118, sext(v108) dst_sel:DWORD dst_unused:UNUSED_PAD src0_sel:WORD_0
    v_lshlrev_b32 v116, 16, v124
    v_and_b32 v117, s32, v124
    v_mul_f32 v118, s33, v118
    v_lshlrev_b32 v124, 16, v125
    v_and_b32 v125, s32, v125
    v_lshlrev_b32_sdwa v108, 3, v108 dst_sel:DWORD dst_unused:UNUSED_PAD src0_sel:DWORD src1_sel:WORD_1
    v_pk_fma_f32 v[116:117], v[116:117], v[118:119], s[28:29] op_sel_hi:[1,0,1]
    v_pk_fma_f32 v[124:125], v[124:125], v[118:119], s[28:29] op_sel_hi:[1,0,1]
    v_perm_b32 v116, v117, v116, s35
    v_perm_b32 v117, v125, v124, s35
    v_lshl_add_u64 v[116:117], v[116:117], 0, s[30:31]
    ds_add_rtn_u64 v[124:125], v108, v[116:117] offset:50000

    s_mov_b64 exec, s[70:71]
    v_cvt_f32_i32_sdwa v118, sext(v109) dst_sel:DWORD dst_unused:UNUSED_PAD src0_sel:WORD_0
    v_lshlrev_b32 v116, 16, v126
    v_and_b32 v117, s32, v126
    v_mul_f32 v118, s33, v118
    v_lshlrev_b32 v126, 16, v127
    v_and_b32 v127, s32, v127
    v_lshlrev_b32_sdwa v109, 3, v109 dst_sel:DWORD dst_unused:UNUSED_PAD src0_sel:DWORD src1_sel:WORD_1
    v_pk_fma_f32 v[116:117], v[116:117], v[118:119], s[28:29] op_sel_hi:[1,0,1]
    v_pk_fma_f32 v[126:127], v[126:127], v[118:119], s[28:29] op_sel_hi:[1,0,1]
    v_perm_b32 v116, v117, v116, s35
    v_perm_b32 v117, v127, v126, s35
    v_lshl_add_u64 v[116:117], v[116:117], 0, s[30:31]
    ds_add_rtn_u64 v[126:127], v109, v[116:117] offset:50000

    s_waitcnt lgkmcnt(0)
    s_mov_b64 exec, s[64:65]
    v_or3_b32 v1, v120, v121, v1
    s_mov_b64 exec, s[66:67]
    v_or3_b32 v1, v122, v123, v1
    s_mov_b64 exec, s[68:69]
    v_or3_b32 v1, v124, v125, v1
    s_mov_b64 exec, s[70:71]
    v_or3_b32 v1, v126, v127, v1
    s_mov_b64 exec, -1
L_nt2_67:
    s_movk_i32 s53, 15360
    buffer_load_dwordx4 v[106:109], v2, s[16:19], s53 offen
    buffer_load_dword v114, v2, s[16:19], s53 offen offset:16
    s_cmp_le_u32 s40, 3584
    s_cbranch_scc1 L_noleft_68
    s_min_u32 s40, s40, 3968
    s_lshl_b32 s52, s38, 6
    s_add_u32 s52, s52, s36
    s_mul_i32 s52, s52, 19840
    s_add_u32 s20, s44, s52
    s_addc_u32 s21, s45, 0
    s_mul_i32 s52, s40, 5
    s_add_u32 s52, s52, 3
    s_and_b32 s22, s52, -4

    s_lshr_b32 s55, s39, 2
    s_add_u32 s55, s55, 3584
    v_and_b32 v120, 63, v0
    v_add_u32 v120, s55, v120
L_left_71:
    s_cmp_ge_u32 s55, s40
    s_cbranch_scc1 L_leftend_72
    v_mul_u32_u24 v121, 5, v120
    buffer_load_dword v122, v121, s[20:23], 0 offen
    buffer_load_ubyte v123, v121, s[20:23], 0 offen offset:4
    s_waitcnt vmcnt(0)

    v_perm_b32 v121, v123, v122, s24
    v_lshrrev_b32 v126, 30, v122
    v_and_b32 v121, 0x1fff, v121
    v_mul_u32_u24 v126, 6250, v126
    v_add_lshl_u32 v121, v121, v126, 3

    buffer_load_dwordx2 v[124:125], v121, s[8:11], s50 offen
    v_cmp_gt_u32 vcc, s40, v120
    s_waitcnt vmcnt(0)

    s_mov_b64 exec, vcc
    v_and_b32 v122, 0x3fffffff, v122
    v_cvt_f32_i32_sdwa v118, sext(v122) dst_sel:DWORD dst_unused:UNUSED_PAD src0_sel:WORD_0
    v_lshlrev_b32 v116, 16, v124
    v_and_b32 v117, s32, v124
    v_mul_f32 v118, s33, v118
    v_lshlrev_b32 v124, 16, v125
    v_and_b32 v125, s32, v125
    v_lshlrev_b32_sdwa v122, 3, v122 dst_sel:DWORD dst_unused:UNUSED_PAD src0_sel:DWORD src1_sel:WORD_1
    v_pk_fma_f32 v[116:117], v[116:117], v[118:119], s[28:29] op_sel_hi:[1,0,1]
    v_pk_fma_f32 v[124:125], v[124:125], v[118:119], s[28:29] op_sel_hi:[1,0,1]
    v_perm_b32 v116, v117, v116, s35
    v_perm_b32 v117, v125, v124, s35
    v_lshl_add_u64 v[116:117], v[116:117], 0, s[30:31]
    ds_add_rtn_u64 v[124:125], v122, v[116:117] offset:50000

    s_waitcnt lgkmcnt(0)
    v_or3_b32 v1, v124, v125, v1
    s_mov_b64 exec, -1
    v_add_u32 v120, 128, v120
    s_add_u32 s55, s55, 128
    s_branch L_left_71
L_leftend_72:

L_noleft_68:
    s_waitcnt lgkmcnt(0)
    s_barrier
    s_waitcnt vmcnt(7)
    ds_write_addtid_b32 v76 offset:0
    ds_write_addtid_b32 v77 offset:256
    ds_write_addtid_b32 v78 offset:512
    ds_write_addtid_b32 v79 offset:768
    s_waitcnt vmcnt(6)
    ds_write_addtid_b32 v80 offset:16384
    ds_write_addtid_b32 v81 offset:16640
    ds_write_addtid_b32 v82 offset:16896
    ds_write_addtid_b32 v83 offset:17152
    s_waitcnt vmcnt(5)
    ds_write_addtid_b32 v84 offset:32768
    ds_write_addtid_b32 v85 offset:33024
    ds_write_addtid_b32 v86 offset:33280
    ds_write_addtid_b32 v87 offset:33536
    v_lshlrev_b32 v119, 2, v0
    s_waitcnt vmcnt(4)
    s_mov_b64 exec, s[48:49]
    ds_write_b32 v119, v88 offset:49152
    s_mov_b64 exec, -1
    s_add_u32 s43, s43, 50048
    s_add_u32 s14, s43, 50000
    s_min_u32 s14, s14, s41
    buffer_load_dwordx4 v[76:79], v3, s[12:15], s43 offen
    s_add_u32 s52, s43, 16384
    buffer_load_dwordx4 v[80:83], v3, s[12:15], s52 offen
    v_cmp_gt_u32 s[64:65], 2.0, v4
    v_and_b32 v4, 0x3fffffff, v4
    v_cmp_gt_u32 s[66:67], 2.0, v5
    v_and_b32 v5, 0x3fffffff, v5
    v_cmp_gt_u32 s[68:69], 2.0, v6
    v_and_b32 v6, 0x3fffffff, v6
    v_cmp_gt_u32 s[70:71], 2.0, v7
    v_and_b32 v7, 0x3fffffff, v7
    v_cmp_gt_u32 s[72:73], 2.0, v8
    v_and_b32 v8, 0x3fffffff, v8
    v_cmp_gt_u32 s[74:75], 2.0, v9
    v_and_b32 v9, 0x3fffffff, v9
    v_cmp_gt_u32 s[76:77], 2.0, v10
    v_and_b32 v10, 0x3fffffff, v10
    v_cmp_gt_u32 s[78:79], 2.0, v11
    v_and_b32 v11, 0x3fffffff, v11
    v_cmp_gt_u32 s[80:81], 2.0, v12
    v_and_b32 v12, 0x3fffffff, v12
    v_cmp_gt_u32 s[82:83], 2.0, v13
    v_and_b32 v13, 0x3fffffff, v13
    v_cmp_gt_u32 s[84:85], 2.0, v14
    v_and_b32 v14, 0x3fffffff, v14
    v_cmp_gt_u32 s[86:87], 2.0, v15
    v_and_b32 v15, 0x3fffffff, v15
    s_waitcnt lgkmcnt(0)
    s_barrier
    s_add_u32 s52, s43, 32768
    buffer_load_dwordx4 v[84:87], v3, s[12:15], s52 offen
    s_add_u32 s52, s43, 49152
    v_lshlrev_b32 v119, 2, v0
    buffer_load_dword v88, v119, s[12:15], s52 offen
    s_mov_b64 exec, s[64:65]
    ds_read_b64 v[28:29], v28
    s_mov_b64 exec, s[66:67]
    ds_read_b64 v[30:31], v30
    s_mov_b64 exec, s[68:69]
    ds_read_b64 v[32:33], v32
    s_mov_b64 exec, s[70:71]
    ds_read_b64 v[34:35], v34
    s_mov_b64 exec, s[72:73]
    ds_read_b64 v[36:37], v36
    s_mov_b64 exec, s[74:75]
    ds_read_b64 v[38:39], v38
    s_mov_b64 exec, s[76:77]
    ds_read_b64 v[40:41], v40
    s_mov_b64 exec, s[78:79]
    ds_read_b64 v[42:43], v42
    s_mov_b64 exec, s[80:81]
    ds_read_b64 v[44:45], v44
    s_mov_b64 exec, s[82:83]
    ds_read_b64 v[46:47], v46
    s_mov_b64 exec, s[84:85]
    ds_read_b64 v[48:49], v48
    s_mov_b64 exec, s[86:87]
    ds_read_b64 v[50:51], v50
    s_mov_b64 exec, -1
    v_cmp_gt_u32 s[64:65], 2.0, v16
    v_and_b32 v16, 0x3fffffff, v16
    v_cmp_gt_u32 s[66:67], 2.0, v17
    v_and_b32 v17, 0x3fffffff, v17
    v_cmp_gt_u32 s[68:69], 2.0, v18
    v_and_b32 v18, 0x3fffffff, v18
    v_cmp_gt_u32 s[70:71], 2.0, v19
    v_and_b32 v19, 0x3fffffff, v19
    v_cmp_gt_u32 s[72:73], 2.0, v20
    v_and_b32 v20, 0x3fffffff, v20
    v_cmp_gt_u32 s[74:75], 2.0, v21
    v_and_b32 v21, 0x3fffffff, v21
    v_cmp_gt_u32 s[76:77], 2.0, v22
    v_and_b32 v22, 0x3fffffff, v22
    v_cmp_gt_u32 s[78:79], 2.0, v23
    v_and_b32 v23, 0x3fffffff, v23
    v_cmp_gt_u32 s[80:81], 2.0, v24
    v_and_b32 v24, 0x3fffffff, v24
    v_cmp_gt_u32 s[82:83], 2.0, v25
    v_and_b32 v25, 0x3fffffff, v25
    v_cmp_gt_u32 s[84:85], 2.0, v26
    v_and_b32 v26, 0x3fffffff, v26
    v_cmp_gt_u32 s[86:87], 2.0, v27
    v_and_b32 v27, 0x3fffffff, v27
    s_mov_b64 exec, s[64:65]
    ds_read_b64 v[52:53], v52
    s_mov_b64 exec, s[66:67]
    ds_read_b64 v[54:55], v54
    s_mov_b64 exec, s[68:69]
    ds_read_b64 v[56:57], v56
    s_mov_b64 exec, s[70:71]
    ds_read_b64 v[58:59], v58
    s_mov_b64 exec, s[72:73]
    ds_read_b64 v[60:61], v60
    s_mov_b64 exec, s[74:75]
    ds_read_b64 v[62:63], v62
    s_mov_b64 exec, s[76:77]
    ds_read_b64 v[64:65], v64
    s_mov_b64 exec, s[78:79]
    ds_read_b64 v[66:67], v66
    s_mov_b64 exec, s[80:81]
    ds_read_b64 v[68:69], v68
    s_mov_b64 exec, s[82:83]
    ds_read_b64 v[70:71], v70
    s_mov_b64 exec, s[84:85]
    ds_read_b64 v[72:73], v72
    s_mov_b64 exec, s[86:87]
    ds_read_b64 v[74:75], v74
    s_mov_b64 exec, -1
    s_movk_i32 s53, 12800
    buffer_load_dwordx4 v[102:105], v2, s[16:19], s53 offen
    buffer_load_dword v113, v2, s[16:19], s53 offen offset:16
    s_cmp_ge_u32 s5, s4
    s_cbranch_scc1 L_bend_65
    s_waitcnt lgkmcnt(15)
    v_mad_i32_i16 v120, v28, v4, s96
    v_mad_i32_i16 v28, v28, v4, s96 op_sel:[1,0,0,0]
    v_mad_i32_i16 v121, v29, v4, s96
    v_mad_i32_i16 v29, v29, v4, s96 op_sel:[1,0,0,0]
    v_lshlrev_b32_sdwa v4, 3, v4 dst_sel:DWORD dst_unused:UNUSED_PAD src0_sel:DWORD src1_sel:WORD_1
    v_perm_b32 v28, v28, v120, s97
    v_perm_b32 v29, v29, v121, s97
    v_lshl_add_u64 v[28:29], v[28:29], 0, s[30:31]

    ds_add_rtn_u64 v[28:29], v4, v[28:29] offset:50000
    v_mad_i32_i16 v122, v30, v5, s96
    v_mad_i32_i16 v30, v30, v5, s96 op_sel:[1,0,0,0]
    v_mad_i32_i16 v123, v31, v5, s96
    v_mad_i32_i16 v31, v31, v5, s96 op_sel:[1,0,0,0]
    v_lshlrev_b32_sdwa v5, 3, v5 dst_sel:DWORD dst_unused:UNUSED_PAD src0_sel:DWORD src1_sel:WORD_1
    v_perm_b32 v30, v30, v122, s97
    v_perm_b32 v31, v31, v123, s97
    v_lshl_add_u64 v[30:31], v[30:31], 0, s[30:31]

    ds_add_rtn_u64 v[30:31], v5, v[30:31] offset:50000
    v_mad_i32_i16 v124, v32, v6, s96
    v_mad_i32_i16 v32, v32, v6, s96 op_sel:[1,0,0,0]
    v_mad_i32_i16 v125, v33, v6, s96
    v_mad_i32_i16 v33, v33, v6, s96 op_sel:[1,0,0,0]
    v_lshlrev_b32_sdwa v6, 3, v6 dst_sel:DWORD dst_unused:UNUSED_PAD src0_sel:DWORD src1_sel:WORD_1
    v_perm_b32 v32, v32, v124, s97
    v_perm_b32 v33, v33, v125, s97
    v_lshl_add_u64 v[32:33], v[32:33], 0, s[30:31]

    ds_add_rtn_u64 v[32:33], v6, v[32:33] offset:50000
    v_mad_i32_i16 v126, v34, v7, s96
    v_mad_i32_i16 v34, v34, v7, s96 op_sel:[1,0,0,0]
    v_mad_i32_i16 v127, v35, v7, s96
    v_mad_i32_i16 v35, v35, v7, s96 op_sel:[1,0,0,0]
    v_lshlrev_b32_sdwa v7, 3, v7 dst_sel:DWORD dst_unused:UNUSED_PAD src0_sel:DWORD src1_sel:WORD_1
    v_perm_b32 v34, v34, v126, s97
    v_perm_b32 v35, v35, v127, s97
    v_lshl_add_u64 v[34:35], v[34:35], 0, s[30:31]

    ds_add_rtn_u64 v[34:35], v7, v[34:35] offset:50000
    v_mad_i32_i16 v120, v36, v8, s96
    v_mad_i32_i16 v36, v36, v8, s96 op_sel:[1,0,0,0]
    v_mad_i32_i16 v121, v37, v8, s96
    v_mad_i32_i16 v37, v37, v8, s96 op_sel:[1,0,0,0]
    v_lshlrev_b32_sdwa v8, 3, v8 dst_sel:DWORD dst_unused:UNUSED_PAD src0_sel:DWORD src1_sel:WORD_1
    v_perm_b32 v36, v36, v120, s97
    v_perm_b32 v37, v37, v121, s97
    v_lshl_add_u64 v[36:37], v[36:37], 0, s[30:31]

    ds_add_rtn_u64 v[36:37], v8, v[36:37] offset:50000
    v_mad_i32_i16 v122, v38, v9, s96
    v_mad_i32_i16 v38, v38, v9, s96 op_sel:[1,0,0,0]
    v_mad_i32_i16 v123, v39, v9, s96
    v_mad_i32_i16 v39, v39, v9, s96 op_sel:[1,0,0,0]
    v_lshlrev_b32_sdwa v9, 3, v9 dst_sel:DWORD dst_unused:UNUSED_PAD src0_sel:DWORD src1_sel:WORD_1
    v_perm_b32 v38, v38, v122, s97
    v_perm_b32 v39, v39, v123, s97
    v_lshl_add_u64 v[38:39], v[38:39], 0, s[30:31]

    ds_add_rtn_u64 v[38:39], v9, v[38:39] offset:50000
    v_mad_i32_i16 v124, v40, v10, s96
    v_mad_i32_i16 v40, v40, v10, s96 op_sel:[1,0,0,0]
    v_mad_i32_i16 v125, v41, v10, s96
    v_mad_i32_i16 v41, v41, v10, s96 op_sel:[1,0,0,0]
    v_lshlrev_b32_sdwa v10, 3, v10 dst_sel:DWORD dst_unused:UNUSED_PAD src0_sel:DWORD src1_sel:WORD_1
    v_perm_b32 v40, v40, v124, s97
    v_perm_b32 v41, v41, v125, s97
    v_lshl_add_u64 v[40:41], v[40:41], 0, s[30:31]

    ds_add_rtn_u64 v[40:41], v10, v[40:41] offset:50000
    v_mad_i32_i16 v126, v42, v11, s96
    v_mad_i32_i16 v42, v42, v11, s96 op_sel:[1,0,0,0]
    v_mad_i32_i16 v127, v43, v11, s96
    v_mad_i32_i16 v43, v43, v11, s96 op_sel:[1,0,0,0]
    v_lshlrev_b32_sdwa v11, 3, v11 dst_sel:DWORD dst_unused:UNUSED_PAD src0_sel:DWORD src1_sel:WORD_1
    v_perm_b32 v42, v42, v126, s97
    v_perm_b32 v43, v43, v127, s97
    v_lshl_add_u64 v[42:43], v[42:43], 0, s[30:31]

    ds_add_rtn_u64 v[42:43], v11, v[42:43] offset:50000
    s_waitcnt lgkmcnt(4)
    v_or3_b32 v1, v28, v29, v1
    v_or3_b32 v1, v30, v31, v1
    v_or3_b32 v1, v32, v33, v1
    v_or3_b32 v1, v34, v35, v1
    s_barrier
    s_waitcnt vmcnt(5)
    ds_write_addtid_b32 v76 offset:0
    ds_write_addtid_b32 v77 offset:256
    ds_write_addtid_b32 v78 offset:512
    ds_write_addtid_b32 v79 offset:768
    s_waitcnt vmcnt(4)
    ds_write_addtid_b32 v80 offset:16384
    ds_write_addtid_b32 v81 offset:16640
    ds_write_addtid_b32 v82 offset:16896
    ds_write_addtid_b32 v83 offset:17152
    s_waitcnt vmcnt(3)
    ds_write_addtid_b32 v84 offset:32768
    ds_write_addtid_b32 v85 offset:33024
    ds_write_addtid_b32 v86 offset:33280
    ds_write_addtid_b32 v87 offset:33536
    v_lshlrev_b32 v119, 2, v0
    s_waitcnt vmcnt(2)
    s_mov_b64 exec, s[48:49]
    ds_write_b32 v119, v88 offset:49152
    s_mov_b64 exec, -1
    s_add_u32 s43, s43, 50048
    s_add_u32 s14, s43, 50000
    s_min_u32 s14, s14, s41
    buffer_load_dwordx4 v[76:79], v3, s[12:15], s43 offen
    s_add_u32 s52, s43, 16384
    buffer_load_dwordx4 v[80:83], v3, s[12:15], s52 offen
    s_add_u32 s52, s43, 32768
    buffer_load_dwordx4 v[84:87], v3, s[12:15], s52 offen
    s_add_u32 s52, s43, 49152
    v_lshlrev_b32 v119, 2, v0
    buffer_load_dword v88, v119, s[12:15], s52 offen
    s_add_u32 s54, s43, 50048
    buffer_load_dword v115, v89, s[60:63], s54 offen
    s_add_u32 s54, s50, 200000
    buffer_load_dword v115, v89, s[8:11], s54 offen
    s_movk_i32 s53, 0
    buffer_load_dwordx4 v[4:7], v2, s[16:19], s53 offen
    buffer_load_dword v35, v2, s[16:19], s53 offen offset:16
    v_mad_i32_i16 v120, v44, v12, s96
    v_mad_i32_i16 v44, v44, v12, s96 op_sel:[1,0,0,0]
    v_mad_i32_i16 v121, v45, v12, s96
    v_mad_i32_i16 v45, v45, v12, s96 op_sel:[1,0,0,0]
    v_lshlrev_b32_sdwa v12, 3, v12 dst_sel:DWORD dst_unused:UNUSED_PAD src0_sel:DWORD src1_sel:WORD_1
    v_perm_b32 v44, v44, v120, s97
    v_perm_b32 v45, v45, v121, s97
    v_lshl_add_u64 v[44:45], v[44:45], 0, s[30:31]

    ds_add_rtn_u64 v[44:45], v12, v[44:45] offset:50000
    v_mad_i32_i16 v122, v46, v13, s96
    v_mad_i32_i16 v46, v46, v13, s96 op_sel:[1,0,0,0]
    v_mad_i32_i16 v123, v47, v13, s96
    v_mad_i32_i16 v47, v47, v13, s96 op_sel:[1,0,0,0]
    v_lshlrev_b32_sdwa v13, 3, v13 dst_sel:DWORD dst_unused:UNUSED_PAD src0_sel:DWORD src1_sel:WORD_1
    v_perm_b32 v46, v46, v122, s97
    v_perm_b32 v47, v47, v123, s97
    v_lshl_add_u64 v[46:47], v[46:47], 0, s[30:31]

    ds_add_rtn_u64 v[46:47], v13, v[46:47] offset:50000
    v_mad_i32_i16 v124, v48, v14, s96
    v_mad_i32_i16 v48, v48, v14, s96 op_sel:[1,0,0,0]
    v_mad_i32_i16 v125, v49, v14, s96
    v_mad_i32_i16 v49, v49, v14, s96 op_sel:[1,0,0,0]
    v_lshlrev_b32_sdwa v14, 3, v14 dst_sel:DWORD dst_unused:UNUSED_PAD src0_sel:DWORD src1_sel:WORD_1
    v_perm_b32 v48, v48, v124, s97
    v_perm_b32 v49, v49, v125, s97
    v_lshl_add_u64 v[48:49], v[48:49], 0, s[30:31]

    ds_add_rtn_u64 v[48:49], v14, v[48:49] offset:50000
    v_mad_i32_i16 v126, v50, v15, s96
    v_mad_i32_i16 v50, v50, v15, s96 op_sel:[1,0,0,0]
    v_mad_i32_i16 v127, v51, v15, s96
    v_mad_i32_i16 v51, v51, v15, s96 op_sel:[1,0,0,0]
    v_lshlrev_b32_sdwa v15, 3, v15 dst_sel:DWORD dst_unused:UNUSED_PAD src0_sel:DWORD src1_sel:WORD_1
    v_perm_b32 v50, v50, v126, s97
    v_perm_b32 v51, v51, v127, s97
    v_lshl_add_u64 v[50:51], v[50:51], 0, s[30:31]

    ds_add_rtn_u64 v[50:51], v15, v[50:51] offset:50000
    s_waitcnt lgkmcnt(15)
    v_or3_b32 v1, v36, v37, v1
    v_or3_b32 v1, v38, v39, v1
    v_or3_b32 v1, v40, v41, v1
    v_or3_b32 v1, v42, v43, v1
    s_movk_i32 s53, 2560
    buffer_load_dwordx4 v[8:11], v2, s[16:19], s53 offen
    buffer_load_dword v43, v2, s[16:19], s53 offen offset:16
    s_mov_b32 s40, s88
    s_sub_u32 s42, s40, s39

    s_add_u32 s55, s38, 2
    s_min_u32 s55, s55, 31
    s_mov_b32 s88, s89
    s_mov_b32 s89, s90
    s_mov_b32 s90, s91
    s_mov_b32 s91, s92
    s_mov_b32 s92, s93
    s_mov_b32 s93, s94
    s_mov_b32 s94, s95
    s_mov_b32 s95, 0
    s_min_u32 s88, s88, 3968
    s_lshl_b32 s52, s55, 6
    s_add_u32 s52, s52, s36
    s_mul_i32 s52, s52, 19840
    s_add_u32 s16, s44, s52
    s_addc_u32 s17, s45, 0
    s_mul_i32 s52, s88, 5
    s_add_u32 s52, s52, 3
    s_and_b32 s18, s52, -4

    v_mad_i32_i16 v120, v52, v16, s96
    v_mad_i32_i16 v52, v52, v16, s96 op_sel:[1,0,0,0]
    v_mad_i32_i16 v121, v53, v16, s96
    v_mad_i32_i16 v53, v53, v16, s96 op_sel:[1,0,0,0]
    v_lshlrev_b32_sdwa v16, 3, v16 dst_sel:DWORD dst_unused:UNUSED_PAD src0_sel:DWORD src1_sel:WORD_1
    v_perm_b32 v52, v52, v120, s97
    v_perm_b32 v53, v53, v121, s97
    v_lshl_add_u64 v[52:53], v[52:53], 0, s[30:31]

    ds_add_rtn_u64 v[52:53], v16, v[52:53] offset:50000
    v_mad_i32_i16 v122, v54, v17, s96
    v_mad_i32_i16 v54, v54, v17, s96 op_sel:[1,0,0,0]
    v_mad_i32_i16 v123, v55, v17, s96
    v_mad_i32_i16 v55, v55, v17, s96 op_sel:[1,0,0,0]
    v_lshlrev_b32_sdwa v17, 3, v17 dst_sel:DWORD dst_unused:UNUSED_PAD src0_sel:DWORD src1_sel:WORD_1
    v_perm_b32 v54, v54, v122, s97
    v_perm_b32 v55, v55, v123, s97
    v_lshl_add_u64 v[54:55], v[54:55], 0, s[30:31]

    ds_add_rtn_u64 v[54:55], v17, v[54:55] offset:50000
    v_mad_i32_i16 v124, v56, v18, s96
    v_mad_i32_i16 v56, v56, v18, s96 op_sel:[1,0,0,0]
    v_mad_i32_i16 v125, v57, v18, s96
    v_mad_i32_i16 v57, v57, v18, s96 op_sel:[1,0,0,0]
    v_lshlrev_b32_sdwa v18, 3, v18 dst_sel:DWORD dst_unused:UNUSED_PAD src0_sel:DWORD src1_sel:WORD_1
    v_perm_b32 v56, v56, v124, s97
    v_perm_b32 v57, v57, v125, s97
    v_lshl_add_u64 v[56:57], v[56:57], 0, s[30:31]

    ds_add_rtn_u64 v[56:57], v18, v[56:57] offset:50000
    v_mad_i32_i16 v126, v58, v19, s96
    v_mad_i32_i16 v58, v58, v19, s96 op_sel:[1,0,0,0]
    v_mad_i32_i16 v127, v59, v19, s96
    v_mad_i32_i16 v59, v59, v19, s96 op_sel:[1,0,0,0]
    v_lshlrev_b32_sdwa v19, 3, v19 dst_sel:DWORD dst_unused:UNUSED_PAD src0_sel:DWORD src1_sel:WORD_1
    v_perm_b32 v58, v58, v126, s97
    v_perm_b32 v59, v59, v127, s97
    v_lshl_add_u64 v[58:59], v[58:59], 0, s[30:31]

    ds_add_rtn_u64 v[58:59], v19, v[58:59] offset:50000
    s_waitcnt lgkmcnt(4)
    v_or3_b32 v1, v44, v45, v1
    v_or3_b32 v1, v46, v47, v1
    v_or3_b32 v1, v48, v49, v1
    v_or3_b32 v1, v50, v51, v1
    s_waitcnt vmcnt(30)
    v_perm_b32 v44, v91, v90, s24
    v_perm_b32 v46, v92, v91, s25
    v_perm_b32 v48, v93, v92, s26
    v_perm_b32 v50, v110, v93, s27
    v_mov_b32 v12, v90
    v_alignbyte_b32 v13, v92, v91, 1
    v_alignbyte_b32 v14, v93, v92, 2
    v_alignbyte_b32 v15, v110, v93, 3
    v_lshlrev_b32_sdwa v44, 3, v44 dst_sel:WORD_0 dst_unused:UNUSED_PAD src0_sel:DWORD src1_sel:DWORD
    v_lshlrev_b32_sdwa v46, 3, v46 dst_sel:WORD_0 dst_unused:UNUSED_PAD src0_sel:DWORD src1_sel:DWORD
    v_lshlrev_b32_sdwa v48, 3, v48 dst_sel:WORD_0 dst_unused:UNUSED_PAD src0_sel:DWORD src1_sel:DWORD
    v_lshlrev_b32_sdwa v50, 3, v50 dst_sel:WORD_0 dst_unused:UNUSED_PAD src0_sel:DWORD src1_sel:DWORD
    s_cmp_lt_i32 s42, 1280
    s_cbranch_scc1 L_ufix_73
L_uback_74:

    s_barrier
    v_subrev_co_u32 v12, s[80:81], 2.0, v12
    v_subrev_co_u32 v13, s[82:83], 2.0, v13
    v_subrev_co_u32 v14, s[84:85], 2.0, v14
    v_subrev_co_u32 v15, s[86:87], 2.0, v15
    s_mov_b64 exec, s[80:81]
    ds_read_b64 v[44:45], v44
    s_mov_b64 exec, s[82:83]
    ds_read_b64 v[46:47], v46
    s_mov_b64 exec, s[84:85]
    ds_read_b64 v[48:49], v48
    s_mov_b64 exec, s[86:87]
    ds_read_b64 v[50:51], v50
    s_mov_b64 exec, -1
    v_mad_i32_i16 v120, v60, v20, s96
    v_mad_i32_i16 v60, v60, v20, s96 op_sel:[1,0,0,0]
    v_mad_i32_i16 v121, v61, v20, s96
    v_mad_i32_i16 v61, v61, v20, s96 op_sel:[1,0,0,0]
    v_lshlrev_b32_sdwa v20, 3, v20 dst_sel:DWORD dst_unused:UNUSED_PAD src0_sel:DWORD src1_sel:WORD_1
    v_perm_b32 v60, v60, v120, s97
    v_perm_b32 v61, v61, v121, s97
    v_lshl_add_u64 v[60:61], v[60:61], 0, s[30:31]

    ds_add_rtn_u64 v[60:61], v20, v[60:61] offset:50000
    v_mad_i32_i16 v122, v62, v21, s96
    v_mad_i32_i16 v62, v62, v21, s96 op_sel:[1,0,0,0]
    v_mad_i32_i16 v123, v63, v21, s96
    v_mad_i32_i16 v63, v63, v21, s96 op_sel:[1,0,0,0]
    v_lshlrev_b32_sdwa v21, 3, v21 dst_sel:DWORD dst_unused:UNUSED_PAD src0_sel:DWORD src1_sel:WORD_1
    v_perm_b32 v62, v62, v122, s97
    v_perm_b32 v63, v63, v123, s97
    v_lshl_add_u64 v[62:63], v[62:63], 0, s[30:31]

    ds_add_rtn_u64 v[62:63], v21, v[62:63] offset:50000
    v_mad_i32_i16 v124, v64, v22, s96
    v_mad_i32_i16 v64, v64, v22, s96 op_sel:[1,0,0,0]
    v_mad_i32_i16 v125, v65, v22, s96
    v_mad_i32_i16 v65, v65, v22, s96 op_sel:[1,0,0,0]
    v_lshlrev_b32_sdwa v22, 3, v22 dst_sel:DWORD dst_unused:UNUSED_PAD src0_sel:DWORD src1_sel:WORD_1
    v_perm_b32 v64, v64, v124, s97
    v_perm_b32 v65, v65, v125, s97
    v_lshl_add_u64 v[64:65], v[64:65], 0, s[30:31]

    ds_add_rtn_u64 v[64:65], v22, v[64:65] offset:50000
    v_mad_i32_i16 v126, v66, v23, s96
    v_mad_i32_i16 v66, v66, v23, s96 op_sel:[1,0,0,0]
    v_mad_i32_i16 v127, v67, v23, s96
    v_mad_i32_i16 v67, v67, v23, s96 op_sel:[1,0,0,0]
    v_lshlrev_b32_sdwa v23, 3, v23 dst_sel:DWORD dst_unused:UNUSED_PAD src0_sel:DWORD src1_sel:WORD_1
    v_perm_b32 v66, v66, v126, s97
    v_perm_b32 v67, v67, v127, s97
    v_lshl_add_u64 v[66:67], v[66:67], 0, s[30:31]

    ds_add_rtn_u64 v[66:67], v23, v[66:67] offset:50000
    s_waitcnt lgkmcnt(8)
    v_or3_b32 v1, v52, v53, v1
    v_or3_b32 v1, v54, v55, v1
    v_or3_b32 v1, v56, v57, v1
    v_or3_b32 v1, v58, v59, v1
    s_waitcnt vmcnt(24)
    v_perm_b32 v52, v95, v94, s24
    v_perm_b32 v54, v96, v95, s25
    v_perm_b32 v56, v97, v96, s26
    v_perm_b32 v58, v111, v97, s27
    v_mov_b32 v16, v94
    v_alignbyte_b32 v17, v96, v95, 1
    v_alignbyte_b32 v18, v97, v96, 2
    v_alignbyte_b32 v19, v111, v97, 3
    v_lshlrev_b32_sdwa v52, 3, v52 dst_sel:WORD_0 dst_unused:UNUSED_PAD src0_sel:DWORD src1_sel:DWORD
    v_lshlrev_b32_sdwa v54, 3, v54 dst_sel:WORD_0 dst_unused:UNUSED_PAD src0_sel:DWORD src1_sel:DWORD
    v_lshlrev_b32_sdwa v56, 3, v56 dst_sel:WORD_0 dst_unused:UNUSED_PAD src0_sel:DWORD src1_sel:DWORD
    v_lshlrev_b32_sdwa v58, 3, v58 dst_sel:WORD_0 dst_unused:UNUSED_PAD src0_sel:DWORD src1_sel:DWORD
    s_cmp_lt_i32 s42, 1792
    s_cbranch_scc1 L_ufix_75
L_uback_76:

    v_subrev_co_u32 v16, s[64:65], 2.0, v16
    v_subrev_co_u32 v17, s[66:67], 2.0, v17
    v_subrev_co_u32 v18, s[68:69], 2.0, v18
    v_subrev_co_u32 v19, s[70:71], 2.0, v19
    s_mov_b64 exec, s[64:65]
    ds_read_b64 v[52:53], v52
    s_mov_b64 exec, s[66:67]
    ds_read_b64 v[54:55], v54
    s_mov_b64 exec, s[68:69]
    ds_read_b64 v[56:57], v56
    s_mov_b64 exec, s[70:71]
    ds_read_b64 v[58:59], v58
    s_mov_b64 exec, -1
    v_mad_i32_i16 v120, v68, v24, s96
    v_mad_i32_i16 v68, v68, v24, s96 op_sel:[1,0,0,0]
    v_mad_i32_i16 v121, v69, v24, s96
    v_mad_i32_i16 v69, v69, v24, s96 op_sel:[1,0,0,0]
    v_lshlrev_b32_sdwa v24, 3, v24 dst_sel:DWORD dst_unused:UNUSED_PAD src0_sel:DWORD src1_sel:WORD_1
    v_perm_b32 v68, v68, v120, s97
    v_perm_b32 v69, v69, v121, s97
    v_lshl_add_u64 v[68:69], v[68:69], 0, s[30:31]

    ds_add_rtn_u64 v[68:69], v24, v[68:69] offset:50000
    v_mad_i32_i16 v122, v70, v25, s96
    v_mad_i32_i16 v70, v70, v25, s96 op_sel:[1,0,0,0]
    v_mad_i32_i16 v123, v71, v25, s96
    v_mad_i32_i16 v71, v71, v25, s96 op_sel:[1,0,0,0]
    v_lshlrev_b32_sdwa v25, 3, v25 dst_sel:DWORD dst_unused:UNUSED_PAD src0_sel:DWORD src1_sel:WORD_1
    v_perm_b32 v70, v70, v122, s97
    v_perm_b32 v71, v71, v123, s97
    v_lshl_add_u64 v[70:71], v[70:71], 0, s[30:31]

    ds_add_rtn_u64 v[70:71], v25, v[70:71] offset:50000
    v_mad_i32_i16 v124, v72, v26, s96
    v_mad_i32_i16 v72, v72, v26, s96 op_sel:[1,0,0,0]
    v_mad_i32_i16 v125, v73, v26, s96
    v_mad_i32_i16 v73, v73, v26, s96 op_sel:[1,0,0,0]
    v_lshlrev_b32_sdwa v26, 3, v26 dst_sel:DWORD dst_unused:UNUSED_PAD src0_sel:DWORD src1_sel:WORD_1
    v_perm_b32 v72, v72, v124, s97
    v_perm_b32 v73, v73, v125, s97
    v_lshl_add_u64 v[72:73], v[72:73], 0, s[30:31]

    ds_add_rtn_u64 v[72:73], v26, v[72:73] offset:50000
    v_mad_i32_i16 v126, v74, v27, s96
    v_mad_i32_i16 v74, v74, v27, s96 op_sel:[1,0,0,0]
    v_mad_i32_i16 v127, v75, v27, s96
    v_mad_i32_i16 v75, v75, v27, s96 op_sel:[1,0,0,0]
    v_lshlrev_b32_sdwa v27, 3, v27 dst_sel:DWORD dst_unused:UNUSED_PAD src0_sel:DWORD src1_sel:WORD_1
    v_perm_b32 v74, v74, v126, s97
    v_perm_b32 v75, v75, v127, s97
    v_lshl_add_u64 v[74:75], v[74:75], 0, s[30:31]

    ds_add_rtn_u64 v[74:75], v27, v[74:75] offset:50000
    s_waitcnt lgkmcnt(8)
    v_or3_b32 v1, v60, v61, v1
    v_or3_b32 v1, v62, v63, v1
    v_or3_b32 v1, v64, v65, v1
    v_or3_b32 v1, v66, v67, v1
    s_waitcnt vmcnt(18)
    v_perm_b32 v60, v99, v98, s24
    v_perm_b32 v62, v100, v99, s25
    v_perm_b32 v64, v101, v100, s26
    v_perm_b32 v66, v112, v101, s27
    v_mov_b32 v20, v98
    v_alignbyte_b32 v21, v100, v99, 1
    v_alignbyte_b32 v22, v101, v100, 2
    v_alignbyte_b32 v23, v112, v101, 3
    v_lshlrev_b32_sdwa v60, 3, v60 dst_sel:WORD_0 dst_unused:UNUSED_PAD src0_sel:DWORD src1_sel:DWORD
    v_lshlrev_b32_sdwa v62, 3, v62 dst_sel:WORD_0 dst_unused:UNUSED_PAD src0_sel:DWORD src1_sel:DWORD
    v_lshlrev_b32_sdwa v64, 3, v64 dst_sel:WORD_0 dst_unused:UNUSED_PAD src0_sel:DWORD src1_sel:DWORD
    v_lshlrev_b32_sdwa v66, 3, v66 dst_sel:WORD_0 dst_unused:UNUSED_PAD src0_sel:DWORD src1_sel:DWORD
    s_cmp_lt_i32 s42, 2304
    s_cbranch_scc1 L_ufix_77
L_uback_78:

    v_subrev_co_u32 v20, s[72:73], 2.0, v20
    v_subrev_co_u32 v21, s[74:75], 2.0, v21
    v_subrev_co_u32 v22, s[76:77], 2.0, v22
    v_subrev_co_u32 v23, s[78:79], 2.0, v23
    s_mov_b64 exec, s[72:73]
    ds_read_b64 v[60:61], v60
    s_mov_b64 exec, s[74:75]
    ds_read_b64 v[62:63], v62
    s_mov_b64 exec, s[76:77]
    ds_read_b64 v[64:65], v64
    s_mov_b64 exec, s[78:79]
    ds_read_b64 v[66:67], v66
    s_mov_b64 exec, -1
    s_waitcnt lgkmcnt(4)
    v_or3_b32 v1, v68, v69, v1
    v_or3_b32 v1, v70, v71, v1
    v_or3_b32 v1, v72, v73, v1
    v_or3_b32 v1, v74, v75, v1
    s_waitcnt vmcnt(10)
    v_perm_b32 v68, v103, v102, s24
    v_perm_b32 v70, v104, v103, s25
    v_perm_b32 v72, v105, v104, s26
    v_perm_b32 v74, v113, v105, s27
    v_mov_b32 v24, v102
    v_alignbyte_b32 v25, v104, v103, 1
    v_alignbyte_b32 v26, v105, v104, 2
    v_alignbyte_b32 v27, v113, v105, 3
    v_lshlrev_b32_sdwa v68, 3, v68 dst_sel:WORD_0 dst_unused:UNUSED_PAD src0_sel:DWORD src1_sel:DWORD
    v_lshlrev_b32_sdwa v70, 3, v70 dst_sel:WORD_0 dst_unused:UNUSED_PAD src0_sel:DWORD src1_sel:DWORD
    v_lshlrev_b32_sdwa v72, 3, v72 dst_sel:WORD_0 dst_unused:UNUSED_PAD src0_sel:DWORD src1_sel:DWORD
    v_lshlrev_b32_sdwa v74, 3, v74 dst_sel:WORD_0 dst_unused:UNUSED_PAD src0_sel:DWORD src1_sel:DWORD
    s_cmp_lt_i32 s42, 2816
    s_cbranch_scc1 L_ufix_79
L_uback_80:

    v_subrev_co_u32 v24, s[80:81], 2.0, v24
    v_subrev_co_u32 v25, s[82:83], 2.0, v25
    v_subrev_co_u32 v26, s[84:85], 2.0, v26
    v_subrev_co_u32 v27, s[86:87], 2.0, v27
    s_mov_b64 exec, s[80:81]
    ds_read_b64 v[68:69], v68
    s_mov_b64 exec, s[82:83]
    ds_read_b64 v[70:71], v70
    s_mov_b64 exec, s[84:85]
    ds_read_b64 v[72:73], v72
    s_mov_b64 exec, s[86:87]
    ds_read_b64 v[74:75], v74
    s_mov_b64 exec, -1
    s_waitcnt vmcnt(2)
    v_perm_b32 v28, v5, v4, s24
    v_perm_b32 v30, v6, v5, s25
    v_perm_b32 v32, v7, v6, s26
    v_perm_b32 v34, v35, v7, s27
    v_alignbyte_b32 v5, v6, v5, 1
    v_alignbyte_b32 v6, v7, v6, 2
    v_alignbyte_b32 v7, v35, v7, 3
    v_lshlrev_b32_sdwa v28, 3, v28 dst_sel:WORD_0 dst_unused:UNUSED_PAD src0_sel:DWORD src1_sel:DWORD
    v_lshlrev_b32_sdwa v30, 3, v30 dst_sel:WORD_0 dst_unused:UNUSED_PAD src0_sel:DWORD src1_sel:DWORD
    v_lshlrev_b32_sdwa v32, 3, v32 dst_sel:WORD_0 dst_unused:UNUSED_PAD src0_sel:DWORD src1_sel:DWORD
    v_lshlrev_b32_sdwa v34, 3, v34 dst_sel:WORD_0 dst_unused:UNUSED_PAD src0_sel:DWORD src1_sel:DWORD
    s_cmp_lt_i32 s42, 256
    s_cbranch_scc1 L_ufix_81
L_uback_82:

    v_subrev_co_u32 v4, s[64:65], 2.0, v4
    v_subrev_co_u32 v5, s[66:67], 2.0, v5
    v_subrev_co_u32 v6, s[68:69], 2.0, v6
    v_subrev_co_u32 v7, s[70:71], 2.0, v7
    s_mov_b64 exec, s[64:65]
    ds_read_b64 v[28:29], v28
    s_mov_b64 exec, s[66:67]
    ds_read_b64 v[30:31], v30
    s_mov_b64 exec, s[68:69]
    ds_read_b64 v[32:33], v32
    s_mov_b64 exec, s[70:71]
    ds_read_b64 v[34:35], v34
    s_mov_b64 exec, -1
    s_waitcnt vmcnt(0)
    v_perm_b32 v36, v9, v8, s24
    v_perm_b32 v38, v10, v9, s25
    v_perm_b32 v40, v11, v10, s26
    v_perm_b32 v42, v43, v11, s27
    v_alignbyte_b32 v9, v10, v9, 1
    v_alignbyte_b32 v10, v11, v10, 2
    v_alignbyte_b32 v11, v43, v11, 3
    v_lshlrev_b32_sdwa v36, 3, v36 dst_sel:WORD_0 dst_unused:UNUSED_PAD src0_sel:DWORD src1_sel:DWORD
    v_lshlrev_b32_sdwa v38, 3, v38 dst_sel:WORD_0 dst_unused:UNUSED_PAD src0_sel:DWORD src1_sel:DWORD
    v_lshlrev_b32_sdwa v40, 3, v40 dst_sel:WORD_0 dst_unused:UNUSED_PAD src0_sel:DWORD src1_sel:DWORD
    v_lshlrev_b32_sdwa v42, 3, v42 dst_sel:WORD_0 dst_unused:UNUSED_PAD src0_sel:DWORD src1_sel:DWORD
    s_cmp_lt_i32 s42, 768
    s_cbranch_scc1 L_ufix_83
L_uback_84:

    v_subrev_co_u32 v8, s[72:73], 2.0, v8
    v_subrev_co_u32 v9, s[74:75], 2.0, v9
    v_subrev_co_u32 v10, s[76:77], 2.0, v10
    v_subrev_co_u32 v11, s[78:79], 2.0, v11
    s_mov_b64 exec, s[72:73]
    ds_read_b64 v[36:37], v36
    s_mov_b64 exec, s[74:75]
    ds_read_b64 v[38:39], v38
    s_mov_b64 exec, s[76:77]
    ds_read_b64 v[40:41], v40
    s_mov_b64 exec, s[78:79]
    ds_read_b64 v[42:43], v42
    s_mov_b64 exec, -1
    s_mov_b32 s38, s5
    s_add_u32 s50, s50, 200000
    s_branch L_batch_64
L_bend_65:

    s_waitcnt lgkmcnt(15)
    v_mad_i32_i16 v120, v28, v4, s96
    v_mad_i32_i16 v28, v28, v4, s96 op_sel:[1,0,0,0]
    v_mad_i32_i16 v121, v29, v4, s96
    v_mad_i32_i16 v29, v29, v4, s96 op_sel:[1,0,0,0]
    v_lshlrev_b32_sdwa v4, 3, v4 dst_sel:DWORD dst_unused:UNUSED_PAD src0_sel:DWORD src1_sel:WORD_1
    v_perm_b32 v28, v28, v120, s97
    v_perm_b32 v29, v29, v121, s97
    v_lshl_add_u64 v[28:29], v[28:29], 0, s[30:31]

    ds_add_rtn_u64 v[28:29], v4, v[28:29] offset:50000
    v_mad_i32_i16 v122, v30, v5, s96
    v_mad_i32_i16 v30, v30, v5, s96 op_sel:[1,0,0,0]
    v_mad_i32_i16 v123, v31, v5, s96
    v_mad_i32_i16 v31, v31, v5, s96 op_sel:[1,0,0,0]
    v_lshlrev_b32_sdwa v5, 3, v5 dst_sel:DWORD dst_unused:UNUSED_PAD src0_sel:DWORD src1_sel:WORD_1
    v_perm_b32 v30, v30, v122, s97
    v_perm_b32 v31, v31, v123, s97
    v_lshl_add_u64 v[30:31], v[30:31], 0, s[30:31]

    ds_add_rtn_u64 v[30:31], v5, v[30:31] offset:50000
    v_mad_i32_i16 v124, v32, v6, s96
    v_mad_i32_i16 v32, v32, v6, s96 op_sel:[1,0,0,0]
    v_mad_i32_i16 v125, v33, v6, s96
    v_mad_i32_i16 v33, v33, v6, s96 op_sel:[1,0,0,0]
    v_lshlrev_b32_sdwa v6, 3, v6 dst_sel:DWORD dst_unused:UNUSED_PAD src0_sel:DWORD src1_sel:WORD_1
    v_perm_b32 v32, v32, v124, s97
    v_perm_b32 v33, v33, v125, s97
    v_lshl_add_u64 v[32:33], v[32:33], 0, s[30:31]

    ds_add_rtn_u64 v[32:33], v6, v[32:33] offset:50000
    v_mad_i32_i16 v126, v34, v7, s96
    v_mad_i32_i16 v34, v34, v7, s96 op_sel:[1,0,0,0]
    v_mad_i32_i16 v127, v35, v7, s96
    v_mad_i32_i16 v35, v35, v7, s96 op_sel:[1,0,0,0]
    v_lshlrev_b32_sdwa v7, 3, v7 dst_sel:DWORD dst_unused:UNUSED_PAD src0_sel:DWORD src1_sel:WORD_1
    v_perm_b32 v34, v34, v126, s97
    v_perm_b32 v35, v35, v127, s97
    v_lshl_add_u64 v[34:35], v[34:35], 0, s[30:31]

    ds_add_rtn_u64 v[34:35], v7, v[34:35] offset:50000
    v_mad_i32_i16 v120, v36, v8, s96
    v_mad_i32_i16 v36, v36, v8, s96 op_sel:[1,0,0,0]
    v_mad_i32_i16 v121, v37, v8, s96
    v_mad_i32_i16 v37, v37, v8, s96 op_sel:[1,0,0,0]
    v_lshlrev_b32_sdwa v8, 3, v8 dst_sel:DWORD dst_unused:UNUSED_PAD src0_sel:DWORD src1_sel:WORD_1
    v_perm_b32 v36, v36, v120, s97
    v_perm_b32 v37, v37, v121, s97
    v_lshl_add_u64 v[36:37], v[36:37], 0, s[30:31]

    ds_add_rtn_u64 v[36:37], v8, v[36:37] offset:50000
    v_mad_i32_i16 v122, v38, v9, s96
    v_mad_i32_i16 v38, v38, v9, s96 op_sel:[1,0,0,0]
    v_mad_i32_i16 v123, v39, v9, s96
    v_mad_i32_i16 v39, v39, v9, s96 op_sel:[1,0,0,0]
    v_lshlrev_b32_sdwa v9, 3, v9 dst_sel:DWORD dst_unused:UNUSED_PAD src0_sel:DWORD src1_sel:WORD_1
    v_perm_b32 v38, v38, v122, s97
    v_perm_b32 v39, v39, v123, s97
    v_lshl_add_u64 v[38:39], v[38:39], 0, s[30:31]

    ds_add_rtn_u64 v[38:39], v9, v[38:39] offset:50000
    v_mad_i32_i16 v124, v40, v10, s96
    v_mad_i32_i16 v40, v40, v10, s96 op_sel:[1,0,0,0]
    v_mad_i32_i16 v125, v41, v10, s96
    v_mad_i32_i16 v41, v41, v10, s96 op_sel:[1,0,0,0]
    v_lshlrev_b32_sdwa v10, 3, v10 dst_sel:DWORD dst_unused:UNUSED_PAD src0_sel:DWORD src1_sel:WORD_1
    v_perm_b32 v40, v40, v124, s97
    v_perm_b32 v41, v41, v125, s97
    v_lshl_add_u64 v[40:41], v[40:41], 0, s[30:31]

    ds_add_rtn_u64 v[40:41], v10, v[40:41] offset:50000
    v_mad_i32_i16 v126, v42, v11, s96
    v_mad_i32_i16 v42, v42, v11, s96 op_sel:[1,0,0,0]
    v_mad_i32_i16 v127, v43, v11, s96
    v_mad_i32_i16 v43, v43, v11, s96 op_sel:[1,0,0,0]
    v_lshlrev_b32_sdwa v11, 3, v11 dst_sel:DWORD dst_unused:UNUSED_PAD src0_sel:DWORD src1_sel:WORD_1
    v_perm_b32 v42, v42, v126, s97
    v_perm_b32 v43, v43, v127, s97
    v_lshl_add_u64 v[42:43], v[42:43], 0, s[30:31]

    ds_add_rtn_u64 v[42:43], v11, v[42:43] offset:50000
    s_waitcnt lgkmcnt(4)
    v_or3_b32 v1, v28, v29, v1
    v_or3_b32 v1, v30, v31, v1
    v_or3_b32 v1, v32, v33, v1
    v_or3_b32 v1, v34, v35, v1
    v_mad_i32_i16 v120, v44, v12, s96
    v_mad_i32_i16 v44, v44, v12, s96 op_sel:[1,0,0,0]
    v_mad_i32_i16 v121, v45, v12, s96
    v_mad_i32_i16 v45, v45, v12, s96 op_sel:[1,0,0,0]
    v_lshlrev_b32_sdwa v12, 3, v12 dst_sel:DWORD dst_unused:UNUSED_PAD src0_sel:DWORD src1_sel:WORD_1
    v_perm_b32 v44, v44, v120, s97
    v_perm_b32 v45, v45, v121, s97
    v_lshl_add_u64 v[44:45], v[44:45], 0, s[30:31]

    ds_add_rtn_u64 v[44:45], v12, v[44:45] offset:50000
    v_mad_i32_i16 v122, v46, v13, s96
    v_mad_i32_i16 v46, v46, v13, s96 op_sel:[1,0,0,0]
    v_mad_i32_i16 v123, v47, v13, s96
    v_mad_i32_i16 v47, v47, v13, s96 op_sel:[1,0,0,0]
    v_lshlrev_b32_sdwa v13, 3, v13 dst_sel:DWORD dst_unused:UNUSED_PAD src0_sel:DWORD src1_sel:WORD_1
    v_perm_b32 v46, v46, v122, s97
    v_perm_b32 v47, v47, v123, s97
    v_lshl_add_u64 v[46:47], v[46:47], 0, s[30:31]

    ds_add_rtn_u64 v[46:47], v13, v[46:47] offset:50000
    v_mad_i32_i16 v124, v48, v14, s96
    v_mad_i32_i16 v48, v48, v14, s96 op_sel:[1,0,0,0]
    v_mad_i32_i16 v125, v49, v14, s96
    v_mad_i32_i16 v49, v49, v14, s96 op_sel:[1,0,0,0]
    v_lshlrev_b32_sdwa v14, 3, v14 dst_sel:DWORD dst_unused:UNUSED_PAD src0_sel:DWORD src1_sel:WORD_1
    v_perm_b32 v48, v48, v124, s97
    v_perm_b32 v49, v49, v125, s97
    v_lshl_add_u64 v[48:49], v[48:49], 0, s[30:31]

    ds_add_rtn_u64 v[48:49], v14, v[48:49] offset:50000
    v_mad_i32_i16 v126, v50, v15, s96
    v_mad_i32_i16 v50, v50, v15, s96 op_sel:[1,0,0,0]
    v_mad_i32_i16 v127, v51, v15, s96
    v_mad_i32_i16 v51, v51, v15, s96 op_sel:[1,0,0,0]
    v_lshlrev_b32_sdwa v15, 3, v15 dst_sel:DWORD dst_unused:UNUSED_PAD src0_sel:DWORD src1_sel:WORD_1
    v_perm_b32 v50, v50, v126, s97
    v_perm_b32 v51, v51, v127, s97
    v_lshl_add_u64 v[50:51], v[50:51], 0, s[30:31]

    ds_add_rtn_u64 v[50:51], v15, v[50:51] offset:50000
    s_waitcnt lgkmcnt(4)
    v_or3_b32 v1, v36, v37, v1
    v_or3_b32 v1, v38, v39, v1
    v_or3_b32 v1, v40, v41, v1
    v_or3_b32 v1, v42, v43, v1
    v_mad_i32_i16 v120, v52, v16, s96
    v_mad_i32_i16 v52, v52, v16, s96 op_sel:[1,0,0,0]
    v_mad_i32_i16 v121, v53, v16, s96
    v_mad_i32_i16 v53, v53, v16, s96 op_sel:[1,0,0,0]
    v_lshlrev_b32_sdwa v16, 3, v16 dst_sel:DWORD dst_unused:UNUSED_PAD src0_sel:DWORD src1_sel:WORD_1
    v_perm_b32 v52, v52, v120, s97
    v_perm_b32 v53, v53, v121, s97
    v_lshl_add_u64 v[52:53], v[52:53], 0, s[30:31]

    ds_add_rtn_u64 v[52:53], v16, v[52:53] offset:50000
    v_mad_i32_i16 v122, v54, v17, s96
    v_mad_i32_i16 v54, v54, v17, s96 op_sel:[1,0,0,0]
    v_mad_i32_i16 v123, v55, v17, s96
    v_mad_i32_i16 v55, v55, v17, s96 op_sel:[1,0,0,0]
    v_lshlrev_b32_sdwa v17, 3, v17 dst_sel:DWORD dst_unused:UNUSED_PAD src0_sel:DWORD src1_sel:WORD_1
    v_perm_b32 v54, v54, v122, s97
    v_perm_b32 v55, v55, v123, s97
    v_lshl_add_u64 v[54:55], v[54:55], 0, s[30:31]

    ds_add_rtn_u64 v[54:55], v17, v[54:55] offset:50000
    v_mad_i32_i16 v124, v56, v18, s96
    v_mad_i32_i16 v56, v56, v18, s96 op_sel:[1,0,0,0]
    v_mad_i32_i16 v125, v57, v18, s96
    v_mad_i32_i16 v57, v57, v18, s96 op_sel:[1,0,0,0]
    v_lshlrev_b32_sdwa v18, 3, v18 dst_sel:DWORD dst_unused:UNUSED_PAD src0_sel:DWORD src1_sel:WORD_1
    v_perm_b32 v56, v56, v124, s97
    v_perm_b32 v57, v57, v125, s97
    v_lshl_add_u64 v[56:57], v[56:57], 0, s[30:31]

    ds_add_rtn_u64 v[56:57], v18, v[56:57] offset:50000
    v_mad_i32_i16 v126, v58, v19, s96
    v_mad_i32_i16 v58, v58, v19, s96 op_sel:[1,0,0,0]
    v_mad_i32_i16 v127, v59, v19, s96
    v_mad_i32_i16 v59, v59, v19, s96 op_sel:[1,0,0,0]
    v_lshlrev_b32_sdwa v19, 3, v19 dst_sel:DWORD dst_unused:UNUSED_PAD src0_sel:DWORD src1_sel:WORD_1
    v_perm_b32 v58, v58, v126, s97
    v_perm_b32 v59, v59, v127, s97
    v_lshl_add_u64 v[58:59], v[58:59], 0, s[30:31]

    ds_add_rtn_u64 v[58:59], v19, v[58:59] offset:50000
    s_waitcnt lgkmcnt(4)
    v_or3_b32 v1, v44, v45, v1
    v_or3_b32 v1, v46, v47, v1
    v_or3_b32 v1, v48, v49, v1
    v_or3_b32 v1, v50, v51, v1
    v_mad_i32_i16 v120, v60, v20, s96
    v_mad_i32_i16 v60, v60, v20, s96 op_sel:[1,0,0,0]
    v_mad_i32_i16 v121, v61, v20, s96
    v_mad_i32_i16 v61, v61, v20, s96 op_sel:[1,0,0,0]
    v_lshlrev_b32_sdwa v20, 3, v20 dst_sel:DWORD dst_unused:UNUSED_PAD src0_sel:DWORD src1_sel:WORD_1
    v_perm_b32 v60, v60, v120, s97
    v_perm_b32 v61, v61, v121, s97
    v_lshl_add_u64 v[60:61], v[60:61], 0, s[30:31]

    ds_add_rtn_u64 v[60:61], v20, v[60:61] offset:50000
    v_mad_i32_i16 v122, v62, v21, s96
    v_mad_i32_i16 v62, v62, v21, s96 op_sel:[1,0,0,0]
    v_mad_i32_i16 v123, v63, v21, s96
    v_mad_i32_i16 v63, v63, v21, s96 op_sel:[1,0,0,0]
    v_lshlrev_b32_sdwa v21, 3, v21 dst_sel:DWORD dst_unused:UNUSED_PAD src0_sel:DWORD src1_sel:WORD_1
    v_perm_b32 v62, v62, v122, s97
    v_perm_b32 v63, v63, v123, s97
    v_lshl_add_u64 v[62:63], v[62:63], 0, s[30:31]

    ds_add_rtn_u64 v[62:63], v21, v[62:63] offset:50000
    v_mad_i32_i16 v124, v64, v22, s96
    v_mad_i32_i16 v64, v64, v22, s96 op_sel:[1,0,0,0]
    v_mad_i32_i16 v125, v65, v22, s96
    v_mad_i32_i16 v65, v65, v22, s96 op_sel:[1,0,0,0]
    v_lshlrev_b32_sdwa v22, 3, v22 dst_sel:DWORD dst_unused:UNUSED_PAD src0_sel:DWORD src1_sel:WORD_1
    v_perm_b32 v64, v64, v124, s97
    v_perm_b32 v65, v65, v125, s97
    v_lshl_add_u64 v[64:65], v[64:65], 0, s[30:31]

    ds_add_rtn_u64 v[64:65], v22, v[64:65] offset:50000
    v_mad_i32_i16 v126, v66, v23, s96
    v_mad_i32_i16 v66, v66, v23, s96 op_sel:[1,0,0,0]
    v_mad_i32_i16 v127, v67, v23, s96
    v_mad_i32_i16 v67, v67, v23, s96 op_sel:[1,0,0,0]
    v_lshlrev_b32_sdwa v23, 3, v23 dst_sel:DWORD dst_unused:UNUSED_PAD src0_sel:DWORD src1_sel:WORD_1
    v_perm_b32 v66, v66, v126, s97
    v_perm_b32 v67, v67, v127, s97
    v_lshl_add_u64 v[66:67], v[66:67], 0, s[30:31]

    ds_add_rtn_u64 v[66:67], v23, v[66:67] offset:50000
    s_waitcnt lgkmcnt(4)
    v_or3_b32 v1, v52, v53, v1
    v_or3_b32 v1, v54, v55, v1
    v_or3_b32 v1, v56, v57, v1
    v_or3_b32 v1, v58, v59, v1
    v_mad_i32_i16 v120, v68, v24, s96
    v_mad_i32_i16 v68, v68, v24, s96 op_sel:[1,0,0,0]
    v_mad_i32_i16 v121, v69, v24, s96
    v_mad_i32_i16 v69, v69, v24, s96 op_sel:[1,0,0,0]
    v_lshlrev_b32_sdwa v24, 3, v24 dst_sel:DWORD dst_unused:UNUSED_PAD src0_sel:DWORD src1_sel:WORD_1
    v_perm_b32 v68, v68, v120, s97
    v_perm_b32 v69, v69, v121, s97
    v_lshl_add_u64 v[68:69], v[68:69], 0, s[30:31]

    ds_add_rtn_u64 v[68:69], v24, v[68:69] offset:50000
    v_mad_i32_i16 v122, v70, v25, s96
    v_mad_i32_i16 v70, v70, v25, s96 op_sel:[1,0,0,0]
    v_mad_i32_i16 v123, v71, v25, s96
    v_mad_i32_i16 v71, v71, v25, s96 op_sel:[1,0,0,0]
    v_lshlrev_b32_sdwa v25, 3, v25 dst_sel:DWORD dst_unused:UNUSED_PAD src0_sel:DWORD src1_sel:WORD_1
    v_perm_b32 v70, v70, v122, s97
    v_perm_b32 v71, v71, v123, s97
    v_lshl_add_u64 v[70:71], v[70:71], 0, s[30:31]

    ds_add_rtn_u64 v[70:71], v25, v[70:71] offset:50000
    v_mad_i32_i16 v124, v72, v26, s96
    v_mad_i32_i16 v72, v72, v26, s96 op_sel:[1,0,0,0]
    v_mad_i32_i16 v125, v73, v26, s96
    v_mad_i32_i16 v73, v73, v26, s96 op_sel:[1,0,0,0]
    v_lshlrev_b32_sdwa v26, 3, v26 dst_sel:DWORD dst_unused:UNUSED_PAD src0_sel:DWORD src1_sel:WORD_1
    v_perm_b32 v72, v72, v124, s97
    v_perm_b32 v73, v73, v125, s97
    v_lshl_add_u64 v[72:73], v[72:73], 0, s[30:31]

    ds_add_rtn_u64 v[72:73], v26, v[72:73] offset:50000
    v_mad_i32_i16 v126, v74, v27, s96
    v_mad_i32_i16 v74, v74, v27, s96 op_sel:[1,0,0,0]
    v_mad_i32_i16 v127, v75, v27, s96
    v_mad_i32_i16 v75, v75, v27, s96 op_sel:[1,0,0,0]
    v_lshlrev_b32_sdwa v27, 3, v27 dst_sel:DWORD dst_unused:UNUSED_PAD src0_sel:DWORD src1_sel:WORD_1
    v_perm_b32 v74, v74, v126, s97
    v_perm_b32 v75, v75, v127, s97
    v_lshl_add_u64 v[74:75], v[74:75], 0, s[30:31]

    ds_add_rtn_u64 v[74:75], v27, v[74:75] offset:50000
    s_waitcnt lgkmcnt(4)
    v_or3_b32 v1, v60, v61, v1
    v_or3_b32 v1, v62, v63, v1
    v_or3_b32 v1, v64, v65, v1
    v_or3_b32 v1, v66, v67, v1
    s_waitcnt lgkmcnt(0)
    v_or3_b32 v1, v68, v69, v1
    v_or3_b32 v1, v70, v71, v1
    v_or3_b32 v1, v72, v73, v1
    v_or3_b32 v1, v74, v75, v1
    s_barrier
    s_mul_i32 s3, s37, 6400000
    s_mul_i32 s5, s36, 100000
    s_add_u32 s3, s3, s5
    s_add_u32 s3, s3, 6799360

    s_add_u32 s20, s6, s3
    s_addc_u32 s21, s7, 0
    s_mov_b32 s22, 100000
    s_mov_b32 s23, 0x20000
    v_lshlrev_b32 v68, 3, v0
    v_add_u32 v69, 50000, v68
    v_add_u32 v70, 115536, v68
    v_cmp_gt_u32 vcc, 212, v0
    v_mov_b32 v52, 0
    v_mov_b32 v53, 0

    ds_read_b64 v[28:29], v69 offset:0
    ds_read_b64 v[30:31], v69 offset:8192
    ds_read_b64 v[32:33], v69 offset:16384
    ds_read_b64 v[34:35], v69 offset:24576
    ds_read_b64 v[36:37], v69 offset:32768
    ds_read_b64 v[38:39], v69 offset:40960
    ds_read_b64 v[40:41], v69 offset:49152
    ds_read_b64 v[42:43], v69 offset:57344
    ds_read_b64 v[44:45], v70 offset:0
    ds_read_b64 v[46:47], v70 offset:8192
    ds_read_b64 v[48:49], v70 offset:16384
    ds_read_b64 v[50:51], v70 offset:24576
    s_mov_b64 exec, vcc
    ds_read_b64 v[52:53], v70 offset:32768
    s_mov_b64 exec, -1
    s_waitcnt lgkmcnt(12)
    s_mov_b32 s3, 0
    buffer_store_dwordx2 v[28:29], v68, s[20:23], s3 offen
    s_waitcnt lgkmcnt(11)
    s_mov_b32 s3, 8192
    buffer_store_dwordx2 v[30:31], v68, s[20:23], s3 offen
    s_waitcnt lgkmcnt(10)
    s_mov_b32 s3, 16384
    buffer_store_dwordx2 v[32:33], v68, s[20:23], s3 offen
    s_waitcnt lgkmcnt(9)
    s_mov_b32 s3, 24576
    buffer_store_dwordx2 v[34:35], v68, s[20:23], s3 offen
    s_waitcnt lgkmcnt(8)
    s_mov_b32 s3, 32768
    buffer_store_dwordx2 v[36:37], v68, s[20:23], s3 offen
    s_waitcnt lgkmcnt(7)
    s_mov_b32 s3, 40960
    buffer_store_dwordx2 v[38:39], v68, s[20:23], s3 offen
    s_waitcnt lgkmcnt(6)
    s_mov_b32 s3, 49152
    buffer_store_dwordx2 v[40:41], v68, s[20:23], s3 offen
    s_waitcnt lgkmcnt(5)
    s_mov_b32 s3, 57344
    buffer_store_dwordx2 v[42:43], v68, s[20:23], s3 offen
    s_waitcnt lgkmcnt(4)
    s_mov_b32 s3, 65536
    buffer_store_dwordx2 v[44:45], v68, s[20:23], s3 offen
    s_waitcnt lgkmcnt(3)
    s_mov_b32 s3, 73728
    buffer_store_dwordx2 v[46:47], v68, s[20:23], s3 offen
    s_waitcnt lgkmcnt(2)
    s_mov_b32 s3, 81920
    buffer_store_dwordx2 v[48:49], v68, s[20:23], s3 offen
    s_waitcnt lgkmcnt(1)
    s_mov_b32 s3, 90112
    buffer_store_dwordx2 v[50:51], v68, s[20:23], s3 offen
    s_waitcnt lgkmcnt(0)
    s_mov_b32 s3, 98304
    buffer_store_dwordx2 v[52:53], v68, s[20:23], s3 offen
    v_or3_b32 v1, v28, v29, v1
    v_or3_b32 v1, v30, v31, v1
    v_or3_b32 v1, v32, v33, v1
    v_or3_b32 v1, v34, v35, v1
    v_or3_b32 v1, v36, v37, v1
    v_or3_b32 v1, v38, v39, v1
    v_or3_b32 v1, v40, v41, v1
    v_or3_b32 v1, v42, v43, v1
    v_or3_b32 v1, v44, v45, v1
    v_or3_b32 v1, v46, v47, v1
    v_or3_b32 v1, v48, v49, v1
    v_or3_b32 v1, v50, v51, v1
    v_or3_b32 v1, v52, v53, v1
    v_and_b32 v1, 0x80008000, v1
    v_cmp_ne_u32 vcc, 0, v1
    v_mov_b32 v71, 150024
    v_mov_b32 v72, 1
    s_cbranch_vccz L_nf_85
    ds_write_b32 v71, v72
L_nf_85:
    s_waitcnt lgkmcnt(0)
    s_barrier
    ds_read_b32 v72, v71
    s_waitcnt lgkmcnt(0)
    v_readfirstlane_b32 s3, v72
    s_nop 1
    s_cmp_lg_u32 s3, 0
    s_cbranch_scc1 L_p2slow_51

L_fin_86:
    s_add_u32 s20, s6, 147456
    s_addc_u32 s21, s7, 0
    s_mov_b32 s22, 1024
    s_mov_b32 s23, 0x20000
    s_lshl_b32 s3, s36, 2
    s_add_u32 s3, s3, s37
    s_lshl_b32 s3, s3, 2
    v_lshlrev_b32 v73, 20, v0
    v_mov_b32 v74, s34
    buffer_store_dword v74, v73, s[20:23], s3 offen

L_p2done_50:
    s_endpgm

L_ufix_52:
    v_and_b32 v117, 63, v0
    v_lshlrev_b32 v117, 2, v117
    s_sub_i32 s54, s42, 1024
    v_cmp_le_i32 vcc, s54, v117
    s_mov_b64 exec, vcc
    v_mov_b32 v12, 0
    v_mov_b32 v44, 0
    s_mov_b64 exec, -1
    s_sub_i32 s54, s42, 1025
    v_cmp_le_i32 vcc, s54, v117
    s_mov_b64 exec, vcc
    v_mov_b32 v13, 0
    v_mov_b32 v46, 0
    s_mov_b64 exec, -1
    s_sub_i32 s54, s42, 1026
    v_cmp_le_i32 vcc, s54, v117
    s_mov_b64 exec, vcc
    v_mov_b32 v14, 0
    v_mov_b32 v48, 0
    s_mov_b64 exec, -1
    s_sub_i32 s54, s42, 1027
    v_cmp_le_i32 vcc, s54, v117
    s_mov_b64 exec, vcc
    v_mov_b32 v15, 0
    v_mov_b32 v50, 0
    s_mov_b64 exec, -1
    s_branch L_uback_53
L_ufix_54:
    v_and_b32 v117, 63, v0
    v_lshlrev_b32 v117, 2, v117
    s_sub_i32 s54, s42, 1536
    v_cmp_le_i32 vcc, s54, v117
    s_mov_b64 exec, vcc
    v_mov_b32 v16, 0
    v_mov_b32 v52, 0
    s_mov_b64 exec, -1
    s_sub_i32 s54, s42, 1537
    v_cmp_le_i32 vcc, s54, v117
    s_mov_b64 exec, vcc
    v_mov_b32 v17, 0
    v_mov_b32 v54, 0
    s_mov_b64 exec, -1
    s_sub_i32 s54, s42, 1538
    v_cmp_le_i32 vcc, s54, v117
    s_mov_b64 exec, vcc
    v_mov_b32 v18, 0
    v_mov_b32 v56, 0
    s_mov_b64 exec, -1
    s_sub_i32 s54, s42, 1539
    v_cmp_le_i32 vcc, s54, v117
    s_mov_b64 exec, vcc
    v_mov_b32 v19, 0
    v_mov_b32 v58, 0
    s_mov_b64 exec, -1
    s_branch L_uback_55
L_ufix_56:
    v_and_b32 v117, 63, v0
    v_lshlrev_b32 v117, 2, v117
    s_sub_i32 s54, s42, 2048
    v_cmp_le_i32 vcc, s54, v117
    s_mov_b64 exec, vcc
    v_mov_b32 v20, 0
    v_mov_b32 v60, 0
    s_mov_b64 exec, -1
    s_sub_i32 s54, s42, 2049
    v_cmp_le_i32 vcc, s54, v117
    s_mov_b64 exec, vcc
    v_mov_b32 v21, 0
    v_mov_b32 v62, 0
    s_mov_b64 exec, -1
    s_sub_i32 s54, s42, 2050
    v_cmp_le_i32 vcc, s54, v117
    s_mov_b64 exec, vcc
    v_mov_b32 v22, 0
    v_mov_b32 v64, 0
    s_mov_b64 exec, -1
    s_sub_i32 s54, s42, 2051
    v_cmp_le_i32 vcc, s54, v117
    s_mov_b64 exec, vcc
    v_mov_b32 v23, 0
    v_mov_b32 v66, 0
    s_mov_b64 exec, -1
    s_branch L_uback_57
L_ufix_58:
    v_and_b32 v117, 63, v0
    v_lshlrev_b32 v117, 2, v117
    s_sub_i32 s54, s42, 2560
    v_cmp_le_i32 vcc, s54, v117
    s_mov_b64 exec, vcc
    v_mov_b32 v24, 0
    v_mov_b32 v68, 0
    s_mov_b64 exec, -1
    s_sub_i32 s54, s42, 2561
    v_cmp_le_i32 vcc, s54, v117
    s_mov_b64 exec, vcc
    v_mov_b32 v25, 0
    v_mov_b32 v70, 0
    s_mov_b64 exec, -1
    s_sub_i32 s54, s42, 2562
    v_cmp_le_i32 vcc, s54, v117
    s_mov_b64 exec, vcc
    v_mov_b32 v26, 0
    v_mov_b32 v72, 0
    s_mov_b64 exec, -1
    s_sub_i32 s54, s42, 2563
    v_cmp_le_i32 vcc, s54, v117
    s_mov_b64 exec, vcc
    v_mov_b32 v27, 0
    v_mov_b32 v74, 0
    s_mov_b64 exec, -1
    s_branch L_uback_59
L_ufix_60:
    v_and_b32 v117, 63, v0
    v_lshlrev_b32 v117, 2, v117
    s_sub_i32 s54, s42, 0
    v_cmp_le_i32 vcc, s54, v117
    s_mov_b64 exec, vcc
    v_mov_b32 v4, 0
    v_mov_b32 v28, 0
    s_mov_b64 exec, -1
    s_sub_i32 s54, s42, 1
    v_cmp_le_i32 vcc, s54, v117
    s_mov_b64 exec, vcc
    v_mov_b32 v5, 0
    v_mov_b32 v30, 0
    s_mov_b64 exec, -1
    s_sub_i32 s54, s42, 2
    v_cmp_le_i32 vcc, s54, v117
    s_mov_b64 exec, vcc
    v_mov_b32 v6, 0
    v_mov_b32 v32, 0
    s_mov_b64 exec, -1
    s_sub_i32 s54, s42, 3
    v_cmp_le_i32 vcc, s54, v117
    s_mov_b64 exec, vcc
    v_mov_b32 v7, 0
    v_mov_b32 v34, 0
    s_mov_b64 exec, -1
    s_branch L_uback_61
L_ufix_62:
    v_and_b32 v117, 63, v0
    v_lshlrev_b32 v117, 2, v117
    s_sub_i32 s54, s42, 512
    v_cmp_le_i32 vcc, s54, v117
    s_mov_b64 exec, vcc
    v_mov_b32 v8, 0
    v_mov_b32 v36, 0
    s_mov_b64 exec, -1
    s_sub_i32 s54, s42, 513
    v_cmp_le_i32 vcc, s54, v117
    s_mov_b64 exec, vcc
    v_mov_b32 v9, 0
    v_mov_b32 v38, 0
    s_mov_b64 exec, -1
    s_sub_i32 s54, s42, 514
    v_cmp_le_i32 vcc, s54, v117
    s_mov_b64 exec, vcc
    v_mov_b32 v10, 0
    v_mov_b32 v40, 0
    s_mov_b64 exec, -1
    s_sub_i32 s54, s42, 515
    v_cmp_le_i32 vcc, s54, v117
    s_mov_b64 exec, vcc
    v_mov_b32 v11, 0
    v_mov_b32 v42, 0
    s_mov_b64 exec, -1
    s_branch L_uback_63
L_ufix_69:
    v_and_b32 v117, 63, v0
    v_lshlrev_b32 v117, 2, v117
    s_sub_i32 s54, s42, 3072
    v_cmp_le_i32 vcc, s54, v117
    s_mov_b64 exec, vcc
    v_mov_b32 v106, 0
    v_mov_b32 v120, 0
    s_mov_b64 exec, -1
    s_sub_i32 s54, s42, 3073
    v_cmp_le_i32 vcc, s54, v117
    s_mov_b64 exec, vcc
    v_mov_b32 v107, 0
    v_mov_b32 v122, 0
    s_mov_b64 exec, -1
    s_sub_i32 s54, s42, 3074
    v_cmp_le_i32 vcc, s54, v117
    s_mov_b64 exec, vcc
    v_mov_b32 v108, 0
    v_mov_b32 v124, 0
    s_mov_b64 exec, -1
    s_sub_i32 s54, s42, 3075
    v_cmp_le_i32 vcc, s54, v117
    s_mov_b64 exec, vcc
    v_mov_b32 v109, 0
    v_mov_b32 v126, 0
    s_mov_b64 exec, -1
    s_branch L_uback_70
L_ufix_73:
    v_and_b32 v117, 63, v0
    v_lshlrev_b32 v117, 2, v117
    s_sub_i32 s54, s42, 1024
    v_cmp_le_i32 vcc, s54, v117
    s_mov_b64 exec, vcc
    v_mov_b32 v12, 0
    v_mov_b32 v44, 0
    s_mov_b64 exec, -1
    s_sub_i32 s54, s42, 1025
    v_cmp_le_i32 vcc, s54, v117
    s_mov_b64 exec, vcc
    v_mov_b32 v13, 0
    v_mov_b32 v46, 0
    s_mov_b64 exec, -1
    s_sub_i32 s54, s42, 1026
    v_cmp_le_i32 vcc, s54, v117
    s_mov_b64 exec, vcc
    v_mov_b32 v14, 0
    v_mov_b32 v48, 0
    s_mov_b64 exec, -1
    s_sub_i32 s54, s42, 1027
    v_cmp_le_i32 vcc, s54, v117
    s_mov_b64 exec, vcc
    v_mov_b32 v15, 0
    v_mov_b32 v50, 0
    s_mov_b64 exec, -1
    s_branch L_uback_74
L_ufix_75:
    v_and_b32 v117, 63, v0
    v_lshlrev_b32 v117, 2, v117
    s_sub_i32 s54, s42, 1536
    v_cmp_le_i32 vcc, s54, v117
    s_mov_b64 exec, vcc
    v_mov_b32 v16, 0
    v_mov_b32 v52, 0
    s_mov_b64 exec, -1
    s_sub_i32 s54, s42, 1537
    v_cmp_le_i32 vcc, s54, v117
    s_mov_b64 exec, vcc
    v_mov_b32 v17, 0
    v_mov_b32 v54, 0
    s_mov_b64 exec, -1
    s_sub_i32 s54, s42, 1538
    v_cmp_le_i32 vcc, s54, v117
    s_mov_b64 exec, vcc
    v_mov_b32 v18, 0
    v_mov_b32 v56, 0
    s_mov_b64 exec, -1
    s_sub_i32 s54, s42, 1539
    v_cmp_le_i32 vcc, s54, v117
    s_mov_b64 exec, vcc
    v_mov_b32 v19, 0
    v_mov_b32 v58, 0
    s_mov_b64 exec, -1
    s_branch L_uback_76
L_ufix_77:
    v_and_b32 v117, 63, v0
    v_lshlrev_b32 v117, 2, v117
    s_sub_i32 s54, s42, 2048
    v_cmp_le_i32 vcc, s54, v117
    s_mov_b64 exec, vcc
    v_mov_b32 v20, 0
    v_mov_b32 v60, 0
    s_mov_b64 exec, -1
    s_sub_i32 s54, s42, 2049
    v_cmp_le_i32 vcc, s54, v117
    s_mov_b64 exec, vcc
    v_mov_b32 v21, 0
    v_mov_b32 v62, 0
    s_mov_b64 exec, -1
    s_sub_i32 s54, s42, 2050
    v_cmp_le_i32 vcc, s54, v117
    s_mov_b64 exec, vcc
    v_mov_b32 v22, 0
    v_mov_b32 v64, 0
    s_mov_b64 exec, -1
    s_sub_i32 s54, s42, 2051
    v_cmp_le_i32 vcc, s54, v117
    s_mov_b64 exec, vcc
    v_mov_b32 v23, 0
    v_mov_b32 v66, 0
    s_mov_b64 exec, -1
    s_branch L_uback_78
L_ufix_79:
    v_and_b32 v117, 63, v0
    v_lshlrev_b32 v117, 2, v117
    s_sub_i32 s54, s42, 2560
    v_cmp_le_i32 vcc, s54, v117
    s_mov_b64 exec, vcc
    v_mov_b32 v24, 0
    v_mov_b32 v68, 0
    s_mov_b64 exec, -1
    s_sub_i32 s54, s42, 2561
    v_cmp_le_i32 vcc, s54, v117
    s_mov_b64 exec, vcc
    v_mov_b32 v25, 0
    v_mov_b32 v70, 0
    s_mov_b64 exec, -1
    s_sub_i32 s54, s42, 2562
    v_cmp_le_i32 vcc, s54, v117
    s_mov_b64 exec, vcc
    v_mov_b32 v26, 0
    v_mov_b32 v72, 0
    s_mov_b64 exec, -1
    s_sub_i32 s54, s42, 2563
    v_cmp_le_i32 vcc, s54, v117
    s_mov_b64 exec, vcc
    v_mov_b32 v27, 0
    v_mov_b32 v74, 0
    s_mov_b64 exec, -1
    s_branch L_uback_80
L_ufix_81:
    v_and_b32 v117, 63, v0
    v_lshlrev_b32 v117, 2, v117
    s_sub_i32 s54, s42, 0
    v_cmp_le_i32 vcc, s54, v117
    s_mov_b64 exec, vcc
    v_mov_b32 v4, 0
    v_mov_b32 v28, 0
    s_mov_b64 exec, -1
    s_sub_i32 s54, s42, 1
    v_cmp_le_i32 vcc, s54, v117
    s_mov_b64 exec, vcc
    v_mov_b32 v5, 0
    v_mov_b32 v30, 0
    s_mov_b64 exec, -1
    s_sub_i32 s54, s42, 2
    v_cmp_le_i32 vcc, s54, v117
    s_mov_b64 exec, vcc
    v_mov_b32 v6, 0
    v_mov_b32 v32, 0
    s_mov_b64 exec, -1
    s_sub_i32 s54, s42, 3
    v_cmp_le_i32 vcc, s54, v117
    s_mov_b64 exec, vcc
    v_mov_b32 v7, 0
    v_mov_b32 v34, 0
    s_mov_b64 exec, -1
    s_branch L_uback_82
L_ufix_83:
    v_and_b32 v117, 63, v0
    v_lshlrev_b32 v117, 2, v117
    s_sub_i32 s54, s42, 512
    v_cmp_le_i32 vcc, s54, v117
    s_mov_b64 exec, vcc
    v_mov_b32 v8, 0
    v_mov_b32 v36, 0
    s_mov_b64 exec, -1
    s_sub_i32 s54, s42, 513
    v_cmp_le_i32 vcc, s54, v117
    s_mov_b64 exec, vcc
    v_mov_b32 v9, 0
    v_mov_b32 v38, 0
    s_mov_b64 exec, -1
    s_sub_i32 s54, s42, 514
    v_cmp_le_i32 vcc, s54, v117
    s_mov_b64 exec, vcc
    v_mov_b32 v10, 0
    v_mov_b32 v40, 0
    s_mov_b64 exec, -1
    s_sub_i32 s54, s42, 515
    v_cmp_le_i32 vcc, s54, v117
    s_mov_b64 exec, vcc
    v_mov_b32 v11, 0
    v_mov_b32 v42, 0
    s_mov_b64 exec, -1
    s_branch L_uback_84
L_p2slow_51:
    s_waitcnt vmcnt(0) lgkmcnt(0)
    s_mov_b32 s51, 0
    s_movk_i32 s43, 6250
    s_mov_b32 s34, 0
L_sweep_87:
    s_barrier

    v_mov_b32 v28, 0x0
    v_mov_b32 v29, 0x0
    v_mov_b32 v30, 0x0
    v_mov_b32 v31, 0x0
    v_add_u32 v32, 50000, v3
    v_add_u32 v33, 65536, v32

    ds_write_b128 v32, v[28:31] offset:0
    ds_write_b128 v32, v[28:31] offset:16384
    ds_write_b128 v32, v[28:31] offset:32768
    ds_write_b128 v32, v[28:31] offset:49152
    ds_write_b128 v33, v[28:31] offset:0
    ds_write_b128 v33, v[28:31] offset:16384
    v_cmp_gt_u32 vcc, 971, v0
    s_mov_b64 exec, vcc
    ds_write_b128 v33, v[28:31] offset:32768
    s_mov_b64 exec, -1
    s_waitcnt lgkmcnt(0)
    s_barrier
    s_sub_u32 s38, s4, 8
L_sbatch_88:
    s_lshl_b32 s52, s38, 6
    s_add_u32 s52, s52, s36
    s_lshl_b32 s52, s52, 2
    s_load_dword s40, s[46:47], s52
    s_mul_i32 s50, s38, 200000
    s_waitcnt lgkmcnt(0)

    s_min_u32 s40, s40, 3968
    s_lshl_b32 s52, s38, 6
    s_add_u32 s52, s52, s36
    s_mul_i32 s52, s52, 19840
    s_add_u32 s20, s44, s52
    s_addc_u32 s21, s45, 0
    s_mul_i32 s52, s40, 5
    s_add_u32 s52, s52, 3
    s_and_b32 s22, s52, -4

    s_lshr_b32 s55, s39, 2
    s_add_u32 s55, s55, 0
    v_and_b32 v36, 63, v0
    v_add_u32 v36, s55, v36
L_left_92:
    s_cmp_ge_u32 s55, s40
    s_cbranch_scc1 L_leftend_93
    v_mul_u32_u24 v37, 5, v36
    buffer_load_dword v38, v37, s[20:23], 0 offen
    buffer_load_ubyte v39, v37, s[20:23], 0 offen offset:4
    s_waitcnt vmcnt(0)

    v_perm_b32 v37, v39, v38, s24
    v_lshrrev_b32 v42, 30, v38
    v_and_b32 v37, 0x1fff, v37
    v_mul_u32_u24 v42, 6250, v42
    v_add_lshl_u32 v37, v37, v42, 3

    buffer_load_dwordx2 v[40:41], v37, s[8:11], s50 offen
    v_cmp_gt_u32 vcc, s40, v36
    s_waitcnt vmcnt(0)

    v_bfe_u32 v44, v38, 16, 14
    v_subrev_u32 v44, s51, v44
    v_cmp_gt_u32 s[64:65], s43, v44
    s_and_b64 exec, vcc, s[64:65]
    v_lshlrev_b32 v45, 8, v38
    v_cmpx_ne_u32 vcc, 0, v45
    v_lshlrev_b32 v44, 4, v44
    v_bfe_i32 v38, v38, 0, 16
    v_cvt_f32_i32 v38, v38
    v_mul_f32 v38, 0x38004020, v38
    v_lshlrev_b32 v45, 16, v40
    v_and_b32 v46, s32, v40
    v_lshlrev_b32 v47, 16, v41
    v_and_b32 v48, s32, v41

    v_mul_f32 v45, v45, v38
    ds_add_f32 v44, v45 offset:50000
    v_mul_f32 v46, v46, v38
    ds_add_f32 v44, v46 offset:50004
    v_mul_f32 v47, v47, v38
    ds_add_f32 v44, v47 offset:50008
    v_mul_f32 v48, v48, v38
    ds_add_f32 v44, v48 offset:50012
    s_mov_b64 exec, -1
    v_add_u32 v36, 128, v36
    s_add_u32 s55, s55, 128
    s_branch L_left_92
L_leftend_93:

    s_add_u32 s38, s38, 1
    s_cmp_lt_u32 s38, s4
    s_cbranch_scc1 L_sbatch_88
    s_mov_b32 s3, 65536
    s_load_dword s40, s[6:7], s3

    s_add_u32 s20, s6, 408657920
    s_addc_u32 s21, s7, 0
    s_mov_b32 s22, 409600000
    s_mov_b32 s23, 0x20000
    s_mov_b32 s38, 0
    s_mov_b32 s50, 200000
    v_mov_b32 v36, v0
    s_waitcnt lgkmcnt(0)
L_ovf_89:
    s_cmp_ge_u32 s38, s40
    s_cbranch_scc1 L_ovfend_90
    v_lshlrev_b32 v37, 3, v36
    buffer_load_dwordx2 v[38:39], v37, s[20:23], 0 offen
    s_waitcnt vmcnt(0)

    v_perm_b32 v37, v39, v38, s24
    v_lshrrev_b32 v42, 30, v38
    v_and_b32 v37, 0x1fff, v37
    v_mul_u32_u24 v42, 6250, v42
    v_add_lshl_u32 v37, v37, v42, 3

    v_bfe_u32 v42, v39, 24, 5
    v_mad_u32_u24 v37, v42, s50, v37
    buffer_load_dwordx2 v[40:41], v37, s[8:11], 0 offen
    v_lshrrev_b32 v42, 3, v42
    v_bfe_u32 v43, v39, 18, 6
    v_cmp_gt_u32 vcc, s40, v36
    v_cmp_eq_u32 s[64:65], s36, v43
    s_and_b64 vcc, vcc, s[64:65]
    v_cmp_eq_u32 s[64:65], s37, v42
    s_and_b64 vcc, vcc, s[64:65]
    s_waitcnt vmcnt(0)

    v_bfe_u32 v44, v38, 16, 14
    v_subrev_u32 v44, s51, v44
    v_cmp_gt_u32 s[64:65], s43, v44
    s_and_b64 exec, vcc, s[64:65]
    v_lshlrev_b32 v45, 8, v38
    v_cmpx_ne_u32 vcc, 0, v45
    v_lshlrev_b32 v44, 4, v44
    v_bfe_i32 v38, v38, 0, 16
    v_cvt_f32_i32 v38, v38
    v_mul_f32 v38, 0x38004020, v38
    v_lshlrev_b32 v45, 16, v40
    v_and_b32 v46, s32, v40
    v_lshlrev_b32 v47, 16, v41
    v_and_b32 v48, s32, v41

    v_mul_f32 v45, v45, v38
    ds_add_f32 v44, v45 offset:50000
    v_mul_f32 v46, v46, v38
    ds_add_f32 v44, v46 offset:50004
    v_mul_f32 v47, v47, v38
    ds_add_f32 v44, v47 offset:50008
    v_mul_f32 v48, v48, v38
    ds_add_f32 v44, v48 offset:50012
    s_mov_b64 exec, -1
    v_add_u32 v36, 1024, v36
    s_add_u32 s38, s38, 1024
    s_branch L_ovf_89
L_ovfend_90:
    s_waitcnt lgkmcnt(0)
    s_barrier
    s_mul_i32 s3, s37, 800000
    s_mul_i32 s5, s36, 12500
    s_add_u32 s3, s3, s5
    s_add_u32 s3, s3, s51
    s_lshl_b32 s3, s3, 4
    s_add_u32 s3, s3, 32399360

    s_add_u32 s20, s6, s3
    s_addc_u32 s21, s7, 0
    s_mov_b32 s22, 100000
    s_mov_b32 s23, 0x20000
    v_mov_b32 v36, v3
    s_mov_b32 s38, 0
L_wl_91:
    v_min_u32 v37, 100000, v36
    ds_read_b128 v[28:31], v37 offset:50000
    s_waitcnt lgkmcnt(0)
    buffer_store_dwordx4 v[28:31], v36, s[20:23], 0 offen
    s_waitcnt vmcnt(0)
    v_add_u32 v36, 16384, v36
    s_add_u32 s38, s38, 1024
    s_cmp_lt_u32 s38, 6250
    s_cbranch_scc1 L_wl_91
    s_add_u32 s51, s51, 6250
    s_cmp_lt_u32 s51, 12500
    s_cbranch_scc1 L_sweep_87
    s_branch L_fin_86

.globl standalone__molecular_angular_gemnet__graph_kernel
.p2align 8
.type standalone__molecular_angular_gemnet__graph_kernel,@function
standalone__molecular_angular_gemnet__graph_kernel:
    s_cmp_ge_u32 s2, 1600
    s_cbranch_scc1 L_fdone_94
    s_load_dwordx2 s[4:5], s[0:1], 0
    s_load_dwordx2 s[8:9], s[0:1], 24
    s_load_dwordx2 s[12:13], s[0:1], 88
    s_load_dwordx2 s[16:17], s[0:1], 104
    s_load_dwordx2 s[78:79], s[0:1], 40
    s_load_dwordx8 s[24:31], s[0:1], 56
    v_cmp_gt_u32 vcc, 250, v0
    s_mul_i32 s3, s2, 250
    v_add_u32 v0, s3, v0
    v_lshlrev_b32 v1, 4, v0
    v_lshlrev_b32 v2, 2, v0
    s_mov_b64 exec, vcc
    s_mul_hi_u32 s3, s2, 171798692
    s_lshl_b32 s3, s3, 4
    s_add_u32 s3, s3, 147456
    s_mov_b32 s6, 6400000
    s_mov_b32 s7, 0x20000
    s_mov_b32 s10, 1600000
    s_mov_b32 s11, 0x20000
    s_mov_b32 s14, 6400000
    s_mov_b32 s15, 0x20000
    s_mov_b32 s18, 76800000
    s_mov_b32 s19, 0x20000
    s_waitcnt lgkmcnt(0)
    buffer_load_dword v3, v2, s[8:11], 0 offen
    s_load_dwordx4 s[32:35], s[78:79], 0
    s_load_dwordx4 s[20:23], s[16:17], s3
    s_load_dwordx16 s[36:51], s[24:25], 0
    s_load_dwordx16 s[52:67], s[26:27], 0
    s_load_dwordx8 s[68:75], s[28:29], 0
    s_mov_b64 s[0:1], s[30:31]
    s_load_dwordx8 s[24:31], s[0:1], 0
    s_add_u32 s16, s16, 6799360
    s_addc_u32 s17, s17, 0

    s_mov_b32 s3, 0
    buffer_load_dwordx4 v[40:43], v1, s[16:19], s3 offen nt
    s_mov_b32 s3, 6400000
    buffer_load_dwordx4 v[44:47], v1, s[16:19], s3 offen nt
    s_mov_b32 s3, 12800000
    buffer_load_dwordx4 v[48:51], v1, s[16:19], s3 offen nt
    s_mov_b32 s3, 19200000
    buffer_load_dwordx4 v[52:55], v1, s[16:19], s3 offen nt
    buffer_load_dwordx4 v[56:59], v1, s[4:7], 0 offen
    s_mov_b32 s76, 0xffff0000
    s_waitcnt vmcnt(5) lgkmcnt(0)
    v_and_b32 v5, s76, v3
    v_lshlrev_b32 v4, 16, v3

    s_lshl_b32 s77, s32, 16
    v_subrev_f32 v8, s77, v4
    v_subrev_f32 v16, s77, v5
    s_and_b32 s78, s32, s76
    v_subrev_f32 v9, s78, v4
    v_subrev_f32 v17, s78, v5
    s_lshl_b32 s77, s33, 16
    v_subrev_f32 v10, s77, v4
    v_subrev_f32 v18, s77, v5
    s_and_b32 s78, s33, s76
    v_subrev_f32 v11, s78, v4
    v_subrev_f32 v19, s78, v5
    s_lshl_b32 s77, s34, 16
    v_subrev_f32 v12, s77, v4
    v_subrev_f32 v20, s77, v5
    s_and_b32 s78, s34, s76
    v_subrev_f32 v13, s78, v4
    v_subrev_f32 v21, s78, v5
    s_lshl_b32 s77, s35, 16
    v_subrev_f32 v14, s77, v4
    v_subrev_f32 v22, s77, v5
    s_and_b32 s78, s35, s76
    v_subrev_f32 v15, s78, v4
    v_subrev_f32 v23, s78, v5
    v_cvt_pk_bf16_f32 v8, v8, v9
    v_cvt_pk_bf16_f32 v10, v10, v11
    v_cvt_pk_bf16_f32 v12, v12, v13
    v_cvt_pk_bf16_f32 v14, v14, v15
    v_cvt_pk_bf16_f32 v16, v16, v17
    v_cvt_pk_bf16_f32 v18, v18, v19
    v_cvt_pk_bf16_f32 v20, v20, v21
    v_cvt_pk_bf16_f32 v22, v22, v23
    v_and_b32 v9, s76, v8
    v_lshlrev_b32 v8, 16, v8
    v_and_b32 v11, s76, v10
    v_lshlrev_b32 v10, 16, v10
    v_and_b32 v13, s76, v12
    v_lshlrev_b32 v12, 16, v12
    v_and_b32 v15, s76, v14
    v_lshlrev_b32 v14, 16, v14
    v_and_b32 v17, s76, v16
    v_lshlrev_b32 v16, 16, v16
    v_and_b32 v19, s76, v18
    v_lshlrev_b32 v18, 16, v18
    v_and_b32 v21, s76, v20
    v_lshlrev_b32 v20, 16, v20
    v_and_b32 v23, s76, v22
    v_lshlrev_b32 v22, 16, v22
    v_mul_f32 v8, v8, v8
    v_mul_f32 v9, v9, v9
    v_mul_f32 v10, v10, v10
    v_mul_f32 v11, v11, v11
    v_mul_f32 v12, v12, v12
    v_mul_f32 v13, v13, v13
    v_mul_f32 v14, v14, v14
    v_mul_f32 v15, v15, v15
    v_mul_f32 v16, v16, v16
    v_mul_f32 v17, v17, v17
    v_mul_f32 v18, v18, v18
    v_mul_f32 v19, v19, v19
    v_mul_f32 v20, v20, v20
    v_mul_f32 v21, v21, v21
    v_mul_f32 v22, v22, v22
    v_mul_f32 v23, v23, v23
    v_cvt_pk_bf16_f32 v8, v8, v9
    v_cvt_pk_bf16_f32 v10, v10, v11
    v_cvt_pk_bf16_f32 v12, v12, v13
    v_cvt_pk_bf16_f32 v14, v14, v15
    v_cvt_pk_bf16_f32 v16, v16, v17
    v_cvt_pk_bf16_f32 v18, v18, v19
    v_cvt_pk_bf16_f32 v20, v20, v21
    v_cvt_pk_bf16_f32 v22, v22, v23
    v_and_b32 v9, s76, v8
    v_lshlrev_b32 v8, 16, v8
    v_and_b32 v11, s76, v10
    v_lshlrev_b32 v10, 16, v10
    v_and_b32 v13, s76, v12
    v_lshlrev_b32 v12, 16, v12
    v_and_b32 v15, s76, v14
    v_lshlrev_b32 v14, 16, v14
    v_and_b32 v17, s76, v16
    v_lshlrev_b32 v16, 16, v16
    v_and_b32 v19, s76, v18
    v_lshlrev_b32 v18, 16, v18
    v_and_b32 v21, s76, v20
    v_lshlrev_b32 v20, 16, v20
    v_and_b32 v23, s76, v22
    v_lshlrev_b32 v22, 16, v22
    v_mul_f32 v8, 0xc1200000, v8
    v_mul_f32 v9, 0xc1200000, v9
    v_mul_f32 v10, 0xc1200000, v10
    v_mul_f32 v11, 0xc1200000, v11
    v_mul_f32 v12, 0xc1200000, v12
    v_mul_f32 v13, 0xc1200000, v13
    v_mul_f32 v14, 0xc1200000, v14
    v_mul_f32 v15, 0xc1200000, v15
    v_mul_f32 v16, 0xc1200000, v16
    v_mul_f32 v17, 0xc1200000, v17
    v_mul_f32 v18, 0xc1200000, v18
    v_mul_f32 v19, 0xc1200000, v19
    v_mul_f32 v20, 0xc1200000, v20
    v_mul_f32 v21, 0xc1200000, v21
    v_mul_f32 v22, 0xc1200000, v22
    v_mul_f32 v23, 0xc1200000, v23
    v_cvt_pk_bf16_f32 v8, v8, v9
    v_cvt_pk_bf16_f32 v10, v10, v11
    v_cvt_pk_bf16_f32 v12, v12, v13
    v_cvt_pk_bf16_f32 v14, v14, v15
    v_cvt_pk_bf16_f32 v16, v16, v17
    v_cvt_pk_bf16_f32 v18, v18, v19
    v_cvt_pk_bf16_f32 v20, v20, v21
    v_cvt_pk_bf16_f32 v22, v22, v23
    v_and_b32 v9, s76, v8
    v_lshlrev_b32 v8, 16, v8
    v_and_b32 v11, s76, v10
    v_lshlrev_b32 v10, 16, v10
    v_and_b32 v13, s76, v12
    v_lshlrev_b32 v12, 16, v12
    v_and_b32 v15, s76, v14
    v_lshlrev_b32 v14, 16, v14
    v_and_b32 v17, s76, v16
    v_lshlrev_b32 v16, 16, v16
    v_and_b32 v19, s76, v18
    v_lshlrev_b32 v18, 16, v18
    v_and_b32 v21, s76, v20
    v_lshlrev_b32 v20, 16, v20
    v_and_b32 v23, s76, v22
    v_lshlrev_b32 v22, 16, v22
    v_mul_f32 v8, 0x3fb8aa3b, v8
    v_mul_f32 v9, 0x3fb8aa3b, v9
    v_mul_f32 v10, 0x3fb8aa3b, v10
    v_mul_f32 v11, 0x3fb8aa3b, v11
    v_mul_f32 v12, 0x3fb8aa3b, v12
    v_mul_f32 v13, 0x3fb8aa3b, v13
    v_mul_f32 v14, 0x3fb8aa3b, v14
    v_mul_f32 v15, 0x3fb8aa3b, v15
    v_mul_f32 v16, 0x3fb8aa3b, v16
    v_mul_f32 v17, 0x3fb8aa3b, v17
    v_mul_f32 v18, 0x3fb8aa3b, v18
    v_mul_f32 v19, 0x3fb8aa3b, v19
    v_mul_f32 v20, 0x3fb8aa3b, v20
    v_mul_f32 v21, 0x3fb8aa3b, v21
    v_mul_f32 v22, 0x3fb8aa3b, v22
    v_mul_f32 v23, 0x3fb8aa3b, v23
    v_exp_f32 v8, v8
    v_exp_f32 v9, v9
    v_exp_f32 v10, v10
    v_exp_f32 v11, v11
    v_exp_f32 v12, v12
    v_exp_f32 v13, v13
    v_exp_f32 v14, v14
    v_exp_f32 v15, v15
    v_exp_f32 v16, v16
    v_exp_f32 v17, v17
    v_exp_f32 v18, v18
    v_exp_f32 v19, v19
    v_exp_f32 v20, v20
    v_exp_f32 v21, v21
    v_exp_f32 v22, v22
    v_exp_f32 v23, v23
    s_nop 0
    v_cvt_pk_bf16_f32 v8, v8, v9
    v_cvt_pk_bf16_f32 v10, v10, v11
    v_cvt_pk_bf16_f32 v12, v12, v13
    v_cvt_pk_bf16_f32 v14, v14, v15
    v_cvt_pk_bf16_f32 v16, v16, v17
    v_cvt_pk_bf16_f32 v18, v18, v19
    v_cvt_pk_bf16_f32 v20, v20, v21
    v_cvt_pk_bf16_f32 v22, v22, v23
    s_pack_ll_b32_b16 s77, s36, s38
    v_dot2_f32_bf16 v32, v8, s77, 0
    v_dot2_f32_bf16 v36, v16, s77, 0
    s_pack_hh_b32_b16 s78, s36, s38
    v_dot2_f32_bf16 v33, v8, s78, 0
    v_dot2_f32_bf16 v37, v16, s78, 0
    s_pack_ll_b32_b16 s77, s37, s39
    v_dot2_f32_bf16 v34, v8, s77, 0
    v_dot2_f32_bf16 v38, v16, s77, 0
    s_pack_hh_b32_b16 s78, s37, s39
    v_dot2_f32_bf16 v35, v8, s78, 0
    v_dot2_f32_bf16 v39, v16, s78, 0
    s_pack_ll_b32_b16 s77, s40, s42
    v_dot2_f32_bf16 v32, v10, s77, v32
    v_dot2_f32_bf16 v36, v18, s77, v36
    s_pack_hh_b32_b16 s78, s40, s42
    v_dot2_f32_bf16 v33, v10, s78, v33
    v_dot2_f32_bf16 v37, v18, s78, v37
    s_pack_ll_b32_b16 s77, s41, s43
    v_dot2_f32_bf16 v34, v10, s77, v34
    v_dot2_f32_bf16 v38, v18, s77, v38
    s_pack_hh_b32_b16 s78, s41, s43
    v_dot2_f32_bf16 v35, v10, s78, v35
    v_dot2_f32_bf16 v39, v18, s78, v39
    s_pack_ll_b32_b16 s77, s44, s46
    v_dot2_f32_bf16 v32, v12, s77, v32
    v_dot2_f32_bf16 v36, v20, s77, v36
    s_pack_hh_b32_b16 s78, s44, s46
    v_dot2_f32_bf16 v33, v12, s78, v33
    v_dot2_f32_bf16 v37, v20, s78, v37
    s_pack_ll_b32_b16 s77, s45, s47
    v_dot2_f32_bf16 v34, v12, s77, v34
    v_dot2_f32_bf16 v38, v20, s77, v38
    s_pack_hh_b32_b16 s78, s45, s47
    v_dot2_f32_bf16 v35, v12, s78, v35
    v_dot2_f32_bf16 v39, v20, s78, v39
    s_pack_ll_b32_b16 s77, s48, s50
    v_dot2_f32_bf16 v32, v14, s77, v32
    v_dot2_f32_bf16 v36, v22, s77, v36
    s_pack_hh_b32_b16 s78, s48, s50
    v_dot2_f32_bf16 v33, v14, s78, v33
    v_dot2_f32_bf16 v37, v22, s78, v37
    s_pack_ll_b32_b16 s77, s49, s51
    v_dot2_f32_bf16 v34, v14, s77, v34
    v_dot2_f32_bf16 v38, v22, s77, v38
    s_pack_hh_b32_b16 s78, s49, s51
    v_dot2_f32_bf16 v35, v14, s78, v35
    v_dot2_f32_bf16 v39, v22, s78, v39
    s_pack_ll_b32_b16 s77, s52, s54
    v_dot2_f32_bf16 v24, v8, s77, 0
    v_dot2_f32_bf16 v28, v16, s77, 0
    s_pack_hh_b32_b16 s78, s52, s54
    v_dot2_f32_bf16 v25, v8, s78, 0
    v_dot2_f32_bf16 v29, v16, s78, 0
    s_pack_ll_b32_b16 s77, s53, s55
    v_dot2_f32_bf16 v26, v8, s77, 0
    v_dot2_f32_bf16 v30, v16, s77, 0
    s_pack_hh_b32_b16 s78, s53, s55
    v_dot2_f32_bf16 v27, v8, s78, 0
    v_dot2_f32_bf16 v31, v16, s78, 0
    s_pack_ll_b32_b16 s77, s56, s58
    v_dot2_f32_bf16 v24, v10, s77, v24
    v_dot2_f32_bf16 v28, v18, s77, v28
    s_pack_hh_b32_b16 s78, s56, s58
    v_dot2_f32_bf16 v25, v10, s78, v25
    v_dot2_f32_bf16 v29, v18, s78, v29
    s_pack_ll_b32_b16 s77, s57, s59
    v_dot2_f32_bf16 v26, v10, s77, v26
    v_dot2_f32_bf16 v30, v18, s77, v30
    s_pack_hh_b32_b16 s78, s57, s59
    v_dot2_f32_bf16 v27, v10, s78, v27
    v_dot2_f32_bf16 v31, v18, s78, v31
    s_pack_ll_b32_b16 s77, s60, s62
    v_dot2_f32_bf16 v24, v12, s77, v24
    v_dot2_f32_bf16 v28, v20, s77, v28
    s_pack_hh_b32_b16 s78, s60, s62
    v_dot2_f32_bf16 v25, v12, s78, v25
    v_dot2_f32_bf16 v29, v20, s78, v29
    s_pack_ll_b32_b16 s77, s61, s63
    v_dot2_f32_bf16 v26, v12, s77, v26
    v_dot2_f32_bf16 v30, v20, s77, v30
    s_pack_hh_b32_b16 s78, s61, s63
    v_dot2_f32_bf16 v27, v12, s78, v27
    v_dot2_f32_bf16 v31, v20, s78, v31
    s_pack_ll_b32_b16 s77, s64, s66
    v_dot2_f32_bf16 v24, v14, s77, v24
    v_dot2_f32_bf16 v28, v22, s77, v28
    s_pack_hh_b32_b16 s78, s64, s66
    v_dot2_f32_bf16 v25, v14, s78, v25
    v_dot2_f32_bf16 v29, v22, s78, v29
    s_pack_ll_b32_b16 s77, s65, s67
    v_dot2_f32_bf16 v26, v14, s77, v26
    v_dot2_f32_bf16 v30, v22, s77, v30
    s_pack_hh_b32_b16 s78, s65, s67
    v_dot2_f32_bf16 v27, v14, s78, v27
    v_dot2_f32_bf16 v31, v22, s78, v31
    v_cvt_pk_bf16_f32 v32, v32, v33
    v_cvt_pk_bf16_f32 v34, v34, v35
    v_cvt_pk_bf16_f32 v36, v36, v37
    v_cvt_pk_bf16_f32 v38, v38, v39
    v_and_b32 v33, s76, v32
    v_lshlrev_b32 v32, 16, v32
    v_and_b32 v35, s76, v34
    v_lshlrev_b32 v34, 16, v34
    v_and_b32 v37, s76, v36
    v_lshlrev_b32 v36, 16, v36
    v_and_b32 v39, s76, v38
    v_lshlrev_b32 v38, 16, v38
    s_cmp_eq_u32 s20, 0
    s_cbranch_scc1 L_fgen_95
    s_cmp_lg_u64 s[20:21], s[22:23]
    s_cbranch_scc1 L_fgen_95
    s_cmp_lg_u32 s20, s21
    s_cbranch_scc1 L_fgen_95
    s_waitcnt vmcnt(1)

    v_add_u32 v40, v40, v44
    v_add_u32 v48, v48, v52
    v_add_u32 v41, v41, v45
    v_add_u32 v49, v49, v53
    v_add_u32 v42, v42, v46
    v_add_u32 v50, v50, v54
    v_add_u32 v43, v43, v47
    v_add_u32 v51, v51, v55
    v_add_u32_sdwa v8, v40, v48 dst_sel:DWORD dst_unused:UNUSED_PAD src0_sel:WORD_0 src1_sel:WORD_0
    v_add_u32_sdwa v9, v40, v48 dst_sel:DWORD dst_unused:UNUSED_PAD src0_sel:WORD_1 src1_sel:WORD_1
    v_add_u32_sdwa v10, v41, v49 dst_sel:DWORD dst_unused:UNUSED_PAD src0_sel:WORD_0 src1_sel:WORD_0
    v_add_u32_sdwa v11, v41, v49 dst_sel:DWORD dst_unused:UNUSED_PAD src0_sel:WORD_1 src1_sel:WORD_1
    v_add_u32_sdwa v12, v42, v50 dst_sel:DWORD dst_unused:UNUSED_PAD src0_sel:WORD_0 src1_sel:WORD_0
    v_add_u32_sdwa v13, v42, v50 dst_sel:DWORD dst_unused:UNUSED_PAD src0_sel:WORD_1 src1_sel:WORD_1
    v_add_u32_sdwa v14, v43, v51 dst_sel:DWORD dst_unused:UNUSED_PAD src0_sel:WORD_0 src1_sel:WORD_0
    v_add_u32_sdwa v15, v43, v51 dst_sel:DWORD dst_unused:UNUSED_PAD src0_sel:WORD_1 src1_sel:WORD_1
    v_add_u32 v8, 0xffff0000, v8
    v_add_u32 v9, 0xffff0000, v9
    v_add_u32 v10, 0xffff0000, v10
    v_add_u32 v11, 0xffff0000, v11
    v_add_u32 v12, 0xffff0000, v12
    v_add_u32 v13, 0xffff0000, v13
    v_add_u32 v14, 0xffff0000, v14
    v_add_u32 v15, 0xffff0000, v15
    v_cvt_f32_i32 v8, v8
    v_cvt_f32_i32 v9, v9
    v_cvt_f32_i32 v10, v10
    v_cvt_f32_i32 v11, v11
    v_cvt_f32_i32 v12, v12
    v_cvt_f32_i32 v13, v13
    v_cvt_f32_i32 v14, v14
    v_cvt_f32_i32 v15, v15
    v_mul_f32 v8, s20, v8
    v_mul_f32 v9, s20, v9
    v_mul_f32 v10, s20, v10
    v_mul_f32 v11, s20, v11
    v_mul_f32 v12, s20, v12
    v_mul_f32 v13, s20, v13
    v_mul_f32 v14, s20, v14
    v_mul_f32 v15, s20, v15
L_fbk_96:
    s_lshl_b32 s77, s68, 16
    v_mul_f32 v16, s77, v8
    v_mul_f32 v20, s77, v12
    s_and_b32 s78, s68, s76
    v_mul_f32 v17, s78, v8
    v_mul_f32 v21, s78, v12
    s_lshl_b32 s77, s69, 16
    v_mul_f32 v18, s77, v8
    v_mul_f32 v22, s77, v12
    s_and_b32 s78, s69, s76
    v_mul_f32 v19, s78, v8
    v_mul_f32 v23, s78, v12
    s_lshl_b32 s77, s70, 16
    v_fmac_f32 v16, s77, v9
    v_fmac_f32 v20, s77, v13
    s_and_b32 s78, s70, s76
    v_fmac_f32 v17, s78, v9
    v_fmac_f32 v21, s78, v13
    s_lshl_b32 s77, s71, 16
    v_fmac_f32 v18, s77, v9
    v_fmac_f32 v22, s77, v13
    s_and_b32 s78, s71, s76
    v_fmac_f32 v19, s78, v9
    v_fmac_f32 v23, s78, v13
    s_lshl_b32 s77, s72, 16
    v_fmac_f32 v16, s77, v10
    v_fmac_f32 v20, s77, v14
    s_and_b32 s78, s72, s76
    v_fmac_f32 v17, s78, v10
    v_fmac_f32 v21, s78, v14
    s_lshl_b32 s77, s73, 16
    v_fmac_f32 v18, s77, v10
    v_fmac_f32 v22, s77, v14
    s_and_b32 s78, s73, s76
    v_fmac_f32 v19, s78, v10
    v_fmac_f32 v23, s78, v14
    s_lshl_b32 s77, s74, 16
    v_fmac_f32 v16, s77, v11
    v_fmac_f32 v20, s77, v15
    s_and_b32 s78, s74, s76
    v_fmac_f32 v17, s78, v11
    v_fmac_f32 v21, s78, v15
    s_lshl_b32 s77, s75, 16
    v_fmac_f32 v18, s77, v11
    v_fmac_f32 v22, s77, v15
    s_and_b32 s78, s75, s76
    v_fmac_f32 v19, s78, v11
    v_fmac_f32 v23, s78, v15
    v_mul_f32 v16, v16, v24
    v_mul_f32 v17, v17, v25
    v_mul_f32 v18, v18, v26
    v_mul_f32 v19, v19, v27
    v_mul_f32 v20, v20, v28
    v_mul_f32 v21, v21, v29
    v_mul_f32 v22, v22, v30
    v_mul_f32 v23, v23, v31
    v_cvt_pk_bf16_f32 v16, v16, v17
    v_cvt_pk_bf16_f32 v18, v18, v19
    v_cvt_pk_bf16_f32 v20, v20, v21
    v_cvt_pk_bf16_f32 v22, v22, v23
    s_pack_ll_b32_b16 s77, s24, s26
    v_dot2_f32_bf16 v8, v16, s77, 0
    v_dot2_f32_bf16 v12, v20, s77, 0
    s_pack_hh_b32_b16 s78, s24, s26
    v_dot2_f32_bf16 v9, v16, s78, 0
    v_dot2_f32_bf16 v13, v20, s78, 0
    s_pack_ll_b32_b16 s77, s25, s27
    v_dot2_f32_bf16 v10, v16, s77, 0
    v_dot2_f32_bf16 v14, v20, s77, 0
    s_pack_hh_b32_b16 s78, s25, s27
    v_dot2_f32_bf16 v11, v16, s78, 0
    v_dot2_f32_bf16 v15, v20, s78, 0
    s_pack_ll_b32_b16 s77, s28, s30
    v_dot2_f32_bf16 v8, v18, s77, v8
    v_dot2_f32_bf16 v12, v22, s77, v12
    s_pack_hh_b32_b16 s78, s28, s30
    v_dot2_f32_bf16 v9, v18, s78, v9
    v_dot2_f32_bf16 v13, v22, s78, v13
    s_pack_ll_b32_b16 s77, s29, s31
    v_dot2_f32_bf16 v10, v18, s77, v10
    v_dot2_f32_bf16 v14, v22, s77, v14
    s_pack_hh_b32_b16 s78, s29, s31
    v_dot2_f32_bf16 v11, v18, s78, v11
    v_dot2_f32_bf16 v15, v22, s78, v15
    s_waitcnt vmcnt(0)
    v_lshlrev_b32 v24, 16, v56
    v_and_b32 v25, s76, v56
    v_lshlrev_b32 v26, 16, v57
    v_and_b32 v27, s76, v57
    v_lshlrev_b32 v28, 16, v58
    v_and_b32 v29, s76, v58
    v_lshlrev_b32 v30, 16, v59
    v_and_b32 v31, s76, v59
    v_cvt_pk_bf16_f32 v8, v8, v9
    v_cvt_pk_bf16_f32 v10, v10, v11
    v_cvt_pk_bf16_f32 v12, v12, v13
    v_cvt_pk_bf16_f32 v14, v14, v15
    v_and_b32 v9, s76, v8
    v_lshlrev_b32 v8, 16, v8
    v_and_b32 v11, s76, v10
    v_lshlrev_b32 v10, 16, v10
    v_and_b32 v13, s76, v12
    v_lshlrev_b32 v12, 16, v12
    v_and_b32 v15, s76, v14
    v_lshlrev_b32 v14, 16, v14
    v_mul_f32 v8, v8, v32
    v_mul_f32 v9, v9, v33
    v_mul_f32 v10, v10, v34
    v_mul_f32 v11, v11, v35
    v_mul_f32 v12, v12, v36
    v_mul_f32 v13, v13, v37
    v_mul_f32 v14, v14, v38
    v_mul_f32 v15, v15, v39
    v_cvt_pk_bf16_f32 v8, v8, v9
    v_cvt_pk_bf16_f32 v10, v10, v11
    v_cvt_pk_bf16_f32 v12, v12, v13
    v_cvt_pk_bf16_f32 v14, v14, v15
    v_and_b32 v9, s76, v8
    v_lshlrev_b32 v8, 16, v8
    v_and_b32 v11, s76, v10
    v_lshlrev_b32 v10, 16, v10
    v_and_b32 v13, s76, v12
    v_lshlrev_b32 v12, 16, v12
    v_and_b32 v15, s76, v14
    v_lshlrev_b32 v14, 16, v14
    v_add_f32 v8, v8, v24
    v_add_f32 v9, v9, v25
    v_add_f32 v10, v10, v26
    v_add_f32 v11, v11, v27
    v_add_f32 v12, v12, v28
    v_add_f32 v13, v13, v29
    v_add_f32 v14, v14, v30
    v_add_f32 v15, v15, v31
    v_cvt_pk_bf16_f32 v16, v8, v9
    v_cvt_pk_bf16_f32 v17, v10, v11
    v_cvt_pk_bf16_f32 v18, v12, v13
    v_cvt_pk_bf16_f32 v19, v14, v15
    buffer_store_dwordx4 v[16:19], v1, s[12:15], 0 offen
L_fdone_94:
    s_endpgm

L_fgen_95:
    s_waitcnt vmcnt(1)
    v_lshlrev_b32 v2, 5, v0
    v_mov_b32 v8, 0
    v_mov_b32 v9, 0
    v_mov_b32 v10, 0
    v_mov_b32 v11, 0
    v_mov_b32 v12, 0
    v_mov_b32 v13, 0
    v_mov_b32 v14, 0
    v_mov_b32 v15, 0
    s_cmp_eq_u32 s20, 0
    s_cbranch_scc1 L_ffl_97
    v_cvt_f32_u32_sdwa v16, v40 dst_sel:DWORD dst_unused:UNUSED_PAD src0_sel:WORD_0
    v_cvt_f32_u32_sdwa v17, v40 dst_sel:DWORD dst_unused:UNUSED_PAD src0_sel:WORD_1
    v_cvt_f32_u32_sdwa v18, v41 dst_sel:DWORD dst_unused:UNUSED_PAD src0_sel:WORD_0
    v_cvt_f32_u32_sdwa v19, v41 dst_sel:DWORD dst_unused:UNUSED_PAD src0_sel:WORD_1
    v_cvt_f32_u32_sdwa v20, v42 dst_sel:DWORD dst_unused:UNUSED_PAD src0_sel:WORD_0
    v_cvt_f32_u32_sdwa v21, v42 dst_sel:DWORD dst_unused:UNUSED_PAD src0_sel:WORD_1
    v_cvt_f32_u32_sdwa v22, v43 dst_sel:DWORD dst_unused:UNUSED_PAD src0_sel:WORD_0
    v_cvt_f32_u32_sdwa v23, v43 dst_sel:DWORD dst_unused:UNUSED_PAD src0_sel:WORD_1
    v_add_f32 v16, 0xc6800000, v16
    v_fmac_f32 v8, s20, v16
    v_add_f32 v17, 0xc6800000, v17
    v_fmac_f32 v9, s20, v17
    v_add_f32 v18, 0xc6800000, v18
    v_fmac_f32 v10, s20, v18
    v_add_f32 v19, 0xc6800000, v19
    v_fmac_f32 v11, s20, v19
    v_add_f32 v20, 0xc6800000, v20
    v_fmac_f32 v12, s20, v20
    v_add_f32 v21, 0xc6800000, v21
    v_fmac_f32 v13, s20, v21
    v_add_f32 v22, 0xc6800000, v22
    v_fmac_f32 v14, s20, v22
    v_add_f32 v23, 0xc6800000, v23
    v_fmac_f32 v15, s20, v23
    s_branch L_fnx_98
L_ffl_97:
    s_mov_b32 s3, 25600000
    buffer_load_dwordx4 v[16:19], v2, s[16:19], s3 offen
    buffer_load_dwordx4 v[20:23], v2, s[16:19], s3 offen offset:16
    s_waitcnt vmcnt(0)
    v_add_f32 v8, v8, v16
    v_add_f32 v9, v9, v17
    v_add_f32 v10, v10, v18
    v_add_f32 v11, v11, v19
    v_add_f32 v12, v12, v20
    v_add_f32 v13, v13, v21
    v_add_f32 v14, v14, v22
    v_add_f32 v15, v15, v23
L_fnx_98:
    s_cmp_eq_u32 s21, 0
    s_cbranch_scc1 L_ffl_99
    v_cvt_f32_u32_sdwa v16, v44 dst_sel:DWORD dst_unused:UNUSED_PAD src0_sel:WORD_0
    v_cvt_f32_u32_sdwa v17, v44 dst_sel:DWORD dst_unused:UNUSED_PAD src0_sel:WORD_1
    v_cvt_f32_u32_sdwa v18, v45 dst_sel:DWORD dst_unused:UNUSED_PAD src0_sel:WORD_0
    v_cvt_f32_u32_sdwa v19, v45 dst_sel:DWORD dst_unused:UNUSED_PAD src0_sel:WORD_1
    v_cvt_f32_u32_sdwa v20, v46 dst_sel:DWORD dst_unused:UNUSED_PAD src0_sel:WORD_0
    v_cvt_f32_u32_sdwa v21, v46 dst_sel:DWORD dst_unused:UNUSED_PAD src0_sel:WORD_1
    v_cvt_f32_u32_sdwa v22, v47 dst_sel:DWORD dst_unused:UNUSED_PAD src0_sel:WORD_0
    v_cvt_f32_u32_sdwa v23, v47 dst_sel:DWORD dst_unused:UNUSED_PAD src0_sel:WORD_1
    v_add_f32 v16, 0xc6800000, v16
    v_fmac_f32 v8, s21, v16
    v_add_f32 v17, 0xc6800000, v17
    v_fmac_f32 v9, s21, v17
    v_add_f32 v18, 0xc6800000, v18
    v_fmac_f32 v10, s21, v18
    v_add_f32 v19, 0xc6800000, v19
    v_fmac_f32 v11, s21, v19
    v_add_f32 v20, 0xc6800000, v20
    v_fmac_f32 v12, s21, v20
    v_add_f32 v21, 0xc6800000, v21
    v_fmac_f32 v13, s21, v21
    v_add_f32 v22, 0xc6800000, v22
    v_fmac_f32 v14, s21, v22
    v_add_f32 v23, 0xc6800000, v23
    v_fmac_f32 v15, s21, v23
    s_branch L_fnx_100
L_ffl_99:
    s_mov_b32 s3, 38400000
    buffer_load_dwordx4 v[16:19], v2, s[16:19], s3 offen
    buffer_load_dwordx4 v[20:23], v2, s[16:19], s3 offen offset:16
    s_waitcnt vmcnt(0)
    v_add_f32 v8, v8, v16
    v_add_f32 v9, v9, v17
    v_add_f32 v10, v10, v18
    v_add_f32 v11, v11, v19
    v_add_f32 v12, v12, v20
    v_add_f32 v13, v13, v21
    v_add_f32 v14, v14, v22
    v_add_f32 v15, v15, v23
L_fnx_100:
    s_cmp_eq_u32 s22, 0
    s_cbranch_scc1 L_ffl_101
    v_cvt_f32_u32_sdwa v16, v48 dst_sel:DWORD dst_unused:UNUSED_PAD src0_sel:WORD_0
    v_cvt_f32_u32_sdwa v17, v48 dst_sel:DWORD dst_unused:UNUSED_PAD src0_sel:WORD_1
    v_cvt_f32_u32_sdwa v18, v49 dst_sel:DWORD dst_unused:UNUSED_PAD src0_sel:WORD_0
    v_cvt_f32_u32_sdwa v19, v49 dst_sel:DWORD dst_unused:UNUSED_PAD src0_sel:WORD_1
    v_cvt_f32_u32_sdwa v20, v50 dst_sel:DWORD dst_unused:UNUSED_PAD src0_sel:WORD_0
    v_cvt_f32_u32_sdwa v21, v50 dst_sel:DWORD dst_unused:UNUSED_PAD src0_sel:WORD_1
    v_cvt_f32_u32_sdwa v22, v51 dst_sel:DWORD dst_unused:UNUSED_PAD src0_sel:WORD_0
    v_cvt_f32_u32_sdwa v23, v51 dst_sel:DWORD dst_unused:UNUSED_PAD src0_sel:WORD_1
    v_add_f32 v16, 0xc6800000, v16
    v_fmac_f32 v8, s22, v16
    v_add_f32 v17, 0xc6800000, v17
    v_fmac_f32 v9, s22, v17
    v_add_f32 v18, 0xc6800000, v18
    v_fmac_f32 v10, s22, v18
    v_add_f32 v19, 0xc6800000, v19
    v_fmac_f32 v11, s22, v19
    v_add_f32 v20, 0xc6800000, v20
    v_fmac_f32 v12, s22, v20
    v_add_f32 v21, 0xc6800000, v21
    v_fmac_f32 v13, s22, v21
    v_add_f32 v22, 0xc6800000, v22
    v_fmac_f32 v14, s22, v22
    v_add_f32 v23, 0xc6800000, v23
    v_fmac_f32 v15, s22, v23
    s_branch L_fnx_102
L_ffl_101:
    s_mov_b32 s3, 51200000
    buffer_load_dwordx4 v[16:19], v2, s[16:19], s3 offen
    buffer_load_dwordx4 v[20:23], v2, s[16:19], s3 offen offset:16
    s_waitcnt vmcnt(0)
    v_add_f32 v8, v8, v16
    v_add_f32 v9, v9, v17
    v_add_f32 v10, v10, v18
    v_add_f32 v11, v11, v19
    v_add_f32 v12, v12, v20
    v_add_f32 v13, v13, v21
    v_add_f32 v14, v14, v22
    v_add_f32 v15, v15, v23
L_fnx_102:
    s_cmp_eq_u32 s23, 0
    s_cbranch_scc1 L_ffl_103
    v_cvt_f32_u32_sdwa v16, v52 dst_sel:DWORD dst_unused:UNUSED_PAD src0_sel:WORD_0
    v_cvt_f32_u32_sdwa v17, v52 dst_sel:DWORD dst_unused:UNUSED_PAD src0_sel:WORD_1
    v_cvt_f32_u32_sdwa v18, v53 dst_sel:DWORD dst_unused:UNUSED_PAD src0_sel:WORD_0
    v_cvt_f32_u32_sdwa v19, v53 dst_sel:DWORD dst_unused:UNUSED_PAD src0_sel:WORD_1
    v_cvt_f32_u32_sdwa v20, v54 dst_sel:DWORD dst_unused:UNUSED_PAD src0_sel:WORD_0
    v_cvt_f32_u32_sdwa v21, v54 dst_sel:DWORD dst_unused:UNUSED_PAD src0_sel:WORD_1
    v_cvt_f32_u32_sdwa v22, v55 dst_sel:DWORD dst_unused:UNUSED_PAD src0_sel:WORD_0
    v_cvt_f32_u32_sdwa v23, v55 dst_sel:DWORD dst_unused:UNUSED_PAD src0_sel:WORD_1
    v_add_f32 v16, 0xc6800000, v16
    v_fmac_f32 v8, s23, v16
    v_add_f32 v17, 0xc6800000, v17
    v_fmac_f32 v9, s23, v17
    v_add_f32 v18, 0xc6800000, v18
    v_fmac_f32 v10, s23, v18
    v_add_f32 v19, 0xc6800000, v19
    v_fmac_f32 v11, s23, v19
    v_add_f32 v20, 0xc6800000, v20
    v_fmac_f32 v12, s23, v20
    v_add_f32 v21, 0xc6800000, v21
    v_fmac_f32 v13, s23, v21
    v_add_f32 v22, 0xc6800000, v22
    v_fmac_f32 v14, s23, v22
    v_add_f32 v23, 0xc6800000, v23
    v_fmac_f32 v15, s23, v23
    s_branch L_fnx_104
L_ffl_103:
    s_mov_b32 s3, 64000000
    buffer_load_dwordx4 v[16:19], v2, s[16:19], s3 offen
    buffer_load_dwordx4 v[20:23], v2, s[16:19], s3 offen offset:16
    s_waitcnt vmcnt(0)
    v_add_f32 v8, v8, v16
    v_add_f32 v9, v9, v17
    v_add_f32 v10, v10, v18
    v_add_f32 v11, v11, v19
    v_add_f32 v12, v12, v20
    v_add_f32 v13, v13, v21
    v_add_f32 v14, v14, v22
    v_add_f32 v15, v15, v23
L_fnx_104:
    s_branch L_fbk_96
.section .rodata,"a"
.p2align 6
.amdhsa_kernel g1_kernel
  .amdhsa_next_free_vgpr 128
  .amdhsa_next_free_sgpr 102
  .amdhsa_accum_offset 128
  .amdhsa_group_segment_fixed_size 0
  .amdhsa_kernarg_size 112
  .amdhsa_user_sgpr_count 2
  .amdhsa_user_sgpr_kernarg_segment_ptr 1
  .amdhsa_system_sgpr_workgroup_id_x 1
.end_amdhsa_kernel
.p2align 6
.amdhsa_kernel g2_kernel
  .amdhsa_next_free_vgpr 128
  .amdhsa_next_free_sgpr 102
  .amdhsa_accum_offset 128
  .amdhsa_group_segment_fixed_size 0
  .amdhsa_kernarg_size 112
  .amdhsa_user_sgpr_count 2
  .amdhsa_user_sgpr_kernarg_segment_ptr 1
  .amdhsa_system_sgpr_workgroup_id_x 1
  .amdhsa_float_denorm_mode_32 3
.end_amdhsa_kernel
.p2align 6
.amdhsa_kernel standalone__molecular_angular_gemnet__graph_kernel
  .amdhsa_next_free_vgpr 60
  .amdhsa_next_free_sgpr 80
  .amdhsa_accum_offset 60
  .amdhsa_group_segment_fixed_size 0
  .amdhsa_kernarg_size 112
  .amdhsa_user_sgpr_count 2
  .amdhsa_user_sgpr_kernarg_segment_ptr 1
  .amdhsa_system_sgpr_workgroup_id_x 1
  .amdhsa_float_denorm_mode_32 3
.end_amdhsa_kernel
```

```asm
; @launch kernel=g1_kernel grid=(256,1,1) block=(1024,1,1) lds=163840
; @launch kernel=g2_kernel grid=(256,1,1) block=(1024,1,1) lds=163840
; @launch kernel=standalone__molecular_angular_gemnet__graph_kernel grid=(1600,1,1) block=(256,1,1) lds=0
.amdgcn_target "amdgcn-amd-amdhsa--gfx950"
.text
.globl g1_kernel
.p2align 8
.type g1_kernel,@function
g1_kernel:
    s_cmp_ge_u32 s2, 256
    s_cbranch_scc1 L_p1done_1
    s_load_dwordx4 s[80:83], s[0:1], 8
    s_load_dwordx2 s[84:85], s[0:1], 32
    s_load_dwordx2 s[86:87], s[0:1], 48
    s_load_dwordx4 s[4:7], s[0:1], 96
    s_load_dwordx2 s[78:79], s[0:1], 0
    v_lshlrev_b32 v1, 4, v0
    v_lshlrev_b32 v2, 3, v0
    v_lshlrev_b32 v98, 20, v0
    s_waitcnt lgkmcnt(0)
    s_load_dword s88, s[86:87], 0

    s_mov_b32 s96, s4
    s_mov_b32 s97, s5
    s_mov_b32 s98, 256
    s_mov_b32 s99, 0x20000
    v_readfirstlane_b32 s74, v0
    s_nop 1
    s_or_b32 s74, s74, s2
    s_cbranch_scc1 L_noinit_2

    v_mov_b32 v110, 1
    buffer_atomic_add v110, v98, s[96:99], 0 offen offset:64 sc0
    s_waitcnt vmcnt(0)
    v_readfirstlane_b32 s74, v110
    s_nop 1
    s_cmp_lg_u32 s74, 0
    s_cbranch_scc1 L_zno_4

    s_mov_b32 s92, s6
    s_mov_b32 s93, s7
    s_mov_b32 s94, 65552
    s_mov_b32 s95, 0x20000
    v_mov_b32 v110, 0
    v_mov_b32 v111, 0
    v_mov_b32 v112, 0
    v_mov_b32 v113, 0
L_zl_3:
    buffer_store_dwordx4 v[110:113], v1, s[92:95], s74 offen sc0 sc1
    s_add_u32 s74, s74, 1024
    s_cmp_le_u32 s74, 65536
    s_cbranch_scc1 L_zl_3
    v_mov_b32 v114, 1
    s_waitcnt vmcnt(0)
    buffer_atomic_add v114, v98, s[96:99], 0 offen offset:128
L_zno_4:

L_noinit_2:
    s_mov_b32 s20, s78
    s_mov_b32 s21, s79
    s_mov_b32 s22, 6400000
    s_mov_b32 s23, 0x20000
    v_mul_u32_u24 v110, 6240, v0
    v_and_b32 v111, 63, v0
    v_and_b32 v112, 0x3c0, v0
    v_lshlrev_b32 v111, 2, v111
    v_lshl_or_b32 v111, v112, 4, v111
    v_lshlrev_b32 v100, 2, v0
    s_lshr_b32 s50, s2, 1
    s_and_b32 s53, s2, 1
    s_mul_i32 s3, s50, 50000
    s_mul_i32 s54, s53, 24576
    s_add_u32 s3, s3, s54

    buffer_load_dwordx4 v[56:59], v110, s[20:23], 0 offen
    s_add_u32 s20, s78, s3
    s_addc_u32 s21, s79, 0
    s_mov_b32 s22, 24576
    s_mov_b32 s23, 0x20000
    s_movk_i32 s3, 16384
    buffer_load_dword v44, v111, s[20:23], 0 offen offset:0
    buffer_load_dword v45, v111, s[20:23], 0 offen offset:256
    buffer_load_dword v46, v111, s[20:23], 0 offen offset:512
    buffer_load_dword v47, v111, s[20:23], 0 offen offset:768
    buffer_load_dword v48, v111, s[20:23], s3 offen offset:0
    buffer_load_dword v49, v111, s[20:23], s3 offen offset:256
    buffer_load_dword v50, v111, s[20:23], s3 offen offset:512
    buffer_load_dword v51, v111, s[20:23], s3 offen offset:768
    s_mul_i32 s22, s53, 25424
    s_movk_i32 s3, 24576

    buffer_load_dword v52, v100, s[20:23], s3 offen
    s_mul_i32 s3, s50, 50048
    s_add_u32 s3, s3, s54
    s_add_u32 s54, s3, 393216

    s_mov_b32 s8, s80
    s_mov_b32 s9, s81
    s_mov_b32 s10, 0
    s_mov_b32 s11, 0x20000
    s_mov_b32 s12, s82
    s_mov_b32 s13, s83
    s_mov_b32 s14, 0
    s_mov_b32 s15, 0x20000
    s_mov_b32 s16, s84
    s_mov_b32 s17, s85
    s_mov_b32 s18, 0
    s_mov_b32 s19, 0x20000
    s_lshr_b32 s74, s2, 1
    s_and_b32 s74, s74, 28
    s_lshr_b32 s86, 0x00102010, s74
    s_lshr_b32 s87, 0x44414241, s74
    s_lshr_b32 s41, 0x43221100, s74
    s_and_b32 s86, s86, 15
    s_and_b32 s87, s87, 15
    s_and_b32 s41, s41, 15
    s_lshr_b32 s74, s2, 6
    s_lshl_b32 s74, s74, 3
    s_and_b32 s75, s2, 7
    s_add_u32 s74, s74, s75
    s_mul_i32 s74, s74, 5
    s_add_u32 s41, s41, s74

    s_mul_i32 s78, s41, 16000
    s_add_u32 s49, s78, 16000
    s_cmp_ge_u32 s41, 3200
    s_cmovk_i32 s49, 0
    s_cmovk_i32 s78, 0
    s_lshl_b32 s10, s49, 2
    s_lshl_b32 s14, s49, 2
    s_lshl_b32 s18, s49, 1
    s_sub_u32 s79, s87, s86
    s_bfm_b32 s85, s79, s86
    s_lshl_b32 s86, s86, 12
    s_lshl_b32 s87, s87, 12
    s_min_u32 s87, s87, 16000

    s_add_u32 s79, s78, 0
    s_bitcmp1_b32 s85, 0
    s_cselect_b32 s79, s79, 0x1ff00000
    s_lshl_b32 s56, s79, 2
    s_lshl_b32 s61, s79, 1

    s_add_u32 s79, s78, 4096
    s_bitcmp1_b32 s85, 1
    s_cselect_b32 s79, s79, 0x1ff00000
    s_lshl_b32 s57, s79, 2
    s_lshl_b32 s62, s79, 1

    s_add_u32 s79, s78, 8192
    s_bitcmp1_b32 s85, 2
    s_cselect_b32 s79, s79, 0x1ff00000
    s_lshl_b32 s58, s79, 2
    s_lshl_b32 s63, s79, 1

    s_add_u32 s79, s78, 12288
    s_bitcmp1_b32 s85, 3
    s_cselect_b32 s79, s79, 0x1ff00000
    s_lshl_b32 s59, s79, 2
    s_lshl_b32 s64, s79, 1

    buffer_load_dwordx4 v[20:23], v1, s[12:15], s56 offen nt
    buffer_load_dwordx4 v[4:7], v1, s[8:11], s56 offen nt
    buffer_load_dwordx2 v[36:37], v2, s[16:19], s61 offen nt
    buffer_load_dwordx4 v[24:27], v1, s[12:15], s57 offen nt
    buffer_load_dwordx4 v[8:11], v1, s[8:11], s57 offen nt
    buffer_load_dwordx2 v[38:39], v2, s[16:19], s62 offen nt
    buffer_load_dwordx4 v[28:31], v1, s[12:15], s58 offen nt
    buffer_load_dwordx4 v[12:15], v1, s[8:11], s58 offen nt
    buffer_load_dwordx2 v[40:41], v2, s[16:19], s63 offen nt
    buffer_load_dwordx4 v[32:35], v1, s[12:15], s59 offen nt
    buffer_load_dwordx4 v[16:19], v1, s[8:11], s59 offen nt
    buffer_load_dwordx2 v[42:43], v2, s[16:19], s64 offen nt
    s_and_b32 s5, s2, 7
    s_mul_i32 s3, s5, 8192

    s_add_u32 s20, s6, s3
    s_addc_u32 s21, s7, 0
    s_mov_b32 s22, 8192
    s_mov_b32 s23, 0x20000
    s_mul_i32 s3, s5, 40632320
    s_add_u32 s3, s3, 83599360
    s_add_u32 s24, s6, s3
    s_addc_u32 s25, s7, 0
    s_mov_b32 s26, 40632320
    s_mov_b32 s27, 0x20000
    s_add_u32 s32, s6, 408657920
    s_addc_u32 s33, s7, 0
    s_mov_b32 s34, 409600000
    s_mov_b32 s35, 0x20000
    s_add_u32 s36, s6, 65536
    s_addc_u32 s37, s7, 0
    s_mov_b32 s38, 4
    s_mov_b32 s39, 0x20000
    s_mov_b32 s40, 687195
    s_mov_b32 s42, -6250
    s_mov_b32 s43, 1942
    s_mov_b32 s45, 0x06050400
    s_mov_b32 s46, 0x05040c00
    s_mov_b32 s47, 0x04020100
    s_mov_b32 s48, 3968
    s_mov_b32 s50, 0
    v_mov_b32 v104, 1
    v_mov_b32 v105, 0x46ff8000
    s_mov_b32 s55, 0x05040100
    v_mul_u32_u24 v106, 5, v0
    v_mov_b32 v108, 16384
    v_mov_b32 v114, 0
    v_mov_b32 v115, 0
    v_mov_b32 v116, 0
    v_mov_b32 v117, -1
    ds_write_b64 v2, v[114:115]
    s_movk_i32 s3, 928
    v_cmp_gt_u32 s[66:67], s3, v0
    s_movk_i32 s3, 640
    v_cmp_gt_u32 s[68:69], s3, v0
    s_mov_b64 exec, 1
    ds_write_b128 v108, v[114:117]
    s_mov_b64 exec, -1
    s_waitcnt lgkmcnt(0)
    s_lshl_b32 s88, s88, 16
    v_mov_b32 v110, 0.15915494
    v_mul_f32 v110, s88, v110
    s_mov_b32 s3, 0x7fff7fff
    v_readfirstlane_b32 s44, v110

    s_waitcnt vmcnt(12)
    v_mov_b32 v61, 0
    v_mov_b32 v62, 0
    v_mov_b32 v63, 0
    v_dot2_f32_bf16 v61, v44, v44, v61
    v_dot2_f32_bf16 v61, v45, v45, v61
    v_dot2_f32_bf16 v61, v46, v46, v61
    v_dot2_f32_bf16 v61, v47, v47, v61
    v_dot2_f32_bf16 v61, v48, v48, v61
    v_dot2_f32_bf16 v61, v49, v49, v61
    v_dot2_f32_bf16 v61, v50, v50, v61
    v_dot2_f32_bf16 v61, v51, v51, v61
    v_dot2_f32_bf16 v61, v52, v52, v61
    v_dot2_f32_bf16 v62, v56, v56, v62
    v_dot2_f32_bf16 v62, v57, v57, v62
    v_dot2_f32_bf16 v62, v58, v58, v62
    v_dot2_f32_bf16 v62, v59, v59, v62
    v_and_b32 v60, s3, v44
    v_and_b32 v64, s3, v45
    v_pk_max_u16 v60, v60, v64
    v_and_b32 v64, s3, v46
    v_pk_max_u16 v60, v60, v64
    v_and_b32 v64, s3, v47
    v_pk_max_u16 v60, v60, v64
    v_and_b32 v64, s3, v48
    v_pk_max_u16 v60, v60, v64
    v_and_b32 v64, s3, v49
    v_pk_max_u16 v60, v60, v64
    v_and_b32 v64, s3, v50
    v_pk_max_u16 v60, v60, v64
    v_and_b32 v64, s3, v51
    v_pk_max_u16 v60, v60, v64
    v_and_b32 v64, s3, v52
    v_pk_max_u16 v60, v60, v64
    v_lshrrev_b32 v64, 16, v60
    v_and_b32 v60, 0xffff, v60
    v_max_u32 v60, v60, v64

    s_nop 1
    v_max_u32_dpp v60, v60, v60 row_shr:1 row_mask:0xf bank_mask:0xf
    s_nop 1
    v_max_u32_dpp v60, v60, v60 row_shr:2 row_mask:0xf bank_mask:0xf
    s_nop 1
    v_max_u32_dpp v60, v60, v60 row_shr:4 row_mask:0xf bank_mask:0xf
    s_nop 1
    v_max_u32_dpp v60, v60, v60 row_shr:8 row_mask:0xf bank_mask:0xf
    s_nop 1
    v_max_u32_dpp v60, v60, v60 row_bcast:15 row_mask:0xa bank_mask:0xf
    s_nop 1
    v_max_u32_dpp v60, v60, v60 row_bcast:31 row_mask:0xc bank_mask:0xf
    s_nop 1
    v_add_f32_dpp v61, v61, v61 row_shr:1 row_mask:0xf bank_mask:0xf
    s_nop 1
    v_add_f32_dpp v61, v61, v61 row_shr:2 row_mask:0xf bank_mask:0xf
    s_nop 1
    v_add_f32_dpp v61, v61, v61 row_shr:4 row_mask:0xf bank_mask:0xf
    s_nop 1
    v_add_f32_dpp v61, v61, v61 row_shr:8 row_mask:0xf bank_mask:0xf
    s_nop 1
    v_add_f32_dpp v61, v61, v61 row_bcast:15 row_mask:0xa bank_mask:0xf
    s_nop 1
    v_add_f32_dpp v61, v61, v61 row_bcast:31 row_mask:0xc bank_mask:0xf
    s_nop 1
    v_add_f32_dpp v62, v62, v62 row_shr:1 row_mask:0xf bank_mask:0xf
    s_nop 1
    v_add_f32_dpp v62, v62, v62 row_shr:2 row_mask:0xf bank_mask:0xf
    s_nop 1
    v_add_f32_dpp v62, v62, v62 row_shr:4 row_mask:0xf bank_mask:0xf
    s_nop 1
    v_add_f32_dpp v62, v62, v62 row_shr:8 row_mask:0xf bank_mask:0xf
    s_nop 1
    v_add_f32_dpp v62, v62, v62 row_bcast:15 row_mask:0xa bank_mask:0xf
    s_nop 1
    v_add_f32_dpp v62, v62, v62 row_bcast:31 row_mask:0xc bank_mask:0xf
    v_lshrrev_b32 v64, 6, v0
    v_lshlrev_b32 v64, 4, v64
    s_mov_b32 exec_lo, 0
    s_brev_b32 exec_hi, 1
    ds_write_b128 v64, v[60:63] offset:8192
    s_mov_b64 exec, -1
    v_and_b32 v64, 15, v0
    v_lshlrev_b32 v64, 4, v64
    s_waitcnt lgkmcnt(0)
    s_barrier
    ds_read_b128 v[60:63], v64 offset:8192
    s_waitcnt lgkmcnt(0)

    s_nop 0
    v_max_u32_dpp v60, v60, v60 row_ror:1 row_mask:0xf bank_mask:0xf
    v_add_f32_dpp v61, v61, v61 row_ror:1 row_mask:0xf bank_mask:0xf
    v_add_f32_dpp v62, v62, v62 row_ror:1 row_mask:0xf bank_mask:0xf

    s_nop 0
    v_max_u32_dpp v60, v60, v60 row_ror:2 row_mask:0xf bank_mask:0xf
    v_add_f32_dpp v61, v61, v61 row_ror:2 row_mask:0xf bank_mask:0xf
    v_add_f32_dpp v62, v62, v62 row_ror:2 row_mask:0xf bank_mask:0xf

    s_nop 0
    v_max_u32_dpp v60, v60, v60 row_ror:4 row_mask:0xf bank_mask:0xf
    v_add_f32_dpp v61, v61, v61 row_ror:4 row_mask:0xf bank_mask:0xf
    v_add_f32_dpp v62, v62, v62 row_ror:4 row_mask:0xf bank_mask:0xf

    s_nop 0
    v_max_u32_dpp v60, v60, v60 row_ror:8 row_mask:0xf bank_mask:0xf
    v_add_f32_dpp v61, v61, v61 row_ror:8 row_mask:0xf bank_mask:0xf
    v_add_f32_dpp v62, v62, v62 row_ror:8 row_mask:0xf bank_mask:0xf

    v_rsq_f32 v62, v62
    v_mov_b32 v65, 0x4b400000
    v_mul_f32 v62, 0x4806b64a, v62
    s_nop 0
    v_readfirstlane_b32 s74, v62

    s_add_u32 s92, s6, 135168
    s_addc_u32 s93, s7, 0
    s_mov_b32 s94, 4096
    s_mov_b32 s95, 0x20000
    s_lshl_b32 s3, s2, 4
    buffer_store_dwordx4 v[60:63], v98, s[92:95], s3 offen
    v_lshlrev_b32 v66, 16, v44
    v_and_b32 v44, 0xffff0000, v44
    v_fma_f32 v66, v66, s74, v65
    v_fma_f32 v44, v44, s74, v65
    v_perm_b32 v44, v44, v66, s55

    v_lshlrev_b32 v66, 16, v45
    v_and_b32 v45, 0xffff0000, v45
    v_fma_f32 v66, v66, s74, v65
    v_fma_f32 v45, v45, s74, v65
    v_perm_b32 v45, v45, v66, s55

    v_lshlrev_b32 v66, 16, v46
    v_and_b32 v46, 0xffff0000, v46
    v_fma_f32 v66, v66, s74, v65
    v_fma_f32 v46, v46, s74, v65
    v_perm_b32 v46, v46, v66, s55

    v_lshlrev_b32 v66, 16, v47
    v_and_b32 v47, 0xffff0000, v47
    v_fma_f32 v66, v66, s74, v65
    v_fma_f32 v47, v47, s74, v65
    v_perm_b32 v47, v47, v66, s55

    v_lshlrev_b32 v66, 16, v48
    v_and_b32 v48, 0xffff0000, v48
    v_fma_f32 v66, v66, s74, v65
    v_fma_f32 v48, v48, s74, v65
    v_perm_b32 v48, v48, v66, s55

    v_lshlrev_b32 v66, 16, v49
    v_and_b32 v49, 0xffff0000, v49
    v_fma_f32 v66, v66, s74, v65
    v_fma_f32 v49, v49, s74, v65
    v_perm_b32 v49, v49, v66, s55

    v_lshlrev_b32 v66, 16, v50
    v_and_b32 v50, 0xffff0000, v50
    v_fma_f32 v66, v66, s74, v65
    v_fma_f32 v50, v50, s74, v65
    v_perm_b32 v50, v50, v66, s55

    v_lshlrev_b32 v66, 16, v51
    v_and_b32 v51, 0xffff0000, v51
    v_fma_f32 v66, v66, s74, v65
    v_fma_f32 v51, v51, s74, v65
    v_perm_b32 v51, v51, v66, s55

    v_lshlrev_b32 v66, 16, v52
    v_and_b32 v52, 0xffff0000, v52
    v_fma_f32 v66, v66, s74, v65
    v_fma_f32 v52, v52, s74, v65
    v_perm_b32 v52, v52, v66, s55

    s_add_u32 s92, s6, s54
    s_addc_u32 s93, s7, 0
    s_mov_b32 s94, 24576
    s_mov_b32 s95, 0x20000
    s_movk_i32 s3, 16384
    buffer_store_dwordx4 v[44:47], v1, s[92:95], 0 offen
    buffer_store_dwordx4 v[48:51], v1, s[92:95], s3 offen
    s_mul_i32 s94, s53, 25424
    s_movk_i32 s3, 24576

    buffer_store_dword v52, v100, s[92:95], s3 offen
    s_nop 1
    s_mov_b32 s82, s85
    s_mov_b32 s83, s86
    s_mov_b32 s84, s87
    v_mov_b32 v99, 1
    buffer_atomic_add v99, v98, s[96:99], 0 offen sc0
    v_mov_b32 v100, 0
    buffer_atomic_add v100, v98, s[96:99], 0 offen offset:128 sc0
    s_waitcnt vmcnt(15)
    s_bitcmp0_b32 s82, 0
    s_cbranch_scc1 L_ska_7
    v_mul_hi_u32_u24 v45, s40, v20
    v_mul_hi_u32_u24 v44, s40, v4
    v_mul_hi_u32_u24 v47, s40, v21
    v_mul_hi_u32_u24 v46, s40, v5
    v_mul_hi_u32_u24 v49, s40, v22
    v_mul_hi_u32_u24 v48, s40, v6
    v_mul_hi_u32_u24 v51, s40, v23
    v_mul_hi_u32_u24 v50, s40, v7
    v_and_b32 v45, -2, v45
    v_mad_u32_u24 v4, v44, s43, v4
    v_and_b32 v76, -4, v44
    v_and_b32 v47, -2, v47
    v_mad_u32_u24 v5, v46, s43, v5
    v_and_b32 v77, -4, v46
    v_and_b32 v49, -2, v49
    v_mad_u32_u24 v6, v48, s43, v6
    v_and_b32 v78, -4, v48
    v_and_b32 v51, -2, v51
    v_mad_u32_u24 v7, v50, s43, v7
    v_and_b32 v79, -4, v50
    v_mad_i32_i24 v20, v45, s42, v20
    v_lshl_add_u32 v45, v76, 5, v45
    v_mad_i32_i24 v21, v47, s42, v21
    v_lshl_add_u32 v47, v77, 5, v47
    v_mad_i32_i24 v22, v49, s42, v22
    v_lshl_add_u32 v49, v78, 5, v49
    v_mad_i32_i24 v23, v51, s42, v23
    v_lshl_add_u32 v51, v79, 5, v51
    v_add_u32 v45, v45, v45
    ds_add_rtn_u32 v76, v45, v104
    v_add_u32 v47, v47, v47
    ds_add_rtn_u32 v77, v47, v104
    v_add_u32 v49, v49, v49
    ds_add_rtn_u32 v78, v49, v104
    v_add_u32 v51, v51, v51
    ds_add_rtn_u32 v79, v51, v104
    v_lshlrev_b32 v110, 16, v36
    v_and_b32 v111, 0xffff0000, v36
    v_lshlrev_b32 v112, 16, v37
    v_and_b32 v113, 0xffff0000, v37
    v_mul_f32 v110, s44, v110
    v_mul_f32 v111, s44, v111
    v_mul_f32 v112, s44, v112
    v_mul_f32 v113, s44, v113
    v_fract_f32 v110, v110
    v_fract_f32 v111, v111
    v_fract_f32 v112, v112
    v_fract_f32 v113, v113
    v_cos_f32 v110, v110
    v_cos_f32 v111, v111
    v_cos_f32 v112, v112
    v_cos_f32 v113, v113
    v_lshl_or_b32 v44, v44, 14, v20
    v_perm_b32 v45, v45, v4, s46
    v_bfe_u32 v4, v4, 8, 5

    v_lshl_or_b32 v46, v46, 14, v21
    v_perm_b32 v47, v47, v5, s46
    v_bfe_u32 v5, v5, 8, 5

    v_lshl_or_b32 v48, v48, 14, v22
    v_perm_b32 v49, v49, v6, s46
    v_bfe_u32 v6, v6, 8, 5

    v_lshl_or_b32 v50, v50, 14, v23
    v_perm_b32 v51, v51, v7, s46
    v_bfe_u32 v7, v7, 8, 5

    v_fmaak_f32 v110, v110, v105, 0x4b400010
    v_fmaak_f32 v111, v111, v105, 0x4b400010
    v_fmaak_f32 v112, v112, v105, 0x4b400010
    v_fmaak_f32 v113, v113, v105, 0x4b400010
    v_sub_u32 v110, v110, v4
    v_sub_u32 v111, v111, v5
    v_sub_u32 v112, v112, v6
    v_sub_u32 v113, v113, v7
    v_bfi_b32 v110, 31, v4, v110
    v_bfi_b32 v111, 31, v5, v111
    v_bfi_b32 v112, 31, v6, v112
    v_bfi_b32 v113, 31, v7, v113
    v_perm_b32 v44, v44, v110, s55
    v_perm_b32 v46, v46, v111, s55
    v_perm_b32 v48, v48, v112, s55
    v_perm_b32 v50, v50, v113, s55
L_ska_7:
    s_waitcnt vmcnt(12)
    s_bitcmp0_b32 s82, 1
    s_cbranch_scc1 L_ska_8
    v_mul_hi_u32_u24 v53, s40, v24
    v_mul_hi_u32_u24 v52, s40, v8
    v_mul_hi_u32_u24 v55, s40, v25
    v_mul_hi_u32_u24 v54, s40, v9
    v_mul_hi_u32_u24 v57, s40, v26
    v_mul_hi_u32_u24 v56, s40, v10
    v_mul_hi_u32_u24 v59, s40, v27
    v_mul_hi_u32_u24 v58, s40, v11
    v_and_b32 v53, -2, v53
    v_mad_u32_u24 v8, v52, s43, v8
    v_and_b32 v80, -4, v52
    v_and_b32 v55, -2, v55
    v_mad_u32_u24 v9, v54, s43, v9
    v_and_b32 v81, -4, v54
    v_and_b32 v57, -2, v57
    v_mad_u32_u24 v10, v56, s43, v10
    v_and_b32 v82, -4, v56
    v_and_b32 v59, -2, v59
    v_mad_u32_u24 v11, v58, s43, v11
    v_and_b32 v83, -4, v58
    v_mad_i32_i24 v24, v53, s42, v24
    v_lshl_add_u32 v53, v80, 5, v53
    v_mad_i32_i24 v25, v55, s42, v25
    v_lshl_add_u32 v55, v81, 5, v55
    v_mad_i32_i24 v26, v57, s42, v26
    v_lshl_add_u32 v57, v82, 5, v57
    v_mad_i32_i24 v27, v59, s42, v27
    v_lshl_add_u32 v59, v83, 5, v59
    v_add_u32 v53, v53, v53
    ds_add_rtn_u32 v80, v53, v104
    v_add_u32 v55, v55, v55
    ds_add_rtn_u32 v81, v55, v104
    v_add_u32 v57, v57, v57
    ds_add_rtn_u32 v82, v57, v104
    v_add_u32 v59, v59, v59
    ds_add_rtn_u32 v83, v59, v104
    v_lshlrev_b32 v110, 16, v38
    v_and_b32 v111, 0xffff0000, v38
    v_lshlrev_b32 v112, 16, v39
    v_and_b32 v113, 0xffff0000, v39
    v_mul_f32 v110, s44, v110
    v_mul_f32 v111, s44, v111
    v_mul_f32 v112, s44, v112
    v_mul_f32 v113, s44, v113
    v_fract_f32 v110, v110
    v_fract_f32 v111, v111
    v_fract_f32 v112, v112
    v_fract_f32 v113, v113
    v_cos_f32 v110, v110
    v_cos_f32 v111, v111
    v_cos_f32 v112, v112
    v_cos_f32 v113, v113
    v_lshl_or_b32 v52, v52, 14, v24
    v_perm_b32 v53, v53, v8, s46
    v_bfe_u32 v8, v8, 8, 5

    v_lshl_or_b32 v54, v54, 14, v25
    v_perm_b32 v55, v55, v9, s46
    v_bfe_u32 v9, v9, 8, 5

    v_lshl_or_b32 v56, v56, 14, v26
    v_perm_b32 v57, v57, v10, s46
    v_bfe_u32 v10, v10, 8, 5

    v_lshl_or_b32 v58, v58, 14, v27
    v_perm_b32 v59, v59, v11, s46
    v_bfe_u32 v11, v11, 8, 5

    v_fmaak_f32 v110, v110, v105, 0x4b400010
    v_fmaak_f32 v111, v111, v105, 0x4b400010
    v_fmaak_f32 v112, v112, v105, 0x4b400010
    v_fmaak_f32 v113, v113, v105, 0x4b400010
    v_sub_u32 v110, v110, v8
    v_sub_u32 v111, v111, v9
    v_sub_u32 v112, v112, v10
    v_sub_u32 v113, v113, v11
    v_bfi_b32 v110, 31, v8, v110
    v_bfi_b32 v111, 31, v9, v111
    v_bfi_b32 v112, 31, v10, v112
    v_bfi_b32 v113, 31, v11, v113
    v_perm_b32 v52, v52, v110, s55
    v_perm_b32 v54, v54, v111, s55
    v_perm_b32 v56, v56, v112, s55
    v_perm_b32 v58, v58, v113, s55
L_ska_8:
    s_waitcnt vmcnt(9)
    s_bitcmp0_b32 s82, 2
    s_cbranch_scc1 L_ska_9
    v_mul_hi_u32_u24 v61, s40, v28
    v_mul_hi_u32_u24 v60, s40, v12
    v_mul_hi_u32_u24 v63, s40, v29
    v_mul_hi_u32_u24 v62, s40, v13
    v_mul_hi_u32_u24 v65, s40, v30
    v_mul_hi_u32_u24 v64, s40, v14
    v_mul_hi_u32_u24 v67, s40, v31
    v_mul_hi_u32_u24 v66, s40, v15
    v_and_b32 v61, -2, v61
    v_mad_u32_u24 v12, v60, s43, v12
    v_and_b32 v84, -4, v60
    v_and_b32 v63, -2, v63
    v_mad_u32_u24 v13, v62, s43, v13
    v_and_b32 v85, -4, v62
    v_and_b32 v65, -2, v65
    v_mad_u32_u24 v14, v64, s43, v14
    v_and_b32 v86, -4, v64
    v_and_b32 v67, -2, v67
    v_mad_u32_u24 v15, v66, s43, v15
    v_and_b32 v87, -4, v66
    v_mad_i32_i24 v28, v61, s42, v28
    v_lshl_add_u32 v61, v84, 5, v61
    v_mad_i32_i24 v29, v63, s42, v29
    v_lshl_add_u32 v63, v85, 5, v63
    v_mad_i32_i24 v30, v65, s42, v30
    v_lshl_add_u32 v65, v86, 5, v65
    v_mad_i32_i24 v31, v67, s42, v31
    v_lshl_add_u32 v67, v87, 5, v67
    v_add_u32 v61, v61, v61
    ds_add_rtn_u32 v84, v61, v104
    v_add_u32 v63, v63, v63
    ds_add_rtn_u32 v85, v63, v104
    v_add_u32 v65, v65, v65
    ds_add_rtn_u32 v86, v65, v104
    v_add_u32 v67, v67, v67
    ds_add_rtn_u32 v87, v67, v104
    v_lshlrev_b32 v110, 16, v40
    v_and_b32 v111, 0xffff0000, v40
    v_lshlrev_b32 v112, 16, v41
    v_and_b32 v113, 0xffff0000, v41
    v_mul_f32 v110, s44, v110
    v_mul_f32 v111, s44, v111
    v_mul_f32 v112, s44, v112
    v_mul_f32 v113, s44, v113
    v_fract_f32 v110, v110
    v_fract_f32 v111, v111
    v_fract_f32 v112, v112
    v_fract_f32 v113, v113
    v_cos_f32 v110, v110
    v_cos_f32 v111, v111
    v_cos_f32 v112, v112
    v_cos_f32 v113, v113
    v_lshl_or_b32 v60, v60, 14, v28
    v_perm_b32 v61, v61, v12, s46
    v_bfe_u32 v12, v12, 8, 5

    v_lshl_or_b32 v62, v62, 14, v29
    v_perm_b32 v63, v63, v13, s46
    v_bfe_u32 v13, v13, 8, 5

    v_lshl_or_b32 v64, v64, 14, v30
    v_perm_b32 v65, v65, v14, s46
    v_bfe_u32 v14, v14, 8, 5

    v_lshl_or_b32 v66, v66, 14, v31
    v_perm_b32 v67, v67, v15, s46
    v_bfe_u32 v15, v15, 8, 5

    v_fmaak_f32 v110, v110, v105, 0x4b400010
    v_fmaak_f32 v111, v111, v105, 0x4b400010
    v_fmaak_f32 v112, v112, v105, 0x4b400010
    v_fmaak_f32 v113, v113, v105, 0x4b400010
    v_sub_u32 v110, v110, v12
    v_sub_u32 v111, v111, v13
    v_sub_u32 v112, v112, v14
    v_sub_u32 v113, v113, v15
    v_bfi_b32 v110, 31, v12, v110
    v_bfi_b32 v111, 31, v13, v111
    v_bfi_b32 v112, 31, v14, v112
    v_bfi_b32 v113, 31, v15, v113
    v_perm_b32 v60, v60, v110, s55
    v_perm_b32 v62, v62, v111, s55
    v_perm_b32 v64, v64, v112, s55
    v_perm_b32 v66, v66, v113, s55
L_ska_9:
    s_waitcnt vmcnt(6)
    s_bitcmp0_b32 s82, 3
    s_cbranch_scc1 L_ska_10
    s_mov_b64 exec, s[66:67]
    v_mul_hi_u32_u24 v69, s40, v32
    v_mul_hi_u32_u24 v68, s40, v16
    v_mul_hi_u32_u24 v71, s40, v33
    v_mul_hi_u32_u24 v70, s40, v17
    v_mul_hi_u32_u24 v73, s40, v34
    v_mul_hi_u32_u24 v72, s40, v18
    v_mul_hi_u32_u24 v75, s40, v35
    v_mul_hi_u32_u24 v74, s40, v19
    v_and_b32 v69, -2, v69
    v_mad_u32_u24 v16, v68, s43, v16
    v_and_b32 v88, -4, v68
    v_and_b32 v71, -2, v71
    v_mad_u32_u24 v17, v70, s43, v17
    v_and_b32 v89, -4, v70
    v_and_b32 v73, -2, v73
    v_mad_u32_u24 v18, v72, s43, v18
    v_and_b32 v90, -4, v72
    v_and_b32 v75, -2, v75
    v_mad_u32_u24 v19, v74, s43, v19
    v_and_b32 v91, -4, v74
    v_mad_i32_i24 v32, v69, s42, v32
    v_lshl_add_u32 v69, v88, 5, v69
    v_mad_i32_i24 v33, v71, s42, v33
    v_lshl_add_u32 v71, v89, 5, v71
    v_mad_i32_i24 v34, v73, s42, v34
    v_lshl_add_u32 v73, v90, 5, v73
    v_mad_i32_i24 v35, v75, s42, v35
    v_lshl_add_u32 v75, v91, 5, v75
    v_add_u32 v69, v69, v69
    ds_add_rtn_u32 v88, v69, v104
    v_add_u32 v71, v71, v71
    ds_add_rtn_u32 v89, v71, v104
    v_add_u32 v73, v73, v73
    ds_add_rtn_u32 v90, v73, v104
    v_add_u32 v75, v75, v75
    ds_add_rtn_u32 v91, v75, v104
    v_lshlrev_b32 v110, 16, v42
    v_and_b32 v111, 0xffff0000, v42
    v_lshlrev_b32 v112, 16, v43
    v_and_b32 v113, 0xffff0000, v43
    v_mul_f32 v110, s44, v110
    v_mul_f32 v111, s44, v111
    v_mul_f32 v112, s44, v112
    v_mul_f32 v113, s44, v113
    v_fract_f32 v110, v110
    v_fract_f32 v111, v111
    v_fract_f32 v112, v112
    v_fract_f32 v113, v113
    v_cos_f32 v110, v110
    v_cos_f32 v111, v111
    v_cos_f32 v112, v112
    v_cos_f32 v113, v113
    v_lshl_or_b32 v68, v68, 14, v32
    v_perm_b32 v69, v69, v16, s46
    v_bfe_u32 v16, v16, 8, 5

    v_lshl_or_b32 v70, v70, 14, v33
    v_perm_b32 v71, v71, v17, s46
    v_bfe_u32 v17, v17, 8, 5

    v_lshl_or_b32 v72, v72, 14, v34
    v_perm_b32 v73, v73, v18, s46
    v_bfe_u32 v18, v18, 8, 5

    v_lshl_or_b32 v74, v74, 14, v35
    v_perm_b32 v75, v75, v19, s46
    v_bfe_u32 v19, v19, 8, 5

    v_fmaak_f32 v110, v110, v105, 0x4b400010
    v_fmaak_f32 v111, v111, v105, 0x4b400010
    v_fmaak_f32 v112, v112, v105, 0x4b400010
    v_fmaak_f32 v113, v113, v105, 0x4b400010
    v_sub_u32 v110, v110, v16
    v_sub_u32 v111, v111, v17
    v_sub_u32 v112, v112, v18
    v_sub_u32 v113, v113, v19
    v_bfi_b32 v110, 31, v16, v110
    v_bfi_b32 v111, 31, v17, v111
    v_bfi_b32 v112, 31, v18, v112
    v_bfi_b32 v113, 31, v19, v113
    v_perm_b32 v68, v68, v110, s55
    v_perm_b32 v70, v70, v111, s55
    v_perm_b32 v72, v72, v112, s55
    v_perm_b32 v74, v74, v113, s55
    s_mov_b64 exec, -1
L_ska_10:
    s_waitcnt vmcnt(0)
    v_or_b32 v100, v100, v0
    s_nop 0
    v_readfirstlane_b32 s74, v100
    s_nop 1
    s_cmp_lg_u32 s74, 0
    s_cbranch_scc1 L_ready_12

    v_mov_b32 v110, 1
    buffer_atomic_add v110, v98, s[96:99], 0 offen offset:64 sc0
    s_waitcnt vmcnt(0)
    v_readfirstlane_b32 s74, v110
    s_nop 1
    s_cmp_lg_u32 s74, 0
    s_cbranch_scc1 L_zno_14

    s_mov_b32 s92, s6
    s_mov_b32 s93, s7
    s_mov_b32 s94, 65552
    s_mov_b32 s95, 0x20000
    v_mov_b32 v110, 0
    v_mov_b32 v111, 0
    v_mov_b32 v112, 0
    v_mov_b32 v113, 0
L_zl_13:
    buffer_store_dwordx4 v[110:113], v1, s[92:95], s74 offen sc0 sc1
    s_add_u32 s74, s74, 1024
    s_cmp_le_u32 s74, 65536
    s_cbranch_scc1 L_zl_13
    v_mov_b32 v114, 1
    s_waitcnt vmcnt(0)
    buffer_atomic_add v114, v98, s[96:99], 0 offen offset:128
L_zno_14:

L_spin_11:
    v_mov_b32 v100, 0
    buffer_atomic_add v100, v98, s[96:99], 0 offen offset:128 sc0
    s_waitcnt vmcnt(0)
    v_readfirstlane_b32 s74, v100
    s_nop 1
    s_cmp_eq_u32 s74, 0
    s_cbranch_scc1 L_spin_11
L_ready_12:

    v_cmp_eq_u32 vcc, 0, v0
    s_waitcnt vmcnt(1)
    s_mov_b64 exec, vcc
    ds_write_b32 v108, v99 offset:8
    s_mov_b64 exec, -1
    s_waitcnt lgkmcnt(0)
    s_barrier

    ds_read2_b32 v[110:111], v108 offset0:1 offset1:2
    ds_read_b64 v[94:95], v2
    s_waitcnt lgkmcnt(0)
    v_readfirstlane_b32 s53, v110
    v_readfirstlane_b32 s41, v111

    v_and_b32 v94, 0xffff, v94
    v_and_b32 v95, 0xffff, v95
    v_add_u32 v97, v94, v95
    s_nop 1
    v_add_u32_dpp v97, v97, v97 row_shr:1 row_mask:0xf bank_mask:0xf
    s_nop 1
    v_add_u32_dpp v97, v97, v97 row_shr:2 row_mask:0xf bank_mask:0xf
    s_nop 1
    v_add_u32_dpp v97, v97, v97 row_shr:4 row_mask:0xf bank_mask:0xf
    s_nop 1
    v_add_u32_dpp v97, v97, v97 row_shr:8 row_mask:0xf bank_mask:0xf
    s_nop 1
    v_add_u32_dpp v97, v97, v97 row_bcast:15 row_mask:0xa bank_mask:0xf
    s_nop 1
    v_add_u32_dpp v97, v97, v97 row_bcast:31 row_mask:0xc bank_mask:0xf
    s_mov_b32 exec_lo, 0
    s_brev_b32 exec_hi, 1
    ds_add_rtn_u32 v96, v108, v97
    s_mov_b64 exec, -1

    v_add_u32 v92, v94, v94
    v_add_u32 v93, v95, v95
    v_med3_u32 v92, v94, 2, v92
    v_med3_u32 v93, v95, 2, v93
    buffer_atomic_add_x2 v[92:93], v2, s[20:23], 0 offen sc0
    s_add_u32 s41, s41, 160
    s_sub_u32 s78, s41, 3008
    s_lshr_b32 s79, s78, 1
    s_add_u32 s79, s79, 3008
    s_and_b32 s86, s78, 1
    s_lshl_b32 s86, s86, 1
    s_add_u32 s87, s86, 2
    s_cmp_lt_u32 s41, 3008
    s_cselect_b32 s41, s41, s79
    s_cmovk_i32 s86, 0
    s_cmovk_i32 s87, 4

    s_mul_i32 s78, s41, 16000
    s_add_u32 s49, s78, 16000
    s_cmp_ge_u32 s41, 3200
    s_cmovk_i32 s49, 0
    s_cmovk_i32 s78, 0
    s_lshl_b32 s10, s49, 2
    s_lshl_b32 s14, s49, 2
    s_lshl_b32 s18, s49, 1
    s_sub_u32 s79, s87, s86
    s_bfm_b32 s85, s79, s86
    s_lshl_b32 s86, s86, 12
    s_lshl_b32 s87, s87, 12
    s_min_u32 s87, s87, 16000

    s_add_u32 s79, s78, 0
    s_bitcmp1_b32 s85, 0
    s_cselect_b32 s79, s79, 0x1ff00000
    s_lshl_b32 s56, s79, 2
    s_lshl_b32 s61, s79, 1

    s_add_u32 s79, s78, 4096
    s_bitcmp1_b32 s85, 1
    s_cselect_b32 s79, s79, 0x1ff00000
    s_lshl_b32 s57, s79, 2
    s_lshl_b32 s62, s79, 1

    s_add_u32 s79, s78, 8192
    s_bitcmp1_b32 s85, 2
    s_cselect_b32 s79, s79, 0x1ff00000
    s_lshl_b32 s58, s79, 2
    s_lshl_b32 s63, s79, 1

    s_add_u32 s79, s78, 12288
    s_bitcmp1_b32 s85, 3
    s_cselect_b32 s79, s79, 0x1ff00000
    s_lshl_b32 s59, s79, 2
    s_lshl_b32 s64, s79, 1

    s_waitcnt lgkmcnt(0)
    v_readlane_b32 s77, v96, 63
    v_mul_u32_u24 v114, 7936, v0
    v_sub_u32 v97, v97, v95
    s_sub_u32 s50, s50, s83
    s_sub_u32 s77, s77, s50
    v_add_u32 v97, s77, v97
    v_sub_u32 v96, v97, v94
    v_lshlrev_b32 v111, 16, v97
    v_lshlrev_b32 v110, 16, v96
    ds_write_b64 v2, v[110:111]
    v_sub_u32 v96, v114, v96
    v_sub_u32 v97, v114, v97
    v_add_u32 v97, s48, v97
    s_add_u32 s50, s50, s84
    s_mov_b32 s28, s82
    s_mov_b32 s29, s83
    s_mov_b32 s30, s84
    s_lshl_b32 s74, s29, 3
    s_lshl_b32 s75, s30, 3
    v_mov_b32 v125, s74
    v_mov_b32 v126, s75
    v_mov_b32 v127, -1

    s_waitcnt lgkmcnt(0)
    s_barrier

    s_mov_b64 exec, 1
    ds_write_b32 v125, v127 offset:16396
    ds_write_b32 v126, v127 offset:16404
    s_mov_b64 exec, -1

    buffer_load_dwordx4 v[20:23], v1, s[12:15], s56 offen nt
    buffer_load_dwordx4 v[4:7], v1, s[8:11], s56 offen nt
    buffer_load_dwordx2 v[36:37], v2, s[16:19], s61 offen nt
    s_bitcmp0_b32 s28, 0
    s_cbranch_scc1 L_skz_15
    v_lshrrev_b32 v110, 16, v45
    ds_read_b32 v110, v110
    v_lshrrev_b32 v111, 16, v47
    ds_read_b32 v111, v111
    v_lshrrev_b32 v112, 16, v49
    ds_read_b32 v112, v112
    v_lshrrev_b32 v113, 16, v51
    ds_read_b32 v113, v113
    s_waitcnt lgkmcnt(3)
    v_add_u32_sdwa v110, v110, v76 dst_sel:DWORD dst_unused:UNUSED_PAD src0_sel:WORD_1 src1_sel:WORD_0
    v_lshlrev_b32 v110, 3, v110
    ds_write_b64 v110, v[44:45] offset:16400

    s_waitcnt lgkmcnt(3)
    v_add_u32_sdwa v111, v111, v77 dst_sel:DWORD dst_unused:UNUSED_PAD src0_sel:WORD_1 src1_sel:WORD_0
    v_lshlrev_b32 v111, 3, v111
    ds_write_b64 v111, v[46:47] offset:16400

    s_waitcnt lgkmcnt(3)
    v_add_u32_sdwa v112, v112, v78 dst_sel:DWORD dst_unused:UNUSED_PAD src0_sel:WORD_1 src1_sel:WORD_0
    v_lshlrev_b32 v112, 3, v112
    ds_write_b64 v112, v[48:49] offset:16400

    s_waitcnt lgkmcnt(3)
    v_add_u32_sdwa v113, v113, v79 dst_sel:DWORD dst_unused:UNUSED_PAD src0_sel:WORD_1 src1_sel:WORD_0
    v_lshlrev_b32 v113, 3, v113
    ds_write_b64 v113, v[50:51] offset:16400

L_skz_15:
    s_bitcmp0_b32 s28, 1
    s_cbranch_scc1 L_skz_16
    v_lshrrev_b32 v110, 16, v53
    ds_read_b32 v110, v110
    v_lshrrev_b32 v111, 16, v55
    ds_read_b32 v111, v111
    v_lshrrev_b32 v112, 16, v57
    ds_read_b32 v112, v112
    v_lshrrev_b32 v113, 16, v59
    ds_read_b32 v113, v113
    s_waitcnt lgkmcnt(3)
    v_add_u32_sdwa v110, v110, v80 dst_sel:DWORD dst_unused:UNUSED_PAD src0_sel:WORD_1 src1_sel:WORD_0
    v_lshlrev_b32 v110, 3, v110
    ds_write_b64 v110, v[52:53] offset:16400

    s_waitcnt lgkmcnt(3)
    v_add_u32_sdwa v111, v111, v81 dst_sel:DWORD dst_unused:UNUSED_PAD src0_sel:WORD_1 src1_sel:WORD_0
    v_lshlrev_b32 v111, 3, v111
    ds_write_b64 v111, v[54:55] offset:16400

    s_waitcnt lgkmcnt(3)
    v_add_u32_sdwa v112, v112, v82 dst_sel:DWORD dst_unused:UNUSED_PAD src0_sel:WORD_1 src1_sel:WORD_0
    v_lshlrev_b32 v112, 3, v112
    ds_write_b64 v112, v[56:57] offset:16400

    s_waitcnt lgkmcnt(3)
    v_add_u32_sdwa v113, v113, v83 dst_sel:DWORD dst_unused:UNUSED_PAD src0_sel:WORD_1 src1_sel:WORD_0
    v_lshlrev_b32 v113, 3, v113
    ds_write_b64 v113, v[58:59] offset:16400

L_skz_16:
    buffer_load_dwordx4 v[24:27], v1, s[12:15], s57 offen nt
    buffer_load_dwordx4 v[8:11], v1, s[8:11], s57 offen nt
    buffer_load_dwordx2 v[38:39], v2, s[16:19], s62 offen nt
    s_bitcmp0_b32 s28, 2
    s_cbranch_scc1 L_skz_17
    v_lshrrev_b32 v110, 16, v61
    ds_read_b32 v110, v110
    v_lshrrev_b32 v111, 16, v63
    ds_read_b32 v111, v111
    v_lshrrev_b32 v112, 16, v65
    ds_read_b32 v112, v112
    v_lshrrev_b32 v113, 16, v67
    ds_read_b32 v113, v113
    s_waitcnt lgkmcnt(3)
    v_add_u32_sdwa v110, v110, v84 dst_sel:DWORD dst_unused:UNUSED_PAD src0_sel:WORD_1 src1_sel:WORD_0
    v_lshlrev_b32 v110, 3, v110
    ds_write_b64 v110, v[60:61] offset:16400

    s_waitcnt lgkmcnt(3)
    v_add_u32_sdwa v111, v111, v85 dst_sel:DWORD dst_unused:UNUSED_PAD src0_sel:WORD_1 src1_sel:WORD_0
    v_lshlrev_b32 v111, 3, v111
    ds_write_b64 v111, v[62:63] offset:16400

    s_waitcnt lgkmcnt(3)
    v_add_u32_sdwa v112, v112, v86 dst_sel:DWORD dst_unused:UNUSED_PAD src0_sel:WORD_1 src1_sel:WORD_0
    v_lshlrev_b32 v112, 3, v112
    ds_write_b64 v112, v[64:65] offset:16400

    s_waitcnt lgkmcnt(3)
    v_add_u32_sdwa v113, v113, v87 dst_sel:DWORD dst_unused:UNUSED_PAD src0_sel:WORD_1 src1_sel:WORD_0
    v_lshlrev_b32 v113, 3, v113
    ds_write_b64 v113, v[66:67] offset:16400

L_skz_17:
    s_bitcmp0_b32 s28, 3
    s_cbranch_scc1 L_skz_18
    s_mov_b64 exec, s[66:67]
    v_lshrrev_b32 v110, 16, v69
    ds_read_b32 v110, v110
    v_lshrrev_b32 v111, 16, v71
    ds_read_b32 v111, v111
    v_lshrrev_b32 v112, 16, v73
    ds_read_b32 v112, v112
    v_lshrrev_b32 v113, 16, v75
    ds_read_b32 v113, v113
    s_waitcnt lgkmcnt(3)
    v_add_u32_sdwa v110, v110, v88 dst_sel:DWORD dst_unused:UNUSED_PAD src0_sel:WORD_1 src1_sel:WORD_0
    v_lshlrev_b32 v110, 3, v110
    ds_write_b64 v110, v[68:69] offset:16400

    s_waitcnt lgkmcnt(3)
    v_add_u32_sdwa v111, v111, v89 dst_sel:DWORD dst_unused:UNUSED_PAD src0_sel:WORD_1 src1_sel:WORD_0
    v_lshlrev_b32 v111, 3, v111
    ds_write_b64 v111, v[70:71] offset:16400

    s_waitcnt lgkmcnt(3)
    v_add_u32_sdwa v112, v112, v90 dst_sel:DWORD dst_unused:UNUSED_PAD src0_sel:WORD_1 src1_sel:WORD_0
    v_lshlrev_b32 v112, 3, v112
    ds_write_b64 v112, v[72:73] offset:16400

    s_waitcnt lgkmcnt(3)
    v_add_u32_sdwa v113, v113, v91 dst_sel:DWORD dst_unused:UNUSED_PAD src0_sel:WORD_1 src1_sel:WORD_0
    v_lshlrev_b32 v113, 3, v113
    ds_write_b64 v113, v[74:75] offset:16400

    s_mov_b64 exec, -1
L_skz_18:
    buffer_load_dwordx4 v[28:31], v1, s[12:15], s58 offen nt
    buffer_load_dwordx4 v[12:15], v1, s[8:11], s58 offen nt
    buffer_load_dwordx2 v[40:41], v2, s[16:19], s63 offen nt
    buffer_load_dwordx4 v[32:35], v1, s[12:15], s59 offen nt
    buffer_load_dwordx4 v[16:19], v1, s[8:11], s59 offen nt
    buffer_load_dwordx2 v[42:43], v2, s[16:19], s64 offen nt
    s_cmp_eq_u32 s49, 0
    s_cbranch_scc1 L_p1epi_6
L_p1loop_5:
    s_mov_b32 s82, s85
    s_mov_b32 s83, s86
    s_mov_b32 s84, s87
    v_mov_b32 v99, 1
    buffer_atomic_add v99, v98, s[96:99], 0 offen sc0
    s_waitcnt vmcnt(10)
    s_bitcmp0_b32 s82, 0
    s_cbranch_scc1 L_ska_19
    v_mul_hi_u32_u24 v45, s40, v20
    v_mul_hi_u32_u24 v44, s40, v4
    v_mul_hi_u32_u24 v47, s40, v21
    v_mul_hi_u32_u24 v46, s40, v5
    v_mul_hi_u32_u24 v49, s40, v22
    v_mul_hi_u32_u24 v48, s40, v6
    v_mul_hi_u32_u24 v51, s40, v23
    v_mul_hi_u32_u24 v50, s40, v7
    v_and_b32 v45, -2, v45
    v_mad_u32_u24 v4, v44, s43, v4
    v_and_b32 v76, -4, v44
    v_and_b32 v47, -2, v47
    v_mad_u32_u24 v5, v46, s43, v5
    v_and_b32 v77, -4, v46
    v_and_b32 v49, -2, v49
    v_mad_u32_u24 v6, v48, s43, v6
    v_and_b32 v78, -4, v48
    v_and_b32 v51, -2, v51
    v_mad_u32_u24 v7, v50, s43, v7
    v_and_b32 v79, -4, v50
    v_mad_i32_i24 v20, v45, s42, v20
    v_lshl_add_u32 v45, v76, 5, v45
    v_mad_i32_i24 v21, v47, s42, v21
    v_lshl_add_u32 v47, v77, 5, v47
    v_mad_i32_i24 v22, v49, s42, v22
    v_lshl_add_u32 v49, v78, 5, v49
    v_mad_i32_i24 v23, v51, s42, v23
    v_lshl_add_u32 v51, v79, 5, v51
    v_add_u32 v45, v45, v45
    ds_add_rtn_u32 v76, v45, v104
    v_add_u32 v47, v47, v47
    ds_add_rtn_u32 v77, v47, v104
    v_add_u32 v49, v49, v49
    ds_add_rtn_u32 v78, v49, v104
    v_add_u32 v51, v51, v51
    ds_add_rtn_u32 v79, v51, v104
    v_lshlrev_b32 v110, 16, v36
    v_and_b32 v111, 0xffff0000, v36
    v_lshlrev_b32 v112, 16, v37
    v_and_b32 v113, 0xffff0000, v37
    v_mul_f32 v110, s44, v110
    v_mul_f32 v111, s44, v111
    v_mul_f32 v112, s44, v112
    v_mul_f32 v113, s44, v113
    v_fract_f32 v110, v110
    v_fract_f32 v111, v111
    v_fract_f32 v112, v112
    v_fract_f32 v113, v113
    v_cos_f32 v110, v110
    v_cos_f32 v111, v111
    v_cos_f32 v112, v112
    v_cos_f32 v113, v113
    v_lshl_or_b32 v44, v44, 14, v20
    v_perm_b32 v45, v45, v4, s46
    v_bfe_u32 v4, v4, 8, 5

    v_lshl_or_b32 v46, v46, 14, v21
    v_perm_b32 v47, v47, v5, s46
    v_bfe_u32 v5, v5, 8, 5

    v_lshl_or_b32 v48, v48, 14, v22
    v_perm_b32 v49, v49, v6, s46
    v_bfe_u32 v6, v6, 8, 5

    v_lshl_or_b32 v50, v50, 14, v23
    v_perm_b32 v51, v51, v7, s46
    v_bfe_u32 v7, v7, 8, 5

    v_fmaak_f32 v110, v110, v105, 0x4b400010
    v_fmaak_f32 v111, v111, v105, 0x4b400010
    v_fmaak_f32 v112, v112, v105, 0x4b400010
    v_fmaak_f32 v113, v113, v105, 0x4b400010
    v_sub_u32 v110, v110, v4
    v_sub_u32 v111, v111, v5
    v_sub_u32 v112, v112, v6
    v_sub_u32 v113, v113, v7
    v_bfi_b32 v110, 31, v4, v110
    v_bfi_b32 v111, 31, v5, v111
    v_bfi_b32 v112, 31, v6, v112
    v_bfi_b32 v113, 31, v7, v113
    v_perm_b32 v44, v44, v110, s55
    v_perm_b32 v46, v46, v111, s55
    v_perm_b32 v48, v48, v112, s55
    v_perm_b32 v50, v50, v113, s55
L_ska_19:
    s_waitcnt vmcnt(7)
    s_bitcmp0_b32 s82, 1
    s_cbranch_scc1 L_ska_20
    v_mul_hi_u32_u24 v53, s40, v24
    v_mul_hi_u32_u24 v52, s40, v8
    v_mul_hi_u32_u24 v55, s40, v25
    v_mul_hi_u32_u24 v54, s40, v9
    v_mul_hi_u32_u24 v57, s40, v26
    v_mul_hi_u32_u24 v56, s40, v10
    v_mul_hi_u32_u24 v59, s40, v27
    v_mul_hi_u32_u24 v58, s40, v11
    v_and_b32 v53, -2, v53
    v_mad_u32_u24 v8, v52, s43, v8
    v_and_b32 v80, -4, v52
    v_and_b32 v55, -2, v55
    v_mad_u32_u24 v9, v54, s43, v9
    v_and_b32 v81, -4, v54
    v_and_b32 v57, -2, v57
    v_mad_u32_u24 v10, v56, s43, v10
    v_and_b32 v82, -4, v56
    v_and_b32 v59, -2, v59
    v_mad_u32_u24 v11, v58, s43, v11
    v_and_b32 v83, -4, v58
    v_mad_i32_i24 v24, v53, s42, v24
    v_lshl_add_u32 v53, v80, 5, v53
    v_mad_i32_i24 v25, v55, s42, v25
    v_lshl_add_u32 v55, v81, 5, v55
    v_mad_i32_i24 v26, v57, s42, v26
    v_lshl_add_u32 v57, v82, 5, v57
    v_mad_i32_i24 v27, v59, s42, v27
    v_lshl_add_u32 v59, v83, 5, v59
    v_add_u32 v53, v53, v53
    ds_add_rtn_u32 v80, v53, v104
    v_add_u32 v55, v55, v55
    ds_add_rtn_u32 v81, v55, v104
    v_add_u32 v57, v57, v57
    ds_add_rtn_u32 v82, v57, v104
    v_add_u32 v59, v59, v59
    ds_add_rtn_u32 v83, v59, v104
    v_lshlrev_b32 v110, 16, v38
    v_and_b32 v111, 0xffff0000, v38
    v_lshlrev_b32 v112, 16, v39
    v_and_b32 v113, 0xffff0000, v39
    v_mul_f32 v110, s44, v110
    v_mul_f32 v111, s44, v111
    v_mul_f32 v112, s44, v112
    v_mul_f32 v113, s44, v113
    v_fract_f32 v110, v110
    v_fract_f32 v111, v111
    v_fract_f32 v112, v112
    v_fract_f32 v113, v113
    v_cos_f32 v110, v110
    v_cos_f32 v111, v111
    v_cos_f32 v112, v112
    v_cos_f32 v113, v113
    v_lshl_or_b32 v52, v52, 14, v24
    v_perm_b32 v53, v53, v8, s46
    v_bfe_u32 v8, v8, 8, 5

    v_lshl_or_b32 v54, v54, 14, v25
    v_perm_b32 v55, v55, v9, s46
    v_bfe_u32 v9, v9, 8, 5

    v_lshl_or_b32 v56, v56, 14, v26
    v_perm_b32 v57, v57, v10, s46
    v_bfe_u32 v10, v10, 8, 5

    v_lshl_or_b32 v58, v58, 14, v27
    v_perm_b32 v59, v59, v11, s46
    v_bfe_u32 v11, v11, 8, 5

    v_fmaak_f32 v110, v110, v105, 0x4b400010
    v_fmaak_f32 v111, v111, v105, 0x4b400010
    v_fmaak_f32 v112, v112, v105, 0x4b400010
    v_fmaak_f32 v113, v113, v105, 0x4b400010
    v_sub_u32 v110, v110, v8
    v_sub_u32 v111, v111, v9
    v_sub_u32 v112, v112, v10
    v_sub_u32 v113, v113, v11
    v_bfi_b32 v110, 31, v8, v110
    v_bfi_b32 v111, 31, v9, v111
    v_bfi_b32 v112, 31, v10, v112
    v_bfi_b32 v113, 31, v11, v113
    v_perm_b32 v52, v52, v110, s55
    v_perm_b32 v54, v54, v111, s55
    v_perm_b32 v56, v56, v112, s55
    v_perm_b32 v58, v58, v113, s55
L_ska_20:
    s_waitcnt vmcnt(1)
    s_waitcnt vmcnt(0)
    v_cmp_eq_u32 vcc, 0, v0
    s_mov_b64 exec, vcc
    ds_write_b32 v108, v99 offset:8
    s_mov_b64 exec, -1
    s_waitcnt vmcnt(10)
    v_add_u32 v110, v92, v94
    v_min_u32 v92, s48, v92
    v_add_u32 v111, v93, v95
    v_min_u32 v93, s48, v93
    v_max_u32 v110, v110, v111
    v_add_u32 v92, v92, v96
    v_add_u32 v93, v93, v97
    v_cmp_le_u32 vcc, s48, v110
    v_lshl_add_u32 v92, v92, 2, v92
    v_lshl_add_u32 v93, v93, 2, v93
    ds_write_b64 v2, v[92:93] offset:8192
    s_cbranch_vccz L_noov_21
    ds_write_b32 v108, v104 offset:4
L_noov_21:

    s_waitcnt lgkmcnt(0)
    s_barrier
    ds_read2_b32 v[110:111], v108 offset0:1 offset1:2
    s_waitcnt lgkmcnt(0)
    v_readfirstlane_b32 s53, v110
    v_readfirstlane_b32 s41, v111
    s_nop 1

    s_add_u32 s41, s41, 160
    s_sub_u32 s78, s41, 3008
    s_lshr_b32 s79, s78, 1
    s_add_u32 s79, s79, 3008
    s_and_b32 s86, s78, 1
    s_lshl_b32 s86, s86, 1
    s_add_u32 s87, s86, 2
    s_cmp_lt_u32 s41, 3008
    s_cselect_b32 s41, s41, s79
    s_cmovk_i32 s86, 0
    s_cmovk_i32 s87, 4

    s_mul_i32 s78, s41, 16000
    s_add_u32 s49, s78, 16000
    s_cmp_ge_u32 s41, 3200
    s_cmovk_i32 s49, 0
    s_cmovk_i32 s78, 0
    s_lshl_b32 s10, s49, 2
    s_lshl_b32 s14, s49, 2
    s_lshl_b32 s18, s49, 1
    s_sub_u32 s79, s87, s86
    s_bfm_b32 s85, s79, s86
    s_lshl_b32 s86, s86, 12
    s_lshl_b32 s87, s87, 12
    s_min_u32 s87, s87, 16000

    s_add_u32 s79, s78, 0
    s_bitcmp1_b32 s85, 0
    s_cselect_b32 s79, s79, 0x1ff00000
    s_lshl_b32 s56, s79, 2
    s_lshl_b32 s61, s79, 1

    s_add_u32 s79, s78, 4096
    s_bitcmp1_b32 s85, 1
    s_cselect_b32 s79, s79, 0x1ff00000
    s_lshl_b32 s57, s79, 2
    s_lshl_b32 s62, s79, 1

    s_add_u32 s79, s78, 8192
    s_bitcmp1_b32 s85, 2
    s_cselect_b32 s79, s79, 0x1ff00000
    s_lshl_b32 s58, s79, 2
    s_lshl_b32 s63, s79, 1

    s_add_u32 s79, s78, 12288
    s_bitcmp1_b32 s85, 3
    s_cselect_b32 s79, s79, 0x1ff00000
    s_lshl_b32 s59, s79, 2
    s_lshl_b32 s64, s79, 1

    s_cmp_lg_u32 s53, 0
    s_cbranch_scc1 L_slow_22
L_sback_23:
    s_bitcmp0_b32 s28, 0
    s_cbranch_scc1 L_skw_27
    ds_read_b64 v[110:111], v2 offset:16400
    ds_read_b64 v[112:113], v2 offset:16408
    ds_read_b64 v[114:115], v2 offset:16392

    ds_read_b64 v[118:119], v2 offset:24592
    ds_read_b64 v[120:121], v2 offset:24600
    ds_read_b64 v[122:123], v2 offset:24584

    s_waitcnt lgkmcnt(3)
    v_lshrrev_b32 v116, 16, v111
    ds_read_b32 v116, v116 offset:8192

    s_waitcnt lgkmcnt(1)
    v_lshrrev_b32 v124, 16, v119
    ds_read_b32 v124, v124 offset:8192

    v_cmp_ne_u32_sdwa s[80:81], v111, v113 src0_sel:WORD_1 src1_sel:WORD_1
    v_cmp_ne_u32_sdwa vcc, v111, v115 src0_sel:WORD_1 src1_sel:WORD_1
    v_alignbyte_b32 v114, v115, v114, 2
    s_mov_b32 s54, -3
    v_alignbyte_b32 v111, v111, v110, 1
    v_perm_b32 v110, v110, v114, s47
    s_waitcnt lgkmcnt(1)
    v_add3_u32 v116, v116, v106, s54
    v_sub_u32 v117, 0, v116
    v_and_b32 v117, 3, v117
    s_mov_b64 exec, s[80:81]
    v_mov_b32 v117, 0
    v_mov_b32 v112, 0
    s_mov_b64 exec, vcc
    v_mov_b32 v117, 3

    s_mov_b64 exec, -1
    v_alignbyte_b32 v110, v111, v110, v117
    v_alignbyte_b32 v111, v112, v111, v117
    v_add_u32 v116, v116, v117

    buffer_store_dwordx2 v[110:111], v116, s[24:27], 0 offen
    v_cmp_ne_u32_sdwa s[80:81], v119, v121 src0_sel:WORD_1 src1_sel:WORD_1
    v_cmp_ne_u32_sdwa vcc, v119, v123 src0_sel:WORD_1 src1_sel:WORD_1
    v_alignbyte_b32 v122, v123, v122, 2
    s_mov_b32 s54, 5117
    v_alignbyte_b32 v119, v119, v118, 1
    v_perm_b32 v118, v118, v122, s47
    s_waitcnt lgkmcnt(0)
    v_add3_u32 v124, v124, v106, s54
    v_sub_u32 v125, 0, v124
    v_and_b32 v125, 3, v125
    s_mov_b64 exec, s[80:81]
    v_mov_b32 v125, 0
    v_mov_b32 v120, 0
    s_mov_b64 exec, vcc
    v_mov_b32 v125, 3

    s_mov_b64 exec, -1
    v_alignbyte_b32 v118, v119, v118, v125
    v_alignbyte_b32 v119, v120, v119, v125
    v_add_u32 v124, v124, v125

    buffer_store_dwordx2 v[118:119], v124, s[24:27], 0 offen
L_skw_27:
    s_bitcmp0_b32 s28, 0
    s_cbranch_scc1 L_skw_28
    ds_read_b64 v[110:111], v2 offset:32784
    ds_read_b64 v[112:113], v2 offset:32792
    ds_read_b64 v[114:115], v2 offset:32776

    ds_read_b64 v[118:119], v2 offset:40976
    ds_read_b64 v[120:121], v2 offset:40984
    ds_read_b64 v[122:123], v2 offset:40968

    s_waitcnt lgkmcnt(3)
    v_lshrrev_b32 v116, 16, v111
    ds_read_b32 v116, v116 offset:8192

    s_waitcnt lgkmcnt(1)
    v_lshrrev_b32 v124, 16, v119
    ds_read_b32 v124, v124 offset:8192

    v_cmp_ne_u32_sdwa s[80:81], v111, v113 src0_sel:WORD_1 src1_sel:WORD_1
    v_cmp_ne_u32_sdwa vcc, v111, v115 src0_sel:WORD_1 src1_sel:WORD_1
    v_alignbyte_b32 v114, v115, v114, 2
    s_mov_b32 s54, 10237
    v_alignbyte_b32 v111, v111, v110, 1
    v_perm_b32 v110, v110, v114, s47
    s_waitcnt lgkmcnt(1)
    v_add3_u32 v116, v116, v106, s54
    v_sub_u32 v117, 0, v116
    v_and_b32 v117, 3, v117
    s_mov_b64 exec, s[80:81]
    v_mov_b32 v117, 0
    v_mov_b32 v112, 0
    s_mov_b64 exec, vcc
    v_mov_b32 v117, 3

    s_mov_b64 exec, -1
    v_alignbyte_b32 v110, v111, v110, v117
    v_alignbyte_b32 v111, v112, v111, v117
    v_add_u32 v116, v116, v117

    buffer_store_dwordx2 v[110:111], v116, s[24:27], 0 offen
    v_cmp_ne_u32_sdwa s[80:81], v119, v121 src0_sel:WORD_1 src1_sel:WORD_1
    v_cmp_ne_u32_sdwa vcc, v119, v123 src0_sel:WORD_1 src1_sel:WORD_1
    v_alignbyte_b32 v122, v123, v122, 2
    s_mov_b32 s54, 15357
    v_alignbyte_b32 v119, v119, v118, 1
    v_perm_b32 v118, v118, v122, s47
    s_waitcnt lgkmcnt(0)
    v_add3_u32 v124, v124, v106, s54
    v_sub_u32 v125, 0, v124
    v_and_b32 v125, 3, v125
    s_mov_b64 exec, s[80:81]
    v_mov_b32 v125, 0
    v_mov_b32 v120, 0
    s_mov_b64 exec, vcc
    v_mov_b32 v125, 3

    s_mov_b64 exec, -1
    v_alignbyte_b32 v118, v119, v118, v125
    v_alignbyte_b32 v119, v120, v119, v125
    v_add_u32 v124, v124, v125

    buffer_store_dwordx2 v[118:119], v124, s[24:27], 0 offen
L_skw_28:
    s_bitcmp0_b32 s82, 2
    s_cbranch_scc1 L_ska_29
    v_mul_hi_u32_u24 v61, s40, v28
    v_mul_hi_u32_u24 v60, s40, v12
    v_mul_hi_u32_u24 v63, s40, v29
    v_mul_hi_u32_u24 v62, s40, v13
    v_mul_hi_u32_u24 v65, s40, v30
    v_mul_hi_u32_u24 v64, s40, v14
    v_mul_hi_u32_u24 v67, s40, v31
    v_mul_hi_u32_u24 v66, s40, v15
    v_and_b32 v61, -2, v61
    v_mad_u32_u24 v12, v60, s43, v12
    v_and_b32 v84, -4, v60
    v_and_b32 v63, -2, v63
    v_mad_u32_u24 v13, v62, s43, v13
    v_and_b32 v85, -4, v62
    v_and_b32 v65, -2, v65
    v_mad_u32_u24 v14, v64, s43, v14
    v_and_b32 v86, -4, v64
    v_and_b32 v67, -2, v67
    v_mad_u32_u24 v15, v66, s43, v15
    v_and_b32 v87, -4, v66
    v_mad_i32_i24 v28, v61, s42, v28
    v_lshl_add_u32 v61, v84, 5, v61
    v_mad_i32_i24 v29, v63, s42, v29
    v_lshl_add_u32 v63, v85, 5, v63
    v_mad_i32_i24 v30, v65, s42, v30
    v_lshl_add_u32 v65, v86, 5, v65
    v_mad_i32_i24 v31, v67, s42, v31
    v_lshl_add_u32 v67, v87, 5, v67
    v_add_u32 v61, v61, v61
    ds_add_rtn_u32 v84, v61, v104
    v_add_u32 v63, v63, v63
    ds_add_rtn_u32 v85, v63, v104
    v_add_u32 v65, v65, v65
    ds_add_rtn_u32 v86, v65, v104
    v_add_u32 v67, v67, v67
    ds_add_rtn_u32 v87, v67, v104
    v_lshlrev_b32 v110, 16, v40
    v_and_b32 v111, 0xffff0000, v40
    v_lshlrev_b32 v112, 16, v41
    v_and_b32 v113, 0xffff0000, v41
    v_mul_f32 v110, s44, v110
    v_mul_f32 v111, s44, v111
    v_mul_f32 v112, s44, v112
    v_mul_f32 v113, s44, v113
    v_fract_f32 v110, v110
    v_fract_f32 v111, v111
    v_fract_f32 v112, v112
    v_fract_f32 v113, v113
    v_cos_f32 v110, v110
    v_cos_f32 v111, v111
    v_cos_f32 v112, v112
    v_cos_f32 v113, v113
    v_lshl_or_b32 v60, v60, 14, v28
    v_perm_b32 v61, v61, v12, s46
    v_bfe_u32 v12, v12, 8, 5

    v_lshl_or_b32 v62, v62, 14, v29
    v_perm_b32 v63, v63, v13, s46
    v_bfe_u32 v13, v13, 8, 5

    v_lshl_or_b32 v64, v64, 14, v30
    v_perm_b32 v65, v65, v14, s46
    v_bfe_u32 v14, v14, 8, 5

    v_lshl_or_b32 v66, v66, 14, v31
    v_perm_b32 v67, v67, v15, s46
    v_bfe_u32 v15, v15, 8, 5

    v_fmaak_f32 v110, v110, v105, 0x4b400010
    v_fmaak_f32 v111, v111, v105, 0x4b400010
    v_fmaak_f32 v112, v112, v105, 0x4b400010
    v_fmaak_f32 v113, v113, v105, 0x4b400010
    v_sub_u32 v110, v110, v12
    v_sub_u32 v111, v111, v13
    v_sub_u32 v112, v112, v14
    v_sub_u32 v113, v113, v15
    v_bfi_b32 v110, 31, v12, v110
    v_bfi_b32 v111, 31, v13, v111
    v_bfi_b32 v112, 31, v14, v112
    v_bfi_b32 v113, 31, v15, v113
    v_perm_b32 v60, v60, v110, s55
    v_perm_b32 v62, v62, v111, s55
    v_perm_b32 v64, v64, v112, s55
    v_perm_b32 v66, v66, v113, s55
L_ska_29:
    s_bitcmp0_b32 s28, 1
    s_cbranch_scc1 L_skw_30
    v_add_u32 v107, 32768, v2
    ds_read_b64 v[110:111], v107 offset:16400
    ds_read_b64 v[112:113], v107 offset:16408
    ds_read_b64 v[114:115], v107 offset:16392

    ds_read_b64 v[118:119], v107 offset:24592
    ds_read_b64 v[120:121], v107 offset:24600
    ds_read_b64 v[122:123], v107 offset:24584

    s_waitcnt lgkmcnt(3)
    v_lshrrev_b32 v116, 16, v111
    ds_read_b32 v116, v116 offset:8192

    s_waitcnt lgkmcnt(1)
    v_lshrrev_b32 v124, 16, v119
    ds_read_b32 v124, v124 offset:8192

    v_cmp_ne_u32_sdwa s[80:81], v111, v113 src0_sel:WORD_1 src1_sel:WORD_1
    v_cmp_ne_u32_sdwa vcc, v111, v115 src0_sel:WORD_1 src1_sel:WORD_1
    v_alignbyte_b32 v114, v115, v114, 2
    s_mov_b32 s54, 20477
    v_alignbyte_b32 v111, v111, v110, 1
    v_perm_b32 v110, v110, v114, s47
    s_waitcnt lgkmcnt(1)
    v_add3_u32 v116, v116, v106, s54
    v_sub_u32 v117, 0, v116
    v_and_b32 v117, 3, v117
    s_mov_b64 exec, s[80:81]
    v_mov_b32 v117, 0
    v_mov_b32 v112, 0
    s_mov_b64 exec, vcc
    v_mov_b32 v117, 3

    s_mov_b64 exec, -1
    v_alignbyte_b32 v110, v111, v110, v117
    v_alignbyte_b32 v111, v112, v111, v117
    v_add_u32 v116, v116, v117

    buffer_store_dwordx2 v[110:111], v116, s[24:27], 0 offen
    v_cmp_ne_u32_sdwa s[80:81], v119, v121 src0_sel:WORD_1 src1_sel:WORD_1
    v_cmp_ne_u32_sdwa vcc, v119, v123 src0_sel:WORD_1 src1_sel:WORD_1
    v_alignbyte_b32 v122, v123, v122, 2
    s_mov_b32 s54, 25597
    v_alignbyte_b32 v119, v119, v118, 1
    v_perm_b32 v118, v118, v122, s47
    s_waitcnt lgkmcnt(0)
    v_add3_u32 v124, v124, v106, s54
    v_sub_u32 v125, 0, v124
    v_and_b32 v125, 3, v125
    s_mov_b64 exec, s[80:81]
    v_mov_b32 v125, 0
    v_mov_b32 v120, 0
    s_mov_b64 exec, vcc
    v_mov_b32 v125, 3

    s_mov_b64 exec, -1
    v_alignbyte_b32 v118, v119, v118, v125
    v_alignbyte_b32 v119, v120, v119, v125
    v_add_u32 v124, v124, v125

    buffer_store_dwordx2 v[118:119], v124, s[24:27], 0 offen
L_skw_30:
    s_bitcmp0_b32 s28, 1
    s_cbranch_scc1 L_skw_31
    v_add_u32 v107, 32768, v2
    ds_read_b64 v[110:111], v107 offset:32784
    ds_read_b64 v[112:113], v107 offset:32792
    ds_read_b64 v[114:115], v107 offset:32776

    ds_read_b64 v[118:119], v107 offset:40976
    ds_read_b64 v[120:121], v107 offset:40984
    ds_read_b64 v[122:123], v107 offset:40968

    s_waitcnt lgkmcnt(3)
    v_lshrrev_b32 v116, 16, v111
    ds_read_b32 v116, v116 offset:8192

    s_waitcnt lgkmcnt(1)
    v_lshrrev_b32 v124, 16, v119
    ds_read_b32 v124, v124 offset:8192

    v_cmp_ne_u32_sdwa s[80:81], v111, v113 src0_sel:WORD_1 src1_sel:WORD_1
    v_cmp_ne_u32_sdwa vcc, v111, v115 src0_sel:WORD_1 src1_sel:WORD_1
    v_alignbyte_b32 v114, v115, v114, 2
    s_mov_b32 s54, 30717
    v_alignbyte_b32 v111, v111, v110, 1
    v_perm_b32 v110, v110, v114, s47
    s_waitcnt lgkmcnt(1)
    v_add3_u32 v116, v116, v106, s54
    v_sub_u32 v117, 0, v116
    v_and_b32 v117, 3, v117
    s_mov_b64 exec, s[80:81]
    v_mov_b32 v117, 0
    v_mov_b32 v112, 0
    s_mov_b64 exec, vcc
    v_mov_b32 v117, 3

    s_mov_b64 exec, -1
    v_alignbyte_b32 v110, v111, v110, v117
    v_alignbyte_b32 v111, v112, v111, v117
    v_add_u32 v116, v116, v117

    buffer_store_dwordx2 v[110:111], v116, s[24:27], 0 offen
    v_cmp_ne_u32_sdwa s[80:81], v119, v121 src0_sel:WORD_1 src1_sel:WORD_1
    v_cmp_ne_u32_sdwa vcc, v119, v123 src0_sel:WORD_1 src1_sel:WORD_1
    v_alignbyte_b32 v122, v123, v122, 2
    s_mov_b32 s54, 35837
    v_alignbyte_b32 v119, v119, v118, 1
    v_perm_b32 v118, v118, v122, s47
    s_waitcnt lgkmcnt(0)
    v_add3_u32 v124, v124, v106, s54
    v_sub_u32 v125, 0, v124
    v_and_b32 v125, 3, v125
    s_mov_b64 exec, s[80:81]
    v_mov_b32 v125, 0
    v_mov_b32 v120, 0
    s_mov_b64 exec, vcc
    v_mov_b32 v125, 3

    s_mov_b64 exec, -1
    v_alignbyte_b32 v118, v119, v118, v125
    v_alignbyte_b32 v119, v120, v119, v125
    v_add_u32 v124, v124, v125

    buffer_store_dwordx2 v[118:119], v124, s[24:27], 0 offen
L_skw_31:
    s_bitcmp0_b32 s28, 2
    s_cbranch_scc1 L_skw_32
    v_add_u32 v107, 65536, v2
    ds_read_b64 v[110:111], v107 offset:16400
    ds_read_b64 v[112:113], v107 offset:16408
    ds_read_b64 v[114:115], v107 offset:16392

    ds_read_b64 v[118:119], v107 offset:24592
    ds_read_b64 v[120:121], v107 offset:24600
    ds_read_b64 v[122:123], v107 offset:24584

    s_waitcnt lgkmcnt(3)
    v_lshrrev_b32 v116, 16, v111
    ds_read_b32 v116, v116 offset:8192

    s_waitcnt lgkmcnt(1)
    v_lshrrev_b32 v124, 16, v119
    ds_read_b32 v124, v124 offset:8192

    v_cmp_ne_u32_sdwa s[80:81], v111, v113 src0_sel:WORD_1 src1_sel:WORD_1
    v_cmp_ne_u32_sdwa vcc, v111, v115 src0_sel:WORD_1 src1_sel:WORD_1
    v_alignbyte_b32 v114, v115, v114, 2
    s_mov_b32 s54, 40957
    v_alignbyte_b32 v111, v111, v110, 1
    v_perm_b32 v110, v110, v114, s47
    s_waitcnt lgkmcnt(1)
    v_add3_u32 v116, v116, v106, s54
    v_sub_u32 v117, 0, v116
    v_and_b32 v117, 3, v117
    s_mov_b64 exec, s[80:81]
    v_mov_b32 v117, 0
    v_mov_b32 v112, 0
    s_mov_b64 exec, vcc
    v_mov_b32 v117, 3

    s_mov_b64 exec, -1
    v_alignbyte_b32 v110, v111, v110, v117
    v_alignbyte_b32 v111, v112, v111, v117
    v_add_u32 v116, v116, v117

    buffer_store_dwordx2 v[110:111], v116, s[24:27], 0 offen
    v_cmp_ne_u32_sdwa s[80:81], v119, v121 src0_sel:WORD_1 src1_sel:WORD_1
    v_cmp_ne_u32_sdwa vcc, v119, v123 src0_sel:WORD_1 src1_sel:WORD_1
    v_alignbyte_b32 v122, v123, v122, 2
    s_mov_b32 s54, 46077
    v_alignbyte_b32 v119, v119, v118, 1
    v_perm_b32 v118, v118, v122, s47
    s_waitcnt lgkmcnt(0)
    v_add3_u32 v124, v124, v106, s54
    v_sub_u32 v125, 0, v124
    v_and_b32 v125, 3, v125
    s_mov_b64 exec, s[80:81]
    v_mov_b32 v125, 0
    v_mov_b32 v120, 0
    s_mov_b64 exec, vcc
    v_mov_b32 v125, 3

    s_mov_b64 exec, -1
    v_alignbyte_b32 v118, v119, v118, v125
    v_alignbyte_b32 v119, v120, v119, v125
    v_add_u32 v124, v124, v125

    buffer_store_dwordx2 v[118:119], v124, s[24:27], 0 offen
L_skw_32:
    s_bitcmp0_b32 s82, 3
    s_cbranch_scc1 L_ska_33
    s_mov_b64 exec, s[66:67]
    v_mul_hi_u32_u24 v69, s40, v32
    v_mul_hi_u32_u24 v68, s40, v16
    v_mul_hi_u32_u24 v71, s40, v33
    v_mul_hi_u32_u24 v70, s40, v17
    v_mul_hi_u32_u24 v73, s40, v34
    v_mul_hi_u32_u24 v72, s40, v18
    v_mul_hi_u32_u24 v75, s40, v35
    v_mul_hi_u32_u24 v74, s40, v19
    v_and_b32 v69, -2, v69
    v_mad_u32_u24 v16, v68, s43, v16
    v_and_b32 v88, -4, v68
    v_and_b32 v71, -2, v71
    v_mad_u32_u24 v17, v70, s43, v17
    v_and_b32 v89, -4, v70
    v_and_b32 v73, -2, v73
    v_mad_u32_u24 v18, v72, s43, v18
    v_and_b32 v90, -4, v72
    v_and_b32 v75, -2, v75
    v_mad_u32_u24 v19, v74, s43, v19
    v_and_b32 v91, -4, v74
    v_mad_i32_i24 v32, v69, s42, v32
    v_lshl_add_u32 v69, v88, 5, v69
    v_mad_i32_i24 v33, v71, s42, v33
    v_lshl_add_u32 v71, v89, 5, v71
    v_mad_i32_i24 v34, v73, s42, v34
    v_lshl_add_u32 v73, v90, 5, v73
    v_mad_i32_i24 v35, v75, s42, v35
    v_lshl_add_u32 v75, v91, 5, v75
    v_add_u32 v69, v69, v69
    ds_add_rtn_u32 v88, v69, v104
    v_add_u32 v71, v71, v71
    ds_add_rtn_u32 v89, v71, v104
    v_add_u32 v73, v73, v73
    ds_add_rtn_u32 v90, v73, v104
    v_add_u32 v75, v75, v75
    ds_add_rtn_u32 v91, v75, v104
    v_lshlrev_b32 v110, 16, v42
    v_and_b32 v111, 0xffff0000, v42
    v_lshlrev_b32 v112, 16, v43
    v_and_b32 v113, 0xffff0000, v43
    v_mul_f32 v110, s44, v110
    v_mul_f32 v111, s44, v111
    v_mul_f32 v112, s44, v112
    v_mul_f32 v113, s44, v113
    v_fract_f32 v110, v110
    v_fract_f32 v111, v111
    v_fract_f32 v112, v112
    v_fract_f32 v113, v113
    v_cos_f32 v110, v110
    v_cos_f32 v111, v111
    v_cos_f32 v112, v112
    v_cos_f32 v113, v113
    v_lshl_or_b32 v68, v68, 14, v32
    v_perm_b32 v69, v69, v16, s46
    v_bfe_u32 v16, v16, 8, 5

    v_lshl_or_b32 v70, v70, 14, v33
    v_perm_b32 v71, v71, v17, s46
    v_bfe_u32 v17, v17, 8, 5

    v_lshl_or_b32 v72, v72, 14, v34
    v_perm_b32 v73, v73, v18, s46
    v_bfe_u32 v18, v18, 8, 5

    v_lshl_or_b32 v74, v74, 14, v35
    v_perm_b32 v75, v75, v19, s46
    v_bfe_u32 v19, v19, 8, 5

    v_fmaak_f32 v110, v110, v105, 0x4b400010
    v_fmaak_f32 v111, v111, v105, 0x4b400010
    v_fmaak_f32 v112, v112, v105, 0x4b400010
    v_fmaak_f32 v113, v113, v105, 0x4b400010
    v_sub_u32 v110, v110, v16
    v_sub_u32 v111, v111, v17
    v_sub_u32 v112, v112, v18
    v_sub_u32 v113, v113, v19
    v_bfi_b32 v110, 31, v16, v110
    v_bfi_b32 v111, 31, v17, v111
    v_bfi_b32 v112, 31, v18, v112
    v_bfi_b32 v113, 31, v19, v113
    v_perm_b32 v68, v68, v110, s55
    v_perm_b32 v70, v70, v111, s55
    v_perm_b32 v72, v72, v112, s55
    v_perm_b32 v74, v74, v113, s55
    s_mov_b64 exec, -1
L_ska_33:
    s_bitcmp0_b32 s28, 2
    s_cbranch_scc1 L_skw_34
    v_add_u32 v107, 65536, v2
    ds_read_b64 v[110:111], v107 offset:32784
    ds_read_b64 v[112:113], v107 offset:32792
    ds_read_b64 v[114:115], v107 offset:32776

    ds_read_b64 v[118:119], v107 offset:40976
    ds_read_b64 v[120:121], v107 offset:40984
    ds_read_b64 v[122:123], v107 offset:40968

    s_waitcnt lgkmcnt(3)
    v_lshrrev_b32 v116, 16, v111
    ds_read_b32 v116, v116 offset:8192

    s_waitcnt lgkmcnt(1)
    v_lshrrev_b32 v124, 16, v119
    ds_read_b32 v124, v124 offset:8192

    v_cmp_ne_u32_sdwa s[80:81], v111, v113 src0_sel:WORD_1 src1_sel:WORD_1
    v_cmp_ne_u32_sdwa vcc, v111, v115 src0_sel:WORD_1 src1_sel:WORD_1
    v_alignbyte_b32 v114, v115, v114, 2
    s_mov_b32 s54, 51197
    v_alignbyte_b32 v111, v111, v110, 1
    v_perm_b32 v110, v110, v114, s47
    s_waitcnt lgkmcnt(1)
    v_add3_u32 v116, v116, v106, s54
    v_sub_u32 v117, 0, v116
    v_and_b32 v117, 3, v117
    s_mov_b64 exec, s[80:81]
    v_mov_b32 v117, 0
    v_mov_b32 v112, 0
    s_mov_b64 exec, vcc
    v_mov_b32 v117, 3

    s_mov_b64 exec, -1
    v_alignbyte_b32 v110, v111, v110, v117
    v_alignbyte_b32 v111, v112, v111, v117
    v_add_u32 v116, v116, v117

    buffer_store_dwordx2 v[110:111], v116, s[24:27], 0 offen
    v_cmp_ne_u32_sdwa s[80:81], v119, v121 src0_sel:WORD_1 src1_sel:WORD_1
    v_cmp_ne_u32_sdwa vcc, v119, v123 src0_sel:WORD_1 src1_sel:WORD_1
    v_alignbyte_b32 v122, v123, v122, 2
    s_mov_b32 s54, 56317
    v_alignbyte_b32 v119, v119, v118, 1
    v_perm_b32 v118, v118, v122, s47
    s_waitcnt lgkmcnt(0)
    v_add3_u32 v124, v124, v106, s54
    v_sub_u32 v125, 0, v124
    v_and_b32 v125, 3, v125
    s_mov_b64 exec, s[80:81]
    v_mov_b32 v125, 0
    v_mov_b32 v120, 0
    s_mov_b64 exec, vcc
    v_mov_b32 v125, 3

    s_mov_b64 exec, -1
    v_alignbyte_b32 v118, v119, v118, v125
    v_alignbyte_b32 v119, v120, v119, v125
    v_add_u32 v124, v124, v125

    buffer_store_dwordx2 v[118:119], v124, s[24:27], 0 offen
L_skw_34:
    s_bitcmp0_b32 s28, 3
    s_cbranch_scc1 L_skw_35
    v_add_u32 v107, 98304, v2
    ds_read_b64 v[110:111], v107 offset:16400
    ds_read_b64 v[112:113], v107 offset:16408
    ds_read_b64 v[114:115], v107 offset:16392

    ds_read_b64 v[118:119], v107 offset:24592
    ds_read_b64 v[120:121], v107 offset:24600
    ds_read_b64 v[122:123], v107 offset:24584

    s_waitcnt lgkmcnt(3)
    v_lshrrev_b32 v116, 16, v111
    ds_read_b32 v116, v116 offset:8192

    s_waitcnt lgkmcnt(1)
    v_lshrrev_b32 v124, 16, v119
    ds_read_b32 v124, v124 offset:8192

    v_cmp_ne_u32_sdwa s[80:81], v111, v113 src0_sel:WORD_1 src1_sel:WORD_1
    v_cmp_ne_u32_sdwa vcc, v111, v115 src0_sel:WORD_1 src1_sel:WORD_1
    v_alignbyte_b32 v114, v115, v114, 2
    s_mov_b32 s54, 61437
    v_alignbyte_b32 v111, v111, v110, 1
    v_perm_b32 v110, v110, v114, s47
    s_waitcnt lgkmcnt(1)
    v_add3_u32 v116, v116, v106, s54
    v_sub_u32 v117, 0, v116
    v_and_b32 v117, 3, v117
    s_mov_b64 exec, s[80:81]
    v_mov_b32 v117, 0
    v_mov_b32 v112, 0
    s_mov_b64 exec, vcc
    v_mov_b32 v117, 3

    s_mov_b64 exec, -1
    v_alignbyte_b32 v110, v111, v110, v117
    v_alignbyte_b32 v111, v112, v111, v117
    v_add_u32 v116, v116, v117

    buffer_store_dwordx2 v[110:111], v116, s[24:27], 0 offen
    v_cmp_ne_u32_sdwa s[80:81], v119, v121 src0_sel:WORD_1 src1_sel:WORD_1
    v_cmp_ne_u32_sdwa vcc, v119, v123 src0_sel:WORD_1 src1_sel:WORD_1
    v_alignbyte_b32 v122, v123, v122, 2
    s_mov_b32 s54, 66557
    v_alignbyte_b32 v119, v119, v118, 1
    v_perm_b32 v118, v118, v122, s47
    s_waitcnt lgkmcnt(0)
    v_add3_u32 v124, v124, v106, s54
    v_sub_u32 v125, 0, v124
    v_and_b32 v125, 3, v125
    s_mov_b64 exec, s[80:81]
    v_mov_b32 v125, 0
    v_mov_b32 v120, 0
    s_mov_b64 exec, vcc
    v_mov_b32 v125, 3

    s_mov_b64 exec, -1
    v_alignbyte_b32 v118, v119, v118, v125
    v_alignbyte_b32 v119, v120, v119, v125
    v_add_u32 v124, v124, v125

    buffer_store_dwordx2 v[118:119], v124, s[24:27], 0 offen
L_skw_35:
    s_bitcmp0_b32 s28, 3
    s_cbranch_scc1 L_skw_36
    v_add_u32 v107, 98304, v2
    ds_read_b64 v[110:111], v107 offset:32784
    ds_read_b64 v[112:113], v107 offset:32792
    ds_read_b64 v[114:115], v107 offset:32776

    ds_read_b64 v[118:119], v107 offset:40976
    ds_read_b64 v[120:121], v107 offset:40984
    ds_read_b64 v[122:123], v107 offset:40968

    s_waitcnt lgkmcnt(3)
    v_lshrrev_b32 v116, 16, v111
    ds_read_b32 v116, v116 offset:8192

    s_waitcnt lgkmcnt(1)
    v_lshrrev_b32 v124, 16, v119
    ds_read_b32 v124, v124 offset:8192

    v_cmp_ne_u32_sdwa s[80:81], v111, v113 src0_sel:WORD_1 src1_sel:WORD_1
    v_cmp_ne_u32_sdwa vcc, v111, v115 src0_sel:WORD_1 src1_sel:WORD_1
    v_alignbyte_b32 v114, v115, v114, 2
    s_mov_b32 s54, 71677
    v_alignbyte_b32 v111, v111, v110, 1
    v_perm_b32 v110, v110, v114, s47
    s_waitcnt lgkmcnt(1)
    v_add3_u32 v116, v116, v106, s54
    v_sub_u32 v117, 0, v116
    v_and_b32 v117, 3, v117
    s_mov_b64 exec, s[80:81]
    v_mov_b32 v117, 0
    v_mov_b32 v112, 0
    s_mov_b64 exec, vcc
    v_mov_b32 v117, 3

    s_mov_b64 exec, -1
    v_alignbyte_b32 v110, v111, v110, v117
    v_alignbyte_b32 v111, v112, v111, v117
    v_add_u32 v116, v116, v117

    buffer_store_dwordx2 v[110:111], v116, s[24:27], 0 offen
    v_cmp_ne_u32_sdwa s[80:81], v119, v121 src0_sel:WORD_1 src1_sel:WORD_1
    v_cmp_ne_u32_sdwa vcc, v119, v123 src0_sel:WORD_1 src1_sel:WORD_1
    v_alignbyte_b32 v122, v123, v122, 2
    s_mov_b32 s54, 76797
    v_alignbyte_b32 v119, v119, v118, 1
    v_perm_b32 v118, v118, v122, s47
    s_waitcnt lgkmcnt(0)
    v_add3_u32 v124, v124, v106, s54
    v_sub_u32 v125, 0, v124
    v_and_b32 v125, 3, v125
    s_mov_b64 exec, s[80:81]
    v_mov_b32 v125, 0
    v_mov_b32 v120, 0
    s_mov_b64 exec, vcc
    v_mov_b32 v125, 3

    s_andn2_b64 exec, -1, s[68:69]
    v_bfrev_b32 v124, 1
    s_mov_b64 exec, -1
    v_alignbyte_b32 v118, v119, v118, v125
    v_alignbyte_b32 v119, v120, v119, v125
    v_add_u32 v124, v124, v125

    buffer_store_dwordx2 v[118:119], v124, s[24:27], 0 offen
L_skw_36:
    s_waitcnt lgkmcnt(0)
    s_barrier

    buffer_load_dwordx4 v[20:23], v1, s[12:15], s56 offen nt
    buffer_load_dwordx4 v[4:7], v1, s[8:11], s56 offen nt
    buffer_load_dwordx2 v[36:37], v2, s[16:19], s61 offen nt
    ds_read_b64 v[94:95], v2
    s_waitcnt lgkmcnt(0)
    v_and_b32 v94, 0xffff, v94
    v_and_b32 v95, 0xffff, v95
    v_add_u32 v97, v94, v95
    s_nop 1
    v_add_u32_dpp v97, v97, v97 row_shr:1 row_mask:0xf bank_mask:0xf
    s_nop 1
    v_add_u32_dpp v97, v97, v97 row_shr:2 row_mask:0xf bank_mask:0xf
    s_nop 1
    v_add_u32_dpp v97, v97, v97 row_shr:4 row_mask:0xf bank_mask:0xf
    s_nop 1
    v_add_u32_dpp v97, v97, v97 row_shr:8 row_mask:0xf bank_mask:0xf
    s_nop 1
    v_add_u32_dpp v97, v97, v97 row_bcast:15 row_mask:0xa bank_mask:0xf
    s_nop 1
    v_add_u32_dpp v97, v97, v97 row_bcast:31 row_mask:0xc bank_mask:0xf
    s_mov_b32 exec_lo, 0
    s_brev_b32 exec_hi, 1
    ds_add_rtn_u32 v96, v108, v97
    s_mov_b64 exec, -1

    v_add_u32 v92, v94, v94
    v_add_u32 v93, v95, v95
    v_med3_u32 v92, v94, 2, v92
    v_med3_u32 v93, v95, 2, v93
    buffer_atomic_add_x2 v[92:93], v2, s[20:23], 0 offen sc0
    s_waitcnt lgkmcnt(0)
    v_readlane_b32 s77, v96, 63
    v_mul_u32_u24 v114, 7936, v0
    v_sub_u32 v97, v97, v95
    s_sub_u32 s50, s50, s83
    s_sub_u32 s77, s77, s50
    v_add_u32 v97, s77, v97
    v_sub_u32 v96, v97, v94
    v_lshlrev_b32 v111, 16, v97
    v_lshlrev_b32 v110, 16, v96
    ds_write_b64 v2, v[110:111]
    v_sub_u32 v96, v114, v96
    v_sub_u32 v97, v114, v97
    v_add_u32 v97, s48, v97
    s_add_u32 s50, s50, s84
    s_mov_b32 s28, s82
    s_mov_b32 s29, s83
    s_mov_b32 s30, s84
    s_lshl_b32 s74, s29, 3
    s_lshl_b32 s75, s30, 3
    v_mov_b32 v125, s74
    v_mov_b32 v126, s75
    v_mov_b32 v127, -1

    s_waitcnt lgkmcnt(0)
    s_barrier

    s_mov_b64 exec, 1
    ds_write_b32 v125, v127 offset:16396
    ds_write_b32 v126, v127 offset:16404
    s_mov_b64 exec, -1

    buffer_load_dwordx4 v[24:27], v1, s[12:15], s57 offen nt
    buffer_load_dwordx4 v[8:11], v1, s[8:11], s57 offen nt
    buffer_load_dwordx2 v[38:39], v2, s[16:19], s62 offen nt
    s_bitcmp0_b32 s28, 0
    s_cbranch_scc1 L_skz_37
    v_lshrrev_b32 v110, 16, v45
    ds_read_b32 v110, v110
    v_lshrrev_b32 v111, 16, v47
    ds_read_b32 v111, v111
    v_lshrrev_b32 v112, 16, v49
    ds_read_b32 v112, v112
    v_lshrrev_b32 v113, 16, v51
    ds_read_b32 v113, v113
    v_lshrrev_b32 v114, 16, v53
    ds_read_b32 v114, v114
    v_lshrrev_b32 v115, 16, v55
    ds_read_b32 v115, v115
    v_lshrrev_b32 v116, 16, v57
    ds_read_b32 v116, v116
    v_lshrrev_b32 v117, 16, v59
    ds_read_b32 v117, v117
    s_waitcnt lgkmcnt(7)
    v_add_u32_sdwa v110, v110, v76 dst_sel:DWORD dst_unused:UNUSED_PAD src0_sel:WORD_1 src1_sel:WORD_0
    v_lshlrev_b32 v110, 3, v110
    ds_write_b64 v110, v[44:45] offset:16400

    s_waitcnt lgkmcnt(7)
    v_add_u32_sdwa v111, v111, v77 dst_sel:DWORD dst_unused:UNUSED_PAD src0_sel:WORD_1 src1_sel:WORD_0
    v_lshlrev_b32 v111, 3, v111
    ds_write_b64 v111, v[46:47] offset:16400

    s_waitcnt lgkmcnt(7)
    v_add_u32_sdwa v112, v112, v78 dst_sel:DWORD dst_unused:UNUSED_PAD src0_sel:WORD_1 src1_sel:WORD_0
    v_lshlrev_b32 v112, 3, v112
    ds_write_b64 v112, v[48:49] offset:16400

    s_waitcnt lgkmcnt(7)
    v_add_u32_sdwa v113, v113, v79 dst_sel:DWORD dst_unused:UNUSED_PAD src0_sel:WORD_1 src1_sel:WORD_0
    v_lshlrev_b32 v113, 3, v113
    ds_write_b64 v113, v[50:51] offset:16400

    s_waitcnt lgkmcnt(7)
    v_add_u32_sdwa v114, v114, v80 dst_sel:DWORD dst_unused:UNUSED_PAD src0_sel:WORD_1 src1_sel:WORD_0
    v_lshlrev_b32 v114, 3, v114
    ds_write_b64 v114, v[52:53] offset:16400

    s_waitcnt lgkmcnt(7)
    v_add_u32_sdwa v115, v115, v81 dst_sel:DWORD dst_unused:UNUSED_PAD src0_sel:WORD_1 src1_sel:WORD_0
    v_lshlrev_b32 v115, 3, v115
    ds_write_b64 v115, v[54:55] offset:16400

    s_waitcnt lgkmcnt(7)
    v_add_u32_sdwa v116, v116, v82 dst_sel:DWORD dst_unused:UNUSED_PAD src0_sel:WORD_1 src1_sel:WORD_0
    v_lshlrev_b32 v116, 3, v116
    ds_write_b64 v116, v[56:57] offset:16400

    s_waitcnt lgkmcnt(7)
    v_add_u32_sdwa v117, v117, v83 dst_sel:DWORD dst_unused:UNUSED_PAD src0_sel:WORD_1 src1_sel:WORD_0
    v_lshlrev_b32 v117, 3, v117
    ds_write_b64 v117, v[58:59] offset:16400

L_skz_37:
    buffer_load_dwordx4 v[28:31], v1, s[12:15], s58 offen nt
    buffer_load_dwordx4 v[12:15], v1, s[8:11], s58 offen nt
    buffer_load_dwordx2 v[40:41], v2, s[16:19], s63 offen nt
    s_bitcmp0_b32 s28, 2
    s_cbranch_scc1 L_skz_38
    v_lshrrev_b32 v110, 16, v61
    ds_read_b32 v110, v110
    v_lshrrev_b32 v111, 16, v63
    ds_read_b32 v111, v111
    v_lshrrev_b32 v112, 16, v65
    ds_read_b32 v112, v112
    v_lshrrev_b32 v113, 16, v67
    ds_read_b32 v113, v113
    s_waitcnt lgkmcnt(3)
    v_add_u32_sdwa v110, v110, v84 dst_sel:DWORD dst_unused:UNUSED_PAD src0_sel:WORD_1 src1_sel:WORD_0
    v_lshlrev_b32 v110, 3, v110
    ds_write_b64 v110, v[60:61] offset:16400

    s_waitcnt lgkmcnt(3)
    v_add_u32_sdwa v111, v111, v85 dst_sel:DWORD dst_unused:UNUSED_PAD src0_sel:WORD_1 src1_sel:WORD_0
    v_lshlrev_b32 v111, 3, v111
    ds_write_b64 v111, v[62:63] offset:16400

    s_waitcnt lgkmcnt(3)
    v_add_u32_sdwa v112, v112, v86 dst_sel:DWORD dst_unused:UNUSED_PAD src0_sel:WORD_1 src1_sel:WORD_0
    v_lshlrev_b32 v112, 3, v112
    ds_write_b64 v112, v[64:65] offset:16400

    s_waitcnt lgkmcnt(3)
    v_add_u32_sdwa v113, v113, v87 dst_sel:DWORD dst_unused:UNUSED_PAD src0_sel:WORD_1 src1_sel:WORD_0
    v_lshlrev_b32 v113, 3, v113
    ds_write_b64 v113, v[66:67] offset:16400

L_skz_38:
    s_bitcmp0_b32 s28, 3
    s_cbranch_scc1 L_skz_39
    s_mov_b64 exec, s[66:67]
    v_lshrrev_b32 v110, 16, v69
    ds_read_b32 v110, v110
    v_lshrrev_b32 v111, 16, v71
    ds_read_b32 v111, v111
    v_lshrrev_b32 v112, 16, v73
    ds_read_b32 v112, v112
    v_lshrrev_b32 v113, 16, v75
    ds_read_b32 v113, v113
    s_waitcnt lgkmcnt(3)
    v_add_u32_sdwa v110, v110, v88 dst_sel:DWORD dst_unused:UNUSED_PAD src0_sel:WORD_1 src1_sel:WORD_0
    v_lshlrev_b32 v110, 3, v110
    ds_write_b64 v110, v[68:69] offset:16400

    s_waitcnt lgkmcnt(3)
    v_add_u32_sdwa v111, v111, v89 dst_sel:DWORD dst_unused:UNUSED_PAD src0_sel:WORD_1 src1_sel:WORD_0
    v_lshlrev_b32 v111, 3, v111
    ds_write_b64 v111, v[70:71] offset:16400

    s_waitcnt lgkmcnt(3)
    v_add_u32_sdwa v112, v112, v90 dst_sel:DWORD dst_unused:UNUSED_PAD src0_sel:WORD_1 src1_sel:WORD_0
    v_lshlrev_b32 v112, 3, v112
    ds_write_b64 v112, v[72:73] offset:16400

    s_waitcnt lgkmcnt(3)
    v_add_u32_sdwa v113, v113, v91 dst_sel:DWORD dst_unused:UNUSED_PAD src0_sel:WORD_1 src1_sel:WORD_0
    v_lshlrev_b32 v113, 3, v113
    ds_write_b64 v113, v[74:75] offset:16400

    s_mov_b64 exec, -1
L_skz_39:
    buffer_load_dwordx4 v[32:35], v1, s[12:15], s59 offen nt
    buffer_load_dwordx4 v[16:19], v1, s[8:11], s59 offen nt
    buffer_load_dwordx2 v[42:43], v2, s[16:19], s64 offen nt
    s_cmp_lg_u32 s49, 0
    s_cbranch_scc1 L_p1loop_5
L_p1epi_6:
    s_waitcnt vmcnt(0)
    s_waitcnt vmcnt(9)
    v_add_u32 v110, v92, v94
    v_min_u32 v92, s48, v92
    v_add_u32 v111, v93, v95
    v_min_u32 v93, s48, v93
    v_max_u32 v110, v110, v111
    v_add_u32 v92, v92, v96
    v_add_u32 v93, v93, v97
    v_cmp_le_u32 vcc, s48, v110
    v_lshl_add_u32 v92, v92, 2, v92
    v_lshl_add_u32 v93, v93, 2, v93
    ds_write_b64 v2, v[92:93] offset:8192
    s_cbranch_vccz L_noov_40
    ds_write_b32 v108, v104 offset:4
L_noov_40:

    s_waitcnt lgkmcnt(0)
    s_barrier
    ds_read_b32 v110, v108 offset:4
    s_waitcnt lgkmcnt(0)
    v_readfirstlane_b32 s53, v110
    s_nop 1

    s_cmp_lg_u32 s53, 0
    s_cbranch_scc1 L_slow_41
L_sback_42:
    s_bitcmp0_b32 s28, 0
    s_cbranch_scc1 L_skw_46
    ds_read_b64 v[4:5], v2 offset:16400
    ds_read_b64 v[6:7], v2 offset:16408
    ds_read_b64 v[8:9], v2 offset:16392

    ds_read_b64 v[12:13], v2 offset:24592
    ds_read_b64 v[14:15], v2 offset:24600
    ds_read_b64 v[16:17], v2 offset:24584

    ds_read_b64 v[20:21], v2 offset:32784
    ds_read_b64 v[22:23], v2 offset:32792
    ds_read_b64 v[24:25], v2 offset:32776

    ds_read_b64 v[28:29], v2 offset:40976
    ds_read_b64 v[30:31], v2 offset:40984
    ds_read_b64 v[32:33], v2 offset:40968

    s_waitcnt lgkmcnt(9)
    v_lshrrev_b32 v10, 16, v5
    ds_read_b32 v10, v10 offset:8192

    s_waitcnt lgkmcnt(7)
    v_lshrrev_b32 v18, 16, v13
    ds_read_b32 v18, v18 offset:8192

    s_waitcnt lgkmcnt(5)
    v_lshrrev_b32 v26, 16, v21
    ds_read_b32 v26, v26 offset:8192

    s_waitcnt lgkmcnt(3)
    v_lshrrev_b32 v34, 16, v29
    ds_read_b32 v34, v34 offset:8192

    v_cmp_ne_u32_sdwa s[80:81], v5, v7 src0_sel:WORD_1 src1_sel:WORD_1
    v_cmp_ne_u32_sdwa vcc, v5, v9 src0_sel:WORD_1 src1_sel:WORD_1
    v_alignbyte_b32 v8, v9, v8, 2
    s_mov_b32 s54, -3
    v_alignbyte_b32 v5, v5, v4, 1
    v_perm_b32 v4, v4, v8, s47
    s_waitcnt lgkmcnt(3)
    v_add3_u32 v10, v10, v106, s54
    v_sub_u32 v11, 0, v10
    v_and_b32 v11, 3, v11
    s_mov_b64 exec, s[80:81]
    v_mov_b32 v11, 0
    v_mov_b32 v6, 0
    s_mov_b64 exec, vcc
    v_mov_b32 v11, 3

    s_mov_b64 exec, -1
    v_alignbyte_b32 v4, v5, v4, v11
    v_alignbyte_b32 v5, v6, v5, v11
    v_add_u32 v10, v10, v11

    buffer_store_dwordx2 v[4:5], v10, s[24:27], 0 offen
    v_cmp_ne_u32_sdwa s[80:81], v13, v15 src0_sel:WORD_1 src1_sel:WORD_1
    v_cmp_ne_u32_sdwa vcc, v13, v17 src0_sel:WORD_1 src1_sel:WORD_1
    v_alignbyte_b32 v16, v17, v16, 2
    s_mov_b32 s54, 5117
    v_alignbyte_b32 v13, v13, v12, 1
    v_perm_b32 v12, v12, v16, s47
    s_waitcnt lgkmcnt(2)
    v_add3_u32 v18, v18, v106, s54
    v_sub_u32 v19, 0, v18
    v_and_b32 v19, 3, v19
    s_mov_b64 exec, s[80:81]
    v_mov_b32 v19, 0
    v_mov_b32 v14, 0
    s_mov_b64 exec, vcc
    v_mov_b32 v19, 3

    s_mov_b64 exec, -1
    v_alignbyte_b32 v12, v13, v12, v19
    v_alignbyte_b32 v13, v14, v13, v19
    v_add_u32 v18, v18, v19

    buffer_store_dwordx2 v[12:13], v18, s[24:27], 0 offen
    v_cmp_ne_u32_sdwa s[80:81], v21, v23 src0_sel:WORD_1 src1_sel:WORD_1
    v_cmp_ne_u32_sdwa vcc, v21, v25 src0_sel:WORD_1 src1_sel:WORD_1
    v_alignbyte_b32 v24, v25, v24, 2
    s_mov_b32 s54, 10237
    v_alignbyte_b32 v21, v21, v20, 1
    v_perm_b32 v20, v20, v24, s47
    s_waitcnt lgkmcnt(1)
    v_add3_u32 v26, v26, v106, s54
    v_sub_u32 v27, 0, v26
    v_and_b32 v27, 3, v27
    s_mov_b64 exec, s[80:81]
    v_mov_b32 v27, 0
    v_mov_b32 v22, 0
    s_mov_b64 exec, vcc
    v_mov_b32 v27, 3

    s_mov_b64 exec, -1
    v_alignbyte_b32 v20, v21, v20, v27
    v_alignbyte_b32 v21, v22, v21, v27
    v_add_u32 v26, v26, v27

    buffer_store_dwordx2 v[20:21], v26, s[24:27], 0 offen
    v_cmp_ne_u32_sdwa s[80:81], v29, v31 src0_sel:WORD_1 src1_sel:WORD_1
    v_cmp_ne_u32_sdwa vcc, v29, v33 src0_sel:WORD_1 src1_sel:WORD_1
    v_alignbyte_b32 v32, v33, v32, 2
    s_mov_b32 s54, 15357
    v_alignbyte_b32 v29, v29, v28, 1
    v_perm_b32 v28, v28, v32, s47
    s_waitcnt lgkmcnt(0)
    v_add3_u32 v34, v34, v106, s54
    v_sub_u32 v35, 0, v34
    v_and_b32 v35, 3, v35
    s_mov_b64 exec, s[80:81]
    v_mov_b32 v35, 0
    v_mov_b32 v30, 0
    s_mov_b64 exec, vcc
    v_mov_b32 v35, 3

    s_mov_b64 exec, -1
    v_alignbyte_b32 v28, v29, v28, v35
    v_alignbyte_b32 v29, v30, v29, v35
    v_add_u32 v34, v34, v35

    buffer_store_dwordx2 v[28:29], v34, s[24:27], 0 offen
L_skw_46:
    s_bitcmp0_b32 s28, 1
    s_cbranch_scc1 L_skw_47
    v_add_u32 v107, 32768, v2
    ds_read_b64 v[4:5], v107 offset:16400
    ds_read_b64 v[6:7], v107 offset:16408
    ds_read_b64 v[8:9], v107 offset:16392

    ds_read_b64 v[12:13], v107 offset:24592
    ds_read_b64 v[14:15], v107 offset:24600
    ds_read_b64 v[16:17], v107 offset:24584

    ds_read_b64 v[20:21], v107 offset:32784
    ds_read_b64 v[22:23], v107 offset:32792
    ds_read_b64 v[24:25], v107 offset:32776

    ds_read_b64 v[28:29], v107 offset:40976
    ds_read_b64 v[30:31], v107 offset:40984
    ds_read_b64 v[32:33], v107 offset:40968

    s_waitcnt lgkmcnt(9)
    v_lshrrev_b32 v10, 16, v5
    ds_read_b32 v10, v10 offset:8192

    s_waitcnt lgkmcnt(7)
    v_lshrrev_b32 v18, 16, v13
    ds_read_b32 v18, v18 offset:8192

    s_waitcnt lgkmcnt(5)
    v_lshrrev_b32 v26, 16, v21
    ds_read_b32 v26, v26 offset:8192

    s_waitcnt lgkmcnt(3)
    v_lshrrev_b32 v34, 16, v29
    ds_read_b32 v34, v34 offset:8192

    v_cmp_ne_u32_sdwa s[80:81], v5, v7 src0_sel:WORD_1 src1_sel:WORD_1
    v_cmp_ne_u32_sdwa vcc, v5, v9 src0_sel:WORD_1 src1_sel:WORD_1
    v_alignbyte_b32 v8, v9, v8, 2
    s_mov_b32 s54, 20477
    v_alignbyte_b32 v5, v5, v4, 1
    v_perm_b32 v4, v4, v8, s47
    s_waitcnt lgkmcnt(3)
    v_add3_u32 v10, v10, v106, s54
    v_sub_u32 v11, 0, v10
    v_and_b32 v11, 3, v11
    s_mov_b64 exec, s[80:81]
    v_mov_b32 v11, 0
    v_mov_b32 v6, 0
    s_mov_b64 exec, vcc
    v_mov_b32 v11, 3

    s_mov_b64 exec, -1
    v_alignbyte_b32 v4, v5, v4, v11
    v_alignbyte_b32 v5, v6, v5, v11
    v_add_u32 v10, v10, v11

    buffer_store_dwordx2 v[4:5], v10, s[24:27], 0 offen
    v_cmp_ne_u32_sdwa s[80:81], v13, v15 src0_sel:WORD_1 src1_sel:WORD_1
    v_cmp_ne_u32_sdwa vcc, v13, v17 src0_sel:WORD_1 src1_sel:WORD_1
    v_alignbyte_b32 v16, v17, v16, 2
    s_mov_b32 s54, 25597
    v_alignbyte_b32 v13, v13, v12, 1
    v_perm_b32 v12, v12, v16, s47
    s_waitcnt lgkmcnt(2)
    v_add3_u32 v18, v18, v106, s54
    v_sub_u32 v19, 0, v18
    v_and_b32 v19, 3, v19
    s_mov_b64 exec, s[80:81]
    v_mov_b32 v19, 0
    v_mov_b32 v14, 0
    s_mov_b64 exec, vcc
    v_mov_b32 v19, 3

    s_mov_b64 exec, -1
    v_alignbyte_b32 v12, v13, v12, v19
    v_alignbyte_b32 v13, v14, v13, v19
    v_add_u32 v18, v18, v19

    buffer_store_dwordx2 v[12:13], v18, s[24:27], 0 offen
    v_cmp_ne_u32_sdwa s[80:81], v21, v23 src0_sel:WORD_1 src1_sel:WORD_1
    v_cmp_ne_u32_sdwa vcc, v21, v25 src0_sel:WORD_1 src1_sel:WORD_1
    v_alignbyte_b32 v24, v25, v24, 2
    s_mov_b32 s54, 30717
    v_alignbyte_b32 v21, v21, v20, 1
    v_perm_b32 v20, v20, v24, s47
    s_waitcnt lgkmcnt(1)
    v_add3_u32 v26, v26, v106, s54
    v_sub_u32 v27, 0, v26
    v_and_b32 v27, 3, v27
    s_mov_b64 exec, s[80:81]
    v_mov_b32 v27, 0
    v_mov_b32 v22, 0
    s_mov_b64 exec, vcc
    v_mov_b32 v27, 3

    s_mov_b64 exec, -1
    v_alignbyte_b32 v20, v21, v20, v27
    v_alignbyte_b32 v21, v22, v21, v27
    v_add_u32 v26, v26, v27

    buffer_store_dwordx2 v[20:21], v26, s[24:27], 0 offen
    v_cmp_ne_u32_sdwa s[80:81], v29, v31 src0_sel:WORD_1 src1_sel:WORD_1
    v_cmp_ne_u32_sdwa vcc, v29, v33 src0_sel:WORD_1 src1_sel:WORD_1
    v_alignbyte_b32 v32, v33, v32, 2
    s_mov_b32 s54, 35837
    v_alignbyte_b32 v29, v29, v28, 1
    v_perm_b32 v28, v28, v32, s47
    s_waitcnt lgkmcnt(0)
    v_add3_u32 v34, v34, v106, s54
    v_sub_u32 v35, 0, v34
    v_and_b32 v35, 3, v35
    s_mov_b64 exec, s[80:81]
    v_mov_b32 v35, 0
    v_mov_b32 v30, 0
    s_mov_b64 exec, vcc
    v_mov_b32 v35, 3

    s_mov_b64 exec, -1
    v_alignbyte_b32 v28, v29, v28, v35
    v_alignbyte_b32 v29, v30, v29, v35
    v_add_u32 v34, v34, v35

    buffer_store_dwordx2 v[28:29], v34, s[24:27], 0 offen
L_skw_47:
    s_bitcmp0_b32 s28, 2
    s_cbranch_scc1 L_skw_48
    v_add_u32 v107, 65536, v2
    ds_read_b64 v[4:5], v107 offset:16400
    ds_read_b64 v[6:7], v107 offset:16408
    ds_read_b64 v[8:9], v107 offset:16392

    ds_read_b64 v[12:13], v107 offset:24592
    ds_read_b64 v[14:15], v107 offset:24600
    ds_read_b64 v[16:17], v107 offset:24584

    ds_read_b64 v[20:21], v107 offset:32784
    ds_read_b64 v[22:23], v107 offset:32792
    ds_read_b64 v[24:25], v107 offset:32776

    ds_read_b64 v[28:29], v107 offset:40976
    ds_read_b64 v[30:31], v107 offset:40984
    ds_read_b64 v[32:33], v107 offset:40968

    s_waitcnt lgkmcnt(9)
    v_lshrrev_b32 v10, 16, v5
    ds_read_b32 v10, v10 offset:8192

    s_waitcnt lgkmcnt(7)
    v_lshrrev_b32 v18, 16, v13
    ds_read_b32 v18, v18 offset:8192

    s_waitcnt lgkmcnt(5)
    v_lshrrev_b32 v26, 16, v21
    ds_read_b32 v26, v26 offset:8192

    s_waitcnt lgkmcnt(3)
    v_lshrrev_b32 v34, 16, v29
    ds_read_b32 v34, v34 offset:8192

    v_cmp_ne_u32_sdwa s[80:81], v5, v7 src0_sel:WORD_1 src1_sel:WORD_1
    v_cmp_ne_u32_sdwa vcc, v5, v9 src0_sel:WORD_1 src1_sel:WORD_1
    v_alignbyte_b32 v8, v9, v8, 2
    s_mov_b32 s54, 40957
    v_alignbyte_b32 v5, v5, v4, 1
    v_perm_b32 v4, v4, v8, s47
    s_waitcnt lgkmcnt(3)
    v_add3_u32 v10, v10, v106, s54
    v_sub_u32 v11, 0, v10
    v_and_b32 v11, 3, v11
    s_mov_b64 exec, s[80:81]
    v_mov_b32 v11, 0
    v_mov_b32 v6, 0
    s_mov_b64 exec, vcc
    v_mov_b32 v11, 3

    s_mov_b64 exec, -1
    v_alignbyte_b32 v4, v5, v4, v11
    v_alignbyte_b32 v5, v6, v5, v11
    v_add_u32 v10, v10, v11

    buffer_store_dwordx2 v[4:5], v10, s[24:27], 0 offen
    v_cmp_ne_u32_sdwa s[80:81], v13, v15 src0_sel:WORD_1 src1_sel:WORD_1
    v_cmp_ne_u32_sdwa vcc, v13, v17 src0_sel:WORD_1 src1_sel:WORD_1
    v_alignbyte_b32 v16, v17, v16, 2
    s_mov_b32 s54, 46077
    v_alignbyte_b32 v13, v13, v12, 1
    v_perm_b32 v12, v12, v16, s47
    s_waitcnt lgkmcnt(2)
    v_add3_u32 v18, v18, v106, s54
    v_sub_u32 v19, 0, v18
    v_and_b32 v19, 3, v19
    s_mov_b64 exec, s[80:81]
    v_mov_b32 v19, 0
    v_mov_b32 v14, 0
    s_mov_b64 exec, vcc
    v_mov_b32 v19, 3

    s_mov_b64 exec, -1
    v_alignbyte_b32 v12, v13, v12, v19
    v_alignbyte_b32 v13, v14, v13, v19
    v_add_u32 v18, v18, v19

    buffer_store_dwordx2 v[12:13], v18, s[24:27], 0 offen
    v_cmp_ne_u32_sdwa s[80:81], v21, v23 src0_sel:WORD_1 src1_sel:WORD_1
    v_cmp_ne_u32_sdwa vcc, v21, v25 src0_sel:WORD_1 src1_sel:WORD_1
    v_alignbyte_b32 v24, v25, v24, 2
    s_mov_b32 s54, 51197
    v_alignbyte_b32 v21, v21, v20, 1
    v_perm_b32 v20, v20, v24, s47
    s_waitcnt lgkmcnt(1)
    v_add3_u32 v26, v26, v106, s54
    v_sub_u32 v27, 0, v26
    v_and_b32 v27, 3, v27
    s_mov_b64 exec, s[80:81]
    v_mov_b32 v27, 0
    v_mov_b32 v22, 0
    s_mov_b64 exec, vcc
    v_mov_b32 v27, 3

    s_mov_b64 exec, -1
    v_alignbyte_b32 v20, v21, v20, v27
    v_alignbyte_b32 v21, v22, v21, v27
    v_add_u32 v26, v26, v27

    buffer_store_dwordx2 v[20:21], v26, s[24:27], 0 offen
    v_cmp_ne_u32_sdwa s[80:81], v29, v31 src0_sel:WORD_1 src1_sel:WORD_1
    v_cmp_ne_u32_sdwa vcc, v29, v33 src0_sel:WORD_1 src1_sel:WORD_1
    v_alignbyte_b32 v32, v33, v32, 2
    s_mov_b32 s54, 56317
    v_alignbyte_b32 v29, v29, v28, 1
    v_perm_b32 v28, v28, v32, s47
    s_waitcnt lgkmcnt(0)
    v_add3_u32 v34, v34, v106, s54
    v_sub_u32 v35, 0, v34
    v_and_b32 v35, 3, v35
    s_mov_b64 exec, s[80:81]
    v_mov_b32 v35, 0
    v_mov_b32 v30, 0
    s_mov_b64 exec, vcc
    v_mov_b32 v35, 3

    s_mov_b64 exec, -1
    v_alignbyte_b32 v28, v29, v28, v35
    v_alignbyte_b32 v29, v30, v29, v35
    v_add_u32 v34, v34, v35

    buffer_store_dwordx2 v[28:29], v34, s[24:27], 0 offen
L_skw_48:
    s_bitcmp0_b32 s28, 3
    s_cbranch_scc1 L_skw_49
    v_add_u32 v107, 98304, v2
    ds_read_b64 v[4:5], v107 offset:16400
    ds_read_b64 v[6:7], v107 offset:16408
    ds_read_b64 v[8:9], v107 offset:16392

    ds_read_b64 v[12:13], v107 offset:24592
    ds_read_b64 v[14:15], v107 offset:24600
    ds_read_b64 v[16:17], v107 offset:24584

    ds_read_b64 v[20:21], v107 offset:32784
    ds_read_b64 v[22:23], v107 offset:32792
    ds_read_b64 v[24:25], v107 offset:32776

    ds_read_b64 v[28:29], v107 offset:40976
    ds_read_b64 v[30:31], v107 offset:40984
    ds_read_b64 v[32:33], v107 offset:40968

    s_waitcnt lgkmcnt(9)
    v_lshrrev_b32 v10, 16, v5
    ds_read_b32 v10, v10 offset:8192

    s_waitcnt lgkmcnt(7)
    v_lshrrev_b32 v18, 16, v13
    ds_read_b32 v18, v18 offset:8192

    s_waitcnt lgkmcnt(5)
    v_lshrrev_b32 v26, 16, v21
    ds_read_b32 v26, v26 offset:8192

    s_waitcnt lgkmcnt(3)
    v_lshrrev_b32 v34, 16, v29
    ds_read_b32 v34, v34 offset:8192

    v_cmp_ne_u32_sdwa s[80:81], v5, v7 src0_sel:WORD_1 src1_sel:WORD_1
    v_cmp_ne_u32_sdwa vcc, v5, v9 src0_sel:WORD_1 src1_sel:WORD_1
    v_alignbyte_b32 v8, v9, v8, 2
    s_mov_b32 s54, 61437
    v_alignbyte_b32 v5, v5, v4, 1
    v_perm_b32 v4, v4, v8, s47
    s_waitcnt lgkmcnt(3)
    v_add3_u32 v10, v10, v106, s54
    v_sub_u32 v11, 0, v10
    v_and_b32 v11, 3, v11
    s_mov_b64 exec, s[80:81]
    v_mov_b32 v11, 0
    v_mov_b32 v6, 0
    s_mov_b64 exec, vcc
    v_mov_b32 v11, 3

    s_mov_b64 exec, -1
    v_alignbyte_b32 v4, v5, v4, v11
    v_alignbyte_b32 v5, v6, v5, v11
    v_add_u32 v10, v10, v11

    buffer_store_dwordx2 v[4:5], v10, s[24:27], 0 offen
    v_cmp_ne_u32_sdwa s[80:81], v13, v15 src0_sel:WORD_1 src1_sel:WORD_1
    v_cmp_ne_u32_sdwa vcc, v13, v17 src0_sel:WORD_1 src1_sel:WORD_1
    v_alignbyte_b32 v16, v17, v16, 2
    s_mov_b32 s54, 66557
    v_alignbyte_b32 v13, v13, v12, 1
    v_perm_b32 v12, v12, v16, s47
    s_waitcnt lgkmcnt(2)
    v_add3_u32 v18, v18, v106, s54
    v_sub_u32 v19, 0, v18
    v_and_b32 v19, 3, v19
    s_mov_b64 exec, s[80:81]
    v_mov_b32 v19, 0
    v_mov_b32 v14, 0
    s_mov_b64 exec, vcc
    v_mov_b32 v19, 3

    s_mov_b64 exec, -1
    v_alignbyte_b32 v12, v13, v12, v19
    v_alignbyte_b32 v13, v14, v13, v19
    v_add_u32 v18, v18, v19

    buffer_store_dwordx2 v[12:13], v18, s[24:27], 0 offen
    v_cmp_ne_u32_sdwa s[80:81], v21, v23 src0_sel:WORD_1 src1_sel:WORD_1
    v_cmp_ne_u32_sdwa vcc, v21, v25 src0_sel:WORD_1 src1_sel:WORD_1
    v_alignbyte_b32 v24, v25, v24, 2
    s_mov_b32 s54, 71677
    v_alignbyte_b32 v21, v21, v20, 1
    v_perm_b32 v20, v20, v24, s47
    s_waitcnt lgkmcnt(1)
    v_add3_u32 v26, v26, v106, s54
    v_sub_u32 v27, 0, v26
    v_and_b32 v27, 3, v27
    s_mov_b64 exec, s[80:81]
    v_mov_b32 v27, 0
    v_mov_b32 v22, 0
    s_mov_b64 exec, vcc
    v_mov_b32 v27, 3

    s_mov_b64 exec, -1
    v_alignbyte_b32 v20, v21, v20, v27
    v_alignbyte_b32 v21, v22, v21, v27
    v_add_u32 v26, v26, v27

    buffer_store_dwordx2 v[20:21], v26, s[24:27], 0 offen
    v_cmp_ne_u32_sdwa s[80:81], v29, v31 src0_sel:WORD_1 src1_sel:WORD_1
    v_cmp_ne_u32_sdwa vcc, v29, v33 src0_sel:WORD_1 src1_sel:WORD_1
    v_alignbyte_b32 v32, v33, v32, 2
    s_mov_b32 s54, 76797
    v_alignbyte_b32 v29, v29, v28, 1
    v_perm_b32 v28, v28, v32, s47
    s_waitcnt lgkmcnt(0)
    v_add3_u32 v34, v34, v106, s54
    v_sub_u32 v35, 0, v34
    v_and_b32 v35, 3, v35
    s_mov_b64 exec, s[80:81]
    v_mov_b32 v35, 0
    v_mov_b32 v30, 0
    s_mov_b64 exec, vcc
    v_mov_b32 v35, 3

    s_andn2_b64 exec, -1, s[68:69]
    v_bfrev_b32 v34, 1
    s_mov_b64 exec, -1
    v_alignbyte_b32 v28, v29, v28, v35
    v_alignbyte_b32 v29, v30, v29, v35
    v_add_u32 v34, v34, v35

    buffer_store_dwordx2 v[28:29], v34, s[24:27], 0 offen
L_skw_49:
L_p1done_1:
    s_endpgm

L_slow_22:
    v_add_u32 v112, s29, v0
    v_mov_b32 v118, 0
    s_mov_b32 s75, 4960
L_sl_24:
    v_lshlrev_b32 v113, 3, v112
    ds_read_b64 v[110:111], v113 offset:16400
    ds_read_b32 v119, v113 offset:16412
    ds_read_b32 v120, v113 offset:16396
    s_waitcnt lgkmcnt(0)
    v_lshrrev_b32 v114, 16, v111
    ds_read_b32 v115, v114 offset:8192
    v_add_u32 v114, 4, v114
    v_mul_u32_u24 v114, s75, v114
    s_waitcnt lgkmcnt(0)
    v_mad_u32_u24 v115, v112, 5, v115
    v_cmp_gt_u32 s[72:73], s30, v112
    v_cmp_ge_u32 vcc, v115, v114
    s_and_b64 s[80:81], vcc, s[72:73]
    s_cbranch_scc0 L_s1_25
    s_bcnt1_i32_b64 s76, s[80:81]
    v_mbcnt_lo_u32_b32 v117, s80, 0
    v_mbcnt_hi_u32_b32 v117, s81, v117
    v_mov_b32 v116, s76
    s_mov_b64 exec, 1
    buffer_atomic_add v116, v118, s[36:39], 0 offen sc0
    s_waitcnt vmcnt(0)
    v_readfirstlane_b32 s76, v116
    s_mov_b64 exec, s[80:81]
    s_nop 0
    v_add_lshl_u32 v116, v117, s76, 3
    buffer_store_dwordx2 v[110:111], v116, s[32:35], 0 offen
L_s1_25:
    s_andn2_b64 exec, s[72:73], vcc
    s_cbranch_execz L_s2_26
    buffer_store_dword v110, v115, s[24:27], 0 offen
    buffer_store_byte v111, v115, s[24:27], 0 offen offset:4
    v_add_u32 v115, 5, v115
    v_cmpx_lt_u32 vcc, v115, v114
    v_cmpx_ne_u32_sdwa vcc, v111, v119 src0_sel:WORD_1 src1_sel:WORD_1
    v_cmpx_ne_u32_sdwa vcc, v111, v120 src0_sel:WORD_1 src1_sel:WORD_1
    s_cbranch_execz L_s2_26
    buffer_store_dword v118, v115, s[24:27], 0 offen
L_s2_26:
    s_mov_b64 exec, -1
    v_add_u32 v112, 1024, v112
    s_nop 0
    v_readfirstlane_b32 s76, v112
    s_nop 1
    s_cmp_lt_u32 s76, s30
    s_cbranch_scc1 L_sl_24
    s_mov_b32 s28, 0
    s_branch L_sback_23

L_slow_41:
    v_add_u32 v112, s29, v0
    v_mov_b32 v118, 0
    s_mov_b32 s75, 4960
L_sl_43:
    v_lshlrev_b32 v113, 3, v112
    ds_read_b64 v[110:111], v113 offset:16400
    ds_read_b32 v119, v113 offset:16412
    ds_read_b32 v120, v113 offset:16396
    s_waitcnt lgkmcnt(0)
    v_lshrrev_b32 v114, 16, v111
    ds_read_b32 v115, v114 offset:8192
    v_add_u32 v114, 4, v114
    v_mul_u32_u24 v114, s75, v114
    s_waitcnt lgkmcnt(0)
    v_mad_u32_u24 v115, v112, 5, v115
    v_cmp_gt_u32 s[72:73], s30, v112
    v_cmp_ge_u32 vcc, v115, v114
    s_and_b64 s[80:81], vcc, s[72:73]
    s_cbranch_scc0 L_s1_44
    s_bcnt1_i32_b64 s76, s[80:81]
    v_mbcnt_lo_u32_b32 v117, s80, 0
    v_mbcnt_hi_u32_b32 v117, s81, v117
    v_mov_b32 v116, s76
    s_mov_b64 exec, 1
    buffer_atomic_add v116, v118, s[36:39], 0 offen sc0
    s_waitcnt vmcnt(0)
    v_readfirstlane_b32 s76, v116
    s_mov_b64 exec, s[80:81]
    s_nop 0
    v_add_lshl_u32 v116, v117, s76, 3
    buffer_store_dwordx2 v[110:111], v116, s[32:35], 0 offen
L_s1_44:
    s_andn2_b64 exec, s[72:73], vcc
    s_cbranch_execz L_s2_45
    buffer_store_dword v110, v115, s[24:27], 0 offen
    buffer_store_byte v111, v115, s[24:27], 0 offen offset:4
    v_add_u32 v115, 5, v115
    v_cmpx_lt_u32 vcc, v115, v114
    v_cmpx_ne_u32_sdwa vcc, v111, v119 src0_sel:WORD_1 src1_sel:WORD_1
    v_cmpx_ne_u32_sdwa vcc, v111, v120 src0_sel:WORD_1 src1_sel:WORD_1
    s_cbranch_execz L_s2_45
    buffer_store_dword v118, v115, s[24:27], 0 offen
L_s2_45:
    s_mov_b64 exec, -1
    v_add_u32 v112, 1024, v112
    s_nop 0
    v_readfirstlane_b32 s76, v112
    s_nop 1
    s_cmp_lt_u32 s76, s30
    s_cbranch_scc1 L_sl_43
    s_mov_b32 s28, 0
    s_branch L_sback_42

.globl g2_kernel
.p2align 8
.type g2_kernel,@function
g2_kernel:
    s_cmp_ge_u32 s2, 256
    s_cbranch_scc1 L_p2done_50
    s_load_dwordx2 s[8:9], s[0:1], 0
    s_load_dwordx2 s[6:7], s[0:1], 104
    v_lshrrev_b32 v4, 6, v0
    s_lshr_b32 s37, s2, 1
    s_and_b32 s37, s37, 3
    s_lshr_b32 s36, s2, 3
    s_lshl_b32 s36, s36, 1
    s_and_b32 s3, s2, 1
    s_or_b32 s36, s36, s3
    v_readfirstlane_b32 s4, v4
    v_and_b32 v2, 63, v0
    v_lshrrev_b32 v3, 9, v0
    v_lshl_or_b32 v2, v3, 6, v2
    v_mul_u32_u24 v2, 20, v2
    v_lshlrev_b32 v3, 4, v0
    s_waitcnt lgkmcnt(0)
    s_lshl_b32 m0, s4, 10
    s_and_b32 s5, s4, 7
    s_lshr_b32 s39, s4, 3
    s_lshl_b32 s39, s39, 8
    s_mul_i32 s3, s5, 8192
    s_add_u32 s46, s6, s3
    s_addc_u32 s47, s7, 0
    s_mul_i32 s3, s5, 40632320
    s_add_u32 s3, s3, 83599360
    s_add_u32 s44, s6, s3
    s_addc_u32 s45, s7, 0
    s_mul_i32 s38, s37, 8
    s_add_u32 s4, s38, 8
    s_lshl_b32 s3, s38, 6
    s_add_u32 s3, s3, s36
    s_lshl_b32 s3, s3, 2
    s_add_u32 s52, s46, s3
    s_addc_u32 s53, s47, 0

    s_load_dword s88, s[52:53], 0
    s_load_dword s89, s[52:53], 256
    s_load_dword s90, s[52:53], 512
    s_load_dword s91, s[52:53], 768
    s_load_dword s92, s[52:53], 1024
    s_load_dword s93, s[52:53], 1280
    s_load_dword s94, s[52:53], 1536
    s_load_dword s95, s[52:53], 1792
    s_mov_b32 s3, 65536
    s_load_dword s51, s[6:7], s3
    s_mov_b32 s10, 6400000
    s_mov_b32 s11, 0x20000

    s_add_u32 s12, s6, 393216
    s_addc_u32 s13, s7, 0
    s_mov_b32 s14, 0
    s_mov_b32 s15, 0x20000
    s_add_u32 s60, s6, 393216
    s_addc_u32 s61, s7, 0
    s_mov_b32 s62, 6406144
    s_mov_b32 s63, 0x20000
    s_mov_b32 s3, 135176
    s_load_dword s33, s[6:7], s3

    s_mul_i32 s43, s38, 200192
    s_mul_i32 s41, s4, 200192
    s_mul_i32 s50, s38, 200000
    s_add_u32 s14, s43, 50000

    buffer_load_dwordx4 v[76:79], v3, s[12:15], s43 offen
    s_add_u32 s52, s43, 16384
    buffer_load_dwordx4 v[80:83], v3, s[12:15], s52 offen
    s_add_u32 s52, s43, 32768
    buffer_load_dwordx4 v[84:87], v3, s[12:15], s52 offen
    s_add_u32 s52, s43, 49152
    v_lshlrev_b32 v119, 2, v0
    buffer_load_dword v88, v119, s[12:15], s52 offen
    s_add_u32 s20, s6, 135168
    s_addc_u32 s21, s7, 0
    s_mov_b32 s22, 4096
    s_mov_b32 s23, 0x20000
    v_and_b32 v44, 63, v0
    v_lshlrev_b32 v44, 4, v44
    buffer_load_dwordx2 v[120:121], v44, s[20:23], 0 offen offset:0
    buffer_load_dwordx2 v[122:123], v44, s[20:23], 0 offen offset:1024
    buffer_load_dwordx2 v[124:125], v44, s[20:23], 0 offen offset:2048
    buffer_load_dwordx2 v[126:127], v44, s[20:23], 0 offen offset:3072
    s_lshr_b32 s3, s2, 3
    s_mul_i32 s3, s3, 49
    v_add_lshl_u32 v89, v0, s3, 7
    v_cmp_gt_u32 vcc, 49, v0
    v_bfrev_b32 v28, 1
    s_nop 0
    v_cndmask_b32 v89, v28, v89, vcc

    s_mov_b32 s19, 0x20000
    s_mov_b32 s28, 0x4b404000
    s_mov_b32 s29, 0x4b404000
    s_mov_b32 s30, 0xbfffc000
    s_mov_b32 s31, 0xbfffbfff
    s_mov_b32 s32, 0xffff0000
    s_mov_b32 s35, 0x05040100
    s_mov_b32 s97, 0x07060302
    s_mov_b32 s96, 0x40008000
    s_movk_i32 s3, 212
    v_cmp_gt_u32 s[48:49], s3, v0

    v_mov_b32 v1, 0
    s_mov_b32 s24, 0xc0c0004
    s_mov_b32 s25, 0xc0c0105
    s_mov_b32 s26, 0xc0c0206
    s_mov_b32 s27, 0xc0c0307
    s_waitcnt lgkmcnt(0)
    s_min_u32 s88, s88, 3968
    s_lshl_b32 s52, s38, 6
    s_add_u32 s52, s52, s36
    s_mul_i32 s52, s52, 19840
    s_add_u32 s16, s44, s52
    s_addc_u32 s17, s45, 0
    s_mul_i32 s52, s88, 5
    s_add_u32 s52, s52, 3
    s_and_b32 s18, s52, -4

    s_movk_i32 s53, 5120
    buffer_load_dwordx4 v[90:93], v2, s[16:19], s53 offen
    buffer_load_dword v110, v2, s[16:19], s53 offen offset:16
    s_movk_i32 s53, 7680
    buffer_load_dwordx4 v[94:97], v2, s[16:19], s53 offen
    buffer_load_dword v111, v2, s[16:19], s53 offen offset:16
    s_movk_i32 s53, 10240
    buffer_load_dwordx4 v[98:101], v2, s[16:19], s53 offen
    buffer_load_dword v112, v2, s[16:19], s53 offen offset:16
    s_movk_i32 s53, 12800
    buffer_load_dwordx4 v[102:105], v2, s[16:19], s53 offen
    buffer_load_dword v113, v2, s[16:19], s53 offen offset:16
    s_movk_i32 s53, 0
    buffer_load_dwordx4 v[4:7], v2, s[16:19], s53 offen
    buffer_load_dword v35, v2, s[16:19], s53 offen offset:16
    s_movk_i32 s53, 2560
    buffer_load_dwordx4 v[8:11], v2, s[16:19], s53 offen
    buffer_load_dword v43, v2, s[16:19], s53 offen offset:16
    s_movk_i32 s53, 15360
    buffer_load_dwordx4 v[106:109], v2, s[16:19], s53 offen
    buffer_load_dword v114, v2, s[16:19], s53 offen offset:16
    v_mov_b32 v28, 0x40004000
    v_mov_b32 v29, 0x40004000
    v_mov_b32 v30, 0x40004000
    v_mov_b32 v31, 0x40004000
    v_add_u32 v32, 50000, v3
    v_add_u32 v33, 65536, v32

    ds_write_b128 v32, v[28:31] offset:0
    ds_write_b128 v32, v[28:31] offset:16384
    ds_write_b128 v32, v[28:31] offset:32768
    ds_write_b128 v32, v[28:31] offset:49152
    ds_write_b128 v33, v[28:31] offset:0
    ds_write_b128 v33, v[28:31] offset:16384
    v_cmp_gt_u32 vcc, 971, v0
    s_mov_b64 exec, vcc
    ds_write_b128 v33, v[28:31] offset:32768
    s_mov_b64 exec, -1
    s_waitcnt vmcnt(21)
    ds_write_addtid_b32 v76 offset:0
    ds_write_addtid_b32 v77 offset:256
    ds_write_addtid_b32 v78 offset:512
    ds_write_addtid_b32 v79 offset:768
    s_waitcnt vmcnt(20)
    ds_write_addtid_b32 v80 offset:16384
    ds_write_addtid_b32 v81 offset:16640
    ds_write_addtid_b32 v82 offset:16896
    ds_write_addtid_b32 v83 offset:17152
    s_waitcnt vmcnt(19)
    ds_write_addtid_b32 v84 offset:32768
    ds_write_addtid_b32 v85 offset:33024
    ds_write_addtid_b32 v86 offset:33280
    ds_write_addtid_b32 v87 offset:33536
    v_lshlrev_b32 v119, 2, v0
    s_waitcnt vmcnt(18)
    s_mov_b64 exec, s[48:49]
    ds_write_b32 v119, v88 offset:49152
    s_mov_b64 exec, -1
    s_add_u32 s43, s43, 50048
    s_add_u32 s14, s43, 50000
    s_min_u32 s14, s14, s41
    buffer_load_dwordx4 v[76:79], v3, s[12:15], s43 offen
    s_add_u32 s52, s43, 16384
    buffer_load_dwordx4 v[80:83], v3, s[12:15], s52 offen
    s_add_u32 s52, s43, 32768
    buffer_load_dwordx4 v[84:87], v3, s[12:15], s52 offen
    s_add_u32 s52, s43, 49152
    v_lshlrev_b32 v119, 2, v0
    buffer_load_dword v88, v119, s[12:15], s52 offen
    s_add_u32 s54, s43, 50048
    buffer_load_dword v115, v89, s[60:63], s54 offen
    s_add_u32 s54, s50, 0
    buffer_load_dword v115, v89, s[8:11], s54 offen
    s_waitcnt vmcnt(20)
    v_max3_u32 v120, v120, v122, v124
    v_add_f32 v121, v121, v123
    v_add_f32 v125, v125, v127
    v_max_u32 v120, v120, v126
    v_add_f32 v121, v121, v125

    s_nop 1
    v_max_u32_dpp v120, v120, v120 row_shr:1 row_mask:0xf bank_mask:0xf
    s_nop 1
    v_max_u32_dpp v120, v120, v120 row_shr:2 row_mask:0xf bank_mask:0xf
    s_nop 1
    v_max_u32_dpp v120, v120, v120 row_shr:4 row_mask:0xf bank_mask:0xf
    s_nop 1
    v_max_u32_dpp v120, v120, v120 row_shr:8 row_mask:0xf bank_mask:0xf
    s_nop 1
    v_max_u32_dpp v120, v120, v120 row_bcast:15 row_mask:0xa bank_mask:0xf
    s_nop 1
    v_max_u32_dpp v120, v120, v120 row_bcast:31 row_mask:0xc bank_mask:0xf
    s_nop 1
    v_add_f32_dpp v121, v121, v121 row_shr:1 row_mask:0xf bank_mask:0xf
    s_nop 1
    v_add_f32_dpp v121, v121, v121 row_shr:2 row_mask:0xf bank_mask:0xf
    s_nop 1
    v_add_f32_dpp v121, v121, v121 row_shr:4 row_mask:0xf bank_mask:0xf
    s_nop 1
    v_add_f32_dpp v121, v121, v121 row_shr:8 row_mask:0xf bank_mask:0xf
    s_nop 1
    v_add_f32_dpp v121, v121, v121 row_bcast:15 row_mask:0xa bank_mask:0xf
    s_nop 1
    v_add_f32_dpp v121, v121, v121 row_bcast:31 row_mask:0xc bank_mask:0xf
    v_lshlrev_b32 v120, 16, v120
    v_mul_f32 v121, 0x34a7c5ac, v121
    v_sqrt_f32 v121, v121
    v_mul_f32 v120, s33, v120
    v_mul_f32 v121, s33, v121
    v_cmp_gt_f32 vcc, 0x46fde800, v120
    s_mov_b64 s[64:65], vcc
    v_cmp_lt_f32 vcc, 0x44000000, v121
    v_mov_b32 v120, 0x37800000
    v_mul_f32 v120, s33, v120
    s_and_b64 vcc, vcc, s[64:65]
    v_mul_f32 v121, 0x46ff8000, v120
    v_rcp_f32 v121, v121
    v_readfirstlane_b32 s33, v120
    s_waitcnt lgkmcnt(0)
    s_barrier
    v_readfirstlane_b32 s34, v121
    v_mov_b32 v120, 150016
    v_mov_b32 v121, 0
    ds_write_b32 v120, v121 offset:8
    s_bitcmp0_b64 vcc, 63
    s_cbranch_scc1 L_p2slow_51
    s_cmp_lg_u32 s51, 0
    s_cbranch_scc1 L_p2slow_51

    s_mov_b32 s40, s88
    s_sub_u32 s42, s40, s39

    s_add_u32 s55, s38, 1
    s_min_u32 s55, s55, 31
    s_mov_b32 s88, s89
    s_mov_b32 s89, s90
    s_mov_b32 s90, s91
    s_mov_b32 s91, s92
    s_mov_b32 s92, s93
    s_mov_b32 s93, s94
    s_mov_b32 s94, s95
    s_mov_b32 s95, 0
    s_min_u32 s88, s88, 3968
    s_lshl_b32 s52, s55, 6
    s_add_u32 s52, s52, s36
    s_mul_i32 s52, s52, 19840
    s_add_u32 s16, s44, s52
    s_addc_u32 s17, s45, 0
    s_mul_i32 s52, s88, 5
    s_add_u32 s52, s52, 3
    s_and_b32 s18, s52, -4

    s_waitcnt vmcnt(18)
    v_perm_b32 v44, v91, v90, s24
    v_perm_b32 v46, v92, v91, s25
    v_perm_b32 v48, v93, v92, s26
    v_perm_b32 v50, v110, v93, s27
    v_mov_b32 v12, v90
    v_alignbyte_b32 v13, v92, v91, 1
    v_alignbyte_b32 v14, v93, v92, 2
    v_alignbyte_b32 v15, v110, v93, 3
    v_lshlrev_b32_sdwa v44, 3, v44 dst_sel:WORD_0 dst_unused:UNUSED_PAD src0_sel:DWORD src1_sel:DWORD
    v_lshlrev_b32_sdwa v46, 3, v46 dst_sel:WORD_0 dst_unused:UNUSED_PAD src0_sel:DWORD src1_sel:DWORD
    v_lshlrev_b32_sdwa v48, 3, v48 dst_sel:WORD_0 dst_unused:UNUSED_PAD src0_sel:DWORD src1_sel:DWORD
    v_lshlrev_b32_sdwa v50, 3, v50 dst_sel:WORD_0 dst_unused:UNUSED_PAD src0_sel:DWORD src1_sel:DWORD
    s_cmp_lt_i32 s42, 1280
    s_cbranch_scc1 L_ufix_52
L_uback_53:

    v_subrev_co_u32 v12, s[80:81], 2.0, v12
    v_subrev_co_u32 v13, s[82:83], 2.0, v13
    v_subrev_co_u32 v14, s[84:85], 2.0, v14
    v_subrev_co_u32 v15, s[86:87], 2.0, v15
    s_mov_b64 exec, s[80:81]
    ds_read_b64 v[44:45], v44
    s_mov_b64 exec, s[82:83]
    ds_read_b64 v[46:47], v46
    s_mov_b64 exec, s[84:85]
    ds_read_b64 v[48:49], v48
    s_mov_b64 exec, s[86:87]
    ds_read_b64 v[50:51], v50
    s_mov_b64 exec, -1
    s_waitcnt vmcnt(16)
    v_perm_b32 v52, v95, v94, s24
    v_perm_b32 v54, v96, v95, s25
    v_perm_b32 v56, v97, v96, s26
    v_perm_b32 v58, v111, v97, s27
    v_mov_b32 v16, v94
    v_alignbyte_b32 v17, v96, v95, 1
    v_alignbyte_b32 v18, v97, v96, 2
    v_alignbyte_b32 v19, v111, v97, 3
    v_lshlrev_b32_sdwa v52, 3, v52 dst_sel:WORD_0 dst_unused:UNUSED_PAD src0_sel:DWORD src1_sel:DWORD
    v_lshlrev_b32_sdwa v54, 3, v54 dst_sel:WORD_0 dst_unused:UNUSED_PAD src0_sel:DWORD src1_sel:DWORD
    v_lshlrev_b32_sdwa v56, 3, v56 dst_sel:WORD_0 dst_unused:UNUSED_PAD src0_sel:DWORD src1_sel:DWORD
    v_lshlrev_b32_sdwa v58, 3, v58 dst_sel:WORD_0 dst_unused:UNUSED_PAD src0_sel:DWORD src1_sel:DWORD
    s_cmp_lt_i32 s42, 1792
    s_cbranch_scc1 L_ufix_54
L_uback_55:

    v_subrev_co_u32 v16, s[64:65], 2.0, v16
    v_subrev_co_u32 v17, s[66:67], 2.0, v17
    v_subrev_co_u32 v18, s[68:69], 2.0, v18
    v_subrev_co_u32 v19, s[70:71], 2.0, v19
    s_mov_b64 exec, s[64:65]
    ds_read_b64 v[52:53], v52
    s_mov_b64 exec, s[66:67]
    ds_read_b64 v[54:55], v54
    s_mov_b64 exec, s[68:69]
    ds_read_b64 v[56:57], v56
    s_mov_b64 exec, s[70:71]
    ds_read_b64 v[58:59], v58
    s_mov_b64 exec, -1
    s_waitcnt vmcnt(14)
    v_perm_b32 v60, v99, v98, s24
    v_perm_b32 v62, v100, v99, s25
    v_perm_b32 v64, v101, v100, s26
    v_perm_b32 v66, v112, v101, s27
    v_mov_b32 v20, v98
    v_alignbyte_b32 v21, v100, v99, 1
    v_alignbyte_b32 v22, v101, v100, 2
    v_alignbyte_b32 v23, v112, v101, 3
    v_lshlrev_b32_sdwa v60, 3, v60 dst_sel:WORD_0 dst_unused:UNUSED_PAD src0_sel:DWORD src1_sel:DWORD
    v_lshlrev_b32_sdwa v62, 3, v62 dst_sel:WORD_0 dst_unused:UNUSED_PAD src0_sel:DWORD src1_sel:DWORD
    v_lshlrev_b32_sdwa v64, 3, v64 dst_sel:WORD_0 dst_unused:UNUSED_PAD src0_sel:DWORD src1_sel:DWORD
    v_lshlrev_b32_sdwa v66, 3, v66 dst_sel:WORD_0 dst_unused:UNUSED_PAD src0_sel:DWORD src1_sel:DWORD
    s_cmp_lt_i32 s42, 2304
    s_cbranch_scc1 L_ufix_56
L_uback_57:

    v_subrev_co_u32 v20, s[72:73], 2.0, v20
    v_subrev_co_u32 v21, s[74:75], 2.0, v21
    v_subrev_co_u32 v22, s[76:77], 2.0, v22
    v_subrev_co_u32 v23, s[78:79], 2.0, v23
    s_mov_b64 exec, s[72:73]
    ds_read_b64 v[60:61], v60
    s_mov_b64 exec, s[74:75]
    ds_read_b64 v[62:63], v62
    s_mov_b64 exec, s[76:77]
    ds_read_b64 v[64:65], v64
    s_mov_b64 exec, s[78:79]
    ds_read_b64 v[66:67], v66
    s_mov_b64 exec, -1
    s_waitcnt vmcnt(12)
    v_perm_b32 v68, v103, v102, s24
    v_perm_b32 v70, v104, v103, s25
    v_perm_b32 v72, v105, v104, s26
    v_perm_b32 v74, v113, v105, s27
    v_mov_b32 v24, v102
    v_alignbyte_b32 v25, v104, v103, 1
    v_alignbyte_b32 v26, v105, v104, 2
    v_alignbyte_b32 v27, v113, v105, 3
    v_lshlrev_b32_sdwa v68, 3, v68 dst_sel:WORD_0 dst_unused:UNUSED_PAD src0_sel:DWORD src1_sel:DWORD
    v_lshlrev_b32_sdwa v70, 3, v70 dst_sel:WORD_0 dst_unused:UNUSED_PAD src0_sel:DWORD src1_sel:DWORD
    v_lshlrev_b32_sdwa v72, 3, v72 dst_sel:WORD_0 dst_unused:UNUSED_PAD src0_sel:DWORD src1_sel:DWORD
    v_lshlrev_b32_sdwa v74, 3, v74 dst_sel:WORD_0 dst_unused:UNUSED_PAD src0_sel:DWORD src1_sel:DWORD
    s_cmp_lt_i32 s42, 2816
    s_cbranch_scc1 L_ufix_58
L_uback_59:

    v_subrev_co_u32 v24, s[80:81], 2.0, v24
    v_subrev_co_u32 v25, s[82:83], 2.0, v25
    v_subrev_co_u32 v26, s[84:85], 2.0, v26
    v_subrev_co_u32 v27, s[86:87], 2.0, v27
    s_mov_b64 exec, s[80:81]
    ds_read_b64 v[68:69], v68
    s_mov_b64 exec, s[82:83]
    ds_read_b64 v[70:71], v70
    s_mov_b64 exec, s[84:85]
    ds_read_b64 v[72:73], v72
    s_mov_b64 exec, s[86:87]
    ds_read_b64 v[74:75], v74
    s_mov_b64 exec, -1
    s_waitcnt vmcnt(10)
    v_perm_b32 v28, v5, v4, s24
    v_perm_b32 v30, v6, v5, s25
    v_perm_b32 v32, v7, v6, s26
    v_perm_b32 v34, v35, v7, s27
    v_alignbyte_b32 v5, v6, v5, 1
    v_alignbyte_b32 v6, v7, v6, 2
    v_alignbyte_b32 v7, v35, v7, 3
    v_lshlrev_b32_sdwa v28, 3, v28 dst_sel:WORD_0 dst_unused:UNUSED_PAD src0_sel:DWORD src1_sel:DWORD
    v_lshlrev_b32_sdwa v30, 3, v30 dst_sel:WORD_0 dst_unused:UNUSED_PAD src0_sel:DWORD src1_sel:DWORD
    v_lshlrev_b32_sdwa v32, 3, v32 dst_sel:WORD_0 dst_unused:UNUSED_PAD src0_sel:DWORD src1_sel:DWORD
    v_lshlrev_b32_sdwa v34, 3, v34 dst_sel:WORD_0 dst_unused:UNUSED_PAD src0_sel:DWORD src1_sel:DWORD
    s_cmp_lt_i32 s42, 256
    s_cbranch_scc1 L_ufix_60
L_uback_61:

    v_subrev_co_u32 v4, s[64:65], 2.0, v4
    v_subrev_co_u32 v5, s[66:67], 2.0, v5
    v_subrev_co_u32 v6, s[68:69], 2.0, v6
    v_subrev_co_u32 v7, s[70:71], 2.0, v7
    s_mov_b64 exec, s[64:65]
    ds_read_b64 v[28:29], v28
    s_mov_b64 exec, s[66:67]
    ds_read_b64 v[30:31], v30
    s_mov_b64 exec, s[68:69]
    ds_read_b64 v[32:33], v32
    s_mov_b64 exec, s[70:71]
    ds_read_b64 v[34:35], v34
    s_mov_b64 exec, -1
    s_waitcnt vmcnt(8)
    v_perm_b32 v36, v9, v8, s24
    v_perm_b32 v38, v10, v9, s25
    v_perm_b32 v40, v11, v10, s26
    v_perm_b32 v42, v43, v11, s27
    v_alignbyte_b32 v9, v10, v9, 1
    v_alignbyte_b32 v10, v11, v10, 2
    v_alignbyte_b32 v11, v43, v11, 3
    v_lshlrev_b32_sdwa v36, 3, v36 dst_sel:WORD_0 dst_unused:UNUSED_PAD src0_sel:DWORD src1_sel:DWORD
    v_lshlrev_b32_sdwa v38, 3, v38 dst_sel:WORD_0 dst_unused:UNUSED_PAD src0_sel:DWORD src1_sel:DWORD
    v_lshlrev_b32_sdwa v40, 3, v40 dst_sel:WORD_0 dst_unused:UNUSED_PAD src0_sel:DWORD src1_sel:DWORD
    v_lshlrev_b32_sdwa v42, 3, v42 dst_sel:WORD_0 dst_unused:UNUSED_PAD src0_sel:DWORD src1_sel:DWORD
    s_cmp_lt_i32 s42, 768
    s_cbranch_scc1 L_ufix_62
L_uback_63:

    v_subrev_co_u32 v8, s[72:73], 2.0, v8
    v_subrev_co_u32 v9, s[74:75], 2.0, v9
    v_subrev_co_u32 v10, s[76:77], 2.0, v10
    v_subrev_co_u32 v11, s[78:79], 2.0, v11
    s_mov_b64 exec, s[72:73]
    ds_read_b64 v[36:37], v36
    s_mov_b64 exec, s[74:75]
    ds_read_b64 v[38:39], v38
    s_mov_b64 exec, s[76:77]
    ds_read_b64 v[40:41], v40
    s_mov_b64 exec, s[78:79]
    ds_read_b64 v[42:43], v42
    s_mov_b64 exec, -1
L_batch_64:
    s_add_u32 s5, s38, 1

    s_movk_i32 s53, 5120
    buffer_load_dwordx4 v[90:93], v2, s[16:19], s53 offen
    buffer_load_dword v110, v2, s[16:19], s53 offen offset:16
    s_waitcnt lgkmcnt(0)
    s_barrier
    s_waitcnt vmcnt(7)
    ds_write_addtid_b32 v76 offset:0
    ds_write_addtid_b32 v77 offset:256
    ds_write_addtid_b32 v78 offset:512
    ds_write_addtid_b32 v79 offset:768
    s_waitcnt vmcnt(6)
    ds_write_addtid_b32 v80 offset:16384
    ds_write_addtid_b32 v81 offset:16640
    ds_write_addtid_b32 v82 offset:16896
    ds_write_addtid_b32 v83 offset:17152
    s_waitcnt vmcnt(5)
    ds_write_addtid_b32 v84 offset:32768
    ds_write_addtid_b32 v85 offset:33024
    ds_write_addtid_b32 v86 offset:33280
    ds_write_addtid_b32 v87 offset:33536
    v_lshlrev_b32 v119, 2, v0
    s_waitcnt vmcnt(4)
    s_mov_b64 exec, s[48:49]
    ds_write_b32 v119, v88 offset:49152
    s_mov_b64 exec, -1
    s_add_u32 s43, s43, 50048
    s_add_u32 s14, s43, 50000
    s_min_u32 s14, s14, s41
    buffer_load_dwordx4 v[76:79], v3, s[12:15], s43 offen
    s_add_u32 s52, s43, 16384
    buffer_load_dwordx4 v[80:83], v3, s[12:15], s52 offen
    v_subrev_co_u32 v4, s[64:65], 2.0, v4
    v_subrev_co_u32 v5, s[66:67], 2.0, v5
    v_subrev_co_u32 v6, s[68:69], 2.0, v6
    v_subrev_co_u32 v7, s[70:71], 2.0, v7
    v_subrev_co_u32 v8, s[72:73], 2.0, v8
    v_subrev_co_u32 v9, s[74:75], 2.0, v9
    v_subrev_co_u32 v10, s[76:77], 2.0, v10
    v_subrev_co_u32 v11, s[78:79], 2.0, v11
    v_subrev_co_u32 v12, s[80:81], 2.0, v12
    v_subrev_co_u32 v13, s[82:83], 2.0, v13
    v_subrev_co_u32 v14, s[84:85], 2.0, v14
    v_subrev_co_u32 v15, s[86:87], 2.0, v15
    s_waitcnt lgkmcnt(0)
    s_barrier
    s_add_u32 s52, s43, 32768
    buffer_load_dwordx4 v[84:87], v3, s[12:15], s52 offen
    s_add_u32 s52, s43, 49152
    v_lshlrev_b32 v119, 2, v0
    buffer_load_dword v88, v119, s[12:15], s52 offen
    s_mov_b64 exec, s[64:65]
    ds_read_b64 v[28:29], v28
    s_mov_b64 exec, s[66:67]
    ds_read_b64 v[30:31], v30
    s_mov_b64 exec, s[68:69]
    ds_read_b64 v[32:33], v32
    s_mov_b64 exec, s[70:71]
    ds_read_b64 v[34:35], v34
    s_mov_b64 exec, s[72:73]
    ds_read_b64 v[36:37], v36
    s_mov_b64 exec, s[74:75]
    ds_read_b64 v[38:39], v38
    s_mov_b64 exec, s[76:77]
    ds_read_b64 v[40:41], v40
    s_mov_b64 exec, s[78:79]
    ds_read_b64 v[42:43], v42
    s_mov_b64 exec, s[80:81]
    ds_read_b64 v[44:45], v44
    s_mov_b64 exec, s[82:83]
    ds_read_b64 v[46:47], v46
    s_mov_b64 exec, s[84:85]
    ds_read_b64 v[48:49], v48
    s_mov_b64 exec, s[86:87]
    ds_read_b64 v[50:51], v50
    s_mov_b64 exec, -1
    v_subrev_co_u32 v16, s[64:65], 2.0, v16
    v_subrev_co_u32 v17, s[66:67], 2.0, v17
    v_subrev_co_u32 v18, s[68:69], 2.0, v18
    v_subrev_co_u32 v19, s[70:71], 2.0, v19
    v_subrev_co_u32 v20, s[72:73], 2.0, v20
    v_subrev_co_u32 v21, s[74:75], 2.0, v21
    v_subrev_co_u32 v22, s[76:77], 2.0, v22
    v_subrev_co_u32 v23, s[78:79], 2.0, v23
    v_subrev_co_u32 v24, s[80:81], 2.0, v24
    v_subrev_co_u32 v25, s[82:83], 2.0, v25
    v_subrev_co_u32 v26, s[84:85], 2.0, v26
    v_subrev_co_u32 v27, s[86:87], 2.0, v27
    s_mov_b64 exec, s[64:65]
    ds_read_b64 v[52:53], v52
    s_mov_b64 exec, s[66:67]
    ds_read_b64 v[54:55], v54
    s_mov_b64 exec, s[68:69]
    ds_read_b64 v[56:57], v56
    s_mov_b64 exec, s[70:71]
    ds_read_b64 v[58:59], v58
    s_mov_b64 exec, s[72:73]
    ds_read_b64 v[60:61], v60
    s_mov_b64 exec, s[74:75]
    ds_read_b64 v[62:63], v62
    s_mov_b64 exec, s[76:77]
    ds_read_b64 v[64:65], v64
    s_mov_b64 exec, s[78:79]
    ds_read_b64 v[66:67], v66
    s_mov_b64 exec, s[80:81]
    ds_read_b64 v[68:69], v68
    s_mov_b64 exec, s[82:83]
    ds_read_b64 v[70:71], v70
    s_mov_b64 exec, s[84:85]
    ds_read_b64 v[72:73], v72
    s_mov_b64 exec, s[86:87]
    ds_read_b64 v[74:75], v74
    s_mov_b64 exec, -1
    s_cmp_le_i32 s42, 3072
    s_cbranch_scc1 L_nt1_66
    s_waitcnt vmcnt(12)
    v_perm_b32 v120, v107, v106, s24
    v_perm_b32 v122, v108, v107, s25
    v_perm_b32 v124, v109, v108, s26
    v_perm_b32 v126, v114, v109, s27
    v_alignbyte_b32 v107, v108, v107, 1
    v_alignbyte_b32 v108, v109, v108, 2
    v_alignbyte_b32 v109, v114, v109, 3
    v_lshlrev_b32_sdwa v120, 3, v120 dst_sel:WORD_0 dst_unused:UNUSED_PAD src0_sel:DWORD src1_sel:DWORD
    v_lshlrev_b32_sdwa v122, 3, v122 dst_sel:WORD_0 dst_unused:UNUSED_PAD src0_sel:DWORD src1_sel:DWORD
    v_lshlrev_b32_sdwa v124, 3, v124 dst_sel:WORD_0 dst_unused:UNUSED_PAD src0_sel:DWORD src1_sel:DWORD
    v_lshlrev_b32_sdwa v126, 3, v126 dst_sel:WORD_0 dst_unused:UNUSED_PAD src0_sel:DWORD src1_sel:DWORD
    s_cmp_lt_i32 s42, 3328
    s_cbranch_scc1 L_ufix_69
L_uback_70:

    v_lshrrev_b32 v117, 30, v106
    v_and_b32 v106, 0x3fffffff, v106
    v_mul_u32_u24 v117, 50000, v117
    v_cmp_ne_u32 vcc, 0, v106
    v_add_u32 v120, v120, v117
    s_mov_b64 exec, vcc

    buffer_load_dwordx2 v[120:121], v120, s[8:11], s50 offen
    s_mov_b64 exec, -1
    v_lshrrev_b32 v117, 30, v107
    v_and_b32 v107, 0x3fffffff, v107
    v_mul_u32_u24 v117, 50000, v117
    v_cmp_ne_u32 vcc, 0, v107
    v_add_u32 v122, v122, v117
    s_mov_b64 exec, vcc

    buffer_load_dwordx2 v[122:123], v122, s[8:11], s50 offen
    s_mov_b64 exec, -1
    v_lshrrev_b32 v117, 30, v108
    v_and_b32 v108, 0x3fffffff, v108
    v_mul_u32_u24 v117, 50000, v117
    v_cmp_ne_u32 vcc, 0, v108
    v_add_u32 v124, v124, v117
    s_mov_b64 exec, vcc

    buffer_load_dwordx2 v[124:125], v124, s[8:11], s50 offen
    s_mov_b64 exec, -1
    v_lshrrev_b32 v117, 30, v109
    v_and_b32 v109, 0x3fffffff, v109
    v_mul_u32_u24 v117, 50000, v117
    v_cmp_ne_u32 vcc, 0, v109
    v_add_u32 v126, v126, v117
    s_mov_b64 exec, vcc

    buffer_load_dwordx2 v[126:127], v126, s[8:11], s50 offen
    s_mov_b64 exec, -1
L_nt1_66:
    s_movk_i32 s53, 7680
    buffer_load_dwordx4 v[94:97], v2, s[16:19], s53 offen
    buffer_load_dword v111, v2, s[16:19], s53 offen offset:16
    s_waitcnt lgkmcnt(0)
    s_barrier
    s_waitcnt vmcnt(5)
    ds_write_addtid_b32 v76 offset:0
    ds_write_addtid_b32 v77 offset:256
    ds_write_addtid_b32 v78 offset:512
    ds_write_addtid_b32 v79 offset:768
    s_waitcnt vmcnt(4)
    ds_write_addtid_b32 v80 offset:16384
    ds_write_addtid_b32 v81 offset:16640
    ds_write_addtid_b32 v82 offset:16896
    ds_write_addtid_b32 v83 offset:17152
    s_waitcnt vmcnt(3)
    ds_write_addtid_b32 v84 offset:32768
    ds_write_addtid_b32 v85 offset:33024
    ds_write_addtid_b32 v86 offset:33280
    ds_write_addtid_b32 v87 offset:33536
    v_lshlrev_b32 v119, 2, v0
    s_waitcnt vmcnt(2)
    s_mov_b64 exec, s[48:49]
    ds_write_b32 v119, v88 offset:49152
    s_mov_b64 exec, -1
    s_add_u32 s43, s43, 50048
    s_add_u32 s14, s43, 50000
    s_min_u32 s14, s14, s41
    buffer_load_dwordx4 v[76:79], v3, s[12:15], s43 offen
    s_add_u32 s52, s43, 16384
    buffer_load_dwordx4 v[80:83], v3, s[12:15], s52 offen
    v_subrev_co_u32 v4, s[64:65], 2.0, v4
    v_subrev_co_u32 v5, s[66:67], 2.0, v5
    v_subrev_co_u32 v6, s[68:69], 2.0, v6
    v_subrev_co_u32 v7, s[70:71], 2.0, v7
    v_subrev_co_u32 v8, s[72:73], 2.0, v8
    v_subrev_co_u32 v9, s[74:75], 2.0, v9
    v_subrev_co_u32 v10, s[76:77], 2.0, v10
    v_subrev_co_u32 v11, s[78:79], 2.0, v11
    v_subrev_co_u32 v12, s[80:81], 2.0, v12
    v_subrev_co_u32 v13, s[82:83], 2.0, v13
    v_subrev_co_u32 v14, s[84:85], 2.0, v14
    v_subrev_co_u32 v15, s[86:87], 2.0, v15
    s_waitcnt lgkmcnt(0)
    s_barrier
    s_add_u32 s52, s43, 32768
    buffer_load_dwordx4 v[84:87], v3, s[12:15], s52 offen
    s_add_u32 s52, s43, 49152
    v_lshlrev_b32 v119, 2, v0
    buffer_load_dword v88, v119, s[12:15], s52 offen
    s_mov_b64 exec, s[64:65]
    ds_read_b64 v[28:29], v28
    s_mov_b64 exec, s[66:67]
    ds_read_b64 v[30:31], v30
    s_mov_b64 exec, s[68:69]
    ds_read_b64 v[32:33], v32
    s_mov_b64 exec, s[70:71]
    ds_read_b64 v[34:35], v34
    s_mov_b64 exec, s[72:73]
    ds_read_b64 v[36:37], v36
    s_mov_b64 exec, s[74:75]
    ds_read_b64 v[38:39], v38
    s_mov_b64 exec, s[76:77]
    ds_read_b64 v[40:41], v40
    s_mov_b64 exec, s[78:79]
    ds_read_b64 v[42:43], v42
    s_mov_b64 exec, s[80:81]
    ds_read_b64 v[44:45], v44
    s_mov_b64 exec, s[82:83]
    ds_read_b64 v[46:47], v46
    s_mov_b64 exec, s[84:85]
    ds_read_b64 v[48:49], v48
    s_mov_b64 exec, s[86:87]
    ds_read_b64 v[50:51], v50
    s_mov_b64 exec, -1
    v_subrev_co_u32 v16, s[64:65], 2.0, v16
    v_subrev_co_u32 v17, s[66:67], 2.0, v17
    v_subrev_co_u32 v18, s[68:69], 2.0, v18
    v_subrev_co_u32 v19, s[70:71], 2.0, v19
    v_subrev_co_u32 v20, s[72:73], 2.0, v20
    v_subrev_co_u32 v21, s[74:75], 2.0, v21
    v_subrev_co_u32 v22, s[76:77], 2.0, v22
    v_subrev_co_u32 v23, s[78:79], 2.0, v23
    v_subrev_co_u32 v24, s[80:81], 2.0, v24
    v_subrev_co_u32 v25, s[82:83], 2.0, v25
    v_subrev_co_u32 v26, s[84:85], 2.0, v26
    v_subrev_co_u32 v27, s[86:87], 2.0, v27
    s_mov_b64 exec, s[64:65]
    ds_read_b64 v[52:53], v52
    s_mov_b64 exec, s[66:67]
    ds_read_b64 v[54:55], v54
    s_mov_b64 exec, s[68:69]
    ds_read_b64 v[56:57], v56
    s_mov_b64 exec, s[70:71]
    ds_read_b64 v[58:59], v58
    s_mov_b64 exec, s[72:73]
    ds_read_b64 v[60:61], v60
    s_mov_b64 exec, s[74:75]
    ds_read_b64 v[62:63], v62
    s_mov_b64 exec, s[76:77]
    ds_read_b64 v[64:65], v64
    s_mov_b64 exec, s[78:79]
    ds_read_b64 v[66:67], v66
    s_mov_b64 exec, s[80:81]
    ds_read_b64 v[68:69], v68
    s_mov_b64 exec, s[82:83]
    ds_read_b64 v[70:71], v70
    s_mov_b64 exec, s[84:85]
    ds_read_b64 v[72:73], v72
    s_mov_b64 exec, s[86:87]
    ds_read_b64 v[74:75], v74
    s_mov_b64 exec, -1
    s_movk_i32 s53, 10240
    buffer_load_dwordx4 v[98:101], v2, s[16:19], s53 offen
    buffer_load_dword v112, v2, s[16:19], s53 offen offset:16
    s_cmp_le_i32 s42, 3072
    s_cbranch_scc1 L_nt2_67
    s_waitcnt vmcnt(8)
    v_cmp_ne_u32 s[64:65], 0, v106
    v_cmp_ne_u32 s[66:67], 0, v107
    v_cmp_ne_u32 s[68:69], 0, v108
    v_cmp_ne_u32 s[70:71], 0, v109
    s_mov_b64 exec, s[64:65]
    v_cvt_f32_i32_sdwa v118, sext(v106) dst_sel:DWORD dst_unused:UNUSED_PAD src0_sel:WORD_0
    v_lshlrev_b32 v116, 16, v120
    v_and_b32 v117, s32, v120
    v_mul_f32 v118, s33, v118
    v_lshlrev_b32 v120, 16, v121
    v_and_b32 v121, s32, v121
    v_lshlrev_b32_sdwa v106, 3, v106 dst_sel:DWORD dst_unused:UNUSED_PAD src0_sel:DWORD src1_sel:WORD_1
    v_pk_fma_f32 v[116:117], v[116:117], v[118:119], s[28:29] op_sel_hi:[1,0,1]
    v_pk_fma_f32 v[120:121], v[120:121], v[118:119], s[28:29] op_sel_hi:[1,0,1]
    v_perm_b32 v116, v117, v116, s35
    v_perm_b32 v117, v121, v120, s35
    v_lshl_add_u64 v[116:117], v[116:117], 0, s[30:31]
    ds_add_rtn_u64 v[120:121], v106, v[116:117] offset:50000

    s_mov_b64 exec, s[66:67]
    v_cvt_f32_i32_sdwa v118, sext(v107) dst_sel:DWORD dst_unused:UNUSED_PAD src0_sel:WORD_0
    v_lshlrev_b32 v116, 16, v122
    v_and_b32 v117, s32, v122
    v_mul_f32 v118, s33, v118
    v_lshlrev_b32 v122, 16, v123
    v_and_b32 v123, s32, v123
    v_lshlrev_b32_sdwa v107, 3, v107 dst_sel:DWORD dst_unused:UNUSED_PAD src0_sel:DWORD src1_sel:WORD_1
    v_pk_fma_f32 v[116:117], v[116:117], v[118:119], s[28:29] op_sel_hi:[1,0,1]
    v_pk_fma_f32 v[122:123], v[122:123], v[118:119], s[28:29] op_sel_hi:[1,0,1]
    v_perm_b32 v116, v117, v116, s35
    v_perm_b32 v117, v123, v122, s35
    v_lshl_add_u64 v[116:117], v[116:117], 0, s[30:31]
    ds_add_rtn_u64 v[122:123], v107, v[116:117] offset:50000

    s_mov_b64 exec, s[68:69]
    v_cvt_f32_i32_sdwa v118, sext(v108) dst_sel:DWORD dst_unused:UNUSED_PAD src0_sel:WORD_0
    v_lshlrev_b32 v116, 16, v124
    v_and_b32 v117, s32, v124
    v_mul_f32 v118, s33, v118
    v_lshlrev_b32 v124, 16, v125
    v_and_b32 v125, s32, v125
    v_lshlrev_b32_sdwa v108, 3, v108 dst_sel:DWORD dst_unused:UNUSED_PAD src0_sel:DWORD src1_sel:WORD_1
    v_pk_fma_f32 v[116:117], v[116:117], v[118:119], s[28:29] op_sel_hi:[1,0,1]
    v_pk_fma_f32 v[124:125], v[124:125], v[118:119], s[28:29] op_sel_hi:[1,0,1]
    v_perm_b32 v116, v117, v116, s35
    v_perm_b32 v117, v125, v124, s35
    v_lshl_add_u64 v[116:117], v[116:117], 0, s[30:31]
    ds_add_rtn_u64 v[124:125], v108, v[116:117] offset:50000

    s_mov_b64 exec, s[70:71]
    v_cvt_f32_i32_sdwa v118, sext(v109) dst_sel:DWORD dst_unused:UNUSED_PAD src0_sel:WORD_0
    v_lshlrev_b32 v116, 16, v126
    v_and_b32 v117, s32, v126
    v_mul_f32 v118, s33, v118
    v_lshlrev_b32 v126, 16, v127
    v_and_b32 v127, s32, v127
    v_lshlrev_b32_sdwa v109, 3, v109 dst_sel:DWORD dst_unused:UNUSED_PAD src0_sel:DWORD src1_sel:WORD_1
    v_pk_fma_f32 v[116:117], v[116:117], v[118:119], s[28:29] op_sel_hi:[1,0,1]
    v_pk_fma_f32 v[126:127], v[126:127], v[118:119], s[28:29] op_sel_hi:[1,0,1]
    v_perm_b32 v116, v117, v116, s35
    v_perm_b32 v117, v127, v126, s35
    v_lshl_add_u64 v[116:117], v[116:117], 0, s[30:31]
    ds_add_rtn_u64 v[126:127], v109, v[116:117] offset:50000

    s_waitcnt lgkmcnt(0)
    s_mov_b64 exec, s[64:65]
    v_or3_b32 v1, v120, v121, v1
    s_mov_b64 exec, s[66:67]
    v_or3_b32 v1, v122, v123, v1
    s_mov_b64 exec, s[68:69]
    v_or3_b32 v1, v124, v125, v1
    s_mov_b64 exec, s[70:71]
    v_or3_b32 v1, v126, v127, v1
    s_mov_b64 exec, -1
L_nt2_67:
    s_movk_i32 s53, 15360
    buffer_load_dwordx4 v[106:109], v2, s[16:19], s53 offen
    buffer_load_dword v114, v2, s[16:19], s53 offen offset:16
    s_cmp_le_u32 s40, 3584
    s_cbranch_scc1 L_noleft_68
    s_min_u32 s40, s40, 3968
    s_lshl_b32 s52, s38, 6
    s_add_u32 s52, s52, s36
    s_mul_i32 s52, s52, 19840
    s_add_u32 s20, s44, s52
    s_addc_u32 s21, s45, 0
    s_mul_i32 s52, s40, 5
    s_add_u32 s52, s52, 3
    s_and_b32 s22, s52, -4

    s_lshr_b32 s55, s39, 2
    s_add_u32 s55, s55, 3584
    v_and_b32 v120, 63, v0
    v_add_u32 v120, s55, v120
L_left_71:
    s_cmp_ge_u32 s55, s40
    s_cbranch_scc1 L_leftend_72
    v_mul_u32_u24 v121, 5, v120
    buffer_load_dword v122, v121, s[20:23], 0 offen
    buffer_load_ubyte v123, v121, s[20:23], 0 offen offset:4
    s_waitcnt vmcnt(0)

    v_perm_b32 v121, v123, v122, s24
    v_lshrrev_b32 v126, 30, v122
    v_and_b32 v121, 0x1fff, v121
    v_mul_u32_u24 v126, 6250, v126
    v_add_lshl_u32 v121, v121, v126, 3

    buffer_load_dwordx2 v[124:125], v121, s[8:11], s50 offen
    v_cmp_gt_u32 vcc, s40, v120
    s_waitcnt vmcnt(0)

    s_mov_b64 exec, vcc
    v_and_b32 v122, 0x3fffffff, v122
    v_cvt_f32_i32_sdwa v118, sext(v122) dst_sel:DWORD dst_unused:UNUSED_PAD src0_sel:WORD_0
    v_lshlrev_b32 v116, 16, v124
    v_and_b32 v117, s32, v124
    v_mul_f32 v118, s33, v118
    v_lshlrev_b32 v124, 16, v125
    v_and_b32 v125, s32, v125
    v_lshlrev_b32_sdwa v122, 3, v122 dst_sel:DWORD dst_unused:UNUSED_PAD src0_sel:DWORD src1_sel:WORD_1
    v_pk_fma_f32 v[116:117], v[116:117], v[118:119], s[28:29] op_sel_hi:[1,0,1]
    v_pk_fma_f32 v[124:125], v[124:125], v[118:119], s[28:29] op_sel_hi:[1,0,1]
    v_perm_b32 v116, v117, v116, s35
    v_perm_b32 v117, v125, v124, s35
    v_lshl_add_u64 v[116:117], v[116:117], 0, s[30:31]
    ds_add_rtn_u64 v[124:125], v122, v[116:117] offset:50000

    s_waitcnt lgkmcnt(0)
    v_or3_b32 v1, v124, v125, v1
    s_mov_b64 exec, -1
    v_add_u32 v120, 128, v120
    s_add_u32 s55, s55, 128
    s_branch L_left_71
L_leftend_72:

L_noleft_68:
    s_waitcnt lgkmcnt(0)
    s_barrier
    s_waitcnt vmcnt(7)
    ds_write_addtid_b32 v76 offset:0
    ds_write_addtid_b32 v77 offset:256
    ds_write_addtid_b32 v78 offset:512
    ds_write_addtid_b32 v79 offset:768
    s_waitcnt vmcnt(6)
    ds_write_addtid_b32 v80 offset:16384
    ds_write_addtid_b32 v81 offset:16640
    ds_write_addtid_b32 v82 offset:16896
    ds_write_addtid_b32 v83 offset:17152
    s_waitcnt vmcnt(5)
    ds_write_addtid_b32 v84 offset:32768
    ds_write_addtid_b32 v85 offset:33024
    ds_write_addtid_b32 v86 offset:33280
    ds_write_addtid_b32 v87 offset:33536
    v_lshlrev_b32 v119, 2, v0
    s_waitcnt vmcnt(4)
    s_mov_b64 exec, s[48:49]
    ds_write_b32 v119, v88 offset:49152
    s_mov_b64 exec, -1
    s_add_u32 s43, s43, 50048
    s_add_u32 s14, s43, 50000
    s_min_u32 s14, s14, s41
    buffer_load_dwordx4 v[76:79], v3, s[12:15], s43 offen
    s_add_u32 s52, s43, 16384
    buffer_load_dwordx4 v[80:83], v3, s[12:15], s52 offen
    v_cmp_gt_u32 s[64:65], 2.0, v4
    v_and_b32 v4, 0x3fffffff, v4
    v_cmp_gt_u32 s[66:67], 2.0, v5
    v_and_b32 v5, 0x3fffffff, v5
    v_cmp_gt_u32 s[68:69], 2.0, v6
    v_and_b32 v6, 0x3fffffff, v6
    v_cmp_gt_u32 s[70:71], 2.0, v7
    v_and_b32 v7, 0x3fffffff, v7
    v_cmp_gt_u32 s[72:73], 2.0, v8
    v_and_b32 v8, 0x3fffffff, v8
    v_cmp_gt_u32 s[74:75], 2.0, v9
    v_and_b32 v9, 0x3fffffff, v9
    v_cmp_gt_u32 s[76:77], 2.0, v10
    v_and_b32 v10, 0x3fffffff, v10
    v_cmp_gt_u32 s[78:79], 2.0, v11
    v_and_b32 v11, 0x3fffffff, v11
    v_cmp_gt_u32 s[80:81], 2.0, v12
    v_and_b32 v12, 0x3fffffff, v12
    v_cmp_gt_u32 s[82:83], 2.0, v13
    v_and_b32 v13, 0x3fffffff, v13
    v_cmp_gt_u32 s[84:85], 2.0, v14
    v_and_b32 v14, 0x3fffffff, v14
    v_cmp_gt_u32 s[86:87], 2.0, v15
    v_and_b32 v15, 0x3fffffff, v15
    s_waitcnt lgkmcnt(0)
    s_barrier
    s_add_u32 s52, s43, 32768
    buffer_load_dwordx4 v[84:87], v3, s[12:15], s52 offen
    s_add_u32 s52, s43, 49152
    v_lshlrev_b32 v119, 2, v0
    buffer_load_dword v88, v119, s[12:15], s52 offen
    s_mov_b64 exec, s[64:65]
    ds_read_b64 v[28:29], v28
    s_mov_b64 exec, s[66:67]
    ds_read_b64 v[30:31], v30
    s_mov_b64 exec, s[68:69]
    ds_read_b64 v[32:33], v32
    s_mov_b64 exec, s[70:71]
    ds_read_b64 v[34:35], v34
    s_mov_b64 exec, s[72:73]
    ds_read_b64 v[36:37], v36
    s_mov_b64 exec, s[74:75]
    ds_read_b64 v[38:39], v38
    s_mov_b64 exec, s[76:77]
    ds_read_b64 v[40:41], v40
    s_mov_b64 exec, s[78:79]
    ds_read_b64 v[42:43], v42
    s_mov_b64 exec, s[80:81]
    ds_read_b64 v[44:45], v44
    s_mov_b64 exec, s[82:83]
    ds_read_b64 v[46:47], v46
    s_mov_b64 exec, s[84:85]
    ds_read_b64 v[48:49], v48
    s_mov_b64 exec, s[86:87]
    ds_read_b64 v[50:51], v50
    s_mov_b64 exec, -1
    v_cmp_gt_u32 s[64:65], 2.0, v16
    v_and_b32 v16, 0x3fffffff, v16
    v_cmp_gt_u32 s[66:67], 2.0, v17
    v_and_b32 v17, 0x3fffffff, v17
    v_cmp_gt_u32 s[68:69], 2.0, v18
    v_and_b32 v18, 0x3fffffff, v18
    v_cmp_gt_u32 s[70:71], 2.0, v19
    v_and_b32 v19, 0x3fffffff, v19
    v_cmp_gt_u32 s[72:73], 2.0, v20
    v_and_b32 v20, 0x3fffffff, v20
    v_cmp_gt_u32 s[74:75], 2.0, v21
    v_and_b32 v21, 0x3fffffff, v21
    v_cmp_gt_u32 s[76:77], 2.0, v22
    v_and_b32 v22, 0x3fffffff, v22
    v_cmp_gt_u32 s[78:79], 2.0, v23
    v_and_b32 v23, 0x3fffffff, v23
    v_cmp_gt_u32 s[80:81], 2.0, v24
    v_and_b32 v24, 0x3fffffff, v24
    v_cmp_gt_u32 s[82:83], 2.0, v25
    v_and_b32 v25, 0x3fffffff, v25
    v_cmp_gt_u32 s[84:85], 2.0, v26
    v_and_b32 v26, 0x3fffffff, v26
    v_cmp_gt_u32 s[86:87], 2.0, v27
    v_and_b32 v27, 0x3fffffff, v27
    s_mov_b64 exec, s[64:65]
    ds_read_b64 v[52:53], v52
    s_mov_b64 exec, s[66:67]
    ds_read_b64 v[54:55], v54
    s_mov_b64 exec, s[68:69]
    ds_read_b64 v[56:57], v56
    s_mov_b64 exec, s[70:71]
    ds_read_b64 v[58:59], v58
    s_mov_b64 exec, s[72:73]
    ds_read_b64 v[60:61], v60
    s_mov_b64 exec, s[74:75]
    ds_read_b64 v[62:63], v62
    s_mov_b64 exec, s[76:77]
    ds_read_b64 v[64:65], v64
    s_mov_b64 exec, s[78:79]
    ds_read_b64 v[66:67], v66
    s_mov_b64 exec, s[80:81]
    ds_read_b64 v[68:69], v68
    s_mov_b64 exec, s[82:83]
    ds_read_b64 v[70:71], v70
    s_mov_b64 exec, s[84:85]
    ds_read_b64 v[72:73], v72
    s_mov_b64 exec, s[86:87]
    ds_read_b64 v[74:75], v74
    s_mov_b64 exec, -1
    s_movk_i32 s53, 12800
    buffer_load_dwordx4 v[102:105], v2, s[16:19], s53 offen
    buffer_load_dword v113, v2, s[16:19], s53 offen offset:16
    s_cmp_ge_u32 s5, s4
    s_cbranch_scc1 L_bend_65
    s_waitcnt lgkmcnt(15)
    v_mad_i32_i16 v120, v28, v4, s96
    v_mad_i32_i16 v28, v28, v4, s96 op_sel:[1,0,0,0]
    v_mad_i32_i16 v121, v29, v4, s96
    v_mad_i32_i16 v29, v29, v4, s96 op_sel:[1,0,0,0]
    v_lshlrev_b32_sdwa v4, 3, v4 dst_sel:DWORD dst_unused:UNUSED_PAD src0_sel:DWORD src1_sel:WORD_1
    v_perm_b32 v28, v28, v120, s97
    v_perm_b32 v29, v29, v121, s97
    v_lshl_add_u64 v[28:29], v[28:29], 0, s[30:31]

    ds_add_rtn_u64 v[28:29], v4, v[28:29] offset:50000
    v_mad_i32_i16 v122, v30, v5, s96
    v_mad_i32_i16 v30, v30, v5, s96 op_sel:[1,0,0,0]
    v_mad_i32_i16 v123, v31, v5, s96
    v_mad_i32_i16 v31, v31, v5, s96 op_sel:[1,0,0,0]
    v_lshlrev_b32_sdwa v5, 3, v5 dst_sel:DWORD dst_unused:UNUSED_PAD src0_sel:DWORD src1_sel:WORD_1
    v_perm_b32 v30, v30, v122, s97
    v_perm_b32 v31, v31, v123, s97
    v_lshl_add_u64 v[30:31], v[30:31], 0, s[30:31]

    ds_add_rtn_u64 v[30:31], v5, v[30:31] offset:50000
    v_mad_i32_i16 v124, v32, v6, s96
    v_mad_i32_i16 v32, v32, v6, s96 op_sel:[1,0,0,0]
    v_mad_i32_i16 v125, v33, v6, s96
    v_mad_i32_i16 v33, v33, v6, s96 op_sel:[1,0,0,0]
    v_lshlrev_b32_sdwa v6, 3, v6 dst_sel:DWORD dst_unused:UNUSED_PAD src0_sel:DWORD src1_sel:WORD_1
    v_perm_b32 v32, v32, v124, s97
    v_perm_b32 v33, v33, v125, s97
    v_lshl_add_u64 v[32:33], v[32:33], 0, s[30:31]

    ds_add_rtn_u64 v[32:33], v6, v[32:33] offset:50000
    v_mad_i32_i16 v126, v34, v7, s96
    v_mad_i32_i16 v34, v34, v7, s96 op_sel:[1,0,0,0]
    v_mad_i32_i16 v127, v35, v7, s96
    v_mad_i32_i16 v35, v35, v7, s96 op_sel:[1,0,0,0]
    v_lshlrev_b32_sdwa v7, 3, v7 dst_sel:DWORD dst_unused:UNUSED_PAD src0_sel:DWORD src1_sel:WORD_1
    v_perm_b32 v34, v34, v126, s97
    v_perm_b32 v35, v35, v127, s97
    v_lshl_add_u64 v[34:35], v[34:35], 0, s[30:31]

    ds_add_rtn_u64 v[34:35], v7, v[34:35] offset:50000
    v_mad_i32_i16 v120, v36, v8, s96
    v_mad_i32_i16 v36, v36, v8, s96 op_sel:[1,0,0,0]
    v_mad_i32_i16 v121, v37, v8, s96
    v_mad_i32_i16 v37, v37, v8, s96 op_sel:[1,0,0,0]
    v_lshlrev_b32_sdwa v8, 3, v8 dst_sel:DWORD dst_unused:UNUSED_PAD src0_sel:DWORD src1_sel:WORD_1
    v_perm_b32 v36, v36, v120, s97
    v_perm_b32 v37, v37, v121, s97
    v_lshl_add_u64 v[36:37], v[36:37], 0, s[30:31]

    ds_add_rtn_u64 v[36:37], v8, v[36:37] offset:50000
    v_mad_i32_i16 v122, v38, v9, s96
    v_mad_i32_i16 v38, v38, v9, s96 op_sel:[1,0,0,0]
    v_mad_i32_i16 v123, v39, v9, s96
    v_mad_i32_i16 v39, v39, v9, s96 op_sel:[1,0,0,0]
    v_lshlrev_b32_sdwa v9, 3, v9 dst_sel:DWORD dst_unused:UNUSED_PAD src0_sel:DWORD src1_sel:WORD_1
    v_perm_b32 v38, v38, v122, s97
    v_perm_b32 v39, v39, v123, s97
    v_lshl_add_u64 v[38:39], v[38:39], 0, s[30:31]

    ds_add_rtn_u64 v[38:39], v9, v[38:39] offset:50000
    v_mad_i32_i16 v124, v40, v10, s96
    v_mad_i32_i16 v40, v40, v10, s96 op_sel:[1,0,0,0]
    v_mad_i32_i16 v125, v41, v10, s96
    v_mad_i32_i16 v41, v41, v10, s96 op_sel:[1,0,0,0]
    v_lshlrev_b32_sdwa v10, 3, v10 dst_sel:DWORD dst_unused:UNUSED_PAD src0_sel:DWORD src1_sel:WORD_1
    v_perm_b32 v40, v40, v124, s97
    v_perm_b32 v41, v41, v125, s97
    v_lshl_add_u64 v[40:41], v[40:41], 0, s[30:31]

    ds_add_rtn_u64 v[40:41], v10, v[40:41] offset:50000
    v_mad_i32_i16 v126, v42, v11, s96
    v_mad_i32_i16 v42, v42, v11, s96 op_sel:[1,0,0,0]
    v_mad_i32_i16 v127, v43, v11, s96
    v_mad_i32_i16 v43, v43, v11, s96 op_sel:[1,0,0,0]
    v_lshlrev_b32_sdwa v11, 3, v11 dst_sel:DWORD dst_unused:UNUSED_PAD src0_sel:DWORD src1_sel:WORD_1
    v_perm_b32 v42, v42, v126, s97
    v_perm_b32 v43, v43, v127, s97
    v_lshl_add_u64 v[42:43], v[42:43], 0, s[30:31]

    ds_add_rtn_u64 v[42:43], v11, v[42:43] offset:50000
    s_waitcnt lgkmcnt(4)
    v_or3_b32 v1, v28, v29, v1
    v_or3_b32 v1, v30, v31, v1
    v_or3_b32 v1, v32, v33, v1
    v_or3_b32 v1, v34, v35, v1
    s_barrier
    s_waitcnt vmcnt(5)
    ds_write_addtid_b32 v76 offset:0
    ds_write_addtid_b32 v77 offset:256
    ds_write_addtid_b32 v78 offset:512
    ds_write_addtid_b32 v79 offset:768
    s_waitcnt vmcnt(4)
    ds_write_addtid_b32 v80 offset:16384
    ds_write_addtid_b32 v81 offset:16640
    ds_write_addtid_b32 v82 offset:16896
    ds_write_addtid_b32 v83 offset:17152
    s_waitcnt vmcnt(3)
    ds_write_addtid_b32 v84 offset:32768
    ds_write_addtid_b32 v85 offset:33024
    ds_write_addtid_b32 v86 offset:33280
    ds_write_addtid_b32 v87 offset:33536
    v_lshlrev_b32 v119, 2, v0
    s_waitcnt vmcnt(2)
    s_mov_b64 exec, s[48:49]
    ds_write_b32 v119, v88 offset:49152
    s_mov_b64 exec, -1
    s_add_u32 s43, s43, 50048
    s_add_u32 s14, s43, 50000
    s_min_u32 s14, s14, s41
    buffer_load_dwordx4 v[76:79], v3, s[12:15], s43 offen
    s_add_u32 s52, s43, 16384
    buffer_load_dwordx4 v[80:83], v3, s[12:15], s52 offen
    s_add_u32 s52, s43, 32768
    buffer_load_dwordx4 v[84:87], v3, s[12:15], s52 offen
    s_add_u32 s52, s43, 49152
    v_lshlrev_b32 v119, 2, v0
    buffer_load_dword v88, v119, s[12:15], s52 offen
    s_add_u32 s54, s43, 50048
    buffer_load_dword v115, v89, s[60:63], s54 offen
    s_add_u32 s54, s50, 200000
    buffer_load_dword v115, v89, s[8:11], s54 offen
    s_movk_i32 s53, 0
    buffer_load_dwordx4 v[4:7], v2, s[16:19], s53 offen
    buffer_load_dword v35, v2, s[16:19], s53 offen offset:16
    v_mad_i32_i16 v120, v44, v12, s96
    v_mad_i32_i16 v44, v44, v12, s96 op_sel:[1,0,0,0]
    v_mad_i32_i16 v121, v45, v12, s96
    v_mad_i32_i16 v45, v45, v12, s96 op_sel:[1,0,0,0]
    v_lshlrev_b32_sdwa v12, 3, v12 dst_sel:DWORD dst_unused:UNUSED_PAD src0_sel:DWORD src1_sel:WORD_1
    v_perm_b32 v44, v44, v120, s97
    v_perm_b32 v45, v45, v121, s97
    v_lshl_add_u64 v[44:45], v[44:45], 0, s[30:31]

    ds_add_rtn_u64 v[44:45], v12, v[44:45] offset:50000
    v_mad_i32_i16 v122, v46, v13, s96
    v_mad_i32_i16 v46, v46, v13, s96 op_sel:[1,0,0,0]
    v_mad_i32_i16 v123, v47, v13, s96
    v_mad_i32_i16 v47, v47, v13, s96 op_sel:[1,0,0,0]
    v_lshlrev_b32_sdwa v13, 3, v13 dst_sel:DWORD dst_unused:UNUSED_PAD src0_sel:DWORD src1_sel:WORD_1
    v_perm_b32 v46, v46, v122, s97
    v_perm_b32 v47, v47, v123, s97
    v_lshl_add_u64 v[46:47], v[46:47], 0, s[30:31]

    ds_add_rtn_u64 v[46:47], v13, v[46:47] offset:50000
    v_mad_i32_i16 v124, v48, v14, s96
    v_mad_i32_i16 v48, v48, v14, s96 op_sel:[1,0,0,0]
    v_mad_i32_i16 v125, v49, v14, s96
    v_mad_i32_i16 v49, v49, v14, s96 op_sel:[1,0,0,0]
    v_lshlrev_b32_sdwa v14, 3, v14 dst_sel:DWORD dst_unused:UNUSED_PAD src0_sel:DWORD src1_sel:WORD_1
    v_perm_b32 v48, v48, v124, s97
    v_perm_b32 v49, v49, v125, s97
    v_lshl_add_u64 v[48:49], v[48:49], 0, s[30:31]

    ds_add_rtn_u64 v[48:49], v14, v[48:49] offset:50000
    v_mad_i32_i16 v126, v50, v15, s96
    v_mad_i32_i16 v50, v50, v15, s96 op_sel:[1,0,0,0]
    v_mad_i32_i16 v127, v51, v15, s96
    v_mad_i32_i16 v51, v51, v15, s96 op_sel:[1,0,0,0]
    v_lshlrev_b32_sdwa v15, 3, v15 dst_sel:DWORD dst_unused:UNUSED_PAD src0_sel:DWORD src1_sel:WORD_1
    v_perm_b32 v50, v50, v126, s97
    v_perm_b32 v51, v51, v127, s97
    v_lshl_add_u64 v[50:51], v[50:51], 0, s[30:31]

    ds_add_rtn_u64 v[50:51], v15, v[50:51] offset:50000
    s_waitcnt lgkmcnt(15)
    v_or3_b32 v1, v36, v37, v1
    v_or3_b32 v1, v38, v39, v1
    v_or3_b32 v1, v40, v41, v1
    v_or3_b32 v1, v42, v43, v1
    s_movk_i32 s53, 2560
    buffer_load_dwordx4 v[8:11], v2, s[16:19], s53 offen
    buffer_load_dword v43, v2, s[16:19], s53 offen offset:16
    s_mov_b32 s40, s88
    s_sub_u32 s42, s40, s39

    s_add_u32 s55, s38, 2
    s_min_u32 s55, s55, 31
    s_mov_b32 s88, s89
    s_mov_b32 s89, s90
    s_mov_b32 s90, s91
    s_mov_b32 s91, s92
    s_mov_b32 s92, s93
    s_mov_b32 s93, s94
    s_mov_b32 s94, s95
    s_mov_b32 s95, 0
    s_min_u32 s88, s88, 3968
    s_lshl_b32 s52, s55, 6
    s_add_u32 s52, s52, s36
    s_mul_i32 s52, s52, 19840
    s_add_u32 s16, s44, s52
    s_addc_u32 s17, s45, 0
    s_mul_i32 s52, s88, 5
    s_add_u32 s52, s52, 3
    s_and_b32 s18, s52, -4

    v_mad_i32_i16 v120, v52, v16, s96
    v_mad_i32_i16 v52, v52, v16, s96 op_sel:[1,0,0,0]
    v_mad_i32_i16 v121, v53, v16, s96
    v_mad_i32_i16 v53, v53, v16, s96 op_sel:[1,0,0,0]
    v_lshlrev_b32_sdwa v16, 3, v16 dst_sel:DWORD dst_unused:UNUSED_PAD src0_sel:DWORD src1_sel:WORD_1
    v_perm_b32 v52, v52, v120, s97
    v_perm_b32 v53, v53, v121, s97
    v_lshl_add_u64 v[52:53], v[52:53], 0, s[30:31]

    ds_add_rtn_u64 v[52:53], v16, v[52:53] offset:50000
    v_mad_i32_i16 v122, v54, v17, s96
    v_mad_i32_i16 v54, v54, v17, s96 op_sel:[1,0,0,0]
    v_mad_i32_i16 v123, v55, v17, s96
    v_mad_i32_i16 v55, v55, v17, s96 op_sel:[1,0,0,0]
    v_lshlrev_b32_sdwa v17, 3, v17 dst_sel:DWORD dst_unused:UNUSED_PAD src0_sel:DWORD src1_sel:WORD_1
    v_perm_b32 v54, v54, v122, s97
    v_perm_b32 v55, v55, v123, s97
    v_lshl_add_u64 v[54:55], v[54:55], 0, s[30:31]

    ds_add_rtn_u64 v[54:55], v17, v[54:55] offset:50000
    v_mad_i32_i16 v124, v56, v18, s96
    v_mad_i32_i16 v56, v56, v18, s96 op_sel:[1,0,0,0]
    v_mad_i32_i16 v125, v57, v18, s96
    v_mad_i32_i16 v57, v57, v18, s96 op_sel:[1,0,0,0]
    v_lshlrev_b32_sdwa v18, 3, v18 dst_sel:DWORD dst_unused:UNUSED_PAD src0_sel:DWORD src1_sel:WORD_1
    v_perm_b32 v56, v56, v124, s97
    v_perm_b32 v57, v57, v125, s97
    v_lshl_add_u64 v[56:57], v[56:57], 0, s[30:31]

    ds_add_rtn_u64 v[56:57], v18, v[56:57] offset:50000
    v_mad_i32_i16 v126, v58, v19, s96
    v_mad_i32_i16 v58, v58, v19, s96 op_sel:[1,0,0,0]
    v_mad_i32_i16 v127, v59, v19, s96
    v_mad_i32_i16 v59, v59, v19, s96 op_sel:[1,0,0,0]
    v_lshlrev_b32_sdwa v19, 3, v19 dst_sel:DWORD dst_unused:UNUSED_PAD src0_sel:DWORD src1_sel:WORD_1
    v_perm_b32 v58, v58, v126, s97
    v_perm_b32 v59, v59, v127, s97
    v_lshl_add_u64 v[58:59], v[58:59], 0, s[30:31]

    ds_add_rtn_u64 v[58:59], v19, v[58:59] offset:50000
    s_waitcnt lgkmcnt(4)
    v_or3_b32 v1, v44, v45, v1
    v_or3_b32 v1, v46, v47, v1
    v_or3_b32 v1, v48, v49, v1
    v_or3_b32 v1, v50, v51, v1
    s_waitcnt vmcnt(30)
    v_perm_b32 v44, v91, v90, s24
    v_perm_b32 v46, v92, v91, s25
    v_perm_b32 v48, v93, v92, s26
    v_perm_b32 v50, v110, v93, s27
    v_mov_b32 v12, v90
    v_alignbyte_b32 v13, v92, v91, 1
    v_alignbyte_b32 v14, v93, v92, 2
    v_alignbyte_b32 v15, v110, v93, 3
    v_lshlrev_b32_sdwa v44, 3, v44 dst_sel:WORD_0 dst_unused:UNUSED_PAD src0_sel:DWORD src1_sel:DWORD
    v_lshlrev_b32_sdwa v46, 3, v46 dst_sel:WORD_0 dst_unused:UNUSED_PAD src0_sel:DWORD src1_sel:DWORD
    v_lshlrev_b32_sdwa v48, 3, v48 dst_sel:WORD_0 dst_unused:UNUSED_PAD src0_sel:DWORD src1_sel:DWORD
    v_lshlrev_b32_sdwa v50, 3, v50 dst_sel:WORD_0 dst_unused:UNUSED_PAD src0_sel:DWORD src1_sel:DWORD
    s_cmp_lt_i32 s42, 1280
    s_cbranch_scc1 L_ufix_73
L_uback_74:

    s_barrier
    v_subrev_co_u32 v12, s[80:81], 2.0, v12
    v_subrev_co_u32 v13, s[82:83], 2.0, v13
    v_subrev_co_u32 v14, s[84:85], 2.0, v14
    v_subrev_co_u32 v15, s[86:87], 2.0, v15
    s_mov_b64 exec, s[80:81]
    ds_read_b64 v[44:45], v44
    s_mov_b64 exec, s[82:83]
    ds_read_b64 v[46:47], v46
    s_mov_b64 exec, s[84:85]
    ds_read_b64 v[48:49], v48
    s_mov_b64 exec, s[86:87]
    ds_read_b64 v[50:51], v50
    s_mov_b64 exec, -1
    v_mad_i32_i16 v120, v60, v20, s96
    v_mad_i32_i16 v60, v60, v20, s96 op_sel:[1,0,0,0]
    v_mad_i32_i16 v121, v61, v20, s96
    v_mad_i32_i16 v61, v61, v20, s96 op_sel:[1,0,0,0]
    v_lshlrev_b32_sdwa v20, 3, v20 dst_sel:DWORD dst_unused:UNUSED_PAD src0_sel:DWORD src1_sel:WORD_1
    v_perm_b32 v60, v60, v120, s97
    v_perm_b32 v61, v61, v121, s97
    v_lshl_add_u64 v[60:61], v[60:61], 0, s[30:31]

    ds_add_rtn_u64 v[60:61], v20, v[60:61] offset:50000
    v_mad_i32_i16 v122, v62, v21, s96
    v_mad_i32_i16 v62, v62, v21, s96 op_sel:[1,0,0,0]
    v_mad_i32_i16 v123, v63, v21, s96
    v_mad_i32_i16 v63, v63, v21, s96 op_sel:[1,0,0,0]
    v_lshlrev_b32_sdwa v21, 3, v21 dst_sel:DWORD dst_unused:UNUSED_PAD src0_sel:DWORD src1_sel:WORD_1
    v_perm_b32 v62, v62, v122, s97
    v_perm_b32 v63, v63, v123, s97
    v_lshl_add_u64 v[62:63], v[62:63], 0, s[30:31]

    ds_add_rtn_u64 v[62:63], v21, v[62:63] offset:50000
    v_mad_i32_i16 v124, v64, v22, s96
    v_mad_i32_i16 v64, v64, v22, s96 op_sel:[1,0,0,0]
    v_mad_i32_i16 v125, v65, v22, s96
    v_mad_i32_i16 v65, v65, v22, s96 op_sel:[1,0,0,0]
    v_lshlrev_b32_sdwa v22, 3, v22 dst_sel:DWORD dst_unused:UNUSED_PAD src0_sel:DWORD src1_sel:WORD_1
    v_perm_b32 v64, v64, v124, s97
    v_perm_b32 v65, v65, v125, s97
    v_lshl_add_u64 v[64:65], v[64:65], 0, s[30:31]

    ds_add_rtn_u64 v[64:65], v22, v[64:65] offset:50000
    v_mad_i32_i16 v126, v66, v23, s96
    v_mad_i32_i16 v66, v66, v23, s96 op_sel:[1,0,0,0]
    v_mad_i32_i16 v127, v67, v23, s96
    v_mad_i32_i16 v67, v67, v23, s96 op_sel:[1,0,0,0]
    v_lshlrev_b32_sdwa v23, 3, v23 dst_sel:DWORD dst_unused:UNUSED_PAD src0_sel:DWORD src1_sel:WORD_1
    v_perm_b32 v66, v66, v126, s97
    v_perm_b32 v67, v67, v127, s97
    v_lshl_add_u64 v[66:67], v[66:67], 0, s[30:31]

    ds_add_rtn_u64 v[66:67], v23, v[66:67] offset:50000
    s_waitcnt lgkmcnt(8)
    v_or3_b32 v1, v52, v53, v1
    v_or3_b32 v1, v54, v55, v1
    v_or3_b32 v1, v56, v57, v1
    v_or3_b32 v1, v58, v59, v1
    s_waitcnt vmcnt(24)
    v_perm_b32 v52, v95, v94, s24
    v_perm_b32 v54, v96, v95, s25
    v_perm_b32 v56, v97, v96, s26
    v_perm_b32 v58, v111, v97, s27
    v_mov_b32 v16, v94
    v_alignbyte_b32 v17, v96, v95, 1
    v_alignbyte_b32 v18, v97, v96, 2
    v_alignbyte_b32 v19, v111, v97, 3
    v_lshlrev_b32_sdwa v52, 3, v52 dst_sel:WORD_0 dst_unused:UNUSED_PAD src0_sel:DWORD src1_sel:DWORD
    v_lshlrev_b32_sdwa v54, 3, v54 dst_sel:WORD_0 dst_unused:UNUSED_PAD src0_sel:DWORD src1_sel:DWORD
    v_lshlrev_b32_sdwa v56, 3, v56 dst_sel:WORD_0 dst_unused:UNUSED_PAD src0_sel:DWORD src1_sel:DWORD
    v_lshlrev_b32_sdwa v58, 3, v58 dst_sel:WORD_0 dst_unused:UNUSED_PAD src0_sel:DWORD src1_sel:DWORD
    s_cmp_lt_i32 s42, 1792
    s_cbranch_scc1 L_ufix_75
L_uback_76:

    v_subrev_co_u32 v16, s[64:65], 2.0, v16
    v_subrev_co_u32 v17, s[66:67], 2.0, v17
    v_subrev_co_u32 v18, s[68:69], 2.0, v18
    v_subrev_co_u32 v19, s[70:71], 2.0, v19
    s_mov_b64 exec, s[64:65]
    ds_read_b64 v[52:53], v52
    s_mov_b64 exec, s[66:67]
    ds_read_b64 v[54:55], v54
    s_mov_b64 exec, s[68:69]
    ds_read_b64 v[56:57], v56
    s_mov_b64 exec, s[70:71]
    ds_read_b64 v[58:59], v58
    s_mov_b64 exec, -1
    v_mad_i32_i16 v120, v68, v24, s96
    v_mad_i32_i16 v68, v68, v24, s96 op_sel:[1,0,0,0]
    v_mad_i32_i16 v121, v69, v24, s96
    v_mad_i32_i16 v69, v69, v24, s96 op_sel:[1,0,0,0]
    v_lshlrev_b32_sdwa v24, 3, v24 dst_sel:DWORD dst_unused:UNUSED_PAD src0_sel:DWORD src1_sel:WORD_1
    v_perm_b32 v68, v68, v120, s97
    v_perm_b32 v69, v69, v121, s97
    v_lshl_add_u64 v[68:69], v[68:69], 0, s[30:31]

    ds_add_rtn_u64 v[68:69], v24, v[68:69] offset:50000
    v_mad_i32_i16 v122, v70, v25, s96
    v_mad_i32_i16 v70, v70, v25, s96 op_sel:[1,0,0,0]
    v_mad_i32_i16 v123, v71, v25, s96
    v_mad_i32_i16 v71, v71, v25, s96 op_sel:[1,0,0,0]
    v_lshlrev_b32_sdwa v25, 3, v25 dst_sel:DWORD dst_unused:UNUSED_PAD src0_sel:DWORD src1_sel:WORD_1
    v_perm_b32 v70, v70, v122, s97
    v_perm_b32 v71, v71, v123, s97
    v_lshl_add_u64 v[70:71], v[70:71], 0, s[30:31]

    ds_add_rtn_u64 v[70:71], v25, v[70:71] offset:50000
    v_mad_i32_i16 v124, v72, v26, s96
    v_mad_i32_i16 v72, v72, v26, s96 op_sel:[1,0,0,0]
    v_mad_i32_i16 v125, v73, v26, s96
    v_mad_i32_i16 v73, v73, v26, s96 op_sel:[1,0,0,0]
    v_lshlrev_b32_sdwa v26, 3, v26 dst_sel:DWORD dst_unused:UNUSED_PAD src0_sel:DWORD src1_sel:WORD_1
    v_perm_b32 v72, v72, v124, s97
    v_perm_b32 v73, v73, v125, s97
    v_lshl_add_u64 v[72:73], v[72:73], 0, s[30:31]

    ds_add_rtn_u64 v[72:73], v26, v[72:73] offset:50000
    v_mad_i32_i16 v126, v74, v27, s96
    v_mad_i32_i16 v74, v74, v27, s96 op_sel:[1,0,0,0]
    v_mad_i32_i16 v127, v75, v27, s96
    v_mad_i32_i16 v75, v75, v27, s96 op_sel:[1,0,0,0]
    v_lshlrev_b32_sdwa v27, 3, v27 dst_sel:DWORD dst_unused:UNUSED_PAD src0_sel:DWORD src1_sel:WORD_1
    v_perm_b32 v74, v74, v126, s97
    v_perm_b32 v75, v75, v127, s97
    v_lshl_add_u64 v[74:75], v[74:75], 0, s[30:31]

    ds_add_rtn_u64 v[74:75], v27, v[74:75] offset:50000
    s_waitcnt lgkmcnt(8)
    v_or3_b32 v1, v60, v61, v1
    v_or3_b32 v1, v62, v63, v1
    v_or3_b32 v1, v64, v65, v1
    v_or3_b32 v1, v66, v67, v1
    s_waitcnt vmcnt(18)
    v_perm_b32 v60, v99, v98, s24
    v_perm_b32 v62, v100, v99, s25
    v_perm_b32 v64, v101, v100, s26
    v_perm_b32 v66, v112, v101, s27
    v_mov_b32 v20, v98
    v_alignbyte_b32 v21, v100, v99, 1
    v_alignbyte_b32 v22, v101, v100, 2
    v_alignbyte_b32 v23, v112, v101, 3
    v_lshlrev_b32_sdwa v60, 3, v60 dst_sel:WORD_0 dst_unused:UNUSED_PAD src0_sel:DWORD src1_sel:DWORD
    v_lshlrev_b32_sdwa v62, 3, v62 dst_sel:WORD_0 dst_unused:UNUSED_PAD src0_sel:DWORD src1_sel:DWORD
    v_lshlrev_b32_sdwa v64, 3, v64 dst_sel:WORD_0 dst_unused:UNUSED_PAD src0_sel:DWORD src1_sel:DWORD
    v_lshlrev_b32_sdwa v66, 3, v66 dst_sel:WORD_0 dst_unused:UNUSED_PAD src0_sel:DWORD src1_sel:DWORD
    s_cmp_lt_i32 s42, 2304
    s_cbranch_scc1 L_ufix_77
L_uback_78:

    v_subrev_co_u32 v20, s[72:73], 2.0, v20
    v_subrev_co_u32 v21, s[74:75], 2.0, v21
    v_subrev_co_u32 v22, s[76:77], 2.0, v22
    v_subrev_co_u32 v23, s[78:79], 2.0, v23
    s_mov_b64 exec, s[72:73]
    ds_read_b64 v[60:61], v60
    s_mov_b64 exec, s[74:75]
    ds_read_b64 v[62:63], v62
    s_mov_b64 exec, s[76:77]
    ds_read_b64 v[64:65], v64
    s_mov_b64 exec, s[78:79]
    ds_read_b64 v[66:67], v66
    s_mov_b64 exec, -1
    s_waitcnt lgkmcnt(4)
    v_or3_b32 v1, v68, v69, v1
    v_or3_b32 v1, v70, v71, v1
    v_or3_b32 v1, v72, v73, v1
    v_or3_b32 v1, v74, v75, v1
    s_waitcnt vmcnt(10)
    v_perm_b32 v68, v103, v102, s24
    v_perm_b32 v70, v104, v103, s25
    v_perm_b32 v72, v105, v104, s26
    v_perm_b32 v74, v113, v105, s27
    v_mov_b32 v24, v102
    v_alignbyte_b32 v25, v104, v103, 1
    v_alignbyte_b32 v26, v105, v104, 2
    v_alignbyte_b32 v27, v113, v105, 3
    v_lshlrev_b32_sdwa v68, 3, v68 dst_sel:WORD_0 dst_unused:UNUSED_PAD src0_sel:DWORD src1_sel:DWORD
    v_lshlrev_b32_sdwa v70, 3, v70 dst_sel:WORD_0 dst_unused:UNUSED_PAD src0_sel:DWORD src1_sel:DWORD
    v_lshlrev_b32_sdwa v72, 3, v72 dst_sel:WORD_0 dst_unused:UNUSED_PAD src0_sel:DWORD src1_sel:DWORD
    v_lshlrev_b32_sdwa v74, 3, v74 dst_sel:WORD_0 dst_unused:UNUSED_PAD src0_sel:DWORD src1_sel:DWORD
    s_cmp_lt_i32 s42, 2816
    s_cbranch_scc1 L_ufix_79
L_uback_80:

    v_subrev_co_u32 v24, s[80:81], 2.0, v24
    v_subrev_co_u32 v25, s[82:83], 2.0, v25
    v_subrev_co_u32 v26, s[84:85], 2.0, v26
    v_subrev_co_u32 v27, s[86:87], 2.0, v27
    s_mov_b64 exec, s[80:81]
    ds_read_b64 v[68:69], v68
    s_mov_b64 exec, s[82:83]
    ds_read_b64 v[70:71], v70
    s_mov_b64 exec, s[84:85]
    ds_read_b64 v[72:73], v72
    s_mov_b64 exec, s[86:87]
    ds_read_b64 v[74:75], v74
    s_mov_b64 exec, -1
    s_waitcnt vmcnt(2)
    v_perm_b32 v28, v5, v4, s24
    v_perm_b32 v30, v6, v5, s25
    v_perm_b32 v32, v7, v6, s26
    v_perm_b32 v34, v35, v7, s27
    v_alignbyte_b32 v5, v6, v5, 1
    v_alignbyte_b32 v6, v7, v6, 2
    v_alignbyte_b32 v7, v35, v7, 3
    v_lshlrev_b32_sdwa v28, 3, v28 dst_sel:WORD_0 dst_unused:UNUSED_PAD src0_sel:DWORD src1_sel:DWORD
    v_lshlrev_b32_sdwa v30, 3, v30 dst_sel:WORD_0 dst_unused:UNUSED_PAD src0_sel:DWORD src1_sel:DWORD
    v_lshlrev_b32_sdwa v32, 3, v32 dst_sel:WORD_0 dst_unused:UNUSED_PAD src0_sel:DWORD src1_sel:DWORD
    v_lshlrev_b32_sdwa v34, 3, v34 dst_sel:WORD_0 dst_unused:UNUSED_PAD src0_sel:DWORD src1_sel:DWORD
    s_cmp_lt_i32 s42, 256
    s_cbranch_scc1 L_ufix_81
L_uback_82:

    v_subrev_co_u32 v4, s[64:65], 2.0, v4
    v_subrev_co_u32 v5, s[66:67], 2.0, v5
    v_subrev_co_u32 v6, s[68:69], 2.0, v6
    v_subrev_co_u32 v7, s[70:71], 2.0, v7
    s_mov_b64 exec, s[64:65]
    ds_read_b64 v[28:29], v28
    s_mov_b64 exec, s[66:67]
    ds_read_b64 v[30:31], v30
    s_mov_b64 exec, s[68:69]
    ds_read_b64 v[32:33], v32
    s_mov_b64 exec, s[70:71]
    ds_read_b64 v[34:35], v34
    s_mov_b64 exec, -1
    s_waitcnt vmcnt(0)
    v_perm_b32 v36, v9, v8, s24
    v_perm_b32 v38, v10, v9, s25
    v_perm_b32 v40, v11, v10, s26
    v_perm_b32 v42, v43, v11, s27
    v_alignbyte_b32 v9, v10, v9, 1
    v_alignbyte_b32 v10, v11, v10, 2
    v_alignbyte_b32 v11, v43, v11, 3
    v_lshlrev_b32_sdwa v36, 3, v36 dst_sel:WORD_0 dst_unused:UNUSED_PAD src0_sel:DWORD src1_sel:DWORD
    v_lshlrev_b32_sdwa v38, 3, v38 dst_sel:WORD_0 dst_unused:UNUSED_PAD src0_sel:DWORD src1_sel:DWORD
    v_lshlrev_b32_sdwa v40, 3, v40 dst_sel:WORD_0 dst_unused:UNUSED_PAD src0_sel:DWORD src1_sel:DWORD
    v_lshlrev_b32_sdwa v42, 3, v42 dst_sel:WORD_0 dst_unused:UNUSED_PAD src0_sel:DWORD src1_sel:DWORD
    s_cmp_lt_i32 s42, 768
    s_cbranch_scc1 L_ufix_83
L_uback_84:

    v_subrev_co_u32 v8, s[72:73], 2.0, v8
    v_subrev_co_u32 v9, s[74:75], 2.0, v9
    v_subrev_co_u32 v10, s[76:77], 2.0, v10
    v_subrev_co_u32 v11, s[78:79], 2.0, v11
    s_mov_b64 exec, s[72:73]
    ds_read_b64 v[36:37], v36
    s_mov_b64 exec, s[74:75]
    ds_read_b64 v[38:39], v38
    s_mov_b64 exec, s[76:77]
    ds_read_b64 v[40:41], v40
    s_mov_b64 exec, s[78:79]
    ds_read_b64 v[42:43], v42
    s_mov_b64 exec, -1
    s_mov_b32 s38, s5
    s_add_u32 s50, s50, 200000
    s_branch L_batch_64
L_bend_65:

    s_waitcnt lgkmcnt(15)
    v_mad_i32_i16 v120, v28, v4, s96
    v_mad_i32_i16 v28, v28, v4, s96 op_sel:[1,0,0,0]
    v_mad_i32_i16 v121, v29, v4, s96
    v_mad_i32_i16 v29, v29, v4, s96 op_sel:[1,0,0,0]
    v_lshlrev_b32_sdwa v4, 3, v4 dst_sel:DWORD dst_unused:UNUSED_PAD src0_sel:DWORD src1_sel:WORD_1
    v_perm_b32 v28, v28, v120, s97
    v_perm_b32 v29, v29, v121, s97
    v_lshl_add_u64 v[28:29], v[28:29], 0, s[30:31]

    ds_add_rtn_u64 v[28:29], v4, v[28:29] offset:50000
    v_mad_i32_i16 v122, v30, v5, s96
    v_mad_i32_i16 v30, v30, v5, s96 op_sel:[1,0,0,0]
    v_mad_i32_i16 v123, v31, v5, s96
    v_mad_i32_i16 v31, v31, v5, s96 op_sel:[1,0,0,0]
    v_lshlrev_b32_sdwa v5, 3, v5 dst_sel:DWORD dst_unused:UNUSED_PAD src0_sel:DWORD src1_sel:WORD_1
    v_perm_b32 v30, v30, v122, s97
    v_perm_b32 v31, v31, v123, s97
    v_lshl_add_u64 v[30:31], v[30:31], 0, s[30:31]

    ds_add_rtn_u64 v[30:31], v5, v[30:31] offset:50000
    v_mad_i32_i16 v124, v32, v6, s96
    v_mad_i32_i16 v32, v32, v6, s96 op_sel:[1,0,0,0]
    v_mad_i32_i16 v125, v33, v6, s96
    v_mad_i32_i16 v33, v33, v6, s96 op_sel:[1,0,0,0]
    v_lshlrev_b32_sdwa v6, 3, v6 dst_sel:DWORD dst_unused:UNUSED_PAD src0_sel:DWORD src1_sel:WORD_1
    v_perm_b32 v32, v32, v124, s97
    v_perm_b32 v33, v33, v125, s97
    v_lshl_add_u64 v[32:33], v[32:33], 0, s[30:31]

    ds_add_rtn_u64 v[32:33], v6, v[32:33] offset:50000
    v_mad_i32_i16 v126, v34, v7, s96
    v_mad_i32_i16 v34, v34, v7, s96 op_sel:[1,0,0,0]
    v_mad_i32_i16 v127, v35, v7, s96
    v_mad_i32_i16 v35, v35, v7, s96 op_sel:[1,0,0,0]
    v_lshlrev_b32_sdwa v7, 3, v7 dst_sel:DWORD dst_unused:UNUSED_PAD src0_sel:DWORD src1_sel:WORD_1
    v_perm_b32 v34, v34, v126, s97
    v_perm_b32 v35, v35, v127, s97
    v_lshl_add_u64 v[34:35], v[34:35], 0, s[30:31]

    ds_add_rtn_u64 v[34:35], v7, v[34:35] offset:50000
    v_mad_i32_i16 v120, v36, v8, s96
    v_mad_i32_i16 v36, v36, v8, s96 op_sel:[1,0,0,0]
    v_mad_i32_i16 v121, v37, v8, s96
    v_mad_i32_i16 v37, v37, v8, s96 op_sel:[1,0,0,0]
    v_lshlrev_b32_sdwa v8, 3, v8 dst_sel:DWORD dst_unused:UNUSED_PAD src0_sel:DWORD src1_sel:WORD_1
    v_perm_b32 v36, v36, v120, s97
    v_perm_b32 v37, v37, v121, s97
    v_lshl_add_u64 v[36:37], v[36:37], 0, s[30:31]

    ds_add_rtn_u64 v[36:37], v8, v[36:37] offset:50000
    v_mad_i32_i16 v122, v38, v9, s96
    v_mad_i32_i16 v38, v38, v9, s96 op_sel:[1,0,0,0]
    v_mad_i32_i16 v123, v39, v9, s96
    v_mad_i32_i16 v39, v39, v9, s96 op_sel:[1,0,0,0]
    v_lshlrev_b32_sdwa v9, 3, v9 dst_sel:DWORD dst_unused:UNUSED_PAD src0_sel:DWORD src1_sel:WORD_1
    v_perm_b32 v38, v38, v122, s97
    v_perm_b32 v39, v39, v123, s97
    v_lshl_add_u64 v[38:39], v[38:39], 0, s[30:31]

    ds_add_rtn_u64 v[38:39], v9, v[38:39] offset:50000
    v_mad_i32_i16 v124, v40, v10, s96
    v_mad_i32_i16 v40, v40, v10, s96 op_sel:[1,0,0,0]
    v_mad_i32_i16 v125, v41, v10, s96
    v_mad_i32_i16 v41, v41, v10, s96 op_sel:[1,0,0,0]
    v_lshlrev_b32_sdwa v10, 3, v10 dst_sel:DWORD dst_unused:UNUSED_PAD src0_sel:DWORD src1_sel:WORD_1
    v_perm_b32 v40, v40, v124, s97
    v_perm_b32 v41, v41, v125, s97
    v_lshl_add_u64 v[40:41], v[40:41], 0, s[30:31]

    ds_add_rtn_u64 v[40:41], v10, v[40:41] offset:50000
    v_mad_i32_i16 v126, v42, v11, s96
    v_mad_i32_i16 v42, v42, v11, s96 op_sel:[1,0,0,0]
    v_mad_i32_i16 v127, v43, v11, s96
    v_mad_i32_i16 v43, v43, v11, s96 op_sel:[1,0,0,0]
    v_lshlrev_b32_sdwa v11, 3, v11 dst_sel:DWORD dst_unused:UNUSED_PAD src0_sel:DWORD src1_sel:WORD_1
    v_perm_b32 v42, v42, v126, s97
    v_perm_b32 v43, v43, v127, s97
    v_lshl_add_u64 v[42:43], v[42:43], 0, s[30:31]

    ds_add_rtn_u64 v[42:43], v11, v[42:43] offset:50000
    s_waitcnt lgkmcnt(4)
    v_or3_b32 v1, v28, v29, v1
    v_or3_b32 v1, v30, v31, v1
    v_or3_b32 v1, v32, v33, v1
    v_or3_b32 v1, v34, v35, v1
    v_mad_i32_i16 v120, v44, v12, s96
    v_mad_i32_i16 v44, v44, v12, s96 op_sel:[1,0,0,0]
    v_mad_i32_i16 v121, v45, v12, s96
    v_mad_i32_i16 v45, v45, v12, s96 op_sel:[1,0,0,0]
    v_lshlrev_b32_sdwa v12, 3, v12 dst_sel:DWORD dst_unused:UNUSED_PAD src0_sel:DWORD src1_sel:WORD_1
    v_perm_b32 v44, v44, v120, s97
    v_perm_b32 v45, v45, v121, s97
    v_lshl_add_u64 v[44:45], v[44:45], 0, s[30:31]

    ds_add_rtn_u64 v[44:45], v12, v[44:45] offset:50000
    v_mad_i32_i16 v122, v46, v13, s96
    v_mad_i32_i16 v46, v46, v13, s96 op_sel:[1,0,0,0]
    v_mad_i32_i16 v123, v47, v13, s96
    v_mad_i32_i16 v47, v47, v13, s96 op_sel:[1,0,0,0]
    v_lshlrev_b32_sdwa v13, 3, v13 dst_sel:DWORD dst_unused:UNUSED_PAD src0_sel:DWORD src1_sel:WORD_1
    v_perm_b32 v46, v46, v122, s97
    v_perm_b32 v47, v47, v123, s97
    v_lshl_add_u64 v[46:47], v[46:47], 0, s[30:31]

    ds_add_rtn_u64 v[46:47], v13, v[46:47] offset:50000
    v_mad_i32_i16 v124, v48, v14, s96
    v_mad_i32_i16 v48, v48, v14, s96 op_sel:[1,0,0,0]
    v_mad_i32_i16 v125, v49, v14, s96
    v_mad_i32_i16 v49, v49, v14, s96 op_sel:[1,0,0,0]
    v_lshlrev_b32_sdwa v14, 3, v14 dst_sel:DWORD dst_unused:UNUSED_PAD src0_sel:DWORD src1_sel:WORD_1
    v_perm_b32 v48, v48, v124, s97
    v_perm_b32 v49, v49, v125, s97
    v_lshl_add_u64 v[48:49], v[48:49], 0, s[30:31]

    ds_add_rtn_u64 v[48:49], v14, v[48:49] offset:50000
    v_mad_i32_i16 v126, v50, v15, s96
    v_mad_i32_i16 v50, v50, v15, s96 op_sel:[1,0,0,0]
    v_mad_i32_i16 v127, v51, v15, s96
    v_mad_i32_i16 v51, v51, v15, s96 op_sel:[1,0,0,0]
    v_lshlrev_b32_sdwa v15, 3, v15 dst_sel:DWORD dst_unused:UNUSED_PAD src0_sel:DWORD src1_sel:WORD_1
    v_perm_b32 v50, v50, v126, s97
    v_perm_b32 v51, v51, v127, s97
    v_lshl_add_u64 v[50:51], v[50:51], 0, s[30:31]

    ds_add_rtn_u64 v[50:51], v15, v[50:51] offset:50000
    s_waitcnt lgkmcnt(4)
    v_or3_b32 v1, v36, v37, v1
    v_or3_b32 v1, v38, v39, v1
    v_or3_b32 v1, v40, v41, v1
    v_or3_b32 v1, v42, v43, v1
    v_mad_i32_i16 v120, v52, v16, s96
    v_mad_i32_i16 v52, v52, v16, s96 op_sel:[1,0,0,0]
    v_mad_i32_i16 v121, v53, v16, s96
    v_mad_i32_i16 v53, v53, v16, s96 op_sel:[1,0,0,0]
    v_lshlrev_b32_sdwa v16, 3, v16 dst_sel:DWORD dst_unused:UNUSED_PAD src0_sel:DWORD src1_sel:WORD_1
    v_perm_b32 v52, v52, v120, s97
    v_perm_b32 v53, v53, v121, s97
    v_lshl_add_u64 v[52:53], v[52:53], 0, s[30:31]

    ds_add_rtn_u64 v[52:53], v16, v[52:53] offset:50000
    v_mad_i32_i16 v122, v54, v17, s96
    v_mad_i32_i16 v54, v54, v17, s96 op_sel:[1,0,0,0]
    v_mad_i32_i16 v123, v55, v17, s96
    v_mad_i32_i16 v55, v55, v17, s96 op_sel:[1,0,0,0]
    v_lshlrev_b32_sdwa v17, 3, v17 dst_sel:DWORD dst_unused:UNUSED_PAD src0_sel:DWORD src1_sel:WORD_1
    v_perm_b32 v54, v54, v122, s97
    v_perm_b32 v55, v55, v123, s97
    v_lshl_add_u64 v[54:55], v[54:55], 0, s[30:31]

    ds_add_rtn_u64 v[54:55], v17, v[54:55] offset:50000
    v_mad_i32_i16 v124, v56, v18, s96
    v_mad_i32_i16 v56, v56, v18, s96 op_sel:[1,0,0,0]
    v_mad_i32_i16 v125, v57, v18, s96
    v_mad_i32_i16 v57, v57, v18, s96 op_sel:[1,0,0,0]
    v_lshlrev_b32_sdwa v18, 3, v18 dst_sel:DWORD dst_unused:UNUSED_PAD src0_sel:DWORD src1_sel:WORD_1
    v_perm_b32 v56, v56, v124, s97
    v_perm_b32 v57, v57, v125, s97
    v_lshl_add_u64 v[56:57], v[56:57], 0, s[30:31]

    ds_add_rtn_u64 v[56:57], v18, v[56:57] offset:50000
    v_mad_i32_i16 v126, v58, v19, s96
    v_mad_i32_i16 v58, v58, v19, s96 op_sel:[1,0,0,0]
    v_mad_i32_i16 v127, v59, v19, s96
    v_mad_i32_i16 v59, v59, v19, s96 op_sel:[1,0,0,0]
    v_lshlrev_b32_sdwa v19, 3, v19 dst_sel:DWORD dst_unused:UNUSED_PAD src0_sel:DWORD src1_sel:WORD_1
    v_perm_b32 v58, v58, v126, s97
    v_perm_b32 v59, v59, v127, s97
    v_lshl_add_u64 v[58:59], v[58:59], 0, s[30:31]

    ds_add_rtn_u64 v[58:59], v19, v[58:59] offset:50000
    s_waitcnt lgkmcnt(4)
    v_or3_b32 v1, v44, v45, v1
    v_or3_b32 v1, v46, v47, v1
    v_or3_b32 v1, v48, v49, v1
    v_or3_b32 v1, v50, v51, v1
    v_mad_i32_i16 v120, v60, v20, s96
    v_mad_i32_i16 v60, v60, v20, s96 op_sel:[1,0,0,0]
    v_mad_i32_i16 v121, v61, v20, s96
    v_mad_i32_i16 v61, v61, v20, s96 op_sel:[1,0,0,0]
    v_lshlrev_b32_sdwa v20, 3, v20 dst_sel:DWORD dst_unused:UNUSED_PAD src0_sel:DWORD src1_sel:WORD_1
    v_perm_b32 v60, v60, v120, s97
    v_perm_b32 v61, v61, v121, s97
    v_lshl_add_u64 v[60:61], v[60:61], 0, s[30:31]

    ds_add_rtn_u64 v[60:61], v20, v[60:61] offset:50000
    v_mad_i32_i16 v122, v62, v21, s96
    v_mad_i32_i16 v62, v62, v21, s96 op_sel:[1,0,0,0]
    v_mad_i32_i16 v123, v63, v21, s96
    v_mad_i32_i16 v63, v63, v21, s96 op_sel:[1,0,0,0]
    v_lshlrev_b32_sdwa v21, 3, v21 dst_sel:DWORD dst_unused:UNUSED_PAD src0_sel:DWORD src1_sel:WORD_1
    v_perm_b32 v62, v62, v122, s97
    v_perm_b32 v63, v63, v123, s97
    v_lshl_add_u64 v[62:63], v[62:63], 0, s[30:31]

    ds_add_rtn_u64 v[62:63], v21, v[62:63] offset:50000
    v_mad_i32_i16 v124, v64, v22, s96
    v_mad_i32_i16 v64, v64, v22, s96 op_sel:[1,0,0,0]
    v_mad_i32_i16 v125, v65, v22, s96
    v_mad_i32_i16 v65, v65, v22, s96 op_sel:[1,0,0,0]
    v_lshlrev_b32_sdwa v22, 3, v22 dst_sel:DWORD dst_unused:UNUSED_PAD src0_sel:DWORD src1_sel:WORD_1
    v_perm_b32 v64, v64, v124, s97
    v_perm_b32 v65, v65, v125, s97
    v_lshl_add_u64 v[64:65], v[64:65], 0, s[30:31]

    ds_add_rtn_u64 v[64:65], v22, v[64:65] offset:50000
    v_mad_i32_i16 v126, v66, v23, s96
    v_mad_i32_i16 v66, v66, v23, s96 op_sel:[1,0,0,0]
    v_mad_i32_i16 v127, v67, v23, s96
    v_mad_i32_i16 v67, v67, v23, s96 op_sel:[1,0,0,0]
    v_lshlrev_b32_sdwa v23, 3, v23 dst_sel:DWORD dst_unused:UNUSED_PAD src0_sel:DWORD src1_sel:WORD_1
    v_perm_b32 v66, v66, v126, s97
    v_perm_b32 v67, v67, v127, s97
    v_lshl_add_u64 v[66:67], v[66:67], 0, s[30:31]

    ds_add_rtn_u64 v[66:67], v23, v[66:67] offset:50000
    s_waitcnt lgkmcnt(4)
    v_or3_b32 v1, v52, v53, v1
    v_or3_b32 v1, v54, v55, v1
    v_or3_b32 v1, v56, v57, v1
    v_or3_b32 v1, v58, v59, v1
    v_mad_i32_i16 v120, v68, v24, s96
    v_mad_i32_i16 v68, v68, v24, s96 op_sel:[1,0,0,0]
    v_mad_i32_i16 v121, v69, v24, s96
    v_mad_i32_i16 v69, v69, v24, s96 op_sel:[1,0,0,0]
    v_lshlrev_b32_sdwa v24, 3, v24 dst_sel:DWORD dst_unused:UNUSED_PAD src0_sel:DWORD src1_sel:WORD_1
    v_perm_b32 v68, v68, v120, s97
    v_perm_b32 v69, v69, v121, s97
    v_lshl_add_u64 v[68:69], v[68:69], 0, s[30:31]

    ds_add_rtn_u64 v[68:69], v24, v[68:69] offset:50000
    v_mad_i32_i16 v122, v70, v25, s96
    v_mad_i32_i16 v70, v70, v25, s96 op_sel:[1,0,0,0]
    v_mad_i32_i16 v123, v71, v25, s96
    v_mad_i32_i16 v71, v71, v25, s96 op_sel:[1,0,0,0]
    v_lshlrev_b32_sdwa v25, 3, v25 dst_sel:DWORD dst_unused:UNUSED_PAD src0_sel:DWORD src1_sel:WORD_1
    v_perm_b32 v70, v70, v122, s97
    v_perm_b32 v71, v71, v123, s97
    v_lshl_add_u64 v[70:71], v[70:71], 0, s[30:31]

    ds_add_rtn_u64 v[70:71], v25, v[70:71] offset:50000
    v_mad_i32_i16 v124, v72, v26, s96
    v_mad_i32_i16 v72, v72, v26, s96 op_sel:[1,0,0,0]
    v_mad_i32_i16 v125, v73, v26, s96
    v_mad_i32_i16 v73, v73, v26, s96 op_sel:[1,0,0,0]
    v_lshlrev_b32_sdwa v26, 3, v26 dst_sel:DWORD dst_unused:UNUSED_PAD src0_sel:DWORD src1_sel:WORD_1
    v_perm_b32 v72, v72, v124, s97
    v_perm_b32 v73, v73, v125, s97
    v_lshl_add_u64 v[72:73], v[72:73], 0, s[30:31]

    ds_add_rtn_u64 v[72:73], v26, v[72:73] offset:50000
    v_mad_i32_i16 v126, v74, v27, s96
    v_mad_i32_i16 v74, v74, v27, s96 op_sel:[1,0,0,0]
    v_mad_i32_i16 v127, v75, v27, s96
    v_mad_i32_i16 v75, v75, v27, s96 op_sel:[1,0,0,0]
    v_lshlrev_b32_sdwa v27, 3, v27 dst_sel:DWORD dst_unused:UNUSED_PAD src0_sel:DWORD src1_sel:WORD_1
    v_perm_b32 v74, v74, v126, s97
    v_perm_b32 v75, v75, v127, s97
    v_lshl_add_u64 v[74:75], v[74:75], 0, s[30:31]

    ds_add_rtn_u64 v[74:75], v27, v[74:75] offset:50000
    s_waitcnt lgkmcnt(4)
    v_or3_b32 v1, v60, v61, v1
    v_or3_b32 v1, v62, v63, v1
    v_or3_b32 v1, v64, v65, v1
    v_or3_b32 v1, v66, v67, v1
    s_waitcnt lgkmcnt(0)
    v_or3_b32 v1, v68, v69, v1
    v_or3_b32 v1, v70, v71, v1
    v_or3_b32 v1, v72, v73, v1
    v_or3_b32 v1, v74, v75, v1
    s_barrier
    s_mul_i32 s3, s37, 6400000
    s_mul_i32 s5, s36, 100000
    s_add_u32 s3, s3, s5
    s_add_u32 s3, s3, 6799360

    s_add_u32 s20, s6, s3
    s_addc_u32 s21, s7, 0
    s_mov_b32 s22, 100000
    s_mov_b32 s23, 0x20000
    v_lshlrev_b32 v68, 3, v0
    v_add_u32 v69, 50000, v68
    v_add_u32 v70, 115536, v68
    v_cmp_gt_u32 vcc, 212, v0
    v_mov_b32 v52, 0
    v_mov_b32 v53, 0

    ds_read_b64 v[28:29], v69 offset:0
    ds_read_b64 v[30:31], v69 offset:8192
    ds_read_b64 v[32:33], v69 offset:16384
    ds_read_b64 v[34:35], v69 offset:24576
    ds_read_b64 v[36:37], v69 offset:32768
    ds_read_b64 v[38:39], v69 offset:40960
    ds_read_b64 v[40:41], v69 offset:49152
    ds_read_b64 v[42:43], v69 offset:57344
    ds_read_b64 v[44:45], v70 offset:0
    ds_read_b64 v[46:47], v70 offset:8192
    ds_read_b64 v[48:49], v70 offset:16384
    ds_read_b64 v[50:51], v70 offset:24576
    s_mov_b64 exec, vcc
    ds_read_b64 v[52:53], v70 offset:32768
    s_mov_b64 exec, -1
    s_waitcnt lgkmcnt(12)
    s_mov_b32 s3, 0
    buffer_store_dwordx2 v[28:29], v68, s[20:23], s3 offen
    s_waitcnt lgkmcnt(11)
    s_mov_b32 s3, 8192
    buffer_store_dwordx2 v[30:31], v68, s[20:23], s3 offen
    s_waitcnt lgkmcnt(10)
    s_mov_b32 s3, 16384
    buffer_store_dwordx2 v[32:33], v68, s[20:23], s3 offen
    s_waitcnt lgkmcnt(9)
    s_mov_b32 s3, 24576
    buffer_store_dwordx2 v[34:35], v68, s[20:23], s3 offen
    s_waitcnt lgkmcnt(8)
    s_mov_b32 s3, 32768
    buffer_store_dwordx2 v[36:37], v68, s[20:23], s3 offen
    s_waitcnt lgkmcnt(7)
    s_mov_b32 s3, 40960
    buffer_store_dwordx2 v[38:39], v68, s[20:23], s3 offen
    s_waitcnt lgkmcnt(6)
    s_mov_b32 s3, 49152
    buffer_store_dwordx2 v[40:41], v68, s[20:23], s3 offen
    s_waitcnt lgkmcnt(5)
    s_mov_b32 s3, 57344
    buffer_store_dwordx2 v[42:43], v68, s[20:23], s3 offen
    s_waitcnt lgkmcnt(4)
    s_mov_b32 s3, 65536
    buffer_store_dwordx2 v[44:45], v68, s[20:23], s3 offen
    s_waitcnt lgkmcnt(3)
    s_mov_b32 s3, 73728
    buffer_store_dwordx2 v[46:47], v68, s[20:23], s3 offen
    s_waitcnt lgkmcnt(2)
    s_mov_b32 s3, 81920
    buffer_store_dwordx2 v[48:49], v68, s[20:23], s3 offen
    s_waitcnt lgkmcnt(1)
    s_mov_b32 s3, 90112
    buffer_store_dwordx2 v[50:51], v68, s[20:23], s3 offen
    s_waitcnt lgkmcnt(0)
    s_mov_b32 s3, 98304
    buffer_store_dwordx2 v[52:53], v68, s[20:23], s3 offen
    v_or3_b32 v1, v28, v29, v1
    v_or3_b32 v1, v30, v31, v1
    v_or3_b32 v1, v32, v33, v1
    v_or3_b32 v1, v34, v35, v1
    v_or3_b32 v1, v36, v37, v1
    v_or3_b32 v1, v38, v39, v1
    v_or3_b32 v1, v40, v41, v1
    v_or3_b32 v1, v42, v43, v1
    v_or3_b32 v1, v44, v45, v1
    v_or3_b32 v1, v46, v47, v1
    v_or3_b32 v1, v48, v49, v1
    v_or3_b32 v1, v50, v51, v1
    v_or3_b32 v1, v52, v53, v1
    v_and_b32 v1, 0x80008000, v1
    v_cmp_ne_u32 vcc, 0, v1
    v_mov_b32 v71, 150024
    v_mov_b32 v72, 1
    s_cbranch_vccz L_nf_85
    ds_write_b32 v71, v72
L_nf_85:
    s_waitcnt lgkmcnt(0)
    s_barrier
    ds_read_b32 v72, v71
    s_waitcnt lgkmcnt(0)
    v_readfirstlane_b32 s3, v72
    s_nop 1
    s_cmp_lg_u32 s3, 0
    s_cbranch_scc1 L_p2slow_51

L_fin_86:
    s_add_u32 s20, s6, 147456
    s_addc_u32 s21, s7, 0
    s_mov_b32 s22, 1024
    s_mov_b32 s23, 0x20000
    s_lshl_b32 s3, s36, 2
    s_add_u32 s3, s3, s37
    s_lshl_b32 s3, s3, 2
    v_lshlrev_b32 v73, 20, v0
    v_mov_b32 v74, s34
    buffer_store_dword v74, v73, s[20:23], s3 offen

L_p2done_50:
    s_endpgm

L_ufix_52:
    v_and_b32 v117, 63, v0
    v_lshlrev_b32 v117, 2, v117
    s_sub_i32 s54, s42, 1024
    v_cmp_le_i32 vcc, s54, v117
    s_mov_b64 exec, vcc
    v_mov_b32 v12, 0
    v_mov_b32 v44, 0
    s_mov_b64 exec, -1
    s_sub_i32 s54, s42, 1025
    v_cmp_le_i32 vcc, s54, v117
    s_mov_b64 exec, vcc
    v_mov_b32 v13, 0
    v_mov_b32 v46, 0
    s_mov_b64 exec, -1
    s_sub_i32 s54, s42, 1026
    v_cmp_le_i32 vcc, s54, v117
    s_mov_b64 exec, vcc
    v_mov_b32 v14, 0
    v_mov_b32 v48, 0
    s_mov_b64 exec, -1
    s_sub_i32 s54, s42, 1027
    v_cmp_le_i32 vcc, s54, v117
    s_mov_b64 exec, vcc
    v_mov_b32 v15, 0
    v_mov_b32 v50, 0
    s_mov_b64 exec, -1
    s_branch L_uback_53
L_ufix_54:
    v_and_b32 v117, 63, v0
    v_lshlrev_b32 v117, 2, v117
    s_sub_i32 s54, s42, 1536
    v_cmp_le_i32 vcc, s54, v117
    s_mov_b64 exec, vcc
    v_mov_b32 v16, 0
    v_mov_b32 v52, 0
    s_mov_b64 exec, -1
    s_sub_i32 s54, s42, 1537
    v_cmp_le_i32 vcc, s54, v117
    s_mov_b64 exec, vcc
    v_mov_b32 v17, 0
    v_mov_b32 v54, 0
    s_mov_b64 exec, -1
    s_sub_i32 s54, s42, 1538
    v_cmp_le_i32 vcc, s54, v117
    s_mov_b64 exec, vcc
    v_mov_b32 v18, 0
    v_mov_b32 v56, 0
    s_mov_b64 exec, -1
    s_sub_i32 s54, s42, 1539
    v_cmp_le_i32 vcc, s54, v117
    s_mov_b64 exec, vcc
    v_mov_b32 v19, 0
    v_mov_b32 v58, 0
    s_mov_b64 exec, -1
    s_branch L_uback_55
L_ufix_56:
    v_and_b32 v117, 63, v0
    v_lshlrev_b32 v117, 2, v117
    s_sub_i32 s54, s42, 2048
    v_cmp_le_i32 vcc, s54, v117
    s_mov_b64 exec, vcc
    v_mov_b32 v20, 0
    v_mov_b32 v60, 0
    s_mov_b64 exec, -1
    s_sub_i32 s54, s42, 2049
    v_cmp_le_i32 vcc, s54, v117
    s_mov_b64 exec, vcc
    v_mov_b32 v21, 0
    v_mov_b32 v62, 0
    s_mov_b64 exec, -1
    s_sub_i32 s54, s42, 2050
    v_cmp_le_i32 vcc, s54, v117
    s_mov_b64 exec, vcc
    v_mov_b32 v22, 0
    v_mov_b32 v64, 0
    s_mov_b64 exec, -1
    s_sub_i32 s54, s42, 2051
    v_cmp_le_i32 vcc, s54, v117
    s_mov_b64 exec, vcc
    v_mov_b32 v23, 0
    v_mov_b32 v66, 0
    s_mov_b64 exec, -1
    s_branch L_uback_57
L_ufix_58:
    v_and_b32 v117, 63, v0
    v_lshlrev_b32 v117, 2, v117
    s_sub_i32 s54, s42, 2560
    v_cmp_le_i32 vcc, s54, v117
    s_mov_b64 exec, vcc
    v_mov_b32 v24, 0
    v_mov_b32 v68, 0
    s_mov_b64 exec, -1
    s_sub_i32 s54, s42, 2561
    v_cmp_le_i32 vcc, s54, v117
    s_mov_b64 exec, vcc
    v_mov_b32 v25, 0
    v_mov_b32 v70, 0
    s_mov_b64 exec, -1
    s_sub_i32 s54, s42, 2562
    v_cmp_le_i32 vcc, s54, v117
    s_mov_b64 exec, vcc
    v_mov_b32 v26, 0
    v_mov_b32 v72, 0
    s_mov_b64 exec, -1
    s_sub_i32 s54, s42, 2563
    v_cmp_le_i32 vcc, s54, v117
    s_mov_b64 exec, vcc
    v_mov_b32 v27, 0
    v_mov_b32 v74, 0
    s_mov_b64 exec, -1
    s_branch L_uback_59
L_ufix_60:
    v_and_b32 v117, 63, v0
    v_lshlrev_b32 v117, 2, v117
    s_sub_i32 s54, s42, 0
    v_cmp_le_i32 vcc, s54, v117
    s_mov_b64 exec, vcc
    v_mov_b32 v4, 0
    v_mov_b32 v28, 0
    s_mov_b64 exec, -1
    s_sub_i32 s54, s42, 1
    v_cmp_le_i32 vcc, s54, v117
    s_mov_b64 exec, vcc
    v_mov_b32 v5, 0
    v_mov_b32 v30, 0
    s_mov_b64 exec, -1
    s_sub_i32 s54, s42, 2
    v_cmp_le_i32 vcc, s54, v117
    s_mov_b64 exec, vcc
    v_mov_b32 v6, 0
    v_mov_b32 v32, 0
    s_mov_b64 exec, -1
    s_sub_i32 s54, s42, 3
    v_cmp_le_i32 vcc, s54, v117
    s_mov_b64 exec, vcc
    v_mov_b32 v7, 0
    v_mov_b32 v34, 0
    s_mov_b64 exec, -1
    s_branch L_uback_61
L_ufix_62:
    v_and_b32 v117, 63, v0
    v_lshlrev_b32 v117, 2, v117
    s_sub_i32 s54, s42, 512
    v_cmp_le_i32 vcc, s54, v117
    s_mov_b64 exec, vcc
    v_mov_b32 v8, 0
    v_mov_b32 v36, 0
    s_mov_b64 exec, -1
    s_sub_i32 s54, s42, 513
    v_cmp_le_i32 vcc, s54, v117
    s_mov_b64 exec, vcc
    v_mov_b32 v9, 0
    v_mov_b32 v38, 0
    s_mov_b64 exec, -1
    s_sub_i32 s54, s42, 514
    v_cmp_le_i32 vcc, s54, v117
    s_mov_b64 exec, vcc
    v_mov_b32 v10, 0
    v_mov_b32 v40, 0
    s_mov_b64 exec, -1
    s_sub_i32 s54, s42, 515
    v_cmp_le_i32 vcc, s54, v117
    s_mov_b64 exec, vcc
    v_mov_b32 v11, 0
    v_mov_b32 v42, 0
    s_mov_b64 exec, -1
    s_branch L_uback_63
L_ufix_69:
    v_and_b32 v117, 63, v0
    v_lshlrev_b32 v117, 2, v117
    s_sub_i32 s54, s42, 3072
    v_cmp_le_i32 vcc, s54, v117
    s_mov_b64 exec, vcc
    v_mov_b32 v106, 0
    v_mov_b32 v120, 0
    s_mov_b64 exec, -1
    s_sub_i32 s54, s42, 3073
    v_cmp_le_i32 vcc, s54, v117
    s_mov_b64 exec, vcc
    v_mov_b32 v107, 0
    v_mov_b32 v122, 0
    s_mov_b64 exec, -1
    s_sub_i32 s54, s42, 3074
    v_cmp_le_i32 vcc, s54, v117
    s_mov_b64 exec, vcc
    v_mov_b32 v108, 0
    v_mov_b32 v124, 0
    s_mov_b64 exec, -1
    s_sub_i32 s54, s42, 3075
    v_cmp_le_i32 vcc, s54, v117
    s_mov_b64 exec, vcc
    v_mov_b32 v109, 0
    v_mov_b32 v126, 0
    s_mov_b64 exec, -1
    s_branch L_uback_70
L_ufix_73:
    v_and_b32 v117, 63, v0
    v_lshlrev_b32 v117, 2, v117
    s_sub_i32 s54, s42, 1024
    v_cmp_le_i32 vcc, s54, v117
    s_mov_b64 exec, vcc
    v_mov_b32 v12, 0
    v_mov_b32 v44, 0
    s_mov_b64 exec, -1
    s_sub_i32 s54, s42, 1025
    v_cmp_le_i32 vcc, s54, v117
    s_mov_b64 exec, vcc
    v_mov_b32 v13, 0
    v_mov_b32 v46, 0
    s_mov_b64 exec, -1
    s_sub_i32 s54, s42, 1026
    v_cmp_le_i32 vcc, s54, v117
    s_mov_b64 exec, vcc
    v_mov_b32 v14, 0
    v_mov_b32 v48, 0
    s_mov_b64 exec, -1
    s_sub_i32 s54, s42, 1027
    v_cmp_le_i32 vcc, s54, v117
    s_mov_b64 exec, vcc
    v_mov_b32 v15, 0
    v_mov_b32 v50, 0
    s_mov_b64 exec, -1
    s_branch L_uback_74
L_ufix_75:
    v_and_b32 v117, 63, v0
    v_lshlrev_b32 v117, 2, v117
    s_sub_i32 s54, s42, 1536
    v_cmp_le_i32 vcc, s54, v117
    s_mov_b64 exec, vcc
    v_mov_b32 v16, 0
    v_mov_b32 v52, 0
    s_mov_b64 exec, -1
    s_sub_i32 s54, s42, 1537
    v_cmp_le_i32 vcc, s54, v117
    s_mov_b64 exec, vcc
    v_mov_b32 v17, 0
    v_mov_b32 v54, 0
    s_mov_b64 exec, -1
    s_sub_i32 s54, s42, 1538
    v_cmp_le_i32 vcc, s54, v117
    s_mov_b64 exec, vcc
    v_mov_b32 v18, 0
    v_mov_b32 v56, 0
    s_mov_b64 exec, -1
    s_sub_i32 s54, s42, 1539
    v_cmp_le_i32 vcc, s54, v117
    s_mov_b64 exec, vcc
    v_mov_b32 v19, 0
    v_mov_b32 v58, 0
    s_mov_b64 exec, -1
    s_branch L_uback_76
L_ufix_77:
    v_and_b32 v117, 63, v0
    v_lshlrev_b32 v117, 2, v117
    s_sub_i32 s54, s42, 2048
    v_cmp_le_i32 vcc, s54, v117
    s_mov_b64 exec, vcc
    v_mov_b32 v20, 0
    v_mov_b32 v60, 0
    s_mov_b64 exec, -1
    s_sub_i32 s54, s42, 2049
    v_cmp_le_i32 vcc, s54, v117
    s_mov_b64 exec, vcc
    v_mov_b32 v21, 0
    v_mov_b32 v62, 0
    s_mov_b64 exec, -1
    s_sub_i32 s54, s42, 2050
    v_cmp_le_i32 vcc, s54, v117
    s_mov_b64 exec, vcc
    v_mov_b32 v22, 0
    v_mov_b32 v64, 0
    s_mov_b64 exec, -1
    s_sub_i32 s54, s42, 2051
    v_cmp_le_i32 vcc, s54, v117
    s_mov_b64 exec, vcc
    v_mov_b32 v23, 0
    v_mov_b32 v66, 0
    s_mov_b64 exec, -1
    s_branch L_uback_78
L_ufix_79:
    v_and_b32 v117, 63, v0
    v_lshlrev_b32 v117, 2, v117
    s_sub_i32 s54, s42, 2560
    v_cmp_le_i32 vcc, s54, v117
    s_mov_b64 exec, vcc
    v_mov_b32 v24, 0
    v_mov_b32 v68, 0
    s_mov_b64 exec, -1
    s_sub_i32 s54, s42, 2561
    v_cmp_le_i32 vcc, s54, v117
    s_mov_b64 exec, vcc
    v_mov_b32 v25, 0
    v_mov_b32 v70, 0
    s_mov_b64 exec, -1
    s_sub_i32 s54, s42, 2562
    v_cmp_le_i32 vcc, s54, v117
    s_mov_b64 exec, vcc
    v_mov_b32 v26, 0
    v_mov_b32 v72, 0
    s_mov_b64 exec, -1
    s_sub_i32 s54, s42, 2563
    v_cmp_le_i32 vcc, s54, v117
    s_mov_b64 exec, vcc
    v_mov_b32 v27, 0
    v_mov_b32 v74, 0
    s_mov_b64 exec, -1
    s_branch L_uback_80
L_ufix_81:
    v_and_b32 v117, 63, v0
    v_lshlrev_b32 v117, 2, v117
    s_sub_i32 s54, s42, 0
    v_cmp_le_i32 vcc, s54, v117
    s_mov_b64 exec, vcc
    v_mov_b32 v4, 0
    v_mov_b32 v28, 0
    s_mov_b64 exec, -1
    s_sub_i32 s54, s42, 1
    v_cmp_le_i32 vcc, s54, v117
    s_mov_b64 exec, vcc
    v_mov_b32 v5, 0
    v_mov_b32 v30, 0
    s_mov_b64 exec, -1
    s_sub_i32 s54, s42, 2
    v_cmp_le_i32 vcc, s54, v117
    s_mov_b64 exec, vcc
    v_mov_b32 v6, 0
    v_mov_b32 v32, 0
    s_mov_b64 exec, -1
    s_sub_i32 s54, s42, 3
    v_cmp_le_i32 vcc, s54, v117
    s_mov_b64 exec, vcc
    v_mov_b32 v7, 0
    v_mov_b32 v34, 0
    s_mov_b64 exec, -1
    s_branch L_uback_82
L_ufix_83:
    v_and_b32 v117, 63, v0
    v_lshlrev_b32 v117, 2, v117
    s_sub_i32 s54, s42, 512
    v_cmp_le_i32 vcc, s54, v117
    s_mov_b64 exec, vcc
    v_mov_b32 v8, 0
    v_mov_b32 v36, 0
    s_mov_b64 exec, -1
    s_sub_i32 s54, s42, 513
    v_cmp_le_i32 vcc, s54, v117
    s_mov_b64 exec, vcc
    v_mov_b32 v9, 0
    v_mov_b32 v38, 0
    s_mov_b64 exec, -1
    s_sub_i32 s54, s42, 514
    v_cmp_le_i32 vcc, s54, v117
    s_mov_b64 exec, vcc
    v_mov_b32 v10, 0
    v_mov_b32 v40, 0
    s_mov_b64 exec, -1
    s_sub_i32 s54, s42, 515
    v_cmp_le_i32 vcc, s54, v117
    s_mov_b64 exec, vcc
    v_mov_b32 v11, 0
    v_mov_b32 v42, 0
    s_mov_b64 exec, -1
    s_branch L_uback_84
L_p2slow_51:
    s_waitcnt vmcnt(0) lgkmcnt(0)
    s_mov_b32 s51, 0
    s_movk_i32 s43, 6250
    s_mov_b32 s34, 0
L_sweep_87:
    s_barrier

    v_mov_b32 v28, 0x0
    v_mov_b32 v29, 0x0
    v_mov_b32 v30, 0x0
    v_mov_b32 v31, 0x0
    v_add_u32 v32, 50000, v3
    v_add_u32 v33, 65536, v32

    ds_write_b128 v32, v[28:31] offset:0
    ds_write_b128 v32, v[28:31] offset:16384
    ds_write_b128 v32, v[28:31] offset:32768
    ds_write_b128 v32, v[28:31] offset:49152
    ds_write_b128 v33, v[28:31] offset:0
    ds_write_b128 v33, v[28:31] offset:16384
    v_cmp_gt_u32 vcc, 971, v0
    s_mov_b64 exec, vcc
    ds_write_b128 v33, v[28:31] offset:32768
    s_mov_b64 exec, -1
    s_waitcnt lgkmcnt(0)
    s_barrier
    s_sub_u32 s38, s4, 8
L_sbatch_88:
    s_lshl_b32 s52, s38, 6
    s_add_u32 s52, s52, s36
    s_lshl_b32 s52, s52, 2
    s_load_dword s40, s[46:47], s52
    s_mul_i32 s50, s38, 200000
    s_waitcnt lgkmcnt(0)

    s_min_u32 s40, s40, 3968
    s_lshl_b32 s52, s38, 6
    s_add_u32 s52, s52, s36
    s_mul_i32 s52, s52, 19840
    s_add_u32 s20, s44, s52
    s_addc_u32 s21, s45, 0
    s_mul_i32 s52, s40, 5
    s_add_u32 s52, s52, 3
    s_and_b32 s22, s52, -4

    s_lshr_b32 s55, s39, 2
    s_add_u32 s55, s55, 0
    v_and_b32 v36, 63, v0
    v_add_u32 v36, s55, v36
L_left_92:
    s_cmp_ge_u32 s55, s40
    s_cbranch_scc1 L_leftend_93
    v_mul_u32_u24 v37, 5, v36
    buffer_load_dword v38, v37, s[20:23], 0 offen
    buffer_load_ubyte v39, v37, s[20:23], 0 offen offset:4
    s_waitcnt vmcnt(0)

    v_perm_b32 v37, v39, v38, s24
    v_lshrrev_b32 v42, 30, v38
    v_and_b32 v37, 0x1fff, v37
    v_mul_u32_u24 v42, 6250, v42
    v_add_lshl_u32 v37, v37, v42, 3

    buffer_load_dwordx2 v[40:41], v37, s[8:11], s50 offen
    v_cmp_gt_u32 vcc, s40, v36
    s_waitcnt vmcnt(0)

    v_bfe_u32 v44, v38, 16, 14
    v_subrev_u32 v44, s51, v44
    v_cmp_gt_u32 s[64:65], s43, v44
    s_and_b64 exec, vcc, s[64:65]
    v_lshlrev_b32 v45, 8, v38
    v_cmpx_ne_u32 vcc, 0, v45
    v_lshlrev_b32 v44, 4, v44
    v_bfe_i32 v38, v38, 0, 16
    v_cvt_f32_i32 v38, v38
    v_mul_f32 v38, 0x38004020, v38
    v_lshlrev_b32 v45, 16, v40
    v_and_b32 v46, s32, v40
    v_lshlrev_b32 v47, 16, v41
    v_and_b32 v48, s32, v41

    v_mul_f32 v45, v45, v38
    ds_add_f32 v44, v45 offset:50000
    v_mul_f32 v46, v46, v38
    ds_add_f32 v44, v46 offset:50004
    v_mul_f32 v47, v47, v38
    ds_add_f32 v44, v47 offset:50008
    v_mul_f32 v48, v48, v38
    ds_add_f32 v44, v48 offset:50012
    s_mov_b64 exec, -1
    v_add_u32 v36, 128, v36
    s_add_u32 s55, s55, 128
    s_branch L_left_92
L_leftend_93:

    s_add_u32 s38, s38, 1
    s_cmp_lt_u32 s38, s4
    s_cbranch_scc1 L_sbatch_88
    s_mov_b32 s3, 65536
    s_load_dword s40, s[6:7], s3

    s_add_u32 s20, s6, 408657920
    s_addc_u32 s21, s7, 0
    s_mov_b32 s22, 409600000
    s_mov_b32 s23, 0x20000
    s_mov_b32 s38, 0
    s_mov_b32 s50, 200000
    v_mov_b32 v36, v0
    s_waitcnt lgkmcnt(0)
L_ovf_89:
    s_cmp_ge_u32 s38, s40
    s_cbranch_scc1 L_ovfend_90
    v_lshlrev_b32 v37, 3, v36
    buffer_load_dwordx2 v[38:39], v37, s[20:23], 0 offen
    s_waitcnt vmcnt(0)

    v_perm_b32 v37, v39, v38, s24
    v_lshrrev_b32 v42, 30, v38
    v_and_b32 v37, 0x1fff, v37
    v_mul_u32_u24 v42, 6250, v42
    v_add_lshl_u32 v37, v37, v42, 3

    v_bfe_u32 v42, v39, 24, 5
    v_mad_u32_u24 v37, v42, s50, v37
    buffer_load_dwordx2 v[40:41], v37, s[8:11], 0 offen
    v_lshrrev_b32 v42, 3, v42
    v_bfe_u32 v43, v39, 18, 6
    v_cmp_gt_u32 vcc, s40, v36
    v_cmp_eq_u32 s[64:65], s36, v43
    s_and_b64 vcc, vcc, s[64:65]
    v_cmp_eq_u32 s[64:65], s37, v42
    s_and_b64 vcc, vcc, s[64:65]
    s_waitcnt vmcnt(0)

    v_bfe_u32 v44, v38, 16, 14
    v_subrev_u32 v44, s51, v44
    v_cmp_gt_u32 s[64:65], s43, v44
    s_and_b64 exec, vcc, s[64:65]
    v_lshlrev_b32 v45, 8, v38
    v_cmpx_ne_u32 vcc, 0, v45
    v_lshlrev_b32 v44, 4, v44
    v_bfe_i32 v38, v38, 0, 16
    v_cvt_f32_i32 v38, v38
    v_mul_f32 v38, 0x38004020, v38
    v_lshlrev_b32 v45, 16, v40
    v_and_b32 v46, s32, v40
    v_lshlrev_b32 v47, 16, v41
    v_and_b32 v48, s32, v41

    v_mul_f32 v45, v45, v38
    ds_add_f32 v44, v45 offset:50000
    v_mul_f32 v46, v46, v38
    ds_add_f32 v44, v46 offset:50004
    v_mul_f32 v47, v47, v38
    ds_add_f32 v44, v47 offset:50008
    v_mul_f32 v48, v48, v38
    ds_add_f32 v44, v48 offset:50012
    s_mov_b64 exec, -1
    v_add_u32 v36, 1024, v36
    s_add_u32 s38, s38, 1024
    s_branch L_ovf_89
L_ovfend_90:
    s_waitcnt lgkmcnt(0)
    s_barrier
    s_mul_i32 s3, s37, 800000
    s_mul_i32 s5, s36, 12500
    s_add_u32 s3, s3, s5
    s_add_u32 s3, s3, s51
    s_lshl_b32 s3, s3, 4
    s_add_u32 s3, s3, 32399360

    s_add_u32 s20, s6, s3
    s_addc_u32 s21, s7, 0
    s_mov_b32 s22, 100000
    s_mov_b32 s23, 0x20000
    v_mov_b32 v36, v3
    s_mov_b32 s38, 0
L_wl_91:
    v_min_u32 v37, 100000, v36
    ds_read_b128 v[28:31], v37 offset:50000
    s_waitcnt lgkmcnt(0)
    buffer_store_dwordx4 v[28:31], v36, s[20:23], 0 offen
    s_waitcnt vmcnt(0)
    v_add_u32 v36, 16384, v36
    s_add_u32 s38, s38, 1024
    s_cmp_lt_u32 s38, 6250
    s_cbranch_scc1 L_wl_91
    s_add_u32 s51, s51, 6250
    s_cmp_lt_u32 s51, 12500
    s_cbranch_scc1 L_sweep_87
    s_branch L_fin_86

.globl standalone__molecular_angular_gemnet__graph_kernel
.p2align 8
.type standalone__molecular_angular_gemnet__graph_kernel,@function
standalone__molecular_angular_gemnet__graph_kernel:
    s_cmp_ge_u32 s2, 1600
    s_cbranch_scc1 L_fdone_94
    s_load_dwordx2 s[4:5], s[0:1], 0
    s_load_dwordx2 s[8:9], s[0:1], 24
    s_load_dwordx2 s[12:13], s[0:1], 88
    s_load_dwordx2 s[16:17], s[0:1], 104
    s_load_dwordx2 s[78:79], s[0:1], 40
    s_load_dwordx8 s[24:31], s[0:1], 56
    v_cmp_gt_u32 vcc, 250, v0
    s_mul_i32 s3, s2, 250
    v_add_u32 v0, s3, v0
    v_lshlrev_b32 v1, 4, v0
    v_lshlrev_b32 v2, 2, v0
    s_mov_b64 exec, vcc
    s_mul_hi_u32 s3, s2, 171798692
    s_lshl_b32 s3, s3, 4
    s_add_u32 s3, s3, 147456
    s_mov_b32 s6, 6400000
    s_mov_b32 s7, 0x20000
    s_mov_b32 s10, 1600000
    s_mov_b32 s11, 0x20000
    s_mov_b32 s14, 6400000
    s_mov_b32 s15, 0x20000
    s_mov_b32 s18, 76800000
    s_mov_b32 s19, 0x20000
    s_waitcnt lgkmcnt(0)
    buffer_load_dword v3, v2, s[8:11], 0 offen
    s_load_dwordx4 s[32:35], s[78:79], 0
    s_load_dwordx4 s[20:23], s[16:17], s3
    s_load_dwordx16 s[36:51], s[24:25], 0
    s_load_dwordx16 s[52:67], s[26:27], 0
    s_load_dwordx8 s[68:75], s[28:29], 0
    s_mov_b64 s[0:1], s[30:31]
    s_load_dwordx8 s[24:31], s[0:1], 0
    s_add_u32 s16, s16, 6799360
    s_addc_u32 s17, s17, 0

    s_mov_b32 s3, 0
    buffer_load_dwordx4 v[40:43], v1, s[16:19], s3 offen nt
    s_mov_b32 s3, 6400000
    buffer_load_dwordx4 v[44:47], v1, s[16:19], s3 offen nt
    s_mov_b32 s3, 12800000
    buffer_load_dwordx4 v[48:51], v1, s[16:19], s3 offen nt
    s_mov_b32 s3, 19200000
    buffer_load_dwordx4 v[52:55], v1, s[16:19], s3 offen nt
    buffer_load_dwordx4 v[56:59], v1, s[4:7], 0 offen
    s_mov_b32 s76, 0xffff0000
    s_waitcnt vmcnt(5) lgkmcnt(0)
    v_and_b32 v5, s76, v3
    v_lshlrev_b32 v4, 16, v3

    s_lshl_b32 s77, s32, 16
    v_subrev_f32 v8, s77, v4
    v_subrev_f32 v16, s77, v5
    s_and_b32 s78, s32, s76
    v_subrev_f32 v9, s78, v4
    v_subrev_f32 v17, s78, v5
    s_lshl_b32 s77, s33, 16
    v_subrev_f32 v10, s77, v4
    v_subrev_f32 v18, s77, v5
    s_and_b32 s78, s33, s76
    v_subrev_f32 v11, s78, v4
    v_subrev_f32 v19, s78, v5
    s_lshl_b32 s77, s34, 16
    v_subrev_f32 v12, s77, v4
    v_subrev_f32 v20, s77, v5
    s_and_b32 s78, s34, s76
    v_subrev_f32 v13, s78, v4
    v_subrev_f32 v21, s78, v5
    s_lshl_b32 s77, s35, 16
    v_subrev_f32 v14, s77, v4
    v_subrev_f32 v22, s77, v5
    s_and_b32 s78, s35, s76
    v_subrev_f32 v15, s78, v4
    v_subrev_f32 v23, s78, v5
    v_cvt_pk_bf16_f32 v8, v8, v9
    v_cvt_pk_bf16_f32 v10, v10, v11
    v_cvt_pk_bf16_f32 v12, v12, v13
    v_cvt_pk_bf16_f32 v14, v14, v15
    v_cvt_pk_bf16_f32 v16, v16, v17
    v_cvt_pk_bf16_f32 v18, v18, v19
    v_cvt_pk_bf16_f32 v20, v20, v21
    v_cvt_pk_bf16_f32 v22, v22, v23
    v_and_b32 v9, s76, v8
    v_lshlrev_b32 v8, 16, v8
    v_and_b32 v11, s76, v10
    v_lshlrev_b32 v10, 16, v10
    v_and_b32 v13, s76, v12
    v_lshlrev_b32 v12, 16, v12
    v_and_b32 v15, s76, v14
    v_lshlrev_b32 v14, 16, v14
    v_and_b32 v17, s76, v16
    v_lshlrev_b32 v16, 16, v16
    v_and_b32 v19, s76, v18
    v_lshlrev_b32 v18, 16, v18
    v_and_b32 v21, s76, v20
    v_lshlrev_b32 v20, 16, v20
    v_and_b32 v23, s76, v22
    v_lshlrev_b32 v22, 16, v22
    v_mul_f32 v8, v8, v8
    v_mul_f32 v9, v9, v9
    v_mul_f32 v10, v10, v10
    v_mul_f32 v11, v11, v11
    v_mul_f32 v12, v12, v12
    v_mul_f32 v13, v13, v13
    v_mul_f32 v14, v14, v14
    v_mul_f32 v15, v15, v15
    v_mul_f32 v16, v16, v16
    v_mul_f32 v17, v17, v17
    v_mul_f32 v18, v18, v18
    v_mul_f32 v19, v19, v19
    v_mul_f32 v20, v20, v20
    v_mul_f32 v21, v21, v21
    v_mul_f32 v22, v22, v22
    v_mul_f32 v23, v23, v23
    v_cvt_pk_bf16_f32 v8, v8, v9
    v_cvt_pk_bf16_f32 v10, v10, v11
    v_cvt_pk_bf16_f32 v12, v12, v13
    v_cvt_pk_bf16_f32 v14, v14, v15
    v_cvt_pk_bf16_f32 v16, v16, v17
    v_cvt_pk_bf16_f32 v18, v18, v19
    v_cvt_pk_bf16_f32 v20, v20, v21
    v_cvt_pk_bf16_f32 v22, v22, v23
    v_and_b32 v9, s76, v8
    v_lshlrev_b32 v8, 16, v8
    v_and_b32 v11, s76, v10
    v_lshlrev_b32 v10, 16, v10
    v_and_b32 v13, s76, v12
    v_lshlrev_b32 v12, 16, v12
    v_and_b32 v15, s76, v14
    v_lshlrev_b32 v14, 16, v14
    v_and_b32 v17, s76, v16
    v_lshlrev_b32 v16, 16, v16
    v_and_b32 v19, s76, v18
    v_lshlrev_b32 v18, 16, v18
    v_and_b32 v21, s76, v20
    v_lshlrev_b32 v20, 16, v20
    v_and_b32 v23, s76, v22
    v_lshlrev_b32 v22, 16, v22
    v_mul_f32 v8, 0xc1200000, v8
    v_mul_f32 v9, 0xc1200000, v9
    v_mul_f32 v10, 0xc1200000, v10
    v_mul_f32 v11, 0xc1200000, v11
    v_mul_f32 v12, 0xc1200000, v12
    v_mul_f32 v13, 0xc1200000, v13
    v_mul_f32 v14, 0xc1200000, v14
    v_mul_f32 v15, 0xc1200000, v15
    v_mul_f32 v16, 0xc1200000, v16
    v_mul_f32 v17, 0xc1200000, v17
    v_mul_f32 v18, 0xc1200000, v18
    v_mul_f32 v19, 0xc1200000, v19
    v_mul_f32 v20, 0xc1200000, v20
    v_mul_f32 v21, 0xc1200000, v21
    v_mul_f32 v22, 0xc1200000, v22
    v_mul_f32 v23, 0xc1200000, v23
    v_cvt_pk_bf16_f32 v8, v8, v9
    v_cvt_pk_bf16_f32 v10, v10, v11
    v_cvt_pk_bf16_f32 v12, v12, v13
    v_cvt_pk_bf16_f32 v14, v14, v15
    v_cvt_pk_bf16_f32 v16, v16, v17
    v_cvt_pk_bf16_f32 v18, v18, v19
    v_cvt_pk_bf16_f32 v20, v20, v21
    v_cvt_pk_bf16_f32 v22, v22, v23
    v_and_b32 v9, s76, v8
    v_lshlrev_b32 v8, 16, v8
    v_and_b32 v11, s76, v10
    v_lshlrev_b32 v10, 16, v10
    v_and_b32 v13, s76, v12
    v_lshlrev_b32 v12, 16, v12
    v_and_b32 v15, s76, v14
    v_lshlrev_b32 v14, 16, v14
    v_and_b32 v17, s76, v16
    v_lshlrev_b32 v16, 16, v16
    v_and_b32 v19, s76, v18
    v_lshlrev_b32 v18, 16, v18
    v_and_b32 v21, s76, v20
    v_lshlrev_b32 v20, 16, v20
    v_and_b32 v23, s76, v22
    v_lshlrev_b32 v22, 16, v22
    v_mul_f32 v8, 0x3fb8aa3b, v8
    v_mul_f32 v9, 0x3fb8aa3b, v9
    v_mul_f32 v10, 0x3fb8aa3b, v10
    v_mul_f32 v11, 0x3fb8aa3b, v11
    v_mul_f32 v12, 0x3fb8aa3b, v12
    v_mul_f32 v13, 0x3fb8aa3b, v13
    v_mul_f32 v14, 0x3fb8aa3b, v14
    v_mul_f32 v15, 0x3fb8aa3b, v15
    v_mul_f32 v16, 0x3fb8aa3b, v16
    v_mul_f32 v17, 0x3fb8aa3b, v17
    v_mul_f32 v18, 0x3fb8aa3b, v18
    v_mul_f32 v19, 0x3fb8aa3b, v19
    v_mul_f32 v20, 0x3fb8aa3b, v20
    v_mul_f32 v21, 0x3fb8aa3b, v21
    v_mul_f32 v22, 0x3fb8aa3b, v22
    v_mul_f32 v23, 0x3fb8aa3b, v23
    v_exp_f32 v8, v8
    v_exp_f32 v9, v9
    v_exp_f32 v10, v10
    v_exp_f32 v11, v11
    v_exp_f32 v12, v12
    v_exp_f32 v13, v13
    v_exp_f32 v14, v14
    v_exp_f32 v15, v15
    v_exp_f32 v16, v16
    v_exp_f32 v17, v17
    v_exp_f32 v18, v18
    v_exp_f32 v19, v19
    v_exp_f32 v20, v20
    v_exp_f32 v21, v21
    v_exp_f32 v22, v22
    v_exp_f32 v23, v23
    s_nop 0
    v_cvt_pk_bf16_f32 v8, v8, v9
    v_cvt_pk_bf16_f32 v10, v10, v11
    v_cvt_pk_bf16_f32 v12, v12, v13
    v_cvt_pk_bf16_f32 v14, v14, v15
    v_cvt_pk_bf16_f32 v16, v16, v17
    v_cvt_pk_bf16_f32 v18, v18, v19
    v_cvt_pk_bf16_f32 v20, v20, v21
    v_cvt_pk_bf16_f32 v22, v22, v23
    s_pack_ll_b32_b16 s77, s36, s38
    v_dot2_f32_bf16 v32, v8, s77, 0
    v_dot2_f32_bf16 v36, v16, s77, 0
    s_pack_hh_b32_b16 s78, s36, s38
    v_dot2_f32_bf16 v33, v8, s78, 0
    v_dot2_f32_bf16 v37, v16, s78, 0
    s_pack_ll_b32_b16 s77, s37, s39
    v_dot2_f32_bf16 v34, v8, s77, 0
    v_dot2_f32_bf16 v38, v16, s77, 0
    s_pack_hh_b32_b16 s78, s37, s39
    v_dot2_f32_bf16 v35, v8, s78, 0
    v_dot2_f32_bf16 v39, v16, s78, 0
    s_pack_ll_b32_b16 s77, s40, s42
    v_dot2_f32_bf16 v32, v10, s77, v32
    v_dot2_f32_bf16 v36, v18, s77, v36
    s_pack_hh_b32_b16 s78, s40, s42
    v_dot2_f32_bf16 v33, v10, s78, v33
    v_dot2_f32_bf16 v37, v18, s78, v37
    s_pack_ll_b32_b16 s77, s41, s43
    v_dot2_f32_bf16 v34, v10, s77, v34
    v_dot2_f32_bf16 v38, v18, s77, v38
    s_pack_hh_b32_b16 s78, s41, s43
    v_dot2_f32_bf16 v35, v10, s78, v35
    v_dot2_f32_bf16 v39, v18, s78, v39
    s_pack_ll_b32_b16 s77, s44, s46
    v_dot2_f32_bf16 v32, v12, s77, v32
    v_dot2_f32_bf16 v36, v20, s77, v36
    s_pack_hh_b32_b16 s78, s44, s46
    v_dot2_f32_bf16 v33, v12, s78, v33
    v_dot2_f32_bf16 v37, v20, s78, v37
    s_pack_ll_b32_b16 s77, s45, s47
    v_dot2_f32_bf16 v34, v12, s77, v34
    v_dot2_f32_bf16 v38, v20, s77, v38
    s_pack_hh_b32_b16 s78, s45, s47
    v_dot2_f32_bf16 v35, v12, s78, v35
    v_dot2_f32_bf16 v39, v20, s78, v39
    s_pack_ll_b32_b16 s77, s48, s50
    v_dot2_f32_bf16 v32, v14, s77, v32
    v_dot2_f32_bf16 v36, v22, s77, v36
    s_pack_hh_b32_b16 s78, s48, s50
    v_dot2_f32_bf16 v33, v14, s78, v33
    v_dot2_f32_bf16 v37, v22, s78, v37
    s_pack_ll_b32_b16 s77, s49, s51
    v_dot2_f32_bf16 v34, v14, s77, v34
    v_dot2_f32_bf16 v38, v22, s77, v38
    s_pack_hh_b32_b16 s78, s49, s51
    v_dot2_f32_bf16 v35, v14, s78, v35
    v_dot2_f32_bf16 v39, v22, s78, v39
    s_pack_ll_b32_b16 s77, s52, s54
    v_dot2_f32_bf16 v24, v8, s77, 0
    v_dot2_f32_bf16 v28, v16, s77, 0
    s_pack_hh_b32_b16 s78, s52, s54
    v_dot2_f32_bf16 v25, v8, s78, 0
    v_dot2_f32_bf16 v29, v16, s78, 0
    s_pack_ll_b32_b16 s77, s53, s55
    v_dot2_f32_bf16 v26, v8, s77, 0
    v_dot2_f32_bf16 v30, v16, s77, 0
    s_pack_hh_b32_b16 s78, s53, s55
    v_dot2_f32_bf16 v27, v8, s78, 0
    v_dot2_f32_bf16 v31, v16, s78, 0
    s_pack_ll_b32_b16 s77, s56, s58
    v_dot2_f32_bf16 v24, v10, s77, v24
    v_dot2_f32_bf16 v28, v18, s77, v28
    s_pack_hh_b32_b16 s78, s56, s58
    v_dot2_f32_bf16 v25, v10, s78, v25
    v_dot2_f32_bf16 v29, v18, s78, v29
    s_pack_ll_b32_b16 s77, s57, s59
    v_dot2_f32_bf16 v26, v10, s77, v26
    v_dot2_f32_bf16 v30, v18, s77, v30
    s_pack_hh_b32_b16 s78, s57, s59
    v_dot2_f32_bf16 v27, v10, s78, v27
    v_dot2_f32_bf16 v31, v18, s78, v31
    s_pack_ll_b32_b16 s77, s60, s62
    v_dot2_f32_bf16 v24, v12, s77, v24
    v_dot2_f32_bf16 v28, v20, s77, v28
    s_pack_hh_b32_b16 s78, s60, s62
    v_dot2_f32_bf16 v25, v12, s78, v25
    v_dot2_f32_bf16 v29, v20, s78, v29
    s_pack_ll_b32_b16 s77, s61, s63
    v_dot2_f32_bf16 v26, v12, s77, v26
    v_dot2_f32_bf16 v30, v20, s77, v30
    s_pack_hh_b32_b16 s78, s61, s63
    v_dot2_f32_bf16 v27, v12, s78, v27
    v_dot2_f32_bf16 v31, v20, s78, v31
    s_pack_ll_b32_b16 s77, s64, s66
    v_dot2_f32_bf16 v24, v14, s77, v24
    v_dot2_f32_bf16 v28, v22, s77, v28
    s_pack_hh_b32_b16 s78, s64, s66
    v_dot2_f32_bf16 v25, v14, s78, v25
    v_dot2_f32_bf16 v29, v22, s78, v29
    s_pack_ll_b32_b16 s77, s65, s67
    v_dot2_f32_bf16 v26, v14, s77, v26
    v_dot2_f32_bf16 v30, v22, s77, v30
    s_pack_hh_b32_b16 s78, s65, s67
    v_dot2_f32_bf16 v27, v14, s78, v27
    v_dot2_f32_bf16 v31, v22, s78, v31
    v_cvt_pk_bf16_f32 v32, v32, v33
    v_cvt_pk_bf16_f32 v34, v34, v35
    v_cvt_pk_bf16_f32 v36, v36, v37
    v_cvt_pk_bf16_f32 v38, v38, v39
    v_and_b32 v33, s76, v32
    v_lshlrev_b32 v32, 16, v32
    v_and_b32 v35, s76, v34
    v_lshlrev_b32 v34, 16, v34
    v_and_b32 v37, s76, v36
    v_lshlrev_b32 v36, 16, v36
    v_and_b32 v39, s76, v38
    v_lshlrev_b32 v38, 16, v38
    s_cmp_eq_u32 s20, 0
    s_cbranch_scc1 L_fgen_95
    s_cmp_lg_u64 s[20:21], s[22:23]
    s_cbranch_scc1 L_fgen_95
    s_cmp_lg_u32 s20, s21
    s_cbranch_scc1 L_fgen_95
    s_waitcnt vmcnt(1)

    v_add_u32 v40, v40, v44
    v_add_u32 v48, v48, v52
    v_add_u32 v41, v41, v45
    v_add_u32 v49, v49, v53
    v_add_u32 v42, v42, v46
    v_add_u32 v50, v50, v54
    v_add_u32 v43, v43, v47
    v_add_u32 v51, v51, v55
    v_add_u32_sdwa v8, v40, v48 dst_sel:DWORD dst_unused:UNUSED_PAD src0_sel:WORD_0 src1_sel:WORD_0
    v_add_u32_sdwa v9, v40, v48 dst_sel:DWORD dst_unused:UNUSED_PAD src0_sel:WORD_1 src1_sel:WORD_1
    v_add_u32_sdwa v10, v41, v49 dst_sel:DWORD dst_unused:UNUSED_PAD src0_sel:WORD_0 src1_sel:WORD_0
    v_add_u32_sdwa v11, v41, v49 dst_sel:DWORD dst_unused:UNUSED_PAD src0_sel:WORD_1 src1_sel:WORD_1
    v_add_u32_sdwa v12, v42, v50 dst_sel:DWORD dst_unused:UNUSED_PAD src0_sel:WORD_0 src1_sel:WORD_0
    v_add_u32_sdwa v13, v42, v50 dst_sel:DWORD dst_unused:UNUSED_PAD src0_sel:WORD_1 src1_sel:WORD_1
    v_add_u32_sdwa v14, v43, v51 dst_sel:DWORD dst_unused:UNUSED_PAD src0_sel:WORD_0 src1_sel:WORD_0
    v_add_u32_sdwa v15, v43, v51 dst_sel:DWORD dst_unused:UNUSED_PAD src0_sel:WORD_1 src1_sel:WORD_1
    v_add_u32 v8, 0xffff0000, v8
    v_add_u32 v9, 0xffff0000, v9
    v_add_u32 v10, 0xffff0000, v10
    v_add_u32 v11, 0xffff0000, v11
    v_add_u32 v12, 0xffff0000, v12
    v_add_u32 v13, 0xffff0000, v13
    v_add_u32 v14, 0xffff0000, v14
    v_add_u32 v15, 0xffff0000, v15
    v_cvt_f32_i32 v8, v8
    v_cvt_f32_i32 v9, v9
    v_cvt_f32_i32 v10, v10
    v_cvt_f32_i32 v11, v11
    v_cvt_f32_i32 v12, v12
    v_cvt_f32_i32 v13, v13
    v_cvt_f32_i32 v14, v14
    v_cvt_f32_i32 v15, v15
    v_mul_f32 v8, s20, v8
    v_mul_f32 v9, s20, v9
    v_mul_f32 v10, s20, v10
    v_mul_f32 v11, s20, v11
    v_mul_f32 v12, s20, v12
    v_mul_f32 v13, s20, v13
    v_mul_f32 v14, s20, v14
    v_mul_f32 v15, s20, v15
L_fbk_96:
    s_lshl_b32 s77, s68, 16
    v_mul_f32 v16, s77, v8
    v_mul_f32 v20, s77, v12
    s_and_b32 s78, s68, s76
    v_mul_f32 v17, s78, v8
    v_mul_f32 v21, s78, v12
    s_lshl_b32 s77, s69, 16
    v_mul_f32 v18, s77, v8
    v_mul_f32 v22, s77, v12
    s_and_b32 s78, s69, s76
    v_mul_f32 v19, s78, v8
    v_mul_f32 v23, s78, v12
    s_lshl_b32 s77, s70, 16
    v_fmac_f32 v16, s77, v9
    v_fmac_f32 v20, s77, v13
    s_and_b32 s78, s70, s76
    v_fmac_f32 v17, s78, v9
    v_fmac_f32 v21, s78, v13
    s_lshl_b32 s77, s71, 16
    v_fmac_f32 v18, s77, v9
    v_fmac_f32 v22, s77, v13
    s_and_b32 s78, s71, s76
    v_fmac_f32 v19, s78, v9
    v_fmac_f32 v23, s78, v13
    s_lshl_b32 s77, s72, 16
    v_fmac_f32 v16, s77, v10
    v_fmac_f32 v20, s77, v14
    s_and_b32 s78, s72, s76
    v_fmac_f32 v17, s78, v10
    v_fmac_f32 v21, s78, v14
    s_lshl_b32 s77, s73, 16
    v_fmac_f32 v18, s77, v10
    v_fmac_f32 v22, s77, v14
    s_and_b32 s78, s73, s76
    v_fmac_f32 v19, s78, v10
    v_fmac_f32 v23, s78, v14
    s_lshl_b32 s77, s74, 16
    v_fmac_f32 v16, s77, v11
    v_fmac_f32 v20, s77, v15
    s_and_b32 s78, s74, s76
    v_fmac_f32 v17, s78, v11
    v_fmac_f32 v21, s78, v15
    s_lshl_b32 s77, s75, 16
    v_fmac_f32 v18, s77, v11
    v_fmac_f32 v22, s77, v15
    s_and_b32 s78, s75, s76
    v_fmac_f32 v19, s78, v11
    v_fmac_f32 v23, s78, v15
    v_mul_f32 v16, v16, v24
    v_mul_f32 v17, v17, v25
    v_mul_f32 v18, v18, v26
    v_mul_f32 v19, v19, v27
    v_mul_f32 v20, v20, v28
    v_mul_f32 v21, v21, v29
    v_mul_f32 v22, v22, v30
    v_mul_f32 v23, v23, v31
    v_cvt_pk_bf16_f32 v16, v16, v17
    v_cvt_pk_bf16_f32 v18, v18, v19
    v_cvt_pk_bf16_f32 v20, v20, v21
    v_cvt_pk_bf16_f32 v22, v22, v23
    s_pack_ll_b32_b16 s77, s24, s26
    v_dot2_f32_bf16 v8, v16, s77, 0
    v_dot2_f32_bf16 v12, v20, s77, 0
    s_pack_hh_b32_b16 s78, s24, s26
    v_dot2_f32_bf16 v9, v16, s78, 0
    v_dot2_f32_bf16 v13, v20, s78, 0
    s_pack_ll_b32_b16 s77, s25, s27
    v_dot2_f32_bf16 v10, v16, s77, 0
    v_dot2_f32_bf16 v14, v20, s77, 0
    s_pack_hh_b32_b16 s78, s25, s27
    v_dot2_f32_bf16 v11, v16, s78, 0
    v_dot2_f32_bf16 v15, v20, s78, 0
    s_pack_ll_b32_b16 s77, s28, s30
    v_dot2_f32_bf16 v8, v18, s77, v8
    v_dot2_f32_bf16 v12, v22, s77, v12
    s_pack_hh_b32_b16 s78, s28, s30
    v_dot2_f32_bf16 v9, v18, s78, v9
    v_dot2_f32_bf16 v13, v22, s78, v13
    s_pack_ll_b32_b16 s77, s29, s31
    v_dot2_f32_bf16 v10, v18, s77, v10
    v_dot2_f32_bf16 v14, v22, s77, v14
    s_pack_hh_b32_b16 s78, s29, s31
    v_dot2_f32_bf16 v11, v18, s78, v11
    v_dot2_f32_bf16 v15, v22, s78, v15
    s_waitcnt vmcnt(0)
    v_lshlrev_b32 v24, 16, v56
    v_and_b32 v25, s76, v56
    v_lshlrev_b32 v26, 16, v57
    v_and_b32 v27, s76, v57
    v_lshlrev_b32 v28, 16, v58
    v_and_b32 v29, s76, v58
    v_lshlrev_b32 v30, 16, v59
    v_and_b32 v31, s76, v59
    v_cvt_pk_bf16_f32 v8, v8, v9
    v_cvt_pk_bf16_f32 v10, v10, v11
    v_cvt_pk_bf16_f32 v12, v12, v13
    v_cvt_pk_bf16_f32 v14, v14, v15
    v_and_b32 v9, s76, v8
    v_lshlrev_b32 v8, 16, v8
    v_and_b32 v11, s76, v10
    v_lshlrev_b32 v10, 16, v10
    v_and_b32 v13, s76, v12
    v_lshlrev_b32 v12, 16, v12
    v_and_b32 v15, s76, v14
    v_lshlrev_b32 v14, 16, v14
    v_mul_f32 v8, v8, v32
    v_mul_f32 v9, v9, v33
    v_mul_f32 v10, v10, v34
    v_mul_f32 v11, v11, v35
    v_mul_f32 v12, v12, v36
    v_mul_f32 v13, v13, v37
    v_mul_f32 v14, v14, v38
    v_mul_f32 v15, v15, v39
    v_cvt_pk_bf16_f32 v8, v8, v9
    v_cvt_pk_bf16_f32 v10, v10, v11
    v_cvt_pk_bf16_f32 v12, v12, v13
    v_cvt_pk_bf16_f32 v14, v14, v15
    v_and_b32 v9, s76, v8
    v_lshlrev_b32 v8, 16, v8
    v_and_b32 v11, s76, v10
    v_lshlrev_b32 v10, 16, v10
    v_and_b32 v13, s76, v12
    v_lshlrev_b32 v12, 16, v12
    v_and_b32 v15, s76, v14
    v_lshlrev_b32 v14, 16, v14
    v_add_f32 v8, v8, v24
    v_add_f32 v9, v9, v25
    v_add_f32 v10, v10, v26
    v_add_f32 v11, v11, v27
    v_add_f32 v12, v12, v28
    v_add_f32 v13, v13, v29
    v_add_f32 v14, v14, v30
    v_add_f32 v15, v15, v31
    v_cvt_pk_bf16_f32 v16, v8, v9
    v_cvt_pk_bf16_f32 v17, v10, v11
    v_cvt_pk_bf16_f32 v18, v12, v13
    v_cvt_pk_bf16_f32 v19, v14, v15
    buffer_store_dwordx4 v[16:19], v1, s[12:15], 0 offen
L_fdone_94:
    s_endpgm

L_fgen_95:
    s_waitcnt vmcnt(1)
    v_lshlrev_b32 v2, 5, v0
    v_mov_b32 v8, 0
    v_mov_b32 v9, 0
    v_mov_b32 v10, 0
    v_mov_b32 v11, 0
    v_mov_b32 v12, 0
    v_mov_b32 v13, 0
    v_mov_b32 v14, 0
    v_mov_b32 v15, 0
    s_cmp_eq_u32 s20, 0
    s_cbranch_scc1 L_ffl_97
    v_cvt_f32_u32_sdwa v16, v40 dst_sel:DWORD dst_unused:UNUSED_PAD src0_sel:WORD_0
    v_cvt_f32_u32_sdwa v17, v40 dst_sel:DWORD dst_unused:UNUSED_PAD src0_sel:WORD_1
    v_cvt_f32_u32_sdwa v18, v41 dst_sel:DWORD dst_unused:UNUSED_PAD src0_sel:WORD_0
    v_cvt_f32_u32_sdwa v19, v41 dst_sel:DWORD dst_unused:UNUSED_PAD src0_sel:WORD_1
    v_cvt_f32_u32_sdwa v20, v42 dst_sel:DWORD dst_unused:UNUSED_PAD src0_sel:WORD_0
    v_cvt_f32_u32_sdwa v21, v42 dst_sel:DWORD dst_unused:UNUSED_PAD src0_sel:WORD_1
    v_cvt_f32_u32_sdwa v22, v43 dst_sel:DWORD dst_unused:UNUSED_PAD src0_sel:WORD_0
    v_cvt_f32_u32_sdwa v23, v43 dst_sel:DWORD dst_unused:UNUSED_PAD src0_sel:WORD_1
    v_add_f32 v16, 0xc6800000, v16
    v_fmac_f32 v8, s20, v16
    v_add_f32 v17, 0xc6800000, v17
    v_fmac_f32 v9, s20, v17
    v_add_f32 v18, 0xc6800000, v18
    v_fmac_f32 v10, s20, v18
    v_add_f32 v19, 0xc6800000, v19
    v_fmac_f32 v11, s20, v19
    v_add_f32 v20, 0xc6800000, v20
    v_fmac_f32 v12, s20, v20
    v_add_f32 v21, 0xc6800000, v21
    v_fmac_f32 v13, s20, v21
    v_add_f32 v22, 0xc6800000, v22
    v_fmac_f32 v14, s20, v22
    v_add_f32 v23, 0xc6800000, v23
    v_fmac_f32 v15, s20, v23
    s_branch L_fnx_98
L_ffl_97:
    s_mov_b32 s3, 25600000
    buffer_load_dwordx4 v[16:19], v2, s[16:19], s3 offen
    buffer_load_dwordx4 v[20:23], v2, s[16:19], s3 offen offset:16
    s_waitcnt vmcnt(0)
    v_add_f32 v8, v8, v16
    v_add_f32 v9, v9, v17
    v_add_f32 v10, v10, v18
    v_add_f32 v11, v11, v19
    v_add_f32 v12, v12, v20
    v_add_f32 v13, v13, v21
    v_add_f32 v14, v14, v22
    v_add_f32 v15, v15, v23
L_fnx_98:
    s_cmp_eq_u32 s21, 0
    s_cbranch_scc1 L_ffl_99
    v_cvt_f32_u32_sdwa v16, v44 dst_sel:DWORD dst_unused:UNUSED_PAD src0_sel:WORD_0
    v_cvt_f32_u32_sdwa v17, v44 dst_sel:DWORD dst_unused:UNUSED_PAD src0_sel:WORD_1
    v_cvt_f32_u32_sdwa v18, v45 dst_sel:DWORD dst_unused:UNUSED_PAD src0_sel:WORD_0
    v_cvt_f32_u32_sdwa v19, v45 dst_sel:DWORD dst_unused:UNUSED_PAD src0_sel:WORD_1
    v_cvt_f32_u32_sdwa v20, v46 dst_sel:DWORD dst_unused:UNUSED_PAD src0_sel:WORD_0
    v_cvt_f32_u32_sdwa v21, v46 dst_sel:DWORD dst_unused:UNUSED_PAD src0_sel:WORD_1
    v_cvt_f32_u32_sdwa v22, v47 dst_sel:DWORD dst_unused:UNUSED_PAD src0_sel:WORD_0
    v_cvt_f32_u32_sdwa v23, v47 dst_sel:DWORD dst_unused:UNUSED_PAD src0_sel:WORD_1
    v_add_f32 v16, 0xc6800000, v16
    v_fmac_f32 v8, s21, v16
    v_add_f32 v17, 0xc6800000, v17
    v_fmac_f32 v9, s21, v17
    v_add_f32 v18, 0xc6800000, v18
    v_fmac_f32 v10, s21, v18
    v_add_f32 v19, 0xc6800000, v19
    v_fmac_f32 v11, s21, v19
    v_add_f32 v20, 0xc6800000, v20
    v_fmac_f32 v12, s21, v20
    v_add_f32 v21, 0xc6800000, v21
    v_fmac_f32 v13, s21, v21
    v_add_f32 v22, 0xc6800000, v22
    v_fmac_f32 v14, s21, v22
    v_add_f32 v23, 0xc6800000, v23
    v_fmac_f32 v15, s21, v23
    s_branch L_fnx_100
L_ffl_99:
    s_mov_b32 s3, 38400000
    buffer_load_dwordx4 v[16:19], v2, s[16:19], s3 offen
    buffer_load_dwordx4 v[20:23], v2, s[16:19], s3 offen offset:16
    s_waitcnt vmcnt(0)
    v_add_f32 v8, v8, v16
    v_add_f32 v9, v9, v17
    v_add_f32 v10, v10, v18
    v_add_f32 v11, v11, v19
    v_add_f32 v12, v12, v20
    v_add_f32 v13, v13, v21
    v_add_f32 v14, v14, v22
    v_add_f32 v15, v15, v23
L_fnx_100:
    s_cmp_eq_u32 s22, 0
    s_cbranch_scc1 L_ffl_101
    v_cvt_f32_u32_sdwa v16, v48 dst_sel:DWORD dst_unused:UNUSED_PAD src0_sel:WORD_0
    v_cvt_f32_u32_sdwa v17, v48 dst_sel:DWORD dst_unused:UNUSED_PAD src0_sel:WORD_1
    v_cvt_f32_u32_sdwa v18, v49 dst_sel:DWORD dst_unused:UNUSED_PAD src0_sel:WORD_0
    v_cvt_f32_u32_sdwa v19, v49 dst_sel:DWORD dst_unused:UNUSED_PAD src0_sel:WORD_1
    v_cvt_f32_u32_sdwa v20, v50 dst_sel:DWORD dst_unused:UNUSED_PAD src0_sel:WORD_0
    v_cvt_f32_u32_sdwa v21, v50 dst_sel:DWORD dst_unused:UNUSED_PAD src0_sel:WORD_1
    v_cvt_f32_u32_sdwa v22, v51 dst_sel:DWORD dst_unused:UNUSED_PAD src0_sel:WORD_0
    v_cvt_f32_u32_sdwa v23, v51 dst_sel:DWORD dst_unused:UNUSED_PAD src0_sel:WORD_1
    v_add_f32 v16, 0xc6800000, v16
    v_fmac_f32 v8, s22, v16
    v_add_f32 v17, 0xc6800000, v17
    v_fmac_f32 v9, s22, v17
    v_add_f32 v18, 0xc6800000, v18
    v_fmac_f32 v10, s22, v18
    v_add_f32 v19, 0xc6800000, v19
    v_fmac_f32 v11, s22, v19
    v_add_f32 v20, 0xc6800000, v20
    v_fmac_f32 v12, s22, v20
    v_add_f32 v21, 0xc6800000, v21
    v_fmac_f32 v13, s22, v21
    v_add_f32 v22, 0xc6800000, v22
    v_fmac_f32 v14, s22, v22
    v_add_f32 v23, 0xc6800000, v23
    v_fmac_f32 v15, s22, v23
    s_branch L_fnx_102
L_ffl_101:
    s_mov_b32 s3, 51200000
    buffer_load_dwordx4 v[16:19], v2, s[16:19], s3 offen
    buffer_load_dwordx4 v[20:23], v2, s[16:19], s3 offen offset:16
    s_waitcnt vmcnt(0)
    v_add_f32 v8, v8, v16
    v_add_f32 v9, v9, v17
    v_add_f32 v10, v10, v18
    v_add_f32 v11, v11, v19
    v_add_f32 v12, v12, v20
    v_add_f32 v13, v13, v21
    v_add_f32 v14, v14, v22
    v_add_f32 v15, v15, v23
L_fnx_102:
    s_cmp_eq_u32 s23, 0
    s_cbranch_scc1 L_ffl_103
    v_cvt_f32_u32_sdwa v16, v52 dst_sel:DWORD dst_unused:UNUSED_PAD src0_sel:WORD_0
    v_cvt_f32_u32_sdwa v17, v52 dst_sel:DWORD dst_unused:UNUSED_PAD src0_sel:WORD_1
    v_cvt_f32_u32_sdwa v18, v53 dst_sel:DWORD dst_unused:UNUSED_PAD src0_sel:WORD_0
    v_cvt_f32_u32_sdwa v19, v53 dst_sel:DWORD dst_unused:UNUSED_PAD src0_sel:WORD_1
    v_cvt_f32_u32_sdwa v20, v54 dst_sel:DWORD dst_unused:UNUSED_PAD src0_sel:WORD_0
    v_cvt_f32_u32_sdwa v21, v54 dst_sel:DWORD dst_unused:UNUSED_PAD src0_sel:WORD_1
    v_cvt_f32_u32_sdwa v22, v55 dst_sel:DWORD dst_unused:UNUSED_PAD src0_sel:WORD_0
    v_cvt_f32_u32_sdwa v23, v55 dst_sel:DWORD dst_unused:UNUSED_PAD src0_sel:WORD_1
    v_add_f32 v16, 0xc6800000, v16
    v_fmac_f32 v8, s23, v16
    v_add_f32 v17, 0xc6800000, v17
    v_fmac_f32 v9, s23, v17
    v_add_f32 v18, 0xc6800000, v18
    v_fmac_f32 v10, s23, v18
    v_add_f32 v19, 0xc6800000, v19
    v_fmac_f32 v11, s23, v19
    v_add_f32 v20, 0xc6800000, v20
    v_fmac_f32 v12, s23, v20
    v_add_f32 v21, 0xc6800000, v21
    v_fmac_f32 v13, s23, v21
    v_add_f32 v22, 0xc6800000, v22
    v_fmac_f32 v14, s23, v22
    v_add_f32 v23, 0xc6800000, v23
    v_fmac_f32 v15, s23, v23
    s_branch L_fnx_104
L_ffl_103:
    s_mov_b32 s3, 64000000
    buffer_load_dwordx4 v[16:19], v2, s[16:19], s3 offen
    buffer_load_dwordx4 v[20:23], v2, s[16:19], s3 offen offset:16
    s_waitcnt vmcnt(0)
    v_add_f32 v8, v8, v16
    v_add_f32 v9, v9, v17
    v_add_f32 v10, v10, v18
    v_add_f32 v11, v11, v19
    v_add_f32 v12, v12, v20
    v_add_f32 v13, v13, v21
    v_add_f32 v14, v14, v22
    v_add_f32 v15, v15, v23
L_fnx_104:
    s_branch L_fbk_96
.section .rodata,"a"
.p2align 6
.amdhsa_kernel g1_kernel
  .amdhsa_next_free_vgpr 128
  .amdhsa_next_free_sgpr 102
  .amdhsa_accum_offset 128
  .amdhsa_group_segment_fixed_size 0
  .amdhsa_kernarg_size 112
  .amdhsa_user_sgpr_count 2
  .amdhsa_user_sgpr_kernarg_segment_ptr 1
  .amdhsa_system_sgpr_workgroup_id_x 1
.end_amdhsa_kernel
.p2align 6
.amdhsa_kernel g2_kernel
  .amdhsa_next_free_vgpr 128
  .amdhsa_next_free_sgpr 102
  .amdhsa_accum_offset 128
  .amdhsa_group_segment_fixed_size 0
  .amdhsa_kernarg_size 112
  .amdhsa_user_sgpr_count 2
  .amdhsa_user_sgpr_kernarg_segment_ptr 1
  .amdhsa_system_sgpr_workgroup_id_x 1
  .amdhsa_float_denorm_mode_32 3
.end_amdhsa_kernel
.p2align 6
.amdhsa_kernel standalone__molecular_angular_gemnet__graph_kernel
  .amdhsa_next_free_vgpr 60
  .amdhsa_next_free_sgpr 80
  .amdhsa_accum_offset 60
  .amdhsa_group_segment_fixed_size 0
  .amdhsa_kernarg_size 112
  .amdhsa_user_sgpr_count 2
  .amdhsa_user_sgpr_kernarg_segment_ptr 1
  .amdhsa_system_sgpr_workgroup_id_x 1
  .amdhsa_float_denorm_mode_32 3
.end_amdhsa_kernel
```

```asm
; @launch kernel=g1_kernel grid=(256,1,1) block=(1024,1,1) lds=163840
; @launch kernel=standalone__molecular_angular_gemnet__graph_kernel grid=(256,1,1) block=(1024,1,1) lds=163840
.amdgcn_target "amdgcn-amd-amdhsa--gfx950"
.text
.globl g1_kernel
.p2align 8
.type g1_kernel,@function
g1_kernel:
    s_cmp_ge_u32 s2, 256
    s_cbranch_scc1 L_p1done_1
    s_load_dwordx4 s[80:83], s[0:1], 8
    s_load_dwordx2 s[84:85], s[0:1], 32
    s_load_dwordx2 s[86:87], s[0:1], 48
    s_load_dwordx4 s[4:7], s[0:1], 96
    s_load_dwordx2 s[78:79], s[0:1], 0
    v_lshlrev_b32 v1, 4, v0
    v_lshlrev_b32 v2, 3, v0
    v_lshlrev_b32 v98, 20, v0
    s_waitcnt lgkmcnt(0)
    s_load_dword s88, s[86:87], 0

    s_mov_b32 s96, s4
    s_mov_b32 s97, s5
    s_mov_b32 s98, 256
    s_mov_b32 s99, 0x20000
    v_readfirstlane_b32 s74, v0
    s_nop 1
    s_or_b32 s74, s74, s2
    s_cbranch_scc1 L_noinit_2

    v_mov_b32 v110, 1
    buffer_atomic_add v110, v98, s[96:99], 0 offen offset:64 sc0
    s_waitcnt vmcnt(0)
    v_readfirstlane_b32 s74, v110
    s_nop 1
    s_cmp_lg_u32 s74, 0
    s_cbranch_scc1 L_zno_4

    s_mov_b32 s92, s6
    s_mov_b32 s93, s7
    s_mov_b32 s94, 65552
    s_mov_b32 s95, 0x20000
    v_mov_b32 v110, 0
    v_mov_b32 v111, 0
    v_mov_b32 v112, 0
    v_mov_b32 v113, 0
L_zl_3:
    buffer_store_dwordx4 v[110:113], v1, s[92:95], s74 offen sc0 sc1
    s_add_u32 s74, s74, 1024
    s_cmp_le_u32 s74, 65536
    s_cbranch_scc1 L_zl_3
    v_mov_b32 v114, 1
    s_waitcnt vmcnt(0)
    buffer_atomic_add v114, v98, s[96:99], 0 offen offset:128
L_zno_4:

L_noinit_2:
    s_mov_b32 s20, s78
    s_mov_b32 s21, s79
    s_mov_b32 s22, 6400000
    s_mov_b32 s23, 0x20000
    v_mul_u32_u24 v110, 6240, v0
    v_and_b32 v111, 63, v0
    v_and_b32 v112, 0x3c0, v0
    v_lshlrev_b32 v111, 2, v111
    v_lshl_or_b32 v111, v112, 4, v111
    v_lshlrev_b32 v100, 2, v0
    s_lshr_b32 s50, s2, 1
    s_and_b32 s53, s2, 1
    s_mul_i32 s3, s50, 50000
    s_mul_i32 s54, s53, 24576
    s_add_u32 s3, s3, s54

    buffer_load_dwordx4 v[56:59], v110, s[20:23], 0 offen
    s_add_u32 s20, s78, s3
    s_addc_u32 s21, s79, 0
    s_mov_b32 s22, 24576
    s_mov_b32 s23, 0x20000
    s_movk_i32 s3, 16384
    buffer_load_dword v44, v111, s[20:23], 0 offen offset:0
    buffer_load_dword v45, v111, s[20:23], 0 offen offset:256
    buffer_load_dword v46, v111, s[20:23], 0 offen offset:512
    buffer_load_dword v47, v111, s[20:23], 0 offen offset:768
    buffer_load_dword v48, v111, s[20:23], s3 offen offset:0
    buffer_load_dword v49, v111, s[20:23], s3 offen offset:256
    buffer_load_dword v50, v111, s[20:23], s3 offen offset:512
    buffer_load_dword v51, v111, s[20:23], s3 offen offset:768
    s_mul_i32 s22, s53, 25424
    s_movk_i32 s3, 24576

    buffer_load_dword v52, v100, s[20:23], s3 offen
    s_mul_i32 s3, s50, 50048
    s_add_u32 s3, s3, s54
    s_add_u32 s54, s3, 393216

    s_mov_b32 s8, s80
    s_mov_b32 s9, s81
    s_mov_b32 s10, 0
    s_mov_b32 s11, 0x20000
    s_mov_b32 s12, s82
    s_mov_b32 s13, s83
    s_mov_b32 s14, 0
    s_mov_b32 s15, 0x20000
    s_mov_b32 s16, s84
    s_mov_b32 s17, s85
    s_mov_b32 s18, 0
    s_mov_b32 s19, 0x20000
    s_lshr_b32 s74, s2, 1
    s_and_b32 s74, s74, 28
    s_lshr_b32 s86, 0x00102010, s74
    s_lshr_b32 s87, 0x44414241, s74
    s_lshr_b32 s41, 0x43221100, s74
    s_and_b32 s86, s86, 15
    s_and_b32 s87, s87, 15
    s_and_b32 s41, s41, 15
    s_lshr_b32 s74, s2, 6
    s_lshl_b32 s74, s74, 3
    s_and_b32 s75, s2, 7
    s_add_u32 s74, s74, s75
    s_mul_i32 s74, s74, 5
    s_add_u32 s41, s41, s74

    s_mul_i32 s78, s41, 16000
    s_add_u32 s49, s78, 16000
    s_cmp_ge_u32 s41, 3200
    s_cmovk_i32 s49, 0
    s_cmovk_i32 s78, 0
    s_lshl_b32 s10, s49, 2
    s_lshl_b32 s14, s49, 2
    s_lshl_b32 s18, s49, 1
    s_sub_u32 s79, s87, s86
    s_bfm_b32 s85, s79, s86
    s_lshl_b32 s86, s86, 12
    s_lshl_b32 s87, s87, 12
    s_min_u32 s87, s87, 16000

    s_add_u32 s79, s78, 0
    s_bitcmp1_b32 s85, 0
    s_cselect_b32 s79, s79, 0x1ff00000
    s_lshl_b32 s56, s79, 2
    s_lshl_b32 s61, s79, 1

    s_add_u32 s79, s78, 4096
    s_bitcmp1_b32 s85, 1
    s_cselect_b32 s79, s79, 0x1ff00000
    s_lshl_b32 s57, s79, 2
    s_lshl_b32 s62, s79, 1

    s_add_u32 s79, s78, 8192
    s_bitcmp1_b32 s85, 2
    s_cselect_b32 s79, s79, 0x1ff00000
    s_lshl_b32 s58, s79, 2
    s_lshl_b32 s63, s79, 1

    s_add_u32 s79, s78, 12288
    s_bitcmp1_b32 s85, 3
    s_cselect_b32 s79, s79, 0x1ff00000
    s_lshl_b32 s59, s79, 2
    s_lshl_b32 s64, s79, 1

    buffer_load_dwordx4 v[20:23], v1, s[12:15], s56 offen nt
    buffer_load_dwordx4 v[4:7], v1, s[8:11], s56 offen nt
    buffer_load_dwordx2 v[36:37], v2, s[16:19], s61 offen nt
    buffer_load_dwordx4 v[24:27], v1, s[12:15], s57 offen nt
    buffer_load_dwordx4 v[8:11], v1, s[8:11], s57 offen nt
    buffer_load_dwordx2 v[38:39], v2, s[16:19], s62 offen nt
    buffer_load_dwordx4 v[28:31], v1, s[12:15], s58 offen nt
    buffer_load_dwordx4 v[12:15], v1, s[8:11], s58 offen nt
    buffer_load_dwordx2 v[40:41], v2, s[16:19], s63 offen nt
    buffer_load_dwordx4 v[32:35], v1, s[12:15], s59 offen nt
    buffer_load_dwordx4 v[16:19], v1, s[8:11], s59 offen nt
    buffer_load_dwordx2 v[42:43], v2, s[16:19], s64 offen nt
    s_and_b32 s5, s2, 7
    s_mul_i32 s3, s5, 8192

    s_add_u32 s20, s6, s3
    s_addc_u32 s21, s7, 0
    s_mov_b32 s22, 8192
    s_mov_b32 s23, 0x20000
    s_mul_i32 s3, s5, 40632320
    s_add_u32 s3, s3, 83599360
    s_add_u32 s24, s6, s3
    s_addc_u32 s25, s7, 0
    s_mov_b32 s26, 40632320
    s_mov_b32 s27, 0x20000
    s_add_u32 s32, s6, 408657920
    s_addc_u32 s33, s7, 0
    s_mov_b32 s34, 409600000
    s_mov_b32 s35, 0x20000
    s_add_u32 s36, s6, 65536
    s_addc_u32 s37, s7, 0
    s_mov_b32 s38, 4
    s_mov_b32 s39, 0x20000
    s_mov_b32 s40, 687195
    s_mov_b32 s42, -6250
    s_mov_b32 s43, 1942
    s_mov_b32 s45, 0x06050400
    s_mov_b32 s46, 0x05040c00
    s_mov_b32 s47, 0x04020100
    s_mov_b32 s48, 3968
    s_mov_b32 s50, 0
    v_mov_b32 v104, 1
    v_mov_b32 v105, 0x46ff8000
    s_mov_b32 s55, 0x05040100
    v_mul_u32_u24 v106, 5, v0
    v_mov_b32 v108, 16384
    v_mov_b32 v114, 0
    v_mov_b32 v115, 0
    v_mov_b32 v116, 0
    v_mov_b32 v117, -1
    ds_write_b64 v2, v[114:115]
    s_movk_i32 s3, 928
    v_cmp_gt_u32 s[66:67], s3, v0
    s_movk_i32 s3, 640
    v_cmp_gt_u32 s[68:69], s3, v0
    s_mov_b64 exec, 1
    ds_write_b128 v108, v[114:117]
    s_mov_b64 exec, -1
    s_waitcnt lgkmcnt(0)
    s_lshl_b32 s88, s88, 16
    v_mov_b32 v110, 0.15915494
    v_mul_f32 v110, s88, v110
    s_mov_b32 s3, 0x7fff7fff
    v_readfirstlane_b32 s44, v110

    s_waitcnt vmcnt(12)
    v_mov_b32 v61, 0
    v_mov_b32 v62, 0
    v_mov_b32 v63, 0
    v_dot2_f32_bf16 v61, v44, v44, v61
    v_dot2_f32_bf16 v61, v45, v45, v61
    v_dot2_f32_bf16 v61, v46, v46, v61
    v_dot2_f32_bf16 v61, v47, v47, v61
    v_dot2_f32_bf16 v61, v48, v48, v61
    v_dot2_f32_bf16 v61, v49, v49, v61
    v_dot2_f32_bf16 v61, v50, v50, v61
    v_dot2_f32_bf16 v61, v51, v51, v61
    v_dot2_f32_bf16 v61, v52, v52, v61
    v_dot2_f32_bf16 v62, v56, v56, v62
    v_dot2_f32_bf16 v62, v57, v57, v62
    v_dot2_f32_bf16 v62, v58, v58, v62
    v_dot2_f32_bf16 v62, v59, v59, v62
    v_and_b32 v60, s3, v44
    v_and_b32 v64, s3, v45
    v_pk_max_u16 v60, v60, v64
    v_and_b32 v64, s3, v46
    v_pk_max_u16 v60, v60, v64
    v_and_b32 v64, s3, v47
    v_pk_max_u16 v60, v60, v64
    v_and_b32 v64, s3, v48
    v_pk_max_u16 v60, v60, v64
    v_and_b32 v64, s3, v49
    v_pk_max_u16 v60, v60, v64
    v_and_b32 v64, s3, v50
    v_pk_max_u16 v60, v60, v64
    v_and_b32 v64, s3, v51
    v_pk_max_u16 v60, v60, v64
    v_and_b32 v64, s3, v52
    v_pk_max_u16 v60, v60, v64
    v_lshrrev_b32 v64, 16, v60
    v_and_b32 v60, 0xffff, v60
    v_max_u32 v60, v60, v64

    s_nop 1
    v_max_u32_dpp v60, v60, v60 row_shr:1 row_mask:0xf bank_mask:0xf
    s_nop 1
    v_max_u32_dpp v60, v60, v60 row_shr:2 row_mask:0xf bank_mask:0xf
    s_nop 1
    v_max_u32_dpp v60, v60, v60 row_shr:4 row_mask:0xf bank_mask:0xf
    s_nop 1
    v_max_u32_dpp v60, v60, v60 row_shr:8 row_mask:0xf bank_mask:0xf
    s_nop 1
    v_max_u32_dpp v60, v60, v60 row_bcast:15 row_mask:0xa bank_mask:0xf
    s_nop 1
    v_max_u32_dpp v60, v60, v60 row_bcast:31 row_mask:0xc bank_mask:0xf
    s_nop 1
    v_add_f32_dpp v61, v61, v61 row_shr:1 row_mask:0xf bank_mask:0xf
    s_nop 1
    v_add_f32_dpp v61, v61, v61 row_shr:2 row_mask:0xf bank_mask:0xf
    s_nop 1
    v_add_f32_dpp v61, v61, v61 row_shr:4 row_mask:0xf bank_mask:0xf
    s_nop 1
    v_add_f32_dpp v61, v61, v61 row_shr:8 row_mask:0xf bank_mask:0xf
    s_nop 1
    v_add_f32_dpp v61, v61, v61 row_bcast:15 row_mask:0xa bank_mask:0xf
    s_nop 1
    v_add_f32_dpp v61, v61, v61 row_bcast:31 row_mask:0xc bank_mask:0xf
    s_nop 1
    v_add_f32_dpp v62, v62, v62 row_shr:1 row_mask:0xf bank_mask:0xf
    s_nop 1
    v_add_f32_dpp v62, v62, v62 row_shr:2 row_mask:0xf bank_mask:0xf
    s_nop 1
    v_add_f32_dpp v62, v62, v62 row_shr:4 row_mask:0xf bank_mask:0xf
    s_nop 1
    v_add_f32_dpp v62, v62, v62 row_shr:8 row_mask:0xf bank_mask:0xf
    s_nop 1
    v_add_f32_dpp v62, v62, v62 row_bcast:15 row_mask:0xa bank_mask:0xf
    s_nop 1
    v_add_f32_dpp v62, v62, v62 row_bcast:31 row_mask:0xc bank_mask:0xf
    v_lshrrev_b32 v64, 6, v0
    v_lshlrev_b32 v64, 4, v64
    s_mov_b32 exec_lo, 0
    s_brev_b32 exec_hi, 1
    ds_write_b128 v64, v[60:63] offset:8192
    s_mov_b64 exec, -1
    v_and_b32 v64, 15, v0
    v_lshlrev_b32 v64, 4, v64
    s_waitcnt lgkmcnt(0)
    s_barrier
    ds_read_b128 v[60:63], v64 offset:8192
    s_waitcnt lgkmcnt(0)

    s_nop 0
    v_max_u32_dpp v60, v60, v60 row_ror:1 row_mask:0xf bank_mask:0xf
    v_add_f32_dpp v61, v61, v61 row_ror:1 row_mask:0xf bank_mask:0xf
    v_add_f32_dpp v62, v62, v62 row_ror:1 row_mask:0xf bank_mask:0xf

    s_nop 0
    v_max_u32_dpp v60, v60, v60 row_ror:2 row_mask:0xf bank_mask:0xf
    v_add_f32_dpp v61, v61, v61 row_ror:2 row_mask:0xf bank_mask:0xf
    v_add_f32_dpp v62, v62, v62 row_ror:2 row_mask:0xf bank_mask:0xf

    s_nop 0
    v_max_u32_dpp v60, v60, v60 row_ror:4 row_mask:0xf bank_mask:0xf
    v_add_f32_dpp v61, v61, v61 row_ror:4 row_mask:0xf bank_mask:0xf
    v_add_f32_dpp v62, v62, v62 row_ror:4 row_mask:0xf bank_mask:0xf

    s_nop 0
    v_max_u32_dpp v60, v60, v60 row_ror:8 row_mask:0xf bank_mask:0xf
    v_add_f32_dpp v61, v61, v61 row_ror:8 row_mask:0xf bank_mask:0xf
    v_add_f32_dpp v62, v62, v62 row_ror:8 row_mask:0xf bank_mask:0xf

    v_rsq_f32 v62, v62
    v_mov_b32 v65, 0x4b400000
    v_mul_f32 v62, 0x4806b64a, v62
    s_nop 0
    v_readfirstlane_b32 s74, v62

    s_add_u32 s92, s6, 135168
    s_addc_u32 s93, s7, 0
    s_mov_b32 s94, 4096
    s_mov_b32 s95, 0x20000
    s_lshl_b32 s3, s2, 4
    buffer_store_dwordx4 v[60:63], v98, s[92:95], s3 offen
    v_lshlrev_b32 v66, 16, v44
    v_and_b32 v44, 0xffff0000, v44
    v_fma_f32 v66, v66, s74, v65
    v_fma_f32 v44, v44, s74, v65
    v_perm_b32 v44, v44, v66, s55

    v_lshlrev_b32 v66, 16, v45
    v_and_b32 v45, 0xffff0000, v45
    v_fma_f32 v66, v66, s74, v65
    v_fma_f32 v45, v45, s74, v65
    v_perm_b32 v45, v45, v66, s55

    v_lshlrev_b32 v66, 16, v46
    v_and_b32 v46, 0xffff0000, v46
    v_fma_f32 v66, v66, s74, v65
    v_fma_f32 v46, v46, s74, v65
    v_perm_b32 v46, v46, v66, s55

    v_lshlrev_b32 v66, 16, v47
    v_and_b32 v47, 0xffff0000, v47
    v_fma_f32 v66, v66, s74, v65
    v_fma_f32 v47, v47, s74, v65
    v_perm_b32 v47, v47, v66, s55

    v_lshlrev_b32 v66, 16, v48
    v_and_b32 v48, 0xffff0000, v48
    v_fma_f32 v66, v66, s74, v65
    v_fma_f32 v48, v48, s74, v65
    v_perm_b32 v48, v48, v66, s55

    v_lshlrev_b32 v66, 16, v49
    v_and_b32 v49, 0xffff0000, v49
    v_fma_f32 v66, v66, s74, v65
    v_fma_f32 v49, v49, s74, v65
    v_perm_b32 v49, v49, v66, s55

    v_lshlrev_b32 v66, 16, v50
    v_and_b32 v50, 0xffff0000, v50
    v_fma_f32 v66, v66, s74, v65
    v_fma_f32 v50, v50, s74, v65
    v_perm_b32 v50, v50, v66, s55

    v_lshlrev_b32 v66, 16, v51
    v_and_b32 v51, 0xffff0000, v51
    v_fma_f32 v66, v66, s74, v65
    v_fma_f32 v51, v51, s74, v65
    v_perm_b32 v51, v51, v66, s55

    v_lshlrev_b32 v66, 16, v52
    v_and_b32 v52, 0xffff0000, v52
    v_fma_f32 v66, v66, s74, v65
    v_fma_f32 v52, v52, s74, v65
    v_perm_b32 v52, v52, v66, s55

    s_add_u32 s92, s6, s54
    s_addc_u32 s93, s7, 0
    s_mov_b32 s94, 24576
    s_mov_b32 s95, 0x20000
    s_movk_i32 s3, 16384
    buffer_store_dwordx4 v[44:47], v1, s[92:95], 0 offen
    buffer_store_dwordx4 v[48:51], v1, s[92:95], s3 offen
    s_mul_i32 s94, s53, 25424
    s_movk_i32 s3, 24576

    buffer_store_dword v52, v100, s[92:95], s3 offen
    s_nop 1
    s_mov_b32 s82, s85
    s_mov_b32 s83, s86
    s_mov_b32 s84, s87
    v_mov_b32 v99, 1
    buffer_atomic_add v99, v98, s[96:99], 0 offen sc0
    v_mov_b32 v100, 0
    buffer_atomic_add v100, v98, s[96:99], 0 offen offset:128 sc0
    s_waitcnt vmcnt(15)
    s_bitcmp0_b32 s82, 0
    s_cbranch_scc1 L_ska_7
    v_mul_hi_u32_u24 v45, s40, v20
    v_mul_hi_u32_u24 v44, s40, v4
    v_mul_hi_u32_u24 v47, s40, v21
    v_mul_hi_u32_u24 v46, s40, v5
    v_mul_hi_u32_u24 v49, s40, v22
    v_mul_hi_u32_u24 v48, s40, v6
    v_mul_hi_u32_u24 v51, s40, v23
    v_mul_hi_u32_u24 v50, s40, v7
    v_and_b32 v45, -2, v45
    v_mad_u32_u24 v4, v44, s43, v4
    v_and_b32 v76, -4, v44
    v_and_b32 v47, -2, v47
    v_mad_u32_u24 v5, v46, s43, v5
    v_and_b32 v77, -4, v46
    v_and_b32 v49, -2, v49
    v_mad_u32_u24 v6, v48, s43, v6
    v_and_b32 v78, -4, v48
    v_and_b32 v51, -2, v51
    v_mad_u32_u24 v7, v50, s43, v7
    v_and_b32 v79, -4, v50
    v_mad_i32_i24 v20, v45, s42, v20
    v_lshl_add_u32 v45, v76, 5, v45
    v_mad_i32_i24 v21, v47, s42, v21
    v_lshl_add_u32 v47, v77, 5, v47
    v_mad_i32_i24 v22, v49, s42, v22
    v_lshl_add_u32 v49, v78, 5, v49
    v_mad_i32_i24 v23, v51, s42, v23
    v_lshl_add_u32 v51, v79, 5, v51
    v_add_u32 v45, v45, v45
    ds_add_rtn_u32 v76, v45, v104
    v_add_u32 v47, v47, v47
    ds_add_rtn_u32 v77, v47, v104
    v_add_u32 v49, v49, v49
    ds_add_rtn_u32 v78, v49, v104
    v_add_u32 v51, v51, v51
    ds_add_rtn_u32 v79, v51, v104
    v_lshlrev_b32 v110, 16, v36
    v_and_b32 v111, 0xffff0000, v36
    v_lshlrev_b32 v112, 16, v37
    v_and_b32 v113, 0xffff0000, v37
    v_mul_f32 v110, s44, v110
    v_mul_f32 v111, s44, v111
    v_mul_f32 v112, s44, v112
    v_mul_f32 v113, s44, v113
    v_fract_f32 v110, v110
    v_fract_f32 v111, v111
    v_fract_f32 v112, v112
    v_fract_f32 v113, v113
    v_cos_f32 v110, v110
    v_cos_f32 v111, v111
    v_cos_f32 v112, v112
    v_cos_f32 v113, v113
    v_lshl_or_b32 v44, v44, 14, v20
    v_perm_b32 v45, v45, v4, s46
    v_bfe_u32 v4, v4, 8, 5

    v_lshl_or_b32 v46, v46, 14, v21
    v_perm_b32 v47, v47, v5, s46
    v_bfe_u32 v5, v5, 8, 5

    v_lshl_or_b32 v48, v48, 14, v22
    v_perm_b32 v49, v49, v6, s46
    v_bfe_u32 v6, v6, 8, 5

    v_lshl_or_b32 v50, v50, 14, v23
    v_perm_b32 v51, v51, v7, s46
    v_bfe_u32 v7, v7, 8, 5

    v_fmaak_f32 v110, v110, v105, 0x4b400010
    v_fmaak_f32 v111, v111, v105, 0x4b400010
    v_fmaak_f32 v112, v112, v105, 0x4b400010
    v_fmaak_f32 v113, v113, v105, 0x4b400010
    v_sub_u32 v110, v110, v4
    v_sub_u32 v111, v111, v5
    v_sub_u32 v112, v112, v6
    v_sub_u32 v113, v113, v7
    v_bfi_b32 v110, 31, v4, v110
    v_bfi_b32 v111, 31, v5, v111
    v_bfi_b32 v112, 31, v6, v112
    v_bfi_b32 v113, 31, v7, v113
    v_perm_b32 v44, v44, v110, s55
    v_perm_b32 v46, v46, v111, s55
    v_perm_b32 v48, v48, v112, s55
    v_perm_b32 v50, v50, v113, s55
L_ska_7:
    s_waitcnt vmcnt(12)
    s_bitcmp0_b32 s82, 1
    s_cbranch_scc1 L_ska_8
    v_mul_hi_u32_u24 v53, s40, v24
    v_mul_hi_u32_u24 v52, s40, v8
    v_mul_hi_u32_u24 v55, s40, v25
    v_mul_hi_u32_u24 v54, s40, v9
    v_mul_hi_u32_u24 v57, s40, v26
    v_mul_hi_u32_u24 v56, s40, v10
    v_mul_hi_u32_u24 v59, s40, v27
    v_mul_hi_u32_u24 v58, s40, v11
    v_and_b32 v53, -2, v53
    v_mad_u32_u24 v8, v52, s43, v8
    v_and_b32 v80, -4, v52
    v_and_b32 v55, -2, v55
    v_mad_u32_u24 v9, v54, s43, v9
    v_and_b32 v81, -4, v54
    v_and_b32 v57, -2, v57
    v_mad_u32_u24 v10, v56, s43, v10
    v_and_b32 v82, -4, v56
    v_and_b32 v59, -2, v59
    v_mad_u32_u24 v11, v58, s43, v11
    v_and_b32 v83, -4, v58
    v_mad_i32_i24 v24, v53, s42, v24
    v_lshl_add_u32 v53, v80, 5, v53
    v_mad_i32_i24 v25, v55, s42, v25
    v_lshl_add_u32 v55, v81, 5, v55
    v_mad_i32_i24 v26, v57, s42, v26
    v_lshl_add_u32 v57, v82, 5, v57
    v_mad_i32_i24 v27, v59, s42, v27
    v_lshl_add_u32 v59, v83, 5, v59
    v_add_u32 v53, v53, v53
    ds_add_rtn_u32 v80, v53, v104
    v_add_u32 v55, v55, v55
    ds_add_rtn_u32 v81, v55, v104
    v_add_u32 v57, v57, v57
    ds_add_rtn_u32 v82, v57, v104
    v_add_u32 v59, v59, v59
    ds_add_rtn_u32 v83, v59, v104
    v_lshlrev_b32 v110, 16, v38
    v_and_b32 v111, 0xffff0000, v38
    v_lshlrev_b32 v112, 16, v39
    v_and_b32 v113, 0xffff0000, v39
    v_mul_f32 v110, s44, v110
    v_mul_f32 v111, s44, v111
    v_mul_f32 v112, s44, v112
    v_mul_f32 v113, s44, v113
    v_fract_f32 v110, v110
    v_fract_f32 v111, v111
    v_fract_f32 v112, v112
    v_fract_f32 v113, v113
    v_cos_f32 v110, v110
    v_cos_f32 v111, v111
    v_cos_f32 v112, v112
    v_cos_f32 v113, v113
    v_lshl_or_b32 v52, v52, 14, v24
    v_perm_b32 v53, v53, v8, s46
    v_bfe_u32 v8, v8, 8, 5

    v_lshl_or_b32 v54, v54, 14, v25
    v_perm_b32 v55, v55, v9, s46
    v_bfe_u32 v9, v9, 8, 5

    v_lshl_or_b32 v56, v56, 14, v26
    v_perm_b32 v57, v57, v10, s46
    v_bfe_u32 v10, v10, 8, 5

    v_lshl_or_b32 v58, v58, 14, v27
    v_perm_b32 v59, v59, v11, s46
    v_bfe_u32 v11, v11, 8, 5

    v_fmaak_f32 v110, v110, v105, 0x4b400010
    v_fmaak_f32 v111, v111, v105, 0x4b400010
    v_fmaak_f32 v112, v112, v105, 0x4b400010
    v_fmaak_f32 v113, v113, v105, 0x4b400010
    v_sub_u32 v110, v110, v8
    v_sub_u32 v111, v111, v9
    v_sub_u32 v112, v112, v10
    v_sub_u32 v113, v113, v11
    v_bfi_b32 v110, 31, v8, v110
    v_bfi_b32 v111, 31, v9, v111
    v_bfi_b32 v112, 31, v10, v112
    v_bfi_b32 v113, 31, v11, v113
    v_perm_b32 v52, v52, v110, s55
    v_perm_b32 v54, v54, v111, s55
    v_perm_b32 v56, v56, v112, s55
    v_perm_b32 v58, v58, v113, s55
L_ska_8:
    s_waitcnt vmcnt(9)
    s_bitcmp0_b32 s82, 2
    s_cbranch_scc1 L_ska_9
    v_mul_hi_u32_u24 v61, s40, v28
    v_mul_hi_u32_u24 v60, s40, v12
    v_mul_hi_u32_u24 v63, s40, v29
    v_mul_hi_u32_u24 v62, s40, v13
    v_mul_hi_u32_u24 v65, s40, v30
    v_mul_hi_u32_u24 v64, s40, v14
    v_mul_hi_u32_u24 v67, s40, v31
    v_mul_hi_u32_u24 v66, s40, v15
    v_and_b32 v61, -2, v61
    v_mad_u32_u24 v12, v60, s43, v12
    v_and_b32 v84, -4, v60
    v_and_b32 v63, -2, v63
    v_mad_u32_u24 v13, v62, s43, v13
    v_and_b32 v85, -4, v62
    v_and_b32 v65, -2, v65
    v_mad_u32_u24 v14, v64, s43, v14
    v_and_b32 v86, -4, v64
    v_and_b32 v67, -2, v67
    v_mad_u32_u24 v15, v66, s43, v15
    v_and_b32 v87, -4, v66
    v_mad_i32_i24 v28, v61, s42, v28
    v_lshl_add_u32 v61, v84, 5, v61
    v_mad_i32_i24 v29, v63, s42, v29
    v_lshl_add_u32 v63, v85, 5, v63
    v_mad_i32_i24 v30, v65, s42, v30
    v_lshl_add_u32 v65, v86, 5, v65
    v_mad_i32_i24 v31, v67, s42, v31
    v_lshl_add_u32 v67, v87, 5, v67
    v_add_u32 v61, v61, v61
    ds_add_rtn_u32 v84, v61, v104
    v_add_u32 v63, v63, v63
    ds_add_rtn_u32 v85, v63, v104
    v_add_u32 v65, v65, v65
    ds_add_rtn_u32 v86, v65, v104
    v_add_u32 v67, v67, v67
    ds_add_rtn_u32 v87, v67, v104
    v_lshlrev_b32 v110, 16, v40
    v_and_b32 v111, 0xffff0000, v40
    v_lshlrev_b32 v112, 16, v41
    v_and_b32 v113, 0xffff0000, v41
    v_mul_f32 v110, s44, v110
    v_mul_f32 v111, s44, v111
    v_mul_f32 v112, s44, v112
    v_mul_f32 v113, s44, v113
    v_fract_f32 v110, v110
    v_fract_f32 v111, v111
    v_fract_f32 v112, v112
    v_fract_f32 v113, v113
    v_cos_f32 v110, v110
    v_cos_f32 v111, v111
    v_cos_f32 v112, v112
    v_cos_f32 v113, v113
    v_lshl_or_b32 v60, v60, 14, v28
    v_perm_b32 v61, v61, v12, s46
    v_bfe_u32 v12, v12, 8, 5

    v_lshl_or_b32 v62, v62, 14, v29
    v_perm_b32 v63, v63, v13, s46
    v_bfe_u32 v13, v13, 8, 5

    v_lshl_or_b32 v64, v64, 14, v30
    v_perm_b32 v65, v65, v14, s46
    v_bfe_u32 v14, v14, 8, 5

    v_lshl_or_b32 v66, v66, 14, v31
    v_perm_b32 v67, v67, v15, s46
    v_bfe_u32 v15, v15, 8, 5

    v_fmaak_f32 v110, v110, v105, 0x4b400010
    v_fmaak_f32 v111, v111, v105, 0x4b400010
    v_fmaak_f32 v112, v112, v105, 0x4b400010
    v_fmaak_f32 v113, v113, v105, 0x4b400010
    v_sub_u32 v110, v110, v12
    v_sub_u32 v111, v111, v13
    v_sub_u32 v112, v112, v14
    v_sub_u32 v113, v113, v15
    v_bfi_b32 v110, 31, v12, v110
    v_bfi_b32 v111, 31, v13, v111
    v_bfi_b32 v112, 31, v14, v112
    v_bfi_b32 v113, 31, v15, v113
    v_perm_b32 v60, v60, v110, s55
    v_perm_b32 v62, v62, v111, s55
    v_perm_b32 v64, v64, v112, s55
    v_perm_b32 v66, v66, v113, s55
L_ska_9:
    s_waitcnt vmcnt(6)
    s_bitcmp0_b32 s82, 3
    s_cbranch_scc1 L_ska_10
    s_mov_b64 exec, s[66:67]
    v_mul_hi_u32_u24 v69, s40, v32
    v_mul_hi_u32_u24 v68, s40, v16
    v_mul_hi_u32_u24 v71, s40, v33
    v_mul_hi_u32_u24 v70, s40, v17
    v_mul_hi_u32_u24 v73, s40, v34
    v_mul_hi_u32_u24 v72, s40, v18
    v_mul_hi_u32_u24 v75, s40, v35
    v_mul_hi_u32_u24 v74, s40, v19
    v_and_b32 v69, -2, v69
    v_mad_u32_u24 v16, v68, s43, v16
    v_and_b32 v88, -4, v68
    v_and_b32 v71, -2, v71
    v_mad_u32_u24 v17, v70, s43, v17
    v_and_b32 v89, -4, v70
    v_and_b32 v73, -2, v73
    v_mad_u32_u24 v18, v72, s43, v18
    v_and_b32 v90, -4, v72
    v_and_b32 v75, -2, v75
    v_mad_u32_u24 v19, v74, s43, v19
    v_and_b32 v91, -4, v74
    v_mad_i32_i24 v32, v69, s42, v32
    v_lshl_add_u32 v69, v88, 5, v69
    v_mad_i32_i24 v33, v71, s42, v33
    v_lshl_add_u32 v71, v89, 5, v71
    v_mad_i32_i24 v34, v73, s42, v34
    v_lshl_add_u32 v73, v90, 5, v73
    v_mad_i32_i24 v35, v75, s42, v35
    v_lshl_add_u32 v75, v91, 5, v75
    v_add_u32 v69, v69, v69
    ds_add_rtn_u32 v88, v69, v104
    v_add_u32 v71, v71, v71
    ds_add_rtn_u32 v89, v71, v104
    v_add_u32 v73, v73, v73
    ds_add_rtn_u32 v90, v73, v104
    v_add_u32 v75, v75, v75
    ds_add_rtn_u32 v91, v75, v104
    v_lshlrev_b32 v110, 16, v42
    v_and_b32 v111, 0xffff0000, v42
    v_lshlrev_b32 v112, 16, v43
    v_and_b32 v113, 0xffff0000, v43
    v_mul_f32 v110, s44, v110
    v_mul_f32 v111, s44, v111
    v_mul_f32 v112, s44, v112
    v_mul_f32 v113, s44, v113
    v_fract_f32 v110, v110
    v_fract_f32 v111, v111
    v_fract_f32 v112, v112
    v_fract_f32 v113, v113
    v_cos_f32 v110, v110
    v_cos_f32 v111, v111
    v_cos_f32 v112, v112
    v_cos_f32 v113, v113
    v_lshl_or_b32 v68, v68, 14, v32
    v_perm_b32 v69, v69, v16, s46
    v_bfe_u32 v16, v16, 8, 5

    v_lshl_or_b32 v70, v70, 14, v33
    v_perm_b32 v71, v71, v17, s46
    v_bfe_u32 v17, v17, 8, 5

    v_lshl_or_b32 v72, v72, 14, v34
    v_perm_b32 v73, v73, v18, s46
    v_bfe_u32 v18, v18, 8, 5

    v_lshl_or_b32 v74, v74, 14, v35
    v_perm_b32 v75, v75, v19, s46
    v_bfe_u32 v19, v19, 8, 5

    v_fmaak_f32 v110, v110, v105, 0x4b400010
    v_fmaak_f32 v111, v111, v105, 0x4b400010
    v_fmaak_f32 v112, v112, v105, 0x4b400010
    v_fmaak_f32 v113, v113, v105, 0x4b400010
    v_sub_u32 v110, v110, v16
    v_sub_u32 v111, v111, v17
    v_sub_u32 v112, v112, v18
    v_sub_u32 v113, v113, v19
    v_bfi_b32 v110, 31, v16, v110
    v_bfi_b32 v111, 31, v17, v111
    v_bfi_b32 v112, 31, v18, v112
    v_bfi_b32 v113, 31, v19, v113
    v_perm_b32 v68, v68, v110, s55
    v_perm_b32 v70, v70, v111, s55
    v_perm_b32 v72, v72, v112, s55
    v_perm_b32 v74, v74, v113, s55
    s_mov_b64 exec, -1
L_ska_10:
    s_waitcnt vmcnt(0)
    v_or_b32 v100, v100, v0
    s_nop 0
    v_readfirstlane_b32 s74, v100
    s_nop 1
    s_cmp_lg_u32 s74, 0
    s_cbranch_scc1 L_ready_12

    v_mov_b32 v110, 1
    buffer_atomic_add v110, v98, s[96:99], 0 offen offset:64 sc0
    s_waitcnt vmcnt(0)
    v_readfirstlane_b32 s74, v110
    s_nop 1
    s_cmp_lg_u32 s74, 0
    s_cbranch_scc1 L_zno_14

    s_mov_b32 s92, s6
    s_mov_b32 s93, s7
    s_mov_b32 s94, 65552
    s_mov_b32 s95, 0x20000
    v_mov_b32 v110, 0
    v_mov_b32 v111, 0
    v_mov_b32 v112, 0
    v_mov_b32 v113, 0
L_zl_13:
    buffer_store_dwordx4 v[110:113], v1, s[92:95], s74 offen sc0 sc1
    s_add_u32 s74, s74, 1024
    s_cmp_le_u32 s74, 65536
    s_cbranch_scc1 L_zl_13
    v_mov_b32 v114, 1
    s_waitcnt vmcnt(0)
    buffer_atomic_add v114, v98, s[96:99], 0 offen offset:128
L_zno_14:

L_spin_11:
    v_mov_b32 v100, 0
    buffer_atomic_add v100, v98, s[96:99], 0 offen offset:128 sc0
    s_waitcnt vmcnt(0)
    v_readfirstlane_b32 s74, v100
    s_nop 1
    s_cmp_eq_u32 s74, 0
    s_cbranch_scc1 L_spin_11
L_ready_12:

    v_cmp_eq_u32 vcc, 0, v0
    s_waitcnt vmcnt(1)
    s_mov_b64 exec, vcc
    ds_write_b32 v108, v99 offset:8
    s_mov_b64 exec, -1
    s_waitcnt lgkmcnt(0)
    s_barrier

    ds_read2_b32 v[110:111], v108 offset0:1 offset1:2
    ds_read_b64 v[94:95], v2
    s_waitcnt lgkmcnt(0)
    v_readfirstlane_b32 s53, v110
    v_readfirstlane_b32 s41, v111

    v_and_b32 v94, 0xffff, v94
    v_and_b32 v95, 0xffff, v95
    v_add_u32 v97, v94, v95
    s_nop 1
    v_add_u32_dpp v97, v97, v97 row_shr:1 row_mask:0xf bank_mask:0xf
    s_nop 1
    v_add_u32_dpp v97, v97, v97 row_shr:2 row_mask:0xf bank_mask:0xf
    s_nop 1
    v_add_u32_dpp v97, v97, v97 row_shr:4 row_mask:0xf bank_mask:0xf
    s_nop 1
    v_add_u32_dpp v97, v97, v97 row_shr:8 row_mask:0xf bank_mask:0xf
    s_nop 1
    v_add_u32_dpp v97, v97, v97 row_bcast:15 row_mask:0xa bank_mask:0xf
    s_nop 1
    v_add_u32_dpp v97, v97, v97 row_bcast:31 row_mask:0xc bank_mask:0xf
    s_mov_b32 exec_lo, 0
    s_brev_b32 exec_hi, 1
    ds_add_rtn_u32 v96, v108, v97
    s_mov_b64 exec, -1

    v_add_u32 v92, v94, v94
    v_add_u32 v93, v95, v95
    v_med3_u32 v92, v94, 2, v92
    v_med3_u32 v93, v95, 2, v93
    buffer_atomic_add_x2 v[92:93], v2, s[20:23], 0 offen sc0
    s_add_u32 s41, s41, 160
    s_sub_u32 s78, s41, 3008
    s_lshr_b32 s79, s78, 1
    s_add_u32 s79, s79, 3008
    s_and_b32 s86, s78, 1
    s_lshl_b32 s86, s86, 1
    s_add_u32 s87, s86, 2
    s_cmp_lt_u32 s41, 3008
    s_cselect_b32 s41, s41, s79
    s_cmovk_i32 s86, 0
    s_cmovk_i32 s87, 4

    s_mul_i32 s78, s41, 16000
    s_add_u32 s49, s78, 16000
    s_cmp_ge_u32 s41, 3200
    s_cmovk_i32 s49, 0
    s_cmovk_i32 s78, 0
    s_lshl_b32 s10, s49, 2
    s_lshl_b32 s14, s49, 2
    s_lshl_b32 s18, s49, 1
    s_sub_u32 s79, s87, s86
    s_bfm_b32 s85, s79, s86
    s_lshl_b32 s86, s86, 12
    s_lshl_b32 s87, s87, 12
    s_min_u32 s87, s87, 16000

    s_add_u32 s79, s78, 0
    s_bitcmp1_b32 s85, 0
    s_cselect_b32 s79, s79, 0x1ff00000
    s_lshl_b32 s56, s79, 2
    s_lshl_b32 s61, s79, 1

    s_add_u32 s79, s78, 4096
    s_bitcmp1_b32 s85, 1
    s_cselect_b32 s79, s79, 0x1ff00000
    s_lshl_b32 s57, s79, 2
    s_lshl_b32 s62, s79, 1

    s_add_u32 s79, s78, 8192
    s_bitcmp1_b32 s85, 2
    s_cselect_b32 s79, s79, 0x1ff00000
    s_lshl_b32 s58, s79, 2
    s_lshl_b32 s63, s79, 1

    s_add_u32 s79, s78, 12288
    s_bitcmp1_b32 s85, 3
    s_cselect_b32 s79, s79, 0x1ff00000
    s_lshl_b32 s59, s79, 2
    s_lshl_b32 s64, s79, 1

    s_waitcnt lgkmcnt(0)
    v_readlane_b32 s77, v96, 63
    v_mul_u32_u24 v114, 7936, v0
    v_sub_u32 v97, v97, v95
    s_sub_u32 s50, s50, s83
    s_sub_u32 s77, s77, s50
    v_add_u32 v97, s77, v97
    v_sub_u32 v96, v97, v94
    v_lshlrev_b32 v111, 16, v97
    v_lshlrev_b32 v110, 16, v96
    ds_write_b64 v2, v[110:111]
    v_sub_u32 v96, v114, v96
    v_sub_u32 v97, v114, v97
    v_add_u32 v97, s48, v97
    s_add_u32 s50, s50, s84
    s_mov_b32 s28, s82
    s_mov_b32 s29, s83
    s_mov_b32 s30, s84
    s_lshl_b32 s74, s29, 3
    s_lshl_b32 s75, s30, 3
    v_mov_b32 v125, s74
    v_mov_b32 v126, s75
    v_mov_b32 v127, -1

    s_waitcnt lgkmcnt(0)
    s_barrier

    s_mov_b64 exec, 1
    ds_write_b32 v125, v127 offset:16396
    ds_write_b32 v126, v127 offset:16404
    s_mov_b64 exec, -1

    buffer_load_dwordx4 v[20:23], v1, s[12:15], s56 offen nt
    buffer_load_dwordx4 v[4:7], v1, s[8:11], s56 offen nt
    buffer_load_dwordx2 v[36:37], v2, s[16:19], s61 offen nt
    s_bitcmp0_b32 s28, 0
    s_cbranch_scc1 L_skz_15
    v_lshrrev_b32 v110, 16, v45
    ds_read_b32 v110, v110
    v_lshrrev_b32 v111, 16, v47
    ds_read_b32 v111, v111
    v_lshrrev_b32 v112, 16, v49
    ds_read_b32 v112, v112
    v_lshrrev_b32 v113, 16, v51
    ds_read_b32 v113, v113
    s_waitcnt lgkmcnt(3)
    v_add_u32_sdwa v110, v110, v76 dst_sel:DWORD dst_unused:UNUSED_PAD src0_sel:WORD_1 src1_sel:WORD_0
    v_lshlrev_b32 v110, 3, v110
    ds_write_b64 v110, v[44:45] offset:16400

    s_waitcnt lgkmcnt(3)
    v_add_u32_sdwa v111, v111, v77 dst_sel:DWORD dst_unused:UNUSED_PAD src0_sel:WORD_1 src1_sel:WORD_0
    v_lshlrev_b32 v111, 3, v111
    ds_write_b64 v111, v[46:47] offset:16400

    s_waitcnt lgkmcnt(3)
    v_add_u32_sdwa v112, v112, v78 dst_sel:DWORD dst_unused:UNUSED_PAD src0_sel:WORD_1 src1_sel:WORD_0
    v_lshlrev_b32 v112, 3, v112
    ds_write_b64 v112, v[48:49] offset:16400

    s_waitcnt lgkmcnt(3)
    v_add_u32_sdwa v113, v113, v79 dst_sel:DWORD dst_unused:UNUSED_PAD src0_sel:WORD_1 src1_sel:WORD_0
    v_lshlrev_b32 v113, 3, v113
    ds_write_b64 v113, v[50:51] offset:16400

L_skz_15:
    s_bitcmp0_b32 s28, 1
    s_cbranch_scc1 L_skz_16
    v_lshrrev_b32 v110, 16, v53
    ds_read_b32 v110, v110
    v_lshrrev_b32 v111, 16, v55
    ds_read_b32 v111, v111
    v_lshrrev_b32 v112, 16, v57
    ds_read_b32 v112, v112
    v_lshrrev_b32 v113, 16, v59
    ds_read_b32 v113, v113
    s_waitcnt lgkmcnt(3)
    v_add_u32_sdwa v110, v110, v80 dst_sel:DWORD dst_unused:UNUSED_PAD src0_sel:WORD_1 src1_sel:WORD_0
    v_lshlrev_b32 v110, 3, v110
    ds_write_b64 v110, v[52:53] offset:16400

    s_waitcnt lgkmcnt(3)
    v_add_u32_sdwa v111, v111, v81 dst_sel:DWORD dst_unused:UNUSED_PAD src0_sel:WORD_1 src1_sel:WORD_0
    v_lshlrev_b32 v111, 3, v111
    ds_write_b64 v111, v[54:55] offset:16400

    s_waitcnt lgkmcnt(3)
    v_add_u32_sdwa v112, v112, v82 dst_sel:DWORD dst_unused:UNUSED_PAD src0_sel:WORD_1 src1_sel:WORD_0
    v_lshlrev_b32 v112, 3, v112
    ds_write_b64 v112, v[56:57] offset:16400

    s_waitcnt lgkmcnt(3)
    v_add_u32_sdwa v113, v113, v83 dst_sel:DWORD dst_unused:UNUSED_PAD src0_sel:WORD_1 src1_sel:WORD_0
    v_lshlrev_b32 v113, 3, v113
    ds_write_b64 v113, v[58:59] offset:16400

L_skz_16:
    buffer_load_dwordx4 v[24:27], v1, s[12:15], s57 offen nt
    buffer_load_dwordx4 v[8:11], v1, s[8:11], s57 offen nt
    buffer_load_dwordx2 v[38:39], v2, s[16:19], s62 offen nt
    s_bitcmp0_b32 s28, 2
    s_cbranch_scc1 L_skz_17
    v_lshrrev_b32 v110, 16, v61
    ds_read_b32 v110, v110
    v_lshrrev_b32 v111, 16, v63
    ds_read_b32 v111, v111
    v_lshrrev_b32 v112, 16, v65
    ds_read_b32 v112, v112
    v_lshrrev_b32 v113, 16, v67
    ds_read_b32 v113, v113
    s_waitcnt lgkmcnt(3)
    v_add_u32_sdwa v110, v110, v84 dst_sel:DWORD dst_unused:UNUSED_PAD src0_sel:WORD_1 src1_sel:WORD_0
    v_lshlrev_b32 v110, 3, v110
    ds_write_b64 v110, v[60:61] offset:16400

    s_waitcnt lgkmcnt(3)
    v_add_u32_sdwa v111, v111, v85 dst_sel:DWORD dst_unused:UNUSED_PAD src0_sel:WORD_1 src1_sel:WORD_0
    v_lshlrev_b32 v111, 3, v111
    ds_write_b64 v111, v[62:63] offset:16400

    s_waitcnt lgkmcnt(3)
    v_add_u32_sdwa v112, v112, v86 dst_sel:DWORD dst_unused:UNUSED_PAD src0_sel:WORD_1 src1_sel:WORD_0
    v_lshlrev_b32 v112, 3, v112
    ds_write_b64 v112, v[64:65] offset:16400

    s_waitcnt lgkmcnt(3)
    v_add_u32_sdwa v113, v113, v87 dst_sel:DWORD dst_unused:UNUSED_PAD src0_sel:WORD_1 src1_sel:WORD_0
    v_lshlrev_b32 v113, 3, v113
    ds_write_b64 v113, v[66:67] offset:16400

L_skz_17:
    s_bitcmp0_b32 s28, 3
    s_cbranch_scc1 L_skz_18
    s_mov_b64 exec, s[66:67]
    v_lshrrev_b32 v110, 16, v69
    ds_read_b32 v110, v110
    v_lshrrev_b32 v111, 16, v71
    ds_read_b32 v111, v111
    v_lshrrev_b32 v112, 16, v73
    ds_read_b32 v112, v112
    v_lshrrev_b32 v113, 16, v75
    ds_read_b32 v113, v113
    s_waitcnt lgkmcnt(3)
    v_add_u32_sdwa v110, v110, v88 dst_sel:DWORD dst_unused:UNUSED_PAD src0_sel:WORD_1 src1_sel:WORD_0
    v_lshlrev_b32 v110, 3, v110
    ds_write_b64 v110, v[68:69] offset:16400

    s_waitcnt lgkmcnt(3)
    v_add_u32_sdwa v111, v111, v89 dst_sel:DWORD dst_unused:UNUSED_PAD src0_sel:WORD_1 src1_sel:WORD_0
    v_lshlrev_b32 v111, 3, v111
    ds_write_b64 v111, v[70:71] offset:16400

    s_waitcnt lgkmcnt(3)
    v_add_u32_sdwa v112, v112, v90 dst_sel:DWORD dst_unused:UNUSED_PAD src0_sel:WORD_1 src1_sel:WORD_0
    v_lshlrev_b32 v112, 3, v112
    ds_write_b64 v112, v[72:73] offset:16400

    s_waitcnt lgkmcnt(3)
    v_add_u32_sdwa v113, v113, v91 dst_sel:DWORD dst_unused:UNUSED_PAD src0_sel:WORD_1 src1_sel:WORD_0
    v_lshlrev_b32 v113, 3, v113
    ds_write_b64 v113, v[74:75] offset:16400

    s_mov_b64 exec, -1
L_skz_18:
    buffer_load_dwordx4 v[28:31], v1, s[12:15], s58 offen nt
    buffer_load_dwordx4 v[12:15], v1, s[8:11], s58 offen nt
    buffer_load_dwordx2 v[40:41], v2, s[16:19], s63 offen nt
    buffer_load_dwordx4 v[32:35], v1, s[12:15], s59 offen nt
    buffer_load_dwordx4 v[16:19], v1, s[8:11], s59 offen nt
    buffer_load_dwordx2 v[42:43], v2, s[16:19], s64 offen nt
    s_cmp_eq_u32 s49, 0
    s_cbranch_scc1 L_p1epi_6
L_p1loop_5:
    s_mov_b32 s82, s85
    s_mov_b32 s83, s86
    s_mov_b32 s84, s87
    v_mov_b32 v99, 1
    buffer_atomic_add v99, v98, s[96:99], 0 offen sc0
    s_waitcnt vmcnt(10)
    s_bitcmp0_b32 s82, 0
    s_cbranch_scc1 L_ska_19
    v_mul_hi_u32_u24 v45, s40, v20
    v_mul_hi_u32_u24 v44, s40, v4
    v_mul_hi_u32_u24 v47, s40, v21
    v_mul_hi_u32_u24 v46, s40, v5
    v_mul_hi_u32_u24 v49, s40, v22
    v_mul_hi_u32_u24 v48, s40, v6
    v_mul_hi_u32_u24 v51, s40, v23
    v_mul_hi_u32_u24 v50, s40, v7
    v_and_b32 v45, -2, v45
    v_mad_u32_u24 v4, v44, s43, v4
    v_and_b32 v76, -4, v44
    v_and_b32 v47, -2, v47
    v_mad_u32_u24 v5, v46, s43, v5
    v_and_b32 v77, -4, v46
    v_and_b32 v49, -2, v49
    v_mad_u32_u24 v6, v48, s43, v6
    v_and_b32 v78, -4, v48
    v_and_b32 v51, -2, v51
    v_mad_u32_u24 v7, v50, s43, v7
    v_and_b32 v79, -4, v50
    v_mad_i32_i24 v20, v45, s42, v20
    v_lshl_add_u32 v45, v76, 5, v45
    v_mad_i32_i24 v21, v47, s42, v21
    v_lshl_add_u32 v47, v77, 5, v47
    v_mad_i32_i24 v22, v49, s42, v22
    v_lshl_add_u32 v49, v78, 5, v49
    v_mad_i32_i24 v23, v51, s42, v23
    v_lshl_add_u32 v51, v79, 5, v51
    v_add_u32 v45, v45, v45
    ds_add_rtn_u32 v76, v45, v104
    v_add_u32 v47, v47, v47
    ds_add_rtn_u32 v77, v47, v104
    v_add_u32 v49, v49, v49
    ds_add_rtn_u32 v78, v49, v104
    v_add_u32 v51, v51, v51
    ds_add_rtn_u32 v79, v51, v104
    v_lshlrev_b32 v110, 16, v36
    v_and_b32 v111, 0xffff0000, v36
    v_lshlrev_b32 v112, 16, v37
    v_and_b32 v113, 0xffff0000, v37
    v_mul_f32 v110, s44, v110
    v_mul_f32 v111, s44, v111
    v_mul_f32 v112, s44, v112
    v_mul_f32 v113, s44, v113
    v_fract_f32 v110, v110
    v_fract_f32 v111, v111
    v_fract_f32 v112, v112
    v_fract_f32 v113, v113
    v_cos_f32 v110, v110
    v_cos_f32 v111, v111
    v_cos_f32 v112, v112
    v_cos_f32 v113, v113
    v_lshl_or_b32 v44, v44, 14, v20
    v_perm_b32 v45, v45, v4, s46
    v_bfe_u32 v4, v4, 8, 5

    v_lshl_or_b32 v46, v46, 14, v21
    v_perm_b32 v47, v47, v5, s46
    v_bfe_u32 v5, v5, 8, 5

    v_lshl_or_b32 v48, v48, 14, v22
    v_perm_b32 v49, v49, v6, s46
    v_bfe_u32 v6, v6, 8, 5

    v_lshl_or_b32 v50, v50, 14, v23
    v_perm_b32 v51, v51, v7, s46
    v_bfe_u32 v7, v7, 8, 5

    v_fmaak_f32 v110, v110, v105, 0x4b400010
    v_fmaak_f32 v111, v111, v105, 0x4b400010
    v_fmaak_f32 v112, v112, v105, 0x4b400010
    v_fmaak_f32 v113, v113, v105, 0x4b400010
    v_sub_u32 v110, v110, v4
    v_sub_u32 v111, v111, v5
    v_sub_u32 v112, v112, v6
    v_sub_u32 v113, v113, v7
    v_bfi_b32 v110, 31, v4, v110
    v_bfi_b32 v111, 31, v5, v111
    v_bfi_b32 v112, 31, v6, v112
    v_bfi_b32 v113, 31, v7, v113
    v_perm_b32 v44, v44, v110, s55
    v_perm_b32 v46, v46, v111, s55
    v_perm_b32 v48, v48, v112, s55
    v_perm_b32 v50, v50, v113, s55
L_ska_19:
    s_waitcnt vmcnt(7)
    s_bitcmp0_b32 s82, 1
    s_cbranch_scc1 L_ska_20
    v_mul_hi_u32_u24 v53, s40, v24
    v_mul_hi_u32_u24 v52, s40, v8
    v_mul_hi_u32_u24 v55, s40, v25
    v_mul_hi_u32_u24 v54, s40, v9
    v_mul_hi_u32_u24 v57, s40, v26
    v_mul_hi_u32_u24 v56, s40, v10
    v_mul_hi_u32_u24 v59, s40, v27
    v_mul_hi_u32_u24 v58, s40, v11
    v_and_b32 v53, -2, v53
    v_mad_u32_u24 v8, v52, s43, v8
    v_and_b32 v80, -4, v52
    v_and_b32 v55, -2, v55
    v_mad_u32_u24 v9, v54, s43, v9
    v_and_b32 v81, -4, v54
    v_and_b32 v57, -2, v57
    v_mad_u32_u24 v10, v56, s43, v10
    v_and_b32 v82, -4, v56
    v_and_b32 v59, -2, v59
    v_mad_u32_u24 v11, v58, s43, v11
    v_and_b32 v83, -4, v58
    v_mad_i32_i24 v24, v53, s42, v24
    v_lshl_add_u32 v53, v80, 5, v53
    v_mad_i32_i24 v25, v55, s42, v25
    v_lshl_add_u32 v55, v81, 5, v55
    v_mad_i32_i24 v26, v57, s42, v26
    v_lshl_add_u32 v57, v82, 5, v57
    v_mad_i32_i24 v27, v59, s42, v27
    v_lshl_add_u32 v59, v83, 5, v59
    v_add_u32 v53, v53, v53
    ds_add_rtn_u32 v80, v53, v104
    v_add_u32 v55, v55, v55
    ds_add_rtn_u32 v81, v55, v104
    v_add_u32 v57, v57, v57
    ds_add_rtn_u32 v82, v57, v104
    v_add_u32 v59, v59, v59
    ds_add_rtn_u32 v83, v59, v104
    v_lshlrev_b32 v110, 16, v38
    v_and_b32 v111, 0xffff0000, v38
    v_lshlrev_b32 v112, 16, v39
    v_and_b32 v113, 0xffff0000, v39
    v_mul_f32 v110, s44, v110
    v_mul_f32 v111, s44, v111
    v_mul_f32 v112, s44, v112
    v_mul_f32 v113, s44, v113
    v_fract_f32 v110, v110
    v_fract_f32 v111, v111
    v_fract_f32 v112, v112
    v_fract_f32 v113, v113
    v_cos_f32 v110, v110
    v_cos_f32 v111, v111
    v_cos_f32 v112, v112
    v_cos_f32 v113, v113
    v_lshl_or_b32 v52, v52, 14, v24
    v_perm_b32 v53, v53, v8, s46
    v_bfe_u32 v8, v8, 8, 5

    v_lshl_or_b32 v54, v54, 14, v25
    v_perm_b32 v55, v55, v9, s46
    v_bfe_u32 v9, v9, 8, 5

    v_lshl_or_b32 v56, v56, 14, v26
    v_perm_b32 v57, v57, v10, s46
    v_bfe_u32 v10, v10, 8, 5

    v_lshl_or_b32 v58, v58, 14, v27
    v_perm_b32 v59, v59, v11, s46
    v_bfe_u32 v11, v11, 8, 5

    v_fmaak_f32 v110, v110, v105, 0x4b400010
    v_fmaak_f32 v111, v111, v105, 0x4b400010
    v_fmaak_f32 v112, v112, v105, 0x4b400010
    v_fmaak_f32 v113, v113, v105, 0x4b400010
    v_sub_u32 v110, v110, v8
    v_sub_u32 v111, v111, v9
    v_sub_u32 v112, v112, v10
    v_sub_u32 v113, v113, v11
    v_bfi_b32 v110, 31, v8, v110
    v_bfi_b32 v111, 31, v9, v111
    v_bfi_b32 v112, 31, v10, v112
    v_bfi_b32 v113, 31, v11, v113
    v_perm_b32 v52, v52, v110, s55
    v_perm_b32 v54, v54, v111, s55
    v_perm_b32 v56, v56, v112, s55
    v_perm_b32 v58, v58, v113, s55
L_ska_20:
    s_waitcnt vmcnt(1)
    s_waitcnt vmcnt(0)
    v_cmp_eq_u32 vcc, 0, v0
    s_mov_b64 exec, vcc
    ds_write_b32 v108, v99 offset:8
    s_mov_b64 exec, -1
    s_waitcnt vmcnt(10)
    v_add_u32 v110, v92, v94
    v_min_u32 v92, s48, v92
    v_add_u32 v111, v93, v95
    v_min_u32 v93, s48, v93
    v_max_u32 v110, v110, v111
    v_add_u32 v92, v92, v96
    v_add_u32 v93, v93, v97
    v_cmp_le_u32 vcc, s48, v110
    v_lshl_add_u32 v92, v92, 2, v92
    v_lshl_add_u32 v93, v93, 2, v93
    ds_write_b64 v2, v[92:93] offset:8192
    s_cbranch_vccz L_noov_21
    ds_write_b32 v108, v104 offset:4
L_noov_21:

    s_waitcnt lgkmcnt(0)
    s_barrier
    ds_read2_b32 v[110:111], v108 offset0:1 offset1:2
    s_waitcnt lgkmcnt(0)
    v_readfirstlane_b32 s53, v110
    v_readfirstlane_b32 s41, v111
    s_nop 1

    s_add_u32 s41, s41, 160
    s_sub_u32 s78, s41, 3008
    s_lshr_b32 s79, s78, 1
    s_add_u32 s79, s79, 3008
    s_and_b32 s86, s78, 1
    s_lshl_b32 s86, s86, 1
    s_add_u32 s87, s86, 2
    s_cmp_lt_u32 s41, 3008
    s_cselect_b32 s41, s41, s79
    s_cmovk_i32 s86, 0
    s_cmovk_i32 s87, 4

    s_mul_i32 s78, s41, 16000
    s_add_u32 s49, s78, 16000
    s_cmp_ge_u32 s41, 3200
    s_cmovk_i32 s49, 0
    s_cmovk_i32 s78, 0
    s_lshl_b32 s10, s49, 2
    s_lshl_b32 s14, s49, 2
    s_lshl_b32 s18, s49, 1
    s_sub_u32 s79, s87, s86
    s_bfm_b32 s85, s79, s86
    s_lshl_b32 s86, s86, 12
    s_lshl_b32 s87, s87, 12
    s_min_u32 s87, s87, 16000

    s_add_u32 s79, s78, 0
    s_bitcmp1_b32 s85, 0
    s_cselect_b32 s79, s79, 0x1ff00000
    s_lshl_b32 s56, s79, 2
    s_lshl_b32 s61, s79, 1

    s_add_u32 s79, s78, 4096
    s_bitcmp1_b32 s85, 1
    s_cselect_b32 s79, s79, 0x1ff00000
    s_lshl_b32 s57, s79, 2
    s_lshl_b32 s62, s79, 1

    s_add_u32 s79, s78, 8192
    s_bitcmp1_b32 s85, 2
    s_cselect_b32 s79, s79, 0x1ff00000
    s_lshl_b32 s58, s79, 2
    s_lshl_b32 s63, s79, 1

    s_add_u32 s79, s78, 12288
    s_bitcmp1_b32 s85, 3
    s_cselect_b32 s79, s79, 0x1ff00000
    s_lshl_b32 s59, s79, 2
    s_lshl_b32 s64, s79, 1

    s_cmp_lg_u32 s53, 0
    s_cbranch_scc1 L_slow_22
L_sback_23:
    s_bitcmp0_b32 s28, 0
    s_cbranch_scc1 L_skw_27
    ds_read_b64 v[110:111], v2 offset:16400
    ds_read_b64 v[112:113], v2 offset:16408
    ds_read_b64 v[114:115], v2 offset:16392

    ds_read_b64 v[118:119], v2 offset:24592
    ds_read_b64 v[120:121], v2 offset:24600
    ds_read_b64 v[122:123], v2 offset:24584

    s_waitcnt lgkmcnt(3)
    v_lshrrev_b32 v116, 16, v111
    ds_read_b32 v116, v116 offset:8192

    s_waitcnt lgkmcnt(1)
    v_lshrrev_b32 v124, 16, v119
    ds_read_b32 v124, v124 offset:8192

    v_cmp_ne_u32_sdwa s[80:81], v111, v113 src0_sel:WORD_1 src1_sel:WORD_1
    v_cmp_ne_u32_sdwa vcc, v111, v115 src0_sel:WORD_1 src1_sel:WORD_1
    v_alignbyte_b32 v114, v115, v114, 2
    s_mov_b32 s54, -3
    v_alignbyte_b32 v111, v111, v110, 1
    v_perm_b32 v110, v110, v114, s47
    s_waitcnt lgkmcnt(1)
    v_add3_u32 v116, v116, v106, s54
    v_sub_u32 v117, 0, v116
    v_and_b32 v117, 3, v117
    s_mov_b64 exec, s[80:81]
    v_mov_b32 v117, 0
    v_mov_b32 v112, 0
    s_mov_b64 exec, vcc
    v_mov_b32 v117, 3

    s_mov_b64 exec, -1
    v_alignbyte_b32 v110, v111, v110, v117
    v_alignbyte_b32 v111, v112, v111, v117
    v_add_u32 v116, v116, v117

    buffer_store_dwordx2 v[110:111], v116, s[24:27], 0 offen
    v_cmp_ne_u32_sdwa s[80:81], v119, v121 src0_sel:WORD_1 src1_sel:WORD_1
    v_cmp_ne_u32_sdwa vcc, v119, v123 src0_sel:WORD_1 src1_sel:WORD_1
    v_alignbyte_b32 v122, v123, v122, 2
    s_mov_b32 s54, 5117
    v_alignbyte_b32 v119, v119, v118, 1
    v_perm_b32 v118, v118, v122, s47
    s_waitcnt lgkmcnt(0)
    v_add3_u32 v124, v124, v106, s54
    v_sub_u32 v125, 0, v124
    v_and_b32 v125, 3, v125
    s_mov_b64 exec, s[80:81]
    v_mov_b32 v125, 0
    v_mov_b32 v120, 0
    s_mov_b64 exec, vcc
    v_mov_b32 v125, 3

    s_mov_b64 exec, -1
    v_alignbyte_b32 v118, v119, v118, v125
    v_alignbyte_b32 v119, v120, v119, v125
    v_add_u32 v124, v124, v125

    buffer_store_dwordx2 v[118:119], v124, s[24:27], 0 offen
L_skw_27:
    s_bitcmp0_b32 s28, 0
    s_cbranch_scc1 L_skw_28
    ds_read_b64 v[110:111], v2 offset:32784
    ds_read_b64 v[112:113], v2 offset:32792
    ds_read_b64 v[114:115], v2 offset:32776

    ds_read_b64 v[118:119], v2 offset:40976
    ds_read_b64 v[120:121], v2 offset:40984
    ds_read_b64 v[122:123], v2 offset:40968

    s_waitcnt lgkmcnt(3)
    v_lshrrev_b32 v116, 16, v111
    ds_read_b32 v116, v116 offset:8192

    s_waitcnt lgkmcnt(1)
    v_lshrrev_b32 v124, 16, v119
    ds_read_b32 v124, v124 offset:8192

    v_cmp_ne_u32_sdwa s[80:81], v111, v113 src0_sel:WORD_1 src1_sel:WORD_1
    v_cmp_ne_u32_sdwa vcc, v111, v115 src0_sel:WORD_1 src1_sel:WORD_1
    v_alignbyte_b32 v114, v115, v114, 2
    s_mov_b32 s54, 10237
    v_alignbyte_b32 v111, v111, v110, 1
    v_perm_b32 v110, v110, v114, s47
    s_waitcnt lgkmcnt(1)
    v_add3_u32 v116, v116, v106, s54
    v_sub_u32 v117, 0, v116
    v_and_b32 v117, 3, v117
    s_mov_b64 exec, s[80:81]
    v_mov_b32 v117, 0
    v_mov_b32 v112, 0
    s_mov_b64 exec, vcc
    v_mov_b32 v117, 3

    s_mov_b64 exec, -1
    v_alignbyte_b32 v110, v111, v110, v117
    v_alignbyte_b32 v111, v112, v111, v117
    v_add_u32 v116, v116, v117

    buffer_store_dwordx2 v[110:111], v116, s[24:27], 0 offen
    v_cmp_ne_u32_sdwa s[80:81], v119, v121 src0_sel:WORD_1 src1_sel:WORD_1
    v_cmp_ne_u32_sdwa vcc, v119, v123 src0_sel:WORD_1 src1_sel:WORD_1
    v_alignbyte_b32 v122, v123, v122, 2
    s_mov_b32 s54, 15357
    v_alignbyte_b32 v119, v119, v118, 1
    v_perm_b32 v118, v118, v122, s47
    s_waitcnt lgkmcnt(0)
    v_add3_u32 v124, v124, v106, s54
    v_sub_u32 v125, 0, v124
    v_and_b32 v125, 3, v125
    s_mov_b64 exec, s[80:81]
    v_mov_b32 v125, 0
    v_mov_b32 v120, 0
    s_mov_b64 exec, vcc
    v_mov_b32 v125, 3

    s_mov_b64 exec, -1
    v_alignbyte_b32 v118, v119, v118, v125
    v_alignbyte_b32 v119, v120, v119, v125
    v_add_u32 v124, v124, v125

    buffer_store_dwordx2 v[118:119], v124, s[24:27], 0 offen
L_skw_28:
    s_bitcmp0_b32 s82, 2
    s_cbranch_scc1 L_ska_29
    v_mul_hi_u32_u24 v61, s40, v28
    v_mul_hi_u32_u24 v60, s40, v12
    v_mul_hi_u32_u24 v63, s40, v29
    v_mul_hi_u32_u24 v62, s40, v13
    v_mul_hi_u32_u24 v65, s40, v30
    v_mul_hi_u32_u24 v64, s40, v14
    v_mul_hi_u32_u24 v67, s40, v31
    v_mul_hi_u32_u24 v66, s40, v15
    v_and_b32 v61, -2, v61
    v_mad_u32_u24 v12, v60, s43, v12
    v_and_b32 v84, -4, v60
    v_and_b32 v63, -2, v63
    v_mad_u32_u24 v13, v62, s43, v13
    v_and_b32 v85, -4, v62
    v_and_b32 v65, -2, v65
    v_mad_u32_u24 v14, v64, s43, v14
    v_and_b32 v86, -4, v64
    v_and_b32 v67, -2, v67
    v_mad_u32_u24 v15, v66, s43, v15
    v_and_b32 v87, -4, v66
    v_mad_i32_i24 v28, v61, s42, v28
    v_lshl_add_u32 v61, v84, 5, v61
    v_mad_i32_i24 v29, v63, s42, v29
    v_lshl_add_u32 v63, v85, 5, v63
    v_mad_i32_i24 v30, v65, s42, v30
    v_lshl_add_u32 v65, v86, 5, v65
    v_mad_i32_i24 v31, v67, s42, v31
    v_lshl_add_u32 v67, v87, 5, v67
    v_add_u32 v61, v61, v61
    ds_add_rtn_u32 v84, v61, v104
    v_add_u32 v63, v63, v63
    ds_add_rtn_u32 v85, v63, v104
    v_add_u32 v65, v65, v65
    ds_add_rtn_u32 v86, v65, v104
    v_add_u32 v67, v67, v67
    ds_add_rtn_u32 v87, v67, v104
    v_lshlrev_b32 v110, 16, v40
    v_and_b32 v111, 0xffff0000, v40
    v_lshlrev_b32 v112, 16, v41
    v_and_b32 v113, 0xffff0000, v41
    v_mul_f32 v110, s44, v110
    v_mul_f32 v111, s44, v111
    v_mul_f32 v112, s44, v112
    v_mul_f32 v113, s44, v113
    v_fract_f32 v110, v110
    v_fract_f32 v111, v111
    v_fract_f32 v112, v112
    v_fract_f32 v113, v113
    v_cos_f32 v110, v110
    v_cos_f32 v111, v111
    v_cos_f32 v112, v112
    v_cos_f32 v113, v113
    v_lshl_or_b32 v60, v60, 14, v28
    v_perm_b32 v61, v61, v12, s46
    v_bfe_u32 v12, v12, 8, 5

    v_lshl_or_b32 v62, v62, 14, v29
    v_perm_b32 v63, v63, v13, s46
    v_bfe_u32 v13, v13, 8, 5

    v_lshl_or_b32 v64, v64, 14, v30
    v_perm_b32 v65, v65, v14, s46
    v_bfe_u32 v14, v14, 8, 5

    v_lshl_or_b32 v66, v66, 14, v31
    v_perm_b32 v67, v67, v15, s46
    v_bfe_u32 v15, v15, 8, 5

    v_fmaak_f32 v110, v110, v105, 0x4b400010
    v_fmaak_f32 v111, v111, v105, 0x4b400010
    v_fmaak_f32 v112, v112, v105, 0x4b400010
    v_fmaak_f32 v113, v113, v105, 0x4b400010
    v_sub_u32 v110, v110, v12
    v_sub_u32 v111, v111, v13
    v_sub_u32 v112, v112, v14
    v_sub_u32 v113, v113, v15
    v_bfi_b32 v110, 31, v12, v110
    v_bfi_b32 v111, 31, v13, v111
    v_bfi_b32 v112, 31, v14, v112
    v_bfi_b32 v113, 31, v15, v113
    v_perm_b32 v60, v60, v110, s55
    v_perm_b32 v62, v62, v111, s55
    v_perm_b32 v64, v64, v112, s55
    v_perm_b32 v66, v66, v113, s55
L_ska_29:
    s_bitcmp0_b32 s28, 1
    s_cbranch_scc1 L_skw_30
    v_add_u32 v107, 32768, v2
    ds_read_b64 v[110:111], v107 offset:16400
    ds_read_b64 v[112:113], v107 offset:16408
    ds_read_b64 v[114:115], v107 offset:16392

    ds_read_b64 v[118:119], v107 offset:24592
    ds_read_b64 v[120:121], v107 offset:24600
    ds_read_b64 v[122:123], v107 offset:24584

    s_waitcnt lgkmcnt(3)
    v_lshrrev_b32 v116, 16, v111
    ds_read_b32 v116, v116 offset:8192

    s_waitcnt lgkmcnt(1)
    v_lshrrev_b32 v124, 16, v119
    ds_read_b32 v124, v124 offset:8192

    v_cmp_ne_u32_sdwa s[80:81], v111, v113 src0_sel:WORD_1 src1_sel:WORD_1
    v_cmp_ne_u32_sdwa vcc, v111, v115 src0_sel:WORD_1 src1_sel:WORD_1
    v_alignbyte_b32 v114, v115, v114, 2
    s_mov_b32 s54, 20477
    v_alignbyte_b32 v111, v111, v110, 1
    v_perm_b32 v110, v110, v114, s47
    s_waitcnt lgkmcnt(1)
    v_add3_u32 v116, v116, v106, s54
    v_sub_u32 v117, 0, v116
    v_and_b32 v117, 3, v117
    s_mov_b64 exec, s[80:81]
    v_mov_b32 v117, 0
    v_mov_b32 v112, 0
    s_mov_b64 exec, vcc
    v_mov_b32 v117, 3

    s_mov_b64 exec, -1
    v_alignbyte_b32 v110, v111, v110, v117
    v_alignbyte_b32 v111, v112, v111, v117
    v_add_u32 v116, v116, v117

    buffer_store_dwordx2 v[110:111], v116, s[24:27], 0 offen
    v_cmp_ne_u32_sdwa s[80:81], v119, v121 src0_sel:WORD_1 src1_sel:WORD_1
    v_cmp_ne_u32_sdwa vcc, v119, v123 src0_sel:WORD_1 src1_sel:WORD_1
    v_alignbyte_b32 v122, v123, v122, 2
    s_mov_b32 s54, 25597
    v_alignbyte_b32 v119, v119, v118, 1
    v_perm_b32 v118, v118, v122, s47
    s_waitcnt lgkmcnt(0)
    v_add3_u32 v124, v124, v106, s54
    v_sub_u32 v125, 0, v124
    v_and_b32 v125, 3, v125
    s_mov_b64 exec, s[80:81]
    v_mov_b32 v125, 0
    v_mov_b32 v120, 0
    s_mov_b64 exec, vcc
    v_mov_b32 v125, 3

    s_mov_b64 exec, -1
    v_alignbyte_b32 v118, v119, v118, v125
    v_alignbyte_b32 v119, v120, v119, v125
    v_add_u32 v124, v124, v125

    buffer_store_dwordx2 v[118:119], v124, s[24:27], 0 offen
L_skw_30:
    s_bitcmp0_b32 s28, 1
    s_cbranch_scc1 L_skw_31
    v_add_u32 v107, 32768, v2
    ds_read_b64 v[110:111], v107 offset:32784
    ds_read_b64 v[112:113], v107 offset:32792
    ds_read_b64 v[114:115], v107 offset:32776

    ds_read_b64 v[118:119], v107 offset:40976
    ds_read_b64 v[120:121], v107 offset:40984
    ds_read_b64 v[122:123], v107 offset:40968

    s_waitcnt lgkmcnt(3)
    v_lshrrev_b32 v116, 16, v111
    ds_read_b32 v116, v116 offset:8192

    s_waitcnt lgkmcnt(1)
    v_lshrrev_b32 v124, 16, v119
    ds_read_b32 v124, v124 offset:8192

    v_cmp_ne_u32_sdwa s[80:81], v111, v113 src0_sel:WORD_1 src1_sel:WORD_1
    v_cmp_ne_u32_sdwa vcc, v111, v115 src0_sel:WORD_1 src1_sel:WORD_1
    v_alignbyte_b32 v114, v115, v114, 2
    s_mov_b32 s54, 30717
    v_alignbyte_b32 v111, v111, v110, 1
    v_perm_b32 v110, v110, v114, s47
    s_waitcnt lgkmcnt(1)
    v_add3_u32 v116, v116, v106, s54
    v_sub_u32 v117, 0, v116
    v_and_b32 v117, 3, v117
    s_mov_b64 exec, s[80:81]
    v_mov_b32 v117, 0
    v_mov_b32 v112, 0
    s_mov_b64 exec, vcc
    v_mov_b32 v117, 3

    s_mov_b64 exec, -1
    v_alignbyte_b32 v110, v111, v110, v117
    v_alignbyte_b32 v111, v112, v111, v117
    v_add_u32 v116, v116, v117

    buffer_store_dwordx2 v[110:111], v116, s[24:27], 0 offen
    v_cmp_ne_u32_sdwa s[80:81], v119, v121 src0_sel:WORD_1 src1_sel:WORD_1
    v_cmp_ne_u32_sdwa vcc, v119, v123 src0_sel:WORD_1 src1_sel:WORD_1
    v_alignbyte_b32 v122, v123, v122, 2
    s_mov_b32 s54, 35837
    v_alignbyte_b32 v119, v119, v118, 1
    v_perm_b32 v118, v118, v122, s47
    s_waitcnt lgkmcnt(0)
    v_add3_u32 v124, v124, v106, s54
    v_sub_u32 v125, 0, v124
    v_and_b32 v125, 3, v125
    s_mov_b64 exec, s[80:81]
    v_mov_b32 v125, 0
    v_mov_b32 v120, 0
    s_mov_b64 exec, vcc
    v_mov_b32 v125, 3

    s_mov_b64 exec, -1
    v_alignbyte_b32 v118, v119, v118, v125
    v_alignbyte_b32 v119, v120, v119, v125
    v_add_u32 v124, v124, v125

    buffer_store_dwordx2 v[118:119], v124, s[24:27], 0 offen
L_skw_31:
    s_bitcmp0_b32 s28, 2
    s_cbranch_scc1 L_skw_32
    v_add_u32 v107, 65536, v2
    ds_read_b64 v[110:111], v107 offset:16400
    ds_read_b64 v[112:113], v107 offset:16408
    ds_read_b64 v[114:115], v107 offset:16392

    ds_read_b64 v[118:119], v107 offset:24592
    ds_read_b64 v[120:121], v107 offset:24600
    ds_read_b64 v[122:123], v107 offset:24584

    s_waitcnt lgkmcnt(3)
    v_lshrrev_b32 v116, 16, v111
    ds_read_b32 v116, v116 offset:8192

    s_waitcnt lgkmcnt(1)
    v_lshrrev_b32 v124, 16, v119
    ds_read_b32 v124, v124 offset:8192

    v_cmp_ne_u32_sdwa s[80:81], v111, v113 src0_sel:WORD_1 src1_sel:WORD_1
    v_cmp_ne_u32_sdwa vcc, v111, v115 src0_sel:WORD_1 src1_sel:WORD_1
    v_alignbyte_b32 v114, v115, v114, 2
    s_mov_b32 s54, 40957
    v_alignbyte_b32 v111, v111, v110, 1
    v_perm_b32 v110, v110, v114, s47
    s_waitcnt lgkmcnt(1)
    v_add3_u32 v116, v116, v106, s54
    v_sub_u32 v117, 0, v116
    v_and_b32 v117, 3, v117
    s_mov_b64 exec, s[80:81]
    v_mov_b32 v117, 0
    v_mov_b32 v112, 0
    s_mov_b64 exec, vcc
    v_mov_b32 v117, 3

    s_mov_b64 exec, -1
    v_alignbyte_b32 v110, v111, v110, v117
    v_alignbyte_b32 v111, v112, v111, v117
    v_add_u32 v116, v116, v117

    buffer_store_dwordx2 v[110:111], v116, s[24:27], 0 offen
    v_cmp_ne_u32_sdwa s[80:81], v119, v121 src0_sel:WORD_1 src1_sel:WORD_1
    v_cmp_ne_u32_sdwa vcc, v119, v123 src0_sel:WORD_1 src1_sel:WORD_1
    v_alignbyte_b32 v122, v123, v122, 2
    s_mov_b32 s54, 46077
    v_alignbyte_b32 v119, v119, v118, 1
    v_perm_b32 v118, v118, v122, s47
    s_waitcnt lgkmcnt(0)
    v_add3_u32 v124, v124, v106, s54
    v_sub_u32 v125, 0, v124
    v_and_b32 v125, 3, v125
    s_mov_b64 exec, s[80:81]
    v_mov_b32 v125, 0
    v_mov_b32 v120, 0
    s_mov_b64 exec, vcc
    v_mov_b32 v125, 3

    s_mov_b64 exec, -1
    v_alignbyte_b32 v118, v119, v118, v125
    v_alignbyte_b32 v119, v120, v119, v125
    v_add_u32 v124, v124, v125

    buffer_store_dwordx2 v[118:119], v124, s[24:27], 0 offen
L_skw_32:
    s_bitcmp0_b32 s82, 3
    s_cbranch_scc1 L_ska_33
    s_mov_b64 exec, s[66:67]
    v_mul_hi_u32_u24 v69, s40, v32
    v_mul_hi_u32_u24 v68, s40, v16
    v_mul_hi_u32_u24 v71, s40, v33
    v_mul_hi_u32_u24 v70, s40, v17
    v_mul_hi_u32_u24 v73, s40, v34
    v_mul_hi_u32_u24 v72, s40, v18
    v_mul_hi_u32_u24 v75, s40, v35
    v_mul_hi_u32_u24 v74, s40, v19
    v_and_b32 v69, -2, v69
    v_mad_u32_u24 v16, v68, s43, v16
    v_and_b32 v88, -4, v68
    v_and_b32 v71, -2, v71
    v_mad_u32_u24 v17, v70, s43, v17
    v_and_b32 v89, -4, v70
    v_and_b32 v73, -2, v73
    v_mad_u32_u24 v18, v72, s43, v18
    v_and_b32 v90, -4, v72
    v_and_b32 v75, -2, v75
    v_mad_u32_u24 v19, v74, s43, v19
    v_and_b32 v91, -4, v74
    v_mad_i32_i24 v32, v69, s42, v32
    v_lshl_add_u32 v69, v88, 5, v69
    v_mad_i32_i24 v33, v71, s42, v33
    v_lshl_add_u32 v71, v89, 5, v71
    v_mad_i32_i24 v34, v73, s42, v34
    v_lshl_add_u32 v73, v90, 5, v73
    v_mad_i32_i24 v35, v75, s42, v35
    v_lshl_add_u32 v75, v91, 5, v75
    v_add_u32 v69, v69, v69
    ds_add_rtn_u32 v88, v69, v104
    v_add_u32 v71, v71, v71
    ds_add_rtn_u32 v89, v71, v104
    v_add_u32 v73, v73, v73
    ds_add_rtn_u32 v90, v73, v104
    v_add_u32 v75, v75, v75
    ds_add_rtn_u32 v91, v75, v104
    v_lshlrev_b32 v110, 16, v42
    v_and_b32 v111, 0xffff0000, v42
    v_lshlrev_b32 v112, 16, v43
    v_and_b32 v113, 0xffff0000, v43
    v_mul_f32 v110, s44, v110
    v_mul_f32 v111, s44, v111
    v_mul_f32 v112, s44, v112
    v_mul_f32 v113, s44, v113
    v_fract_f32 v110, v110
    v_fract_f32 v111, v111
    v_fract_f32 v112, v112
    v_fract_f32 v113, v113
    v_cos_f32 v110, v110
    v_cos_f32 v111, v111
    v_cos_f32 v112, v112
    v_cos_f32 v113, v113
    v_lshl_or_b32 v68, v68, 14, v32
    v_perm_b32 v69, v69, v16, s46
    v_bfe_u32 v16, v16, 8, 5

    v_lshl_or_b32 v70, v70, 14, v33
    v_perm_b32 v71, v71, v17, s46
    v_bfe_u32 v17, v17, 8, 5

    v_lshl_or_b32 v72, v72, 14, v34
    v_perm_b32 v73, v73, v18, s46
    v_bfe_u32 v18, v18, 8, 5

    v_lshl_or_b32 v74, v74, 14, v35
    v_perm_b32 v75, v75, v19, s46
    v_bfe_u32 v19, v19, 8, 5

    v_fmaak_f32 v110, v110, v105, 0x4b400010
    v_fmaak_f32 v111, v111, v105, 0x4b400010
    v_fmaak_f32 v112, v112, v105, 0x4b400010
    v_fmaak_f32 v113, v113, v105, 0x4b400010
    v_sub_u32 v110, v110, v16
    v_sub_u32 v111, v111, v17
    v_sub_u32 v112, v112, v18
    v_sub_u32 v113, v113, v19
    v_bfi_b32 v110, 31, v16, v110
    v_bfi_b32 v111, 31, v17, v111
    v_bfi_b32 v112, 31, v18, v112
    v_bfi_b32 v113, 31, v19, v113
    v_perm_b32 v68, v68, v110, s55
    v_perm_b32 v70, v70, v111, s55
    v_perm_b32 v72, v72, v112, s55
    v_perm_b32 v74, v74, v113, s55
    s_mov_b64 exec, -1
L_ska_33:
    s_bitcmp0_b32 s28, 2
    s_cbranch_scc1 L_skw_34
    v_add_u32 v107, 65536, v2
    ds_read_b64 v[110:111], v107 offset:32784
    ds_read_b64 v[112:113], v107 offset:32792
    ds_read_b64 v[114:115], v107 offset:32776

    ds_read_b64 v[118:119], v107 offset:40976
    ds_read_b64 v[120:121], v107 offset:40984
    ds_read_b64 v[122:123], v107 offset:40968

    s_waitcnt lgkmcnt(3)
    v_lshrrev_b32 v116, 16, v111
    ds_read_b32 v116, v116 offset:8192

    s_waitcnt lgkmcnt(1)
    v_lshrrev_b32 v124, 16, v119
    ds_read_b32 v124, v124 offset:8192

    v_cmp_ne_u32_sdwa s[80:81], v111, v113 src0_sel:WORD_1 src1_sel:WORD_1
    v_cmp_ne_u32_sdwa vcc, v111, v115 src0_sel:WORD_1 src1_sel:WORD_1
    v_alignbyte_b32 v114, v115, v114, 2
    s_mov_b32 s54, 51197
    v_alignbyte_b32 v111, v111, v110, 1
    v_perm_b32 v110, v110, v114, s47
    s_waitcnt lgkmcnt(1)
    v_add3_u32 v116, v116, v106, s54
    v_sub_u32 v117, 0, v116
    v_and_b32 v117, 3, v117
    s_mov_b64 exec, s[80:81]
    v_mov_b32 v117, 0
    v_mov_b32 v112, 0
    s_mov_b64 exec, vcc
    v_mov_b32 v117, 3

    s_mov_b64 exec, -1
    v_alignbyte_b32 v110, v111, v110, v117
    v_alignbyte_b32 v111, v112, v111, v117
    v_add_u32 v116, v116, v117

    buffer_store_dwordx2 v[110:111], v116, s[24:27], 0 offen
    v_cmp_ne_u32_sdwa s[80:81], v119, v121 src0_sel:WORD_1 src1_sel:WORD_1
    v_cmp_ne_u32_sdwa vcc, v119, v123 src0_sel:WORD_1 src1_sel:WORD_1
    v_alignbyte_b32 v122, v123, v122, 2
    s_mov_b32 s54, 56317
    v_alignbyte_b32 v119, v119, v118, 1
    v_perm_b32 v118, v118, v122, s47
    s_waitcnt lgkmcnt(0)
    v_add3_u32 v124, v124, v106, s54
    v_sub_u32 v125, 0, v124
    v_and_b32 v125, 3, v125
    s_mov_b64 exec, s[80:81]
    v_mov_b32 v125, 0
    v_mov_b32 v120, 0
    s_mov_b64 exec, vcc
    v_mov_b32 v125, 3

    s_mov_b64 exec, -1
    v_alignbyte_b32 v118, v119, v118, v125
    v_alignbyte_b32 v119, v120, v119, v125
    v_add_u32 v124, v124, v125

    buffer_store_dwordx2 v[118:119], v124, s[24:27], 0 offen
L_skw_34:
    s_bitcmp0_b32 s28, 3
    s_cbranch_scc1 L_skw_35
    v_add_u32 v107, 98304, v2
    ds_read_b64 v[110:111], v107 offset:16400
    ds_read_b64 v[112:113], v107 offset:16408
    ds_read_b64 v[114:115], v107 offset:16392

    ds_read_b64 v[118:119], v107 offset:24592
    ds_read_b64 v[120:121], v107 offset:24600
    ds_read_b64 v[122:123], v107 offset:24584

    s_waitcnt lgkmcnt(3)
    v_lshrrev_b32 v116, 16, v111
    ds_read_b32 v116, v116 offset:8192

    s_waitcnt lgkmcnt(1)
    v_lshrrev_b32 v124, 16, v119
    ds_read_b32 v124, v124 offset:8192

    v_cmp_ne_u32_sdwa s[80:81], v111, v113 src0_sel:WORD_1 src1_sel:WORD_1
    v_cmp_ne_u32_sdwa vcc, v111, v115 src0_sel:WORD_1 src1_sel:WORD_1
    v_alignbyte_b32 v114, v115, v114, 2
    s_mov_b32 s54, 61437
    v_alignbyte_b32 v111, v111, v110, 1
    v_perm_b32 v110, v110, v114, s47
    s_waitcnt lgkmcnt(1)
    v_add3_u32 v116, v116, v106, s54
    v_sub_u32 v117, 0, v116
    v_and_b32 v117, 3, v117
    s_mov_b64 exec, s[80:81]
    v_mov_b32 v117, 0
    v_mov_b32 v112, 0
    s_mov_b64 exec, vcc
    v_mov_b32 v117, 3

    s_mov_b64 exec, -1
    v_alignbyte_b32 v110, v111, v110, v117
    v_alignbyte_b32 v111, v112, v111, v117
    v_add_u32 v116, v116, v117

    buffer_store_dwordx2 v[110:111], v116, s[24:27], 0 offen
    v_cmp_ne_u32_sdwa s[80:81], v119, v121 src0_sel:WORD_1 src1_sel:WORD_1
    v_cmp_ne_u32_sdwa vcc, v119, v123 src0_sel:WORD_1 src1_sel:WORD_1
    v_alignbyte_b32 v122, v123, v122, 2
    s_mov_b32 s54, 66557
    v_alignbyte_b32 v119, v119, v118, 1
    v_perm_b32 v118, v118, v122, s47
    s_waitcnt lgkmcnt(0)
    v_add3_u32 v124, v124, v106, s54
    v_sub_u32 v125, 0, v124
    v_and_b32 v125, 3, v125
    s_mov_b64 exec, s[80:81]
    v_mov_b32 v125, 0
    v_mov_b32 v120, 0
    s_mov_b64 exec, vcc
    v_mov_b32 v125, 3

    s_mov_b64 exec, -1
    v_alignbyte_b32 v118, v119, v118, v125
    v_alignbyte_b32 v119, v120, v119, v125
    v_add_u32 v124, v124, v125

    buffer_store_dwordx2 v[118:119], v124, s[24:27], 0 offen
L_skw_35:
    s_bitcmp0_b32 s28, 3
    s_cbranch_scc1 L_skw_36
    v_add_u32 v107, 98304, v2
    ds_read_b64 v[110:111], v107 offset:32784
    ds_read_b64 v[112:113], v107 offset:32792
    ds_read_b64 v[114:115], v107 offset:32776

    ds_read_b64 v[118:119], v107 offset:40976
    ds_read_b64 v[120:121], v107 offset:40984
    ds_read_b64 v[122:123], v107 offset:40968

    s_waitcnt lgkmcnt(3)
    v_lshrrev_b32 v116, 16, v111
    ds_read_b32 v116, v116 offset:8192

    s_waitcnt lgkmcnt(1)
    v_lshrrev_b32 v124, 16, v119
    ds_read_b32 v124, v124 offset:8192

    v_cmp_ne_u32_sdwa s[80:81], v111, v113 src0_sel:WORD_1 src1_sel:WORD_1
    v_cmp_ne_u32_sdwa vcc, v111, v115 src0_sel:WORD_1 src1_sel:WORD_1
    v_alignbyte_b32 v114, v115, v114, 2
    s_mov_b32 s54, 71677
    v_alignbyte_b32 v111, v111, v110, 1
    v_perm_b32 v110, v110, v114, s47
    s_waitcnt lgkmcnt(1)
    v_add3_u32 v116, v116, v106, s54
    v_sub_u32 v117, 0, v116
    v_and_b32 v117, 3, v117
    s_mov_b64 exec, s[80:81]
    v_mov_b32 v117, 0
    v_mov_b32 v112, 0
    s_mov_b64 exec, vcc
    v_mov_b32 v117, 3

    s_mov_b64 exec, -1
    v_alignbyte_b32 v110, v111, v110, v117
    v_alignbyte_b32 v111, v112, v111, v117
    v_add_u32 v116, v116, v117

    buffer_store_dwordx2 v[110:111], v116, s[24:27], 0 offen
    v_cmp_ne_u32_sdwa s[80:81], v119, v121 src0_sel:WORD_1 src1_sel:WORD_1
    v_cmp_ne_u32_sdwa vcc, v119, v123 src0_sel:WORD_1 src1_sel:WORD_1
    v_alignbyte_b32 v122, v123, v122, 2
    s_mov_b32 s54, 76797
    v_alignbyte_b32 v119, v119, v118, 1
    v_perm_b32 v118, v118, v122, s47
    s_waitcnt lgkmcnt(0)
    v_add3_u32 v124, v124, v106, s54
    v_sub_u32 v125, 0, v124
    v_and_b32 v125, 3, v125
    s_mov_b64 exec, s[80:81]
    v_mov_b32 v125, 0
    v_mov_b32 v120, 0
    s_mov_b64 exec, vcc
    v_mov_b32 v125, 3

    s_andn2_b64 exec, -1, s[68:69]
    v_bfrev_b32 v124, 1
    s_mov_b64 exec, -1
    v_alignbyte_b32 v118, v119, v118, v125
    v_alignbyte_b32 v119, v120, v119, v125
    v_add_u32 v124, v124, v125

    buffer_store_dwordx2 v[118:119], v124, s[24:27], 0 offen
L_skw_36:
    s_waitcnt lgkmcnt(0)
    s_barrier

    buffer_load_dwordx4 v[20:23], v1, s[12:15], s56 offen nt
    buffer_load_dwordx4 v[4:7], v1, s[8:11], s56 offen nt
    buffer_load_dwordx2 v[36:37], v2, s[16:19], s61 offen nt
    ds_read_b64 v[94:95], v2
    s_waitcnt lgkmcnt(0)
    v_and_b32 v94, 0xffff, v94
    v_and_b32 v95, 0xffff, v95
    v_add_u32 v97, v94, v95
    s_nop 1
    v_add_u32_dpp v97, v97, v97 row_shr:1 row_mask:0xf bank_mask:0xf
    s_nop 1
    v_add_u32_dpp v97, v97, v97 row_shr:2 row_mask:0xf bank_mask:0xf
    s_nop 1
    v_add_u32_dpp v97, v97, v97 row_shr:4 row_mask:0xf bank_mask:0xf
    s_nop 1
    v_add_u32_dpp v97, v97, v97 row_shr:8 row_mask:0xf bank_mask:0xf
    s_nop 1
    v_add_u32_dpp v97, v97, v97 row_bcast:15 row_mask:0xa bank_mask:0xf
    s_nop 1
    v_add_u32_dpp v97, v97, v97 row_bcast:31 row_mask:0xc bank_mask:0xf
    s_mov_b32 exec_lo, 0
    s_brev_b32 exec_hi, 1
    ds_add_rtn_u32 v96, v108, v97
    s_mov_b64 exec, -1

    v_add_u32 v92, v94, v94
    v_add_u32 v93, v95, v95
    v_med3_u32 v92, v94, 2, v92
    v_med3_u32 v93, v95, 2, v93
    buffer_atomic_add_x2 v[92:93], v2, s[20:23], 0 offen sc0
    s_waitcnt lgkmcnt(0)
    v_readlane_b32 s77, v96, 63
    v_mul_u32_u24 v114, 7936, v0
    v_sub_u32 v97, v97, v95
    s_sub_u32 s50, s50, s83
    s_sub_u32 s77, s77, s50
    v_add_u32 v97, s77, v97
    v_sub_u32 v96, v97, v94
    v_lshlrev_b32 v111, 16, v97
    v_lshlrev_b32 v110, 16, v96
    ds_write_b64 v2, v[110:111]
    v_sub_u32 v96, v114, v96
    v_sub_u32 v97, v114, v97
    v_add_u32 v97, s48, v97
    s_add_u32 s50, s50, s84
    s_mov_b32 s28, s82
    s_mov_b32 s29, s83
    s_mov_b32 s30, s84
    s_lshl_b32 s74, s29, 3
    s_lshl_b32 s75, s30, 3
    v_mov_b32 v125, s74
    v_mov_b32 v126, s75
    v_mov_b32 v127, -1

    s_waitcnt lgkmcnt(0)
    s_barrier

    s_mov_b64 exec, 1
    ds_write_b32 v125, v127 offset:16396
    ds_write_b32 v126, v127 offset:16404
    s_mov_b64 exec, -1

    buffer_load_dwordx4 v[24:27], v1, s[12:15], s57 offen nt
    buffer_load_dwordx4 v[8:11], v1, s[8:11], s57 offen nt
    buffer_load_dwordx2 v[38:39], v2, s[16:19], s62 offen nt
    s_bitcmp0_b32 s28, 0
    s_cbranch_scc1 L_skz_37
    v_lshrrev_b32 v110, 16, v45
    ds_read_b32 v110, v110
    v_lshrrev_b32 v111, 16, v47
    ds_read_b32 v111, v111
    v_lshrrev_b32 v112, 16, v49
    ds_read_b32 v112, v112
    v_lshrrev_b32 v113, 16, v51
    ds_read_b32 v113, v113
    v_lshrrev_b32 v114, 16, v53
    ds_read_b32 v114, v114
    v_lshrrev_b32 v115, 16, v55
    ds_read_b32 v115, v115
    v_lshrrev_b32 v116, 16, v57
    ds_read_b32 v116, v116
    v_lshrrev_b32 v117, 16, v59
    ds_read_b32 v117, v117
    s_waitcnt lgkmcnt(7)
    v_add_u32_sdwa v110, v110, v76 dst_sel:DWORD dst_unused:UNUSED_PAD src0_sel:WORD_1 src1_sel:WORD_0
    v_lshlrev_b32 v110, 3, v110
    ds_write_b64 v110, v[44:45] offset:16400

    s_waitcnt lgkmcnt(7)
    v_add_u32_sdwa v111, v111, v77 dst_sel:DWORD dst_unused:UNUSED_PAD src0_sel:WORD_1 src1_sel:WORD_0
    v_lshlrev_b32 v111, 3, v111
    ds_write_b64 v111, v[46:47] offset:16400

    s_waitcnt lgkmcnt(7)
    v_add_u32_sdwa v112, v112, v78 dst_sel:DWORD dst_unused:UNUSED_PAD src0_sel:WORD_1 src1_sel:WORD_0
    v_lshlrev_b32 v112, 3, v112
    ds_write_b64 v112, v[48:49] offset:16400

    s_waitcnt lgkmcnt(7)
    v_add_u32_sdwa v113, v113, v79 dst_sel:DWORD dst_unused:UNUSED_PAD src0_sel:WORD_1 src1_sel:WORD_0
    v_lshlrev_b32 v113, 3, v113
    ds_write_b64 v113, v[50:51] offset:16400

    s_waitcnt lgkmcnt(7)
    v_add_u32_sdwa v114, v114, v80 dst_sel:DWORD dst_unused:UNUSED_PAD src0_sel:WORD_1 src1_sel:WORD_0
    v_lshlrev_b32 v114, 3, v114
    ds_write_b64 v114, v[52:53] offset:16400

    s_waitcnt lgkmcnt(7)
    v_add_u32_sdwa v115, v115, v81 dst_sel:DWORD dst_unused:UNUSED_PAD src0_sel:WORD_1 src1_sel:WORD_0
    v_lshlrev_b32 v115, 3, v115
    ds_write_b64 v115, v[54:55] offset:16400

    s_waitcnt lgkmcnt(7)
    v_add_u32_sdwa v116, v116, v82 dst_sel:DWORD dst_unused:UNUSED_PAD src0_sel:WORD_1 src1_sel:WORD_0
    v_lshlrev_b32 v116, 3, v116
    ds_write_b64 v116, v[56:57] offset:16400

    s_waitcnt lgkmcnt(7)
    v_add_u32_sdwa v117, v117, v83 dst_sel:DWORD dst_unused:UNUSED_PAD src0_sel:WORD_1 src1_sel:WORD_0
    v_lshlrev_b32 v117, 3, v117
    ds_write_b64 v117, v[58:59] offset:16400

L_skz_37:
    buffer_load_dwordx4 v[28:31], v1, s[12:15], s58 offen nt
    buffer_load_dwordx4 v[12:15], v1, s[8:11], s58 offen nt
    buffer_load_dwordx2 v[40:41], v2, s[16:19], s63 offen nt
    s_bitcmp0_b32 s28, 2
    s_cbranch_scc1 L_skz_38
    v_lshrrev_b32 v110, 16, v61
    ds_read_b32 v110, v110
    v_lshrrev_b32 v111, 16, v63
    ds_read_b32 v111, v111
    v_lshrrev_b32 v112, 16, v65
    ds_read_b32 v112, v112
    v_lshrrev_b32 v113, 16, v67
    ds_read_b32 v113, v113
    s_waitcnt lgkmcnt(3)
    v_add_u32_sdwa v110, v110, v84 dst_sel:DWORD dst_unused:UNUSED_PAD src0_sel:WORD_1 src1_sel:WORD_0
    v_lshlrev_b32 v110, 3, v110
    ds_write_b64 v110, v[60:61] offset:16400

    s_waitcnt lgkmcnt(3)
    v_add_u32_sdwa v111, v111, v85 dst_sel:DWORD dst_unused:UNUSED_PAD src0_sel:WORD_1 src1_sel:WORD_0
    v_lshlrev_b32 v111, 3, v111
    ds_write_b64 v111, v[62:63] offset:16400

    s_waitcnt lgkmcnt(3)
    v_add_u32_sdwa v112, v112, v86 dst_sel:DWORD dst_unused:UNUSED_PAD src0_sel:WORD_1 src1_sel:WORD_0
    v_lshlrev_b32 v112, 3, v112
    ds_write_b64 v112, v[64:65] offset:16400

    s_waitcnt lgkmcnt(3)
    v_add_u32_sdwa v113, v113, v87 dst_sel:DWORD dst_unused:UNUSED_PAD src0_sel:WORD_1 src1_sel:WORD_0
    v_lshlrev_b32 v113, 3, v113
    ds_write_b64 v113, v[66:67] offset:16400

L_skz_38:
    s_bitcmp0_b32 s28, 3
    s_cbranch_scc1 L_skz_39
    s_mov_b64 exec, s[66:67]
    v_lshrrev_b32 v110, 16, v69
    ds_read_b32 v110, v110
    v_lshrrev_b32 v111, 16, v71
    ds_read_b32 v111, v111
    v_lshrrev_b32 v112, 16, v73
    ds_read_b32 v112, v112
    v_lshrrev_b32 v113, 16, v75
    ds_read_b32 v113, v113
    s_waitcnt lgkmcnt(3)
    v_add_u32_sdwa v110, v110, v88 dst_sel:DWORD dst_unused:UNUSED_PAD src0_sel:WORD_1 src1_sel:WORD_0
    v_lshlrev_b32 v110, 3, v110
    ds_write_b64 v110, v[68:69] offset:16400

    s_waitcnt lgkmcnt(3)
    v_add_u32_sdwa v111, v111, v89 dst_sel:DWORD dst_unused:UNUSED_PAD src0_sel:WORD_1 src1_sel:WORD_0
    v_lshlrev_b32 v111, 3, v111
    ds_write_b64 v111, v[70:71] offset:16400

    s_waitcnt lgkmcnt(3)
    v_add_u32_sdwa v112, v112, v90 dst_sel:DWORD dst_unused:UNUSED_PAD src0_sel:WORD_1 src1_sel:WORD_0
    v_lshlrev_b32 v112, 3, v112
    ds_write_b64 v112, v[72:73] offset:16400

    s_waitcnt lgkmcnt(3)
    v_add_u32_sdwa v113, v113, v91 dst_sel:DWORD dst_unused:UNUSED_PAD src0_sel:WORD_1 src1_sel:WORD_0
    v_lshlrev_b32 v113, 3, v113
    ds_write_b64 v113, v[74:75] offset:16400

    s_mov_b64 exec, -1
L_skz_39:
    buffer_load_dwordx4 v[32:35], v1, s[12:15], s59 offen nt
    buffer_load_dwordx4 v[16:19], v1, s[8:11], s59 offen nt
    buffer_load_dwordx2 v[42:43], v2, s[16:19], s64 offen nt
    s_cmp_lg_u32 s49, 0
    s_cbranch_scc1 L_p1loop_5
L_p1epi_6:
    s_waitcnt vmcnt(0)
    s_waitcnt vmcnt(9)
    v_add_u32 v110, v92, v94
    v_min_u32 v92, s48, v92
    v_add_u32 v111, v93, v95
    v_min_u32 v93, s48, v93
    v_max_u32 v110, v110, v111
    v_add_u32 v92, v92, v96
    v_add_u32 v93, v93, v97
    v_cmp_le_u32 vcc, s48, v110
    v_lshl_add_u32 v92, v92, 2, v92
    v_lshl_add_u32 v93, v93, 2, v93
    ds_write_b64 v2, v[92:93] offset:8192
    s_cbranch_vccz L_noov_40
    ds_write_b32 v108, v104 offset:4
L_noov_40:

    s_waitcnt lgkmcnt(0)
    s_barrier
    ds_read_b32 v110, v108 offset:4
    s_waitcnt lgkmcnt(0)
    v_readfirstlane_b32 s53, v110
    s_nop 1

    s_cmp_lg_u32 s53, 0
    s_cbranch_scc1 L_slow_41
L_sback_42:
    s_bitcmp0_b32 s28, 0
    s_cbranch_scc1 L_skw_46
    ds_read_b64 v[4:5], v2 offset:16400
    ds_read_b64 v[6:7], v2 offset:16408
    ds_read_b64 v[8:9], v2 offset:16392

    ds_read_b64 v[12:13], v2 offset:24592
    ds_read_b64 v[14:15], v2 offset:24600
    ds_read_b64 v[16:17], v2 offset:24584

    ds_read_b64 v[20:21], v2 offset:32784
    ds_read_b64 v[22:23], v2 offset:32792
    ds_read_b64 v[24:25], v2 offset:32776

    ds_read_b64 v[28:29], v2 offset:40976
    ds_read_b64 v[30:31], v2 offset:40984
    ds_read_b64 v[32:33], v2 offset:40968

    s_waitcnt lgkmcnt(9)
    v_lshrrev_b32 v10, 16, v5
    ds_read_b32 v10, v10 offset:8192

    s_waitcnt lgkmcnt(7)
    v_lshrrev_b32 v18, 16, v13
    ds_read_b32 v18, v18 offset:8192

    s_waitcnt lgkmcnt(5)
    v_lshrrev_b32 v26, 16, v21
    ds_read_b32 v26, v26 offset:8192

    s_waitcnt lgkmcnt(3)
    v_lshrrev_b32 v34, 16, v29
    ds_read_b32 v34, v34 offset:8192

    v_cmp_ne_u32_sdwa s[80:81], v5, v7 src0_sel:WORD_1 src1_sel:WORD_1
    v_cmp_ne_u32_sdwa vcc, v5, v9 src0_sel:WORD_1 src1_sel:WORD_1
    v_alignbyte_b32 v8, v9, v8, 2
    s_mov_b32 s54, -3
    v_alignbyte_b32 v5, v5, v4, 1
    v_perm_b32 v4, v4, v8, s47
    s_waitcnt lgkmcnt(3)
    v_add3_u32 v10, v10, v106, s54
    v_sub_u32 v11, 0, v10
    v_and_b32 v11, 3, v11
    s_mov_b64 exec, s[80:81]
    v_mov_b32 v11, 0
    v_mov_b32 v6, 0
    s_mov_b64 exec, vcc
    v_mov_b32 v11, 3

    s_mov_b64 exec, -1
    v_alignbyte_b32 v4, v5, v4, v11
    v_alignbyte_b32 v5, v6, v5, v11
    v_add_u32 v10, v10, v11

    buffer_store_dwordx2 v[4:5], v10, s[24:27], 0 offen
    v_cmp_ne_u32_sdwa s[80:81], v13, v15 src0_sel:WORD_1 src1_sel:WORD_1
    v_cmp_ne_u32_sdwa vcc, v13, v17 src0_sel:WORD_1 src1_sel:WORD_1
    v_alignbyte_b32 v16, v17, v16, 2
    s_mov_b32 s54, 5117
    v_alignbyte_b32 v13, v13, v12, 1
    v_perm_b32 v12, v12, v16, s47
    s_waitcnt lgkmcnt(2)
    v_add3_u32 v18, v18, v106, s54
    v_sub_u32 v19, 0, v18
    v_and_b32 v19, 3, v19
    s_mov_b64 exec, s[80:81]
    v_mov_b32 v19, 0
    v_mov_b32 v14, 0
    s_mov_b64 exec, vcc
    v_mov_b32 v19, 3

    s_mov_b64 exec, -1
    v_alignbyte_b32 v12, v13, v12, v19
    v_alignbyte_b32 v13, v14, v13, v19
    v_add_u32 v18, v18, v19

    buffer_store_dwordx2 v[12:13], v18, s[24:27], 0 offen
    v_cmp_ne_u32_sdwa s[80:81], v21, v23 src0_sel:WORD_1 src1_sel:WORD_1
    v_cmp_ne_u32_sdwa vcc, v21, v25 src0_sel:WORD_1 src1_sel:WORD_1
    v_alignbyte_b32 v24, v25, v24, 2
    s_mov_b32 s54, 10237
    v_alignbyte_b32 v21, v21, v20, 1
    v_perm_b32 v20, v20, v24, s47
    s_waitcnt lgkmcnt(1)
    v_add3_u32 v26, v26, v106, s54
    v_sub_u32 v27, 0, v26
    v_and_b32 v27, 3, v27
    s_mov_b64 exec, s[80:81]
    v_mov_b32 v27, 0
    v_mov_b32 v22, 0
    s_mov_b64 exec, vcc
    v_mov_b32 v27, 3

    s_mov_b64 exec, -1
    v_alignbyte_b32 v20, v21, v20, v27
    v_alignbyte_b32 v21, v22, v21, v27
    v_add_u32 v26, v26, v27

    buffer_store_dwordx2 v[20:21], v26, s[24:27], 0 offen
    v_cmp_ne_u32_sdwa s[80:81], v29, v31 src0_sel:WORD_1 src1_sel:WORD_1
    v_cmp_ne_u32_sdwa vcc, v29, v33 src0_sel:WORD_1 src1_sel:WORD_1
    v_alignbyte_b32 v32, v33, v32, 2
    s_mov_b32 s54, 15357
    v_alignbyte_b32 v29, v29, v28, 1
    v_perm_b32 v28, v28, v32, s47
    s_waitcnt lgkmcnt(0)
    v_add3_u32 v34, v34, v106, s54
    v_sub_u32 v35, 0, v34
    v_and_b32 v35, 3, v35
    s_mov_b64 exec, s[80:81]
    v_mov_b32 v35, 0
    v_mov_b32 v30, 0
    s_mov_b64 exec, vcc
    v_mov_b32 v35, 3

    s_mov_b64 exec, -1
    v_alignbyte_b32 v28, v29, v28, v35
    v_alignbyte_b32 v29, v30, v29, v35
    v_add_u32 v34, v34, v35

    buffer_store_dwordx2 v[28:29], v34, s[24:27], 0 offen
L_skw_46:
    s_bitcmp0_b32 s28, 1
    s_cbranch_scc1 L_skw_47
    v_add_u32 v107, 32768, v2
    ds_read_b64 v[4:5], v107 offset:16400
    ds_read_b64 v[6:7], v107 offset:16408
    ds_read_b64 v[8:9], v107 offset:16392

    ds_read_b64 v[12:13], v107 offset:24592
    ds_read_b64 v[14:15], v107 offset:24600
    ds_read_b64 v[16:17], v107 offset:24584

    ds_read_b64 v[20:21], v107 offset:32784
    ds_read_b64 v[22:23], v107 offset:32792
    ds_read_b64 v[24:25], v107 offset:32776

    ds_read_b64 v[28:29], v107 offset:40976
    ds_read_b64 v[30:31], v107 offset:40984
    ds_read_b64 v[32:33], v107 offset:40968

    s_waitcnt lgkmcnt(9)
    v_lshrrev_b32 v10, 16, v5
    ds_read_b32 v10, v10 offset:8192

    s_waitcnt lgkmcnt(7)
    v_lshrrev_b32 v18, 16, v13
    ds_read_b32 v18, v18 offset:8192

    s_waitcnt lgkmcnt(5)
    v_lshrrev_b32 v26, 16, v21
    ds_read_b32 v26, v26 offset:8192

    s_waitcnt lgkmcnt(3)
    v_lshrrev_b32 v34, 16, v29
    ds_read_b32 v34, v34 offset:8192

    v_cmp_ne_u32_sdwa s[80:81], v5, v7 src0_sel:WORD_1 src1_sel:WORD_1
    v_cmp_ne_u32_sdwa vcc, v5, v9 src0_sel:WORD_1 src1_sel:WORD_1
    v_alignbyte_b32 v8, v9, v8, 2
    s_mov_b32 s54, 20477
    v_alignbyte_b32 v5, v5, v4, 1
    v_perm_b32 v4, v4, v8, s47
    s_waitcnt lgkmcnt(3)
    v_add3_u32 v10, v10, v106, s54
    v_sub_u32 v11, 0, v10
    v_and_b32 v11, 3, v11
    s_mov_b64 exec, s[80:81]
    v_mov_b32 v11, 0
    v_mov_b32 v6, 0
    s_mov_b64 exec, vcc
    v_mov_b32 v11, 3

    s_mov_b64 exec, -1
    v_alignbyte_b32 v4, v5, v4, v11
    v_alignbyte_b32 v5, v6, v5, v11
    v_add_u32 v10, v10, v11

    buffer_store_dwordx2 v[4:5], v10, s[24:27], 0 offen
    v_cmp_ne_u32_sdwa s[80:81], v13, v15 src0_sel:WORD_1 src1_sel:WORD_1
    v_cmp_ne_u32_sdwa vcc, v13, v17 src0_sel:WORD_1 src1_sel:WORD_1
    v_alignbyte_b32 v16, v17, v16, 2
    s_mov_b32 s54, 25597
    v_alignbyte_b32 v13, v13, v12, 1
    v_perm_b32 v12, v12, v16, s47
    s_waitcnt lgkmcnt(2)
    v_add3_u32 v18, v18, v106, s54
    v_sub_u32 v19, 0, v18
    v_and_b32 v19, 3, v19
    s_mov_b64 exec, s[80:81]
    v_mov_b32 v19, 0
    v_mov_b32 v14, 0
    s_mov_b64 exec, vcc
    v_mov_b32 v19, 3

    s_mov_b64 exec, -1
    v_alignbyte_b32 v12, v13, v12, v19
    v_alignbyte_b32 v13, v14, v13, v19
    v_add_u32 v18, v18, v19

    buffer_store_dwordx2 v[12:13], v18, s[24:27], 0 offen
    v_cmp_ne_u32_sdwa s[80:81], v21, v23 src0_sel:WORD_1 src1_sel:WORD_1
    v_cmp_ne_u32_sdwa vcc, v21, v25 src0_sel:WORD_1 src1_sel:WORD_1
    v_alignbyte_b32 v24, v25, v24, 2
    s_mov_b32 s54, 30717
    v_alignbyte_b32 v21, v21, v20, 1
    v_perm_b32 v20, v20, v24, s47
    s_waitcnt lgkmcnt(1)
    v_add3_u32 v26, v26, v106, s54
    v_sub_u32 v27, 0, v26
    v_and_b32 v27, 3, v27
    s_mov_b64 exec, s[80:81]
    v_mov_b32 v27, 0
    v_mov_b32 v22, 0
    s_mov_b64 exec, vcc
    v_mov_b32 v27, 3

    s_mov_b64 exec, -1
    v_alignbyte_b32 v20, v21, v20, v27
    v_alignbyte_b32 v21, v22, v21, v27
    v_add_u32 v26, v26, v27

    buffer_store_dwordx2 v[20:21], v26, s[24:27], 0 offen
    v_cmp_ne_u32_sdwa s[80:81], v29, v31 src0_sel:WORD_1 src1_sel:WORD_1
    v_cmp_ne_u32_sdwa vcc, v29, v33 src0_sel:WORD_1 src1_sel:WORD_1
    v_alignbyte_b32 v32, v33, v32, 2
    s_mov_b32 s54, 35837
    v_alignbyte_b32 v29, v29, v28, 1
    v_perm_b32 v28, v28, v32, s47
    s_waitcnt lgkmcnt(0)
    v_add3_u32 v34, v34, v106, s54
    v_sub_u32 v35, 0, v34
    v_and_b32 v35, 3, v35
    s_mov_b64 exec, s[80:81]
    v_mov_b32 v35, 0
    v_mov_b32 v30, 0
    s_mov_b64 exec, vcc
    v_mov_b32 v35, 3

    s_mov_b64 exec, -1
    v_alignbyte_b32 v28, v29, v28, v35
    v_alignbyte_b32 v29, v30, v29, v35
    v_add_u32 v34, v34, v35

    buffer_store_dwordx2 v[28:29], v34, s[24:27], 0 offen
L_skw_47:
    s_bitcmp0_b32 s28, 2
    s_cbranch_scc1 L_skw_48
    v_add_u32 v107, 65536, v2
    ds_read_b64 v[4:5], v107 offset:16400
    ds_read_b64 v[6:7], v107 offset:16408
    ds_read_b64 v[8:9], v107 offset:16392

    ds_read_b64 v[12:13], v107 offset:24592
    ds_read_b64 v[14:15], v107 offset:24600
    ds_read_b64 v[16:17], v107 offset:24584

    ds_read_b64 v[20:21], v107 offset:32784
    ds_read_b64 v[22:23], v107 offset:32792
    ds_read_b64 v[24:25], v107 offset:32776

    ds_read_b64 v[28:29], v107 offset:40976
    ds_read_b64 v[30:31], v107 offset:40984
    ds_read_b64 v[32:33], v107 offset:40968

    s_waitcnt lgkmcnt(9)
    v_lshrrev_b32 v10, 16, v5
    ds_read_b32 v10, v10 offset:8192

    s_waitcnt lgkmcnt(7)
    v_lshrrev_b32 v18, 16, v13
    ds_read_b32 v18, v18 offset:8192

    s_waitcnt lgkmcnt(5)
    v_lshrrev_b32 v26, 16, v21
    ds_read_b32 v26, v26 offset:8192

    s_waitcnt lgkmcnt(3)
    v_lshrrev_b32 v34, 16, v29
    ds_read_b32 v34, v34 offset:8192

    v_cmp_ne_u32_sdwa s[80:81], v5, v7 src0_sel:WORD_1 src1_sel:WORD_1
    v_cmp_ne_u32_sdwa vcc, v5, v9 src0_sel:WORD_1 src1_sel:WORD_1
    v_alignbyte_b32 v8, v9, v8, 2
    s_mov_b32 s54, 40957
    v_alignbyte_b32 v5, v5, v4, 1
    v_perm_b32 v4, v4, v8, s47
    s_waitcnt lgkmcnt(3)
    v_add3_u32 v10, v10, v106, s54
    v_sub_u32 v11, 0, v10
    v_and_b32 v11, 3, v11
    s_mov_b64 exec, s[80:81]
    v_mov_b32 v11, 0
    v_mov_b32 v6, 0
    s_mov_b64 exec, vcc
    v_mov_b32 v11, 3

    s_mov_b64 exec, -1
    v_alignbyte_b32 v4, v5, v4, v11
    v_alignbyte_b32 v5, v6, v5, v11
    v_add_u32 v10, v10, v11

    buffer_store_dwordx2 v[4:5], v10, s[24:27], 0 offen
    v_cmp_ne_u32_sdwa s[80:81], v13, v15 src0_sel:WORD_1 src1_sel:WORD_1
    v_cmp_ne_u32_sdwa vcc, v13, v17 src0_sel:WORD_1 src1_sel:WORD_1
    v_alignbyte_b32 v16, v17, v16, 2
    s_mov_b32 s54, 46077
    v_alignbyte_b32 v13, v13, v12, 1
    v_perm_b32 v12, v12, v16, s47
    s_waitcnt lgkmcnt(2)
    v_add3_u32 v18, v18, v106, s54
    v_sub_u32 v19, 0, v18
    v_and_b32 v19, 3, v19
    s_mov_b64 exec, s[80:81]
    v_mov_b32 v19, 0
    v_mov_b32 v14, 0
    s_mov_b64 exec, vcc
    v_mov_b32 v19, 3

    s_mov_b64 exec, -1
    v_alignbyte_b32 v12, v13, v12, v19
    v_alignbyte_b32 v13, v14, v13, v19
    v_add_u32 v18, v18, v19

    buffer_store_dwordx2 v[12:13], v18, s[24:27], 0 offen
    v_cmp_ne_u32_sdwa s[80:81], v21, v23 src0_sel:WORD_1 src1_sel:WORD_1
    v_cmp_ne_u32_sdwa vcc, v21, v25 src0_sel:WORD_1 src1_sel:WORD_1
    v_alignbyte_b32 v24, v25, v24, 2
    s_mov_b32 s54, 51197
    v_alignbyte_b32 v21, v21, v20, 1
    v_perm_b32 v20, v20, v24, s47
    s_waitcnt lgkmcnt(1)
    v_add3_u32 v26, v26, v106, s54
    v_sub_u32 v27, 0, v26
    v_and_b32 v27, 3, v27
    s_mov_b64 exec, s[80:81]
    v_mov_b32 v27, 0
    v_mov_b32 v22, 0
    s_mov_b64 exec, vcc
    v_mov_b32 v27, 3

    s_mov_b64 exec, -1
    v_alignbyte_b32 v20, v21, v20, v27
    v_alignbyte_b32 v21, v22, v21, v27
    v_add_u32 v26, v26, v27

    buffer_store_dwordx2 v[20:21], v26, s[24:27], 0 offen
    v_cmp_ne_u32_sdwa s[80:81], v29, v31 src0_sel:WORD_1 src1_sel:WORD_1
    v_cmp_ne_u32_sdwa vcc, v29, v33 src0_sel:WORD_1 src1_sel:WORD_1
    v_alignbyte_b32 v32, v33, v32, 2
    s_mov_b32 s54, 56317
    v_alignbyte_b32 v29, v29, v28, 1
    v_perm_b32 v28, v28, v32, s47
    s_waitcnt lgkmcnt(0)
    v_add3_u32 v34, v34, v106, s54
    v_sub_u32 v35, 0, v34
    v_and_b32 v35, 3, v35
    s_mov_b64 exec, s[80:81]
    v_mov_b32 v35, 0
    v_mov_b32 v30, 0
    s_mov_b64 exec, vcc
    v_mov_b32 v35, 3

    s_mov_b64 exec, -1
    v_alignbyte_b32 v28, v29, v28, v35
    v_alignbyte_b32 v29, v30, v29, v35
    v_add_u32 v34, v34, v35

    buffer_store_dwordx2 v[28:29], v34, s[24:27], 0 offen
L_skw_48:
    s_bitcmp0_b32 s28, 3
    s_cbranch_scc1 L_skw_49
    v_add_u32 v107, 98304, v2
    ds_read_b64 v[4:5], v107 offset:16400
    ds_read_b64 v[6:7], v107 offset:16408
    ds_read_b64 v[8:9], v107 offset:16392

    ds_read_b64 v[12:13], v107 offset:24592
    ds_read_b64 v[14:15], v107 offset:24600
    ds_read_b64 v[16:17], v107 offset:24584

    ds_read_b64 v[20:21], v107 offset:32784
    ds_read_b64 v[22:23], v107 offset:32792
    ds_read_b64 v[24:25], v107 offset:32776

    ds_read_b64 v[28:29], v107 offset:40976
    ds_read_b64 v[30:31], v107 offset:40984
    ds_read_b64 v[32:33], v107 offset:40968

    s_waitcnt lgkmcnt(9)
    v_lshrrev_b32 v10, 16, v5
    ds_read_b32 v10, v10 offset:8192

    s_waitcnt lgkmcnt(7)
    v_lshrrev_b32 v18, 16, v13
    ds_read_b32 v18, v18 offset:8192

    s_waitcnt lgkmcnt(5)
    v_lshrrev_b32 v26, 16, v21
    ds_read_b32 v26, v26 offset:8192

    s_waitcnt lgkmcnt(3)
    v_lshrrev_b32 v34, 16, v29
    ds_read_b32 v34, v34 offset:8192

    v_cmp_ne_u32_sdwa s[80:81], v5, v7 src0_sel:WORD_1 src1_sel:WORD_1
    v_cmp_ne_u32_sdwa vcc, v5, v9 src0_sel:WORD_1 src1_sel:WORD_1
    v_alignbyte_b32 v8, v9, v8, 2
    s_mov_b32 s54, 61437
    v_alignbyte_b32 v5, v5, v4, 1
    v_perm_b32 v4, v4, v8, s47
    s_waitcnt lgkmcnt(3)
    v_add3_u32 v10, v10, v106, s54
    v_sub_u32 v11, 0, v10
    v_and_b32 v11, 3, v11
    s_mov_b64 exec, s[80:81]
    v_mov_b32 v11, 0
    v_mov_b32 v6, 0
    s_mov_b64 exec, vcc
    v_mov_b32 v11, 3

    s_mov_b64 exec, -1
    v_alignbyte_b32 v4, v5, v4, v11
    v_alignbyte_b32 v5, v6, v5, v11
    v_add_u32 v10, v10, v11

    buffer_store_dwordx2 v[4:5], v10, s[24:27], 0 offen
    v_cmp_ne_u32_sdwa s[80:81], v13, v15 src0_sel:WORD_1 src1_sel:WORD_1
    v_cmp_ne_u32_sdwa vcc, v13, v17 src0_sel:WORD_1 src1_sel:WORD_1
    v_alignbyte_b32 v16, v17, v16, 2
    s_mov_b32 s54, 66557
    v_alignbyte_b32 v13, v13, v12, 1
    v_perm_b32 v12, v12, v16, s47
    s_waitcnt lgkmcnt(2)
    v_add3_u32 v18, v18, v106, s54
    v_sub_u32 v19, 0, v18
    v_and_b32 v19, 3, v19
    s_mov_b64 exec, s[80:81]
    v_mov_b32 v19, 0
    v_mov_b32 v14, 0
    s_mov_b64 exec, vcc
    v_mov_b32 v19, 3

    s_mov_b64 exec, -1
    v_alignbyte_b32 v12, v13, v12, v19
    v_alignbyte_b32 v13, v14, v13, v19
    v_add_u32 v18, v18, v19

    buffer_store_dwordx2 v[12:13], v18, s[24:27], 0 offen
    v_cmp_ne_u32_sdwa s[80:81], v21, v23 src0_sel:WORD_1 src1_sel:WORD_1
    v_cmp_ne_u32_sdwa vcc, v21, v25 src0_sel:WORD_1 src1_sel:WORD_1
    v_alignbyte_b32 v24, v25, v24, 2
    s_mov_b32 s54, 71677
    v_alignbyte_b32 v21, v21, v20, 1
    v_perm_b32 v20, v20, v24, s47
    s_waitcnt lgkmcnt(1)
    v_add3_u32 v26, v26, v106, s54
    v_sub_u32 v27, 0, v26
    v_and_b32 v27, 3, v27
    s_mov_b64 exec, s[80:81]
    v_mov_b32 v27, 0
    v_mov_b32 v22, 0
    s_mov_b64 exec, vcc
    v_mov_b32 v27, 3

    s_mov_b64 exec, -1
    v_alignbyte_b32 v20, v21, v20, v27
    v_alignbyte_b32 v21, v22, v21, v27
    v_add_u32 v26, v26, v27

    buffer_store_dwordx2 v[20:21], v26, s[24:27], 0 offen
    v_cmp_ne_u32_sdwa s[80:81], v29, v31 src0_sel:WORD_1 src1_sel:WORD_1
    v_cmp_ne_u32_sdwa vcc, v29, v33 src0_sel:WORD_1 src1_sel:WORD_1
    v_alignbyte_b32 v32, v33, v32, 2
    s_mov_b32 s54, 76797
    v_alignbyte_b32 v29, v29, v28, 1
    v_perm_b32 v28, v28, v32, s47
    s_waitcnt lgkmcnt(0)
    v_add3_u32 v34, v34, v106, s54
    v_sub_u32 v35, 0, v34
    v_and_b32 v35, 3, v35
    s_mov_b64 exec, s[80:81]
    v_mov_b32 v35, 0
    v_mov_b32 v30, 0
    s_mov_b64 exec, vcc
    v_mov_b32 v35, 3

    s_andn2_b64 exec, -1, s[68:69]
    v_bfrev_b32 v34, 1
    s_mov_b64 exec, -1
    v_alignbyte_b32 v28, v29, v28, v35
    v_alignbyte_b32 v29, v30, v29, v35
    v_add_u32 v34, v34, v35

    buffer_store_dwordx2 v[28:29], v34, s[24:27], 0 offen
L_skw_49:
L_p1done_1:
    s_endpgm

L_slow_22:
    v_add_u32 v112, s29, v0
    v_mov_b32 v118, 0
    s_mov_b32 s75, 4960
L_sl_24:
    v_lshlrev_b32 v113, 3, v112
    ds_read_b64 v[110:111], v113 offset:16400
    ds_read_b32 v119, v113 offset:16412
    ds_read_b32 v120, v113 offset:16396
    s_waitcnt lgkmcnt(0)
    v_lshrrev_b32 v114, 16, v111
    ds_read_b32 v115, v114 offset:8192
    v_add_u32 v114, 4, v114
    v_mul_u32_u24 v114, s75, v114
    s_waitcnt lgkmcnt(0)
    v_mad_u32_u24 v115, v112, 5, v115
    v_cmp_gt_u32 s[72:73], s30, v112
    v_cmp_ge_u32 vcc, v115, v114
    s_and_b64 s[80:81], vcc, s[72:73]
    s_cbranch_scc0 L_s1_25
    s_bcnt1_i32_b64 s76, s[80:81]
    v_mbcnt_lo_u32_b32 v117, s80, 0
    v_mbcnt_hi_u32_b32 v117, s81, v117
    v_mov_b32 v116, s76
    s_mov_b64 exec, 1
    buffer_atomic_add v116, v118, s[36:39], 0 offen sc0
    s_waitcnt vmcnt(0)
    v_readfirstlane_b32 s76, v116
    s_mov_b64 exec, s[80:81]
    s_nop 0
    v_add_lshl_u32 v116, v117, s76, 3
    buffer_store_dwordx2 v[110:111], v116, s[32:35], 0 offen
L_s1_25:
    s_andn2_b64 exec, s[72:73], vcc
    s_cbranch_execz L_s2_26
    buffer_store_dword v110, v115, s[24:27], 0 offen
    buffer_store_byte v111, v115, s[24:27], 0 offen offset:4
    v_add_u32 v115, 5, v115
    v_cmpx_lt_u32 vcc, v115, v114
    v_cmpx_ne_u32_sdwa vcc, v111, v119 src0_sel:WORD_1 src1_sel:WORD_1
    v_cmpx_ne_u32_sdwa vcc, v111, v120 src0_sel:WORD_1 src1_sel:WORD_1
    s_cbranch_execz L_s2_26
    buffer_store_dword v118, v115, s[24:27], 0 offen
L_s2_26:
    s_mov_b64 exec, -1
    v_add_u32 v112, 1024, v112
    s_nop 0
    v_readfirstlane_b32 s76, v112
    s_nop 1
    s_cmp_lt_u32 s76, s30
    s_cbranch_scc1 L_sl_24
    s_mov_b32 s28, 0
    s_branch L_sback_23

L_slow_41:
    v_add_u32 v112, s29, v0
    v_mov_b32 v118, 0
    s_mov_b32 s75, 4960
L_sl_43:
    v_lshlrev_b32 v113, 3, v112
    ds_read_b64 v[110:111], v113 offset:16400
    ds_read_b32 v119, v113 offset:16412
    ds_read_b32 v120, v113 offset:16396
    s_waitcnt lgkmcnt(0)
    v_lshrrev_b32 v114, 16, v111
    ds_read_b32 v115, v114 offset:8192
    v_add_u32 v114, 4, v114
    v_mul_u32_u24 v114, s75, v114
    s_waitcnt lgkmcnt(0)
    v_mad_u32_u24 v115, v112, 5, v115
    v_cmp_gt_u32 s[72:73], s30, v112
    v_cmp_ge_u32 vcc, v115, v114
    s_and_b64 s[80:81], vcc, s[72:73]
    s_cbranch_scc0 L_s1_44
    s_bcnt1_i32_b64 s76, s[80:81]
    v_mbcnt_lo_u32_b32 v117, s80, 0
    v_mbcnt_hi_u32_b32 v117, s81, v117
    v_mov_b32 v116, s76
    s_mov_b64 exec, 1
    buffer_atomic_add v116, v118, s[36:39], 0 offen sc0
    s_waitcnt vmcnt(0)
    v_readfirstlane_b32 s76, v116
    s_mov_b64 exec, s[80:81]
    s_nop 0
    v_add_lshl_u32 v116, v117, s76, 3
    buffer_store_dwordx2 v[110:111], v116, s[32:35], 0 offen
L_s1_44:
    s_andn2_b64 exec, s[72:73], vcc
    s_cbranch_execz L_s2_45
    buffer_store_dword v110, v115, s[24:27], 0 offen
    buffer_store_byte v111, v115, s[24:27], 0 offen offset:4
    v_add_u32 v115, 5, v115
    v_cmpx_lt_u32 vcc, v115, v114
    v_cmpx_ne_u32_sdwa vcc, v111, v119 src0_sel:WORD_1 src1_sel:WORD_1
    v_cmpx_ne_u32_sdwa vcc, v111, v120 src0_sel:WORD_1 src1_sel:WORD_1
    s_cbranch_execz L_s2_45
    buffer_store_dword v118, v115, s[24:27], 0 offen
L_s2_45:
    s_mov_b64 exec, -1
    v_add_u32 v112, 1024, v112
    s_nop 0
    v_readfirstlane_b32 s76, v112
    s_nop 1
    s_cmp_lt_u32 s76, s30
    s_cbranch_scc1 L_sl_43
    s_mov_b32 s28, 0
    s_branch L_sback_42

.globl standalone__molecular_angular_gemnet__graph_kernel
.p2align 8
.type standalone__molecular_angular_gemnet__graph_kernel,@function
standalone__molecular_angular_gemnet__graph_kernel:
    s_cmp_ge_u32 s2, 256
    s_cbranch_scc1 L_p2done_50
    s_load_dwordx2 s[8:9], s[0:1], 0
    s_load_dwordx2 s[6:7], s[0:1], 104
    v_lshrrev_b32 v4, 6, v0
    s_lshr_b32 s37, s2, 1
    s_and_b32 s37, s37, 3
    s_lshr_b32 s36, s2, 3
    s_lshl_b32 s36, s36, 1
    s_and_b32 s3, s2, 1
    s_or_b32 s36, s36, s3
    v_readfirstlane_b32 s4, v4
    v_and_b32 v2, 63, v0
    v_lshrrev_b32 v3, 9, v0
    v_lshl_or_b32 v2, v3, 6, v2
    v_mul_u32_u24 v2, 20, v2
    v_lshlrev_b32 v3, 4, v0
    s_waitcnt lgkmcnt(0)
    s_lshl_b32 m0, s4, 10
    s_and_b32 s5, s4, 7
    s_lshr_b32 s39, s4, 3
    s_lshl_b32 s39, s39, 8
    s_mul_i32 s3, s5, 8192
    s_add_u32 s46, s6, s3
    s_addc_u32 s47, s7, 0
    s_mul_i32 s3, s5, 40632320
    s_add_u32 s3, s3, 83599360
    s_add_u32 s44, s6, s3
    s_addc_u32 s45, s7, 0
    s_mul_i32 s38, s37, 8
    s_add_u32 s4, s38, 8
    s_lshl_b32 s3, s38, 6
    s_add_u32 s3, s3, s36
    s_lshl_b32 s3, s3, 2
    s_add_u32 s52, s46, s3
    s_addc_u32 s53, s47, 0

    s_load_dword s88, s[52:53], 0
    s_load_dword s89, s[52:53], 256
    s_load_dword s90, s[52:53], 512
    s_load_dword s91, s[52:53], 768
    s_load_dword s92, s[52:53], 1024
    s_load_dword s93, s[52:53], 1280
    s_load_dword s94, s[52:53], 1536
    s_load_dword s95, s[52:53], 1792
    s_mov_b32 s3, 65536
    s_load_dword s51, s[6:7], s3
    s_mov_b32 s10, 6400000
    s_mov_b32 s11, 0x20000

    s_add_u32 s12, s6, 393216
    s_addc_u32 s13, s7, 0
    s_mov_b32 s14, 0
    s_mov_b32 s15, 0x20000
    s_add_u32 s60, s6, 393216
    s_addc_u32 s61, s7, 0
    s_mov_b32 s62, 6406144
    s_mov_b32 s63, 0x20000
    s_mov_b32 s3, 135176
    s_load_dword s33, s[6:7], s3

    s_mul_i32 s43, s38, 200192
    s_mul_i32 s41, s4, 200192
    s_mul_i32 s50, s38, 200000
    s_add_u32 s14, s43, 50000

    buffer_load_dwordx4 v[76:79], v3, s[12:15], s43 offen
    s_add_u32 s52, s43, 16384
    buffer_load_dwordx4 v[80:83], v3, s[12:15], s52 offen
    s_add_u32 s52, s43, 32768
    buffer_load_dwordx4 v[84:87], v3, s[12:15], s52 offen
    s_add_u32 s52, s43, 49152
    v_lshlrev_b32 v119, 2, v0
    buffer_load_dword v88, v119, s[12:15], s52 offen
    s_add_u32 s20, s6, 135168
    s_addc_u32 s21, s7, 0
    s_mov_b32 s22, 4096
    s_mov_b32 s23, 0x20000
    v_and_b32 v44, 63, v0
    v_lshlrev_b32 v44, 4, v44
    buffer_load_dwordx2 v[120:121], v44, s[20:23], 0 offen offset:0
    buffer_load_dwordx2 v[122:123], v44, s[20:23], 0 offen offset:1024
    buffer_load_dwordx2 v[124:125], v44, s[20:23], 0 offen offset:2048
    buffer_load_dwordx2 v[126:127], v44, s[20:23], 0 offen offset:3072
    s_lshr_b32 s3, s2, 3
    s_mul_i32 s3, s3, 49
    v_add_lshl_u32 v89, v0, s3, 7
    v_cmp_gt_u32 vcc, 49, v0
    v_bfrev_b32 v28, 1
    s_nop 0
    v_cndmask_b32 v89, v28, v89, vcc

    s_mov_b32 s19, 0x20000
    s_mov_b32 s28, 0x4b404000
    s_mov_b32 s29, 0x4b404000
    s_mov_b32 s30, 0xbfffc000
    s_mov_b32 s31, 0xbfffbfff
    s_mov_b32 s32, 0xffff0000
    s_mov_b32 s35, 0x05040100
    s_mov_b32 s97, 0x07060302
    s_mov_b32 s96, 0x40008000
    s_movk_i32 s3, 212
    v_cmp_gt_u32 s[48:49], s3, v0

    v_mov_b32 v1, 0
    s_mov_b32 s24, 0xc0c0004
    s_mov_b32 s25, 0xc0c0105
    s_mov_b32 s26, 0xc0c0206
    s_mov_b32 s27, 0xc0c0307
    s_waitcnt lgkmcnt(0)
    s_min_u32 s88, s88, 3968
    s_lshl_b32 s52, s38, 6
    s_add_u32 s52, s52, s36
    s_mul_i32 s52, s52, 19840
    s_add_u32 s16, s44, s52
    s_addc_u32 s17, s45, 0
    s_mul_i32 s52, s88, 5
    s_add_u32 s52, s52, 3
    s_and_b32 s18, s52, -4

    s_movk_i32 s53, 5120
    buffer_load_dwordx4 v[90:93], v2, s[16:19], s53 offen
    buffer_load_dword v110, v2, s[16:19], s53 offen offset:16
    s_movk_i32 s53, 7680
    buffer_load_dwordx4 v[94:97], v2, s[16:19], s53 offen
    buffer_load_dword v111, v2, s[16:19], s53 offen offset:16
    s_movk_i32 s53, 10240
    buffer_load_dwordx4 v[98:101], v2, s[16:19], s53 offen
    buffer_load_dword v112, v2, s[16:19], s53 offen offset:16
    s_movk_i32 s53, 12800
    buffer_load_dwordx4 v[102:105], v2, s[16:19], s53 offen
    buffer_load_dword v113, v2, s[16:19], s53 offen offset:16
    s_movk_i32 s53, 0
    buffer_load_dwordx4 v[4:7], v2, s[16:19], s53 offen
    buffer_load_dword v35, v2, s[16:19], s53 offen offset:16
    s_movk_i32 s53, 2560
    buffer_load_dwordx4 v[8:11], v2, s[16:19], s53 offen
    buffer_load_dword v43, v2, s[16:19], s53 offen offset:16
    s_movk_i32 s53, 15360
    buffer_load_dwordx4 v[106:109], v2, s[16:19], s53 offen
    buffer_load_dword v114, v2, s[16:19], s53 offen offset:16
    v_mov_b32 v28, 0x40004000
    v_mov_b32 v29, 0x40004000
    v_mov_b32 v30, 0x40004000
    v_mov_b32 v31, 0x40004000
    v_add_u32 v32, 50000, v3
    v_add_u32 v33, 65536, v32

    ds_write_b128 v32, v[28:31] offset:0
    ds_write_b128 v32, v[28:31] offset:16384
    ds_write_b128 v32, v[28:31] offset:32768
    ds_write_b128 v32, v[28:31] offset:49152
    ds_write_b128 v33, v[28:31] offset:0
    ds_write_b128 v33, v[28:31] offset:16384
    v_cmp_gt_u32 vcc, 971, v0
    s_mov_b64 exec, vcc
    ds_write_b128 v33, v[28:31] offset:32768
    s_mov_b64 exec, -1
    s_waitcnt vmcnt(21)
    ds_write_addtid_b32 v76 offset:0
    ds_write_addtid_b32 v77 offset:256
    ds_write_addtid_b32 v78 offset:512
    ds_write_addtid_b32 v79 offset:768
    s_waitcnt vmcnt(20)
    ds_write_addtid_b32 v80 offset:16384
    ds_write_addtid_b32 v81 offset:16640
    ds_write_addtid_b32 v82 offset:16896
    ds_write_addtid_b32 v83 offset:17152
    s_waitcnt vmcnt(19)
    ds_write_addtid_b32 v84 offset:32768
    ds_write_addtid_b32 v85 offset:33024
    ds_write_addtid_b32 v86 offset:33280
    ds_write_addtid_b32 v87 offset:33536
    v_lshlrev_b32 v119, 2, v0
    s_waitcnt vmcnt(18)
    s_mov_b64 exec, s[48:49]
    ds_write_b32 v119, v88 offset:49152
    s_mov_b64 exec, -1
    s_add_u32 s43, s43, 50048
    s_add_u32 s14, s43, 50000
    s_min_u32 s14, s14, s41
    buffer_load_dwordx4 v[76:79], v3, s[12:15], s43 offen
    s_add_u32 s52, s43, 16384
    buffer_load_dwordx4 v[80:83], v3, s[12:15], s52 offen
    s_add_u32 s52, s43, 32768
    buffer_load_dwordx4 v[84:87], v3, s[12:15], s52 offen
    s_add_u32 s52, s43, 49152
    v_lshlrev_b32 v119, 2, v0
    buffer_load_dword v88, v119, s[12:15], s52 offen
    s_add_u32 s54, s43, 50048
    buffer_load_dword v115, v89, s[60:63], s54 offen
    s_add_u32 s54, s50, 0
    buffer_load_dword v115, v89, s[8:11], s54 offen
    s_waitcnt vmcnt(20)
    v_max3_u32 v120, v120, v122, v124
    v_add_f32 v121, v121, v123
    v_add_f32 v125, v125, v127
    v_max_u32 v120, v120, v126
    v_add_f32 v121, v121, v125

    s_nop 1
    v_max_u32_dpp v120, v120, v120 row_shr:1 row_mask:0xf bank_mask:0xf
    s_nop 1
    v_max_u32_dpp v120, v120, v120 row_shr:2 row_mask:0xf bank_mask:0xf
    s_nop 1
    v_max_u32_dpp v120, v120, v120 row_shr:4 row_mask:0xf bank_mask:0xf
    s_nop 1
    v_max_u32_dpp v120, v120, v120 row_shr:8 row_mask:0xf bank_mask:0xf
    s_nop 1
    v_max_u32_dpp v120, v120, v120 row_bcast:15 row_mask:0xa bank_mask:0xf
    s_nop 1
    v_max_u32_dpp v120, v120, v120 row_bcast:31 row_mask:0xc bank_mask:0xf
    s_nop 1
    v_add_f32_dpp v121, v121, v121 row_shr:1 row_mask:0xf bank_mask:0xf
    s_nop 1
    v_add_f32_dpp v121, v121, v121 row_shr:2 row_mask:0xf bank_mask:0xf
    s_nop 1
    v_add_f32_dpp v121, v121, v121 row_shr:4 row_mask:0xf bank_mask:0xf
    s_nop 1
    v_add_f32_dpp v121, v121, v121 row_shr:8 row_mask:0xf bank_mask:0xf
    s_nop 1
    v_add_f32_dpp v121, v121, v121 row_bcast:15 row_mask:0xa bank_mask:0xf
    s_nop 1
    v_add_f32_dpp v121, v121, v121 row_bcast:31 row_mask:0xc bank_mask:0xf
    v_lshlrev_b32 v120, 16, v120
    v_mul_f32 v121, 0x34a7c5ac, v121
    v_sqrt_f32 v121, v121
    v_mul_f32 v120, s33, v120
    v_mul_f32 v121, s33, v121
    v_cmp_gt_f32 vcc, 0x46fde800, v120
    s_mov_b64 s[64:65], vcc
    v_cmp_lt_f32 vcc, 0x44000000, v121
    v_mov_b32 v120, 0x37800000
    v_mul_f32 v120, s33, v120
    s_and_b64 vcc, vcc, s[64:65]
    v_mul_f32 v121, 0x46ff8000, v120
    v_rcp_f32 v121, v121
    v_readfirstlane_b32 s33, v120
    s_waitcnt lgkmcnt(0)
    s_barrier
    v_readfirstlane_b32 s34, v121
    v_mov_b32 v120, 150016
    v_mov_b32 v121, 0
    ds_write_b32 v120, v121 offset:8
    s_bitcmp0_b64 vcc, 63
    s_cbranch_scc1 L_p2slow_51
    s_cmp_lg_u32 s51, 0
    s_cbranch_scc1 L_p2slow_51

    s_mov_b32 s40, s88
    s_sub_u32 s42, s40, s39

    s_add_u32 s55, s38, 1
    s_min_u32 s55, s55, 31
    s_mov_b32 s88, s89
    s_mov_b32 s89, s90
    s_mov_b32 s90, s91
    s_mov_b32 s91, s92
    s_mov_b32 s92, s93
    s_mov_b32 s93, s94
    s_mov_b32 s94, s95
    s_mov_b32 s95, 0
    s_min_u32 s88, s88, 3968
    s_lshl_b32 s52, s55, 6
    s_add_u32 s52, s52, s36
    s_mul_i32 s52, s52, 19840
    s_add_u32 s16, s44, s52
    s_addc_u32 s17, s45, 0
    s_mul_i32 s52, s88, 5
    s_add_u32 s52, s52, 3
    s_and_b32 s18, s52, -4

    s_waitcnt vmcnt(18)
    v_perm_b32 v44, v91, v90, s24
    v_perm_b32 v46, v92, v91, s25
    v_perm_b32 v48, v93, v92, s26
    v_perm_b32 v50, v110, v93, s27
    v_mov_b32 v12, v90
    v_alignbyte_b32 v13, v92, v91, 1
    v_alignbyte_b32 v14, v93, v92, 2
    v_alignbyte_b32 v15, v110, v93, 3
    v_lshlrev_b32_sdwa v44, 3, v44 dst_sel:WORD_0 dst_unused:UNUSED_PAD src0_sel:DWORD src1_sel:DWORD
    v_lshlrev_b32_sdwa v46, 3, v46 dst_sel:WORD_0 dst_unused:UNUSED_PAD src0_sel:DWORD src1_sel:DWORD
    v_lshlrev_b32_sdwa v48, 3, v48 dst_sel:WORD_0 dst_unused:UNUSED_PAD src0_sel:DWORD src1_sel:DWORD
    v_lshlrev_b32_sdwa v50, 3, v50 dst_sel:WORD_0 dst_unused:UNUSED_PAD src0_sel:DWORD src1_sel:DWORD
    s_cmp_lt_i32 s42, 1280
    s_cbranch_scc1 L_ufix_52
L_uback_53:

    v_subrev_co_u32 v12, s[80:81], 2.0, v12
    v_subrev_co_u32 v13, s[82:83], 2.0, v13
    v_subrev_co_u32 v14, s[84:85], 2.0, v14
    v_subrev_co_u32 v15, s[86:87], 2.0, v15
    s_mov_b64 exec, s[80:81]
    ds_read_b64 v[44:45], v44
    s_mov_b64 exec, s[82:83]
    ds_read_b64 v[46:47], v46
    s_mov_b64 exec, s[84:85]
    ds_read_b64 v[48:49], v48
    s_mov_b64 exec, s[86:87]
    ds_read_b64 v[50:51], v50
    s_mov_b64 exec, -1
    s_waitcnt vmcnt(16)
    v_perm_b32 v52, v95, v94, s24
    v_perm_b32 v54, v96, v95, s25
    v_perm_b32 v56, v97, v96, s26
    v_perm_b32 v58, v111, v97, s27
    v_mov_b32 v16, v94
    v_alignbyte_b32 v17, v96, v95, 1
    v_alignbyte_b32 v18, v97, v96, 2
    v_alignbyte_b32 v19, v111, v97, 3
    v_lshlrev_b32_sdwa v52, 3, v52 dst_sel:WORD_0 dst_unused:UNUSED_PAD src0_sel:DWORD src1_sel:DWORD
    v_lshlrev_b32_sdwa v54, 3, v54 dst_sel:WORD_0 dst_unused:UNUSED_PAD src0_sel:DWORD src1_sel:DWORD
    v_lshlrev_b32_sdwa v56, 3, v56 dst_sel:WORD_0 dst_unused:UNUSED_PAD src0_sel:DWORD src1_sel:DWORD
    v_lshlrev_b32_sdwa v58, 3, v58 dst_sel:WORD_0 dst_unused:UNUSED_PAD src0_sel:DWORD src1_sel:DWORD
    s_cmp_lt_i32 s42, 1792
    s_cbranch_scc1 L_ufix_54
L_uback_55:

    v_subrev_co_u32 v16, s[64:65], 2.0, v16
    v_subrev_co_u32 v17, s[66:67], 2.0, v17
    v_subrev_co_u32 v18, s[68:69], 2.0, v18
    v_subrev_co_u32 v19, s[70:71], 2.0, v19
    s_mov_b64 exec, s[64:65]
    ds_read_b64 v[52:53], v52
    s_mov_b64 exec, s[66:67]
    ds_read_b64 v[54:55], v54
    s_mov_b64 exec, s[68:69]
    ds_read_b64 v[56:57], v56
    s_mov_b64 exec, s[70:71]
    ds_read_b64 v[58:59], v58
    s_mov_b64 exec, -1
    s_waitcnt vmcnt(14)
    v_perm_b32 v60, v99, v98, s24
    v_perm_b32 v62, v100, v99, s25
    v_perm_b32 v64, v101, v100, s26
    v_perm_b32 v66, v112, v101, s27
    v_mov_b32 v20, v98
    v_alignbyte_b32 v21, v100, v99, 1
    v_alignbyte_b32 v22, v101, v100, 2
    v_alignbyte_b32 v23, v112, v101, 3
    v_lshlrev_b32_sdwa v60, 3, v60 dst_sel:WORD_0 dst_unused:UNUSED_PAD src0_sel:DWORD src1_sel:DWORD
    v_lshlrev_b32_sdwa v62, 3, v62 dst_sel:WORD_0 dst_unused:UNUSED_PAD src0_sel:DWORD src1_sel:DWORD
    v_lshlrev_b32_sdwa v64, 3, v64 dst_sel:WORD_0 dst_unused:UNUSED_PAD src0_sel:DWORD src1_sel:DWORD
    v_lshlrev_b32_sdwa v66, 3, v66 dst_sel:WORD_0 dst_unused:UNUSED_PAD src0_sel:DWORD src1_sel:DWORD
    s_cmp_lt_i32 s42, 2304
    s_cbranch_scc1 L_ufix_56
L_uback_57:

    v_subrev_co_u32 v20, s[72:73], 2.0, v20
    v_subrev_co_u32 v21, s[74:75], 2.0, v21
    v_subrev_co_u32 v22, s[76:77], 2.0, v22
    v_subrev_co_u32 v23, s[78:79], 2.0, v23
    s_mov_b64 exec, s[72:73]
    ds_read_b64 v[60:61], v60
    s_mov_b64 exec, s[74:75]
    ds_read_b64 v[62:63], v62
    s_mov_b64 exec, s[76:77]
    ds_read_b64 v[64:65], v64
    s_mov_b64 exec, s[78:79]
    ds_read_b64 v[66:67], v66
    s_mov_b64 exec, -1
    s_waitcnt vmcnt(12)
    v_perm_b32 v68, v103, v102, s24
    v_perm_b32 v70, v104, v103, s25
    v_perm_b32 v72, v105, v104, s26
    v_perm_b32 v74, v113, v105, s27
    v_mov_b32 v24, v102
    v_alignbyte_b32 v25, v104, v103, 1
    v_alignbyte_b32 v26, v105, v104, 2
    v_alignbyte_b32 v27, v113, v105, 3
    v_lshlrev_b32_sdwa v68, 3, v68 dst_sel:WORD_0 dst_unused:UNUSED_PAD src0_sel:DWORD src1_sel:DWORD
    v_lshlrev_b32_sdwa v70, 3, v70 dst_sel:WORD_0 dst_unused:UNUSED_PAD src0_sel:DWORD src1_sel:DWORD
    v_lshlrev_b32_sdwa v72, 3, v72 dst_sel:WORD_0 dst_unused:UNUSED_PAD src0_sel:DWORD src1_sel:DWORD
    v_lshlrev_b32_sdwa v74, 3, v74 dst_sel:WORD_0 dst_unused:UNUSED_PAD src0_sel:DWORD src1_sel:DWORD
    s_cmp_lt_i32 s42, 2816
    s_cbranch_scc1 L_ufix_58
L_uback_59:

    v_subrev_co_u32 v24, s[80:81], 2.0, v24
    v_subrev_co_u32 v25, s[82:83], 2.0, v25
    v_subrev_co_u32 v26, s[84:85], 2.0, v26
    v_subrev_co_u32 v27, s[86:87], 2.0, v27
    s_mov_b64 exec, s[80:81]
    ds_read_b64 v[68:69], v68
    s_mov_b64 exec, s[82:83]
    ds_read_b64 v[70:71], v70
    s_mov_b64 exec, s[84:85]
    ds_read_b64 v[72:73], v72
    s_mov_b64 exec, s[86:87]
    ds_read_b64 v[74:75], v74
    s_mov_b64 exec, -1
    s_waitcnt vmcnt(10)
    v_perm_b32 v28, v5, v4, s24
    v_perm_b32 v30, v6, v5, s25
    v_perm_b32 v32, v7, v6, s26
    v_perm_b32 v34, v35, v7, s27
    v_alignbyte_b32 v5, v6, v5, 1
    v_alignbyte_b32 v6, v7, v6, 2
    v_alignbyte_b32 v7, v35, v7, 3
    v_lshlrev_b32_sdwa v28, 3, v28 dst_sel:WORD_0 dst_unused:UNUSED_PAD src0_sel:DWORD src1_sel:DWORD
    v_lshlrev_b32_sdwa v30, 3, v30 dst_sel:WORD_0 dst_unused:UNUSED_PAD src0_sel:DWORD src1_sel:DWORD
    v_lshlrev_b32_sdwa v32, 3, v32 dst_sel:WORD_0 dst_unused:UNUSED_PAD src0_sel:DWORD src1_sel:DWORD
    v_lshlrev_b32_sdwa v34, 3, v34 dst_sel:WORD_0 dst_unused:UNUSED_PAD src0_sel:DWORD src1_sel:DWORD
    s_cmp_lt_i32 s42, 256
    s_cbranch_scc1 L_ufix_60
L_uback_61:

    v_subrev_co_u32 v4, s[64:65], 2.0, v4
    v_subrev_co_u32 v5, s[66:67], 2.0, v5
    v_subrev_co_u32 v6, s[68:69], 2.0, v6
    v_subrev_co_u32 v7, s[70:71], 2.0, v7
    s_mov_b64 exec, s[64:65]
    ds_read_b64 v[28:29], v28
    s_mov_b64 exec, s[66:67]
    ds_read_b64 v[30:31], v30
    s_mov_b64 exec, s[68:69]
    ds_read_b64 v[32:33], v32
    s_mov_b64 exec, s[70:71]
    ds_read_b64 v[34:35], v34
    s_mov_b64 exec, -1
    s_waitcnt vmcnt(8)
    v_perm_b32 v36, v9, v8, s24
    v_perm_b32 v38, v10, v9, s25
    v_perm_b32 v40, v11, v10, s26
    v_perm_b32 v42, v43, v11, s27
    v_alignbyte_b32 v9, v10, v9, 1
    v_alignbyte_b32 v10, v11, v10, 2
    v_alignbyte_b32 v11, v43, v11, 3
    v_lshlrev_b32_sdwa v36, 3, v36 dst_sel:WORD_0 dst_unused:UNUSED_PAD src0_sel:DWORD src1_sel:DWORD
    v_lshlrev_b32_sdwa v38, 3, v38 dst_sel:WORD_0 dst_unused:UNUSED_PAD src0_sel:DWORD src1_sel:DWORD
    v_lshlrev_b32_sdwa v40, 3, v40 dst_sel:WORD_0 dst_unused:UNUSED_PAD src0_sel:DWORD src1_sel:DWORD
    v_lshlrev_b32_sdwa v42, 3, v42 dst_sel:WORD_0 dst_unused:UNUSED_PAD src0_sel:DWORD src1_sel:DWORD
    s_cmp_lt_i32 s42, 768
    s_cbranch_scc1 L_ufix_62
L_uback_63:

    v_subrev_co_u32 v8, s[72:73], 2.0, v8
    v_subrev_co_u32 v9, s[74:75], 2.0, v9
    v_subrev_co_u32 v10, s[76:77], 2.0, v10
    v_subrev_co_u32 v11, s[78:79], 2.0, v11
    s_mov_b64 exec, s[72:73]
    ds_read_b64 v[36:37], v36
    s_mov_b64 exec, s[74:75]
    ds_read_b64 v[38:39], v38
    s_mov_b64 exec, s[76:77]
    ds_read_b64 v[40:41], v40
    s_mov_b64 exec, s[78:79]
    ds_read_b64 v[42:43], v42
    s_mov_b64 exec, -1
L_batch_64:
    s_add_u32 s5, s38, 1

    s_movk_i32 s53, 5120
    buffer_load_dwordx4 v[90:93], v2, s[16:19], s53 offen
    buffer_load_dword v110, v2, s[16:19], s53 offen offset:16
    s_waitcnt lgkmcnt(0)
    s_barrier
    s_waitcnt vmcnt(7)
    ds_write_addtid_b32 v76 offset:0
    ds_write_addtid_b32 v77 offset:256
    ds_write_addtid_b32 v78 offset:512
    ds_write_addtid_b32 v79 offset:768
    s_waitcnt vmcnt(6)
    ds_write_addtid_b32 v80 offset:16384
    ds_write_addtid_b32 v81 offset:16640
    ds_write_addtid_b32 v82 offset:16896
    ds_write_addtid_b32 v83 offset:17152
    s_waitcnt vmcnt(5)
    ds_write_addtid_b32 v84 offset:32768
    ds_write_addtid_b32 v85 offset:33024
    ds_write_addtid_b32 v86 offset:33280
    ds_write_addtid_b32 v87 offset:33536
    v_lshlrev_b32 v119, 2, v0
    s_waitcnt vmcnt(4)
    s_mov_b64 exec, s[48:49]
    ds_write_b32 v119, v88 offset:49152
    s_mov_b64 exec, -1
    s_add_u32 s43, s43, 50048
    s_add_u32 s14, s43, 50000
    s_min_u32 s14, s14, s41
    buffer_load_dwordx4 v[76:79], v3, s[12:15], s43 offen
    s_add_u32 s52, s43, 16384
    buffer_load_dwordx4 v[80:83], v3, s[12:15], s52 offen
    v_subrev_co_u32 v4, s[64:65], 2.0, v4
    v_subrev_co_u32 v5, s[66:67], 2.0, v5
    v_subrev_co_u32 v6, s[68:69], 2.0, v6
    v_subrev_co_u32 v7, s[70:71], 2.0, v7
    v_subrev_co_u32 v8, s[72:73], 2.0, v8
    v_subrev_co_u32 v9, s[74:75], 2.0, v9
    v_subrev_co_u32 v10, s[76:77], 2.0, v10
    v_subrev_co_u32 v11, s[78:79], 2.0, v11
    v_subrev_co_u32 v12, s[80:81], 2.0, v12
    v_subrev_co_u32 v13, s[82:83], 2.0, v13
    v_subrev_co_u32 v14, s[84:85], 2.0, v14
    v_subrev_co_u32 v15, s[86:87], 2.0, v15
    s_waitcnt lgkmcnt(0)
    s_barrier
    s_add_u32 s52, s43, 32768
    buffer_load_dwordx4 v[84:87], v3, s[12:15], s52 offen
    s_add_u32 s52, s43, 49152
    v_lshlrev_b32 v119, 2, v0
    buffer_load_dword v88, v119, s[12:15], s52 offen
    s_mov_b64 exec, s[64:65]
    ds_read_b64 v[28:29], v28
    s_mov_b64 exec, s[66:67]
    ds_read_b64 v[30:31], v30
    s_mov_b64 exec, s[68:69]
    ds_read_b64 v[32:33], v32
    s_mov_b64 exec, s[70:71]
    ds_read_b64 v[34:35], v34
    s_mov_b64 exec, s[72:73]
    ds_read_b64 v[36:37], v36
    s_mov_b64 exec, s[74:75]
    ds_read_b64 v[38:39], v38
    s_mov_b64 exec, s[76:77]
    ds_read_b64 v[40:41], v40
    s_mov_b64 exec, s[78:79]
    ds_read_b64 v[42:43], v42
    s_mov_b64 exec, s[80:81]
    ds_read_b64 v[44:45], v44
    s_mov_b64 exec, s[82:83]
    ds_read_b64 v[46:47], v46
    s_mov_b64 exec, s[84:85]
    ds_read_b64 v[48:49], v48
    s_mov_b64 exec, s[86:87]
    ds_read_b64 v[50:51], v50
    s_mov_b64 exec, -1
    v_subrev_co_u32 v16, s[64:65], 2.0, v16
    v_subrev_co_u32 v17, s[66:67], 2.0, v17
    v_subrev_co_u32 v18, s[68:69], 2.0, v18
    v_subrev_co_u32 v19, s[70:71], 2.0, v19
    v_subrev_co_u32 v20, s[72:73], 2.0, v20
    v_subrev_co_u32 v21, s[74:75], 2.0, v21
    v_subrev_co_u32 v22, s[76:77], 2.0, v22
    v_subrev_co_u32 v23, s[78:79], 2.0, v23
    v_subrev_co_u32 v24, s[80:81], 2.0, v24
    v_subrev_co_u32 v25, s[82:83], 2.0, v25
    v_subrev_co_u32 v26, s[84:85], 2.0, v26
    v_subrev_co_u32 v27, s[86:87], 2.0, v27
    s_mov_b64 exec, s[64:65]
    ds_read_b64 v[52:53], v52
    s_mov_b64 exec, s[66:67]
    ds_read_b64 v[54:55], v54
    s_mov_b64 exec, s[68:69]
    ds_read_b64 v[56:57], v56
    s_mov_b64 exec, s[70:71]
    ds_read_b64 v[58:59], v58
    s_mov_b64 exec, s[72:73]
    ds_read_b64 v[60:61], v60
    s_mov_b64 exec, s[74:75]
    ds_read_b64 v[62:63], v62
    s_mov_b64 exec, s[76:77]
    ds_read_b64 v[64:65], v64
    s_mov_b64 exec, s[78:79]
    ds_read_b64 v[66:67], v66
    s_mov_b64 exec, s[80:81]
    ds_read_b64 v[68:69], v68
    s_mov_b64 exec, s[82:83]
    ds_read_b64 v[70:71], v70
    s_mov_b64 exec, s[84:85]
    ds_read_b64 v[72:73], v72
    s_mov_b64 exec, s[86:87]
    ds_read_b64 v[74:75], v74
    s_mov_b64 exec, -1
    s_cmp_le_i32 s42, 3072
    s_cbranch_scc1 L_nt1_66
    s_waitcnt vmcnt(12)
    v_perm_b32 v120, v107, v106, s24
    v_perm_b32 v122, v108, v107, s25
    v_perm_b32 v124, v109, v108, s26
    v_perm_b32 v126, v114, v109, s27
    v_alignbyte_b32 v107, v108, v107, 1
    v_alignbyte_b32 v108, v109, v108, 2
    v_alignbyte_b32 v109, v114, v109, 3
    v_lshlrev_b32_sdwa v120, 3, v120 dst_sel:WORD_0 dst_unused:UNUSED_PAD src0_sel:DWORD src1_sel:DWORD
    v_lshlrev_b32_sdwa v122, 3, v122 dst_sel:WORD_0 dst_unused:UNUSED_PAD src0_sel:DWORD src1_sel:DWORD
    v_lshlrev_b32_sdwa v124, 3, v124 dst_sel:WORD_0 dst_unused:UNUSED_PAD src0_sel:DWORD src1_sel:DWORD
    v_lshlrev_b32_sdwa v126, 3, v126 dst_sel:WORD_0 dst_unused:UNUSED_PAD src0_sel:DWORD src1_sel:DWORD
    s_cmp_lt_i32 s42, 3328
    s_cbranch_scc1 L_ufix_69
L_uback_70:

    v_lshrrev_b32 v117, 30, v106
    v_and_b32 v106, 0x3fffffff, v106
    v_mul_u32_u24 v117, 50000, v117
    v_cmp_ne_u32 vcc, 0, v106
    v_add_u32 v120, v120, v117
    s_mov_b64 exec, vcc

    buffer_load_dwordx2 v[120:121], v120, s[8:11], s50 offen
    s_mov_b64 exec, -1
    v_lshrrev_b32 v117, 30, v107
    v_and_b32 v107, 0x3fffffff, v107
    v_mul_u32_u24 v117, 50000, v117
    v_cmp_ne_u32 vcc, 0, v107
    v_add_u32 v122, v122, v117
    s_mov_b64 exec, vcc

    buffer_load_dwordx2 v[122:123], v122, s[8:11], s50 offen
    s_mov_b64 exec, -1
    v_lshrrev_b32 v117, 30, v108
    v_and_b32 v108, 0x3fffffff, v108
    v_mul_u32_u24 v117, 50000, v117
    v_cmp_ne_u32 vcc, 0, v108
    v_add_u32 v124, v124, v117
    s_mov_b64 exec, vcc

    buffer_load_dwordx2 v[124:125], v124, s[8:11], s50 offen
    s_mov_b64 exec, -1
    v_lshrrev_b32 v117, 30, v109
    v_and_b32 v109, 0x3fffffff, v109
    v_mul_u32_u24 v117, 50000, v117
    v_cmp_ne_u32 vcc, 0, v109
    v_add_u32 v126, v126, v117
    s_mov_b64 exec, vcc

    buffer_load_dwordx2 v[126:127], v126, s[8:11], s50 offen
    s_mov_b64 exec, -1
L_nt1_66:
    s_movk_i32 s53, 7680
    buffer_load_dwordx4 v[94:97], v2, s[16:19], s53 offen
    buffer_load_dword v111, v2, s[16:19], s53 offen offset:16
    s_waitcnt lgkmcnt(0)
    s_barrier
    s_waitcnt vmcnt(5)
    ds_write_addtid_b32 v76 offset:0
    ds_write_addtid_b32 v77 offset:256
    ds_write_addtid_b32 v78 offset:512
    ds_write_addtid_b32 v79 offset:768
    s_waitcnt vmcnt(4)
    ds_write_addtid_b32 v80 offset:16384
    ds_write_addtid_b32 v81 offset:16640
    ds_write_addtid_b32 v82 offset:16896
    ds_write_addtid_b32 v83 offset:17152
    s_waitcnt vmcnt(3)
    ds_write_addtid_b32 v84 offset:32768
    ds_write_addtid_b32 v85 offset:33024
    ds_write_addtid_b32 v86 offset:33280
    ds_write_addtid_b32 v87 offset:33536
    v_lshlrev_b32 v119, 2, v0
    s_waitcnt vmcnt(2)
    s_mov_b64 exec, s[48:49]
    ds_write_b32 v119, v88 offset:49152
    s_mov_b64 exec, -1
    s_add_u32 s43, s43, 50048
    s_add_u32 s14, s43, 50000
    s_min_u32 s14, s14, s41
    buffer_load_dwordx4 v[76:79], v3, s[12:15], s43 offen
    s_add_u32 s52, s43, 16384
    buffer_load_dwordx4 v[80:83], v3, s[12:15], s52 offen
    v_subrev_co_u32 v4, s[64:65], 2.0, v4
    v_subrev_co_u32 v5, s[66:67], 2.0, v5
    v_subrev_co_u32 v6, s[68:69], 2.0, v6
    v_subrev_co_u32 v7, s[70:71], 2.0, v7
    v_subrev_co_u32 v8, s[72:73], 2.0, v8
    v_subrev_co_u32 v9, s[74:75], 2.0, v9
    v_subrev_co_u32 v10, s[76:77], 2.0, v10
    v_subrev_co_u32 v11, s[78:79], 2.0, v11
    v_subrev_co_u32 v12, s[80:81], 2.0, v12
    v_subrev_co_u32 v13, s[82:83], 2.0, v13
    v_subrev_co_u32 v14, s[84:85], 2.0, v14
    v_subrev_co_u32 v15, s[86:87], 2.0, v15
    s_waitcnt lgkmcnt(0)
    s_barrier
    s_add_u32 s52, s43, 32768
    buffer_load_dwordx4 v[84:87], v3, s[12:15], s52 offen
    s_add_u32 s52, s43, 49152
    v_lshlrev_b32 v119, 2, v0
    buffer_load_dword v88, v119, s[12:15], s52 offen
    s_mov_b64 exec, s[64:65]
    ds_read_b64 v[28:29], v28
    s_mov_b64 exec, s[66:67]
    ds_read_b64 v[30:31], v30
    s_mov_b64 exec, s[68:69]
    ds_read_b64 v[32:33], v32
    s_mov_b64 exec, s[70:71]
    ds_read_b64 v[34:35], v34
    s_mov_b64 exec, s[72:73]
    ds_read_b64 v[36:37], v36
    s_mov_b64 exec, s[74:75]
    ds_read_b64 v[38:39], v38
    s_mov_b64 exec, s[76:77]
    ds_read_b64 v[40:41], v40
    s_mov_b64 exec, s[78:79]
    ds_read_b64 v[42:43], v42
    s_mov_b64 exec, s[80:81]
    ds_read_b64 v[44:45], v44
    s_mov_b64 exec, s[82:83]
    ds_read_b64 v[46:47], v46
    s_mov_b64 exec, s[84:85]
    ds_read_b64 v[48:49], v48
    s_mov_b64 exec, s[86:87]
    ds_read_b64 v[50:51], v50
    s_mov_b64 exec, -1
    v_subrev_co_u32 v16, s[64:65], 2.0, v16
    v_subrev_co_u32 v17, s[66:67], 2.0, v17
    v_subrev_co_u32 v18, s[68:69], 2.0, v18
    v_subrev_co_u32 v19, s[70:71], 2.0, v19
    v_subrev_co_u32 v20, s[72:73], 2.0, v20
    v_subrev_co_u32 v21, s[74:75], 2.0, v21
    v_subrev_co_u32 v22, s[76:77], 2.0, v22
    v_subrev_co_u32 v23, s[78:79], 2.0, v23
    v_subrev_co_u32 v24, s[80:81], 2.0, v24
    v_subrev_co_u32 v25, s[82:83], 2.0, v25
    v_subrev_co_u32 v26, s[84:85], 2.0, v26
    v_subrev_co_u32 v27, s[86:87], 2.0, v27
    s_mov_b64 exec, s[64:65]
    ds_read_b64 v[52:53], v52
    s_mov_b64 exec, s[66:67]
    ds_read_b64 v[54:55], v54
    s_mov_b64 exec, s[68:69]
    ds_read_b64 v[56:57], v56
    s_mov_b64 exec, s[70:71]
    ds_read_b64 v[58:59], v58
    s_mov_b64 exec, s[72:73]
    ds_read_b64 v[60:61], v60
    s_mov_b64 exec, s[74:75]
    ds_read_b64 v[62:63], v62
    s_mov_b64 exec, s[76:77]
    ds_read_b64 v[64:65], v64
    s_mov_b64 exec, s[78:79]
    ds_read_b64 v[66:67], v66
    s_mov_b64 exec, s[80:81]
    ds_read_b64 v[68:69], v68
    s_mov_b64 exec, s[82:83]
    ds_read_b64 v[70:71], v70
    s_mov_b64 exec, s[84:85]
    ds_read_b64 v[72:73], v72
    s_mov_b64 exec, s[86:87]
    ds_read_b64 v[74:75], v74
    s_mov_b64 exec, -1
    s_movk_i32 s53, 10240
    buffer_load_dwordx4 v[98:101], v2, s[16:19], s53 offen
    buffer_load_dword v112, v2, s[16:19], s53 offen offset:16
    s_cmp_le_i32 s42, 3072
    s_cbranch_scc1 L_nt2_67
    s_waitcnt vmcnt(8)
    v_cmp_ne_u32 s[64:65], 0, v106
    v_cmp_ne_u32 s[66:67], 0, v107
    v_cmp_ne_u32 s[68:69], 0, v108
    v_cmp_ne_u32 s[70:71], 0, v109
    s_mov_b64 exec, s[64:65]
    v_cvt_f32_i32_sdwa v118, sext(v106) dst_sel:DWORD dst_unused:UNUSED_PAD src0_sel:WORD_0
    v_lshlrev_b32 v116, 16, v120
    v_and_b32 v117, s32, v120
    v_mul_f32 v118, s33, v118
    v_lshlrev_b32 v120, 16, v121
    v_and_b32 v121, s32, v121
    v_lshlrev_b32_sdwa v106, 3, v106 dst_sel:DWORD dst_unused:UNUSED_PAD src0_sel:DWORD src1_sel:WORD_1
    v_pk_fma_f32 v[116:117], v[116:117], v[118:119], s[28:29] op_sel_hi:[1,0,1]
    v_pk_fma_f32 v[120:121], v[120:121], v[118:119], s[28:29] op_sel_hi:[1,0,1]
    v_perm_b32 v116, v117, v116, s35
    v_perm_b32 v117, v121, v120, s35
    v_lshl_add_u64 v[116:117], v[116:117], 0, s[30:31]
    ds_add_rtn_u64 v[120:121], v106, v[116:117] offset:50000

    s_mov_b64 exec, s[66:67]
    v_cvt_f32_i32_sdwa v118, sext(v107) dst_sel:DWORD dst_unused:UNUSED_PAD src0_sel:WORD_0
    v_lshlrev_b32 v116, 16, v122
    v_and_b32 v117, s32, v122
    v_mul_f32 v118, s33, v118
    v_lshlrev_b32 v122, 16, v123
    v_and_b32 v123, s32, v123
    v_lshlrev_b32_sdwa v107, 3, v107 dst_sel:DWORD dst_unused:UNUSED_PAD src0_sel:DWORD src1_sel:WORD_1
    v_pk_fma_f32 v[116:117], v[116:117], v[118:119], s[28:29] op_sel_hi:[1,0,1]
    v_pk_fma_f32 v[122:123], v[122:123], v[118:119], s[28:29] op_sel_hi:[1,0,1]
    v_perm_b32 v116, v117, v116, s35
    v_perm_b32 v117, v123, v122, s35
    v_lshl_add_u64 v[116:117], v[116:117], 0, s[30:31]
    ds_add_rtn_u64 v[122:123], v107, v[116:117] offset:50000

    s_mov_b64 exec, s[68:69]
    v_cvt_f32_i32_sdwa v118, sext(v108) dst_sel:DWORD dst_unused:UNUSED_PAD src0_sel:WORD_0
    v_lshlrev_b32 v116, 16, v124
    v_and_b32 v117, s32, v124
    v_mul_f32 v118, s33, v118
    v_lshlrev_b32 v124, 16, v125
    v_and_b32 v125, s32, v125
    v_lshlrev_b32_sdwa v108, 3, v108 dst_sel:DWORD dst_unused:UNUSED_PAD src0_sel:DWORD src1_sel:WORD_1
    v_pk_fma_f32 v[116:117], v[116:117], v[118:119], s[28:29] op_sel_hi:[1,0,1]
    v_pk_fma_f32 v[124:125], v[124:125], v[118:119], s[28:29] op_sel_hi:[1,0,1]
    v_perm_b32 v116, v117, v116, s35
    v_perm_b32 v117, v125, v124, s35
    v_lshl_add_u64 v[116:117], v[116:117], 0, s[30:31]
    ds_add_rtn_u64 v[124:125], v108, v[116:117] offset:50000

    s_mov_b64 exec, s[70:71]
    v_cvt_f32_i32_sdwa v118, sext(v109) dst_sel:DWORD dst_unused:UNUSED_PAD src0_sel:WORD_0
    v_lshlrev_b32 v116, 16, v126
    v_and_b32 v117, s32, v126
    v_mul_f32 v118, s33, v118
    v_lshlrev_b32 v126, 16, v127
    v_and_b32 v127, s32, v127
    v_lshlrev_b32_sdwa v109, 3, v109 dst_sel:DWORD dst_unused:UNUSED_PAD src0_sel:DWORD src1_sel:WORD_1
    v_pk_fma_f32 v[116:117], v[116:117], v[118:119], s[28:29] op_sel_hi:[1,0,1]
    v_pk_fma_f32 v[126:127], v[126:127], v[118:119], s[28:29] op_sel_hi:[1,0,1]
    v_perm_b32 v116, v117, v116, s35
    v_perm_b32 v117, v127, v126, s35
    v_lshl_add_u64 v[116:117], v[116:117], 0, s[30:31]
    ds_add_rtn_u64 v[126:127], v109, v[116:117] offset:50000

    s_waitcnt lgkmcnt(0)
    s_mov_b64 exec, s[64:65]
    v_or3_b32 v1, v120, v121, v1
    s_mov_b64 exec, s[66:67]
    v_or3_b32 v1, v122, v123, v1
    s_mov_b64 exec, s[68:69]
    v_or3_b32 v1, v124, v125, v1
    s_mov_b64 exec, s[70:71]
    v_or3_b32 v1, v126, v127, v1
    s_mov_b64 exec, -1
L_nt2_67:
    s_movk_i32 s53, 15360
    buffer_load_dwordx4 v[106:109], v2, s[16:19], s53 offen
    buffer_load_dword v114, v2, s[16:19], s53 offen offset:16
    s_cmp_le_u32 s40, 3584
    s_cbranch_scc1 L_noleft_68
    s_min_u32 s40, s40, 3968
    s_lshl_b32 s52, s38, 6
    s_add_u32 s52, s52, s36
    s_mul_i32 s52, s52, 19840
    s_add_u32 s20, s44, s52
    s_addc_u32 s21, s45, 0
    s_mul_i32 s52, s40, 5
    s_add_u32 s52, s52, 3
    s_and_b32 s22, s52, -4

    s_lshr_b32 s55, s39, 2
    s_add_u32 s55, s55, 3584
    v_and_b32 v120, 63, v0
    v_add_u32 v120, s55, v120
L_left_71:
    s_cmp_ge_u32 s55, s40
    s_cbranch_scc1 L_leftend_72
    v_mul_u32_u24 v121, 5, v120
    buffer_load_dword v122, v121, s[20:23], 0 offen
    buffer_load_ubyte v123, v121, s[20:23], 0 offen offset:4
    s_waitcnt vmcnt(0)

    v_perm_b32 v121, v123, v122, s24
    v_lshrrev_b32 v126, 30, v122
    v_and_b32 v121, 0x1fff, v121
    v_mul_u32_u24 v126, 6250, v126
    v_add_lshl_u32 v121, v121, v126, 3

    buffer_load_dwordx2 v[124:125], v121, s[8:11], s50 offen
    v_cmp_gt_u32 vcc, s40, v120
    s_waitcnt vmcnt(0)

    s_mov_b64 exec, vcc
    v_and_b32 v122, 0x3fffffff, v122
    v_cvt_f32_i32_sdwa v118, sext(v122) dst_sel:DWORD dst_unused:UNUSED_PAD src0_sel:WORD_0
    v_lshlrev_b32 v116, 16, v124
    v_and_b32 v117, s32, v124
    v_mul_f32 v118, s33, v118
    v_lshlrev_b32 v124, 16, v125
    v_and_b32 v125, s32, v125
    v_lshlrev_b32_sdwa v122, 3, v122 dst_sel:DWORD dst_unused:UNUSED_PAD src0_sel:DWORD src1_sel:WORD_1
    v_pk_fma_f32 v[116:117], v[116:117], v[118:119], s[28:29] op_sel_hi:[1,0,1]
    v_pk_fma_f32 v[124:125], v[124:125], v[118:119], s[28:29] op_sel_hi:[1,0,1]
    v_perm_b32 v116, v117, v116, s35
    v_perm_b32 v117, v125, v124, s35
    v_lshl_add_u64 v[116:117], v[116:117], 0, s[30:31]
    ds_add_rtn_u64 v[124:125], v122, v[116:117] offset:50000

    s_waitcnt lgkmcnt(0)
    v_or3_b32 v1, v124, v125, v1
    s_mov_b64 exec, -1
    v_add_u32 v120, 128, v120
    s_add_u32 s55, s55, 128
    s_branch L_left_71
L_leftend_72:

L_noleft_68:
    s_waitcnt lgkmcnt(0)
    s_barrier
    s_waitcnt vmcnt(7)
    ds_write_addtid_b32 v76 offset:0
    ds_write_addtid_b32 v77 offset:256
    ds_write_addtid_b32 v78 offset:512
    ds_write_addtid_b32 v79 offset:768
    s_waitcnt vmcnt(6)
    ds_write_addtid_b32 v80 offset:16384
    ds_write_addtid_b32 v81 offset:16640
    ds_write_addtid_b32 v82 offset:16896
    ds_write_addtid_b32 v83 offset:17152
    s_waitcnt vmcnt(5)
    ds_write_addtid_b32 v84 offset:32768
    ds_write_addtid_b32 v85 offset:33024
    ds_write_addtid_b32 v86 offset:33280
    ds_write_addtid_b32 v87 offset:33536
    v_lshlrev_b32 v119, 2, v0
    s_waitcnt vmcnt(4)
    s_mov_b64 exec, s[48:49]
    ds_write_b32 v119, v88 offset:49152
    s_mov_b64 exec, -1
    s_add_u32 s43, s43, 50048
    s_add_u32 s14, s43, 50000
    s_min_u32 s14, s14, s41
    buffer_load_dwordx4 v[76:79], v3, s[12:15], s43 offen
    s_add_u32 s52, s43, 16384
    buffer_load_dwordx4 v[80:83], v3, s[12:15], s52 offen
    v_cmp_gt_u32 s[64:65], 2.0, v4
    v_and_b32 v4, 0x3fffffff, v4
    v_cmp_gt_u32 s[66:67], 2.0, v5
    v_and_b32 v5, 0x3fffffff, v5
    v_cmp_gt_u32 s[68:69], 2.0, v6
    v_and_b32 v6, 0x3fffffff, v6
    v_cmp_gt_u32 s[70:71], 2.0, v7
    v_and_b32 v7, 0x3fffffff, v7
    v_cmp_gt_u32 s[72:73], 2.0, v8
    v_and_b32 v8, 0x3fffffff, v8
    v_cmp_gt_u32 s[74:75], 2.0, v9
    v_and_b32 v9, 0x3fffffff, v9
    v_cmp_gt_u32 s[76:77], 2.0, v10
    v_and_b32 v10, 0x3fffffff, v10
    v_cmp_gt_u32 s[78:79], 2.0, v11
    v_and_b32 v11, 0x3fffffff, v11
    v_cmp_gt_u32 s[80:81], 2.0, v12
    v_and_b32 v12, 0x3fffffff, v12
    v_cmp_gt_u32 s[82:83], 2.0, v13
    v_and_b32 v13, 0x3fffffff, v13
    v_cmp_gt_u32 s[84:85], 2.0, v14
    v_and_b32 v14, 0x3fffffff, v14
    v_cmp_gt_u32 s[86:87], 2.0, v15
    v_and_b32 v15, 0x3fffffff, v15
    s_waitcnt lgkmcnt(0)
    s_barrier
    s_add_u32 s52, s43, 32768
    buffer_load_dwordx4 v[84:87], v3, s[12:15], s52 offen
    s_add_u32 s52, s43, 49152
    v_lshlrev_b32 v119, 2, v0
    buffer_load_dword v88, v119, s[12:15], s52 offen
    s_mov_b64 exec, s[64:65]
    ds_read_b64 v[28:29], v28
    s_mov_b64 exec, s[66:67]
    ds_read_b64 v[30:31], v30
    s_mov_b64 exec, s[68:69]
    ds_read_b64 v[32:33], v32
    s_mov_b64 exec, s[70:71]
    ds_read_b64 v[34:35], v34
    s_mov_b64 exec, s[72:73]
    ds_read_b64 v[36:37], v36
    s_mov_b64 exec, s[74:75]
    ds_read_b64 v[38:39], v38
    s_mov_b64 exec, s[76:77]
    ds_read_b64 v[40:41], v40
    s_mov_b64 exec, s[78:79]
    ds_read_b64 v[42:43], v42
    s_mov_b64 exec, s[80:81]
    ds_read_b64 v[44:45], v44
    s_mov_b64 exec, s[82:83]
    ds_read_b64 v[46:47], v46
    s_mov_b64 exec, s[84:85]
    ds_read_b64 v[48:49], v48
    s_mov_b64 exec, s[86:87]
    ds_read_b64 v[50:51], v50
    s_mov_b64 exec, -1
    v_cmp_gt_u32 s[64:65], 2.0, v16
    v_and_b32 v16, 0x3fffffff, v16
    v_cmp_gt_u32 s[66:67], 2.0, v17
    v_and_b32 v17, 0x3fffffff, v17
    v_cmp_gt_u32 s[68:69], 2.0, v18
    v_and_b32 v18, 0x3fffffff, v18
    v_cmp_gt_u32 s[70:71], 2.0, v19
    v_and_b32 v19, 0x3fffffff, v19
    v_cmp_gt_u32 s[72:73], 2.0, v20
    v_and_b32 v20, 0x3fffffff, v20
    v_cmp_gt_u32 s[74:75], 2.0, v21
    v_and_b32 v21, 0x3fffffff, v21
    v_cmp_gt_u32 s[76:77], 2.0, v22
    v_and_b32 v22, 0x3fffffff, v22
    v_cmp_gt_u32 s[78:79], 2.0, v23
    v_and_b32 v23, 0x3fffffff, v23
    v_cmp_gt_u32 s[80:81], 2.0, v24
    v_and_b32 v24, 0x3fffffff, v24
    v_cmp_gt_u32 s[82:83], 2.0, v25
    v_and_b32 v25, 0x3fffffff, v25
    v_cmp_gt_u32 s[84:85], 2.0, v26
    v_and_b32 v26, 0x3fffffff, v26
    v_cmp_gt_u32 s[86:87], 2.0, v27
    v_and_b32 v27, 0x3fffffff, v27
    s_mov_b64 exec, s[64:65]
    ds_read_b64 v[52:53], v52
    s_mov_b64 exec, s[66:67]
    ds_read_b64 v[54:55], v54
    s_mov_b64 exec, s[68:69]
    ds_read_b64 v[56:57], v56
    s_mov_b64 exec, s[70:71]
    ds_read_b64 v[58:59], v58
    s_mov_b64 exec, s[72:73]
    ds_read_b64 v[60:61], v60
    s_mov_b64 exec, s[74:75]
    ds_read_b64 v[62:63], v62
    s_mov_b64 exec, s[76:77]
    ds_read_b64 v[64:65], v64
    s_mov_b64 exec, s[78:79]
    ds_read_b64 v[66:67], v66
    s_mov_b64 exec, s[80:81]
    ds_read_b64 v[68:69], v68
    s_mov_b64 exec, s[82:83]
    ds_read_b64 v[70:71], v70
    s_mov_b64 exec, s[84:85]
    ds_read_b64 v[72:73], v72
    s_mov_b64 exec, s[86:87]
    ds_read_b64 v[74:75], v74
    s_mov_b64 exec, -1
    s_movk_i32 s53, 12800
    buffer_load_dwordx4 v[102:105], v2, s[16:19], s53 offen
    buffer_load_dword v113, v2, s[16:19], s53 offen offset:16
    s_cmp_ge_u32 s5, s4
    s_cbranch_scc1 L_bend_65
    s_waitcnt lgkmcnt(15)
    v_mad_i32_i16 v120, v28, v4, s96
    v_mad_i32_i16 v28, v28, v4, s96 op_sel:[1,0,0,0]
    v_mad_i32_i16 v121, v29, v4, s96
    v_mad_i32_i16 v29, v29, v4, s96 op_sel:[1,0,0,0]
    v_lshlrev_b32_sdwa v4, 3, v4 dst_sel:DWORD dst_unused:UNUSED_PAD src0_sel:DWORD src1_sel:WORD_1
    v_perm_b32 v28, v28, v120, s97
    v_perm_b32 v29, v29, v121, s97
    v_lshl_add_u64 v[28:29], v[28:29], 0, s[30:31]

    ds_add_rtn_u64 v[28:29], v4, v[28:29] offset:50000
    v_mad_i32_i16 v122, v30, v5, s96
    v_mad_i32_i16 v30, v30, v5, s96 op_sel:[1,0,0,0]
    v_mad_i32_i16 v123, v31, v5, s96
    v_mad_i32_i16 v31, v31, v5, s96 op_sel:[1,0,0,0]
    v_lshlrev_b32_sdwa v5, 3, v5 dst_sel:DWORD dst_unused:UNUSED_PAD src0_sel:DWORD src1_sel:WORD_1
    v_perm_b32 v30, v30, v122, s97
    v_perm_b32 v31, v31, v123, s97
    v_lshl_add_u64 v[30:31], v[30:31], 0, s[30:31]

    ds_add_rtn_u64 v[30:31], v5, v[30:31] offset:50000
    v_mad_i32_i16 v124, v32, v6, s96
    v_mad_i32_i16 v32, v32, v6, s96 op_sel:[1,0,0,0]
    v_mad_i32_i16 v125, v33, v6, s96
    v_mad_i32_i16 v33, v33, v6, s96 op_sel:[1,0,0,0]
    v_lshlrev_b32_sdwa v6, 3, v6 dst_sel:DWORD dst_unused:UNUSED_PAD src0_sel:DWORD src1_sel:WORD_1
    v_perm_b32 v32, v32, v124, s97
    v_perm_b32 v33, v33, v125, s97
    v_lshl_add_u64 v[32:33], v[32:33], 0, s[30:31]

    ds_add_rtn_u64 v[32:33], v6, v[32:33] offset:50000
    v_mad_i32_i16 v126, v34, v7, s96
    v_mad_i32_i16 v34, v34, v7, s96 op_sel:[1,0,0,0]
    v_mad_i32_i16 v127, v35, v7, s96
    v_mad_i32_i16 v35, v35, v7, s96 op_sel:[1,0,0,0]
    v_lshlrev_b32_sdwa v7, 3, v7 dst_sel:DWORD dst_unused:UNUSED_PAD src0_sel:DWORD src1_sel:WORD_1
    v_perm_b32 v34, v34, v126, s97
    v_perm_b32 v35, v35, v127, s97
    v_lshl_add_u64 v[34:35], v[34:35], 0, s[30:31]

    ds_add_rtn_u64 v[34:35], v7, v[34:35] offset:50000
    v_mad_i32_i16 v120, v36, v8, s96
    v_mad_i32_i16 v36, v36, v8, s96 op_sel:[1,0,0,0]
    v_mad_i32_i16 v121, v37, v8, s96
    v_mad_i32_i16 v37, v37, v8, s96 op_sel:[1,0,0,0]
    v_lshlrev_b32_sdwa v8, 3, v8 dst_sel:DWORD dst_unused:UNUSED_PAD src0_sel:DWORD src1_sel:WORD_1
    v_perm_b32 v36, v36, v120, s97
    v_perm_b32 v37, v37, v121, s97
    v_lshl_add_u64 v[36:37], v[36:37], 0, s[30:31]

    ds_add_rtn_u64 v[36:37], v8, v[36:37] offset:50000
    v_mad_i32_i16 v122, v38, v9, s96
    v_mad_i32_i16 v38, v38, v9, s96 op_sel:[1,0,0,0]
    v_mad_i32_i16 v123, v39, v9, s96
    v_mad_i32_i16 v39, v39, v9, s96 op_sel:[1,0,0,0]
    v_lshlrev_b32_sdwa v9, 3, v9 dst_sel:DWORD dst_unused:UNUSED_PAD src0_sel:DWORD src1_sel:WORD_1
    v_perm_b32 v38, v38, v122, s97
    v_perm_b32 v39, v39, v123, s97
    v_lshl_add_u64 v[38:39], v[38:39], 0, s[30:31]

    ds_add_rtn_u64 v[38:39], v9, v[38:39] offset:50000
    v_mad_i32_i16 v124, v40, v10, s96
    v_mad_i32_i16 v40, v40, v10, s96 op_sel:[1,0,0,0]
    v_mad_i32_i16 v125, v41, v10, s96
    v_mad_i32_i16 v41, v41, v10, s96 op_sel:[1,0,0,0]
    v_lshlrev_b32_sdwa v10, 3, v10 dst_sel:DWORD dst_unused:UNUSED_PAD src0_sel:DWORD src1_sel:WORD_1
    v_perm_b32 v40, v40, v124, s97
    v_perm_b32 v41, v41, v125, s97
    v_lshl_add_u64 v[40:41], v[40:41], 0, s[30:31]

    ds_add_rtn_u64 v[40:41], v10, v[40:41] offset:50000
    v_mad_i32_i16 v126, v42, v11, s96
    v_mad_i32_i16 v42, v42, v11, s96 op_sel:[1,0,0,0]
    v_mad_i32_i16 v127, v43, v11, s96
    v_mad_i32_i16 v43, v43, v11, s96 op_sel:[1,0,0,0]
    v_lshlrev_b32_sdwa v11, 3, v11 dst_sel:DWORD dst_unused:UNUSED_PAD src0_sel:DWORD src1_sel:WORD_1
    v_perm_b32 v42, v42, v126, s97
    v_perm_b32 v43, v43, v127, s97
    v_lshl_add_u64 v[42:43], v[42:43], 0, s[30:31]

    ds_add_rtn_u64 v[42:43], v11, v[42:43] offset:50000
    s_waitcnt lgkmcnt(4)
    v_or3_b32 v1, v28, v29, v1
    v_or3_b32 v1, v30, v31, v1
    v_or3_b32 v1, v32, v33, v1
    v_or3_b32 v1, v34, v35, v1
    s_barrier
    s_waitcnt vmcnt(5)
    ds_write_addtid_b32 v76 offset:0
    ds_write_addtid_b32 v77 offset:256
    ds_write_addtid_b32 v78 offset:512
    ds_write_addtid_b32 v79 offset:768
    s_waitcnt vmcnt(4)
    ds_write_addtid_b32 v80 offset:16384
    ds_write_addtid_b32 v81 offset:16640
    ds_write_addtid_b32 v82 offset:16896
    ds_write_addtid_b32 v83 offset:17152
    s_waitcnt vmcnt(3)
    ds_write_addtid_b32 v84 offset:32768
    ds_write_addtid_b32 v85 offset:33024
    ds_write_addtid_b32 v86 offset:33280
    ds_write_addtid_b32 v87 offset:33536
    v_lshlrev_b32 v119, 2, v0
    s_waitcnt vmcnt(2)
    s_mov_b64 exec, s[48:49]
    ds_write_b32 v119, v88 offset:49152
    s_mov_b64 exec, -1
    s_add_u32 s43, s43, 50048
    s_add_u32 s14, s43, 50000
    s_min_u32 s14, s14, s41
    buffer_load_dwordx4 v[76:79], v3, s[12:15], s43 offen
    s_add_u32 s52, s43, 16384
    buffer_load_dwordx4 v[80:83], v3, s[12:15], s52 offen
    s_add_u32 s52, s43, 32768
    buffer_load_dwordx4 v[84:87], v3, s[12:15], s52 offen
    s_add_u32 s52, s43, 49152
    v_lshlrev_b32 v119, 2, v0
    buffer_load_dword v88, v119, s[12:15], s52 offen
    s_add_u32 s54, s43, 50048
    buffer_load_dword v115, v89, s[60:63], s54 offen
    s_add_u32 s54, s50, 200000
    buffer_load_dword v115, v89, s[8:11], s54 offen
    s_movk_i32 s53, 0
    buffer_load_dwordx4 v[4:7], v2, s[16:19], s53 offen
    buffer_load_dword v35, v2, s[16:19], s53 offen offset:16
    v_mad_i32_i16 v120, v44, v12, s96
    v_mad_i32_i16 v44, v44, v12, s96 op_sel:[1,0,0,0]
    v_mad_i32_i16 v121, v45, v12, s96
    v_mad_i32_i16 v45, v45, v12, s96 op_sel:[1,0,0,0]
    v_lshlrev_b32_sdwa v12, 3, v12 dst_sel:DWORD dst_unused:UNUSED_PAD src0_sel:DWORD src1_sel:WORD_1
    v_perm_b32 v44, v44, v120, s97
    v_perm_b32 v45, v45, v121, s97
    v_lshl_add_u64 v[44:45], v[44:45], 0, s[30:31]

    ds_add_rtn_u64 v[44:45], v12, v[44:45] offset:50000
    v_mad_i32_i16 v122, v46, v13, s96
    v_mad_i32_i16 v46, v46, v13, s96 op_sel:[1,0,0,0]
    v_mad_i32_i16 v123, v47, v13, s96
    v_mad_i32_i16 v47, v47, v13, s96 op_sel:[1,0,0,0]
    v_lshlrev_b32_sdwa v13, 3, v13 dst_sel:DWORD dst_unused:UNUSED_PAD src0_sel:DWORD src1_sel:WORD_1
    v_perm_b32 v46, v46, v122, s97
    v_perm_b32 v47, v47, v123, s97
    v_lshl_add_u64 v[46:47], v[46:47], 0, s[30:31]

    ds_add_rtn_u64 v[46:47], v13, v[46:47] offset:50000
    v_mad_i32_i16 v124, v48, v14, s96
    v_mad_i32_i16 v48, v48, v14, s96 op_sel:[1,0,0,0]
    v_mad_i32_i16 v125, v49, v14, s96
    v_mad_i32_i16 v49, v49, v14, s96 op_sel:[1,0,0,0]
    v_lshlrev_b32_sdwa v14, 3, v14 dst_sel:DWORD dst_unused:UNUSED_PAD src0_sel:DWORD src1_sel:WORD_1
    v_perm_b32 v48, v48, v124, s97
    v_perm_b32 v49, v49, v125, s97
    v_lshl_add_u64 v[48:49], v[48:49], 0, s[30:31]

    ds_add_rtn_u64 v[48:49], v14, v[48:49] offset:50000
    v_mad_i32_i16 v126, v50, v15, s96
    v_mad_i32_i16 v50, v50, v15, s96 op_sel:[1,0,0,0]
    v_mad_i32_i16 v127, v51, v15, s96
    v_mad_i32_i16 v51, v51, v15, s96 op_sel:[1,0,0,0]
    v_lshlrev_b32_sdwa v15, 3, v15 dst_sel:DWORD dst_unused:UNUSED_PAD src0_sel:DWORD src1_sel:WORD_1
    v_perm_b32 v50, v50, v126, s97
    v_perm_b32 v51, v51, v127, s97
    v_lshl_add_u64 v[50:51], v[50:51], 0, s[30:31]

    ds_add_rtn_u64 v[50:51], v15, v[50:51] offset:50000
    s_waitcnt lgkmcnt(15)
    v_or3_b32 v1, v36, v37, v1
    v_or3_b32 v1, v38, v39, v1
    v_or3_b32 v1, v40, v41, v1
    v_or3_b32 v1, v42, v43, v1
    s_movk_i32 s53, 2560
    buffer_load_dwordx4 v[8:11], v2, s[16:19], s53 offen
    buffer_load_dword v43, v2, s[16:19], s53 offen offset:16
    s_mov_b32 s40, s88
    s_sub_u32 s42, s40, s39

    s_add_u32 s55, s38, 2
    s_min_u32 s55, s55, 31
    s_mov_b32 s88, s89
    s_mov_b32 s89, s90
    s_mov_b32 s90, s91
    s_mov_b32 s91, s92
    s_mov_b32 s92, s93
    s_mov_b32 s93, s94
    s_mov_b32 s94, s95
    s_mov_b32 s95, 0
    s_min_u32 s88, s88, 3968
    s_lshl_b32 s52, s55, 6
    s_add_u32 s52, s52, s36
    s_mul_i32 s52, s52, 19840
    s_add_u32 s16, s44, s52
    s_addc_u32 s17, s45, 0
    s_mul_i32 s52, s88, 5
    s_add_u32 s52, s52, 3
    s_and_b32 s18, s52, -4

    v_mad_i32_i16 v120, v52, v16, s96
    v_mad_i32_i16 v52, v52, v16, s96 op_sel:[1,0,0,0]
    v_mad_i32_i16 v121, v53, v16, s96
    v_mad_i32_i16 v53, v53, v16, s96 op_sel:[1,0,0,0]
    v_lshlrev_b32_sdwa v16, 3, v16 dst_sel:DWORD dst_unused:UNUSED_PAD src0_sel:DWORD src1_sel:WORD_1
    v_perm_b32 v52, v52, v120, s97
    v_perm_b32 v53, v53, v121, s97
    v_lshl_add_u64 v[52:53], v[52:53], 0, s[30:31]

    ds_add_rtn_u64 v[52:53], v16, v[52:53] offset:50000
    v_mad_i32_i16 v122, v54, v17, s96
    v_mad_i32_i16 v54, v54, v17, s96 op_sel:[1,0,0,0]
    v_mad_i32_i16 v123, v55, v17, s96
    v_mad_i32_i16 v55, v55, v17, s96 op_sel:[1,0,0,0]
    v_lshlrev_b32_sdwa v17, 3, v17 dst_sel:DWORD dst_unused:UNUSED_PAD src0_sel:DWORD src1_sel:WORD_1
    v_perm_b32 v54, v54, v122, s97
    v_perm_b32 v55, v55, v123, s97
    v_lshl_add_u64 v[54:55], v[54:55], 0, s[30:31]

    ds_add_rtn_u64 v[54:55], v17, v[54:55] offset:50000
    v_mad_i32_i16 v124, v56, v18, s96
    v_mad_i32_i16 v56, v56, v18, s96 op_sel:[1,0,0,0]
    v_mad_i32_i16 v125, v57, v18, s96
    v_mad_i32_i16 v57, v57, v18, s96 op_sel:[1,0,0,0]
    v_lshlrev_b32_sdwa v18, 3, v18 dst_sel:DWORD dst_unused:UNUSED_PAD src0_sel:DWORD src1_sel:WORD_1
    v_perm_b32 v56, v56, v124, s97
    v_perm_b32 v57, v57, v125, s97
    v_lshl_add_u64 v[56:57], v[56:57], 0, s[30:31]

    ds_add_rtn_u64 v[56:57], v18, v[56:57] offset:50000
    v_mad_i32_i16 v126, v58, v19, s96
    v_mad_i32_i16 v58, v58, v19, s96 op_sel:[1,0,0,0]
    v_mad_i32_i16 v127, v59, v19, s96
    v_mad_i32_i16 v59, v59, v19, s96 op_sel:[1,0,0,0]
    v_lshlrev_b32_sdwa v19, 3, v19 dst_sel:DWORD dst_unused:UNUSED_PAD src0_sel:DWORD src1_sel:WORD_1
    v_perm_b32 v58, v58, v126, s97
    v_perm_b32 v59, v59, v127, s97
    v_lshl_add_u64 v[58:59], v[58:59], 0, s[30:31]

    ds_add_rtn_u64 v[58:59], v19, v[58:59] offset:50000
    s_waitcnt lgkmcnt(4)
    v_or3_b32 v1, v44, v45, v1
    v_or3_b32 v1, v46, v47, v1
    v_or3_b32 v1, v48, v49, v1
    v_or3_b32 v1, v50, v51, v1
    s_waitcnt vmcnt(30)
    v_perm_b32 v44, v91, v90, s24
    v_perm_b32 v46, v92, v91, s25
    v_perm_b32 v48, v93, v92, s26
    v_perm_b32 v50, v110, v93, s27
    v_mov_b32 v12, v90
    v_alignbyte_b32 v13, v92, v91, 1
    v_alignbyte_b32 v14, v93, v92, 2
    v_alignbyte_b32 v15, v110, v93, 3
    v_lshlrev_b32_sdwa v44, 3, v44 dst_sel:WORD_0 dst_unused:UNUSED_PAD src0_sel:DWORD src1_sel:DWORD
    v_lshlrev_b32_sdwa v46, 3, v46 dst_sel:WORD_0 dst_unused:UNUSED_PAD src0_sel:DWORD src1_sel:DWORD
    v_lshlrev_b32_sdwa v48, 3, v48 dst_sel:WORD_0 dst_unused:UNUSED_PAD src0_sel:DWORD src1_sel:DWORD
    v_lshlrev_b32_sdwa v50, 3, v50 dst_sel:WORD_0 dst_unused:UNUSED_PAD src0_sel:DWORD src1_sel:DWORD
    s_cmp_lt_i32 s42, 1280
    s_cbranch_scc1 L_ufix_73
L_uback_74:

    s_barrier
    v_subrev_co_u32 v12, s[80:81], 2.0, v12
    v_subrev_co_u32 v13, s[82:83], 2.0, v13
    v_subrev_co_u32 v14, s[84:85], 2.0, v14
    v_subrev_co_u32 v15, s[86:87], 2.0, v15
    s_mov_b64 exec, s[80:81]
    ds_read_b64 v[44:45], v44
    s_mov_b64 exec, s[82:83]
    ds_read_b64 v[46:47], v46
    s_mov_b64 exec, s[84:85]
    ds_read_b64 v[48:49], v48
    s_mov_b64 exec, s[86:87]
    ds_read_b64 v[50:51], v50
    s_mov_b64 exec, -1
    v_mad_i32_i16 v120, v60, v20, s96
    v_mad_i32_i16 v60, v60, v20, s96 op_sel:[1,0,0,0]
    v_mad_i32_i16 v121, v61, v20, s96
    v_mad_i32_i16 v61, v61, v20, s96 op_sel:[1,0,0,0]
    v_lshlrev_b32_sdwa v20, 3, v20 dst_sel:DWORD dst_unused:UNUSED_PAD src0_sel:DWORD src1_sel:WORD_1
    v_perm_b32 v60, v60, v120, s97
    v_perm_b32 v61, v61, v121, s97
    v_lshl_add_u64 v[60:61], v[60:61], 0, s[30:31]

    ds_add_rtn_u64 v[60:61], v20, v[60:61] offset:50000
    v_mad_i32_i16 v122, v62, v21, s96
    v_mad_i32_i16 v62, v62, v21, s96 op_sel:[1,0,0,0]
    v_mad_i32_i16 v123, v63, v21, s96
    v_mad_i32_i16 v63, v63, v21, s96 op_sel:[1,0,0,0]
    v_lshlrev_b32_sdwa v21, 3, v21 dst_sel:DWORD dst_unused:UNUSED_PAD src0_sel:DWORD src1_sel:WORD_1
    v_perm_b32 v62, v62, v122, s97
    v_perm_b32 v63, v63, v123, s97
    v_lshl_add_u64 v[62:63], v[62:63], 0, s[30:31]

    ds_add_rtn_u64 v[62:63], v21, v[62:63] offset:50000
    v_mad_i32_i16 v124, v64, v22, s96
    v_mad_i32_i16 v64, v64, v22, s96 op_sel:[1,0,0,0]
    v_mad_i32_i16 v125, v65, v22, s96
    v_mad_i32_i16 v65, v65, v22, s96 op_sel:[1,0,0,0]
    v_lshlrev_b32_sdwa v22, 3, v22 dst_sel:DWORD dst_unused:UNUSED_PAD src0_sel:DWORD src1_sel:WORD_1
    v_perm_b32 v64, v64, v124, s97
    v_perm_b32 v65, v65, v125, s97
    v_lshl_add_u64 v[64:65], v[64:65], 0, s[30:31]

    ds_add_rtn_u64 v[64:65], v22, v[64:65] offset:50000
    v_mad_i32_i16 v126, v66, v23, s96
    v_mad_i32_i16 v66, v66, v23, s96 op_sel:[1,0,0,0]
    v_mad_i32_i16 v127, v67, v23, s96
    v_mad_i32_i16 v67, v67, v23, s96 op_sel:[1,0,0,0]
    v_lshlrev_b32_sdwa v23, 3, v23 dst_sel:DWORD dst_unused:UNUSED_PAD src0_sel:DWORD src1_sel:WORD_1
    v_perm_b32 v66, v66, v126, s97
    v_perm_b32 v67, v67, v127, s97
    v_lshl_add_u64 v[66:67], v[66:67], 0, s[30:31]

    ds_add_rtn_u64 v[66:67], v23, v[66:67] offset:50000
    s_waitcnt lgkmcnt(8)
    v_or3_b32 v1, v52, v53, v1
    v_or3_b32 v1, v54, v55, v1
    v_or3_b32 v1, v56, v57, v1
    v_or3_b32 v1, v58, v59, v1
    s_waitcnt vmcnt(24)
    v_perm_b32 v52, v95, v94, s24
    v_perm_b32 v54, v96, v95, s25
    v_perm_b32 v56, v97, v96, s26
    v_perm_b32 v58, v111, v97, s27
    v_mov_b32 v16, v94
    v_alignbyte_b32 v17, v96, v95, 1
    v_alignbyte_b32 v18, v97, v96, 2
    v_alignbyte_b32 v19, v111, v97, 3
    v_lshlrev_b32_sdwa v52, 3, v52 dst_sel:WORD_0 dst_unused:UNUSED_PAD src0_sel:DWORD src1_sel:DWORD
    v_lshlrev_b32_sdwa v54, 3, v54 dst_sel:WORD_0 dst_unused:UNUSED_PAD src0_sel:DWORD src1_sel:DWORD
    v_lshlrev_b32_sdwa v56, 3, v56 dst_sel:WORD_0 dst_unused:UNUSED_PAD src0_sel:DWORD src1_sel:DWORD
    v_lshlrev_b32_sdwa v58, 3, v58 dst_sel:WORD_0 dst_unused:UNUSED_PAD src0_sel:DWORD src1_sel:DWORD
    s_cmp_lt_i32 s42, 1792
    s_cbranch_scc1 L_ufix_75
L_uback_76:

    v_subrev_co_u32 v16, s[64:65], 2.0, v16
    v_subrev_co_u32 v17, s[66:67], 2.0, v17
    v_subrev_co_u32 v18, s[68:69], 2.0, v18
    v_subrev_co_u32 v19, s[70:71], 2.0, v19
    s_mov_b64 exec, s[64:65]
    ds_read_b64 v[52:53], v52
    s_mov_b64 exec, s[66:67]
    ds_read_b64 v[54:55], v54
    s_mov_b64 exec, s[68:69]
    ds_read_b64 v[56:57], v56
    s_mov_b64 exec, s[70:71]
    ds_read_b64 v[58:59], v58
    s_mov_b64 exec, -1
    v_mad_i32_i16 v120, v68, v24, s96
    v_mad_i32_i16 v68, v68, v24, s96 op_sel:[1,0,0,0]
    v_mad_i32_i16 v121, v69, v24, s96
    v_mad_i32_i16 v69, v69, v24, s96 op_sel:[1,0,0,0]
    v_lshlrev_b32_sdwa v24, 3, v24 dst_sel:DWORD dst_unused:UNUSED_PAD src0_sel:DWORD src1_sel:WORD_1
    v_perm_b32 v68, v68, v120, s97
    v_perm_b32 v69, v69, v121, s97
    v_lshl_add_u64 v[68:69], v[68:69], 0, s[30:31]

    ds_add_rtn_u64 v[68:69], v24, v[68:69] offset:50000
    v_mad_i32_i16 v122, v70, v25, s96
    v_mad_i32_i16 v70, v70, v25, s96 op_sel:[1,0,0,0]
    v_mad_i32_i16 v123, v71, v25, s96
    v_mad_i32_i16 v71, v71, v25, s96 op_sel:[1,0,0,0]
    v_lshlrev_b32_sdwa v25, 3, v25 dst_sel:DWORD dst_unused:UNUSED_PAD src0_sel:DWORD src1_sel:WORD_1
    v_perm_b32 v70, v70, v122, s97
    v_perm_b32 v71, v71, v123, s97
    v_lshl_add_u64 v[70:71], v[70:71], 0, s[30:31]

    ds_add_rtn_u64 v[70:71], v25, v[70:71] offset:50000
    v_mad_i32_i16 v124, v72, v26, s96
    v_mad_i32_i16 v72, v72, v26, s96 op_sel:[1,0,0,0]
    v_mad_i32_i16 v125, v73, v26, s96
    v_mad_i32_i16 v73, v73, v26, s96 op_sel:[1,0,0,0]
    v_lshlrev_b32_sdwa v26, 3, v26 dst_sel:DWORD dst_unused:UNUSED_PAD src0_sel:DWORD src1_sel:WORD_1
    v_perm_b32 v72, v72, v124, s97
    v_perm_b32 v73, v73, v125, s97
    v_lshl_add_u64 v[72:73], v[72:73], 0, s[30:31]

    ds_add_rtn_u64 v[72:73], v26, v[72:73] offset:50000
    v_mad_i32_i16 v126, v74, v27, s96
    v_mad_i32_i16 v74, v74, v27, s96 op_sel:[1,0,0,0]
    v_mad_i32_i16 v127, v75, v27, s96
    v_mad_i32_i16 v75, v75, v27, s96 op_sel:[1,0,0,0]
    v_lshlrev_b32_sdwa v27, 3, v27 dst_sel:DWORD dst_unused:UNUSED_PAD src0_sel:DWORD src1_sel:WORD_1
    v_perm_b32 v74, v74, v126, s97
    v_perm_b32 v75, v75, v127, s97
    v_lshl_add_u64 v[74:75], v[74:75], 0, s[30:31]

    ds_add_rtn_u64 v[74:75], v27, v[74:75] offset:50000
    s_waitcnt lgkmcnt(8)
    v_or3_b32 v1, v60, v61, v1
    v_or3_b32 v1, v62, v63, v1
    v_or3_b32 v1, v64, v65, v1
    v_or3_b32 v1, v66, v67, v1
    s_waitcnt vmcnt(18)
    v_perm_b32 v60, v99, v98, s24
    v_perm_b32 v62, v100, v99, s25
    v_perm_b32 v64, v101, v100, s26
    v_perm_b32 v66, v112, v101, s27
    v_mov_b32 v20, v98
    v_alignbyte_b32 v21, v100, v99, 1
    v_alignbyte_b32 v22, v101, v100, 2
    v_alignbyte_b32 v23, v112, v101, 3
    v_lshlrev_b32_sdwa v60, 3, v60 dst_sel:WORD_0 dst_unused:UNUSED_PAD src0_sel:DWORD src1_sel:DWORD
    v_lshlrev_b32_sdwa v62, 3, v62 dst_sel:WORD_0 dst_unused:UNUSED_PAD src0_sel:DWORD src1_sel:DWORD
    v_lshlrev_b32_sdwa v64, 3, v64 dst_sel:WORD_0 dst_unused:UNUSED_PAD src0_sel:DWORD src1_sel:DWORD
    v_lshlrev_b32_sdwa v66, 3, v66 dst_sel:WORD_0 dst_unused:UNUSED_PAD src0_sel:DWORD src1_sel:DWORD
    s_cmp_lt_i32 s42, 2304
    s_cbranch_scc1 L_ufix_77
L_uback_78:

    v_subrev_co_u32 v20, s[72:73], 2.0, v20
    v_subrev_co_u32 v21, s[74:75], 2.0, v21
    v_subrev_co_u32 v22, s[76:77], 2.0, v22
    v_subrev_co_u32 v23, s[78:79], 2.0, v23
    s_mov_b64 exec, s[72:73]
    ds_read_b64 v[60:61], v60
    s_mov_b64 exec, s[74:75]
    ds_read_b64 v[62:63], v62
    s_mov_b64 exec, s[76:77]
    ds_read_b64 v[64:65], v64
    s_mov_b64 exec, s[78:79]
    ds_read_b64 v[66:67], v66
    s_mov_b64 exec, -1
    s_waitcnt lgkmcnt(4)
    v_or3_b32 v1, v68, v69, v1
    v_or3_b32 v1, v70, v71, v1
    v_or3_b32 v1, v72, v73, v1
    v_or3_b32 v1, v74, v75, v1
    s_waitcnt vmcnt(10)
    v_perm_b32 v68, v103, v102, s24
    v_perm_b32 v70, v104, v103, s25
    v_perm_b32 v72, v105, v104, s26
    v_perm_b32 v74, v113, v105, s27
    v_mov_b32 v24, v102
    v_alignbyte_b32 v25, v104, v103, 1
    v_alignbyte_b32 v26, v105, v104, 2
    v_alignbyte_b32 v27, v113, v105, 3
    v_lshlrev_b32_sdwa v68, 3, v68 dst_sel:WORD_0 dst_unused:UNUSED_PAD src0_sel:DWORD src1_sel:DWORD
    v_lshlrev_b32_sdwa v70, 3, v70 dst_sel:WORD_0 dst_unused:UNUSED_PAD src0_sel:DWORD src1_sel:DWORD
    v_lshlrev_b32_sdwa v72, 3, v72 dst_sel:WORD_0 dst_unused:UNUSED_PAD src0_sel:DWORD src1_sel:DWORD
    v_lshlrev_b32_sdwa v74, 3, v74 dst_sel:WORD_0 dst_unused:UNUSED_PAD src0_sel:DWORD src1_sel:DWORD
    s_cmp_lt_i32 s42, 2816
    s_cbranch_scc1 L_ufix_79
L_uback_80:

    v_subrev_co_u32 v24, s[80:81], 2.0, v24
    v_subrev_co_u32 v25, s[82:83], 2.0, v25
    v_subrev_co_u32 v26, s[84:85], 2.0, v26
    v_subrev_co_u32 v27, s[86:87], 2.0, v27
    s_mov_b64 exec, s[80:81]
    ds_read_b64 v[68:69], v68
    s_mov_b64 exec, s[82:83]
    ds_read_b64 v[70:71], v70
    s_mov_b64 exec, s[84:85]
    ds_read_b64 v[72:73], v72
    s_mov_b64 exec, s[86:87]
    ds_read_b64 v[74:75], v74
    s_mov_b64 exec, -1
    s_waitcnt vmcnt(2)
    v_perm_b32 v28, v5, v4, s24
    v_perm_b32 v30, v6, v5, s25
    v_perm_b32 v32, v7, v6, s26
    v_perm_b32 v34, v35, v7, s27
    v_alignbyte_b32 v5, v6, v5, 1
    v_alignbyte_b32 v6, v7, v6, 2
    v_alignbyte_b32 v7, v35, v7, 3
    v_lshlrev_b32_sdwa v28, 3, v28 dst_sel:WORD_0 dst_unused:UNUSED_PAD src0_sel:DWORD src1_sel:DWORD
    v_lshlrev_b32_sdwa v30, 3, v30 dst_sel:WORD_0 dst_unused:UNUSED_PAD src0_sel:DWORD src1_sel:DWORD
    v_lshlrev_b32_sdwa v32, 3, v32 dst_sel:WORD_0 dst_unused:UNUSED_PAD src0_sel:DWORD src1_sel:DWORD
    v_lshlrev_b32_sdwa v34, 3, v34 dst_sel:WORD_0 dst_unused:UNUSED_PAD src0_sel:DWORD src1_sel:DWORD
    s_cmp_lt_i32 s42, 256
    s_cbranch_scc1 L_ufix_81
L_uback_82:

    v_subrev_co_u32 v4, s[64:65], 2.0, v4
    v_subrev_co_u32 v5, s[66:67], 2.0, v5
    v_subrev_co_u32 v6, s[68:69], 2.0, v6
    v_subrev_co_u32 v7, s[70:71], 2.0, v7
    s_mov_b64 exec, s[64:65]
    ds_read_b64 v[28:29], v28
    s_mov_b64 exec, s[66:67]
    ds_read_b64 v[30:31], v30
    s_mov_b64 exec, s[68:69]
    ds_read_b64 v[32:33], v32
    s_mov_b64 exec, s[70:71]
    ds_read_b64 v[34:35], v34
    s_mov_b64 exec, -1
    s_waitcnt vmcnt(0)
    v_perm_b32 v36, v9, v8, s24
    v_perm_b32 v38, v10, v9, s25
    v_perm_b32 v40, v11, v10, s26
    v_perm_b32 v42, v43, v11, s27
    v_alignbyte_b32 v9, v10, v9, 1
    v_alignbyte_b32 v10, v11, v10, 2
    v_alignbyte_b32 v11, v43, v11, 3
    v_lshlrev_b32_sdwa v36, 3, v36 dst_sel:WORD_0 dst_unused:UNUSED_PAD src0_sel:DWORD src1_sel:DWORD
    v_lshlrev_b32_sdwa v38, 3, v38 dst_sel:WORD_0 dst_unused:UNUSED_PAD src0_sel:DWORD src1_sel:DWORD
    v_lshlrev_b32_sdwa v40, 3, v40 dst_sel:WORD_0 dst_unused:UNUSED_PAD src0_sel:DWORD src1_sel:DWORD
    v_lshlrev_b32_sdwa v42, 3, v42 dst_sel:WORD_0 dst_unused:UNUSED_PAD src0_sel:DWORD src1_sel:DWORD
    s_cmp_lt_i32 s42, 768
    s_cbranch_scc1 L_ufix_83
L_uback_84:

    v_subrev_co_u32 v8, s[72:73], 2.0, v8
    v_subrev_co_u32 v9, s[74:75], 2.0, v9
    v_subrev_co_u32 v10, s[76:77], 2.0, v10
    v_subrev_co_u32 v11, s[78:79], 2.0, v11
    s_mov_b64 exec, s[72:73]
    ds_read_b64 v[36:37], v36
    s_mov_b64 exec, s[74:75]
    ds_read_b64 v[38:39], v38
    s_mov_b64 exec, s[76:77]
    ds_read_b64 v[40:41], v40
    s_mov_b64 exec, s[78:79]
    ds_read_b64 v[42:43], v42
    s_mov_b64 exec, -1
    s_mov_b32 s38, s5
    s_add_u32 s50, s50, 200000
    s_branch L_batch_64
L_bend_65:

    s_load_dwordx2 s[64:65], s[0:1], 24
    s_load_dwordx2 s[86:87], s[0:1], 40
    s_load_dwordx8 s[88:95], s[0:1], 56
    s_mov_b32 s66, 1600000
    s_mov_b32 s67, 0x20000

    s_waitcnt lgkmcnt(15)
    v_mad_i32_i16 v120, v28, v4, s96
    v_mad_i32_i16 v28, v28, v4, s96 op_sel:[1,0,0,0]
    v_mad_i32_i16 v121, v29, v4, s96
    v_mad_i32_i16 v29, v29, v4, s96 op_sel:[1,0,0,0]
    v_lshlrev_b32_sdwa v4, 3, v4 dst_sel:DWORD dst_unused:UNUSED_PAD src0_sel:DWORD src1_sel:WORD_1
    v_perm_b32 v28, v28, v120, s97
    v_perm_b32 v29, v29, v121, s97
    v_lshl_add_u64 v[28:29], v[28:29], 0, s[30:31]

    ds_add_rtn_u64 v[28:29], v4, v[28:29] offset:50000
    v_mad_i32_i16 v122, v30, v5, s96
    v_mad_i32_i16 v30, v30, v5, s96 op_sel:[1,0,0,0]
    v_mad_i32_i16 v123, v31, v5, s96
    v_mad_i32_i16 v31, v31, v5, s96 op_sel:[1,0,0,0]
    v_lshlrev_b32_sdwa v5, 3, v5 dst_sel:DWORD dst_unused:UNUSED_PAD src0_sel:DWORD src1_sel:WORD_1
    v_perm_b32 v30, v30, v122, s97
    v_perm_b32 v31, v31, v123, s97
    v_lshl_add_u64 v[30:31], v[30:31], 0, s[30:31]

    ds_add_rtn_u64 v[30:31], v5, v[30:31] offset:50000
    v_mad_i32_i16 v124, v32, v6, s96
    v_mad_i32_i16 v32, v32, v6, s96 op_sel:[1,0,0,0]
    v_mad_i32_i16 v125, v33, v6, s96
    v_mad_i32_i16 v33, v33, v6, s96 op_sel:[1,0,0,0]
    v_lshlrev_b32_sdwa v6, 3, v6 dst_sel:DWORD dst_unused:UNUSED_PAD src0_sel:DWORD src1_sel:WORD_1
    v_perm_b32 v32, v32, v124, s97
    v_perm_b32 v33, v33, v125, s97
    v_lshl_add_u64 v[32:33], v[32:33], 0, s[30:31]

    ds_add_rtn_u64 v[32:33], v6, v[32:33] offset:50000
    v_mad_i32_i16 v126, v34, v7, s96
    v_mad_i32_i16 v34, v34, v7, s96 op_sel:[1,0,0,0]
    v_mad_i32_i16 v127, v35, v7, s96
    v_mad_i32_i16 v35, v35, v7, s96 op_sel:[1,0,0,0]
    v_lshlrev_b32_sdwa v7, 3, v7 dst_sel:DWORD dst_unused:UNUSED_PAD src0_sel:DWORD src1_sel:WORD_1
    v_perm_b32 v34, v34, v126, s97
    v_perm_b32 v35, v35, v127, s97
    v_lshl_add_u64 v[34:35], v[34:35], 0, s[30:31]

    ds_add_rtn_u64 v[34:35], v7, v[34:35] offset:50000
    v_mad_i32_i16 v120, v36, v8, s96
    v_mad_i32_i16 v36, v36, v8, s96 op_sel:[1,0,0,0]
    v_mad_i32_i16 v121, v37, v8, s96
    v_mad_i32_i16 v37, v37, v8, s96 op_sel:[1,0,0,0]
    v_lshlrev_b32_sdwa v8, 3, v8 dst_sel:DWORD dst_unused:UNUSED_PAD src0_sel:DWORD src1_sel:WORD_1
    v_perm_b32 v36, v36, v120, s97
    v_perm_b32 v37, v37, v121, s97
    v_lshl_add_u64 v[36:37], v[36:37], 0, s[30:31]

    ds_add_rtn_u64 v[36:37], v8, v[36:37] offset:50000
    v_mad_i32_i16 v122, v38, v9, s96
    v_mad_i32_i16 v38, v38, v9, s96 op_sel:[1,0,0,0]
    v_mad_i32_i16 v123, v39, v9, s96
    v_mad_i32_i16 v39, v39, v9, s96 op_sel:[1,0,0,0]
    v_lshlrev_b32_sdwa v9, 3, v9 dst_sel:DWORD dst_unused:UNUSED_PAD src0_sel:DWORD src1_sel:WORD_1
    v_perm_b32 v38, v38, v122, s97
    v_perm_b32 v39, v39, v123, s97
    v_lshl_add_u64 v[38:39], v[38:39], 0, s[30:31]

    ds_add_rtn_u64 v[38:39], v9, v[38:39] offset:50000
    v_mad_i32_i16 v124, v40, v10, s96
    v_mad_i32_i16 v40, v40, v10, s96 op_sel:[1,0,0,0]
    v_mad_i32_i16 v125, v41, v10, s96
    v_mad_i32_i16 v41, v41, v10, s96 op_sel:[1,0,0,0]
    v_lshlrev_b32_sdwa v10, 3, v10 dst_sel:DWORD dst_unused:UNUSED_PAD src0_sel:DWORD src1_sel:WORD_1
    v_perm_b32 v40, v40, v124, s97
    v_perm_b32 v41, v41, v125, s97
    v_lshl_add_u64 v[40:41], v[40:41], 0, s[30:31]

    ds_add_rtn_u64 v[40:41], v10, v[40:41] offset:50000
    v_mad_i32_i16 v126, v42, v11, s96
    v_mad_i32_i16 v42, v42, v11, s96 op_sel:[1,0,0,0]
    v_mad_i32_i16 v127, v43, v11, s96
    v_mad_i32_i16 v43, v43, v11, s96 op_sel:[1,0,0,0]
    v_lshlrev_b32_sdwa v11, 3, v11 dst_sel:DWORD dst_unused:UNUSED_PAD src0_sel:DWORD src1_sel:WORD_1
    v_perm_b32 v42, v42, v126, s97
    v_perm_b32 v43, v43, v127, s97
    v_lshl_add_u64 v[42:43], v[42:43], 0, s[30:31]

    ds_add_rtn_u64 v[42:43], v11, v[42:43] offset:50000
    s_waitcnt lgkmcnt(4)
    v_or3_b32 v1, v28, v29, v1
    v_or3_b32 v1, v30, v31, v1
    v_or3_b32 v1, v32, v33, v1
    v_or3_b32 v1, v34, v35, v1
    v_mad_i32_i16 v120, v44, v12, s96
    v_mad_i32_i16 v44, v44, v12, s96 op_sel:[1,0,0,0]
    v_mad_i32_i16 v121, v45, v12, s96
    v_mad_i32_i16 v45, v45, v12, s96 op_sel:[1,0,0,0]
    v_lshlrev_b32_sdwa v12, 3, v12 dst_sel:DWORD dst_unused:UNUSED_PAD src0_sel:DWORD src1_sel:WORD_1
    v_perm_b32 v44, v44, v120, s97
    v_perm_b32 v45, v45, v121, s97
    v_lshl_add_u64 v[44:45], v[44:45], 0, s[30:31]

    ds_add_rtn_u64 v[44:45], v12, v[44:45] offset:50000
    v_mad_i32_i16 v122, v46, v13, s96
    v_mad_i32_i16 v46, v46, v13, s96 op_sel:[1,0,0,0]
    v_mad_i32_i16 v123, v47, v13, s96
    v_mad_i32_i16 v47, v47, v13, s96 op_sel:[1,0,0,0]
    v_lshlrev_b32_sdwa v13, 3, v13 dst_sel:DWORD dst_unused:UNUSED_PAD src0_sel:DWORD src1_sel:WORD_1
    v_perm_b32 v46, v46, v122, s97
    v_perm_b32 v47, v47, v123, s97
    v_lshl_add_u64 v[46:47], v[46:47], 0, s[30:31]

    ds_add_rtn_u64 v[46:47], v13, v[46:47] offset:50000
    v_mad_i32_i16 v124, v48, v14, s96
    v_mad_i32_i16 v48, v48, v14, s96 op_sel:[1,0,0,0]
    v_mad_i32_i16 v125, v49, v14, s96
    v_mad_i32_i16 v49, v49, v14, s96 op_sel:[1,0,0,0]
    v_lshlrev_b32_sdwa v14, 3, v14 dst_sel:DWORD dst_unused:UNUSED_PAD src0_sel:DWORD src1_sel:WORD_1
    v_perm_b32 v48, v48, v124, s97
    v_perm_b32 v49, v49, v125, s97
    v_lshl_add_u64 v[48:49], v[48:49], 0, s[30:31]

    ds_add_rtn_u64 v[48:49], v14, v[48:49] offset:50000
    v_mad_i32_i16 v126, v50, v15, s96
    v_mad_i32_i16 v50, v50, v15, s96 op_sel:[1,0,0,0]
    v_mad_i32_i16 v127, v51, v15, s96
    v_mad_i32_i16 v51, v51, v15, s96 op_sel:[1,0,0,0]
    v_lshlrev_b32_sdwa v15, 3, v15 dst_sel:DWORD dst_unused:UNUSED_PAD src0_sel:DWORD src1_sel:WORD_1
    v_perm_b32 v50, v50, v126, s97
    v_perm_b32 v51, v51, v127, s97
    v_lshl_add_u64 v[50:51], v[50:51], 0, s[30:31]

    ds_add_rtn_u64 v[50:51], v15, v[50:51] offset:50000
    s_waitcnt lgkmcnt(4)
    v_or3_b32 v1, v36, v37, v1
    v_or3_b32 v1, v38, v39, v1
    v_or3_b32 v1, v40, v41, v1
    v_or3_b32 v1, v42, v43, v1
    v_mad_i32_i16 v120, v52, v16, s96
    v_mad_i32_i16 v52, v52, v16, s96 op_sel:[1,0,0,0]
    v_mad_i32_i16 v121, v53, v16, s96
    v_mad_i32_i16 v53, v53, v16, s96 op_sel:[1,0,0,0]
    v_lshlrev_b32_sdwa v16, 3, v16 dst_sel:DWORD dst_unused:UNUSED_PAD src0_sel:DWORD src1_sel:WORD_1
    v_perm_b32 v52, v52, v120, s97
    v_perm_b32 v53, v53, v121, s97
    v_lshl_add_u64 v[52:53], v[52:53], 0, s[30:31]

    ds_add_rtn_u64 v[52:53], v16, v[52:53] offset:50000
    v_mad_i32_i16 v122, v54, v17, s96
    v_mad_i32_i16 v54, v54, v17, s96 op_sel:[1,0,0,0]
    v_mad_i32_i16 v123, v55, v17, s96
    v_mad_i32_i16 v55, v55, v17, s96 op_sel:[1,0,0,0]
    v_lshlrev_b32_sdwa v17, 3, v17 dst_sel:DWORD dst_unused:UNUSED_PAD src0_sel:DWORD src1_sel:WORD_1
    v_perm_b32 v54, v54, v122, s97
    v_perm_b32 v55, v55, v123, s97
    v_lshl_add_u64 v[54:55], v[54:55], 0, s[30:31]

    ds_add_rtn_u64 v[54:55], v17, v[54:55] offset:50000
    v_mad_i32_i16 v124, v56, v18, s96
    v_mad_i32_i16 v56, v56, v18, s96 op_sel:[1,0,0,0]
    v_mad_i32_i16 v125, v57, v18, s96
    v_mad_i32_i16 v57, v57, v18, s96 op_sel:[1,0,0,0]
    v_lshlrev_b32_sdwa v18, 3, v18 dst_sel:DWORD dst_unused:UNUSED_PAD src0_sel:DWORD src1_sel:WORD_1
    v_perm_b32 v56, v56, v124, s97
    v_perm_b32 v57, v57, v125, s97
    v_lshl_add_u64 v[56:57], v[56:57], 0, s[30:31]

    ds_add_rtn_u64 v[56:57], v18, v[56:57] offset:50000
    v_mad_i32_i16 v126, v58, v19, s96
    v_mad_i32_i16 v58, v58, v19, s96 op_sel:[1,0,0,0]
    v_mad_i32_i16 v127, v59, v19, s96
    v_mad_i32_i16 v59, v59, v19, s96 op_sel:[1,0,0,0]
    v_lshlrev_b32_sdwa v19, 3, v19 dst_sel:DWORD dst_unused:UNUSED_PAD src0_sel:DWORD src1_sel:WORD_1
    v_perm_b32 v58, v58, v126, s97
    v_perm_b32 v59, v59, v127, s97
    v_lshl_add_u64 v[58:59], v[58:59], 0, s[30:31]

    ds_add_rtn_u64 v[58:59], v19, v[58:59] offset:50000
    s_waitcnt lgkmcnt(4)
    v_or3_b32 v1, v44, v45, v1
    v_or3_b32 v1, v46, v47, v1
    v_or3_b32 v1, v48, v49, v1
    v_or3_b32 v1, v50, v51, v1
    v_mad_i32_i16 v120, v60, v20, s96
    v_mad_i32_i16 v60, v60, v20, s96 op_sel:[1,0,0,0]
    v_mad_i32_i16 v121, v61, v20, s96
    v_mad_i32_i16 v61, v61, v20, s96 op_sel:[1,0,0,0]
    v_lshlrev_b32_sdwa v20, 3, v20 dst_sel:DWORD dst_unused:UNUSED_PAD src0_sel:DWORD src1_sel:WORD_1
    v_perm_b32 v60, v60, v120, s97
    v_perm_b32 v61, v61, v121, s97
    v_lshl_add_u64 v[60:61], v[60:61], 0, s[30:31]

    ds_add_rtn_u64 v[60:61], v20, v[60:61] offset:50000
    v_mad_i32_i16 v122, v62, v21, s96
    v_mad_i32_i16 v62, v62, v21, s96 op_sel:[1,0,0,0]
    v_mad_i32_i16 v123, v63, v21, s96
    v_mad_i32_i16 v63, v63, v21, s96 op_sel:[1,0,0,0]
    v_lshlrev_b32_sdwa v21, 3, v21 dst_sel:DWORD dst_unused:UNUSED_PAD src0_sel:DWORD src1_sel:WORD_1
    v_perm_b32 v62, v62, v122, s97
    v_perm_b32 v63, v63, v123, s97
    v_lshl_add_u64 v[62:63], v[62:63], 0, s[30:31]

    ds_add_rtn_u64 v[62:63], v21, v[62:63] offset:50000
    v_mad_i32_i16 v124, v64, v22, s96
    v_mad_i32_i16 v64, v64, v22, s96 op_sel:[1,0,0,0]
    v_mad_i32_i16 v125, v65, v22, s96
    v_mad_i32_i16 v65, v65, v22, s96 op_sel:[1,0,0,0]
    v_lshlrev_b32_sdwa v22, 3, v22 dst_sel:DWORD dst_unused:UNUSED_PAD src0_sel:DWORD src1_sel:WORD_1
    v_perm_b32 v64, v64, v124, s97
    v_perm_b32 v65, v65, v125, s97
    v_lshl_add_u64 v[64:65], v[64:65], 0, s[30:31]

    ds_add_rtn_u64 v[64:65], v22, v[64:65] offset:50000
    v_mad_i32_i16 v126, v66, v23, s96
    v_mad_i32_i16 v66, v66, v23, s96 op_sel:[1,0,0,0]
    v_mad_i32_i16 v127, v67, v23, s96
    v_mad_i32_i16 v67, v67, v23, s96 op_sel:[1,0,0,0]
    v_lshlrev_b32_sdwa v23, 3, v23 dst_sel:DWORD dst_unused:UNUSED_PAD src0_sel:DWORD src1_sel:WORD_1
    v_perm_b32 v66, v66, v126, s97
    v_perm_b32 v67, v67, v127, s97
    v_lshl_add_u64 v[66:67], v[66:67], 0, s[30:31]

    ds_add_rtn_u64 v[66:67], v23, v[66:67] offset:50000
    s_waitcnt lgkmcnt(4)
    v_or3_b32 v1, v52, v53, v1
    v_or3_b32 v1, v54, v55, v1
    v_or3_b32 v1, v56, v57, v1
    v_or3_b32 v1, v58, v59, v1
    v_mad_i32_i16 v120, v68, v24, s96
    v_mad_i32_i16 v68, v68, v24, s96 op_sel:[1,0,0,0]
    v_mad_i32_i16 v121, v69, v24, s96
    v_mad_i32_i16 v69, v69, v24, s96 op_sel:[1,0,0,0]
    v_lshlrev_b32_sdwa v24, 3, v24 dst_sel:DWORD dst_unused:UNUSED_PAD src0_sel:DWORD src1_sel:WORD_1
    v_perm_b32 v68, v68, v120, s97
    v_perm_b32 v69, v69, v121, s97
    v_lshl_add_u64 v[68:69], v[68:69], 0, s[30:31]

    ds_add_rtn_u64 v[68:69], v24, v[68:69] offset:50000
    v_mad_i32_i16 v122, v70, v25, s96
    v_mad_i32_i16 v70, v70, v25, s96 op_sel:[1,0,0,0]
    v_mad_i32_i16 v123, v71, v25, s96
    v_mad_i32_i16 v71, v71, v25, s96 op_sel:[1,0,0,0]
    v_lshlrev_b32_sdwa v25, 3, v25 dst_sel:DWORD dst_unused:UNUSED_PAD src0_sel:DWORD src1_sel:WORD_1
    v_perm_b32 v70, v70, v122, s97
    v_perm_b32 v71, v71, v123, s97
    v_lshl_add_u64 v[70:71], v[70:71], 0, s[30:31]

    ds_add_rtn_u64 v[70:71], v25, v[70:71] offset:50000
    v_mad_i32_i16 v124, v72, v26, s96
    v_mad_i32_i16 v72, v72, v26, s96 op_sel:[1,0,0,0]
    v_mad_i32_i16 v125, v73, v26, s96
    v_mad_i32_i16 v73, v73, v26, s96 op_sel:[1,0,0,0]
    v_lshlrev_b32_sdwa v26, 3, v26 dst_sel:DWORD dst_unused:UNUSED_PAD src0_sel:DWORD src1_sel:WORD_1
    v_perm_b32 v72, v72, v124, s97
    v_perm_b32 v73, v73, v125, s97
    v_lshl_add_u64 v[72:73], v[72:73], 0, s[30:31]

    ds_add_rtn_u64 v[72:73], v26, v[72:73] offset:50000
    v_mad_i32_i16 v126, v74, v27, s96
    v_mad_i32_i16 v74, v74, v27, s96 op_sel:[1,0,0,0]
    v_mad_i32_i16 v127, v75, v27, s96
    v_mad_i32_i16 v75, v75, v27, s96 op_sel:[1,0,0,0]
    v_lshlrev_b32_sdwa v27, 3, v27 dst_sel:DWORD dst_unused:UNUSED_PAD src0_sel:DWORD src1_sel:WORD_1
    v_perm_b32 v74, v74, v126, s97
    v_perm_b32 v75, v75, v127, s97
    v_lshl_add_u64 v[74:75], v[74:75], 0, s[30:31]

    ds_add_rtn_u64 v[74:75], v27, v[74:75] offset:50000
    s_waitcnt lgkmcnt(4)
    v_or3_b32 v1, v60, v61, v1
    v_or3_b32 v1, v62, v63, v1
    v_or3_b32 v1, v64, v65, v1
    v_or3_b32 v1, v66, v67, v1
    s_waitcnt lgkmcnt(0)
    v_or3_b32 v1, v68, v69, v1
    v_or3_b32 v1, v70, v71, v1
    v_or3_b32 v1, v72, v73, v1
    v_or3_b32 v1, v74, v75, v1
    s_waitcnt vmcnt(0)
    s_waitcnt lgkmcnt(0)
    s_load_dwordx4 s[28:31], s[86:87], 0
    s_load_dwordx16 s[68:83], s[88:89], 0
    s_load_dwordx8 s[12:19], s[92:93], 0
    s_load_dwordx8 s[56:63], s[94:95], 0
    s_mov_b64 s[48:49], s[90:91]
    s_load_dwordx16 s[84:99], s[48:49], 0

    s_mov_b32 s41, s37
    s_mul_i32 s3, s41, 3125
    s_add_u32 s5, s3, 3126
    s_add_u32 s3, s3, 1
    s_lshr_b32 s3, s3, 1
    s_lshr_b32 s5, s5, 1
    s_sub_u32 s5, s5, s3
    s_sub_u32 s5, s5, 782
    v_cmp_gt_u32 vcc, s5, v0
    s_mul_i32 s5, s36, 6250
    s_add_u32 s3, s3, s5
    v_add_u32 v6, s3, v0
    v_add_u32 v7, 782, v6
    v_mov_b32 v8, 0x2000000
    v_lshlrev_b32 v4, 4, v6
    v_cndmask_b32 v7, v8, v7, vcc
    v_lshlrev_b32 v6, 2, v6
    v_lshlrev_b32 v5, 4, v7
    v_lshlrev_b32 v7, 2, v7
    v_cmp_gt_u32 vcc, 782, v0
    s_mov_b64 exec, vcc
    s_cbranch_execz L_skld_88
    buffer_load_dword v6, v6, s[64:67], 0 offen
    buffer_load_dword v7, v7, s[64:67], 0 offen
    buffer_load_dwordx4 v[108:111], v4, s[8:11], 0 offen
    buffer_load_dwordx4 v[112:115], v5, s[8:11], 0 offen

L_skld_88:
    s_mov_b64 exec, -1
    s_barrier

    v_add_u32 v116, 50000, v3
    v_add_u32 v117, 115536, v3
    v_cmp_gt_u32 vcc, 106, v0

    v_mov_b32 v100, 0
    v_mov_b32 v101, 0
    v_mov_b32 v102, 0
    v_mov_b32 v103, 0
    ds_read_b128 v[76:79], v116 offset:0
    ds_read_b128 v[80:83], v116 offset:16384
    ds_read_b128 v[84:87], v116 offset:32768
    ds_read_b128 v[88:91], v116 offset:49152
    ds_read_b128 v[92:95], v117 offset:0
    ds_read_b128 v[96:99], v117 offset:16384
    s_mov_b64 exec, vcc
    ds_read_b128 v[100:103], v117 offset:32768
    s_mov_b64 exec, -1
    s_mul_i32 s3, s37, 6400000
    s_mul_i32 s5, s36, 100000
    s_add_u32 s3, s3, s5
    s_add_u32 s3, s3, 6799360

    s_add_u32 s20, s6, s3
    s_addc_u32 s21, s7, 0
    s_mov_b32 s22, 100000
    s_mov_b32 s23, 0x20000
    s_waitcnt lgkmcnt(6)
    s_mov_b32 s3, 0
    buffer_store_dwordx4 v[76:79], v3, s[20:23], s3 offen sc1
    s_waitcnt lgkmcnt(5)
    s_mov_b32 s3, 16384
    buffer_store_dwordx4 v[80:83], v3, s[20:23], s3 offen sc1
    s_waitcnt lgkmcnt(4)
    s_mov_b32 s3, 32768
    buffer_store_dwordx4 v[84:87], v3, s[20:23], s3 offen sc1
    s_waitcnt lgkmcnt(3)
    s_mov_b32 s3, 49152
    buffer_store_dwordx4 v[88:91], v3, s[20:23], s3 offen sc1
    s_waitcnt lgkmcnt(2)
    s_mov_b32 s3, 65536
    buffer_store_dwordx4 v[92:95], v3, s[20:23], s3 offen sc1
    s_waitcnt lgkmcnt(1)
    s_mov_b32 s3, 81920
    buffer_store_dwordx4 v[96:99], v3, s[20:23], s3 offen sc1
    s_waitcnt lgkmcnt(0)
    s_mov_b32 s3, 98304
    buffer_store_dwordx4 v[100:103], v3, s[20:23], s3 offen sc1
    v_or3_b32 v1, v76, v77, v1
    v_or3_b32 v1, v78, v79, v1
    v_or3_b32 v1, v80, v81, v1
    v_or3_b32 v1, v82, v83, v1
    v_or3_b32 v1, v84, v85, v1
    v_or3_b32 v1, v86, v87, v1
    v_or3_b32 v1, v88, v89, v1
    v_or3_b32 v1, v90, v91, v1
    v_or3_b32 v1, v92, v93, v1
    v_or3_b32 v1, v94, v95, v1
    v_or3_b32 v1, v96, v97, v1
    v_or3_b32 v1, v98, v99, v1
    v_or3_b32 v1, v100, v101, v1
    v_or3_b32 v1, v102, v103, v1
    v_and_b32 v1, 0x80008000, v1
    v_cmp_ne_u32 vcc, 0, v1
    v_mov_b32 v116, 150024
    v_mov_b32 v117, 1
    s_cbranch_vccz L_nf_85
    ds_write_b32 v116, v117
L_nf_85:
    s_mov_b32 s33, 1
    s_mov_b32 s42, 0
    v_cmp_gt_u32 vcc, 782, v0
    s_mov_b64 exec, vcc
    s_cbranch_execz L_p1end_90
    s_waitcnt vmcnt(9)
    s_branch L_lddone_87
L_fin_86:

    s_load_dwordx2 s[64:65], s[0:1], 24
    s_load_dwordx2 s[86:87], s[0:1], 40
    s_load_dwordx8 s[88:95], s[0:1], 56
    s_mov_b32 s66, 1600000
    s_mov_b32 s67, 0x20000

    s_waitcnt lgkmcnt(0)
    s_load_dwordx4 s[28:31], s[86:87], 0
    s_load_dwordx16 s[68:83], s[88:89], 0
    s_load_dwordx8 s[12:19], s[92:93], 0
    s_load_dwordx8 s[56:63], s[94:95], 0
    s_mov_b64 s[48:49], s[90:91]
    s_load_dwordx16 s[84:99], s[48:49], 0

    s_mov_b32 s42, 1
    s_mov_b32 s41, s37
L_qloop_89:
    s_mul_i32 s3, s41, 3125
    s_add_u32 s5, s3, 3126
    s_add_u32 s3, s3, 1
    s_lshr_b32 s3, s3, 1
    s_lshr_b32 s5, s5, 1
    s_sub_u32 s5, s5, s3
    s_sub_u32 s5, s5, 782
    v_cmp_gt_u32 vcc, s5, v0
    s_mul_i32 s5, s36, 6250
    s_add_u32 s3, s3, s5
    v_add_u32 v6, s3, v0
    v_add_u32 v7, 782, v6
    v_mov_b32 v8, 0x2000000
    v_lshlrev_b32 v4, 4, v6
    v_cndmask_b32 v7, v8, v7, vcc
    v_lshlrev_b32 v6, 2, v6
    v_lshlrev_b32 v5, 4, v7
    v_lshlrev_b32 v7, 2, v7
    v_cmp_gt_u32 vcc, 782, v0
    s_mov_b64 exec, vcc
    s_cbranch_execz L_p1end_90
    buffer_load_dword v6, v6, s[64:67], 0 offen
    buffer_load_dword v7, v7, s[64:67], 0 offen
    buffer_load_dwordx4 v[108:111], v4, s[8:11], 0 offen
    buffer_load_dwordx4 v[112:115], v5, s[8:11], 0 offen

    s_waitcnt vmcnt(2)
L_lddone_87:
    s_waitcnt lgkmcnt(0)
    v_lshlrev_b32 v8, 16, v6
    v_and_b32 v9, s32, v6
    v_lshlrev_b32 v10, 16, v7
    v_and_b32 v11, s32, v7

    s_lshl_b32 s52, s28, 16
    v_subrev_f32 v12, s52, v8
    v_subrev_f32 v20, s52, v9
    v_subrev_f32 v28, s52, v10
    v_subrev_f32 v36, s52, v11
    s_and_b32 s53, s28, s32
    v_subrev_f32 v13, s53, v8
    v_subrev_f32 v21, s53, v9
    v_subrev_f32 v29, s53, v10
    v_subrev_f32 v37, s53, v11
    s_lshl_b32 s52, s29, 16
    v_subrev_f32 v14, s52, v8
    v_subrev_f32 v22, s52, v9
    v_subrev_f32 v30, s52, v10
    v_subrev_f32 v38, s52, v11
    s_and_b32 s53, s29, s32
    v_subrev_f32 v15, s53, v8
    v_subrev_f32 v23, s53, v9
    v_subrev_f32 v31, s53, v10
    v_subrev_f32 v39, s53, v11
    s_lshl_b32 s52, s30, 16
    v_subrev_f32 v16, s52, v8
    v_subrev_f32 v24, s52, v9
    v_subrev_f32 v32, s52, v10
    v_subrev_f32 v40, s52, v11
    s_and_b32 s53, s30, s32
    v_subrev_f32 v17, s53, v8
    v_subrev_f32 v25, s53, v9
    v_subrev_f32 v33, s53, v10
    v_subrev_f32 v41, s53, v11
    s_lshl_b32 s52, s31, 16
    v_subrev_f32 v18, s52, v8
    v_subrev_f32 v26, s52, v9
    v_subrev_f32 v34, s52, v10
    v_subrev_f32 v42, s52, v11
    s_and_b32 s53, s31, s32
    v_subrev_f32 v19, s53, v8
    v_subrev_f32 v27, s53, v9
    v_subrev_f32 v35, s53, v10
    v_subrev_f32 v43, s53, v11
    v_cvt_pk_bf16_f32 v12, v12, v13
    v_cvt_pk_bf16_f32 v14, v14, v15
    v_cvt_pk_bf16_f32 v16, v16, v17
    v_cvt_pk_bf16_f32 v18, v18, v19
    v_cvt_pk_bf16_f32 v20, v20, v21
    v_cvt_pk_bf16_f32 v22, v22, v23
    v_cvt_pk_bf16_f32 v24, v24, v25
    v_cvt_pk_bf16_f32 v26, v26, v27
    v_cvt_pk_bf16_f32 v28, v28, v29
    v_cvt_pk_bf16_f32 v30, v30, v31
    v_cvt_pk_bf16_f32 v32, v32, v33
    v_cvt_pk_bf16_f32 v34, v34, v35
    v_cvt_pk_bf16_f32 v36, v36, v37
    v_cvt_pk_bf16_f32 v38, v38, v39
    v_cvt_pk_bf16_f32 v40, v40, v41
    v_cvt_pk_bf16_f32 v42, v42, v43
    v_and_b32 v13, s32, v12
    v_lshlrev_b32 v12, 16, v12
    v_and_b32 v15, s32, v14
    v_lshlrev_b32 v14, 16, v14
    v_and_b32 v17, s32, v16
    v_lshlrev_b32 v16, 16, v16
    v_and_b32 v19, s32, v18
    v_lshlrev_b32 v18, 16, v18
    v_and_b32 v21, s32, v20
    v_lshlrev_b32 v20, 16, v20
    v_and_b32 v23, s32, v22
    v_lshlrev_b32 v22, 16, v22
    v_and_b32 v25, s32, v24
    v_lshlrev_b32 v24, 16, v24
    v_and_b32 v27, s32, v26
    v_lshlrev_b32 v26, 16, v26
    v_and_b32 v29, s32, v28
    v_lshlrev_b32 v28, 16, v28
    v_and_b32 v31, s32, v30
    v_lshlrev_b32 v30, 16, v30
    v_and_b32 v33, s32, v32
    v_lshlrev_b32 v32, 16, v32
    v_and_b32 v35, s32, v34
    v_lshlrev_b32 v34, 16, v34
    v_and_b32 v37, s32, v36
    v_lshlrev_b32 v36, 16, v36
    v_and_b32 v39, s32, v38
    v_lshlrev_b32 v38, 16, v38
    v_and_b32 v41, s32, v40
    v_lshlrev_b32 v40, 16, v40
    v_and_b32 v43, s32, v42
    v_lshlrev_b32 v42, 16, v42
    v_mul_f32 v12, v12, v12
    v_mul_f32 v13, v13, v13
    v_mul_f32 v14, v14, v14
    v_mul_f32 v15, v15, v15
    v_mul_f32 v16, v16, v16
    v_mul_f32 v17, v17, v17
    v_mul_f32 v18, v18, v18
    v_mul_f32 v19, v19, v19
    v_mul_f32 v20, v20, v20
    v_mul_f32 v21, v21, v21
    v_mul_f32 v22, v22, v22
    v_mul_f32 v23, v23, v23
    v_mul_f32 v24, v24, v24
    v_mul_f32 v25, v25, v25
    v_mul_f32 v26, v26, v26
    v_mul_f32 v27, v27, v27
    v_mul_f32 v28, v28, v28
    v_mul_f32 v29, v29, v29
    v_mul_f32 v30, v30, v30
    v_mul_f32 v31, v31, v31
    v_mul_f32 v32, v32, v32
    v_mul_f32 v33, v33, v33
    v_mul_f32 v34, v34, v34
    v_mul_f32 v35, v35, v35
    v_mul_f32 v36, v36, v36
    v_mul_f32 v37, v37, v37
    v_mul_f32 v38, v38, v38
    v_mul_f32 v39, v39, v39
    v_mul_f32 v40, v40, v40
    v_mul_f32 v41, v41, v41
    v_mul_f32 v42, v42, v42
    v_mul_f32 v43, v43, v43
    v_cvt_pk_bf16_f32 v12, v12, v13
    v_cvt_pk_bf16_f32 v14, v14, v15
    v_cvt_pk_bf16_f32 v16, v16, v17
    v_cvt_pk_bf16_f32 v18, v18, v19
    v_cvt_pk_bf16_f32 v20, v20, v21
    v_cvt_pk_bf16_f32 v22, v22, v23
    v_cvt_pk_bf16_f32 v24, v24, v25
    v_cvt_pk_bf16_f32 v26, v26, v27
    v_cvt_pk_bf16_f32 v28, v28, v29
    v_cvt_pk_bf16_f32 v30, v30, v31
    v_cvt_pk_bf16_f32 v32, v32, v33
    v_cvt_pk_bf16_f32 v34, v34, v35
    v_cvt_pk_bf16_f32 v36, v36, v37
    v_cvt_pk_bf16_f32 v38, v38, v39
    v_cvt_pk_bf16_f32 v40, v40, v41
    v_cvt_pk_bf16_f32 v42, v42, v43
    v_and_b32 v13, s32, v12
    v_lshlrev_b32 v12, 16, v12
    v_and_b32 v15, s32, v14
    v_lshlrev_b32 v14, 16, v14
    v_and_b32 v17, s32, v16
    v_lshlrev_b32 v16, 16, v16
    v_and_b32 v19, s32, v18
    v_lshlrev_b32 v18, 16, v18
    v_and_b32 v21, s32, v20
    v_lshlrev_b32 v20, 16, v20
    v_and_b32 v23, s32, v22
    v_lshlrev_b32 v22, 16, v22
    v_and_b32 v25, s32, v24
    v_lshlrev_b32 v24, 16, v24
    v_and_b32 v27, s32, v26
    v_lshlrev_b32 v26, 16, v26
    v_and_b32 v29, s32, v28
    v_lshlrev_b32 v28, 16, v28
    v_and_b32 v31, s32, v30
    v_lshlrev_b32 v30, 16, v30
    v_and_b32 v33, s32, v32
    v_lshlrev_b32 v32, 16, v32
    v_and_b32 v35, s32, v34
    v_lshlrev_b32 v34, 16, v34
    v_and_b32 v37, s32, v36
    v_lshlrev_b32 v36, 16, v36
    v_and_b32 v39, s32, v38
    v_lshlrev_b32 v38, 16, v38
    v_and_b32 v41, s32, v40
    v_lshlrev_b32 v40, 16, v40
    v_and_b32 v43, s32, v42
    v_lshlrev_b32 v42, 16, v42
    v_mul_f32 v12, 0xc1200000, v12
    v_mul_f32 v13, 0xc1200000, v13
    v_mul_f32 v14, 0xc1200000, v14
    v_mul_f32 v15, 0xc1200000, v15
    v_mul_f32 v16, 0xc1200000, v16
    v_mul_f32 v17, 0xc1200000, v17
    v_mul_f32 v18, 0xc1200000, v18
    v_mul_f32 v19, 0xc1200000, v19
    v_mul_f32 v20, 0xc1200000, v20
    v_mul_f32 v21, 0xc1200000, v21
    v_mul_f32 v22, 0xc1200000, v22
    v_mul_f32 v23, 0xc1200000, v23
    v_mul_f32 v24, 0xc1200000, v24
    v_mul_f32 v25, 0xc1200000, v25
    v_mul_f32 v26, 0xc1200000, v26
    v_mul_f32 v27, 0xc1200000, v27
    v_mul_f32 v28, 0xc1200000, v28
    v_mul_f32 v29, 0xc1200000, v29
    v_mul_f32 v30, 0xc1200000, v30
    v_mul_f32 v31, 0xc1200000, v31
    v_mul_f32 v32, 0xc1200000, v32
    v_mul_f32 v33, 0xc1200000, v33
    v_mul_f32 v34, 0xc1200000, v34
    v_mul_f32 v35, 0xc1200000, v35
    v_mul_f32 v36, 0xc1200000, v36
    v_mul_f32 v37, 0xc1200000, v37
    v_mul_f32 v38, 0xc1200000, v38
    v_mul_f32 v39, 0xc1200000, v39
    v_mul_f32 v40, 0xc1200000, v40
    v_mul_f32 v41, 0xc1200000, v41
    v_mul_f32 v42, 0xc1200000, v42
    v_mul_f32 v43, 0xc1200000, v43
    v_cvt_pk_bf16_f32 v12, v12, v13
    v_cvt_pk_bf16_f32 v14, v14, v15
    v_cvt_pk_bf16_f32 v16, v16, v17
    v_cvt_pk_bf16_f32 v18, v18, v19
    v_cvt_pk_bf16_f32 v20, v20, v21
    v_cvt_pk_bf16_f32 v22, v22, v23
    v_cvt_pk_bf16_f32 v24, v24, v25
    v_cvt_pk_bf16_f32 v26, v26, v27
    v_cvt_pk_bf16_f32 v28, v28, v29
    v_cvt_pk_bf16_f32 v30, v30, v31
    v_cvt_pk_bf16_f32 v32, v32, v33
    v_cvt_pk_bf16_f32 v34, v34, v35
    v_cvt_pk_bf16_f32 v36, v36, v37
    v_cvt_pk_bf16_f32 v38, v38, v39
    v_cvt_pk_bf16_f32 v40, v40, v41
    v_cvt_pk_bf16_f32 v42, v42, v43
    v_and_b32 v13, s32, v12
    v_lshlrev_b32 v12, 16, v12
    v_and_b32 v15, s32, v14
    v_lshlrev_b32 v14, 16, v14
    v_and_b32 v17, s32, v16
    v_lshlrev_b32 v16, 16, v16
    v_and_b32 v19, s32, v18
    v_lshlrev_b32 v18, 16, v18
    v_and_b32 v21, s32, v20
    v_lshlrev_b32 v20, 16, v20
    v_and_b32 v23, s32, v22
    v_lshlrev_b32 v22, 16, v22
    v_and_b32 v25, s32, v24
    v_lshlrev_b32 v24, 16, v24
    v_and_b32 v27, s32, v26
    v_lshlrev_b32 v26, 16, v26
    v_and_b32 v29, s32, v28
    v_lshlrev_b32 v28, 16, v28
    v_and_b32 v31, s32, v30
    v_lshlrev_b32 v30, 16, v30
    v_and_b32 v33, s32, v32
    v_lshlrev_b32 v32, 16, v32
    v_and_b32 v35, s32, v34
    v_lshlrev_b32 v34, 16, v34
    v_and_b32 v37, s32, v36
    v_lshlrev_b32 v36, 16, v36
    v_and_b32 v39, s32, v38
    v_lshlrev_b32 v38, 16, v38
    v_and_b32 v41, s32, v40
    v_lshlrev_b32 v40, 16, v40
    v_and_b32 v43, s32, v42
    v_lshlrev_b32 v42, 16, v42
    v_mul_f32 v12, 0x3fb8aa3b, v12
    v_mul_f32 v13, 0x3fb8aa3b, v13
    v_mul_f32 v14, 0x3fb8aa3b, v14
    v_mul_f32 v15, 0x3fb8aa3b, v15
    v_mul_f32 v16, 0x3fb8aa3b, v16
    v_mul_f32 v17, 0x3fb8aa3b, v17
    v_mul_f32 v18, 0x3fb8aa3b, v18
    v_mul_f32 v19, 0x3fb8aa3b, v19
    v_mul_f32 v20, 0x3fb8aa3b, v20
    v_mul_f32 v21, 0x3fb8aa3b, v21
    v_mul_f32 v22, 0x3fb8aa3b, v22
    v_mul_f32 v23, 0x3fb8aa3b, v23
    v_mul_f32 v24, 0x3fb8aa3b, v24
    v_mul_f32 v25, 0x3fb8aa3b, v25
    v_mul_f32 v26, 0x3fb8aa3b, v26
    v_mul_f32 v27, 0x3fb8aa3b, v27
    v_mul_f32 v28, 0x3fb8aa3b, v28
    v_mul_f32 v29, 0x3fb8aa3b, v29
    v_mul_f32 v30, 0x3fb8aa3b, v30
    v_mul_f32 v31, 0x3fb8aa3b, v31
    v_mul_f32 v32, 0x3fb8aa3b, v32
    v_mul_f32 v33, 0x3fb8aa3b, v33
    v_mul_f32 v34, 0x3fb8aa3b, v34
    v_mul_f32 v35, 0x3fb8aa3b, v35
    v_mul_f32 v36, 0x3fb8aa3b, v36
    v_mul_f32 v37, 0x3fb8aa3b, v37
    v_mul_f32 v38, 0x3fb8aa3b, v38
    v_mul_f32 v39, 0x3fb8aa3b, v39
    v_mul_f32 v40, 0x3fb8aa3b, v40
    v_mul_f32 v41, 0x3fb8aa3b, v41
    v_mul_f32 v42, 0x3fb8aa3b, v42
    v_mul_f32 v43, 0x3fb8aa3b, v43
    v_exp_f32 v12, v12
    v_exp_f32 v13, v13
    v_exp_f32 v14, v14
    v_exp_f32 v15, v15
    v_exp_f32 v16, v16
    v_exp_f32 v17, v17
    v_exp_f32 v18, v18
    v_exp_f32 v19, v19
    v_exp_f32 v20, v20
    v_exp_f32 v21, v21
    v_exp_f32 v22, v22
    v_exp_f32 v23, v23
    v_exp_f32 v24, v24
    v_exp_f32 v25, v25
    v_exp_f32 v26, v26
    v_exp_f32 v27, v27
    v_exp_f32 v28, v28
    v_exp_f32 v29, v29
    v_exp_f32 v30, v30
    v_exp_f32 v31, v31
    v_exp_f32 v32, v32
    v_exp_f32 v33, v33
    v_exp_f32 v34, v34
    v_exp_f32 v35, v35
    v_exp_f32 v36, v36
    v_exp_f32 v37, v37
    v_exp_f32 v38, v38
    v_exp_f32 v39, v39
    v_exp_f32 v40, v40
    v_exp_f32 v41, v41
    v_exp_f32 v42, v42
    v_exp_f32 v43, v43
    s_nop 0
    v_cvt_pk_bf16_f32 v12, v12, v13
    v_cvt_pk_bf16_f32 v14, v14, v15
    v_cvt_pk_bf16_f32 v16, v16, v17
    v_cvt_pk_bf16_f32 v18, v18, v19
    v_cvt_pk_bf16_f32 v20, v20, v21
    v_cvt_pk_bf16_f32 v22, v22, v23
    v_cvt_pk_bf16_f32 v24, v24, v25
    v_cvt_pk_bf16_f32 v26, v26, v27
    v_cvt_pk_bf16_f32 v28, v28, v29
    v_cvt_pk_bf16_f32 v30, v30, v31
    v_cvt_pk_bf16_f32 v32, v32, v33
    v_cvt_pk_bf16_f32 v34, v34, v35
    v_cvt_pk_bf16_f32 v36, v36, v37
    v_cvt_pk_bf16_f32 v38, v38, v39
    v_cvt_pk_bf16_f32 v40, v40, v41
    v_cvt_pk_bf16_f32 v42, v42, v43
L_p1end_90:
    s_mov_b64 exec, -1
    s_cmp_eq_u32 s42, 2
    s_cbranch_scc1 L_part2_91
    s_waitcnt vmcnt(0) lgkmcnt(0)
    s_barrier
    s_cmp_lg_u32 s42, 0
    s_cbranch_scc1 L_nochk_97
    v_mov_b32 v116, 150024
    ds_read_b32 v117, v116
    s_waitcnt lgkmcnt(0)
    v_readfirstlane_b32 s3, v117
    s_nop 1
    s_cmp_lg_u32 s3, 0
    s_cbranch_scc1 L_p2slow_51
L_nochk_97:

    s_load_dwordx2 s[24:25], s[0:1], 88
    s_load_dwordx2 s[44:45], s[0:1], 96
    s_mov_b32 s26, 6400000
    s_mov_b32 s27, 0x20000
    s_movk_i32 s46, 256
    s_mov_b32 s47, 0x20000
    s_lshl_b32 s50, s36, 2
    v_and_b32 v116, 63, v0
    v_lshlrev_b32 v116, 20, v116

    s_add_u32 s20, s6, 6799360
    s_addc_u32 s21, s7, 0
    s_mov_b32 s22, 76800000
    s_mov_b32 s23, 0x20000
    v_readfirstlane_b32 s3, v0
    s_waitcnt lgkmcnt(0)
    s_cmp_eq_u32 s3, 960
    s_cbranch_scc1 L_sync_98
L_part2_91:
    v_cmp_gt_u32 vcc, 782, v0
    s_mov_b64 exec, vcc
    s_cbranch_execz L_p2end_92

    s_pack_ll_b32_b16 s52, s68, s70
    v_dot2_f32_bf16 v60, v12, s52, 0
    v_dot2_f32_bf16 v64, v20, s52, 0
    v_dot2_f32_bf16 v68, v28, s52, 0
    v_dot2_f32_bf16 v72, v36, s52, 0
    s_pack_hh_b32_b16 s53, s68, s70
    v_dot2_f32_bf16 v61, v12, s53, 0
    v_dot2_f32_bf16 v65, v20, s53, 0
    v_dot2_f32_bf16 v69, v28, s53, 0
    v_dot2_f32_bf16 v73, v36, s53, 0
    s_pack_ll_b32_b16 s52, s69, s71
    v_dot2_f32_bf16 v62, v12, s52, 0
    v_dot2_f32_bf16 v66, v20, s52, 0
    v_dot2_f32_bf16 v70, v28, s52, 0
    v_dot2_f32_bf16 v74, v36, s52, 0
    s_pack_hh_b32_b16 s53, s69, s71
    v_dot2_f32_bf16 v63, v12, s53, 0
    v_dot2_f32_bf16 v67, v20, s53, 0
    v_dot2_f32_bf16 v71, v28, s53, 0
    v_dot2_f32_bf16 v75, v36, s53, 0
    s_pack_ll_b32_b16 s52, s72, s74
    v_dot2_f32_bf16 v60, v14, s52, v60
    v_dot2_f32_bf16 v64, v22, s52, v64
    v_dot2_f32_bf16 v68, v30, s52, v68
    v_dot2_f32_bf16 v72, v38, s52, v72
    s_pack_hh_b32_b16 s53, s72, s74
    v_dot2_f32_bf16 v61, v14, s53, v61
    v_dot2_f32_bf16 v65, v22, s53, v65
    v_dot2_f32_bf16 v69, v30, s53, v69
    v_dot2_f32_bf16 v73, v38, s53, v73
    s_pack_ll_b32_b16 s52, s73, s75
    v_dot2_f32_bf16 v62, v14, s52, v62
    v_dot2_f32_bf16 v66, v22, s52, v66
    v_dot2_f32_bf16 v70, v30, s52, v70
    v_dot2_f32_bf16 v74, v38, s52, v74
    s_pack_hh_b32_b16 s53, s73, s75
    v_dot2_f32_bf16 v63, v14, s53, v63
    v_dot2_f32_bf16 v67, v22, s53, v67
    v_dot2_f32_bf16 v71, v30, s53, v71
    v_dot2_f32_bf16 v75, v38, s53, v75
    s_pack_ll_b32_b16 s52, s76, s78
    v_dot2_f32_bf16 v60, v16, s52, v60
    v_dot2_f32_bf16 v64, v24, s52, v64
    v_dot2_f32_bf16 v68, v32, s52, v68
    v_dot2_f32_bf16 v72, v40, s52, v72
    s_pack_hh_b32_b16 s53, s76, s78
    v_dot2_f32_bf16 v61, v16, s53, v61
    v_dot2_f32_bf16 v65, v24, s53, v65
    v_dot2_f32_bf16 v69, v32, s53, v69
    v_dot2_f32_bf16 v73, v40, s53, v73
    s_pack_ll_b32_b16 s52, s77, s79
    v_dot2_f32_bf16 v62, v16, s52, v62
    v_dot2_f32_bf16 v66, v24, s52, v66
    v_dot2_f32_bf16 v70, v32, s52, v70
    v_dot2_f32_bf16 v74, v40, s52, v74
    s_pack_hh_b32_b16 s53, s77, s79
    v_dot2_f32_bf16 v63, v16, s53, v63
    v_dot2_f32_bf16 v67, v24, s53, v67
    v_dot2_f32_bf16 v71, v32, s53, v71
    v_dot2_f32_bf16 v75, v40, s53, v75
    s_pack_ll_b32_b16 s52, s80, s82
    v_dot2_f32_bf16 v60, v18, s52, v60
    v_dot2_f32_bf16 v64, v26, s52, v64
    v_dot2_f32_bf16 v68, v34, s52, v68
    v_dot2_f32_bf16 v72, v42, s52, v72
    s_pack_hh_b32_b16 s53, s80, s82
    v_dot2_f32_bf16 v61, v18, s53, v61
    v_dot2_f32_bf16 v65, v26, s53, v65
    v_dot2_f32_bf16 v69, v34, s53, v69
    v_dot2_f32_bf16 v73, v42, s53, v73
    s_pack_ll_b32_b16 s52, s81, s83
    v_dot2_f32_bf16 v62, v18, s52, v62
    v_dot2_f32_bf16 v66, v26, s52, v66
    v_dot2_f32_bf16 v70, v34, s52, v70
    v_dot2_f32_bf16 v74, v42, s52, v74
    s_pack_hh_b32_b16 s53, s81, s83
    v_dot2_f32_bf16 v63, v18, s53, v63
    v_dot2_f32_bf16 v67, v26, s53, v67
    v_dot2_f32_bf16 v71, v34, s53, v71
    v_dot2_f32_bf16 v75, v42, s53, v75
    s_pack_ll_b32_b16 s52, s84, s86
    v_dot2_f32_bf16 v44, v12, s52, 0
    v_dot2_f32_bf16 v48, v20, s52, 0
    v_dot2_f32_bf16 v52, v28, s52, 0
    v_dot2_f32_bf16 v56, v36, s52, 0
    s_pack_hh_b32_b16 s53, s84, s86
    v_dot2_f32_bf16 v45, v12, s53, 0
    v_dot2_f32_bf16 v49, v20, s53, 0
    v_dot2_f32_bf16 v53, v28, s53, 0
    v_dot2_f32_bf16 v57, v36, s53, 0
    s_pack_ll_b32_b16 s52, s85, s87
    v_dot2_f32_bf16 v46, v12, s52, 0
    v_dot2_f32_bf16 v50, v20, s52, 0
    v_dot2_f32_bf16 v54, v28, s52, 0
    v_dot2_f32_bf16 v58, v36, s52, 0
    s_pack_hh_b32_b16 s53, s85, s87
    v_dot2_f32_bf16 v47, v12, s53, 0
    v_dot2_f32_bf16 v51, v20, s53, 0
    v_dot2_f32_bf16 v55, v28, s53, 0
    v_dot2_f32_bf16 v59, v36, s53, 0
    s_pack_ll_b32_b16 s52, s88, s90
    v_dot2_f32_bf16 v44, v14, s52, v44
    v_dot2_f32_bf16 v48, v22, s52, v48
    v_dot2_f32_bf16 v52, v30, s52, v52
    v_dot2_f32_bf16 v56, v38, s52, v56
    s_pack_hh_b32_b16 s53, s88, s90
    v_dot2_f32_bf16 v45, v14, s53, v45
    v_dot2_f32_bf16 v49, v22, s53, v49
    v_dot2_f32_bf16 v53, v30, s53, v53
    v_dot2_f32_bf16 v57, v38, s53, v57
    s_pack_ll_b32_b16 s52, s89, s91
    v_dot2_f32_bf16 v46, v14, s52, v46
    v_dot2_f32_bf16 v50, v22, s52, v50
    v_dot2_f32_bf16 v54, v30, s52, v54
    v_dot2_f32_bf16 v58, v38, s52, v58
    s_pack_hh_b32_b16 s53, s89, s91
    v_dot2_f32_bf16 v47, v14, s53, v47
    v_dot2_f32_bf16 v51, v22, s53, v51
    v_dot2_f32_bf16 v55, v30, s53, v55
    v_dot2_f32_bf16 v59, v38, s53, v59
    s_pack_ll_b32_b16 s52, s92, s94
    v_dot2_f32_bf16 v44, v16, s52, v44
    v_dot2_f32_bf16 v48, v24, s52, v48
    v_dot2_f32_bf16 v52, v32, s52, v52
    v_dot2_f32_bf16 v56, v40, s52, v56
    s_pack_hh_b32_b16 s53, s92, s94
    v_dot2_f32_bf16 v45, v16, s53, v45
    v_dot2_f32_bf16 v49, v24, s53, v49
    v_dot2_f32_bf16 v53, v32, s53, v53
    v_dot2_f32_bf16 v57, v40, s53, v57
    s_pack_ll_b32_b16 s52, s93, s95
    v_dot2_f32_bf16 v46, v16, s52, v46
    v_dot2_f32_bf16 v50, v24, s52, v50
    v_dot2_f32_bf16 v54, v32, s52, v54
    v_dot2_f32_bf16 v58, v40, s52, v58
    s_pack_hh_b32_b16 s53, s93, s95
    v_dot2_f32_bf16 v47, v16, s53, v47
    v_dot2_f32_bf16 v51, v24, s53, v51
    v_dot2_f32_bf16 v55, v32, s53, v55
    v_dot2_f32_bf16 v59, v40, s53, v59
    s_pack_ll_b32_b16 s52, s96, s98
    v_dot2_f32_bf16 v44, v18, s52, v44
    v_dot2_f32_bf16 v48, v26, s52, v48
    v_dot2_f32_bf16 v52, v34, s52, v52
    v_dot2_f32_bf16 v56, v42, s52, v56
    s_pack_hh_b32_b16 s53, s96, s98
    v_dot2_f32_bf16 v45, v18, s53, v45
    v_dot2_f32_bf16 v49, v26, s53, v49
    v_dot2_f32_bf16 v53, v34, s53, v53
    v_dot2_f32_bf16 v57, v42, s53, v57
    s_pack_ll_b32_b16 s52, s97, s99
    v_dot2_f32_bf16 v46, v18, s52, v46
    v_dot2_f32_bf16 v50, v26, s52, v50
    v_dot2_f32_bf16 v54, v34, s52, v54
    v_dot2_f32_bf16 v58, v42, s52, v58
    s_pack_hh_b32_b16 s53, s97, s99
    v_dot2_f32_bf16 v47, v18, s53, v47
    v_dot2_f32_bf16 v51, v26, s53, v51
    v_dot2_f32_bf16 v55, v34, s53, v55
    v_dot2_f32_bf16 v59, v42, s53, v59
    v_cvt_pk_bf16_f32 v60, v60, v61
    v_cvt_pk_bf16_f32 v62, v62, v63
    v_cvt_pk_bf16_f32 v64, v64, v65
    v_cvt_pk_bf16_f32 v66, v66, v67
    v_cvt_pk_bf16_f32 v68, v68, v69
    v_cvt_pk_bf16_f32 v70, v70, v71
    v_cvt_pk_bf16_f32 v72, v72, v73
    v_cvt_pk_bf16_f32 v74, v74, v75
    v_and_b32 v61, s32, v60
    v_lshlrev_b32 v60, 16, v60
    v_and_b32 v63, s32, v62
    v_lshlrev_b32 v62, 16, v62
    v_and_b32 v65, s32, v64
    v_lshlrev_b32 v64, 16, v64
    v_and_b32 v67, s32, v66
    v_lshlrev_b32 v66, 16, v66
    v_and_b32 v69, s32, v68
    v_lshlrev_b32 v68, 16, v68
    v_and_b32 v71, s32, v70
    v_lshlrev_b32 v70, 16, v70
    v_and_b32 v73, s32, v72
    v_lshlrev_b32 v72, 16, v72
    v_and_b32 v75, s32, v74
    v_lshlrev_b32 v74, 16, v74
L_p2end_92:
    s_mov_b64 exec, -1
    s_cmp_eq_u32 s42, 2
    s_cbranch_scc1 L_post_95
L_bcast_93:
    v_mov_b32 v118, 150016
    s_mov_b32 s42, 2
    s_waitcnt lgkmcnt(0)
    s_barrier
    ds_read_b32 v117, v118
    s_waitcnt lgkmcnt(0)
    v_readfirstlane_b32 s35, v117
    s_nop 1
    s_bitcmp1_b32 s35, 16
    s_cbranch_scc1 L_nextq_94
L_post_95:
    v_cmp_gt_u32 vcc, 782, v0
    s_mov_b64 exec, vcc
    s_cbranch_execz L_postend_96

    s_mov_b32 s3, 0
    buffer_load_dwordx4 v[76:79], v4, s[20:23], s3 offen sc1
    buffer_load_dwordx4 v[92:95], v5, s[20:23], s3 offen sc1
    s_mov_b32 s3, 6400000
    buffer_load_dwordx4 v[80:83], v4, s[20:23], s3 offen sc1
    buffer_load_dwordx4 v[96:99], v5, s[20:23], s3 offen sc1
    s_mov_b32 s3, 12800000
    buffer_load_dwordx4 v[84:87], v4, s[20:23], s3 offen sc1
    buffer_load_dwordx4 v[100:103], v5, s[20:23], s3 offen sc1
    s_mov_b32 s3, 19200000
    buffer_load_dwordx4 v[88:91], v4, s[20:23], s3 offen sc1
    buffer_load_dwordx4 v[104:107], v5, s[20:23], s3 offen sc1
    s_and_b32 s3, s35, 0xf0
    s_cbranch_scc1 L_fgen_102
    s_waitcnt vmcnt(0)

    v_add_u32 v76, v76, v80
    v_add_u32 v84, v84, v88
    v_add_u32 v77, v77, v81
    v_add_u32 v85, v85, v89
    v_add_u32 v78, v78, v82
    v_add_u32 v86, v86, v90
    v_add_u32 v79, v79, v83
    v_add_u32 v87, v87, v91
    v_add_u32_sdwa v12, v76, v84 dst_sel:DWORD dst_unused:UNUSED_PAD src0_sel:WORD_0 src1_sel:WORD_0
    v_add_u32_sdwa v13, v76, v84 dst_sel:DWORD dst_unused:UNUSED_PAD src0_sel:WORD_1 src1_sel:WORD_1
    v_add_u32_sdwa v14, v77, v85 dst_sel:DWORD dst_unused:UNUSED_PAD src0_sel:WORD_0 src1_sel:WORD_0
    v_add_u32_sdwa v15, v77, v85 dst_sel:DWORD dst_unused:UNUSED_PAD src0_sel:WORD_1 src1_sel:WORD_1
    v_add_u32_sdwa v16, v78, v86 dst_sel:DWORD dst_unused:UNUSED_PAD src0_sel:WORD_0 src1_sel:WORD_0
    v_add_u32_sdwa v17, v78, v86 dst_sel:DWORD dst_unused:UNUSED_PAD src0_sel:WORD_1 src1_sel:WORD_1
    v_add_u32_sdwa v18, v79, v87 dst_sel:DWORD dst_unused:UNUSED_PAD src0_sel:WORD_0 src1_sel:WORD_0
    v_add_u32_sdwa v19, v79, v87 dst_sel:DWORD dst_unused:UNUSED_PAD src0_sel:WORD_1 src1_sel:WORD_1
    v_add_u32 v92, v92, v96
    v_add_u32 v100, v100, v104
    v_add_u32 v93, v93, v97
    v_add_u32 v101, v101, v105
    v_add_u32 v94, v94, v98
    v_add_u32 v102, v102, v106
    v_add_u32 v95, v95, v99
    v_add_u32 v103, v103, v107
    v_add_u32_sdwa v20, v92, v100 dst_sel:DWORD dst_unused:UNUSED_PAD src0_sel:WORD_0 src1_sel:WORD_0
    v_add_u32_sdwa v21, v92, v100 dst_sel:DWORD dst_unused:UNUSED_PAD src0_sel:WORD_1 src1_sel:WORD_1
    v_add_u32_sdwa v22, v93, v101 dst_sel:DWORD dst_unused:UNUSED_PAD src0_sel:WORD_0 src1_sel:WORD_0
    v_add_u32_sdwa v23, v93, v101 dst_sel:DWORD dst_unused:UNUSED_PAD src0_sel:WORD_1 src1_sel:WORD_1
    v_add_u32_sdwa v24, v94, v102 dst_sel:DWORD dst_unused:UNUSED_PAD src0_sel:WORD_0 src1_sel:WORD_0
    v_add_u32_sdwa v25, v94, v102 dst_sel:DWORD dst_unused:UNUSED_PAD src0_sel:WORD_1 src1_sel:WORD_1
    v_add_u32_sdwa v26, v95, v103 dst_sel:DWORD dst_unused:UNUSED_PAD src0_sel:WORD_0 src1_sel:WORD_0
    v_add_u32_sdwa v27, v95, v103 dst_sel:DWORD dst_unused:UNUSED_PAD src0_sel:WORD_1 src1_sel:WORD_1
    v_add_u32 v12, 0xffff0000, v12
    v_add_u32 v13, 0xffff0000, v13
    v_add_u32 v14, 0xffff0000, v14
    v_add_u32 v15, 0xffff0000, v15
    v_add_u32 v16, 0xffff0000, v16
    v_add_u32 v17, 0xffff0000, v17
    v_add_u32 v18, 0xffff0000, v18
    v_add_u32 v19, 0xffff0000, v19
    v_add_u32 v20, 0xffff0000, v20
    v_add_u32 v21, 0xffff0000, v21
    v_add_u32 v22, 0xffff0000, v22
    v_add_u32 v23, 0xffff0000, v23
    v_add_u32 v24, 0xffff0000, v24
    v_add_u32 v25, 0xffff0000, v25
    v_add_u32 v26, 0xffff0000, v26
    v_add_u32 v27, 0xffff0000, v27
    v_cvt_f32_i32 v12, v12
    v_cvt_f32_i32 v13, v13
    v_cvt_f32_i32 v14, v14
    v_cvt_f32_i32 v15, v15
    v_cvt_f32_i32 v16, v16
    v_cvt_f32_i32 v17, v17
    v_cvt_f32_i32 v18, v18
    v_cvt_f32_i32 v19, v19
    v_cvt_f32_i32 v20, v20
    v_cvt_f32_i32 v21, v21
    v_cvt_f32_i32 v22, v22
    v_cvt_f32_i32 v23, v23
    v_cvt_f32_i32 v24, v24
    v_cvt_f32_i32 v25, v25
    v_cvt_f32_i32 v26, v26
    v_cvt_f32_i32 v27, v27
    v_mul_f32 v12, s34, v12
    v_mul_f32 v13, s34, v13
    v_mul_f32 v14, s34, v14
    v_mul_f32 v15, s34, v15
    v_mul_f32 v16, s34, v16
    v_mul_f32 v17, s34, v17
    v_mul_f32 v18, s34, v18
    v_mul_f32 v19, s34, v19
    v_mul_f32 v20, s34, v20
    v_mul_f32 v21, s34, v21
    v_mul_f32 v22, s34, v22
    v_mul_f32 v23, s34, v23
    v_mul_f32 v24, s34, v24
    v_mul_f32 v25, s34, v25
    v_mul_f32 v26, s34, v26
    v_mul_f32 v27, s34, v27
L_fbk_103:
    s_lshl_b32 s52, s12, 16
    v_mul_f32 v28, s52, v12
    v_mul_f32 v32, s52, v16
    v_mul_f32 v36, s52, v20
    v_mul_f32 v40, s52, v24
    s_and_b32 s53, s12, s32
    v_mul_f32 v29, s53, v12
    v_mul_f32 v33, s53, v16
    v_mul_f32 v37, s53, v20
    v_mul_f32 v41, s53, v24
    s_lshl_b32 s52, s13, 16
    v_mul_f32 v30, s52, v12
    v_mul_f32 v34, s52, v16
    v_mul_f32 v38, s52, v20
    v_mul_f32 v42, s52, v24
    s_and_b32 s53, s13, s32
    v_mul_f32 v31, s53, v12
    v_mul_f32 v35, s53, v16
    v_mul_f32 v39, s53, v20
    v_mul_f32 v43, s53, v24
    s_lshl_b32 s52, s14, 16
    v_fmac_f32 v28, s52, v13
    v_fmac_f32 v32, s52, v17
    v_fmac_f32 v36, s52, v21
    v_fmac_f32 v40, s52, v25
    s_and_b32 s53, s14, s32
    v_fmac_f32 v29, s53, v13
    v_fmac_f32 v33, s53, v17
    v_fmac_f32 v37, s53, v21
    v_fmac_f32 v41, s53, v25
    s_lshl_b32 s52, s15, 16
    v_fmac_f32 v30, s52, v13
    v_fmac_f32 v34, s52, v17
    v_fmac_f32 v38, s52, v21
    v_fmac_f32 v42, s52, v25
    s_and_b32 s53, s15, s32
    v_fmac_f32 v31, s53, v13
    v_fmac_f32 v35, s53, v17
    v_fmac_f32 v39, s53, v21
    v_fmac_f32 v43, s53, v25
    s_lshl_b32 s52, s16, 16
    v_fmac_f32 v28, s52, v14
    v_fmac_f32 v32, s52, v18
    v_fmac_f32 v36, s52, v22
    v_fmac_f32 v40, s52, v26
    s_and_b32 s53, s16, s32
    v_fmac_f32 v29, s53, v14
    v_fmac_f32 v33, s53, v18
    v_fmac_f32 v37, s53, v22
    v_fmac_f32 v41, s53, v26
    s_lshl_b32 s52, s17, 16
    v_fmac_f32 v30, s52, v14
    v_fmac_f32 v34, s52, v18
    v_fmac_f32 v38, s52, v22
    v_fmac_f32 v42, s52, v26
    s_and_b32 s53, s17, s32
    v_fmac_f32 v31, s53, v14
    v_fmac_f32 v35, s53, v18
    v_fmac_f32 v39, s53, v22
    v_fmac_f32 v43, s53, v26
    s_lshl_b32 s52, s18, 16
    v_fmac_f32 v28, s52, v15
    v_fmac_f32 v32, s52, v19
    v_fmac_f32 v36, s52, v23
    v_fmac_f32 v40, s52, v27
    s_and_b32 s53, s18, s32
    v_fmac_f32 v29, s53, v15
    v_fmac_f32 v33, s53, v19
    v_fmac_f32 v37, s53, v23
    v_fmac_f32 v41, s53, v27
    s_lshl_b32 s52, s19, 16
    v_fmac_f32 v30, s52, v15
    v_fmac_f32 v34, s52, v19
    v_fmac_f32 v38, s52, v23
    v_fmac_f32 v42, s52, v27
    s_and_b32 s53, s19, s32
    v_fmac_f32 v31, s53, v15
    v_fmac_f32 v35, s53, v19
    v_fmac_f32 v39, s53, v23
    v_fmac_f32 v43, s53, v27
    v_mul_f32 v28, v28, v44
    v_mul_f32 v29, v29, v45
    v_mul_f32 v30, v30, v46
    v_mul_f32 v31, v31, v47
    v_mul_f32 v32, v32, v48
    v_mul_f32 v33, v33, v49
    v_mul_f32 v34, v34, v50
    v_mul_f32 v35, v35, v51
    v_mul_f32 v36, v36, v52
    v_mul_f32 v37, v37, v53
    v_mul_f32 v38, v38, v54
    v_mul_f32 v39, v39, v55
    v_mul_f32 v40, v40, v56
    v_mul_f32 v41, v41, v57
    v_mul_f32 v42, v42, v58
    v_mul_f32 v43, v43, v59
    v_cvt_pk_bf16_f32 v28, v28, v29
    v_cvt_pk_bf16_f32 v30, v30, v31
    v_cvt_pk_bf16_f32 v32, v32, v33
    v_cvt_pk_bf16_f32 v34, v34, v35
    v_cvt_pk_bf16_f32 v36, v36, v37
    v_cvt_pk_bf16_f32 v38, v38, v39
    v_cvt_pk_bf16_f32 v40, v40, v41
    v_cvt_pk_bf16_f32 v42, v42, v43
    s_pack_ll_b32_b16 s52, s56, s58
    v_dot2_f32_bf16 v12, v28, s52, 0
    v_dot2_f32_bf16 v16, v32, s52, 0
    v_dot2_f32_bf16 v20, v36, s52, 0
    v_dot2_f32_bf16 v24, v40, s52, 0
    s_pack_hh_b32_b16 s53, s56, s58
    v_dot2_f32_bf16 v13, v28, s53, 0
    v_dot2_f32_bf16 v17, v32, s53, 0
    v_dot2_f32_bf16 v21, v36, s53, 0
    v_dot2_f32_bf16 v25, v40, s53, 0
    s_pack_ll_b32_b16 s52, s57, s59
    v_dot2_f32_bf16 v14, v28, s52, 0
    v_dot2_f32_bf16 v18, v32, s52, 0
    v_dot2_f32_bf16 v22, v36, s52, 0
    v_dot2_f32_bf16 v26, v40, s52, 0
    s_pack_hh_b32_b16 s53, s57, s59
    v_dot2_f32_bf16 v15, v28, s53, 0
    v_dot2_f32_bf16 v19, v32, s53, 0
    v_dot2_f32_bf16 v23, v36, s53, 0
    v_dot2_f32_bf16 v27, v40, s53, 0
    s_pack_ll_b32_b16 s52, s60, s62
    v_dot2_f32_bf16 v12, v30, s52, v12
    v_dot2_f32_bf16 v16, v34, s52, v16
    v_dot2_f32_bf16 v20, v38, s52, v20
    v_dot2_f32_bf16 v24, v42, s52, v24
    s_pack_hh_b32_b16 s53, s60, s62
    v_dot2_f32_bf16 v13, v30, s53, v13
    v_dot2_f32_bf16 v17, v34, s53, v17
    v_dot2_f32_bf16 v21, v38, s53, v21
    v_dot2_f32_bf16 v25, v42, s53, v25
    s_pack_ll_b32_b16 s52, s61, s63
    v_dot2_f32_bf16 v14, v30, s52, v14
    v_dot2_f32_bf16 v18, v34, s52, v18
    v_dot2_f32_bf16 v22, v38, s52, v22
    v_dot2_f32_bf16 v26, v42, s52, v26
    s_pack_hh_b32_b16 s53, s61, s63
    v_dot2_f32_bf16 v15, v30, s53, v15
    v_dot2_f32_bf16 v19, v34, s53, v19
    v_dot2_f32_bf16 v23, v38, s53, v23
    v_dot2_f32_bf16 v27, v42, s53, v27
    v_lshlrev_b32 v44, 16, v108
    v_and_b32 v45, s32, v108
    v_lshlrev_b32 v46, 16, v109
    v_and_b32 v47, s32, v109
    v_lshlrev_b32 v48, 16, v110
    v_and_b32 v49, s32, v110
    v_lshlrev_b32 v50, 16, v111
    v_and_b32 v51, s32, v111
    v_lshlrev_b32 v52, 16, v112
    v_and_b32 v53, s32, v112
    v_lshlrev_b32 v54, 16, v113
    v_and_b32 v55, s32, v113
    v_lshlrev_b32 v56, 16, v114
    v_and_b32 v57, s32, v114
    v_lshlrev_b32 v58, 16, v115
    v_and_b32 v59, s32, v115
    v_cvt_pk_bf16_f32 v12, v12, v13
    v_cvt_pk_bf16_f32 v14, v14, v15
    v_cvt_pk_bf16_f32 v16, v16, v17
    v_cvt_pk_bf16_f32 v18, v18, v19
    v_cvt_pk_bf16_f32 v20, v20, v21
    v_cvt_pk_bf16_f32 v22, v22, v23
    v_cvt_pk_bf16_f32 v24, v24, v25
    v_cvt_pk_bf16_f32 v26, v26, v27
    v_and_b32 v13, s32, v12
    v_lshlrev_b32 v12, 16, v12
    v_and_b32 v15, s32, v14
    v_lshlrev_b32 v14, 16, v14
    v_and_b32 v17, s32, v16
    v_lshlrev_b32 v16, 16, v16
    v_and_b32 v19, s32, v18
    v_lshlrev_b32 v18, 16, v18
    v_and_b32 v21, s32, v20
    v_lshlrev_b32 v20, 16, v20
    v_and_b32 v23, s32, v22
    v_lshlrev_b32 v22, 16, v22
    v_and_b32 v25, s32, v24
    v_lshlrev_b32 v24, 16, v24
    v_and_b32 v27, s32, v26
    v_lshlrev_b32 v26, 16, v26
    v_mul_f32 v12, v12, v60
    v_mul_f32 v13, v13, v61
    v_mul_f32 v14, v14, v62
    v_mul_f32 v15, v15, v63
    v_mul_f32 v16, v16, v64
    v_mul_f32 v17, v17, v65
    v_mul_f32 v18, v18, v66
    v_mul_f32 v19, v19, v67
    v_mul_f32 v20, v20, v68
    v_mul_f32 v21, v21, v69
    v_mul_f32 v22, v22, v70
    v_mul_f32 v23, v23, v71
    v_mul_f32 v24, v24, v72
    v_mul_f32 v25, v25, v73
    v_mul_f32 v26, v26, v74
    v_mul_f32 v27, v27, v75
    v_cvt_pk_bf16_f32 v12, v12, v13
    v_cvt_pk_bf16_f32 v14, v14, v15
    v_cvt_pk_bf16_f32 v16, v16, v17
    v_cvt_pk_bf16_f32 v18, v18, v19
    v_cvt_pk_bf16_f32 v20, v20, v21
    v_cvt_pk_bf16_f32 v22, v22, v23
    v_cvt_pk_bf16_f32 v24, v24, v25
    v_cvt_pk_bf16_f32 v26, v26, v27
    v_and_b32 v13, s32, v12
    v_lshlrev_b32 v12, 16, v12
    v_and_b32 v15, s32, v14
    v_lshlrev_b32 v14, 16, v14
    v_and_b32 v17, s32, v16
    v_lshlrev_b32 v16, 16, v16
    v_and_b32 v19, s32, v18
    v_lshlrev_b32 v18, 16, v18
    v_and_b32 v21, s32, v20
    v_lshlrev_b32 v20, 16, v20
    v_and_b32 v23, s32, v22
    v_lshlrev_b32 v22, 16, v22
    v_and_b32 v25, s32, v24
    v_lshlrev_b32 v24, 16, v24
    v_and_b32 v27, s32, v26
    v_lshlrev_b32 v26, 16, v26
    v_add_f32 v12, v12, v44
    v_add_f32 v13, v13, v45
    v_add_f32 v14, v14, v46
    v_add_f32 v15, v15, v47
    v_add_f32 v16, v16, v48
    v_add_f32 v17, v17, v49
    v_add_f32 v18, v18, v50
    v_add_f32 v19, v19, v51
    v_add_f32 v20, v20, v52
    v_add_f32 v21, v21, v53
    v_add_f32 v22, v22, v54
    v_add_f32 v23, v23, v55
    v_add_f32 v24, v24, v56
    v_add_f32 v25, v25, v57
    v_add_f32 v26, v26, v58
    v_add_f32 v27, v27, v59
    v_cvt_pk_bf16_f32 v28, v12, v13
    v_cvt_pk_bf16_f32 v29, v14, v15
    v_cvt_pk_bf16_f32 v30, v16, v17
    v_cvt_pk_bf16_f32 v31, v18, v19
    v_cvt_pk_bf16_f32 v32, v20, v21
    v_cvt_pk_bf16_f32 v33, v22, v23
    v_cvt_pk_bf16_f32 v34, v24, v25
    v_cvt_pk_bf16_f32 v35, v26, v27
    buffer_store_dwordx4 v[28:31], v4, s[24:27], 0 offen
    buffer_store_dwordx4 v[32:35], v5, s[24:27], 0 offen
L_postend_96:
    s_mov_b64 exec, -1
L_nextq_94:
    s_bfe_u32 s3, s35, 0x40008
    s_cbranch_scc0 L_fend_112
    s_ff1_i32_b32 s41, s3
    s_add_u32 s3, s41, 8
    s_bitset0_b32 s35, s3
    s_branch L_qloop_89
L_fend_112:

L_p2done_50:
    s_endpgm

L_ufix_52:
    v_and_b32 v117, 63, v0
    v_lshlrev_b32 v117, 2, v117
    s_sub_i32 s54, s42, 1024
    v_cmp_le_i32 vcc, s54, v117
    s_mov_b64 exec, vcc
    v_mov_b32 v12, 0
    v_mov_b32 v44, 0
    s_mov_b64 exec, -1
    s_sub_i32 s54, s42, 1025
    v_cmp_le_i32 vcc, s54, v117
    s_mov_b64 exec, vcc
    v_mov_b32 v13, 0
    v_mov_b32 v46, 0
    s_mov_b64 exec, -1
    s_sub_i32 s54, s42, 1026
    v_cmp_le_i32 vcc, s54, v117
    s_mov_b64 exec, vcc
    v_mov_b32 v14, 0
    v_mov_b32 v48, 0
    s_mov_b64 exec, -1
    s_sub_i32 s54, s42, 1027
    v_cmp_le_i32 vcc, s54, v117
    s_mov_b64 exec, vcc
    v_mov_b32 v15, 0
    v_mov_b32 v50, 0
    s_mov_b64 exec, -1
    s_branch L_uback_53
L_ufix_54:
    v_and_b32 v117, 63, v0
    v_lshlrev_b32 v117, 2, v117
    s_sub_i32 s54, s42, 1536
    v_cmp_le_i32 vcc, s54, v117
    s_mov_b64 exec, vcc
    v_mov_b32 v16, 0
    v_mov_b32 v52, 0
    s_mov_b64 exec, -1
    s_sub_i32 s54, s42, 1537
    v_cmp_le_i32 vcc, s54, v117
    s_mov_b64 exec, vcc
    v_mov_b32 v17, 0
    v_mov_b32 v54, 0
    s_mov_b64 exec, -1
    s_sub_i32 s54, s42, 1538
    v_cmp_le_i32 vcc, s54, v117
    s_mov_b64 exec, vcc
    v_mov_b32 v18, 0
    v_mov_b32 v56, 0
    s_mov_b64 exec, -1
    s_sub_i32 s54, s42, 1539
    v_cmp_le_i32 vcc, s54, v117
    s_mov_b64 exec, vcc
    v_mov_b32 v19, 0
    v_mov_b32 v58, 0
    s_mov_b64 exec, -1
    s_branch L_uback_55
L_ufix_56:
    v_and_b32 v117, 63, v0
    v_lshlrev_b32 v117, 2, v117
    s_sub_i32 s54, s42, 2048
    v_cmp_le_i32 vcc, s54, v117
    s_mov_b64 exec, vcc
    v_mov_b32 v20, 0
    v_mov_b32 v60, 0
    s_mov_b64 exec, -1
    s_sub_i32 s54, s42, 2049
    v_cmp_le_i32 vcc, s54, v117
    s_mov_b64 exec, vcc
    v_mov_b32 v21, 0
    v_mov_b32 v62, 0
    s_mov_b64 exec, -1
    s_sub_i32 s54, s42, 2050
    v_cmp_le_i32 vcc, s54, v117
    s_mov_b64 exec, vcc
    v_mov_b32 v22, 0
    v_mov_b32 v64, 0
    s_mov_b64 exec, -1
    s_sub_i32 s54, s42, 2051
    v_cmp_le_i32 vcc, s54, v117
    s_mov_b64 exec, vcc
    v_mov_b32 v23, 0
    v_mov_b32 v66, 0
    s_mov_b64 exec, -1
    s_branch L_uback_57
L_ufix_58:
    v_and_b32 v117, 63, v0
    v_lshlrev_b32 v117, 2, v117
    s_sub_i32 s54, s42, 2560
    v_cmp_le_i32 vcc, s54, v117
    s_mov_b64 exec, vcc
    v_mov_b32 v24, 0
    v_mov_b32 v68, 0
    s_mov_b64 exec, -1
    s_sub_i32 s54, s42, 2561
    v_cmp_le_i32 vcc, s54, v117
    s_mov_b64 exec, vcc
    v_mov_b32 v25, 0
    v_mov_b32 v70, 0
    s_mov_b64 exec, -1
    s_sub_i32 s54, s42, 2562
    v_cmp_le_i32 vcc, s54, v117
    s_mov_b64 exec, vcc
    v_mov_b32 v26, 0
    v_mov_b32 v72, 0
    s_mov_b64 exec, -1
    s_sub_i32 s54, s42, 2563
    v_cmp_le_i32 vcc, s54, v117
    s_mov_b64 exec, vcc
    v_mov_b32 v27, 0
    v_mov_b32 v74, 0
    s_mov_b64 exec, -1
    s_branch L_uback_59
L_ufix_60:
    v_and_b32 v117, 63, v0
    v_lshlrev_b32 v117, 2, v117
    s_sub_i32 s54, s42, 0
    v_cmp_le_i32 vcc, s54, v117
    s_mov_b64 exec, vcc
    v_mov_b32 v4, 0
    v_mov_b32 v28, 0
    s_mov_b64 exec, -1
    s_sub_i32 s54, s42, 1
    v_cmp_le_i32 vcc, s54, v117
    s_mov_b64 exec, vcc
    v_mov_b32 v5, 0
    v_mov_b32 v30, 0
    s_mov_b64 exec, -1
    s_sub_i32 s54, s42, 2
    v_cmp_le_i32 vcc, s54, v117
    s_mov_b64 exec, vcc
    v_mov_b32 v6, 0
    v_mov_b32 v32, 0
    s_mov_b64 exec, -1
    s_sub_i32 s54, s42, 3
    v_cmp_le_i32 vcc, s54, v117
    s_mov_b64 exec, vcc
    v_mov_b32 v7, 0
    v_mov_b32 v34, 0
    s_mov_b64 exec, -1
    s_branch L_uback_61
L_ufix_62:
    v_and_b32 v117, 63, v0
    v_lshlrev_b32 v117, 2, v117
    s_sub_i32 s54, s42, 512
    v_cmp_le_i32 vcc, s54, v117
    s_mov_b64 exec, vcc
    v_mov_b32 v8, 0
    v_mov_b32 v36, 0
    s_mov_b64 exec, -1
    s_sub_i32 s54, s42, 513
    v_cmp_le_i32 vcc, s54, v117
    s_mov_b64 exec, vcc
    v_mov_b32 v9, 0
    v_mov_b32 v38, 0
    s_mov_b64 exec, -1
    s_sub_i32 s54, s42, 514
    v_cmp_le_i32 vcc, s54, v117
    s_mov_b64 exec, vcc
    v_mov_b32 v10, 0
    v_mov_b32 v40, 0
    s_mov_b64 exec, -1
    s_sub_i32 s54, s42, 515
    v_cmp_le_i32 vcc, s54, v117
    s_mov_b64 exec, vcc
    v_mov_b32 v11, 0
    v_mov_b32 v42, 0
    s_mov_b64 exec, -1
    s_branch L_uback_63
L_ufix_69:
    v_and_b32 v117, 63, v0
    v_lshlrev_b32 v117, 2, v117
    s_sub_i32 s54, s42, 3072
    v_cmp_le_i32 vcc, s54, v117
    s_mov_b64 exec, vcc
    v_mov_b32 v106, 0
    v_mov_b32 v120, 0
    s_mov_b64 exec, -1
    s_sub_i32 s54, s42, 3073
    v_cmp_le_i32 vcc, s54, v117
    s_mov_b64 exec, vcc
    v_mov_b32 v107, 0
    v_mov_b32 v122, 0
    s_mov_b64 exec, -1
    s_sub_i32 s54, s42, 3074
    v_cmp_le_i32 vcc, s54, v117
    s_mov_b64 exec, vcc
    v_mov_b32 v108, 0
    v_mov_b32 v124, 0
    s_mov_b64 exec, -1
    s_sub_i32 s54, s42, 3075
    v_cmp_le_i32 vcc, s54, v117
    s_mov_b64 exec, vcc
    v_mov_b32 v109, 0
    v_mov_b32 v126, 0
    s_mov_b64 exec, -1
    s_branch L_uback_70
L_ufix_73:
    v_and_b32 v117, 63, v0
    v_lshlrev_b32 v117, 2, v117
    s_sub_i32 s54, s42, 1024
    v_cmp_le_i32 vcc, s54, v117
    s_mov_b64 exec, vcc
    v_mov_b32 v12, 0
    v_mov_b32 v44, 0
    s_mov_b64 exec, -1
    s_sub_i32 s54, s42, 1025
    v_cmp_le_i32 vcc, s54, v117
    s_mov_b64 exec, vcc
    v_mov_b32 v13, 0
    v_mov_b32 v46, 0
    s_mov_b64 exec, -1
    s_sub_i32 s54, s42, 1026
    v_cmp_le_i32 vcc, s54, v117
    s_mov_b64 exec, vcc
    v_mov_b32 v14, 0
    v_mov_b32 v48, 0
    s_mov_b64 exec, -1
    s_sub_i32 s54, s42, 1027
    v_cmp_le_i32 vcc, s54, v117
    s_mov_b64 exec, vcc
    v_mov_b32 v15, 0
    v_mov_b32 v50, 0
    s_mov_b64 exec, -1
    s_branch L_uback_74
L_ufix_75:
    v_and_b32 v117, 63, v0
    v_lshlrev_b32 v117, 2, v117
    s_sub_i32 s54, s42, 1536
    v_cmp_le_i32 vcc, s54, v117
    s_mov_b64 exec, vcc
    v_mov_b32 v16, 0
    v_mov_b32 v52, 0
    s_mov_b64 exec, -1
    s_sub_i32 s54, s42, 1537
    v_cmp_le_i32 vcc, s54, v117
    s_mov_b64 exec, vcc
    v_mov_b32 v17, 0
    v_mov_b32 v54, 0
    s_mov_b64 exec, -1
    s_sub_i32 s54, s42, 1538
    v_cmp_le_i32 vcc, s54, v117
    s_mov_b64 exec, vcc
    v_mov_b32 v18, 0
    v_mov_b32 v56, 0
    s_mov_b64 exec, -1
    s_sub_i32 s54, s42, 1539
    v_cmp_le_i32 vcc, s54, v117
    s_mov_b64 exec, vcc
    v_mov_b32 v19, 0
    v_mov_b32 v58, 0
    s_mov_b64 exec, -1
    s_branch L_uback_76
L_ufix_77:
    v_and_b32 v117, 63, v0
    v_lshlrev_b32 v117, 2, v117
    s_sub_i32 s54, s42, 2048
    v_cmp_le_i32 vcc, s54, v117
    s_mov_b64 exec, vcc
    v_mov_b32 v20, 0
    v_mov_b32 v60, 0
    s_mov_b64 exec, -1
    s_sub_i32 s54, s42, 2049
    v_cmp_le_i32 vcc, s54, v117
    s_mov_b64 exec, vcc
    v_mov_b32 v21, 0
    v_mov_b32 v62, 0
    s_mov_b64 exec, -1
    s_sub_i32 s54, s42, 2050
    v_cmp_le_i32 vcc, s54, v117
    s_mov_b64 exec, vcc
    v_mov_b32 v22, 0
    v_mov_b32 v64, 0
    s_mov_b64 exec, -1
    s_sub_i32 s54, s42, 2051
    v_cmp_le_i32 vcc, s54, v117
    s_mov_b64 exec, vcc
    v_mov_b32 v23, 0
    v_mov_b32 v66, 0
    s_mov_b64 exec, -1
    s_branch L_uback_78
L_ufix_79:
    v_and_b32 v117, 63, v0
    v_lshlrev_b32 v117, 2, v117
    s_sub_i32 s54, s42, 2560
    v_cmp_le_i32 vcc, s54, v117
    s_mov_b64 exec, vcc
    v_mov_b32 v24, 0
    v_mov_b32 v68, 0
    s_mov_b64 exec, -1
    s_sub_i32 s54, s42, 2561
    v_cmp_le_i32 vcc, s54, v117
    s_mov_b64 exec, vcc
    v_mov_b32 v25, 0
    v_mov_b32 v70, 0
    s_mov_b64 exec, -1
    s_sub_i32 s54, s42, 2562
    v_cmp_le_i32 vcc, s54, v117
    s_mov_b64 exec, vcc
    v_mov_b32 v26, 0
    v_mov_b32 v72, 0
    s_mov_b64 exec, -1
    s_sub_i32 s54, s42, 2563
    v_cmp_le_i32 vcc, s54, v117
    s_mov_b64 exec, vcc
    v_mov_b32 v27, 0
    v_mov_b32 v74, 0
    s_mov_b64 exec, -1
    s_branch L_uback_80
L_ufix_81:
    v_and_b32 v117, 63, v0
    v_lshlrev_b32 v117, 2, v117
    s_sub_i32 s54, s42, 0
    v_cmp_le_i32 vcc, s54, v117
    s_mov_b64 exec, vcc
    v_mov_b32 v4, 0
    v_mov_b32 v28, 0
    s_mov_b64 exec, -1
    s_sub_i32 s54, s42, 1
    v_cmp_le_i32 vcc, s54, v117
    s_mov_b64 exec, vcc
    v_mov_b32 v5, 0
    v_mov_b32 v30, 0
    s_mov_b64 exec, -1
    s_sub_i32 s54, s42, 2
    v_cmp_le_i32 vcc, s54, v117
    s_mov_b64 exec, vcc
    v_mov_b32 v6, 0
    v_mov_b32 v32, 0
    s_mov_b64 exec, -1
    s_sub_i32 s54, s42, 3
    v_cmp_le_i32 vcc, s54, v117
    s_mov_b64 exec, vcc
    v_mov_b32 v7, 0
    v_mov_b32 v34, 0
    s_mov_b64 exec, -1
    s_branch L_uback_82
L_ufix_83:
    v_and_b32 v117, 63, v0
    v_lshlrev_b32 v117, 2, v117
    s_sub_i32 s54, s42, 512
    v_cmp_le_i32 vcc, s54, v117
    s_mov_b64 exec, vcc
    v_mov_b32 v8, 0
    v_mov_b32 v36, 0
    s_mov_b64 exec, -1
    s_sub_i32 s54, s42, 513
    v_cmp_le_i32 vcc, s54, v117
    s_mov_b64 exec, vcc
    v_mov_b32 v9, 0
    v_mov_b32 v38, 0
    s_mov_b64 exec, -1
    s_sub_i32 s54, s42, 514
    v_cmp_le_i32 vcc, s54, v117
    s_mov_b64 exec, vcc
    v_mov_b32 v10, 0
    v_mov_b32 v40, 0
    s_mov_b64 exec, -1
    s_sub_i32 s54, s42, 515
    v_cmp_le_i32 vcc, s54, v117
    s_mov_b64 exec, vcc
    v_mov_b32 v11, 0
    v_mov_b32 v42, 0
    s_mov_b64 exec, -1
    s_branch L_uback_84
L_sync_98:
    v_mov_b32 v117, s33
    buffer_atomic_add v117, v116, s[44:47], s50 offen sc0
    s_waitcnt vmcnt(0)
    v_readfirstlane_b32 s4, v117
    s_movk_i32 s5, 400
    s_nop 0
    s_add_u32 s4, s4, s33
    s_bitcmp1_b32 s4, 2
    s_cbranch_scc1 L_tell_101
L_poll_99:
    s_sub_u32 s5, s5, 1
    s_cbranch_scc1 L_gave_100
    v_mov_b32 v117, 0
    buffer_atomic_add v117, v116, s[44:47], s50 offen sc0
    s_waitcnt vmcnt(0)
    v_readfirstlane_b32 s4, v117
    s_nop 1
    s_and_b32 s4, s4, 0xff
    s_bitcmp0_b32 s4, 2
    s_cbranch_scc1 L_poll_99
    s_branch L_tell_101
L_gave_100:
    s_lshl_b32 s4, 0x100, s37
    v_mov_b32 v117, s4
    buffer_atomic_or v117, v116, s[44:47], s50 offen sc0
    s_waitcnt vmcnt(0)
    v_readfirstlane_b32 s4, v117
    s_nop 1
    s_and_b32 s4, s4, 0xff
    s_bitcmp1_b32 s4, 2
    s_cselect_b32 s4, s4, 0x10000
L_tell_101:
    v_mov_b32 v117, s4
    v_mov_b32 v118, 150016
    ds_write_b32 v118, v117
    s_branch L_bcast_93

L_fgen_102:
    s_waitcnt vmcnt(0)
    v_lshlrev_b32 v6, 1, v4
    v_lshlrev_b32 v7, 1, v5
    v_mov_b32 v12, 0
    v_mov_b32 v13, 0
    v_mov_b32 v14, 0
    v_mov_b32 v15, 0
    v_mov_b32 v16, 0
    v_mov_b32 v17, 0
    v_mov_b32 v18, 0
    v_mov_b32 v19, 0
    v_mov_b32 v20, 0
    v_mov_b32 v21, 0
    v_mov_b32 v22, 0
    v_mov_b32 v23, 0
    v_mov_b32 v24, 0
    v_mov_b32 v25, 0
    v_mov_b32 v26, 0
    v_mov_b32 v27, 0
    s_bitcmp1_b32 s35, 4
    s_cbranch_scc1 L_ffl_104
    v_cvt_f32_u32_sdwa v28, v76 dst_sel:DWORD dst_unused:UNUSED_PAD src0_sel:WORD_0
    v_cvt_f32_u32_sdwa v29, v76 dst_sel:DWORD dst_unused:UNUSED_PAD src0_sel:WORD_1
    v_cvt_f32_u32_sdwa v30, v77 dst_sel:DWORD dst_unused:UNUSED_PAD src0_sel:WORD_0
    v_cvt_f32_u32_sdwa v31, v77 dst_sel:DWORD dst_unused:UNUSED_PAD src0_sel:WORD_1
    v_cvt_f32_u32_sdwa v32, v78 dst_sel:DWORD dst_unused:UNUSED_PAD src0_sel:WORD_0
    v_cvt_f32_u32_sdwa v33, v78 dst_sel:DWORD dst_unused:UNUSED_PAD src0_sel:WORD_1
    v_cvt_f32_u32_sdwa v34, v79 dst_sel:DWORD dst_unused:UNUSED_PAD src0_sel:WORD_0
    v_cvt_f32_u32_sdwa v35, v79 dst_sel:DWORD dst_unused:UNUSED_PAD src0_sel:WORD_1
    v_cvt_f32_u32_sdwa v36, v92 dst_sel:DWORD dst_unused:UNUSED_PAD src0_sel:WORD_0
    v_cvt_f32_u32_sdwa v37, v92 dst_sel:DWORD dst_unused:UNUSED_PAD src0_sel:WORD_1
    v_cvt_f32_u32_sdwa v38, v93 dst_sel:DWORD dst_unused:UNUSED_PAD src0_sel:WORD_0
    v_cvt_f32_u32_sdwa v39, v93 dst_sel:DWORD dst_unused:UNUSED_PAD src0_sel:WORD_1
    v_cvt_f32_u32_sdwa v40, v94 dst_sel:DWORD dst_unused:UNUSED_PAD src0_sel:WORD_0
    v_cvt_f32_u32_sdwa v41, v94 dst_sel:DWORD dst_unused:UNUSED_PAD src0_sel:WORD_1
    v_cvt_f32_u32_sdwa v42, v95 dst_sel:DWORD dst_unused:UNUSED_PAD src0_sel:WORD_0
    v_cvt_f32_u32_sdwa v43, v95 dst_sel:DWORD dst_unused:UNUSED_PAD src0_sel:WORD_1
    v_add_f32 v28, 0xc6800000, v28
    v_fmac_f32 v12, s34, v28
    v_add_f32 v29, 0xc6800000, v29
    v_fmac_f32 v13, s34, v29
    v_add_f32 v30, 0xc6800000, v30
    v_fmac_f32 v14, s34, v30
    v_add_f32 v31, 0xc6800000, v31
    v_fmac_f32 v15, s34, v31
    v_add_f32 v32, 0xc6800000, v32
    v_fmac_f32 v16, s34, v32
    v_add_f32 v33, 0xc6800000, v33
    v_fmac_f32 v17, s34, v33
    v_add_f32 v34, 0xc6800000, v34
    v_fmac_f32 v18, s34, v34
    v_add_f32 v35, 0xc6800000, v35
    v_fmac_f32 v19, s34, v35
    v_add_f32 v36, 0xc6800000, v36
    v_fmac_f32 v20, s34, v36
    v_add_f32 v37, 0xc6800000, v37
    v_fmac_f32 v21, s34, v37
    v_add_f32 v38, 0xc6800000, v38
    v_fmac_f32 v22, s34, v38
    v_add_f32 v39, 0xc6800000, v39
    v_fmac_f32 v23, s34, v39
    v_add_f32 v40, 0xc6800000, v40
    v_fmac_f32 v24, s34, v40
    v_add_f32 v41, 0xc6800000, v41
    v_fmac_f32 v25, s34, v41
    v_add_f32 v42, 0xc6800000, v42
    v_fmac_f32 v26, s34, v42
    v_add_f32 v43, 0xc6800000, v43
    v_fmac_f32 v27, s34, v43
    s_branch L_fnx_105
L_ffl_104:
    s_mov_b32 s3, 25600000
    buffer_load_dwordx4 v[28:31], v6, s[20:23], s3 offen offset:0 sc1
    buffer_load_dwordx4 v[32:35], v6, s[20:23], s3 offen offset:16 sc1
    buffer_load_dwordx4 v[36:39], v7, s[20:23], s3 offen offset:0 sc1
    buffer_load_dwordx4 v[40:43], v7, s[20:23], s3 offen offset:16 sc1
    s_waitcnt vmcnt(0)
    v_add_f32 v12, v12, v28
    v_add_f32 v13, v13, v29
    v_add_f32 v14, v14, v30
    v_add_f32 v15, v15, v31
    v_add_f32 v16, v16, v32
    v_add_f32 v17, v17, v33
    v_add_f32 v18, v18, v34
    v_add_f32 v19, v19, v35
    v_add_f32 v20, v20, v36
    v_add_f32 v21, v21, v37
    v_add_f32 v22, v22, v38
    v_add_f32 v23, v23, v39
    v_add_f32 v24, v24, v40
    v_add_f32 v25, v25, v41
    v_add_f32 v26, v26, v42
    v_add_f32 v27, v27, v43
L_fnx_105:
    s_bitcmp1_b32 s35, 5
    s_cbranch_scc1 L_ffl_106
    v_cvt_f32_u32_sdwa v28, v80 dst_sel:DWORD dst_unused:UNUSED_PAD src0_sel:WORD_0
    v_cvt_f32_u32_sdwa v29, v80 dst_sel:DWORD dst_unused:UNUSED_PAD src0_sel:WORD_1
    v_cvt_f32_u32_sdwa v30, v81 dst_sel:DWORD dst_unused:UNUSED_PAD src0_sel:WORD_0
    v_cvt_f32_u32_sdwa v31, v81 dst_sel:DWORD dst_unused:UNUSED_PAD src0_sel:WORD_1
    v_cvt_f32_u32_sdwa v32, v82 dst_sel:DWORD dst_unused:UNUSED_PAD src0_sel:WORD_0
    v_cvt_f32_u32_sdwa v33, v82 dst_sel:DWORD dst_unused:UNUSED_PAD src0_sel:WORD_1
    v_cvt_f32_u32_sdwa v34, v83 dst_sel:DWORD dst_unused:UNUSED_PAD src0_sel:WORD_0
    v_cvt_f32_u32_sdwa v35, v83 dst_sel:DWORD dst_unused:UNUSED_PAD src0_sel:WORD_1
    v_cvt_f32_u32_sdwa v36, v96 dst_sel:DWORD dst_unused:UNUSED_PAD src0_sel:WORD_0
    v_cvt_f32_u32_sdwa v37, v96 dst_sel:DWORD dst_unused:UNUSED_PAD src0_sel:WORD_1
    v_cvt_f32_u32_sdwa v38, v97 dst_sel:DWORD dst_unused:UNUSED_PAD src0_sel:WORD_0
    v_cvt_f32_u32_sdwa v39, v97 dst_sel:DWORD dst_unused:UNUSED_PAD src0_sel:WORD_1
    v_cvt_f32_u32_sdwa v40, v98 dst_sel:DWORD dst_unused:UNUSED_PAD src0_sel:WORD_0
    v_cvt_f32_u32_sdwa v41, v98 dst_sel:DWORD dst_unused:UNUSED_PAD src0_sel:WORD_1
    v_cvt_f32_u32_sdwa v42, v99 dst_sel:DWORD dst_unused:UNUSED_PAD src0_sel:WORD_0
    v_cvt_f32_u32_sdwa v43, v99 dst_sel:DWORD dst_unused:UNUSED_PAD src0_sel:WORD_1
    v_add_f32 v28, 0xc6800000, v28
    v_fmac_f32 v12, s34, v28
    v_add_f32 v29, 0xc6800000, v29
    v_fmac_f32 v13, s34, v29
    v_add_f32 v30, 0xc6800000, v30
    v_fmac_f32 v14, s34, v30
    v_add_f32 v31, 0xc6800000, v31
    v_fmac_f32 v15, s34, v31
    v_add_f32 v32, 0xc6800000, v32
    v_fmac_f32 v16, s34, v32
    v_add_f32 v33, 0xc6800000, v33
    v_fmac_f32 v17, s34, v33
    v_add_f32 v34, 0xc6800000, v34
    v_fmac_f32 v18, s34, v34
    v_add_f32 v35, 0xc6800000, v35
    v_fmac_f32 v19, s34, v35
    v_add_f32 v36, 0xc6800000, v36
    v_fmac_f32 v20, s34, v36
    v_add_f32 v37, 0xc6800000, v37
    v_fmac_f32 v21, s34, v37
    v_add_f32 v38, 0xc6800000, v38
    v_fmac_f32 v22, s34, v38
    v_add_f32 v39, 0xc6800000, v39
    v_fmac_f32 v23, s34, v39
    v_add_f32 v40, 0xc6800000, v40
    v_fmac_f32 v24, s34, v40
    v_add_f32 v41, 0xc6800000, v41
    v_fmac_f32 v25, s34, v41
    v_add_f32 v42, 0xc6800000, v42
    v_fmac_f32 v26, s34, v42
    v_add_f32 v43, 0xc6800000, v43
    v_fmac_f32 v27, s34, v43
    s_branch L_fnx_107
L_ffl_106:
    s_mov_b32 s3, 38400000
    buffer_load_dwordx4 v[28:31], v6, s[20:23], s3 offen offset:0 sc1
    buffer_load_dwordx4 v[32:35], v6, s[20:23], s3 offen offset:16 sc1
    buffer_load_dwordx4 v[36:39], v7, s[20:23], s3 offen offset:0 sc1
    buffer_load_dwordx4 v[40:43], v7, s[20:23], s3 offen offset:16 sc1
    s_waitcnt vmcnt(0)
    v_add_f32 v12, v12, v28
    v_add_f32 v13, v13, v29
    v_add_f32 v14, v14, v30
    v_add_f32 v15, v15, v31
    v_add_f32 v16, v16, v32
    v_add_f32 v17, v17, v33
    v_add_f32 v18, v18, v34
    v_add_f32 v19, v19, v35
    v_add_f32 v20, v20, v36
    v_add_f32 v21, v21, v37
    v_add_f32 v22, v22, v38
    v_add_f32 v23, v23, v39
    v_add_f32 v24, v24, v40
    v_add_f32 v25, v25, v41
    v_add_f32 v26, v26, v42
    v_add_f32 v27, v27, v43
L_fnx_107:
    s_bitcmp1_b32 s35, 6
    s_cbranch_scc1 L_ffl_108
    v_cvt_f32_u32_sdwa v28, v84 dst_sel:DWORD dst_unused:UNUSED_PAD src0_sel:WORD_0
    v_cvt_f32_u32_sdwa v29, v84 dst_sel:DWORD dst_unused:UNUSED_PAD src0_sel:WORD_1
    v_cvt_f32_u32_sdwa v30, v85 dst_sel:DWORD dst_unused:UNUSED_PAD src0_sel:WORD_0
    v_cvt_f32_u32_sdwa v31, v85 dst_sel:DWORD dst_unused:UNUSED_PAD src0_sel:WORD_1
    v_cvt_f32_u32_sdwa v32, v86 dst_sel:DWORD dst_unused:UNUSED_PAD src0_sel:WORD_0
    v_cvt_f32_u32_sdwa v33, v86 dst_sel:DWORD dst_unused:UNUSED_PAD src0_sel:WORD_1
    v_cvt_f32_u32_sdwa v34, v87 dst_sel:DWORD dst_unused:UNUSED_PAD src0_sel:WORD_0
    v_cvt_f32_u32_sdwa v35, v87 dst_sel:DWORD dst_unused:UNUSED_PAD src0_sel:WORD_1
    v_cvt_f32_u32_sdwa v36, v100 dst_sel:DWORD dst_unused:UNUSED_PAD src0_sel:WORD_0
    v_cvt_f32_u32_sdwa v37, v100 dst_sel:DWORD dst_unused:UNUSED_PAD src0_sel:WORD_1
    v_cvt_f32_u32_sdwa v38, v101 dst_sel:DWORD dst_unused:UNUSED_PAD src0_sel:WORD_0
    v_cvt_f32_u32_sdwa v39, v101 dst_sel:DWORD dst_unused:UNUSED_PAD src0_sel:WORD_1
    v_cvt_f32_u32_sdwa v40, v102 dst_sel:DWORD dst_unused:UNUSED_PAD src0_sel:WORD_0
    v_cvt_f32_u32_sdwa v41, v102 dst_sel:DWORD dst_unused:UNUSED_PAD src0_sel:WORD_1
    v_cvt_f32_u32_sdwa v42, v103 dst_sel:DWORD dst_unused:UNUSED_PAD src0_sel:WORD_0
    v_cvt_f32_u32_sdwa v43, v103 dst_sel:DWORD dst_unused:UNUSED_PAD src0_sel:WORD_1
    v_add_f32 v28, 0xc6800000, v28
    v_fmac_f32 v12, s34, v28
    v_add_f32 v29, 0xc6800000, v29
    v_fmac_f32 v13, s34, v29
    v_add_f32 v30, 0xc6800000, v30
    v_fmac_f32 v14, s34, v30
    v_add_f32 v31, 0xc6800000, v31
    v_fmac_f32 v15, s34, v31
    v_add_f32 v32, 0xc6800000, v32
    v_fmac_f32 v16, s34, v32
    v_add_f32 v33, 0xc6800000, v33
    v_fmac_f32 v17, s34, v33
    v_add_f32 v34, 0xc6800000, v34
    v_fmac_f32 v18, s34, v34
    v_add_f32 v35, 0xc6800000, v35
    v_fmac_f32 v19, s34, v35
    v_add_f32 v36, 0xc6800000, v36
    v_fmac_f32 v20, s34, v36
    v_add_f32 v37, 0xc6800000, v37
    v_fmac_f32 v21, s34, v37
    v_add_f32 v38, 0xc6800000, v38
    v_fmac_f32 v22, s34, v38
    v_add_f32 v39, 0xc6800000, v39
    v_fmac_f32 v23, s34, v39
    v_add_f32 v40, 0xc6800000, v40
    v_fmac_f32 v24, s34, v40
    v_add_f32 v41, 0xc6800000, v41
    v_fmac_f32 v25, s34, v41
    v_add_f32 v42, 0xc6800000, v42
    v_fmac_f32 v26, s34, v42
    v_add_f32 v43, 0xc6800000, v43
    v_fmac_f32 v27, s34, v43
    s_branch L_fnx_109
L_ffl_108:
    s_mov_b32 s3, 51200000
    buffer_load_dwordx4 v[28:31], v6, s[20:23], s3 offen offset:0 sc1
    buffer_load_dwordx4 v[32:35], v6, s[20:23], s3 offen offset:16 sc1
    buffer_load_dwordx4 v[36:39], v7, s[20:23], s3 offen offset:0 sc1
    buffer_load_dwordx4 v[40:43], v7, s[20:23], s3 offen offset:16 sc1
    s_waitcnt vmcnt(0)
    v_add_f32 v12, v12, v28
    v_add_f32 v13, v13, v29
    v_add_f32 v14, v14, v30
    v_add_f32 v15, v15, v31
    v_add_f32 v16, v16, v32
    v_add_f32 v17, v17, v33
    v_add_f32 v18, v18, v34
    v_add_f32 v19, v19, v35
    v_add_f32 v20, v20, v36
    v_add_f32 v21, v21, v37
    v_add_f32 v22, v22, v38
    v_add_f32 v23, v23, v39
    v_add_f32 v24, v24, v40
    v_add_f32 v25, v25, v41
    v_add_f32 v26, v26, v42
    v_add_f32 v27, v27, v43
L_fnx_109:
    s_bitcmp1_b32 s35, 7
    s_cbranch_scc1 L_ffl_110
    v_cvt_f32_u32_sdwa v28, v88 dst_sel:DWORD dst_unused:UNUSED_PAD src0_sel:WORD_0
    v_cvt_f32_u32_sdwa v29, v88 dst_sel:DWORD dst_unused:UNUSED_PAD src0_sel:WORD_1
    v_cvt_f32_u32_sdwa v30, v89 dst_sel:DWORD dst_unused:UNUSED_PAD src0_sel:WORD_0
    v_cvt_f32_u32_sdwa v31, v89 dst_sel:DWORD dst_unused:UNUSED_PAD src0_sel:WORD_1
    v_cvt_f32_u32_sdwa v32, v90 dst_sel:DWORD dst_unused:UNUSED_PAD src0_sel:WORD_0
    v_cvt_f32_u32_sdwa v33, v90 dst_sel:DWORD dst_unused:UNUSED_PAD src0_sel:WORD_1
    v_cvt_f32_u32_sdwa v34, v91 dst_sel:DWORD dst_unused:UNUSED_PAD src0_sel:WORD_0
    v_cvt_f32_u32_sdwa v35, v91 dst_sel:DWORD dst_unused:UNUSED_PAD src0_sel:WORD_1
    v_cvt_f32_u32_sdwa v36, v104 dst_sel:DWORD dst_unused:UNUSED_PAD src0_sel:WORD_0
    v_cvt_f32_u32_sdwa v37, v104 dst_sel:DWORD dst_unused:UNUSED_PAD src0_sel:WORD_1
    v_cvt_f32_u32_sdwa v38, v105 dst_sel:DWORD dst_unused:UNUSED_PAD src0_sel:WORD_0
    v_cvt_f32_u32_sdwa v39, v105 dst_sel:DWORD dst_unused:UNUSED_PAD src0_sel:WORD_1
    v_cvt_f32_u32_sdwa v40, v106 dst_sel:DWORD dst_unused:UNUSED_PAD src0_sel:WORD_0
    v_cvt_f32_u32_sdwa v41, v106 dst_sel:DWORD dst_unused:UNUSED_PAD src0_sel:WORD_1
    v_cvt_f32_u32_sdwa v42, v107 dst_sel:DWORD dst_unused:UNUSED_PAD src0_sel:WORD_0
    v_cvt_f32_u32_sdwa v43, v107 dst_sel:DWORD dst_unused:UNUSED_PAD src0_sel:WORD_1
    v_add_f32 v28, 0xc6800000, v28
    v_fmac_f32 v12, s34, v28
    v_add_f32 v29, 0xc6800000, v29
    v_fmac_f32 v13, s34, v29
    v_add_f32 v30, 0xc6800000, v30
    v_fmac_f32 v14, s34, v30
    v_add_f32 v31, 0xc6800000, v31
    v_fmac_f32 v15, s34, v31
    v_add_f32 v32, 0xc6800000, v32
    v_fmac_f32 v16, s34, v32
    v_add_f32 v33, 0xc6800000, v33
    v_fmac_f32 v17, s34, v33
    v_add_f32 v34, 0xc6800000, v34
    v_fmac_f32 v18, s34, v34
    v_add_f32 v35, 0xc6800000, v35
    v_fmac_f32 v19, s34, v35
    v_add_f32 v36, 0xc6800000, v36
    v_fmac_f32 v20, s34, v36
    v_add_f32 v37, 0xc6800000, v37
    v_fmac_f32 v21, s34, v37
    v_add_f32 v38, 0xc6800000, v38
    v_fmac_f32 v22, s34, v38
    v_add_f32 v39, 0xc6800000, v39
    v_fmac_f32 v23, s34, v39
    v_add_f32 v40, 0xc6800000, v40
    v_fmac_f32 v24, s34, v40
    v_add_f32 v41, 0xc6800000, v41
    v_fmac_f32 v25, s34, v41
    v_add_f32 v42, 0xc6800000, v42
    v_fmac_f32 v26, s34, v42
    v_add_f32 v43, 0xc6800000, v43
    v_fmac_f32 v27, s34, v43
    s_branch L_fnx_111
L_ffl_110:
    s_mov_b32 s3, 64000000
    buffer_load_dwordx4 v[28:31], v6, s[20:23], s3 offen offset:0 sc1
    buffer_load_dwordx4 v[32:35], v6, s[20:23], s3 offen offset:16 sc1
    buffer_load_dwordx4 v[36:39], v7, s[20:23], s3 offen offset:0 sc1
    buffer_load_dwordx4 v[40:43], v7, s[20:23], s3 offen offset:16 sc1
    s_waitcnt vmcnt(0)
    v_add_f32 v12, v12, v28
    v_add_f32 v13, v13, v29
    v_add_f32 v14, v14, v30
    v_add_f32 v15, v15, v31
    v_add_f32 v16, v16, v32
    v_add_f32 v17, v17, v33
    v_add_f32 v18, v18, v34
    v_add_f32 v19, v19, v35
    v_add_f32 v20, v20, v36
    v_add_f32 v21, v21, v37
    v_add_f32 v22, v22, v38
    v_add_f32 v23, v23, v39
    v_add_f32 v24, v24, v40
    v_add_f32 v25, v25, v41
    v_add_f32 v26, v26, v42
    v_add_f32 v27, v27, v43
L_fnx_111:
    s_branch L_fbk_103
L_p2slow_51:
    s_waitcnt vmcnt(0) lgkmcnt(0)
    s_mov_b32 s51, 0
    s_movk_i32 s43, 6250

L_sweep_113:
    s_barrier

    v_mov_b32 v28, 0x0
    v_mov_b32 v29, 0x0
    v_mov_b32 v30, 0x0
    v_mov_b32 v31, 0x0
    v_add_u32 v32, 50000, v3
    v_add_u32 v33, 65536, v32

    ds_write_b128 v32, v[28:31] offset:0
    ds_write_b128 v32, v[28:31] offset:16384
    ds_write_b128 v32, v[28:31] offset:32768
    ds_write_b128 v32, v[28:31] offset:49152
    ds_write_b128 v33, v[28:31] offset:0
    ds_write_b128 v33, v[28:31] offset:16384
    v_cmp_gt_u32 vcc, 971, v0
    s_mov_b64 exec, vcc
    ds_write_b128 v33, v[28:31] offset:32768
    s_mov_b64 exec, -1
    s_waitcnt lgkmcnt(0)
    s_barrier
    s_sub_u32 s38, s4, 8
L_sbatch_114:
    s_lshl_b32 s52, s38, 6
    s_add_u32 s52, s52, s36
    s_lshl_b32 s52, s52, 2
    s_load_dword s40, s[46:47], s52
    s_mul_i32 s50, s38, 200000
    s_waitcnt lgkmcnt(0)

    s_min_u32 s40, s40, 3968
    s_lshl_b32 s52, s38, 6
    s_add_u32 s52, s52, s36
    s_mul_i32 s52, s52, 19840
    s_add_u32 s20, s44, s52
    s_addc_u32 s21, s45, 0
    s_mul_i32 s52, s40, 5
    s_add_u32 s52, s52, 3
    s_and_b32 s22, s52, -4

    s_lshr_b32 s55, s39, 2
    s_add_u32 s55, s55, 0
    v_and_b32 v36, 63, v0
    v_add_u32 v36, s55, v36
L_left_118:
    s_cmp_ge_u32 s55, s40
    s_cbranch_scc1 L_leftend_119
    v_mul_u32_u24 v37, 5, v36
    buffer_load_dword v38, v37, s[20:23], 0 offen
    buffer_load_ubyte v39, v37, s[20:23], 0 offen offset:4
    s_waitcnt vmcnt(0)

    v_perm_b32 v37, v39, v38, s24
    v_lshrrev_b32 v42, 30, v38
    v_and_b32 v37, 0x1fff, v37
    v_mul_u32_u24 v42, 6250, v42
    v_add_lshl_u32 v37, v37, v42, 3

    buffer_load_dwordx2 v[40:41], v37, s[8:11], s50 offen
    v_cmp_gt_u32 vcc, s40, v36
    s_waitcnt vmcnt(0)

    v_bfe_u32 v44, v38, 16, 14
    v_subrev_u32 v44, s51, v44
    v_cmp_gt_u32 s[64:65], s43, v44
    s_and_b64 exec, vcc, s[64:65]
    v_lshlrev_b32 v45, 8, v38
    v_cmpx_ne_u32 vcc, 0, v45
    v_lshlrev_b32 v44, 4, v44
    v_bfe_i32 v38, v38, 0, 16
    v_cvt_f32_i32 v38, v38
    v_mul_f32 v38, 0x38004020, v38
    v_lshlrev_b32 v45, 16, v40
    v_and_b32 v46, s32, v40
    v_lshlrev_b32 v47, 16, v41
    v_and_b32 v48, s32, v41

    v_mul_f32 v45, v45, v38
    ds_add_f32 v44, v45 offset:50000
    v_mul_f32 v46, v46, v38
    ds_add_f32 v44, v46 offset:50004
    v_mul_f32 v47, v47, v38
    ds_add_f32 v44, v47 offset:50008
    v_mul_f32 v48, v48, v38
    ds_add_f32 v44, v48 offset:50012
    s_mov_b64 exec, -1
    v_add_u32 v36, 128, v36
    s_add_u32 s55, s55, 128
    s_branch L_left_118
L_leftend_119:

    s_add_u32 s38, s38, 1
    s_cmp_lt_u32 s38, s4
    s_cbranch_scc1 L_sbatch_114
    s_mov_b32 s3, 65536
    s_load_dword s40, s[6:7], s3

    s_add_u32 s20, s6, 408657920
    s_addc_u32 s21, s7, 0
    s_mov_b32 s22, 409600000
    s_mov_b32 s23, 0x20000
    s_mov_b32 s38, 0
    s_mov_b32 s50, 200000
    v_mov_b32 v36, v0
    s_waitcnt lgkmcnt(0)
L_ovf_115:
    s_cmp_ge_u32 s38, s40
    s_cbranch_scc1 L_ovfend_116
    v_lshlrev_b32 v37, 3, v36
    buffer_load_dwordx2 v[38:39], v37, s[20:23], 0 offen
    s_waitcnt vmcnt(0)

    v_perm_b32 v37, v39, v38, s24
    v_lshrrev_b32 v42, 30, v38
    v_and_b32 v37, 0x1fff, v37
    v_mul_u32_u24 v42, 6250, v42
    v_add_lshl_u32 v37, v37, v42, 3

    v_bfe_u32 v42, v39, 24, 5
    v_mad_u32_u24 v37, v42, s50, v37
    buffer_load_dwordx2 v[40:41], v37, s[8:11], 0 offen
    v_lshrrev_b32 v42, 3, v42
    v_bfe_u32 v43, v39, 18, 6
    v_cmp_gt_u32 vcc, s40, v36
    v_cmp_eq_u32 s[64:65], s36, v43
    s_and_b64 vcc, vcc, s[64:65]
    v_cmp_eq_u32 s[64:65], s37, v42
    s_and_b64 vcc, vcc, s[64:65]
    s_waitcnt vmcnt(0)

    v_bfe_u32 v44, v38, 16, 14
    v_subrev_u32 v44, s51, v44
    v_cmp_gt_u32 s[64:65], s43, v44
    s_and_b64 exec, vcc, s[64:65]
    v_lshlrev_b32 v45, 8, v38
    v_cmpx_ne_u32 vcc, 0, v45
    v_lshlrev_b32 v44, 4, v44
    v_bfe_i32 v38, v38, 0, 16
    v_cvt_f32_i32 v38, v38
    v_mul_f32 v38, 0x38004020, v38
    v_lshlrev_b32 v45, 16, v40
    v_and_b32 v46, s32, v40
    v_lshlrev_b32 v47, 16, v41
    v_and_b32 v48, s32, v41

    v_mul_f32 v45, v45, v38
    ds_add_f32 v44, v45 offset:50000
    v_mul_f32 v46, v46, v38
    ds_add_f32 v44, v46 offset:50004
    v_mul_f32 v47, v47, v38
    ds_add_f32 v44, v47 offset:50008
    v_mul_f32 v48, v48, v38
    ds_add_f32 v44, v48 offset:50012
    s_mov_b64 exec, -1
    v_add_u32 v36, 1024, v36
    s_add_u32 s38, s38, 1024
    s_branch L_ovf_115
L_ovfend_116:
    s_waitcnt lgkmcnt(0)
    s_barrier
    s_mul_i32 s3, s37, 800000
    s_mul_i32 s5, s36, 12500
    s_add_u32 s3, s3, s5
    s_add_u32 s3, s3, s51
    s_lshl_b32 s3, s3, 4
    s_add_u32 s3, s3, 32399360

    s_add_u32 s20, s6, s3
    s_addc_u32 s21, s7, 0
    s_mov_b32 s22, 100000
    s_mov_b32 s23, 0x20000
    v_mov_b32 v36, v3
    s_mov_b32 s38, 0
L_wl_117:
    v_min_u32 v37, 100000, v36
    ds_read_b128 v[28:31], v37 offset:50000
    s_waitcnt lgkmcnt(0)
    buffer_store_dwordx4 v[28:31], v36, s[20:23], 0 offen sc1
    s_waitcnt vmcnt(0)
    v_add_u32 v36, 16384, v36
    s_add_u32 s38, s38, 1024
    s_cmp_lt_u32 s38, 6250
    s_cbranch_scc1 L_wl_117
    s_add_u32 s51, s51, 6250
    s_cmp_lt_u32 s51, 12500
    s_cbranch_scc1 L_sweep_113
    s_lshl_b32 s33, 16, s37
    s_add_u32 s33, s33, 1
    s_branch L_fin_86

.section .rodata,"a"
.p2align 6
.amdhsa_kernel g1_kernel
  .amdhsa_next_free_vgpr 128
  .amdhsa_next_free_sgpr 102
  .amdhsa_accum_offset 128
  .amdhsa_group_segment_fixed_size 0
  .amdhsa_kernarg_size 112
  .amdhsa_user_sgpr_count 2
  .amdhsa_user_sgpr_kernarg_segment_ptr 1
  .amdhsa_system_sgpr_workgroup_id_x 1
.end_amdhsa_kernel
.p2align 6
.amdhsa_kernel standalone__molecular_angular_gemnet__graph_kernel
  .amdhsa_next_free_vgpr 128
  .amdhsa_next_free_sgpr 102
  .amdhsa_accum_offset 128
  .amdhsa_group_segment_fixed_size 0
  .amdhsa_kernarg_size 112
  .amdhsa_user_sgpr_count 2
  .amdhsa_user_sgpr_kernarg_segment_ptr 1
  .amdhsa_system_sgpr_workgroup_id_x 1
  .amdhsa_float_denorm_mode_32 3
.end_amdhsa_kernel
```

```asm
; @launch kernel=g1_kernel grid=(256,1,1) block=(1024,1,1) lds=163840
; @launch kernel=standalone__molecular_angular_gemnet__graph_kernel grid=(256,1,1) block=(1024,1,1) lds=163840
.amdgcn_target "amdgcn-amd-amdhsa--gfx950"
.text
.globl g1_kernel
.p2align 8
.type g1_kernel,@function
g1_kernel:
    s_cmp_ge_u32 s2, 256
    s_cbranch_scc1 L_p1done_1
    s_load_dwordx4 s[80:83], s[0:1], 8
    s_load_dwordx2 s[84:85], s[0:1], 32
    s_load_dwordx2 s[86:87], s[0:1], 48
    s_load_dwordx4 s[4:7], s[0:1], 96
    s_load_dwordx2 s[78:79], s[0:1], 0
    v_lshlrev_b32 v1, 4, v0
    v_lshlrev_b32 v2, 3, v0
    v_lshlrev_b32 v98, 20, v0
    s_waitcnt lgkmcnt(0)
    s_load_dword s88, s[86:87], 0

    s_mov_b32 s96, s4
    s_mov_b32 s97, s5
    s_mov_b32 s98, 256
    s_mov_b32 s99, 0x20000
    v_readfirstlane_b32 s74, v0
    s_nop 1
    s_or_b32 s74, s74, s2
    s_cbranch_scc1 L_noinit_2

    v_mov_b32 v110, 1
    buffer_atomic_add v110, v98, s[96:99], 0 offen offset:64 sc0
    s_waitcnt vmcnt(0)
    v_readfirstlane_b32 s74, v110
    s_nop 1
    s_cmp_lg_u32 s74, 0
    s_cbranch_scc1 L_zno_4

    s_mov_b32 s92, s6
    s_mov_b32 s93, s7
    s_mov_b32 s94, 65552
    s_mov_b32 s95, 0x20000
    v_mov_b32 v110, 0
    v_mov_b32 v111, 0
    v_mov_b32 v112, 0
    v_mov_b32 v113, 0
L_zl_3:
    buffer_store_dwordx4 v[110:113], v1, s[92:95], s74 offen sc0 sc1
    s_add_u32 s74, s74, 1024
    s_cmp_le_u32 s74, 65536
    s_cbranch_scc1 L_zl_3
    v_mov_b32 v114, 1
    s_waitcnt vmcnt(0)
    buffer_atomic_add v114, v98, s[96:99], 0 offen offset:128
L_zno_4:

L_noinit_2:
    s_mov_b32 s20, s78
    s_mov_b32 s21, s79
    s_mov_b32 s22, 6400000
    s_mov_b32 s23, 0x20000
    v_mul_u32_u24 v110, 6240, v0
    v_and_b32 v111, 63, v0
    v_and_b32 v112, 0x3c0, v0
    v_lshlrev_b32 v111, 2, v111
    v_lshl_or_b32 v111, v112, 4, v111
    v_lshlrev_b32 v100, 2, v0
    s_lshr_b32 s50, s2, 1
    s_and_b32 s53, s2, 1
    s_mul_i32 s3, s50, 50000
    s_mul_i32 s54, s53, 24576
    s_add_u32 s3, s3, s54

    buffer_load_dwordx4 v[56:59], v110, s[20:23], 0 offen
    s_add_u32 s20, s78, s3
    s_addc_u32 s21, s79, 0
    s_mov_b32 s22, 24576
    s_mov_b32 s23, 0x20000
    s_movk_i32 s3, 16384
    buffer_load_dword v44, v111, s[20:23], 0 offen offset:0
    buffer_load_dword v45, v111, s[20:23], 0 offen offset:256
    buffer_load_dword v46, v111, s[20:23], 0 offen offset:512
    buffer_load_dword v47, v111, s[20:23], 0 offen offset:768
    buffer_load_dword v48, v111, s[20:23], s3 offen offset:0
    buffer_load_dword v49, v111, s[20:23], s3 offen offset:256
    buffer_load_dword v50, v111, s[20:23], s3 offen offset:512
    buffer_load_dword v51, v111, s[20:23], s3 offen offset:768
    s_mul_i32 s22, s53, 25424
    s_movk_i32 s3, 24576

    buffer_load_dword v52, v100, s[20:23], s3 offen
    s_mul_i32 s3, s50, 50048
    s_add_u32 s3, s3, s54
    s_add_u32 s54, s3, 393216

    s_mov_b32 s8, s80
    s_mov_b32 s9, s81
    s_mov_b32 s10, 0
    s_mov_b32 s11, 0x20000
    s_mov_b32 s12, s82
    s_mov_b32 s13, s83
    s_mov_b32 s14, 0
    s_mov_b32 s15, 0x20000
    s_mov_b32 s16, s84
    s_mov_b32 s17, s85
    s_mov_b32 s18, 0
    s_mov_b32 s19, 0x20000
    s_lshr_b32 s74, s2, 1
    s_and_b32 s74, s74, 28
    s_lshr_b32 s86, 0x00102010, s74
    s_lshr_b32 s87, 0x44414241, s74
    s_lshr_b32 s41, 0x43221100, s74
    s_and_b32 s86, s86, 15
    s_and_b32 s87, s87, 15
    s_and_b32 s41, s41, 15
    s_lshr_b32 s74, s2, 6
    s_lshl_b32 s74, s74, 3
    s_and_b32 s75, s2, 7
    s_add_u32 s74, s74, s75
    s_mul_i32 s74, s74, 5
    s_add_u32 s41, s41, s74

    s_mul_i32 s78, s41, 16000
    s_add_u32 s49, s78, 16000
    s_cmp_ge_u32 s41, 3200
    s_cmovk_i32 s49, 0
    s_cmovk_i32 s78, 0
    s_lshl_b32 s10, s49, 2
    s_lshl_b32 s14, s49, 2
    s_lshl_b32 s18, s49, 1
    s_sub_u32 s79, s87, s86
    s_bfm_b32 s85, s79, s86
    s_lshl_b32 s86, s86, 12
    s_lshl_b32 s87, s87, 12
    s_min_u32 s87, s87, 16000

    s_add_u32 s79, s78, 0
    s_bitcmp1_b32 s85, 0
    s_cselect_b32 s79, s79, 0x1ff00000
    s_lshl_b32 s56, s79, 2
    s_lshl_b32 s61, s79, 1

    s_add_u32 s79, s78, 4096
    s_bitcmp1_b32 s85, 1
    s_cselect_b32 s79, s79, 0x1ff00000
    s_lshl_b32 s57, s79, 2
    s_lshl_b32 s62, s79, 1

    s_add_u32 s79, s78, 8192
    s_bitcmp1_b32 s85, 2
    s_cselect_b32 s79, s79, 0x1ff00000
    s_lshl_b32 s58, s79, 2
    s_lshl_b32 s63, s79, 1

    s_add_u32 s79, s78, 12288
    s_bitcmp1_b32 s85, 3
    s_cselect_b32 s79, s79, 0x1ff00000
    s_lshl_b32 s59, s79, 2
    s_lshl_b32 s64, s79, 1

    buffer_load_dwordx4 v[20:23], v1, s[12:15], s56 offen nt
    buffer_load_dwordx4 v[4:7], v1, s[8:11], s56 offen nt
    buffer_load_dwordx2 v[36:37], v2, s[16:19], s61 offen nt
    buffer_load_dwordx4 v[24:27], v1, s[12:15], s57 offen nt
    buffer_load_dwordx4 v[8:11], v1, s[8:11], s57 offen nt
    buffer_load_dwordx2 v[38:39], v2, s[16:19], s62 offen nt
    buffer_load_dwordx4 v[28:31], v1, s[12:15], s58 offen nt
    buffer_load_dwordx4 v[12:15], v1, s[8:11], s58 offen nt
    buffer_load_dwordx2 v[40:41], v2, s[16:19], s63 offen nt
    buffer_load_dwordx4 v[32:35], v1, s[12:15], s59 offen nt
    buffer_load_dwordx4 v[16:19], v1, s[8:11], s59 offen nt
    buffer_load_dwordx2 v[42:43], v2, s[16:19], s64 offen nt
    s_and_b32 s5, s2, 7
    s_mul_i32 s3, s5, 8192

    s_add_u32 s20, s6, s3
    s_addc_u32 s21, s7, 0
    s_mov_b32 s22, 8192
    s_mov_b32 s23, 0x20000
    s_mul_i32 s3, s5, 40632320
    s_add_u32 s3, s3, 83599360
    s_add_u32 s24, s6, s3
    s_addc_u32 s25, s7, 0
    s_mov_b32 s26, 40632320
    s_mov_b32 s27, 0x20000
    s_add_u32 s32, s6, 408657920
    s_addc_u32 s33, s7, 0
    s_mov_b32 s34, 409600000
    s_mov_b32 s35, 0x20000
    s_add_u32 s36, s6, 65536
    s_addc_u32 s37, s7, 0
    s_mov_b32 s38, 4
    s_mov_b32 s39, 0x20000
    s_mov_b32 s40, 687195
    s_mov_b32 s42, -6250
    s_mov_b32 s43, 1942
    s_mov_b32 s45, 0x06050400
    s_mov_b32 s46, 0x05040c00
    s_mov_b32 s47, 0x04020100
    s_mov_b32 s48, 3968
    s_mov_b32 s50, 0
    v_mov_b32 v104, 1
    v_mov_b32 v105, 0x46ff8000
    s_mov_b32 s55, 0x05040100
    v_mul_u32_u24 v106, 5, v0
    v_mov_b32 v108, 16384
    v_mov_b32 v114, 0
    v_mov_b32 v115, 0
    v_mov_b32 v116, 0
    v_mov_b32 v117, -1
    ds_write_b64 v2, v[114:115]
    s_movk_i32 s3, 928
    v_cmp_gt_u32 s[66:67], s3, v0
    s_movk_i32 s3, 640
    v_cmp_gt_u32 s[68:69], s3, v0
    s_mov_b64 exec, 1
    ds_write_b128 v108, v[114:117]
    s_mov_b64 exec, -1
    s_waitcnt lgkmcnt(0)
    s_lshl_b32 s88, s88, 16
    v_mov_b32 v110, 0.15915494
    v_mul_f32 v110, s88, v110
    s_mov_b32 s3, 0x7fff7fff
    v_readfirstlane_b32 s44, v110

    s_waitcnt vmcnt(12)
    v_mov_b32 v61, 0
    v_mov_b32 v62, 0
    v_mov_b32 v63, 0
    v_dot2_f32_bf16 v61, v44, v44, v61
    v_dot2_f32_bf16 v61, v45, v45, v61
    v_dot2_f32_bf16 v61, v46, v46, v61
    v_dot2_f32_bf16 v61, v47, v47, v61
    v_dot2_f32_bf16 v61, v48, v48, v61
    v_dot2_f32_bf16 v61, v49, v49, v61
    v_dot2_f32_bf16 v61, v50, v50, v61
    v_dot2_f32_bf16 v61, v51, v51, v61
    v_dot2_f32_bf16 v61, v52, v52, v61
    v_dot2_f32_bf16 v62, v56, v56, v62
    v_dot2_f32_bf16 v62, v57, v57, v62
    v_dot2_f32_bf16 v62, v58, v58, v62
    v_dot2_f32_bf16 v62, v59, v59, v62
    v_and_b32 v60, s3, v44
    v_and_b32 v64, s3, v45
    v_pk_max_u16 v60, v60, v64
    v_and_b32 v64, s3, v46
    v_pk_max_u16 v60, v60, v64
    v_and_b32 v64, s3, v47
    v_pk_max_u16 v60, v60, v64
    v_and_b32 v64, s3, v48
    v_pk_max_u16 v60, v60, v64
    v_and_b32 v64, s3, v49
    v_pk_max_u16 v60, v60, v64
    v_and_b32 v64, s3, v50
    v_pk_max_u16 v60, v60, v64
    v_and_b32 v64, s3, v51
    v_pk_max_u16 v60, v60, v64
    v_and_b32 v64, s3, v52
    v_pk_max_u16 v60, v60, v64
    v_lshrrev_b32 v64, 16, v60
    v_and_b32 v60, 0xffff, v60
    v_max_u32 v60, v60, v64

    s_nop 1
    v_max_u32_dpp v60, v60, v60 row_shr:1 row_mask:0xf bank_mask:0xf
    s_nop 1
    v_max_u32_dpp v60, v60, v60 row_shr:2 row_mask:0xf bank_mask:0xf
    s_nop 1
    v_max_u32_dpp v60, v60, v60 row_shr:4 row_mask:0xf bank_mask:0xf
    s_nop 1
    v_max_u32_dpp v60, v60, v60 row_shr:8 row_mask:0xf bank_mask:0xf
    s_nop 1
    v_max_u32_dpp v60, v60, v60 row_bcast:15 row_mask:0xa bank_mask:0xf
    s_nop 1
    v_max_u32_dpp v60, v60, v60 row_bcast:31 row_mask:0xc bank_mask:0xf
    s_nop 1
    v_add_f32_dpp v61, v61, v61 row_shr:1 row_mask:0xf bank_mask:0xf
    s_nop 1
    v_add_f32_dpp v61, v61, v61 row_shr:2 row_mask:0xf bank_mask:0xf
    s_nop 1
    v_add_f32_dpp v61, v61, v61 row_shr:4 row_mask:0xf bank_mask:0xf
    s_nop 1
    v_add_f32_dpp v61, v61, v61 row_shr:8 row_mask:0xf bank_mask:0xf
    s_nop 1
    v_add_f32_dpp v61, v61, v61 row_bcast:15 row_mask:0xa bank_mask:0xf
    s_nop 1
    v_add_f32_dpp v61, v61, v61 row_bcast:31 row_mask:0xc bank_mask:0xf
    s_nop 1
    v_add_f32_dpp v62, v62, v62 row_shr:1 row_mask:0xf bank_mask:0xf
    s_nop 1
    v_add_f32_dpp v62, v62, v62 row_shr:2 row_mask:0xf bank_mask:0xf
    s_nop 1
    v_add_f32_dpp v62, v62, v62 row_shr:4 row_mask:0xf bank_mask:0xf
    s_nop 1
    v_add_f32_dpp v62, v62, v62 row_shr:8 row_mask:0xf bank_mask:0xf
    s_nop 1
    v_add_f32_dpp v62, v62, v62 row_bcast:15 row_mask:0xa bank_mask:0xf
    s_nop 1
    v_add_f32_dpp v62, v62, v62 row_bcast:31 row_mask:0xc bank_mask:0xf
    v_lshrrev_b32 v64, 6, v0
    v_lshlrev_b32 v64, 4, v64
    s_mov_b32 exec_lo, 0
    s_brev_b32 exec_hi, 1
    ds_write_b128 v64, v[60:63] offset:8192
    s_mov_b64 exec, -1
    v_and_b32 v64, 15, v0
    v_lshlrev_b32 v64, 4, v64
    s_waitcnt lgkmcnt(0)
    s_barrier
    ds_read_b128 v[60:63], v64 offset:8192
    s_waitcnt lgkmcnt(0)

    s_nop 0
    v_max_u32_dpp v60, v60, v60 row_ror:1 row_mask:0xf bank_mask:0xf
    v_add_f32_dpp v61, v61, v61 row_ror:1 row_mask:0xf bank_mask:0xf
    v_add_f32_dpp v62, v62, v62 row_ror:1 row_mask:0xf bank_mask:0xf

    s_nop 0
    v_max_u32_dpp v60, v60, v60 row_ror:2 row_mask:0xf bank_mask:0xf
    v_add_f32_dpp v61, v61, v61 row_ror:2 row_mask:0xf bank_mask:0xf
    v_add_f32_dpp v62, v62, v62 row_ror:2 row_mask:0xf bank_mask:0xf

    s_nop 0
    v_max_u32_dpp v60, v60, v60 row_ror:4 row_mask:0xf bank_mask:0xf
    v_add_f32_dpp v61, v61, v61 row_ror:4 row_mask:0xf bank_mask:0xf
    v_add_f32_dpp v62, v62, v62 row_ror:4 row_mask:0xf bank_mask:0xf

    s_nop 0
    v_max_u32_dpp v60, v60, v60 row_ror:8 row_mask:0xf bank_mask:0xf
    v_add_f32_dpp v61, v61, v61 row_ror:8 row_mask:0xf bank_mask:0xf
    v_add_f32_dpp v62, v62, v62 row_ror:8 row_mask:0xf bank_mask:0xf

    v_rsq_f32 v62, v62
    v_mov_b32 v65, 0x4b400000
    v_mul_f32 v62, 0x4806b64a, v62
    s_nop 0
    v_readfirstlane_b32 s74, v62

    s_add_u32 s92, s6, 135168
    s_addc_u32 s93, s7, 0
    s_mov_b32 s94, 4096
    s_mov_b32 s95, 0x20000
    s_lshl_b32 s3, s2, 4
    buffer_store_dwordx4 v[60:63], v98, s[92:95], s3 offen
    v_lshlrev_b32 v66, 16, v44
    v_and_b32 v44, 0xffff0000, v44
    v_fma_f32 v66, v66, s74, v65
    v_fma_f32 v44, v44, s74, v65
    v_perm_b32 v44, v44, v66, s55

    v_lshlrev_b32 v66, 16, v45
    v_and_b32 v45, 0xffff0000, v45
    v_fma_f32 v66, v66, s74, v65
    v_fma_f32 v45, v45, s74, v65
    v_perm_b32 v45, v45, v66, s55

    v_lshlrev_b32 v66, 16, v46
    v_and_b32 v46, 0xffff0000, v46
    v_fma_f32 v66, v66, s74, v65
    v_fma_f32 v46, v46, s74, v65
    v_perm_b32 v46, v46, v66, s55

    v_lshlrev_b32 v66, 16, v47
    v_and_b32 v47, 0xffff0000, v47
    v_fma_f32 v66, v66, s74, v65
    v_fma_f32 v47, v47, s74, v65
    v_perm_b32 v47, v47, v66, s55

    v_lshlrev_b32 v66, 16, v48
    v_and_b32 v48, 0xffff0000, v48
    v_fma_f32 v66, v66, s74, v65
    v_fma_f32 v48, v48, s74, v65
    v_perm_b32 v48, v48, v66, s55

    v_lshlrev_b32 v66, 16, v49
    v_and_b32 v49, 0xffff0000, v49
    v_fma_f32 v66, v66, s74, v65
    v_fma_f32 v49, v49, s74, v65
    v_perm_b32 v49, v49, v66, s55

    v_lshlrev_b32 v66, 16, v50
    v_and_b32 v50, 0xffff0000, v50
    v_fma_f32 v66, v66, s74, v65
    v_fma_f32 v50, v50, s74, v65
    v_perm_b32 v50, v50, v66, s55

    v_lshlrev_b32 v66, 16, v51
    v_and_b32 v51, 0xffff0000, v51
    v_fma_f32 v66, v66, s74, v65
    v_fma_f32 v51, v51, s74, v65
    v_perm_b32 v51, v51, v66, s55

    v_lshlrev_b32 v66, 16, v52
    v_and_b32 v52, 0xffff0000, v52
    v_fma_f32 v66, v66, s74, v65
    v_fma_f32 v52, v52, s74, v65
    v_perm_b32 v52, v52, v66, s55

    s_add_u32 s92, s6, s54
    s_addc_u32 s93, s7, 0
    s_mov_b32 s94, 24576
    s_mov_b32 s95, 0x20000
    s_movk_i32 s3, 16384
    buffer_store_dwordx4 v[44:47], v1, s[92:95], 0 offen
    buffer_store_dwordx4 v[48:51], v1, s[92:95], s3 offen
    s_mul_i32 s94, s53, 25424
    s_movk_i32 s3, 24576

    buffer_store_dword v52, v100, s[92:95], s3 offen
    s_nop 1
    s_mov_b32 s82, s85
    s_mov_b32 s83, s86
    s_mov_b32 s84, s87
    v_mov_b32 v99, 1
    buffer_atomic_add v99, v98, s[96:99], 0 offen sc0
    v_mov_b32 v100, 0
    buffer_atomic_add v100, v98, s[96:99], 0 offen offset:128 sc0
    s_waitcnt vmcnt(15)
    s_bitcmp0_b32 s82, 0
    s_cbranch_scc1 L_ska_7
    v_mul_hi_u32_u24 v45, s40, v20
    v_mul_hi_u32_u24 v44, s40, v4
    v_mul_hi_u32_u24 v47, s40, v21
    v_mul_hi_u32_u24 v46, s40, v5
    v_mul_hi_u32_u24 v49, s40, v22
    v_mul_hi_u32_u24 v48, s40, v6
    v_mul_hi_u32_u24 v51, s40, v23
    v_mul_hi_u32_u24 v50, s40, v7
    v_and_b32 v45, -2, v45
    v_mad_u32_u24 v4, v44, s43, v4
    v_and_b32 v76, -4, v44
    v_and_b32 v47, -2, v47
    v_mad_u32_u24 v5, v46, s43, v5
    v_and_b32 v77, -4, v46
    v_and_b32 v49, -2, v49
    v_mad_u32_u24 v6, v48, s43, v6
    v_and_b32 v78, -4, v48
    v_and_b32 v51, -2, v51
    v_mad_u32_u24 v7, v50, s43, v7
    v_and_b32 v79, -4, v50
    v_mad_i32_i24 v20, v45, s42, v20
    v_lshl_add_u32 v45, v76, 5, v45
    v_mad_i32_i24 v21, v47, s42, v21
    v_lshl_add_u32 v47, v77, 5, v47
    v_mad_i32_i24 v22, v49, s42, v22
    v_lshl_add_u32 v49, v78, 5, v49
    v_mad_i32_i24 v23, v51, s42, v23
    v_lshl_add_u32 v51, v79, 5, v51
    v_add_u32 v45, v45, v45
    ds_add_rtn_u32 v76, v45, v104
    v_add_u32 v47, v47, v47
    ds_add_rtn_u32 v77, v47, v104
    v_add_u32 v49, v49, v49
    ds_add_rtn_u32 v78, v49, v104
    v_add_u32 v51, v51, v51
    ds_add_rtn_u32 v79, v51, v104
    v_lshlrev_b32 v110, 16, v36
    v_and_b32 v111, 0xffff0000, v36
    v_lshlrev_b32 v112, 16, v37
    v_and_b32 v113, 0xffff0000, v37
    v_mul_f32 v110, s44, v110
    v_mul_f32 v111, s44, v111
    v_mul_f32 v112, s44, v112
    v_mul_f32 v113, s44, v113
    v_fract_f32 v110, v110
    v_fract_f32 v111, v111
    v_fract_f32 v112, v112
    v_fract_f32 v113, v113
    v_cos_f32 v110, v110
    v_cos_f32 v111, v111
    v_cos_f32 v112, v112
    v_cos_f32 v113, v113
    v_lshl_or_b32 v44, v44, 14, v20
    v_perm_b32 v45, v45, v4, s46
    v_bfe_u32 v4, v4, 8, 5

    v_lshl_or_b32 v46, v46, 14, v21
    v_perm_b32 v47, v47, v5, s46
    v_bfe_u32 v5, v5, 8, 5

    v_lshl_or_b32 v48, v48, 14, v22
    v_perm_b32 v49, v49, v6, s46
    v_bfe_u32 v6, v6, 8, 5

    v_lshl_or_b32 v50, v50, 14, v23
    v_perm_b32 v51, v51, v7, s46
    v_bfe_u32 v7, v7, 8, 5

    v_fmaak_f32 v110, v110, v105, 0x4b400010
    v_fmaak_f32 v111, v111, v105, 0x4b400010
    v_fmaak_f32 v112, v112, v105, 0x4b400010
    v_fmaak_f32 v113, v113, v105, 0x4b400010
    v_sub_u32 v110, v110, v4
    v_sub_u32 v111, v111, v5
    v_sub_u32 v112, v112, v6
    v_sub_u32 v113, v113, v7
    v_bfi_b32 v110, 31, v4, v110
    v_bfi_b32 v111, 31, v5, v111
    v_bfi_b32 v112, 31, v6, v112
    v_bfi_b32 v113, 31, v7, v113
    v_perm_b32 v44, v44, v110, s55
    v_perm_b32 v46, v46, v111, s55
    v_perm_b32 v48, v48, v112, s55
    v_perm_b32 v50, v50, v113, s55
L_ska_7:
    s_waitcnt vmcnt(12)
    s_bitcmp0_b32 s82, 1
    s_cbranch_scc1 L_ska_8
    v_mul_hi_u32_u24 v53, s40, v24
    v_mul_hi_u32_u24 v52, s40, v8
    v_mul_hi_u32_u24 v55, s40, v25
    v_mul_hi_u32_u24 v54, s40, v9
    v_mul_hi_u32_u24 v57, s40, v26
    v_mul_hi_u32_u24 v56, s40, v10
    v_mul_hi_u32_u24 v59, s40, v27
    v_mul_hi_u32_u24 v58, s40, v11
    v_and_b32 v53, -2, v53
    v_mad_u32_u24 v8, v52, s43, v8
    v_and_b32 v80, -4, v52
    v_and_b32 v55, -2, v55
    v_mad_u32_u24 v9, v54, s43, v9
    v_and_b32 v81, -4, v54
    v_and_b32 v57, -2, v57
    v_mad_u32_u24 v10, v56, s43, v10
    v_and_b32 v82, -4, v56
    v_and_b32 v59, -2, v59
    v_mad_u32_u24 v11, v58, s43, v11
    v_and_b32 v83, -4, v58
    v_mad_i32_i24 v24, v53, s42, v24
    v_lshl_add_u32 v53, v80, 5, v53
    v_mad_i32_i24 v25, v55, s42, v25
    v_lshl_add_u32 v55, v81, 5, v55
    v_mad_i32_i24 v26, v57, s42, v26
    v_lshl_add_u32 v57, v82, 5, v57
    v_mad_i32_i24 v27, v59, s42, v27
    v_lshl_add_u32 v59, v83, 5, v59
    v_add_u32 v53, v53, v53
    ds_add_rtn_u32 v80, v53, v104
    v_add_u32 v55, v55, v55
    ds_add_rtn_u32 v81, v55, v104
    v_add_u32 v57, v57, v57
    ds_add_rtn_u32 v82, v57, v104
    v_add_u32 v59, v59, v59
    ds_add_rtn_u32 v83, v59, v104
    v_lshlrev_b32 v110, 16, v38
    v_and_b32 v111, 0xffff0000, v38
    v_lshlrev_b32 v112, 16, v39
    v_and_b32 v113, 0xffff0000, v39
    v_mul_f32 v110, s44, v110
    v_mul_f32 v111, s44, v111
    v_mul_f32 v112, s44, v112
    v_mul_f32 v113, s44, v113
    v_fract_f32 v110, v110
    v_fract_f32 v111, v111
    v_fract_f32 v112, v112
    v_fract_f32 v113, v113
    v_cos_f32 v110, v110
    v_cos_f32 v111, v111
    v_cos_f32 v112, v112
    v_cos_f32 v113, v113
    v_lshl_or_b32 v52, v52, 14, v24
    v_perm_b32 v53, v53, v8, s46
    v_bfe_u32 v8, v8, 8, 5

    v_lshl_or_b32 v54, v54, 14, v25
    v_perm_b32 v55, v55, v9, s46
    v_bfe_u32 v9, v9, 8, 5

    v_lshl_or_b32 v56, v56, 14, v26
    v_perm_b32 v57, v57, v10, s46
    v_bfe_u32 v10, v10, 8, 5

    v_lshl_or_b32 v58, v58, 14, v27
    v_perm_b32 v59, v59, v11, s46
    v_bfe_u32 v11, v11, 8, 5

    v_fmaak_f32 v110, v110, v105, 0x4b400010
    v_fmaak_f32 v111, v111, v105, 0x4b400010
    v_fmaak_f32 v112, v112, v105, 0x4b400010
    v_fmaak_f32 v113, v113, v105, 0x4b400010
    v_sub_u32 v110, v110, v8
    v_sub_u32 v111, v111, v9
    v_sub_u32 v112, v112, v10
    v_sub_u32 v113, v113, v11
    v_bfi_b32 v110, 31, v8, v110
    v_bfi_b32 v111, 31, v9, v111
    v_bfi_b32 v112, 31, v10, v112
    v_bfi_b32 v113, 31, v11, v113
    v_perm_b32 v52, v52, v110, s55
    v_perm_b32 v54, v54, v111, s55
    v_perm_b32 v56, v56, v112, s55
    v_perm_b32 v58, v58, v113, s55
L_ska_8:
    s_waitcnt vmcnt(9)
    s_bitcmp0_b32 s82, 2
    s_cbranch_scc1 L_ska_9
    v_mul_hi_u32_u24 v61, s40, v28
    v_mul_hi_u32_u24 v60, s40, v12
    v_mul_hi_u32_u24 v63, s40, v29
    v_mul_hi_u32_u24 v62, s40, v13
    v_mul_hi_u32_u24 v65, s40, v30
    v_mul_hi_u32_u24 v64, s40, v14
    v_mul_hi_u32_u24 v67, s40, v31
    v_mul_hi_u32_u24 v66, s40, v15
    v_and_b32 v61, -2, v61
    v_mad_u32_u24 v12, v60, s43, v12
    v_and_b32 v84, -4, v60
    v_and_b32 v63, -2, v63
    v_mad_u32_u24 v13, v62, s43, v13
    v_and_b32 v85, -4, v62
    v_and_b32 v65, -2, v65
    v_mad_u32_u24 v14, v64, s43, v14
    v_and_b32 v86, -4, v64
    v_and_b32 v67, -2, v67
    v_mad_u32_u24 v15, v66, s43, v15
    v_and_b32 v87, -4, v66
    v_mad_i32_i24 v28, v61, s42, v28
    v_lshl_add_u32 v61, v84, 5, v61
    v_mad_i32_i24 v29, v63, s42, v29
    v_lshl_add_u32 v63, v85, 5, v63
    v_mad_i32_i24 v30, v65, s42, v30
    v_lshl_add_u32 v65, v86, 5, v65
    v_mad_i32_i24 v31, v67, s42, v31
    v_lshl_add_u32 v67, v87, 5, v67
    v_add_u32 v61, v61, v61
    ds_add_rtn_u32 v84, v61, v104
    v_add_u32 v63, v63, v63
    ds_add_rtn_u32 v85, v63, v104
    v_add_u32 v65, v65, v65
    ds_add_rtn_u32 v86, v65, v104
    v_add_u32 v67, v67, v67
    ds_add_rtn_u32 v87, v67, v104
    v_lshlrev_b32 v110, 16, v40
    v_and_b32 v111, 0xffff0000, v40
    v_lshlrev_b32 v112, 16, v41
    v_and_b32 v113, 0xffff0000, v41
    v_mul_f32 v110, s44, v110
    v_mul_f32 v111, s44, v111
    v_mul_f32 v112, s44, v112
    v_mul_f32 v113, s44, v113
    v_fract_f32 v110, v110
    v_fract_f32 v111, v111
    v_fract_f32 v112, v112
    v_fract_f32 v113, v113
    v_cos_f32 v110, v110
    v_cos_f32 v111, v111
    v_cos_f32 v112, v112
    v_cos_f32 v113, v113
    v_lshl_or_b32 v60, v60, 14, v28
    v_perm_b32 v61, v61, v12, s46
    v_bfe_u32 v12, v12, 8, 5

    v_lshl_or_b32 v62, v62, 14, v29
    v_perm_b32 v63, v63, v13, s46
    v_bfe_u32 v13, v13, 8, 5

    v_lshl_or_b32 v64, v64, 14, v30
    v_perm_b32 v65, v65, v14, s46
    v_bfe_u32 v14, v14, 8, 5

    v_lshl_or_b32 v66, v66, 14, v31
    v_perm_b32 v67, v67, v15, s46
    v_bfe_u32 v15, v15, 8, 5

    v_fmaak_f32 v110, v110, v105, 0x4b400010
    v_fmaak_f32 v111, v111, v105, 0x4b400010
    v_fmaak_f32 v112, v112, v105, 0x4b400010
    v_fmaak_f32 v113, v113, v105, 0x4b400010
    v_sub_u32 v110, v110, v12
    v_sub_u32 v111, v111, v13
    v_sub_u32 v112, v112, v14
    v_sub_u32 v113, v113, v15
    v_bfi_b32 v110, 31, v12, v110
    v_bfi_b32 v111, 31, v13, v111
    v_bfi_b32 v112, 31, v14, v112
    v_bfi_b32 v113, 31, v15, v113
    v_perm_b32 v60, v60, v110, s55
    v_perm_b32 v62, v62, v111, s55
    v_perm_b32 v64, v64, v112, s55
    v_perm_b32 v66, v66, v113, s55
L_ska_9:
    s_waitcnt vmcnt(6)
    s_bitcmp0_b32 s82, 3
    s_cbranch_scc1 L_ska_10
    s_mov_b64 exec, s[66:67]
    v_mul_hi_u32_u24 v69, s40, v32
    v_mul_hi_u32_u24 v68, s40, v16
    v_mul_hi_u32_u24 v71, s40, v33
    v_mul_hi_u32_u24 v70, s40, v17
    v_mul_hi_u32_u24 v73, s40, v34
    v_mul_hi_u32_u24 v72, s40, v18
    v_mul_hi_u32_u24 v75, s40, v35
    v_mul_hi_u32_u24 v74, s40, v19
    v_and_b32 v69, -2, v69
    v_mad_u32_u24 v16, v68, s43, v16
    v_and_b32 v88, -4, v68
    v_and_b32 v71, -2, v71
    v_mad_u32_u24 v17, v70, s43, v17
    v_and_b32 v89, -4, v70
    v_and_b32 v73, -2, v73
    v_mad_u32_u24 v18, v72, s43, v18
    v_and_b32 v90, -4, v72
    v_and_b32 v75, -2, v75
    v_mad_u32_u24 v19, v74, s43, v19
    v_and_b32 v91, -4, v74
    v_mad_i32_i24 v32, v69, s42, v32
    v_lshl_add_u32 v69, v88, 5, v69
    v_mad_i32_i24 v33, v71, s42, v33
    v_lshl_add_u32 v71, v89, 5, v71
    v_mad_i32_i24 v34, v73, s42, v34
    v_lshl_add_u32 v73, v90, 5, v73
    v_mad_i32_i24 v35, v75, s42, v35
    v_lshl_add_u32 v75, v91, 5, v75
    v_add_u32 v69, v69, v69
    ds_add_rtn_u32 v88, v69, v104
    v_add_u32 v71, v71, v71
    ds_add_rtn_u32 v89, v71, v104
    v_add_u32 v73, v73, v73
    ds_add_rtn_u32 v90, v73, v104
    v_add_u32 v75, v75, v75
    ds_add_rtn_u32 v91, v75, v104
    v_lshlrev_b32 v110, 16, v42
    v_and_b32 v111, 0xffff0000, v42
    v_lshlrev_b32 v112, 16, v43
    v_and_b32 v113, 0xffff0000, v43
    v_mul_f32 v110, s44, v110
    v_mul_f32 v111, s44, v111
    v_mul_f32 v112, s44, v112
    v_mul_f32 v113, s44, v113
    v_fract_f32 v110, v110
    v_fract_f32 v111, v111
    v_fract_f32 v112, v112
    v_fract_f32 v113, v113
    v_cos_f32 v110, v110
    v_cos_f32 v111, v111
    v_cos_f32 v112, v112
    v_cos_f32 v113, v113
    v_lshl_or_b32 v68, v68, 14, v32
    v_perm_b32 v69, v69, v16, s46
    v_bfe_u32 v16, v16, 8, 5

    v_lshl_or_b32 v70, v70, 14, v33
    v_perm_b32 v71, v71, v17, s46
    v_bfe_u32 v17, v17, 8, 5

    v_lshl_or_b32 v72, v72, 14, v34
    v_perm_b32 v73, v73, v18, s46
    v_bfe_u32 v18, v18, 8, 5

    v_lshl_or_b32 v74, v74, 14, v35
    v_perm_b32 v75, v75, v19, s46
    v_bfe_u32 v19, v19, 8, 5

    v_fmaak_f32 v110, v110, v105, 0x4b400010
    v_fmaak_f32 v111, v111, v105, 0x4b400010
    v_fmaak_f32 v112, v112, v105, 0x4b400010
    v_fmaak_f32 v113, v113, v105, 0x4b400010
    v_sub_u32 v110, v110, v16
    v_sub_u32 v111, v111, v17
    v_sub_u32 v112, v112, v18
    v_sub_u32 v113, v113, v19
    v_bfi_b32 v110, 31, v16, v110
    v_bfi_b32 v111, 31, v17, v111
    v_bfi_b32 v112, 31, v18, v112
    v_bfi_b32 v113, 31, v19, v113
    v_perm_b32 v68, v68, v110, s55
    v_perm_b32 v70, v70, v111, s55
    v_perm_b32 v72, v72, v112, s55
    v_perm_b32 v74, v74, v113, s55
    s_mov_b64 exec, -1
L_ska_10:
    s_waitcnt vmcnt(0)
    v_or_b32 v100, v100, v0
    s_nop 0
    v_readfirstlane_b32 s74, v100
    s_nop 1
    s_cmp_lg_u32 s74, 0
    s_cbranch_scc1 L_ready_12

    v_mov_b32 v110, 1
    buffer_atomic_add v110, v98, s[96:99], 0 offen offset:64 sc0
    s_waitcnt vmcnt(0)
    v_readfirstlane_b32 s74, v110
    s_nop 1
    s_cmp_lg_u32 s74, 0
    s_cbranch_scc1 L_zno_14

    s_mov_b32 s92, s6
    s_mov_b32 s93, s7
    s_mov_b32 s94, 65552
    s_mov_b32 s95, 0x20000
    v_mov_b32 v110, 0
    v_mov_b32 v111, 0
    v_mov_b32 v112, 0
    v_mov_b32 v113, 0
L_zl_13:
    buffer_store_dwordx4 v[110:113], v1, s[92:95], s74 offen sc0 sc1
    s_add_u32 s74, s74, 1024
    s_cmp_le_u32 s74, 65536
    s_cbranch_scc1 L_zl_13
    v_mov_b32 v114, 1
    s_waitcnt vmcnt(0)
    buffer_atomic_add v114, v98, s[96:99], 0 offen offset:128
L_zno_14:

L_spin_11:
    v_mov_b32 v100, 0
    buffer_atomic_add v100, v98, s[96:99], 0 offen offset:128 sc0
    s_waitcnt vmcnt(0)
    v_readfirstlane_b32 s74, v100
    s_nop 1
    s_cmp_eq_u32 s74, 0
    s_cbranch_scc1 L_spin_11
L_ready_12:

    v_cmp_eq_u32 vcc, 0, v0
    s_waitcnt vmcnt(1)
    s_mov_b64 exec, vcc
    ds_write_b32 v108, v99 offset:8
    s_mov_b64 exec, -1
    s_waitcnt lgkmcnt(0)
    s_barrier

    ds_read2_b32 v[110:111], v108 offset0:1 offset1:2
    ds_read_b64 v[94:95], v2
    s_waitcnt lgkmcnt(0)
    v_readfirstlane_b32 s53, v110
    v_readfirstlane_b32 s41, v111

    v_and_b32 v94, 0xffff, v94
    v_and_b32 v95, 0xffff, v95
    v_add_u32 v97, v94, v95
    s_nop 1
    v_add_u32_dpp v97, v97, v97 row_shr:1 row_mask:0xf bank_mask:0xf
    s_nop 1
    v_add_u32_dpp v97, v97, v97 row_shr:2 row_mask:0xf bank_mask:0xf
    s_nop 1
    v_add_u32_dpp v97, v97, v97 row_shr:4 row_mask:0xf bank_mask:0xf
    s_nop 1
    v_add_u32_dpp v97, v97, v97 row_shr:8 row_mask:0xf bank_mask:0xf
    s_nop 1
    v_add_u32_dpp v97, v97, v97 row_bcast:15 row_mask:0xa bank_mask:0xf
    s_nop 1
    v_add_u32_dpp v97, v97, v97 row_bcast:31 row_mask:0xc bank_mask:0xf
    s_mov_b32 exec_lo, 0
    s_brev_b32 exec_hi, 1
    ds_add_rtn_u32 v96, v108, v97
    s_mov_b64 exec, -1

    v_add_u32 v92, v94, v94
    v_add_u32 v93, v95, v95
    v_med3_u32 v92, v94, 2, v92
    v_med3_u32 v93, v95, 2, v93
    buffer_atomic_add_x2 v[92:93], v2, s[20:23], 0 offen sc0
    s_add_u32 s41, s41, 160
    s_sub_u32 s78, s41, 3008
    s_lshr_b32 s79, s78, 1
    s_add_u32 s79, s79, 3008
    s_and_b32 s86, s78, 1
    s_lshl_b32 s86, s86, 1
    s_add_u32 s87, s86, 2
    s_cmp_lt_u32 s41, 3008
    s_cselect_b32 s41, s41, s79
    s_cmovk_i32 s86, 0
    s_cmovk_i32 s87, 4

    s_mul_i32 s78, s41, 16000
    s_add_u32 s49, s78, 16000
    s_cmp_ge_u32 s41, 3200
    s_cmovk_i32 s49, 0
    s_cmovk_i32 s78, 0
    s_lshl_b32 s10, s49, 2
    s_lshl_b32 s14, s49, 2
    s_lshl_b32 s18, s49, 1
    s_sub_u32 s79, s87, s86
    s_bfm_b32 s85, s79, s86
    s_lshl_b32 s86, s86, 12
    s_lshl_b32 s87, s87, 12
    s_min_u32 s87, s87, 16000

    s_add_u32 s79, s78, 0
    s_bitcmp1_b32 s85, 0
    s_cselect_b32 s79, s79, 0x1ff00000
    s_lshl_b32 s56, s79, 2
    s_lshl_b32 s61, s79, 1

    s_add_u32 s79, s78, 4096
    s_bitcmp1_b32 s85, 1
    s_cselect_b32 s79, s79, 0x1ff00000
    s_lshl_b32 s57, s79, 2
    s_lshl_b32 s62, s79, 1

    s_add_u32 s79, s78, 8192
    s_bitcmp1_b32 s85, 2
    s_cselect_b32 s79, s79, 0x1ff00000
    s_lshl_b32 s58, s79, 2
    s_lshl_b32 s63, s79, 1

    s_add_u32 s79, s78, 12288
    s_bitcmp1_b32 s85, 3
    s_cselect_b32 s79, s79, 0x1ff00000
    s_lshl_b32 s59, s79, 2
    s_lshl_b32 s64, s79, 1

    s_waitcnt lgkmcnt(0)
    v_readlane_b32 s77, v96, 63
    v_mul_u32_u24 v114, 7936, v0
    v_sub_u32 v97, v97, v95
    s_sub_u32 s50, s50, s83
    s_sub_u32 s77, s77, s50
    v_add_u32 v97, s77, v97
    v_sub_u32 v96, v97, v94
    v_lshlrev_b32 v111, 16, v97
    v_lshlrev_b32 v110, 16, v96
    ds_write_b64 v2, v[110:111]
    v_sub_u32 v96, v114, v96
    v_sub_u32 v97, v114, v97
    v_add_u32 v97, s48, v97
    s_add_u32 s50, s50, s84
    s_mov_b32 s28, s82
    s_mov_b32 s29, s83
    s_mov_b32 s30, s84
    s_lshl_b32 s74, s29, 3
    s_lshl_b32 s75, s30, 3
    v_mov_b32 v125, s74
    v_mov_b32 v126, s75
    v_mov_b32 v127, -1

    s_waitcnt lgkmcnt(0)
    s_barrier

    s_mov_b64 exec, 1
    ds_write_b32 v125, v127 offset:16396
    ds_write_b32 v126, v127 offset:16404
    s_mov_b64 exec, -1

    buffer_load_dwordx4 v[20:23], v1, s[12:15], s56 offen nt
    buffer_load_dwordx4 v[4:7], v1, s[8:11], s56 offen nt
    buffer_load_dwordx2 v[36:37], v2, s[16:19], s61 offen nt
    s_bitcmp0_b32 s28, 0
    s_cbranch_scc1 L_skz_15
    v_lshrrev_b32 v110, 16, v45
    ds_read_b32 v110, v110
    v_lshrrev_b32 v111, 16, v47
    ds_read_b32 v111, v111
    v_lshrrev_b32 v112, 16, v49
    ds_read_b32 v112, v112
    v_lshrrev_b32 v113, 16, v51
    ds_read_b32 v113, v113
    s_waitcnt lgkmcnt(3)
    v_add_u32_sdwa v110, v110, v76 dst_sel:DWORD dst_unused:UNUSED_PAD src0_sel:WORD_1 src1_sel:WORD_0
    v_lshlrev_b32 v110, 3, v110
    ds_write_b64 v110, v[44:45] offset:16400

    s_waitcnt lgkmcnt(3)
    v_add_u32_sdwa v111, v111, v77 dst_sel:DWORD dst_unused:UNUSED_PAD src0_sel:WORD_1 src1_sel:WORD_0
    v_lshlrev_b32 v111, 3, v111
    ds_write_b64 v111, v[46:47] offset:16400

    s_waitcnt lgkmcnt(3)
    v_add_u32_sdwa v112, v112, v78 dst_sel:DWORD dst_unused:UNUSED_PAD src0_sel:WORD_1 src1_sel:WORD_0
    v_lshlrev_b32 v112, 3, v112
    ds_write_b64 v112, v[48:49] offset:16400

    s_waitcnt lgkmcnt(3)
    v_add_u32_sdwa v113, v113, v79 dst_sel:DWORD dst_unused:UNUSED_PAD src0_sel:WORD_1 src1_sel:WORD_0
    v_lshlrev_b32 v113, 3, v113
    ds_write_b64 v113, v[50:51] offset:16400

L_skz_15:
    s_bitcmp0_b32 s28, 1
    s_cbranch_scc1 L_skz_16
    v_lshrrev_b32 v110, 16, v53
    ds_read_b32 v110, v110
    v_lshrrev_b32 v111, 16, v55
    ds_read_b32 v111, v111
    v_lshrrev_b32 v112, 16, v57
    ds_read_b32 v112, v112
    v_lshrrev_b32 v113, 16, v59
    ds_read_b32 v113, v113
    s_waitcnt lgkmcnt(3)
    v_add_u32_sdwa v110, v110, v80 dst_sel:DWORD dst_unused:UNUSED_PAD src0_sel:WORD_1 src1_sel:WORD_0
    v_lshlrev_b32 v110, 3, v110
    ds_write_b64 v110, v[52:53] offset:16400

    s_waitcnt lgkmcnt(3)
    v_add_u32_sdwa v111, v111, v81 dst_sel:DWORD dst_unused:UNUSED_PAD src0_sel:WORD_1 src1_sel:WORD_0
    v_lshlrev_b32 v111, 3, v111
    ds_write_b64 v111, v[54:55] offset:16400

    s_waitcnt lgkmcnt(3)
    v_add_u32_sdwa v112, v112, v82 dst_sel:DWORD dst_unused:UNUSED_PAD src0_sel:WORD_1 src1_sel:WORD_0
    v_lshlrev_b32 v112, 3, v112
    ds_write_b64 v112, v[56:57] offset:16400

    s_waitcnt lgkmcnt(3)
    v_add_u32_sdwa v113, v113, v83 dst_sel:DWORD dst_unused:UNUSED_PAD src0_sel:WORD_1 src1_sel:WORD_0
    v_lshlrev_b32 v113, 3, v113
    ds_write_b64 v113, v[58:59] offset:16400

L_skz_16:
    buffer_load_dwordx4 v[24:27], v1, s[12:15], s57 offen nt
    buffer_load_dwordx4 v[8:11], v1, s[8:11], s57 offen nt
    buffer_load_dwordx2 v[38:39], v2, s[16:19], s62 offen nt
    s_bitcmp0_b32 s28, 2
    s_cbranch_scc1 L_skz_17
    v_lshrrev_b32 v110, 16, v61
    ds_read_b32 v110, v110
    v_lshrrev_b32 v111, 16, v63
    ds_read_b32 v111, v111
    v_lshrrev_b32 v112, 16, v65
    ds_read_b32 v112, v112
    v_lshrrev_b32 v113, 16, v67
    ds_read_b32 v113, v113
    s_waitcnt lgkmcnt(3)
    v_add_u32_sdwa v110, v110, v84 dst_sel:DWORD dst_unused:UNUSED_PAD src0_sel:WORD_1 src1_sel:WORD_0
    v_lshlrev_b32 v110, 3, v110
    ds_write_b64 v110, v[60:61] offset:16400

    s_waitcnt lgkmcnt(3)
    v_add_u32_sdwa v111, v111, v85 dst_sel:DWORD dst_unused:UNUSED_PAD src0_sel:WORD_1 src1_sel:WORD_0
    v_lshlrev_b32 v111, 3, v111
    ds_write_b64 v111, v[62:63] offset:16400

    s_waitcnt lgkmcnt(3)
    v_add_u32_sdwa v112, v112, v86 dst_sel:DWORD dst_unused:UNUSED_PAD src0_sel:WORD_1 src1_sel:WORD_0
    v_lshlrev_b32 v112, 3, v112
    ds_write_b64 v112, v[64:65] offset:16400

    s_waitcnt lgkmcnt(3)
    v_add_u32_sdwa v113, v113, v87 dst_sel:DWORD dst_unused:UNUSED_PAD src0_sel:WORD_1 src1_sel:WORD_0
    v_lshlrev_b32 v113, 3, v113
    ds_write_b64 v113, v[66:67] offset:16400

L_skz_17:
    s_bitcmp0_b32 s28, 3
    s_cbranch_scc1 L_skz_18
    s_mov_b64 exec, s[66:67]
    v_lshrrev_b32 v110, 16, v69
    ds_read_b32 v110, v110
    v_lshrrev_b32 v111, 16, v71
    ds_read_b32 v111, v111
    v_lshrrev_b32 v112, 16, v73
    ds_read_b32 v112, v112
    v_lshrrev_b32 v113, 16, v75
    ds_read_b32 v113, v113
    s_waitcnt lgkmcnt(3)
    v_add_u32_sdwa v110, v110, v88 dst_sel:DWORD dst_unused:UNUSED_PAD src0_sel:WORD_1 src1_sel:WORD_0
    v_lshlrev_b32 v110, 3, v110
    ds_write_b64 v110, v[68:69] offset:16400

    s_waitcnt lgkmcnt(3)
    v_add_u32_sdwa v111, v111, v89 dst_sel:DWORD dst_unused:UNUSED_PAD src0_sel:WORD_1 src1_sel:WORD_0
    v_lshlrev_b32 v111, 3, v111
    ds_write_b64 v111, v[70:71] offset:16400

    s_waitcnt lgkmcnt(3)
    v_add_u32_sdwa v112, v112, v90 dst_sel:DWORD dst_unused:UNUSED_PAD src0_sel:WORD_1 src1_sel:WORD_0
    v_lshlrev_b32 v112, 3, v112
    ds_write_b64 v112, v[72:73] offset:16400

    s_waitcnt lgkmcnt(3)
    v_add_u32_sdwa v113, v113, v91 dst_sel:DWORD dst_unused:UNUSED_PAD src0_sel:WORD_1 src1_sel:WORD_0
    v_lshlrev_b32 v113, 3, v113
    ds_write_b64 v113, v[74:75] offset:16400

    s_mov_b64 exec, -1
L_skz_18:
    buffer_load_dwordx4 v[28:31], v1, s[12:15], s58 offen nt
    buffer_load_dwordx4 v[12:15], v1, s[8:11], s58 offen nt
    buffer_load_dwordx2 v[40:41], v2, s[16:19], s63 offen nt
    buffer_load_dwordx4 v[32:35], v1, s[12:15], s59 offen nt
    buffer_load_dwordx4 v[16:19], v1, s[8:11], s59 offen nt
    buffer_load_dwordx2 v[42:43], v2, s[16:19], s64 offen nt
    s_cmp_eq_u32 s49, 0
    s_cbranch_scc1 L_p1epi_6
L_p1loop_5:
    s_mov_b32 s82, s85
    s_mov_b32 s83, s86
    s_mov_b32 s84, s87
    v_mov_b32 v99, 1
    buffer_atomic_add v99, v98, s[96:99], 0 offen sc0
    s_waitcnt vmcnt(10)
    s_bitcmp0_b32 s82, 0
    s_cbranch_scc1 L_ska_19
    v_mul_hi_u32_u24 v45, s40, v20
    v_mul_hi_u32_u24 v44, s40, v4
    v_mul_hi_u32_u24 v47, s40, v21
    v_mul_hi_u32_u24 v46, s40, v5
    v_mul_hi_u32_u24 v49, s40, v22
    v_mul_hi_u32_u24 v48, s40, v6
    v_mul_hi_u32_u24 v51, s40, v23
    v_mul_hi_u32_u24 v50, s40, v7
    v_and_b32 v45, -2, v45
    v_mad_u32_u24 v4, v44, s43, v4
    v_and_b32 v76, -4, v44
    v_and_b32 v47, -2, v47
    v_mad_u32_u24 v5, v46, s43, v5
    v_and_b32 v77, -4, v46
    v_and_b32 v49, -2, v49
    v_mad_u32_u24 v6, v48, s43, v6
    v_and_b32 v78, -4, v48
    v_and_b32 v51, -2, v51
    v_mad_u32_u24 v7, v50, s43, v7
    v_and_b32 v79, -4, v50
    v_mad_i32_i24 v20, v45, s42, v20
    v_lshl_add_u32 v45, v76, 5, v45
    v_mad_i32_i24 v21, v47, s42, v21
    v_lshl_add_u32 v47, v77, 5, v47
    v_mad_i32_i24 v22, v49, s42, v22
    v_lshl_add_u32 v49, v78, 5, v49
    v_mad_i32_i24 v23, v51, s42, v23
    v_lshl_add_u32 v51, v79, 5, v51
    v_add_u32 v45, v45, v45
    ds_add_rtn_u32 v76, v45, v104
    v_add_u32 v47, v47, v47
    ds_add_rtn_u32 v77, v47, v104
    v_add_u32 v49, v49, v49
    ds_add_rtn_u32 v78, v49, v104
    v_add_u32 v51, v51, v51
    ds_add_rtn_u32 v79, v51, v104
    v_lshlrev_b32 v110, 16, v36
    v_and_b32 v111, 0xffff0000, v36
    v_lshlrev_b32 v112, 16, v37
    v_and_b32 v113, 0xffff0000, v37
    v_mul_f32 v110, s44, v110
    v_mul_f32 v111, s44, v111
    v_mul_f32 v112, s44, v112
    v_mul_f32 v113, s44, v113
    v_fract_f32 v110, v110
    v_fract_f32 v111, v111
    v_fract_f32 v112, v112
    v_fract_f32 v113, v113
    v_cos_f32 v110, v110
    v_cos_f32 v111, v111
    v_cos_f32 v112, v112
    v_cos_f32 v113, v113
    v_lshl_or_b32 v44, v44, 14, v20
    v_perm_b32 v45, v45, v4, s46
    v_bfe_u32 v4, v4, 8, 5

    v_lshl_or_b32 v46, v46, 14, v21
    v_perm_b32 v47, v47, v5, s46
    v_bfe_u32 v5, v5, 8, 5

    v_lshl_or_b32 v48, v48, 14, v22
    v_perm_b32 v49, v49, v6, s46
    v_bfe_u32 v6, v6, 8, 5

    v_lshl_or_b32 v50, v50, 14, v23
    v_perm_b32 v51, v51, v7, s46
    v_bfe_u32 v7, v7, 8, 5

    v_fmaak_f32 v110, v110, v105, 0x4b400010
    v_fmaak_f32 v111, v111, v105, 0x4b400010
    v_fmaak_f32 v112, v112, v105, 0x4b400010
    v_fmaak_f32 v113, v113, v105, 0x4b400010
    v_sub_u32 v110, v110, v4
    v_sub_u32 v111, v111, v5
    v_sub_u32 v112, v112, v6
    v_sub_u32 v113, v113, v7
    v_bfi_b32 v110, 31, v4, v110
    v_bfi_b32 v111, 31, v5, v111
    v_bfi_b32 v112, 31, v6, v112
    v_bfi_b32 v113, 31, v7, v113
    v_perm_b32 v44, v44, v110, s55
    v_perm_b32 v46, v46, v111, s55
    v_perm_b32 v48, v48, v112, s55
    v_perm_b32 v50, v50, v113, s55
L_ska_19:
    s_waitcnt vmcnt(7)
    s_bitcmp0_b32 s82, 1
    s_cbranch_scc1 L_ska_20
    v_mul_hi_u32_u24 v53, s40, v24
    v_mul_hi_u32_u24 v52, s40, v8
    v_mul_hi_u32_u24 v55, s40, v25
    v_mul_hi_u32_u24 v54, s40, v9
    v_mul_hi_u32_u24 v57, s40, v26
    v_mul_hi_u32_u24 v56, s40, v10
    v_mul_hi_u32_u24 v59, s40, v27
    v_mul_hi_u32_u24 v58, s40, v11
    v_and_b32 v53, -2, v53
    v_mad_u32_u24 v8, v52, s43, v8
    v_and_b32 v80, -4, v52
    v_and_b32 v55, -2, v55
    v_mad_u32_u24 v9, v54, s43, v9
    v_and_b32 v81, -4, v54
    v_and_b32 v57, -2, v57
    v_mad_u32_u24 v10, v56, s43, v10
    v_and_b32 v82, -4, v56
    v_and_b32 v59, -2, v59
    v_mad_u32_u24 v11, v58, s43, v11
    v_and_b32 v83, -4, v58
    v_mad_i32_i24 v24, v53, s42, v24
    v_lshl_add_u32 v53, v80, 5, v53
    v_mad_i32_i24 v25, v55, s42, v25
    v_lshl_add_u32 v55, v81, 5, v55
    v_mad_i32_i24 v26, v57, s42, v26
    v_lshl_add_u32 v57, v82, 5, v57
    v_mad_i32_i24 v27, v59, s42, v27
    v_lshl_add_u32 v59, v83, 5, v59
    v_add_u32 v53, v53, v53
    ds_add_rtn_u32 v80, v53, v104
    v_add_u32 v55, v55, v55
    ds_add_rtn_u32 v81, v55, v104
    v_add_u32 v57, v57, v57
    ds_add_rtn_u32 v82, v57, v104
    v_add_u32 v59, v59, v59
    ds_add_rtn_u32 v83, v59, v104
    v_lshlrev_b32 v110, 16, v38
    v_and_b32 v111, 0xffff0000, v38
    v_lshlrev_b32 v112, 16, v39
    v_and_b32 v113, 0xffff0000, v39
    v_mul_f32 v110, s44, v110
    v_mul_f32 v111, s44, v111
    v_mul_f32 v112, s44, v112
    v_mul_f32 v113, s44, v113
    v_fract_f32 v110, v110
    v_fract_f32 v111, v111
    v_fract_f32 v112, v112
    v_fract_f32 v113, v113
    v_cos_f32 v110, v110
    v_cos_f32 v111, v111
    v_cos_f32 v112, v112
    v_cos_f32 v113, v113
    v_lshl_or_b32 v52, v52, 14, v24
    v_perm_b32 v53, v53, v8, s46
    v_bfe_u32 v8, v8, 8, 5

    v_lshl_or_b32 v54, v54, 14, v25
    v_perm_b32 v55, v55, v9, s46
    v_bfe_u32 v9, v9, 8, 5

    v_lshl_or_b32 v56, v56, 14, v26
    v_perm_b32 v57, v57, v10, s46
    v_bfe_u32 v10, v10, 8, 5

    v_lshl_or_b32 v58, v58, 14, v27
    v_perm_b32 v59, v59, v11, s46
    v_bfe_u32 v11, v11, 8, 5

    v_fmaak_f32 v110, v110, v105, 0x4b400010
    v_fmaak_f32 v111, v111, v105, 0x4b400010
    v_fmaak_f32 v112, v112, v105, 0x4b400010
    v_fmaak_f32 v113, v113, v105, 0x4b400010
    v_sub_u32 v110, v110, v8
    v_sub_u32 v111, v111, v9
    v_sub_u32 v112, v112, v10
    v_sub_u32 v113, v113, v11
    v_bfi_b32 v110, 31, v8, v110
    v_bfi_b32 v111, 31, v9, v111
    v_bfi_b32 v112, 31, v10, v112
    v_bfi_b32 v113, 31, v11, v113
    v_perm_b32 v52, v52, v110, s55
    v_perm_b32 v54, v54, v111, s55
    v_perm_b32 v56, v56, v112, s55
    v_perm_b32 v58, v58, v113, s55
L_ska_20:
    s_waitcnt vmcnt(1)
    s_waitcnt vmcnt(0)
    v_cmp_eq_u32 vcc, 0, v0
    s_mov_b64 exec, vcc
    ds_write_b32 v108, v99 offset:8
    s_mov_b64 exec, -1
    s_waitcnt vmcnt(10)
    v_add_u32 v110, v92, v94
    v_min_u32 v92, s48, v92
    v_add_u32 v111, v93, v95
    v_min_u32 v93, s48, v93
    v_max_u32 v110, v110, v111
    v_add_u32 v92, v92, v96
    v_add_u32 v93, v93, v97
    v_cmp_le_u32 vcc, s48, v110
    v_lshl_add_u32 v92, v92, 2, v92
    v_lshl_add_u32 v93, v93, 2, v93
    ds_write_b64 v2, v[92:93] offset:8192
    s_cbranch_vccz L_noov_21
    ds_write_b32 v108, v104 offset:4
L_noov_21:

    s_waitcnt lgkmcnt(0)
    s_barrier
    ds_read2_b32 v[110:111], v108 offset0:1 offset1:2
    s_waitcnt lgkmcnt(0)
    v_readfirstlane_b32 s53, v110
    v_readfirstlane_b32 s41, v111
    s_nop 1

    s_add_u32 s41, s41, 160
    s_sub_u32 s78, s41, 3008
    s_lshr_b32 s79, s78, 1
    s_add_u32 s79, s79, 3008
    s_and_b32 s86, s78, 1
    s_lshl_b32 s86, s86, 1
    s_add_u32 s87, s86, 2
    s_cmp_lt_u32 s41, 3008
    s_cselect_b32 s41, s41, s79
    s_cmovk_i32 s86, 0
    s_cmovk_i32 s87, 4

    s_mul_i32 s78, s41, 16000
    s_add_u32 s49, s78, 16000
    s_cmp_ge_u32 s41, 3200
    s_cmovk_i32 s49, 0
    s_cmovk_i32 s78, 0
    s_lshl_b32 s10, s49, 2
    s_lshl_b32 s14, s49, 2
    s_lshl_b32 s18, s49, 1
    s_sub_u32 s79, s87, s86
    s_bfm_b32 s85, s79, s86
    s_lshl_b32 s86, s86, 12
    s_lshl_b32 s87, s87, 12
    s_min_u32 s87, s87, 16000

    s_add_u32 s79, s78, 0
    s_bitcmp1_b32 s85, 0
    s_cselect_b32 s79, s79, 0x1ff00000
    s_lshl_b32 s56, s79, 2
    s_lshl_b32 s61, s79, 1

    s_add_u32 s79, s78, 4096
    s_bitcmp1_b32 s85, 1
    s_cselect_b32 s79, s79, 0x1ff00000
    s_lshl_b32 s57, s79, 2
    s_lshl_b32 s62, s79, 1

    s_add_u32 s79, s78, 8192
    s_bitcmp1_b32 s85, 2
    s_cselect_b32 s79, s79, 0x1ff00000
    s_lshl_b32 s58, s79, 2
    s_lshl_b32 s63, s79, 1

    s_add_u32 s79, s78, 12288
    s_bitcmp1_b32 s85, 3
    s_cselect_b32 s79, s79, 0x1ff00000
    s_lshl_b32 s59, s79, 2
    s_lshl_b32 s64, s79, 1

    s_cmp_lg_u32 s53, 0
    s_cbranch_scc1 L_slow_22
L_sback_23:
    s_bitcmp0_b32 s28, 0
    s_cbranch_scc1 L_skw_27
    ds_read_b64 v[110:111], v2 offset:16400
    ds_read_b64 v[112:113], v2 offset:16408
    ds_read_b64 v[114:115], v2 offset:16392

    ds_read_b64 v[118:119], v2 offset:24592
    ds_read_b64 v[120:121], v2 offset:24600
    ds_read_b64 v[122:123], v2 offset:24584

    s_waitcnt lgkmcnt(3)
    v_lshrrev_b32 v116, 16, v111
    ds_read_b32 v116, v116 offset:8192

    s_waitcnt lgkmcnt(1)
    v_lshrrev_b32 v124, 16, v119
    ds_read_b32 v124, v124 offset:8192

    v_cmp_ne_u32_sdwa s[80:81], v111, v113 src0_sel:WORD_1 src1_sel:WORD_1
    v_cmp_ne_u32_sdwa vcc, v111, v115 src0_sel:WORD_1 src1_sel:WORD_1
    v_alignbyte_b32 v114, v115, v114, 2
    s_mov_b32 s54, -3
    v_alignbyte_b32 v111, v111, v110, 1
    v_perm_b32 v110, v110, v114, s47
    s_waitcnt lgkmcnt(1)
    v_add3_u32 v116, v116, v106, s54
    v_sub_u32 v117, 0, v116
    v_and_b32 v117, 3, v117
    s_mov_b64 exec, s[80:81]
    v_mov_b32 v117, 0
    v_mov_b32 v112, 0
    s_mov_b64 exec, vcc
    v_mov_b32 v117, 3

    s_mov_b64 exec, -1
    v_alignbyte_b32 v110, v111, v110, v117
    v_alignbyte_b32 v111, v112, v111, v117
    v_add_u32 v116, v116, v117

    buffer_store_dwordx2 v[110:111], v116, s[24:27], 0 offen
    v_cmp_ne_u32_sdwa s[80:81], v119, v121 src0_sel:WORD_1 src1_sel:WORD_1
    v_cmp_ne_u32_sdwa vcc, v119, v123 src0_sel:WORD_1 src1_sel:WORD_1
    v_alignbyte_b32 v122, v123, v122, 2
    s_mov_b32 s54, 5117
    v_alignbyte_b32 v119, v119, v118, 1
    v_perm_b32 v118, v118, v122, s47
    s_waitcnt lgkmcnt(0)
    v_add3_u32 v124, v124, v106, s54
    v_sub_u32 v125, 0, v124
    v_and_b32 v125, 3, v125
    s_mov_b64 exec, s[80:81]
    v_mov_b32 v125, 0
    v_mov_b32 v120, 0
    s_mov_b64 exec, vcc
    v_mov_b32 v125, 3

    s_mov_b64 exec, -1
    v_alignbyte_b32 v118, v119, v118, v125
    v_alignbyte_b32 v119, v120, v119, v125
    v_add_u32 v124, v124, v125

    buffer_store_dwordx2 v[118:119], v124, s[24:27], 0 offen
L_skw_27:
    s_bitcmp0_b32 s28, 0
    s_cbranch_scc1 L_skw_28
    ds_read_b64 v[110:111], v2 offset:32784
    ds_read_b64 v[112:113], v2 offset:32792
    ds_read_b64 v[114:115], v2 offset:32776

    ds_read_b64 v[118:119], v2 offset:40976
    ds_read_b64 v[120:121], v2 offset:40984
    ds_read_b64 v[122:123], v2 offset:40968

    s_waitcnt lgkmcnt(3)
    v_lshrrev_b32 v116, 16, v111
    ds_read_b32 v116, v116 offset:8192

    s_waitcnt lgkmcnt(1)
    v_lshrrev_b32 v124, 16, v119
    ds_read_b32 v124, v124 offset:8192

    v_cmp_ne_u32_sdwa s[80:81], v111, v113 src0_sel:WORD_1 src1_sel:WORD_1
    v_cmp_ne_u32_sdwa vcc, v111, v115 src0_sel:WORD_1 src1_sel:WORD_1
    v_alignbyte_b32 v114, v115, v114, 2
    s_mov_b32 s54, 10237
    v_alignbyte_b32 v111, v111, v110, 1
    v_perm_b32 v110, v110, v114, s47
    s_waitcnt lgkmcnt(1)
    v_add3_u32 v116, v116, v106, s54
    v_sub_u32 v117, 0, v116
    v_and_b32 v117, 3, v117
    s_mov_b64 exec, s[80:81]
    v_mov_b32 v117, 0
    v_mov_b32 v112, 0
    s_mov_b64 exec, vcc
    v_mov_b32 v117, 3

    s_mov_b64 exec, -1
    v_alignbyte_b32 v110, v111, v110, v117
    v_alignbyte_b32 v111, v112, v111, v117
    v_add_u32 v116, v116, v117

    buffer_store_dwordx2 v[110:111], v116, s[24:27], 0 offen
    v_cmp_ne_u32_sdwa s[80:81], v119, v121 src0_sel:WORD_1 src1_sel:WORD_1
    v_cmp_ne_u32_sdwa vcc, v119, v123 src0_sel:WORD_1 src1_sel:WORD_1
    v_alignbyte_b32 v122, v123, v122, 2
    s_mov_b32 s54, 15357
    v_alignbyte_b32 v119, v119, v118, 1
    v_perm_b32 v118, v118, v122, s47
    s_waitcnt lgkmcnt(0)
    v_add3_u32 v124, v124, v106, s54
    v_sub_u32 v125, 0, v124
    v_and_b32 v125, 3, v125
    s_mov_b64 exec, s[80:81]
    v_mov_b32 v125, 0
    v_mov_b32 v120, 0
    s_mov_b64 exec, vcc
    v_mov_b32 v125, 3

    s_mov_b64 exec, -1
    v_alignbyte_b32 v118, v119, v118, v125
    v_alignbyte_b32 v119, v120, v119, v125
    v_add_u32 v124, v124, v125

    buffer_store_dwordx2 v[118:119], v124, s[24:27], 0 offen
L_skw_28:
    s_bitcmp0_b32 s82, 2
    s_cbranch_scc1 L_ska_29
    v_mul_hi_u32_u24 v61, s40, v28
    v_mul_hi_u32_u24 v60, s40, v12
    v_mul_hi_u32_u24 v63, s40, v29
    v_mul_hi_u32_u24 v62, s40, v13
    v_mul_hi_u32_u24 v65, s40, v30
    v_mul_hi_u32_u24 v64, s40, v14
    v_mul_hi_u32_u24 v67, s40, v31
    v_mul_hi_u32_u24 v66, s40, v15
    v_and_b32 v61, -2, v61
    v_mad_u32_u24 v12, v60, s43, v12
    v_and_b32 v84, -4, v60
    v_and_b32 v63, -2, v63
    v_mad_u32_u24 v13, v62, s43, v13
    v_and_b32 v85, -4, v62
    v_and_b32 v65, -2, v65
    v_mad_u32_u24 v14, v64, s43, v14
    v_and_b32 v86, -4, v64
    v_and_b32 v67, -2, v67
    v_mad_u32_u24 v15, v66, s43, v15
    v_and_b32 v87, -4, v66
    v_mad_i32_i24 v28, v61, s42, v28
    v_lshl_add_u32 v61, v84, 5, v61
    v_mad_i32_i24 v29, v63, s42, v29
    v_lshl_add_u32 v63, v85, 5, v63
    v_mad_i32_i24 v30, v65, s42, v30
    v_lshl_add_u32 v65, v86, 5, v65
    v_mad_i32_i24 v31, v67, s42, v31
    v_lshl_add_u32 v67, v87, 5, v67
    v_add_u32 v61, v61, v61
    ds_add_rtn_u32 v84, v61, v104
    v_add_u32 v63, v63, v63
    ds_add_rtn_u32 v85, v63, v104
    v_add_u32 v65, v65, v65
    ds_add_rtn_u32 v86, v65, v104
    v_add_u32 v67, v67, v67
    ds_add_rtn_u32 v87, v67, v104
    v_lshlrev_b32 v110, 16, v40
    v_and_b32 v111, 0xffff0000, v40
    v_lshlrev_b32 v112, 16, v41
    v_and_b32 v113, 0xffff0000, v41
    v_mul_f32 v110, s44, v110
    v_mul_f32 v111, s44, v111
    v_mul_f32 v112, s44, v112
    v_mul_f32 v113, s44, v113
    v_fract_f32 v110, v110
    v_fract_f32 v111, v111
    v_fract_f32 v112, v112
    v_fract_f32 v113, v113
    v_cos_f32 v110, v110
    v_cos_f32 v111, v111
    v_cos_f32 v112, v112
    v_cos_f32 v113, v113
    v_lshl_or_b32 v60, v60, 14, v28
    v_perm_b32 v61, v61, v12, s46
    v_bfe_u32 v12, v12, 8, 5

    v_lshl_or_b32 v62, v62, 14, v29
    v_perm_b32 v63, v63, v13, s46
    v_bfe_u32 v13, v13, 8, 5

    v_lshl_or_b32 v64, v64, 14, v30
    v_perm_b32 v65, v65, v14, s46
    v_bfe_u32 v14, v14, 8, 5

    v_lshl_or_b32 v66, v66, 14, v31
    v_perm_b32 v67, v67, v15, s46
    v_bfe_u32 v15, v15, 8, 5

    v_fmaak_f32 v110, v110, v105, 0x4b400010
    v_fmaak_f32 v111, v111, v105, 0x4b400010
    v_fmaak_f32 v112, v112, v105, 0x4b400010
    v_fmaak_f32 v113, v113, v105, 0x4b400010
    v_sub_u32 v110, v110, v12
    v_sub_u32 v111, v111, v13
    v_sub_u32 v112, v112, v14
    v_sub_u32 v113, v113, v15
    v_bfi_b32 v110, 31, v12, v110
    v_bfi_b32 v111, 31, v13, v111
    v_bfi_b32 v112, 31, v14, v112
    v_bfi_b32 v113, 31, v15, v113
    v_perm_b32 v60, v60, v110, s55
    v_perm_b32 v62, v62, v111, s55
    v_perm_b32 v64, v64, v112, s55
    v_perm_b32 v66, v66, v113, s55
L_ska_29:
    s_bitcmp0_b32 s28, 1
    s_cbranch_scc1 L_skw_30
    v_add_u32 v107, 32768, v2
    ds_read_b64 v[110:111], v107 offset:16400
    ds_read_b64 v[112:113], v107 offset:16408
    ds_read_b64 v[114:115], v107 offset:16392

    ds_read_b64 v[118:119], v107 offset:24592
    ds_read_b64 v[120:121], v107 offset:24600
    ds_read_b64 v[122:123], v107 offset:24584

    s_waitcnt lgkmcnt(3)
    v_lshrrev_b32 v116, 16, v111
    ds_read_b32 v116, v116 offset:8192

    s_waitcnt lgkmcnt(1)
    v_lshrrev_b32 v124, 16, v119
    ds_read_b32 v124, v124 offset:8192

    v_cmp_ne_u32_sdwa s[80:81], v111, v113 src0_sel:WORD_1 src1_sel:WORD_1
    v_cmp_ne_u32_sdwa vcc, v111, v115 src0_sel:WORD_1 src1_sel:WORD_1
    v_alignbyte_b32 v114, v115, v114, 2
    s_mov_b32 s54, 20477
    v_alignbyte_b32 v111, v111, v110, 1
    v_perm_b32 v110, v110, v114, s47
    s_waitcnt lgkmcnt(1)
    v_add3_u32 v116, v116, v106, s54
    v_sub_u32 v117, 0, v116
    v_and_b32 v117, 3, v117
    s_mov_b64 exec, s[80:81]
    v_mov_b32 v117, 0
    v_mov_b32 v112, 0
    s_mov_b64 exec, vcc
    v_mov_b32 v117, 3

    s_mov_b64 exec, -1
    v_alignbyte_b32 v110, v111, v110, v117
    v_alignbyte_b32 v111, v112, v111, v117
    v_add_u32 v116, v116, v117

    buffer_store_dwordx2 v[110:111], v116, s[24:27], 0 offen
    v_cmp_ne_u32_sdwa s[80:81], v119, v121 src0_sel:WORD_1 src1_sel:WORD_1
    v_cmp_ne_u32_sdwa vcc, v119, v123 src0_sel:WORD_1 src1_sel:WORD_1
    v_alignbyte_b32 v122, v123, v122, 2
    s_mov_b32 s54, 25597
    v_alignbyte_b32 v119, v119, v118, 1
    v_perm_b32 v118, v118, v122, s47
    s_waitcnt lgkmcnt(0)
    v_add3_u32 v124, v124, v106, s54
    v_sub_u32 v125, 0, v124
    v_and_b32 v125, 3, v125
    s_mov_b64 exec, s[80:81]
    v_mov_b32 v125, 0
    v_mov_b32 v120, 0
    s_mov_b64 exec, vcc
    v_mov_b32 v125, 3

    s_mov_b64 exec, -1
    v_alignbyte_b32 v118, v119, v118, v125
    v_alignbyte_b32 v119, v120, v119, v125
    v_add_u32 v124, v124, v125

    buffer_store_dwordx2 v[118:119], v124, s[24:27], 0 offen
L_skw_30:
    s_bitcmp0_b32 s28, 1
    s_cbranch_scc1 L_skw_31
    v_add_u32 v107, 32768, v2
    ds_read_b64 v[110:111], v107 offset:32784
    ds_read_b64 v[112:113], v107 offset:32792
    ds_read_b64 v[114:115], v107 offset:32776

    ds_read_b64 v[118:119], v107 offset:40976
    ds_read_b64 v[120:121], v107 offset:40984
    ds_read_b64 v[122:123], v107 offset:40968

    s_waitcnt lgkmcnt(3)
    v_lshrrev_b32 v116, 16, v111
    ds_read_b32 v116, v116 offset:8192

    s_waitcnt lgkmcnt(1)
    v_lshrrev_b32 v124, 16, v119
    ds_read_b32 v124, v124 offset:8192

    v_cmp_ne_u32_sdwa s[80:81], v111, v113 src0_sel:WORD_1 src1_sel:WORD_1
    v_cmp_ne_u32_sdwa vcc, v111, v115 src0_sel:WORD_1 src1_sel:WORD_1
    v_alignbyte_b32 v114, v115, v114, 2
    s_mov_b32 s54, 30717
    v_alignbyte_b32 v111, v111, v110, 1
    v_perm_b32 v110, v110, v114, s47
    s_waitcnt lgkmcnt(1)
    v_add3_u32 v116, v116, v106, s54
    v_sub_u32 v117, 0, v116
    v_and_b32 v117, 3, v117
    s_mov_b64 exec, s[80:81]
    v_mov_b32 v117, 0
    v_mov_b32 v112, 0
    s_mov_b64 exec, vcc
    v_mov_b32 v117, 3

    s_mov_b64 exec, -1
    v_alignbyte_b32 v110, v111, v110, v117
    v_alignbyte_b32 v111, v112, v111, v117
    v_add_u32 v116, v116, v117

    buffer_store_dwordx2 v[110:111], v116, s[24:27], 0 offen
    v_cmp_ne_u32_sdwa s[80:81], v119, v121 src0_sel:WORD_1 src1_sel:WORD_1
    v_cmp_ne_u32_sdwa vcc, v119, v123 src0_sel:WORD_1 src1_sel:WORD_1
    v_alignbyte_b32 v122, v123, v122, 2
    s_mov_b32 s54, 35837
    v_alignbyte_b32 v119, v119, v118, 1
    v_perm_b32 v118, v118, v122, s47
    s_waitcnt lgkmcnt(0)
    v_add3_u32 v124, v124, v106, s54
    v_sub_u32 v125, 0, v124
    v_and_b32 v125, 3, v125
    s_mov_b64 exec, s[80:81]
    v_mov_b32 v125, 0
    v_mov_b32 v120, 0
    s_mov_b64 exec, vcc
    v_mov_b32 v125, 3

    s_mov_b64 exec, -1
    v_alignbyte_b32 v118, v119, v118, v125
    v_alignbyte_b32 v119, v120, v119, v125
    v_add_u32 v124, v124, v125

    buffer_store_dwordx2 v[118:119], v124, s[24:27], 0 offen
L_skw_31:
    s_bitcmp0_b32 s28, 2
    s_cbranch_scc1 L_skw_32
    v_add_u32 v107, 65536, v2
    ds_read_b64 v[110:111], v107 offset:16400
    ds_read_b64 v[112:113], v107 offset:16408
    ds_read_b64 v[114:115], v107 offset:16392

    ds_read_b64 v[118:119], v107 offset:24592
    ds_read_b64 v[120:121], v107 offset:24600
    ds_read_b64 v[122:123], v107 offset:24584

    s_waitcnt lgkmcnt(3)
    v_lshrrev_b32 v116, 16, v111
    ds_read_b32 v116, v116 offset:8192

    s_waitcnt lgkmcnt(1)
    v_lshrrev_b32 v124, 16, v119
    ds_read_b32 v124, v124 offset:8192

    v_cmp_ne_u32_sdwa s[80:81], v111, v113 src0_sel:WORD_1 src1_sel:WORD_1
    v_cmp_ne_u32_sdwa vcc, v111, v115 src0_sel:WORD_1 src1_sel:WORD_1
    v_alignbyte_b32 v114, v115, v114, 2
    s_mov_b32 s54, 40957
    v_alignbyte_b32 v111, v111, v110, 1
    v_perm_b32 v110, v110, v114, s47
    s_waitcnt lgkmcnt(1)
    v_add3_u32 v116, v116, v106, s54
    v_sub_u32 v117, 0, v116
    v_and_b32 v117, 3, v117
    s_mov_b64 exec, s[80:81]
    v_mov_b32 v117, 0
    v_mov_b32 v112, 0
    s_mov_b64 exec, vcc
    v_mov_b32 v117, 3

    s_mov_b64 exec, -1
    v_alignbyte_b32 v110, v111, v110, v117
    v_alignbyte_b32 v111, v112, v111, v117
    v_add_u32 v116, v116, v117

    buffer_store_dwordx2 v[110:111], v116, s[24:27], 0 offen
    v_cmp_ne_u32_sdwa s[80:81], v119, v121 src0_sel:WORD_1 src1_sel:WORD_1
    v_cmp_ne_u32_sdwa vcc, v119, v123 src0_sel:WORD_1 src1_sel:WORD_1
    v_alignbyte_b32 v122, v123, v122, 2
    s_mov_b32 s54, 46077
    v_alignbyte_b32 v119, v119, v118, 1
    v_perm_b32 v118, v118, v122, s47
    s_waitcnt lgkmcnt(0)
    v_add3_u32 v124, v124, v106, s54
    v_sub_u32 v125, 0, v124
    v_and_b32 v125, 3, v125
    s_mov_b64 exec, s[80:81]
    v_mov_b32 v125, 0
    v_mov_b32 v120, 0
    s_mov_b64 exec, vcc
    v_mov_b32 v125, 3

    s_mov_b64 exec, -1
    v_alignbyte_b32 v118, v119, v118, v125
    v_alignbyte_b32 v119, v120, v119, v125
    v_add_u32 v124, v124, v125

    buffer_store_dwordx2 v[118:119], v124, s[24:27], 0 offen
L_skw_32:
    s_bitcmp0_b32 s82, 3
    s_cbranch_scc1 L_ska_33
    s_mov_b64 exec, s[66:67]
    v_mul_hi_u32_u24 v69, s40, v32
    v_mul_hi_u32_u24 v68, s40, v16
    v_mul_hi_u32_u24 v71, s40, v33
    v_mul_hi_u32_u24 v70, s40, v17
    v_mul_hi_u32_u24 v73, s40, v34
    v_mul_hi_u32_u24 v72, s40, v18
    v_mul_hi_u32_u24 v75, s40, v35
    v_mul_hi_u32_u24 v74, s40, v19
    v_and_b32 v69, -2, v69
    v_mad_u32_u24 v16, v68, s43, v16
    v_and_b32 v88, -4, v68
    v_and_b32 v71, -2, v71
    v_mad_u32_u24 v17, v70, s43, v17
    v_and_b32 v89, -4, v70
    v_and_b32 v73, -2, v73
    v_mad_u32_u24 v18, v72, s43, v18
    v_and_b32 v90, -4, v72
    v_and_b32 v75, -2, v75
    v_mad_u32_u24 v19, v74, s43, v19
    v_and_b32 v91, -4, v74
    v_mad_i32_i24 v32, v69, s42, v32
    v_lshl_add_u32 v69, v88, 5, v69
    v_mad_i32_i24 v33, v71, s42, v33
    v_lshl_add_u32 v71, v89, 5, v71
    v_mad_i32_i24 v34, v73, s42, v34
    v_lshl_add_u32 v73, v90, 5, v73
    v_mad_i32_i24 v35, v75, s42, v35
    v_lshl_add_u32 v75, v91, 5, v75
    v_add_u32 v69, v69, v69
    ds_add_rtn_u32 v88, v69, v104
    v_add_u32 v71, v71, v71
    ds_add_rtn_u32 v89, v71, v104
    v_add_u32 v73, v73, v73
    ds_add_rtn_u32 v90, v73, v104
    v_add_u32 v75, v75, v75
    ds_add_rtn_u32 v91, v75, v104
    v_lshlrev_b32 v110, 16, v42
    v_and_b32 v111, 0xffff0000, v42
    v_lshlrev_b32 v112, 16, v43
    v_and_b32 v113, 0xffff0000, v43
    v_mul_f32 v110, s44, v110
    v_mul_f32 v111, s44, v111
    v_mul_f32 v112, s44, v112
    v_mul_f32 v113, s44, v113
    v_fract_f32 v110, v110
    v_fract_f32 v111, v111
    v_fract_f32 v112, v112
    v_fract_f32 v113, v113
    v_cos_f32 v110, v110
    v_cos_f32 v111, v111
    v_cos_f32 v112, v112
    v_cos_f32 v113, v113
    v_lshl_or_b32 v68, v68, 14, v32
    v_perm_b32 v69, v69, v16, s46
    v_bfe_u32 v16, v16, 8, 5

    v_lshl_or_b32 v70, v70, 14, v33
    v_perm_b32 v71, v71, v17, s46
    v_bfe_u32 v17, v17, 8, 5

    v_lshl_or_b32 v72, v72, 14, v34
    v_perm_b32 v73, v73, v18, s46
    v_bfe_u32 v18, v18, 8, 5

    v_lshl_or_b32 v74, v74, 14, v35
    v_perm_b32 v75, v75, v19, s46
    v_bfe_u32 v19, v19, 8, 5

    v_fmaak_f32 v110, v110, v105, 0x4b400010
    v_fmaak_f32 v111, v111, v105, 0x4b400010
    v_fmaak_f32 v112, v112, v105, 0x4b400010
    v_fmaak_f32 v113, v113, v105, 0x4b400010
    v_sub_u32 v110, v110, v16
    v_sub_u32 v111, v111, v17
    v_sub_u32 v112, v112, v18
    v_sub_u32 v113, v113, v19
    v_bfi_b32 v110, 31, v16, v110
    v_bfi_b32 v111, 31, v17, v111
    v_bfi_b32 v112, 31, v18, v112
    v_bfi_b32 v113, 31, v19, v113
    v_perm_b32 v68, v68, v110, s55
    v_perm_b32 v70, v70, v111, s55
    v_perm_b32 v72, v72, v112, s55
    v_perm_b32 v74, v74, v113, s55
    s_mov_b64 exec, -1
L_ska_33:
    s_bitcmp0_b32 s28, 2
    s_cbranch_scc1 L_skw_34
    v_add_u32 v107, 65536, v2
    ds_read_b64 v[110:111], v107 offset:32784
    ds_read_b64 v[112:113], v107 offset:32792
    ds_read_b64 v[114:115], v107 offset:32776

    ds_read_b64 v[118:119], v107 offset:40976
    ds_read_b64 v[120:121], v107 offset:40984
    ds_read_b64 v[122:123], v107 offset:40968

    s_waitcnt lgkmcnt(3)
    v_lshrrev_b32 v116, 16, v111
    ds_read_b32 v116, v116 offset:8192

    s_waitcnt lgkmcnt(1)
    v_lshrrev_b32 v124, 16, v119
    ds_read_b32 v124, v124 offset:8192

    v_cmp_ne_u32_sdwa s[80:81], v111, v113 src0_sel:WORD_1 src1_sel:WORD_1
    v_cmp_ne_u32_sdwa vcc, v111, v115 src0_sel:WORD_1 src1_sel:WORD_1
    v_alignbyte_b32 v114, v115, v114, 2
    s_mov_b32 s54, 51197
    v_alignbyte_b32 v111, v111, v110, 1
    v_perm_b32 v110, v110, v114, s47
    s_waitcnt lgkmcnt(1)
    v_add3_u32 v116, v116, v106, s54
    v_sub_u32 v117, 0, v116
    v_and_b32 v117, 3, v117
    s_mov_b64 exec, s[80:81]
    v_mov_b32 v117, 0
    v_mov_b32 v112, 0
    s_mov_b64 exec, vcc
    v_mov_b32 v117, 3

    s_mov_b64 exec, -1
    v_alignbyte_b32 v110, v111, v110, v117
    v_alignbyte_b32 v111, v112, v111, v117
    v_add_u32 v116, v116, v117

    buffer_store_dwordx2 v[110:111], v116, s[24:27], 0 offen
    v_cmp_ne_u32_sdwa s[80:81], v119, v121 src0_sel:WORD_1 src1_sel:WORD_1
    v_cmp_ne_u32_sdwa vcc, v119, v123 src0_sel:WORD_1 src1_sel:WORD_1
    v_alignbyte_b32 v122, v123, v122, 2
    s_mov_b32 s54, 56317
    v_alignbyte_b32 v119, v119, v118, 1
    v_perm_b32 v118, v118, v122, s47
    s_waitcnt lgkmcnt(0)
    v_add3_u32 v124, v124, v106, s54
    v_sub_u32 v125, 0, v124
    v_and_b32 v125, 3, v125
    s_mov_b64 exec, s[80:81]
    v_mov_b32 v125, 0
    v_mov_b32 v120, 0
    s_mov_b64 exec, vcc
    v_mov_b32 v125, 3

    s_mov_b64 exec, -1
    v_alignbyte_b32 v118, v119, v118, v125
    v_alignbyte_b32 v119, v120, v119, v125
    v_add_u32 v124, v124, v125

    buffer_store_dwordx2 v[118:119], v124, s[24:27], 0 offen
L_skw_34:
    s_bitcmp0_b32 s28, 3
    s_cbranch_scc1 L_skw_35
    v_add_u32 v107, 98304, v2
    ds_read_b64 v[110:111], v107 offset:16400
    ds_read_b64 v[112:113], v107 offset:16408
    ds_read_b64 v[114:115], v107 offset:16392

    ds_read_b64 v[118:119], v107 offset:24592
    ds_read_b64 v[120:121], v107 offset:24600
    ds_read_b64 v[122:123], v107 offset:24584

    s_waitcnt lgkmcnt(3)
    v_lshrrev_b32 v116, 16, v111
    ds_read_b32 v116, v116 offset:8192

    s_waitcnt lgkmcnt(1)
    v_lshrrev_b32 v124, 16, v119
    ds_read_b32 v124, v124 offset:8192

    v_cmp_ne_u32_sdwa s[80:81], v111, v113 src0_sel:WORD_1 src1_sel:WORD_1
    v_cmp_ne_u32_sdwa vcc, v111, v115 src0_sel:WORD_1 src1_sel:WORD_1
    v_alignbyte_b32 v114, v115, v114, 2
    s_mov_b32 s54, 61437
    v_alignbyte_b32 v111, v111, v110, 1
    v_perm_b32 v110, v110, v114, s47
    s_waitcnt lgkmcnt(1)
    v_add3_u32 v116, v116, v106, s54
    v_sub_u32 v117, 0, v116
    v_and_b32 v117, 3, v117
    s_mov_b64 exec, s[80:81]
    v_mov_b32 v117, 0
    v_mov_b32 v112, 0
    s_mov_b64 exec, vcc
    v_mov_b32 v117, 3

    s_mov_b64 exec, -1
    v_alignbyte_b32 v110, v111, v110, v117
    v_alignbyte_b32 v111, v112, v111, v117
    v_add_u32 v116, v116, v117

    buffer_store_dwordx2 v[110:111], v116, s[24:27], 0 offen
    v_cmp_ne_u32_sdwa s[80:81], v119, v121 src0_sel:WORD_1 src1_sel:WORD_1
    v_cmp_ne_u32_sdwa vcc, v119, v123 src0_sel:WORD_1 src1_sel:WORD_1
    v_alignbyte_b32 v122, v123, v122, 2
    s_mov_b32 s54, 66557
    v_alignbyte_b32 v119, v119, v118, 1
    v_perm_b32 v118, v118, v122, s47
    s_waitcnt lgkmcnt(0)
    v_add3_u32 v124, v124, v106, s54
    v_sub_u32 v125, 0, v124
    v_and_b32 v125, 3, v125
    s_mov_b64 exec, s[80:81]
    v_mov_b32 v125, 0
    v_mov_b32 v120, 0
    s_mov_b64 exec, vcc
    v_mov_b32 v125, 3

    s_mov_b64 exec, -1
    v_alignbyte_b32 v118, v119, v118, v125
    v_alignbyte_b32 v119, v120, v119, v125
    v_add_u32 v124, v124, v125

    buffer_store_dwordx2 v[118:119], v124, s[24:27], 0 offen
L_skw_35:
    s_bitcmp0_b32 s28, 3
    s_cbranch_scc1 L_skw_36
    v_add_u32 v107, 98304, v2
    ds_read_b64 v[110:111], v107 offset:32784
    ds_read_b64 v[112:113], v107 offset:32792
    ds_read_b64 v[114:115], v107 offset:32776

    ds_read_b64 v[118:119], v107 offset:40976
    ds_read_b64 v[120:121], v107 offset:40984
    ds_read_b64 v[122:123], v107 offset:40968

    s_waitcnt lgkmcnt(3)
    v_lshrrev_b32 v116, 16, v111
    ds_read_b32 v116, v116 offset:8192

    s_waitcnt lgkmcnt(1)
    v_lshrrev_b32 v124, 16, v119
    ds_read_b32 v124, v124 offset:8192

    v_cmp_ne_u32_sdwa s[80:81], v111, v113 src0_sel:WORD_1 src1_sel:WORD_1
    v_cmp_ne_u32_sdwa vcc, v111, v115 src0_sel:WORD_1 src1_sel:WORD_1
    v_alignbyte_b32 v114, v115, v114, 2
    s_mov_b32 s54, 71677
    v_alignbyte_b32 v111, v111, v110, 1
    v_perm_b32 v110, v110, v114, s47
    s_waitcnt lgkmcnt(1)
    v_add3_u32 v116, v116, v106, s54
    v_sub_u32 v117, 0, v116
    v_and_b32 v117, 3, v117
    s_mov_b64 exec, s[80:81]
    v_mov_b32 v117, 0
    v_mov_b32 v112, 0
    s_mov_b64 exec, vcc
    v_mov_b32 v117, 3

    s_mov_b64 exec, -1
    v_alignbyte_b32 v110, v111, v110, v117
    v_alignbyte_b32 v111, v112, v111, v117
    v_add_u32 v116, v116, v117

    buffer_store_dwordx2 v[110:111], v116, s[24:27], 0 offen
    v_cmp_ne_u32_sdwa s[80:81], v119, v121 src0_sel:WORD_1 src1_sel:WORD_1
    v_cmp_ne_u32_sdwa vcc, v119, v123 src0_sel:WORD_1 src1_sel:WORD_1
    v_alignbyte_b32 v122, v123, v122, 2
    s_mov_b32 s54, 76797
    v_alignbyte_b32 v119, v119, v118, 1
    v_perm_b32 v118, v118, v122, s47
    s_waitcnt lgkmcnt(0)
    v_add3_u32 v124, v124, v106, s54
    v_sub_u32 v125, 0, v124
    v_and_b32 v125, 3, v125
    s_mov_b64 exec, s[80:81]
    v_mov_b32 v125, 0
    v_mov_b32 v120, 0
    s_mov_b64 exec, vcc
    v_mov_b32 v125, 3

    s_andn2_b64 exec, -1, s[68:69]
    v_bfrev_b32 v124, 1
    s_mov_b64 exec, -1
    v_alignbyte_b32 v118, v119, v118, v125
    v_alignbyte_b32 v119, v120, v119, v125
    v_add_u32 v124, v124, v125

    buffer_store_dwordx2 v[118:119], v124, s[24:27], 0 offen
L_skw_36:
    s_waitcnt lgkmcnt(0)
    s_barrier

    buffer_load_dwordx4 v[20:23], v1, s[12:15], s56 offen nt
    buffer_load_dwordx4 v[4:7], v1, s[8:11], s56 offen nt
    buffer_load_dwordx2 v[36:37], v2, s[16:19], s61 offen nt
    ds_read_b64 v[94:95], v2
    s_waitcnt lgkmcnt(0)
    v_and_b32 v94, 0xffff, v94
    v_and_b32 v95, 0xffff, v95
    v_add_u32 v97, v94, v95
    s_nop 1
    v_add_u32_dpp v97, v97, v97 row_shr:1 row_mask:0xf bank_mask:0xf
    s_nop 1
    v_add_u32_dpp v97, v97, v97 row_shr:2 row_mask:0xf bank_mask:0xf
    s_nop 1
    v_add_u32_dpp v97, v97, v97 row_shr:4 row_mask:0xf bank_mask:0xf
    s_nop 1
    v_add_u32_dpp v97, v97, v97 row_shr:8 row_mask:0xf bank_mask:0xf
    s_nop 1
    v_add_u32_dpp v97, v97, v97 row_bcast:15 row_mask:0xa bank_mask:0xf
    s_nop 1
    v_add_u32_dpp v97, v97, v97 row_bcast:31 row_mask:0xc bank_mask:0xf
    s_mov_b32 exec_lo, 0
    s_brev_b32 exec_hi, 1
    ds_add_rtn_u32 v96, v108, v97
    s_mov_b64 exec, -1

    v_add_u32 v92, v94, v94
    v_add_u32 v93, v95, v95
    v_med3_u32 v92, v94, 2, v92
    v_med3_u32 v93, v95, 2, v93
    buffer_atomic_add_x2 v[92:93], v2, s[20:23], 0 offen sc0
    s_waitcnt lgkmcnt(0)
    v_readlane_b32 s77, v96, 63
    v_mul_u32_u24 v114, 7936, v0
    v_sub_u32 v97, v97, v95
    s_sub_u32 s50, s50, s83
    s_sub_u32 s77, s77, s50
    v_add_u32 v97, s77, v97
    v_sub_u32 v96, v97, v94
    v_lshlrev_b32 v111, 16, v97
    v_lshlrev_b32 v110, 16, v96
    ds_write_b64 v2, v[110:111]
    v_sub_u32 v96, v114, v96
    v_sub_u32 v97, v114, v97
    v_add_u32 v97, s48, v97
    s_add_u32 s50, s50, s84
    s_mov_b32 s28, s82
    s_mov_b32 s29, s83
    s_mov_b32 s30, s84
    s_lshl_b32 s74, s29, 3
    s_lshl_b32 s75, s30, 3
    v_mov_b32 v125, s74
    v_mov_b32 v126, s75
    v_mov_b32 v127, -1

    s_waitcnt lgkmcnt(0)
    s_barrier

    s_mov_b64 exec, 1
    ds_write_b32 v125, v127 offset:16396
    ds_write_b32 v126, v127 offset:16404
    s_mov_b64 exec, -1

    buffer_load_dwordx4 v[24:27], v1, s[12:15], s57 offen nt
    buffer_load_dwordx4 v[8:11], v1, s[8:11], s57 offen nt
    buffer_load_dwordx2 v[38:39], v2, s[16:19], s62 offen nt
    s_bitcmp0_b32 s28, 0
    s_cbranch_scc1 L_skz_37
    v_lshrrev_b32 v110, 16, v45
    ds_read_b32 v110, v110
    v_lshrrev_b32 v111, 16, v47
    ds_read_b32 v111, v111
    v_lshrrev_b32 v112, 16, v49
    ds_read_b32 v112, v112
    v_lshrrev_b32 v113, 16, v51
    ds_read_b32 v113, v113
    v_lshrrev_b32 v114, 16, v53
    ds_read_b32 v114, v114
    v_lshrrev_b32 v115, 16, v55
    ds_read_b32 v115, v115
    v_lshrrev_b32 v116, 16, v57
    ds_read_b32 v116, v116
    v_lshrrev_b32 v117, 16, v59
    ds_read_b32 v117, v117
    s_waitcnt lgkmcnt(7)
    v_add_u32_sdwa v110, v110, v76 dst_sel:DWORD dst_unused:UNUSED_PAD src0_sel:WORD_1 src1_sel:WORD_0
    v_lshlrev_b32 v110, 3, v110
    ds_write_b64 v110, v[44:45] offset:16400

    s_waitcnt lgkmcnt(7)
    v_add_u32_sdwa v111, v111, v77 dst_sel:DWORD dst_unused:UNUSED_PAD src0_sel:WORD_1 src1_sel:WORD_0
    v_lshlrev_b32 v111, 3, v111
    ds_write_b64 v111, v[46:47] offset:16400

    s_waitcnt lgkmcnt(7)
    v_add_u32_sdwa v112, v112, v78 dst_sel:DWORD dst_unused:UNUSED_PAD src0_sel:WORD_1 src1_sel:WORD_0
    v_lshlrev_b32 v112, 3, v112
    ds_write_b64 v112, v[48:49] offset:16400

    s_waitcnt lgkmcnt(7)
    v_add_u32_sdwa v113, v113, v79 dst_sel:DWORD dst_unused:UNUSED_PAD src0_sel:WORD_1 src1_sel:WORD_0
    v_lshlrev_b32 v113, 3, v113
    ds_write_b64 v113, v[50:51] offset:16400

    s_waitcnt lgkmcnt(7)
    v_add_u32_sdwa v114, v114, v80 dst_sel:DWORD dst_unused:UNUSED_PAD src0_sel:WORD_1 src1_sel:WORD_0
    v_lshlrev_b32 v114, 3, v114
    ds_write_b64 v114, v[52:53] offset:16400

    s_waitcnt lgkmcnt(7)
    v_add_u32_sdwa v115, v115, v81 dst_sel:DWORD dst_unused:UNUSED_PAD src0_sel:WORD_1 src1_sel:WORD_0
    v_lshlrev_b32 v115, 3, v115
    ds_write_b64 v115, v[54:55] offset:16400

    s_waitcnt lgkmcnt(7)
    v_add_u32_sdwa v116, v116, v82 dst_sel:DWORD dst_unused:UNUSED_PAD src0_sel:WORD_1 src1_sel:WORD_0
    v_lshlrev_b32 v116, 3, v116
    ds_write_b64 v116, v[56:57] offset:16400

    s_waitcnt lgkmcnt(7)
    v_add_u32_sdwa v117, v117, v83 dst_sel:DWORD dst_unused:UNUSED_PAD src0_sel:WORD_1 src1_sel:WORD_0
    v_lshlrev_b32 v117, 3, v117
    ds_write_b64 v117, v[58:59] offset:16400

L_skz_37:
    buffer_load_dwordx4 v[28:31], v1, s[12:15], s58 offen nt
    buffer_load_dwordx4 v[12:15], v1, s[8:11], s58 offen nt
    buffer_load_dwordx2 v[40:41], v2, s[16:19], s63 offen nt
    s_bitcmp0_b32 s28, 2
    s_cbranch_scc1 L_skz_38
    v_lshrrev_b32 v110, 16, v61
    ds_read_b32 v110, v110
    v_lshrrev_b32 v111, 16, v63
    ds_read_b32 v111, v111
    v_lshrrev_b32 v112, 16, v65
    ds_read_b32 v112, v112
    v_lshrrev_b32 v113, 16, v67
    ds_read_b32 v113, v113
    s_waitcnt lgkmcnt(3)
    v_add_u32_sdwa v110, v110, v84 dst_sel:DWORD dst_unused:UNUSED_PAD src0_sel:WORD_1 src1_sel:WORD_0
    v_lshlrev_b32 v110, 3, v110
    ds_write_b64 v110, v[60:61] offset:16400

    s_waitcnt lgkmcnt(3)
    v_add_u32_sdwa v111, v111, v85 dst_sel:DWORD dst_unused:UNUSED_PAD src0_sel:WORD_1 src1_sel:WORD_0
    v_lshlrev_b32 v111, 3, v111
    ds_write_b64 v111, v[62:63] offset:16400

    s_waitcnt lgkmcnt(3)
    v_add_u32_sdwa v112, v112, v86 dst_sel:DWORD dst_unused:UNUSED_PAD src0_sel:WORD_1 src1_sel:WORD_0
    v_lshlrev_b32 v112, 3, v112
    ds_write_b64 v112, v[64:65] offset:16400

    s_waitcnt lgkmcnt(3)
    v_add_u32_sdwa v113, v113, v87 dst_sel:DWORD dst_unused:UNUSED_PAD src0_sel:WORD_1 src1_sel:WORD_0
    v_lshlrev_b32 v113, 3, v113
    ds_write_b64 v113, v[66:67] offset:16400

L_skz_38:
    s_bitcmp0_b32 s28, 3
    s_cbranch_scc1 L_skz_39
    s_mov_b64 exec, s[66:67]
    v_lshrrev_b32 v110, 16, v69
    ds_read_b32 v110, v110
    v_lshrrev_b32 v111, 16, v71
    ds_read_b32 v111, v111
    v_lshrrev_b32 v112, 16, v73
    ds_read_b32 v112, v112
    v_lshrrev_b32 v113, 16, v75
    ds_read_b32 v113, v113
    s_waitcnt lgkmcnt(3)
    v_add_u32_sdwa v110, v110, v88 dst_sel:DWORD dst_unused:UNUSED_PAD src0_sel:WORD_1 src1_sel:WORD_0
    v_lshlrev_b32 v110, 3, v110
    ds_write_b64 v110, v[68:69] offset:16400

    s_waitcnt lgkmcnt(3)
    v_add_u32_sdwa v111, v111, v89 dst_sel:DWORD dst_unused:UNUSED_PAD src0_sel:WORD_1 src1_sel:WORD_0
    v_lshlrev_b32 v111, 3, v111
    ds_write_b64 v111, v[70:71] offset:16400

    s_waitcnt lgkmcnt(3)
    v_add_u32_sdwa v112, v112, v90 dst_sel:DWORD dst_unused:UNUSED_PAD src0_sel:WORD_1 src1_sel:WORD_0
    v_lshlrev_b32 v112, 3, v112
    ds_write_b64 v112, v[72:73] offset:16400

    s_waitcnt lgkmcnt(3)
    v_add_u32_sdwa v113, v113, v91 dst_sel:DWORD dst_unused:UNUSED_PAD src0_sel:WORD_1 src1_sel:WORD_0
    v_lshlrev_b32 v113, 3, v113
    ds_write_b64 v113, v[74:75] offset:16400

    s_mov_b64 exec, -1
L_skz_39:
    buffer_load_dwordx4 v[32:35], v1, s[12:15], s59 offen nt
    buffer_load_dwordx4 v[16:19], v1, s[8:11], s59 offen nt
    buffer_load_dwordx2 v[42:43], v2, s[16:19], s64 offen nt
    s_cmp_lg_u32 s49, 0
    s_cbranch_scc1 L_p1loop_5
L_p1epi_6:
    s_waitcnt vmcnt(0)
    s_waitcnt vmcnt(9)
    v_add_u32 v110, v92, v94
    v_min_u32 v92, s48, v92
    v_add_u32 v111, v93, v95
    v_min_u32 v93, s48, v93
    v_max_u32 v110, v110, v111
    v_add_u32 v92, v92, v96
    v_add_u32 v93, v93, v97
    v_cmp_le_u32 vcc, s48, v110
    v_lshl_add_u32 v92, v92, 2, v92
    v_lshl_add_u32 v93, v93, 2, v93
    ds_write_b64 v2, v[92:93] offset:8192
    s_cbranch_vccz L_noov_40
    ds_write_b32 v108, v104 offset:4
L_noov_40:

    s_waitcnt lgkmcnt(0)
    s_barrier
    ds_read_b32 v110, v108 offset:4
    s_waitcnt lgkmcnt(0)
    v_readfirstlane_b32 s53, v110
    s_nop 1

    s_cmp_lg_u32 s53, 0
    s_cbranch_scc1 L_slow_41
L_sback_42:
    s_bitcmp0_b32 s28, 0
    s_cbranch_scc1 L_skw_46
    ds_read_b64 v[4:5], v2 offset:16400
    ds_read_b64 v[6:7], v2 offset:16408
    ds_read_b64 v[8:9], v2 offset:16392

    ds_read_b64 v[12:13], v2 offset:24592
    ds_read_b64 v[14:15], v2 offset:24600
    ds_read_b64 v[16:17], v2 offset:24584

    ds_read_b64 v[20:21], v2 offset:32784
    ds_read_b64 v[22:23], v2 offset:32792
    ds_read_b64 v[24:25], v2 offset:32776

    ds_read_b64 v[28:29], v2 offset:40976
    ds_read_b64 v[30:31], v2 offset:40984
    ds_read_b64 v[32:33], v2 offset:40968

    s_waitcnt lgkmcnt(9)
    v_lshrrev_b32 v10, 16, v5
    ds_read_b32 v10, v10 offset:8192

    s_waitcnt lgkmcnt(7)
    v_lshrrev_b32 v18, 16, v13
    ds_read_b32 v18, v18 offset:8192

    s_waitcnt lgkmcnt(5)
    v_lshrrev_b32 v26, 16, v21
    ds_read_b32 v26, v26 offset:8192

    s_waitcnt lgkmcnt(3)
    v_lshrrev_b32 v34, 16, v29
    ds_read_b32 v34, v34 offset:8192

    v_cmp_ne_u32_sdwa s[80:81], v5, v7 src0_sel:WORD_1 src1_sel:WORD_1
    v_cmp_ne_u32_sdwa vcc, v5, v9 src0_sel:WORD_1 src1_sel:WORD_1
    v_alignbyte_b32 v8, v9, v8, 2
    s_mov_b32 s54, -3
    v_alignbyte_b32 v5, v5, v4, 1
    v_perm_b32 v4, v4, v8, s47
    s_waitcnt lgkmcnt(3)
    v_add3_u32 v10, v10, v106, s54
    v_sub_u32 v11, 0, v10
    v_and_b32 v11, 3, v11
    s_mov_b64 exec, s[80:81]
    v_mov_b32 v11, 0
    v_mov_b32 v6, 0
    s_mov_b64 exec, vcc
    v_mov_b32 v11, 3

    s_mov_b64 exec, -1
    v_alignbyte_b32 v4, v5, v4, v11
    v_alignbyte_b32 v5, v6, v5, v11
    v_add_u32 v10, v10, v11

    buffer_store_dwordx2 v[4:5], v10, s[24:27], 0 offen
    v_cmp_ne_u32_sdwa s[80:81], v13, v15 src0_sel:WORD_1 src1_sel:WORD_1
    v_cmp_ne_u32_sdwa vcc, v13, v17 src0_sel:WORD_1 src1_sel:WORD_1
    v_alignbyte_b32 v16, v17, v16, 2
    s_mov_b32 s54, 5117
    v_alignbyte_b32 v13, v13, v12, 1
    v_perm_b32 v12, v12, v16, s47
    s_waitcnt lgkmcnt(2)
    v_add3_u32 v18, v18, v106, s54
    v_sub_u32 v19, 0, v18
    v_and_b32 v19, 3, v19
    s_mov_b64 exec, s[80:81]
    v_mov_b32 v19, 0
    v_mov_b32 v14, 0
    s_mov_b64 exec, vcc
    v_mov_b32 v19, 3

    s_mov_b64 exec, -1
    v_alignbyte_b32 v12, v13, v12, v19
    v_alignbyte_b32 v13, v14, v13, v19
    v_add_u32 v18, v18, v19

    buffer_store_dwordx2 v[12:13], v18, s[24:27], 0 offen
    v_cmp_ne_u32_sdwa s[80:81], v21, v23 src0_sel:WORD_1 src1_sel:WORD_1
    v_cmp_ne_u32_sdwa vcc, v21, v25 src0_sel:WORD_1 src1_sel:WORD_1
    v_alignbyte_b32 v24, v25, v24, 2
    s_mov_b32 s54, 10237
    v_alignbyte_b32 v21, v21, v20, 1
    v_perm_b32 v20, v20, v24, s47
    s_waitcnt lgkmcnt(1)
    v_add3_u32 v26, v26, v106, s54
    v_sub_u32 v27, 0, v26
    v_and_b32 v27, 3, v27
    s_mov_b64 exec, s[80:81]
    v_mov_b32 v27, 0
    v_mov_b32 v22, 0
    s_mov_b64 exec, vcc
    v_mov_b32 v27, 3

    s_mov_b64 exec, -1
    v_alignbyte_b32 v20, v21, v20, v27
    v_alignbyte_b32 v21, v22, v21, v27
    v_add_u32 v26, v26, v27

    buffer_store_dwordx2 v[20:21], v26, s[24:27], 0 offen
    v_cmp_ne_u32_sdwa s[80:81], v29, v31 src0_sel:WORD_1 src1_sel:WORD_1
    v_cmp_ne_u32_sdwa vcc, v29, v33 src0_sel:WORD_1 src1_sel:WORD_1
    v_alignbyte_b32 v32, v33, v32, 2
    s_mov_b32 s54, 15357
    v_alignbyte_b32 v29, v29, v28, 1
    v_perm_b32 v28, v28, v32, s47
    s_waitcnt lgkmcnt(0)
    v_add3_u32 v34, v34, v106, s54
    v_sub_u32 v35, 0, v34
    v_and_b32 v35, 3, v35
    s_mov_b64 exec, s[80:81]
    v_mov_b32 v35, 0
    v_mov_b32 v30, 0
    s_mov_b64 exec, vcc
    v_mov_b32 v35, 3

    s_mov_b64 exec, -1
    v_alignbyte_b32 v28, v29, v28, v35
    v_alignbyte_b32 v29, v30, v29, v35
    v_add_u32 v34, v34, v35

    buffer_store_dwordx2 v[28:29], v34, s[24:27], 0 offen
L_skw_46:
    s_bitcmp0_b32 s28, 1
    s_cbranch_scc1 L_skw_47
    v_add_u32 v107, 32768, v2
    ds_read_b64 v[4:5], v107 offset:16400
    ds_read_b64 v[6:7], v107 offset:16408
    ds_read_b64 v[8:9], v107 offset:16392

    ds_read_b64 v[12:13], v107 offset:24592
    ds_read_b64 v[14:15], v107 offset:24600
    ds_read_b64 v[16:17], v107 offset:24584

    ds_read_b64 v[20:21], v107 offset:32784
    ds_read_b64 v[22:23], v107 offset:32792
    ds_read_b64 v[24:25], v107 offset:32776

    ds_read_b64 v[28:29], v107 offset:40976
    ds_read_b64 v[30:31], v107 offset:40984
    ds_read_b64 v[32:33], v107 offset:40968

    s_waitcnt lgkmcnt(9)
    v_lshrrev_b32 v10, 16, v5
    ds_read_b32 v10, v10 offset:8192

    s_waitcnt lgkmcnt(7)
    v_lshrrev_b32 v18, 16, v13
    ds_read_b32 v18, v18 offset:8192

    s_waitcnt lgkmcnt(5)
    v_lshrrev_b32 v26, 16, v21
    ds_read_b32 v26, v26 offset:8192

    s_waitcnt lgkmcnt(3)
    v_lshrrev_b32 v34, 16, v29
    ds_read_b32 v34, v34 offset:8192

    v_cmp_ne_u32_sdwa s[80:81], v5, v7 src0_sel:WORD_1 src1_sel:WORD_1
    v_cmp_ne_u32_sdwa vcc, v5, v9 src0_sel:WORD_1 src1_sel:WORD_1
    v_alignbyte_b32 v8, v9, v8, 2
    s_mov_b32 s54, 20477
    v_alignbyte_b32 v5, v5, v4, 1
    v_perm_b32 v4, v4, v8, s47
    s_waitcnt lgkmcnt(3)
    v_add3_u32 v10, v10, v106, s54
    v_sub_u32 v11, 0, v10
    v_and_b32 v11, 3, v11
    s_mov_b64 exec, s[80:81]
    v_mov_b32 v11, 0
    v_mov_b32 v6, 0
    s_mov_b64 exec, vcc
    v_mov_b32 v11, 3

    s_mov_b64 exec, -1
    v_alignbyte_b32 v4, v5, v4, v11
    v_alignbyte_b32 v5, v6, v5, v11
    v_add_u32 v10, v10, v11

    buffer_store_dwordx2 v[4:5], v10, s[24:27], 0 offen
    v_cmp_ne_u32_sdwa s[80:81], v13, v15 src0_sel:WORD_1 src1_sel:WORD_1
    v_cmp_ne_u32_sdwa vcc, v13, v17 src0_sel:WORD_1 src1_sel:WORD_1
    v_alignbyte_b32 v16, v17, v16, 2
    s_mov_b32 s54, 25597
    v_alignbyte_b32 v13, v13, v12, 1
    v_perm_b32 v12, v12, v16, s47
    s_waitcnt lgkmcnt(2)
    v_add3_u32 v18, v18, v106, s54
    v_sub_u32 v19, 0, v18
    v_and_b32 v19, 3, v19
    s_mov_b64 exec, s[80:81]
    v_mov_b32 v19, 0
    v_mov_b32 v14, 0
    s_mov_b64 exec, vcc
    v_mov_b32 v19, 3

    s_mov_b64 exec, -1
    v_alignbyte_b32 v12, v13, v12, v19
    v_alignbyte_b32 v13, v14, v13, v19
    v_add_u32 v18, v18, v19

    buffer_store_dwordx2 v[12:13], v18, s[24:27], 0 offen
    v_cmp_ne_u32_sdwa s[80:81], v21, v23 src0_sel:WORD_1 src1_sel:WORD_1
    v_cmp_ne_u32_sdwa vcc, v21, v25 src0_sel:WORD_1 src1_sel:WORD_1
    v_alignbyte_b32 v24, v25, v24, 2
    s_mov_b32 s54, 30717
    v_alignbyte_b32 v21, v21, v20, 1
    v_perm_b32 v20, v20, v24, s47
    s_waitcnt lgkmcnt(1)
    v_add3_u32 v26, v26, v106, s54
    v_sub_u32 v27, 0, v26
    v_and_b32 v27, 3, v27
    s_mov_b64 exec, s[80:81]
    v_mov_b32 v27, 0
    v_mov_b32 v22, 0
    s_mov_b64 exec, vcc
    v_mov_b32 v27, 3

    s_mov_b64 exec, -1
    v_alignbyte_b32 v20, v21, v20, v27
    v_alignbyte_b32 v21, v22, v21, v27
    v_add_u32 v26, v26, v27

    buffer_store_dwordx2 v[20:21], v26, s[24:27], 0 offen
    v_cmp_ne_u32_sdwa s[80:81], v29, v31 src0_sel:WORD_1 src1_sel:WORD_1
    v_cmp_ne_u32_sdwa vcc, v29, v33 src0_sel:WORD_1 src1_sel:WORD_1
    v_alignbyte_b32 v32, v33, v32, 2
    s_mov_b32 s54, 35837
    v_alignbyte_b32 v29, v29, v28, 1
    v_perm_b32 v28, v28, v32, s47
    s_waitcnt lgkmcnt(0)
    v_add3_u32 v34, v34, v106, s54
    v_sub_u32 v35, 0, v34
    v_and_b32 v35, 3, v35
    s_mov_b64 exec, s[80:81]
    v_mov_b32 v35, 0
    v_mov_b32 v30, 0
    s_mov_b64 exec, vcc
    v_mov_b32 v35, 3

    s_mov_b64 exec, -1
    v_alignbyte_b32 v28, v29, v28, v35
    v_alignbyte_b32 v29, v30, v29, v35
    v_add_u32 v34, v34, v35

    buffer_store_dwordx2 v[28:29], v34, s[24:27], 0 offen
L_skw_47:
    s_bitcmp0_b32 s28, 2
    s_cbranch_scc1 L_skw_48
    v_add_u32 v107, 65536, v2
    ds_read_b64 v[4:5], v107 offset:16400
    ds_read_b64 v[6:7], v107 offset:16408
    ds_read_b64 v[8:9], v107 offset:16392

    ds_read_b64 v[12:13], v107 offset:24592
    ds_read_b64 v[14:15], v107 offset:24600
    ds_read_b64 v[16:17], v107 offset:24584

    ds_read_b64 v[20:21], v107 offset:32784
    ds_read_b64 v[22:23], v107 offset:32792
    ds_read_b64 v[24:25], v107 offset:32776

    ds_read_b64 v[28:29], v107 offset:40976
    ds_read_b64 v[30:31], v107 offset:40984
    ds_read_b64 v[32:33], v107 offset:40968

    s_waitcnt lgkmcnt(9)
    v_lshrrev_b32 v10, 16, v5
    ds_read_b32 v10, v10 offset:8192

    s_waitcnt lgkmcnt(7)
    v_lshrrev_b32 v18, 16, v13
    ds_read_b32 v18, v18 offset:8192

    s_waitcnt lgkmcnt(5)
    v_lshrrev_b32 v26, 16, v21
    ds_read_b32 v26, v26 offset:8192

    s_waitcnt lgkmcnt(3)
    v_lshrrev_b32 v34, 16, v29
    ds_read_b32 v34, v34 offset:8192

    v_cmp_ne_u32_sdwa s[80:81], v5, v7 src0_sel:WORD_1 src1_sel:WORD_1
    v_cmp_ne_u32_sdwa vcc, v5, v9 src0_sel:WORD_1 src1_sel:WORD_1
    v_alignbyte_b32 v8, v9, v8, 2
    s_mov_b32 s54, 40957
    v_alignbyte_b32 v5, v5, v4, 1
    v_perm_b32 v4, v4, v8, s47
    s_waitcnt lgkmcnt(3)
    v_add3_u32 v10, v10, v106, s54
    v_sub_u32 v11, 0, v10
    v_and_b32 v11, 3, v11
    s_mov_b64 exec, s[80:81]
    v_mov_b32 v11, 0
    v_mov_b32 v6, 0
    s_mov_b64 exec, vcc
    v_mov_b32 v11, 3

    s_mov_b64 exec, -1
    v_alignbyte_b32 v4, v5, v4, v11
    v_alignbyte_b32 v5, v6, v5, v11
    v_add_u32 v10, v10, v11

    buffer_store_dwordx2 v[4:5], v10, s[24:27], 0 offen
    v_cmp_ne_u32_sdwa s[80:81], v13, v15 src0_sel:WORD_1 src1_sel:WORD_1
    v_cmp_ne_u32_sdwa vcc, v13, v17 src0_sel:WORD_1 src1_sel:WORD_1
    v_alignbyte_b32 v16, v17, v16, 2
    s_mov_b32 s54, 46077
    v_alignbyte_b32 v13, v13, v12, 1
    v_perm_b32 v12, v12, v16, s47
    s_waitcnt lgkmcnt(2)
    v_add3_u32 v18, v18, v106, s54
    v_sub_u32 v19, 0, v18
    v_and_b32 v19, 3, v19
    s_mov_b64 exec, s[80:81]
    v_mov_b32 v19, 0
    v_mov_b32 v14, 0
    s_mov_b64 exec, vcc
    v_mov_b32 v19, 3

    s_mov_b64 exec, -1
    v_alignbyte_b32 v12, v13, v12, v19
    v_alignbyte_b32 v13, v14, v13, v19
    v_add_u32 v18, v18, v19

    buffer_store_dwordx2 v[12:13], v18, s[24:27], 0 offen
    v_cmp_ne_u32_sdwa s[80:81], v21, v23 src0_sel:WORD_1 src1_sel:WORD_1
    v_cmp_ne_u32_sdwa vcc, v21, v25 src0_sel:WORD_1 src1_sel:WORD_1
    v_alignbyte_b32 v24, v25, v24, 2
    s_mov_b32 s54, 51197
    v_alignbyte_b32 v21, v21, v20, 1
    v_perm_b32 v20, v20, v24, s47
    s_waitcnt lgkmcnt(1)
    v_add3_u32 v26, v26, v106, s54
    v_sub_u32 v27, 0, v26
    v_and_b32 v27, 3, v27
    s_mov_b64 exec, s[80:81]
    v_mov_b32 v27, 0
    v_mov_b32 v22, 0
    s_mov_b64 exec, vcc
    v_mov_b32 v27, 3

    s_mov_b64 exec, -1
    v_alignbyte_b32 v20, v21, v20, v27
    v_alignbyte_b32 v21, v22, v21, v27
    v_add_u32 v26, v26, v27

    buffer_store_dwordx2 v[20:21], v26, s[24:27], 0 offen
    v_cmp_ne_u32_sdwa s[80:81], v29, v31 src0_sel:WORD_1 src1_sel:WORD_1
    v_cmp_ne_u32_sdwa vcc, v29, v33 src0_sel:WORD_1 src1_sel:WORD_1
    v_alignbyte_b32 v32, v33, v32, 2
    s_mov_b32 s54, 56317
    v_alignbyte_b32 v29, v29, v28, 1
    v_perm_b32 v28, v28, v32, s47
    s_waitcnt lgkmcnt(0)
    v_add3_u32 v34, v34, v106, s54
    v_sub_u32 v35, 0, v34
    v_and_b32 v35, 3, v35
    s_mov_b64 exec, s[80:81]
    v_mov_b32 v35, 0
    v_mov_b32 v30, 0
    s_mov_b64 exec, vcc
    v_mov_b32 v35, 3

    s_mov_b64 exec, -1
    v_alignbyte_b32 v28, v29, v28, v35
    v_alignbyte_b32 v29, v30, v29, v35
    v_add_u32 v34, v34, v35

    buffer_store_dwordx2 v[28:29], v34, s[24:27], 0 offen
L_skw_48:
    s_bitcmp0_b32 s28, 3
    s_cbranch_scc1 L_skw_49
    v_add_u32 v107, 98304, v2
    ds_read_b64 v[4:5], v107 offset:16400
    ds_read_b64 v[6:7], v107 offset:16408
    ds_read_b64 v[8:9], v107 offset:16392

    ds_read_b64 v[12:13], v107 offset:24592
    ds_read_b64 v[14:15], v107 offset:24600
    ds_read_b64 v[16:17], v107 offset:24584

    ds_read_b64 v[20:21], v107 offset:32784
    ds_read_b64 v[22:23], v107 offset:32792
    ds_read_b64 v[24:25], v107 offset:32776

    ds_read_b64 v[28:29], v107 offset:40976
    ds_read_b64 v[30:31], v107 offset:40984
    ds_read_b64 v[32:33], v107 offset:40968

    s_waitcnt lgkmcnt(9)
    v_lshrrev_b32 v10, 16, v5
    ds_read_b32 v10, v10 offset:8192

    s_waitcnt lgkmcnt(7)
    v_lshrrev_b32 v18, 16, v13
    ds_read_b32 v18, v18 offset:8192

    s_waitcnt lgkmcnt(5)
    v_lshrrev_b32 v26, 16, v21
    ds_read_b32 v26, v26 offset:8192

    s_waitcnt lgkmcnt(3)
    v_lshrrev_b32 v34, 16, v29
    ds_read_b32 v34, v34 offset:8192

    v_cmp_ne_u32_sdwa s[80:81], v5, v7 src0_sel:WORD_1 src1_sel:WORD_1
    v_cmp_ne_u32_sdwa vcc, v5, v9 src0_sel:WORD_1 src1_sel:WORD_1
    v_alignbyte_b32 v8, v9, v8, 2
    s_mov_b32 s54, 61437
    v_alignbyte_b32 v5, v5, v4, 1
    v_perm_b32 v4, v4, v8, s47
    s_waitcnt lgkmcnt(3)
    v_add3_u32 v10, v10, v106, s54
    v_sub_u32 v11, 0, v10
    v_and_b32 v11, 3, v11
    s_mov_b64 exec, s[80:81]
    v_mov_b32 v11, 0
    v_mov_b32 v6, 0
    s_mov_b64 exec, vcc
    v_mov_b32 v11, 3

    s_mov_b64 exec, -1
    v_alignbyte_b32 v4, v5, v4, v11
    v_alignbyte_b32 v5, v6, v5, v11
    v_add_u32 v10, v10, v11

    buffer_store_dwordx2 v[4:5], v10, s[24:27], 0 offen
    v_cmp_ne_u32_sdwa s[80:81], v13, v15 src0_sel:WORD_1 src1_sel:WORD_1
    v_cmp_ne_u32_sdwa vcc, v13, v17 src0_sel:WORD_1 src1_sel:WORD_1
    v_alignbyte_b32 v16, v17, v16, 2
    s_mov_b32 s54, 66557
    v_alignbyte_b32 v13, v13, v12, 1
    v_perm_b32 v12, v12, v16, s47
    s_waitcnt lgkmcnt(2)
    v_add3_u32 v18, v18, v106, s54
    v_sub_u32 v19, 0, v18
    v_and_b32 v19, 3, v19
    s_mov_b64 exec, s[80:81]
    v_mov_b32 v19, 0
    v_mov_b32 v14, 0
    s_mov_b64 exec, vcc
    v_mov_b32 v19, 3

    s_mov_b64 exec, -1
    v_alignbyte_b32 v12, v13, v12, v19
    v_alignbyte_b32 v13, v14, v13, v19
    v_add_u32 v18, v18, v19

    buffer_store_dwordx2 v[12:13], v18, s[24:27], 0 offen
    v_cmp_ne_u32_sdwa s[80:81], v21, v23 src0_sel:WORD_1 src1_sel:WORD_1
    v_cmp_ne_u32_sdwa vcc, v21, v25 src0_sel:WORD_1 src1_sel:WORD_1
    v_alignbyte_b32 v24, v25, v24, 2
    s_mov_b32 s54, 71677
    v_alignbyte_b32 v21, v21, v20, 1
    v_perm_b32 v20, v20, v24, s47
    s_waitcnt lgkmcnt(1)
    v_add3_u32 v26, v26, v106, s54
    v_sub_u32 v27, 0, v26
    v_and_b32 v27, 3, v27
    s_mov_b64 exec, s[80:81]
    v_mov_b32 v27, 0
    v_mov_b32 v22, 0
    s_mov_b64 exec, vcc
    v_mov_b32 v27, 3

    s_mov_b64 exec, -1
    v_alignbyte_b32 v20, v21, v20, v27
    v_alignbyte_b32 v21, v22, v21, v27
    v_add_u32 v26, v26, v27

    buffer_store_dwordx2 v[20:21], v26, s[24:27], 0 offen
    v_cmp_ne_u32_sdwa s[80:81], v29, v31 src0_sel:WORD_1 src1_sel:WORD_1
    v_cmp_ne_u32_sdwa vcc, v29, v33 src0_sel:WORD_1 src1_sel:WORD_1
    v_alignbyte_b32 v32, v33, v32, 2
    s_mov_b32 s54, 76797
    v_alignbyte_b32 v29, v29, v28, 1
    v_perm_b32 v28, v28, v32, s47
    s_waitcnt lgkmcnt(0)
    v_add3_u32 v34, v34, v106, s54
    v_sub_u32 v35, 0, v34
    v_and_b32 v35, 3, v35
    s_mov_b64 exec, s[80:81]
    v_mov_b32 v35, 0
    v_mov_b32 v30, 0
    s_mov_b64 exec, vcc
    v_mov_b32 v35, 3

    s_andn2_b64 exec, -1, s[68:69]
    v_bfrev_b32 v34, 1
    s_mov_b64 exec, -1
    v_alignbyte_b32 v28, v29, v28, v35
    v_alignbyte_b32 v29, v30, v29, v35
    v_add_u32 v34, v34, v35

    buffer_store_dwordx2 v[28:29], v34, s[24:27], 0 offen
L_skw_49:
L_p1done_1:
    s_endpgm

L_slow_22:
    v_add_u32 v112, s29, v0
    v_mov_b32 v118, 0
    s_mov_b32 s75, 4960
L_sl_24:
    v_lshlrev_b32 v113, 3, v112
    ds_read_b64 v[110:111], v113 offset:16400
    ds_read_b32 v119, v113 offset:16412
    ds_read_b32 v120, v113 offset:16396
    s_waitcnt lgkmcnt(0)
    v_lshrrev_b32 v114, 16, v111
    ds_read_b32 v115, v114 offset:8192
    v_add_u32 v114, 4, v114
    v_mul_u32_u24 v114, s75, v114
    s_waitcnt lgkmcnt(0)
    v_mad_u32_u24 v115, v112, 5, v115
    v_cmp_gt_u32 s[72:73], s30, v112
    v_cmp_ge_u32 vcc, v115, v114
    s_and_b64 s[80:81], vcc, s[72:73]
    s_cbranch_scc0 L_s1_25
    s_bcnt1_i32_b64 s76, s[80:81]
    v_mbcnt_lo_u32_b32 v117, s80, 0
    v_mbcnt_hi_u32_b32 v117, s81, v117
    v_mov_b32 v116, s76
    s_mov_b64 exec, 1
    buffer_atomic_add v116, v118, s[36:39], 0 offen sc0
    s_waitcnt vmcnt(0)
    v_readfirstlane_b32 s76, v116
    s_mov_b64 exec, s[80:81]
    s_nop 0
    v_add_lshl_u32 v116, v117, s76, 3
    buffer_store_dwordx2 v[110:111], v116, s[32:35], 0 offen
L_s1_25:
    s_andn2_b64 exec, s[72:73], vcc
    s_cbranch_execz L_s2_26
    buffer_store_dword v110, v115, s[24:27], 0 offen
    buffer_store_byte v111, v115, s[24:27], 0 offen offset:4
    v_add_u32 v115, 5, v115
    v_cmpx_lt_u32 vcc, v115, v114
    v_cmpx_ne_u32_sdwa vcc, v111, v119 src0_sel:WORD_1 src1_sel:WORD_1
    v_cmpx_ne_u32_sdwa vcc, v111, v120 src0_sel:WORD_1 src1_sel:WORD_1
    s_cbranch_execz L_s2_26
    buffer_store_dword v118, v115, s[24:27], 0 offen
L_s2_26:
    s_mov_b64 exec, -1
    v_add_u32 v112, 1024, v112
    s_nop 0
    v_readfirstlane_b32 s76, v112
    s_nop 1
    s_cmp_lt_u32 s76, s30
    s_cbranch_scc1 L_sl_24
    s_mov_b32 s28, 0
    s_branch L_sback_23

L_slow_41:
    v_add_u32 v112, s29, v0
    v_mov_b32 v118, 0
    s_mov_b32 s75, 4960
L_sl_43:
    v_lshlrev_b32 v113, 3, v112
    ds_read_b64 v[110:111], v113 offset:16400
    ds_read_b32 v119, v113 offset:16412
    ds_read_b32 v120, v113 offset:16396
    s_waitcnt lgkmcnt(0)
    v_lshrrev_b32 v114, 16, v111
    ds_read_b32 v115, v114 offset:8192
    v_add_u32 v114, 4, v114
    v_mul_u32_u24 v114, s75, v114
    s_waitcnt lgkmcnt(0)
    v_mad_u32_u24 v115, v112, 5, v115
    v_cmp_gt_u32 s[72:73], s30, v112
    v_cmp_ge_u32 vcc, v115, v114
    s_and_b64 s[80:81], vcc, s[72:73]
    s_cbranch_scc0 L_s1_44
    s_bcnt1_i32_b64 s76, s[80:81]
    v_mbcnt_lo_u32_b32 v117, s80, 0
    v_mbcnt_hi_u32_b32 v117, s81, v117
    v_mov_b32 v116, s76
    s_mov_b64 exec, 1
    buffer_atomic_add v116, v118, s[36:39], 0 offen sc0
    s_waitcnt vmcnt(0)
    v_readfirstlane_b32 s76, v116
    s_mov_b64 exec, s[80:81]
    s_nop 0
    v_add_lshl_u32 v116, v117, s76, 3
    buffer_store_dwordx2 v[110:111], v116, s[32:35], 0 offen
L_s1_44:
    s_andn2_b64 exec, s[72:73], vcc
    s_cbranch_execz L_s2_45
    buffer_store_dword v110, v115, s[24:27], 0 offen
    buffer_store_byte v111, v115, s[24:27], 0 offen offset:4
    v_add_u32 v115, 5, v115
    v_cmpx_lt_u32 vcc, v115, v114
    v_cmpx_ne_u32_sdwa vcc, v111, v119 src0_sel:WORD_1 src1_sel:WORD_1
    v_cmpx_ne_u32_sdwa vcc, v111, v120 src0_sel:WORD_1 src1_sel:WORD_1
    s_cbranch_execz L_s2_45
    buffer_store_dword v118, v115, s[24:27], 0 offen
L_s2_45:
    s_mov_b64 exec, -1
    v_add_u32 v112, 1024, v112
    s_nop 0
    v_readfirstlane_b32 s76, v112
    s_nop 1
    s_cmp_lt_u32 s76, s30
    s_cbranch_scc1 L_sl_43
    s_mov_b32 s28, 0
    s_branch L_sback_42

.globl standalone__molecular_angular_gemnet__graph_kernel
.p2align 8
.type standalone__molecular_angular_gemnet__graph_kernel,@function
standalone__molecular_angular_gemnet__graph_kernel:
    s_cmp_ge_u32 s2, 256
    s_cbranch_scc1 L_p2done_50
    s_load_dwordx2 s[8:9], s[0:1], 0
    s_load_dwordx2 s[6:7], s[0:1], 104
    v_lshrrev_b32 v4, 6, v0
    s_lshr_b32 s37, s2, 1
    s_and_b32 s37, s37, 3
    s_lshr_b32 s36, s2, 3
    s_lshl_b32 s36, s36, 1
    s_and_b32 s3, s2, 1
    s_or_b32 s36, s36, s3
    v_readfirstlane_b32 s4, v4
    v_and_b32 v2, 63, v0
    v_lshrrev_b32 v3, 9, v0
    v_lshl_or_b32 v2, v3, 6, v2
    v_mul_u32_u24 v2, 20, v2
    v_lshlrev_b32 v3, 4, v0
    s_waitcnt lgkmcnt(0)
    s_lshl_b32 m0, s4, 10
    s_and_b32 s5, s4, 7
    s_lshr_b32 s39, s4, 3
    s_lshl_b32 s39, s39, 8
    s_mul_i32 s3, s5, 8192
    s_add_u32 s46, s6, s3
    s_addc_u32 s47, s7, 0
    s_mul_i32 s3, s5, 40632320
    s_add_u32 s3, s3, 83599360
    s_add_u32 s44, s6, s3
    s_addc_u32 s45, s7, 0
    s_mul_i32 s38, s37, 8
    s_add_u32 s4, s38, 8
    s_lshl_b32 s3, s38, 6
    s_add_u32 s3, s3, s36
    s_lshl_b32 s3, s3, 2
    s_add_u32 s52, s46, s3
    s_addc_u32 s53, s47, 0

    s_load_dword s88, s[52:53], 0
    s_load_dword s89, s[52:53], 256
    s_load_dword s90, s[52:53], 512
    s_load_dword s91, s[52:53], 768
    s_load_dword s92, s[52:53], 1024
    s_load_dword s93, s[52:53], 1280
    s_load_dword s94, s[52:53], 1536
    s_load_dword s95, s[52:53], 1792
    s_mov_b32 s3, 65536
    s_load_dword s51, s[6:7], s3
    s_mov_b32 s10, 6400000
    s_mov_b32 s11, 0x20000

    s_add_u32 s12, s6, 393216
    s_addc_u32 s13, s7, 0
    s_mov_b32 s14, 0
    s_mov_b32 s15, 0x20000
    s_add_u32 s60, s6, 393216
    s_addc_u32 s61, s7, 0
    s_mov_b32 s62, 6406144
    s_mov_b32 s63, 0x20000
    s_mov_b32 s3, 135176
    s_load_dword s33, s[6:7], s3

    s_mul_i32 s43, s38, 200192
    s_mul_i32 s41, s4, 200192
    s_mul_i32 s50, s38, 200000
    s_add_u32 s14, s43, 50000

    buffer_load_dwordx4 v[76:79], v3, s[12:15], s43 offen
    s_add_u32 s52, s43, 16384
    buffer_load_dwordx4 v[80:83], v3, s[12:15], s52 offen
    s_add_u32 s52, s43, 32768
    buffer_load_dwordx4 v[84:87], v3, s[12:15], s52 offen
    s_add_u32 s52, s43, 49152
    v_lshlrev_b32 v119, 2, v0
    buffer_load_dword v88, v119, s[12:15], s52 offen
    s_add_u32 s20, s6, 135168
    s_addc_u32 s21, s7, 0
    s_mov_b32 s22, 4096
    s_mov_b32 s23, 0x20000
    v_and_b32 v44, 63, v0
    v_lshlrev_b32 v44, 4, v44
    buffer_load_dwordx2 v[120:121], v44, s[20:23], 0 offen offset:0
    buffer_load_dwordx2 v[122:123], v44, s[20:23], 0 offen offset:1024
    buffer_load_dwordx2 v[124:125], v44, s[20:23], 0 offen offset:2048
    buffer_load_dwordx2 v[126:127], v44, s[20:23], 0 offen offset:3072
    s_movk_i32 s40, 3072
    s_mov_b32 s19, 0x20000
    s_min_u32 s40, s40, 3968
    s_lshl_b32 s52, s38, 6
    s_add_u32 s52, s52, s36
    s_mul_i32 s52, s52, 19840
    s_add_u32 s16, s44, s52
    s_addc_u32 s17, s45, 0
    s_mul_i32 s52, s40, 5
    s_add_u32 s52, s52, 3
    s_and_b32 s18, s52, -4

    s_movk_i32 s53, 5120
    buffer_load_dwordx4 v[90:93], v2, s[16:19], s53 offen
    buffer_load_dword v110, v2, s[16:19], s53 offen offset:16
    s_movk_i32 s53, 7680
    buffer_load_dwordx4 v[94:97], v2, s[16:19], s53 offen
    buffer_load_dword v111, v2, s[16:19], s53 offen offset:16
    s_lshr_b32 s3, s2, 3
    s_mul_i32 s3, s3, 49
    v_add_lshl_u32 v89, v0, s3, 7
    v_cmp_gt_u32 vcc, 49, v0
    v_bfrev_b32 v28, 1
    s_nop 0
    v_cndmask_b32 v89, v28, v89, vcc

    s_mov_b32 s19, 0x20000
    s_mov_b32 s28, 0x4b404000
    s_mov_b32 s29, 0x4b404000
    s_mov_b32 s30, 0xbfffc000
    s_mov_b32 s31, 0xbfffbfff
    s_mov_b32 s32, 0xffff0000
    s_mov_b32 s35, 0x05040100
    s_mov_b32 s97, 0x07060302
    s_mov_b32 s96, 0x40008000
    s_movk_i32 s3, 212
    v_cmp_gt_u32 s[48:49], s3, v0

    v_mov_b32 v1, 0
    s_mov_b32 s24, 0xc0c0004
    s_mov_b32 s25, 0xc0c0105
    s_mov_b32 s26, 0xc0c0206
    s_mov_b32 s27, 0xc0c0307
    v_mov_b32 v28, 0x40004000
    v_mov_b32 v29, 0x40004000
    v_mov_b32 v30, 0x40004000
    v_mov_b32 v31, 0x40004000
    v_add_u32 v32, 50000, v3
    v_add_u32 v33, 65536, v32

    ds_write_b128 v32, v[28:31] offset:0
    ds_write_b128 v32, v[28:31] offset:16384
    ds_write_b128 v32, v[28:31] offset:32768
    ds_write_b128 v32, v[28:31] offset:49152
    ds_write_b128 v33, v[28:31] offset:0
    ds_write_b128 v33, v[28:31] offset:16384
    v_cmp_gt_u32 vcc, 971, v0
    s_mov_b64 exec, vcc
    ds_write_b128 v33, v[28:31] offset:32768
    s_mov_b64 exec, -1
    s_waitcnt lgkmcnt(0)
    s_min_u32 s88, s88, 3968
    s_lshl_b32 s52, s38, 6
    s_add_u32 s52, s52, s36
    s_mul_i32 s52, s52, 19840
    s_add_u32 s16, s44, s52
    s_addc_u32 s17, s45, 0
    s_mul_i32 s52, s88, 5
    s_add_u32 s52, s52, 3
    s_and_b32 s18, s52, -4

    s_movk_i32 s53, 10240
    buffer_load_dwordx4 v[98:101], v2, s[16:19], s53 offen
    buffer_load_dword v112, v2, s[16:19], s53 offen offset:16
    s_movk_i32 s53, 12800
    buffer_load_dwordx4 v[102:105], v2, s[16:19], s53 offen
    buffer_load_dword v113, v2, s[16:19], s53 offen offset:16
    s_movk_i32 s53, 0
    buffer_load_dwordx4 v[4:7], v2, s[16:19], s53 offen
    buffer_load_dword v35, v2, s[16:19], s53 offen offset:16
    s_movk_i32 s53, 2560
    buffer_load_dwordx4 v[8:11], v2, s[16:19], s53 offen
    buffer_load_dword v43, v2, s[16:19], s53 offen offset:16
    s_movk_i32 s53, 15360
    buffer_load_dwordx4 v[106:109], v2, s[16:19], s53 offen
    buffer_load_dword v114, v2, s[16:19], s53 offen offset:16
    s_waitcnt vmcnt(21)
    ds_write_addtid_b32 v76 offset:0
    ds_write_addtid_b32 v77 offset:256
    ds_write_addtid_b32 v78 offset:512
    ds_write_addtid_b32 v79 offset:768
    s_waitcnt vmcnt(20)
    ds_write_addtid_b32 v80 offset:16384
    ds_write_addtid_b32 v81 offset:16640
    ds_write_addtid_b32 v82 offset:16896
    ds_write_addtid_b32 v83 offset:17152
    s_waitcnt vmcnt(19)
    ds_write_addtid_b32 v84 offset:32768
    ds_write_addtid_b32 v85 offset:33024
    ds_write_addtid_b32 v86 offset:33280
    ds_write_addtid_b32 v87 offset:33536
    v_lshlrev_b32 v119, 2, v0
    s_waitcnt vmcnt(18)
    s_mov_b64 exec, s[48:49]
    ds_write_b32 v119, v88 offset:49152
    s_mov_b64 exec, -1
    s_add_u32 s43, s43, 50048
    s_add_u32 s14, s43, 50000
    s_min_u32 s14, s14, s41
    buffer_load_dwordx4 v[76:79], v3, s[12:15], s43 offen
    s_add_u32 s52, s43, 16384
    buffer_load_dwordx4 v[80:83], v3, s[12:15], s52 offen
    s_add_u32 s52, s43, 32768
    buffer_load_dwordx4 v[84:87], v3, s[12:15], s52 offen
    s_add_u32 s52, s43, 49152
    v_lshlrev_b32 v119, 2, v0
    buffer_load_dword v88, v119, s[12:15], s52 offen
    s_add_u32 s54, s43, 50048
    buffer_load_dword v115, v89, s[60:63], s54 offen
    s_add_u32 s54, s50, 0
    buffer_load_dword v115, v89, s[8:11], s54 offen
    s_waitcnt vmcnt(20)
    v_max3_u32 v120, v120, v122, v124
    v_add_f32 v121, v121, v123
    v_add_f32 v125, v125, v127
    v_max_u32 v120, v120, v126
    v_add_f32 v121, v121, v125

    s_nop 1
    v_max_u32_dpp v120, v120, v120 row_shr:1 row_mask:0xf bank_mask:0xf
    s_nop 1
    v_max_u32_dpp v120, v120, v120 row_shr:2 row_mask:0xf bank_mask:0xf
    s_nop 1
    v_max_u32_dpp v120, v120, v120 row_shr:4 row_mask:0xf bank_mask:0xf
    s_nop 1
    v_max_u32_dpp v120, v120, v120 row_shr:8 row_mask:0xf bank_mask:0xf
    s_nop 1
    v_max_u32_dpp v120, v120, v120 row_bcast:15 row_mask:0xa bank_mask:0xf
    s_nop 1
    v_max_u32_dpp v120, v120, v120 row_bcast:31 row_mask:0xc bank_mask:0xf
    s_nop 1
    v_add_f32_dpp v121, v121, v121 row_shr:1 row_mask:0xf bank_mask:0xf
    s_nop 1
    v_add_f32_dpp v121, v121, v121 row_shr:2 row_mask:0xf bank_mask:0xf
    s_nop 1
    v_add_f32_dpp v121, v121, v121 row_shr:4 row_mask:0xf bank_mask:0xf
    s_nop 1
    v_add_f32_dpp v121, v121, v121 row_shr:8 row_mask:0xf bank_mask:0xf
    s_nop 1
    v_add_f32_dpp v121, v121, v121 row_bcast:15 row_mask:0xa bank_mask:0xf
    s_nop 1
    v_add_f32_dpp v121, v121, v121 row_bcast:31 row_mask:0xc bank_mask:0xf
    v_lshlrev_b32 v120, 16, v120
    v_mul_f32 v121, 0x34a7c5ac, v121
    v_sqrt_f32 v121, v121
    v_mul_f32 v120, s33, v120
    v_mul_f32 v121, s33, v121
    v_cmp_gt_f32 vcc, 0x46fde800, v120
    s_mov_b64 s[64:65], vcc
    v_cmp_lt_f32 vcc, 0x44000000, v121
    v_mov_b32 v120, 0x37800000
    v_mul_f32 v120, s33, v120
    s_and_b64 vcc, vcc, s[64:65]
    v_mul_f32 v121, 0x46ff8000, v120
    v_rcp_f32 v121, v121
    v_readfirstlane_b32 s33, v120
    s_waitcnt lgkmcnt(0)
    s_barrier
    v_readfirstlane_b32 s34, v121
    v_mov_b32 v120, 150016
    v_mov_b32 v121, 0
    ds_write_b32 v120, v121 offset:8
    s_bitcmp0_b64 vcc, 63
    s_cbranch_scc1 L_p2slow_51
    s_cmp_lg_u32 s51, 0
    s_cbranch_scc1 L_p2slow_51

    s_mov_b32 s40, s88
    s_sub_u32 s42, s40, s39

    s_add_u32 s55, s38, 1
    s_min_u32 s55, s55, 31
    s_mov_b32 s88, s89
    s_mov_b32 s89, s90
    s_mov_b32 s90, s91
    s_mov_b32 s91, s92
    s_mov_b32 s92, s93
    s_mov_b32 s93, s94
    s_mov_b32 s94, s95
    s_mov_b32 s95, 0
    s_min_u32 s88, s88, 3968
    s_lshl_b32 s52, s55, 6
    s_add_u32 s52, s52, s36
    s_mul_i32 s52, s52, 19840
    s_add_u32 s16, s44, s52
    s_addc_u32 s17, s45, 0
    s_mul_i32 s52, s88, 5
    s_add_u32 s52, s52, 3
    s_and_b32 s18, s52, -4

    s_waitcnt vmcnt(18)
    v_perm_b32 v44, v91, v90, s24
    v_perm_b32 v46, v92, v91, s25
    v_perm_b32 v48, v93, v92, s26
    v_perm_b32 v50, v110, v93, s27
    v_mov_b32 v12, v90
    v_alignbyte_b32 v13, v92, v91, 1
    v_alignbyte_b32 v14, v93, v92, 2
    v_alignbyte_b32 v15, v110, v93, 3
    v_lshlrev_b32_sdwa v44, 3, v44 dst_sel:WORD_0 dst_unused:UNUSED_PAD src0_sel:DWORD src1_sel:DWORD
    v_lshlrev_b32_sdwa v46, 3, v46 dst_sel:WORD_0 dst_unused:UNUSED_PAD src0_sel:DWORD src1_sel:DWORD
    v_lshlrev_b32_sdwa v48, 3, v48 dst_sel:WORD_0 dst_unused:UNUSED_PAD src0_sel:DWORD src1_sel:DWORD
    v_lshlrev_b32_sdwa v50, 3, v50 dst_sel:WORD_0 dst_unused:UNUSED_PAD src0_sel:DWORD src1_sel:DWORD
    s_cmp_lt_i32 s42, 1280
    s_cbranch_scc1 L_ufix_52
L_uback_53:

    v_subrev_co_u32 v12, s[80:81], 2.0, v12
    v_subrev_co_u32 v13, s[82:83], 2.0, v13
    v_subrev_co_u32 v14, s[84:85], 2.0, v14
    v_subrev_co_u32 v15, s[86:87], 2.0, v15
    s_mov_b64 exec, s[80:81]
    ds_read_b64 v[44:45], v44
    s_mov_b64 exec, s[82:83]
    ds_read_b64 v[46:47], v46
    s_mov_b64 exec, s[84:85]
    ds_read_b64 v[48:49], v48
    s_mov_b64 exec, s[86:87]
    ds_read_b64 v[50:51], v50
    s_mov_b64 exec, -1
    s_movk_i32 s53, 5120
    buffer_load_dwordx4 v[90:93], v2, s[16:19], s53 offen
    buffer_load_dword v110, v2, s[16:19], s53 offen offset:16
    s_waitcnt vmcnt(18)
    v_perm_b32 v52, v95, v94, s24
    v_perm_b32 v54, v96, v95, s25
    v_perm_b32 v56, v97, v96, s26
    v_perm_b32 v58, v111, v97, s27
    v_mov_b32 v16, v94
    v_alignbyte_b32 v17, v96, v95, 1
    v_alignbyte_b32 v18, v97, v96, 2
    v_alignbyte_b32 v19, v111, v97, 3
    v_lshlrev_b32_sdwa v52, 3, v52 dst_sel:WORD_0 dst_unused:UNUSED_PAD src0_sel:DWORD src1_sel:DWORD
    v_lshlrev_b32_sdwa v54, 3, v54 dst_sel:WORD_0 dst_unused:UNUSED_PAD src0_sel:DWORD src1_sel:DWORD
    v_lshlrev_b32_sdwa v56, 3, v56 dst_sel:WORD_0 dst_unused:UNUSED_PAD src0_sel:DWORD src1_sel:DWORD
    v_lshlrev_b32_sdwa v58, 3, v58 dst_sel:WORD_0 dst_unused:UNUSED_PAD src0_sel:DWORD src1_sel:DWORD
    s_cmp_lt_i32 s42, 1792
    s_cbranch_scc1 L_ufix_54
L_uback_55:

    v_subrev_co_u32 v16, s[64:65], 2.0, v16
    v_subrev_co_u32 v17, s[66:67], 2.0, v17
    v_subrev_co_u32 v18, s[68:69], 2.0, v18
    v_subrev_co_u32 v19, s[70:71], 2.0, v19
    s_mov_b64 exec, s[64:65]
    ds_read_b64 v[52:53], v52
    s_mov_b64 exec, s[66:67]
    ds_read_b64 v[54:55], v54
    s_mov_b64 exec, s[68:69]
    ds_read_b64 v[56:57], v56
    s_mov_b64 exec, s[70:71]
    ds_read_b64 v[58:59], v58
    s_mov_b64 exec, -1
    s_movk_i32 s53, 7680
    buffer_load_dwordx4 v[94:97], v2, s[16:19], s53 offen
    buffer_load_dword v111, v2, s[16:19], s53 offen offset:16
    s_waitcnt vmcnt(18)
    v_perm_b32 v60, v99, v98, s24
    v_perm_b32 v62, v100, v99, s25
    v_perm_b32 v64, v101, v100, s26
    v_perm_b32 v66, v112, v101, s27
    v_mov_b32 v20, v98
    v_alignbyte_b32 v21, v100, v99, 1
    v_alignbyte_b32 v22, v101, v100, 2
    v_alignbyte_b32 v23, v112, v101, 3
    v_lshlrev_b32_sdwa v60, 3, v60 dst_sel:WORD_0 dst_unused:UNUSED_PAD src0_sel:DWORD src1_sel:DWORD
    v_lshlrev_b32_sdwa v62, 3, v62 dst_sel:WORD_0 dst_unused:UNUSED_PAD src0_sel:DWORD src1_sel:DWORD
    v_lshlrev_b32_sdwa v64, 3, v64 dst_sel:WORD_0 dst_unused:UNUSED_PAD src0_sel:DWORD src1_sel:DWORD
    v_lshlrev_b32_sdwa v66, 3, v66 dst_sel:WORD_0 dst_unused:UNUSED_PAD src0_sel:DWORD src1_sel:DWORD
    s_cmp_lt_i32 s42, 2304
    s_cbranch_scc1 L_ufix_56
L_uback_57:

    v_subrev_co_u32 v20, s[72:73], 2.0, v20
    v_subrev_co_u32 v21, s[74:75], 2.0, v21
    v_subrev_co_u32 v22, s[76:77], 2.0, v22
    v_subrev_co_u32 v23, s[78:79], 2.0, v23
    s_mov_b64 exec, s[72:73]
    ds_read_b64 v[60:61], v60
    s_mov_b64 exec, s[74:75]
    ds_read_b64 v[62:63], v62
    s_mov_b64 exec, s[76:77]
    ds_read_b64 v[64:65], v64
    s_mov_b64 exec, s[78:79]
    ds_read_b64 v[66:67], v66
    s_mov_b64 exec, -1
    s_movk_i32 s53, 10240
    buffer_load_dwordx4 v[98:101], v2, s[16:19], s53 offen
    buffer_load_dword v112, v2, s[16:19], s53 offen offset:16
    s_waitcnt vmcnt(18)
    v_perm_b32 v68, v103, v102, s24
    v_perm_b32 v70, v104, v103, s25
    v_perm_b32 v72, v105, v104, s26
    v_perm_b32 v74, v113, v105, s27
    v_mov_b32 v24, v102
    v_alignbyte_b32 v25, v104, v103, 1
    v_alignbyte_b32 v26, v105, v104, 2
    v_alignbyte_b32 v27, v113, v105, 3
    v_lshlrev_b32_sdwa v68, 3, v68 dst_sel:WORD_0 dst_unused:UNUSED_PAD src0_sel:DWORD src1_sel:DWORD
    v_lshlrev_b32_sdwa v70, 3, v70 dst_sel:WORD_0 dst_unused:UNUSED_PAD src0_sel:DWORD src1_sel:DWORD
    v_lshlrev_b32_sdwa v72, 3, v72 dst_sel:WORD_0 dst_unused:UNUSED_PAD src0_sel:DWORD src1_sel:DWORD
    v_lshlrev_b32_sdwa v74, 3, v74 dst_sel:WORD_0 dst_unused:UNUSED_PAD src0_sel:DWORD src1_sel:DWORD
    s_cmp_lt_i32 s42, 2816
    s_cbranch_scc1 L_ufix_58
L_uback_59:

    v_subrev_co_u32 v24, s[80:81], 2.0, v24
    v_subrev_co_u32 v25, s[82:83], 2.0, v25
    v_subrev_co_u32 v26, s[84:85], 2.0, v26
    v_subrev_co_u32 v27, s[86:87], 2.0, v27
    s_mov_b64 exec, s[80:81]
    ds_read_b64 v[68:69], v68
    s_mov_b64 exec, s[82:83]
    ds_read_b64 v[70:71], v70
    s_mov_b64 exec, s[84:85]
    ds_read_b64 v[72:73], v72
    s_mov_b64 exec, s[86:87]
    ds_read_b64 v[74:75], v74
    s_mov_b64 exec, -1
    s_waitcnt vmcnt(16)
    v_perm_b32 v28, v5, v4, s24
    v_perm_b32 v30, v6, v5, s25
    v_perm_b32 v32, v7, v6, s26
    v_perm_b32 v34, v35, v7, s27
    v_alignbyte_b32 v5, v6, v5, 1
    v_alignbyte_b32 v6, v7, v6, 2
    v_alignbyte_b32 v7, v35, v7, 3
    v_lshlrev_b32_sdwa v28, 3, v28 dst_sel:WORD_0 dst_unused:UNUSED_PAD src0_sel:DWORD src1_sel:DWORD
    v_lshlrev_b32_sdwa v30, 3, v30 dst_sel:WORD_0 dst_unused:UNUSED_PAD src0_sel:DWORD src1_sel:DWORD
    v_lshlrev_b32_sdwa v32, 3, v32 dst_sel:WORD_0 dst_unused:UNUSED_PAD src0_sel:DWORD src1_sel:DWORD
    v_lshlrev_b32_sdwa v34, 3, v34 dst_sel:WORD_0 dst_unused:UNUSED_PAD src0_sel:DWORD src1_sel:DWORD
    s_cmp_lt_i32 s42, 256
    s_cbranch_scc1 L_ufix_60
L_uback_61:

    v_subrev_co_u32 v4, s[64:65], 2.0, v4
    v_subrev_co_u32 v5, s[66:67], 2.0, v5
    v_subrev_co_u32 v6, s[68:69], 2.0, v6
    v_subrev_co_u32 v7, s[70:71], 2.0, v7
    s_mov_b64 exec, s[64:65]
    ds_read_b64 v[28:29], v28
    s_mov_b64 exec, s[66:67]
    ds_read_b64 v[30:31], v30
    s_mov_b64 exec, s[68:69]
    ds_read_b64 v[32:33], v32
    s_mov_b64 exec, s[70:71]
    ds_read_b64 v[34:35], v34
    s_mov_b64 exec, -1
    s_waitcnt vmcnt(14)
    v_perm_b32 v36, v9, v8, s24
    v_perm_b32 v38, v10, v9, s25
    v_perm_b32 v40, v11, v10, s26
    v_perm_b32 v42, v43, v11, s27
    v_alignbyte_b32 v9, v10, v9, 1
    v_alignbyte_b32 v10, v11, v10, 2
    v_alignbyte_b32 v11, v43, v11, 3
    v_lshlrev_b32_sdwa v36, 3, v36 dst_sel:WORD_0 dst_unused:UNUSED_PAD src0_sel:DWORD src1_sel:DWORD
    v_lshlrev_b32_sdwa v38, 3, v38 dst_sel:WORD_0 dst_unused:UNUSED_PAD src0_sel:DWORD src1_sel:DWORD
    v_lshlrev_b32_sdwa v40, 3, v40 dst_sel:WORD_0 dst_unused:UNUSED_PAD src0_sel:DWORD src1_sel:DWORD
    v_lshlrev_b32_sdwa v42, 3, v42 dst_sel:WORD_0 dst_unused:UNUSED_PAD src0_sel:DWORD src1_sel:DWORD
    s_cmp_lt_i32 s42, 768
    s_cbranch_scc1 L_ufix_62
L_uback_63:

    v_subrev_co_u32 v8, s[72:73], 2.0, v8
    v_subrev_co_u32 v9, s[74:75], 2.0, v9
    v_subrev_co_u32 v10, s[76:77], 2.0, v10
    v_subrev_co_u32 v11, s[78:79], 2.0, v11
    s_mov_b64 exec, s[72:73]
    ds_read_b64 v[36:37], v36
    s_mov_b64 exec, s[74:75]
    ds_read_b64 v[38:39], v38
    s_mov_b64 exec, s[76:77]
    ds_read_b64 v[40:41], v40
    s_mov_b64 exec, s[78:79]
    ds_read_b64 v[42:43], v42
    s_mov_b64 exec, -1
L_batch_64:
    s_add_u32 s5, s38, 1

    s_waitcnt lgkmcnt(0)
    s_barrier
    s_waitcnt vmcnt(11)
    ds_write_addtid_b32 v76 offset:0
    ds_write_addtid_b32 v77 offset:256
    ds_write_addtid_b32 v78 offset:512
    ds_write_addtid_b32 v79 offset:768
    s_waitcnt vmcnt(10)
    ds_write_addtid_b32 v80 offset:16384
    ds_write_addtid_b32 v81 offset:16640
    ds_write_addtid_b32 v82 offset:16896
    ds_write_addtid_b32 v83 offset:17152
    s_waitcnt vmcnt(9)
    ds_write_addtid_b32 v84 offset:32768
    ds_write_addtid_b32 v85 offset:33024
    ds_write_addtid_b32 v86 offset:33280
    ds_write_addtid_b32 v87 offset:33536
    v_lshlrev_b32 v119, 2, v0
    s_waitcnt vmcnt(8)
    s_mov_b64 exec, s[48:49]
    ds_write_b32 v119, v88 offset:49152
    s_mov_b64 exec, -1
    s_add_u32 s43, s43, 50048
    s_add_u32 s14, s43, 50000
    s_min_u32 s14, s14, s41
    buffer_load_dwordx4 v[76:79], v3, s[12:15], s43 offen
    s_add_u32 s52, s43, 16384
    buffer_load_dwordx4 v[80:83], v3, s[12:15], s52 offen
    v_subrev_co_u32 v4, s[64:65], 2.0, v4
    v_subrev_co_u32 v5, s[66:67], 2.0, v5
    v_subrev_co_u32 v6, s[68:69], 2.0, v6
    v_subrev_co_u32 v7, s[70:71], 2.0, v7
    v_subrev_co_u32 v8, s[72:73], 2.0, v8
    v_subrev_co_u32 v9, s[74:75], 2.0, v9
    v_subrev_co_u32 v10, s[76:77], 2.0, v10
    v_subrev_co_u32 v11, s[78:79], 2.0, v11
    v_subrev_co_u32 v12, s[80:81], 2.0, v12
    v_subrev_co_u32 v13, s[82:83], 2.0, v13
    v_subrev_co_u32 v14, s[84:85], 2.0, v14
    v_subrev_co_u32 v15, s[86:87], 2.0, v15
    s_waitcnt lgkmcnt(0)
    s_barrier
    s_cmp_le_i32 s42, 3072
    s_cbranch_scc1 L_nt1_66
    s_waitcnt vmcnt(14)
    v_perm_b32 v120, v107, v106, s24
    v_perm_b32 v122, v108, v107, s25
    v_perm_b32 v124, v109, v108, s26
    v_perm_b32 v126, v114, v109, s27
    v_alignbyte_b32 v107, v108, v107, 1
    v_alignbyte_b32 v108, v109, v108, 2
    v_alignbyte_b32 v109, v114, v109, 3
    v_lshlrev_b32_sdwa v120, 3, v120 dst_sel:WORD_0 dst_unused:UNUSED_PAD src0_sel:DWORD src1_sel:DWORD
    v_lshlrev_b32_sdwa v122, 3, v122 dst_sel:WORD_0 dst_unused:UNUSED_PAD src0_sel:DWORD src1_sel:DWORD
    v_lshlrev_b32_sdwa v124, 3, v124 dst_sel:WORD_0 dst_unused:UNUSED_PAD src0_sel:DWORD src1_sel:DWORD
    v_lshlrev_b32_sdwa v126, 3, v126 dst_sel:WORD_0 dst_unused:UNUSED_PAD src0_sel:DWORD src1_sel:DWORD
    s_cmp_lt_i32 s42, 3328
    s_cbranch_scc1 L_ufix_69
L_uback_70:

    v_lshrrev_b32 v117, 30, v106
    v_and_b32 v106, 0x3fffffff, v106
    v_mul_u32_u24 v117, 50000, v117
    v_cmp_ne_u32 vcc, 0, v106
    v_add_u32 v120, v120, v117
    s_mov_b64 exec, vcc

    buffer_load_dwordx2 v[120:121], v120, s[8:11], s50 offen
    s_mov_b64 exec, -1
    v_lshrrev_b32 v117, 30, v107
    v_and_b32 v107, 0x3fffffff, v107
    v_mul_u32_u24 v117, 50000, v117
    v_cmp_ne_u32 vcc, 0, v107
    v_add_u32 v122, v122, v117
    s_mov_b64 exec, vcc

    buffer_load_dwordx2 v[122:123], v122, s[8:11], s50 offen
    s_mov_b64 exec, -1
    v_lshrrev_b32 v117, 30, v108
    v_and_b32 v108, 0x3fffffff, v108
    v_mul_u32_u24 v117, 50000, v117
    v_cmp_ne_u32 vcc, 0, v108
    v_add_u32 v124, v124, v117
    s_mov_b64 exec, vcc

    buffer_load_dwordx2 v[124:125], v124, s[8:11], s50 offen
    s_mov_b64 exec, -1
    v_lshrrev_b32 v117, 30, v109
    v_and_b32 v109, 0x3fffffff, v109
    v_mul_u32_u24 v117, 50000, v117
    v_cmp_ne_u32 vcc, 0, v109
    v_add_u32 v126, v126, v117
    s_mov_b64 exec, vcc

    buffer_load_dwordx2 v[126:127], v126, s[8:11], s50 offen
    s_mov_b64 exec, -1
L_nt1_66:
    s_add_u32 s52, s43, 32768
    buffer_load_dwordx4 v[84:87], v3, s[12:15], s52 offen
    s_add_u32 s52, s43, 49152
    v_lshlrev_b32 v119, 2, v0
    buffer_load_dword v88, v119, s[12:15], s52 offen
    s_mov_b64 exec, s[64:65]
    ds_read_b64 v[28:29], v28
    s_mov_b64 exec, s[66:67]
    ds_read_b64 v[30:31], v30
    s_mov_b64 exec, s[68:69]
    ds_read_b64 v[32:33], v32
    s_mov_b64 exec, s[70:71]
    ds_read_b64 v[34:35], v34
    s_mov_b64 exec, s[72:73]
    ds_read_b64 v[36:37], v36
    s_mov_b64 exec, s[74:75]
    ds_read_b64 v[38:39], v38
    s_mov_b64 exec, s[76:77]
    ds_read_b64 v[40:41], v40
    s_mov_b64 exec, s[78:79]
    ds_read_b64 v[42:43], v42
    s_mov_b64 exec, s[80:81]
    ds_read_b64 v[44:45], v44
    s_mov_b64 exec, s[82:83]
    ds_read_b64 v[46:47], v46
    s_mov_b64 exec, s[84:85]
    ds_read_b64 v[48:49], v48
    s_mov_b64 exec, s[86:87]
    ds_read_b64 v[50:51], v50
    s_mov_b64 exec, -1
    v_subrev_co_u32 v16, s[64:65], 2.0, v16
    v_subrev_co_u32 v17, s[66:67], 2.0, v17
    v_subrev_co_u32 v18, s[68:69], 2.0, v18
    v_subrev_co_u32 v19, s[70:71], 2.0, v19
    v_subrev_co_u32 v20, s[72:73], 2.0, v20
    v_subrev_co_u32 v21, s[74:75], 2.0, v21
    v_subrev_co_u32 v22, s[76:77], 2.0, v22
    v_subrev_co_u32 v23, s[78:79], 2.0, v23
    v_subrev_co_u32 v24, s[80:81], 2.0, v24
    v_subrev_co_u32 v25, s[82:83], 2.0, v25
    v_subrev_co_u32 v26, s[84:85], 2.0, v26
    v_subrev_co_u32 v27, s[86:87], 2.0, v27
    s_mov_b64 exec, s[64:65]
    ds_read_b64 v[52:53], v52
    s_mov_b64 exec, s[66:67]
    ds_read_b64 v[54:55], v54
    s_mov_b64 exec, s[68:69]
    ds_read_b64 v[56:57], v56
    s_mov_b64 exec, s[70:71]
    ds_read_b64 v[58:59], v58
    s_mov_b64 exec, s[72:73]
    ds_read_b64 v[60:61], v60
    s_mov_b64 exec, s[74:75]
    ds_read_b64 v[62:63], v62
    s_mov_b64 exec, s[76:77]
    ds_read_b64 v[64:65], v64
    s_mov_b64 exec, s[78:79]
    ds_read_b64 v[66:67], v66
    s_mov_b64 exec, s[80:81]
    ds_read_b64 v[68:69], v68
    s_mov_b64 exec, s[82:83]
    ds_read_b64 v[70:71], v70
    s_mov_b64 exec, s[84:85]
    ds_read_b64 v[72:73], v72
    s_mov_b64 exec, s[86:87]
    ds_read_b64 v[74:75], v74
    s_mov_b64 exec, -1
    s_waitcnt lgkmcnt(0)
    s_barrier
    s_waitcnt vmcnt(3)
    ds_write_addtid_b32 v76 offset:0
    ds_write_addtid_b32 v77 offset:256
    ds_write_addtid_b32 v78 offset:512
    ds_write_addtid_b32 v79 offset:768
    s_waitcnt vmcnt(2)
    ds_write_addtid_b32 v80 offset:16384
    ds_write_addtid_b32 v81 offset:16640
    ds_write_addtid_b32 v82 offset:16896
    ds_write_addtid_b32 v83 offset:17152
    s_waitcnt vmcnt(1)
    ds_write_addtid_b32 v84 offset:32768
    ds_write_addtid_b32 v85 offset:33024
    ds_write_addtid_b32 v86 offset:33280
    ds_write_addtid_b32 v87 offset:33536
    v_lshlrev_b32 v119, 2, v0
    s_waitcnt vmcnt(0)
    s_mov_b64 exec, s[48:49]
    ds_write_b32 v119, v88 offset:49152
    s_mov_b64 exec, -1
    s_add_u32 s43, s43, 50048
    s_add_u32 s14, s43, 50000
    s_min_u32 s14, s14, s41
    buffer_load_dwordx4 v[76:79], v3, s[12:15], s43 offen
    s_add_u32 s52, s43, 16384
    buffer_load_dwordx4 v[80:83], v3, s[12:15], s52 offen
    v_subrev_co_u32 v4, s[64:65], 2.0, v4
    v_subrev_co_u32 v5, s[66:67], 2.0, v5
    v_subrev_co_u32 v6, s[68:69], 2.0, v6
    v_subrev_co_u32 v7, s[70:71], 2.0, v7
    v_subrev_co_u32 v8, s[72:73], 2.0, v8
    v_subrev_co_u32 v9, s[74:75], 2.0, v9
    v_subrev_co_u32 v10, s[76:77], 2.0, v10
    v_subrev_co_u32 v11, s[78:79], 2.0, v11
    v_subrev_co_u32 v12, s[80:81], 2.0, v12
    v_subrev_co_u32 v13, s[82:83], 2.0, v13
    v_subrev_co_u32 v14, s[84:85], 2.0, v14
    v_subrev_co_u32 v15, s[86:87], 2.0, v15
    s_waitcnt lgkmcnt(0)
    s_barrier
    s_add_u32 s52, s43, 32768
    buffer_load_dwordx4 v[84:87], v3, s[12:15], s52 offen
    s_add_u32 s52, s43, 49152
    v_lshlrev_b32 v119, 2, v0
    buffer_load_dword v88, v119, s[12:15], s52 offen
    s_cmp_le_i32 s42, 3072
    s_cbranch_scc1 L_nt2_67
    s_waitcnt vmcnt(6)
    v_cmp_ne_u32 s[56:57], 0, v106
    v_cmp_ne_u32 s[58:59], 0, v107
    v_cmp_ne_u32 s[98:99], 0, v108
    v_cmp_ne_u32 vcc, 0, v109
    s_mov_b64 exec, s[56:57]
    v_cvt_f32_i32_sdwa v118, sext(v106) dst_sel:DWORD dst_unused:UNUSED_PAD src0_sel:WORD_0
    v_lshlrev_b32 v116, 16, v120
    v_and_b32 v117, s32, v120
    v_mul_f32 v118, s33, v118
    v_lshlrev_b32 v120, 16, v121
    v_and_b32 v121, s32, v121
    v_lshlrev_b32_sdwa v106, 3, v106 dst_sel:DWORD dst_unused:UNUSED_PAD src0_sel:DWORD src1_sel:WORD_1
    v_pk_fma_f32 v[116:117], v[116:117], v[118:119], s[28:29] op_sel_hi:[1,0,1]
    v_pk_fma_f32 v[120:121], v[120:121], v[118:119], s[28:29] op_sel_hi:[1,0,1]
    v_perm_b32 v116, v117, v116, s35
    v_perm_b32 v117, v121, v120, s35
    v_lshl_add_u64 v[116:117], v[116:117], 0, s[30:31]
    ds_add_rtn_u64 v[120:121], v106, v[116:117] offset:50000

    s_mov_b64 exec, s[58:59]
    v_cvt_f32_i32_sdwa v118, sext(v107) dst_sel:DWORD dst_unused:UNUSED_PAD src0_sel:WORD_0
    v_lshlrev_b32 v116, 16, v122
    v_and_b32 v117, s32, v122
    v_mul_f32 v118, s33, v118
    v_lshlrev_b32 v122, 16, v123
    v_and_b32 v123, s32, v123
    v_lshlrev_b32_sdwa v107, 3, v107 dst_sel:DWORD dst_unused:UNUSED_PAD src0_sel:DWORD src1_sel:WORD_1
    v_pk_fma_f32 v[116:117], v[116:117], v[118:119], s[28:29] op_sel_hi:[1,0,1]
    v_pk_fma_f32 v[122:123], v[122:123], v[118:119], s[28:29] op_sel_hi:[1,0,1]
    v_perm_b32 v116, v117, v116, s35
    v_perm_b32 v117, v123, v122, s35
    v_lshl_add_u64 v[116:117], v[116:117], 0, s[30:31]
    ds_add_rtn_u64 v[122:123], v107, v[116:117] offset:50000

    s_mov_b64 exec, s[98:99]
    v_cvt_f32_i32_sdwa v118, sext(v108) dst_sel:DWORD dst_unused:UNUSED_PAD src0_sel:WORD_0
    v_lshlrev_b32 v116, 16, v124
    v_and_b32 v117, s32, v124
    v_mul_f32 v118, s33, v118
    v_lshlrev_b32 v124, 16, v125
    v_and_b32 v125, s32, v125
    v_lshlrev_b32_sdwa v108, 3, v108 dst_sel:DWORD dst_unused:UNUSED_PAD src0_sel:DWORD src1_sel:WORD_1
    v_pk_fma_f32 v[116:117], v[116:117], v[118:119], s[28:29] op_sel_hi:[1,0,1]
    v_pk_fma_f32 v[124:125], v[124:125], v[118:119], s[28:29] op_sel_hi:[1,0,1]
    v_perm_b32 v116, v117, v116, s35
    v_perm_b32 v117, v125, v124, s35
    v_lshl_add_u64 v[116:117], v[116:117], 0, s[30:31]
    ds_add_rtn_u64 v[124:125], v108, v[116:117] offset:50000

    s_mov_b64 exec, vcc
    v_cvt_f32_i32_sdwa v118, sext(v109) dst_sel:DWORD dst_unused:UNUSED_PAD src0_sel:WORD_0
    v_lshlrev_b32 v116, 16, v126
    v_and_b32 v117, s32, v126
    v_mul_f32 v118, s33, v118
    v_lshlrev_b32 v126, 16, v127
    v_and_b32 v127, s32, v127
    v_lshlrev_b32_sdwa v109, 3, v109 dst_sel:DWORD dst_unused:UNUSED_PAD src0_sel:DWORD src1_sel:WORD_1
    v_pk_fma_f32 v[116:117], v[116:117], v[118:119], s[28:29] op_sel_hi:[1,0,1]
    v_pk_fma_f32 v[126:127], v[126:127], v[118:119], s[28:29] op_sel_hi:[1,0,1]
    v_perm_b32 v116, v117, v116, s35
    v_perm_b32 v117, v127, v126, s35
    v_lshl_add_u64 v[116:117], v[116:117], 0, s[30:31]
    ds_add_rtn_u64 v[126:127], v109, v[116:117] offset:50000

    s_waitcnt lgkmcnt(0)
    s_mov_b64 exec, s[56:57]
    v_or3_b32 v1, v120, v121, v1
    s_mov_b64 exec, s[58:59]
    v_or3_b32 v1, v122, v123, v1
    s_mov_b64 exec, s[98:99]
    v_or3_b32 v1, v124, v125, v1
    s_mov_b64 exec, vcc
    v_or3_b32 v1, v126, v127, v1
    s_mov_b64 exec, -1
L_nt2_67:
    s_mov_b64 exec, s[64:65]
    ds_read_b64 v[28:29], v28
    s_mov_b64 exec, s[66:67]
    ds_read_b64 v[30:31], v30
    s_mov_b64 exec, s[68:69]
    ds_read_b64 v[32:33], v32
    s_mov_b64 exec, s[70:71]
    ds_read_b64 v[34:35], v34
    s_mov_b64 exec, s[72:73]
    ds_read_b64 v[36:37], v36
    s_mov_b64 exec, s[74:75]
    ds_read_b64 v[38:39], v38
    s_mov_b64 exec, s[76:77]
    ds_read_b64 v[40:41], v40
    s_mov_b64 exec, s[78:79]
    ds_read_b64 v[42:43], v42
    s_mov_b64 exec, s[80:81]
    ds_read_b64 v[44:45], v44
    s_mov_b64 exec, s[82:83]
    ds_read_b64 v[46:47], v46
    s_mov_b64 exec, s[84:85]
    ds_read_b64 v[48:49], v48
    s_mov_b64 exec, s[86:87]
    ds_read_b64 v[50:51], v50
    s_mov_b64 exec, -1
    v_subrev_co_u32 v16, s[64:65], 2.0, v16
    v_subrev_co_u32 v17, s[66:67], 2.0, v17
    v_subrev_co_u32 v18, s[68:69], 2.0, v18
    v_subrev_co_u32 v19, s[70:71], 2.0, v19
    v_subrev_co_u32 v20, s[72:73], 2.0, v20
    v_subrev_co_u32 v21, s[74:75], 2.0, v21
    v_subrev_co_u32 v22, s[76:77], 2.0, v22
    v_subrev_co_u32 v23, s[78:79], 2.0, v23
    v_subrev_co_u32 v24, s[80:81], 2.0, v24
    v_subrev_co_u32 v25, s[82:83], 2.0, v25
    v_subrev_co_u32 v26, s[84:85], 2.0, v26
    v_subrev_co_u32 v27, s[86:87], 2.0, v27
    s_mov_b64 exec, s[64:65]
    ds_read_b64 v[52:53], v52
    s_mov_b64 exec, s[66:67]
    ds_read_b64 v[54:55], v54
    s_mov_b64 exec, s[68:69]
    ds_read_b64 v[56:57], v56
    s_mov_b64 exec, s[70:71]
    ds_read_b64 v[58:59], v58
    s_mov_b64 exec, s[72:73]
    ds_read_b64 v[60:61], v60
    s_mov_b64 exec, s[74:75]
    ds_read_b64 v[62:63], v62
    s_mov_b64 exec, s[76:77]
    ds_read_b64 v[64:65], v64
    s_mov_b64 exec, s[78:79]
    ds_read_b64 v[66:67], v66
    s_mov_b64 exec, s[80:81]
    ds_read_b64 v[68:69], v68
    s_mov_b64 exec, s[82:83]
    ds_read_b64 v[70:71], v70
    s_mov_b64 exec, s[84:85]
    ds_read_b64 v[72:73], v72
    s_mov_b64 exec, s[86:87]
    ds_read_b64 v[74:75], v74
    s_mov_b64 exec, -1
    s_movk_i32 s53, 15360
    buffer_load_dwordx4 v[106:109], v2, s[16:19], s53 offen
    buffer_load_dword v114, v2, s[16:19], s53 offen offset:16
    s_cmp_le_u32 s40, 3584
    s_cbranch_scc1 L_noleft_68
    s_min_u32 s40, s40, 3968
    s_lshl_b32 s52, s38, 6
    s_add_u32 s52, s52, s36
    s_mul_i32 s52, s52, 19840
    s_add_u32 s20, s44, s52
    s_addc_u32 s21, s45, 0
    s_mul_i32 s52, s40, 5
    s_add_u32 s52, s52, 3
    s_and_b32 s22, s52, -4

    s_lshr_b32 s55, s39, 2
    s_add_u32 s55, s55, 3584
    v_and_b32 v120, 63, v0
    v_add_u32 v120, s55, v120
L_left_71:
    s_cmp_ge_u32 s55, s40
    s_cbranch_scc1 L_leftend_72
    v_mul_u32_u24 v121, 5, v120
    buffer_load_dword v122, v121, s[20:23], 0 offen
    buffer_load_ubyte v123, v121, s[20:23], 0 offen offset:4
    s_waitcnt vmcnt(0)

    v_perm_b32 v121, v123, v122, s24
    v_lshrrev_b32 v126, 30, v122
    v_and_b32 v121, 0x1fff, v121
    v_mul_u32_u24 v126, 6250, v126
    v_add_lshl_u32 v121, v121, v126, 3

    buffer_load_dwordx2 v[124:125], v121, s[8:11], s50 offen
    v_cmp_gt_u32 vcc, s40, v120
    s_waitcnt vmcnt(0)

    s_mov_b64 exec, vcc
    v_and_b32 v122, 0x3fffffff, v122
    v_cvt_f32_i32_sdwa v118, sext(v122) dst_sel:DWORD dst_unused:UNUSED_PAD src0_sel:WORD_0
    v_lshlrev_b32 v116, 16, v124
    v_and_b32 v117, s32, v124
    v_mul_f32 v118, s33, v118
    v_lshlrev_b32 v124, 16, v125
    v_and_b32 v125, s32, v125
    v_lshlrev_b32_sdwa v122, 3, v122 dst_sel:DWORD dst_unused:UNUSED_PAD src0_sel:DWORD src1_sel:WORD_1
    v_pk_fma_f32 v[116:117], v[116:117], v[118:119], s[28:29] op_sel_hi:[1,0,1]
    v_pk_fma_f32 v[124:125], v[124:125], v[118:119], s[28:29] op_sel_hi:[1,0,1]
    v_perm_b32 v116, v117, v116, s35
    v_perm_b32 v117, v125, v124, s35
    v_lshl_add_u64 v[116:117], v[116:117], 0, s[30:31]
    ds_add_rtn_u64 v[124:125], v122, v[116:117] offset:50000

    s_waitcnt lgkmcnt(0)
    v_or3_b32 v1, v124, v125, v1
    s_mov_b64 exec, -1
    v_add_u32 v120, 128, v120
    s_add_u32 s55, s55, 128
    s_branch L_left_71
L_leftend_72:

L_noleft_68:
    s_waitcnt lgkmcnt(0)
    s_barrier
    s_waitcnt vmcnt(5)
    ds_write_addtid_b32 v76 offset:0
    ds_write_addtid_b32 v77 offset:256
    ds_write_addtid_b32 v78 offset:512
    ds_write_addtid_b32 v79 offset:768
    s_waitcnt vmcnt(4)
    ds_write_addtid_b32 v80 offset:16384
    ds_write_addtid_b32 v81 offset:16640
    ds_write_addtid_b32 v82 offset:16896
    ds_write_addtid_b32 v83 offset:17152
    s_waitcnt vmcnt(3)
    ds_write_addtid_b32 v84 offset:32768
    ds_write_addtid_b32 v85 offset:33024
    ds_write_addtid_b32 v86 offset:33280
    ds_write_addtid_b32 v87 offset:33536
    v_lshlrev_b32 v119, 2, v0
    s_waitcnt vmcnt(2)
    s_mov_b64 exec, s[48:49]
    ds_write_b32 v119, v88 offset:49152
    s_mov_b64 exec, -1
    s_add_u32 s43, s43, 50048
    s_add_u32 s14, s43, 50000
    s_min_u32 s14, s14, s41
    buffer_load_dwordx4 v[76:79], v3, s[12:15], s43 offen
    s_add_u32 s52, s43, 16384
    buffer_load_dwordx4 v[80:83], v3, s[12:15], s52 offen
    v_cmp_gt_u32 s[64:65], 2.0, v4
    v_and_b32 v4, 0x3fffffff, v4
    v_cmp_gt_u32 s[66:67], 2.0, v5
    v_and_b32 v5, 0x3fffffff, v5
    v_cmp_gt_u32 s[68:69], 2.0, v6
    v_and_b32 v6, 0x3fffffff, v6
    v_cmp_gt_u32 s[70:71], 2.0, v7
    v_and_b32 v7, 0x3fffffff, v7
    v_cmp_gt_u32 s[72:73], 2.0, v8
    v_and_b32 v8, 0x3fffffff, v8
    v_cmp_gt_u32 s[74:75], 2.0, v9
    v_and_b32 v9, 0x3fffffff, v9
    v_cmp_gt_u32 s[76:77], 2.0, v10
    v_and_b32 v10, 0x3fffffff, v10
    v_cmp_gt_u32 s[78:79], 2.0, v11
    v_and_b32 v11, 0x3fffffff, v11
    v_cmp_gt_u32 s[80:81], 2.0, v12
    v_and_b32 v12, 0x3fffffff, v12
    v_cmp_gt_u32 s[82:83], 2.0, v13
    v_and_b32 v13, 0x3fffffff, v13
    v_cmp_gt_u32 s[84:85], 2.0, v14
    v_and_b32 v14, 0x3fffffff, v14
    v_cmp_gt_u32 s[86:87], 2.0, v15
    v_and_b32 v15, 0x3fffffff, v15
    s_waitcnt lgkmcnt(0)
    s_barrier
    s_add_u32 s52, s43, 32768
    buffer_load_dwordx4 v[84:87], v3, s[12:15], s52 offen
    s_add_u32 s52, s43, 49152
    v_lshlrev_b32 v119, 2, v0
    buffer_load_dword v88, v119, s[12:15], s52 offen
    s_mov_b64 exec, s[64:65]
    ds_read_b64 v[28:29], v28
    s_mov_b64 exec, s[66:67]
    ds_read_b64 v[30:31], v30
    s_mov_b64 exec, s[68:69]
    ds_read_b64 v[32:33], v32
    s_mov_b64 exec, s[70:71]
    ds_read_b64 v[34:35], v34
    s_mov_b64 exec, s[72:73]
    ds_read_b64 v[36:37], v36
    s_mov_b64 exec, s[74:75]
    ds_read_b64 v[38:39], v38
    s_mov_b64 exec, s[76:77]
    ds_read_b64 v[40:41], v40
    s_mov_b64 exec, s[78:79]
    ds_read_b64 v[42:43], v42
    s_mov_b64 exec, s[80:81]
    ds_read_b64 v[44:45], v44
    s_mov_b64 exec, s[82:83]
    ds_read_b64 v[46:47], v46
    s_mov_b64 exec, s[84:85]
    ds_read_b64 v[48:49], v48
    s_mov_b64 exec, s[86:87]
    ds_read_b64 v[50:51], v50
    s_mov_b64 exec, -1
    v_cmp_gt_u32 s[64:65], 2.0, v16
    v_and_b32 v16, 0x3fffffff, v16
    v_cmp_gt_u32 s[66:67], 2.0, v17
    v_and_b32 v17, 0x3fffffff, v17
    v_cmp_gt_u32 s[68:69], 2.0, v18
    v_and_b32 v18, 0x3fffffff, v18
    v_cmp_gt_u32 s[70:71], 2.0, v19
    v_and_b32 v19, 0x3fffffff, v19
    v_cmp_gt_u32 s[72:73], 2.0, v20
    v_and_b32 v20, 0x3fffffff, v20
    v_cmp_gt_u32 s[74:75], 2.0, v21
    v_and_b32 v21, 0x3fffffff, v21
    v_cmp_gt_u32 s[76:77], 2.0, v22
    v_and_b32 v22, 0x3fffffff, v22
    v_cmp_gt_u32 s[78:79], 2.0, v23
    v_and_b32 v23, 0x3fffffff, v23
    v_cmp_gt_u32 s[80:81], 2.0, v24
    v_and_b32 v24, 0x3fffffff, v24
    v_cmp_gt_u32 s[82:83], 2.0, v25
    v_and_b32 v25, 0x3fffffff, v25
    v_cmp_gt_u32 s[84:85], 2.0, v26
    v_and_b32 v26, 0x3fffffff, v26
    v_cmp_gt_u32 s[86:87], 2.0, v27
    v_and_b32 v27, 0x3fffffff, v27
    s_mov_b64 exec, s[64:65]
    ds_read_b64 v[52:53], v52
    s_mov_b64 exec, s[66:67]
    ds_read_b64 v[54:55], v54
    s_mov_b64 exec, s[68:69]
    ds_read_b64 v[56:57], v56
    s_mov_b64 exec, s[70:71]
    ds_read_b64 v[58:59], v58
    s_mov_b64 exec, s[72:73]
    ds_read_b64 v[60:61], v60
    s_mov_b64 exec, s[74:75]
    ds_read_b64 v[62:63], v62
    s_mov_b64 exec, s[76:77]
    ds_read_b64 v[64:65], v64
    s_mov_b64 exec, s[78:79]
    ds_read_b64 v[66:67], v66
    s_mov_b64 exec, s[80:81]
    ds_read_b64 v[68:69], v68
    s_mov_b64 exec, s[82:83]
    ds_read_b64 v[70:71], v70
    s_mov_b64 exec, s[84:85]
    ds_read_b64 v[72:73], v72
    s_mov_b64 exec, s[86:87]
    ds_read_b64 v[74:75], v74
    s_mov_b64 exec, -1
    s_movk_i32 s53, 12800
    buffer_load_dwordx4 v[102:105], v2, s[16:19], s53 offen
    buffer_load_dword v113, v2, s[16:19], s53 offen offset:16
    s_cmp_ge_u32 s5, s4
    s_cbranch_scc1 L_bend_65
    s_waitcnt lgkmcnt(15)
    v_mad_i32_i16 v120, v28, v4, s96
    v_mad_i32_i16 v28, v28, v4, s96 op_sel:[1,0,0,0]
    v_mad_i32_i16 v121, v29, v4, s96
    v_mad_i32_i16 v29, v29, v4, s96 op_sel:[1,0,0,0]
    v_lshlrev_b32_sdwa v4, 3, v4 dst_sel:DWORD dst_unused:UNUSED_PAD src0_sel:DWORD src1_sel:WORD_1
    v_perm_b32 v28, v28, v120, s97
    v_perm_b32 v29, v29, v121, s97
    v_lshl_add_u64 v[28:29], v[28:29], 0, s[30:31]

    ds_add_rtn_u64 v[28:29], v4, v[28:29] offset:50000
    v_mad_i32_i16 v122, v30, v5, s96
    v_mad_i32_i16 v30, v30, v5, s96 op_sel:[1,0,0,0]
    v_mad_i32_i16 v123, v31, v5, s96
    v_mad_i32_i16 v31, v31, v5, s96 op_sel:[1,0,0,0]
    v_lshlrev_b32_sdwa v5, 3, v5 dst_sel:DWORD dst_unused:UNUSED_PAD src0_sel:DWORD src1_sel:WORD_1
    v_perm_b32 v30, v30, v122, s97
    v_perm_b32 v31, v31, v123, s97
    v_lshl_add_u64 v[30:31], v[30:31], 0, s[30:31]

    ds_add_rtn_u64 v[30:31], v5, v[30:31] offset:50000
    v_mad_i32_i16 v124, v32, v6, s96
    v_mad_i32_i16 v32, v32, v6, s96 op_sel:[1,0,0,0]
    v_mad_i32_i16 v125, v33, v6, s96
    v_mad_i32_i16 v33, v33, v6, s96 op_sel:[1,0,0,0]
    v_lshlrev_b32_sdwa v6, 3, v6 dst_sel:DWORD dst_unused:UNUSED_PAD src0_sel:DWORD src1_sel:WORD_1
    v_perm_b32 v32, v32, v124, s97
    v_perm_b32 v33, v33, v125, s97
    v_lshl_add_u64 v[32:33], v[32:33], 0, s[30:31]

    ds_add_rtn_u64 v[32:33], v6, v[32:33] offset:50000
    v_mad_i32_i16 v126, v34, v7, s96
    v_mad_i32_i16 v34, v34, v7, s96 op_sel:[1,0,0,0]
    v_mad_i32_i16 v127, v35, v7, s96
    v_mad_i32_i16 v35, v35, v7, s96 op_sel:[1,0,0,0]
    v_lshlrev_b32_sdwa v7, 3, v7 dst_sel:DWORD dst_unused:UNUSED_PAD src0_sel:DWORD src1_sel:WORD_1
    v_perm_b32 v34, v34, v126, s97
    v_perm_b32 v35, v35, v127, s97
    v_lshl_add_u64 v[34:35], v[34:35], 0, s[30:31]

    ds_add_rtn_u64 v[34:35], v7, v[34:35] offset:50000
    v_mad_i32_i16 v120, v36, v8, s96
    v_mad_i32_i16 v36, v36, v8, s96 op_sel:[1,0,0,0]
    v_mad_i32_i16 v121, v37, v8, s96
    v_mad_i32_i16 v37, v37, v8, s96 op_sel:[1,0,0,0]
    v_lshlrev_b32_sdwa v8, 3, v8 dst_sel:DWORD dst_unused:UNUSED_PAD src0_sel:DWORD src1_sel:WORD_1
    v_perm_b32 v36, v36, v120, s97
    v_perm_b32 v37, v37, v121, s97
    v_lshl_add_u64 v[36:37], v[36:37], 0, s[30:31]

    ds_add_rtn_u64 v[36:37], v8, v[36:37] offset:50000
    v_mad_i32_i16 v122, v38, v9, s96
    v_mad_i32_i16 v38, v38, v9, s96 op_sel:[1,0,0,0]
    v_mad_i32_i16 v123, v39, v9, s96
    v_mad_i32_i16 v39, v39, v9, s96 op_sel:[1,0,0,0]
    v_lshlrev_b32_sdwa v9, 3, v9 dst_sel:DWORD dst_unused:UNUSED_PAD src0_sel:DWORD src1_sel:WORD_1
    v_perm_b32 v38, v38, v122, s97
    v_perm_b32 v39, v39, v123, s97
    v_lshl_add_u64 v[38:39], v[38:39], 0, s[30:31]

    ds_add_rtn_u64 v[38:39], v9, v[38:39] offset:50000
    v_mad_i32_i16 v124, v40, v10, s96
    v_mad_i32_i16 v40, v40, v10, s96 op_sel:[1,0,0,0]
    v_mad_i32_i16 v125, v41, v10, s96
    v_mad_i32_i16 v41, v41, v10, s96 op_sel:[1,0,0,0]
    v_lshlrev_b32_sdwa v10, 3, v10 dst_sel:DWORD dst_unused:UNUSED_PAD src0_sel:DWORD src1_sel:WORD_1
    v_perm_b32 v40, v40, v124, s97
    v_perm_b32 v41, v41, v125, s97
    v_lshl_add_u64 v[40:41], v[40:41], 0, s[30:31]

    ds_add_rtn_u64 v[40:41], v10, v[40:41] offset:50000
    v_mad_i32_i16 v126, v42, v11, s96
    v_mad_i32_i16 v42, v42, v11, s96 op_sel:[1,0,0,0]
    v_mad_i32_i16 v127, v43, v11, s96
    v_mad_i32_i16 v43, v43, v11, s96 op_sel:[1,0,0,0]
    v_lshlrev_b32_sdwa v11, 3, v11 dst_sel:DWORD dst_unused:UNUSED_PAD src0_sel:DWORD src1_sel:WORD_1
    v_perm_b32 v42, v42, v126, s97
    v_perm_b32 v43, v43, v127, s97
    v_lshl_add_u64 v[42:43], v[42:43], 0, s[30:31]

    ds_add_rtn_u64 v[42:43], v11, v[42:43] offset:50000
    s_waitcnt lgkmcnt(4)
    v_or3_b32 v1, v28, v29, v1
    v_or3_b32 v1, v30, v31, v1
    v_or3_b32 v1, v32, v33, v1
    v_or3_b32 v1, v34, v35, v1
    s_movk_i32 s53, 0
    buffer_load_dwordx4 v[4:7], v2, s[16:19], s53 offen
    buffer_load_dword v35, v2, s[16:19], s53 offen offset:16
    s_barrier
    s_waitcnt vmcnt(7)
    ds_write_addtid_b32 v76 offset:0
    ds_write_addtid_b32 v77 offset:256
    ds_write_addtid_b32 v78 offset:512
    ds_write_addtid_b32 v79 offset:768
    s_waitcnt vmcnt(6)
    ds_write_addtid_b32 v80 offset:16384
    ds_write_addtid_b32 v81 offset:16640
    ds_write_addtid_b32 v82 offset:16896
    ds_write_addtid_b32 v83 offset:17152
    s_waitcnt vmcnt(5)
    ds_write_addtid_b32 v84 offset:32768
    ds_write_addtid_b32 v85 offset:33024
    ds_write_addtid_b32 v86 offset:33280
    ds_write_addtid_b32 v87 offset:33536
    v_lshlrev_b32 v119, 2, v0
    s_waitcnt vmcnt(4)
    s_mov_b64 exec, s[48:49]
    ds_write_b32 v119, v88 offset:49152
    s_mov_b64 exec, -1
    s_add_u32 s43, s43, 50048
    s_add_u32 s14, s43, 50000
    s_min_u32 s14, s14, s41
    buffer_load_dwordx4 v[76:79], v3, s[12:15], s43 offen
    s_add_u32 s52, s43, 16384
    buffer_load_dwordx4 v[80:83], v3, s[12:15], s52 offen
    s_add_u32 s52, s43, 32768
    buffer_load_dwordx4 v[84:87], v3, s[12:15], s52 offen
    s_add_u32 s52, s43, 49152
    v_lshlrev_b32 v119, 2, v0
    buffer_load_dword v88, v119, s[12:15], s52 offen
    s_add_u32 s54, s43, 50048
    buffer_load_dword v115, v89, s[60:63], s54 offen
    s_add_u32 s54, s50, 200000
    buffer_load_dword v115, v89, s[8:11], s54 offen
    v_mad_i32_i16 v120, v44, v12, s96
    v_mad_i32_i16 v44, v44, v12, s96 op_sel:[1,0,0,0]
    v_mad_i32_i16 v121, v45, v12, s96
    v_mad_i32_i16 v45, v45, v12, s96 op_sel:[1,0,0,0]
    v_lshlrev_b32_sdwa v12, 3, v12 dst_sel:DWORD dst_unused:UNUSED_PAD src0_sel:DWORD src1_sel:WORD_1
    v_perm_b32 v44, v44, v120, s97
    v_perm_b32 v45, v45, v121, s97
    v_lshl_add_u64 v[44:45], v[44:45], 0, s[30:31]

    ds_add_rtn_u64 v[44:45], v12, v[44:45] offset:50000
    v_mad_i32_i16 v122, v46, v13, s96
    v_mad_i32_i16 v46, v46, v13, s96 op_sel:[1,0,0,0]
    v_mad_i32_i16 v123, v47, v13, s96
    v_mad_i32_i16 v47, v47, v13, s96 op_sel:[1,0,0,0]
    v_lshlrev_b32_sdwa v13, 3, v13 dst_sel:DWORD dst_unused:UNUSED_PAD src0_sel:DWORD src1_sel:WORD_1
    v_perm_b32 v46, v46, v122, s97
    v_perm_b32 v47, v47, v123, s97
    v_lshl_add_u64 v[46:47], v[46:47], 0, s[30:31]

    ds_add_rtn_u64 v[46:47], v13, v[46:47] offset:50000
    v_mad_i32_i16 v124, v48, v14, s96
    v_mad_i32_i16 v48, v48, v14, s96 op_sel:[1,0,0,0]
    v_mad_i32_i16 v125, v49, v14, s96
    v_mad_i32_i16 v49, v49, v14, s96 op_sel:[1,0,0,0]
    v_lshlrev_b32_sdwa v14, 3, v14 dst_sel:DWORD dst_unused:UNUSED_PAD src0_sel:DWORD src1_sel:WORD_1
    v_perm_b32 v48, v48, v124, s97
    v_perm_b32 v49, v49, v125, s97
    v_lshl_add_u64 v[48:49], v[48:49], 0, s[30:31]

    ds_add_rtn_u64 v[48:49], v14, v[48:49] offset:50000
    v_mad_i32_i16 v126, v50, v15, s96
    v_mad_i32_i16 v50, v50, v15, s96 op_sel:[1,0,0,0]
    v_mad_i32_i16 v127, v51, v15, s96
    v_mad_i32_i16 v51, v51, v15, s96 op_sel:[1,0,0,0]
    v_lshlrev_b32_sdwa v15, 3, v15 dst_sel:DWORD dst_unused:UNUSED_PAD src0_sel:DWORD src1_sel:WORD_1
    v_perm_b32 v50, v50, v126, s97
    v_perm_b32 v51, v51, v127, s97
    v_lshl_add_u64 v[50:51], v[50:51], 0, s[30:31]

    ds_add_rtn_u64 v[50:51], v15, v[50:51] offset:50000
    s_waitcnt lgkmcnt(15)
    v_or3_b32 v1, v36, v37, v1
    v_or3_b32 v1, v38, v39, v1
    v_or3_b32 v1, v40, v41, v1
    v_or3_b32 v1, v42, v43, v1
    s_movk_i32 s53, 2560
    buffer_load_dwordx4 v[8:11], v2, s[16:19], s53 offen
    buffer_load_dword v43, v2, s[16:19], s53 offen offset:16
    s_mov_b32 s40, s88
    s_sub_u32 s42, s40, s39

    s_add_u32 s55, s38, 2
    s_min_u32 s55, s55, 31
    s_mov_b32 s88, s89
    s_mov_b32 s89, s90
    s_mov_b32 s90, s91
    s_mov_b32 s91, s92
    s_mov_b32 s92, s93
    s_mov_b32 s93, s94
    s_mov_b32 s94, s95
    s_mov_b32 s95, 0
    s_min_u32 s88, s88, 3968
    s_lshl_b32 s52, s55, 6
    s_add_u32 s52, s52, s36
    s_mul_i32 s52, s52, 19840
    s_add_u32 s16, s44, s52
    s_addc_u32 s17, s45, 0
    s_mul_i32 s52, s88, 5
    s_add_u32 s52, s52, 3
    s_and_b32 s18, s52, -4

    v_mad_i32_i16 v120, v52, v16, s96
    v_mad_i32_i16 v52, v52, v16, s96 op_sel:[1,0,0,0]
    v_mad_i32_i16 v121, v53, v16, s96
    v_mad_i32_i16 v53, v53, v16, s96 op_sel:[1,0,0,0]
    v_lshlrev_b32_sdwa v16, 3, v16 dst_sel:DWORD dst_unused:UNUSED_PAD src0_sel:DWORD src1_sel:WORD_1
    v_perm_b32 v52, v52, v120, s97
    v_perm_b32 v53, v53, v121, s97
    v_lshl_add_u64 v[52:53], v[52:53], 0, s[30:31]

    ds_add_rtn_u64 v[52:53], v16, v[52:53] offset:50000
    v_mad_i32_i16 v122, v54, v17, s96
    v_mad_i32_i16 v54, v54, v17, s96 op_sel:[1,0,0,0]
    v_mad_i32_i16 v123, v55, v17, s96
    v_mad_i32_i16 v55, v55, v17, s96 op_sel:[1,0,0,0]
    v_lshlrev_b32_sdwa v17, 3, v17 dst_sel:DWORD dst_unused:UNUSED_PAD src0_sel:DWORD src1_sel:WORD_1
    v_perm_b32 v54, v54, v122, s97
    v_perm_b32 v55, v55, v123, s97
    v_lshl_add_u64 v[54:55], v[54:55], 0, s[30:31]

    ds_add_rtn_u64 v[54:55], v17, v[54:55] offset:50000
    v_mad_i32_i16 v124, v56, v18, s96
    v_mad_i32_i16 v56, v56, v18, s96 op_sel:[1,0,0,0]
    v_mad_i32_i16 v125, v57, v18, s96
    v_mad_i32_i16 v57, v57, v18, s96 op_sel:[1,0,0,0]
    v_lshlrev_b32_sdwa v18, 3, v18 dst_sel:DWORD dst_unused:UNUSED_PAD src0_sel:DWORD src1_sel:WORD_1
    v_perm_b32 v56, v56, v124, s97
    v_perm_b32 v57, v57, v125, s97
    v_lshl_add_u64 v[56:57], v[56:57], 0, s[30:31]

    ds_add_rtn_u64 v[56:57], v18, v[56:57] offset:50000
    v_mad_i32_i16 v126, v58, v19, s96
    v_mad_i32_i16 v58, v58, v19, s96 op_sel:[1,0,0,0]
    v_mad_i32_i16 v127, v59, v19, s96
    v_mad_i32_i16 v59, v59, v19, s96 op_sel:[1,0,0,0]
    v_lshlrev_b32_sdwa v19, 3, v19 dst_sel:DWORD dst_unused:UNUSED_PAD src0_sel:DWORD src1_sel:WORD_1
    v_perm_b32 v58, v58, v126, s97
    v_perm_b32 v59, v59, v127, s97
    v_lshl_add_u64 v[58:59], v[58:59], 0, s[30:31]

    ds_add_rtn_u64 v[58:59], v19, v[58:59] offset:50000
    s_waitcnt lgkmcnt(4)
    v_or3_b32 v1, v44, v45, v1
    v_or3_b32 v1, v46, v47, v1
    v_or3_b32 v1, v48, v49, v1
    v_or3_b32 v1, v50, v51, v1
    s_waitcnt vmcnt(30)
    v_perm_b32 v44, v91, v90, s24
    v_perm_b32 v46, v92, v91, s25
    v_perm_b32 v48, v93, v92, s26
    v_perm_b32 v50, v110, v93, s27
    v_mov_b32 v12, v90
    v_alignbyte_b32 v13, v92, v91, 1
    v_alignbyte_b32 v14, v93, v92, 2
    v_alignbyte_b32 v15, v110, v93, 3
    v_lshlrev_b32_sdwa v44, 3, v44 dst_sel:WORD_0 dst_unused:UNUSED_PAD src0_sel:DWORD src1_sel:DWORD
    v_lshlrev_b32_sdwa v46, 3, v46 dst_sel:WORD_0 dst_unused:UNUSED_PAD src0_sel:DWORD src1_sel:DWORD
    v_lshlrev_b32_sdwa v48, 3, v48 dst_sel:WORD_0 dst_unused:UNUSED_PAD src0_sel:DWORD src1_sel:DWORD
    v_lshlrev_b32_sdwa v50, 3, v50 dst_sel:WORD_0 dst_unused:UNUSED_PAD src0_sel:DWORD src1_sel:DWORD
    s_cmp_lt_i32 s42, 1280
    s_cbranch_scc1 L_ufix_73
L_uback_74:

    s_movk_i32 s53, 5120
    buffer_load_dwordx4 v[90:93], v2, s[16:19], s53 offen
    buffer_load_dword v110, v2, s[16:19], s53 offen offset:16
    s_barrier
    v_subrev_co_u32 v12, s[80:81], 2.0, v12
    v_subrev_co_u32 v13, s[82:83], 2.0, v13
    v_subrev_co_u32 v14, s[84:85], 2.0, v14
    v_subrev_co_u32 v15, s[86:87], 2.0, v15
    s_mov_b64 exec, s[80:81]
    ds_read_b64 v[44:45], v44
    s_mov_b64 exec, s[82:83]
    ds_read_b64 v[46:47], v46
    s_mov_b64 exec, s[84:85]
    ds_read_b64 v[48:49], v48
    s_mov_b64 exec, s[86:87]
    ds_read_b64 v[50:51], v50
    s_mov_b64 exec, -1
    v_mad_i32_i16 v120, v60, v20, s96
    v_mad_i32_i16 v60, v60, v20, s96 op_sel:[1,0,0,0]
    v_mad_i32_i16 v121, v61, v20, s96
    v_mad_i32_i16 v61, v61, v20, s96 op_sel:[1,0,0,0]
    v_lshlrev_b32_sdwa v20, 3, v20 dst_sel:DWORD dst_unused:UNUSED_PAD src0_sel:DWORD src1_sel:WORD_1
    v_perm_b32 v60, v60, v120, s97
    v_perm_b32 v61, v61, v121, s97
    v_lshl_add_u64 v[60:61], v[60:61], 0, s[30:31]

    ds_add_rtn_u64 v[60:61], v20, v[60:61] offset:50000
    v_mad_i32_i16 v122, v62, v21, s96
    v_mad_i32_i16 v62, v62, v21, s96 op_sel:[1,0,0,0]
    v_mad_i32_i16 v123, v63, v21, s96
    v_mad_i32_i16 v63, v63, v21, s96 op_sel:[1,0,0,0]
    v_lshlrev_b32_sdwa v21, 3, v21 dst_sel:DWORD dst_unused:UNUSED_PAD src0_sel:DWORD src1_sel:WORD_1
    v_perm_b32 v62, v62, v122, s97
    v_perm_b32 v63, v63, v123, s97
    v_lshl_add_u64 v[62:63], v[62:63], 0, s[30:31]

    ds_add_rtn_u64 v[62:63], v21, v[62:63] offset:50000
    v_mad_i32_i16 v124, v64, v22, s96
    v_mad_i32_i16 v64, v64, v22, s96 op_sel:[1,0,0,0]
    v_mad_i32_i16 v125, v65, v22, s96
    v_mad_i32_i16 v65, v65, v22, s96 op_sel:[1,0,0,0]
    v_lshlrev_b32_sdwa v22, 3, v22 dst_sel:DWORD dst_unused:UNUSED_PAD src0_sel:DWORD src1_sel:WORD_1
    v_perm_b32 v64, v64, v124, s97
    v_perm_b32 v65, v65, v125, s97
    v_lshl_add_u64 v[64:65], v[64:65], 0, s[30:31]

    ds_add_rtn_u64 v[64:65], v22, v[64:65] offset:50000
    v_mad_i32_i16 v126, v66, v23, s96
    v_mad_i32_i16 v66, v66, v23, s96 op_sel:[1,0,0,0]
    v_mad_i32_i16 v127, v67, v23, s96
    v_mad_i32_i16 v67, v67, v23, s96 op_sel:[1,0,0,0]
    v_lshlrev_b32_sdwa v23, 3, v23 dst_sel:DWORD dst_unused:UNUSED_PAD src0_sel:DWORD src1_sel:WORD_1
    v_perm_b32 v66, v66, v126, s97
    v_perm_b32 v67, v67, v127, s97
    v_lshl_add_u64 v[66:67], v[66:67], 0, s[30:31]

    ds_add_rtn_u64 v[66:67], v23, v[66:67] offset:50000
    s_waitcnt lgkmcnt(8)
    v_or3_b32 v1, v52, v53, v1
    v_or3_b32 v1, v54, v55, v1
    v_or3_b32 v1, v56, v57, v1
    v_or3_b32 v1, v58, v59, v1
    s_waitcnt vmcnt(30)
    v_perm_b32 v52, v95, v94, s24
    v_perm_b32 v54, v96, v95, s25
    v_perm_b32 v56, v97, v96, s26
    v_perm_b32 v58, v111, v97, s27
    v_mov_b32 v16, v94
    v_alignbyte_b32 v17, v96, v95, 1
    v_alignbyte_b32 v18, v97, v96, 2
    v_alignbyte_b32 v19, v111, v97, 3
    v_lshlrev_b32_sdwa v52, 3, v52 dst_sel:WORD_0 dst_unused:UNUSED_PAD src0_sel:DWORD src1_sel:DWORD
    v_lshlrev_b32_sdwa v54, 3, v54 dst_sel:WORD_0 dst_unused:UNUSED_PAD src0_sel:DWORD src1_sel:DWORD
    v_lshlrev_b32_sdwa v56, 3, v56 dst_sel:WORD_0 dst_unused:UNUSED_PAD src0_sel:DWORD src1_sel:DWORD
    v_lshlrev_b32_sdwa v58, 3, v58 dst_sel:WORD_0 dst_unused:UNUSED_PAD src0_sel:DWORD src1_sel:DWORD
    s_cmp_lt_i32 s42, 1792
    s_cbranch_scc1 L_ufix_75
L_uback_76:

    v_subrev_co_u32 v16, s[64:65], 2.0, v16
    v_subrev_co_u32 v17, s[66:67], 2.0, v17
    v_subrev_co_u32 v18, s[68:69], 2.0, v18
    v_subrev_co_u32 v19, s[70:71], 2.0, v19
    s_mov_b64 exec, s[64:65]
    ds_read_b64 v[52:53], v52
    s_mov_b64 exec, s[66:67]
    ds_read_b64 v[54:55], v54
    s_mov_b64 exec, s[68:69]
    ds_read_b64 v[56:57], v56
    s_mov_b64 exec, s[70:71]
    ds_read_b64 v[58:59], v58
    s_mov_b64 exec, -1
    s_movk_i32 s53, 7680
    buffer_load_dwordx4 v[94:97], v2, s[16:19], s53 offen
    buffer_load_dword v111, v2, s[16:19], s53 offen offset:16
    v_mad_i32_i16 v120, v68, v24, s96
    v_mad_i32_i16 v68, v68, v24, s96 op_sel:[1,0,0,0]
    v_mad_i32_i16 v121, v69, v24, s96
    v_mad_i32_i16 v69, v69, v24, s96 op_sel:[1,0,0,0]
    v_lshlrev_b32_sdwa v24, 3, v24 dst_sel:DWORD dst_unused:UNUSED_PAD src0_sel:DWORD src1_sel:WORD_1
    v_perm_b32 v68, v68, v120, s97
    v_perm_b32 v69, v69, v121, s97
    v_lshl_add_u64 v[68:69], v[68:69], 0, s[30:31]

    ds_add_rtn_u64 v[68:69], v24, v[68:69] offset:50000
    v_mad_i32_i16 v122, v70, v25, s96
    v_mad_i32_i16 v70, v70, v25, s96 op_sel:[1,0,0,0]
    v_mad_i32_i16 v123, v71, v25, s96
    v_mad_i32_i16 v71, v71, v25, s96 op_sel:[1,0,0,0]
    v_lshlrev_b32_sdwa v25, 3, v25 dst_sel:DWORD dst_unused:UNUSED_PAD src0_sel:DWORD src1_sel:WORD_1
    v_perm_b32 v70, v70, v122, s97
    v_perm_b32 v71, v71, v123, s97
    v_lshl_add_u64 v[70:71], v[70:71], 0, s[30:31]

    ds_add_rtn_u64 v[70:71], v25, v[70:71] offset:50000
    v_mad_i32_i16 v124, v72, v26, s96
    v_mad_i32_i16 v72, v72, v26, s96 op_sel:[1,0,0,0]
    v_mad_i32_i16 v125, v73, v26, s96
    v_mad_i32_i16 v73, v73, v26, s96 op_sel:[1,0,0,0]
    v_lshlrev_b32_sdwa v26, 3, v26 dst_sel:DWORD dst_unused:UNUSED_PAD src0_sel:DWORD src1_sel:WORD_1
    v_perm_b32 v72, v72, v124, s97
    v_perm_b32 v73, v73, v125, s97
    v_lshl_add_u64 v[72:73], v[72:73], 0, s[30:31]

    ds_add_rtn_u64 v[72:73], v26, v[72:73] offset:50000
    v_mad_i32_i16 v126, v74, v27, s96
    v_mad_i32_i16 v74, v74, v27, s96 op_sel:[1,0,0,0]
    v_mad_i32_i16 v127, v75, v27, s96
    v_mad_i32_i16 v75, v75, v27, s96 op_sel:[1,0,0,0]
    v_lshlrev_b32_sdwa v27, 3, v27 dst_sel:DWORD dst_unused:UNUSED_PAD src0_sel:DWORD src1_sel:WORD_1
    v_perm_b32 v74, v74, v126, s97
    v_perm_b32 v75, v75, v127, s97
    v_lshl_add_u64 v[74:75], v[74:75], 0, s[30:31]

    ds_add_rtn_u64 v[74:75], v27, v[74:75] offset:50000
    s_waitcnt lgkmcnt(8)
    v_or3_b32 v1, v60, v61, v1
    v_or3_b32 v1, v62, v63, v1
    v_or3_b32 v1, v64, v65, v1
    v_or3_b32 v1, v66, v67, v1
    s_waitcnt vmcnt(30)
    v_perm_b32 v60, v99, v98, s24
    v_perm_b32 v62, v100, v99, s25
    v_perm_b32 v64, v101, v100, s26
    v_perm_b32 v66, v112, v101, s27
    v_mov_b32 v20, v98
    v_alignbyte_b32 v21, v100, v99, 1
    v_alignbyte_b32 v22, v101, v100, 2
    v_alignbyte_b32 v23, v112, v101, 3
    v_lshlrev_b32_sdwa v60, 3, v60 dst_sel:WORD_0 dst_unused:UNUSED_PAD src0_sel:DWORD src1_sel:DWORD
    v_lshlrev_b32_sdwa v62, 3, v62 dst_sel:WORD_0 dst_unused:UNUSED_PAD src0_sel:DWORD src1_sel:DWORD
    v_lshlrev_b32_sdwa v64, 3, v64 dst_sel:WORD_0 dst_unused:UNUSED_PAD src0_sel:DWORD src1_sel:DWORD
    v_lshlrev_b32_sdwa v66, 3, v66 dst_sel:WORD_0 dst_unused:UNUSED_PAD src0_sel:DWORD src1_sel:DWORD
    s_cmp_lt_i32 s42, 2304
    s_cbranch_scc1 L_ufix_77
L_uback_78:

    v_subrev_co_u32 v20, s[72:73], 2.0, v20
    v_subrev_co_u32 v21, s[74:75], 2.0, v21
    v_subrev_co_u32 v22, s[76:77], 2.0, v22
    v_subrev_co_u32 v23, s[78:79], 2.0, v23
    s_mov_b64 exec, s[72:73]
    ds_read_b64 v[60:61], v60
    s_mov_b64 exec, s[74:75]
    ds_read_b64 v[62:63], v62
    s_mov_b64 exec, s[76:77]
    ds_read_b64 v[64:65], v64
    s_mov_b64 exec, s[78:79]
    ds_read_b64 v[66:67], v66
    s_mov_b64 exec, -1
    s_movk_i32 s53, 10240
    buffer_load_dwordx4 v[98:101], v2, s[16:19], s53 offen
    buffer_load_dword v112, v2, s[16:19], s53 offen offset:16
    s_waitcnt lgkmcnt(4)
    v_or3_b32 v1, v68, v69, v1
    v_or3_b32 v1, v70, v71, v1
    v_or3_b32 v1, v72, v73, v1
    v_or3_b32 v1, v74, v75, v1
    s_waitcnt vmcnt(16)
    v_perm_b32 v68, v103, v102, s24
    v_perm_b32 v70, v104, v103, s25
    v_perm_b32 v72, v105, v104, s26
    v_perm_b32 v74, v113, v105, s27
    v_mov_b32 v24, v102
    v_alignbyte_b32 v25, v104, v103, 1
    v_alignbyte_b32 v26, v105, v104, 2
    v_alignbyte_b32 v27, v113, v105, 3
    v_lshlrev_b32_sdwa v68, 3, v68 dst_sel:WORD_0 dst_unused:UNUSED_PAD src0_sel:DWORD src1_sel:DWORD
    v_lshlrev_b32_sdwa v70, 3, v70 dst_sel:WORD_0 dst_unused:UNUSED_PAD src0_sel:DWORD src1_sel:DWORD
    v_lshlrev_b32_sdwa v72, 3, v72 dst_sel:WORD_0 dst_unused:UNUSED_PAD src0_sel:DWORD src1_sel:DWORD
    v_lshlrev_b32_sdwa v74, 3, v74 dst_sel:WORD_0 dst_unused:UNUSED_PAD src0_sel:DWORD src1_sel:DWORD
    s_cmp_lt_i32 s42, 2816
    s_cbranch_scc1 L_ufix_79
L_uback_80:

    v_subrev_co_u32 v24, s[80:81], 2.0, v24
    v_subrev_co_u32 v25, s[82:83], 2.0, v25
    v_subrev_co_u32 v26, s[84:85], 2.0, v26
    v_subrev_co_u32 v27, s[86:87], 2.0, v27
    s_mov_b64 exec, s[80:81]
    ds_read_b64 v[68:69], v68
    s_mov_b64 exec, s[82:83]
    ds_read_b64 v[70:71], v70
    s_mov_b64 exec, s[84:85]
    ds_read_b64 v[72:73], v72
    s_mov_b64 exec, s[86:87]
    ds_read_b64 v[74:75], v74
    s_mov_b64 exec, -1
    s_waitcnt vmcnt(14)
    v_perm_b32 v28, v5, v4, s24
    v_perm_b32 v30, v6, v5, s25
    v_perm_b32 v32, v7, v6, s26
    v_perm_b32 v34, v35, v7, s27
    v_alignbyte_b32 v5, v6, v5, 1
    v_alignbyte_b32 v6, v7, v6, 2
    v_alignbyte_b32 v7, v35, v7, 3
    v_lshlrev_b32_sdwa v28, 3, v28 dst_sel:WORD_0 dst_unused:UNUSED_PAD src0_sel:DWORD src1_sel:DWORD
    v_lshlrev_b32_sdwa v30, 3, v30 dst_sel:WORD_0 dst_unused:UNUSED_PAD src0_sel:DWORD src1_sel:DWORD
    v_lshlrev_b32_sdwa v32, 3, v32 dst_sel:WORD_0 dst_unused:UNUSED_PAD src0_sel:DWORD src1_sel:DWORD
    v_lshlrev_b32_sdwa v34, 3, v34 dst_sel:WORD_0 dst_unused:UNUSED_PAD src0_sel:DWORD src1_sel:DWORD
    s_cmp_lt_i32 s42, 256
    s_cbranch_scc1 L_ufix_81
L_uback_82:

    v_subrev_co_u32 v4, s[64:65], 2.0, v4
    v_subrev_co_u32 v5, s[66:67], 2.0, v5
    v_subrev_co_u32 v6, s[68:69], 2.0, v6
    v_subrev_co_u32 v7, s[70:71], 2.0, v7
    s_mov_b64 exec, s[64:65]
    ds_read_b64 v[28:29], v28
    s_mov_b64 exec, s[66:67]
    ds_read_b64 v[30:31], v30
    s_mov_b64 exec, s[68:69]
    ds_read_b64 v[32:33], v32
    s_mov_b64 exec, s[70:71]
    ds_read_b64 v[34:35], v34
    s_mov_b64 exec, -1
    s_waitcnt vmcnt(6)
    v_perm_b32 v36, v9, v8, s24
    v_perm_b32 v38, v10, v9, s25
    v_perm_b32 v40, v11, v10, s26
    v_perm_b32 v42, v43, v11, s27
    v_alignbyte_b32 v9, v10, v9, 1
    v_alignbyte_b32 v10, v11, v10, 2
    v_alignbyte_b32 v11, v43, v11, 3
    v_lshlrev_b32_sdwa v36, 3, v36 dst_sel:WORD_0 dst_unused:UNUSED_PAD src0_sel:DWORD src1_sel:DWORD
    v_lshlrev_b32_sdwa v38, 3, v38 dst_sel:WORD_0 dst_unused:UNUSED_PAD src0_sel:DWORD src1_sel:DWORD
    v_lshlrev_b32_sdwa v40, 3, v40 dst_sel:WORD_0 dst_unused:UNUSED_PAD src0_sel:DWORD src1_sel:DWORD
    v_lshlrev_b32_sdwa v42, 3, v42 dst_sel:WORD_0 dst_unused:UNUSED_PAD src0_sel:DWORD src1_sel:DWORD
    s_cmp_lt_i32 s42, 768
    s_cbranch_scc1 L_ufix_83
L_uback_84:

    v_subrev_co_u32 v8, s[72:73], 2.0, v8
    v_subrev_co_u32 v9, s[74:75], 2.0, v9
    v_subrev_co_u32 v10, s[76:77], 2.0, v10
    v_subrev_co_u32 v11, s[78:79], 2.0, v11
    s_mov_b64 exec, s[72:73]
    ds_read_b64 v[36:37], v36
    s_mov_b64 exec, s[74:75]
    ds_read_b64 v[38:39], v38
    s_mov_b64 exec, s[76:77]
    ds_read_b64 v[40:41], v40
    s_mov_b64 exec, s[78:79]
    ds_read_b64 v[42:43], v42
    s_mov_b64 exec, -1
    s_mov_b32 s38, s5
    s_add_u32 s50, s50, 200000
    s_branch L_batch_64
L_bend_65:

    s_load_dwordx2 s[64:65], s[0:1], 24
    s_load_dwordx2 s[86:87], s[0:1], 40
    s_load_dwordx8 s[88:95], s[0:1], 56
    s_mov_b32 s66, 1600000
    s_mov_b32 s67, 0x20000

    s_waitcnt lgkmcnt(15)
    v_mad_i32_i16 v120, v28, v4, s96
    v_mad_i32_i16 v28, v28, v4, s96 op_sel:[1,0,0,0]
    v_mad_i32_i16 v121, v29, v4, s96
    v_mad_i32_i16 v29, v29, v4, s96 op_sel:[1,0,0,0]
    v_lshlrev_b32_sdwa v4, 3, v4 dst_sel:DWORD dst_unused:UNUSED_PAD src0_sel:DWORD src1_sel:WORD_1
    v_perm_b32 v28, v28, v120, s97
    v_perm_b32 v29, v29, v121, s97
    v_lshl_add_u64 v[28:29], v[28:29], 0, s[30:31]

    ds_add_rtn_u64 v[28:29], v4, v[28:29] offset:50000
    v_mad_i32_i16 v122, v30, v5, s96
    v_mad_i32_i16 v30, v30, v5, s96 op_sel:[1,0,0,0]
    v_mad_i32_i16 v123, v31, v5, s96
    v_mad_i32_i16 v31, v31, v5, s96 op_sel:[1,0,0,0]
    v_lshlrev_b32_sdwa v5, 3, v5 dst_sel:DWORD dst_unused:UNUSED_PAD src0_sel:DWORD src1_sel:WORD_1
    v_perm_b32 v30, v30, v122, s97
    v_perm_b32 v31, v31, v123, s97
    v_lshl_add_u64 v[30:31], v[30:31], 0, s[30:31]

    ds_add_rtn_u64 v[30:31], v5, v[30:31] offset:50000
    v_mad_i32_i16 v124, v32, v6, s96
    v_mad_i32_i16 v32, v32, v6, s96 op_sel:[1,0,0,0]
    v_mad_i32_i16 v125, v33, v6, s96
    v_mad_i32_i16 v33, v33, v6, s96 op_sel:[1,0,0,0]
    v_lshlrev_b32_sdwa v6, 3, v6 dst_sel:DWORD dst_unused:UNUSED_PAD src0_sel:DWORD src1_sel:WORD_1
    v_perm_b32 v32, v32, v124, s97
    v_perm_b32 v33, v33, v125, s97
    v_lshl_add_u64 v[32:33], v[32:33], 0, s[30:31]

    ds_add_rtn_u64 v[32:33], v6, v[32:33] offset:50000
    v_mad_i32_i16 v126, v34, v7, s96
    v_mad_i32_i16 v34, v34, v7, s96 op_sel:[1,0,0,0]
    v_mad_i32_i16 v127, v35, v7, s96
    v_mad_i32_i16 v35, v35, v7, s96 op_sel:[1,0,0,0]
    v_lshlrev_b32_sdwa v7, 3, v7 dst_sel:DWORD dst_unused:UNUSED_PAD src0_sel:DWORD src1_sel:WORD_1
    v_perm_b32 v34, v34, v126, s97
    v_perm_b32 v35, v35, v127, s97
    v_lshl_add_u64 v[34:35], v[34:35], 0, s[30:31]

    ds_add_rtn_u64 v[34:35], v7, v[34:35] offset:50000
    v_mad_i32_i16 v120, v36, v8, s96
    v_mad_i32_i16 v36, v36, v8, s96 op_sel:[1,0,0,0]
    v_mad_i32_i16 v121, v37, v8, s96
    v_mad_i32_i16 v37, v37, v8, s96 op_sel:[1,0,0,0]
    v_lshlrev_b32_sdwa v8, 3, v8 dst_sel:DWORD dst_unused:UNUSED_PAD src0_sel:DWORD src1_sel:WORD_1
    v_perm_b32 v36, v36, v120, s97
    v_perm_b32 v37, v37, v121, s97
    v_lshl_add_u64 v[36:37], v[36:37], 0, s[30:31]

    ds_add_rtn_u64 v[36:37], v8, v[36:37] offset:50000
    v_mad_i32_i16 v122, v38, v9, s96
    v_mad_i32_i16 v38, v38, v9, s96 op_sel:[1,0,0,0]
    v_mad_i32_i16 v123, v39, v9, s96
    v_mad_i32_i16 v39, v39, v9, s96 op_sel:[1,0,0,0]
    v_lshlrev_b32_sdwa v9, 3, v9 dst_sel:DWORD dst_unused:UNUSED_PAD src0_sel:DWORD src1_sel:WORD_1
    v_perm_b32 v38, v38, v122, s97
    v_perm_b32 v39, v39, v123, s97
    v_lshl_add_u64 v[38:39], v[38:39], 0, s[30:31]

    ds_add_rtn_u64 v[38:39], v9, v[38:39] offset:50000
    v_mad_i32_i16 v124, v40, v10, s96
    v_mad_i32_i16 v40, v40, v10, s96 op_sel:[1,0,0,0]
    v_mad_i32_i16 v125, v41, v10, s96
    v_mad_i32_i16 v41, v41, v10, s96 op_sel:[1,0,0,0]
    v_lshlrev_b32_sdwa v10, 3, v10 dst_sel:DWORD dst_unused:UNUSED_PAD src0_sel:DWORD src1_sel:WORD_1
    v_perm_b32 v40, v40, v124, s97
    v_perm_b32 v41, v41, v125, s97
    v_lshl_add_u64 v[40:41], v[40:41], 0, s[30:31]

    ds_add_rtn_u64 v[40:41], v10, v[40:41] offset:50000
    v_mad_i32_i16 v126, v42, v11, s96
    v_mad_i32_i16 v42, v42, v11, s96 op_sel:[1,0,0,0]
    v_mad_i32_i16 v127, v43, v11, s96
    v_mad_i32_i16 v43, v43, v11, s96 op_sel:[1,0,0,0]
    v_lshlrev_b32_sdwa v11, 3, v11 dst_sel:DWORD dst_unused:UNUSED_PAD src0_sel:DWORD src1_sel:WORD_1
    v_perm_b32 v42, v42, v126, s97
    v_perm_b32 v43, v43, v127, s97
    v_lshl_add_u64 v[42:43], v[42:43], 0, s[30:31]

    ds_add_rtn_u64 v[42:43], v11, v[42:43] offset:50000
    s_waitcnt lgkmcnt(4)
    v_or3_b32 v1, v28, v29, v1
    v_or3_b32 v1, v30, v31, v1
    v_or3_b32 v1, v32, v33, v1
    v_or3_b32 v1, v34, v35, v1
    v_mad_i32_i16 v120, v44, v12, s96
    v_mad_i32_i16 v44, v44, v12, s96 op_sel:[1,0,0,0]
    v_mad_i32_i16 v121, v45, v12, s96
    v_mad_i32_i16 v45, v45, v12, s96 op_sel:[1,0,0,0]
    v_lshlrev_b32_sdwa v12, 3, v12 dst_sel:DWORD dst_unused:UNUSED_PAD src0_sel:DWORD src1_sel:WORD_1
    v_perm_b32 v44, v44, v120, s97
    v_perm_b32 v45, v45, v121, s97
    v_lshl_add_u64 v[44:45], v[44:45], 0, s[30:31]

    ds_add_rtn_u64 v[44:45], v12, v[44:45] offset:50000
    v_mad_i32_i16 v122, v46, v13, s96
    v_mad_i32_i16 v46, v46, v13, s96 op_sel:[1,0,0,0]
    v_mad_i32_i16 v123, v47, v13, s96
    v_mad_i32_i16 v47, v47, v13, s96 op_sel:[1,0,0,0]
    v_lshlrev_b32_sdwa v13, 3, v13 dst_sel:DWORD dst_unused:UNUSED_PAD src0_sel:DWORD src1_sel:WORD_1
    v_perm_b32 v46, v46, v122, s97
    v_perm_b32 v47, v47, v123, s97
    v_lshl_add_u64 v[46:47], v[46:47], 0, s[30:31]

    ds_add_rtn_u64 v[46:47], v13, v[46:47] offset:50000
    v_mad_i32_i16 v124, v48, v14, s96
    v_mad_i32_i16 v48, v48, v14, s96 op_sel:[1,0,0,0]
    v_mad_i32_i16 v125, v49, v14, s96
    v_mad_i32_i16 v49, v49, v14, s96 op_sel:[1,0,0,0]
    v_lshlrev_b32_sdwa v14, 3, v14 dst_sel:DWORD dst_unused:UNUSED_PAD src0_sel:DWORD src1_sel:WORD_1
    v_perm_b32 v48, v48, v124, s97
    v_perm_b32 v49, v49, v125, s97
    v_lshl_add_u64 v[48:49], v[48:49], 0, s[30:31]

    ds_add_rtn_u64 v[48:49], v14, v[48:49] offset:50000
    v_mad_i32_i16 v126, v50, v15, s96
    v_mad_i32_i16 v50, v50, v15, s96 op_sel:[1,0,0,0]
    v_mad_i32_i16 v127, v51, v15, s96
    v_mad_i32_i16 v51, v51, v15, s96 op_sel:[1,0,0,0]
    v_lshlrev_b32_sdwa v15, 3, v15 dst_sel:DWORD dst_unused:UNUSED_PAD src0_sel:DWORD src1_sel:WORD_1
    v_perm_b32 v50, v50, v126, s97
    v_perm_b32 v51, v51, v127, s97
    v_lshl_add_u64 v[50:51], v[50:51], 0, s[30:31]

    ds_add_rtn_u64 v[50:51], v15, v[50:51] offset:50000
    s_waitcnt lgkmcnt(4)
    v_or3_b32 v1, v36, v37, v1
    v_or3_b32 v1, v38, v39, v1
    v_or3_b32 v1, v40, v41, v1
    v_or3_b32 v1, v42, v43, v1
    v_mad_i32_i16 v120, v52, v16, s96
    v_mad_i32_i16 v52, v52, v16, s96 op_sel:[1,0,0,0]
    v_mad_i32_i16 v121, v53, v16, s96
    v_mad_i32_i16 v53, v53, v16, s96 op_sel:[1,0,0,0]
    v_lshlrev_b32_sdwa v16, 3, v16 dst_sel:DWORD dst_unused:UNUSED_PAD src0_sel:DWORD src1_sel:WORD_1
    v_perm_b32 v52, v52, v120, s97
    v_perm_b32 v53, v53, v121, s97
    v_lshl_add_u64 v[52:53], v[52:53], 0, s[30:31]

    ds_add_rtn_u64 v[52:53], v16, v[52:53] offset:50000
    v_mad_i32_i16 v122, v54, v17, s96
    v_mad_i32_i16 v54, v54, v17, s96 op_sel:[1,0,0,0]
    v_mad_i32_i16 v123, v55, v17, s96
    v_mad_i32_i16 v55, v55, v17, s96 op_sel:[1,0,0,0]
    v_lshlrev_b32_sdwa v17, 3, v17 dst_sel:DWORD dst_unused:UNUSED_PAD src0_sel:DWORD src1_sel:WORD_1
    v_perm_b32 v54, v54, v122, s97
    v_perm_b32 v55, v55, v123, s97
    v_lshl_add_u64 v[54:55], v[54:55], 0, s[30:31]

    ds_add_rtn_u64 v[54:55], v17, v[54:55] offset:50000
    v_mad_i32_i16 v124, v56, v18, s96
    v_mad_i32_i16 v56, v56, v18, s96 op_sel:[1,0,0,0]
    v_mad_i32_i16 v125, v57, v18, s96
    v_mad_i32_i16 v57, v57, v18, s96 op_sel:[1,0,0,0]
    v_lshlrev_b32_sdwa v18, 3, v18 dst_sel:DWORD dst_unused:UNUSED_PAD src0_sel:DWORD src1_sel:WORD_1
    v_perm_b32 v56, v56, v124, s97
    v_perm_b32 v57, v57, v125, s97
    v_lshl_add_u64 v[56:57], v[56:57], 0, s[30:31]

    ds_add_rtn_u64 v[56:57], v18, v[56:57] offset:50000
    v_mad_i32_i16 v126, v58, v19, s96
    v_mad_i32_i16 v58, v58, v19, s96 op_sel:[1,0,0,0]
    v_mad_i32_i16 v127, v59, v19, s96
    v_mad_i32_i16 v59, v59, v19, s96 op_sel:[1,0,0,0]
    v_lshlrev_b32_sdwa v19, 3, v19 dst_sel:DWORD dst_unused:UNUSED_PAD src0_sel:DWORD src1_sel:WORD_1
    v_perm_b32 v58, v58, v126, s97
    v_perm_b32 v59, v59, v127, s97
    v_lshl_add_u64 v[58:59], v[58:59], 0, s[30:31]

    ds_add_rtn_u64 v[58:59], v19, v[58:59] offset:50000
    s_waitcnt lgkmcnt(4)
    v_or3_b32 v1, v44, v45, v1
    v_or3_b32 v1, v46, v47, v1
    v_or3_b32 v1, v48, v49, v1
    v_or3_b32 v1, v50, v51, v1
    v_mad_i32_i16 v120, v60, v20, s96
    v_mad_i32_i16 v60, v60, v20, s96 op_sel:[1,0,0,0]
    v_mad_i32_i16 v121, v61, v20, s96
    v_mad_i32_i16 v61, v61, v20, s96 op_sel:[1,0,0,0]
    v_lshlrev_b32_sdwa v20, 3, v20 dst_sel:DWORD dst_unused:UNUSED_PAD src0_sel:DWORD src1_sel:WORD_1
    v_perm_b32 v60, v60, v120, s97
    v_perm_b32 v61, v61, v121, s97
    v_lshl_add_u64 v[60:61], v[60:61], 0, s[30:31]

    ds_add_rtn_u64 v[60:61], v20, v[60:61] offset:50000
    v_mad_i32_i16 v122, v62, v21, s96
    v_mad_i32_i16 v62, v62, v21, s96 op_sel:[1,0,0,0]
    v_mad_i32_i16 v123, v63, v21, s96
    v_mad_i32_i16 v63, v63, v21, s96 op_sel:[1,0,0,0]
    v_lshlrev_b32_sdwa v21, 3, v21 dst_sel:DWORD dst_unused:UNUSED_PAD src0_sel:DWORD src1_sel:WORD_1
    v_perm_b32 v62, v62, v122, s97
    v_perm_b32 v63, v63, v123, s97
    v_lshl_add_u64 v[62:63], v[62:63], 0, s[30:31]

    ds_add_rtn_u64 v[62:63], v21, v[62:63] offset:50000
    v_mad_i32_i16 v124, v64, v22, s96
    v_mad_i32_i16 v64, v64, v22, s96 op_sel:[1,0,0,0]
    v_mad_i32_i16 v125, v65, v22, s96
    v_mad_i32_i16 v65, v65, v22, s96 op_sel:[1,0,0,0]
    v_lshlrev_b32_sdwa v22, 3, v22 dst_sel:DWORD dst_unused:UNUSED_PAD src0_sel:DWORD src1_sel:WORD_1
    v_perm_b32 v64, v64, v124, s97
    v_perm_b32 v65, v65, v125, s97
    v_lshl_add_u64 v[64:65], v[64:65], 0, s[30:31]

    ds_add_rtn_u64 v[64:65], v22, v[64:65] offset:50000
    v_mad_i32_i16 v126, v66, v23, s96
    v_mad_i32_i16 v66, v66, v23, s96 op_sel:[1,0,0,0]
    v_mad_i32_i16 v127, v67, v23, s96
    v_mad_i32_i16 v67, v67, v23, s96 op_sel:[1,0,0,0]
    v_lshlrev_b32_sdwa v23, 3, v23 dst_sel:DWORD dst_unused:UNUSED_PAD src0_sel:DWORD src1_sel:WORD_1
    v_perm_b32 v66, v66, v126, s97
    v_perm_b32 v67, v67, v127, s97
    v_lshl_add_u64 v[66:67], v[66:67], 0, s[30:31]

    ds_add_rtn_u64 v[66:67], v23, v[66:67] offset:50000
    s_waitcnt lgkmcnt(4)
    v_or3_b32 v1, v52, v53, v1
    v_or3_b32 v1, v54, v55, v1
    v_or3_b32 v1, v56, v57, v1
    v_or3_b32 v1, v58, v59, v1
    v_mad_i32_i16 v120, v68, v24, s96
    v_mad_i32_i16 v68, v68, v24, s96 op_sel:[1,0,0,0]
    v_mad_i32_i16 v121, v69, v24, s96
    v_mad_i32_i16 v69, v69, v24, s96 op_sel:[1,0,0,0]
    v_lshlrev_b32_sdwa v24, 3, v24 dst_sel:DWORD dst_unused:UNUSED_PAD src0_sel:DWORD src1_sel:WORD_1
    v_perm_b32 v68, v68, v120, s97
    v_perm_b32 v69, v69, v121, s97
    v_lshl_add_u64 v[68:69], v[68:69], 0, s[30:31]

    ds_add_rtn_u64 v[68:69], v24, v[68:69] offset:50000
    v_mad_i32_i16 v122, v70, v25, s96
    v_mad_i32_i16 v70, v70, v25, s96 op_sel:[1,0,0,0]
    v_mad_i32_i16 v123, v71, v25, s96
    v_mad_i32_i16 v71, v71, v25, s96 op_sel:[1,0,0,0]
    v_lshlrev_b32_sdwa v25, 3, v25 dst_sel:DWORD dst_unused:UNUSED_PAD src0_sel:DWORD src1_sel:WORD_1
    v_perm_b32 v70, v70, v122, s97
    v_perm_b32 v71, v71, v123, s97
    v_lshl_add_u64 v[70:71], v[70:71], 0, s[30:31]

    ds_add_rtn_u64 v[70:71], v25, v[70:71] offset:50000
    v_mad_i32_i16 v124, v72, v26, s96
    v_mad_i32_i16 v72, v72, v26, s96 op_sel:[1,0,0,0]
    v_mad_i32_i16 v125, v73, v26, s96
    v_mad_i32_i16 v73, v73, v26, s96 op_sel:[1,0,0,0]
    v_lshlrev_b32_sdwa v26, 3, v26 dst_sel:DWORD dst_unused:UNUSED_PAD src0_sel:DWORD src1_sel:WORD_1
    v_perm_b32 v72, v72, v124, s97
    v_perm_b32 v73, v73, v125, s97
    v_lshl_add_u64 v[72:73], v[72:73], 0, s[30:31]

    ds_add_rtn_u64 v[72:73], v26, v[72:73] offset:50000
    v_mad_i32_i16 v126, v74, v27, s96
    v_mad_i32_i16 v74, v74, v27, s96 op_sel:[1,0,0,0]
    v_mad_i32_i16 v127, v75, v27, s96
    v_mad_i32_i16 v75, v75, v27, s96 op_sel:[1,0,0,0]
    v_lshlrev_b32_sdwa v27, 3, v27 dst_sel:DWORD dst_unused:UNUSED_PAD src0_sel:DWORD src1_sel:WORD_1
    v_perm_b32 v74, v74, v126, s97
    v_perm_b32 v75, v75, v127, s97
    v_lshl_add_u64 v[74:75], v[74:75], 0, s[30:31]

    ds_add_rtn_u64 v[74:75], v27, v[74:75] offset:50000
    s_waitcnt lgkmcnt(4)
    v_or3_b32 v1, v60, v61, v1
    v_or3_b32 v1, v62, v63, v1
    v_or3_b32 v1, v64, v65, v1
    v_or3_b32 v1, v66, v67, v1
    s_waitcnt lgkmcnt(0)
    v_or3_b32 v1, v68, v69, v1
    v_or3_b32 v1, v70, v71, v1
    v_or3_b32 v1, v72, v73, v1
    v_or3_b32 v1, v74, v75, v1
    s_waitcnt vmcnt(0)
    s_waitcnt lgkmcnt(0)
    s_load_dwordx4 s[28:31], s[86:87], 0
    s_load_dwordx16 s[68:83], s[88:89], 0
    s_load_dwordx8 s[12:19], s[92:93], 0
    s_load_dwordx8 s[56:63], s[94:95], 0
    s_mov_b64 s[48:49], s[90:91]
    s_load_dwordx16 s[84:99], s[48:49], 0

    s_mov_b32 s41, s37
    s_mul_i32 s3, s41, 3125
    s_add_u32 s5, s3, 3126
    s_add_u32 s3, s3, 1
    s_lshr_b32 s3, s3, 1
    s_lshr_b32 s5, s5, 1
    s_sub_u32 s5, s5, s3
    s_sub_u32 s5, s5, 782
    v_cmp_gt_u32 vcc, s5, v0
    s_mul_i32 s5, s36, 6250
    s_add_u32 s3, s3, s5
    v_add_u32 v6, s3, v0
    v_add_u32 v7, 782, v6
    v_mov_b32 v8, 0x2000000
    v_lshlrev_b32 v4, 4, v6
    v_cndmask_b32 v7, v8, v7, vcc
    v_lshlrev_b32 v6, 2, v6
    v_lshlrev_b32 v5, 4, v7
    v_lshlrev_b32 v7, 2, v7
    v_cmp_gt_u32 vcc, 782, v0
    s_mov_b64 exec, vcc
    s_cbranch_execz L_skld_88
    buffer_load_dword v6, v6, s[64:67], 0 offen
    buffer_load_dword v7, v7, s[64:67], 0 offen
    buffer_load_dwordx4 v[108:111], v4, s[8:11], 0 offen
    buffer_load_dwordx4 v[112:115], v5, s[8:11], 0 offen

L_skld_88:
    s_mov_b64 exec, -1
    s_barrier

    v_add_u32 v116, 50000, v3
    v_add_u32 v117, 115536, v3
    v_cmp_gt_u32 vcc, 106, v0

    v_mov_b32 v100, 0
    v_mov_b32 v101, 0
    v_mov_b32 v102, 0
    v_mov_b32 v103, 0
    ds_read_b128 v[76:79], v116 offset:0
    ds_read_b128 v[80:83], v116 offset:16384
    ds_read_b128 v[84:87], v116 offset:32768
    ds_read_b128 v[88:91], v116 offset:49152
    ds_read_b128 v[92:95], v117 offset:0
    ds_read_b128 v[96:99], v117 offset:16384
    s_mov_b64 exec, vcc
    ds_read_b128 v[100:103], v117 offset:32768
    s_mov_b64 exec, -1
    s_mul_i32 s3, s37, 6400000
    s_mul_i32 s5, s36, 100000
    s_add_u32 s3, s3, s5
    s_add_u32 s3, s3, 6799360

    s_add_u32 s20, s6, s3
    s_addc_u32 s21, s7, 0
    s_mov_b32 s22, 100000
    s_mov_b32 s23, 0x20000
    s_waitcnt lgkmcnt(6)
    s_mov_b32 s3, 0
    buffer_store_dwordx4 v[76:79], v3, s[20:23], s3 offen sc1
    s_waitcnt lgkmcnt(5)
    s_mov_b32 s3, 16384
    buffer_store_dwordx4 v[80:83], v3, s[20:23], s3 offen sc1
    s_waitcnt lgkmcnt(4)
    s_mov_b32 s3, 32768
    buffer_store_dwordx4 v[84:87], v3, s[20:23], s3 offen sc1
    s_waitcnt lgkmcnt(3)
    s_mov_b32 s3, 49152
    buffer_store_dwordx4 v[88:91], v3, s[20:23], s3 offen sc1
    s_waitcnt lgkmcnt(2)
    s_mov_b32 s3, 65536
    buffer_store_dwordx4 v[92:95], v3, s[20:23], s3 offen sc1
    s_waitcnt lgkmcnt(1)
    s_mov_b32 s3, 81920
    buffer_store_dwordx4 v[96:99], v3, s[20:23], s3 offen sc1
    s_waitcnt lgkmcnt(0)
    s_mov_b32 s3, 98304
    buffer_store_dwordx4 v[100:103], v3, s[20:23], s3 offen sc1
    v_or3_b32 v1, v76, v77, v1
    v_or3_b32 v1, v78, v79, v1
    v_or3_b32 v1, v80, v81, v1
    v_or3_b32 v1, v82, v83, v1
    v_or3_b32 v1, v84, v85, v1
    v_or3_b32 v1, v86, v87, v1
    v_or3_b32 v1, v88, v89, v1
    v_or3_b32 v1, v90, v91, v1
    v_or3_b32 v1, v92, v93, v1
    v_or3_b32 v1, v94, v95, v1
    v_or3_b32 v1, v96, v97, v1
    v_or3_b32 v1, v98, v99, v1
    v_or3_b32 v1, v100, v101, v1
    v_or3_b32 v1, v102, v103, v1
    v_and_b32 v1, 0x80008000, v1
    v_cmp_ne_u32 vcc, 0, v1
    v_mov_b32 v116, 150024
    v_mov_b32 v117, 1
    s_cbranch_vccz L_nf_85
    ds_write_b32 v116, v117
L_nf_85:
    s_mov_b32 s33, 1
    s_mov_b32 s42, 0
    v_cmp_gt_u32 vcc, 782, v0
    s_mov_b64 exec, vcc
    s_cbranch_execz L_p1end_90
    s_waitcnt vmcnt(9)
    s_branch L_lddone_87
L_fin_86:

    s_load_dwordx2 s[64:65], s[0:1], 24
    s_load_dwordx2 s[86:87], s[0:1], 40
    s_load_dwordx8 s[88:95], s[0:1], 56
    s_mov_b32 s66, 1600000
    s_mov_b32 s67, 0x20000

    s_waitcnt lgkmcnt(0)
    s_load_dwordx4 s[28:31], s[86:87], 0
    s_load_dwordx16 s[68:83], s[88:89], 0
    s_load_dwordx8 s[12:19], s[92:93], 0
    s_load_dwordx8 s[56:63], s[94:95], 0
    s_mov_b64 s[48:49], s[90:91]
    s_load_dwordx16 s[84:99], s[48:49], 0

    s_mov_b32 s42, 1
    s_mov_b32 s41, s37
L_qloop_89:
    s_mul_i32 s3, s41, 3125
    s_add_u32 s5, s3, 3126
    s_add_u32 s3, s3, 1
    s_lshr_b32 s3, s3, 1
    s_lshr_b32 s5, s5, 1
    s_sub_u32 s5, s5, s3
    s_sub_u32 s5, s5, 782
    v_cmp_gt_u32 vcc, s5, v0
    s_mul_i32 s5, s36, 6250
    s_add_u32 s3, s3, s5
    v_add_u32 v6, s3, v0
    v_add_u32 v7, 782, v6
    v_mov_b32 v8, 0x2000000
    v_lshlrev_b32 v4, 4, v6
    v_cndmask_b32 v7, v8, v7, vcc
    v_lshlrev_b32 v6, 2, v6
    v_lshlrev_b32 v5, 4, v7
    v_lshlrev_b32 v7, 2, v7
    v_cmp_gt_u32 vcc, 782, v0
    s_mov_b64 exec, vcc
    s_cbranch_execz L_p1end_90
    buffer_load_dword v6, v6, s[64:67], 0 offen
    buffer_load_dword v7, v7, s[64:67], 0 offen
    buffer_load_dwordx4 v[108:111], v4, s[8:11], 0 offen
    buffer_load_dwordx4 v[112:115], v5, s[8:11], 0 offen

    s_waitcnt vmcnt(2)
L_lddone_87:
    s_waitcnt lgkmcnt(0)
    v_lshlrev_b32 v8, 16, v6
    v_and_b32 v9, s32, v6
    v_lshlrev_b32 v10, 16, v7
    v_and_b32 v11, s32, v7

    s_lshl_b32 s52, s28, 16
    v_subrev_f32 v12, s52, v8
    v_subrev_f32 v20, s52, v9
    v_subrev_f32 v28, s52, v10
    v_subrev_f32 v36, s52, v11
    s_and_b32 s53, s28, s32
    v_subrev_f32 v13, s53, v8
    v_subrev_f32 v21, s53, v9
    v_subrev_f32 v29, s53, v10
    v_subrev_f32 v37, s53, v11
    s_lshl_b32 s52, s29, 16
    v_subrev_f32 v14, s52, v8
    v_subrev_f32 v22, s52, v9
    v_subrev_f32 v30, s52, v10
    v_subrev_f32 v38, s52, v11
    s_and_b32 s53, s29, s32
    v_subrev_f32 v15, s53, v8
    v_subrev_f32 v23, s53, v9
    v_subrev_f32 v31, s53, v10
    v_subrev_f32 v39, s53, v11
    s_lshl_b32 s52, s30, 16
    v_subrev_f32 v16, s52, v8
    v_subrev_f32 v24, s52, v9
    v_subrev_f32 v32, s52, v10
    v_subrev_f32 v40, s52, v11
    s_and_b32 s53, s30, s32
    v_subrev_f32 v17, s53, v8
    v_subrev_f32 v25, s53, v9
    v_subrev_f32 v33, s53, v10
    v_subrev_f32 v41, s53, v11
    s_lshl_b32 s52, s31, 16
    v_subrev_f32 v18, s52, v8
    v_subrev_f32 v26, s52, v9
    v_subrev_f32 v34, s52, v10
    v_subrev_f32 v42, s52, v11
    s_and_b32 s53, s31, s32
    v_subrev_f32 v19, s53, v8
    v_subrev_f32 v27, s53, v9
    v_subrev_f32 v35, s53, v10
    v_subrev_f32 v43, s53, v11
    v_cvt_pk_bf16_f32 v12, v12, v13
    v_cvt_pk_bf16_f32 v14, v14, v15
    v_cvt_pk_bf16_f32 v16, v16, v17
    v_cvt_pk_bf16_f32 v18, v18, v19
    v_cvt_pk_bf16_f32 v20, v20, v21
    v_cvt_pk_bf16_f32 v22, v22, v23
    v_cvt_pk_bf16_f32 v24, v24, v25
    v_cvt_pk_bf16_f32 v26, v26, v27
    v_cvt_pk_bf16_f32 v28, v28, v29
    v_cvt_pk_bf16_f32 v30, v30, v31
    v_cvt_pk_bf16_f32 v32, v32, v33
    v_cvt_pk_bf16_f32 v34, v34, v35
    v_cvt_pk_bf16_f32 v36, v36, v37
    v_cvt_pk_bf16_f32 v38, v38, v39
    v_cvt_pk_bf16_f32 v40, v40, v41
    v_cvt_pk_bf16_f32 v42, v42, v43
    v_and_b32 v13, s32, v12
    v_lshlrev_b32 v12, 16, v12
    v_and_b32 v15, s32, v14
    v_lshlrev_b32 v14, 16, v14
    v_and_b32 v17, s32, v16
    v_lshlrev_b32 v16, 16, v16
    v_and_b32 v19, s32, v18
    v_lshlrev_b32 v18, 16, v18
    v_and_b32 v21, s32, v20
    v_lshlrev_b32 v20, 16, v20
    v_and_b32 v23, s32, v22
    v_lshlrev_b32 v22, 16, v22
    v_and_b32 v25, s32, v24
    v_lshlrev_b32 v24, 16, v24
    v_and_b32 v27, s32, v26
    v_lshlrev_b32 v26, 16, v26
    v_and_b32 v29, s32, v28
    v_lshlrev_b32 v28, 16, v28
    v_and_b32 v31, s32, v30
    v_lshlrev_b32 v30, 16, v30
    v_and_b32 v33, s32, v32
    v_lshlrev_b32 v32, 16, v32
    v_and_b32 v35, s32, v34
    v_lshlrev_b32 v34, 16, v34
    v_and_b32 v37, s32, v36
    v_lshlrev_b32 v36, 16, v36
    v_and_b32 v39, s32, v38
    v_lshlrev_b32 v38, 16, v38
    v_and_b32 v41, s32, v40
    v_lshlrev_b32 v40, 16, v40
    v_and_b32 v43, s32, v42
    v_lshlrev_b32 v42, 16, v42
    v_mul_f32 v12, v12, v12
    v_mul_f32 v13, v13, v13
    v_mul_f32 v14, v14, v14
    v_mul_f32 v15, v15, v15
    v_mul_f32 v16, v16, v16
    v_mul_f32 v17, v17, v17
    v_mul_f32 v18, v18, v18
    v_mul_f32 v19, v19, v19
    v_mul_f32 v20, v20, v20
    v_mul_f32 v21, v21, v21
    v_mul_f32 v22, v22, v22
    v_mul_f32 v23, v23, v23
    v_mul_f32 v24, v24, v24
    v_mul_f32 v25, v25, v25
    v_mul_f32 v26, v26, v26
    v_mul_f32 v27, v27, v27
    v_mul_f32 v28, v28, v28
    v_mul_f32 v29, v29, v29
    v_mul_f32 v30, v30, v30
    v_mul_f32 v31, v31, v31
    v_mul_f32 v32, v32, v32
    v_mul_f32 v33, v33, v33
    v_mul_f32 v34, v34, v34
    v_mul_f32 v35, v35, v35
    v_mul_f32 v36, v36, v36
    v_mul_f32 v37, v37, v37
    v_mul_f32 v38, v38, v38
    v_mul_f32 v39, v39, v39
    v_mul_f32 v40, v40, v40
    v_mul_f32 v41, v41, v41
    v_mul_f32 v42, v42, v42
    v_mul_f32 v43, v43, v43
    v_cvt_pk_bf16_f32 v12, v12, v13
    v_cvt_pk_bf16_f32 v14, v14, v15
    v_cvt_pk_bf16_f32 v16, v16, v17
    v_cvt_pk_bf16_f32 v18, v18, v19
    v_cvt_pk_bf16_f32 v20, v20, v21
    v_cvt_pk_bf16_f32 v22, v22, v23
    v_cvt_pk_bf16_f32 v24, v24, v25
    v_cvt_pk_bf16_f32 v26, v26, v27
    v_cvt_pk_bf16_f32 v28, v28, v29
    v_cvt_pk_bf16_f32 v30, v30, v31
    v_cvt_pk_bf16_f32 v32, v32, v33
    v_cvt_pk_bf16_f32 v34, v34, v35
    v_cvt_pk_bf16_f32 v36, v36, v37
    v_cvt_pk_bf16_f32 v38, v38, v39
    v_cvt_pk_bf16_f32 v40, v40, v41
    v_cvt_pk_bf16_f32 v42, v42, v43
    v_and_b32 v13, s32, v12
    v_lshlrev_b32 v12, 16, v12
    v_and_b32 v15, s32, v14
    v_lshlrev_b32 v14, 16, v14
    v_and_b32 v17, s32, v16
    v_lshlrev_b32 v16, 16, v16
    v_and_b32 v19, s32, v18
    v_lshlrev_b32 v18, 16, v18
    v_and_b32 v21, s32, v20
    v_lshlrev_b32 v20, 16, v20
    v_and_b32 v23, s32, v22
    v_lshlrev_b32 v22, 16, v22
    v_and_b32 v25, s32, v24
    v_lshlrev_b32 v24, 16, v24
    v_and_b32 v27, s32, v26
    v_lshlrev_b32 v26, 16, v26
    v_and_b32 v29, s32, v28
    v_lshlrev_b32 v28, 16, v28
    v_and_b32 v31, s32, v30
    v_lshlrev_b32 v30, 16, v30
    v_and_b32 v33, s32, v32
    v_lshlrev_b32 v32, 16, v32
    v_and_b32 v35, s32, v34
    v_lshlrev_b32 v34, 16, v34
    v_and_b32 v37, s32, v36
    v_lshlrev_b32 v36, 16, v36
    v_and_b32 v39, s32, v38
    v_lshlrev_b32 v38, 16, v38
    v_and_b32 v41, s32, v40
    v_lshlrev_b32 v40, 16, v40
    v_and_b32 v43, s32, v42
    v_lshlrev_b32 v42, 16, v42
    v_mul_f32 v12, 0xc1200000, v12
    v_mul_f32 v13, 0xc1200000, v13
    v_mul_f32 v14, 0xc1200000, v14
    v_mul_f32 v15, 0xc1200000, v15
    v_mul_f32 v16, 0xc1200000, v16
    v_mul_f32 v17, 0xc1200000, v17
    v_mul_f32 v18, 0xc1200000, v18
    v_mul_f32 v19, 0xc1200000, v19
    v_mul_f32 v20, 0xc1200000, v20
    v_mul_f32 v21, 0xc1200000, v21
    v_mul_f32 v22, 0xc1200000, v22
    v_mul_f32 v23, 0xc1200000, v23
    v_mul_f32 v24, 0xc1200000, v24
    v_mul_f32 v25, 0xc1200000, v25
    v_mul_f32 v26, 0xc1200000, v26
    v_mul_f32 v27, 0xc1200000, v27
    v_mul_f32 v28, 0xc1200000, v28
    v_mul_f32 v29, 0xc1200000, v29
    v_mul_f32 v30, 0xc1200000, v30
    v_mul_f32 v31, 0xc1200000, v31
    v_mul_f32 v32, 0xc1200000, v32
    v_mul_f32 v33, 0xc1200000, v33
    v_mul_f32 v34, 0xc1200000, v34
    v_mul_f32 v35, 0xc1200000, v35
    v_mul_f32 v36, 0xc1200000, v36
    v_mul_f32 v37, 0xc1200000, v37
    v_mul_f32 v38, 0xc1200000, v38
    v_mul_f32 v39, 0xc1200000, v39
    v_mul_f32 v40, 0xc1200000, v40
    v_mul_f32 v41, 0xc1200000, v41
    v_mul_f32 v42, 0xc1200000, v42
    v_mul_f32 v43, 0xc1200000, v43
    v_cvt_pk_bf16_f32 v12, v12, v13
    v_cvt_pk_bf16_f32 v14, v14, v15
    v_cvt_pk_bf16_f32 v16, v16, v17
    v_cvt_pk_bf16_f32 v18, v18, v19
    v_cvt_pk_bf16_f32 v20, v20, v21
    v_cvt_pk_bf16_f32 v22, v22, v23
    v_cvt_pk_bf16_f32 v24, v24, v25
    v_cvt_pk_bf16_f32 v26, v26, v27
    v_cvt_pk_bf16_f32 v28, v28, v29
    v_cvt_pk_bf16_f32 v30, v30, v31
    v_cvt_pk_bf16_f32 v32, v32, v33
    v_cvt_pk_bf16_f32 v34, v34, v35
    v_cvt_pk_bf16_f32 v36, v36, v37
    v_cvt_pk_bf16_f32 v38, v38, v39
    v_cvt_pk_bf16_f32 v40, v40, v41
    v_cvt_pk_bf16_f32 v42, v42, v43
    v_and_b32 v13, s32, v12
    v_lshlrev_b32 v12, 16, v12
    v_and_b32 v15, s32, v14
    v_lshlrev_b32 v14, 16, v14
    v_and_b32 v17, s32, v16
    v_lshlrev_b32 v16, 16, v16
    v_and_b32 v19, s32, v18
    v_lshlrev_b32 v18, 16, v18
    v_and_b32 v21, s32, v20
    v_lshlrev_b32 v20, 16, v20
    v_and_b32 v23, s32, v22
    v_lshlrev_b32 v22, 16, v22
    v_and_b32 v25, s32, v24
    v_lshlrev_b32 v24, 16, v24
    v_and_b32 v27, s32, v26
    v_lshlrev_b32 v26, 16, v26
    v_and_b32 v29, s32, v28
    v_lshlrev_b32 v28, 16, v28
    v_and_b32 v31, s32, v30
    v_lshlrev_b32 v30, 16, v30
    v_and_b32 v33, s32, v32
    v_lshlrev_b32 v32, 16, v32
    v_and_b32 v35, s32, v34
    v_lshlrev_b32 v34, 16, v34
    v_and_b32 v37, s32, v36
    v_lshlrev_b32 v36, 16, v36
    v_and_b32 v39, s32, v38
    v_lshlrev_b32 v38, 16, v38
    v_and_b32 v41, s32, v40
    v_lshlrev_b32 v40, 16, v40
    v_and_b32 v43, s32, v42
    v_lshlrev_b32 v42, 16, v42
    v_mul_f32 v12, 0x3fb8aa3b, v12
    v_mul_f32 v13, 0x3fb8aa3b, v13
    v_mul_f32 v14, 0x3fb8aa3b, v14
    v_mul_f32 v15, 0x3fb8aa3b, v15
    v_mul_f32 v16, 0x3fb8aa3b, v16
    v_mul_f32 v17, 0x3fb8aa3b, v17
    v_mul_f32 v18, 0x3fb8aa3b, v18
    v_mul_f32 v19, 0x3fb8aa3b, v19
    v_mul_f32 v20, 0x3fb8aa3b, v20
    v_mul_f32 v21, 0x3fb8aa3b, v21
    v_mul_f32 v22, 0x3fb8aa3b, v22
    v_mul_f32 v23, 0x3fb8aa3b, v23
    v_mul_f32 v24, 0x3fb8aa3b, v24
    v_mul_f32 v25, 0x3fb8aa3b, v25
    v_mul_f32 v26, 0x3fb8aa3b, v26
    v_mul_f32 v27, 0x3fb8aa3b, v27
    v_mul_f32 v28, 0x3fb8aa3b, v28
    v_mul_f32 v29, 0x3fb8aa3b, v29
    v_mul_f32 v30, 0x3fb8aa3b, v30
    v_mul_f32 v31, 0x3fb8aa3b, v31
    v_mul_f32 v32, 0x3fb8aa3b, v32
    v_mul_f32 v33, 0x3fb8aa3b, v33
    v_mul_f32 v34, 0x3fb8aa3b, v34
    v_mul_f32 v35, 0x3fb8aa3b, v35
    v_mul_f32 v36, 0x3fb8aa3b, v36
    v_mul_f32 v37, 0x3fb8aa3b, v37
    v_mul_f32 v38, 0x3fb8aa3b, v38
    v_mul_f32 v39, 0x3fb8aa3b, v39
    v_mul_f32 v40, 0x3fb8aa3b, v40
    v_mul_f32 v41, 0x3fb8aa3b, v41
    v_mul_f32 v42, 0x3fb8aa3b, v42
    v_mul_f32 v43, 0x3fb8aa3b, v43
    v_exp_f32 v12, v12
    v_exp_f32 v13, v13
    v_exp_f32 v14, v14
    v_exp_f32 v15, v15
    v_exp_f32 v16, v16
    v_exp_f32 v17, v17
    v_exp_f32 v18, v18
    v_exp_f32 v19, v19
    v_exp_f32 v20, v20
    v_exp_f32 v21, v21
    v_exp_f32 v22, v22
    v_exp_f32 v23, v23
    v_exp_f32 v24, v24
    v_exp_f32 v25, v25
    v_exp_f32 v26, v26
    v_exp_f32 v27, v27
    v_exp_f32 v28, v28
    v_exp_f32 v29, v29
    v_exp_f32 v30, v30
    v_exp_f32 v31, v31
    v_exp_f32 v32, v32
    v_exp_f32 v33, v33
    v_exp_f32 v34, v34
    v_exp_f32 v35, v35
    v_exp_f32 v36, v36
    v_exp_f32 v37, v37
    v_exp_f32 v38, v38
    v_exp_f32 v39, v39
    v_exp_f32 v40, v40
    v_exp_f32 v41, v41
    v_exp_f32 v42, v42
    v_exp_f32 v43, v43
    s_nop 0
    v_cvt_pk_bf16_f32 v12, v12, v13
    v_cvt_pk_bf16_f32 v14, v14, v15
    v_cvt_pk_bf16_f32 v16, v16, v17
    v_cvt_pk_bf16_f32 v18, v18, v19
    v_cvt_pk_bf16_f32 v20, v20, v21
    v_cvt_pk_bf16_f32 v22, v22, v23
    v_cvt_pk_bf16_f32 v24, v24, v25
    v_cvt_pk_bf16_f32 v26, v26, v27
    v_cvt_pk_bf16_f32 v28, v28, v29
    v_cvt_pk_bf16_f32 v30, v30, v31
    v_cvt_pk_bf16_f32 v32, v32, v33
    v_cvt_pk_bf16_f32 v34, v34, v35
    v_cvt_pk_bf16_f32 v36, v36, v37
    v_cvt_pk_bf16_f32 v38, v38, v39
    v_cvt_pk_bf16_f32 v40, v40, v41
    v_cvt_pk_bf16_f32 v42, v42, v43
L_p1end_90:
    s_mov_b64 exec, -1
    s_cmp_eq_u32 s42, 2
    s_cbranch_scc1 L_part2_91
    s_waitcnt vmcnt(0) lgkmcnt(0)
    s_barrier
    s_cmp_lg_u32 s42, 0
    s_cbranch_scc1 L_nochk_97
    v_mov_b32 v116, 150024
    ds_read_b32 v117, v116
    s_waitcnt lgkmcnt(0)
    v_readfirstlane_b32 s3, v117
    s_nop 1
    s_cmp_lg_u32 s3, 0
    s_cbranch_scc1 L_p2slow_51
L_nochk_97:

    s_load_dwordx2 s[24:25], s[0:1], 88
    s_load_dwordx2 s[44:45], s[0:1], 96
    s_mov_b32 s26, 6400000
    s_mov_b32 s27, 0x20000
    s_movk_i32 s46, 256
    s_mov_b32 s47, 0x20000
    s_lshl_b32 s50, s36, 2
    v_and_b32 v116, 63, v0
    v_lshlrev_b32 v116, 20, v116

    s_add_u32 s20, s6, 6799360
    s_addc_u32 s21, s7, 0
    s_mov_b32 s22, 76800000
    s_mov_b32 s23, 0x20000
    v_readfirstlane_b32 s3, v0
    s_waitcnt lgkmcnt(0)
    s_cmp_eq_u32 s3, 960
    s_cbranch_scc1 L_sync_98
L_part2_91:
    v_cmp_gt_u32 vcc, 782, v0
    s_mov_b64 exec, vcc
    s_cbranch_execz L_p2end_92

    s_pack_ll_b32_b16 s52, s68, s70
    v_dot2_f32_bf16 v60, v12, s52, 0
    v_dot2_f32_bf16 v64, v20, s52, 0
    v_dot2_f32_bf16 v68, v28, s52, 0
    v_dot2_f32_bf16 v72, v36, s52, 0
    s_pack_hh_b32_b16 s53, s68, s70
    v_dot2_f32_bf16 v61, v12, s53, 0
    v_dot2_f32_bf16 v65, v20, s53, 0
    v_dot2_f32_bf16 v69, v28, s53, 0
    v_dot2_f32_bf16 v73, v36, s53, 0
    s_pack_ll_b32_b16 s52, s69, s71
    v_dot2_f32_bf16 v62, v12, s52, 0
    v_dot2_f32_bf16 v66, v20, s52, 0
    v_dot2_f32_bf16 v70, v28, s52, 0
    v_dot2_f32_bf16 v74, v36, s52, 0
    s_pack_hh_b32_b16 s53, s69, s71
    v_dot2_f32_bf16 v63, v12, s53, 0
    v_dot2_f32_bf16 v67, v20, s53, 0
    v_dot2_f32_bf16 v71, v28, s53, 0
    v_dot2_f32_bf16 v75, v36, s53, 0
    s_pack_ll_b32_b16 s52, s72, s74
    v_dot2_f32_bf16 v60, v14, s52, v60
    v_dot2_f32_bf16 v64, v22, s52, v64
    v_dot2_f32_bf16 v68, v30, s52, v68
    v_dot2_f32_bf16 v72, v38, s52, v72
    s_pack_hh_b32_b16 s53, s72, s74
    v_dot2_f32_bf16 v61, v14, s53, v61
    v_dot2_f32_bf16 v65, v22, s53, v65
    v_dot2_f32_bf16 v69, v30, s53, v69
    v_dot2_f32_bf16 v73, v38, s53, v73
    s_pack_ll_b32_b16 s52, s73, s75
    v_dot2_f32_bf16 v62, v14, s52, v62
    v_dot2_f32_bf16 v66, v22, s52, v66
    v_dot2_f32_bf16 v70, v30, s52, v70
    v_dot2_f32_bf16 v74, v38, s52, v74
    s_pack_hh_b32_b16 s53, s73, s75
    v_dot2_f32_bf16 v63, v14, s53, v63
    v_dot2_f32_bf16 v67, v22, s53, v67
    v_dot2_f32_bf16 v71, v30, s53, v71
    v_dot2_f32_bf16 v75, v38, s53, v75
    s_pack_ll_b32_b16 s52, s76, s78
    v_dot2_f32_bf16 v60, v16, s52, v60
    v_dot2_f32_bf16 v64, v24, s52, v64
    v_dot2_f32_bf16 v68, v32, s52, v68
    v_dot2_f32_bf16 v72, v40, s52, v72
    s_pack_hh_b32_b16 s53, s76, s78
    v_dot2_f32_bf16 v61, v16, s53, v61
    v_dot2_f32_bf16 v65, v24, s53, v65
    v_dot2_f32_bf16 v69, v32, s53, v69
    v_dot2_f32_bf16 v73, v40, s53, v73
    s_pack_ll_b32_b16 s52, s77, s79
    v_dot2_f32_bf16 v62, v16, s52, v62
    v_dot2_f32_bf16 v66, v24, s52, v66
    v_dot2_f32_bf16 v70, v32, s52, v70
    v_dot2_f32_bf16 v74, v40, s52, v74
    s_pack_hh_b32_b16 s53, s77, s79
    v_dot2_f32_bf16 v63, v16, s53, v63
    v_dot2_f32_bf16 v67, v24, s53, v67
    v_dot2_f32_bf16 v71, v32, s53, v71
    v_dot2_f32_bf16 v75, v40, s53, v75
    s_pack_ll_b32_b16 s52, s80, s82
    v_dot2_f32_bf16 v60, v18, s52, v60
    v_dot2_f32_bf16 v64, v26, s52, v64
    v_dot2_f32_bf16 v68, v34, s52, v68
    v_dot2_f32_bf16 v72, v42, s52, v72
    s_pack_hh_b32_b16 s53, s80, s82
    v_dot2_f32_bf16 v61, v18, s53, v61
    v_dot2_f32_bf16 v65, v26, s53, v65
    v_dot2_f32_bf16 v69, v34, s53, v69
    v_dot2_f32_bf16 v73, v42, s53, v73
    s_pack_ll_b32_b16 s52, s81, s83
    v_dot2_f32_bf16 v62, v18, s52, v62
    v_dot2_f32_bf16 v66, v26, s52, v66
    v_dot2_f32_bf16 v70, v34, s52, v70
    v_dot2_f32_bf16 v74, v42, s52, v74
    s_pack_hh_b32_b16 s53, s81, s83
    v_dot2_f32_bf16 v63, v18, s53, v63
    v_dot2_f32_bf16 v67, v26, s53, v67
    v_dot2_f32_bf16 v71, v34, s53, v71
    v_dot2_f32_bf16 v75, v42, s53, v75
    s_pack_ll_b32_b16 s52, s84, s86
    v_dot2_f32_bf16 v44, v12, s52, 0
    v_dot2_f32_bf16 v48, v20, s52, 0
    v_dot2_f32_bf16 v52, v28, s52, 0
    v_dot2_f32_bf16 v56, v36, s52, 0
    s_pack_hh_b32_b16 s53, s84, s86
    v_dot2_f32_bf16 v45, v12, s53, 0
    v_dot2_f32_bf16 v49, v20, s53, 0
    v_dot2_f32_bf16 v53, v28, s53, 0
    v_dot2_f32_bf16 v57, v36, s53, 0
    s_pack_ll_b32_b16 s52, s85, s87
    v_dot2_f32_bf16 v46, v12, s52, 0
    v_dot2_f32_bf16 v50, v20, s52, 0
    v_dot2_f32_bf16 v54, v28, s52, 0
    v_dot2_f32_bf16 v58, v36, s52, 0
    s_pack_hh_b32_b16 s53, s85, s87
    v_dot2_f32_bf16 v47, v12, s53, 0
    v_dot2_f32_bf16 v51, v20, s53, 0
    v_dot2_f32_bf16 v55, v28, s53, 0
    v_dot2_f32_bf16 v59, v36, s53, 0
    s_pack_ll_b32_b16 s52, s88, s90
    v_dot2_f32_bf16 v44, v14, s52, v44
    v_dot2_f32_bf16 v48, v22, s52, v48
    v_dot2_f32_bf16 v52, v30, s52, v52
    v_dot2_f32_bf16 v56, v38, s52, v56
    s_pack_hh_b32_b16 s53, s88, s90
    v_dot2_f32_bf16 v45, v14, s53, v45
    v_dot2_f32_bf16 v49, v22, s53, v49
    v_dot2_f32_bf16 v53, v30, s53, v53
    v_dot2_f32_bf16 v57, v38, s53, v57
    s_pack_ll_b32_b16 s52, s89, s91
    v_dot2_f32_bf16 v46, v14, s52, v46
    v_dot2_f32_bf16 v50, v22, s52, v50
    v_dot2_f32_bf16 v54, v30, s52, v54
    v_dot2_f32_bf16 v58, v38, s52, v58
    s_pack_hh_b32_b16 s53, s89, s91
    v_dot2_f32_bf16 v47, v14, s53, v47
    v_dot2_f32_bf16 v51, v22, s53, v51
    v_dot2_f32_bf16 v55, v30, s53, v55
    v_dot2_f32_bf16 v59, v38, s53, v59
    s_pack_ll_b32_b16 s52, s92, s94
    v_dot2_f32_bf16 v44, v16, s52, v44
    v_dot2_f32_bf16 v48, v24, s52, v48
    v_dot2_f32_bf16 v52, v32, s52, v52
    v_dot2_f32_bf16 v56, v40, s52, v56
    s_pack_hh_b32_b16 s53, s92, s94
    v_dot2_f32_bf16 v45, v16, s53, v45
    v_dot2_f32_bf16 v49, v24, s53, v49
    v_dot2_f32_bf16 v53, v32, s53, v53
    v_dot2_f32_bf16 v57, v40, s53, v57
    s_pack_ll_b32_b16 s52, s93, s95
    v_dot2_f32_bf16 v46, v16, s52, v46
    v_dot2_f32_bf16 v50, v24, s52, v50
    v_dot2_f32_bf16 v54, v32, s52, v54
    v_dot2_f32_bf16 v58, v40, s52, v58
    s_pack_hh_b32_b16 s53, s93, s95
    v_dot2_f32_bf16 v47, v16, s53, v47
    v_dot2_f32_bf16 v51, v24, s53, v51
    v_dot2_f32_bf16 v55, v32, s53, v55
    v_dot2_f32_bf16 v59, v40, s53, v59
    s_pack_ll_b32_b16 s52, s96, s98
    v_dot2_f32_bf16 v44, v18, s52, v44
    v_dot2_f32_bf16 v48, v26, s52, v48
    v_dot2_f32_bf16 v52, v34, s52, v52
    v_dot2_f32_bf16 v56, v42, s52, v56
    s_pack_hh_b32_b16 s53, s96, s98
    v_dot2_f32_bf16 v45, v18, s53, v45
    v_dot2_f32_bf16 v49, v26, s53, v49
    v_dot2_f32_bf16 v53, v34, s53, v53
    v_dot2_f32_bf16 v57, v42, s53, v57
    s_pack_ll_b32_b16 s52, s97, s99
    v_dot2_f32_bf16 v46, v18, s52, v46
    v_dot2_f32_bf16 v50, v26, s52, v50
    v_dot2_f32_bf16 v54, v34, s52, v54
    v_dot2_f32_bf16 v58, v42, s52, v58
    s_pack_hh_b32_b16 s53, s97, s99
    v_dot2_f32_bf16 v47, v18, s53, v47
    v_dot2_f32_bf16 v51, v26, s53, v51
    v_dot2_f32_bf16 v55, v34, s53, v55
    v_dot2_f32_bf16 v59, v42, s53, v59
    v_cvt_pk_bf16_f32 v60, v60, v61
    v_cvt_pk_bf16_f32 v62, v62, v63
    v_cvt_pk_bf16_f32 v64, v64, v65
    v_cvt_pk_bf16_f32 v66, v66, v67
    v_cvt_pk_bf16_f32 v68, v68, v69
    v_cvt_pk_bf16_f32 v70, v70, v71
    v_cvt_pk_bf16_f32 v72, v72, v73
    v_cvt_pk_bf16_f32 v74, v74, v75
    v_and_b32 v61, s32, v60
    v_lshlrev_b32 v60, 16, v60
    v_and_b32 v63, s32, v62
    v_lshlrev_b32 v62, 16, v62
    v_and_b32 v65, s32, v64
    v_lshlrev_b32 v64, 16, v64
    v_and_b32 v67, s32, v66
    v_lshlrev_b32 v66, 16, v66
    v_and_b32 v69, s32, v68
    v_lshlrev_b32 v68, 16, v68
    v_and_b32 v71, s32, v70
    v_lshlrev_b32 v70, 16, v70
    v_and_b32 v73, s32, v72
    v_lshlrev_b32 v72, 16, v72
    v_and_b32 v75, s32, v74
    v_lshlrev_b32 v74, 16, v74
L_p2end_92:
    s_mov_b64 exec, -1
    s_cmp_eq_u32 s42, 2
    s_cbranch_scc1 L_post_95
L_bcast_93:
    v_mov_b32 v118, 150016
    s_mov_b32 s42, 2
    s_waitcnt lgkmcnt(0)
    s_barrier
    ds_read_b32 v117, v118
    s_waitcnt lgkmcnt(0)
    v_readfirstlane_b32 s35, v117
    s_nop 1
    s_bitcmp1_b32 s35, 16
    s_cbranch_scc1 L_nextq_94
L_post_95:
    v_cmp_gt_u32 vcc, 782, v0
    s_mov_b64 exec, vcc
    s_cbranch_execz L_postend_96

    s_mov_b32 s3, 0
    buffer_load_dwordx4 v[76:79], v4, s[20:23], s3 offen sc1
    buffer_load_dwordx4 v[92:95], v5, s[20:23], s3 offen sc1
    s_mov_b32 s3, 6400000
    buffer_load_dwordx4 v[80:83], v4, s[20:23], s3 offen sc1
    buffer_load_dwordx4 v[96:99], v5, s[20:23], s3 offen sc1
    s_mov_b32 s3, 12800000
    buffer_load_dwordx4 v[84:87], v4, s[20:23], s3 offen sc1
    buffer_load_dwordx4 v[100:103], v5, s[20:23], s3 offen sc1
    s_mov_b32 s3, 19200000
    buffer_load_dwordx4 v[88:91], v4, s[20:23], s3 offen sc1
    buffer_load_dwordx4 v[104:107], v5, s[20:23], s3 offen sc1
    s_and_b32 s3, s35, 0xf0
    s_cbranch_scc1 L_fgen_102
    s_waitcnt vmcnt(0)

    v_add_u32 v76, v76, v80
    v_add_u32 v84, v84, v88
    v_add_u32 v77, v77, v81
    v_add_u32 v85, v85, v89
    v_add_u32 v78, v78, v82
    v_add_u32 v86, v86, v90
    v_add_u32 v79, v79, v83
    v_add_u32 v87, v87, v91
    v_add_u32_sdwa v12, v76, v84 dst_sel:DWORD dst_unused:UNUSED_PAD src0_sel:WORD_0 src1_sel:WORD_0
    v_add_u32_sdwa v13, v76, v84 dst_sel:DWORD dst_unused:UNUSED_PAD src0_sel:WORD_1 src1_sel:WORD_1
    v_add_u32_sdwa v14, v77, v85 dst_sel:DWORD dst_unused:UNUSED_PAD src0_sel:WORD_0 src1_sel:WORD_0
    v_add_u32_sdwa v15, v77, v85 dst_sel:DWORD dst_unused:UNUSED_PAD src0_sel:WORD_1 src1_sel:WORD_1
    v_add_u32_sdwa v16, v78, v86 dst_sel:DWORD dst_unused:UNUSED_PAD src0_sel:WORD_0 src1_sel:WORD_0
    v_add_u32_sdwa v17, v78, v86 dst_sel:DWORD dst_unused:UNUSED_PAD src0_sel:WORD_1 src1_sel:WORD_1
    v_add_u32_sdwa v18, v79, v87 dst_sel:DWORD dst_unused:UNUSED_PAD src0_sel:WORD_0 src1_sel:WORD_0
    v_add_u32_sdwa v19, v79, v87 dst_sel:DWORD dst_unused:UNUSED_PAD src0_sel:WORD_1 src1_sel:WORD_1
    v_add_u32 v92, v92, v96
    v_add_u32 v100, v100, v104
    v_add_u32 v93, v93, v97
    v_add_u32 v101, v101, v105
    v_add_u32 v94, v94, v98
    v_add_u32 v102, v102, v106
    v_add_u32 v95, v95, v99
    v_add_u32 v103, v103, v107
    v_add_u32_sdwa v20, v92, v100 dst_sel:DWORD dst_unused:UNUSED_PAD src0_sel:WORD_0 src1_sel:WORD_0
    v_add_u32_sdwa v21, v92, v100 dst_sel:DWORD dst_unused:UNUSED_PAD src0_sel:WORD_1 src1_sel:WORD_1
    v_add_u32_sdwa v22, v93, v101 dst_sel:DWORD dst_unused:UNUSED_PAD src0_sel:WORD_0 src1_sel:WORD_0
    v_add_u32_sdwa v23, v93, v101 dst_sel:DWORD dst_unused:UNUSED_PAD src0_sel:WORD_1 src1_sel:WORD_1
    v_add_u32_sdwa v24, v94, v102 dst_sel:DWORD dst_unused:UNUSED_PAD src0_sel:WORD_0 src1_sel:WORD_0
    v_add_u32_sdwa v25, v94, v102 dst_sel:DWORD dst_unused:UNUSED_PAD src0_sel:WORD_1 src1_sel:WORD_1
    v_add_u32_sdwa v26, v95, v103 dst_sel:DWORD dst_unused:UNUSED_PAD src0_sel:WORD_0 src1_sel:WORD_0
    v_add_u32_sdwa v27, v95, v103 dst_sel:DWORD dst_unused:UNUSED_PAD src0_sel:WORD_1 src1_sel:WORD_1
    v_add_u32 v12, 0xffff0000, v12
    v_add_u32 v13, 0xffff0000, v13
    v_add_u32 v14, 0xffff0000, v14
    v_add_u32 v15, 0xffff0000, v15
    v_add_u32 v16, 0xffff0000, v16
    v_add_u32 v17, 0xffff0000, v17
    v_add_u32 v18, 0xffff0000, v18
    v_add_u32 v19, 0xffff0000, v19
    v_add_u32 v20, 0xffff0000, v20
    v_add_u32 v21, 0xffff0000, v21
    v_add_u32 v22, 0xffff0000, v22
    v_add_u32 v23, 0xffff0000, v23
    v_add_u32 v24, 0xffff0000, v24
    v_add_u32 v25, 0xffff0000, v25
    v_add_u32 v26, 0xffff0000, v26
    v_add_u32 v27, 0xffff0000, v27
    v_cvt_f32_i32 v12, v12
    v_cvt_f32_i32 v13, v13
    v_cvt_f32_i32 v14, v14
    v_cvt_f32_i32 v15, v15
    v_cvt_f32_i32 v16, v16
    v_cvt_f32_i32 v17, v17
    v_cvt_f32_i32 v18, v18
    v_cvt_f32_i32 v19, v19
    v_cvt_f32_i32 v20, v20
    v_cvt_f32_i32 v21, v21
    v_cvt_f32_i32 v22, v22
    v_cvt_f32_i32 v23, v23
    v_cvt_f32_i32 v24, v24
    v_cvt_f32_i32 v25, v25
    v_cvt_f32_i32 v26, v26
    v_cvt_f32_i32 v27, v27
    v_mul_f32 v12, s34, v12
    v_mul_f32 v13, s34, v13
    v_mul_f32 v14, s34, v14
    v_mul_f32 v15, s34, v15
    v_mul_f32 v16, s34, v16
    v_mul_f32 v17, s34, v17
    v_mul_f32 v18, s34, v18
    v_mul_f32 v19, s34, v19
    v_mul_f32 v20, s34, v20
    v_mul_f32 v21, s34, v21
    v_mul_f32 v22, s34, v22
    v_mul_f32 v23, s34, v23
    v_mul_f32 v24, s34, v24
    v_mul_f32 v25, s34, v25
    v_mul_f32 v26, s34, v26
    v_mul_f32 v27, s34, v27
L_fbk_103:
    s_lshl_b32 s52, s12, 16
    v_mul_f32 v28, s52, v12
    v_mul_f32 v32, s52, v16
    v_mul_f32 v36, s52, v20
    v_mul_f32 v40, s52, v24
    s_and_b32 s53, s12, s32
    v_mul_f32 v29, s53, v12
    v_mul_f32 v33, s53, v16
    v_mul_f32 v37, s53, v20
    v_mul_f32 v41, s53, v24
    s_lshl_b32 s52, s13, 16
    v_mul_f32 v30, s52, v12
    v_mul_f32 v34, s52, v16
    v_mul_f32 v38, s52, v20
    v_mul_f32 v42, s52, v24
    s_and_b32 s53, s13, s32
    v_mul_f32 v31, s53, v12
    v_mul_f32 v35, s53, v16
    v_mul_f32 v39, s53, v20
    v_mul_f32 v43, s53, v24
    s_lshl_b32 s52, s14, 16
    v_fmac_f32 v28, s52, v13
    v_fmac_f32 v32, s52, v17
    v_fmac_f32 v36, s52, v21
    v_fmac_f32 v40, s52, v25
    s_and_b32 s53, s14, s32
    v_fmac_f32 v29, s53, v13
    v_fmac_f32 v33, s53, v17
    v_fmac_f32 v37, s53, v21
    v_fmac_f32 v41, s53, v25
    s_lshl_b32 s52, s15, 16
    v_fmac_f32 v30, s52, v13
    v_fmac_f32 v34, s52, v17
    v_fmac_f32 v38, s52, v21
    v_fmac_f32 v42, s52, v25
    s_and_b32 s53, s15, s32
    v_fmac_f32 v31, s53, v13
    v_fmac_f32 v35, s53, v17
    v_fmac_f32 v39, s53, v21
    v_fmac_f32 v43, s53, v25
    s_lshl_b32 s52, s16, 16
    v_fmac_f32 v28, s52, v14
    v_fmac_f32 v32, s52, v18
    v_fmac_f32 v36, s52, v22
    v_fmac_f32 v40, s52, v26
    s_and_b32 s53, s16, s32
    v_fmac_f32 v29, s53, v14
    v_fmac_f32 v33, s53, v18
    v_fmac_f32 v37, s53, v22
    v_fmac_f32 v41, s53, v26
    s_lshl_b32 s52, s17, 16
    v_fmac_f32 v30, s52, v14
    v_fmac_f32 v34, s52, v18
    v_fmac_f32 v38, s52, v22
    v_fmac_f32 v42, s52, v26
    s_and_b32 s53, s17, s32
    v_fmac_f32 v31, s53, v14
    v_fmac_f32 v35, s53, v18
    v_fmac_f32 v39, s53, v22
    v_fmac_f32 v43, s53, v26
    s_lshl_b32 s52, s18, 16
    v_fmac_f32 v28, s52, v15
    v_fmac_f32 v32, s52, v19
    v_fmac_f32 v36, s52, v23
    v_fmac_f32 v40, s52, v27
    s_and_b32 s53, s18, s32
    v_fmac_f32 v29, s53, v15
    v_fmac_f32 v33, s53, v19
    v_fmac_f32 v37, s53, v23
    v_fmac_f32 v41, s53, v27
    s_lshl_b32 s52, s19, 16
    v_fmac_f32 v30, s52, v15
    v_fmac_f32 v34, s52, v19
    v_fmac_f32 v38, s52, v23
    v_fmac_f32 v42, s52, v27
    s_and_b32 s53, s19, s32
    v_fmac_f32 v31, s53, v15
    v_fmac_f32 v35, s53, v19
    v_fmac_f32 v39, s53, v23
    v_fmac_f32 v43, s53, v27
    v_mul_f32 v28, v28, v44
    v_mul_f32 v29, v29, v45
    v_mul_f32 v30, v30, v46
    v_mul_f32 v31, v31, v47
    v_mul_f32 v32, v32, v48
    v_mul_f32 v33, v33, v49
    v_mul_f32 v34, v34, v50
    v_mul_f32 v35, v35, v51
    v_mul_f32 v36, v36, v52
    v_mul_f32 v37, v37, v53
    v_mul_f32 v38, v38, v54
    v_mul_f32 v39, v39, v55
    v_mul_f32 v40, v40, v56
    v_mul_f32 v41, v41, v57
    v_mul_f32 v42, v42, v58
    v_mul_f32 v43, v43, v59
    v_cvt_pk_bf16_f32 v28, v28, v29
    v_cvt_pk_bf16_f32 v30, v30, v31
    v_cvt_pk_bf16_f32 v32, v32, v33
    v_cvt_pk_bf16_f32 v34, v34, v35
    v_cvt_pk_bf16_f32 v36, v36, v37
    v_cvt_pk_bf16_f32 v38, v38, v39
    v_cvt_pk_bf16_f32 v40, v40, v41
    v_cvt_pk_bf16_f32 v42, v42, v43
    s_pack_ll_b32_b16 s52, s56, s58
    v_dot2_f32_bf16 v12, v28, s52, 0
    v_dot2_f32_bf16 v16, v32, s52, 0
    v_dot2_f32_bf16 v20, v36, s52, 0
    v_dot2_f32_bf16 v24, v40, s52, 0
    s_pack_hh_b32_b16 s53, s56, s58
    v_dot2_f32_bf16 v13, v28, s53, 0
    v_dot2_f32_bf16 v17, v32, s53, 0
    v_dot2_f32_bf16 v21, v36, s53, 0
    v_dot2_f32_bf16 v25, v40, s53, 0
    s_pack_ll_b32_b16 s52, s57, s59
    v_dot2_f32_bf16 v14, v28, s52, 0
    v_dot2_f32_bf16 v18, v32, s52, 0
    v_dot2_f32_bf16 v22, v36, s52, 0
    v_dot2_f32_bf16 v26, v40, s52, 0
    s_pack_hh_b32_b16 s53, s57, s59
    v_dot2_f32_bf16 v15, v28, s53, 0
    v_dot2_f32_bf16 v19, v32, s53, 0
    v_dot2_f32_bf16 v23, v36, s53, 0
    v_dot2_f32_bf16 v27, v40, s53, 0
    s_pack_ll_b32_b16 s52, s60, s62
    v_dot2_f32_bf16 v12, v30, s52, v12
    v_dot2_f32_bf16 v16, v34, s52, v16
    v_dot2_f32_bf16 v20, v38, s52, v20
    v_dot2_f32_bf16 v24, v42, s52, v24
    s_pack_hh_b32_b16 s53, s60, s62
    v_dot2_f32_bf16 v13, v30, s53, v13
    v_dot2_f32_bf16 v17, v34, s53, v17
    v_dot2_f32_bf16 v21, v38, s53, v21
    v_dot2_f32_bf16 v25, v42, s53, v25
    s_pack_ll_b32_b16 s52, s61, s63
    v_dot2_f32_bf16 v14, v30, s52, v14
    v_dot2_f32_bf16 v18, v34, s52, v18
    v_dot2_f32_bf16 v22, v38, s52, v22
    v_dot2_f32_bf16 v26, v42, s52, v26
    s_pack_hh_b32_b16 s53, s61, s63
    v_dot2_f32_bf16 v15, v30, s53, v15
    v_dot2_f32_bf16 v19, v34, s53, v19
    v_dot2_f32_bf16 v23, v38, s53, v23
    v_dot2_f32_bf16 v27, v42, s53, v27
    v_lshlrev_b32 v44, 16, v108
    v_and_b32 v45, s32, v108
    v_lshlrev_b32 v46, 16, v109
    v_and_b32 v47, s32, v109
    v_lshlrev_b32 v48, 16, v110
    v_and_b32 v49, s32, v110
    v_lshlrev_b32 v50, 16, v111
    v_and_b32 v51, s32, v111
    v_lshlrev_b32 v52, 16, v112
    v_and_b32 v53, s32, v112
    v_lshlrev_b32 v54, 16, v113
    v_and_b32 v55, s32, v113
    v_lshlrev_b32 v56, 16, v114
    v_and_b32 v57, s32, v114
    v_lshlrev_b32 v58, 16, v115
    v_and_b32 v59, s32, v115
    v_cvt_pk_bf16_f32 v12, v12, v13
    v_cvt_pk_bf16_f32 v14, v14, v15
    v_cvt_pk_bf16_f32 v16, v16, v17
    v_cvt_pk_bf16_f32 v18, v18, v19
    v_cvt_pk_bf16_f32 v20, v20, v21
    v_cvt_pk_bf16_f32 v22, v22, v23
    v_cvt_pk_bf16_f32 v24, v24, v25
    v_cvt_pk_bf16_f32 v26, v26, v27
    v_and_b32 v13, s32, v12
    v_lshlrev_b32 v12, 16, v12
    v_and_b32 v15, s32, v14
    v_lshlrev_b32 v14, 16, v14
    v_and_b32 v17, s32, v16
    v_lshlrev_b32 v16, 16, v16
    v_and_b32 v19, s32, v18
    v_lshlrev_b32 v18, 16, v18
    v_and_b32 v21, s32, v20
    v_lshlrev_b32 v20, 16, v20
    v_and_b32 v23, s32, v22
    v_lshlrev_b32 v22, 16, v22
    v_and_b32 v25, s32, v24
    v_lshlrev_b32 v24, 16, v24
    v_and_b32 v27, s32, v26
    v_lshlrev_b32 v26, 16, v26
    v_mul_f32 v12, v12, v60
    v_mul_f32 v13, v13, v61
    v_mul_f32 v14, v14, v62
    v_mul_f32 v15, v15, v63
    v_mul_f32 v16, v16, v64
    v_mul_f32 v17, v17, v65
    v_mul_f32 v18, v18, v66
    v_mul_f32 v19, v19, v67
    v_mul_f32 v20, v20, v68
    v_mul_f32 v21, v21, v69
    v_mul_f32 v22, v22, v70
    v_mul_f32 v23, v23, v71
    v_mul_f32 v24, v24, v72
    v_mul_f32 v25, v25, v73
    v_mul_f32 v26, v26, v74
    v_mul_f32 v27, v27, v75
    v_cvt_pk_bf16_f32 v12, v12, v13
    v_cvt_pk_bf16_f32 v14, v14, v15
    v_cvt_pk_bf16_f32 v16, v16, v17
    v_cvt_pk_bf16_f32 v18, v18, v19
    v_cvt_pk_bf16_f32 v20, v20, v21
    v_cvt_pk_bf16_f32 v22, v22, v23
    v_cvt_pk_bf16_f32 v24, v24, v25
    v_cvt_pk_bf16_f32 v26, v26, v27
    v_and_b32 v13, s32, v12
    v_lshlrev_b32 v12, 16, v12
    v_and_b32 v15, s32, v14
    v_lshlrev_b32 v14, 16, v14
    v_and_b32 v17, s32, v16
    v_lshlrev_b32 v16, 16, v16
    v_and_b32 v19, s32, v18
    v_lshlrev_b32 v18, 16, v18
    v_and_b32 v21, s32, v20
    v_lshlrev_b32 v20, 16, v20
    v_and_b32 v23, s32, v22
    v_lshlrev_b32 v22, 16, v22
    v_and_b32 v25, s32, v24
    v_lshlrev_b32 v24, 16, v24
    v_and_b32 v27, s32, v26
    v_lshlrev_b32 v26, 16, v26
    v_add_f32 v12, v12, v44
    v_add_f32 v13, v13, v45
    v_add_f32 v14, v14, v46
    v_add_f32 v15, v15, v47
    v_add_f32 v16, v16, v48
    v_add_f32 v17, v17, v49
    v_add_f32 v18, v18, v50
    v_add_f32 v19, v19, v51
    v_add_f32 v20, v20, v52
    v_add_f32 v21, v21, v53
    v_add_f32 v22, v22, v54
    v_add_f32 v23, v23, v55
    v_add_f32 v24, v24, v56
    v_add_f32 v25, v25, v57
    v_add_f32 v26, v26, v58
    v_add_f32 v27, v27, v59
    v_cvt_pk_bf16_f32 v28, v12, v13
    v_cvt_pk_bf16_f32 v29, v14, v15
    v_cvt_pk_bf16_f32 v30, v16, v17
    v_cvt_pk_bf16_f32 v31, v18, v19
    v_cvt_pk_bf16_f32 v32, v20, v21
    v_cvt_pk_bf16_f32 v33, v22, v23
    v_cvt_pk_bf16_f32 v34, v24, v25
    v_cvt_pk_bf16_f32 v35, v26, v27
    buffer_store_dwordx4 v[28:31], v4, s[24:27], 0 offen
    buffer_store_dwordx4 v[32:35], v5, s[24:27], 0 offen
L_postend_96:
    s_mov_b64 exec, -1
L_nextq_94:
    s_bfe_u32 s3, s35, 0x40008
    s_cbranch_scc0 L_fend_112
    s_ff1_i32_b32 s41, s3
    s_add_u32 s3, s41, 8
    s_bitset0_b32 s35, s3
    s_branch L_qloop_89
L_fend_112:

L_p2done_50:
    s_endpgm

L_ufix_52:
    v_and_b32 v117, 63, v0
    v_lshlrev_b32 v117, 2, v117
    s_sub_i32 s54, s42, 1024
    v_cmp_le_i32 vcc, s54, v117
    s_mov_b64 exec, vcc
    v_mov_b32 v12, 0
    v_mov_b32 v44, 0
    s_mov_b64 exec, -1
    s_sub_i32 s54, s42, 1025
    v_cmp_le_i32 vcc, s54, v117
    s_mov_b64 exec, vcc
    v_mov_b32 v13, 0
    v_mov_b32 v46, 0
    s_mov_b64 exec, -1
    s_sub_i32 s54, s42, 1026
    v_cmp_le_i32 vcc, s54, v117
    s_mov_b64 exec, vcc
    v_mov_b32 v14, 0
    v_mov_b32 v48, 0
    s_mov_b64 exec, -1
    s_sub_i32 s54, s42, 1027
    v_cmp_le_i32 vcc, s54, v117
    s_mov_b64 exec, vcc
    v_mov_b32 v15, 0
    v_mov_b32 v50, 0
    s_mov_b64 exec, -1
    s_branch L_uback_53
L_ufix_54:
    v_and_b32 v117, 63, v0
    v_lshlrev_b32 v117, 2, v117
    s_sub_i32 s54, s42, 1536
    v_cmp_le_i32 vcc, s54, v117
    s_mov_b64 exec, vcc
    v_mov_b32 v16, 0
    v_mov_b32 v52, 0
    s_mov_b64 exec, -1
    s_sub_i32 s54, s42, 1537
    v_cmp_le_i32 vcc, s54, v117
    s_mov_b64 exec, vcc
    v_mov_b32 v17, 0
    v_mov_b32 v54, 0
    s_mov_b64 exec, -1
    s_sub_i32 s54, s42, 1538
    v_cmp_le_i32 vcc, s54, v117
    s_mov_b64 exec, vcc
    v_mov_b32 v18, 0
    v_mov_b32 v56, 0
    s_mov_b64 exec, -1
    s_sub_i32 s54, s42, 1539
    v_cmp_le_i32 vcc, s54, v117
    s_mov_b64 exec, vcc
    v_mov_b32 v19, 0
    v_mov_b32 v58, 0
    s_mov_b64 exec, -1
    s_branch L_uback_55
L_ufix_56:
    v_and_b32 v117, 63, v0
    v_lshlrev_b32 v117, 2, v117
    s_sub_i32 s54, s42, 2048
    v_cmp_le_i32 vcc, s54, v117
    s_mov_b64 exec, vcc
    v_mov_b32 v20, 0
    v_mov_b32 v60, 0
    s_mov_b64 exec, -1
    s_sub_i32 s54, s42, 2049
    v_cmp_le_i32 vcc, s54, v117
    s_mov_b64 exec, vcc
    v_mov_b32 v21, 0
    v_mov_b32 v62, 0
    s_mov_b64 exec, -1
    s_sub_i32 s54, s42, 2050
    v_cmp_le_i32 vcc, s54, v117
    s_mov_b64 exec, vcc
    v_mov_b32 v22, 0
    v_mov_b32 v64, 0
    s_mov_b64 exec, -1
    s_sub_i32 s54, s42, 2051
    v_cmp_le_i32 vcc, s54, v117
    s_mov_b64 exec, vcc
    v_mov_b32 v23, 0
    v_mov_b32 v66, 0
    s_mov_b64 exec, -1
    s_branch L_uback_57
L_ufix_58:
    v_and_b32 v117, 63, v0
    v_lshlrev_b32 v117, 2, v117
    s_sub_i32 s54, s42, 2560
    v_cmp_le_i32 vcc, s54, v117
    s_mov_b64 exec, vcc
    v_mov_b32 v24, 0
    v_mov_b32 v68, 0
    s_mov_b64 exec, -1
    s_sub_i32 s54, s42, 2561
    v_cmp_le_i32 vcc, s54, v117
    s_mov_b64 exec, vcc
    v_mov_b32 v25, 0
    v_mov_b32 v70, 0
    s_mov_b64 exec, -1
    s_sub_i32 s54, s42, 2562
    v_cmp_le_i32 vcc, s54, v117
    s_mov_b64 exec, vcc
    v_mov_b32 v26, 0
    v_mov_b32 v72, 0
    s_mov_b64 exec, -1
    s_sub_i32 s54, s42, 2563
    v_cmp_le_i32 vcc, s54, v117
    s_mov_b64 exec, vcc
    v_mov_b32 v27, 0
    v_mov_b32 v74, 0
    s_mov_b64 exec, -1
    s_branch L_uback_59
L_ufix_60:
    v_and_b32 v117, 63, v0
    v_lshlrev_b32 v117, 2, v117
    s_sub_i32 s54, s42, 0
    v_cmp_le_i32 vcc, s54, v117
    s_mov_b64 exec, vcc
    v_mov_b32 v4, 0
    v_mov_b32 v28, 0
    s_mov_b64 exec, -1
    s_sub_i32 s54, s42, 1
    v_cmp_le_i32 vcc, s54, v117
    s_mov_b64 exec, vcc
    v_mov_b32 v5, 0
    v_mov_b32 v30, 0
    s_mov_b64 exec, -1
    s_sub_i32 s54, s42, 2
    v_cmp_le_i32 vcc, s54, v117
    s_mov_b64 exec, vcc
    v_mov_b32 v6, 0
    v_mov_b32 v32, 0
    s_mov_b64 exec, -1
    s_sub_i32 s54, s42, 3
    v_cmp_le_i32 vcc, s54, v117
    s_mov_b64 exec, vcc
    v_mov_b32 v7, 0
    v_mov_b32 v34, 0
    s_mov_b64 exec, -1
    s_branch L_uback_61
L_ufix_62:
    v_and_b32 v117, 63, v0
    v_lshlrev_b32 v117, 2, v117
    s_sub_i32 s54, s42, 512
    v_cmp_le_i32 vcc, s54, v117
    s_mov_b64 exec, vcc
    v_mov_b32 v8, 0
    v_mov_b32 v36, 0
    s_mov_b64 exec, -1
    s_sub_i32 s54, s42, 513
    v_cmp_le_i32 vcc, s54, v117
    s_mov_b64 exec, vcc
    v_mov_b32 v9, 0
    v_mov_b32 v38, 0
    s_mov_b64 exec, -1
    s_sub_i32 s54, s42, 514
    v_cmp_le_i32 vcc, s54, v117
    s_mov_b64 exec, vcc
    v_mov_b32 v10, 0
    v_mov_b32 v40, 0
    s_mov_b64 exec, -1
    s_sub_i32 s54, s42, 515
    v_cmp_le_i32 vcc, s54, v117
    s_mov_b64 exec, vcc
    v_mov_b32 v11, 0
    v_mov_b32 v42, 0
    s_mov_b64 exec, -1
    s_branch L_uback_63
L_ufix_69:
    v_and_b32 v117, 63, v0
    v_lshlrev_b32 v117, 2, v117
    s_sub_i32 s54, s42, 3072
    v_cmp_le_i32 vcc, s54, v117
    s_mov_b64 exec, vcc
    v_mov_b32 v106, 0
    v_mov_b32 v120, 0
    s_mov_b64 exec, -1
    s_sub_i32 s54, s42, 3073
    v_cmp_le_i32 vcc, s54, v117
    s_mov_b64 exec, vcc
    v_mov_b32 v107, 0
    v_mov_b32 v122, 0
    s_mov_b64 exec, -1
    s_sub_i32 s54, s42, 3074
    v_cmp_le_i32 vcc, s54, v117
    s_mov_b64 exec, vcc
    v_mov_b32 v108, 0
    v_mov_b32 v124, 0
    s_mov_b64 exec, -1
    s_sub_i32 s54, s42, 3075
    v_cmp_le_i32 vcc, s54, v117
    s_mov_b64 exec, vcc
    v_mov_b32 v109, 0
    v_mov_b32 v126, 0
    s_mov_b64 exec, -1
    s_branch L_uback_70
L_ufix_73:
    v_and_b32 v117, 63, v0
    v_lshlrev_b32 v117, 2, v117
    s_sub_i32 s54, s42, 1024
    v_cmp_le_i32 vcc, s54, v117
    s_mov_b64 exec, vcc
    v_mov_b32 v12, 0
    v_mov_b32 v44, 0
    s_mov_b64 exec, -1
    s_sub_i32 s54, s42, 1025
    v_cmp_le_i32 vcc, s54, v117
    s_mov_b64 exec, vcc
    v_mov_b32 v13, 0
    v_mov_b32 v46, 0
    s_mov_b64 exec, -1
    s_sub_i32 s54, s42, 1026
    v_cmp_le_i32 vcc, s54, v117
    s_mov_b64 exec, vcc
    v_mov_b32 v14, 0
    v_mov_b32 v48, 0
    s_mov_b64 exec, -1
    s_sub_i32 s54, s42, 1027
    v_cmp_le_i32 vcc, s54, v117
    s_mov_b64 exec, vcc
    v_mov_b32 v15, 0
    v_mov_b32 v50, 0
    s_mov_b64 exec, -1
    s_branch L_uback_74
L_ufix_75:
    v_and_b32 v117, 63, v0
    v_lshlrev_b32 v117, 2, v117
    s_sub_i32 s54, s42, 1536
    v_cmp_le_i32 vcc, s54, v117
    s_mov_b64 exec, vcc
    v_mov_b32 v16, 0
    v_mov_b32 v52, 0
    s_mov_b64 exec, -1
    s_sub_i32 s54, s42, 1537
    v_cmp_le_i32 vcc, s54, v117
    s_mov_b64 exec, vcc
    v_mov_b32 v17, 0
    v_mov_b32 v54, 0
    s_mov_b64 exec, -1
    s_sub_i32 s54, s42, 1538
    v_cmp_le_i32 vcc, s54, v117
    s_mov_b64 exec, vcc
    v_mov_b32 v18, 0
    v_mov_b32 v56, 0
    s_mov_b64 exec, -1
    s_sub_i32 s54, s42, 1539
    v_cmp_le_i32 vcc, s54, v117
    s_mov_b64 exec, vcc
    v_mov_b32 v19, 0
    v_mov_b32 v58, 0
    s_mov_b64 exec, -1
    s_branch L_uback_76
L_ufix_77:
    v_and_b32 v117, 63, v0
    v_lshlrev_b32 v117, 2, v117
    s_sub_i32 s54, s42, 2048
    v_cmp_le_i32 vcc, s54, v117
    s_mov_b64 exec, vcc
    v_mov_b32 v20, 0
    v_mov_b32 v60, 0
    s_mov_b64 exec, -1
    s_sub_i32 s54, s42, 2049
    v_cmp_le_i32 vcc, s54, v117
    s_mov_b64 exec, vcc
    v_mov_b32 v21, 0
    v_mov_b32 v62, 0
    s_mov_b64 exec, -1
    s_sub_i32 s54, s42, 2050
    v_cmp_le_i32 vcc, s54, v117
    s_mov_b64 exec, vcc
    v_mov_b32 v22, 0
    v_mov_b32 v64, 0
    s_mov_b64 exec, -1
    s_sub_i32 s54, s42, 2051
    v_cmp_le_i32 vcc, s54, v117
    s_mov_b64 exec, vcc
    v_mov_b32 v23, 0
    v_mov_b32 v66, 0
    s_mov_b64 exec, -1
    s_branch L_uback_78
L_ufix_79:
    v_and_b32 v117, 63, v0
    v_lshlrev_b32 v117, 2, v117
    s_sub_i32 s54, s42, 2560
    v_cmp_le_i32 vcc, s54, v117
    s_mov_b64 exec, vcc
    v_mov_b32 v24, 0
    v_mov_b32 v68, 0
    s_mov_b64 exec, -1
    s_sub_i32 s54, s42, 2561
    v_cmp_le_i32 vcc, s54, v117
    s_mov_b64 exec, vcc
    v_mov_b32 v25, 0
    v_mov_b32 v70, 0
    s_mov_b64 exec, -1
    s_sub_i32 s54, s42, 2562
    v_cmp_le_i32 vcc, s54, v117
    s_mov_b64 exec, vcc
    v_mov_b32 v26, 0
    v_mov_b32 v72, 0
    s_mov_b64 exec, -1
    s_sub_i32 s54, s42, 2563
    v_cmp_le_i32 vcc, s54, v117
    s_mov_b64 exec, vcc
    v_mov_b32 v27, 0
    v_mov_b32 v74, 0
    s_mov_b64 exec, -1
    s_branch L_uback_80
L_ufix_81:
    v_and_b32 v117, 63, v0
    v_lshlrev_b32 v117, 2, v117
    s_sub_i32 s54, s42, 0
    v_cmp_le_i32 vcc, s54, v117
    s_mov_b64 exec, vcc
    v_mov_b32 v4, 0
    v_mov_b32 v28, 0
    s_mov_b64 exec, -1
    s_sub_i32 s54, s42, 1
    v_cmp_le_i32 vcc, s54, v117
    s_mov_b64 exec, vcc
    v_mov_b32 v5, 0
    v_mov_b32 v30, 0
    s_mov_b64 exec, -1
    s_sub_i32 s54, s42, 2
    v_cmp_le_i32 vcc, s54, v117
    s_mov_b64 exec, vcc
    v_mov_b32 v6, 0
    v_mov_b32 v32, 0
    s_mov_b64 exec, -1
    s_sub_i32 s54, s42, 3
    v_cmp_le_i32 vcc, s54, v117
    s_mov_b64 exec, vcc
    v_mov_b32 v7, 0
    v_mov_b32 v34, 0
    s_mov_b64 exec, -1
    s_branch L_uback_82
L_ufix_83:
    v_and_b32 v117, 63, v0
    v_lshlrev_b32 v117, 2, v117
    s_sub_i32 s54, s42, 512
    v_cmp_le_i32 vcc, s54, v117
    s_mov_b64 exec, vcc
    v_mov_b32 v8, 0
    v_mov_b32 v36, 0
    s_mov_b64 exec, -1
    s_sub_i32 s54, s42, 513
    v_cmp_le_i32 vcc, s54, v117
    s_mov_b64 exec, vcc
    v_mov_b32 v9, 0
    v_mov_b32 v38, 0
    s_mov_b64 exec, -1
    s_sub_i32 s54, s42, 514
    v_cmp_le_i32 vcc, s54, v117
    s_mov_b64 exec, vcc
    v_mov_b32 v10, 0
    v_mov_b32 v40, 0
    s_mov_b64 exec, -1
    s_sub_i32 s54, s42, 515
    v_cmp_le_i32 vcc, s54, v117
    s_mov_b64 exec, vcc
    v_mov_b32 v11, 0
    v_mov_b32 v42, 0
    s_mov_b64 exec, -1
    s_branch L_uback_84
L_sync_98:
    v_mov_b32 v117, s33
    buffer_atomic_add v117, v116, s[44:47], s50 offen sc0
    s_waitcnt vmcnt(0)
    v_readfirstlane_b32 s4, v117
    s_movk_i32 s5, 400
    s_nop 0
    s_add_u32 s4, s4, s33
    s_bitcmp1_b32 s4, 2
    s_cbranch_scc1 L_tell_101
L_poll_99:
    s_sub_u32 s5, s5, 1
    s_cbranch_scc1 L_gave_100
    v_mov_b32 v117, 0
    buffer_atomic_add v117, v116, s[44:47], s50 offen sc0
    s_waitcnt vmcnt(0)
    v_readfirstlane_b32 s4, v117
    s_nop 1
    s_and_b32 s4, s4, 0xff
    s_bitcmp0_b32 s4, 2
    s_cbranch_scc1 L_poll_99
    s_branch L_tell_101
L_gave_100:
    s_lshl_b32 s4, 0x100, s37
    v_mov_b32 v117, s4
    buffer_atomic_or v117, v116, s[44:47], s50 offen sc0
    s_waitcnt vmcnt(0)
    v_readfirstlane_b32 s4, v117
    s_nop 1
    s_and_b32 s4, s4, 0xff
    s_bitcmp1_b32 s4, 2
    s_cselect_b32 s4, s4, 0x10000
L_tell_101:
    v_mov_b32 v117, s4
    v_mov_b32 v118, 150016
    ds_write_b32 v118, v117
    s_branch L_bcast_93

L_fgen_102:
    s_waitcnt vmcnt(0)
    v_lshlrev_b32 v6, 1, v4
    v_lshlrev_b32 v7, 1, v5
    v_mov_b32 v12, 0
    v_mov_b32 v13, 0
    v_mov_b32 v14, 0
    v_mov_b32 v15, 0
    v_mov_b32 v16, 0
    v_mov_b32 v17, 0
    v_mov_b32 v18, 0
    v_mov_b32 v19, 0
    v_mov_b32 v20, 0
    v_mov_b32 v21, 0
    v_mov_b32 v22, 0
    v_mov_b32 v23, 0
    v_mov_b32 v24, 0
    v_mov_b32 v25, 0
    v_mov_b32 v26, 0
    v_mov_b32 v27, 0
    s_bitcmp1_b32 s35, 4
    s_cbranch_scc1 L_ffl_104
    v_cvt_f32_u32_sdwa v28, v76 dst_sel:DWORD dst_unused:UNUSED_PAD src0_sel:WORD_0
    v_cvt_f32_u32_sdwa v29, v76 dst_sel:DWORD dst_unused:UNUSED_PAD src0_sel:WORD_1
    v_cvt_f32_u32_sdwa v30, v77 dst_sel:DWORD dst_unused:UNUSED_PAD src0_sel:WORD_0
    v_cvt_f32_u32_sdwa v31, v77 dst_sel:DWORD dst_unused:UNUSED_PAD src0_sel:WORD_1
    v_cvt_f32_u32_sdwa v32, v78 dst_sel:DWORD dst_unused:UNUSED_PAD src0_sel:WORD_0
    v_cvt_f32_u32_sdwa v33, v78 dst_sel:DWORD dst_unused:UNUSED_PAD src0_sel:WORD_1
    v_cvt_f32_u32_sdwa v34, v79 dst_sel:DWORD dst_unused:UNUSED_PAD src0_sel:WORD_0
    v_cvt_f32_u32_sdwa v35, v79 dst_sel:DWORD dst_unused:UNUSED_PAD src0_sel:WORD_1
    v_cvt_f32_u32_sdwa v36, v92 dst_sel:DWORD dst_unused:UNUSED_PAD src0_sel:WORD_0
    v_cvt_f32_u32_sdwa v37, v92 dst_sel:DWORD dst_unused:UNUSED_PAD src0_sel:WORD_1
    v_cvt_f32_u32_sdwa v38, v93 dst_sel:DWORD dst_unused:UNUSED_PAD src0_sel:WORD_0
    v_cvt_f32_u32_sdwa v39, v93 dst_sel:DWORD dst_unused:UNUSED_PAD src0_sel:WORD_1
    v_cvt_f32_u32_sdwa v40, v94 dst_sel:DWORD dst_unused:UNUSED_PAD src0_sel:WORD_0
    v_cvt_f32_u32_sdwa v41, v94 dst_sel:DWORD dst_unused:UNUSED_PAD src0_sel:WORD_1
    v_cvt_f32_u32_sdwa v42, v95 dst_sel:DWORD dst_unused:UNUSED_PAD src0_sel:WORD_0
    v_cvt_f32_u32_sdwa v43, v95 dst_sel:DWORD dst_unused:UNUSED_PAD src0_sel:WORD_1
    v_add_f32 v28, 0xc6800000, v28
    v_fmac_f32 v12, s34, v28
    v_add_f32 v29, 0xc6800000, v29
    v_fmac_f32 v13, s34, v29
    v_add_f32 v30, 0xc6800000, v30
    v_fmac_f32 v14, s34, v30
    v_add_f32 v31, 0xc6800000, v31
    v_fmac_f32 v15, s34, v31
    v_add_f32 v32, 0xc6800000, v32
    v_fmac_f32 v16, s34, v32
    v_add_f32 v33, 0xc6800000, v33
    v_fmac_f32 v17, s34, v33
    v_add_f32 v34, 0xc6800000, v34
    v_fmac_f32 v18, s34, v34
    v_add_f32 v35, 0xc6800000, v35
    v_fmac_f32 v19, s34, v35
    v_add_f32 v36, 0xc6800000, v36
    v_fmac_f32 v20, s34, v36
    v_add_f32 v37, 0xc6800000, v37
    v_fmac_f32 v21, s34, v37
    v_add_f32 v38, 0xc6800000, v38
    v_fmac_f32 v22, s34, v38
    v_add_f32 v39, 0xc6800000, v39
    v_fmac_f32 v23, s34, v39
    v_add_f32 v40, 0xc6800000, v40
    v_fmac_f32 v24, s34, v40
    v_add_f32 v41, 0xc6800000, v41
    v_fmac_f32 v25, s34, v41
    v_add_f32 v42, 0xc6800000, v42
    v_fmac_f32 v26, s34, v42
    v_add_f32 v43, 0xc6800000, v43
    v_fmac_f32 v27, s34, v43
    s_branch L_fnx_105
L_ffl_104:
    s_mov_b32 s3, 25600000
    buffer_load_dwordx4 v[28:31], v6, s[20:23], s3 offen offset:0 sc1
    buffer_load_dwordx4 v[32:35], v6, s[20:23], s3 offen offset:16 sc1
    buffer_load_dwordx4 v[36:39], v7, s[20:23], s3 offen offset:0 sc1
    buffer_load_dwordx4 v[40:43], v7, s[20:23], s3 offen offset:16 sc1
    s_waitcnt vmcnt(0)
    v_add_f32 v12, v12, v28
    v_add_f32 v13, v13, v29
    v_add_f32 v14, v14, v30
    v_add_f32 v15, v15, v31
    v_add_f32 v16, v16, v32
    v_add_f32 v17, v17, v33
    v_add_f32 v18, v18, v34
    v_add_f32 v19, v19, v35
    v_add_f32 v20, v20, v36
    v_add_f32 v21, v21, v37
    v_add_f32 v22, v22, v38
    v_add_f32 v23, v23, v39
    v_add_f32 v24, v24, v40
    v_add_f32 v25, v25, v41
    v_add_f32 v26, v26, v42
    v_add_f32 v27, v27, v43
L_fnx_105:
    s_bitcmp1_b32 s35, 5
    s_cbranch_scc1 L_ffl_106
    v_cvt_f32_u32_sdwa v28, v80 dst_sel:DWORD dst_unused:UNUSED_PAD src0_sel:WORD_0
    v_cvt_f32_u32_sdwa v29, v80 dst_sel:DWORD dst_unused:UNUSED_PAD src0_sel:WORD_1
    v_cvt_f32_u32_sdwa v30, v81 dst_sel:DWORD dst_unused:UNUSED_PAD src0_sel:WORD_0
    v_cvt_f32_u32_sdwa v31, v81 dst_sel:DWORD dst_unused:UNUSED_PAD src0_sel:WORD_1
    v_cvt_f32_u32_sdwa v32, v82 dst_sel:DWORD dst_unused:UNUSED_PAD src0_sel:WORD_0
    v_cvt_f32_u32_sdwa v33, v82 dst_sel:DWORD dst_unused:UNUSED_PAD src0_sel:WORD_1
    v_cvt_f32_u32_sdwa v34, v83 dst_sel:DWORD dst_unused:UNUSED_PAD src0_sel:WORD_0
    v_cvt_f32_u32_sdwa v35, v83 dst_sel:DWORD dst_unused:UNUSED_PAD src0_sel:WORD_1
    v_cvt_f32_u32_sdwa v36, v96 dst_sel:DWORD dst_unused:UNUSED_PAD src0_sel:WORD_0
    v_cvt_f32_u32_sdwa v37, v96 dst_sel:DWORD dst_unused:UNUSED_PAD src0_sel:WORD_1
    v_cvt_f32_u32_sdwa v38, v97 dst_sel:DWORD dst_unused:UNUSED_PAD src0_sel:WORD_0
    v_cvt_f32_u32_sdwa v39, v97 dst_sel:DWORD dst_unused:UNUSED_PAD src0_sel:WORD_1
    v_cvt_f32_u32_sdwa v40, v98 dst_sel:DWORD dst_unused:UNUSED_PAD src0_sel:WORD_0
    v_cvt_f32_u32_sdwa v41, v98 dst_sel:DWORD dst_unused:UNUSED_PAD src0_sel:WORD_1
    v_cvt_f32_u32_sdwa v42, v99 dst_sel:DWORD dst_unused:UNUSED_PAD src0_sel:WORD_0
    v_cvt_f32_u32_sdwa v43, v99 dst_sel:DWORD dst_unused:UNUSED_PAD src0_sel:WORD_1
    v_add_f32 v28, 0xc6800000, v28
    v_fmac_f32 v12, s34, v28
    v_add_f32 v29, 0xc6800000, v29
    v_fmac_f32 v13, s34, v29
    v_add_f32 v30, 0xc6800000, v30
    v_fmac_f32 v14, s34, v30
    v_add_f32 v31, 0xc6800000, v31
    v_fmac_f32 v15, s34, v31
    v_add_f32 v32, 0xc6800000, v32
    v_fmac_f32 v16, s34, v32
    v_add_f32 v33, 0xc6800000, v33
    v_fmac_f32 v17, s34, v33
    v_add_f32 v34, 0xc6800000, v34
    v_fmac_f32 v18, s34, v34
    v_add_f32 v35, 0xc6800000, v35
    v_fmac_f32 v19, s34, v35
    v_add_f32 v36, 0xc6800000, v36
    v_fmac_f32 v20, s34, v36
    v_add_f32 v37, 0xc6800000, v37
    v_fmac_f32 v21, s34, v37
    v_add_f32 v38, 0xc6800000, v38
    v_fmac_f32 v22, s34, v38
    v_add_f32 v39, 0xc6800000, v39
    v_fmac_f32 v23, s34, v39
    v_add_f32 v40, 0xc6800000, v40
    v_fmac_f32 v24, s34, v40
    v_add_f32 v41, 0xc6800000, v41
    v_fmac_f32 v25, s34, v41
    v_add_f32 v42, 0xc6800000, v42
    v_fmac_f32 v26, s34, v42
    v_add_f32 v43, 0xc6800000, v43
    v_fmac_f32 v27, s34, v43
    s_branch L_fnx_107
L_ffl_106:
    s_mov_b32 s3, 38400000
    buffer_load_dwordx4 v[28:31], v6, s[20:23], s3 offen offset:0 sc1
    buffer_load_dwordx4 v[32:35], v6, s[20:23], s3 offen offset:16 sc1
    buffer_load_dwordx4 v[36:39], v7, s[20:23], s3 offen offset:0 sc1
    buffer_load_dwordx4 v[40:43], v7, s[20:23], s3 offen offset:16 sc1
    s_waitcnt vmcnt(0)
    v_add_f32 v12, v12, v28
    v_add_f32 v13, v13, v29
    v_add_f32 v14, v14, v30
    v_add_f32 v15, v15, v31
    v_add_f32 v16, v16, v32
    v_add_f32 v17, v17, v33
    v_add_f32 v18, v18, v34
    v_add_f32 v19, v19, v35
    v_add_f32 v20, v20, v36
    v_add_f32 v21, v21, v37
    v_add_f32 v22, v22, v38
    v_add_f32 v23, v23, v39
    v_add_f32 v24, v24, v40
    v_add_f32 v25, v25, v41
    v_add_f32 v26, v26, v42
    v_add_f32 v27, v27, v43
L_fnx_107:
    s_bitcmp1_b32 s35, 6
    s_cbranch_scc1 L_ffl_108
    v_cvt_f32_u32_sdwa v28, v84 dst_sel:DWORD dst_unused:UNUSED_PAD src0_sel:WORD_0
    v_cvt_f32_u32_sdwa v29, v84 dst_sel:DWORD dst_unused:UNUSED_PAD src0_sel:WORD_1
    v_cvt_f32_u32_sdwa v30, v85 dst_sel:DWORD dst_unused:UNUSED_PAD src0_sel:WORD_0
    v_cvt_f32_u32_sdwa v31, v85 dst_sel:DWORD dst_unused:UNUSED_PAD src0_sel:WORD_1
    v_cvt_f32_u32_sdwa v32, v86 dst_sel:DWORD dst_unused:UNUSED_PAD src0_sel:WORD_0
    v_cvt_f32_u32_sdwa v33, v86 dst_sel:DWORD dst_unused:UNUSED_PAD src0_sel:WORD_1
    v_cvt_f32_u32_sdwa v34, v87 dst_sel:DWORD dst_unused:UNUSED_PAD src0_sel:WORD_0
    v_cvt_f32_u32_sdwa v35, v87 dst_sel:DWORD dst_unused:UNUSED_PAD src0_sel:WORD_1
    v_cvt_f32_u32_sdwa v36, v100 dst_sel:DWORD dst_unused:UNUSED_PAD src0_sel:WORD_0
    v_cvt_f32_u32_sdwa v37, v100 dst_sel:DWORD dst_unused:UNUSED_PAD src0_sel:WORD_1
    v_cvt_f32_u32_sdwa v38, v101 dst_sel:DWORD dst_unused:UNUSED_PAD src0_sel:WORD_0
    v_cvt_f32_u32_sdwa v39, v101 dst_sel:DWORD dst_unused:UNUSED_PAD src0_sel:WORD_1
    v_cvt_f32_u32_sdwa v40, v102 dst_sel:DWORD dst_unused:UNUSED_PAD src0_sel:WORD_0
    v_cvt_f32_u32_sdwa v41, v102 dst_sel:DWORD dst_unused:UNUSED_PAD src0_sel:WORD_1
    v_cvt_f32_u32_sdwa v42, v103 dst_sel:DWORD dst_unused:UNUSED_PAD src0_sel:WORD_0
    v_cvt_f32_u32_sdwa v43, v103 dst_sel:DWORD dst_unused:UNUSED_PAD src0_sel:WORD_1
    v_add_f32 v28, 0xc6800000, v28
    v_fmac_f32 v12, s34, v28
    v_add_f32 v29, 0xc6800000, v29
    v_fmac_f32 v13, s34, v29
    v_add_f32 v30, 0xc6800000, v30
    v_fmac_f32 v14, s34, v30
    v_add_f32 v31, 0xc6800000, v31
    v_fmac_f32 v15, s34, v31
    v_add_f32 v32, 0xc6800000, v32
    v_fmac_f32 v16, s34, v32
    v_add_f32 v33, 0xc6800000, v33
    v_fmac_f32 v17, s34, v33
    v_add_f32 v34, 0xc6800000, v34
    v_fmac_f32 v18, s34, v34
    v_add_f32 v35, 0xc6800000, v35
    v_fmac_f32 v19, s34, v35
    v_add_f32 v36, 0xc6800000, v36
    v_fmac_f32 v20, s34, v36
    v_add_f32 v37, 0xc6800000, v37
    v_fmac_f32 v21, s34, v37
    v_add_f32 v38, 0xc6800000, v38
    v_fmac_f32 v22, s34, v38
    v_add_f32 v39, 0xc6800000, v39
    v_fmac_f32 v23, s34, v39
    v_add_f32 v40, 0xc6800000, v40
    v_fmac_f32 v24, s34, v40
    v_add_f32 v41, 0xc6800000, v41
    v_fmac_f32 v25, s34, v41
    v_add_f32 v42, 0xc6800000, v42
    v_fmac_f32 v26, s34, v42
    v_add_f32 v43, 0xc6800000, v43
    v_fmac_f32 v27, s34, v43
    s_branch L_fnx_109
L_ffl_108:
    s_mov_b32 s3, 51200000
    buffer_load_dwordx4 v[28:31], v6, s[20:23], s3 offen offset:0 sc1
    buffer_load_dwordx4 v[32:35], v6, s[20:23], s3 offen offset:16 sc1
    buffer_load_dwordx4 v[36:39], v7, s[20:23], s3 offen offset:0 sc1
    buffer_load_dwordx4 v[40:43], v7, s[20:23], s3 offen offset:16 sc1
    s_waitcnt vmcnt(0)
    v_add_f32 v12, v12, v28
    v_add_f32 v13, v13, v29
    v_add_f32 v14, v14, v30
    v_add_f32 v15, v15, v31
    v_add_f32 v16, v16, v32
    v_add_f32 v17, v17, v33
    v_add_f32 v18, v18, v34
    v_add_f32 v19, v19, v35
    v_add_f32 v20, v20, v36
    v_add_f32 v21, v21, v37
    v_add_f32 v22, v22, v38
    v_add_f32 v23, v23, v39
    v_add_f32 v24, v24, v40
    v_add_f32 v25, v25, v41
    v_add_f32 v26, v26, v42
    v_add_f32 v27, v27, v43
L_fnx_109:
    s_bitcmp1_b32 s35, 7
    s_cbranch_scc1 L_ffl_110
    v_cvt_f32_u32_sdwa v28, v88 dst_sel:DWORD dst_unused:UNUSED_PAD src0_sel:WORD_0
    v_cvt_f32_u32_sdwa v29, v88 dst_sel:DWORD dst_unused:UNUSED_PAD src0_sel:WORD_1
    v_cvt_f32_u32_sdwa v30, v89 dst_sel:DWORD dst_unused:UNUSED_PAD src0_sel:WORD_0
    v_cvt_f32_u32_sdwa v31, v89 dst_sel:DWORD dst_unused:UNUSED_PAD src0_sel:WORD_1
    v_cvt_f32_u32_sdwa v32, v90 dst_sel:DWORD dst_unused:UNUSED_PAD src0_sel:WORD_0
    v_cvt_f32_u32_sdwa v33, v90 dst_sel:DWORD dst_unused:UNUSED_PAD src0_sel:WORD_1
    v_cvt_f32_u32_sdwa v34, v91 dst_sel:DWORD dst_unused:UNUSED_PAD src0_sel:WORD_0
    v_cvt_f32_u32_sdwa v35, v91 dst_sel:DWORD dst_unused:UNUSED_PAD src0_sel:WORD_1
    v_cvt_f32_u32_sdwa v36, v104 dst_sel:DWORD dst_unused:UNUSED_PAD src0_sel:WORD_0
    v_cvt_f32_u32_sdwa v37, v104 dst_sel:DWORD dst_unused:UNUSED_PAD src0_sel:WORD_1
    v_cvt_f32_u32_sdwa v38, v105 dst_sel:DWORD dst_unused:UNUSED_PAD src0_sel:WORD_0
    v_cvt_f32_u32_sdwa v39, v105 dst_sel:DWORD dst_unused:UNUSED_PAD src0_sel:WORD_1
    v_cvt_f32_u32_sdwa v40, v106 dst_sel:DWORD dst_unused:UNUSED_PAD src0_sel:WORD_0
    v_cvt_f32_u32_sdwa v41, v106 dst_sel:DWORD dst_unused:UNUSED_PAD src0_sel:WORD_1
    v_cvt_f32_u32_sdwa v42, v107 dst_sel:DWORD dst_unused:UNUSED_PAD src0_sel:WORD_0
    v_cvt_f32_u32_sdwa v43, v107 dst_sel:DWORD dst_unused:UNUSED_PAD src0_sel:WORD_1
    v_add_f32 v28, 0xc6800000, v28
    v_fmac_f32 v12, s34, v28
    v_add_f32 v29, 0xc6800000, v29
    v_fmac_f32 v13, s34, v29
    v_add_f32 v30, 0xc6800000, v30
    v_fmac_f32 v14, s34, v30
    v_add_f32 v31, 0xc6800000, v31
    v_fmac_f32 v15, s34, v31
    v_add_f32 v32, 0xc6800000, v32
    v_fmac_f32 v16, s34, v32
    v_add_f32 v33, 0xc6800000, v33
    v_fmac_f32 v17, s34, v33
    v_add_f32 v34, 0xc6800000, v34
    v_fmac_f32 v18, s34, v34
    v_add_f32 v35, 0xc6800000, v35
    v_fmac_f32 v19, s34, v35
    v_add_f32 v36, 0xc6800000, v36
    v_fmac_f32 v20, s34, v36
    v_add_f32 v37, 0xc6800000, v37
    v_fmac_f32 v21, s34, v37
    v_add_f32 v38, 0xc6800000, v38
    v_fmac_f32 v22, s34, v38
    v_add_f32 v39, 0xc6800000, v39
    v_fmac_f32 v23, s34, v39
    v_add_f32 v40, 0xc6800000, v40
    v_fmac_f32 v24, s34, v40
    v_add_f32 v41, 0xc6800000, v41
    v_fmac_f32 v25, s34, v41
    v_add_f32 v42, 0xc6800000, v42
    v_fmac_f32 v26, s34, v42
    v_add_f32 v43, 0xc6800000, v43
    v_fmac_f32 v27, s34, v43
    s_branch L_fnx_111
L_ffl_110:
    s_mov_b32 s3, 64000000
    buffer_load_dwordx4 v[28:31], v6, s[20:23], s3 offen offset:0 sc1
    buffer_load_dwordx4 v[32:35], v6, s[20:23], s3 offen offset:16 sc1
    buffer_load_dwordx4 v[36:39], v7, s[20:23], s3 offen offset:0 sc1
    buffer_load_dwordx4 v[40:43], v7, s[20:23], s3 offen offset:16 sc1
    s_waitcnt vmcnt(0)
    v_add_f32 v12, v12, v28
    v_add_f32 v13, v13, v29
    v_add_f32 v14, v14, v30
    v_add_f32 v15, v15, v31
    v_add_f32 v16, v16, v32
    v_add_f32 v17, v17, v33
    v_add_f32 v18, v18, v34
    v_add_f32 v19, v19, v35
    v_add_f32 v20, v20, v36
    v_add_f32 v21, v21, v37
    v_add_f32 v22, v22, v38
    v_add_f32 v23, v23, v39
    v_add_f32 v24, v24, v40
    v_add_f32 v25, v25, v41
    v_add_f32 v26, v26, v42
    v_add_f32 v27, v27, v43
L_fnx_111:
    s_branch L_fbk_103
L_p2slow_51:
    s_waitcnt vmcnt(0) lgkmcnt(0)
    s_mov_b32 s51, 0
    s_movk_i32 s43, 6250

L_sweep_113:
    s_barrier

    v_mov_b32 v28, 0x0
    v_mov_b32 v29, 0x0
    v_mov_b32 v30, 0x0
    v_mov_b32 v31, 0x0
    v_add_u32 v32, 50000, v3
    v_add_u32 v33, 65536, v32

    ds_write_b128 v32, v[28:31] offset:0
    ds_write_b128 v32, v[28:31] offset:16384
    ds_write_b128 v32, v[28:31] offset:32768
    ds_write_b128 v32, v[28:31] offset:49152
    ds_write_b128 v33, v[28:31] offset:0
    ds_write_b128 v33, v[28:31] offset:16384
    v_cmp_gt_u32 vcc, 971, v0
    s_mov_b64 exec, vcc
    ds_write_b128 v33, v[28:31] offset:32768
    s_mov_b64 exec, -1
    s_waitcnt lgkmcnt(0)
    s_barrier
    s_sub_u32 s38, s4, 8
L_sbatch_114:
    s_lshl_b32 s52, s38, 6
    s_add_u32 s52, s52, s36
    s_lshl_b32 s52, s52, 2
    s_load_dword s40, s[46:47], s52
    s_mul_i32 s50, s38, 200000
    s_waitcnt lgkmcnt(0)

    s_min_u32 s40, s40, 3968
    s_lshl_b32 s52, s38, 6
    s_add_u32 s52, s52, s36
    s_mul_i32 s52, s52, 19840
    s_add_u32 s20, s44, s52
    s_addc_u32 s21, s45, 0
    s_mul_i32 s52, s40, 5
    s_add_u32 s52, s52, 3
    s_and_b32 s22, s52, -4

    s_lshr_b32 s55, s39, 2
    s_add_u32 s55, s55, 0
    v_and_b32 v36, 63, v0
    v_add_u32 v36, s55, v36
L_left_118:
    s_cmp_ge_u32 s55, s40
    s_cbranch_scc1 L_leftend_119
    v_mul_u32_u24 v37, 5, v36
    buffer_load_dword v38, v37, s[20:23], 0 offen
    buffer_load_ubyte v39, v37, s[20:23], 0 offen offset:4
    s_waitcnt vmcnt(0)

    v_perm_b32 v37, v39, v38, s24
    v_lshrrev_b32 v42, 30, v38
    v_and_b32 v37, 0x1fff, v37
    v_mul_u32_u24 v42, 6250, v42
    v_add_lshl_u32 v37, v37, v42, 3

    buffer_load_dwordx2 v[40:41], v37, s[8:11], s50 offen
    v_cmp_gt_u32 vcc, s40, v36
    s_waitcnt vmcnt(0)

    v_bfe_u32 v44, v38, 16, 14
    v_subrev_u32 v44, s51, v44
    v_cmp_gt_u32 s[64:65], s43, v44
    s_and_b64 exec, vcc, s[64:65]
    v_lshlrev_b32 v45, 8, v38
    v_cmpx_ne_u32 vcc, 0, v45
    v_lshlrev_b32 v44, 4, v44
    v_bfe_i32 v38, v38, 0, 16
    v_cvt_f32_i32 v38, v38
    v_mul_f32 v38, 0x38004020, v38
    v_lshlrev_b32 v45, 16, v40
    v_and_b32 v46, s32, v40
    v_lshlrev_b32 v47, 16, v41
    v_and_b32 v48, s32, v41

    v_mul_f32 v45, v45, v38
    ds_add_f32 v44, v45 offset:50000
    v_mul_f32 v46, v46, v38
    ds_add_f32 v44, v46 offset:50004
    v_mul_f32 v47, v47, v38
    ds_add_f32 v44, v47 offset:50008
    v_mul_f32 v48, v48, v38
    ds_add_f32 v44, v48 offset:50012
    s_mov_b64 exec, -1
    v_add_u32 v36, 128, v36
    s_add_u32 s55, s55, 128
    s_branch L_left_118
L_leftend_119:

    s_add_u32 s38, s38, 1
    s_cmp_lt_u32 s38, s4
    s_cbranch_scc1 L_sbatch_114
    s_mov_b32 s3, 65536
    s_load_dword s40, s[6:7], s3

    s_add_u32 s20, s6, 408657920
    s_addc_u32 s21, s7, 0
    s_mov_b32 s22, 409600000
    s_mov_b32 s23, 0x20000
    s_mov_b32 s38, 0
    s_mov_b32 s50, 200000
    v_mov_b32 v36, v0
    s_waitcnt lgkmcnt(0)
L_ovf_115:
    s_cmp_ge_u32 s38, s40
    s_cbranch_scc1 L_ovfend_116
    v_lshlrev_b32 v37, 3, v36
    buffer_load_dwordx2 v[38:39], v37, s[20:23], 0 offen
    s_waitcnt vmcnt(0)

    v_perm_b32 v37, v39, v38, s24
    v_lshrrev_b32 v42, 30, v38
    v_and_b32 v37, 0x1fff, v37
    v_mul_u32_u24 v42, 6250, v42
    v_add_lshl_u32 v37, v37, v42, 3

    v_bfe_u32 v42, v39, 24, 5
    v_mad_u32_u24 v37, v42, s50, v37
    buffer_load_dwordx2 v[40:41], v37, s[8:11], 0 offen
    v_lshrrev_b32 v42, 3, v42
    v_bfe_u32 v43, v39, 18, 6
    v_cmp_gt_u32 vcc, s40, v36
    v_cmp_eq_u32 s[64:65], s36, v43
    s_and_b64 vcc, vcc, s[64:65]
    v_cmp_eq_u32 s[64:65], s37, v42
    s_and_b64 vcc, vcc, s[64:65]
    s_waitcnt vmcnt(0)

    v_bfe_u32 v44, v38, 16, 14
    v_subrev_u32 v44, s51, v44
    v_cmp_gt_u32 s[64:65], s43, v44
    s_and_b64 exec, vcc, s[64:65]
    v_lshlrev_b32 v45, 8, v38
    v_cmpx_ne_u32 vcc, 0, v45
    v_lshlrev_b32 v44, 4, v44
    v_bfe_i32 v38, v38, 0, 16
    v_cvt_f32_i32 v38, v38
    v_mul_f32 v38, 0x38004020, v38
    v_lshlrev_b32 v45, 16, v40
    v_and_b32 v46, s32, v40
    v_lshlrev_b32 v47, 16, v41
    v_and_b32 v48, s32, v41

    v_mul_f32 v45, v45, v38
    ds_add_f32 v44, v45 offset:50000
    v_mul_f32 v46, v46, v38
    ds_add_f32 v44, v46 offset:50004
    v_mul_f32 v47, v47, v38
    ds_add_f32 v44, v47 offset:50008
    v_mul_f32 v48, v48, v38
    ds_add_f32 v44, v48 offset:50012
    s_mov_b64 exec, -1
    v_add_u32 v36, 1024, v36
    s_add_u32 s38, s38, 1024
    s_branch L_ovf_115
L_ovfend_116:
    s_waitcnt lgkmcnt(0)
    s_barrier
    s_mul_i32 s3, s37, 800000
    s_mul_i32 s5, s36, 12500
    s_add_u32 s3, s3, s5
    s_add_u32 s3, s3, s51
    s_lshl_b32 s3, s3, 4
    s_add_u32 s3, s3, 32399360

    s_add_u32 s20, s6, s3
    s_addc_u32 s21, s7, 0
    s_mov_b32 s22, 100000
    s_mov_b32 s23, 0x20000
    v_mov_b32 v36, v3
    s_mov_b32 s38, 0
L_wl_117:
    v_min_u32 v37, 100000, v36
    ds_read_b128 v[28:31], v37 offset:50000
    s_waitcnt lgkmcnt(0)
    buffer_store_dwordx4 v[28:31], v36, s[20:23], 0 offen sc1
    s_waitcnt vmcnt(0)
    v_add_u32 v36, 16384, v36
    s_add_u32 s38, s38, 1024
    s_cmp_lt_u32 s38, 6250
    s_cbranch_scc1 L_wl_117
    s_add_u32 s51, s51, 6250
    s_cmp_lt_u32 s51, 12500
    s_cbranch_scc1 L_sweep_113
    s_lshl_b32 s33, 16, s37
    s_add_u32 s33, s33, 1
    s_branch L_fin_86

.section .rodata,"a"
.p2align 6
.amdhsa_kernel g1_kernel
  .amdhsa_next_free_vgpr 128
  .amdhsa_next_free_sgpr 102
  .amdhsa_accum_offset 128
  .amdhsa_group_segment_fixed_size 0
  .amdhsa_kernarg_size 112
  .amdhsa_user_sgpr_count 2
  .amdhsa_user_sgpr_kernarg_segment_ptr 1
  .amdhsa_system_sgpr_workgroup_id_x 1
.end_amdhsa_kernel
.p2align 6
.amdhsa_kernel standalone__molecular_angular_gemnet__graph_kernel
  .amdhsa_next_free_vgpr 128
  .amdhsa_next_free_sgpr 102
  .amdhsa_accum_offset 128
  .amdhsa_group_segment_fixed_size 0
  .amdhsa_kernarg_size 112
  .amdhsa_user_sgpr_count 2
  .amdhsa_user_sgpr_kernarg_segment_ptr 1
  .amdhsa_system_sgpr_workgroup_id_x 1
  .amdhsa_float_denorm_mode_32 3
.end_amdhsa_kernel
```

```asm
; @launch kernel=g1_kernel grid=(256,1,1) block=(1024,1,1) lds=163840
; @launch kernel=standalone__molecular_angular_gemnet__graph_kernel grid=(256,1,1) block=(1024,1,1) lds=163840
.amdgcn_target "amdgcn-amd-amdhsa--gfx950"
.text
.globl g1_kernel
.p2align 8
.type g1_kernel,@function
g1_kernel:
    s_cmp_ge_u32 s2, 256
    s_cbranch_scc1 L_p1done_1
    s_load_dwordx4 s[80:83], s[0:1], 8
    s_load_dwordx2 s[84:85], s[0:1], 32
    s_load_dwordx2 s[86:87], s[0:1], 48
    s_load_dwordx4 s[4:7], s[0:1], 96
    s_load_dwordx2 s[78:79], s[0:1], 0
    v_lshlrev_b32 v1, 4, v0
    v_lshlrev_b32 v2, 3, v0
    v_lshlrev_b32 v98, 20, v0
    s_waitcnt lgkmcnt(0)
    s_load_dword s88, s[86:87], 0

    s_mov_b32 s96, s4
    s_mov_b32 s97, s5
    s_mov_b32 s98, 256
    s_mov_b32 s99, 0x20000
    v_readfirstlane_b32 s74, v0
    s_nop 1
    s_or_b32 s74, s74, s2
    s_cbranch_scc1 L_noinit_2

    v_mov_b32 v110, 1
    buffer_atomic_add v110, v98, s[96:99], 0 offen offset:64 sc0
    s_waitcnt vmcnt(0)
    v_readfirstlane_b32 s74, v110
    s_nop 1
    s_cmp_lg_u32 s74, 0
    s_cbranch_scc1 L_zno_4

    s_mov_b32 s92, s6
    s_mov_b32 s93, s7
    s_mov_b32 s94, 65552
    s_mov_b32 s95, 0x20000
    v_mov_b32 v110, 0
    v_mov_b32 v111, 0
    v_mov_b32 v112, 0
    v_mov_b32 v113, 0
L_zl_3:
    buffer_store_dwordx4 v[110:113], v1, s[92:95], s74 offen sc0 sc1
    s_add_u32 s74, s74, 1024
    s_cmp_le_u32 s74, 65536
    s_cbranch_scc1 L_zl_3
    v_mov_b32 v114, 1
    s_waitcnt vmcnt(0)
    buffer_atomic_add v114, v98, s[96:99], 0 offen offset:128
L_zno_4:

L_noinit_2:
    s_mov_b32 s20, s78
    s_mov_b32 s21, s79
    s_mov_b32 s22, 6400000
    s_mov_b32 s23, 0x20000
    v_mul_u32_u24 v110, 6240, v0
    v_and_b32 v111, 63, v0
    v_and_b32 v112, 0x3c0, v0
    v_lshlrev_b32 v111, 2, v111
    v_lshl_or_b32 v111, v112, 4, v111
    v_lshlrev_b32 v100, 2, v0
    s_lshr_b32 s50, s2, 1
    s_and_b32 s53, s2, 1
    s_mul_i32 s3, s50, 50000
    s_mul_i32 s54, s53, 24576
    s_add_u32 s3, s3, s54

    buffer_load_dwordx4 v[56:59], v110, s[20:23], 0 offen
    s_add_u32 s20, s78, s3
    s_addc_u32 s21, s79, 0
    s_mov_b32 s22, 24576
    s_mov_b32 s23, 0x20000
    s_movk_i32 s3, 16384
    buffer_load_dword v44, v111, s[20:23], 0 offen offset:0
    buffer_load_dword v45, v111, s[20:23], 0 offen offset:256
    buffer_load_dword v46, v111, s[20:23], 0 offen offset:512
    buffer_load_dword v47, v111, s[20:23], 0 offen offset:768
    buffer_load_dword v48, v111, s[20:23], s3 offen offset:0
    buffer_load_dword v49, v111, s[20:23], s3 offen offset:256
    buffer_load_dword v50, v111, s[20:23], s3 offen offset:512
    buffer_load_dword v51, v111, s[20:23], s3 offen offset:768
    s_mul_i32 s22, s53, 25424
    s_movk_i32 s3, 24576

    buffer_load_dword v52, v100, s[20:23], s3 offen
    s_mul_i32 s3, s50, 50048
    s_add_u32 s3, s3, s54
    s_add_u32 s54, s3, 393216

    s_mov_b32 s8, s80
    s_mov_b32 s9, s81
    s_mov_b32 s10, 0
    s_mov_b32 s11, 0x20000
    s_mov_b32 s12, s82
    s_mov_b32 s13, s83
    s_mov_b32 s14, 0
    s_mov_b32 s15, 0x20000
    s_mov_b32 s16, s84
    s_mov_b32 s17, s85
    s_mov_b32 s18, 0
    s_mov_b32 s19, 0x20000
    s_lshr_b32 s74, s2, 1
    s_and_b32 s74, s74, 28
    s_lshr_b32 s86, 0x00102010, s74
    s_lshr_b32 s87, 0x44414241, s74
    s_lshr_b32 s41, 0x43221100, s74
    s_and_b32 s86, s86, 15
    s_and_b32 s87, s87, 15
    s_and_b32 s41, s41, 15
    s_lshr_b32 s74, s2, 6
    s_lshl_b32 s74, s74, 3
    s_and_b32 s75, s2, 7
    s_add_u32 s74, s74, s75
    s_mul_i32 s74, s74, 5
    s_add_u32 s41, s41, s74

    s_mul_i32 s78, s41, 16000
    s_add_u32 s49, s78, 16000
    s_cmp_ge_u32 s41, 3200
    s_cmovk_i32 s49, 0
    s_cmovk_i32 s78, 0
    s_lshl_b32 s10, s49, 2
    s_lshl_b32 s14, s49, 2
    s_lshl_b32 s18, s49, 1
    s_sub_u32 s79, s87, s86
    s_bfm_b32 s85, s79, s86
    s_lshl_b32 s86, s86, 12
    s_lshl_b32 s87, s87, 12
    s_min_u32 s87, s87, 16000

    s_add_u32 s79, s78, 0
    s_bitcmp1_b32 s85, 0
    s_cselect_b32 s79, s79, 0x1ff00000
    s_lshl_b32 s56, s79, 2
    s_lshl_b32 s61, s79, 1

    s_add_u32 s79, s78, 4096
    s_bitcmp1_b32 s85, 1
    s_cselect_b32 s79, s79, 0x1ff00000
    s_lshl_b32 s57, s79, 2
    s_lshl_b32 s62, s79, 1

    s_add_u32 s79, s78, 8192
    s_bitcmp1_b32 s85, 2
    s_cselect_b32 s79, s79, 0x1ff00000
    s_lshl_b32 s58, s79, 2
    s_lshl_b32 s63, s79, 1

    s_add_u32 s79, s78, 12288
    s_bitcmp1_b32 s85, 3
    s_cselect_b32 s79, s79, 0x1ff00000
    s_lshl_b32 s59, s79, 2
    s_lshl_b32 s64, s79, 1

    buffer_load_dwordx4 v[20:23], v1, s[12:15], s56 offen nt
    buffer_load_dwordx4 v[4:7], v1, s[8:11], s56 offen nt
    buffer_load_dwordx2 v[36:37], v2, s[16:19], s61 offen nt
    buffer_load_dwordx4 v[24:27], v1, s[12:15], s57 offen nt
    buffer_load_dwordx4 v[8:11], v1, s[8:11], s57 offen nt
    buffer_load_dwordx2 v[38:39], v2, s[16:19], s62 offen nt
    buffer_load_dwordx4 v[28:31], v1, s[12:15], s58 offen nt
    buffer_load_dwordx4 v[12:15], v1, s[8:11], s58 offen nt
    buffer_load_dwordx2 v[40:41], v2, s[16:19], s63 offen nt
    buffer_load_dwordx4 v[32:35], v1, s[12:15], s59 offen nt
    buffer_load_dwordx4 v[16:19], v1, s[8:11], s59 offen nt
    buffer_load_dwordx2 v[42:43], v2, s[16:19], s64 offen nt
    s_and_b32 s5, s2, 7
    s_mul_i32 s3, s5, 8192

    s_add_u32 s20, s6, s3
    s_addc_u32 s21, s7, 0
    s_mov_b32 s22, 8192
    s_mov_b32 s23, 0x20000
    s_mul_i32 s3, s5, 40632320
    s_add_u32 s3, s3, 83599360
    s_add_u32 s24, s6, s3
    s_addc_u32 s25, s7, 0
    s_mov_b32 s26, 40632320
    s_mov_b32 s27, 0x20000
    s_add_u32 s32, s6, 408657920
    s_addc_u32 s33, s7, 0
    s_mov_b32 s34, 409600000
    s_mov_b32 s35, 0x20000
    s_add_u32 s36, s6, 65536
    s_addc_u32 s37, s7, 0
    s_mov_b32 s38, 4
    s_mov_b32 s39, 0x20000
    s_mov_b32 s40, 687195
    s_mov_b32 s42, -6250
    s_mov_b32 s43, 1942
    s_mov_b32 s45, 0x06050400
    s_mov_b32 s46, 0x05040c00
    s_mov_b32 s47, 0x04020100
    s_mov_b32 s48, 3968
    s_mov_b32 s50, 0
    v_mov_b32 v104, 1
    v_mov_b32 v105, 0x46ff8000
    s_mov_b32 s55, 0x05040100
    v_mul_u32_u24 v106, 5, v0
    v_mov_b32 v108, 16384
    v_mov_b32 v114, 0
    v_mov_b32 v115, 0
    v_mov_b32 v116, 0
    v_mov_b32 v117, -1
    ds_write_b64 v2, v[114:115]
    s_movk_i32 s3, 928
    v_cmp_gt_u32 s[66:67], s3, v0
    s_movk_i32 s3, 640
    v_cmp_gt_u32 s[68:69], s3, v0
    s_mov_b64 exec, 1
    ds_write_b128 v108, v[114:117]
    s_mov_b64 exec, -1
    s_waitcnt lgkmcnt(0)
    s_lshl_b32 s88, s88, 16
    v_mov_b32 v110, 0.15915494
    v_mul_f32 v110, s88, v110
    s_mov_b32 s3, 0x7fff7fff
    v_readfirstlane_b32 s44, v110

    s_waitcnt vmcnt(12)
    v_mov_b32 v61, 0
    v_mov_b32 v62, 0
    v_mov_b32 v63, 0
    v_dot2_f32_bf16 v61, v44, v44, v61
    v_dot2_f32_bf16 v61, v45, v45, v61
    v_dot2_f32_bf16 v61, v46, v46, v61
    v_dot2_f32_bf16 v61, v47, v47, v61
    v_dot2_f32_bf16 v61, v48, v48, v61
    v_dot2_f32_bf16 v61, v49, v49, v61
    v_dot2_f32_bf16 v61, v50, v50, v61
    v_dot2_f32_bf16 v61, v51, v51, v61
    v_dot2_f32_bf16 v61, v52, v52, v61
    v_dot2_f32_bf16 v62, v56, v56, v62
    v_dot2_f32_bf16 v62, v57, v57, v62
    v_dot2_f32_bf16 v62, v58, v58, v62
    v_dot2_f32_bf16 v62, v59, v59, v62
    v_and_b32 v60, s3, v44
    v_and_b32 v64, s3, v45
    v_pk_max_u16 v60, v60, v64
    v_and_b32 v64, s3, v46
    v_pk_max_u16 v60, v60, v64
    v_and_b32 v64, s3, v47
    v_pk_max_u16 v60, v60, v64
    v_and_b32 v64, s3, v48
    v_pk_max_u16 v60, v60, v64
    v_and_b32 v64, s3, v49
    v_pk_max_u16 v60, v60, v64
    v_and_b32 v64, s3, v50
    v_pk_max_u16 v60, v60, v64
    v_and_b32 v64, s3, v51
    v_pk_max_u16 v60, v60, v64
    v_and_b32 v64, s3, v52
    v_pk_max_u16 v60, v60, v64
    v_lshrrev_b32 v64, 16, v60
    v_and_b32 v60, 0xffff, v60
    v_max_u32 v60, v60, v64

    s_nop 1
    v_max_u32_dpp v60, v60, v60 row_shr:1 row_mask:0xf bank_mask:0xf
    s_nop 1
    v_max_u32_dpp v60, v60, v60 row_shr:2 row_mask:0xf bank_mask:0xf
    s_nop 1
    v_max_u32_dpp v60, v60, v60 row_shr:4 row_mask:0xf bank_mask:0xf
    s_nop 1
    v_max_u32_dpp v60, v60, v60 row_shr:8 row_mask:0xf bank_mask:0xf
    s_nop 1
    v_max_u32_dpp v60, v60, v60 row_bcast:15 row_mask:0xa bank_mask:0xf
    s_nop 1
    v_max_u32_dpp v60, v60, v60 row_bcast:31 row_mask:0xc bank_mask:0xf
    s_nop 1
    v_add_f32_dpp v61, v61, v61 row_shr:1 row_mask:0xf bank_mask:0xf
    s_nop 1
    v_add_f32_dpp v61, v61, v61 row_shr:2 row_mask:0xf bank_mask:0xf
    s_nop 1
    v_add_f32_dpp v61, v61, v61 row_shr:4 row_mask:0xf bank_mask:0xf
    s_nop 1
    v_add_f32_dpp v61, v61, v61 row_shr:8 row_mask:0xf bank_mask:0xf
    s_nop 1
    v_add_f32_dpp v61, v61, v61 row_bcast:15 row_mask:0xa bank_mask:0xf
    s_nop 1
    v_add_f32_dpp v61, v61, v61 row_bcast:31 row_mask:0xc bank_mask:0xf
    s_nop 1
    v_add_f32_dpp v62, v62, v62 row_shr:1 row_mask:0xf bank_mask:0xf
    s_nop 1
    v_add_f32_dpp v62, v62, v62 row_shr:2 row_mask:0xf bank_mask:0xf
    s_nop 1
    v_add_f32_dpp v62, v62, v62 row_shr:4 row_mask:0xf bank_mask:0xf
    s_nop 1
    v_add_f32_dpp v62, v62, v62 row_shr:8 row_mask:0xf bank_mask:0xf
    s_nop 1
    v_add_f32_dpp v62, v62, v62 row_bcast:15 row_mask:0xa bank_mask:0xf
    s_nop 1
    v_add_f32_dpp v62, v62, v62 row_bcast:31 row_mask:0xc bank_mask:0xf
    v_lshrrev_b32 v64, 6, v0
    v_lshlrev_b32 v64, 4, v64
    s_mov_b32 exec_lo, 0
    s_brev_b32 exec_hi, 1
    ds_write_b128 v64, v[60:63] offset:8192
    s_mov_b64 exec, -1
    v_and_b32 v64, 15, v0
    v_lshlrev_b32 v64, 4, v64
    s_waitcnt lgkmcnt(0)
    s_barrier
    ds_read_b128 v[60:63], v64 offset:8192
    s_waitcnt lgkmcnt(0)

    s_nop 0
    v_max_u32_dpp v60, v60, v60 row_ror:1 row_mask:0xf bank_mask:0xf
    v_add_f32_dpp v61, v61, v61 row_ror:1 row_mask:0xf bank_mask:0xf
    v_add_f32_dpp v62, v62, v62 row_ror:1 row_mask:0xf bank_mask:0xf

    s_nop 0
    v_max_u32_dpp v60, v60, v60 row_ror:2 row_mask:0xf bank_mask:0xf
    v_add_f32_dpp v61, v61, v61 row_ror:2 row_mask:0xf bank_mask:0xf
    v_add_f32_dpp v62, v62, v62 row_ror:2 row_mask:0xf bank_mask:0xf

    s_nop 0
    v_max_u32_dpp v60, v60, v60 row_ror:4 row_mask:0xf bank_mask:0xf
    v_add_f32_dpp v61, v61, v61 row_ror:4 row_mask:0xf bank_mask:0xf
    v_add_f32_dpp v62, v62, v62 row_ror:4 row_mask:0xf bank_mask:0xf

    s_nop 0
    v_max_u32_dpp v60, v60, v60 row_ror:8 row_mask:0xf bank_mask:0xf
    v_add_f32_dpp v61, v61, v61 row_ror:8 row_mask:0xf bank_mask:0xf
    v_add_f32_dpp v62, v62, v62 row_ror:8 row_mask:0xf bank_mask:0xf

    v_rsq_f32 v62, v62
    v_mov_b32 v65, 0x4b400000
    v_mul_f32 v62, 0x47decb04, v62
    s_nop 0
    v_readfirstlane_b32 s74, v62

    s_add_u32 s92, s6, 135168
    s_addc_u32 s93, s7, 0
    s_mov_b32 s94, 4096
    s_mov_b32 s95, 0x20000
    s_lshl_b32 s3, s2, 4
    buffer_store_dwordx4 v[60:63], v98, s[92:95], s3 offen
    v_lshlrev_b32 v66, 16, v44
    v_and_b32 v44, 0xffff0000, v44
    v_fma_f32 v66, v66, s74, v65
    v_fma_f32 v44, v44, s74, v65
    v_perm_b32 v44, v44, v66, s55

    v_lshlrev_b32 v66, 16, v45
    v_and_b32 v45, 0xffff0000, v45
    v_fma_f32 v66, v66, s74, v65
    v_fma_f32 v45, v45, s74, v65
    v_perm_b32 v45, v45, v66, s55

    v_lshlrev_b32 v66, 16, v46
    v_and_b32 v46, 0xffff0000, v46
    v_fma_f32 v66, v66, s74, v65
    v_fma_f32 v46, v46, s74, v65
    v_perm_b32 v46, v46, v66, s55

    v_lshlrev_b32 v66, 16, v47
    v_and_b32 v47, 0xffff0000, v47
    v_fma_f32 v66, v66, s74, v65
    v_fma_f32 v47, v47, s74, v65
    v_perm_b32 v47, v47, v66, s55

    v_lshlrev_b32 v66, 16, v48
    v_and_b32 v48, 0xffff0000, v48
    v_fma_f32 v66, v66, s74, v65
    v_fma_f32 v48, v48, s74, v65
    v_perm_b32 v48, v48, v66, s55

    v_lshlrev_b32 v66, 16, v49
    v_and_b32 v49, 0xffff0000, v49
    v_fma_f32 v66, v66, s74, v65
    v_fma_f32 v49, v49, s74, v65
    v_perm_b32 v49, v49, v66, s55

    v_lshlrev_b32 v66, 16, v50
    v_and_b32 v50, 0xffff0000, v50
    v_fma_f32 v66, v66, s74, v65
    v_fma_f32 v50, v50, s74, v65
    v_perm_b32 v50, v50, v66, s55

    v_lshlrev_b32 v66, 16, v51
    v_and_b32 v51, 0xffff0000, v51
    v_fma_f32 v66, v66, s74, v65
    v_fma_f32 v51, v51, s74, v65
    v_perm_b32 v51, v51, v66, s55

    v_lshlrev_b32 v66, 16, v52
    v_and_b32 v52, 0xffff0000, v52
    v_fma_f32 v66, v66, s74, v65
    v_fma_f32 v52, v52, s74, v65
    v_perm_b32 v52, v52, v66, s55

    s_add_u32 s92, s6, s54
    s_addc_u32 s93, s7, 0
    s_mov_b32 s94, 24576
    s_mov_b32 s95, 0x20000
    s_movk_i32 s3, 16384
    buffer_store_dwordx4 v[44:47], v1, s[92:95], 0 offen
    buffer_store_dwordx4 v[48:51], v1, s[92:95], s3 offen
    s_mul_i32 s94, s53, 25424
    s_movk_i32 s3, 24576

    buffer_store_dword v52, v100, s[92:95], s3 offen
    s_nop 1
    s_mov_b32 s82, s85
    s_mov_b32 s83, s86
    s_mov_b32 s84, s87
    v_mov_b32 v99, 1
    buffer_atomic_add v99, v98, s[96:99], 0 offen sc0
    v_mov_b32 v100, 0
    buffer_atomic_add v100, v98, s[96:99], 0 offen offset:128 sc0
    s_waitcnt vmcnt(15)
    s_bitcmp0_b32 s82, 0
    s_cbranch_scc1 L_ska_7
    v_mul_hi_u32_u24 v45, s40, v20
    v_mul_hi_u32_u24 v44, s40, v4
    v_mul_hi_u32_u24 v47, s40, v21
    v_mul_hi_u32_u24 v46, s40, v5
    v_mul_hi_u32_u24 v49, s40, v22
    v_mul_hi_u32_u24 v48, s40, v6
    v_mul_hi_u32_u24 v51, s40, v23
    v_mul_hi_u32_u24 v50, s40, v7
    v_and_b32 v45, -2, v45
    v_mad_u32_u24 v4, v44, s43, v4
    v_and_b32 v76, -4, v44
    v_and_b32 v47, -2, v47
    v_mad_u32_u24 v5, v46, s43, v5
    v_and_b32 v77, -4, v46
    v_and_b32 v49, -2, v49
    v_mad_u32_u24 v6, v48, s43, v6
    v_and_b32 v78, -4, v48
    v_and_b32 v51, -2, v51
    v_mad_u32_u24 v7, v50, s43, v7
    v_and_b32 v79, -4, v50
    v_mad_i32_i24 v20, v45, s42, v20
    v_lshl_add_u32 v45, v76, 5, v45
    v_mad_i32_i24 v21, v47, s42, v21
    v_lshl_add_u32 v47, v77, 5, v47
    v_mad_i32_i24 v22, v49, s42, v22
    v_lshl_add_u32 v49, v78, 5, v49
    v_mad_i32_i24 v23, v51, s42, v23
    v_lshl_add_u32 v51, v79, 5, v51
    v_add_u32 v45, v45, v45
    ds_add_rtn_u32 v76, v45, v104
    v_add_u32 v47, v47, v47
    ds_add_rtn_u32 v77, v47, v104
    v_add_u32 v49, v49, v49
    ds_add_rtn_u32 v78, v49, v104
    v_add_u32 v51, v51, v51
    ds_add_rtn_u32 v79, v51, v104
    v_lshlrev_b32 v110, 16, v36
    v_and_b32 v111, 0xffff0000, v36
    v_lshlrev_b32 v112, 16, v37
    v_and_b32 v113, 0xffff0000, v37
    v_mul_f32 v110, s44, v110
    v_mul_f32 v111, s44, v111
    v_mul_f32 v112, s44, v112
    v_mul_f32 v113, s44, v113
    v_fract_f32 v110, v110
    v_fract_f32 v111, v111
    v_fract_f32 v112, v112
    v_fract_f32 v113, v113
    v_cos_f32 v110, v110
    v_cos_f32 v111, v111
    v_cos_f32 v112, v112
    v_cos_f32 v113, v113
    v_lshl_or_b32 v44, v44, 14, v20
    v_perm_b32 v45, v45, v4, s46
    v_bfe_u32 v4, v4, 8, 5

    v_lshl_or_b32 v46, v46, 14, v21
    v_perm_b32 v47, v47, v5, s46
    v_bfe_u32 v5, v5, 8, 5

    v_lshl_or_b32 v48, v48, 14, v22
    v_perm_b32 v49, v49, v6, s46
    v_bfe_u32 v6, v6, 8, 5

    v_lshl_or_b32 v50, v50, 14, v23
    v_perm_b32 v51, v51, v7, s46
    v_bfe_u32 v7, v7, 8, 5

    v_fmaak_f32 v110, v110, v105, 0x4b400010
    v_fmaak_f32 v111, v111, v105, 0x4b400010
    v_fmaak_f32 v112, v112, v105, 0x4b400010
    v_fmaak_f32 v113, v113, v105, 0x4b400010
    v_sub_u32 v110, v110, v4
    v_sub_u32 v111, v111, v5
    v_sub_u32 v112, v112, v6
    v_sub_u32 v113, v113, v7
    v_bfi_b32 v110, 31, v4, v110
    v_bfi_b32 v111, 31, v5, v111
    v_bfi_b32 v112, 31, v6, v112
    v_bfi_b32 v113, 31, v7, v113
    v_perm_b32 v44, v44, v110, s55
    v_perm_b32 v46, v46, v111, s55
    v_perm_b32 v48, v48, v112, s55
    v_perm_b32 v50, v50, v113, s55
L_ska_7:
    s_waitcnt vmcnt(12)
    s_bitcmp0_b32 s82, 1
    s_cbranch_scc1 L_ska_8
    v_mul_hi_u32_u24 v53, s40, v24
    v_mul_hi_u32_u24 v52, s40, v8
    v_mul_hi_u32_u24 v55, s40, v25
    v_mul_hi_u32_u24 v54, s40, v9
    v_mul_hi_u32_u24 v57, s40, v26
    v_mul_hi_u32_u24 v56, s40, v10
    v_mul_hi_u32_u24 v59, s40, v27
    v_mul_hi_u32_u24 v58, s40, v11
    v_and_b32 v53, -2, v53
    v_mad_u32_u24 v8, v52, s43, v8
    v_and_b32 v80, -4, v52
    v_and_b32 v55, -2, v55
    v_mad_u32_u24 v9, v54, s43, v9
    v_and_b32 v81, -4, v54
    v_and_b32 v57, -2, v57
    v_mad_u32_u24 v10, v56, s43, v10
    v_and_b32 v82, -4, v56
    v_and_b32 v59, -2, v59
    v_mad_u32_u24 v11, v58, s43, v11
    v_and_b32 v83, -4, v58
    v_mad_i32_i24 v24, v53, s42, v24
    v_lshl_add_u32 v53, v80, 5, v53
    v_mad_i32_i24 v25, v55, s42, v25
    v_lshl_add_u32 v55, v81, 5, v55
    v_mad_i32_i24 v26, v57, s42, v26
    v_lshl_add_u32 v57, v82, 5, v57
    v_mad_i32_i24 v27, v59, s42, v27
    v_lshl_add_u32 v59, v83, 5, v59
    v_add_u32 v53, v53, v53
    ds_add_rtn_u32 v80, v53, v104
    v_add_u32 v55, v55, v55
    ds_add_rtn_u32 v81, v55, v104
    v_add_u32 v57, v57, v57
    ds_add_rtn_u32 v82, v57, v104
    v_add_u32 v59, v59, v59
    ds_add_rtn_u32 v83, v59, v104
    v_lshlrev_b32 v110, 16, v38
    v_and_b32 v111, 0xffff0000, v38
    v_lshlrev_b32 v112, 16, v39
    v_and_b32 v113, 0xffff0000, v39
    v_mul_f32 v110, s44, v110
    v_mul_f32 v111, s44, v111
    v_mul_f32 v112, s44, v112
    v_mul_f32 v113, s44, v113
    v_fract_f32 v110, v110
    v_fract_f32 v111, v111
    v_fract_f32 v112, v112
    v_fract_f32 v113, v113
    v_cos_f32 v110, v110
    v_cos_f32 v111, v111
    v_cos_f32 v112, v112
    v_cos_f32 v113, v113
    v_lshl_or_b32 v52, v52, 14, v24
    v_perm_b32 v53, v53, v8, s46
    v_bfe_u32 v8, v8, 8, 5

    v_lshl_or_b32 v54, v54, 14, v25
    v_perm_b32 v55, v55, v9, s46
    v_bfe_u32 v9, v9, 8, 5

    v_lshl_or_b32 v56, v56, 14, v26
    v_perm_b32 v57, v57, v10, s46
    v_bfe_u32 v10, v10, 8, 5

    v_lshl_or_b32 v58, v58, 14, v27
    v_perm_b32 v59, v59, v11, s46
    v_bfe_u32 v11, v11, 8, 5

    v_fmaak_f32 v110, v110, v105, 0x4b400010
    v_fmaak_f32 v111, v111, v105, 0x4b400010
    v_fmaak_f32 v112, v112, v105, 0x4b400010
    v_fmaak_f32 v113, v113, v105, 0x4b400010
    v_sub_u32 v110, v110, v8
    v_sub_u32 v111, v111, v9
    v_sub_u32 v112, v112, v10
    v_sub_u32 v113, v113, v11
    v_bfi_b32 v110, 31, v8, v110
    v_bfi_b32 v111, 31, v9, v111
    v_bfi_b32 v112, 31, v10, v112
    v_bfi_b32 v113, 31, v11, v113
    v_perm_b32 v52, v52, v110, s55
    v_perm_b32 v54, v54, v111, s55
    v_perm_b32 v56, v56, v112, s55
    v_perm_b32 v58, v58, v113, s55
L_ska_8:
    s_waitcnt vmcnt(9)
    s_bitcmp0_b32 s82, 2
    s_cbranch_scc1 L_ska_9
    v_mul_hi_u32_u24 v61, s40, v28
    v_mul_hi_u32_u24 v60, s40, v12
    v_mul_hi_u32_u24 v63, s40, v29
    v_mul_hi_u32_u24 v62, s40, v13
    v_mul_hi_u32_u24 v65, s40, v30
    v_mul_hi_u32_u24 v64, s40, v14
    v_mul_hi_u32_u24 v67, s40, v31
    v_mul_hi_u32_u24 v66, s40, v15
    v_and_b32 v61, -2, v61
    v_mad_u32_u24 v12, v60, s43, v12
    v_and_b32 v84, -4, v60
    v_and_b32 v63, -2, v63
    v_mad_u32_u24 v13, v62, s43, v13
    v_and_b32 v85, -4, v62
    v_and_b32 v65, -2, v65
    v_mad_u32_u24 v14, v64, s43, v14
    v_and_b32 v86, -4, v64
    v_and_b32 v67, -2, v67
    v_mad_u32_u24 v15, v66, s43, v15
    v_and_b32 v87, -4, v66
    v_mad_i32_i24 v28, v61, s42, v28
    v_lshl_add_u32 v61, v84, 5, v61
    v_mad_i32_i24 v29, v63, s42, v29
    v_lshl_add_u32 v63, v85, 5, v63
    v_mad_i32_i24 v30, v65, s42, v30
    v_lshl_add_u32 v65, v86, 5, v65
    v_mad_i32_i24 v31, v67, s42, v31
    v_lshl_add_u32 v67, v87, 5, v67
    v_add_u32 v61, v61, v61
    ds_add_rtn_u32 v84, v61, v104
    v_add_u32 v63, v63, v63
    ds_add_rtn_u32 v85, v63, v104
    v_add_u32 v65, v65, v65
    ds_add_rtn_u32 v86, v65, v104
    v_add_u32 v67, v67, v67
    ds_add_rtn_u32 v87, v67, v104
    v_lshlrev_b32 v110, 16, v40
    v_and_b32 v111, 0xffff0000, v40
    v_lshlrev_b32 v112, 16, v41
    v_and_b32 v113, 0xffff0000, v41
    v_mul_f32 v110, s44, v110
    v_mul_f32 v111, s44, v111
    v_mul_f32 v112, s44, v112
    v_mul_f32 v113, s44, v113
    v_fract_f32 v110, v110
    v_fract_f32 v111, v111
    v_fract_f32 v112, v112
    v_fract_f32 v113, v113
    v_cos_f32 v110, v110
    v_cos_f32 v111, v111
    v_cos_f32 v112, v112
    v_cos_f32 v113, v113
    v_lshl_or_b32 v60, v60, 14, v28
    v_perm_b32 v61, v61, v12, s46
    v_bfe_u32 v12, v12, 8, 5

    v_lshl_or_b32 v62, v62, 14, v29
    v_perm_b32 v63, v63, v13, s46
    v_bfe_u32 v13, v13, 8, 5

    v_lshl_or_b32 v64, v64, 14, v30
    v_perm_b32 v65, v65, v14, s46
    v_bfe_u32 v14, v14, 8, 5

    v_lshl_or_b32 v66, v66, 14, v31
    v_perm_b32 v67, v67, v15, s46
    v_bfe_u32 v15, v15, 8, 5

    v_fmaak_f32 v110, v110, v105, 0x4b400010
    v_fmaak_f32 v111, v111, v105, 0x4b400010
    v_fmaak_f32 v112, v112, v105, 0x4b400010
    v_fmaak_f32 v113, v113, v105, 0x4b400010
    v_sub_u32 v110, v110, v12
    v_sub_u32 v111, v111, v13
    v_sub_u32 v112, v112, v14
    v_sub_u32 v113, v113, v15
    v_bfi_b32 v110, 31, v12, v110
    v_bfi_b32 v111, 31, v13, v111
    v_bfi_b32 v112, 31, v14, v112
    v_bfi_b32 v113, 31, v15, v113
    v_perm_b32 v60, v60, v110, s55
    v_perm_b32 v62, v62, v111, s55
    v_perm_b32 v64, v64, v112, s55
    v_perm_b32 v66, v66, v113, s55
L_ska_9:
    s_waitcnt vmcnt(6)
    s_bitcmp0_b32 s82, 3
    s_cbranch_scc1 L_ska_10
    s_mov_b64 exec, s[66:67]
    v_mul_hi_u32_u24 v69, s40, v32
    v_mul_hi_u32_u24 v68, s40, v16
    v_mul_hi_u32_u24 v71, s40, v33
    v_mul_hi_u32_u24 v70, s40, v17
    v_mul_hi_u32_u24 v73, s40, v34
    v_mul_hi_u32_u24 v72, s40, v18
    v_mul_hi_u32_u24 v75, s40, v35
    v_mul_hi_u32_u24 v74, s40, v19
    v_and_b32 v69, -2, v69
    v_mad_u32_u24 v16, v68, s43, v16
    v_and_b32 v88, -4, v68
    v_and_b32 v71, -2, v71
    v_mad_u32_u24 v17, v70, s43, v17
    v_and_b32 v89, -4, v70
    v_and_b32 v73, -2, v73
    v_mad_u32_u24 v18, v72, s43, v18
    v_and_b32 v90, -4, v72
    v_and_b32 v75, -2, v75
    v_mad_u32_u24 v19, v74, s43, v19
    v_and_b32 v91, -4, v74
    v_mad_i32_i24 v32, v69, s42, v32
    v_lshl_add_u32 v69, v88, 5, v69
    v_mad_i32_i24 v33, v71, s42, v33
    v_lshl_add_u32 v71, v89, 5, v71
    v_mad_i32_i24 v34, v73, s42, v34
    v_lshl_add_u32 v73, v90, 5, v73
    v_mad_i32_i24 v35, v75, s42, v35
    v_lshl_add_u32 v75, v91, 5, v75
    v_add_u32 v69, v69, v69
    ds_add_rtn_u32 v88, v69, v104
    v_add_u32 v71, v71, v71
    ds_add_rtn_u32 v89, v71, v104
    v_add_u32 v73, v73, v73
    ds_add_rtn_u32 v90, v73, v104
    v_add_u32 v75, v75, v75
    ds_add_rtn_u32 v91, v75, v104
    v_lshlrev_b32 v110, 16, v42
    v_and_b32 v111, 0xffff0000, v42
    v_lshlrev_b32 v112, 16, v43
    v_and_b32 v113, 0xffff0000, v43
    v_mul_f32 v110, s44, v110
    v_mul_f32 v111, s44, v111
    v_mul_f32 v112, s44, v112
    v_mul_f32 v113, s44, v113
    v_fract_f32 v110, v110
    v_fract_f32 v111, v111
    v_fract_f32 v112, v112
    v_fract_f32 v113, v113
    v_cos_f32 v110, v110
    v_cos_f32 v111, v111
    v_cos_f32 v112, v112
    v_cos_f32 v113, v113
    v_lshl_or_b32 v68, v68, 14, v32
    v_perm_b32 v69, v69, v16, s46
    v_bfe_u32 v16, v16, 8, 5

    v_lshl_or_b32 v70, v70, 14, v33
    v_perm_b32 v71, v71, v17, s46
    v_bfe_u32 v17, v17, 8, 5

    v_lshl_or_b32 v72, v72, 14, v34
    v_perm_b32 v73, v73, v18, s46
    v_bfe_u32 v18, v18, 8, 5

    v_lshl_or_b32 v74, v74, 14, v35
    v_perm_b32 v75, v75, v19, s46
    v_bfe_u32 v19, v19, 8, 5

    v_fmaak_f32 v110, v110, v105, 0x4b400010
    v_fmaak_f32 v111, v111, v105, 0x4b400010
    v_fmaak_f32 v112, v112, v105, 0x4b400010
    v_fmaak_f32 v113, v113, v105, 0x4b400010
    v_sub_u32 v110, v110, v16
    v_sub_u32 v111, v111, v17
    v_sub_u32 v112, v112, v18
    v_sub_u32 v113, v113, v19
    v_bfi_b32 v110, 31, v16, v110
    v_bfi_b32 v111, 31, v17, v111
    v_bfi_b32 v112, 31, v18, v112
    v_bfi_b32 v113, 31, v19, v113
    v_perm_b32 v68, v68, v110, s55
    v_perm_b32 v70, v70, v111, s55
    v_perm_b32 v72, v72, v112, s55
    v_perm_b32 v74, v74, v113, s55
    s_mov_b64 exec, -1
L_ska_10:
    s_waitcnt vmcnt(0)
    v_or_b32 v100, v100, v0
    s_nop 0
    v_readfirstlane_b32 s74, v100
    s_nop 1
    s_cmp_lg_u32 s74, 0
    s_cbranch_scc1 L_ready_12

    v_mov_b32 v110, 1
    buffer_atomic_add v110, v98, s[96:99], 0 offen offset:64 sc0
    s_waitcnt vmcnt(0)
    v_readfirstlane_b32 s74, v110
    s_nop 1
    s_cmp_lg_u32 s74, 0
    s_cbranch_scc1 L_zno_14

    s_mov_b32 s92, s6
    s_mov_b32 s93, s7
    s_mov_b32 s94, 65552
    s_mov_b32 s95, 0x20000
    v_mov_b32 v110, 0
    v_mov_b32 v111, 0
    v_mov_b32 v112, 0
    v_mov_b32 v113, 0
L_zl_13:
    buffer_store_dwordx4 v[110:113], v1, s[92:95], s74 offen sc0 sc1
    s_add_u32 s74, s74, 1024
    s_cmp_le_u32 s74, 65536
    s_cbranch_scc1 L_zl_13
    v_mov_b32 v114, 1
    s_waitcnt vmcnt(0)
    buffer_atomic_add v114, v98, s[96:99], 0 offen offset:128
L_zno_14:

L_spin_11:
    v_mov_b32 v100, 0
    buffer_atomic_add v100, v98, s[96:99], 0 offen offset:128 sc0
    s_waitcnt vmcnt(0)
    v_readfirstlane_b32 s74, v100
    s_nop 1
    s_cmp_eq_u32 s74, 0
    s_cbranch_scc1 L_spin_11
L_ready_12:

    v_cmp_eq_u32 vcc, 0, v0
    s_waitcnt vmcnt(1)
    s_mov_b64 exec, vcc
    ds_write_b32 v108, v99 offset:8
    s_mov_b64 exec, -1
    s_waitcnt lgkmcnt(0)
    s_barrier

    ds_read2_b32 v[110:111], v108 offset0:1 offset1:2
    ds_read_b64 v[94:95], v2
    s_waitcnt lgkmcnt(0)
    v_readfirstlane_b32 s53, v110
    v_readfirstlane_b32 s41, v111

    v_and_b32 v94, 0xffff, v94
    v_and_b32 v95, 0xffff, v95
    v_add_u32 v97, v94, v95
    s_nop 1
    v_add_u32_dpp v97, v97, v97 row_shr:1 row_mask:0xf bank_mask:0xf
    s_nop 1
    v_add_u32_dpp v97, v97, v97 row_shr:2 row_mask:0xf bank_mask:0xf
    s_nop 1
    v_add_u32_dpp v97, v97, v97 row_shr:4 row_mask:0xf bank_mask:0xf
    s_nop 1
    v_add_u32_dpp v97, v97, v97 row_shr:8 row_mask:0xf bank_mask:0xf
    s_nop 1
    v_add_u32_dpp v97, v97, v97 row_bcast:15 row_mask:0xa bank_mask:0xf
    s_nop 1
    v_add_u32_dpp v97, v97, v97 row_bcast:31 row_mask:0xc bank_mask:0xf
    s_mov_b32 exec_lo, 0
    s_brev_b32 exec_hi, 1
    ds_add_rtn_u32 v96, v108, v97
    s_mov_b64 exec, -1

    v_add_u32 v92, v94, v94
    v_add_u32 v93, v95, v95
    v_med3_u32 v92, v94, 2, v92
    v_med3_u32 v93, v95, 2, v93
    buffer_atomic_add_x2 v[92:93], v2, s[20:23], 0 offen sc0
    s_add_u32 s41, s41, 160
    s_sub_u32 s78, s41, 3008
    s_lshr_b32 s79, s78, 1
    s_add_u32 s79, s79, 3008
    s_and_b32 s86, s78, 1
    s_lshl_b32 s86, s86, 1
    s_add_u32 s87, s86, 2
    s_cmp_lt_u32 s41, 3008
    s_cselect_b32 s41, s41, s79
    s_cmovk_i32 s86, 0
    s_cmovk_i32 s87, 4

    s_mul_i32 s78, s41, 16000
    s_add_u32 s49, s78, 16000
    s_cmp_ge_u32 s41, 3200
    s_cmovk_i32 s49, 0
    s_cmovk_i32 s78, 0
    s_lshl_b32 s10, s49, 2
    s_lshl_b32 s14, s49, 2
    s_lshl_b32 s18, s49, 1
    s_sub_u32 s79, s87, s86
    s_bfm_b32 s85, s79, s86
    s_lshl_b32 s86, s86, 12
    s_lshl_b32 s87, s87, 12
    s_min_u32 s87, s87, 16000

    s_add_u32 s79, s78, 0
    s_bitcmp1_b32 s85, 0
    s_cselect_b32 s79, s79, 0x1ff00000
    s_lshl_b32 s56, s79, 2
    s_lshl_b32 s61, s79, 1

    s_add_u32 s79, s78, 4096
    s_bitcmp1_b32 s85, 1
    s_cselect_b32 s79, s79, 0x1ff00000
    s_lshl_b32 s57, s79, 2
    s_lshl_b32 s62, s79, 1

    s_add_u32 s79, s78, 8192
    s_bitcmp1_b32 s85, 2
    s_cselect_b32 s79, s79, 0x1ff00000
    s_lshl_b32 s58, s79, 2
    s_lshl_b32 s63, s79, 1

    s_add_u32 s79, s78, 12288
    s_bitcmp1_b32 s85, 3
    s_cselect_b32 s79, s79, 0x1ff00000
    s_lshl_b32 s59, s79, 2
    s_lshl_b32 s64, s79, 1

    s_waitcnt lgkmcnt(0)
    v_readlane_b32 s77, v96, 63
    v_mul_u32_u24 v114, 7936, v0
    v_sub_u32 v97, v97, v95
    s_sub_u32 s50, s50, s83
    s_sub_u32 s77, s77, s50
    v_add_u32 v97, s77, v97
    v_sub_u32 v96, v97, v94
    v_lshlrev_b32 v111, 16, v97
    v_lshlrev_b32 v110, 16, v96
    ds_write_b64 v2, v[110:111]
    v_sub_u32 v96, v114, v96
    v_sub_u32 v97, v114, v97
    v_add_u32 v97, s48, v97
    s_add_u32 s50, s50, s84
    s_mov_b32 s28, s82
    s_mov_b32 s29, s83
    s_mov_b32 s30, s84
    s_lshl_b32 s74, s29, 3
    s_lshl_b32 s75, s30, 3
    v_mov_b32 v125, s74
    v_mov_b32 v126, s75
    v_mov_b32 v127, -1

    s_waitcnt lgkmcnt(0)
    s_barrier

    s_mov_b64 exec, 1
    ds_write_b32 v125, v127 offset:16396
    ds_write_b32 v126, v127 offset:16404
    s_mov_b64 exec, -1

    buffer_load_dwordx4 v[20:23], v1, s[12:15], s56 offen nt
    buffer_load_dwordx4 v[4:7], v1, s[8:11], s56 offen nt
    buffer_load_dwordx2 v[36:37], v2, s[16:19], s61 offen nt
    s_bitcmp0_b32 s28, 0
    s_cbranch_scc1 L_skz_15
    v_lshrrev_b32 v110, 16, v45
    ds_read_b32 v110, v110
    v_lshrrev_b32 v111, 16, v47
    ds_read_b32 v111, v111
    v_lshrrev_b32 v112, 16, v49
    ds_read_b32 v112, v112
    v_lshrrev_b32 v113, 16, v51
    ds_read_b32 v113, v113
    s_waitcnt lgkmcnt(3)
    v_add_u32_sdwa v110, v110, v76 dst_sel:DWORD dst_unused:UNUSED_PAD src0_sel:WORD_1 src1_sel:WORD_0
    v_lshlrev_b32 v110, 3, v110
    ds_write_b64 v110, v[44:45] offset:16400

    s_waitcnt lgkmcnt(3)
    v_add_u32_sdwa v111, v111, v77 dst_sel:DWORD dst_unused:UNUSED_PAD src0_sel:WORD_1 src1_sel:WORD_0
    v_lshlrev_b32 v111, 3, v111
    ds_write_b64 v111, v[46:47] offset:16400

    s_waitcnt lgkmcnt(3)
    v_add_u32_sdwa v112, v112, v78 dst_sel:DWORD dst_unused:UNUSED_PAD src0_sel:WORD_1 src1_sel:WORD_0
    v_lshlrev_b32 v112, 3, v112
    ds_write_b64 v112, v[48:49] offset:16400

    s_waitcnt lgkmcnt(3)
    v_add_u32_sdwa v113, v113, v79 dst_sel:DWORD dst_unused:UNUSED_PAD src0_sel:WORD_1 src1_sel:WORD_0
    v_lshlrev_b32 v113, 3, v113
    ds_write_b64 v113, v[50:51] offset:16400

L_skz_15:
    s_bitcmp0_b32 s28, 1
    s_cbranch_scc1 L_skz_16
    v_lshrrev_b32 v110, 16, v53
    ds_read_b32 v110, v110
    v_lshrrev_b32 v111, 16, v55
    ds_read_b32 v111, v111
    v_lshrrev_b32 v112, 16, v57
    ds_read_b32 v112, v112
    v_lshrrev_b32 v113, 16, v59
    ds_read_b32 v113, v113
    s_waitcnt lgkmcnt(3)
    v_add_u32_sdwa v110, v110, v80 dst_sel:DWORD dst_unused:UNUSED_PAD src0_sel:WORD_1 src1_sel:WORD_0
    v_lshlrev_b32 v110, 3, v110
    ds_write_b64 v110, v[52:53] offset:16400

    s_waitcnt lgkmcnt(3)
    v_add_u32_sdwa v111, v111, v81 dst_sel:DWORD dst_unused:UNUSED_PAD src0_sel:WORD_1 src1_sel:WORD_0
    v_lshlrev_b32 v111, 3, v111
    ds_write_b64 v111, v[54:55] offset:16400

    s_waitcnt lgkmcnt(3)
    v_add_u32_sdwa v112, v112, v82 dst_sel:DWORD dst_unused:UNUSED_PAD src0_sel:WORD_1 src1_sel:WORD_0
    v_lshlrev_b32 v112, 3, v112
    ds_write_b64 v112, v[56:57] offset:16400

    s_waitcnt lgkmcnt(3)
    v_add_u32_sdwa v113, v113, v83 dst_sel:DWORD dst_unused:UNUSED_PAD src0_sel:WORD_1 src1_sel:WORD_0
    v_lshlrev_b32 v113, 3, v113
    ds_write_b64 v113, v[58:59] offset:16400

L_skz_16:
    buffer_load_dwordx4 v[24:27], v1, s[12:15], s57 offen nt
    buffer_load_dwordx4 v[8:11], v1, s[8:11], s57 offen nt
    buffer_load_dwordx2 v[38:39], v2, s[16:19], s62 offen nt
    s_bitcmp0_b32 s28, 2
    s_cbranch_scc1 L_skz_17
    v_lshrrev_b32 v110, 16, v61
    ds_read_b32 v110, v110
    v_lshrrev_b32 v111, 16, v63
    ds_read_b32 v111, v111
    v_lshrrev_b32 v112, 16, v65
    ds_read_b32 v112, v112
    v_lshrrev_b32 v113, 16, v67
    ds_read_b32 v113, v113
    s_waitcnt lgkmcnt(3)
    v_add_u32_sdwa v110, v110, v84 dst_sel:DWORD dst_unused:UNUSED_PAD src0_sel:WORD_1 src1_sel:WORD_0
    v_lshlrev_b32 v110, 3, v110
    ds_write_b64 v110, v[60:61] offset:16400

    s_waitcnt lgkmcnt(3)
    v_add_u32_sdwa v111, v111, v85 dst_sel:DWORD dst_unused:UNUSED_PAD src0_sel:WORD_1 src1_sel:WORD_0
    v_lshlrev_b32 v111, 3, v111
    ds_write_b64 v111, v[62:63] offset:16400

    s_waitcnt lgkmcnt(3)
    v_add_u32_sdwa v112, v112, v86 dst_sel:DWORD dst_unused:UNUSED_PAD src0_sel:WORD_1 src1_sel:WORD_0
    v_lshlrev_b32 v112, 3, v112
    ds_write_b64 v112, v[64:65] offset:16400

    s_waitcnt lgkmcnt(3)
    v_add_u32_sdwa v113, v113, v87 dst_sel:DWORD dst_unused:UNUSED_PAD src0_sel:WORD_1 src1_sel:WORD_0
    v_lshlrev_b32 v113, 3, v113
    ds_write_b64 v113, v[66:67] offset:16400

L_skz_17:
    s_bitcmp0_b32 s28, 3
    s_cbranch_scc1 L_skz_18
    s_mov_b64 exec, s[66:67]
    v_lshrrev_b32 v110, 16, v69
    ds_read_b32 v110, v110
    v_lshrrev_b32 v111, 16, v71
    ds_read_b32 v111, v111
    v_lshrrev_b32 v112, 16, v73
    ds_read_b32 v112, v112
    v_lshrrev_b32 v113, 16, v75
    ds_read_b32 v113, v113
    s_waitcnt lgkmcnt(3)
    v_add_u32_sdwa v110, v110, v88 dst_sel:DWORD dst_unused:UNUSED_PAD src0_sel:WORD_1 src1_sel:WORD_0
    v_lshlrev_b32 v110, 3, v110
    ds_write_b64 v110, v[68:69] offset:16400

    s_waitcnt lgkmcnt(3)
    v_add_u32_sdwa v111, v111, v89 dst_sel:DWORD dst_unused:UNUSED_PAD src0_sel:WORD_1 src1_sel:WORD_0
    v_lshlrev_b32 v111, 3, v111
    ds_write_b64 v111, v[70:71] offset:16400

    s_waitcnt lgkmcnt(3)
    v_add_u32_sdwa v112, v112, v90 dst_sel:DWORD dst_unused:UNUSED_PAD src0_sel:WORD_1 src1_sel:WORD_0
    v_lshlrev_b32 v112, 3, v112
    ds_write_b64 v112, v[72:73] offset:16400

    s_waitcnt lgkmcnt(3)
    v_add_u32_sdwa v113, v113, v91 dst_sel:DWORD dst_unused:UNUSED_PAD src0_sel:WORD_1 src1_sel:WORD_0
    v_lshlrev_b32 v113, 3, v113
    ds_write_b64 v113, v[74:75] offset:16400

    s_mov_b64 exec, -1
L_skz_18:
    buffer_load_dwordx4 v[28:31], v1, s[12:15], s58 offen nt
    buffer_load_dwordx4 v[12:15], v1, s[8:11], s58 offen nt
    buffer_load_dwordx2 v[40:41], v2, s[16:19], s63 offen nt
    buffer_load_dwordx4 v[32:35], v1, s[12:15], s59 offen nt
    buffer_load_dwordx4 v[16:19], v1, s[8:11], s59 offen nt
    buffer_load_dwordx2 v[42:43], v2, s[16:19], s64 offen nt
    s_cmp_eq_u32 s49, 0
    s_cbranch_scc1 L_p1epi_6
L_p1loop_5:
    s_mov_b32 s82, s85
    s_mov_b32 s83, s86
    s_mov_b32 s84, s87
    v_mov_b32 v99, 1
    buffer_atomic_add v99, v98, s[96:99], 0 offen sc0
    s_waitcnt vmcnt(10)
    s_bitcmp0_b32 s82, 0
    s_cbranch_scc1 L_ska_19
    v_mul_hi_u32_u24 v45, s40, v20
    v_mul_hi_u32_u24 v44, s40, v4
    v_mul_hi_u32_u24 v47, s40, v21
    v_mul_hi_u32_u24 v46, s40, v5
    v_mul_hi_u32_u24 v49, s40, v22
    v_mul_hi_u32_u24 v48, s40, v6
    v_mul_hi_u32_u24 v51, s40, v23
    v_mul_hi_u32_u24 v50, s40, v7
    v_and_b32 v45, -2, v45
    v_mad_u32_u24 v4, v44, s43, v4
    v_and_b32 v76, -4, v44
    v_and_b32 v47, -2, v47
    v_mad_u32_u24 v5, v46, s43, v5
    v_and_b32 v77, -4, v46
    v_and_b32 v49, -2, v49
    v_mad_u32_u24 v6, v48, s43, v6
    v_and_b32 v78, -4, v48
    v_and_b32 v51, -2, v51
    v_mad_u32_u24 v7, v50, s43, v7
    v_and_b32 v79, -4, v50
    v_mad_i32_i24 v20, v45, s42, v20
    v_lshl_add_u32 v45, v76, 5, v45
    v_mad_i32_i24 v21, v47, s42, v21
    v_lshl_add_u32 v47, v77, 5, v47
    v_mad_i32_i24 v22, v49, s42, v22
    v_lshl_add_u32 v49, v78, 5, v49
    v_mad_i32_i24 v23, v51, s42, v23
    v_lshl_add_u32 v51, v79, 5, v51
    v_add_u32 v45, v45, v45
    ds_add_rtn_u32 v76, v45, v104
    v_add_u32 v47, v47, v47
    ds_add_rtn_u32 v77, v47, v104
    v_add_u32 v49, v49, v49
    ds_add_rtn_u32 v78, v49, v104
    v_add_u32 v51, v51, v51
    ds_add_rtn_u32 v79, v51, v104
    v_lshlrev_b32 v110, 16, v36
    v_and_b32 v111, 0xffff0000, v36
    v_lshlrev_b32 v112, 16, v37
    v_and_b32 v113, 0xffff0000, v37
    v_mul_f32 v110, s44, v110
    v_mul_f32 v111, s44, v111
    v_mul_f32 v112, s44, v112
    v_mul_f32 v113, s44, v113
    v_fract_f32 v110, v110
    v_fract_f32 v111, v111
    v_fract_f32 v112, v112
    v_fract_f32 v113, v113
    v_cos_f32 v110, v110
    v_cos_f32 v111, v111
    v_cos_f32 v112, v112
    v_cos_f32 v113, v113
    v_lshl_or_b32 v44, v44, 14, v20
    v_perm_b32 v45, v45, v4, s46
    v_bfe_u32 v4, v4, 8, 5

    v_lshl_or_b32 v46, v46, 14, v21
    v_perm_b32 v47, v47, v5, s46
    v_bfe_u32 v5, v5, 8, 5

    v_lshl_or_b32 v48, v48, 14, v22
    v_perm_b32 v49, v49, v6, s46
    v_bfe_u32 v6, v6, 8, 5

    v_lshl_or_b32 v50, v50, 14, v23
    v_perm_b32 v51, v51, v7, s46
    v_bfe_u32 v7, v7, 8, 5

    v_fmaak_f32 v110, v110, v105, 0x4b400010
    v_fmaak_f32 v111, v111, v105, 0x4b400010
    v_fmaak_f32 v112, v112, v105, 0x4b400010
    v_fmaak_f32 v113, v113, v105, 0x4b400010
    v_sub_u32 v110, v110, v4
    v_sub_u32 v111, v111, v5
    v_sub_u32 v112, v112, v6
    v_sub_u32 v113, v113, v7
    v_bfi_b32 v110, 31, v4, v110
    v_bfi_b32 v111, 31, v5, v111
    v_bfi_b32 v112, 31, v6, v112
    v_bfi_b32 v113, 31, v7, v113
    v_perm_b32 v44, v44, v110, s55
    v_perm_b32 v46, v46, v111, s55
    v_perm_b32 v48, v48, v112, s55
    v_perm_b32 v50, v50, v113, s55
L_ska_19:
    s_waitcnt vmcnt(7)
    s_bitcmp0_b32 s82, 1
    s_cbranch_scc1 L_ska_20
    v_mul_hi_u32_u24 v53, s40, v24
    v_mul_hi_u32_u24 v52, s40, v8
    v_mul_hi_u32_u24 v55, s40, v25
    v_mul_hi_u32_u24 v54, s40, v9
    v_mul_hi_u32_u24 v57, s40, v26
    v_mul_hi_u32_u24 v56, s40, v10
    v_mul_hi_u32_u24 v59, s40, v27
    v_mul_hi_u32_u24 v58, s40, v11
    v_and_b32 v53, -2, v53
    v_mad_u32_u24 v8, v52, s43, v8
    v_and_b32 v80, -4, v52
    v_and_b32 v55, -2, v55
    v_mad_u32_u24 v9, v54, s43, v9
    v_and_b32 v81, -4, v54
    v_and_b32 v57, -2, v57
    v_mad_u32_u24 v10, v56, s43, v10
    v_and_b32 v82, -4, v56
    v_and_b32 v59, -2, v59
    v_mad_u32_u24 v11, v58, s43, v11
    v_and_b32 v83, -4, v58
    v_mad_i32_i24 v24, v53, s42, v24
    v_lshl_add_u32 v53, v80, 5, v53
    v_mad_i32_i24 v25, v55, s42, v25
    v_lshl_add_u32 v55, v81, 5, v55
    v_mad_i32_i24 v26, v57, s42, v26
    v_lshl_add_u32 v57, v82, 5, v57
    v_mad_i32_i24 v27, v59, s42, v27
    v_lshl_add_u32 v59, v83, 5, v59
    v_add_u32 v53, v53, v53
    ds_add_rtn_u32 v80, v53, v104
    v_add_u32 v55, v55, v55
    ds_add_rtn_u32 v81, v55, v104
    v_add_u32 v57, v57, v57
    ds_add_rtn_u32 v82, v57, v104
    v_add_u32 v59, v59, v59
    ds_add_rtn_u32 v83, v59, v104
    v_lshlrev_b32 v110, 16, v38
    v_and_b32 v111, 0xffff0000, v38
    v_lshlrev_b32 v112, 16, v39
    v_and_b32 v113, 0xffff0000, v39
    v_mul_f32 v110, s44, v110
    v_mul_f32 v111, s44, v111
    v_mul_f32 v112, s44, v112
    v_mul_f32 v113, s44, v113
    v_fract_f32 v110, v110
    v_fract_f32 v111, v111
    v_fract_f32 v112, v112
    v_fract_f32 v113, v113
    v_cos_f32 v110, v110
    v_cos_f32 v111, v111
    v_cos_f32 v112, v112
    v_cos_f32 v113, v113
    v_lshl_or_b32 v52, v52, 14, v24
    v_perm_b32 v53, v53, v8, s46
    v_bfe_u32 v8, v8, 8, 5

    v_lshl_or_b32 v54, v54, 14, v25
    v_perm_b32 v55, v55, v9, s46
    v_bfe_u32 v9, v9, 8, 5

    v_lshl_or_b32 v56, v56, 14, v26
    v_perm_b32 v57, v57, v10, s46
    v_bfe_u32 v10, v10, 8, 5

    v_lshl_or_b32 v58, v58, 14, v27
    v_perm_b32 v59, v59, v11, s46
    v_bfe_u32 v11, v11, 8, 5

    v_fmaak_f32 v110, v110, v105, 0x4b400010
    v_fmaak_f32 v111, v111, v105, 0x4b400010
    v_fmaak_f32 v112, v112, v105, 0x4b400010
    v_fmaak_f32 v113, v113, v105, 0x4b400010
    v_sub_u32 v110, v110, v8
    v_sub_u32 v111, v111, v9
    v_sub_u32 v112, v112, v10
    v_sub_u32 v113, v113, v11
    v_bfi_b32 v110, 31, v8, v110
    v_bfi_b32 v111, 31, v9, v111
    v_bfi_b32 v112, 31, v10, v112
    v_bfi_b32 v113, 31, v11, v113
    v_perm_b32 v52, v52, v110, s55
    v_perm_b32 v54, v54, v111, s55
    v_perm_b32 v56, v56, v112, s55
    v_perm_b32 v58, v58, v113, s55
L_ska_20:
    s_waitcnt vmcnt(1)
    s_waitcnt vmcnt(0)
    v_cmp_eq_u32 vcc, 0, v0
    s_mov_b64 exec, vcc
    ds_write_b32 v108, v99 offset:8
    s_mov_b64 exec, -1
    s_waitcnt vmcnt(10)
    v_add_u32 v110, v92, v94
    v_min_u32 v92, s48, v92
    v_add_u32 v111, v93, v95
    v_min_u32 v93, s48, v93
    v_max_u32 v110, v110, v111
    v_add_u32 v92, v92, v96
    v_add_u32 v93, v93, v97
    v_cmp_le_u32 vcc, s48, v110
    v_lshl_add_u32 v92, v92, 2, v92
    v_lshl_add_u32 v93, v93, 2, v93
    ds_write_b64 v2, v[92:93] offset:8192
    s_cbranch_vccz L_noov_21
    ds_write_b32 v108, v104 offset:4
L_noov_21:

    s_waitcnt lgkmcnt(0)
    s_barrier
    ds_read2_b32 v[110:111], v108 offset0:1 offset1:2
    s_waitcnt lgkmcnt(0)
    v_readfirstlane_b32 s53, v110
    v_readfirstlane_b32 s41, v111
    s_nop 1

    s_add_u32 s41, s41, 160
    s_sub_u32 s78, s41, 3008
    s_lshr_b32 s79, s78, 1
    s_add_u32 s79, s79, 3008
    s_and_b32 s86, s78, 1
    s_lshl_b32 s86, s86, 1
    s_add_u32 s87, s86, 2
    s_cmp_lt_u32 s41, 3008
    s_cselect_b32 s41, s41, s79
    s_cmovk_i32 s86, 0
    s_cmovk_i32 s87, 4

    s_mul_i32 s78, s41, 16000
    s_add_u32 s49, s78, 16000
    s_cmp_ge_u32 s41, 3200
    s_cmovk_i32 s49, 0
    s_cmovk_i32 s78, 0
    s_lshl_b32 s10, s49, 2
    s_lshl_b32 s14, s49, 2
    s_lshl_b32 s18, s49, 1
    s_sub_u32 s79, s87, s86
    s_bfm_b32 s85, s79, s86
    s_lshl_b32 s86, s86, 12
    s_lshl_b32 s87, s87, 12
    s_min_u32 s87, s87, 16000

    s_add_u32 s79, s78, 0
    s_bitcmp1_b32 s85, 0
    s_cselect_b32 s79, s79, 0x1ff00000
    s_lshl_b32 s56, s79, 2
    s_lshl_b32 s61, s79, 1

    s_add_u32 s79, s78, 4096
    s_bitcmp1_b32 s85, 1
    s_cselect_b32 s79, s79, 0x1ff00000
    s_lshl_b32 s57, s79, 2
    s_lshl_b32 s62, s79, 1

    s_add_u32 s79, s78, 8192
    s_bitcmp1_b32 s85, 2
    s_cselect_b32 s79, s79, 0x1ff00000
    s_lshl_b32 s58, s79, 2
    s_lshl_b32 s63, s79, 1

    s_add_u32 s79, s78, 12288
    s_bitcmp1_b32 s85, 3
    s_cselect_b32 s79, s79, 0x1ff00000
    s_lshl_b32 s59, s79, 2
    s_lshl_b32 s64, s79, 1

    s_cmp_lg_u32 s53, 0
    s_cbranch_scc1 L_slow_22
L_sback_23:
    s_bitcmp0_b32 s28, 0
    s_cbranch_scc1 L_skw_27
    ds_read_b64 v[110:111], v2 offset:16400
    ds_read_b64 v[112:113], v2 offset:16408
    ds_read_b64 v[114:115], v2 offset:16392

    ds_read_b64 v[118:119], v2 offset:24592
    ds_read_b64 v[120:121], v2 offset:24600
    ds_read_b64 v[122:123], v2 offset:24584

    s_waitcnt lgkmcnt(3)
    v_lshrrev_b32 v116, 16, v111
    ds_read_b32 v116, v116 offset:8192

    s_waitcnt lgkmcnt(1)
    v_lshrrev_b32 v124, 16, v119
    ds_read_b32 v124, v124 offset:8192

    v_cmp_ne_u32_sdwa s[80:81], v111, v113 src0_sel:WORD_1 src1_sel:WORD_1
    v_cmp_ne_u32_sdwa vcc, v111, v115 src0_sel:WORD_1 src1_sel:WORD_1
    v_alignbyte_b32 v114, v115, v114, 2
    s_mov_b32 s54, -3
    v_alignbyte_b32 v111, v111, v110, 1
    v_perm_b32 v110, v110, v114, s47
    s_waitcnt lgkmcnt(1)
    v_add3_u32 v116, v116, v106, s54
    v_sub_u32 v117, 0, v116
    v_and_b32 v117, 3, v117
    s_mov_b64 exec, s[80:81]
    v_mov_b32 v117, 0
    v_mov_b32 v112, 0
    s_mov_b64 exec, vcc
    v_mov_b32 v117, 3

    s_mov_b64 exec, -1
    v_alignbyte_b32 v110, v111, v110, v117
    v_alignbyte_b32 v111, v112, v111, v117
    v_add_u32 v116, v116, v117

    buffer_store_dwordx2 v[110:111], v116, s[24:27], 0 offen
    v_cmp_ne_u32_sdwa s[80:81], v119, v121 src0_sel:WORD_1 src1_sel:WORD_1
    v_cmp_ne_u32_sdwa vcc, v119, v123 src0_sel:WORD_1 src1_sel:WORD_1
    v_alignbyte_b32 v122, v123, v122, 2
    s_mov_b32 s54, 5117
    v_alignbyte_b32 v119, v119, v118, 1
    v_perm_b32 v118, v118, v122, s47
    s_waitcnt lgkmcnt(0)
    v_add3_u32 v124, v124, v106, s54
    v_sub_u32 v125, 0, v124
    v_and_b32 v125, 3, v125
    s_mov_b64 exec, s[80:81]
    v_mov_b32 v125, 0
    v_mov_b32 v120, 0
    s_mov_b64 exec, vcc
    v_mov_b32 v125, 3

    s_mov_b64 exec, -1
    v_alignbyte_b32 v118, v119, v118, v125
    v_alignbyte_b32 v119, v120, v119, v125
    v_add_u32 v124, v124, v125

    buffer_store_dwordx2 v[118:119], v124, s[24:27], 0 offen
L_skw_27:
    s_bitcmp0_b32 s28, 0
    s_cbranch_scc1 L_skw_28
    ds_read_b64 v[110:111], v2 offset:32784
    ds_read_b64 v[112:113], v2 offset:32792
    ds_read_b64 v[114:115], v2 offset:32776

    ds_read_b64 v[118:119], v2 offset:40976
    ds_read_b64 v[120:121], v2 offset:40984
    ds_read_b64 v[122:123], v2 offset:40968

    s_waitcnt lgkmcnt(3)
    v_lshrrev_b32 v116, 16, v111
    ds_read_b32 v116, v116 offset:8192

    s_waitcnt lgkmcnt(1)
    v_lshrrev_b32 v124, 16, v119
    ds_read_b32 v124, v124 offset:8192

    v_cmp_ne_u32_sdwa s[80:81], v111, v113 src0_sel:WORD_1 src1_sel:WORD_1
    v_cmp_ne_u32_sdwa vcc, v111, v115 src0_sel:WORD_1 src1_sel:WORD_1
    v_alignbyte_b32 v114, v115, v114, 2
    s_mov_b32 s54, 10237
    v_alignbyte_b32 v111, v111, v110, 1
    v_perm_b32 v110, v110, v114, s47
    s_waitcnt lgkmcnt(1)
    v_add3_u32 v116, v116, v106, s54
    v_sub_u32 v117, 0, v116
    v_and_b32 v117, 3, v117
    s_mov_b64 exec, s[80:81]
    v_mov_b32 v117, 0
    v_mov_b32 v112, 0
    s_mov_b64 exec, vcc
    v_mov_b32 v117, 3

    s_mov_b64 exec, -1
    v_alignbyte_b32 v110, v111, v110, v117
    v_alignbyte_b32 v111, v112, v111, v117
    v_add_u32 v116, v116, v117

    buffer_store_dwordx2 v[110:111], v116, s[24:27], 0 offen
    v_cmp_ne_u32_sdwa s[80:81], v119, v121 src0_sel:WORD_1 src1_sel:WORD_1
    v_cmp_ne_u32_sdwa vcc, v119, v123 src0_sel:WORD_1 src1_sel:WORD_1
    v_alignbyte_b32 v122, v123, v122, 2
    s_mov_b32 s54, 15357
    v_alignbyte_b32 v119, v119, v118, 1
    v_perm_b32 v118, v118, v122, s47
    s_waitcnt lgkmcnt(0)
    v_add3_u32 v124, v124, v106, s54
    v_sub_u32 v125, 0, v124
    v_and_b32 v125, 3, v125
    s_mov_b64 exec, s[80:81]
    v_mov_b32 v125, 0
    v_mov_b32 v120, 0
    s_mov_b64 exec, vcc
    v_mov_b32 v125, 3

    s_mov_b64 exec, -1
    v_alignbyte_b32 v118, v119, v118, v125
    v_alignbyte_b32 v119, v120, v119, v125
    v_add_u32 v124, v124, v125

    buffer_store_dwordx2 v[118:119], v124, s[24:27], 0 offen
L_skw_28:
    s_bitcmp0_b32 s82, 2
    s_cbranch_scc1 L_ska_29
    v_mul_hi_u32_u24 v61, s40, v28
    v_mul_hi_u32_u24 v60, s40, v12
    v_mul_hi_u32_u24 v63, s40, v29
    v_mul_hi_u32_u24 v62, s40, v13
    v_mul_hi_u32_u24 v65, s40, v30
    v_mul_hi_u32_u24 v64, s40, v14
    v_mul_hi_u32_u24 v67, s40, v31
    v_mul_hi_u32_u24 v66, s40, v15
    v_and_b32 v61, -2, v61
    v_mad_u32_u24 v12, v60, s43, v12
    v_and_b32 v84, -4, v60
    v_and_b32 v63, -2, v63
    v_mad_u32_u24 v13, v62, s43, v13
    v_and_b32 v85, -4, v62
    v_and_b32 v65, -2, v65
    v_mad_u32_u24 v14, v64, s43, v14
    v_and_b32 v86, -4, v64
    v_and_b32 v67, -2, v67
    v_mad_u32_u24 v15, v66, s43, v15
    v_and_b32 v87, -4, v66
    v_mad_i32_i24 v28, v61, s42, v28
    v_lshl_add_u32 v61, v84, 5, v61
    v_mad_i32_i24 v29, v63, s42, v29
    v_lshl_add_u32 v63, v85, 5, v63
    v_mad_i32_i24 v30, v65, s42, v30
    v_lshl_add_u32 v65, v86, 5, v65
    v_mad_i32_i24 v31, v67, s42, v31
    v_lshl_add_u32 v67, v87, 5, v67
    v_add_u32 v61, v61, v61
    ds_add_rtn_u32 v84, v61, v104
    v_add_u32 v63, v63, v63
    ds_add_rtn_u32 v85, v63, v104
    v_add_u32 v65, v65, v65
    ds_add_rtn_u32 v86, v65, v104
    v_add_u32 v67, v67, v67
    ds_add_rtn_u32 v87, v67, v104
    v_lshlrev_b32 v110, 16, v40
    v_and_b32 v111, 0xffff0000, v40
    v_lshlrev_b32 v112, 16, v41
    v_and_b32 v113, 0xffff0000, v41
    v_mul_f32 v110, s44, v110
    v_mul_f32 v111, s44, v111
    v_mul_f32 v112, s44, v112
    v_mul_f32 v113, s44, v113
    v_fract_f32 v110, v110
    v_fract_f32 v111, v111
    v_fract_f32 v112, v112
    v_fract_f32 v113, v113
    v_cos_f32 v110, v110
    v_cos_f32 v111, v111
    v_cos_f32 v112, v112
    v_cos_f32 v113, v113
    v_lshl_or_b32 v60, v60, 14, v28
    v_perm_b32 v61, v61, v12, s46
    v_bfe_u32 v12, v12, 8, 5

    v_lshl_or_b32 v62, v62, 14, v29
    v_perm_b32 v63, v63, v13, s46
    v_bfe_u32 v13, v13, 8, 5

    v_lshl_or_b32 v64, v64, 14, v30
    v_perm_b32 v65, v65, v14, s46
    v_bfe_u32 v14, v14, 8, 5

    v_lshl_or_b32 v66, v66, 14, v31
    v_perm_b32 v67, v67, v15, s46
    v_bfe_u32 v15, v15, 8, 5

    v_fmaak_f32 v110, v110, v105, 0x4b400010
    v_fmaak_f32 v111, v111, v105, 0x4b400010
    v_fmaak_f32 v112, v112, v105, 0x4b400010
    v_fmaak_f32 v113, v113, v105, 0x4b400010
    v_sub_u32 v110, v110, v12
    v_sub_u32 v111, v111, v13
    v_sub_u32 v112, v112, v14
    v_sub_u32 v113, v113, v15
    v_bfi_b32 v110, 31, v12, v110
    v_bfi_b32 v111, 31, v13, v111
    v_bfi_b32 v112, 31, v14, v112
    v_bfi_b32 v113, 31, v15, v113
    v_perm_b32 v60, v60, v110, s55
    v_perm_b32 v62, v62, v111, s55
    v_perm_b32 v64, v64, v112, s55
    v_perm_b32 v66, v66, v113, s55
L_ska_29:
    s_bitcmp0_b32 s28, 1
    s_cbranch_scc1 L_skw_30
    v_add_u32 v107, 32768, v2
    ds_read_b64 v[110:111], v107 offset:16400
    ds_read_b64 v[112:113], v107 offset:16408
    ds_read_b64 v[114:115], v107 offset:16392

    ds_read_b64 v[118:119], v107 offset:24592
    ds_read_b64 v[120:121], v107 offset:24600
    ds_read_b64 v[122:123], v107 offset:24584

    s_waitcnt lgkmcnt(3)
    v_lshrrev_b32 v116, 16, v111
    ds_read_b32 v116, v116 offset:8192

    s_waitcnt lgkmcnt(1)
    v_lshrrev_b32 v124, 16, v119
    ds_read_b32 v124, v124 offset:8192

    v_cmp_ne_u32_sdwa s[80:81], v111, v113 src0_sel:WORD_1 src1_sel:WORD_1
    v_cmp_ne_u32_sdwa vcc, v111, v115 src0_sel:WORD_1 src1_sel:WORD_1
    v_alignbyte_b32 v114, v115, v114, 2
    s_mov_b32 s54, 20477
    v_alignbyte_b32 v111, v111, v110, 1
    v_perm_b32 v110, v110, v114, s47
    s_waitcnt lgkmcnt(1)
    v_add3_u32 v116, v116, v106, s54
    v_sub_u32 v117, 0, v116
    v_and_b32 v117, 3, v117
    s_mov_b64 exec, s[80:81]
    v_mov_b32 v117, 0
    v_mov_b32 v112, 0
    s_mov_b64 exec, vcc
    v_mov_b32 v117, 3

    s_mov_b64 exec, -1
    v_alignbyte_b32 v110, v111, v110, v117
    v_alignbyte_b32 v111, v112, v111, v117
    v_add_u32 v116, v116, v117

    buffer_store_dwordx2 v[110:111], v116, s[24:27], 0 offen
    v_cmp_ne_u32_sdwa s[80:81], v119, v121 src0_sel:WORD_1 src1_sel:WORD_1
    v_cmp_ne_u32_sdwa vcc, v119, v123 src0_sel:WORD_1 src1_sel:WORD_1
    v_alignbyte_b32 v122, v123, v122, 2
    s_mov_b32 s54, 25597
    v_alignbyte_b32 v119, v119, v118, 1
    v_perm_b32 v118, v118, v122, s47
    s_waitcnt lgkmcnt(0)
    v_add3_u32 v124, v124, v106, s54
    v_sub_u32 v125, 0, v124
    v_and_b32 v125, 3, v125
    s_mov_b64 exec, s[80:81]
    v_mov_b32 v125, 0
    v_mov_b32 v120, 0
    s_mov_b64 exec, vcc
    v_mov_b32 v125, 3

    s_mov_b64 exec, -1
    v_alignbyte_b32 v118, v119, v118, v125
    v_alignbyte_b32 v119, v120, v119, v125
    v_add_u32 v124, v124, v125

    buffer_store_dwordx2 v[118:119], v124, s[24:27], 0 offen
L_skw_30:
    s_bitcmp0_b32 s28, 1
    s_cbranch_scc1 L_skw_31
    v_add_u32 v107, 32768, v2
    ds_read_b64 v[110:111], v107 offset:32784
    ds_read_b64 v[112:113], v107 offset:32792
    ds_read_b64 v[114:115], v107 offset:32776

    ds_read_b64 v[118:119], v107 offset:40976
    ds_read_b64 v[120:121], v107 offset:40984
    ds_read_b64 v[122:123], v107 offset:40968

    s_waitcnt lgkmcnt(3)
    v_lshrrev_b32 v116, 16, v111
    ds_read_b32 v116, v116 offset:8192

    s_waitcnt lgkmcnt(1)
    v_lshrrev_b32 v124, 16, v119
    ds_read_b32 v124, v124 offset:8192

    v_cmp_ne_u32_sdwa s[80:81], v111, v113 src0_sel:WORD_1 src1_sel:WORD_1
    v_cmp_ne_u32_sdwa vcc, v111, v115 src0_sel:WORD_1 src1_sel:WORD_1
    v_alignbyte_b32 v114, v115, v114, 2
    s_mov_b32 s54, 30717
    v_alignbyte_b32 v111, v111, v110, 1
    v_perm_b32 v110, v110, v114, s47
    s_waitcnt lgkmcnt(1)
    v_add3_u32 v116, v116, v106, s54
    v_sub_u32 v117, 0, v116
    v_and_b32 v117, 3, v117
    s_mov_b64 exec, s[80:81]
    v_mov_b32 v117, 0
    v_mov_b32 v112, 0
    s_mov_b64 exec, vcc
    v_mov_b32 v117, 3

    s_mov_b64 exec, -1
    v_alignbyte_b32 v110, v111, v110, v117
    v_alignbyte_b32 v111, v112, v111, v117
    v_add_u32 v116, v116, v117

    buffer_store_dwordx2 v[110:111], v116, s[24:27], 0 offen
    v_cmp_ne_u32_sdwa s[80:81], v119, v121 src0_sel:WORD_1 src1_sel:WORD_1
    v_cmp_ne_u32_sdwa vcc, v119, v123 src0_sel:WORD_1 src1_sel:WORD_1
    v_alignbyte_b32 v122, v123, v122, 2
    s_mov_b32 s54, 35837
    v_alignbyte_b32 v119, v119, v118, 1
    v_perm_b32 v118, v118, v122, s47
    s_waitcnt lgkmcnt(0)
    v_add3_u32 v124, v124, v106, s54
    v_sub_u32 v125, 0, v124
    v_and_b32 v125, 3, v125
    s_mov_b64 exec, s[80:81]
    v_mov_b32 v125, 0
    v_mov_b32 v120, 0
    s_mov_b64 exec, vcc
    v_mov_b32 v125, 3

    s_mov_b64 exec, -1
    v_alignbyte_b32 v118, v119, v118, v125
    v_alignbyte_b32 v119, v120, v119, v125
    v_add_u32 v124, v124, v125

    buffer_store_dwordx2 v[118:119], v124, s[24:27], 0 offen
L_skw_31:
    s_bitcmp0_b32 s28, 2
    s_cbranch_scc1 L_skw_32
    v_add_u32 v107, 65536, v2
    ds_read_b64 v[110:111], v107 offset:16400
    ds_read_b64 v[112:113], v107 offset:16408
    ds_read_b64 v[114:115], v107 offset:16392

    ds_read_b64 v[118:119], v107 offset:24592
    ds_read_b64 v[120:121], v107 offset:24600
    ds_read_b64 v[122:123], v107 offset:24584

    s_waitcnt lgkmcnt(3)
    v_lshrrev_b32 v116, 16, v111
    ds_read_b32 v116, v116 offset:8192

    s_waitcnt lgkmcnt(1)
    v_lshrrev_b32 v124, 16, v119
    ds_read_b32 v124, v124 offset:8192

    v_cmp_ne_u32_sdwa s[80:81], v111, v113 src0_sel:WORD_1 src1_sel:WORD_1
    v_cmp_ne_u32_sdwa vcc, v111, v115 src0_sel:WORD_1 src1_sel:WORD_1
    v_alignbyte_b32 v114, v115, v114, 2
    s_mov_b32 s54, 40957
    v_alignbyte_b32 v111, v111, v110, 1
    v_perm_b32 v110, v110, v114, s47
    s_waitcnt lgkmcnt(1)
    v_add3_u32 v116, v116, v106, s54
    v_sub_u32 v117, 0, v116
    v_and_b32 v117, 3, v117
    s_mov_b64 exec, s[80:81]
    v_mov_b32 v117, 0
    v_mov_b32 v112, 0
    s_mov_b64 exec, vcc
    v_mov_b32 v117, 3

    s_mov_b64 exec, -1
    v_alignbyte_b32 v110, v111, v110, v117
    v_alignbyte_b32 v111, v112, v111, v117
    v_add_u32 v116, v116, v117

    buffer_store_dwordx2 v[110:111], v116, s[24:27], 0 offen
    v_cmp_ne_u32_sdwa s[80:81], v119, v121 src0_sel:WORD_1 src1_sel:WORD_1
    v_cmp_ne_u32_sdwa vcc, v119, v123 src0_sel:WORD_1 src1_sel:WORD_1
    v_alignbyte_b32 v122, v123, v122, 2
    s_mov_b32 s54, 46077
    v_alignbyte_b32 v119, v119, v118, 1
    v_perm_b32 v118, v118, v122, s47
    s_waitcnt lgkmcnt(0)
    v_add3_u32 v124, v124, v106, s54
    v_sub_u32 v125, 0, v124
    v_and_b32 v125, 3, v125
    s_mov_b64 exec, s[80:81]
    v_mov_b32 v125, 0
    v_mov_b32 v120, 0
    s_mov_b64 exec, vcc
    v_mov_b32 v125, 3

    s_mov_b64 exec, -1
    v_alignbyte_b32 v118, v119, v118, v125
    v_alignbyte_b32 v119, v120, v119, v125
    v_add_u32 v124, v124, v125

    buffer_store_dwordx2 v[118:119], v124, s[24:27], 0 offen
L_skw_32:
    s_bitcmp0_b32 s82, 3
    s_cbranch_scc1 L_ska_33
    s_mov_b64 exec, s[66:67]
    v_mul_hi_u32_u24 v69, s40, v32
    v_mul_hi_u32_u24 v68, s40, v16
    v_mul_hi_u32_u24 v71, s40, v33
    v_mul_hi_u32_u24 v70, s40, v17
    v_mul_hi_u32_u24 v73, s40, v34
    v_mul_hi_u32_u24 v72, s40, v18
    v_mul_hi_u32_u24 v75, s40, v35
    v_mul_hi_u32_u24 v74, s40, v19
    v_and_b32 v69, -2, v69
    v_mad_u32_u24 v16, v68, s43, v16
    v_and_b32 v88, -4, v68
    v_and_b32 v71, -2, v71
    v_mad_u32_u24 v17, v70, s43, v17
    v_and_b32 v89, -4, v70
    v_and_b32 v73, -2, v73
    v_mad_u32_u24 v18, v72, s43, v18
    v_and_b32 v90, -4, v72
    v_and_b32 v75, -2, v75
    v_mad_u32_u24 v19, v74, s43, v19
    v_and_b32 v91, -4, v74
    v_mad_i32_i24 v32, v69, s42, v32
    v_lshl_add_u32 v69, v88, 5, v69
    v_mad_i32_i24 v33, v71, s42, v33
    v_lshl_add_u32 v71, v89, 5, v71
    v_mad_i32_i24 v34, v73, s42, v34
    v_lshl_add_u32 v73, v90, 5, v73
    v_mad_i32_i24 v35, v75, s42, v35
    v_lshl_add_u32 v75, v91, 5, v75
    v_add_u32 v69, v69, v69
    ds_add_rtn_u32 v88, v69, v104
    v_add_u32 v71, v71, v71
    ds_add_rtn_u32 v89, v71, v104
    v_add_u32 v73, v73, v73
    ds_add_rtn_u32 v90, v73, v104
    v_add_u32 v75, v75, v75
    ds_add_rtn_u32 v91, v75, v104
    v_lshlrev_b32 v110, 16, v42
    v_and_b32 v111, 0xffff0000, v42
    v_lshlrev_b32 v112, 16, v43
    v_and_b32 v113, 0xffff0000, v43
    v_mul_f32 v110, s44, v110
    v_mul_f32 v111, s44, v111
    v_mul_f32 v112, s44, v112
    v_mul_f32 v113, s44, v113
    v_fract_f32 v110, v110
    v_fract_f32 v111, v111
    v_fract_f32 v112, v112
    v_fract_f32 v113, v113
    v_cos_f32 v110, v110
    v_cos_f32 v111, v111
    v_cos_f32 v112, v112
    v_cos_f32 v113, v113
    v_lshl_or_b32 v68, v68, 14, v32
    v_perm_b32 v69, v69, v16, s46
    v_bfe_u32 v16, v16, 8, 5

    v_lshl_or_b32 v70, v70, 14, v33
    v_perm_b32 v71, v71, v17, s46
    v_bfe_u32 v17, v17, 8, 5

    v_lshl_or_b32 v72, v72, 14, v34
    v_perm_b32 v73, v73, v18, s46
    v_bfe_u32 v18, v18, 8, 5

    v_lshl_or_b32 v74, v74, 14, v35
    v_perm_b32 v75, v75, v19, s46
    v_bfe_u32 v19, v19, 8, 5

    v_fmaak_f32 v110, v110, v105, 0x4b400010
    v_fmaak_f32 v111, v111, v105, 0x4b400010
    v_fmaak_f32 v112, v112, v105, 0x4b400010
    v_fmaak_f32 v113, v113, v105, 0x4b400010
    v_sub_u32 v110, v110, v16
    v_sub_u32 v111, v111, v17
    v_sub_u32 v112, v112, v18
    v_sub_u32 v113, v113, v19
    v_bfi_b32 v110, 31, v16, v110
    v_bfi_b32 v111, 31, v17, v111
    v_bfi_b32 v112, 31, v18, v112
    v_bfi_b32 v113, 31, v19, v113
    v_perm_b32 v68, v68, v110, s55
    v_perm_b32 v70, v70, v111, s55
    v_perm_b32 v72, v72, v112, s55
    v_perm_b32 v74, v74, v113, s55
    s_mov_b64 exec, -1
L_ska_33:
    s_bitcmp0_b32 s28, 2
    s_cbranch_scc1 L_skw_34
    v_add_u32 v107, 65536, v2
    ds_read_b64 v[110:111], v107 offset:32784
    ds_read_b64 v[112:113], v107 offset:32792
    ds_read_b64 v[114:115], v107 offset:32776

    ds_read_b64 v[118:119], v107 offset:40976
    ds_read_b64 v[120:121], v107 offset:40984
    ds_read_b64 v[122:123], v107 offset:40968

    s_waitcnt lgkmcnt(3)
    v_lshrrev_b32 v116, 16, v111
    ds_read_b32 v116, v116 offset:8192

    s_waitcnt lgkmcnt(1)
    v_lshrrev_b32 v124, 16, v119
    ds_read_b32 v124, v124 offset:8192

    v_cmp_ne_u32_sdwa s[80:81], v111, v113 src0_sel:WORD_1 src1_sel:WORD_1
    v_cmp_ne_u32_sdwa vcc, v111, v115 src0_sel:WORD_1 src1_sel:WORD_1
    v_alignbyte_b32 v114, v115, v114, 2
    s_mov_b32 s54, 51197
    v_alignbyte_b32 v111, v111, v110, 1
    v_perm_b32 v110, v110, v114, s47
    s_waitcnt lgkmcnt(1)
    v_add3_u32 v116, v116, v106, s54
    v_sub_u32 v117, 0, v116
    v_and_b32 v117, 3, v117
    s_mov_b64 exec, s[80:81]
    v_mov_b32 v117, 0
    v_mov_b32 v112, 0
    s_mov_b64 exec, vcc
    v_mov_b32 v117, 3

    s_mov_b64 exec, -1
    v_alignbyte_b32 v110, v111, v110, v117
    v_alignbyte_b32 v111, v112, v111, v117
    v_add_u32 v116, v116, v117

    buffer_store_dwordx2 v[110:111], v116, s[24:27], 0 offen
    v_cmp_ne_u32_sdwa s[80:81], v119, v121 src0_sel:WORD_1 src1_sel:WORD_1
    v_cmp_ne_u32_sdwa vcc, v119, v123 src0_sel:WORD_1 src1_sel:WORD_1
    v_alignbyte_b32 v122, v123, v122, 2
    s_mov_b32 s54, 56317
    v_alignbyte_b32 v119, v119, v118, 1
    v_perm_b32 v118, v118, v122, s47
    s_waitcnt lgkmcnt(0)
    v_add3_u32 v124, v124, v106, s54
    v_sub_u32 v125, 0, v124
    v_and_b32 v125, 3, v125
    s_mov_b64 exec, s[80:81]
    v_mov_b32 v125, 0
    v_mov_b32 v120, 0
    s_mov_b64 exec, vcc
    v_mov_b32 v125, 3

    s_mov_b64 exec, -1
    v_alignbyte_b32 v118, v119, v118, v125
    v_alignbyte_b32 v119, v120, v119, v125
    v_add_u32 v124, v124, v125

    buffer_store_dwordx2 v[118:119], v124, s[24:27], 0 offen
L_skw_34:
    s_bitcmp0_b32 s28, 3
    s_cbranch_scc1 L_skw_35
    v_add_u32 v107, 98304, v2
    ds_read_b64 v[110:111], v107 offset:16400
    ds_read_b64 v[112:113], v107 offset:16408
    ds_read_b64 v[114:115], v107 offset:16392

    ds_read_b64 v[118:119], v107 offset:24592
    ds_read_b64 v[120:121], v107 offset:24600
    ds_read_b64 v[122:123], v107 offset:24584

    s_waitcnt lgkmcnt(3)
    v_lshrrev_b32 v116, 16, v111
    ds_read_b32 v116, v116 offset:8192

    s_waitcnt lgkmcnt(1)
    v_lshrrev_b32 v124, 16, v119
    ds_read_b32 v124, v124 offset:8192

    v_cmp_ne_u32_sdwa s[80:81], v111, v113 src0_sel:WORD_1 src1_sel:WORD_1
    v_cmp_ne_u32_sdwa vcc, v111, v115 src0_sel:WORD_1 src1_sel:WORD_1
    v_alignbyte_b32 v114, v115, v114, 2
    s_mov_b32 s54, 61437
    v_alignbyte_b32 v111, v111, v110, 1
    v_perm_b32 v110, v110, v114, s47
    s_waitcnt lgkmcnt(1)
    v_add3_u32 v116, v116, v106, s54
    v_sub_u32 v117, 0, v116
    v_and_b32 v117, 3, v117
    s_mov_b64 exec, s[80:81]
    v_mov_b32 v117, 0
    v_mov_b32 v112, 0
    s_mov_b64 exec, vcc
    v_mov_b32 v117, 3

    s_mov_b64 exec, -1
    v_alignbyte_b32 v110, v111, v110, v117
    v_alignbyte_b32 v111, v112, v111, v117
    v_add_u32 v116, v116, v117

    buffer_store_dwordx2 v[110:111], v116, s[24:27], 0 offen
    v_cmp_ne_u32_sdwa s[80:81], v119, v121 src0_sel:WORD_1 src1_sel:WORD_1
    v_cmp_ne_u32_sdwa vcc, v119, v123 src0_sel:WORD_1 src1_sel:WORD_1
    v_alignbyte_b32 v122, v123, v122, 2
    s_mov_b32 s54, 66557
    v_alignbyte_b32 v119, v119, v118, 1
    v_perm_b32 v118, v118, v122, s47
    s_waitcnt lgkmcnt(0)
    v_add3_u32 v124, v124, v106, s54
    v_sub_u32 v125, 0, v124
    v_and_b32 v125, 3, v125
    s_mov_b64 exec, s[80:81]
    v_mov_b32 v125, 0
    v_mov_b32 v120, 0
    s_mov_b64 exec, vcc
    v_mov_b32 v125, 3

    s_mov_b64 exec, -1
    v_alignbyte_b32 v118, v119, v118, v125
    v_alignbyte_b32 v119, v120, v119, v125
    v_add_u32 v124, v124, v125

    buffer_store_dwordx2 v[118:119], v124, s[24:27], 0 offen
L_skw_35:
    s_bitcmp0_b32 s28, 3
    s_cbranch_scc1 L_skw_36
    v_add_u32 v107, 98304, v2
    ds_read_b64 v[110:111], v107 offset:32784
    ds_read_b64 v[112:113], v107 offset:32792
    ds_read_b64 v[114:115], v107 offset:32776

    ds_read_b64 v[118:119], v107 offset:40976
    ds_read_b64 v[120:121], v107 offset:40984
    ds_read_b64 v[122:123], v107 offset:40968

    s_waitcnt lgkmcnt(3)
    v_lshrrev_b32 v116, 16, v111
    ds_read_b32 v116, v116 offset:8192

    s_waitcnt lgkmcnt(1)
    v_lshrrev_b32 v124, 16, v119
    ds_read_b32 v124, v124 offset:8192

    v_cmp_ne_u32_sdwa s[80:81], v111, v113 src0_sel:WORD_1 src1_sel:WORD_1
    v_cmp_ne_u32_sdwa vcc, v111, v115 src0_sel:WORD_1 src1_sel:WORD_1
    v_alignbyte_b32 v114, v115, v114, 2
    s_mov_b32 s54, 71677
    v_alignbyte_b32 v111, v111, v110, 1
    v_perm_b32 v110, v110, v114, s47
    s_waitcnt lgkmcnt(1)
    v_add3_u32 v116, v116, v106, s54
    v_sub_u32 v117, 0, v116
    v_and_b32 v117, 3, v117
    s_mov_b64 exec, s[80:81]
    v_mov_b32 v117, 0
    v_mov_b32 v112, 0
    s_mov_b64 exec, vcc
    v_mov_b32 v117, 3

    s_mov_b64 exec, -1
    v_alignbyte_b32 v110, v111, v110, v117
    v_alignbyte_b32 v111, v112, v111, v117
    v_add_u32 v116, v116, v117

    buffer_store_dwordx2 v[110:111], v116, s[24:27], 0 offen
    v_cmp_ne_u32_sdwa s[80:81], v119, v121 src0_sel:WORD_1 src1_sel:WORD_1
    v_cmp_ne_u32_sdwa vcc, v119, v123 src0_sel:WORD_1 src1_sel:WORD_1
    v_alignbyte_b32 v122, v123, v122, 2
    s_mov_b32 s54, 76797
    v_alignbyte_b32 v119, v119, v118, 1
    v_perm_b32 v118, v118, v122, s47
    s_waitcnt lgkmcnt(0)
    v_add3_u32 v124, v124, v106, s54
    v_sub_u32 v125, 0, v124
    v_and_b32 v125, 3, v125
    s_mov_b64 exec, s[80:81]
    v_mov_b32 v125, 0
    v_mov_b32 v120, 0
    s_mov_b64 exec, vcc
    v_mov_b32 v125, 3

    s_andn2_b64 exec, -1, s[68:69]
    v_bfrev_b32 v124, 1
    s_mov_b64 exec, -1
    v_alignbyte_b32 v118, v119, v118, v125
    v_alignbyte_b32 v119, v120, v119, v125
    v_add_u32 v124, v124, v125

    buffer_store_dwordx2 v[118:119], v124, s[24:27], 0 offen
L_skw_36:
    s_waitcnt lgkmcnt(0)
    s_barrier

    buffer_load_dwordx4 v[20:23], v1, s[12:15], s56 offen nt
    buffer_load_dwordx4 v[4:7], v1, s[8:11], s56 offen nt
    buffer_load_dwordx2 v[36:37], v2, s[16:19], s61 offen nt
    ds_read_b64 v[94:95], v2
    s_waitcnt lgkmcnt(0)
    v_and_b32 v94, 0xffff, v94
    v_and_b32 v95, 0xffff, v95
    v_add_u32 v97, v94, v95
    s_nop 1
    v_add_u32_dpp v97, v97, v97 row_shr:1 row_mask:0xf bank_mask:0xf
    s_nop 1
    v_add_u32_dpp v97, v97, v97 row_shr:2 row_mask:0xf bank_mask:0xf
    s_nop 1
    v_add_u32_dpp v97, v97, v97 row_shr:4 row_mask:0xf bank_mask:0xf
    s_nop 1
    v_add_u32_dpp v97, v97, v97 row_shr:8 row_mask:0xf bank_mask:0xf
    s_nop 1
    v_add_u32_dpp v97, v97, v97 row_bcast:15 row_mask:0xa bank_mask:0xf
    s_nop 1
    v_add_u32_dpp v97, v97, v97 row_bcast:31 row_mask:0xc bank_mask:0xf
    s_mov_b32 exec_lo, 0
    s_brev_b32 exec_hi, 1
    ds_add_rtn_u32 v96, v108, v97
    s_mov_b64 exec, -1

    v_add_u32 v92, v94, v94
    v_add_u32 v93, v95, v95
    v_med3_u32 v92, v94, 2, v92
    v_med3_u32 v93, v95, 2, v93
    buffer_atomic_add_x2 v[92:93], v2, s[20:23], 0 offen sc0
    s_waitcnt lgkmcnt(0)
    v_readlane_b32 s77, v96, 63
    v_mul_u32_u24 v114, 7936, v0
    v_sub_u32 v97, v97, v95
    s_sub_u32 s50, s50, s83
    s_sub_u32 s77, s77, s50
    v_add_u32 v97, s77, v97
    v_sub_u32 v96, v97, v94
    v_lshlrev_b32 v111, 16, v97
    v_lshlrev_b32 v110, 16, v96
    ds_write_b64 v2, v[110:111]
    v_sub_u32 v96, v114, v96
    v_sub_u32 v97, v114, v97
    v_add_u32 v97, s48, v97
    s_add_u32 s50, s50, s84
    s_mov_b32 s28, s82
    s_mov_b32 s29, s83
    s_mov_b32 s30, s84
    s_lshl_b32 s74, s29, 3
    s_lshl_b32 s75, s30, 3
    v_mov_b32 v125, s74
    v_mov_b32 v126, s75
    v_mov_b32 v127, -1

    s_waitcnt lgkmcnt(0)
    s_barrier

    s_mov_b64 exec, 1
    ds_write_b32 v125, v127 offset:16396
    ds_write_b32 v126, v127 offset:16404
    s_mov_b64 exec, -1

    buffer_load_dwordx4 v[24:27], v1, s[12:15], s57 offen nt
    buffer_load_dwordx4 v[8:11], v1, s[8:11], s57 offen nt
    buffer_load_dwordx2 v[38:39], v2, s[16:19], s62 offen nt
    s_bitcmp0_b32 s28, 0
    s_cbranch_scc1 L_skz_37
    v_lshrrev_b32 v110, 16, v45
    ds_read_b32 v110, v110
    v_lshrrev_b32 v111, 16, v47
    ds_read_b32 v111, v111
    v_lshrrev_b32 v112, 16, v49
    ds_read_b32 v112, v112
    v_lshrrev_b32 v113, 16, v51
    ds_read_b32 v113, v113
    v_lshrrev_b32 v114, 16, v53
    ds_read_b32 v114, v114
    v_lshrrev_b32 v115, 16, v55
    ds_read_b32 v115, v115
    v_lshrrev_b32 v116, 16, v57
    ds_read_b32 v116, v116
    v_lshrrev_b32 v117, 16, v59
    ds_read_b32 v117, v117
    s_waitcnt lgkmcnt(7)
    v_add_u32_sdwa v110, v110, v76 dst_sel:DWORD dst_unused:UNUSED_PAD src0_sel:WORD_1 src1_sel:WORD_0
    v_lshlrev_b32 v110, 3, v110
    ds_write_b64 v110, v[44:45] offset:16400

    s_waitcnt lgkmcnt(7)
    v_add_u32_sdwa v111, v111, v77 dst_sel:DWORD dst_unused:UNUSED_PAD src0_sel:WORD_1 src1_sel:WORD_0
    v_lshlrev_b32 v111, 3, v111
    ds_write_b64 v111, v[46:47] offset:16400

    s_waitcnt lgkmcnt(7)
    v_add_u32_sdwa v112, v112, v78 dst_sel:DWORD dst_unused:UNUSED_PAD src0_sel:WORD_1 src1_sel:WORD_0
    v_lshlrev_b32 v112, 3, v112
    ds_write_b64 v112, v[48:49] offset:16400

    s_waitcnt lgkmcnt(7)
    v_add_u32_sdwa v113, v113, v79 dst_sel:DWORD dst_unused:UNUSED_PAD src0_sel:WORD_1 src1_sel:WORD_0
    v_lshlrev_b32 v113, 3, v113
    ds_write_b64 v113, v[50:51] offset:16400

    s_waitcnt lgkmcnt(7)
    v_add_u32_sdwa v114, v114, v80 dst_sel:DWORD dst_unused:UNUSED_PAD src0_sel:WORD_1 src1_sel:WORD_0
    v_lshlrev_b32 v114, 3, v114
    ds_write_b64 v114, v[52:53] offset:16400

    s_waitcnt lgkmcnt(7)
    v_add_u32_sdwa v115, v115, v81 dst_sel:DWORD dst_unused:UNUSED_PAD src0_sel:WORD_1 src1_sel:WORD_0
    v_lshlrev_b32 v115, 3, v115
    ds_write_b64 v115, v[54:55] offset:16400

    s_waitcnt lgkmcnt(7)
    v_add_u32_sdwa v116, v116, v82 dst_sel:DWORD dst_unused:UNUSED_PAD src0_sel:WORD_1 src1_sel:WORD_0
    v_lshlrev_b32 v116, 3, v116
    ds_write_b64 v116, v[56:57] offset:16400

    s_waitcnt lgkmcnt(7)
    v_add_u32_sdwa v117, v117, v83 dst_sel:DWORD dst_unused:UNUSED_PAD src0_sel:WORD_1 src1_sel:WORD_0
    v_lshlrev_b32 v117, 3, v117
    ds_write_b64 v117, v[58:59] offset:16400

L_skz_37:
    buffer_load_dwordx4 v[28:31], v1, s[12:15], s58 offen nt
    buffer_load_dwordx4 v[12:15], v1, s[8:11], s58 offen nt
    buffer_load_dwordx2 v[40:41], v2, s[16:19], s63 offen nt
    s_bitcmp0_b32 s28, 2
    s_cbranch_scc1 L_skz_38
    v_lshrrev_b32 v110, 16, v61
    ds_read_b32 v110, v110
    v_lshrrev_b32 v111, 16, v63
    ds_read_b32 v111, v111
    v_lshrrev_b32 v112, 16, v65
    ds_read_b32 v112, v112
    v_lshrrev_b32 v113, 16, v67
    ds_read_b32 v113, v113
    s_waitcnt lgkmcnt(3)
    v_add_u32_sdwa v110, v110, v84 dst_sel:DWORD dst_unused:UNUSED_PAD src0_sel:WORD_1 src1_sel:WORD_0
    v_lshlrev_b32 v110, 3, v110
    ds_write_b64 v110, v[60:61] offset:16400

    s_waitcnt lgkmcnt(3)
    v_add_u32_sdwa v111, v111, v85 dst_sel:DWORD dst_unused:UNUSED_PAD src0_sel:WORD_1 src1_sel:WORD_0
    v_lshlrev_b32 v111, 3, v111
    ds_write_b64 v111, v[62:63] offset:16400

    s_waitcnt lgkmcnt(3)
    v_add_u32_sdwa v112, v112, v86 dst_sel:DWORD dst_unused:UNUSED_PAD src0_sel:WORD_1 src1_sel:WORD_0
    v_lshlrev_b32 v112, 3, v112
    ds_write_b64 v112, v[64:65] offset:16400

    s_waitcnt lgkmcnt(3)
    v_add_u32_sdwa v113, v113, v87 dst_sel:DWORD dst_unused:UNUSED_PAD src0_sel:WORD_1 src1_sel:WORD_0
    v_lshlrev_b32 v113, 3, v113
    ds_write_b64 v113, v[66:67] offset:16400

L_skz_38:
    s_bitcmp0_b32 s28, 3
    s_cbranch_scc1 L_skz_39
    s_mov_b64 exec, s[66:67]
    v_lshrrev_b32 v110, 16, v69
    ds_read_b32 v110, v110
    v_lshrrev_b32 v111, 16, v71
    ds_read_b32 v111, v111
    v_lshrrev_b32 v112, 16, v73
    ds_read_b32 v112, v112
    v_lshrrev_b32 v113, 16, v75
    ds_read_b32 v113, v113
    s_waitcnt lgkmcnt(3)
    v_add_u32_sdwa v110, v110, v88 dst_sel:DWORD dst_unused:UNUSED_PAD src0_sel:WORD_1 src1_sel:WORD_0
    v_lshlrev_b32 v110, 3, v110
    ds_write_b64 v110, v[68:69] offset:16400

    s_waitcnt lgkmcnt(3)
    v_add_u32_sdwa v111, v111, v89 dst_sel:DWORD dst_unused:UNUSED_PAD src0_sel:WORD_1 src1_sel:WORD_0
    v_lshlrev_b32 v111, 3, v111
    ds_write_b64 v111, v[70:71] offset:16400

    s_waitcnt lgkmcnt(3)
    v_add_u32_sdwa v112, v112, v90 dst_sel:DWORD dst_unused:UNUSED_PAD src0_sel:WORD_1 src1_sel:WORD_0
    v_lshlrev_b32 v112, 3, v112
    ds_write_b64 v112, v[72:73] offset:16400

    s_waitcnt lgkmcnt(3)
    v_add_u32_sdwa v113, v113, v91 dst_sel:DWORD dst_unused:UNUSED_PAD src0_sel:WORD_1 src1_sel:WORD_0
    v_lshlrev_b32 v113, 3, v113
    ds_write_b64 v113, v[74:75] offset:16400

    s_mov_b64 exec, -1
L_skz_39:
    buffer_load_dwordx4 v[32:35], v1, s[12:15], s59 offen nt
    buffer_load_dwordx4 v[16:19], v1, s[8:11], s59 offen nt
    buffer_load_dwordx2 v[42:43], v2, s[16:19], s64 offen nt
    s_cmp_lg_u32 s49, 0
    s_cbranch_scc1 L_p1loop_5
L_p1epi_6:
    s_waitcnt vmcnt(0)
    s_waitcnt vmcnt(9)
    v_add_u32 v110, v92, v94
    v_min_u32 v92, s48, v92
    v_add_u32 v111, v93, v95
    v_min_u32 v93, s48, v93
    v_max_u32 v110, v110, v111
    v_add_u32 v92, v92, v96
    v_add_u32 v93, v93, v97
    v_cmp_le_u32 vcc, s48, v110
    v_lshl_add_u32 v92, v92, 2, v92
    v_lshl_add_u32 v93, v93, 2, v93
    ds_write_b64 v2, v[92:93] offset:8192
    s_cbranch_vccz L_noov_40
    ds_write_b32 v108, v104 offset:4
L_noov_40:

    s_waitcnt lgkmcnt(0)
    s_barrier
    ds_read_b32 v110, v108 offset:4
    s_waitcnt lgkmcnt(0)
    v_readfirstlane_b32 s53, v110
    s_nop 1

    s_cmp_lg_u32 s53, 0
    s_cbranch_scc1 L_slow_41
L_sback_42:
    s_bitcmp0_b32 s28, 0
    s_cbranch_scc1 L_skw_46
    ds_read_b64 v[4:5], v2 offset:16400
    ds_read_b64 v[6:7], v2 offset:16408
    ds_read_b64 v[8:9], v2 offset:16392

    ds_read_b64 v[12:13], v2 offset:24592
    ds_read_b64 v[14:15], v2 offset:24600
    ds_read_b64 v[16:17], v2 offset:24584

    ds_read_b64 v[20:21], v2 offset:32784
    ds_read_b64 v[22:23], v2 offset:32792
    ds_read_b64 v[24:25], v2 offset:32776

    ds_read_b64 v[28:29], v2 offset:40976
    ds_read_b64 v[30:31], v2 offset:40984
    ds_read_b64 v[32:33], v2 offset:40968

    s_waitcnt lgkmcnt(9)
    v_lshrrev_b32 v10, 16, v5
    ds_read_b32 v10, v10 offset:8192

    s_waitcnt lgkmcnt(7)
    v_lshrrev_b32 v18, 16, v13
    ds_read_b32 v18, v18 offset:8192

    s_waitcnt lgkmcnt(5)
    v_lshrrev_b32 v26, 16, v21
    ds_read_b32 v26, v26 offset:8192

    s_waitcnt lgkmcnt(3)
    v_lshrrev_b32 v34, 16, v29
    ds_read_b32 v34, v34 offset:8192

    v_cmp_ne_u32_sdwa s[80:81], v5, v7 src0_sel:WORD_1 src1_sel:WORD_1
    v_cmp_ne_u32_sdwa vcc, v5, v9 src0_sel:WORD_1 src1_sel:WORD_1
    v_alignbyte_b32 v8, v9, v8, 2
    s_mov_b32 s54, -3
    v_alignbyte_b32 v5, v5, v4, 1
    v_perm_b32 v4, v4, v8, s47
    s_waitcnt lgkmcnt(3)
    v_add3_u32 v10, v10, v106, s54
    v_sub_u32 v11, 0, v10
    v_and_b32 v11, 3, v11
    s_mov_b64 exec, s[80:81]
    v_mov_b32 v11, 0
    v_mov_b32 v6, 0
    s_mov_b64 exec, vcc
    v_mov_b32 v11, 3

    s_mov_b64 exec, -1
    v_alignbyte_b32 v4, v5, v4, v11
    v_alignbyte_b32 v5, v6, v5, v11
    v_add_u32 v10, v10, v11

    buffer_store_dwordx2 v[4:5], v10, s[24:27], 0 offen
    v_cmp_ne_u32_sdwa s[80:81], v13, v15 src0_sel:WORD_1 src1_sel:WORD_1
    v_cmp_ne_u32_sdwa vcc, v13, v17 src0_sel:WORD_1 src1_sel:WORD_1
    v_alignbyte_b32 v16, v17, v16, 2
    s_mov_b32 s54, 5117
    v_alignbyte_b32 v13, v13, v12, 1
    v_perm_b32 v12, v12, v16, s47
    s_waitcnt lgkmcnt(2)
    v_add3_u32 v18, v18, v106, s54
    v_sub_u32 v19, 0, v18
    v_and_b32 v19, 3, v19
    s_mov_b64 exec, s[80:81]
    v_mov_b32 v19, 0
    v_mov_b32 v14, 0
    s_mov_b64 exec, vcc
    v_mov_b32 v19, 3

    s_mov_b64 exec, -1
    v_alignbyte_b32 v12, v13, v12, v19
    v_alignbyte_b32 v13, v14, v13, v19
    v_add_u32 v18, v18, v19

    buffer_store_dwordx2 v[12:13], v18, s[24:27], 0 offen
    v_cmp_ne_u32_sdwa s[80:81], v21, v23 src0_sel:WORD_1 src1_sel:WORD_1
    v_cmp_ne_u32_sdwa vcc, v21, v25 src0_sel:WORD_1 src1_sel:WORD_1
    v_alignbyte_b32 v24, v25, v24, 2
    s_mov_b32 s54, 10237
    v_alignbyte_b32 v21, v21, v20, 1
    v_perm_b32 v20, v20, v24, s47
    s_waitcnt lgkmcnt(1)
    v_add3_u32 v26, v26, v106, s54
    v_sub_u32 v27, 0, v26
    v_and_b32 v27, 3, v27
    s_mov_b64 exec, s[80:81]
    v_mov_b32 v27, 0
    v_mov_b32 v22, 0
    s_mov_b64 exec, vcc
    v_mov_b32 v27, 3

    s_mov_b64 exec, -1
    v_alignbyte_b32 v20, v21, v20, v27
    v_alignbyte_b32 v21, v22, v21, v27
    v_add_u32 v26, v26, v27

    buffer_store_dwordx2 v[20:21], v26, s[24:27], 0 offen
    v_cmp_ne_u32_sdwa s[80:81], v29, v31 src0_sel:WORD_1 src1_sel:WORD_1
    v_cmp_ne_u32_sdwa vcc, v29, v33 src0_sel:WORD_1 src1_sel:WORD_1
    v_alignbyte_b32 v32, v33, v32, 2
    s_mov_b32 s54, 15357
    v_alignbyte_b32 v29, v29, v28, 1
    v_perm_b32 v28, v28, v32, s47
    s_waitcnt lgkmcnt(0)
    v_add3_u32 v34, v34, v106, s54
    v_sub_u32 v35, 0, v34
    v_and_b32 v35, 3, v35
    s_mov_b64 exec, s[80:81]
    v_mov_b32 v35, 0
    v_mov_b32 v30, 0
    s_mov_b64 exec, vcc
    v_mov_b32 v35, 3

    s_mov_b64 exec, -1
    v_alignbyte_b32 v28, v29, v28, v35
    v_alignbyte_b32 v29, v30, v29, v35
    v_add_u32 v34, v34, v35

    buffer_store_dwordx2 v[28:29], v34, s[24:27], 0 offen
L_skw_46:
    s_bitcmp0_b32 s28, 1
    s_cbranch_scc1 L_skw_47
    v_add_u32 v107, 32768, v2
    ds_read_b64 v[4:5], v107 offset:16400
    ds_read_b64 v[6:7], v107 offset:16408
    ds_read_b64 v[8:9], v107 offset:16392

    ds_read_b64 v[12:13], v107 offset:24592
    ds_read_b64 v[14:15], v107 offset:24600
    ds_read_b64 v[16:17], v107 offset:24584

    ds_read_b64 v[20:21], v107 offset:32784
    ds_read_b64 v[22:23], v107 offset:32792
    ds_read_b64 v[24:25], v107 offset:32776

    ds_read_b64 v[28:29], v107 offset:40976
    ds_read_b64 v[30:31], v107 offset:40984
    ds_read_b64 v[32:33], v107 offset:40968

    s_waitcnt lgkmcnt(9)
    v_lshrrev_b32 v10, 16, v5
    ds_read_b32 v10, v10 offset:8192

    s_waitcnt lgkmcnt(7)
    v_lshrrev_b32 v18, 16, v13
    ds_read_b32 v18, v18 offset:8192

    s_waitcnt lgkmcnt(5)
    v_lshrrev_b32 v26, 16, v21
    ds_read_b32 v26, v26 offset:8192

    s_waitcnt lgkmcnt(3)
    v_lshrrev_b32 v34, 16, v29
    ds_read_b32 v34, v34 offset:8192

    v_cmp_ne_u32_sdwa s[80:81], v5, v7 src0_sel:WORD_1 src1_sel:WORD_1
    v_cmp_ne_u32_sdwa vcc, v5, v9 src0_sel:WORD_1 src1_sel:WORD_1
    v_alignbyte_b32 v8, v9, v8, 2
    s_mov_b32 s54, 20477
    v_alignbyte_b32 v5, v5, v4, 1
    v_perm_b32 v4, v4, v8, s47
    s_waitcnt lgkmcnt(3)
    v_add3_u32 v10, v10, v106, s54
    v_sub_u32 v11, 0, v10
    v_and_b32 v11, 3, v11
    s_mov_b64 exec, s[80:81]
    v_mov_b32 v11, 0
    v_mov_b32 v6, 0
    s_mov_b64 exec, vcc
    v_mov_b32 v11, 3

    s_mov_b64 exec, -1
    v_alignbyte_b32 v4, v5, v4, v11
    v_alignbyte_b32 v5, v6, v5, v11
    v_add_u32 v10, v10, v11

    buffer_store_dwordx2 v[4:5], v10, s[24:27], 0 offen
    v_cmp_ne_u32_sdwa s[80:81], v13, v15 src0_sel:WORD_1 src1_sel:WORD_1
    v_cmp_ne_u32_sdwa vcc, v13, v17 src0_sel:WORD_1 src1_sel:WORD_1
    v_alignbyte_b32 v16, v17, v16, 2
    s_mov_b32 s54, 25597
    v_alignbyte_b32 v13, v13, v12, 1
    v_perm_b32 v12, v12, v16, s47
    s_waitcnt lgkmcnt(2)
    v_add3_u32 v18, v18, v106, s54
    v_sub_u32 v19, 0, v18
    v_and_b32 v19, 3, v19
    s_mov_b64 exec, s[80:81]
    v_mov_b32 v19, 0
    v_mov_b32 v14, 0
    s_mov_b64 exec, vcc
    v_mov_b32 v19, 3

    s_mov_b64 exec, -1
    v_alignbyte_b32 v12, v13, v12, v19
    v_alignbyte_b32 v13, v14, v13, v19
    v_add_u32 v18, v18, v19

    buffer_store_dwordx2 v[12:13], v18, s[24:27], 0 offen
    v_cmp_ne_u32_sdwa s[80:81], v21, v23 src0_sel:WORD_1 src1_sel:WORD_1
    v_cmp_ne_u32_sdwa vcc, v21, v25 src0_sel:WORD_1 src1_sel:WORD_1
    v_alignbyte_b32 v24, v25, v24, 2
    s_mov_b32 s54, 30717
    v_alignbyte_b32 v21, v21, v20, 1
    v_perm_b32 v20, v20, v24, s47
    s_waitcnt lgkmcnt(1)
    v_add3_u32 v26, v26, v106, s54
    v_sub_u32 v27, 0, v26
    v_and_b32 v27, 3, v27
    s_mov_b64 exec, s[80:81]
    v_mov_b32 v27, 0
    v_mov_b32 v22, 0
    s_mov_b64 exec, vcc
    v_mov_b32 v27, 3

    s_mov_b64 exec, -1
    v_alignbyte_b32 v20, v21, v20, v27
    v_alignbyte_b32 v21, v22, v21, v27
    v_add_u32 v26, v26, v27

    buffer_store_dwordx2 v[20:21], v26, s[24:27], 0 offen
    v_cmp_ne_u32_sdwa s[80:81], v29, v31 src0_sel:WORD_1 src1_sel:WORD_1
    v_cmp_ne_u32_sdwa vcc, v29, v33 src0_sel:WORD_1 src1_sel:WORD_1
    v_alignbyte_b32 v32, v33, v32, 2
    s_mov_b32 s54, 35837
    v_alignbyte_b32 v29, v29, v28, 1
    v_perm_b32 v28, v28, v32, s47
    s_waitcnt lgkmcnt(0)
    v_add3_u32 v34, v34, v106, s54
    v_sub_u32 v35, 0, v34
    v_and_b32 v35, 3, v35
    s_mov_b64 exec, s[80:81]
    v_mov_b32 v35, 0
    v_mov_b32 v30, 0
    s_mov_b64 exec, vcc
    v_mov_b32 v35, 3

    s_mov_b64 exec, -1
    v_alignbyte_b32 v28, v29, v28, v35
    v_alignbyte_b32 v29, v30, v29, v35
    v_add_u32 v34, v34, v35

    buffer_store_dwordx2 v[28:29], v34, s[24:27], 0 offen
L_skw_47:
    s_bitcmp0_b32 s28, 2
    s_cbranch_scc1 L_skw_48
    v_add_u32 v107, 65536, v2
    ds_read_b64 v[4:5], v107 offset:16400
    ds_read_b64 v[6:7], v107 offset:16408
    ds_read_b64 v[8:9], v107 offset:16392

    ds_read_b64 v[12:13], v107 offset:24592
    ds_read_b64 v[14:15], v107 offset:24600
    ds_read_b64 v[16:17], v107 offset:24584

    ds_read_b64 v[20:21], v107 offset:32784
    ds_read_b64 v[22:23], v107 offset:32792
    ds_read_b64 v[24:25], v107 offset:32776

    ds_read_b64 v[28:29], v107 offset:40976
    ds_read_b64 v[30:31], v107 offset:40984
    ds_read_b64 v[32:33], v107 offset:40968

    s_waitcnt lgkmcnt(9)
    v_lshrrev_b32 v10, 16, v5
    ds_read_b32 v10, v10 offset:8192

    s_waitcnt lgkmcnt(7)
    v_lshrrev_b32 v18, 16, v13
    ds_read_b32 v18, v18 offset:8192

    s_waitcnt lgkmcnt(5)
    v_lshrrev_b32 v26, 16, v21
    ds_read_b32 v26, v26 offset:8192

    s_waitcnt lgkmcnt(3)
    v_lshrrev_b32 v34, 16, v29
    ds_read_b32 v34, v34 offset:8192

    v_cmp_ne_u32_sdwa s[80:81], v5, v7 src0_sel:WORD_1 src1_sel:WORD_1
    v_cmp_ne_u32_sdwa vcc, v5, v9 src0_sel:WORD_1 src1_sel:WORD_1
    v_alignbyte_b32 v8, v9, v8, 2
    s_mov_b32 s54, 40957
    v_alignbyte_b32 v5, v5, v4, 1
    v_perm_b32 v4, v4, v8, s47
    s_waitcnt lgkmcnt(3)
    v_add3_u32 v10, v10, v106, s54
    v_sub_u32 v11, 0, v10
    v_and_b32 v11, 3, v11
    s_mov_b64 exec, s[80:81]
    v_mov_b32 v11, 0
    v_mov_b32 v6, 0
    s_mov_b64 exec, vcc
    v_mov_b32 v11, 3

    s_mov_b64 exec, -1
    v_alignbyte_b32 v4, v5, v4, v11
    v_alignbyte_b32 v5, v6, v5, v11
    v_add_u32 v10, v10, v11

    buffer_store_dwordx2 v[4:5], v10, s[24:27], 0 offen
    v_cmp_ne_u32_sdwa s[80:81], v13, v15 src0_sel:WORD_1 src1_sel:WORD_1
    v_cmp_ne_u32_sdwa vcc, v13, v17 src0_sel:WORD_1 src1_sel:WORD_1
    v_alignbyte_b32 v16, v17, v16, 2
    s_mov_b32 s54, 46077
    v_alignbyte_b32 v13, v13, v12, 1
    v_perm_b32 v12, v12, v16, s47
    s_waitcnt lgkmcnt(2)
    v_add3_u32 v18, v18, v106, s54
    v_sub_u32 v19, 0, v18
    v_and_b32 v19, 3, v19
    s_mov_b64 exec, s[80:81]
    v_mov_b32 v19, 0
    v_mov_b32 v14, 0
    s_mov_b64 exec, vcc
    v_mov_b32 v19, 3

    s_mov_b64 exec, -1
    v_alignbyte_b32 v12, v13, v12, v19
    v_alignbyte_b32 v13, v14, v13, v19
    v_add_u32 v18, v18, v19

    buffer_store_dwordx2 v[12:13], v18, s[24:27], 0 offen
    v_cmp_ne_u32_sdwa s[80:81], v21, v23 src0_sel:WORD_1 src1_sel:WORD_1
    v_cmp_ne_u32_sdwa vcc, v21, v25 src0_sel:WORD_1 src1_sel:WORD_1
    v_alignbyte_b32 v24, v25, v24, 2
    s_mov_b32 s54, 51197
    v_alignbyte_b32 v21, v21, v20, 1
    v_perm_b32 v20, v20, v24, s47
    s_waitcnt lgkmcnt(1)
    v_add3_u32 v26, v26, v106, s54
    v_sub_u32 v27, 0, v26
    v_and_b32 v27, 3, v27
    s_mov_b64 exec, s[80:81]
    v_mov_b32 v27, 0
    v_mov_b32 v22, 0
    s_mov_b64 exec, vcc
    v_mov_b32 v27, 3

    s_mov_b64 exec, -1
    v_alignbyte_b32 v20, v21, v20, v27
    v_alignbyte_b32 v21, v22, v21, v27
    v_add_u32 v26, v26, v27

    buffer_store_dwordx2 v[20:21], v26, s[24:27], 0 offen
    v_cmp_ne_u32_sdwa s[80:81], v29, v31 src0_sel:WORD_1 src1_sel:WORD_1
    v_cmp_ne_u32_sdwa vcc, v29, v33 src0_sel:WORD_1 src1_sel:WORD_1
    v_alignbyte_b32 v32, v33, v32, 2
    s_mov_b32 s54, 56317
    v_alignbyte_b32 v29, v29, v28, 1
    v_perm_b32 v28, v28, v32, s47
    s_waitcnt lgkmcnt(0)
    v_add3_u32 v34, v34, v106, s54
    v_sub_u32 v35, 0, v34
    v_and_b32 v35, 3, v35
    s_mov_b64 exec, s[80:81]
    v_mov_b32 v35, 0
    v_mov_b32 v30, 0
    s_mov_b64 exec, vcc
    v_mov_b32 v35, 3

    s_mov_b64 exec, -1
    v_alignbyte_b32 v28, v29, v28, v35
    v_alignbyte_b32 v29, v30, v29, v35
    v_add_u32 v34, v34, v35

    buffer_store_dwordx2 v[28:29], v34, s[24:27], 0 offen
L_skw_48:
    s_bitcmp0_b32 s28, 3
    s_cbranch_scc1 L_skw_49
    v_add_u32 v107, 98304, v2
    ds_read_b64 v[4:5], v107 offset:16400
    ds_read_b64 v[6:7], v107 offset:16408
    ds_read_b64 v[8:9], v107 offset:16392

    ds_read_b64 v[12:13], v107 offset:24592
    ds_read_b64 v[14:15], v107 offset:24600
    ds_read_b64 v[16:17], v107 offset:24584

    ds_read_b64 v[20:21], v107 offset:32784
    ds_read_b64 v[22:23], v107 offset:32792
    ds_read_b64 v[24:25], v107 offset:32776

    ds_read_b64 v[28:29], v107 offset:40976
    ds_read_b64 v[30:31], v107 offset:40984
    ds_read_b64 v[32:33], v107 offset:40968

    s_waitcnt lgkmcnt(9)
    v_lshrrev_b32 v10, 16, v5
    ds_read_b32 v10, v10 offset:8192

    s_waitcnt lgkmcnt(7)
    v_lshrrev_b32 v18, 16, v13
    ds_read_b32 v18, v18 offset:8192

    s_waitcnt lgkmcnt(5)
    v_lshrrev_b32 v26, 16, v21
    ds_read_b32 v26, v26 offset:8192

    s_waitcnt lgkmcnt(3)
    v_lshrrev_b32 v34, 16, v29
    ds_read_b32 v34, v34 offset:8192

    v_cmp_ne_u32_sdwa s[80:81], v5, v7 src0_sel:WORD_1 src1_sel:WORD_1
    v_cmp_ne_u32_sdwa vcc, v5, v9 src0_sel:WORD_1 src1_sel:WORD_1
    v_alignbyte_b32 v8, v9, v8, 2
    s_mov_b32 s54, 61437
    v_alignbyte_b32 v5, v5, v4, 1
    v_perm_b32 v4, v4, v8, s47
    s_waitcnt lgkmcnt(3)
    v_add3_u32 v10, v10, v106, s54
    v_sub_u32 v11, 0, v10
    v_and_b32 v11, 3, v11
    s_mov_b64 exec, s[80:81]
    v_mov_b32 v11, 0
    v_mov_b32 v6, 0
    s_mov_b64 exec, vcc
    v_mov_b32 v11, 3

    s_mov_b64 exec, -1
    v_alignbyte_b32 v4, v5, v4, v11
    v_alignbyte_b32 v5, v6, v5, v11
    v_add_u32 v10, v10, v11

    buffer_store_dwordx2 v[4:5], v10, s[24:27], 0 offen
    v_cmp_ne_u32_sdwa s[80:81], v13, v15 src0_sel:WORD_1 src1_sel:WORD_1
    v_cmp_ne_u32_sdwa vcc, v13, v17 src0_sel:WORD_1 src1_sel:WORD_1
    v_alignbyte_b32 v16, v17, v16, 2
    s_mov_b32 s54, 66557
    v_alignbyte_b32 v13, v13, v12, 1
    v_perm_b32 v12, v12, v16, s47
    s_waitcnt lgkmcnt(2)
    v_add3_u32 v18, v18, v106, s54
    v_sub_u32 v19, 0, v18
    v_and_b32 v19, 3, v19
    s_mov_b64 exec, s[80:81]
    v_mov_b32 v19, 0
    v_mov_b32 v14, 0
    s_mov_b64 exec, vcc
    v_mov_b32 v19, 3

    s_mov_b64 exec, -1
    v_alignbyte_b32 v12, v13, v12, v19
    v_alignbyte_b32 v13, v14, v13, v19
    v_add_u32 v18, v18, v19

    buffer_store_dwordx2 v[12:13], v18, s[24:27], 0 offen
    v_cmp_ne_u32_sdwa s[80:81], v21, v23 src0_sel:WORD_1 src1_sel:WORD_1
    v_cmp_ne_u32_sdwa vcc, v21, v25 src0_sel:WORD_1 src1_sel:WORD_1
    v_alignbyte_b32 v24, v25, v24, 2
    s_mov_b32 s54, 71677
    v_alignbyte_b32 v21, v21, v20, 1
    v_perm_b32 v20, v20, v24, s47
    s_waitcnt lgkmcnt(1)
    v_add3_u32 v26, v26, v106, s54
    v_sub_u32 v27, 0, v26
    v_and_b32 v27, 3, v27
    s_mov_b64 exec, s[80:81]
    v_mov_b32 v27, 0
    v_mov_b32 v22, 0
    s_mov_b64 exec, vcc
    v_mov_b32 v27, 3

    s_mov_b64 exec, -1
    v_alignbyte_b32 v20, v21, v20, v27
    v_alignbyte_b32 v21, v22, v21, v27
    v_add_u32 v26, v26, v27

    buffer_store_dwordx2 v[20:21], v26, s[24:27], 0 offen
    v_cmp_ne_u32_sdwa s[80:81], v29, v31 src0_sel:WORD_1 src1_sel:WORD_1
    v_cmp_ne_u32_sdwa vcc, v29, v33 src0_sel:WORD_1 src1_sel:WORD_1
    v_alignbyte_b32 v32, v33, v32, 2
    s_mov_b32 s54, 76797
    v_alignbyte_b32 v29, v29, v28, 1
    v_perm_b32 v28, v28, v32, s47
    s_waitcnt lgkmcnt(0)
    v_add3_u32 v34, v34, v106, s54
    v_sub_u32 v35, 0, v34
    v_and_b32 v35, 3, v35
    s_mov_b64 exec, s[80:81]
    v_mov_b32 v35, 0
    v_mov_b32 v30, 0
    s_mov_b64 exec, vcc
    v_mov_b32 v35, 3

    s_andn2_b64 exec, -1, s[68:69]
    v_bfrev_b32 v34, 1
    s_mov_b64 exec, -1
    v_alignbyte_b32 v28, v29, v28, v35
    v_alignbyte_b32 v29, v30, v29, v35
    v_add_u32 v34, v34, v35

    buffer_store_dwordx2 v[28:29], v34, s[24:27], 0 offen
L_skw_49:
L_p1done_1:
    s_endpgm

L_slow_22:
    v_add_u32 v112, s29, v0
    v_mov_b32 v118, 0
    s_mov_b32 s75, 4960
L_sl_24:
    v_lshlrev_b32 v113, 3, v112
    ds_read_b64 v[110:111], v113 offset:16400
    ds_read_b32 v119, v113 offset:16412
    ds_read_b32 v120, v113 offset:16396
    s_waitcnt lgkmcnt(0)
    v_lshrrev_b32 v114, 16, v111
    ds_read_b32 v115, v114 offset:8192
    v_add_u32 v114, 4, v114
    v_mul_u32_u24 v114, s75, v114
    s_waitcnt lgkmcnt(0)
    v_mad_u32_u24 v115, v112, 5, v115
    v_cmp_gt_u32 s[72:73], s30, v112
    v_cmp_ge_u32 vcc, v115, v114
    s_and_b64 s[80:81], vcc, s[72:73]
    s_cbranch_scc0 L_s1_25
    s_bcnt1_i32_b64 s76, s[80:81]
    v_mbcnt_lo_u32_b32 v117, s80, 0
    v_mbcnt_hi_u32_b32 v117, s81, v117
    v_mov_b32 v116, s76
    s_mov_b64 exec, 1
    buffer_atomic_add v116, v118, s[36:39], 0 offen sc0
    s_waitcnt vmcnt(0)
    v_readfirstlane_b32 s76, v116
    s_mov_b64 exec, s[80:81]
    s_nop 0
    v_add_lshl_u32 v116, v117, s76, 3
    buffer_store_dwordx2 v[110:111], v116, s[32:35], 0 offen
L_s1_25:
    s_andn2_b64 exec, s[72:73], vcc
    s_cbranch_execz L_s2_26
    buffer_store_dword v110, v115, s[24:27], 0 offen
    buffer_store_byte v111, v115, s[24:27], 0 offen offset:4
    v_add_u32 v115, 5, v115
    v_cmpx_lt_u32 vcc, v115, v114
    v_cmpx_ne_u32_sdwa vcc, v111, v119 src0_sel:WORD_1 src1_sel:WORD_1
    v_cmpx_ne_u32_sdwa vcc, v111, v120 src0_sel:WORD_1 src1_sel:WORD_1
    s_cbranch_execz L_s2_26
    buffer_store_dword v118, v115, s[24:27], 0 offen
L_s2_26:
    s_mov_b64 exec, -1
    v_add_u32 v112, 1024, v112
    s_nop 0
    v_readfirstlane_b32 s76, v112
    s_nop 1
    s_cmp_lt_u32 s76, s30
    s_cbranch_scc1 L_sl_24
    s_mov_b32 s28, 0
    s_branch L_sback_23

L_slow_41:
    v_add_u32 v112, s29, v0
    v_mov_b32 v118, 0
    s_mov_b32 s75, 4960
L_sl_43:
    v_lshlrev_b32 v113, 3, v112
    ds_read_b64 v[110:111], v113 offset:16400
    ds_read_b32 v119, v113 offset:16412
    ds_read_b32 v120, v113 offset:16396
    s_waitcnt lgkmcnt(0)
    v_lshrrev_b32 v114, 16, v111
    ds_read_b32 v115, v114 offset:8192
    v_add_u32 v114, 4, v114
    v_mul_u32_u24 v114, s75, v114
    s_waitcnt lgkmcnt(0)
    v_mad_u32_u24 v115, v112, 5, v115
    v_cmp_gt_u32 s[72:73], s30, v112
    v_cmp_ge_u32 vcc, v115, v114
    s_and_b64 s[80:81], vcc, s[72:73]
    s_cbranch_scc0 L_s1_44
    s_bcnt1_i32_b64 s76, s[80:81]
    v_mbcnt_lo_u32_b32 v117, s80, 0
    v_mbcnt_hi_u32_b32 v117, s81, v117
    v_mov_b32 v116, s76
    s_mov_b64 exec, 1
    buffer_atomic_add v116, v118, s[36:39], 0 offen sc0
    s_waitcnt vmcnt(0)
    v_readfirstlane_b32 s76, v116
    s_mov_b64 exec, s[80:81]
    s_nop 0
    v_add_lshl_u32 v116, v117, s76, 3
    buffer_store_dwordx2 v[110:111], v116, s[32:35], 0 offen
L_s1_44:
    s_andn2_b64 exec, s[72:73], vcc
    s_cbranch_execz L_s2_45
    buffer_store_dword v110, v115, s[24:27], 0 offen
    buffer_store_byte v111, v115, s[24:27], 0 offen offset:4
    v_add_u32 v115, 5, v115
    v_cmpx_lt_u32 vcc, v115, v114
    v_cmpx_ne_u32_sdwa vcc, v111, v119 src0_sel:WORD_1 src1_sel:WORD_1
    v_cmpx_ne_u32_sdwa vcc, v111, v120 src0_sel:WORD_1 src1_sel:WORD_1
    s_cbranch_execz L_s2_45
    buffer_store_dword v118, v115, s[24:27], 0 offen
L_s2_45:
    s_mov_b64 exec, -1
    v_add_u32 v112, 1024, v112
    s_nop 0
    v_readfirstlane_b32 s76, v112
    s_nop 1
    s_cmp_lt_u32 s76, s30
    s_cbranch_scc1 L_sl_43
    s_mov_b32 s28, 0
    s_branch L_sback_42

.globl standalone__molecular_angular_gemnet__graph_kernel
.p2align 8
.type standalone__molecular_angular_gemnet__graph_kernel,@function
standalone__molecular_angular_gemnet__graph_kernel:
    s_cmp_ge_u32 s2, 256
    s_cbranch_scc1 L_p2done_50
    s_load_dwordx2 s[8:9], s[0:1], 0
    s_load_dwordx2 s[6:7], s[0:1], 104
    v_lshrrev_b32 v4, 6, v0
    s_lshr_b32 s37, s2, 1
    s_and_b32 s37, s37, 3
    s_lshr_b32 s36, s2, 3
    s_lshl_b32 s36, s36, 1
    s_and_b32 s3, s2, 1
    s_or_b32 s36, s36, s3
    v_readfirstlane_b32 s4, v4
    v_and_b32 v2, 63, v0
    v_lshrrev_b32 v3, 9, v0
    v_lshl_or_b32 v2, v3, 6, v2
    v_mul_u32_u24 v2, 20, v2
    v_lshlrev_b32 v3, 4, v0
    s_waitcnt lgkmcnt(0)
    s_lshl_b32 m0, s4, 10
    s_and_b32 s5, s4, 7
    s_lshr_b32 s39, s4, 3
    s_lshl_b32 s39, s39, 8
    s_mul_i32 s3, s5, 8192
    s_add_u32 s46, s6, s3
    s_addc_u32 s47, s7, 0
    s_mul_i32 s3, s5, 40632320
    s_add_u32 s3, s3, 83599360
    s_add_u32 s44, s6, s3
    s_addc_u32 s45, s7, 0
    s_mul_i32 s38, s37, 8
    s_add_u32 s4, s38, 8
    s_lshl_b32 s3, s38, 6
    s_add_u32 s3, s3, s36
    s_lshl_b32 s3, s3, 2
    s_add_u32 s52, s46, s3
    s_addc_u32 s53, s47, 0

    s_load_dword s88, s[52:53], 0
    s_load_dword s89, s[52:53], 256
    s_load_dword s90, s[52:53], 512
    s_load_dword s91, s[52:53], 768
    s_load_dword s92, s[52:53], 1024
    s_load_dword s93, s[52:53], 1280
    s_load_dword s94, s[52:53], 1536
    s_load_dword s95, s[52:53], 1792
    s_mov_b32 s3, 65536
    s_load_dword s51, s[6:7], s3
    s_mov_b32 s10, 6400000
    s_mov_b32 s11, 0x20000

    s_add_u32 s12, s6, 393216
    s_addc_u32 s13, s7, 0
    s_mov_b32 s14, 0
    s_mov_b32 s15, 0x20000
    s_add_u32 s60, s6, 393216
    s_addc_u32 s61, s7, 0
    s_mov_b32 s62, 6406144
    s_mov_b32 s63, 0x20000
    s_mov_b32 s3, 135176
    s_load_dword s33, s[6:7], s3

    s_mul_i32 s43, s38, 200192
    s_mul_i32 s41, s4, 200192
    s_mul_i32 s50, s38, 200000
    s_add_u32 s14, s43, 50000

    buffer_load_dwordx4 v[76:79], v3, s[12:15], s43 offen
    s_add_u32 s52, s43, 16384
    buffer_load_dwordx4 v[80:83], v3, s[12:15], s52 offen
    s_add_u32 s52, s43, 32768
    buffer_load_dwordx4 v[84:87], v3, s[12:15], s52 offen
    s_add_u32 s52, s43, 49152
    v_lshlrev_b32 v119, 2, v0
    buffer_load_dword v88, v119, s[12:15], s52 offen
    s_add_u32 s20, s6, 135168
    s_addc_u32 s21, s7, 0
    s_mov_b32 s22, 4096
    s_mov_b32 s23, 0x20000
    v_and_b32 v44, 63, v0
    v_lshlrev_b32 v44, 4, v44
    buffer_load_dwordx2 v[120:121], v44, s[20:23], 0 offen offset:0
    buffer_load_dwordx2 v[122:123], v44, s[20:23], 0 offen offset:1024
    buffer_load_dwordx2 v[124:125], v44, s[20:23], 0 offen offset:2048
    buffer_load_dwordx2 v[126:127], v44, s[20:23], 0 offen offset:3072
    s_movk_i32 s40, 3072
    s_mov_b32 s19, 0x20000
    s_min_u32 s40, s40, 3968
    s_lshl_b32 s52, s38, 6
    s_add_u32 s52, s52, s36
    s_mul_i32 s52, s52, 19840
    s_add_u32 s16, s44, s52
    s_addc_u32 s17, s45, 0
    s_mul_i32 s52, s40, 5
    s_add_u32 s52, s52, 3
    s_and_b32 s18, s52, -4

    s_movk_i32 s53, 5120
    buffer_load_dwordx4 v[90:93], v2, s[16:19], s53 offen
    buffer_load_dword v110, v2, s[16:19], s53 offen offset:16
    s_movk_i32 s53, 7680
    buffer_load_dwordx4 v[94:97], v2, s[16:19], s53 offen
    buffer_load_dword v111, v2, s[16:19], s53 offen offset:16
    s_lshr_b32 s3, s2, 3
    s_mul_i32 s3, s3, 49
    v_add_lshl_u32 v89, v0, s3, 7
    v_cmp_gt_u32 vcc, 49, v0
    v_bfrev_b32 v28, 1
    s_nop 0
    v_cndmask_b32 v89, v28, v89, vcc

    s_mov_b32 s19, 0x20000
    s_mov_b32 s28, 0x4b404000
    s_mov_b32 s29, 0x4b404000
    s_mov_b32 s30, 0xbfffc000
    s_mov_b32 s31, 0xbfffbfff
    s_mov_b32 s32, 0xffff0000
    s_mov_b32 s35, 0x05040100
    s_mov_b32 s97, 0x07060302
    s_mov_b32 s96, 0x40008000
    s_movk_i32 s3, 212
    v_cmp_gt_u32 s[48:49], s3, v0

    v_mov_b32 v1, 0
    s_mov_b32 s24, 0xc0c0004
    s_mov_b32 s25, 0xc0c0105
    s_mov_b32 s26, 0xc0c0206
    s_mov_b32 s27, 0xc0c0307
    v_mov_b32 v28, 0x40004000
    v_mov_b32 v29, 0x40004000
    v_mov_b32 v30, 0x40004000
    v_mov_b32 v31, 0x40004000
    v_add_u32 v32, 50000, v3
    v_add_u32 v33, 65536, v32

    ds_write_b128 v32, v[28:31] offset:0
    ds_write_b128 v32, v[28:31] offset:16384
    ds_write_b128 v32, v[28:31] offset:32768
    ds_write_b128 v32, v[28:31] offset:49152
    ds_write_b128 v33, v[28:31] offset:0
    ds_write_b128 v33, v[28:31] offset:16384
    v_cmp_gt_u32 vcc, 971, v0
    s_mov_b64 exec, vcc
    ds_write_b128 v33, v[28:31] offset:32768
    s_mov_b64 exec, -1
    s_waitcnt lgkmcnt(0)
    s_min_u32 s88, s88, 3968
    s_lshl_b32 s52, s38, 6
    s_add_u32 s52, s52, s36
    s_mul_i32 s52, s52, 19840
    s_add_u32 s16, s44, s52
    s_addc_u32 s17, s45, 0
    s_mul_i32 s52, s88, 5
    s_add_u32 s52, s52, 3
    s_and_b32 s18, s52, -4

    s_movk_i32 s53, 10240
    buffer_load_dwordx4 v[98:101], v2, s[16:19], s53 offen
    buffer_load_dword v112, v2, s[16:19], s53 offen offset:16
    s_movk_i32 s53, 12800
    buffer_load_dwordx4 v[102:105], v2, s[16:19], s53 offen
    buffer_load_dword v113, v2, s[16:19], s53 offen offset:16
    s_movk_i32 s53, 0
    buffer_load_dwordx4 v[4:7], v2, s[16:19], s53 offen
    buffer_load_dword v35, v2, s[16:19], s53 offen offset:16
    s_movk_i32 s53, 2560
    buffer_load_dwordx4 v[8:11], v2, s[16:19], s53 offen
    buffer_load_dword v43, v2, s[16:19], s53 offen offset:16
    s_movk_i32 s53, 15360
    buffer_load_dwordx4 v[106:109], v2, s[16:19], s53 offen
    buffer_load_dword v114, v2, s[16:19], s53 offen offset:16
    s_waitcnt vmcnt(21)
    ds_write_addtid_b32 v76 offset:0
    ds_write_addtid_b32 v77 offset:256
    ds_write_addtid_b32 v78 offset:512
    ds_write_addtid_b32 v79 offset:768
    s_waitcnt vmcnt(20)
    ds_write_addtid_b32 v80 offset:16384
    ds_write_addtid_b32 v81 offset:16640
    ds_write_addtid_b32 v82 offset:16896
    ds_write_addtid_b32 v83 offset:17152
    s_waitcnt vmcnt(19)
    ds_write_addtid_b32 v84 offset:32768
    ds_write_addtid_b32 v85 offset:33024
    ds_write_addtid_b32 v86 offset:33280
    ds_write_addtid_b32 v87 offset:33536
    v_lshlrev_b32 v119, 2, v0
    s_waitcnt vmcnt(18)
    s_mov_b64 exec, s[48:49]
    ds_write_b32 v119, v88 offset:49152
    s_mov_b64 exec, -1
    s_add_u32 s43, s43, 50048
    s_add_u32 s14, s43, 50000
    s_min_u32 s14, s14, s41
    buffer_load_dwordx4 v[76:79], v3, s[12:15], s43 offen
    s_add_u32 s52, s43, 16384
    buffer_load_dwordx4 v[80:83], v3, s[12:15], s52 offen
    s_add_u32 s52, s43, 32768
    buffer_load_dwordx4 v[84:87], v3, s[12:15], s52 offen
    s_add_u32 s52, s43, 49152
    v_lshlrev_b32 v119, 2, v0
    buffer_load_dword v88, v119, s[12:15], s52 offen
    s_add_u32 s54, s43, 50048
    buffer_load_dword v115, v89, s[60:63], s54 offen
    s_add_u32 s54, s50, 0
    buffer_load_dword v115, v89, s[8:11], s54 offen
    s_waitcnt vmcnt(20)
    v_max3_u32 v120, v120, v122, v124
    v_add_f32 v121, v121, v123
    v_add_f32 v125, v125, v127
    v_max_u32 v120, v120, v126
    v_add_f32 v121, v121, v125

    s_nop 1
    v_max_u32_dpp v120, v120, v120 row_shr:1 row_mask:0xf bank_mask:0xf
    s_nop 1
    v_max_u32_dpp v120, v120, v120 row_shr:2 row_mask:0xf bank_mask:0xf
    s_nop 1
    v_max_u32_dpp v120, v120, v120 row_shr:4 row_mask:0xf bank_mask:0xf
    s_nop 1
    v_max_u32_dpp v120, v120, v120 row_shr:8 row_mask:0xf bank_mask:0xf
    s_nop 1
    v_max_u32_dpp v120, v120, v120 row_bcast:15 row_mask:0xa bank_mask:0xf
    s_nop 1
    v_max_u32_dpp v120, v120, v120 row_bcast:31 row_mask:0xc bank_mask:0xf
    s_nop 1
    v_add_f32_dpp v121, v121, v121 row_shr:1 row_mask:0xf bank_mask:0xf
    s_nop 1
    v_add_f32_dpp v121, v121, v121 row_shr:2 row_mask:0xf bank_mask:0xf
    s_nop 1
    v_add_f32_dpp v121, v121, v121 row_shr:4 row_mask:0xf bank_mask:0xf
    s_nop 1
    v_add_f32_dpp v121, v121, v121 row_shr:8 row_mask:0xf bank_mask:0xf
    s_nop 1
    v_add_f32_dpp v121, v121, v121 row_bcast:15 row_mask:0xa bank_mask:0xf
    s_nop 1
    v_add_f32_dpp v121, v121, v121 row_bcast:31 row_mask:0xc bank_mask:0xf
    v_lshlrev_b32 v120, 16, v120
    v_mul_f32 v121, 0x34a7c5ac, v121
    v_sqrt_f32 v121, v121
    v_mul_f32 v120, s33, v120
    v_mul_f32 v121, s33, v121
    v_cmp_gt_f32 vcc, 0x46fde800, v120
    s_mov_b64 s[64:65], vcc
    v_cmp_lt_f32 vcc, 0x44000000, v121
    v_mov_b32 v120, 0x37800000
    v_mul_f32 v120, s33, v120
    s_and_b64 vcc, vcc, s[64:65]
    v_mul_f32 v121, 0x46ff8000, v120
    v_rcp_f32 v121, v121
    v_readfirstlane_b32 s33, v120
    s_waitcnt lgkmcnt(0)
    s_barrier
    v_readfirstlane_b32 s34, v121
    v_mov_b32 v120, 150016
    v_mov_b32 v121, 0
    ds_write_b32 v120, v121 offset:8
    s_bitcmp0_b64 vcc, 63
    s_cbranch_scc1 L_p2slow_51
    s_cmp_lg_u32 s51, 0
    s_cbranch_scc1 L_p2slow_51

    s_mov_b32 s40, s88
    s_sub_u32 s42, s40, s39

    s_add_u32 s55, s38, 1
    s_min_u32 s55, s55, 31
    s_mov_b32 s88, s89
    s_mov_b32 s89, s90
    s_mov_b32 s90, s91
    s_mov_b32 s91, s92
    s_mov_b32 s92, s93
    s_mov_b32 s93, s94
    s_mov_b32 s94, s95
    s_mov_b32 s95, 0
    s_min_u32 s88, s88, 3968
    s_lshl_b32 s52, s55, 6
    s_add_u32 s52, s52, s36
    s_mul_i32 s52, s52, 19840
    s_add_u32 s16, s44, s52
    s_addc_u32 s17, s45, 0
    s_mul_i32 s52, s88, 5
    s_add_u32 s52, s52, 3
    s_and_b32 s18, s52, -4

    s_waitcnt vmcnt(18)
    v_perm_b32 v44, v91, v90, s24
    v_perm_b32 v46, v92, v91, s25
    v_perm_b32 v48, v93, v92, s26
    v_perm_b32 v50, v110, v93, s27
    v_mov_b32 v12, v90
    v_alignbyte_b32 v13, v92, v91, 1
    v_alignbyte_b32 v14, v93, v92, 2
    v_alignbyte_b32 v15, v110, v93, 3
    v_lshlrev_b32_sdwa v44, 3, v44 dst_sel:WORD_0 dst_unused:UNUSED_PAD src0_sel:DWORD src1_sel:DWORD
    v_lshlrev_b32_sdwa v46, 3, v46 dst_sel:WORD_0 dst_unused:UNUSED_PAD src0_sel:DWORD src1_sel:DWORD
    v_lshlrev_b32_sdwa v48, 3, v48 dst_sel:WORD_0 dst_unused:UNUSED_PAD src0_sel:DWORD src1_sel:DWORD
    v_lshlrev_b32_sdwa v50, 3, v50 dst_sel:WORD_0 dst_unused:UNUSED_PAD src0_sel:DWORD src1_sel:DWORD
    s_cmp_lt_i32 s42, 1280
    s_cbranch_scc1 L_ufix_52
L_uback_53:

    v_subrev_co_u32 v12, s[80:81], 2.0, v12
    v_subrev_co_u32 v13, s[82:83], 2.0, v13
    v_subrev_co_u32 v14, s[84:85], 2.0, v14
    v_subrev_co_u32 v15, s[86:87], 2.0, v15
    s_mov_b64 exec, s[80:81]
    ds_read_b64 v[44:45], v44
    s_mov_b64 exec, s[82:83]
    ds_read_b64 v[46:47], v46
    s_mov_b64 exec, s[84:85]
    ds_read_b64 v[48:49], v48
    s_mov_b64 exec, s[86:87]
    ds_read_b64 v[50:51], v50
    s_mov_b64 exec, -1
    s_movk_i32 s53, 5120
    buffer_load_dwordx4 v[90:93], v2, s[16:19], s53 offen
    buffer_load_dword v110, v2, s[16:19], s53 offen offset:16
    s_waitcnt vmcnt(18)
    v_perm_b32 v52, v95, v94, s24
    v_perm_b32 v54, v96, v95, s25
    v_perm_b32 v56, v97, v96, s26
    v_perm_b32 v58, v111, v97, s27
    v_mov_b32 v16, v94
    v_alignbyte_b32 v17, v96, v95, 1
    v_alignbyte_b32 v18, v97, v96, 2
    v_alignbyte_b32 v19, v111, v97, 3
    v_lshlrev_b32_sdwa v52, 3, v52 dst_sel:WORD_0 dst_unused:UNUSED_PAD src0_sel:DWORD src1_sel:DWORD
    v_lshlrev_b32_sdwa v54, 3, v54 dst_sel:WORD_0 dst_unused:UNUSED_PAD src0_sel:DWORD src1_sel:DWORD
    v_lshlrev_b32_sdwa v56, 3, v56 dst_sel:WORD_0 dst_unused:UNUSED_PAD src0_sel:DWORD src1_sel:DWORD
    v_lshlrev_b32_sdwa v58, 3, v58 dst_sel:WORD_0 dst_unused:UNUSED_PAD src0_sel:DWORD src1_sel:DWORD
    s_cmp_lt_i32 s42, 1792
    s_cbranch_scc1 L_ufix_54
L_uback_55:

    v_subrev_co_u32 v16, s[64:65], 2.0, v16
    v_subrev_co_u32 v17, s[66:67], 2.0, v17
    v_subrev_co_u32 v18, s[68:69], 2.0, v18
    v_subrev_co_u32 v19, s[70:71], 2.0, v19
    s_mov_b64 exec, s[64:65]
    ds_read_b64 v[52:53], v52
    s_mov_b64 exec, s[66:67]
    ds_read_b64 v[54:55], v54
    s_mov_b64 exec, s[68:69]
    ds_read_b64 v[56:57], v56
    s_mov_b64 exec, s[70:71]
    ds_read_b64 v[58:59], v58
    s_mov_b64 exec, -1
    s_movk_i32 s53, 7680
    buffer_load_dwordx4 v[94:97], v2, s[16:19], s53 offen
    buffer_load_dword v111, v2, s[16:19], s53 offen offset:16
    s_waitcnt vmcnt(18)
    v_perm_b32 v60, v99, v98, s24
    v_perm_b32 v62, v100, v99, s25
    v_perm_b32 v64, v101, v100, s26
    v_perm_b32 v66, v112, v101, s27
    v_mov_b32 v20, v98
    v_alignbyte_b32 v21, v100, v99, 1
    v_alignbyte_b32 v22, v101, v100, 2
    v_alignbyte_b32 v23, v112, v101, 3
    v_lshlrev_b32_sdwa v60, 3, v60 dst_sel:WORD_0 dst_unused:UNUSED_PAD src0_sel:DWORD src1_sel:DWORD
    v_lshlrev_b32_sdwa v62, 3, v62 dst_sel:WORD_0 dst_unused:UNUSED_PAD src0_sel:DWORD src1_sel:DWORD
    v_lshlrev_b32_sdwa v64, 3, v64 dst_sel:WORD_0 dst_unused:UNUSED_PAD src0_sel:DWORD src1_sel:DWORD
    v_lshlrev_b32_sdwa v66, 3, v66 dst_sel:WORD_0 dst_unused:UNUSED_PAD src0_sel:DWORD src1_sel:DWORD
    s_cmp_lt_i32 s42, 2304
    s_cbranch_scc1 L_ufix_56
L_uback_57:

    v_subrev_co_u32 v20, s[72:73], 2.0, v20
    v_subrev_co_u32 v21, s[74:75], 2.0, v21
    v_subrev_co_u32 v22, s[76:77], 2.0, v22
    v_subrev_co_u32 v23, s[78:79], 2.0, v23
    s_mov_b64 exec, s[72:73]
    ds_read_b64 v[60:61], v60
    s_mov_b64 exec, s[74:75]
    ds_read_b64 v[62:63], v62
    s_mov_b64 exec, s[76:77]
    ds_read_b64 v[64:65], v64
    s_mov_b64 exec, s[78:79]
    ds_read_b64 v[66:67], v66
    s_mov_b64 exec, -1
    s_waitcnt vmcnt(16)
    v_perm_b32 v68, v103, v102, s24
    v_perm_b32 v70, v104, v103, s25
    v_perm_b32 v72, v105, v104, s26
    v_perm_b32 v74, v113, v105, s27
    v_mov_b32 v24, v102
    v_alignbyte_b32 v25, v104, v103, 1
    v_alignbyte_b32 v26, v105, v104, 2
    v_alignbyte_b32 v27, v113, v105, 3
    v_lshlrev_b32_sdwa v68, 3, v68 dst_sel:WORD_0 dst_unused:UNUSED_PAD src0_sel:DWORD src1_sel:DWORD
    v_lshlrev_b32_sdwa v70, 3, v70 dst_sel:WORD_0 dst_unused:UNUSED_PAD src0_sel:DWORD src1_sel:DWORD
    v_lshlrev_b32_sdwa v72, 3, v72 dst_sel:WORD_0 dst_unused:UNUSED_PAD src0_sel:DWORD src1_sel:DWORD
    v_lshlrev_b32_sdwa v74, 3, v74 dst_sel:WORD_0 dst_unused:UNUSED_PAD src0_sel:DWORD src1_sel:DWORD
    s_cmp_lt_i32 s42, 2816
    s_cbranch_scc1 L_ufix_58
L_uback_59:

    v_subrev_co_u32 v24, s[80:81], 2.0, v24
    v_subrev_co_u32 v25, s[82:83], 2.0, v25
    v_subrev_co_u32 v26, s[84:85], 2.0, v26
    v_subrev_co_u32 v27, s[86:87], 2.0, v27
    s_mov_b64 exec, s[80:81]
    ds_read_b64 v[68:69], v68
    s_mov_b64 exec, s[82:83]
    ds_read_b64 v[70:71], v70
    s_mov_b64 exec, s[84:85]
    ds_read_b64 v[72:73], v72
    s_mov_b64 exec, s[86:87]
    ds_read_b64 v[74:75], v74
    s_mov_b64 exec, -1
    s_waitcnt vmcnt(14)
    v_perm_b32 v28, v5, v4, s24
    v_perm_b32 v30, v6, v5, s25
    v_perm_b32 v32, v7, v6, s26
    v_perm_b32 v34, v35, v7, s27
    v_alignbyte_b32 v5, v6, v5, 1
    v_alignbyte_b32 v6, v7, v6, 2
    v_alignbyte_b32 v7, v35, v7, 3
    v_lshlrev_b32_sdwa v28, 3, v28 dst_sel:WORD_0 dst_unused:UNUSED_PAD src0_sel:DWORD src1_sel:DWORD
    v_lshlrev_b32_sdwa v30, 3, v30 dst_sel:WORD_0 dst_unused:UNUSED_PAD src0_sel:DWORD src1_sel:DWORD
    v_lshlrev_b32_sdwa v32, 3, v32 dst_sel:WORD_0 dst_unused:UNUSED_PAD src0_sel:DWORD src1_sel:DWORD
    v_lshlrev_b32_sdwa v34, 3, v34 dst_sel:WORD_0 dst_unused:UNUSED_PAD src0_sel:DWORD src1_sel:DWORD
    s_cmp_lt_i32 s42, 256
    s_cbranch_scc1 L_ufix_60
L_uback_61:

    v_subrev_co_u32 v4, s[64:65], 2.0, v4
    v_subrev_co_u32 v5, s[66:67], 2.0, v5
    v_subrev_co_u32 v6, s[68:69], 2.0, v6
    v_subrev_co_u32 v7, s[70:71], 2.0, v7
    s_mov_b64 exec, s[64:65]
    ds_read_b64 v[28:29], v28
    s_mov_b64 exec, s[66:67]
    ds_read_b64 v[30:31], v30
    s_mov_b64 exec, s[68:69]
    ds_read_b64 v[32:33], v32
    s_mov_b64 exec, s[70:71]
    ds_read_b64 v[34:35], v34
    s_mov_b64 exec, -1
    s_waitcnt vmcnt(12)
    v_perm_b32 v36, v9, v8, s24
    v_perm_b32 v38, v10, v9, s25
    v_perm_b32 v40, v11, v10, s26
    v_perm_b32 v42, v43, v11, s27
    v_alignbyte_b32 v9, v10, v9, 1
    v_alignbyte_b32 v10, v11, v10, 2
    v_alignbyte_b32 v11, v43, v11, 3
    v_lshlrev_b32_sdwa v36, 3, v36 dst_sel:WORD_0 dst_unused:UNUSED_PAD src0_sel:DWORD src1_sel:DWORD
    v_lshlrev_b32_sdwa v38, 3, v38 dst_sel:WORD_0 dst_unused:UNUSED_PAD src0_sel:DWORD src1_sel:DWORD
    v_lshlrev_b32_sdwa v40, 3, v40 dst_sel:WORD_0 dst_unused:UNUSED_PAD src0_sel:DWORD src1_sel:DWORD
    v_lshlrev_b32_sdwa v42, 3, v42 dst_sel:WORD_0 dst_unused:UNUSED_PAD src0_sel:DWORD src1_sel:DWORD
    s_cmp_lt_i32 s42, 768
    s_cbranch_scc1 L_ufix_62
L_uback_63:

    v_subrev_co_u32 v8, s[72:73], 2.0, v8
    v_subrev_co_u32 v9, s[74:75], 2.0, v9
    v_subrev_co_u32 v10, s[76:77], 2.0, v10
    v_subrev_co_u32 v11, s[78:79], 2.0, v11
    s_mov_b64 exec, s[72:73]
    ds_read_b64 v[36:37], v36
    s_mov_b64 exec, s[74:75]
    ds_read_b64 v[38:39], v38
    s_mov_b64 exec, s[76:77]
    ds_read_b64 v[40:41], v40
    s_mov_b64 exec, s[78:79]
    ds_read_b64 v[42:43], v42
    s_mov_b64 exec, -1
L_batch_64:
    s_add_u32 s5, s38, 1

    s_waitcnt lgkmcnt(0)
    s_barrier
    s_waitcnt vmcnt(3)
    ds_write_addtid_b32 v76 offset:0
    ds_write_addtid_b32 v77 offset:256
    ds_write_addtid_b32 v78 offset:512
    ds_write_addtid_b32 v79 offset:768
    s_waitcnt vmcnt(2)
    ds_write_addtid_b32 v80 offset:16384
    ds_write_addtid_b32 v81 offset:16640
    ds_write_addtid_b32 v82 offset:16896
    ds_write_addtid_b32 v83 offset:17152
    s_waitcnt vmcnt(1)
    ds_write_addtid_b32 v84 offset:32768
    ds_write_addtid_b32 v85 offset:33024
    ds_write_addtid_b32 v86 offset:33280
    ds_write_addtid_b32 v87 offset:33536
    v_lshlrev_b32 v119, 2, v0
    s_waitcnt vmcnt(0)
    s_mov_b64 exec, s[48:49]
    ds_write_b32 v119, v88 offset:49152
    s_mov_b64 exec, -1
    s_add_u32 s43, s43, 50048
    s_add_u32 s14, s43, 50000
    s_min_u32 s14, s14, s41
    buffer_load_dwordx4 v[76:79], v3, s[12:15], s43 offen
    v_subrev_co_u32 v4, s[64:65], 2.0, v4
    v_subrev_co_u32 v5, s[66:67], 2.0, v5
    v_subrev_co_u32 v6, s[68:69], 2.0, v6
    v_subrev_co_u32 v7, s[70:71], 2.0, v7
    v_subrev_co_u32 v8, s[72:73], 2.0, v8
    v_subrev_co_u32 v9, s[74:75], 2.0, v9
    v_subrev_co_u32 v10, s[76:77], 2.0, v10
    v_subrev_co_u32 v11, s[78:79], 2.0, v11
    v_subrev_co_u32 v12, s[80:81], 2.0, v12
    v_subrev_co_u32 v13, s[82:83], 2.0, v13
    v_subrev_co_u32 v14, s[84:85], 2.0, v14
    v_subrev_co_u32 v15, s[86:87], 2.0, v15
    s_waitcnt lgkmcnt(0)
    s_barrier
    s_add_u32 s52, s43, 16384
    buffer_load_dwordx4 v[80:83], v3, s[12:15], s52 offen
    s_add_u32 s52, s43, 32768
    buffer_load_dwordx4 v[84:87], v3, s[12:15], s52 offen
    s_add_u32 s52, s43, 49152
    v_lshlrev_b32 v119, 2, v0
    buffer_load_dword v88, v119, s[12:15], s52 offen
    s_mov_b64 exec, s[64:65]
    ds_read_b64 v[28:29], v28
    s_mov_b64 exec, s[66:67]
    ds_read_b64 v[30:31], v30
    s_mov_b64 exec, s[68:69]
    ds_read_b64 v[32:33], v32
    s_mov_b64 exec, s[70:71]
    ds_read_b64 v[34:35], v34
    s_mov_b64 exec, s[72:73]
    ds_read_b64 v[36:37], v36
    s_mov_b64 exec, s[74:75]
    ds_read_b64 v[38:39], v38
    s_mov_b64 exec, s[76:77]
    ds_read_b64 v[40:41], v40
    s_mov_b64 exec, s[78:79]
    ds_read_b64 v[42:43], v42
    s_mov_b64 exec, s[80:81]
    ds_read_b64 v[44:45], v44
    s_mov_b64 exec, s[82:83]
    ds_read_b64 v[46:47], v46
    s_mov_b64 exec, s[84:85]
    ds_read_b64 v[48:49], v48
    s_mov_b64 exec, s[86:87]
    ds_read_b64 v[50:51], v50
    s_mov_b64 exec, -1
    v_subrev_co_u32 v16, s[64:65], 2.0, v16
    v_subrev_co_u32 v17, s[66:67], 2.0, v17
    v_subrev_co_u32 v18, s[68:69], 2.0, v18
    v_subrev_co_u32 v19, s[70:71], 2.0, v19
    v_subrev_co_u32 v20, s[72:73], 2.0, v20
    v_subrev_co_u32 v21, s[74:75], 2.0, v21
    v_subrev_co_u32 v22, s[76:77], 2.0, v22
    v_subrev_co_u32 v23, s[78:79], 2.0, v23
    v_subrev_co_u32 v24, s[80:81], 2.0, v24
    v_subrev_co_u32 v25, s[82:83], 2.0, v25
    v_subrev_co_u32 v26, s[84:85], 2.0, v26
    v_subrev_co_u32 v27, s[86:87], 2.0, v27
    s_mov_b64 exec, s[64:65]
    ds_read_b64 v[52:53], v52
    s_mov_b64 exec, s[66:67]
    ds_read_b64 v[54:55], v54
    s_mov_b64 exec, s[68:69]
    ds_read_b64 v[56:57], v56
    s_mov_b64 exec, s[70:71]
    ds_read_b64 v[58:59], v58
    s_mov_b64 exec, s[72:73]
    ds_read_b64 v[60:61], v60
    s_mov_b64 exec, s[74:75]
    ds_read_b64 v[62:63], v62
    s_mov_b64 exec, s[76:77]
    ds_read_b64 v[64:65], v64
    s_mov_b64 exec, s[78:79]
    ds_read_b64 v[66:67], v66
    s_mov_b64 exec, s[80:81]
    ds_read_b64 v[68:69], v68
    s_mov_b64 exec, s[82:83]
    ds_read_b64 v[70:71], v70
    s_mov_b64 exec, s[84:85]
    ds_read_b64 v[72:73], v72
    s_mov_b64 exec, s[86:87]
    ds_read_b64 v[74:75], v74
    s_mov_b64 exec, -1
    s_cmp_le_i32 s42, 3072
    s_cbranch_scc1 L_nt1_66
    s_waitcnt vmcnt(14)
    v_perm_b32 v120, v107, v106, s24
    v_perm_b32 v122, v108, v107, s25
    v_perm_b32 v124, v109, v108, s26
    v_perm_b32 v126, v114, v109, s27
    v_alignbyte_b32 v107, v108, v107, 1
    v_alignbyte_b32 v108, v109, v108, 2
    v_alignbyte_b32 v109, v114, v109, 3
    v_lshlrev_b32_sdwa v120, 3, v120 dst_sel:WORD_0 dst_unused:UNUSED_PAD src0_sel:DWORD src1_sel:DWORD
    v_lshlrev_b32_sdwa v122, 3, v122 dst_sel:WORD_0 dst_unused:UNUSED_PAD src0_sel:DWORD src1_sel:DWORD
    v_lshlrev_b32_sdwa v124, 3, v124 dst_sel:WORD_0 dst_unused:UNUSED_PAD src0_sel:DWORD src1_sel:DWORD
    v_lshlrev_b32_sdwa v126, 3, v126 dst_sel:WORD_0 dst_unused:UNUSED_PAD src0_sel:DWORD src1_sel:DWORD
    s_cmp_lt_i32 s42, 3328
    s_cbranch_scc1 L_ufix_69
L_uback_70:

    v_lshrrev_b32 v117, 30, v106
    v_and_b32 v106, 0x3fffffff, v106
    v_mul_u32_u24 v117, 50000, v117
    v_cmp_ne_u32 vcc, 0, v106
    v_add_u32 v120, v120, v117
    s_mov_b64 exec, vcc

    buffer_load_dwordx2 v[120:121], v120, s[8:11], s50 offen
    s_mov_b64 exec, -1
    v_lshrrev_b32 v117, 30, v107
    v_and_b32 v107, 0x3fffffff, v107
    v_mul_u32_u24 v117, 50000, v117
    v_cmp_ne_u32 vcc, 0, v107
    v_add_u32 v122, v122, v117
    s_mov_b64 exec, vcc

    buffer_load_dwordx2 v[122:123], v122, s[8:11], s50 offen
    s_mov_b64 exec, -1
    v_lshrrev_b32 v117, 30, v108
    v_and_b32 v108, 0x3fffffff, v108
    v_mul_u32_u24 v117, 50000, v117
    v_cmp_ne_u32 vcc, 0, v108
    v_add_u32 v124, v124, v117
    s_mov_b64 exec, vcc

    buffer_load_dwordx2 v[124:125], v124, s[8:11], s50 offen
    s_mov_b64 exec, -1
    v_lshrrev_b32 v117, 30, v109
    v_and_b32 v109, 0x3fffffff, v109
    v_mul_u32_u24 v117, 50000, v117
    v_cmp_ne_u32 vcc, 0, v109
    v_add_u32 v126, v126, v117
    s_mov_b64 exec, vcc

    buffer_load_dwordx2 v[126:127], v126, s[8:11], s50 offen
    s_mov_b64 exec, -1
L_nt1_66:
    s_waitcnt lgkmcnt(0)
    s_barrier
    s_waitcnt vmcnt(3)
    ds_write_addtid_b32 v76 offset:0
    ds_write_addtid_b32 v77 offset:256
    ds_write_addtid_b32 v78 offset:512
    ds_write_addtid_b32 v79 offset:768
    s_waitcnt vmcnt(2)
    ds_write_addtid_b32 v80 offset:16384
    ds_write_addtid_b32 v81 offset:16640
    ds_write_addtid_b32 v82 offset:16896
    ds_write_addtid_b32 v83 offset:17152
    s_waitcnt vmcnt(1)
    ds_write_addtid_b32 v84 offset:32768
    ds_write_addtid_b32 v85 offset:33024
    ds_write_addtid_b32 v86 offset:33280
    ds_write_addtid_b32 v87 offset:33536
    v_lshlrev_b32 v119, 2, v0
    s_waitcnt vmcnt(0)
    s_mov_b64 exec, s[48:49]
    ds_write_b32 v119, v88 offset:49152
    s_mov_b64 exec, -1
    s_add_u32 s43, s43, 50048
    s_add_u32 s14, s43, 50000
    s_min_u32 s14, s14, s41
    buffer_load_dwordx4 v[76:79], v3, s[12:15], s43 offen
    v_subrev_co_u32 v4, s[64:65], 2.0, v4
    v_subrev_co_u32 v5, s[66:67], 2.0, v5
    v_subrev_co_u32 v6, s[68:69], 2.0, v6
    v_subrev_co_u32 v7, s[70:71], 2.0, v7
    v_subrev_co_u32 v8, s[72:73], 2.0, v8
    v_subrev_co_u32 v9, s[74:75], 2.0, v9
    v_subrev_co_u32 v10, s[76:77], 2.0, v10
    v_subrev_co_u32 v11, s[78:79], 2.0, v11
    v_subrev_co_u32 v12, s[80:81], 2.0, v12
    v_subrev_co_u32 v13, s[82:83], 2.0, v13
    v_subrev_co_u32 v14, s[84:85], 2.0, v14
    v_subrev_co_u32 v15, s[86:87], 2.0, v15
    s_waitcnt lgkmcnt(0)
    s_barrier
    s_add_u32 s52, s43, 16384
    buffer_load_dwordx4 v[80:83], v3, s[12:15], s52 offen
    s_add_u32 s52, s43, 32768
    buffer_load_dwordx4 v[84:87], v3, s[12:15], s52 offen
    s_add_u32 s52, s43, 49152
    v_lshlrev_b32 v119, 2, v0
    buffer_load_dword v88, v119, s[12:15], s52 offen
    s_mov_b64 exec, s[64:65]
    ds_read_b64 v[28:29], v28
    s_mov_b64 exec, s[66:67]
    ds_read_b64 v[30:31], v30
    s_mov_b64 exec, s[68:69]
    ds_read_b64 v[32:33], v32
    s_mov_b64 exec, s[70:71]
    ds_read_b64 v[34:35], v34
    s_mov_b64 exec, s[72:73]
    ds_read_b64 v[36:37], v36
    s_mov_b64 exec, s[74:75]
    ds_read_b64 v[38:39], v38
    s_mov_b64 exec, s[76:77]
    ds_read_b64 v[40:41], v40
    s_mov_b64 exec, s[78:79]
    ds_read_b64 v[42:43], v42
    s_mov_b64 exec, s[80:81]
    ds_read_b64 v[44:45], v44
    s_mov_b64 exec, s[82:83]
    ds_read_b64 v[46:47], v46
    s_mov_b64 exec, s[84:85]
    ds_read_b64 v[48:49], v48
    s_mov_b64 exec, s[86:87]
    ds_read_b64 v[50:51], v50
    s_mov_b64 exec, -1
    v_subrev_co_u32 v16, s[64:65], 2.0, v16
    v_subrev_co_u32 v17, s[66:67], 2.0, v17
    v_subrev_co_u32 v18, s[68:69], 2.0, v18
    v_subrev_co_u32 v19, s[70:71], 2.0, v19
    v_subrev_co_u32 v20, s[72:73], 2.0, v20
    v_subrev_co_u32 v21, s[74:75], 2.0, v21
    v_subrev_co_u32 v22, s[76:77], 2.0, v22
    v_subrev_co_u32 v23, s[78:79], 2.0, v23
    v_subrev_co_u32 v24, s[80:81], 2.0, v24
    v_subrev_co_u32 v25, s[82:83], 2.0, v25
    v_subrev_co_u32 v26, s[84:85], 2.0, v26
    v_subrev_co_u32 v27, s[86:87], 2.0, v27
    s_mov_b64 exec, s[64:65]
    ds_read_b64 v[52:53], v52
    s_mov_b64 exec, s[66:67]
    ds_read_b64 v[54:55], v54
    s_mov_b64 exec, s[68:69]
    ds_read_b64 v[56:57], v56
    s_mov_b64 exec, s[70:71]
    ds_read_b64 v[58:59], v58
    s_mov_b64 exec, s[72:73]
    ds_read_b64 v[60:61], v60
    s_mov_b64 exec, s[74:75]
    ds_read_b64 v[62:63], v62
    s_mov_b64 exec, s[76:77]
    ds_read_b64 v[64:65], v64
    s_mov_b64 exec, s[78:79]
    ds_read_b64 v[66:67], v66
    s_mov_b64 exec, s[80:81]
    ds_read_b64 v[68:69], v68
    s_mov_b64 exec, s[82:83]
    ds_read_b64 v[70:71], v70
    s_mov_b64 exec, s[84:85]
    ds_read_b64 v[72:73], v72
    s_mov_b64 exec, s[86:87]
    ds_read_b64 v[74:75], v74
    s_mov_b64 exec, -1
    s_movk_i32 s53, 10240
    buffer_load_dwordx4 v[98:101], v2, s[16:19], s53 offen
    buffer_load_dword v112, v2, s[16:19], s53 offen offset:16
    s_cmp_le_i32 s42, 3072
    s_cbranch_scc1 L_nt2_67
    s_waitcnt vmcnt(6)
    v_cmp_ne_u32 s[56:57], 0, v106
    v_cmp_ne_u32 s[58:59], 0, v107
    v_cmp_ne_u32 s[98:99], 0, v108
    v_cmp_ne_u32 vcc, 0, v109
    s_mov_b64 exec, s[56:57]
    v_cvt_f32_i32_sdwa v118, sext(v106) dst_sel:DWORD dst_unused:UNUSED_PAD src0_sel:WORD_0
    v_lshlrev_b32 v116, 16, v120
    v_and_b32 v117, s32, v120
    v_mul_f32 v118, s33, v118
    v_lshlrev_b32 v120, 16, v121
    v_and_b32 v121, s32, v121
    v_lshlrev_b32_sdwa v106, 3, v106 dst_sel:DWORD dst_unused:UNUSED_PAD src0_sel:DWORD src1_sel:WORD_1
    v_pk_fma_f32 v[116:117], v[116:117], v[118:119], s[28:29] op_sel_hi:[1,0,1]
    v_pk_fma_f32 v[120:121], v[120:121], v[118:119], s[28:29] op_sel_hi:[1,0,1]
    v_perm_b32 v116, v117, v116, s35
    v_perm_b32 v117, v121, v120, s35
    v_lshl_add_u64 v[116:117], v[116:117], 0, s[30:31]
    ds_add_rtn_u64 v[120:121], v106, v[116:117] offset:50000

    s_mov_b64 exec, s[58:59]
    v_cvt_f32_i32_sdwa v118, sext(v107) dst_sel:DWORD dst_unused:UNUSED_PAD src0_sel:WORD_0
    v_lshlrev_b32 v116, 16, v122
    v_and_b32 v117, s32, v122
    v_mul_f32 v118, s33, v118
    v_lshlrev_b32 v122, 16, v123
    v_and_b32 v123, s32, v123
    v_lshlrev_b32_sdwa v107, 3, v107 dst_sel:DWORD dst_unused:UNUSED_PAD src0_sel:DWORD src1_sel:WORD_1
    v_pk_fma_f32 v[116:117], v[116:117], v[118:119], s[28:29] op_sel_hi:[1,0,1]
    v_pk_fma_f32 v[122:123], v[122:123], v[118:119], s[28:29] op_sel_hi:[1,0,1]
    v_perm_b32 v116, v117, v116, s35
    v_perm_b32 v117, v123, v122, s35
    v_lshl_add_u64 v[116:117], v[116:117], 0, s[30:31]
    ds_add_rtn_u64 v[122:123], v107, v[116:117] offset:50000

    s_mov_b64 exec, s[98:99]
    v_cvt_f32_i32_sdwa v118, sext(v108) dst_sel:DWORD dst_unused:UNUSED_PAD src0_sel:WORD_0
    v_lshlrev_b32 v116, 16, v124
    v_and_b32 v117, s32, v124
    v_mul_f32 v118, s33, v118
    v_lshlrev_b32 v124, 16, v125
    v_and_b32 v125, s32, v125
    v_lshlrev_b32_sdwa v108, 3, v108 dst_sel:DWORD dst_unused:UNUSED_PAD src0_sel:DWORD src1_sel:WORD_1
    v_pk_fma_f32 v[116:117], v[116:117], v[118:119], s[28:29] op_sel_hi:[1,0,1]
    v_pk_fma_f32 v[124:125], v[124:125], v[118:119], s[28:29] op_sel_hi:[1,0,1]
    v_perm_b32 v116, v117, v116, s35
    v_perm_b32 v117, v125, v124, s35
    v_lshl_add_u64 v[116:117], v[116:117], 0, s[30:31]
    ds_add_rtn_u64 v[124:125], v108, v[116:117] offset:50000

    s_mov_b64 exec, vcc
    v_cvt_f32_i32_sdwa v118, sext(v109) dst_sel:DWORD dst_unused:UNUSED_PAD src0_sel:WORD_0
    v_lshlrev_b32 v116, 16, v126
    v_and_b32 v117, s32, v126
    v_mul_f32 v118, s33, v118
    v_lshlrev_b32 v126, 16, v127
    v_and_b32 v127, s32, v127
    v_lshlrev_b32_sdwa v109, 3, v109 dst_sel:DWORD dst_unused:UNUSED_PAD src0_sel:DWORD src1_sel:WORD_1
    v_pk_fma_f32 v[116:117], v[116:117], v[118:119], s[28:29] op_sel_hi:[1,0,1]
    v_pk_fma_f32 v[126:127], v[126:127], v[118:119], s[28:29] op_sel_hi:[1,0,1]
    v_perm_b32 v116, v117, v116, s35
    v_perm_b32 v117, v127, v126, s35
    v_lshl_add_u64 v[116:117], v[116:117], 0, s[30:31]
    ds_add_rtn_u64 v[126:127], v109, v[116:117] offset:50000

    s_waitcnt lgkmcnt(0)
    s_mov_b64 exec, s[56:57]
    v_or3_b32 v1, v120, v121, v1
    s_mov_b64 exec, s[58:59]
    v_or3_b32 v1, v122, v123, v1
    s_mov_b64 exec, s[98:99]
    v_or3_b32 v1, v124, v125, v1
    s_mov_b64 exec, vcc
    v_or3_b32 v1, v126, v127, v1
    s_mov_b64 exec, -1
L_nt2_67:
    s_movk_i32 s53, 15360
    buffer_load_dwordx4 v[106:109], v2, s[16:19], s53 offen
    buffer_load_dword v114, v2, s[16:19], s53 offen offset:16
    s_cmp_le_u32 s40, 3584
    s_cbranch_scc1 L_noleft_68
    s_min_u32 s40, s40, 3968
    s_lshl_b32 s52, s38, 6
    s_add_u32 s52, s52, s36
    s_mul_i32 s52, s52, 19840
    s_add_u32 s20, s44, s52
    s_addc_u32 s21, s45, 0
    s_mul_i32 s52, s40, 5
    s_add_u32 s52, s52, 3
    s_and_b32 s22, s52, -4

    s_lshr_b32 s55, s39, 2
    s_add_u32 s55, s55, 3584
    v_and_b32 v120, 63, v0
    v_add_u32 v120, s55, v120
L_left_71:
    s_cmp_ge_u32 s55, s40
    s_cbranch_scc1 L_leftend_72
    v_mul_u32_u24 v121, 5, v120
    buffer_load_dword v122, v121, s[20:23], 0 offen
    buffer_load_ubyte v123, v121, s[20:23], 0 offen offset:4
    s_waitcnt vmcnt(0)

    v_perm_b32 v121, v123, v122, s24
    v_lshrrev_b32 v126, 30, v122
    v_and_b32 v121, 0x1fff, v121
    v_mul_u32_u24 v126, 6250, v126
    v_add_lshl_u32 v121, v121, v126, 3

    buffer_load_dwordx2 v[124:125], v121, s[8:11], s50 offen
    v_cmp_gt_u32 vcc, s40, v120
    s_waitcnt vmcnt(0)

    s_mov_b64 exec, vcc
    v_and_b32 v122, 0x3fffffff, v122
    v_cvt_f32_i32_sdwa v118, sext(v122) dst_sel:DWORD dst_unused:UNUSED_PAD src0_sel:WORD_0
    v_lshlrev_b32 v116, 16, v124
    v_and_b32 v117, s32, v124
    v_mul_f32 v118, s33, v118
    v_lshlrev_b32 v124, 16, v125
    v_and_b32 v125, s32, v125
    v_lshlrev_b32_sdwa v122, 3, v122 dst_sel:DWORD dst_unused:UNUSED_PAD src0_sel:DWORD src1_sel:WORD_1
    v_pk_fma_f32 v[116:117], v[116:117], v[118:119], s[28:29] op_sel_hi:[1,0,1]
    v_pk_fma_f32 v[124:125], v[124:125], v[118:119], s[28:29] op_sel_hi:[1,0,1]
    v_perm_b32 v116, v117, v116, s35
    v_perm_b32 v117, v125, v124, s35
    v_lshl_add_u64 v[116:117], v[116:117], 0, s[30:31]
    ds_add_rtn_u64 v[124:125], v122, v[116:117] offset:50000

    s_waitcnt lgkmcnt(0)
    v_or3_b32 v1, v124, v125, v1
    s_mov_b64 exec, -1
    v_add_u32 v120, 128, v120
    s_add_u32 s55, s55, 128
    s_branch L_left_71
L_leftend_72:

L_noleft_68:
    s_waitcnt lgkmcnt(0)
    s_barrier
    s_waitcnt vmcnt(7)
    ds_write_addtid_b32 v76 offset:0
    ds_write_addtid_b32 v77 offset:256
    ds_write_addtid_b32 v78 offset:512
    ds_write_addtid_b32 v79 offset:768
    s_waitcnt vmcnt(6)
    ds_write_addtid_b32 v80 offset:16384
    ds_write_addtid_b32 v81 offset:16640
    ds_write_addtid_b32 v82 offset:16896
    ds_write_addtid_b32 v83 offset:17152
    s_waitcnt vmcnt(5)
    ds_write_addtid_b32 v84 offset:32768
    ds_write_addtid_b32 v85 offset:33024
    ds_write_addtid_b32 v86 offset:33280
    ds_write_addtid_b32 v87 offset:33536
    v_lshlrev_b32 v119, 2, v0
    s_waitcnt vmcnt(4)
    s_mov_b64 exec, s[48:49]
    ds_write_b32 v119, v88 offset:49152
    s_mov_b64 exec, -1
    s_add_u32 s43, s43, 50048
    s_add_u32 s14, s43, 50000
    s_min_u32 s14, s14, s41
    buffer_load_dwordx4 v[76:79], v3, s[12:15], s43 offen
    v_cmp_gt_u32 s[64:65], 2.0, v4
    v_and_b32 v4, 0x3fffffff, v4
    v_cmp_gt_u32 s[66:67], 2.0, v5
    v_and_b32 v5, 0x3fffffff, v5
    v_cmp_gt_u32 s[68:69], 2.0, v6
    v_and_b32 v6, 0x3fffffff, v6
    v_cmp_gt_u32 s[70:71], 2.0, v7
    v_and_b32 v7, 0x3fffffff, v7
    v_cmp_gt_u32 s[72:73], 2.0, v8
    v_and_b32 v8, 0x3fffffff, v8
    v_cmp_gt_u32 s[74:75], 2.0, v9
    v_and_b32 v9, 0x3fffffff, v9
    v_cmp_gt_u32 s[76:77], 2.0, v10
    v_and_b32 v10, 0x3fffffff, v10
    v_cmp_gt_u32 s[78:79], 2.0, v11
    v_and_b32 v11, 0x3fffffff, v11
    v_cmp_gt_u32 s[80:81], 2.0, v12
    v_and_b32 v12, 0x3fffffff, v12
    v_cmp_gt_u32 s[82:83], 2.0, v13
    v_and_b32 v13, 0x3fffffff, v13
    v_cmp_gt_u32 s[84:85], 2.0, v14
    v_and_b32 v14, 0x3fffffff, v14
    v_cmp_gt_u32 s[86:87], 2.0, v15
    v_and_b32 v15, 0x3fffffff, v15
    s_waitcnt lgkmcnt(0)
    s_barrier
    s_add_u32 s52, s43, 16384
    buffer_load_dwordx4 v[80:83], v3, s[12:15], s52 offen
    s_add_u32 s52, s43, 32768
    buffer_load_dwordx4 v[84:87], v3, s[12:15], s52 offen
    s_add_u32 s52, s43, 49152
    v_lshlrev_b32 v119, 2, v0
    buffer_load_dword v88, v119, s[12:15], s52 offen
    s_mov_b64 exec, s[64:65]
    ds_read_b64 v[28:29], v28
    s_mov_b64 exec, s[66:67]
    ds_read_b64 v[30:31], v30
    s_mov_b64 exec, s[68:69]
    ds_read_b64 v[32:33], v32
    s_mov_b64 exec, s[70:71]
    ds_read_b64 v[34:35], v34
    s_mov_b64 exec, s[72:73]
    ds_read_b64 v[36:37], v36
    s_mov_b64 exec, s[74:75]
    ds_read_b64 v[38:39], v38
    s_mov_b64 exec, s[76:77]
    ds_read_b64 v[40:41], v40
    s_mov_b64 exec, s[78:79]
    ds_read_b64 v[42:43], v42
    s_mov_b64 exec, s[80:81]
    ds_read_b64 v[44:45], v44
    s_mov_b64 exec, s[82:83]
    ds_read_b64 v[46:47], v46
    s_mov_b64 exec, s[84:85]
    ds_read_b64 v[48:49], v48
    s_mov_b64 exec, s[86:87]
    ds_read_b64 v[50:51], v50
    s_mov_b64 exec, -1
    v_cmp_gt_u32 s[64:65], 2.0, v16
    v_and_b32 v16, 0x3fffffff, v16
    v_cmp_gt_u32 s[66:67], 2.0, v17
    v_and_b32 v17, 0x3fffffff, v17
    v_cmp_gt_u32 s[68:69], 2.0, v18
    v_and_b32 v18, 0x3fffffff, v18
    v_cmp_gt_u32 s[70:71], 2.0, v19
    v_and_b32 v19, 0x3fffffff, v19
    v_cmp_gt_u32 s[72:73], 2.0, v20
    v_and_b32 v20, 0x3fffffff, v20
    v_cmp_gt_u32 s[74:75], 2.0, v21
    v_and_b32 v21, 0x3fffffff, v21
    v_cmp_gt_u32 s[76:77], 2.0, v22
    v_and_b32 v22, 0x3fffffff, v22
    v_cmp_gt_u32 s[78:79], 2.0, v23
    v_and_b32 v23, 0x3fffffff, v23
    v_cmp_gt_u32 s[80:81], 2.0, v24
    v_and_b32 v24, 0x3fffffff, v24
    v_cmp_gt_u32 s[82:83], 2.0, v25
    v_and_b32 v25, 0x3fffffff, v25
    v_cmp_gt_u32 s[84:85], 2.0, v26
    v_and_b32 v26, 0x3fffffff, v26
    v_cmp_gt_u32 s[86:87], 2.0, v27
    v_and_b32 v27, 0x3fffffff, v27
    s_mov_b64 exec, s[64:65]
    ds_read_b64 v[52:53], v52
    s_mov_b64 exec, s[66:67]
    ds_read_b64 v[54:55], v54
    s_mov_b64 exec, s[68:69]
    ds_read_b64 v[56:57], v56
    s_mov_b64 exec, s[70:71]
    ds_read_b64 v[58:59], v58
    s_mov_b64 exec, s[72:73]
    ds_read_b64 v[60:61], v60
    s_mov_b64 exec, s[74:75]
    ds_read_b64 v[62:63], v62
    s_mov_b64 exec, s[76:77]
    ds_read_b64 v[64:65], v64
    s_mov_b64 exec, s[78:79]
    ds_read_b64 v[66:67], v66
    s_mov_b64 exec, s[80:81]
    ds_read_b64 v[68:69], v68
    s_mov_b64 exec, s[82:83]
    ds_read_b64 v[70:71], v70
    s_mov_b64 exec, s[84:85]
    ds_read_b64 v[72:73], v72
    s_mov_b64 exec, s[86:87]
    ds_read_b64 v[74:75], v74
    s_mov_b64 exec, -1
    s_movk_i32 s53, 12800
    buffer_load_dwordx4 v[102:105], v2, s[16:19], s53 offen
    buffer_load_dword v113, v2, s[16:19], s53 offen offset:16
    s_cmp_ge_u32 s5, s4
    s_cbranch_scc1 L_bend_65
    s_waitcnt lgkmcnt(15)
    v_mad_i32_i16 v120, v28, v4, s96
    v_mad_i32_i16 v28, v28, v4, s96 op_sel:[1,0,0,0]
    v_mad_i32_i16 v121, v29, v4, s96
    v_mad_i32_i16 v29, v29, v4, s96 op_sel:[1,0,0,0]
    v_lshlrev_b32_sdwa v4, 3, v4 dst_sel:DWORD dst_unused:UNUSED_PAD src0_sel:DWORD src1_sel:WORD_1
    v_perm_b32 v28, v28, v120, s97
    v_perm_b32 v29, v29, v121, s97
    v_lshl_add_u64 v[28:29], v[28:29], 0, s[30:31]

    ds_add_rtn_u64 v[28:29], v4, v[28:29] offset:50000
    v_mad_i32_i16 v122, v30, v5, s96
    v_mad_i32_i16 v30, v30, v5, s96 op_sel:[1,0,0,0]
    v_mad_i32_i16 v123, v31, v5, s96
    v_mad_i32_i16 v31, v31, v5, s96 op_sel:[1,0,0,0]
    v_lshlrev_b32_sdwa v5, 3, v5 dst_sel:DWORD dst_unused:UNUSED_PAD src0_sel:DWORD src1_sel:WORD_1
    v_perm_b32 v30, v30, v122, s97
    v_perm_b32 v31, v31, v123, s97
    v_lshl_add_u64 v[30:31], v[30:31], 0, s[30:31]

    ds_add_rtn_u64 v[30:31], v5, v[30:31] offset:50000
    v_mad_i32_i16 v124, v32, v6, s96
    v_mad_i32_i16 v32, v32, v6, s96 op_sel:[1,0,0,0]
    v_mad_i32_i16 v125, v33, v6, s96
    v_mad_i32_i16 v33, v33, v6, s96 op_sel:[1,0,0,0]
    v_lshlrev_b32_sdwa v6, 3, v6 dst_sel:DWORD dst_unused:UNUSED_PAD src0_sel:DWORD src1_sel:WORD_1
    v_perm_b32 v32, v32, v124, s97
    v_perm_b32 v33, v33, v125, s97
    v_lshl_add_u64 v[32:33], v[32:33], 0, s[30:31]

    ds_add_rtn_u64 v[32:33], v6, v[32:33] offset:50000
    v_mad_i32_i16 v126, v34, v7, s96
    v_mad_i32_i16 v34, v34, v7, s96 op_sel:[1,0,0,0]
    v_mad_i32_i16 v127, v35, v7, s96
    v_mad_i32_i16 v35, v35, v7, s96 op_sel:[1,0,0,0]
    v_lshlrev_b32_sdwa v7, 3, v7 dst_sel:DWORD dst_unused:UNUSED_PAD src0_sel:DWORD src1_sel:WORD_1
    v_perm_b32 v34, v34, v126, s97
    v_perm_b32 v35, v35, v127, s97
    v_lshl_add_u64 v[34:35], v[34:35], 0, s[30:31]

    ds_add_rtn_u64 v[34:35], v7, v[34:35] offset:50000
    v_mad_i32_i16 v120, v36, v8, s96
    v_mad_i32_i16 v36, v36, v8, s96 op_sel:[1,0,0,0]
    v_mad_i32_i16 v121, v37, v8, s96
    v_mad_i32_i16 v37, v37, v8, s96 op_sel:[1,0,0,0]
    v_lshlrev_b32_sdwa v8, 3, v8 dst_sel:DWORD dst_unused:UNUSED_PAD src0_sel:DWORD src1_sel:WORD_1
    v_perm_b32 v36, v36, v120, s97
    v_perm_b32 v37, v37, v121, s97
    v_lshl_add_u64 v[36:37], v[36:37], 0, s[30:31]

    ds_add_rtn_u64 v[36:37], v8, v[36:37] offset:50000
    v_mad_i32_i16 v122, v38, v9, s96
    v_mad_i32_i16 v38, v38, v9, s96 op_sel:[1,0,0,0]
    v_mad_i32_i16 v123, v39, v9, s96
    v_mad_i32_i16 v39, v39, v9, s96 op_sel:[1,0,0,0]
    v_lshlrev_b32_sdwa v9, 3, v9 dst_sel:DWORD dst_unused:UNUSED_PAD src0_sel:DWORD src1_sel:WORD_1
    v_perm_b32 v38, v38, v122, s97
    v_perm_b32 v39, v39, v123, s97
    v_lshl_add_u64 v[38:39], v[38:39], 0, s[30:31]

    ds_add_rtn_u64 v[38:39], v9, v[38:39] offset:50000
    v_mad_i32_i16 v124, v40, v10, s96
    v_mad_i32_i16 v40, v40, v10, s96 op_sel:[1,0,0,0]
    v_mad_i32_i16 v125, v41, v10, s96
    v_mad_i32_i16 v41, v41, v10, s96 op_sel:[1,0,0,0]
    v_lshlrev_b32_sdwa v10, 3, v10 dst_sel:DWORD dst_unused:UNUSED_PAD src0_sel:DWORD src1_sel:WORD_1
    v_perm_b32 v40, v40, v124, s97
    v_perm_b32 v41, v41, v125, s97
    v_lshl_add_u64 v[40:41], v[40:41], 0, s[30:31]

    ds_add_rtn_u64 v[40:41], v10, v[40:41] offset:50000
    v_mad_i32_i16 v126, v42, v11, s96
    v_mad_i32_i16 v42, v42, v11, s96 op_sel:[1,0,0,0]
    v_mad_i32_i16 v127, v43, v11, s96
    v_mad_i32_i16 v43, v43, v11, s96 op_sel:[1,0,0,0]
    v_lshlrev_b32_sdwa v11, 3, v11 dst_sel:DWORD dst_unused:UNUSED_PAD src0_sel:DWORD src1_sel:WORD_1
    v_perm_b32 v42, v42, v126, s97
    v_perm_b32 v43, v43, v127, s97
    v_lshl_add_u64 v[42:43], v[42:43], 0, s[30:31]

    ds_add_rtn_u64 v[42:43], v11, v[42:43] offset:50000
    s_waitcnt lgkmcnt(4)
    v_or3_b32 v1, v28, v29, v1
    v_or3_b32 v1, v30, v31, v1
    v_or3_b32 v1, v32, v33, v1
    v_or3_b32 v1, v34, v35, v1
    s_movk_i32 s53, 0
    buffer_load_dwordx4 v[4:7], v2, s[16:19], s53 offen
    buffer_load_dword v35, v2, s[16:19], s53 offen offset:16
    s_barrier
    s_waitcnt vmcnt(7)
    ds_write_addtid_b32 v76 offset:0
    ds_write_addtid_b32 v77 offset:256
    ds_write_addtid_b32 v78 offset:512
    ds_write_addtid_b32 v79 offset:768
    s_waitcnt vmcnt(6)
    ds_write_addtid_b32 v80 offset:16384
    ds_write_addtid_b32 v81 offset:16640
    ds_write_addtid_b32 v82 offset:16896
    ds_write_addtid_b32 v83 offset:17152
    s_waitcnt vmcnt(5)
    ds_write_addtid_b32 v84 offset:32768
    ds_write_addtid_b32 v85 offset:33024
    ds_write_addtid_b32 v86 offset:33280
    ds_write_addtid_b32 v87 offset:33536
    v_lshlrev_b32 v119, 2, v0
    s_waitcnt vmcnt(4)
    s_mov_b64 exec, s[48:49]
    ds_write_b32 v119, v88 offset:49152
    s_mov_b64 exec, -1
    s_add_u32 s43, s43, 50048
    s_add_u32 s14, s43, 50000
    s_min_u32 s14, s14, s41
    s_add_u32 s54, s43, 50048
    buffer_load_dword v115, v89, s[60:63], s54 offen
    s_add_u32 s54, s50, 200000
    buffer_load_dword v115, v89, s[8:11], s54 offen
    v_mad_i32_i16 v120, v44, v12, s96
    v_mad_i32_i16 v44, v44, v12, s96 op_sel:[1,0,0,0]
    v_mad_i32_i16 v121, v45, v12, s96
    v_mad_i32_i16 v45, v45, v12, s96 op_sel:[1,0,0,0]
    v_lshlrev_b32_sdwa v12, 3, v12 dst_sel:DWORD dst_unused:UNUSED_PAD src0_sel:DWORD src1_sel:WORD_1
    v_perm_b32 v44, v44, v120, s97
    v_perm_b32 v45, v45, v121, s97
    v_lshl_add_u64 v[44:45], v[44:45], 0, s[30:31]

    ds_add_rtn_u64 v[44:45], v12, v[44:45] offset:50000
    v_mad_i32_i16 v122, v46, v13, s96
    v_mad_i32_i16 v46, v46, v13, s96 op_sel:[1,0,0,0]
    v_mad_i32_i16 v123, v47, v13, s96
    v_mad_i32_i16 v47, v47, v13, s96 op_sel:[1,0,0,0]
    v_lshlrev_b32_sdwa v13, 3, v13 dst_sel:DWORD dst_unused:UNUSED_PAD src0_sel:DWORD src1_sel:WORD_1
    v_perm_b32 v46, v46, v122, s97
    v_perm_b32 v47, v47, v123, s97
    v_lshl_add_u64 v[46:47], v[46:47], 0, s[30:31]

    ds_add_rtn_u64 v[46:47], v13, v[46:47] offset:50000
    v_mad_i32_i16 v124, v48, v14, s96
    v_mad_i32_i16 v48, v48, v14, s96 op_sel:[1,0,0,0]
    v_mad_i32_i16 v125, v49, v14, s96
    v_mad_i32_i16 v49, v49, v14, s96 op_sel:[1,0,0,0]
    v_lshlrev_b32_sdwa v14, 3, v14 dst_sel:DWORD dst_unused:UNUSED_PAD src0_sel:DWORD src1_sel:WORD_1
    v_perm_b32 v48, v48, v124, s97
    v_perm_b32 v49, v49, v125, s97
    v_lshl_add_u64 v[48:49], v[48:49], 0, s[30:31]

    ds_add_rtn_u64 v[48:49], v14, v[48:49] offset:50000
    v_mad_i32_i16 v126, v50, v15, s96
    v_mad_i32_i16 v50, v50, v15, s96 op_sel:[1,0,0,0]
    v_mad_i32_i16 v127, v51, v15, s96
    v_mad_i32_i16 v51, v51, v15, s96 op_sel:[1,0,0,0]
    v_lshlrev_b32_sdwa v15, 3, v15 dst_sel:DWORD dst_unused:UNUSED_PAD src0_sel:DWORD src1_sel:WORD_1
    v_perm_b32 v50, v50, v126, s97
    v_perm_b32 v51, v51, v127, s97
    v_lshl_add_u64 v[50:51], v[50:51], 0, s[30:31]

    ds_add_rtn_u64 v[50:51], v15, v[50:51] offset:50000
    s_waitcnt lgkmcnt(15)
    v_or3_b32 v1, v36, v37, v1
    v_or3_b32 v1, v38, v39, v1
    v_or3_b32 v1, v40, v41, v1
    v_or3_b32 v1, v42, v43, v1
    s_movk_i32 s53, 2560
    buffer_load_dwordx4 v[8:11], v2, s[16:19], s53 offen
    buffer_load_dword v43, v2, s[16:19], s53 offen offset:16
    s_mov_b32 s40, s88
    s_sub_u32 s42, s40, s39

    s_add_u32 s55, s38, 2
    s_min_u32 s55, s55, 31
    s_mov_b32 s88, s89
    s_mov_b32 s89, s90
    s_mov_b32 s90, s91
    s_mov_b32 s91, s92
    s_mov_b32 s92, s93
    s_mov_b32 s93, s94
    s_mov_b32 s94, s95
    s_mov_b32 s95, 0
    s_min_u32 s88, s88, 3968
    s_lshl_b32 s52, s55, 6
    s_add_u32 s52, s52, s36
    s_mul_i32 s52, s52, 19840
    s_add_u32 s16, s44, s52
    s_addc_u32 s17, s45, 0
    s_mul_i32 s52, s88, 5
    s_add_u32 s52, s52, 3
    s_and_b32 s18, s52, -4

    v_mad_i32_i16 v120, v52, v16, s96
    v_mad_i32_i16 v52, v52, v16, s96 op_sel:[1,0,0,0]
    v_mad_i32_i16 v121, v53, v16, s96
    v_mad_i32_i16 v53, v53, v16, s96 op_sel:[1,0,0,0]
    v_lshlrev_b32_sdwa v16, 3, v16 dst_sel:DWORD dst_unused:UNUSED_PAD src0_sel:DWORD src1_sel:WORD_1
    v_perm_b32 v52, v52, v120, s97
    v_perm_b32 v53, v53, v121, s97
    v_lshl_add_u64 v[52:53], v[52:53], 0, s[30:31]

    ds_add_rtn_u64 v[52:53], v16, v[52:53] offset:50000
    v_mad_i32_i16 v122, v54, v17, s96
    v_mad_i32_i16 v54, v54, v17, s96 op_sel:[1,0,0,0]
    v_mad_i32_i16 v123, v55, v17, s96
    v_mad_i32_i16 v55, v55, v17, s96 op_sel:[1,0,0,0]
    v_lshlrev_b32_sdwa v17, 3, v17 dst_sel:DWORD dst_unused:UNUSED_PAD src0_sel:DWORD src1_sel:WORD_1
    v_perm_b32 v54, v54, v122, s97
    v_perm_b32 v55, v55, v123, s97
    v_lshl_add_u64 v[54:55], v[54:55], 0, s[30:31]

    ds_add_rtn_u64 v[54:55], v17, v[54:55] offset:50000
    v_mad_i32_i16 v124, v56, v18, s96
    v_mad_i32_i16 v56, v56, v18, s96 op_sel:[1,0,0,0]
    v_mad_i32_i16 v125, v57, v18, s96
    v_mad_i32_i16 v57, v57, v18, s96 op_sel:[1,0,0,0]
    v_lshlrev_b32_sdwa v18, 3, v18 dst_sel:DWORD dst_unused:UNUSED_PAD src0_sel:DWORD src1_sel:WORD_1
    v_perm_b32 v56, v56, v124, s97
    v_perm_b32 v57, v57, v125, s97
    v_lshl_add_u64 v[56:57], v[56:57], 0, s[30:31]

    ds_add_rtn_u64 v[56:57], v18, v[56:57] offset:50000
    v_mad_i32_i16 v126, v58, v19, s96
    v_mad_i32_i16 v58, v58, v19, s96 op_sel:[1,0,0,0]
    v_mad_i32_i16 v127, v59, v19, s96
    v_mad_i32_i16 v59, v59, v19, s96 op_sel:[1,0,0,0]
    v_lshlrev_b32_sdwa v19, 3, v19 dst_sel:DWORD dst_unused:UNUSED_PAD src0_sel:DWORD src1_sel:WORD_1
    v_perm_b32 v58, v58, v126, s97
    v_perm_b32 v59, v59, v127, s97
    v_lshl_add_u64 v[58:59], v[58:59], 0, s[30:31]

    ds_add_rtn_u64 v[58:59], v19, v[58:59] offset:50000
    s_waitcnt lgkmcnt(4)
    v_or3_b32 v1, v44, v45, v1
    v_or3_b32 v1, v46, v47, v1
    v_or3_b32 v1, v48, v49, v1
    v_or3_b32 v1, v50, v51, v1
    s_waitcnt vmcnt(26)
    v_perm_b32 v44, v91, v90, s24
    v_perm_b32 v46, v92, v91, s25
    v_perm_b32 v48, v93, v92, s26
    v_perm_b32 v50, v110, v93, s27
    v_mov_b32 v12, v90
    v_alignbyte_b32 v13, v92, v91, 1
    v_alignbyte_b32 v14, v93, v92, 2
    v_alignbyte_b32 v15, v110, v93, 3
    v_lshlrev_b32_sdwa v44, 3, v44 dst_sel:WORD_0 dst_unused:UNUSED_PAD src0_sel:DWORD src1_sel:DWORD
    v_lshlrev_b32_sdwa v46, 3, v46 dst_sel:WORD_0 dst_unused:UNUSED_PAD src0_sel:DWORD src1_sel:DWORD
    v_lshlrev_b32_sdwa v48, 3, v48 dst_sel:WORD_0 dst_unused:UNUSED_PAD src0_sel:DWORD src1_sel:DWORD
    v_lshlrev_b32_sdwa v50, 3, v50 dst_sel:WORD_0 dst_unused:UNUSED_PAD src0_sel:DWORD src1_sel:DWORD
    s_cmp_lt_i32 s42, 1280
    s_cbranch_scc1 L_ufix_73
L_uback_74:

    s_movk_i32 s53, 5120
    buffer_load_dwordx4 v[90:93], v2, s[16:19], s53 offen
    buffer_load_dword v110, v2, s[16:19], s53 offen offset:16
    s_barrier
    v_subrev_co_u32 v12, s[80:81], 2.0, v12
    v_subrev_co_u32 v13, s[82:83], 2.0, v13
    v_subrev_co_u32 v14, s[84:85], 2.0, v14
    v_subrev_co_u32 v15, s[86:87], 2.0, v15
    s_mov_b64 exec, s[80:81]
    ds_read_b64 v[44:45], v44
    s_mov_b64 exec, s[82:83]
    ds_read_b64 v[46:47], v46
    s_mov_b64 exec, s[84:85]
    ds_read_b64 v[48:49], v48
    s_mov_b64 exec, s[86:87]
    ds_read_b64 v[50:51], v50
    s_mov_b64 exec, -1
    v_mad_i32_i16 v120, v60, v20, s96
    v_mad_i32_i16 v60, v60, v20, s96 op_sel:[1,0,0,0]
    v_mad_i32_i16 v121, v61, v20, s96
    v_mad_i32_i16 v61, v61, v20, s96 op_sel:[1,0,0,0]
    v_lshlrev_b32_sdwa v20, 3, v20 dst_sel:DWORD dst_unused:UNUSED_PAD src0_sel:DWORD src1_sel:WORD_1
    v_perm_b32 v60, v60, v120, s97
    v_perm_b32 v61, v61, v121, s97
    v_lshl_add_u64 v[60:61], v[60:61], 0, s[30:31]

    ds_add_rtn_u64 v[60:61], v20, v[60:61] offset:50000
    v_mad_i32_i16 v122, v62, v21, s96
    v_mad_i32_i16 v62, v62, v21, s96 op_sel:[1,0,0,0]
    v_mad_i32_i16 v123, v63, v21, s96
    v_mad_i32_i16 v63, v63, v21, s96 op_sel:[1,0,0,0]
    v_lshlrev_b32_sdwa v21, 3, v21 dst_sel:DWORD dst_unused:UNUSED_PAD src0_sel:DWORD src1_sel:WORD_1
    v_perm_b32 v62, v62, v122, s97
    v_perm_b32 v63, v63, v123, s97
    v_lshl_add_u64 v[62:63], v[62:63], 0, s[30:31]

    ds_add_rtn_u64 v[62:63], v21, v[62:63] offset:50000
    v_mad_i32_i16 v124, v64, v22, s96
    v_mad_i32_i16 v64, v64, v22, s96 op_sel:[1,0,0,0]
    v_mad_i32_i16 v125, v65, v22, s96
    v_mad_i32_i16 v65, v65, v22, s96 op_sel:[1,0,0,0]
    v_lshlrev_b32_sdwa v22, 3, v22 dst_sel:DWORD dst_unused:UNUSED_PAD src0_sel:DWORD src1_sel:WORD_1
    v_perm_b32 v64, v64, v124, s97
    v_perm_b32 v65, v65, v125, s97
    v_lshl_add_u64 v[64:65], v[64:65], 0, s[30:31]

    ds_add_rtn_u64 v[64:65], v22, v[64:65] offset:50000
    v_mad_i32_i16 v126, v66, v23, s96
    v_mad_i32_i16 v66, v66, v23, s96 op_sel:[1,0,0,0]
    v_mad_i32_i16 v127, v67, v23, s96
    v_mad_i32_i16 v67, v67, v23, s96 op_sel:[1,0,0,0]
    v_lshlrev_b32_sdwa v23, 3, v23 dst_sel:DWORD dst_unused:UNUSED_PAD src0_sel:DWORD src1_sel:WORD_1
    v_perm_b32 v66, v66, v126, s97
    v_perm_b32 v67, v67, v127, s97
    v_lshl_add_u64 v[66:67], v[66:67], 0, s[30:31]

    ds_add_rtn_u64 v[66:67], v23, v[66:67] offset:50000
    s_waitcnt lgkmcnt(8)
    v_or3_b32 v1, v52, v53, v1
    v_or3_b32 v1, v54, v55, v1
    v_or3_b32 v1, v56, v57, v1
    v_or3_b32 v1, v58, v59, v1
    s_waitcnt vmcnt(26)
    v_perm_b32 v52, v95, v94, s24
    v_perm_b32 v54, v96, v95, s25
    v_perm_b32 v56, v97, v96, s26
    v_perm_b32 v58, v111, v97, s27
    v_mov_b32 v16, v94
    v_alignbyte_b32 v17, v96, v95, 1
    v_alignbyte_b32 v18, v97, v96, 2
    v_alignbyte_b32 v19, v111, v97, 3
    v_lshlrev_b32_sdwa v52, 3, v52 dst_sel:WORD_0 dst_unused:UNUSED_PAD src0_sel:DWORD src1_sel:DWORD
    v_lshlrev_b32_sdwa v54, 3, v54 dst_sel:WORD_0 dst_unused:UNUSED_PAD src0_sel:DWORD src1_sel:DWORD
    v_lshlrev_b32_sdwa v56, 3, v56 dst_sel:WORD_0 dst_unused:UNUSED_PAD src0_sel:DWORD src1_sel:DWORD
    v_lshlrev_b32_sdwa v58, 3, v58 dst_sel:WORD_0 dst_unused:UNUSED_PAD src0_sel:DWORD src1_sel:DWORD
    s_cmp_lt_i32 s42, 1792
    s_cbranch_scc1 L_ufix_75
L_uback_76:

    v_subrev_co_u32 v16, s[64:65], 2.0, v16
    v_subrev_co_u32 v17, s[66:67], 2.0, v17
    v_subrev_co_u32 v18, s[68:69], 2.0, v18
    v_subrev_co_u32 v19, s[70:71], 2.0, v19
    s_mov_b64 exec, s[64:65]
    ds_read_b64 v[52:53], v52
    s_mov_b64 exec, s[66:67]
    ds_read_b64 v[54:55], v54
    s_mov_b64 exec, s[68:69]
    ds_read_b64 v[56:57], v56
    s_mov_b64 exec, s[70:71]
    ds_read_b64 v[58:59], v58
    s_mov_b64 exec, -1
    s_movk_i32 s53, 7680
    buffer_load_dwordx4 v[94:97], v2, s[16:19], s53 offen
    buffer_load_dword v111, v2, s[16:19], s53 offen offset:16
    v_mad_i32_i16 v120, v68, v24, s96
    v_mad_i32_i16 v68, v68, v24, s96 op_sel:[1,0,0,0]
    v_mad_i32_i16 v121, v69, v24, s96
    v_mad_i32_i16 v69, v69, v24, s96 op_sel:[1,0,0,0]
    v_lshlrev_b32_sdwa v24, 3, v24 dst_sel:DWORD dst_unused:UNUSED_PAD src0_sel:DWORD src1_sel:WORD_1
    v_perm_b32 v68, v68, v120, s97
    v_perm_b32 v69, v69, v121, s97
    v_lshl_add_u64 v[68:69], v[68:69], 0, s[30:31]

    ds_add_rtn_u64 v[68:69], v24, v[68:69] offset:50000
    v_mad_i32_i16 v122, v70, v25, s96
    v_mad_i32_i16 v70, v70, v25, s96 op_sel:[1,0,0,0]
    v_mad_i32_i16 v123, v71, v25, s96
    v_mad_i32_i16 v71, v71, v25, s96 op_sel:[1,0,0,0]
    v_lshlrev_b32_sdwa v25, 3, v25 dst_sel:DWORD dst_unused:UNUSED_PAD src0_sel:DWORD src1_sel:WORD_1
    v_perm_b32 v70, v70, v122, s97
    v_perm_b32 v71, v71, v123, s97
    v_lshl_add_u64 v[70:71], v[70:71], 0, s[30:31]

    ds_add_rtn_u64 v[70:71], v25, v[70:71] offset:50000
    v_mad_i32_i16 v124, v72, v26, s96
    v_mad_i32_i16 v72, v72, v26, s96 op_sel:[1,0,0,0]
    v_mad_i32_i16 v125, v73, v26, s96
    v_mad_i32_i16 v73, v73, v26, s96 op_sel:[1,0,0,0]
    v_lshlrev_b32_sdwa v26, 3, v26 dst_sel:DWORD dst_unused:UNUSED_PAD src0_sel:DWORD src1_sel:WORD_1
    v_perm_b32 v72, v72, v124, s97
    v_perm_b32 v73, v73, v125, s97
    v_lshl_add_u64 v[72:73], v[72:73], 0, s[30:31]

    ds_add_rtn_u64 v[72:73], v26, v[72:73] offset:50000
    v_mad_i32_i16 v126, v74, v27, s96
    v_mad_i32_i16 v74, v74, v27, s96 op_sel:[1,0,0,0]
    v_mad_i32_i16 v127, v75, v27, s96
    v_mad_i32_i16 v75, v75, v27, s96 op_sel:[1,0,0,0]
    v_lshlrev_b32_sdwa v27, 3, v27 dst_sel:DWORD dst_unused:UNUSED_PAD src0_sel:DWORD src1_sel:WORD_1
    v_perm_b32 v74, v74, v126, s97
    v_perm_b32 v75, v75, v127, s97
    v_lshl_add_u64 v[74:75], v[74:75], 0, s[30:31]

    ds_add_rtn_u64 v[74:75], v27, v[74:75] offset:50000
    s_waitcnt lgkmcnt(8)
    v_or3_b32 v1, v60, v61, v1
    v_or3_b32 v1, v62, v63, v1
    v_or3_b32 v1, v64, v65, v1
    v_or3_b32 v1, v66, v67, v1
    s_waitcnt vmcnt(18)
    v_perm_b32 v60, v99, v98, s24
    v_perm_b32 v62, v100, v99, s25
    v_perm_b32 v64, v101, v100, s26
    v_perm_b32 v66, v112, v101, s27
    v_mov_b32 v20, v98
    v_alignbyte_b32 v21, v100, v99, 1
    v_alignbyte_b32 v22, v101, v100, 2
    v_alignbyte_b32 v23, v112, v101, 3
    v_lshlrev_b32_sdwa v60, 3, v60 dst_sel:WORD_0 dst_unused:UNUSED_PAD src0_sel:DWORD src1_sel:DWORD
    v_lshlrev_b32_sdwa v62, 3, v62 dst_sel:WORD_0 dst_unused:UNUSED_PAD src0_sel:DWORD src1_sel:DWORD
    v_lshlrev_b32_sdwa v64, 3, v64 dst_sel:WORD_0 dst_unused:UNUSED_PAD src0_sel:DWORD src1_sel:DWORD
    v_lshlrev_b32_sdwa v66, 3, v66 dst_sel:WORD_0 dst_unused:UNUSED_PAD src0_sel:DWORD src1_sel:DWORD
    s_cmp_lt_i32 s42, 2304
    s_cbranch_scc1 L_ufix_77
L_uback_78:

    v_subrev_co_u32 v20, s[72:73], 2.0, v20
    v_subrev_co_u32 v21, s[74:75], 2.0, v21
    v_subrev_co_u32 v22, s[76:77], 2.0, v22
    v_subrev_co_u32 v23, s[78:79], 2.0, v23
    s_mov_b64 exec, s[72:73]
    ds_read_b64 v[60:61], v60
    s_mov_b64 exec, s[74:75]
    ds_read_b64 v[62:63], v62
    s_mov_b64 exec, s[76:77]
    ds_read_b64 v[64:65], v64
    s_mov_b64 exec, s[78:79]
    ds_read_b64 v[66:67], v66
    s_mov_b64 exec, -1
    s_waitcnt lgkmcnt(4)
    v_or3_b32 v1, v68, v69, v1
    v_or3_b32 v1, v70, v71, v1
    v_or3_b32 v1, v72, v73, v1
    v_or3_b32 v1, v74, v75, v1
    s_waitcnt vmcnt(10)
    v_perm_b32 v68, v103, v102, s24
    v_perm_b32 v70, v104, v103, s25
    v_perm_b32 v72, v105, v104, s26
    v_perm_b32 v74, v113, v105, s27
    v_mov_b32 v24, v102
    v_alignbyte_b32 v25, v104, v103, 1
    v_alignbyte_b32 v26, v105, v104, 2
    v_alignbyte_b32 v27, v113, v105, 3
    v_lshlrev_b32_sdwa v68, 3, v68 dst_sel:WORD_0 dst_unused:UNUSED_PAD src0_sel:DWORD src1_sel:DWORD
    v_lshlrev_b32_sdwa v70, 3, v70 dst_sel:WORD_0 dst_unused:UNUSED_PAD src0_sel:DWORD src1_sel:DWORD
    v_lshlrev_b32_sdwa v72, 3, v72 dst_sel:WORD_0 dst_unused:UNUSED_PAD src0_sel:DWORD src1_sel:DWORD
    v_lshlrev_b32_sdwa v74, 3, v74 dst_sel:WORD_0 dst_unused:UNUSED_PAD src0_sel:DWORD src1_sel:DWORD
    s_cmp_lt_i32 s42, 2816
    s_cbranch_scc1 L_ufix_79
L_uback_80:

    v_subrev_co_u32 v24, s[80:81], 2.0, v24
    v_subrev_co_u32 v25, s[82:83], 2.0, v25
    v_subrev_co_u32 v26, s[84:85], 2.0, v26
    v_subrev_co_u32 v27, s[86:87], 2.0, v27
    s_mov_b64 exec, s[80:81]
    ds_read_b64 v[68:69], v68
    s_mov_b64 exec, s[82:83]
    ds_read_b64 v[70:71], v70
    s_mov_b64 exec, s[84:85]
    ds_read_b64 v[72:73], v72
    s_mov_b64 exec, s[86:87]
    ds_read_b64 v[74:75], v74
    s_mov_b64 exec, -1
    buffer_load_dwordx4 v[76:79], v3, s[12:15], s43 offen
    s_add_u32 s52, s43, 16384
    buffer_load_dwordx4 v[80:83], v3, s[12:15], s52 offen
    s_add_u32 s52, s43, 32768
    buffer_load_dwordx4 v[84:87], v3, s[12:15], s52 offen
    s_add_u32 s52, s43, 49152
    v_lshlrev_b32 v119, 2, v0
    buffer_load_dword v88, v119, s[12:15], s52 offen
    s_waitcnt vmcnt(12)
    v_perm_b32 v28, v5, v4, s24
    v_perm_b32 v30, v6, v5, s25
    v_perm_b32 v32, v7, v6, s26
    v_perm_b32 v34, v35, v7, s27
    v_alignbyte_b32 v5, v6, v5, 1
    v_alignbyte_b32 v6, v7, v6, 2
    v_alignbyte_b32 v7, v35, v7, 3
    v_lshlrev_b32_sdwa v28, 3, v28 dst_sel:WORD_0 dst_unused:UNUSED_PAD src0_sel:DWORD src1_sel:DWORD
    v_lshlrev_b32_sdwa v30, 3, v30 dst_sel:WORD_0 dst_unused:UNUSED_PAD src0_sel:DWORD src1_sel:DWORD
    v_lshlrev_b32_sdwa v32, 3, v32 dst_sel:WORD_0 dst_unused:UNUSED_PAD src0_sel:DWORD src1_sel:DWORD
    v_lshlrev_b32_sdwa v34, 3, v34 dst_sel:WORD_0 dst_unused:UNUSED_PAD src0_sel:DWORD src1_sel:DWORD
    s_cmp_lt_i32 s42, 256
    s_cbranch_scc1 L_ufix_81
L_uback_82:

    v_subrev_co_u32 v4, s[64:65], 2.0, v4
    v_subrev_co_u32 v5, s[66:67], 2.0, v5
    v_subrev_co_u32 v6, s[68:69], 2.0, v6
    v_subrev_co_u32 v7, s[70:71], 2.0, v7
    s_mov_b64 exec, s[64:65]
    ds_read_b64 v[28:29], v28
    s_mov_b64 exec, s[66:67]
    ds_read_b64 v[30:31], v30
    s_mov_b64 exec, s[68:69]
    ds_read_b64 v[32:33], v32
    s_mov_b64 exec, s[70:71]
    ds_read_b64 v[34:35], v34
    s_mov_b64 exec, -1
    s_waitcnt vmcnt(8)
    v_perm_b32 v36, v9, v8, s24
    v_perm_b32 v38, v10, v9, s25
    v_perm_b32 v40, v11, v10, s26
    v_perm_b32 v42, v43, v11, s27
    v_alignbyte_b32 v9, v10, v9, 1
    v_alignbyte_b32 v10, v11, v10, 2
    v_alignbyte_b32 v11, v43, v11, 3
    v_lshlrev_b32_sdwa v36, 3, v36 dst_sel:WORD_0 dst_unused:UNUSED_PAD src0_sel:DWORD src1_sel:DWORD
    v_lshlrev_b32_sdwa v38, 3, v38 dst_sel:WORD_0 dst_unused:UNUSED_PAD src0_sel:DWORD src1_sel:DWORD
    v_lshlrev_b32_sdwa v40, 3, v40 dst_sel:WORD_0 dst_unused:UNUSED_PAD src0_sel:DWORD src1_sel:DWORD
    v_lshlrev_b32_sdwa v42, 3, v42 dst_sel:WORD_0 dst_unused:UNUSED_PAD src0_sel:DWORD src1_sel:DWORD
    s_cmp_lt_i32 s42, 768
    s_cbranch_scc1 L_ufix_83
L_uback_84:

    v_subrev_co_u32 v8, s[72:73], 2.0, v8
    v_subrev_co_u32 v9, s[74:75], 2.0, v9
    v_subrev_co_u32 v10, s[76:77], 2.0, v10
    v_subrev_co_u32 v11, s[78:79], 2.0, v11
    s_mov_b64 exec, s[72:73]
    ds_read_b64 v[36:37], v36
    s_mov_b64 exec, s[74:75]
    ds_read_b64 v[38:39], v38
    s_mov_b64 exec, s[76:77]
    ds_read_b64 v[40:41], v40
    s_mov_b64 exec, s[78:79]
    ds_read_b64 v[42:43], v42
    s_mov_b64 exec, -1
    s_mov_b32 s38, s5
    s_add_u32 s50, s50, 200000
    s_branch L_batch_64
L_bend_65:

    s_load_dwordx2 s[64:65], s[0:1], 24
    s_load_dwordx2 s[86:87], s[0:1], 40
    s_load_dwordx8 s[88:95], s[0:1], 56
    s_mov_b32 s66, 1600000
    s_mov_b32 s67, 0x20000

    s_waitcnt lgkmcnt(15)
    v_mad_i32_i16 v120, v28, v4, s96
    v_mad_i32_i16 v28, v28, v4, s96 op_sel:[1,0,0,0]
    v_mad_i32_i16 v121, v29, v4, s96
    v_mad_i32_i16 v29, v29, v4, s96 op_sel:[1,0,0,0]
    v_lshlrev_b32_sdwa v4, 3, v4 dst_sel:DWORD dst_unused:UNUSED_PAD src0_sel:DWORD src1_sel:WORD_1
    v_perm_b32 v28, v28, v120, s97
    v_perm_b32 v29, v29, v121, s97
    v_lshl_add_u64 v[28:29], v[28:29], 0, s[30:31]

    ds_add_rtn_u64 v[28:29], v4, v[28:29] offset:50000
    v_mad_i32_i16 v122, v30, v5, s96
    v_mad_i32_i16 v30, v30, v5, s96 op_sel:[1,0,0,0]
    v_mad_i32_i16 v123, v31, v5, s96
    v_mad_i32_i16 v31, v31, v5, s96 op_sel:[1,0,0,0]
    v_lshlrev_b32_sdwa v5, 3, v5 dst_sel:DWORD dst_unused:UNUSED_PAD src0_sel:DWORD src1_sel:WORD_1
    v_perm_b32 v30, v30, v122, s97
    v_perm_b32 v31, v31, v123, s97
    v_lshl_add_u64 v[30:31], v[30:31], 0, s[30:31]

    ds_add_rtn_u64 v[30:31], v5, v[30:31] offset:50000
    v_mad_i32_i16 v124, v32, v6, s96
    v_mad_i32_i16 v32, v32, v6, s96 op_sel:[1,0,0,0]
    v_mad_i32_i16 v125, v33, v6, s96
    v_mad_i32_i16 v33, v33, v6, s96 op_sel:[1,0,0,0]
    v_lshlrev_b32_sdwa v6, 3, v6 dst_sel:DWORD dst_unused:UNUSED_PAD src0_sel:DWORD src1_sel:WORD_1
    v_perm_b32 v32, v32, v124, s97
    v_perm_b32 v33, v33, v125, s97
    v_lshl_add_u64 v[32:33], v[32:33], 0, s[30:31]

    ds_add_rtn_u64 v[32:33], v6, v[32:33] offset:50000
    v_mad_i32_i16 v126, v34, v7, s96
    v_mad_i32_i16 v34, v34, v7, s96 op_sel:[1,0,0,0]
    v_mad_i32_i16 v127, v35, v7, s96
    v_mad_i32_i16 v35, v35, v7, s96 op_sel:[1,0,0,0]
    v_lshlrev_b32_sdwa v7, 3, v7 dst_sel:DWORD dst_unused:UNUSED_PAD src0_sel:DWORD src1_sel:WORD_1
    v_perm_b32 v34, v34, v126, s97
    v_perm_b32 v35, v35, v127, s97
    v_lshl_add_u64 v[34:35], v[34:35], 0, s[30:31]

    ds_add_rtn_u64 v[34:35], v7, v[34:35] offset:50000
    v_mad_i32_i16 v120, v36, v8, s96
    v_mad_i32_i16 v36, v36, v8, s96 op_sel:[1,0,0,0]
    v_mad_i32_i16 v121, v37, v8, s96
    v_mad_i32_i16 v37, v37, v8, s96 op_sel:[1,0,0,0]
    v_lshlrev_b32_sdwa v8, 3, v8 dst_sel:DWORD dst_unused:UNUSED_PAD src0_sel:DWORD src1_sel:WORD_1
    v_perm_b32 v36, v36, v120, s97
    v_perm_b32 v37, v37, v121, s97
    v_lshl_add_u64 v[36:37], v[36:37], 0, s[30:31]

    ds_add_rtn_u64 v[36:37], v8, v[36:37] offset:50000
    v_mad_i32_i16 v122, v38, v9, s96
    v_mad_i32_i16 v38, v38, v9, s96 op_sel:[1,0,0,0]
    v_mad_i32_i16 v123, v39, v9, s96
    v_mad_i32_i16 v39, v39, v9, s96 op_sel:[1,0,0,0]
    v_lshlrev_b32_sdwa v9, 3, v9 dst_sel:DWORD dst_unused:UNUSED_PAD src0_sel:DWORD src1_sel:WORD_1
    v_perm_b32 v38, v38, v122, s97
    v_perm_b32 v39, v39, v123, s97
    v_lshl_add_u64 v[38:39], v[38:39], 0, s[30:31]

    ds_add_rtn_u64 v[38:39], v9, v[38:39] offset:50000
    v_mad_i32_i16 v124, v40, v10, s96
    v_mad_i32_i16 v40, v40, v10, s96 op_sel:[1,0,0,0]
    v_mad_i32_i16 v125, v41, v10, s96
    v_mad_i32_i16 v41, v41, v10, s96 op_sel:[1,0,0,0]
    v_lshlrev_b32_sdwa v10, 3, v10 dst_sel:DWORD dst_unused:UNUSED_PAD src0_sel:DWORD src1_sel:WORD_1
    v_perm_b32 v40, v40, v124, s97
    v_perm_b32 v41, v41, v125, s97
    v_lshl_add_u64 v[40:41], v[40:41], 0, s[30:31]

    ds_add_rtn_u64 v[40:41], v10, v[40:41] offset:50000
    v_mad_i32_i16 v126, v42, v11, s96
    v_mad_i32_i16 v42, v42, v11, s96 op_sel:[1,0,0,0]
    v_mad_i32_i16 v127, v43, v11, s96
    v_mad_i32_i16 v43, v43, v11, s96 op_sel:[1,0,0,0]
    v_lshlrev_b32_sdwa v11, 3, v11 dst_sel:DWORD dst_unused:UNUSED_PAD src0_sel:DWORD src1_sel:WORD_1
    v_perm_b32 v42, v42, v126, s97
    v_perm_b32 v43, v43, v127, s97
    v_lshl_add_u64 v[42:43], v[42:43], 0, s[30:31]

    ds_add_rtn_u64 v[42:43], v11, v[42:43] offset:50000
    s_waitcnt lgkmcnt(4)
    v_or3_b32 v1, v28, v29, v1
    v_or3_b32 v1, v30, v31, v1
    v_or3_b32 v1, v32, v33, v1
    v_or3_b32 v1, v34, v35, v1
    v_mad_i32_i16 v120, v44, v12, s96
    v_mad_i32_i16 v44, v44, v12, s96 op_sel:[1,0,0,0]
    v_mad_i32_i16 v121, v45, v12, s96
    v_mad_i32_i16 v45, v45, v12, s96 op_sel:[1,0,0,0]
    v_lshlrev_b32_sdwa v12, 3, v12 dst_sel:DWORD dst_unused:UNUSED_PAD src0_sel:DWORD src1_sel:WORD_1
    v_perm_b32 v44, v44, v120, s97
    v_perm_b32 v45, v45, v121, s97
    v_lshl_add_u64 v[44:45], v[44:45], 0, s[30:31]

    ds_add_rtn_u64 v[44:45], v12, v[44:45] offset:50000
    v_mad_i32_i16 v122, v46, v13, s96
    v_mad_i32_i16 v46, v46, v13, s96 op_sel:[1,0,0,0]
    v_mad_i32_i16 v123, v47, v13, s96
    v_mad_i32_i16 v47, v47, v13, s96 op_sel:[1,0,0,0]
    v_lshlrev_b32_sdwa v13, 3, v13 dst_sel:DWORD dst_unused:UNUSED_PAD src0_sel:DWORD src1_sel:WORD_1
    v_perm_b32 v46, v46, v122, s97
    v_perm_b32 v47, v47, v123, s97
    v_lshl_add_u64 v[46:47], v[46:47], 0, s[30:31]

    ds_add_rtn_u64 v[46:47], v13, v[46:47] offset:50000
    v_mad_i32_i16 v124, v48, v14, s96
    v_mad_i32_i16 v48, v48, v14, s96 op_sel:[1,0,0,0]
    v_mad_i32_i16 v125, v49, v14, s96
    v_mad_i32_i16 v49, v49, v14, s96 op_sel:[1,0,0,0]
    v_lshlrev_b32_sdwa v14, 3, v14 dst_sel:DWORD dst_unused:UNUSED_PAD src0_sel:DWORD src1_sel:WORD_1
    v_perm_b32 v48, v48, v124, s97
    v_perm_b32 v49, v49, v125, s97
    v_lshl_add_u64 v[48:49], v[48:49], 0, s[30:31]

    ds_add_rtn_u64 v[48:49], v14, v[48:49] offset:50000
    v_mad_i32_i16 v126, v50, v15, s96
    v_mad_i32_i16 v50, v50, v15, s96 op_sel:[1,0,0,0]
    v_mad_i32_i16 v127, v51, v15, s96
    v_mad_i32_i16 v51, v51, v15, s96 op_sel:[1,0,0,0]
    v_lshlrev_b32_sdwa v15, 3, v15 dst_sel:DWORD dst_unused:UNUSED_PAD src0_sel:DWORD src1_sel:WORD_1
    v_perm_b32 v50, v50, v126, s97
    v_perm_b32 v51, v51, v127, s97
    v_lshl_add_u64 v[50:51], v[50:51], 0, s[30:31]

    ds_add_rtn_u64 v[50:51], v15, v[50:51] offset:50000
    s_waitcnt lgkmcnt(4)
    v_or3_b32 v1, v36, v37, v1
    v_or3_b32 v1, v38, v39, v1
    v_or3_b32 v1, v40, v41, v1
    v_or3_b32 v1, v42, v43, v1
    v_mad_i32_i16 v120, v52, v16, s96
    v_mad_i32_i16 v52, v52, v16, s96 op_sel:[1,0,0,0]
    v_mad_i32_i16 v121, v53, v16, s96
    v_mad_i32_i16 v53, v53, v16, s96 op_sel:[1,0,0,0]
    v_lshlrev_b32_sdwa v16, 3, v16 dst_sel:DWORD dst_unused:UNUSED_PAD src0_sel:DWORD src1_sel:WORD_1
    v_perm_b32 v52, v52, v120, s97
    v_perm_b32 v53, v53, v121, s97
    v_lshl_add_u64 v[52:53], v[52:53], 0, s[30:31]

    ds_add_rtn_u64 v[52:53], v16, v[52:53] offset:50000
    v_mad_i32_i16 v122, v54, v17, s96
    v_mad_i32_i16 v54, v54, v17, s96 op_sel:[1,0,0,0]
    v_mad_i32_i16 v123, v55, v17, s96
    v_mad_i32_i16 v55, v55, v17, s96 op_sel:[1,0,0,0]
    v_lshlrev_b32_sdwa v17, 3, v17 dst_sel:DWORD dst_unused:UNUSED_PAD src0_sel:DWORD src1_sel:WORD_1
    v_perm_b32 v54, v54, v122, s97
    v_perm_b32 v55, v55, v123, s97
    v_lshl_add_u64 v[54:55], v[54:55], 0, s[30:31]

    ds_add_rtn_u64 v[54:55], v17, v[54:55] offset:50000
    v_mad_i32_i16 v124, v56, v18, s96
    v_mad_i32_i16 v56, v56, v18, s96 op_sel:[1,0,0,0]
    v_mad_i32_i16 v125, v57, v18, s96
    v_mad_i32_i16 v57, v57, v18, s96 op_sel:[1,0,0,0]
    v_lshlrev_b32_sdwa v18, 3, v18 dst_sel:DWORD dst_unused:UNUSED_PAD src0_sel:DWORD src1_sel:WORD_1
    v_perm_b32 v56, v56, v124, s97
    v_perm_b32 v57, v57, v125, s97
    v_lshl_add_u64 v[56:57], v[56:57], 0, s[30:31]

    ds_add_rtn_u64 v[56:57], v18, v[56:57] offset:50000
    v_mad_i32_i16 v126, v58, v19, s96
    v_mad_i32_i16 v58, v58, v19, s96 op_sel:[1,0,0,0]
    v_mad_i32_i16 v127, v59, v19, s96
    v_mad_i32_i16 v59, v59, v19, s96 op_sel:[1,0,0,0]
    v_lshlrev_b32_sdwa v19, 3, v19 dst_sel:DWORD dst_unused:UNUSED_PAD src0_sel:DWORD src1_sel:WORD_1
    v_perm_b32 v58, v58, v126, s97
    v_perm_b32 v59, v59, v127, s97
    v_lshl_add_u64 v[58:59], v[58:59], 0, s[30:31]

    ds_add_rtn_u64 v[58:59], v19, v[58:59] offset:50000
    s_waitcnt lgkmcnt(4)
    v_or3_b32 v1, v44, v45, v1
    v_or3_b32 v1, v46, v47, v1
    v_or3_b32 v1, v48, v49, v1
    v_or3_b32 v1, v50, v51, v1
    v_mad_i32_i16 v120, v60, v20, s96
    v_mad_i32_i16 v60, v60, v20, s96 op_sel:[1,0,0,0]
    v_mad_i32_i16 v121, v61, v20, s96
    v_mad_i32_i16 v61, v61, v20, s96 op_sel:[1,0,0,0]
    v_lshlrev_b32_sdwa v20, 3, v20 dst_sel:DWORD dst_unused:UNUSED_PAD src0_sel:DWORD src1_sel:WORD_1
    v_perm_b32 v60, v60, v120, s97
    v_perm_b32 v61, v61, v121, s97
    v_lshl_add_u64 v[60:61], v[60:61], 0, s[30:31]

    ds_add_rtn_u64 v[60:61], v20, v[60:61] offset:50000
    v_mad_i32_i16 v122, v62, v21, s96
    v_mad_i32_i16 v62, v62, v21, s96 op_sel:[1,0,0,0]
    v_mad_i32_i16 v123, v63, v21, s96
    v_mad_i32_i16 v63, v63, v21, s96 op_sel:[1,0,0,0]
    v_lshlrev_b32_sdwa v21, 3, v21 dst_sel:DWORD dst_unused:UNUSED_PAD src0_sel:DWORD src1_sel:WORD_1
    v_perm_b32 v62, v62, v122, s97
    v_perm_b32 v63, v63, v123, s97
    v_lshl_add_u64 v[62:63], v[62:63], 0, s[30:31]

    ds_add_rtn_u64 v[62:63], v21, v[62:63] offset:50000
    v_mad_i32_i16 v124, v64, v22, s96
    v_mad_i32_i16 v64, v64, v22, s96 op_sel:[1,0,0,0]
    v_mad_i32_i16 v125, v65, v22, s96
    v_mad_i32_i16 v65, v65, v22, s96 op_sel:[1,0,0,0]
    v_lshlrev_b32_sdwa v22, 3, v22 dst_sel:DWORD dst_unused:UNUSED_PAD src0_sel:DWORD src1_sel:WORD_1
    v_perm_b32 v64, v64, v124, s97
    v_perm_b32 v65, v65, v125, s97
    v_lshl_add_u64 v[64:65], v[64:65], 0, s[30:31]

    ds_add_rtn_u64 v[64:65], v22, v[64:65] offset:50000
    v_mad_i32_i16 v126, v66, v23, s96
    v_mad_i32_i16 v66, v66, v23, s96 op_sel:[1,0,0,0]
    v_mad_i32_i16 v127, v67, v23, s96
    v_mad_i32_i16 v67, v67, v23, s96 op_sel:[1,0,0,0]
    v_lshlrev_b32_sdwa v23, 3, v23 dst_sel:DWORD dst_unused:UNUSED_PAD src0_sel:DWORD src1_sel:WORD_1
    v_perm_b32 v66, v66, v126, s97
    v_perm_b32 v67, v67, v127, s97
    v_lshl_add_u64 v[66:67], v[66:67], 0, s[30:31]

    ds_add_rtn_u64 v[66:67], v23, v[66:67] offset:50000
    s_waitcnt lgkmcnt(4)
    v_or3_b32 v1, v52, v53, v1
    v_or3_b32 v1, v54, v55, v1
    v_or3_b32 v1, v56, v57, v1
    v_or3_b32 v1, v58, v59, v1
    v_mad_i32_i16 v120, v68, v24, s96
    v_mad_i32_i16 v68, v68, v24, s96 op_sel:[1,0,0,0]
    v_mad_i32_i16 v121, v69, v24, s96
    v_mad_i32_i16 v69, v69, v24, s96 op_sel:[1,0,0,0]
    v_lshlrev_b32_sdwa v24, 3, v24 dst_sel:DWORD dst_unused:UNUSED_PAD src0_sel:DWORD src1_sel:WORD_1
    v_perm_b32 v68, v68, v120, s97
    v_perm_b32 v69, v69, v121, s97
    v_lshl_add_u64 v[68:69], v[68:69], 0, s[30:31]

    ds_add_rtn_u64 v[68:69], v24, v[68:69] offset:50000
    v_mad_i32_i16 v122, v70, v25, s96
    v_mad_i32_i16 v70, v70, v25, s96 op_sel:[1,0,0,0]
    v_mad_i32_i16 v123, v71, v25, s96
    v_mad_i32_i16 v71, v71, v25, s96 op_sel:[1,0,0,0]
    v_lshlrev_b32_sdwa v25, 3, v25 dst_sel:DWORD dst_unused:UNUSED_PAD src0_sel:DWORD src1_sel:WORD_1
    v_perm_b32 v70, v70, v122, s97
    v_perm_b32 v71, v71, v123, s97
    v_lshl_add_u64 v[70:71], v[70:71], 0, s[30:31]

    ds_add_rtn_u64 v[70:71], v25, v[70:71] offset:50000
    v_mad_i32_i16 v124, v72, v26, s96
    v_mad_i32_i16 v72, v72, v26, s96 op_sel:[1,0,0,0]
    v_mad_i32_i16 v125, v73, v26, s96
    v_mad_i32_i16 v73, v73, v26, s96 op_sel:[1,0,0,0]
    v_lshlrev_b32_sdwa v26, 3, v26 dst_sel:DWORD dst_unused:UNUSED_PAD src0_sel:DWORD src1_sel:WORD_1
    v_perm_b32 v72, v72, v124, s97
    v_perm_b32 v73, v73, v125, s97
    v_lshl_add_u64 v[72:73], v[72:73], 0, s[30:31]

    ds_add_rtn_u64 v[72:73], v26, v[72:73] offset:50000
    v_mad_i32_i16 v126, v74, v27, s96
    v_mad_i32_i16 v74, v74, v27, s96 op_sel:[1,0,0,0]
    v_mad_i32_i16 v127, v75, v27, s96
    v_mad_i32_i16 v75, v75, v27, s96 op_sel:[1,0,0,0]
    v_lshlrev_b32_sdwa v27, 3, v27 dst_sel:DWORD dst_unused:UNUSED_PAD src0_sel:DWORD src1_sel:WORD_1
    v_perm_b32 v74, v74, v126, s97
    v_perm_b32 v75, v75, v127, s97
    v_lshl_add_u64 v[74:75], v[74:75], 0, s[30:31]

    ds_add_rtn_u64 v[74:75], v27, v[74:75] offset:50000
    s_waitcnt lgkmcnt(4)
    v_or3_b32 v1, v60, v61, v1
    v_or3_b32 v1, v62, v63, v1
    v_or3_b32 v1, v64, v65, v1
    v_or3_b32 v1, v66, v67, v1
    s_waitcnt lgkmcnt(0)
    v_or3_b32 v1, v68, v69, v1
    v_or3_b32 v1, v70, v71, v1
    v_or3_b32 v1, v72, v73, v1
    v_or3_b32 v1, v74, v75, v1
    s_waitcnt vmcnt(0)
    s_waitcnt lgkmcnt(0)
    s_load_dwordx4 s[28:31], s[86:87], 0
    s_load_dwordx16 s[68:83], s[88:89], 0
    s_load_dwordx8 s[12:19], s[92:93], 0
    s_load_dwordx8 s[56:63], s[94:95], 0
    s_mov_b64 s[48:49], s[90:91]
    s_load_dwordx16 s[84:99], s[48:49], 0

    s_mov_b32 s41, s37
    s_mul_i32 s3, s41, 3125
    s_add_u32 s5, s3, 3126
    s_add_u32 s3, s3, 1
    s_lshr_b32 s3, s3, 1
    s_lshr_b32 s5, s5, 1
    s_sub_u32 s5, s5, s3
    s_sub_u32 s5, s5, 782
    v_cmp_gt_u32 vcc, s5, v0
    s_mul_i32 s5, s36, 6250
    s_add_u32 s3, s3, s5
    v_add_u32 v6, s3, v0
    v_add_u32 v7, 782, v6
    v_mov_b32 v8, 0x2000000
    v_lshlrev_b32 v4, 4, v6
    v_cndmask_b32 v7, v8, v7, vcc
    v_lshlrev_b32 v6, 2, v6
    v_lshlrev_b32 v5, 4, v7
    v_lshlrev_b32 v7, 2, v7
    v_cmp_gt_u32 vcc, 782, v0
    s_mov_b64 exec, vcc
    s_cbranch_execz L_skld_88
    buffer_load_dword v6, v6, s[64:67], 0 offen
    buffer_load_dword v7, v7, s[64:67], 0 offen
    buffer_load_dwordx4 v[108:111], v4, s[8:11], 0 offen
    buffer_load_dwordx4 v[112:115], v5, s[8:11], 0 offen

L_skld_88:
    s_mov_b64 exec, -1
    s_barrier

    v_add_u32 v116, 50000, v3
    v_add_u32 v117, 115536, v3
    v_cmp_gt_u32 vcc, 106, v0

    v_mov_b32 v100, 0
    v_mov_b32 v101, 0
    v_mov_b32 v102, 0
    v_mov_b32 v103, 0
    ds_read_b128 v[76:79], v116 offset:0
    ds_read_b128 v[80:83], v116 offset:16384
    ds_read_b128 v[84:87], v116 offset:32768
    ds_read_b128 v[88:91], v116 offset:49152
    ds_read_b128 v[92:95], v117 offset:0
    ds_read_b128 v[96:99], v117 offset:16384
    s_mov_b64 exec, vcc
    ds_read_b128 v[100:103], v117 offset:32768
    s_mov_b64 exec, -1
    s_mul_i32 s3, s37, 6400000
    s_mul_i32 s5, s36, 100000
    s_add_u32 s3, s3, s5
    s_add_u32 s3, s3, 6799360

    s_add_u32 s20, s6, s3
    s_addc_u32 s21, s7, 0
    s_mov_b32 s22, 100000
    s_mov_b32 s23, 0x20000
    s_waitcnt lgkmcnt(6)
    s_mov_b32 s3, 0
    buffer_store_dwordx4 v[76:79], v3, s[20:23], s3 offen sc1
    s_waitcnt lgkmcnt(5)
    s_mov_b32 s3, 16384
    buffer_store_dwordx4 v[80:83], v3, s[20:23], s3 offen sc1
    s_waitcnt lgkmcnt(4)
    s_mov_b32 s3, 32768
    buffer_store_dwordx4 v[84:87], v3, s[20:23], s3 offen sc1
    s_waitcnt lgkmcnt(3)
    s_mov_b32 s3, 49152
    buffer_store_dwordx4 v[88:91], v3, s[20:23], s3 offen sc1
    s_waitcnt lgkmcnt(2)
    s_mov_b32 s3, 65536
    buffer_store_dwordx4 v[92:95], v3, s[20:23], s3 offen sc1
    s_waitcnt lgkmcnt(1)
    s_mov_b32 s3, 81920
    buffer_store_dwordx4 v[96:99], v3, s[20:23], s3 offen sc1
    s_waitcnt lgkmcnt(0)
    s_mov_b32 s3, 98304
    buffer_store_dwordx4 v[100:103], v3, s[20:23], s3 offen sc1
    v_or3_b32 v1, v76, v77, v1
    v_or3_b32 v1, v78, v79, v1
    v_or3_b32 v1, v80, v81, v1
    v_or3_b32 v1, v82, v83, v1
    v_or3_b32 v1, v84, v85, v1
    v_or3_b32 v1, v86, v87, v1
    v_or3_b32 v1, v88, v89, v1
    v_or3_b32 v1, v90, v91, v1
    v_or3_b32 v1, v92, v93, v1
    v_or3_b32 v1, v94, v95, v1
    v_or3_b32 v1, v96, v97, v1
    v_or3_b32 v1, v98, v99, v1
    v_or3_b32 v1, v100, v101, v1
    v_or3_b32 v1, v102, v103, v1
    v_and_b32 v1, 0x80008000, v1
    v_cmp_ne_u32 vcc, 0, v1
    v_mov_b32 v116, 150024
    v_mov_b32 v117, 1
    s_cbranch_vccz L_nf_85
    ds_write_b32 v116, v117
L_nf_85:
    s_mov_b32 s33, 1
    s_mov_b32 s42, 0
    v_cmp_gt_u32 vcc, 782, v0
    s_mov_b64 exec, vcc
    s_cbranch_execz L_p1end_90
    s_waitcnt vmcnt(9)
    s_branch L_lddone_87
L_fin_86:

    s_load_dwordx2 s[64:65], s[0:1], 24
    s_load_dwordx2 s[86:87], s[0:1], 40
    s_load_dwordx8 s[88:95], s[0:1], 56
    s_mov_b32 s66, 1600000
    s_mov_b32 s67, 0x20000

    s_waitcnt lgkmcnt(0)
    s_load_dwordx4 s[28:31], s[86:87], 0
    s_load_dwordx16 s[68:83], s[88:89], 0
    s_load_dwordx8 s[12:19], s[92:93], 0
    s_load_dwordx8 s[56:63], s[94:95], 0
    s_mov_b64 s[48:49], s[90:91]
    s_load_dwordx16 s[84:99], s[48:49], 0

    s_mov_b32 s42, 1
    s_mov_b32 s41, s37
L_qloop_89:
    s_mul_i32 s3, s41, 3125
    s_add_u32 s5, s3, 3126
    s_add_u32 s3, s3, 1
    s_lshr_b32 s3, s3, 1
    s_lshr_b32 s5, s5, 1
    s_sub_u32 s5, s5, s3
    s_sub_u32 s5, s5, 782
    v_cmp_gt_u32 vcc, s5, v0
    s_mul_i32 s5, s36, 6250
    s_add_u32 s3, s3, s5
    v_add_u32 v6, s3, v0
    v_add_u32 v7, 782, v6
    v_mov_b32 v8, 0x2000000
    v_lshlrev_b32 v4, 4, v6
    v_cndmask_b32 v7, v8, v7, vcc
    v_lshlrev_b32 v6, 2, v6
    v_lshlrev_b32 v5, 4, v7
    v_lshlrev_b32 v7, 2, v7
    v_cmp_gt_u32 vcc, 782, v0
    s_mov_b64 exec, vcc
    s_cbranch_execz L_p1end_90
    buffer_load_dword v6, v6, s[64:67], 0 offen
    buffer_load_dword v7, v7, s[64:67], 0 offen
    buffer_load_dwordx4 v[108:111], v4, s[8:11], 0 offen
    buffer_load_dwordx4 v[112:115], v5, s[8:11], 0 offen

    s_waitcnt vmcnt(2)
L_lddone_87:
    s_waitcnt lgkmcnt(0)
    v_lshlrev_b32 v8, 16, v6
    v_and_b32 v9, s32, v6
    v_lshlrev_b32 v10, 16, v7
    v_and_b32 v11, s32, v7

    s_lshl_b32 s52, s28, 16
    v_subrev_f32 v12, s52, v8
    v_subrev_f32 v20, s52, v9
    v_subrev_f32 v28, s52, v10
    v_subrev_f32 v36, s52, v11
    s_and_b32 s53, s28, s32
    v_subrev_f32 v13, s53, v8
    v_subrev_f32 v21, s53, v9
    v_subrev_f32 v29, s53, v10
    v_subrev_f32 v37, s53, v11
    s_lshl_b32 s52, s29, 16
    v_subrev_f32 v14, s52, v8
    v_subrev_f32 v22, s52, v9
    v_subrev_f32 v30, s52, v10
    v_subrev_f32 v38, s52, v11
    s_and_b32 s53, s29, s32
    v_subrev_f32 v15, s53, v8
    v_subrev_f32 v23, s53, v9
    v_subrev_f32 v31, s53, v10
    v_subrev_f32 v39, s53, v11
    s_lshl_b32 s52, s30, 16
    v_subrev_f32 v16, s52, v8
    v_subrev_f32 v24, s52, v9
    v_subrev_f32 v32, s52, v10
    v_subrev_f32 v40, s52, v11
    s_and_b32 s53, s30, s32
    v_subrev_f32 v17, s53, v8
    v_subrev_f32 v25, s53, v9
    v_subrev_f32 v33, s53, v10
    v_subrev_f32 v41, s53, v11
    s_lshl_b32 s52, s31, 16
    v_subrev_f32 v18, s52, v8
    v_subrev_f32 v26, s52, v9
    v_subrev_f32 v34, s52, v10
    v_subrev_f32 v42, s52, v11
    s_and_b32 s53, s31, s32
    v_subrev_f32 v19, s53, v8
    v_subrev_f32 v27, s53, v9
    v_subrev_f32 v35, s53, v10
    v_subrev_f32 v43, s53, v11
    v_cvt_pk_bf16_f32 v12, v12, v13
    v_cvt_pk_bf16_f32 v14, v14, v15
    v_cvt_pk_bf16_f32 v16, v16, v17
    v_cvt_pk_bf16_f32 v18, v18, v19
    v_cvt_pk_bf16_f32 v20, v20, v21
    v_cvt_pk_bf16_f32 v22, v22, v23
    v_cvt_pk_bf16_f32 v24, v24, v25
    v_cvt_pk_bf16_f32 v26, v26, v27
    v_cvt_pk_bf16_f32 v28, v28, v29
    v_cvt_pk_bf16_f32 v30, v30, v31
    v_cvt_pk_bf16_f32 v32, v32, v33
    v_cvt_pk_bf16_f32 v34, v34, v35
    v_cvt_pk_bf16_f32 v36, v36, v37
    v_cvt_pk_bf16_f32 v38, v38, v39
    v_cvt_pk_bf16_f32 v40, v40, v41
    v_cvt_pk_bf16_f32 v42, v42, v43
    v_and_b32 v13, s32, v12
    v_lshlrev_b32 v12, 16, v12
    v_and_b32 v15, s32, v14
    v_lshlrev_b32 v14, 16, v14
    v_and_b32 v17, s32, v16
    v_lshlrev_b32 v16, 16, v16
    v_and_b32 v19, s32, v18
    v_lshlrev_b32 v18, 16, v18
    v_and_b32 v21, s32, v20
    v_lshlrev_b32 v20, 16, v20
    v_and_b32 v23, s32, v22
    v_lshlrev_b32 v22, 16, v22
    v_and_b32 v25, s32, v24
    v_lshlrev_b32 v24, 16, v24
    v_and_b32 v27, s32, v26
    v_lshlrev_b32 v26, 16, v26
    v_and_b32 v29, s32, v28
    v_lshlrev_b32 v28, 16, v28
    v_and_b32 v31, s32, v30
    v_lshlrev_b32 v30, 16, v30
    v_and_b32 v33, s32, v32
    v_lshlrev_b32 v32, 16, v32
    v_and_b32 v35, s32, v34
    v_lshlrev_b32 v34, 16, v34
    v_and_b32 v37, s32, v36
    v_lshlrev_b32 v36, 16, v36
    v_and_b32 v39, s32, v38
    v_lshlrev_b32 v38, 16, v38
    v_and_b32 v41, s32, v40
    v_lshlrev_b32 v40, 16, v40
    v_and_b32 v43, s32, v42
    v_lshlrev_b32 v42, 16, v42
    v_mul_f32 v12, v12, v12
    v_mul_f32 v13, v13, v13
    v_mul_f32 v14, v14, v14
    v_mul_f32 v15, v15, v15
    v_mul_f32 v16, v16, v16
    v_mul_f32 v17, v17, v17
    v_mul_f32 v18, v18, v18
    v_mul_f32 v19, v19, v19
    v_mul_f32 v20, v20, v20
    v_mul_f32 v21, v21, v21
    v_mul_f32 v22, v22, v22
    v_mul_f32 v23, v23, v23
    v_mul_f32 v24, v24, v24
    v_mul_f32 v25, v25, v25
    v_mul_f32 v26, v26, v26
    v_mul_f32 v27, v27, v27
    v_mul_f32 v28, v28, v28
    v_mul_f32 v29, v29, v29
    v_mul_f32 v30, v30, v30
    v_mul_f32 v31, v31, v31
    v_mul_f32 v32, v32, v32
    v_mul_f32 v33, v33, v33
    v_mul_f32 v34, v34, v34
    v_mul_f32 v35, v35, v35
    v_mul_f32 v36, v36, v36
    v_mul_f32 v37, v37, v37
    v_mul_f32 v38, v38, v38
    v_mul_f32 v39, v39, v39
    v_mul_f32 v40, v40, v40
    v_mul_f32 v41, v41, v41
    v_mul_f32 v42, v42, v42
    v_mul_f32 v43, v43, v43
    v_cvt_pk_bf16_f32 v12, v12, v13
    v_cvt_pk_bf16_f32 v14, v14, v15
    v_cvt_pk_bf16_f32 v16, v16, v17
    v_cvt_pk_bf16_f32 v18, v18, v19
    v_cvt_pk_bf16_f32 v20, v20, v21
    v_cvt_pk_bf16_f32 v22, v22, v23
    v_cvt_pk_bf16_f32 v24, v24, v25
    v_cvt_pk_bf16_f32 v26, v26, v27
    v_cvt_pk_bf16_f32 v28, v28, v29
    v_cvt_pk_bf16_f32 v30, v30, v31
    v_cvt_pk_bf16_f32 v32, v32, v33
    v_cvt_pk_bf16_f32 v34, v34, v35
    v_cvt_pk_bf16_f32 v36, v36, v37
    v_cvt_pk_bf16_f32 v38, v38, v39
    v_cvt_pk_bf16_f32 v40, v40, v41
    v_cvt_pk_bf16_f32 v42, v42, v43
    v_and_b32 v13, s32, v12
    v_lshlrev_b32 v12, 16, v12
    v_and_b32 v15, s32, v14
    v_lshlrev_b32 v14, 16, v14
    v_and_b32 v17, s32, v16
    v_lshlrev_b32 v16, 16, v16
    v_and_b32 v19, s32, v18
    v_lshlrev_b32 v18, 16, v18
    v_and_b32 v21, s32, v20
    v_lshlrev_b32 v20, 16, v20
    v_and_b32 v23, s32, v22
    v_lshlrev_b32 v22, 16, v22
    v_and_b32 v25, s32, v24
    v_lshlrev_b32 v24, 16, v24
    v_and_b32 v27, s32, v26
    v_lshlrev_b32 v26, 16, v26
    v_and_b32 v29, s32, v28
    v_lshlrev_b32 v28, 16, v28
    v_and_b32 v31, s32, v30
    v_lshlrev_b32 v30, 16, v30
    v_and_b32 v33, s32, v32
    v_lshlrev_b32 v32, 16, v32
    v_and_b32 v35, s32, v34
    v_lshlrev_b32 v34, 16, v34
    v_and_b32 v37, s32, v36
    v_lshlrev_b32 v36, 16, v36
    v_and_b32 v39, s32, v38
    v_lshlrev_b32 v38, 16, v38
    v_and_b32 v41, s32, v40
    v_lshlrev_b32 v40, 16, v40
    v_and_b32 v43, s32, v42
    v_lshlrev_b32 v42, 16, v42
    v_mul_f32 v12, 0xc1200000, v12
    v_mul_f32 v13, 0xc1200000, v13
    v_mul_f32 v14, 0xc1200000, v14
    v_mul_f32 v15, 0xc1200000, v15
    v_mul_f32 v16, 0xc1200000, v16
    v_mul_f32 v17, 0xc1200000, v17
    v_mul_f32 v18, 0xc1200000, v18
    v_mul_f32 v19, 0xc1200000, v19
    v_mul_f32 v20, 0xc1200000, v20
    v_mul_f32 v21, 0xc1200000, v21
    v_mul_f32 v22, 0xc1200000, v22
    v_mul_f32 v23, 0xc1200000, v23
    v_mul_f32 v24, 0xc1200000, v24
    v_mul_f32 v25, 0xc1200000, v25
    v_mul_f32 v26, 0xc1200000, v26
    v_mul_f32 v27, 0xc1200000, v27
    v_mul_f32 v28, 0xc1200000, v28
    v_mul_f32 v29, 0xc1200000, v29
    v_mul_f32 v30, 0xc1200000, v30
    v_mul_f32 v31, 0xc1200000, v31
    v_mul_f32 v32, 0xc1200000, v32
    v_mul_f32 v33, 0xc1200000, v33
    v_mul_f32 v34, 0xc1200000, v34
    v_mul_f32 v35, 0xc1200000, v35
    v_mul_f32 v36, 0xc1200000, v36
    v_mul_f32 v37, 0xc1200000, v37
    v_mul_f32 v38, 0xc1200000, v38
    v_mul_f32 v39, 0xc1200000, v39
    v_mul_f32 v40, 0xc1200000, v40
    v_mul_f32 v41, 0xc1200000, v41
    v_mul_f32 v42, 0xc1200000, v42
    v_mul_f32 v43, 0xc1200000, v43
    v_cvt_pk_bf16_f32 v12, v12, v13
    v_cvt_pk_bf16_f32 v14, v14, v15
    v_cvt_pk_bf16_f32 v16, v16, v17
    v_cvt_pk_bf16_f32 v18, v18, v19
    v_cvt_pk_bf16_f32 v20, v20, v21
    v_cvt_pk_bf16_f32 v22, v22, v23
    v_cvt_pk_bf16_f32 v24, v24, v25
    v_cvt_pk_bf16_f32 v26, v26, v27
    v_cvt_pk_bf16_f32 v28, v28, v29
    v_cvt_pk_bf16_f32 v30, v30, v31
    v_cvt_pk_bf16_f32 v32, v32, v33
    v_cvt_pk_bf16_f32 v34, v34, v35
    v_cvt_pk_bf16_f32 v36, v36, v37
    v_cvt_pk_bf16_f32 v38, v38, v39
    v_cvt_pk_bf16_f32 v40, v40, v41
    v_cvt_pk_bf16_f32 v42, v42, v43
    v_and_b32 v13, s32, v12
    v_lshlrev_b32 v12, 16, v12
    v_and_b32 v15, s32, v14
    v_lshlrev_b32 v14, 16, v14
    v_and_b32 v17, s32, v16
    v_lshlrev_b32 v16, 16, v16
    v_and_b32 v19, s32, v18
    v_lshlrev_b32 v18, 16, v18
    v_and_b32 v21, s32, v20
    v_lshlrev_b32 v20, 16, v20
    v_and_b32 v23, s32, v22
    v_lshlrev_b32 v22, 16, v22
    v_and_b32 v25, s32, v24
    v_lshlrev_b32 v24, 16, v24
    v_and_b32 v27, s32, v26
    v_lshlrev_b32 v26, 16, v26
    v_and_b32 v29, s32, v28
    v_lshlrev_b32 v28, 16, v28
    v_and_b32 v31, s32, v30
    v_lshlrev_b32 v30, 16, v30
    v_and_b32 v33, s32, v32
    v_lshlrev_b32 v32, 16, v32
    v_and_b32 v35, s32, v34
    v_lshlrev_b32 v34, 16, v34
    v_and_b32 v37, s32, v36
    v_lshlrev_b32 v36, 16, v36
    v_and_b32 v39, s32, v38
    v_lshlrev_b32 v38, 16, v38
    v_and_b32 v41, s32, v40
    v_lshlrev_b32 v40, 16, v40
    v_and_b32 v43, s32, v42
    v_lshlrev_b32 v42, 16, v42
    v_mul_f32 v12, 0x3fb8aa3b, v12
    v_mul_f32 v13, 0x3fb8aa3b, v13
    v_mul_f32 v14, 0x3fb8aa3b, v14
    v_mul_f32 v15, 0x3fb8aa3b, v15
    v_mul_f32 v16, 0x3fb8aa3b, v16
    v_mul_f32 v17, 0x3fb8aa3b, v17
    v_mul_f32 v18, 0x3fb8aa3b, v18
    v_mul_f32 v19, 0x3fb8aa3b, v19
    v_mul_f32 v20, 0x3fb8aa3b, v20
    v_mul_f32 v21, 0x3fb8aa3b, v21
    v_mul_f32 v22, 0x3fb8aa3b, v22
    v_mul_f32 v23, 0x3fb8aa3b, v23
    v_mul_f32 v24, 0x3fb8aa3b, v24
    v_mul_f32 v25, 0x3fb8aa3b, v25
    v_mul_f32 v26, 0x3fb8aa3b, v26
    v_mul_f32 v27, 0x3fb8aa3b, v27
    v_mul_f32 v28, 0x3fb8aa3b, v28
    v_mul_f32 v29, 0x3fb8aa3b, v29
    v_mul_f32 v30, 0x3fb8aa3b, v30
    v_mul_f32 v31, 0x3fb8aa3b, v31
    v_mul_f32 v32, 0x3fb8aa3b, v32
    v_mul_f32 v33, 0x3fb8aa3b, v33
    v_mul_f32 v34, 0x3fb8aa3b, v34
    v_mul_f32 v35, 0x3fb8aa3b, v35
    v_mul_f32 v36, 0x3fb8aa3b, v36
    v_mul_f32 v37, 0x3fb8aa3b, v37
    v_mul_f32 v38, 0x3fb8aa3b, v38
    v_mul_f32 v39, 0x3fb8aa3b, v39
    v_mul_f32 v40, 0x3fb8aa3b, v40
    v_mul_f32 v41, 0x3fb8aa3b, v41
    v_mul_f32 v42, 0x3fb8aa3b, v42
    v_mul_f32 v43, 0x3fb8aa3b, v43
    v_exp_f32 v12, v12
    v_exp_f32 v13, v13
    v_exp_f32 v14, v14
    v_exp_f32 v15, v15
    v_exp_f32 v16, v16
    v_exp_f32 v17, v17
    v_exp_f32 v18, v18
    v_exp_f32 v19, v19
    v_exp_f32 v20, v20
    v_exp_f32 v21, v21
    v_exp_f32 v22, v22
    v_exp_f32 v23, v23
    v_exp_f32 v24, v24
    v_exp_f32 v25, v25
    v_exp_f32 v26, v26
    v_exp_f32 v27, v27
    v_exp_f32 v28, v28
    v_exp_f32 v29, v29
    v_exp_f32 v30, v30
    v_exp_f32 v31, v31
    v_exp_f32 v32, v32
    v_exp_f32 v33, v33
    v_exp_f32 v34, v34
    v_exp_f32 v35, v35
    v_exp_f32 v36, v36
    v_exp_f32 v37, v37
    v_exp_f32 v38, v38
    v_exp_f32 v39, v39
    v_exp_f32 v40, v40
    v_exp_f32 v41, v41
    v_exp_f32 v42, v42
    v_exp_f32 v43, v43
    s_nop 0
    v_cvt_pk_bf16_f32 v12, v12, v13
    v_cvt_pk_bf16_f32 v14, v14, v15
    v_cvt_pk_bf16_f32 v16, v16, v17
    v_cvt_pk_bf16_f32 v18, v18, v19
    v_cvt_pk_bf16_f32 v20, v20, v21
    v_cvt_pk_bf16_f32 v22, v22, v23
    v_cvt_pk_bf16_f32 v24, v24, v25
    v_cvt_pk_bf16_f32 v26, v26, v27
    v_cvt_pk_bf16_f32 v28, v28, v29
    v_cvt_pk_bf16_f32 v30, v30, v31
    v_cvt_pk_bf16_f32 v32, v32, v33
    v_cvt_pk_bf16_f32 v34, v34, v35
    v_cvt_pk_bf16_f32 v36, v36, v37
    v_cvt_pk_bf16_f32 v38, v38, v39
    v_cvt_pk_bf16_f32 v40, v40, v41
    v_cvt_pk_bf16_f32 v42, v42, v43
L_p1end_90:
    s_mov_b64 exec, -1
    s_cmp_eq_u32 s42, 2
    s_cbranch_scc1 L_part2_91
    s_waitcnt vmcnt(0) lgkmcnt(0)
    s_barrier
    s_cmp_lg_u32 s42, 0
    s_cbranch_scc1 L_nochk_97
    v_mov_b32 v116, 150024
    ds_read_b32 v117, v116
    s_waitcnt lgkmcnt(0)
    v_readfirstlane_b32 s3, v117
    s_nop 1
    s_cmp_lg_u32 s3, 0
    s_cbranch_scc1 L_p2slow_51
L_nochk_97:

    s_load_dwordx2 s[24:25], s[0:1], 88
    s_load_dwordx2 s[44:45], s[0:1], 96
    s_mov_b32 s26, 6400000
    s_mov_b32 s27, 0x20000
    s_movk_i32 s46, 256
    s_mov_b32 s47, 0x20000
    s_lshl_b32 s50, s36, 2
    v_and_b32 v116, 63, v0
    v_lshlrev_b32 v116, 20, v116

    s_add_u32 s20, s6, 6799360
    s_addc_u32 s21, s7, 0
    s_mov_b32 s22, 76800000
    s_mov_b32 s23, 0x20000
    v_readfirstlane_b32 s3, v0
    s_waitcnt lgkmcnt(0)
    s_cmp_eq_u32 s3, 960
    s_cbranch_scc1 L_sync_98
L_part2_91:
    v_cmp_gt_u32 vcc, 782, v0
    s_mov_b64 exec, vcc
    s_cbranch_execz L_p2end_92

    s_pack_ll_b32_b16 s52, s68, s70
    v_dot2_f32_bf16 v60, v12, s52, 0
    v_dot2_f32_bf16 v64, v20, s52, 0
    v_dot2_f32_bf16 v68, v28, s52, 0
    v_dot2_f32_bf16 v72, v36, s52, 0
    s_pack_hh_b32_b16 s53, s68, s70
    v_dot2_f32_bf16 v61, v12, s53, 0
    v_dot2_f32_bf16 v65, v20, s53, 0
    v_dot2_f32_bf16 v69, v28, s53, 0
    v_dot2_f32_bf16 v73, v36, s53, 0
    s_pack_ll_b32_b16 s52, s69, s71
    v_dot2_f32_bf16 v62, v12, s52, 0
    v_dot2_f32_bf16 v66, v20, s52, 0
    v_dot2_f32_bf16 v70, v28, s52, 0
    v_dot2_f32_bf16 v74, v36, s52, 0
    s_pack_hh_b32_b16 s53, s69, s71
    v_dot2_f32_bf16 v63, v12, s53, 0
    v_dot2_f32_bf16 v67, v20, s53, 0
    v_dot2_f32_bf16 v71, v28, s53, 0
    v_dot2_f32_bf16 v75, v36, s53, 0
    s_pack_ll_b32_b16 s52, s72, s74
    v_dot2_f32_bf16 v60, v14, s52, v60
    v_dot2_f32_bf16 v64, v22, s52, v64
    v_dot2_f32_bf16 v68, v30, s52, v68
    v_dot2_f32_bf16 v72, v38, s52, v72
    s_pack_hh_b32_b16 s53, s72, s74
    v_dot2_f32_bf16 v61, v14, s53, v61
    v_dot2_f32_bf16 v65, v22, s53, v65
    v_dot2_f32_bf16 v69, v30, s53, v69
    v_dot2_f32_bf16 v73, v38, s53, v73
    s_pack_ll_b32_b16 s52, s73, s75
    v_dot2_f32_bf16 v62, v14, s52, v62
    v_dot2_f32_bf16 v66, v22, s52, v66
    v_dot2_f32_bf16 v70, v30, s52, v70
    v_dot2_f32_bf16 v74, v38, s52, v74
    s_pack_hh_b32_b16 s53, s73, s75
    v_dot2_f32_bf16 v63, v14, s53, v63
    v_dot2_f32_bf16 v67, v22, s53, v67
    v_dot2_f32_bf16 v71, v30, s53, v71
    v_dot2_f32_bf16 v75, v38, s53, v75
    s_pack_ll_b32_b16 s52, s76, s78
    v_dot2_f32_bf16 v60, v16, s52, v60
    v_dot2_f32_bf16 v64, v24, s52, v64
    v_dot2_f32_bf16 v68, v32, s52, v68
    v_dot2_f32_bf16 v72, v40, s52, v72
    s_pack_hh_b32_b16 s53, s76, s78
    v_dot2_f32_bf16 v61, v16, s53, v61
    v_dot2_f32_bf16 v65, v24, s53, v65
    v_dot2_f32_bf16 v69, v32, s53, v69
    v_dot2_f32_bf16 v73, v40, s53, v73
    s_pack_ll_b32_b16 s52, s77, s79
    v_dot2_f32_bf16 v62, v16, s52, v62
    v_dot2_f32_bf16 v66, v24, s52, v66
    v_dot2_f32_bf16 v70, v32, s52, v70
    v_dot2_f32_bf16 v74, v40, s52, v74
    s_pack_hh_b32_b16 s53, s77, s79
    v_dot2_f32_bf16 v63, v16, s53, v63
    v_dot2_f32_bf16 v67, v24, s53, v67
    v_dot2_f32_bf16 v71, v32, s53, v71
    v_dot2_f32_bf16 v75, v40, s53, v75
    s_pack_ll_b32_b16 s52, s80, s82
    v_dot2_f32_bf16 v60, v18, s52, v60
    v_dot2_f32_bf16 v64, v26, s52, v64
    v_dot2_f32_bf16 v68, v34, s52, v68
    v_dot2_f32_bf16 v72, v42, s52, v72
    s_pack_hh_b32_b16 s53, s80, s82
    v_dot2_f32_bf16 v61, v18, s53, v61
    v_dot2_f32_bf16 v65, v26, s53, v65
    v_dot2_f32_bf16 v69, v34, s53, v69
    v_dot2_f32_bf16 v73, v42, s53, v73
    s_pack_ll_b32_b16 s52, s81, s83
    v_dot2_f32_bf16 v62, v18, s52, v62
    v_dot2_f32_bf16 v66, v26, s52, v66
    v_dot2_f32_bf16 v70, v34, s52, v70
    v_dot2_f32_bf16 v74, v42, s52, v74
    s_pack_hh_b32_b16 s53, s81, s83
    v_dot2_f32_bf16 v63, v18, s53, v63
    v_dot2_f32_bf16 v67, v26, s53, v67
    v_dot2_f32_bf16 v71, v34, s53, v71
    v_dot2_f32_bf16 v75, v42, s53, v75
    s_pack_ll_b32_b16 s52, s84, s86
    v_dot2_f32_bf16 v44, v12, s52, 0
    v_dot2_f32_bf16 v48, v20, s52, 0
    v_dot2_f32_bf16 v52, v28, s52, 0
    v_dot2_f32_bf16 v56, v36, s52, 0
    s_pack_hh_b32_b16 s53, s84, s86
    v_dot2_f32_bf16 v45, v12, s53, 0
    v_dot2_f32_bf16 v49, v20, s53, 0
    v_dot2_f32_bf16 v53, v28, s53, 0
    v_dot2_f32_bf16 v57, v36, s53, 0
    s_pack_ll_b32_b16 s52, s85, s87
    v_dot2_f32_bf16 v46, v12, s52, 0
    v_dot2_f32_bf16 v50, v20, s52, 0
    v_dot2_f32_bf16 v54, v28, s52, 0
    v_dot2_f32_bf16 v58, v36, s52, 0
    s_pack_hh_b32_b16 s53, s85, s87
    v_dot2_f32_bf16 v47, v12, s53, 0
    v_dot2_f32_bf16 v51, v20, s53, 0
    v_dot2_f32_bf16 v55, v28, s53, 0
    v_dot2_f32_bf16 v59, v36, s53, 0
    s_pack_ll_b32_b16 s52, s88, s90
    v_dot2_f32_bf16 v44, v14, s52, v44
    v_dot2_f32_bf16 v48, v22, s52, v48
    v_dot2_f32_bf16 v52, v30, s52, v52
    v_dot2_f32_bf16 v56, v38, s52, v56
    s_pack_hh_b32_b16 s53, s88, s90
    v_dot2_f32_bf16 v45, v14, s53, v45
    v_dot2_f32_bf16 v49, v22, s53, v49
    v_dot2_f32_bf16 v53, v30, s53, v53
    v_dot2_f32_bf16 v57, v38, s53, v57
    s_pack_ll_b32_b16 s52, s89, s91
    v_dot2_f32_bf16 v46, v14, s52, v46
    v_dot2_f32_bf16 v50, v22, s52, v50
    v_dot2_f32_bf16 v54, v30, s52, v54
    v_dot2_f32_bf16 v58, v38, s52, v58
    s_pack_hh_b32_b16 s53, s89, s91
    v_dot2_f32_bf16 v47, v14, s53, v47
    v_dot2_f32_bf16 v51, v22, s53, v51
    v_dot2_f32_bf16 v55, v30, s53, v55
    v_dot2_f32_bf16 v59, v38, s53, v59
    s_pack_ll_b32_b16 s52, s92, s94
    v_dot2_f32_bf16 v44, v16, s52, v44
    v_dot2_f32_bf16 v48, v24, s52, v48
    v_dot2_f32_bf16 v52, v32, s52, v52
    v_dot2_f32_bf16 v56, v40, s52, v56
    s_pack_hh_b32_b16 s53, s92, s94
    v_dot2_f32_bf16 v45, v16, s53, v45
    v_dot2_f32_bf16 v49, v24, s53, v49
    v_dot2_f32_bf16 v53, v32, s53, v53
    v_dot2_f32_bf16 v57, v40, s53, v57
    s_pack_ll_b32_b16 s52, s93, s95
    v_dot2_f32_bf16 v46, v16, s52, v46
    v_dot2_f32_bf16 v50, v24, s52, v50
    v_dot2_f32_bf16 v54, v32, s52, v54
    v_dot2_f32_bf16 v58, v40, s52, v58
    s_pack_hh_b32_b16 s53, s93, s95
    v_dot2_f32_bf16 v47, v16, s53, v47
    v_dot2_f32_bf16 v51, v24, s53, v51
    v_dot2_f32_bf16 v55, v32, s53, v55
    v_dot2_f32_bf16 v59, v40, s53, v59
    s_pack_ll_b32_b16 s52, s96, s98
    v_dot2_f32_bf16 v44, v18, s52, v44
    v_dot2_f32_bf16 v48, v26, s52, v48
    v_dot2_f32_bf16 v52, v34, s52, v52
    v_dot2_f32_bf16 v56, v42, s52, v56
    s_pack_hh_b32_b16 s53, s96, s98
    v_dot2_f32_bf16 v45, v18, s53, v45
    v_dot2_f32_bf16 v49, v26, s53, v49
    v_dot2_f32_bf16 v53, v34, s53, v53
    v_dot2_f32_bf16 v57, v42, s53, v57
    s_pack_ll_b32_b16 s52, s97, s99
    v_dot2_f32_bf16 v46, v18, s52, v46
    v_dot2_f32_bf16 v50, v26, s52, v50
    v_dot2_f32_bf16 v54, v34, s52, v54
    v_dot2_f32_bf16 v58, v42, s52, v58
    s_pack_hh_b32_b16 s53, s97, s99
    v_dot2_f32_bf16 v47, v18, s53, v47
    v_dot2_f32_bf16 v51, v26, s53, v51
    v_dot2_f32_bf16 v55, v34, s53, v55
    v_dot2_f32_bf16 v59, v42, s53, v59
    v_cvt_pk_bf16_f32 v60, v60, v61
    v_cvt_pk_bf16_f32 v62, v62, v63
    v_cvt_pk_bf16_f32 v64, v64, v65
    v_cvt_pk_bf16_f32 v66, v66, v67
    v_cvt_pk_bf16_f32 v68, v68, v69
    v_cvt_pk_bf16_f32 v70, v70, v71
    v_cvt_pk_bf16_f32 v72, v72, v73
    v_cvt_pk_bf16_f32 v74, v74, v75
    v_and_b32 v61, s32, v60
    v_lshlrev_b32 v60, 16, v60
    v_and_b32 v63, s32, v62
    v_lshlrev_b32 v62, 16, v62
    v_and_b32 v65, s32, v64
    v_lshlrev_b32 v64, 16, v64
    v_and_b32 v67, s32, v66
    v_lshlrev_b32 v66, 16, v66
    v_and_b32 v69, s32, v68
    v_lshlrev_b32 v68, 16, v68
    v_and_b32 v71, s32, v70
    v_lshlrev_b32 v70, 16, v70
    v_and_b32 v73, s32, v72
    v_lshlrev_b32 v72, 16, v72
    v_and_b32 v75, s32, v74
    v_lshlrev_b32 v74, 16, v74
L_p2end_92:
    s_mov_b64 exec, -1
    s_cmp_eq_u32 s42, 2
    s_cbranch_scc1 L_post_95
L_bcast_93:
    v_mov_b32 v118, 150016
    s_mov_b32 s42, 2
    s_waitcnt lgkmcnt(0)
    s_barrier
    ds_read_b32 v117, v118
    s_waitcnt lgkmcnt(0)
    v_readfirstlane_b32 s35, v117
    s_nop 1
    s_bitcmp1_b32 s35, 16
    s_cbranch_scc1 L_nextq_94
L_post_95:
    v_cmp_gt_u32 vcc, 782, v0
    s_mov_b64 exec, vcc
    s_cbranch_execz L_postend_96

    s_mov_b32 s3, 0
    buffer_load_dwordx4 v[76:79], v4, s[20:23], s3 offen sc1
    buffer_load_dwordx4 v[92:95], v5, s[20:23], s3 offen sc1
    s_mov_b32 s3, 6400000
    buffer_load_dwordx4 v[80:83], v4, s[20:23], s3 offen sc1
    buffer_load_dwordx4 v[96:99], v5, s[20:23], s3 offen sc1
    s_mov_b32 s3, 12800000
    buffer_load_dwordx4 v[84:87], v4, s[20:23], s3 offen sc1
    buffer_load_dwordx4 v[100:103], v5, s[20:23], s3 offen sc1
    s_mov_b32 s3, 19200000
    buffer_load_dwordx4 v[88:91], v4, s[20:23], s3 offen sc1
    buffer_load_dwordx4 v[104:107], v5, s[20:23], s3 offen sc1
    s_and_b32 s3, s35, 0xf0
    s_cbranch_scc1 L_fgen_102
    s_waitcnt vmcnt(0)

    v_add_u32 v76, v76, v80
    v_add_u32 v84, v84, v88
    v_add_u32 v77, v77, v81
    v_add_u32 v85, v85, v89
    v_add_u32 v78, v78, v82
    v_add_u32 v86, v86, v90
    v_add_u32 v79, v79, v83
    v_add_u32 v87, v87, v91
    v_add_u32_sdwa v12, v76, v84 dst_sel:DWORD dst_unused:UNUSED_PAD src0_sel:WORD_0 src1_sel:WORD_0
    v_add_u32_sdwa v13, v76, v84 dst_sel:DWORD dst_unused:UNUSED_PAD src0_sel:WORD_1 src1_sel:WORD_1
    v_add_u32_sdwa v14, v77, v85 dst_sel:DWORD dst_unused:UNUSED_PAD src0_sel:WORD_0 src1_sel:WORD_0
    v_add_u32_sdwa v15, v77, v85 dst_sel:DWORD dst_unused:UNUSED_PAD src0_sel:WORD_1 src1_sel:WORD_1
    v_add_u32_sdwa v16, v78, v86 dst_sel:DWORD dst_unused:UNUSED_PAD src0_sel:WORD_0 src1_sel:WORD_0
    v_add_u32_sdwa v17, v78, v86 dst_sel:DWORD dst_unused:UNUSED_PAD src0_sel:WORD_1 src1_sel:WORD_1
    v_add_u32_sdwa v18, v79, v87 dst_sel:DWORD dst_unused:UNUSED_PAD src0_sel:WORD_0 src1_sel:WORD_0
    v_add_u32_sdwa v19, v79, v87 dst_sel:DWORD dst_unused:UNUSED_PAD src0_sel:WORD_1 src1_sel:WORD_1
    v_add_u32 v92, v92, v96
    v_add_u32 v100, v100, v104
    v_add_u32 v93, v93, v97
    v_add_u32 v101, v101, v105
    v_add_u32 v94, v94, v98
    v_add_u32 v102, v102, v106
    v_add_u32 v95, v95, v99
    v_add_u32 v103, v103, v107
    v_add_u32_sdwa v20, v92, v100 dst_sel:DWORD dst_unused:UNUSED_PAD src0_sel:WORD_0 src1_sel:WORD_0
    v_add_u32_sdwa v21, v92, v100 dst_sel:DWORD dst_unused:UNUSED_PAD src0_sel:WORD_1 src1_sel:WORD_1
    v_add_u32_sdwa v22, v93, v101 dst_sel:DWORD dst_unused:UNUSED_PAD src0_sel:WORD_0 src1_sel:WORD_0
    v_add_u32_sdwa v23, v93, v101 dst_sel:DWORD dst_unused:UNUSED_PAD src0_sel:WORD_1 src1_sel:WORD_1
    v_add_u32_sdwa v24, v94, v102 dst_sel:DWORD dst_unused:UNUSED_PAD src0_sel:WORD_0 src1_sel:WORD_0
    v_add_u32_sdwa v25, v94, v102 dst_sel:DWORD dst_unused:UNUSED_PAD src0_sel:WORD_1 src1_sel:WORD_1
    v_add_u32_sdwa v26, v95, v103 dst_sel:DWORD dst_unused:UNUSED_PAD src0_sel:WORD_0 src1_sel:WORD_0
    v_add_u32_sdwa v27, v95, v103 dst_sel:DWORD dst_unused:UNUSED_PAD src0_sel:WORD_1 src1_sel:WORD_1
    v_add_u32 v12, 0xffff0000, v12
    v_add_u32 v13, 0xffff0000, v13
    v_add_u32 v14, 0xffff0000, v14
    v_add_u32 v15, 0xffff0000, v15
    v_add_u32 v16, 0xffff0000, v16
    v_add_u32 v17, 0xffff0000, v17
    v_add_u32 v18, 0xffff0000, v18
    v_add_u32 v19, 0xffff0000, v19
    v_add_u32 v20, 0xffff0000, v20
    v_add_u32 v21, 0xffff0000, v21
    v_add_u32 v22, 0xffff0000, v22
    v_add_u32 v23, 0xffff0000, v23
    v_add_u32 v24, 0xffff0000, v24
    v_add_u32 v25, 0xffff0000, v25
    v_add_u32 v26, 0xffff0000, v26
    v_add_u32 v27, 0xffff0000, v27
    v_cvt_f32_i32 v12, v12
    v_cvt_f32_i32 v13, v13
    v_cvt_f32_i32 v14, v14
    v_cvt_f32_i32 v15, v15
    v_cvt_f32_i32 v16, v16
    v_cvt_f32_i32 v17, v17
    v_cvt_f32_i32 v18, v18
    v_cvt_f32_i32 v19, v19
    v_cvt_f32_i32 v20, v20
    v_cvt_f32_i32 v21, v21
    v_cvt_f32_i32 v22, v22
    v_cvt_f32_i32 v23, v23
    v_cvt_f32_i32 v24, v24
    v_cvt_f32_i32 v25, v25
    v_cvt_f32_i32 v26, v26
    v_cvt_f32_i32 v27, v27
    v_mul_f32 v12, s34, v12
    v_mul_f32 v13, s34, v13
    v_mul_f32 v14, s34, v14
    v_mul_f32 v15, s34, v15
    v_mul_f32 v16, s34, v16
    v_mul_f32 v17, s34, v17
    v_mul_f32 v18, s34, v18
    v_mul_f32 v19, s34, v19
    v_mul_f32 v20, s34, v20
    v_mul_f32 v21, s34, v21
    v_mul_f32 v22, s34, v22
    v_mul_f32 v23, s34, v23
    v_mul_f32 v24, s34, v24
    v_mul_f32 v25, s34, v25
    v_mul_f32 v26, s34, v26
    v_mul_f32 v27, s34, v27
L_fbk_103:
    s_lshl_b32 s52, s12, 16
    v_mul_f32 v28, s52, v12
    v_mul_f32 v32, s52, v16
    v_mul_f32 v36, s52, v20
    v_mul_f32 v40, s52, v24
    s_and_b32 s53, s12, s32
    v_mul_f32 v29, s53, v12
    v_mul_f32 v33, s53, v16
    v_mul_f32 v37, s53, v20
    v_mul_f32 v41, s53, v24
    s_lshl_b32 s52, s13, 16
    v_mul_f32 v30, s52, v12
    v_mul_f32 v34, s52, v16
    v_mul_f32 v38, s52, v20
    v_mul_f32 v42, s52, v24
    s_and_b32 s53, s13, s32
    v_mul_f32 v31, s53, v12
    v_mul_f32 v35, s53, v16
    v_mul_f32 v39, s53, v20
    v_mul_f32 v43, s53, v24
    s_lshl_b32 s52, s14, 16
    v_fmac_f32 v28, s52, v13
    v_fmac_f32 v32, s52, v17
    v_fmac_f32 v36, s52, v21
    v_fmac_f32 v40, s52, v25
    s_and_b32 s53, s14, s32
    v_fmac_f32 v29, s53, v13
    v_fmac_f32 v33, s53, v17
    v_fmac_f32 v37, s53, v21
    v_fmac_f32 v41, s53, v25
    s_lshl_b32 s52, s15, 16
    v_fmac_f32 v30, s52, v13
    v_fmac_f32 v34, s52, v17
    v_fmac_f32 v38, s52, v21
    v_fmac_f32 v42, s52, v25
    s_and_b32 s53, s15, s32
    v_fmac_f32 v31, s53, v13
    v_fmac_f32 v35, s53, v17
    v_fmac_f32 v39, s53, v21
    v_fmac_f32 v43, s53, v25
    s_lshl_b32 s52, s16, 16
    v_fmac_f32 v28, s52, v14
    v_fmac_f32 v32, s52, v18
    v_fmac_f32 v36, s52, v22
    v_fmac_f32 v40, s52, v26
    s_and_b32 s53, s16, s32
    v_fmac_f32 v29, s53, v14
    v_fmac_f32 v33, s53, v18
    v_fmac_f32 v37, s53, v22
    v_fmac_f32 v41, s53, v26
    s_lshl_b32 s52, s17, 16
    v_fmac_f32 v30, s52, v14
    v_fmac_f32 v34, s52, v18
    v_fmac_f32 v38, s52, v22
    v_fmac_f32 v42, s52, v26
    s_and_b32 s53, s17, s32
    v_fmac_f32 v31, s53, v14
    v_fmac_f32 v35, s53, v18
    v_fmac_f32 v39, s53, v22
    v_fmac_f32 v43, s53, v26
    s_lshl_b32 s52, s18, 16
    v_fmac_f32 v28, s52, v15
    v_fmac_f32 v32, s52, v19
    v_fmac_f32 v36, s52, v23
    v_fmac_f32 v40, s52, v27
    s_and_b32 s53, s18, s32
    v_fmac_f32 v29, s53, v15
    v_fmac_f32 v33, s53, v19
    v_fmac_f32 v37, s53, v23
    v_fmac_f32 v41, s53, v27
    s_lshl_b32 s52, s19, 16
    v_fmac_f32 v30, s52, v15
    v_fmac_f32 v34, s52, v19
    v_fmac_f32 v38, s52, v23
    v_fmac_f32 v42, s52, v27
    s_and_b32 s53, s19, s32
    v_fmac_f32 v31, s53, v15
    v_fmac_f32 v35, s53, v19
    v_fmac_f32 v39, s53, v23
    v_fmac_f32 v43, s53, v27
    v_mul_f32 v28, v28, v44
    v_mul_f32 v29, v29, v45
    v_mul_f32 v30, v30, v46
    v_mul_f32 v31, v31, v47
    v_mul_f32 v32, v32, v48
    v_mul_f32 v33, v33, v49
    v_mul_f32 v34, v34, v50
    v_mul_f32 v35, v35, v51
    v_mul_f32 v36, v36, v52
    v_mul_f32 v37, v37, v53
    v_mul_f32 v38, v38, v54
    v_mul_f32 v39, v39, v55
    v_mul_f32 v40, v40, v56
    v_mul_f32 v41, v41, v57
    v_mul_f32 v42, v42, v58
    v_mul_f32 v43, v43, v59
    v_cvt_pk_bf16_f32 v28, v28, v29
    v_cvt_pk_bf16_f32 v30, v30, v31
    v_cvt_pk_bf16_f32 v32, v32, v33
    v_cvt_pk_bf16_f32 v34, v34, v35
    v_cvt_pk_bf16_f32 v36, v36, v37
    v_cvt_pk_bf16_f32 v38, v38, v39
    v_cvt_pk_bf16_f32 v40, v40, v41
    v_cvt_pk_bf16_f32 v42, v42, v43
    s_pack_ll_b32_b16 s52, s56, s58
    v_dot2_f32_bf16 v12, v28, s52, 0
    v_dot2_f32_bf16 v16, v32, s52, 0
    v_dot2_f32_bf16 v20, v36, s52, 0
    v_dot2_f32_bf16 v24, v40, s52, 0
    s_pack_hh_b32_b16 s53, s56, s58
    v_dot2_f32_bf16 v13, v28, s53, 0
    v_dot2_f32_bf16 v17, v32, s53, 0
    v_dot2_f32_bf16 v21, v36, s53, 0
    v_dot2_f32_bf16 v25, v40, s53, 0
    s_pack_ll_b32_b16 s52, s57, s59
    v_dot2_f32_bf16 v14, v28, s52, 0
    v_dot2_f32_bf16 v18, v32, s52, 0
    v_dot2_f32_bf16 v22, v36, s52, 0
    v_dot2_f32_bf16 v26, v40, s52, 0
    s_pack_hh_b32_b16 s53, s57, s59
    v_dot2_f32_bf16 v15, v28, s53, 0
    v_dot2_f32_bf16 v19, v32, s53, 0
    v_dot2_f32_bf16 v23, v36, s53, 0
    v_dot2_f32_bf16 v27, v40, s53, 0
    s_pack_ll_b32_b16 s52, s60, s62
    v_dot2_f32_bf16 v12, v30, s52, v12
    v_dot2_f32_bf16 v16, v34, s52, v16
    v_dot2_f32_bf16 v20, v38, s52, v20
    v_dot2_f32_bf16 v24, v42, s52, v24
    s_pack_hh_b32_b16 s53, s60, s62
    v_dot2_f32_bf16 v13, v30, s53, v13
    v_dot2_f32_bf16 v17, v34, s53, v17
    v_dot2_f32_bf16 v21, v38, s53, v21
    v_dot2_f32_bf16 v25, v42, s53, v25
    s_pack_ll_b32_b16 s52, s61, s63
    v_dot2_f32_bf16 v14, v30, s52, v14
    v_dot2_f32_bf16 v18, v34, s52, v18
    v_dot2_f32_bf16 v22, v38, s52, v22
    v_dot2_f32_bf16 v26, v42, s52, v26
    s_pack_hh_b32_b16 s53, s61, s63
    v_dot2_f32_bf16 v15, v30, s53, v15
    v_dot2_f32_bf16 v19, v34, s53, v19
    v_dot2_f32_bf16 v23, v38, s53, v23
    v_dot2_f32_bf16 v27, v42, s53, v27
    v_lshlrev_b32 v44, 16, v108
    v_and_b32 v45, s32, v108
    v_lshlrev_b32 v46, 16, v109
    v_and_b32 v47, s32, v109
    v_lshlrev_b32 v48, 16, v110
    v_and_b32 v49, s32, v110
    v_lshlrev_b32 v50, 16, v111
    v_and_b32 v51, s32, v111
    v_lshlrev_b32 v52, 16, v112
    v_and_b32 v53, s32, v112
    v_lshlrev_b32 v54, 16, v113
    v_and_b32 v55, s32, v113
    v_lshlrev_b32 v56, 16, v114
    v_and_b32 v57, s32, v114
    v_lshlrev_b32 v58, 16, v115
    v_and_b32 v59, s32, v115
    v_cvt_pk_bf16_f32 v12, v12, v13
    v_cvt_pk_bf16_f32 v14, v14, v15
    v_cvt_pk_bf16_f32 v16, v16, v17
    v_cvt_pk_bf16_f32 v18, v18, v19
    v_cvt_pk_bf16_f32 v20, v20, v21
    v_cvt_pk_bf16_f32 v22, v22, v23
    v_cvt_pk_bf16_f32 v24, v24, v25
    v_cvt_pk_bf16_f32 v26, v26, v27
    v_and_b32 v13, s32, v12
    v_lshlrev_b32 v12, 16, v12
    v_and_b32 v15, s32, v14
    v_lshlrev_b32 v14, 16, v14
    v_and_b32 v17, s32, v16
    v_lshlrev_b32 v16, 16, v16
    v_and_b32 v19, s32, v18
    v_lshlrev_b32 v18, 16, v18
    v_and_b32 v21, s32, v20
    v_lshlrev_b32 v20, 16, v20
    v_and_b32 v23, s32, v22
    v_lshlrev_b32 v22, 16, v22
    v_and_b32 v25, s32, v24
    v_lshlrev_b32 v24, 16, v24
    v_and_b32 v27, s32, v26
    v_lshlrev_b32 v26, 16, v26
    v_mul_f32 v12, v12, v60
    v_mul_f32 v13, v13, v61
    v_mul_f32 v14, v14, v62
    v_mul_f32 v15, v15, v63
    v_mul_f32 v16, v16, v64
    v_mul_f32 v17, v17, v65
    v_mul_f32 v18, v18, v66
    v_mul_f32 v19, v19, v67
    v_mul_f32 v20, v20, v68
    v_mul_f32 v21, v21, v69
    v_mul_f32 v22, v22, v70
    v_mul_f32 v23, v23, v71
    v_mul_f32 v24, v24, v72
    v_mul_f32 v25, v25, v73
    v_mul_f32 v26, v26, v74
    v_mul_f32 v27, v27, v75
    v_cvt_pk_bf16_f32 v12, v12, v13
    v_cvt_pk_bf16_f32 v14, v14, v15
    v_cvt_pk_bf16_f32 v16, v16, v17
    v_cvt_pk_bf16_f32 v18, v18, v19
    v_cvt_pk_bf16_f32 v20, v20, v21
    v_cvt_pk_bf16_f32 v22, v22, v23
    v_cvt_pk_bf16_f32 v24, v24, v25
    v_cvt_pk_bf16_f32 v26, v26, v27
    v_and_b32 v13, s32, v12
    v_lshlrev_b32 v12, 16, v12
    v_and_b32 v15, s32, v14
    v_lshlrev_b32 v14, 16, v14
    v_and_b32 v17, s32, v16
    v_lshlrev_b32 v16, 16, v16
    v_and_b32 v19, s32, v18
    v_lshlrev_b32 v18, 16, v18
    v_and_b32 v21, s32, v20
    v_lshlrev_b32 v20, 16, v20
    v_and_b32 v23, s32, v22
    v_lshlrev_b32 v22, 16, v22
    v_and_b32 v25, s32, v24
    v_lshlrev_b32 v24, 16, v24
    v_and_b32 v27, s32, v26
    v_lshlrev_b32 v26, 16, v26
    v_add_f32 v12, v12, v44
    v_add_f32 v13, v13, v45
    v_add_f32 v14, v14, v46
    v_add_f32 v15, v15, v47
    v_add_f32 v16, v16, v48
    v_add_f32 v17, v17, v49
    v_add_f32 v18, v18, v50
    v_add_f32 v19, v19, v51
    v_add_f32 v20, v20, v52
    v_add_f32 v21, v21, v53
    v_add_f32 v22, v22, v54
    v_add_f32 v23, v23, v55
    v_add_f32 v24, v24, v56
    v_add_f32 v25, v25, v57
    v_add_f32 v26, v26, v58
    v_add_f32 v27, v27, v59
    v_cvt_pk_bf16_f32 v28, v12, v13
    v_cvt_pk_bf16_f32 v29, v14, v15
    v_cvt_pk_bf16_f32 v30, v16, v17
    v_cvt_pk_bf16_f32 v31, v18, v19
    v_cvt_pk_bf16_f32 v32, v20, v21
    v_cvt_pk_bf16_f32 v33, v22, v23
    v_cvt_pk_bf16_f32 v34, v24, v25
    v_cvt_pk_bf16_f32 v35, v26, v27
    buffer_store_dwordx4 v[28:31], v4, s[24:27], 0 offen
    buffer_store_dwordx4 v[32:35], v5, s[24:27], 0 offen
L_postend_96:
    s_mov_b64 exec, -1
L_nextq_94:
    s_bfe_u32 s3, s35, 0x40008
    s_cbranch_scc0 L_fend_112
    s_ff1_i32_b32 s41, s3
    s_add_u32 s3, s41, 8
    s_bitset0_b32 s35, s3
    s_branch L_qloop_89
L_fend_112:

L_p2done_50:
    s_endpgm

L_ufix_52:
    v_and_b32 v117, 63, v0
    v_lshlrev_b32 v117, 2, v117
    s_sub_i32 s54, s42, 1024
    v_cmp_le_i32 vcc, s54, v117
    s_mov_b64 exec, vcc
    v_mov_b32 v12, 0
    v_mov_b32 v44, 0
    s_mov_b64 exec, -1
    s_sub_i32 s54, s42, 1025
    v_cmp_le_i32 vcc, s54, v117
    s_mov_b64 exec, vcc
    v_mov_b32 v13, 0
    v_mov_b32 v46, 0
    s_mov_b64 exec, -1
    s_sub_i32 s54, s42, 1026
    v_cmp_le_i32 vcc, s54, v117
    s_mov_b64 exec, vcc
    v_mov_b32 v14, 0
    v_mov_b32 v48, 0
    s_mov_b64 exec, -1
    s_sub_i32 s54, s42, 1027
    v_cmp_le_i32 vcc, s54, v117
    s_mov_b64 exec, vcc
    v_mov_b32 v15, 0
    v_mov_b32 v50, 0
    s_mov_b64 exec, -1
    s_branch L_uback_53
L_ufix_54:
    v_and_b32 v117, 63, v0
    v_lshlrev_b32 v117, 2, v117
    s_sub_i32 s54, s42, 1536
    v_cmp_le_i32 vcc, s54, v117
    s_mov_b64 exec, vcc
    v_mov_b32 v16, 0
    v_mov_b32 v52, 0
    s_mov_b64 exec, -1
    s_sub_i32 s54, s42, 1537
    v_cmp_le_i32 vcc, s54, v117
    s_mov_b64 exec, vcc
    v_mov_b32 v17, 0
    v_mov_b32 v54, 0
    s_mov_b64 exec, -1
    s_sub_i32 s54, s42, 1538
    v_cmp_le_i32 vcc, s54, v117
    s_mov_b64 exec, vcc
    v_mov_b32 v18, 0
    v_mov_b32 v56, 0
    s_mov_b64 exec, -1
    s_sub_i32 s54, s42, 1539
    v_cmp_le_i32 vcc, s54, v117
    s_mov_b64 exec, vcc
    v_mov_b32 v19, 0
    v_mov_b32 v58, 0
    s_mov_b64 exec, -1
    s_branch L_uback_55
L_ufix_56:
    v_and_b32 v117, 63, v0
    v_lshlrev_b32 v117, 2, v117
    s_sub_i32 s54, s42, 2048
    v_cmp_le_i32 vcc, s54, v117
    s_mov_b64 exec, vcc
    v_mov_b32 v20, 0
    v_mov_b32 v60, 0
    s_mov_b64 exec, -1
    s_sub_i32 s54, s42, 2049
    v_cmp_le_i32 vcc, s54, v117
    s_mov_b64 exec, vcc
    v_mov_b32 v21, 0
    v_mov_b32 v62, 0
    s_mov_b64 exec, -1
    s_sub_i32 s54, s42, 2050
    v_cmp_le_i32 vcc, s54, v117
    s_mov_b64 exec, vcc
    v_mov_b32 v22, 0
    v_mov_b32 v64, 0
    s_mov_b64 exec, -1
    s_sub_i32 s54, s42, 2051
    v_cmp_le_i32 vcc, s54, v117
    s_mov_b64 exec, vcc
    v_mov_b32 v23, 0
    v_mov_b32 v66, 0
    s_mov_b64 exec, -1
    s_branch L_uback_57
L_ufix_58:
    v_and_b32 v117, 63, v0
    v_lshlrev_b32 v117, 2, v117
    s_sub_i32 s54, s42, 2560
    v_cmp_le_i32 vcc, s54, v117
    s_mov_b64 exec, vcc
    v_mov_b32 v24, 0
    v_mov_b32 v68, 0
    s_mov_b64 exec, -1
    s_sub_i32 s54, s42, 2561
    v_cmp_le_i32 vcc, s54, v117
    s_mov_b64 exec, vcc
    v_mov_b32 v25, 0
    v_mov_b32 v70, 0
    s_mov_b64 exec, -1
    s_sub_i32 s54, s42, 2562
    v_cmp_le_i32 vcc, s54, v117
    s_mov_b64 exec, vcc
    v_mov_b32 v26, 0
    v_mov_b32 v72, 0
    s_mov_b64 exec, -1
    s_sub_i32 s54, s42, 2563
    v_cmp_le_i32 vcc, s54, v117
    s_mov_b64 exec, vcc
    v_mov_b32 v27, 0
    v_mov_b32 v74, 0
    s_mov_b64 exec, -1
    s_branch L_uback_59
L_ufix_60:
    v_and_b32 v117, 63, v0
    v_lshlrev_b32 v117, 2, v117
    s_sub_i32 s54, s42, 0
    v_cmp_le_i32 vcc, s54, v117
    s_mov_b64 exec, vcc
    v_mov_b32 v4, 0
    v_mov_b32 v28, 0
    s_mov_b64 exec, -1
    s_sub_i32 s54, s42, 1
    v_cmp_le_i32 vcc, s54, v117
    s_mov_b64 exec, vcc
    v_mov_b32 v5, 0
    v_mov_b32 v30, 0
    s_mov_b64 exec, -1
    s_sub_i32 s54, s42, 2
    v_cmp_le_i32 vcc, s54, v117
    s_mov_b64 exec, vcc
    v_mov_b32 v6, 0
    v_mov_b32 v32, 0
    s_mov_b64 exec, -1
    s_sub_i32 s54, s42, 3
    v_cmp_le_i32 vcc, s54, v117
    s_mov_b64 exec, vcc
    v_mov_b32 v7, 0
    v_mov_b32 v34, 0
    s_mov_b64 exec, -1
    s_branch L_uback_61
L_ufix_62:
    v_and_b32 v117, 63, v0
    v_lshlrev_b32 v117, 2, v117
    s_sub_i32 s54, s42, 512
    v_cmp_le_i32 vcc, s54, v117
    s_mov_b64 exec, vcc
    v_mov_b32 v8, 0
    v_mov_b32 v36, 0
    s_mov_b64 exec, -1
    s_sub_i32 s54, s42, 513
    v_cmp_le_i32 vcc, s54, v117
    s_mov_b64 exec, vcc
    v_mov_b32 v9, 0
    v_mov_b32 v38, 0
    s_mov_b64 exec, -1
    s_sub_i32 s54, s42, 514
    v_cmp_le_i32 vcc, s54, v117
    s_mov_b64 exec, vcc
    v_mov_b32 v10, 0
    v_mov_b32 v40, 0
    s_mov_b64 exec, -1
    s_sub_i32 s54, s42, 515
    v_cmp_le_i32 vcc, s54, v117
    s_mov_b64 exec, vcc
    v_mov_b32 v11, 0
    v_mov_b32 v42, 0
    s_mov_b64 exec, -1
    s_branch L_uback_63
L_ufix_69:
    v_and_b32 v117, 63, v0
    v_lshlrev_b32 v117, 2, v117
    s_sub_i32 s54, s42, 3072
    v_cmp_le_i32 vcc, s54, v117
    s_mov_b64 exec, vcc
    v_mov_b32 v106, 0
    v_mov_b32 v120, 0
    s_mov_b64 exec, -1
    s_sub_i32 s54, s42, 3073
    v_cmp_le_i32 vcc, s54, v117
    s_mov_b64 exec, vcc
    v_mov_b32 v107, 0
    v_mov_b32 v122, 0
    s_mov_b64 exec, -1
    s_sub_i32 s54, s42, 3074
    v_cmp_le_i32 vcc, s54, v117
    s_mov_b64 exec, vcc
    v_mov_b32 v108, 0
    v_mov_b32 v124, 0
    s_mov_b64 exec, -1
    s_sub_i32 s54, s42, 3075
    v_cmp_le_i32 vcc, s54, v117
    s_mov_b64 exec, vcc
    v_mov_b32 v109, 0
    v_mov_b32 v126, 0
    s_mov_b64 exec, -1
    s_branch L_uback_70
L_ufix_73:
    v_and_b32 v117, 63, v0
    v_lshlrev_b32 v117, 2, v117
    s_sub_i32 s54, s42, 1024
    v_cmp_le_i32 vcc, s54, v117
    s_mov_b64 exec, vcc
    v_mov_b32 v12, 0
    v_mov_b32 v44, 0
    s_mov_b64 exec, -1
    s_sub_i32 s54, s42, 1025
    v_cmp_le_i32 vcc, s54, v117
    s_mov_b64 exec, vcc
    v_mov_b32 v13, 0
    v_mov_b32 v46, 0
    s_mov_b64 exec, -1
    s_sub_i32 s54, s42, 1026
    v_cmp_le_i32 vcc, s54, v117
    s_mov_b64 exec, vcc
    v_mov_b32 v14, 0
    v_mov_b32 v48, 0
    s_mov_b64 exec, -1
    s_sub_i32 s54, s42, 1027
    v_cmp_le_i32 vcc, s54, v117
    s_mov_b64 exec, vcc
    v_mov_b32 v15, 0
    v_mov_b32 v50, 0
    s_mov_b64 exec, -1
    s_branch L_uback_74
L_ufix_75:
    v_and_b32 v117, 63, v0
    v_lshlrev_b32 v117, 2, v117
    s_sub_i32 s54, s42, 1536
    v_cmp_le_i32 vcc, s54, v117
    s_mov_b64 exec, vcc
    v_mov_b32 v16, 0
    v_mov_b32 v52, 0
    s_mov_b64 exec, -1
    s_sub_i32 s54, s42, 1537
    v_cmp_le_i32 vcc, s54, v117
    s_mov_b64 exec, vcc
    v_mov_b32 v17, 0
    v_mov_b32 v54, 0
    s_mov_b64 exec, -1
    s_sub_i32 s54, s42, 1538
    v_cmp_le_i32 vcc, s54, v117
    s_mov_b64 exec, vcc
    v_mov_b32 v18, 0
    v_mov_b32 v56, 0
    s_mov_b64 exec, -1
    s_sub_i32 s54, s42, 1539
    v_cmp_le_i32 vcc, s54, v117
    s_mov_b64 exec, vcc
    v_mov_b32 v19, 0
    v_mov_b32 v58, 0
    s_mov_b64 exec, -1
    s_branch L_uback_76
L_ufix_77:
    v_and_b32 v117, 63, v0
    v_lshlrev_b32 v117, 2, v117
    s_sub_i32 s54, s42, 2048
    v_cmp_le_i32 vcc, s54, v117
    s_mov_b64 exec, vcc
    v_mov_b32 v20, 0
    v_mov_b32 v60, 0
    s_mov_b64 exec, -1
    s_sub_i32 s54, s42, 2049
    v_cmp_le_i32 vcc, s54, v117
    s_mov_b64 exec, vcc
    v_mov_b32 v21, 0
    v_mov_b32 v62, 0
    s_mov_b64 exec, -1
    s_sub_i32 s54, s42, 2050
    v_cmp_le_i32 vcc, s54, v117
    s_mov_b64 exec, vcc
    v_mov_b32 v22, 0
    v_mov_b32 v64, 0
    s_mov_b64 exec, -1
    s_sub_i32 s54, s42, 2051
    v_cmp_le_i32 vcc, s54, v117
    s_mov_b64 exec, vcc
    v_mov_b32 v23, 0
    v_mov_b32 v66, 0
    s_mov_b64 exec, -1
    s_branch L_uback_78
L_ufix_79:
    v_and_b32 v117, 63, v0
    v_lshlrev_b32 v117, 2, v117
    s_sub_i32 s54, s42, 2560
    v_cmp_le_i32 vcc, s54, v117
    s_mov_b64 exec, vcc
    v_mov_b32 v24, 0
    v_mov_b32 v68, 0
    s_mov_b64 exec, -1
    s_sub_i32 s54, s42, 2561
    v_cmp_le_i32 vcc, s54, v117
    s_mov_b64 exec, vcc
    v_mov_b32 v25, 0
    v_mov_b32 v70, 0
    s_mov_b64 exec, -1
    s_sub_i32 s54, s42, 2562
    v_cmp_le_i32 vcc, s54, v117
    s_mov_b64 exec, vcc
    v_mov_b32 v26, 0
    v_mov_b32 v72, 0
    s_mov_b64 exec, -1
    s_sub_i32 s54, s42, 2563
    v_cmp_le_i32 vcc, s54, v117
    s_mov_b64 exec, vcc
    v_mov_b32 v27, 0
    v_mov_b32 v74, 0
    s_mov_b64 exec, -1
    s_branch L_uback_80
L_ufix_81:
    v_and_b32 v117, 63, v0
    v_lshlrev_b32 v117, 2, v117
    s_sub_i32 s54, s42, 0
    v_cmp_le_i32 vcc, s54, v117
    s_mov_b64 exec, vcc
    v_mov_b32 v4, 0
    v_mov_b32 v28, 0
    s_mov_b64 exec, -1
    s_sub_i32 s54, s42, 1
    v_cmp_le_i32 vcc, s54, v117
    s_mov_b64 exec, vcc
    v_mov_b32 v5, 0
    v_mov_b32 v30, 0
    s_mov_b64 exec, -1
    s_sub_i32 s54, s42, 2
    v_cmp_le_i32 vcc, s54, v117
    s_mov_b64 exec, vcc
    v_mov_b32 v6, 0
    v_mov_b32 v32, 0
    s_mov_b64 exec, -1
    s_sub_i32 s54, s42, 3
    v_cmp_le_i32 vcc, s54, v117
    s_mov_b64 exec, vcc
    v_mov_b32 v7, 0
    v_mov_b32 v34, 0
    s_mov_b64 exec, -1
    s_branch L_uback_82
L_ufix_83:
    v_and_b32 v117, 63, v0
    v_lshlrev_b32 v117, 2, v117
    s_sub_i32 s54, s42, 512
    v_cmp_le_i32 vcc, s54, v117
    s_mov_b64 exec, vcc
    v_mov_b32 v8, 0
    v_mov_b32 v36, 0
    s_mov_b64 exec, -1
    s_sub_i32 s54, s42, 513
    v_cmp_le_i32 vcc, s54, v117
    s_mov_b64 exec, vcc
    v_mov_b32 v9, 0
    v_mov_b32 v38, 0
    s_mov_b64 exec, -1
    s_sub_i32 s54, s42, 514
    v_cmp_le_i32 vcc, s54, v117
    s_mov_b64 exec, vcc
    v_mov_b32 v10, 0
    v_mov_b32 v40, 0
    s_mov_b64 exec, -1
    s_sub_i32 s54, s42, 515
    v_cmp_le_i32 vcc, s54, v117
    s_mov_b64 exec, vcc
    v_mov_b32 v11, 0
    v_mov_b32 v42, 0
    s_mov_b64 exec, -1
    s_branch L_uback_84
L_sync_98:
    v_mov_b32 v117, s33
    buffer_atomic_add v117, v116, s[44:47], s50 offen sc0
    s_waitcnt vmcnt(0)
    v_readfirstlane_b32 s4, v117
    s_movk_i32 s5, 400
    s_nop 0
    s_add_u32 s4, s4, s33
    s_bitcmp1_b32 s4, 2
    s_cbranch_scc1 L_tell_101
L_poll_99:
    s_sub_u32 s5, s5, 1
    s_cbranch_scc1 L_gave_100
    v_mov_b32 v117, 0
    buffer_atomic_add v117, v116, s[44:47], s50 offen sc0
    s_waitcnt vmcnt(0)
    v_readfirstlane_b32 s4, v117
    s_nop 1
    s_and_b32 s4, s4, 0xff
    s_bitcmp0_b32 s4, 2
    s_cbranch_scc1 L_poll_99
    s_branch L_tell_101
L_gave_100:
    s_lshl_b32 s4, 0x100, s37
    v_mov_b32 v117, s4
    buffer_atomic_or v117, v116, s[44:47], s50 offen sc0
    s_waitcnt vmcnt(0)
    v_readfirstlane_b32 s4, v117
    s_nop 1
    s_and_b32 s4, s4, 0xff
    s_bitcmp1_b32 s4, 2
    s_cselect_b32 s4, s4, 0x10000
L_tell_101:
    v_mov_b32 v117, s4
    v_mov_b32 v118, 150016
    ds_write_b32 v118, v117
    s_branch L_bcast_93

L_fgen_102:
    s_waitcnt vmcnt(0)
    v_lshlrev_b32 v6, 1, v4
    v_lshlrev_b32 v7, 1, v5
    v_mov_b32 v12, 0
    v_mov_b32 v13, 0
    v_mov_b32 v14, 0
    v_mov_b32 v15, 0
    v_mov_b32 v16, 0
    v_mov_b32 v17, 0
    v_mov_b32 v18, 0
    v_mov_b32 v19, 0
    v_mov_b32 v20, 0
    v_mov_b32 v21, 0
    v_mov_b32 v22, 0
    v_mov_b32 v23, 0
    v_mov_b32 v24, 0
    v_mov_b32 v25, 0
    v_mov_b32 v26, 0
    v_mov_b32 v27, 0
    s_bitcmp1_b32 s35, 4
    s_cbranch_scc1 L_ffl_104
    v_cvt_f32_u32_sdwa v28, v76 dst_sel:DWORD dst_unused:UNUSED_PAD src0_sel:WORD_0
    v_cvt_f32_u32_sdwa v29, v76 dst_sel:DWORD dst_unused:UNUSED_PAD src0_sel:WORD_1
    v_cvt_f32_u32_sdwa v30, v77 dst_sel:DWORD dst_unused:UNUSED_PAD src0_sel:WORD_0
    v_cvt_f32_u32_sdwa v31, v77 dst_sel:DWORD dst_unused:UNUSED_PAD src0_sel:WORD_1
    v_cvt_f32_u32_sdwa v32, v78 dst_sel:DWORD dst_unused:UNUSED_PAD src0_sel:WORD_0
    v_cvt_f32_u32_sdwa v33, v78 dst_sel:DWORD dst_unused:UNUSED_PAD src0_sel:WORD_1
    v_cvt_f32_u32_sdwa v34, v79 dst_sel:DWORD dst_unused:UNUSED_PAD src0_sel:WORD_0
    v_cvt_f32_u32_sdwa v35, v79 dst_sel:DWORD dst_unused:UNUSED_PAD src0_sel:WORD_1
    v_cvt_f32_u32_sdwa v36, v92 dst_sel:DWORD dst_unused:UNUSED_PAD src0_sel:WORD_0
    v_cvt_f32_u32_sdwa v37, v92 dst_sel:DWORD dst_unused:UNUSED_PAD src0_sel:WORD_1
    v_cvt_f32_u32_sdwa v38, v93 dst_sel:DWORD dst_unused:UNUSED_PAD src0_sel:WORD_0
    v_cvt_f32_u32_sdwa v39, v93 dst_sel:DWORD dst_unused:UNUSED_PAD src0_sel:WORD_1
    v_cvt_f32_u32_sdwa v40, v94 dst_sel:DWORD dst_unused:UNUSED_PAD src0_sel:WORD_0
    v_cvt_f32_u32_sdwa v41, v94 dst_sel:DWORD dst_unused:UNUSED_PAD src0_sel:WORD_1
    v_cvt_f32_u32_sdwa v42, v95 dst_sel:DWORD dst_unused:UNUSED_PAD src0_sel:WORD_0
    v_cvt_f32_u32_sdwa v43, v95 dst_sel:DWORD dst_unused:UNUSED_PAD src0_sel:WORD_1
    v_add_f32 v28, 0xc6800000, v28
    v_fmac_f32 v12, s34, v28
    v_add_f32 v29, 0xc6800000, v29
    v_fmac_f32 v13, s34, v29
    v_add_f32 v30, 0xc6800000, v30
    v_fmac_f32 v14, s34, v30
    v_add_f32 v31, 0xc6800000, v31
    v_fmac_f32 v15, s34, v31
    v_add_f32 v32, 0xc6800000, v32
    v_fmac_f32 v16, s34, v32
    v_add_f32 v33, 0xc6800000, v33
    v_fmac_f32 v17, s34, v33
    v_add_f32 v34, 0xc6800000, v34
    v_fmac_f32 v18, s34, v34
    v_add_f32 v35, 0xc6800000, v35
    v_fmac_f32 v19, s34, v35
    v_add_f32 v36, 0xc6800000, v36
    v_fmac_f32 v20, s34, v36
    v_add_f32 v37, 0xc6800000, v37
    v_fmac_f32 v21, s34, v37
    v_add_f32 v38, 0xc6800000, v38
    v_fmac_f32 v22, s34, v38
    v_add_f32 v39, 0xc6800000, v39
    v_fmac_f32 v23, s34, v39
    v_add_f32 v40, 0xc6800000, v40
    v_fmac_f32 v24, s34, v40
    v_add_f32 v41, 0xc6800000, v41
    v_fmac_f32 v25, s34, v41
    v_add_f32 v42, 0xc6800000, v42
    v_fmac_f32 v26, s34, v42
    v_add_f32 v43, 0xc6800000, v43
    v_fmac_f32 v27, s34, v43
    s_branch L_fnx_105
L_ffl_104:
    s_mov_b32 s3, 25600000
    buffer_load_dwordx4 v[28:31], v6, s[20:23], s3 offen offset:0 sc1
    buffer_load_dwordx4 v[32:35], v6, s[20:23], s3 offen offset:16 sc1
    buffer_load_dwordx4 v[36:39], v7, s[20:23], s3 offen offset:0 sc1
    buffer_load_dwordx4 v[40:43], v7, s[20:23], s3 offen offset:16 sc1
    s_waitcnt vmcnt(0)
    v_add_f32 v12, v12, v28
    v_add_f32 v13, v13, v29
    v_add_f32 v14, v14, v30
    v_add_f32 v15, v15, v31
    v_add_f32 v16, v16, v32
    v_add_f32 v17, v17, v33
    v_add_f32 v18, v18, v34
    v_add_f32 v19, v19, v35
    v_add_f32 v20, v20, v36
    v_add_f32 v21, v21, v37
    v_add_f32 v22, v22, v38
    v_add_f32 v23, v23, v39
    v_add_f32 v24, v24, v40
    v_add_f32 v25, v25, v41
    v_add_f32 v26, v26, v42
    v_add_f32 v27, v27, v43
L_fnx_105:
    s_bitcmp1_b32 s35, 5
    s_cbranch_scc1 L_ffl_106
    v_cvt_f32_u32_sdwa v28, v80 dst_sel:DWORD dst_unused:UNUSED_PAD src0_sel:WORD_0
    v_cvt_f32_u32_sdwa v29, v80 dst_sel:DWORD dst_unused:UNUSED_PAD src0_sel:WORD_1
    v_cvt_f32_u32_sdwa v30, v81 dst_sel:DWORD dst_unused:UNUSED_PAD src0_sel:WORD_0
    v_cvt_f32_u32_sdwa v31, v81 dst_sel:DWORD dst_unused:UNUSED_PAD src0_sel:WORD_1
    v_cvt_f32_u32_sdwa v32, v82 dst_sel:DWORD dst_unused:UNUSED_PAD src0_sel:WORD_0
    v_cvt_f32_u32_sdwa v33, v82 dst_sel:DWORD dst_unused:UNUSED_PAD src0_sel:WORD_1
    v_cvt_f32_u32_sdwa v34, v83 dst_sel:DWORD dst_unused:UNUSED_PAD src0_sel:WORD_0
    v_cvt_f32_u32_sdwa v35, v83 dst_sel:DWORD dst_unused:UNUSED_PAD src0_sel:WORD_1
    v_cvt_f32_u32_sdwa v36, v96 dst_sel:DWORD dst_unused:UNUSED_PAD src0_sel:WORD_0
    v_cvt_f32_u32_sdwa v37, v96 dst_sel:DWORD dst_unused:UNUSED_PAD src0_sel:WORD_1
    v_cvt_f32_u32_sdwa v38, v97 dst_sel:DWORD dst_unused:UNUSED_PAD src0_sel:WORD_0
    v_cvt_f32_u32_sdwa v39, v97 dst_sel:DWORD dst_unused:UNUSED_PAD src0_sel:WORD_1
    v_cvt_f32_u32_sdwa v40, v98 dst_sel:DWORD dst_unused:UNUSED_PAD src0_sel:WORD_0
    v_cvt_f32_u32_sdwa v41, v98 dst_sel:DWORD dst_unused:UNUSED_PAD src0_sel:WORD_1
    v_cvt_f32_u32_sdwa v42, v99 dst_sel:DWORD dst_unused:UNUSED_PAD src0_sel:WORD_0
    v_cvt_f32_u32_sdwa v43, v99 dst_sel:DWORD dst_unused:UNUSED_PAD src0_sel:WORD_1
    v_add_f32 v28, 0xc6800000, v28
    v_fmac_f32 v12, s34, v28
    v_add_f32 v29, 0xc6800000, v29
    v_fmac_f32 v13, s34, v29
    v_add_f32 v30, 0xc6800000, v30
    v_fmac_f32 v14, s34, v30
    v_add_f32 v31, 0xc6800000, v31
    v_fmac_f32 v15, s34, v31
    v_add_f32 v32, 0xc6800000, v32
    v_fmac_f32 v16, s34, v32
    v_add_f32 v33, 0xc6800000, v33
    v_fmac_f32 v17, s34, v33
    v_add_f32 v34, 0xc6800000, v34
    v_fmac_f32 v18, s34, v34
    v_add_f32 v35, 0xc6800000, v35
    v_fmac_f32 v19, s34, v35
    v_add_f32 v36, 0xc6800000, v36
    v_fmac_f32 v20, s34, v36
    v_add_f32 v37, 0xc6800000, v37
    v_fmac_f32 v21, s34, v37
    v_add_f32 v38, 0xc6800000, v38
    v_fmac_f32 v22, s34, v38
    v_add_f32 v39, 0xc6800000, v39
    v_fmac_f32 v23, s34, v39
    v_add_f32 v40, 0xc6800000, v40
    v_fmac_f32 v24, s34, v40
    v_add_f32 v41, 0xc6800000, v41
    v_fmac_f32 v25, s34, v41
    v_add_f32 v42, 0xc6800000, v42
    v_fmac_f32 v26, s34, v42
    v_add_f32 v43, 0xc6800000, v43
    v_fmac_f32 v27, s34, v43
    s_branch L_fnx_107
L_ffl_106:
    s_mov_b32 s3, 38400000
    buffer_load_dwordx4 v[28:31], v6, s[20:23], s3 offen offset:0 sc1
    buffer_load_dwordx4 v[32:35], v6, s[20:23], s3 offen offset:16 sc1
    buffer_load_dwordx4 v[36:39], v7, s[20:23], s3 offen offset:0 sc1
    buffer_load_dwordx4 v[40:43], v7, s[20:23], s3 offen offset:16 sc1
    s_waitcnt vmcnt(0)
    v_add_f32 v12, v12, v28
    v_add_f32 v13, v13, v29
    v_add_f32 v14, v14, v30
    v_add_f32 v15, v15, v31
    v_add_f32 v16, v16, v32
    v_add_f32 v17, v17, v33
    v_add_f32 v18, v18, v34
    v_add_f32 v19, v19, v35
    v_add_f32 v20, v20, v36
    v_add_f32 v21, v21, v37
    v_add_f32 v22, v22, v38
    v_add_f32 v23, v23, v39
    v_add_f32 v24, v24, v40
    v_add_f32 v25, v25, v41
    v_add_f32 v26, v26, v42
    v_add_f32 v27, v27, v43
L_fnx_107:
    s_bitcmp1_b32 s35, 6
    s_cbranch_scc1 L_ffl_108
    v_cvt_f32_u32_sdwa v28, v84 dst_sel:DWORD dst_unused:UNUSED_PAD src0_sel:WORD_0
    v_cvt_f32_u32_sdwa v29, v84 dst_sel:DWORD dst_unused:UNUSED_PAD src0_sel:WORD_1
    v_cvt_f32_u32_sdwa v30, v85 dst_sel:DWORD dst_unused:UNUSED_PAD src0_sel:WORD_0
    v_cvt_f32_u32_sdwa v31, v85 dst_sel:DWORD dst_unused:UNUSED_PAD src0_sel:WORD_1
    v_cvt_f32_u32_sdwa v32, v86 dst_sel:DWORD dst_unused:UNUSED_PAD src0_sel:WORD_0
    v_cvt_f32_u32_sdwa v33, v86 dst_sel:DWORD dst_unused:UNUSED_PAD src0_sel:WORD_1
    v_cvt_f32_u32_sdwa v34, v87 dst_sel:DWORD dst_unused:UNUSED_PAD src0_sel:WORD_0
    v_cvt_f32_u32_sdwa v35, v87 dst_sel:DWORD dst_unused:UNUSED_PAD src0_sel:WORD_1
    v_cvt_f32_u32_sdwa v36, v100 dst_sel:DWORD dst_unused:UNUSED_PAD src0_sel:WORD_0
    v_cvt_f32_u32_sdwa v37, v100 dst_sel:DWORD dst_unused:UNUSED_PAD src0_sel:WORD_1
    v_cvt_f32_u32_sdwa v38, v101 dst_sel:DWORD dst_unused:UNUSED_PAD src0_sel:WORD_0
    v_cvt_f32_u32_sdwa v39, v101 dst_sel:DWORD dst_unused:UNUSED_PAD src0_sel:WORD_1
    v_cvt_f32_u32_sdwa v40, v102 dst_sel:DWORD dst_unused:UNUSED_PAD src0_sel:WORD_0
    v_cvt_f32_u32_sdwa v41, v102 dst_sel:DWORD dst_unused:UNUSED_PAD src0_sel:WORD_1
    v_cvt_f32_u32_sdwa v42, v103 dst_sel:DWORD dst_unused:UNUSED_PAD src0_sel:WORD_0
    v_cvt_f32_u32_sdwa v43, v103 dst_sel:DWORD dst_unused:UNUSED_PAD src0_sel:WORD_1
    v_add_f32 v28, 0xc6800000, v28
    v_fmac_f32 v12, s34, v28
    v_add_f32 v29, 0xc6800000, v29
    v_fmac_f32 v13, s34, v29
    v_add_f32 v30, 0xc6800000, v30
    v_fmac_f32 v14, s34, v30
    v_add_f32 v31, 0xc6800000, v31
    v_fmac_f32 v15, s34, v31
    v_add_f32 v32, 0xc6800000, v32
    v_fmac_f32 v16, s34, v32
    v_add_f32 v33, 0xc6800000, v33
    v_fmac_f32 v17, s34, v33
    v_add_f32 v34, 0xc6800000, v34
    v_fmac_f32 v18, s34, v34
    v_add_f32 v35, 0xc6800000, v35
    v_fmac_f32 v19, s34, v35
    v_add_f32 v36, 0xc6800000, v36
    v_fmac_f32 v20, s34, v36
    v_add_f32 v37, 0xc6800000, v37
    v_fmac_f32 v21, s34, v37
    v_add_f32 v38, 0xc6800000, v38
    v_fmac_f32 v22, s34, v38
    v_add_f32 v39, 0xc6800000, v39
    v_fmac_f32 v23, s34, v39
    v_add_f32 v40, 0xc6800000, v40
    v_fmac_f32 v24, s34, v40
    v_add_f32 v41, 0xc6800000, v41
    v_fmac_f32 v25, s34, v41
    v_add_f32 v42, 0xc6800000, v42
    v_fmac_f32 v26, s34, v42
    v_add_f32 v43, 0xc6800000, v43
    v_fmac_f32 v27, s34, v43
    s_branch L_fnx_109
L_ffl_108:
    s_mov_b32 s3, 51200000
    buffer_load_dwordx4 v[28:31], v6, s[20:23], s3 offen offset:0 sc1
    buffer_load_dwordx4 v[32:35], v6, s[20:23], s3 offen offset:16 sc1
    buffer_load_dwordx4 v[36:39], v7, s[20:23], s3 offen offset:0 sc1
    buffer_load_dwordx4 v[40:43], v7, s[20:23], s3 offen offset:16 sc1
    s_waitcnt vmcnt(0)
    v_add_f32 v12, v12, v28
    v_add_f32 v13, v13, v29
    v_add_f32 v14, v14, v30
    v_add_f32 v15, v15, v31
    v_add_f32 v16, v16, v32
    v_add_f32 v17, v17, v33
    v_add_f32 v18, v18, v34
    v_add_f32 v19, v19, v35
    v_add_f32 v20, v20, v36
    v_add_f32 v21, v21, v37
    v_add_f32 v22, v22, v38
    v_add_f32 v23, v23, v39
    v_add_f32 v24, v24, v40
    v_add_f32 v25, v25, v41
    v_add_f32 v26, v26, v42
    v_add_f32 v27, v27, v43
L_fnx_109:
    s_bitcmp1_b32 s35, 7
    s_cbranch_scc1 L_ffl_110
    v_cvt_f32_u32_sdwa v28, v88 dst_sel:DWORD dst_unused:UNUSED_PAD src0_sel:WORD_0
    v_cvt_f32_u32_sdwa v29, v88 dst_sel:DWORD dst_unused:UNUSED_PAD src0_sel:WORD_1
    v_cvt_f32_u32_sdwa v30, v89 dst_sel:DWORD dst_unused:UNUSED_PAD src0_sel:WORD_0
    v_cvt_f32_u32_sdwa v31, v89 dst_sel:DWORD dst_unused:UNUSED_PAD src0_sel:WORD_1
    v_cvt_f32_u32_sdwa v32, v90 dst_sel:DWORD dst_unused:UNUSED_PAD src0_sel:WORD_0
    v_cvt_f32_u32_sdwa v33, v90 dst_sel:DWORD dst_unused:UNUSED_PAD src0_sel:WORD_1
    v_cvt_f32_u32_sdwa v34, v91 dst_sel:DWORD dst_unused:UNUSED_PAD src0_sel:WORD_0
    v_cvt_f32_u32_sdwa v35, v91 dst_sel:DWORD dst_unused:UNUSED_PAD src0_sel:WORD_1
    v_cvt_f32_u32_sdwa v36, v104 dst_sel:DWORD dst_unused:UNUSED_PAD src0_sel:WORD_0
    v_cvt_f32_u32_sdwa v37, v104 dst_sel:DWORD dst_unused:UNUSED_PAD src0_sel:WORD_1
    v_cvt_f32_u32_sdwa v38, v105 dst_sel:DWORD dst_unused:UNUSED_PAD src0_sel:WORD_0
    v_cvt_f32_u32_sdwa v39, v105 dst_sel:DWORD dst_unused:UNUSED_PAD src0_sel:WORD_1
    v_cvt_f32_u32_sdwa v40, v106 dst_sel:DWORD dst_unused:UNUSED_PAD src0_sel:WORD_0
    v_cvt_f32_u32_sdwa v41, v106 dst_sel:DWORD dst_unused:UNUSED_PAD src0_sel:WORD_1
    v_cvt_f32_u32_sdwa v42, v107 dst_sel:DWORD dst_unused:UNUSED_PAD src0_sel:WORD_0
    v_cvt_f32_u32_sdwa v43, v107 dst_sel:DWORD dst_unused:UNUSED_PAD src0_sel:WORD_1
    v_add_f32 v28, 0xc6800000, v28
    v_fmac_f32 v12, s34, v28
    v_add_f32 v29, 0xc6800000, v29
    v_fmac_f32 v13, s34, v29
    v_add_f32 v30, 0xc6800000, v30
    v_fmac_f32 v14, s34, v30
    v_add_f32 v31, 0xc6800000, v31
    v_fmac_f32 v15, s34, v31
    v_add_f32 v32, 0xc6800000, v32
    v_fmac_f32 v16, s34, v32
    v_add_f32 v33, 0xc6800000, v33
    v_fmac_f32 v17, s34, v33
    v_add_f32 v34, 0xc6800000, v34
    v_fmac_f32 v18, s34, v34
    v_add_f32 v35, 0xc6800000, v35
    v_fmac_f32 v19, s34, v35
    v_add_f32 v36, 0xc6800000, v36
    v_fmac_f32 v20, s34, v36
    v_add_f32 v37, 0xc6800000, v37
    v_fmac_f32 v21, s34, v37
    v_add_f32 v38, 0xc6800000, v38
    v_fmac_f32 v22, s34, v38
    v_add_f32 v39, 0xc6800000, v39
    v_fmac_f32 v23, s34, v39
    v_add_f32 v40, 0xc6800000, v40
    v_fmac_f32 v24, s34, v40
    v_add_f32 v41, 0xc6800000, v41
    v_fmac_f32 v25, s34, v41
    v_add_f32 v42, 0xc6800000, v42
    v_fmac_f32 v26, s34, v42
    v_add_f32 v43, 0xc6800000, v43
    v_fmac_f32 v27, s34, v43
    s_branch L_fnx_111
L_ffl_110:
    s_mov_b32 s3, 64000000
    buffer_load_dwordx4 v[28:31], v6, s[20:23], s3 offen offset:0 sc1
    buffer_load_dwordx4 v[32:35], v6, s[20:23], s3 offen offset:16 sc1
    buffer_load_dwordx4 v[36:39], v7, s[20:23], s3 offen offset:0 sc1
    buffer_load_dwordx4 v[40:43], v7, s[20:23], s3 offen offset:16 sc1
    s_waitcnt vmcnt(0)
    v_add_f32 v12, v12, v28
    v_add_f32 v13, v13, v29
    v_add_f32 v14, v14, v30
    v_add_f32 v15, v15, v31
    v_add_f32 v16, v16, v32
    v_add_f32 v17, v17, v33
    v_add_f32 v18, v18, v34
    v_add_f32 v19, v19, v35
    v_add_f32 v20, v20, v36
    v_add_f32 v21, v21, v37
    v_add_f32 v22, v22, v38
    v_add_f32 v23, v23, v39
    v_add_f32 v24, v24, v40
    v_add_f32 v25, v25, v41
    v_add_f32 v26, v26, v42
    v_add_f32 v27, v27, v43
L_fnx_111:
    s_branch L_fbk_103
L_p2slow_51:
    s_waitcnt vmcnt(0) lgkmcnt(0)
    s_mov_b32 s51, 0
    s_movk_i32 s43, 6250

L_sweep_113:
    s_barrier

    v_mov_b32 v28, 0x0
    v_mov_b32 v29, 0x0
    v_mov_b32 v30, 0x0
    v_mov_b32 v31, 0x0
    v_add_u32 v32, 50000, v3
    v_add_u32 v33, 65536, v32

    ds_write_b128 v32, v[28:31] offset:0
    ds_write_b128 v32, v[28:31] offset:16384
    ds_write_b128 v32, v[28:31] offset:32768
    ds_write_b128 v32, v[28:31] offset:49152
    ds_write_b128 v33, v[28:31] offset:0
    ds_write_b128 v33, v[28:31] offset:16384
    v_cmp_gt_u32 vcc, 971, v0
    s_mov_b64 exec, vcc
    ds_write_b128 v33, v[28:31] offset:32768
    s_mov_b64 exec, -1
    s_waitcnt lgkmcnt(0)
    s_barrier
    s_sub_u32 s38, s4, 8
L_sbatch_114:
    s_lshl_b32 s52, s38, 6
    s_add_u32 s52, s52, s36
    s_lshl_b32 s52, s52, 2
    s_load_dword s40, s[46:47], s52
    s_mul_i32 s50, s38, 200000
    s_waitcnt lgkmcnt(0)

    s_min_u32 s40, s40, 3968
    s_lshl_b32 s52, s38, 6
    s_add_u32 s52, s52, s36
    s_mul_i32 s52, s52, 19840
    s_add_u32 s20, s44, s52
    s_addc_u32 s21, s45, 0
    s_mul_i32 s52, s40, 5
    s_add_u32 s52, s52, 3
    s_and_b32 s22, s52, -4

    s_lshr_b32 s55, s39, 2
    s_add_u32 s55, s55, 0
    v_and_b32 v36, 63, v0
    v_add_u32 v36, s55, v36
L_left_118:
    s_cmp_ge_u32 s55, s40
    s_cbranch_scc1 L_leftend_119
    v_mul_u32_u24 v37, 5, v36
    buffer_load_dword v38, v37, s[20:23], 0 offen
    buffer_load_ubyte v39, v37, s[20:23], 0 offen offset:4
    s_waitcnt vmcnt(0)

    v_perm_b32 v37, v39, v38, s24
    v_lshrrev_b32 v42, 30, v38
    v_and_b32 v37, 0x1fff, v37
    v_mul_u32_u24 v42, 6250, v42
    v_add_lshl_u32 v37, v37, v42, 3

    buffer_load_dwordx2 v[40:41], v37, s[8:11], s50 offen
    v_cmp_gt_u32 vcc, s40, v36
    s_waitcnt vmcnt(0)

    v_bfe_u32 v44, v38, 16, 14
    v_subrev_u32 v44, s51, v44
    v_cmp_gt_u32 s[64:65], s43, v44
    s_and_b64 exec, vcc, s[64:65]
    v_lshlrev_b32 v45, 8, v38
    v_cmpx_ne_u32 vcc, 0, v45
    v_lshlrev_b32 v44, 4, v44
    v_bfe_i32 v38, v38, 0, 16
    v_cvt_f32_i32 v38, v38
    v_mul_f32 v38, 0x38004020, v38
    v_lshlrev_b32 v45, 16, v40
    v_and_b32 v46, s32, v40
    v_lshlrev_b32 v47, 16, v41
    v_and_b32 v48, s32, v41

    v_mul_f32 v45, v45, v38
    ds_add_f32 v44, v45 offset:50000
    v_mul_f32 v46, v46, v38
    ds_add_f32 v44, v46 offset:50004
    v_mul_f32 v47, v47, v38
    ds_add_f32 v44, v47 offset:50008
    v_mul_f32 v48, v48, v38
    ds_add_f32 v44, v48 offset:50012
    s_mov_b64 exec, -1
    v_add_u32 v36, 128, v36
    s_add_u32 s55, s55, 128
    s_branch L_left_118
L_leftend_119:

    s_add_u32 s38, s38, 1
    s_cmp_lt_u32 s38, s4
    s_cbranch_scc1 L_sbatch_114
    s_mov_b32 s3, 65536
    s_load_dword s40, s[6:7], s3

    s_add_u32 s20, s6, 408657920
    s_addc_u32 s21, s7, 0
    s_mov_b32 s22, 409600000
    s_mov_b32 s23, 0x20000
    s_mov_b32 s38, 0
    s_mov_b32 s50, 200000
    v_mov_b32 v36, v0
    s_waitcnt lgkmcnt(0)
L_ovf_115:
    s_cmp_ge_u32 s38, s40
    s_cbranch_scc1 L_ovfend_116
    v_lshlrev_b32 v37, 3, v36
    buffer_load_dwordx2 v[38:39], v37, s[20:23], 0 offen
    s_waitcnt vmcnt(0)

    v_perm_b32 v37, v39, v38, s24
    v_lshrrev_b32 v42, 30, v38
    v_and_b32 v37, 0x1fff, v37
    v_mul_u32_u24 v42, 6250, v42
    v_add_lshl_u32 v37, v37, v42, 3

    v_bfe_u32 v42, v39, 24, 5
    v_mad_u32_u24 v37, v42, s50, v37
    buffer_load_dwordx2 v[40:41], v37, s[8:11], 0 offen
    v_lshrrev_b32 v42, 3, v42
    v_bfe_u32 v43, v39, 18, 6
    v_cmp_gt_u32 vcc, s40, v36
    v_cmp_eq_u32 s[64:65], s36, v43
    s_and_b64 vcc, vcc, s[64:65]
    v_cmp_eq_u32 s[64:65], s37, v42
    s_and_b64 vcc, vcc, s[64:65]
    s_waitcnt vmcnt(0)

    v_bfe_u32 v44, v38, 16, 14
    v_subrev_u32 v44, s51, v44
    v_cmp_gt_u32 s[64:65], s43, v44
    s_and_b64 exec, vcc, s[64:65]
    v_lshlrev_b32 v45, 8, v38
    v_cmpx_ne_u32 vcc, 0, v45
    v_lshlrev_b32 v44, 4, v44
    v_bfe_i32 v38, v38, 0, 16
    v_cvt_f32_i32 v38, v38
    v_mul_f32 v38, 0x38004020, v38
    v_lshlrev_b32 v45, 16, v40
    v_and_b32 v46, s32, v40
    v_lshlrev_b32 v47, 16, v41
    v_and_b32 v48, s32, v41

    v_mul_f32 v45, v45, v38
    ds_add_f32 v44, v45 offset:50000
    v_mul_f32 v46, v46, v38
    ds_add_f32 v44, v46 offset:50004
    v_mul_f32 v47, v47, v38
    ds_add_f32 v44, v47 offset:50008
    v_mul_f32 v48, v48, v38
    ds_add_f32 v44, v48 offset:50012
    s_mov_b64 exec, -1
    v_add_u32 v36, 1024, v36
    s_add_u32 s38, s38, 1024
    s_branch L_ovf_115
L_ovfend_116:
    s_waitcnt lgkmcnt(0)
    s_barrier
    s_mul_i32 s3, s37, 800000
    s_mul_i32 s5, s36, 12500
    s_add_u32 s3, s3, s5
    s_add_u32 s3, s3, s51
    s_lshl_b32 s3, s3, 4
    s_add_u32 s3, s3, 32399360

    s_add_u32 s20, s6, s3
    s_addc_u32 s21, s7, 0
    s_mov_b32 s22, 100000
    s_mov_b32 s23, 0x20000
    v_mov_b32 v36, v3
    s_mov_b32 s38, 0
L_wl_117:
    v_min_u32 v37, 100000, v36
    ds_read_b128 v[28:31], v37 offset:50000
    s_waitcnt lgkmcnt(0)
    buffer_store_dwordx4 v[28:31], v36, s[20:23], 0 offen sc1
    s_waitcnt vmcnt(0)
    v_add_u32 v36, 16384, v36
    s_add_u32 s38, s38, 1024
    s_cmp_lt_u32 s38, 6250
    s_cbranch_scc1 L_wl_117
    s_add_u32 s51, s51, 6250
    s_cmp_lt_u32 s51, 12500
    s_cbranch_scc1 L_sweep_113
    s_lshl_b32 s33, 16, s37
    s_add_u32 s33, s33, 1
    s_branch L_fin_86

.section .rodata,"a"
.p2align 6
.amdhsa_kernel g1_kernel
  .amdhsa_next_free_vgpr 128
  .amdhsa_next_free_sgpr 102
  .amdhsa_accum_offset 128
  .amdhsa_group_segment_fixed_size 0
  .amdhsa_kernarg_size 112
  .amdhsa_user_sgpr_count 2
  .amdhsa_user_sgpr_kernarg_segment_ptr 1
  .amdhsa_system_sgpr_workgroup_id_x 1
.end_amdhsa_kernel
.p2align 6
.amdhsa_kernel standalone__molecular_angular_gemnet__graph_kernel
  .amdhsa_next_free_vgpr 128
  .amdhsa_next_free_sgpr 102
  .amdhsa_accum_offset 128
  .amdhsa_group_segment_fixed_size 0
  .amdhsa_kernarg_size 112
  .amdhsa_user_sgpr_count 2
  .amdhsa_user_sgpr_kernarg_segment_ptr 1
  .amdhsa_system_sgpr_workgroup_id_x 1
  .amdhsa_float_denorm_mode_32 3
.end_amdhsa_kernel
```

```asm
; @launch kernel=g1_kernel grid=(256,1,1) block=(1024,1,1) lds=163840
; @launch kernel=standalone__molecular_angular_gemnet__graph_kernel grid=(256,1,1) block=(1024,1,1) lds=163840
.amdgcn_target "amdgcn-amd-amdhsa--gfx950"
.text
.globl g1_kernel
.p2align 8
.type g1_kernel,@function
g1_kernel:
    s_cmp_ge_u32 s2, 256
    s_cbranch_scc1 L_p1done_1
    s_load_dwordx4 s[80:83], s[0:1], 8
    s_load_dwordx2 s[84:85], s[0:1], 32
    s_load_dwordx2 s[86:87], s[0:1], 48
    s_load_dwordx4 s[4:7], s[0:1], 96
    s_load_dwordx2 s[78:79], s[0:1], 0
    v_lshlrev_b32 v1, 4, v0
    v_lshlrev_b32 v2, 3, v0
    v_lshlrev_b32 v98, 20, v0
    s_waitcnt lgkmcnt(0)
    s_load_dword s88, s[86:87], 0

    s_mov_b32 s96, s4
    s_mov_b32 s97, s5
    s_mov_b32 s98, 256
    s_mov_b32 s99, 0x20000
    v_readfirstlane_b32 s74, v0
    s_nop 1
    s_or_b32 s74, s74, s2
    s_cbranch_scc1 L_noinit_2

    v_mov_b32 v110, 1
    buffer_atomic_add v110, v98, s[96:99], 0 offen offset:64 sc0
    s_waitcnt vmcnt(0)
    v_readfirstlane_b32 s74, v110
    s_nop 1
    s_cmp_lg_u32 s74, 0
    s_cbranch_scc1 L_zno_4

    s_mov_b32 s92, s6
    s_mov_b32 s93, s7
    s_mov_b32 s94, 65552
    s_mov_b32 s95, 0x20000
    v_mov_b32 v110, 0
    v_mov_b32 v111, 0
    v_mov_b32 v112, 0
    v_mov_b32 v113, 0
L_zl_3:
    buffer_store_dwordx4 v[110:113], v1, s[92:95], s74 offen sc0 sc1
    s_add_u32 s74, s74, 1024
    s_cmp_le_u32 s74, 65536
    s_cbranch_scc1 L_zl_3
    v_mov_b32 v114, 1
    s_waitcnt vmcnt(0)
    buffer_atomic_add v114, v98, s[96:99], 0 offen offset:128
L_zno_4:

L_noinit_2:
    s_mov_b32 s20, s78
    s_mov_b32 s21, s79
    s_mov_b32 s22, 6400000
    s_mov_b32 s23, 0x20000
    v_mul_u32_u24 v110, 6240, v0
    v_and_b32 v111, 63, v0
    v_and_b32 v112, 0x3c0, v0
    v_lshlrev_b32 v111, 2, v111
    v_lshl_or_b32 v111, v112, 4, v111
    v_lshlrev_b32 v100, 2, v0
    s_lshr_b32 s50, s2, 1
    s_and_b32 s53, s2, 1
    s_mul_i32 s3, s50, 50000
    s_mul_i32 s54, s53, 24576
    s_add_u32 s3, s3, s54

    buffer_load_dwordx4 v[56:59], v110, s[20:23], 0 offen
    s_add_u32 s20, s78, s3
    s_addc_u32 s21, s79, 0
    s_mov_b32 s22, 24576
    s_mov_b32 s23, 0x20000
    s_movk_i32 s3, 16384
    buffer_load_dword v44, v111, s[20:23], 0 offen offset:0
    buffer_load_dword v45, v111, s[20:23], 0 offen offset:256
    buffer_load_dword v46, v111, s[20:23], 0 offen offset:512
    buffer_load_dword v47, v111, s[20:23], 0 offen offset:768
    buffer_load_dword v48, v111, s[20:23], s3 offen offset:0
    buffer_load_dword v49, v111, s[20:23], s3 offen offset:256
    buffer_load_dword v50, v111, s[20:23], s3 offen offset:512
    buffer_load_dword v51, v111, s[20:23], s3 offen offset:768
    s_mul_i32 s22, s53, 25424
    s_movk_i32 s3, 24576

    buffer_load_dword v52, v100, s[20:23], s3 offen
    s_mul_i32 s3, s50, 50048
    s_add_u32 s3, s3, s54
    s_add_u32 s54, s3, 393216

    s_mov_b32 s8, s80
    s_mov_b32 s9, s81
    s_mov_b32 s10, 0
    s_mov_b32 s11, 0x20000
    s_mov_b32 s12, s82
    s_mov_b32 s13, s83
    s_mov_b32 s14, 0
    s_mov_b32 s15, 0x20000
    s_mov_b32 s16, s84
    s_mov_b32 s17, s85
    s_mov_b32 s18, 0
    s_mov_b32 s19, 0x20000
    s_lshr_b32 s74, s2, 1
    s_and_b32 s74, s74, 28
    s_lshr_b32 s86, 0x00102010, s74
    s_lshr_b32 s87, 0x44414241, s74
    s_lshr_b32 s41, 0x43221100, s74
    s_and_b32 s86, s86, 15
    s_and_b32 s87, s87, 15
    s_and_b32 s41, s41, 15
    s_lshr_b32 s74, s2, 6
    s_lshl_b32 s74, s74, 3
    s_and_b32 s75, s2, 7
    s_add_u32 s74, s74, s75
    s_mul_i32 s74, s74, 5
    s_add_u32 s41, s41, s74

    s_mul_i32 s78, s41, 16000
    s_add_u32 s49, s78, 16000
    s_cmp_ge_u32 s41, 3200
    s_cmovk_i32 s49, 0
    s_cmovk_i32 s78, 0
    s_lshl_b32 s10, s49, 2
    s_lshl_b32 s14, s49, 2
    s_lshl_b32 s18, s49, 1
    s_sub_u32 s79, s87, s86
    s_bfm_b32 s85, s79, s86
    s_lshl_b32 s86, s86, 12
    s_lshl_b32 s87, s87, 12
    s_min_u32 s87, s87, 16000

    s_add_u32 s79, s78, 0
    s_bitcmp1_b32 s85, 0
    s_cselect_b32 s79, s79, 0x1ff00000
    s_lshl_b32 s56, s79, 2
    s_lshl_b32 s61, s79, 1

    s_add_u32 s79, s78, 4096
    s_bitcmp1_b32 s85, 1
    s_cselect_b32 s79, s79, 0x1ff00000
    s_lshl_b32 s57, s79, 2
    s_lshl_b32 s62, s79, 1

    s_add_u32 s79, s78, 8192
    s_bitcmp1_b32 s85, 2
    s_cselect_b32 s79, s79, 0x1ff00000
    s_lshl_b32 s58, s79, 2
    s_lshl_b32 s63, s79, 1

    s_add_u32 s79, s78, 12288
    s_bitcmp1_b32 s85, 3
    s_cselect_b32 s79, s79, 0x1ff00000
    s_lshl_b32 s59, s79, 2
    s_lshl_b32 s64, s79, 1

    buffer_load_dwordx4 v[20:23], v1, s[12:15], s56 offen nt
    buffer_load_dwordx4 v[4:7], v1, s[8:11], s56 offen nt
    buffer_load_dwordx2 v[36:37], v2, s[16:19], s61 offen nt
    buffer_load_dwordx4 v[24:27], v1, s[12:15], s57 offen nt
    buffer_load_dwordx4 v[8:11], v1, s[8:11], s57 offen nt
    buffer_load_dwordx2 v[38:39], v2, s[16:19], s62 offen nt
    buffer_load_dwordx4 v[28:31], v1, s[12:15], s58 offen nt
    buffer_load_dwordx4 v[12:15], v1, s[8:11], s58 offen nt
    buffer_load_dwordx2 v[40:41], v2, s[16:19], s63 offen nt
    buffer_load_dwordx4 v[32:35], v1, s[12:15], s59 offen nt
    buffer_load_dwordx4 v[16:19], v1, s[8:11], s59 offen nt
    buffer_load_dwordx2 v[42:43], v2, s[16:19], s64 offen nt
    s_and_b32 s5, s2, 7
    s_mul_i32 s3, s5, 8192

    s_add_u32 s20, s6, s3
    s_addc_u32 s21, s7, 0
    s_mov_b32 s22, 8192
    s_mov_b32 s23, 0x20000
    s_mul_i32 s3, s5, 40632320
    s_add_u32 s3, s3, 83599360
    s_add_u32 s24, s6, s3
    s_addc_u32 s25, s7, 0
    s_mov_b32 s26, 40632320
    s_mov_b32 s27, 0x20000
    s_add_u32 s32, s6, 408657920
    s_addc_u32 s33, s7, 0
    s_mov_b32 s34, 409600000
    s_mov_b32 s35, 0x20000
    s_add_u32 s36, s6, 65536
    s_addc_u32 s37, s7, 0
    s_mov_b32 s38, 4
    s_mov_b32 s39, 0x20000
    s_mov_b32 s40, 687195
    s_mov_b32 s42, -6250
    s_mov_b32 s43, 1942
    s_mov_b32 s45, 0x06050400
    s_mov_b32 s46, 0x05040c00
    s_mov_b32 s47, 0x04020100
    s_mov_b32 s48, 3968
    s_mov_b32 s50, 0
    v_mov_b32 v104, 1
    v_mov_b32 v105, 0x46ff8000
    s_mov_b32 s55, 0x05040100
    v_mul_u32_u24 v106, 5, v0
    v_mov_b32 v108, 16384
    v_mov_b32 v114, 0
    v_mov_b32 v115, 0
    v_mov_b32 v116, 0
    v_mov_b32 v117, -1
    ds_write_b64 v2, v[114:115]
    s_movk_i32 s3, 928
    v_cmp_gt_u32 s[66:67], s3, v0
    s_movk_i32 s3, 640
    v_cmp_gt_u32 s[68:69], s3, v0
    s_mov_b64 exec, 1
    ds_write_b128 v108, v[114:117]
    s_mov_b64 exec, -1
    s_waitcnt lgkmcnt(0)
    s_lshl_b32 s88, s88, 16
    v_mov_b32 v110, 0.15915494
    v_mul_f32 v110, s88, v110
    s_mov_b32 s3, 0x7fff7fff
    v_readfirstlane_b32 s44, v110

    s_waitcnt vmcnt(12)
    v_mov_b32 v61, 0
    v_mov_b32 v62, 0
    v_mov_b32 v63, 0
    v_dot2_f32_bf16 v61, v44, v44, v61
    v_dot2_f32_bf16 v61, v45, v45, v61
    v_dot2_f32_bf16 v61, v46, v46, v61
    v_dot2_f32_bf16 v61, v47, v47, v61
    v_dot2_f32_bf16 v61, v48, v48, v61
    v_dot2_f32_bf16 v61, v49, v49, v61
    v_dot2_f32_bf16 v61, v50, v50, v61
    v_dot2_f32_bf16 v61, v51, v51, v61
    v_dot2_f32_bf16 v61, v52, v52, v61
    v_dot2_f32_bf16 v62, v56, v56, v62
    v_dot2_f32_bf16 v62, v57, v57, v62
    v_dot2_f32_bf16 v62, v58, v58, v62
    v_dot2_f32_bf16 v62, v59, v59, v62
    v_and_b32 v60, s3, v44
    v_and_b32 v64, s3, v45
    v_pk_max_u16 v60, v60, v64
    v_and_b32 v64, s3, v46
    v_pk_max_u16 v60, v60, v64
    v_and_b32 v64, s3, v47
    v_pk_max_u16 v60, v60, v64
    v_and_b32 v64, s3, v48
    v_pk_max_u16 v60, v60, v64
    v_and_b32 v64, s3, v49
    v_pk_max_u16 v60, v60, v64
    v_and_b32 v64, s3, v50
    v_pk_max_u16 v60, v60, v64
    v_and_b32 v64, s3, v51
    v_pk_max_u16 v60, v60, v64
    v_and_b32 v64, s3, v52
    v_pk_max_u16 v60, v60, v64
    v_lshrrev_b32 v64, 16, v60
    v_and_b32 v60, 0xffff, v60
    v_max_u32 v60, v60, v64

    s_nop 1
    v_max_u32_dpp v60, v60, v60 row_shr:1 row_mask:0xf bank_mask:0xf
    s_nop 1
    v_max_u32_dpp v60, v60, v60 row_shr:2 row_mask:0xf bank_mask:0xf
    s_nop 1
    v_max_u32_dpp v60, v60, v60 row_shr:4 row_mask:0xf bank_mask:0xf
    s_nop 1
    v_max_u32_dpp v60, v60, v60 row_shr:8 row_mask:0xf bank_mask:0xf
    s_nop 1
    v_max_u32_dpp v60, v60, v60 row_bcast:15 row_mask:0xa bank_mask:0xf
    s_nop 1
    v_max_u32_dpp v60, v60, v60 row_bcast:31 row_mask:0xc bank_mask:0xf
    s_nop 1
    v_add_f32_dpp v61, v61, v61 row_shr:1 row_mask:0xf bank_mask:0xf
    s_nop 1
    v_add_f32_dpp v61, v61, v61 row_shr:2 row_mask:0xf bank_mask:0xf
    s_nop 1
    v_add_f32_dpp v61, v61, v61 row_shr:4 row_mask:0xf bank_mask:0xf
    s_nop 1
    v_add_f32_dpp v61, v61, v61 row_shr:8 row_mask:0xf bank_mask:0xf
    s_nop 1
    v_add_f32_dpp v61, v61, v61 row_bcast:15 row_mask:0xa bank_mask:0xf
    s_nop 1
    v_add_f32_dpp v61, v61, v61 row_bcast:31 row_mask:0xc bank_mask:0xf
    s_nop 1
    v_add_f32_dpp v62, v62, v62 row_shr:1 row_mask:0xf bank_mask:0xf
    s_nop 1
    v_add_f32_dpp v62, v62, v62 row_shr:2 row_mask:0xf bank_mask:0xf
    s_nop 1
    v_add_f32_dpp v62, v62, v62 row_shr:4 row_mask:0xf bank_mask:0xf
    s_nop 1
    v_add_f32_dpp v62, v62, v62 row_shr:8 row_mask:0xf bank_mask:0xf
    s_nop 1
    v_add_f32_dpp v62, v62, v62 row_bcast:15 row_mask:0xa bank_mask:0xf
    s_nop 1
    v_add_f32_dpp v62, v62, v62 row_bcast:31 row_mask:0xc bank_mask:0xf
    v_lshrrev_b32 v64, 6, v0
    v_lshlrev_b32 v64, 4, v64
    s_mov_b32 exec_lo, 0
    s_brev_b32 exec_hi, 1
    ds_write_b128 v64, v[60:63] offset:8192
    s_mov_b64 exec, -1
    v_and_b32 v64, 15, v0
    v_lshlrev_b32 v64, 4, v64
    s_waitcnt lgkmcnt(0)
    s_barrier
    ds_read_b128 v[60:63], v64 offset:8192
    s_waitcnt lgkmcnt(0)

    s_nop 0
    v_max_u32_dpp v60, v60, v60 row_ror:1 row_mask:0xf bank_mask:0xf
    v_add_f32_dpp v61, v61, v61 row_ror:1 row_mask:0xf bank_mask:0xf
    v_add_f32_dpp v62, v62, v62 row_ror:1 row_mask:0xf bank_mask:0xf

    s_nop 0
    v_max_u32_dpp v60, v60, v60 row_ror:2 row_mask:0xf bank_mask:0xf
    v_add_f32_dpp v61, v61, v61 row_ror:2 row_mask:0xf bank_mask:0xf
    v_add_f32_dpp v62, v62, v62 row_ror:2 row_mask:0xf bank_mask:0xf

    s_nop 0
    v_max_u32_dpp v60, v60, v60 row_ror:4 row_mask:0xf bank_mask:0xf
    v_add_f32_dpp v61, v61, v61 row_ror:4 row_mask:0xf bank_mask:0xf
    v_add_f32_dpp v62, v62, v62 row_ror:4 row_mask:0xf bank_mask:0xf

    s_nop 0
    v_max_u32_dpp v60, v60, v60 row_ror:8 row_mask:0xf bank_mask:0xf
    v_add_f32_dpp v61, v61, v61 row_ror:8 row_mask:0xf bank_mask:0xf
    v_add_f32_dpp v62, v62, v62 row_ror:8 row_mask:0xf bank_mask:0xf

    v_rsq_f32 v62, v62
    v_mov_b32 v65, 0x4b400000
    v_mul_f32 v62, 0x47decb04, v62
    s_nop 0
    v_readfirstlane_b32 s74, v62

    s_add_u32 s92, s6, 135168
    s_addc_u32 s93, s7, 0
    s_mov_b32 s94, 4096
    s_mov_b32 s95, 0x20000
    s_lshl_b32 s3, s2, 4
    buffer_store_dwordx4 v[60:63], v98, s[92:95], s3 offen
    v_lshlrev_b32 v66, 16, v44
    v_and_b32 v44, 0xffff0000, v44
    v_fma_f32 v66, v66, s74, v65
    v_fma_f32 v44, v44, s74, v65
    v_perm_b32 v44, v44, v66, s55

    v_lshlrev_b32 v66, 16, v45
    v_and_b32 v45, 0xffff0000, v45
    v_fma_f32 v66, v66, s74, v65
    v_fma_f32 v45, v45, s74, v65
    v_perm_b32 v45, v45, v66, s55

    v_lshlrev_b32 v66, 16, v46
    v_and_b32 v46, 0xffff0000, v46
    v_fma_f32 v66, v66, s74, v65
    v_fma_f32 v46, v46, s74, v65
    v_perm_b32 v46, v46, v66, s55

    v_lshlrev_b32 v66, 16, v47
    v_and_b32 v47, 0xffff0000, v47
    v_fma_f32 v66, v66, s74, v65
    v_fma_f32 v47, v47, s74, v65
    v_perm_b32 v47, v47, v66, s55

    v_lshlrev_b32 v66, 16, v48
    v_and_b32 v48, 0xffff0000, v48
    v_fma_f32 v66, v66, s74, v65
    v_fma_f32 v48, v48, s74, v65
    v_perm_b32 v48, v48, v66, s55

    v_lshlrev_b32 v66, 16, v49
    v_and_b32 v49, 0xffff0000, v49
    v_fma_f32 v66, v66, s74, v65
    v_fma_f32 v49, v49, s74, v65
    v_perm_b32 v49, v49, v66, s55

    v_lshlrev_b32 v66, 16, v50
    v_and_b32 v50, 0xffff0000, v50
    v_fma_f32 v66, v66, s74, v65
    v_fma_f32 v50, v50, s74, v65
    v_perm_b32 v50, v50, v66, s55

    v_lshlrev_b32 v66, 16, v51
    v_and_b32 v51, 0xffff0000, v51
    v_fma_f32 v66, v66, s74, v65
    v_fma_f32 v51, v51, s74, v65
    v_perm_b32 v51, v51, v66, s55

    v_lshlrev_b32 v66, 16, v52
    v_and_b32 v52, 0xffff0000, v52
    v_fma_f32 v66, v66, s74, v65
    v_fma_f32 v52, v52, s74, v65
    v_perm_b32 v52, v52, v66, s55

    s_add_u32 s92, s6, s54
    s_addc_u32 s93, s7, 0
    s_mov_b32 s94, 24576
    s_mov_b32 s95, 0x20000
    s_movk_i32 s3, 16384
    buffer_store_dwordx4 v[44:47], v1, s[92:95], 0 offen
    buffer_store_dwordx4 v[48:51], v1, s[92:95], s3 offen
    s_mul_i32 s94, s53, 25424
    s_movk_i32 s3, 24576

    buffer_store_dword v52, v100, s[92:95], s3 offen
    s_nop 1
    s_mov_b32 s82, s85
    s_mov_b32 s83, s86
    s_mov_b32 s84, s87
    v_mov_b32 v99, 1
    buffer_atomic_add v99, v98, s[96:99], 0 offen sc0
    v_mov_b32 v100, 0
    buffer_atomic_add v100, v98, s[96:99], 0 offen offset:128 sc0
    s_waitcnt vmcnt(15)
    s_bitcmp0_b32 s82, 0
    s_cbranch_scc1 L_ska_7
    v_mul_hi_u32_u24 v45, s40, v20
    v_mul_hi_u32_u24 v44, s40, v4
    v_mul_hi_u32_u24 v47, s40, v21
    v_mul_hi_u32_u24 v46, s40, v5
    v_mul_hi_u32_u24 v49, s40, v22
    v_mul_hi_u32_u24 v48, s40, v6
    v_mul_hi_u32_u24 v51, s40, v23
    v_mul_hi_u32_u24 v50, s40, v7
    v_and_b32 v45, -2, v45
    v_mad_u32_u24 v4, v44, s43, v4
    v_and_b32 v76, -4, v44
    v_and_b32 v47, -2, v47
    v_mad_u32_u24 v5, v46, s43, v5
    v_and_b32 v77, -4, v46
    v_and_b32 v49, -2, v49
    v_mad_u32_u24 v6, v48, s43, v6
    v_and_b32 v78, -4, v48
    v_and_b32 v51, -2, v51
    v_mad_u32_u24 v7, v50, s43, v7
    v_and_b32 v79, -4, v50
    v_mad_i32_i24 v20, v45, s42, v20
    v_lshl_add_u32 v45, v76, 5, v45
    v_mad_i32_i24 v21, v47, s42, v21
    v_lshl_add_u32 v47, v77, 5, v47
    v_mad_i32_i24 v22, v49, s42, v22
    v_lshl_add_u32 v49, v78, 5, v49
    v_mad_i32_i24 v23, v51, s42, v23
    v_lshl_add_u32 v51, v79, 5, v51
    v_add_u32 v45, v45, v45
    ds_add_rtn_u32 v76, v45, v104
    v_add_u32 v47, v47, v47
    ds_add_rtn_u32 v77, v47, v104
    v_add_u32 v49, v49, v49
    ds_add_rtn_u32 v78, v49, v104
    v_add_u32 v51, v51, v51
    ds_add_rtn_u32 v79, v51, v104
    v_lshlrev_b32 v110, 16, v36
    v_and_b32 v111, 0xffff0000, v36
    v_lshlrev_b32 v112, 16, v37
    v_and_b32 v113, 0xffff0000, v37
    v_mul_f32 v110, s44, v110
    v_mul_f32 v111, s44, v111
    v_mul_f32 v112, s44, v112
    v_mul_f32 v113, s44, v113
    v_fract_f32 v110, v110
    v_fract_f32 v111, v111
    v_fract_f32 v112, v112
    v_fract_f32 v113, v113
    v_cos_f32 v110, v110
    v_cos_f32 v111, v111
    v_cos_f32 v112, v112
    v_cos_f32 v113, v113
    v_lshl_or_b32 v44, v44, 14, v20
    v_perm_b32 v45, v45, v4, s46
    v_bfe_u32 v4, v4, 8, 5

    v_lshl_or_b32 v46, v46, 14, v21
    v_perm_b32 v47, v47, v5, s46
    v_bfe_u32 v5, v5, 8, 5

    v_lshl_or_b32 v48, v48, 14, v22
    v_perm_b32 v49, v49, v6, s46
    v_bfe_u32 v6, v6, 8, 5

    v_lshl_or_b32 v50, v50, 14, v23
    v_perm_b32 v51, v51, v7, s46
    v_bfe_u32 v7, v7, 8, 5

    v_fmaak_f32 v110, v110, v105, 0x4b400010
    v_fmaak_f32 v111, v111, v105, 0x4b400010
    v_fmaak_f32 v112, v112, v105, 0x4b400010
    v_fmaak_f32 v113, v113, v105, 0x4b400010
    v_sub_u32 v110, v110, v4
    v_sub_u32 v111, v111, v5
    v_sub_u32 v112, v112, v6
    v_sub_u32 v113, v113, v7
    v_bfi_b32 v110, 31, v4, v110
    v_bfi_b32 v111, 31, v5, v111
    v_bfi_b32 v112, 31, v6, v112
    v_bfi_b32 v113, 31, v7, v113
    v_perm_b32 v44, v44, v110, s55
    v_perm_b32 v46, v46, v111, s55
    v_perm_b32 v48, v48, v112, s55
    v_perm_b32 v50, v50, v113, s55
L_ska_7:
    s_waitcnt vmcnt(12)
    s_bitcmp0_b32 s82, 1
    s_cbranch_scc1 L_ska_8
    v_mul_hi_u32_u24 v53, s40, v24
    v_mul_hi_u32_u24 v52, s40, v8
    v_mul_hi_u32_u24 v55, s40, v25
    v_mul_hi_u32_u24 v54, s40, v9
    v_mul_hi_u32_u24 v57, s40, v26
    v_mul_hi_u32_u24 v56, s40, v10
    v_mul_hi_u32_u24 v59, s40, v27
    v_mul_hi_u32_u24 v58, s40, v11
    v_and_b32 v53, -2, v53
    v_mad_u32_u24 v8, v52, s43, v8
    v_and_b32 v80, -4, v52
    v_and_b32 v55, -2, v55
    v_mad_u32_u24 v9, v54, s43, v9
    v_and_b32 v81, -4, v54
    v_and_b32 v57, -2, v57
    v_mad_u32_u24 v10, v56, s43, v10
    v_and_b32 v82, -4, v56
    v_and_b32 v59, -2, v59
    v_mad_u32_u24 v11, v58, s43, v11
    v_and_b32 v83, -4, v58
    v_mad_i32_i24 v24, v53, s42, v24
    v_lshl_add_u32 v53, v80, 5, v53
    v_mad_i32_i24 v25, v55, s42, v25
    v_lshl_add_u32 v55, v81, 5, v55
    v_mad_i32_i24 v26, v57, s42, v26
    v_lshl_add_u32 v57, v82, 5, v57
    v_mad_i32_i24 v27, v59, s42, v27
    v_lshl_add_u32 v59, v83, 5, v59
    v_add_u32 v53, v53, v53
    ds_add_rtn_u32 v80, v53, v104
    v_add_u32 v55, v55, v55
    ds_add_rtn_u32 v81, v55, v104
    v_add_u32 v57, v57, v57
    ds_add_rtn_u32 v82, v57, v104
    v_add_u32 v59, v59, v59
    ds_add_rtn_u32 v83, v59, v104
    v_lshlrev_b32 v110, 16, v38
    v_and_b32 v111, 0xffff0000, v38
    v_lshlrev_b32 v112, 16, v39
    v_and_b32 v113, 0xffff0000, v39
    v_mul_f32 v110, s44, v110
    v_mul_f32 v111, s44, v111
    v_mul_f32 v112, s44, v112
    v_mul_f32 v113, s44, v113
    v_fract_f32 v110, v110
    v_fract_f32 v111, v111
    v_fract_f32 v112, v112
    v_fract_f32 v113, v113
    v_cos_f32 v110, v110
    v_cos_f32 v111, v111
    v_cos_f32 v112, v112
    v_cos_f32 v113, v113
    v_lshl_or_b32 v52, v52, 14, v24
    v_perm_b32 v53, v53, v8, s46
    v_bfe_u32 v8, v8, 8, 5

    v_lshl_or_b32 v54, v54, 14, v25
    v_perm_b32 v55, v55, v9, s46
    v_bfe_u32 v9, v9, 8, 5

    v_lshl_or_b32 v56, v56, 14, v26
    v_perm_b32 v57, v57, v10, s46
    v_bfe_u32 v10, v10, 8, 5

    v_lshl_or_b32 v58, v58, 14, v27
    v_perm_b32 v59, v59, v11, s46
    v_bfe_u32 v11, v11, 8, 5

    v_fmaak_f32 v110, v110, v105, 0x4b400010
    v_fmaak_f32 v111, v111, v105, 0x4b400010
    v_fmaak_f32 v112, v112, v105, 0x4b400010
    v_fmaak_f32 v113, v113, v105, 0x4b400010
    v_sub_u32 v110, v110, v8
    v_sub_u32 v111, v111, v9
    v_sub_u32 v112, v112, v10
    v_sub_u32 v113, v113, v11
    v_bfi_b32 v110, 31, v8, v110
    v_bfi_b32 v111, 31, v9, v111
    v_bfi_b32 v112, 31, v10, v112
    v_bfi_b32 v113, 31, v11, v113
    v_perm_b32 v52, v52, v110, s55
    v_perm_b32 v54, v54, v111, s55
    v_perm_b32 v56, v56, v112, s55
    v_perm_b32 v58, v58, v113, s55
L_ska_8:
    s_waitcnt vmcnt(9)
    s_bitcmp0_b32 s82, 2
    s_cbranch_scc1 L_ska_9
    v_mul_hi_u32_u24 v61, s40, v28
    v_mul_hi_u32_u24 v60, s40, v12
    v_mul_hi_u32_u24 v63, s40, v29
    v_mul_hi_u32_u24 v62, s40, v13
    v_mul_hi_u32_u24 v65, s40, v30
    v_mul_hi_u32_u24 v64, s40, v14
    v_mul_hi_u32_u24 v67, s40, v31
    v_mul_hi_u32_u24 v66, s40, v15
    v_and_b32 v61, -2, v61
    v_mad_u32_u24 v12, v60, s43, v12
    v_and_b32 v84, -4, v60
    v_and_b32 v63, -2, v63
    v_mad_u32_u24 v13, v62, s43, v13
    v_and_b32 v85, -4, v62
    v_and_b32 v65, -2, v65
    v_mad_u32_u24 v14, v64, s43, v14
    v_and_b32 v86, -4, v64
    v_and_b32 v67, -2, v67
    v_mad_u32_u24 v15, v66, s43, v15
    v_and_b32 v87, -4, v66
    v_mad_i32_i24 v28, v61, s42, v28
    v_lshl_add_u32 v61, v84, 5, v61
    v_mad_i32_i24 v29, v63, s42, v29
    v_lshl_add_u32 v63, v85, 5, v63
    v_mad_i32_i24 v30, v65, s42, v30
    v_lshl_add_u32 v65, v86, 5, v65
    v_mad_i32_i24 v31, v67, s42, v31
    v_lshl_add_u32 v67, v87, 5, v67
    v_add_u32 v61, v61, v61
    ds_add_rtn_u32 v84, v61, v104
    v_add_u32 v63, v63, v63
    ds_add_rtn_u32 v85, v63, v104
    v_add_u32 v65, v65, v65
    ds_add_rtn_u32 v86, v65, v104
    v_add_u32 v67, v67, v67
    ds_add_rtn_u32 v87, v67, v104
    v_lshlrev_b32 v110, 16, v40
    v_and_b32 v111, 0xffff0000, v40
    v_lshlrev_b32 v112, 16, v41
    v_and_b32 v113, 0xffff0000, v41
    v_mul_f32 v110, s44, v110
    v_mul_f32 v111, s44, v111
    v_mul_f32 v112, s44, v112
    v_mul_f32 v113, s44, v113
    v_fract_f32 v110, v110
    v_fract_f32 v111, v111
    v_fract_f32 v112, v112
    v_fract_f32 v113, v113
    v_cos_f32 v110, v110
    v_cos_f32 v111, v111
    v_cos_f32 v112, v112
    v_cos_f32 v113, v113
    v_lshl_or_b32 v60, v60, 14, v28
    v_perm_b32 v61, v61, v12, s46
    v_bfe_u32 v12, v12, 8, 5

    v_lshl_or_b32 v62, v62, 14, v29
    v_perm_b32 v63, v63, v13, s46
    v_bfe_u32 v13, v13, 8, 5

    v_lshl_or_b32 v64, v64, 14, v30
    v_perm_b32 v65, v65, v14, s46
    v_bfe_u32 v14, v14, 8, 5

    v_lshl_or_b32 v66, v66, 14, v31
    v_perm_b32 v67, v67, v15, s46
    v_bfe_u32 v15, v15, 8, 5

    v_fmaak_f32 v110, v110, v105, 0x4b400010
    v_fmaak_f32 v111, v111, v105, 0x4b400010
    v_fmaak_f32 v112, v112, v105, 0x4b400010
    v_fmaak_f32 v113, v113, v105, 0x4b400010
    v_sub_u32 v110, v110, v12
    v_sub_u32 v111, v111, v13
    v_sub_u32 v112, v112, v14
    v_sub_u32 v113, v113, v15
    v_bfi_b32 v110, 31, v12, v110
    v_bfi_b32 v111, 31, v13, v111
    v_bfi_b32 v112, 31, v14, v112
    v_bfi_b32 v113, 31, v15, v113
    v_perm_b32 v60, v60, v110, s55
    v_perm_b32 v62, v62, v111, s55
    v_perm_b32 v64, v64, v112, s55
    v_perm_b32 v66, v66, v113, s55
L_ska_9:
    s_waitcnt vmcnt(6)
    s_bitcmp0_b32 s82, 3
    s_cbranch_scc1 L_ska_10
    s_mov_b64 exec, s[66:67]
    v_mul_hi_u32_u24 v69, s40, v32
    v_mul_hi_u32_u24 v68, s40, v16
    v_mul_hi_u32_u24 v71, s40, v33
    v_mul_hi_u32_u24 v70, s40, v17
    v_mul_hi_u32_u24 v73, s40, v34
    v_mul_hi_u32_u24 v72, s40, v18
    v_mul_hi_u32_u24 v75, s40, v35
    v_mul_hi_u32_u24 v74, s40, v19
    v_and_b32 v69, -2, v69
    v_mad_u32_u24 v16, v68, s43, v16
    v_and_b32 v88, -4, v68
    v_and_b32 v71, -2, v71
    v_mad_u32_u24 v17, v70, s43, v17
    v_and_b32 v89, -4, v70
    v_and_b32 v73, -2, v73
    v_mad_u32_u24 v18, v72, s43, v18
    v_and_b32 v90, -4, v72
    v_and_b32 v75, -2, v75
    v_mad_u32_u24 v19, v74, s43, v19
    v_and_b32 v91, -4, v74
    v_mad_i32_i24 v32, v69, s42, v32
    v_lshl_add_u32 v69, v88, 5, v69
    v_mad_i32_i24 v33, v71, s42, v33
    v_lshl_add_u32 v71, v89, 5, v71
    v_mad_i32_i24 v34, v73, s42, v34
    v_lshl_add_u32 v73, v90, 5, v73
    v_mad_i32_i24 v35, v75, s42, v35
    v_lshl_add_u32 v75, v91, 5, v75
    v_add_u32 v69, v69, v69
    ds_add_rtn_u32 v88, v69, v104
    v_add_u32 v71, v71, v71
    ds_add_rtn_u32 v89, v71, v104
    v_add_u32 v73, v73, v73
    ds_add_rtn_u32 v90, v73, v104
    v_add_u32 v75, v75, v75
    ds_add_rtn_u32 v91, v75, v104
    v_lshlrev_b32 v110, 16, v42
    v_and_b32 v111, 0xffff0000, v42
    v_lshlrev_b32 v112, 16, v43
    v_and_b32 v113, 0xffff0000, v43
    v_mul_f32 v110, s44, v110
    v_mul_f32 v111, s44, v111
    v_mul_f32 v112, s44, v112
    v_mul_f32 v113, s44, v113
    v_fract_f32 v110, v110
    v_fract_f32 v111, v111
    v_fract_f32 v112, v112
    v_fract_f32 v113, v113
    v_cos_f32 v110, v110
    v_cos_f32 v111, v111
    v_cos_f32 v112, v112
    v_cos_f32 v113, v113
    v_lshl_or_b32 v68, v68, 14, v32
    v_perm_b32 v69, v69, v16, s46
    v_bfe_u32 v16, v16, 8, 5

    v_lshl_or_b32 v70, v70, 14, v33
    v_perm_b32 v71, v71, v17, s46
    v_bfe_u32 v17, v17, 8, 5

    v_lshl_or_b32 v72, v72, 14, v34
    v_perm_b32 v73, v73, v18, s46
    v_bfe_u32 v18, v18, 8, 5

    v_lshl_or_b32 v74, v74, 14, v35
    v_perm_b32 v75, v75, v19, s46
    v_bfe_u32 v19, v19, 8, 5

    v_fmaak_f32 v110, v110, v105, 0x4b400010
    v_fmaak_f32 v111, v111, v105, 0x4b400010
    v_fmaak_f32 v112, v112, v105, 0x4b400010
    v_fmaak_f32 v113, v113, v105, 0x4b400010
    v_sub_u32 v110, v110, v16
    v_sub_u32 v111, v111, v17
    v_sub_u32 v112, v112, v18
    v_sub_u32 v113, v113, v19
    v_bfi_b32 v110, 31, v16, v110
    v_bfi_b32 v111, 31, v17, v111
    v_bfi_b32 v112, 31, v18, v112
    v_bfi_b32 v113, 31, v19, v113
    v_perm_b32 v68, v68, v110, s55
    v_perm_b32 v70, v70, v111, s55
    v_perm_b32 v72, v72, v112, s55
    v_perm_b32 v74, v74, v113, s55
    s_mov_b64 exec, -1
L_ska_10:
    s_waitcnt vmcnt(0)
    v_or_b32 v100, v100, v0
    s_nop 0
    v_readfirstlane_b32 s74, v100
    s_nop 1
    s_cmp_lg_u32 s74, 0
    s_cbranch_scc1 L_ready_12

    v_mov_b32 v110, 1
    buffer_atomic_add v110, v98, s[96:99], 0 offen offset:64 sc0
    s_waitcnt vmcnt(0)
    v_readfirstlane_b32 s74, v110
    s_nop 1
    s_cmp_lg_u32 s74, 0
    s_cbranch_scc1 L_zno_14

    s_mov_b32 s92, s6
    s_mov_b32 s93, s7
    s_mov_b32 s94, 65552
    s_mov_b32 s95, 0x20000
    v_mov_b32 v110, 0
    v_mov_b32 v111, 0
    v_mov_b32 v112, 0
    v_mov_b32 v113, 0
L_zl_13:
    buffer_store_dwordx4 v[110:113], v1, s[92:95], s74 offen sc0 sc1
    s_add_u32 s74, s74, 1024
    s_cmp_le_u32 s74, 65536
    s_cbranch_scc1 L_zl_13
    v_mov_b32 v114, 1
    s_waitcnt vmcnt(0)
    buffer_atomic_add v114, v98, s[96:99], 0 offen offset:128
L_zno_14:

L_spin_11:
    v_mov_b32 v100, 0
    buffer_atomic_add v100, v98, s[96:99], 0 offen offset:128 sc0
    s_waitcnt vmcnt(0)
    v_readfirstlane_b32 s74, v100
    s_nop 1
    s_cmp_eq_u32 s74, 0
    s_cbranch_scc1 L_spin_11
L_ready_12:

    v_cmp_eq_u32 vcc, 0, v0
    s_waitcnt vmcnt(1)
    s_mov_b64 exec, vcc
    ds_write_b32 v108, v99 offset:8
    s_mov_b64 exec, -1
    s_waitcnt lgkmcnt(0)
    s_barrier

    ds_read2_b32 v[110:111], v108 offset0:1 offset1:2
    ds_read_b64 v[94:95], v2
    s_waitcnt lgkmcnt(0)
    v_readfirstlane_b32 s53, v110
    v_readfirstlane_b32 s41, v111

    v_and_b32 v94, 0xffff, v94
    v_and_b32 v95, 0xffff, v95
    v_add_u32 v97, v94, v95
    s_nop 1
    v_add_u32_dpp v97, v97, v97 row_shr:1 row_mask:0xf bank_mask:0xf
    s_nop 1
    v_add_u32_dpp v97, v97, v97 row_shr:2 row_mask:0xf bank_mask:0xf
    s_nop 1
    v_add_u32_dpp v97, v97, v97 row_shr:4 row_mask:0xf bank_mask:0xf
    s_nop 1
    v_add_u32_dpp v97, v97, v97 row_shr:8 row_mask:0xf bank_mask:0xf
    s_nop 1
    v_add_u32_dpp v97, v97, v97 row_bcast:15 row_mask:0xa bank_mask:0xf
    s_nop 1
    v_add_u32_dpp v97, v97, v97 row_bcast:31 row_mask:0xc bank_mask:0xf
    s_mov_b32 exec_lo, 0
    s_brev_b32 exec_hi, 1
    ds_add_rtn_u32 v96, v108, v97
    s_mov_b64 exec, -1

    v_add_u32 v92, v94, v94
    v_add_u32 v93, v95, v95
    v_med3_u32 v92, v94, 2, v92
    v_med3_u32 v93, v95, 2, v93
    buffer_atomic_add_x2 v[92:93], v2, s[20:23], 0 offen sc0
    s_add_u32 s41, s41, 160
    s_sub_u32 s78, s41, 3008
    s_lshr_b32 s79, s78, 1
    s_add_u32 s79, s79, 3008
    s_and_b32 s86, s78, 1
    s_lshl_b32 s86, s86, 1
    s_add_u32 s87, s86, 2
    s_cmp_lt_u32 s41, 3008
    s_cselect_b32 s41, s41, s79
    s_cmovk_i32 s86, 0
    s_cmovk_i32 s87, 4

    s_mul_i32 s78, s41, 16000
    s_add_u32 s49, s78, 16000
    s_cmp_ge_u32 s41, 3200
    s_cmovk_i32 s49, 0
    s_cmovk_i32 s78, 0
    s_lshl_b32 s10, s49, 2
    s_lshl_b32 s14, s49, 2
    s_lshl_b32 s18, s49, 1
    s_sub_u32 s79, s87, s86
    s_bfm_b32 s85, s79, s86
    s_lshl_b32 s86, s86, 12
    s_lshl_b32 s87, s87, 12
    s_min_u32 s87, s87, 16000

    s_add_u32 s79, s78, 0
    s_bitcmp1_b32 s85, 0
    s_cselect_b32 s79, s79, 0x1ff00000
    s_lshl_b32 s56, s79, 2
    s_lshl_b32 s61, s79, 1

    s_add_u32 s79, s78, 4096
    s_bitcmp1_b32 s85, 1
    s_cselect_b32 s79, s79, 0x1ff00000
    s_lshl_b32 s57, s79, 2
    s_lshl_b32 s62, s79, 1

    s_add_u32 s79, s78, 8192
    s_bitcmp1_b32 s85, 2
    s_cselect_b32 s79, s79, 0x1ff00000
    s_lshl_b32 s58, s79, 2
    s_lshl_b32 s63, s79, 1

    s_add_u32 s79, s78, 12288
    s_bitcmp1_b32 s85, 3
    s_cselect_b32 s79, s79, 0x1ff00000
    s_lshl_b32 s59, s79, 2
    s_lshl_b32 s64, s79, 1

    s_waitcnt lgkmcnt(0)
    v_readlane_b32 s77, v96, 63
    v_mul_u32_u24 v114, 7936, v0
    v_sub_u32 v97, v97, v95
    s_sub_u32 s50, s50, s83
    s_sub_u32 s77, s77, s50
    v_add_u32 v97, s77, v97
    v_sub_u32 v96, v97, v94
    v_lshlrev_b32 v111, 16, v97
    v_lshlrev_b32 v110, 16, v96
    ds_write_b64 v2, v[110:111]
    v_sub_u32 v96, v114, v96
    v_sub_u32 v97, v114, v97
    v_add_u32 v97, s48, v97
    s_add_u32 s50, s50, s84
    s_mov_b32 s28, s82
    s_mov_b32 s29, s83
    s_mov_b32 s30, s84
    s_lshl_b32 s74, s29, 3
    s_lshl_b32 s75, s30, 3
    v_mov_b32 v125, s74
    v_mov_b32 v126, s75
    v_mov_b32 v127, -1

    s_waitcnt lgkmcnt(0)
    s_barrier

    s_mov_b64 exec, 1
    ds_write_b32 v125, v127 offset:16396
    ds_write_b32 v126, v127 offset:16404
    s_mov_b64 exec, -1

    buffer_load_dwordx4 v[20:23], v1, s[12:15], s56 offen nt
    buffer_load_dwordx4 v[4:7], v1, s[8:11], s56 offen nt
    buffer_load_dwordx2 v[36:37], v2, s[16:19], s61 offen nt
    s_bitcmp0_b32 s28, 0
    s_cbranch_scc1 L_skz_15
    v_lshrrev_b32 v110, 16, v45
    ds_read_b32 v110, v110
    v_lshrrev_b32 v111, 16, v47
    ds_read_b32 v111, v111
    v_lshrrev_b32 v112, 16, v49
    ds_read_b32 v112, v112
    v_lshrrev_b32 v113, 16, v51
    ds_read_b32 v113, v113
    s_waitcnt lgkmcnt(3)
    v_add_u32_sdwa v110, v110, v76 dst_sel:DWORD dst_unused:UNUSED_PAD src0_sel:WORD_1 src1_sel:WORD_0
    v_lshlrev_b32 v110, 3, v110
    ds_write_b64 v110, v[44:45] offset:16400

    s_waitcnt lgkmcnt(3)
    v_add_u32_sdwa v111, v111, v77 dst_sel:DWORD dst_unused:UNUSED_PAD src0_sel:WORD_1 src1_sel:WORD_0
    v_lshlrev_b32 v111, 3, v111
    ds_write_b64 v111, v[46:47] offset:16400

    s_waitcnt lgkmcnt(3)
    v_add_u32_sdwa v112, v112, v78 dst_sel:DWORD dst_unused:UNUSED_PAD src0_sel:WORD_1 src1_sel:WORD_0
    v_lshlrev_b32 v112, 3, v112
    ds_write_b64 v112, v[48:49] offset:16400

    s_waitcnt lgkmcnt(3)
    v_add_u32_sdwa v113, v113, v79 dst_sel:DWORD dst_unused:UNUSED_PAD src0_sel:WORD_1 src1_sel:WORD_0
    v_lshlrev_b32 v113, 3, v113
    ds_write_b64 v113, v[50:51] offset:16400

L_skz_15:
    s_bitcmp0_b32 s28, 1
    s_cbranch_scc1 L_skz_16
    v_lshrrev_b32 v110, 16, v53
    ds_read_b32 v110, v110
    v_lshrrev_b32 v111, 16, v55
    ds_read_b32 v111, v111
    v_lshrrev_b32 v112, 16, v57
    ds_read_b32 v112, v112
    v_lshrrev_b32 v113, 16, v59
    ds_read_b32 v113, v113
    s_waitcnt lgkmcnt(3)
    v_add_u32_sdwa v110, v110, v80 dst_sel:DWORD dst_unused:UNUSED_PAD src0_sel:WORD_1 src1_sel:WORD_0
    v_lshlrev_b32 v110, 3, v110
    ds_write_b64 v110, v[52:53] offset:16400

    s_waitcnt lgkmcnt(3)
    v_add_u32_sdwa v111, v111, v81 dst_sel:DWORD dst_unused:UNUSED_PAD src0_sel:WORD_1 src1_sel:WORD_0
    v_lshlrev_b32 v111, 3, v111
    ds_write_b64 v111, v[54:55] offset:16400

    s_waitcnt lgkmcnt(3)
    v_add_u32_sdwa v112, v112, v82 dst_sel:DWORD dst_unused:UNUSED_PAD src0_sel:WORD_1 src1_sel:WORD_0
    v_lshlrev_b32 v112, 3, v112
    ds_write_b64 v112, v[56:57] offset:16400

    s_waitcnt lgkmcnt(3)
    v_add_u32_sdwa v113, v113, v83 dst_sel:DWORD dst_unused:UNUSED_PAD src0_sel:WORD_1 src1_sel:WORD_0
    v_lshlrev_b32 v113, 3, v113
    ds_write_b64 v113, v[58:59] offset:16400

L_skz_16:
    buffer_load_dwordx4 v[24:27], v1, s[12:15], s57 offen nt
    buffer_load_dwordx4 v[8:11], v1, s[8:11], s57 offen nt
    buffer_load_dwordx2 v[38:39], v2, s[16:19], s62 offen nt
    s_bitcmp0_b32 s28, 2
    s_cbranch_scc1 L_skz_17
    v_lshrrev_b32 v110, 16, v61
    ds_read_b32 v110, v110
    v_lshrrev_b32 v111, 16, v63
    ds_read_b32 v111, v111
    v_lshrrev_b32 v112, 16, v65
    ds_read_b32 v112, v112
    v_lshrrev_b32 v113, 16, v67
    ds_read_b32 v113, v113
    s_waitcnt lgkmcnt(3)
    v_add_u32_sdwa v110, v110, v84 dst_sel:DWORD dst_unused:UNUSED_PAD src0_sel:WORD_1 src1_sel:WORD_0
    v_lshlrev_b32 v110, 3, v110
    ds_write_b64 v110, v[60:61] offset:16400

    s_waitcnt lgkmcnt(3)
    v_add_u32_sdwa v111, v111, v85 dst_sel:DWORD dst_unused:UNUSED_PAD src0_sel:WORD_1 src1_sel:WORD_0
    v_lshlrev_b32 v111, 3, v111
    ds_write_b64 v111, v[62:63] offset:16400

    s_waitcnt lgkmcnt(3)
    v_add_u32_sdwa v112, v112, v86 dst_sel:DWORD dst_unused:UNUSED_PAD src0_sel:WORD_1 src1_sel:WORD_0
    v_lshlrev_b32 v112, 3, v112
    ds_write_b64 v112, v[64:65] offset:16400

    s_waitcnt lgkmcnt(3)
    v_add_u32_sdwa v113, v113, v87 dst_sel:DWORD dst_unused:UNUSED_PAD src0_sel:WORD_1 src1_sel:WORD_0
    v_lshlrev_b32 v113, 3, v113
    ds_write_b64 v113, v[66:67] offset:16400

L_skz_17:
    s_bitcmp0_b32 s28, 3
    s_cbranch_scc1 L_skz_18
    s_mov_b64 exec, s[66:67]
    v_lshrrev_b32 v110, 16, v69
    ds_read_b32 v110, v110
    v_lshrrev_b32 v111, 16, v71
    ds_read_b32 v111, v111
    v_lshrrev_b32 v112, 16, v73
    ds_read_b32 v112, v112
    v_lshrrev_b32 v113, 16, v75
    ds_read_b32 v113, v113
    s_waitcnt lgkmcnt(3)
    v_add_u32_sdwa v110, v110, v88 dst_sel:DWORD dst_unused:UNUSED_PAD src0_sel:WORD_1 src1_sel:WORD_0
    v_lshlrev_b32 v110, 3, v110
    ds_write_b64 v110, v[68:69] offset:16400

    s_waitcnt lgkmcnt(3)
    v_add_u32_sdwa v111, v111, v89 dst_sel:DWORD dst_unused:UNUSED_PAD src0_sel:WORD_1 src1_sel:WORD_0
    v_lshlrev_b32 v111, 3, v111
    ds_write_b64 v111, v[70:71] offset:16400

    s_waitcnt lgkmcnt(3)
    v_add_u32_sdwa v112, v112, v90 dst_sel:DWORD dst_unused:UNUSED_PAD src0_sel:WORD_1 src1_sel:WORD_0
    v_lshlrev_b32 v112, 3, v112
    ds_write_b64 v112, v[72:73] offset:16400

    s_waitcnt lgkmcnt(3)
    v_add_u32_sdwa v113, v113, v91 dst_sel:DWORD dst_unused:UNUSED_PAD src0_sel:WORD_1 src1_sel:WORD_0
    v_lshlrev_b32 v113, 3, v113
    ds_write_b64 v113, v[74:75] offset:16400

    s_mov_b64 exec, -1
L_skz_18:
    buffer_load_dwordx4 v[28:31], v1, s[12:15], s58 offen nt
    buffer_load_dwordx4 v[12:15], v1, s[8:11], s58 offen nt
    buffer_load_dwordx2 v[40:41], v2, s[16:19], s63 offen nt
    buffer_load_dwordx4 v[32:35], v1, s[12:15], s59 offen nt
    buffer_load_dwordx4 v[16:19], v1, s[8:11], s59 offen nt
    buffer_load_dwordx2 v[42:43], v2, s[16:19], s64 offen nt
    s_cmp_eq_u32 s49, 0
    s_cbranch_scc1 L_p1epi_6
L_p1loop_5:
    s_mov_b32 s82, s85
    s_mov_b32 s83, s86
    s_mov_b32 s84, s87
    v_mov_b32 v99, 1
    buffer_atomic_add v99, v98, s[96:99], 0 offen sc0
    s_waitcnt vmcnt(10)
    s_bitcmp0_b32 s82, 0
    s_cbranch_scc1 L_ska_19
    v_mul_hi_u32_u24 v45, s40, v20
    v_mul_hi_u32_u24 v44, s40, v4
    v_mul_hi_u32_u24 v47, s40, v21
    v_mul_hi_u32_u24 v46, s40, v5
    v_mul_hi_u32_u24 v49, s40, v22
    v_mul_hi_u32_u24 v48, s40, v6
    v_mul_hi_u32_u24 v51, s40, v23
    v_mul_hi_u32_u24 v50, s40, v7
    v_and_b32 v45, -2, v45
    v_mad_u32_u24 v4, v44, s43, v4
    v_and_b32 v76, -4, v44
    v_and_b32 v47, -2, v47
    v_mad_u32_u24 v5, v46, s43, v5
    v_and_b32 v77, -4, v46
    v_and_b32 v49, -2, v49
    v_mad_u32_u24 v6, v48, s43, v6
    v_and_b32 v78, -4, v48
    v_and_b32 v51, -2, v51
    v_mad_u32_u24 v7, v50, s43, v7
    v_and_b32 v79, -4, v50
    v_mad_i32_i24 v20, v45, s42, v20
    v_lshl_add_u32 v45, v76, 5, v45
    v_mad_i32_i24 v21, v47, s42, v21
    v_lshl_add_u32 v47, v77, 5, v47
    v_mad_i32_i24 v22, v49, s42, v22
    v_lshl_add_u32 v49, v78, 5, v49
    v_mad_i32_i24 v23, v51, s42, v23
    v_lshl_add_u32 v51, v79, 5, v51
    v_add_u32 v45, v45, v45
    ds_add_rtn_u32 v76, v45, v104
    v_add_u32 v47, v47, v47
    ds_add_rtn_u32 v77, v47, v104
    v_add_u32 v49, v49, v49
    ds_add_rtn_u32 v78, v49, v104
    v_add_u32 v51, v51, v51
    ds_add_rtn_u32 v79, v51, v104
    v_lshlrev_b32 v110, 16, v36
    v_and_b32 v111, 0xffff0000, v36
    v_lshlrev_b32 v112, 16, v37
    v_and_b32 v113, 0xffff0000, v37
    v_mul_f32 v110, s44, v110
    v_mul_f32 v111, s44, v111
    v_mul_f32 v112, s44, v112
    v_mul_f32 v113, s44, v113
    v_fract_f32 v110, v110
    v_fract_f32 v111, v111
    v_fract_f32 v112, v112
    v_fract_f32 v113, v113
    v_cos_f32 v110, v110
    v_cos_f32 v111, v111
    v_cos_f32 v112, v112
    v_cos_f32 v113, v113
    v_lshl_or_b32 v44, v44, 14, v20
    v_perm_b32 v45, v45, v4, s46
    v_bfe_u32 v4, v4, 8, 5

    v_lshl_or_b32 v46, v46, 14, v21
    v_perm_b32 v47, v47, v5, s46
    v_bfe_u32 v5, v5, 8, 5

    v_lshl_or_b32 v48, v48, 14, v22
    v_perm_b32 v49, v49, v6, s46
    v_bfe_u32 v6, v6, 8, 5

    v_lshl_or_b32 v50, v50, 14, v23
    v_perm_b32 v51, v51, v7, s46
    v_bfe_u32 v7, v7, 8, 5

    v_fmaak_f32 v110, v110, v105, 0x4b400010
    v_fmaak_f32 v111, v111, v105, 0x4b400010
    v_fmaak_f32 v112, v112, v105, 0x4b400010
    v_fmaak_f32 v113, v113, v105, 0x4b400010
    v_sub_u32 v110, v110, v4
    v_sub_u32 v111, v111, v5
    v_sub_u32 v112, v112, v6
    v_sub_u32 v113, v113, v7
    v_bfi_b32 v110, 31, v4, v110
    v_bfi_b32 v111, 31, v5, v111
    v_bfi_b32 v112, 31, v6, v112
    v_bfi_b32 v113, 31, v7, v113
    v_perm_b32 v44, v44, v110, s55
    v_perm_b32 v46, v46, v111, s55
    v_perm_b32 v48, v48, v112, s55
    v_perm_b32 v50, v50, v113, s55
L_ska_19:
    s_waitcnt vmcnt(7)
    s_bitcmp0_b32 s82, 1
    s_cbranch_scc1 L_ska_20
    v_mul_hi_u32_u24 v53, s40, v24
    v_mul_hi_u32_u24 v52, s40, v8
    v_mul_hi_u32_u24 v55, s40, v25
    v_mul_hi_u32_u24 v54, s40, v9
    v_mul_hi_u32_u24 v57, s40, v26
    v_mul_hi_u32_u24 v56, s40, v10
    v_mul_hi_u32_u24 v59, s40, v27
    v_mul_hi_u32_u24 v58, s40, v11
    v_and_b32 v53, -2, v53
    v_mad_u32_u24 v8, v52, s43, v8
    v_and_b32 v80, -4, v52
    v_and_b32 v55, -2, v55
    v_mad_u32_u24 v9, v54, s43, v9
    v_and_b32 v81, -4, v54
    v_and_b32 v57, -2, v57
    v_mad_u32_u24 v10, v56, s43, v10
    v_and_b32 v82, -4, v56
    v_and_b32 v59, -2, v59
    v_mad_u32_u24 v11, v58, s43, v11
    v_and_b32 v83, -4, v58
    v_mad_i32_i24 v24, v53, s42, v24
    v_lshl_add_u32 v53, v80, 5, v53
    v_mad_i32_i24 v25, v55, s42, v25
    v_lshl_add_u32 v55, v81, 5, v55
    v_mad_i32_i24 v26, v57, s42, v26
    v_lshl_add_u32 v57, v82, 5, v57
    v_mad_i32_i24 v27, v59, s42, v27
    v_lshl_add_u32 v59, v83, 5, v59
    v_add_u32 v53, v53, v53
    ds_add_rtn_u32 v80, v53, v104
    v_add_u32 v55, v55, v55
    ds_add_rtn_u32 v81, v55, v104
    v_add_u32 v57, v57, v57
    ds_add_rtn_u32 v82, v57, v104
    v_add_u32 v59, v59, v59
    ds_add_rtn_u32 v83, v59, v104
    v_lshlrev_b32 v110, 16, v38
    v_and_b32 v111, 0xffff0000, v38
    v_lshlrev_b32 v112, 16, v39
    v_and_b32 v113, 0xffff0000, v39
    v_mul_f32 v110, s44, v110
    v_mul_f32 v111, s44, v111
    v_mul_f32 v112, s44, v112
    v_mul_f32 v113, s44, v113
    v_fract_f32 v110, v110
    v_fract_f32 v111, v111
    v_fract_f32 v112, v112
    v_fract_f32 v113, v113
    v_cos_f32 v110, v110
    v_cos_f32 v111, v111
    v_cos_f32 v112, v112
    v_cos_f32 v113, v113
    v_lshl_or_b32 v52, v52, 14, v24
    v_perm_b32 v53, v53, v8, s46
    v_bfe_u32 v8, v8, 8, 5

    v_lshl_or_b32 v54, v54, 14, v25
    v_perm_b32 v55, v55, v9, s46
    v_bfe_u32 v9, v9, 8, 5

    v_lshl_or_b32 v56, v56, 14, v26
    v_perm_b32 v57, v57, v10, s46
    v_bfe_u32 v10, v10, 8, 5

    v_lshl_or_b32 v58, v58, 14, v27
    v_perm_b32 v59, v59, v11, s46
    v_bfe_u32 v11, v11, 8, 5

    v_fmaak_f32 v110, v110, v105, 0x4b400010
    v_fmaak_f32 v111, v111, v105, 0x4b400010
    v_fmaak_f32 v112, v112, v105, 0x4b400010
    v_fmaak_f32 v113, v113, v105, 0x4b400010
    v_sub_u32 v110, v110, v8
    v_sub_u32 v111, v111, v9
    v_sub_u32 v112, v112, v10
    v_sub_u32 v113, v113, v11
    v_bfi_b32 v110, 31, v8, v110
    v_bfi_b32 v111, 31, v9, v111
    v_bfi_b32 v112, 31, v10, v112
    v_bfi_b32 v113, 31, v11, v113
    v_perm_b32 v52, v52, v110, s55
    v_perm_b32 v54, v54, v111, s55
    v_perm_b32 v56, v56, v112, s55
    v_perm_b32 v58, v58, v113, s55
L_ska_20:
    s_waitcnt vmcnt(1)
    s_waitcnt vmcnt(0)
    v_cmp_eq_u32 vcc, 0, v0
    s_mov_b64 exec, vcc
    ds_write_b32 v108, v99 offset:8
    s_mov_b64 exec, -1
    s_waitcnt vmcnt(10)
    v_add_u32 v110, v92, v94
    v_min_u32 v92, s48, v92
    v_add_u32 v111, v93, v95
    v_min_u32 v93, s48, v93
    v_max_u32 v110, v110, v111
    v_add_u32 v92, v92, v96
    v_add_u32 v93, v93, v97
    v_cmp_le_u32 vcc, s48, v110
    v_lshl_add_u32 v92, v92, 2, v92
    v_lshl_add_u32 v93, v93, 2, v93
    ds_write_b64 v2, v[92:93] offset:8192
    s_cbranch_vccz L_noov_21
    ds_write_b32 v108, v104 offset:4
L_noov_21:

    s_waitcnt lgkmcnt(0)
    s_barrier
    ds_read2_b32 v[110:111], v108 offset0:1 offset1:2
    s_waitcnt lgkmcnt(0)
    v_readfirstlane_b32 s53, v110
    v_readfirstlane_b32 s41, v111
    s_nop 1

    s_add_u32 s41, s41, 160
    s_sub_u32 s78, s41, 3008
    s_lshr_b32 s79, s78, 1
    s_add_u32 s79, s79, 3008
    s_and_b32 s86, s78, 1
    s_lshl_b32 s86, s86, 1
    s_add_u32 s87, s86, 2
    s_cmp_lt_u32 s41, 3008
    s_cselect_b32 s41, s41, s79
    s_cmovk_i32 s86, 0
    s_cmovk_i32 s87, 4

    s_mul_i32 s78, s41, 16000
    s_add_u32 s49, s78, 16000
    s_cmp_ge_u32 s41, 3200
    s_cmovk_i32 s49, 0
    s_cmovk_i32 s78, 0
    s_lshl_b32 s10, s49, 2
    s_lshl_b32 s14, s49, 2
    s_lshl_b32 s18, s49, 1
    s_sub_u32 s79, s87, s86
    s_bfm_b32 s85, s79, s86
    s_lshl_b32 s86, s86, 12
    s_lshl_b32 s87, s87, 12
    s_min_u32 s87, s87, 16000

    s_add_u32 s79, s78, 0
    s_bitcmp1_b32 s85, 0
    s_cselect_b32 s79, s79, 0x1ff00000
    s_lshl_b32 s56, s79, 2
    s_lshl_b32 s61, s79, 1

    s_add_u32 s79, s78, 4096
    s_bitcmp1_b32 s85, 1
    s_cselect_b32 s79, s79, 0x1ff00000
    s_lshl_b32 s57, s79, 2
    s_lshl_b32 s62, s79, 1

    s_add_u32 s79, s78, 8192
    s_bitcmp1_b32 s85, 2
    s_cselect_b32 s79, s79, 0x1ff00000
    s_lshl_b32 s58, s79, 2
    s_lshl_b32 s63, s79, 1

    s_add_u32 s79, s78, 12288
    s_bitcmp1_b32 s85, 3
    s_cselect_b32 s79, s79, 0x1ff00000
    s_lshl_b32 s59, s79, 2
    s_lshl_b32 s64, s79, 1

    s_cmp_lg_u32 s53, 0
    s_cbranch_scc1 L_slow_22
L_sback_23:
    s_bitcmp0_b32 s28, 0
    s_cbranch_scc1 L_skw_27
    ds_read_b64 v[110:111], v2 offset:16400
    ds_read_b64 v[112:113], v2 offset:16408
    ds_read_b64 v[114:115], v2 offset:16392

    ds_read_b64 v[118:119], v2 offset:24592
    ds_read_b64 v[120:121], v2 offset:24600
    ds_read_b64 v[122:123], v2 offset:24584

    s_waitcnt lgkmcnt(3)
    v_lshrrev_b32 v116, 16, v111
    ds_read_b32 v116, v116 offset:8192

    s_waitcnt lgkmcnt(1)
    v_lshrrev_b32 v124, 16, v119
    ds_read_b32 v124, v124 offset:8192

    v_cmp_ne_u32_sdwa s[80:81], v111, v113 src0_sel:WORD_1 src1_sel:WORD_1
    v_cmp_ne_u32_sdwa vcc, v111, v115 src0_sel:WORD_1 src1_sel:WORD_1
    v_alignbyte_b32 v114, v115, v114, 2
    s_mov_b32 s54, -3
    v_alignbyte_b32 v111, v111, v110, 1
    v_perm_b32 v110, v110, v114, s47
    s_waitcnt lgkmcnt(1)
    v_add3_u32 v116, v116, v106, s54
    v_sub_u32 v117, 0, v116
    v_and_b32 v117, 3, v117
    s_mov_b64 exec, s[80:81]
    v_mov_b32 v117, 0
    v_mov_b32 v112, 0
    s_mov_b64 exec, vcc
    v_mov_b32 v117, 3

    s_mov_b64 exec, -1
    v_alignbyte_b32 v110, v111, v110, v117
    v_alignbyte_b32 v111, v112, v111, v117
    v_add_u32 v116, v116, v117

    buffer_store_dwordx2 v[110:111], v116, s[24:27], 0 offen
    v_cmp_ne_u32_sdwa s[80:81], v119, v121 src0_sel:WORD_1 src1_sel:WORD_1
    v_cmp_ne_u32_sdwa vcc, v119, v123 src0_sel:WORD_1 src1_sel:WORD_1
    v_alignbyte_b32 v122, v123, v122, 2
    s_mov_b32 s54, 5117
    v_alignbyte_b32 v119, v119, v118, 1
    v_perm_b32 v118, v118, v122, s47
    s_waitcnt lgkmcnt(0)
    v_add3_u32 v124, v124, v106, s54
    v_sub_u32 v125, 0, v124
    v_and_b32 v125, 3, v125
    s_mov_b64 exec, s[80:81]
    v_mov_b32 v125, 0
    v_mov_b32 v120, 0
    s_mov_b64 exec, vcc
    v_mov_b32 v125, 3

    s_mov_b64 exec, -1
    v_alignbyte_b32 v118, v119, v118, v125
    v_alignbyte_b32 v119, v120, v119, v125
    v_add_u32 v124, v124, v125

    buffer_store_dwordx2 v[118:119], v124, s[24:27], 0 offen
L_skw_27:
    s_bitcmp0_b32 s28, 0
    s_cbranch_scc1 L_skw_28
    ds_read_b64 v[110:111], v2 offset:32784
    ds_read_b64 v[112:113], v2 offset:32792
    ds_read_b64 v[114:115], v2 offset:32776

    ds_read_b64 v[118:119], v2 offset:40976
    ds_read_b64 v[120:121], v2 offset:40984
    ds_read_b64 v[122:123], v2 offset:40968

    s_waitcnt lgkmcnt(3)
    v_lshrrev_b32 v116, 16, v111
    ds_read_b32 v116, v116 offset:8192

    s_waitcnt lgkmcnt(1)
    v_lshrrev_b32 v124, 16, v119
    ds_read_b32 v124, v124 offset:8192

    v_cmp_ne_u32_sdwa s[80:81], v111, v113 src0_sel:WORD_1 src1_sel:WORD_1
    v_cmp_ne_u32_sdwa vcc, v111, v115 src0_sel:WORD_1 src1_sel:WORD_1
    v_alignbyte_b32 v114, v115, v114, 2
    s_mov_b32 s54, 10237
    v_alignbyte_b32 v111, v111, v110, 1
    v_perm_b32 v110, v110, v114, s47
    s_waitcnt lgkmcnt(1)
    v_add3_u32 v116, v116, v106, s54
    v_sub_u32 v117, 0, v116
    v_and_b32 v117, 3, v117
    s_mov_b64 exec, s[80:81]
    v_mov_b32 v117, 0
    v_mov_b32 v112, 0
    s_mov_b64 exec, vcc
    v_mov_b32 v117, 3

    s_mov_b64 exec, -1
    v_alignbyte_b32 v110, v111, v110, v117
    v_alignbyte_b32 v111, v112, v111, v117
    v_add_u32 v116, v116, v117

    buffer_store_dwordx2 v[110:111], v116, s[24:27], 0 offen
    v_cmp_ne_u32_sdwa s[80:81], v119, v121 src0_sel:WORD_1 src1_sel:WORD_1
    v_cmp_ne_u32_sdwa vcc, v119, v123 src0_sel:WORD_1 src1_sel:WORD_1
    v_alignbyte_b32 v122, v123, v122, 2
    s_mov_b32 s54, 15357
    v_alignbyte_b32 v119, v119, v118, 1
    v_perm_b32 v118, v118, v122, s47
    s_waitcnt lgkmcnt(0)
    v_add3_u32 v124, v124, v106, s54
    v_sub_u32 v125, 0, v124
    v_and_b32 v125, 3, v125
    s_mov_b64 exec, s[80:81]
    v_mov_b32 v125, 0
    v_mov_b32 v120, 0
    s_mov_b64 exec, vcc
    v_mov_b32 v125, 3

    s_mov_b64 exec, -1
    v_alignbyte_b32 v118, v119, v118, v125
    v_alignbyte_b32 v119, v120, v119, v125
    v_add_u32 v124, v124, v125

    buffer_store_dwordx2 v[118:119], v124, s[24:27], 0 offen
L_skw_28:
    s_bitcmp0_b32 s82, 2
    s_cbranch_scc1 L_ska_29
    v_mul_hi_u32_u24 v61, s40, v28
    v_mul_hi_u32_u24 v60, s40, v12
    v_mul_hi_u32_u24 v63, s40, v29
    v_mul_hi_u32_u24 v62, s40, v13
    v_mul_hi_u32_u24 v65, s40, v30
    v_mul_hi_u32_u24 v64, s40, v14
    v_mul_hi_u32_u24 v67, s40, v31
    v_mul_hi_u32_u24 v66, s40, v15
    v_and_b32 v61, -2, v61
    v_mad_u32_u24 v12, v60, s43, v12
    v_and_b32 v84, -4, v60
    v_and_b32 v63, -2, v63
    v_mad_u32_u24 v13, v62, s43, v13
    v_and_b32 v85, -4, v62
    v_and_b32 v65, -2, v65
    v_mad_u32_u24 v14, v64, s43, v14
    v_and_b32 v86, -4, v64
    v_and_b32 v67, -2, v67
    v_mad_u32_u24 v15, v66, s43, v15
    v_and_b32 v87, -4, v66
    v_mad_i32_i24 v28, v61, s42, v28
    v_lshl_add_u32 v61, v84, 5, v61
    v_mad_i32_i24 v29, v63, s42, v29
    v_lshl_add_u32 v63, v85, 5, v63
    v_mad_i32_i24 v30, v65, s42, v30
    v_lshl_add_u32 v65, v86, 5, v65
    v_mad_i32_i24 v31, v67, s42, v31
    v_lshl_add_u32 v67, v87, 5, v67
    v_add_u32 v61, v61, v61
    ds_add_rtn_u32 v84, v61, v104
    v_add_u32 v63, v63, v63
    ds_add_rtn_u32 v85, v63, v104
    v_add_u32 v65, v65, v65
    ds_add_rtn_u32 v86, v65, v104
    v_add_u32 v67, v67, v67
    ds_add_rtn_u32 v87, v67, v104
    v_lshlrev_b32 v110, 16, v40
    v_and_b32 v111, 0xffff0000, v40
    v_lshlrev_b32 v112, 16, v41
    v_and_b32 v113, 0xffff0000, v41
    v_mul_f32 v110, s44, v110
    v_mul_f32 v111, s44, v111
    v_mul_f32 v112, s44, v112
    v_mul_f32 v113, s44, v113
    v_fract_f32 v110, v110
    v_fract_f32 v111, v111
    v_fract_f32 v112, v112
    v_fract_f32 v113, v113
    v_cos_f32 v110, v110
    v_cos_f32 v111, v111
    v_cos_f32 v112, v112
    v_cos_f32 v113, v113
    v_lshl_or_b32 v60, v60, 14, v28
    v_perm_b32 v61, v61, v12, s46
    v_bfe_u32 v12, v12, 8, 5

    v_lshl_or_b32 v62, v62, 14, v29
    v_perm_b32 v63, v63, v13, s46
    v_bfe_u32 v13, v13, 8, 5

    v_lshl_or_b32 v64, v64, 14, v30
    v_perm_b32 v65, v65, v14, s46
    v_bfe_u32 v14, v14, 8, 5

    v_lshl_or_b32 v66, v66, 14, v31
    v_perm_b32 v67, v67, v15, s46
    v_bfe_u32 v15, v15, 8, 5

    v_fmaak_f32 v110, v110, v105, 0x4b400010
    v_fmaak_f32 v111, v111, v105, 0x4b400010
    v_fmaak_f32 v112, v112, v105, 0x4b400010
    v_fmaak_f32 v113, v113, v105, 0x4b400010
    v_sub_u32 v110, v110, v12
    v_sub_u32 v111, v111, v13
    v_sub_u32 v112, v112, v14
    v_sub_u32 v113, v113, v15
    v_bfi_b32 v110, 31, v12, v110
    v_bfi_b32 v111, 31, v13, v111
    v_bfi_b32 v112, 31, v14, v112
    v_bfi_b32 v113, 31, v15, v113
    v_perm_b32 v60, v60, v110, s55
    v_perm_b32 v62, v62, v111, s55
    v_perm_b32 v64, v64, v112, s55
    v_perm_b32 v66, v66, v113, s55
L_ska_29:
    s_bitcmp0_b32 s28, 1
    s_cbranch_scc1 L_skw_30
    v_add_u32 v107, 32768, v2
    ds_read_b64 v[110:111], v107 offset:16400
    ds_read_b64 v[112:113], v107 offset:16408
    ds_read_b64 v[114:115], v107 offset:16392

    ds_read_b64 v[118:119], v107 offset:24592
    ds_read_b64 v[120:121], v107 offset:24600
    ds_read_b64 v[122:123], v107 offset:24584

    s_waitcnt lgkmcnt(3)
    v_lshrrev_b32 v116, 16, v111
    ds_read_b32 v116, v116 offset:8192

    s_waitcnt lgkmcnt(1)
    v_lshrrev_b32 v124, 16, v119
    ds_read_b32 v124, v124 offset:8192

    v_cmp_ne_u32_sdwa s[80:81], v111, v113 src0_sel:WORD_1 src1_sel:WORD_1
    v_cmp_ne_u32_sdwa vcc, v111, v115 src0_sel:WORD_1 src1_sel:WORD_1
    v_alignbyte_b32 v114, v115, v114, 2
    s_mov_b32 s54, 20477
    v_alignbyte_b32 v111, v111, v110, 1
    v_perm_b32 v110, v110, v114, s47
    s_waitcnt lgkmcnt(1)
    v_add3_u32 v116, v116, v106, s54
    v_sub_u32 v117, 0, v116
    v_and_b32 v117, 3, v117
    s_mov_b64 exec, s[80:81]
    v_mov_b32 v117, 0
    v_mov_b32 v112, 0
    s_mov_b64 exec, vcc
    v_mov_b32 v117, 3

    s_mov_b64 exec, -1
    v_alignbyte_b32 v110, v111, v110, v117
    v_alignbyte_b32 v111, v112, v111, v117
    v_add_u32 v116, v116, v117

    buffer_store_dwordx2 v[110:111], v116, s[24:27], 0 offen
    v_cmp_ne_u32_sdwa s[80:81], v119, v121 src0_sel:WORD_1 src1_sel:WORD_1
    v_cmp_ne_u32_sdwa vcc, v119, v123 src0_sel:WORD_1 src1_sel:WORD_1
    v_alignbyte_b32 v122, v123, v122, 2
    s_mov_b32 s54, 25597
    v_alignbyte_b32 v119, v119, v118, 1
    v_perm_b32 v118, v118, v122, s47
    s_waitcnt lgkmcnt(0)
    v_add3_u32 v124, v124, v106, s54
    v_sub_u32 v125, 0, v124
    v_and_b32 v125, 3, v125
    s_mov_b64 exec, s[80:81]
    v_mov_b32 v125, 0
    v_mov_b32 v120, 0
    s_mov_b64 exec, vcc
    v_mov_b32 v125, 3

    s_mov_b64 exec, -1
    v_alignbyte_b32 v118, v119, v118, v125
    v_alignbyte_b32 v119, v120, v119, v125
    v_add_u32 v124, v124, v125

    buffer_store_dwordx2 v[118:119], v124, s[24:27], 0 offen
L_skw_30:
    s_bitcmp0_b32 s28, 1
    s_cbranch_scc1 L_skw_31
    v_add_u32 v107, 32768, v2
    ds_read_b64 v[110:111], v107 offset:32784
    ds_read_b64 v[112:113], v107 offset:32792
    ds_read_b64 v[114:115], v107 offset:32776

    ds_read_b64 v[118:119], v107 offset:40976
    ds_read_b64 v[120:121], v107 offset:40984
    ds_read_b64 v[122:123], v107 offset:40968

    s_waitcnt lgkmcnt(3)
    v_lshrrev_b32 v116, 16, v111
    ds_read_b32 v116, v116 offset:8192

    s_waitcnt lgkmcnt(1)
    v_lshrrev_b32 v124, 16, v119
    ds_read_b32 v124, v124 offset:8192

    v_cmp_ne_u32_sdwa s[80:81], v111, v113 src0_sel:WORD_1 src1_sel:WORD_1
    v_cmp_ne_u32_sdwa vcc, v111, v115 src0_sel:WORD_1 src1_sel:WORD_1
    v_alignbyte_b32 v114, v115, v114, 2
    s_mov_b32 s54, 30717
    v_alignbyte_b32 v111, v111, v110, 1
    v_perm_b32 v110, v110, v114, s47
    s_waitcnt lgkmcnt(1)
    v_add3_u32 v116, v116, v106, s54
    v_sub_u32 v117, 0, v116
    v_and_b32 v117, 3, v117
    s_mov_b64 exec, s[80:81]
    v_mov_b32 v117, 0
    v_mov_b32 v112, 0
    s_mov_b64 exec, vcc
    v_mov_b32 v117, 3

    s_mov_b64 exec, -1
    v_alignbyte_b32 v110, v111, v110, v117
    v_alignbyte_b32 v111, v112, v111, v117
    v_add_u32 v116, v116, v117

    buffer_store_dwordx2 v[110:111], v116, s[24:27], 0 offen
    v_cmp_ne_u32_sdwa s[80:81], v119, v121 src0_sel:WORD_1 src1_sel:WORD_1
    v_cmp_ne_u32_sdwa vcc, v119, v123 src0_sel:WORD_1 src1_sel:WORD_1
    v_alignbyte_b32 v122, v123, v122, 2
    s_mov_b32 s54, 35837
    v_alignbyte_b32 v119, v119, v118, 1
    v_perm_b32 v118, v118, v122, s47
    s_waitcnt lgkmcnt(0)
    v_add3_u32 v124, v124, v106, s54
    v_sub_u32 v125, 0, v124
    v_and_b32 v125, 3, v125
    s_mov_b64 exec, s[80:81]
    v_mov_b32 v125, 0
    v_mov_b32 v120, 0
    s_mov_b64 exec, vcc
    v_mov_b32 v125, 3

    s_mov_b64 exec, -1
    v_alignbyte_b32 v118, v119, v118, v125
    v_alignbyte_b32 v119, v120, v119, v125
    v_add_u32 v124, v124, v125

    buffer_store_dwordx2 v[118:119], v124, s[24:27], 0 offen
L_skw_31:
    s_bitcmp0_b32 s28, 2
    s_cbranch_scc1 L_skw_32
    v_add_u32 v107, 65536, v2
    ds_read_b64 v[110:111], v107 offset:16400
    ds_read_b64 v[112:113], v107 offset:16408
    ds_read_b64 v[114:115], v107 offset:16392

    ds_read_b64 v[118:119], v107 offset:24592
    ds_read_b64 v[120:121], v107 offset:24600
    ds_read_b64 v[122:123], v107 offset:24584

    s_waitcnt lgkmcnt(3)
    v_lshrrev_b32 v116, 16, v111
    ds_read_b32 v116, v116 offset:8192

    s_waitcnt lgkmcnt(1)
    v_lshrrev_b32 v124, 16, v119
    ds_read_b32 v124, v124 offset:8192

    v_cmp_ne_u32_sdwa s[80:81], v111, v113 src0_sel:WORD_1 src1_sel:WORD_1
    v_cmp_ne_u32_sdwa vcc, v111, v115 src0_sel:WORD_1 src1_sel:WORD_1
    v_alignbyte_b32 v114, v115, v114, 2
    s_mov_b32 s54, 40957
    v_alignbyte_b32 v111, v111, v110, 1
    v_perm_b32 v110, v110, v114, s47
    s_waitcnt lgkmcnt(1)
    v_add3_u32 v116, v116, v106, s54
    v_sub_u32 v117, 0, v116
    v_and_b32 v117, 3, v117
    s_mov_b64 exec, s[80:81]
    v_mov_b32 v117, 0
    v_mov_b32 v112, 0
    s_mov_b64 exec, vcc
    v_mov_b32 v117, 3

    s_mov_b64 exec, -1
    v_alignbyte_b32 v110, v111, v110, v117
    v_alignbyte_b32 v111, v112, v111, v117
    v_add_u32 v116, v116, v117

    buffer_store_dwordx2 v[110:111], v116, s[24:27], 0 offen
    v_cmp_ne_u32_sdwa s[80:81], v119, v121 src0_sel:WORD_1 src1_sel:WORD_1
    v_cmp_ne_u32_sdwa vcc, v119, v123 src0_sel:WORD_1 src1_sel:WORD_1
    v_alignbyte_b32 v122, v123, v122, 2
    s_mov_b32 s54, 46077
    v_alignbyte_b32 v119, v119, v118, 1
    v_perm_b32 v118, v118, v122, s47
    s_waitcnt lgkmcnt(0)
    v_add3_u32 v124, v124, v106, s54
    v_sub_u32 v125, 0, v124
    v_and_b32 v125, 3, v125
    s_mov_b64 exec, s[80:81]
    v_mov_b32 v125, 0
    v_mov_b32 v120, 0
    s_mov_b64 exec, vcc
    v_mov_b32 v125, 3

    s_mov_b64 exec, -1
    v_alignbyte_b32 v118, v119, v118, v125
    v_alignbyte_b32 v119, v120, v119, v125
    v_add_u32 v124, v124, v125

    buffer_store_dwordx2 v[118:119], v124, s[24:27], 0 offen
L_skw_32:
    s_bitcmp0_b32 s82, 3
    s_cbranch_scc1 L_ska_33
    s_mov_b64 exec, s[66:67]
    v_mul_hi_u32_u24 v69, s40, v32
    v_mul_hi_u32_u24 v68, s40, v16
    v_mul_hi_u32_u24 v71, s40, v33
    v_mul_hi_u32_u24 v70, s40, v17
    v_mul_hi_u32_u24 v73, s40, v34
    v_mul_hi_u32_u24 v72, s40, v18
    v_mul_hi_u32_u24 v75, s40, v35
    v_mul_hi_u32_u24 v74, s40, v19
    v_and_b32 v69, -2, v69
    v_mad_u32_u24 v16, v68, s43, v16
    v_and_b32 v88, -4, v68
    v_and_b32 v71, -2, v71
    v_mad_u32_u24 v17, v70, s43, v17
    v_and_b32 v89, -4, v70
    v_and_b32 v73, -2, v73
    v_mad_u32_u24 v18, v72, s43, v18
    v_and_b32 v90, -4, v72
    v_and_b32 v75, -2, v75
    v_mad_u32_u24 v19, v74, s43, v19
    v_and_b32 v91, -4, v74
    v_mad_i32_i24 v32, v69, s42, v32
    v_lshl_add_u32 v69, v88, 5, v69
    v_mad_i32_i24 v33, v71, s42, v33
    v_lshl_add_u32 v71, v89, 5, v71
    v_mad_i32_i24 v34, v73, s42, v34
    v_lshl_add_u32 v73, v90, 5, v73
    v_mad_i32_i24 v35, v75, s42, v35
    v_lshl_add_u32 v75, v91, 5, v75
    v_add_u32 v69, v69, v69
    ds_add_rtn_u32 v88, v69, v104
    v_add_u32 v71, v71, v71
    ds_add_rtn_u32 v89, v71, v104
    v_add_u32 v73, v73, v73
    ds_add_rtn_u32 v90, v73, v104
    v_add_u32 v75, v75, v75
    ds_add_rtn_u32 v91, v75, v104
    v_lshlrev_b32 v110, 16, v42
    v_and_b32 v111, 0xffff0000, v42
    v_lshlrev_b32 v112, 16, v43
    v_and_b32 v113, 0xffff0000, v43
    v_mul_f32 v110, s44, v110
    v_mul_f32 v111, s44, v111
    v_mul_f32 v112, s44, v112
    v_mul_f32 v113, s44, v113
    v_fract_f32 v110, v110
    v_fract_f32 v111, v111
    v_fract_f32 v112, v112
    v_fract_f32 v113, v113
    v_cos_f32 v110, v110
    v_cos_f32 v111, v111
    v_cos_f32 v112, v112
    v_cos_f32 v113, v113
    v_lshl_or_b32 v68, v68, 14, v32
    v_perm_b32 v69, v69, v16, s46
    v_bfe_u32 v16, v16, 8, 5

    v_lshl_or_b32 v70, v70, 14, v33
    v_perm_b32 v71, v71, v17, s46
    v_bfe_u32 v17, v17, 8, 5

    v_lshl_or_b32 v72, v72, 14, v34
    v_perm_b32 v73, v73, v18, s46
    v_bfe_u32 v18, v18, 8, 5

    v_lshl_or_b32 v74, v74, 14, v35
    v_perm_b32 v75, v75, v19, s46
    v_bfe_u32 v19, v19, 8, 5

    v_fmaak_f32 v110, v110, v105, 0x4b400010
    v_fmaak_f32 v111, v111, v105, 0x4b400010
    v_fmaak_f32 v112, v112, v105, 0x4b400010
    v_fmaak_f32 v113, v113, v105, 0x4b400010
    v_sub_u32 v110, v110, v16
    v_sub_u32 v111, v111, v17
    v_sub_u32 v112, v112, v18
    v_sub_u32 v113, v113, v19
    v_bfi_b32 v110, 31, v16, v110
    v_bfi_b32 v111, 31, v17, v111
    v_bfi_b32 v112, 31, v18, v112
    v_bfi_b32 v113, 31, v19, v113
    v_perm_b32 v68, v68, v110, s55
    v_perm_b32 v70, v70, v111, s55
    v_perm_b32 v72, v72, v112, s55
    v_perm_b32 v74, v74, v113, s55
    s_mov_b64 exec, -1
L_ska_33:
    s_bitcmp0_b32 s28, 2
    s_cbranch_scc1 L_skw_34
    v_add_u32 v107, 65536, v2
    ds_read_b64 v[110:111], v107 offset:32784
    ds_read_b64 v[112:113], v107 offset:32792
    ds_read_b64 v[114:115], v107 offset:32776

    ds_read_b64 v[118:119], v107 offset:40976
    ds_read_b64 v[120:121], v107 offset:40984
    ds_read_b64 v[122:123], v107 offset:40968

    s_waitcnt lgkmcnt(3)
    v_lshrrev_b32 v116, 16, v111
    ds_read_b32 v116, v116 offset:8192

    s_waitcnt lgkmcnt(1)
    v_lshrrev_b32 v124, 16, v119
    ds_read_b32 v124, v124 offset:8192

    v_cmp_ne_u32_sdwa s[80:81], v111, v113 src0_sel:WORD_1 src1_sel:WORD_1
    v_cmp_ne_u32_sdwa vcc, v111, v115 src0_sel:WORD_1 src1_sel:WORD_1
    v_alignbyte_b32 v114, v115, v114, 2
    s_mov_b32 s54, 51197
    v_alignbyte_b32 v111, v111, v110, 1
    v_perm_b32 v110, v110, v114, s47
    s_waitcnt lgkmcnt(1)
    v_add3_u32 v116, v116, v106, s54
    v_sub_u32 v117, 0, v116
    v_and_b32 v117, 3, v117
    s_mov_b64 exec, s[80:81]
    v_mov_b32 v117, 0
    v_mov_b32 v112, 0
    s_mov_b64 exec, vcc
    v_mov_b32 v117, 3

    s_mov_b64 exec, -1
    v_alignbyte_b32 v110, v111, v110, v117
    v_alignbyte_b32 v111, v112, v111, v117
    v_add_u32 v116, v116, v117

    buffer_store_dwordx2 v[110:111], v116, s[24:27], 0 offen
    v_cmp_ne_u32_sdwa s[80:81], v119, v121 src0_sel:WORD_1 src1_sel:WORD_1
    v_cmp_ne_u32_sdwa vcc, v119, v123 src0_sel:WORD_1 src1_sel:WORD_1
    v_alignbyte_b32 v122, v123, v122, 2
    s_mov_b32 s54, 56317
    v_alignbyte_b32 v119, v119, v118, 1
    v_perm_b32 v118, v118, v122, s47
    s_waitcnt lgkmcnt(0)
    v_add3_u32 v124, v124, v106, s54
    v_sub_u32 v125, 0, v124
    v_and_b32 v125, 3, v125
    s_mov_b64 exec, s[80:81]
    v_mov_b32 v125, 0
    v_mov_b32 v120, 0
    s_mov_b64 exec, vcc
    v_mov_b32 v125, 3

    s_mov_b64 exec, -1
    v_alignbyte_b32 v118, v119, v118, v125
    v_alignbyte_b32 v119, v120, v119, v125
    v_add_u32 v124, v124, v125

    buffer_store_dwordx2 v[118:119], v124, s[24:27], 0 offen
L_skw_34:
    s_bitcmp0_b32 s28, 3
    s_cbranch_scc1 L_skw_35
    v_add_u32 v107, 98304, v2
    ds_read_b64 v[110:111], v107 offset:16400
    ds_read_b64 v[112:113], v107 offset:16408
    ds_read_b64 v[114:115], v107 offset:16392

    ds_read_b64 v[118:119], v107 offset:24592
    ds_read_b64 v[120:121], v107 offset:24600
    ds_read_b64 v[122:123], v107 offset:24584

    s_waitcnt lgkmcnt(3)
    v_lshrrev_b32 v116, 16, v111
    ds_read_b32 v116, v116 offset:8192

    s_waitcnt lgkmcnt(1)
    v_lshrrev_b32 v124, 16, v119
    ds_read_b32 v124, v124 offset:8192

    v_cmp_ne_u32_sdwa s[80:81], v111, v113 src0_sel:WORD_1 src1_sel:WORD_1
    v_cmp_ne_u32_sdwa vcc, v111, v115 src0_sel:WORD_1 src1_sel:WORD_1
    v_alignbyte_b32 v114, v115, v114, 2
    s_mov_b32 s54, 61437
    v_alignbyte_b32 v111, v111, v110, 1
    v_perm_b32 v110, v110, v114, s47
    s_waitcnt lgkmcnt(1)
    v_add3_u32 v116, v116, v106, s54
    v_sub_u32 v117, 0, v116
    v_and_b32 v117, 3, v117
    s_mov_b64 exec, s[80:81]
    v_mov_b32 v117, 0
    v_mov_b32 v112, 0
    s_mov_b64 exec, vcc
    v_mov_b32 v117, 3

    s_mov_b64 exec, -1
    v_alignbyte_b32 v110, v111, v110, v117
    v_alignbyte_b32 v111, v112, v111, v117
    v_add_u32 v116, v116, v117

    buffer_store_dwordx2 v[110:111], v116, s[24:27], 0 offen
    v_cmp_ne_u32_sdwa s[80:81], v119, v121 src0_sel:WORD_1 src1_sel:WORD_1
    v_cmp_ne_u32_sdwa vcc, v119, v123 src0_sel:WORD_1 src1_sel:WORD_1
    v_alignbyte_b32 v122, v123, v122, 2
    s_mov_b32 s54, 66557
    v_alignbyte_b32 v119, v119, v118, 1
    v_perm_b32 v118, v118, v122, s47
    s_waitcnt lgkmcnt(0)
    v_add3_u32 v124, v124, v106, s54
    v_sub_u32 v125, 0, v124
    v_and_b32 v125, 3, v125
    s_mov_b64 exec, s[80:81]
    v_mov_b32 v125, 0
    v_mov_b32 v120, 0
    s_mov_b64 exec, vcc
    v_mov_b32 v125, 3

    s_mov_b64 exec, -1
    v_alignbyte_b32 v118, v119, v118, v125
    v_alignbyte_b32 v119, v120, v119, v125
    v_add_u32 v124, v124, v125

    buffer_store_dwordx2 v[118:119], v124, s[24:27], 0 offen
L_skw_35:
    s_bitcmp0_b32 s28, 3
    s_cbranch_scc1 L_skw_36
    v_add_u32 v107, 98304, v2
    ds_read_b64 v[110:111], v107 offset:32784
    ds_read_b64 v[112:113], v107 offset:32792
    ds_read_b64 v[114:115], v107 offset:32776

    ds_read_b64 v[118:119], v107 offset:40976
    ds_read_b64 v[120:121], v107 offset:40984
    ds_read_b64 v[122:123], v107 offset:40968

    s_waitcnt lgkmcnt(3)
    v_lshrrev_b32 v116, 16, v111
    ds_read_b32 v116, v116 offset:8192

    s_waitcnt lgkmcnt(1)
    v_lshrrev_b32 v124, 16, v119
    ds_read_b32 v124, v124 offset:8192

    v_cmp_ne_u32_sdwa s[80:81], v111, v113 src0_sel:WORD_1 src1_sel:WORD_1
    v_cmp_ne_u32_sdwa vcc, v111, v115 src0_sel:WORD_1 src1_sel:WORD_1
    v_alignbyte_b32 v114, v115, v114, 2
    s_mov_b32 s54, 71677
    v_alignbyte_b32 v111, v111, v110, 1
    v_perm_b32 v110, v110, v114, s47
    s_waitcnt lgkmcnt(1)
    v_add3_u32 v116, v116, v106, s54
    v_sub_u32 v117, 0, v116
    v_and_b32 v117, 3, v117
    s_mov_b64 exec, s[80:81]
    v_mov_b32 v117, 0
    v_mov_b32 v112, 0
    s_mov_b64 exec, vcc
    v_mov_b32 v117, 3

    s_mov_b64 exec, -1
    v_alignbyte_b32 v110, v111, v110, v117
    v_alignbyte_b32 v111, v112, v111, v117
    v_add_u32 v116, v116, v117

    buffer_store_dwordx2 v[110:111], v116, s[24:27], 0 offen
    v_cmp_ne_u32_sdwa s[80:81], v119, v121 src0_sel:WORD_1 src1_sel:WORD_1
    v_cmp_ne_u32_sdwa vcc, v119, v123 src0_sel:WORD_1 src1_sel:WORD_1
    v_alignbyte_b32 v122, v123, v122, 2
    s_mov_b32 s54, 76797
    v_alignbyte_b32 v119, v119, v118, 1
    v_perm_b32 v118, v118, v122, s47
    s_waitcnt lgkmcnt(0)
    v_add3_u32 v124, v124, v106, s54
    v_sub_u32 v125, 0, v124
    v_and_b32 v125, 3, v125
    s_mov_b64 exec, s[80:81]
    v_mov_b32 v125, 0
    v_mov_b32 v120, 0
    s_mov_b64 exec, vcc
    v_mov_b32 v125, 3

    s_andn2_b64 exec, -1, s[68:69]
    v_bfrev_b32 v124, 1
    s_mov_b64 exec, -1
    v_alignbyte_b32 v118, v119, v118, v125
    v_alignbyte_b32 v119, v120, v119, v125
    v_add_u32 v124, v124, v125

    buffer_store_dwordx2 v[118:119], v124, s[24:27], 0 offen
L_skw_36:
    s_waitcnt lgkmcnt(0)
    s_barrier

    buffer_load_dwordx4 v[20:23], v1, s[12:15], s56 offen nt
    buffer_load_dwordx4 v[4:7], v1, s[8:11], s56 offen nt
    buffer_load_dwordx2 v[36:37], v2, s[16:19], s61 offen nt
    ds_read_b64 v[94:95], v2
    s_waitcnt lgkmcnt(0)
    v_and_b32 v94, 0xffff, v94
    v_and_b32 v95, 0xffff, v95
    v_add_u32 v97, v94, v95
    s_nop 1
    v_add_u32_dpp v97, v97, v97 row_shr:1 row_mask:0xf bank_mask:0xf
    s_nop 1
    v_add_u32_dpp v97, v97, v97 row_shr:2 row_mask:0xf bank_mask:0xf
    s_nop 1
    v_add_u32_dpp v97, v97, v97 row_shr:4 row_mask:0xf bank_mask:0xf
    s_nop 1
    v_add_u32_dpp v97, v97, v97 row_shr:8 row_mask:0xf bank_mask:0xf
    s_nop 1
    v_add_u32_dpp v97, v97, v97 row_bcast:15 row_mask:0xa bank_mask:0xf
    s_nop 1
    v_add_u32_dpp v97, v97, v97 row_bcast:31 row_mask:0xc bank_mask:0xf
    s_mov_b32 exec_lo, 0
    s_brev_b32 exec_hi, 1
    ds_add_rtn_u32 v96, v108, v97
    s_mov_b64 exec, -1

    v_add_u32 v92, v94, v94
    v_add_u32 v93, v95, v95
    v_med3_u32 v92, v94, 2, v92
    v_med3_u32 v93, v95, 2, v93
    buffer_atomic_add_x2 v[92:93], v2, s[20:23], 0 offen sc0
    s_waitcnt lgkmcnt(0)
    v_readlane_b32 s77, v96, 63
    v_mul_u32_u24 v114, 7936, v0
    v_sub_u32 v97, v97, v95
    s_sub_u32 s50, s50, s83
    s_sub_u32 s77, s77, s50
    v_add_u32 v97, s77, v97
    v_sub_u32 v96, v97, v94
    v_lshlrev_b32 v111, 16, v97
    v_lshlrev_b32 v110, 16, v96
    ds_write_b64 v2, v[110:111]
    v_sub_u32 v96, v114, v96
    v_sub_u32 v97, v114, v97
    v_add_u32 v97, s48, v97
    s_add_u32 s50, s50, s84
    s_mov_b32 s28, s82
    s_mov_b32 s29, s83
    s_mov_b32 s30, s84
    s_lshl_b32 s74, s29, 3
    s_lshl_b32 s75, s30, 3
    v_mov_b32 v125, s74
    v_mov_b32 v126, s75
    v_mov_b32 v127, -1

    s_waitcnt lgkmcnt(0)
    s_barrier

    s_mov_b64 exec, 1
    ds_write_b32 v125, v127 offset:16396
    ds_write_b32 v126, v127 offset:16404
    s_mov_b64 exec, -1

    buffer_load_dwordx4 v[24:27], v1, s[12:15], s57 offen nt
    buffer_load_dwordx4 v[8:11], v1, s[8:11], s57 offen nt
    buffer_load_dwordx2 v[38:39], v2, s[16:19], s62 offen nt
    s_bitcmp0_b32 s28, 0
    s_cbranch_scc1 L_skz_37
    v_lshrrev_b32 v110, 16, v45
    ds_read_b32 v110, v110
    v_lshrrev_b32 v111, 16, v47
    ds_read_b32 v111, v111
    v_lshrrev_b32 v112, 16, v49
    ds_read_b32 v112, v112
    v_lshrrev_b32 v113, 16, v51
    ds_read_b32 v113, v113
    v_lshrrev_b32 v114, 16, v53
    ds_read_b32 v114, v114
    v_lshrrev_b32 v115, 16, v55
    ds_read_b32 v115, v115
    v_lshrrev_b32 v116, 16, v57
    ds_read_b32 v116, v116
    v_lshrrev_b32 v117, 16, v59
    ds_read_b32 v117, v117
    s_waitcnt lgkmcnt(7)
    v_add_u32_sdwa v110, v110, v76 dst_sel:DWORD dst_unused:UNUSED_PAD src0_sel:WORD_1 src1_sel:WORD_0
    v_lshlrev_b32 v110, 3, v110
    ds_write_b64 v110, v[44:45] offset:16400

    s_waitcnt lgkmcnt(7)
    v_add_u32_sdwa v111, v111, v77 dst_sel:DWORD dst_unused:UNUSED_PAD src0_sel:WORD_1 src1_sel:WORD_0
    v_lshlrev_b32 v111, 3, v111
    ds_write_b64 v111, v[46:47] offset:16400

    s_waitcnt lgkmcnt(7)
    v_add_u32_sdwa v112, v112, v78 dst_sel:DWORD dst_unused:UNUSED_PAD src0_sel:WORD_1 src1_sel:WORD_0
    v_lshlrev_b32 v112, 3, v112
    ds_write_b64 v112, v[48:49] offset:16400

    s_waitcnt lgkmcnt(7)
    v_add_u32_sdwa v113, v113, v79 dst_sel:DWORD dst_unused:UNUSED_PAD src0_sel:WORD_1 src1_sel:WORD_0
    v_lshlrev_b32 v113, 3, v113
    ds_write_b64 v113, v[50:51] offset:16400

    s_waitcnt lgkmcnt(7)
    v_add_u32_sdwa v114, v114, v80 dst_sel:DWORD dst_unused:UNUSED_PAD src0_sel:WORD_1 src1_sel:WORD_0
    v_lshlrev_b32 v114, 3, v114
    ds_write_b64 v114, v[52:53] offset:16400

    s_waitcnt lgkmcnt(7)
    v_add_u32_sdwa v115, v115, v81 dst_sel:DWORD dst_unused:UNUSED_PAD src0_sel:WORD_1 src1_sel:WORD_0
    v_lshlrev_b32 v115, 3, v115
    ds_write_b64 v115, v[54:55] offset:16400

    s_waitcnt lgkmcnt(7)
    v_add_u32_sdwa v116, v116, v82 dst_sel:DWORD dst_unused:UNUSED_PAD src0_sel:WORD_1 src1_sel:WORD_0
    v_lshlrev_b32 v116, 3, v116
    ds_write_b64 v116, v[56:57] offset:16400

    s_waitcnt lgkmcnt(7)
    v_add_u32_sdwa v117, v117, v83 dst_sel:DWORD dst_unused:UNUSED_PAD src0_sel:WORD_1 src1_sel:WORD_0
    v_lshlrev_b32 v117, 3, v117
    ds_write_b64 v117, v[58:59] offset:16400

L_skz_37:
    buffer_load_dwordx4 v[28:31], v1, s[12:15], s58 offen nt
    buffer_load_dwordx4 v[12:15], v1, s[8:11], s58 offen nt
    buffer_load_dwordx2 v[40:41], v2, s[16:19], s63 offen nt
    s_bitcmp0_b32 s28, 2
    s_cbranch_scc1 L_skz_38
    v_lshrrev_b32 v110, 16, v61
    ds_read_b32 v110, v110
    v_lshrrev_b32 v111, 16, v63
    ds_read_b32 v111, v111
    v_lshrrev_b32 v112, 16, v65
    ds_read_b32 v112, v112
    v_lshrrev_b32 v113, 16, v67
    ds_read_b32 v113, v113
    s_waitcnt lgkmcnt(3)
    v_add_u32_sdwa v110, v110, v84 dst_sel:DWORD dst_unused:UNUSED_PAD src0_sel:WORD_1 src1_sel:WORD_0
    v_lshlrev_b32 v110, 3, v110
    ds_write_b64 v110, v[60:61] offset:16400

    s_waitcnt lgkmcnt(3)
    v_add_u32_sdwa v111, v111, v85 dst_sel:DWORD dst_unused:UNUSED_PAD src0_sel:WORD_1 src1_sel:WORD_0
    v_lshlrev_b32 v111, 3, v111
    ds_write_b64 v111, v[62:63] offset:16400

    s_waitcnt lgkmcnt(3)
    v_add_u32_sdwa v112, v112, v86 dst_sel:DWORD dst_unused:UNUSED_PAD src0_sel:WORD_1 src1_sel:WORD_0
    v_lshlrev_b32 v112, 3, v112
    ds_write_b64 v112, v[64:65] offset:16400

    s_waitcnt lgkmcnt(3)
    v_add_u32_sdwa v113, v113, v87 dst_sel:DWORD dst_unused:UNUSED_PAD src0_sel:WORD_1 src1_sel:WORD_0
    v_lshlrev_b32 v113, 3, v113
    ds_write_b64 v113, v[66:67] offset:16400

L_skz_38:
    s_bitcmp0_b32 s28, 3
    s_cbranch_scc1 L_skz_39
    s_mov_b64 exec, s[66:67]
    v_lshrrev_b32 v110, 16, v69
    ds_read_b32 v110, v110
    v_lshrrev_b32 v111, 16, v71
    ds_read_b32 v111, v111
    v_lshrrev_b32 v112, 16, v73
    ds_read_b32 v112, v112
    v_lshrrev_b32 v113, 16, v75
    ds_read_b32 v113, v113
    s_waitcnt lgkmcnt(3)
    v_add_u32_sdwa v110, v110, v88 dst_sel:DWORD dst_unused:UNUSED_PAD src0_sel:WORD_1 src1_sel:WORD_0
    v_lshlrev_b32 v110, 3, v110
    ds_write_b64 v110, v[68:69] offset:16400

    s_waitcnt lgkmcnt(3)
    v_add_u32_sdwa v111, v111, v89 dst_sel:DWORD dst_unused:UNUSED_PAD src0_sel:WORD_1 src1_sel:WORD_0
    v_lshlrev_b32 v111, 3, v111
    ds_write_b64 v111, v[70:71] offset:16400

    s_waitcnt lgkmcnt(3)
    v_add_u32_sdwa v112, v112, v90 dst_sel:DWORD dst_unused:UNUSED_PAD src0_sel:WORD_1 src1_sel:WORD_0
    v_lshlrev_b32 v112, 3, v112
    ds_write_b64 v112, v[72:73] offset:16400

    s_waitcnt lgkmcnt(3)
    v_add_u32_sdwa v113, v113, v91 dst_sel:DWORD dst_unused:UNUSED_PAD src0_sel:WORD_1 src1_sel:WORD_0
    v_lshlrev_b32 v113, 3, v113
    ds_write_b64 v113, v[74:75] offset:16400

    s_mov_b64 exec, -1
L_skz_39:
    buffer_load_dwordx4 v[32:35], v1, s[12:15], s59 offen nt
    buffer_load_dwordx4 v[16:19], v1, s[8:11], s59 offen nt
    buffer_load_dwordx2 v[42:43], v2, s[16:19], s64 offen nt
    s_cmp_lg_u32 s49, 0
    s_cbranch_scc1 L_p1loop_5
L_p1epi_6:
    s_waitcnt vmcnt(0)
    s_waitcnt vmcnt(9)
    v_add_u32 v110, v92, v94
    v_min_u32 v92, s48, v92
    v_add_u32 v111, v93, v95
    v_min_u32 v93, s48, v93
    v_max_u32 v110, v110, v111
    v_add_u32 v92, v92, v96
    v_add_u32 v93, v93, v97
    v_cmp_le_u32 vcc, s48, v110
    v_lshl_add_u32 v92, v92, 2, v92
    v_lshl_add_u32 v93, v93, 2, v93
    ds_write_b64 v2, v[92:93] offset:8192
    s_cbranch_vccz L_noov_40
    ds_write_b32 v108, v104 offset:4
L_noov_40:

    s_waitcnt lgkmcnt(0)
    s_barrier
    ds_read_b32 v110, v108 offset:4
    s_waitcnt lgkmcnt(0)
    v_readfirstlane_b32 s53, v110
    s_nop 1

    s_cmp_lg_u32 s53, 0
    s_cbranch_scc1 L_slow_41
L_sback_42:
    s_bitcmp0_b32 s28, 0
    s_cbranch_scc1 L_skw_46
    ds_read_b64 v[4:5], v2 offset:16400
    ds_read_b64 v[6:7], v2 offset:16408
    ds_read_b64 v[8:9], v2 offset:16392

    ds_read_b64 v[12:13], v2 offset:24592
    ds_read_b64 v[14:15], v2 offset:24600
    ds_read_b64 v[16:17], v2 offset:24584

    ds_read_b64 v[20:21], v2 offset:32784
    ds_read_b64 v[22:23], v2 offset:32792
    ds_read_b64 v[24:25], v2 offset:32776

    ds_read_b64 v[28:29], v2 offset:40976
    ds_read_b64 v[30:31], v2 offset:40984
    ds_read_b64 v[32:33], v2 offset:40968

    s_waitcnt lgkmcnt(9)
    v_lshrrev_b32 v10, 16, v5
    ds_read_b32 v10, v10 offset:8192

    s_waitcnt lgkmcnt(7)
    v_lshrrev_b32 v18, 16, v13
    ds_read_b32 v18, v18 offset:8192

    s_waitcnt lgkmcnt(5)
    v_lshrrev_b32 v26, 16, v21
    ds_read_b32 v26, v26 offset:8192

    s_waitcnt lgkmcnt(3)
    v_lshrrev_b32 v34, 16, v29
    ds_read_b32 v34, v34 offset:8192

    v_cmp_ne_u32_sdwa s[80:81], v5, v7 src0_sel:WORD_1 src1_sel:WORD_1
    v_cmp_ne_u32_sdwa vcc, v5, v9 src0_sel:WORD_1 src1_sel:WORD_1
    v_alignbyte_b32 v8, v9, v8, 2
    s_mov_b32 s54, -3
    v_alignbyte_b32 v5, v5, v4, 1
    v_perm_b32 v4, v4, v8, s47
    s_waitcnt lgkmcnt(3)
    v_add3_u32 v10, v10, v106, s54
    v_sub_u32 v11, 0, v10
    v_and_b32 v11, 3, v11
    s_mov_b64 exec, s[80:81]
    v_mov_b32 v11, 0
    v_mov_b32 v6, 0
    s_mov_b64 exec, vcc
    v_mov_b32 v11, 3

    s_mov_b64 exec, -1
    v_alignbyte_b32 v4, v5, v4, v11
    v_alignbyte_b32 v5, v6, v5, v11
    v_add_u32 v10, v10, v11

    buffer_store_dwordx2 v[4:5], v10, s[24:27], 0 offen
    v_cmp_ne_u32_sdwa s[80:81], v13, v15 src0_sel:WORD_1 src1_sel:WORD_1
    v_cmp_ne_u32_sdwa vcc, v13, v17 src0_sel:WORD_1 src1_sel:WORD_1
    v_alignbyte_b32 v16, v17, v16, 2
    s_mov_b32 s54, 5117
    v_alignbyte_b32 v13, v13, v12, 1
    v_perm_b32 v12, v12, v16, s47
    s_waitcnt lgkmcnt(2)
    v_add3_u32 v18, v18, v106, s54
    v_sub_u32 v19, 0, v18
    v_and_b32 v19, 3, v19
    s_mov_b64 exec, s[80:81]
    v_mov_b32 v19, 0
    v_mov_b32 v14, 0
    s_mov_b64 exec, vcc
    v_mov_b32 v19, 3

    s_mov_b64 exec, -1
    v_alignbyte_b32 v12, v13, v12, v19
    v_alignbyte_b32 v13, v14, v13, v19
    v_add_u32 v18, v18, v19

    buffer_store_dwordx2 v[12:13], v18, s[24:27], 0 offen
    v_cmp_ne_u32_sdwa s[80:81], v21, v23 src0_sel:WORD_1 src1_sel:WORD_1
    v_cmp_ne_u32_sdwa vcc, v21, v25 src0_sel:WORD_1 src1_sel:WORD_1
    v_alignbyte_b32 v24, v25, v24, 2
    s_mov_b32 s54, 10237
    v_alignbyte_b32 v21, v21, v20, 1
    v_perm_b32 v20, v20, v24, s47
    s_waitcnt lgkmcnt(1)
    v_add3_u32 v26, v26, v106, s54
    v_sub_u32 v27, 0, v26
    v_and_b32 v27, 3, v27
    s_mov_b64 exec, s[80:81]
    v_mov_b32 v27, 0
    v_mov_b32 v22, 0
    s_mov_b64 exec, vcc
    v_mov_b32 v27, 3

    s_mov_b64 exec, -1
    v_alignbyte_b32 v20, v21, v20, v27
    v_alignbyte_b32 v21, v22, v21, v27
    v_add_u32 v26, v26, v27

    buffer_store_dwordx2 v[20:21], v26, s[24:27], 0 offen
    v_cmp_ne_u32_sdwa s[80:81], v29, v31 src0_sel:WORD_1 src1_sel:WORD_1
    v_cmp_ne_u32_sdwa vcc, v29, v33 src0_sel:WORD_1 src1_sel:WORD_1
    v_alignbyte_b32 v32, v33, v32, 2
    s_mov_b32 s54, 15357
    v_alignbyte_b32 v29, v29, v28, 1
    v_perm_b32 v28, v28, v32, s47
    s_waitcnt lgkmcnt(0)
    v_add3_u32 v34, v34, v106, s54
    v_sub_u32 v35, 0, v34
    v_and_b32 v35, 3, v35
    s_mov_b64 exec, s[80:81]
    v_mov_b32 v35, 0
    v_mov_b32 v30, 0
    s_mov_b64 exec, vcc
    v_mov_b32 v35, 3

    s_mov_b64 exec, -1
    v_alignbyte_b32 v28, v29, v28, v35
    v_alignbyte_b32 v29, v30, v29, v35
    v_add_u32 v34, v34, v35

    buffer_store_dwordx2 v[28:29], v34, s[24:27], 0 offen
L_skw_46:
    s_bitcmp0_b32 s28, 1
    s_cbranch_scc1 L_skw_47
    v_add_u32 v107, 32768, v2
    ds_read_b64 v[4:5], v107 offset:16400
    ds_read_b64 v[6:7], v107 offset:16408
    ds_read_b64 v[8:9], v107 offset:16392

    ds_read_b64 v[12:13], v107 offset:24592
    ds_read_b64 v[14:15], v107 offset:24600
    ds_read_b64 v[16:17], v107 offset:24584

    ds_read_b64 v[20:21], v107 offset:32784
    ds_read_b64 v[22:23], v107 offset:32792
    ds_read_b64 v[24:25], v107 offset:32776

    ds_read_b64 v[28:29], v107 offset:40976
    ds_read_b64 v[30:31], v107 offset:40984
    ds_read_b64 v[32:33], v107 offset:40968

    s_waitcnt lgkmcnt(9)
    v_lshrrev_b32 v10, 16, v5
    ds_read_b32 v10, v10 offset:8192

    s_waitcnt lgkmcnt(7)
    v_lshrrev_b32 v18, 16, v13
    ds_read_b32 v18, v18 offset:8192

    s_waitcnt lgkmcnt(5)
    v_lshrrev_b32 v26, 16, v21
    ds_read_b32 v26, v26 offset:8192

    s_waitcnt lgkmcnt(3)
    v_lshrrev_b32 v34, 16, v29
    ds_read_b32 v34, v34 offset:8192

    v_cmp_ne_u32_sdwa s[80:81], v5, v7 src0_sel:WORD_1 src1_sel:WORD_1
    v_cmp_ne_u32_sdwa vcc, v5, v9 src0_sel:WORD_1 src1_sel:WORD_1
    v_alignbyte_b32 v8, v9, v8, 2
    s_mov_b32 s54, 20477
    v_alignbyte_b32 v5, v5, v4, 1
    v_perm_b32 v4, v4, v8, s47
    s_waitcnt lgkmcnt(3)
    v_add3_u32 v10, v10, v106, s54
    v_sub_u32 v11, 0, v10
    v_and_b32 v11, 3, v11
    s_mov_b64 exec, s[80:81]
    v_mov_b32 v11, 0
    v_mov_b32 v6, 0
    s_mov_b64 exec, vcc
    v_mov_b32 v11, 3

    s_mov_b64 exec, -1
    v_alignbyte_b32 v4, v5, v4, v11
    v_alignbyte_b32 v5, v6, v5, v11
    v_add_u32 v10, v10, v11

    buffer_store_dwordx2 v[4:5], v10, s[24:27], 0 offen
    v_cmp_ne_u32_sdwa s[80:81], v13, v15 src0_sel:WORD_1 src1_sel:WORD_1
    v_cmp_ne_u32_sdwa vcc, v13, v17 src0_sel:WORD_1 src1_sel:WORD_1
    v_alignbyte_b32 v16, v17, v16, 2
    s_mov_b32 s54, 25597
    v_alignbyte_b32 v13, v13, v12, 1
    v_perm_b32 v12, v12, v16, s47
    s_waitcnt lgkmcnt(2)
    v_add3_u32 v18, v18, v106, s54
    v_sub_u32 v19, 0, v18
    v_and_b32 v19, 3, v19
    s_mov_b64 exec, s[80:81]
    v_mov_b32 v19, 0
    v_mov_b32 v14, 0
    s_mov_b64 exec, vcc
    v_mov_b32 v19, 3

    s_mov_b64 exec, -1
    v_alignbyte_b32 v12, v13, v12, v19
    v_alignbyte_b32 v13, v14, v13, v19
    v_add_u32 v18, v18, v19

    buffer_store_dwordx2 v[12:13], v18, s[24:27], 0 offen
    v_cmp_ne_u32_sdwa s[80:81], v21, v23 src0_sel:WORD_1 src1_sel:WORD_1
    v_cmp_ne_u32_sdwa vcc, v21, v25 src0_sel:WORD_1 src1_sel:WORD_1
    v_alignbyte_b32 v24, v25, v24, 2
    s_mov_b32 s54, 30717
    v_alignbyte_b32 v21, v21, v20, 1
    v_perm_b32 v20, v20, v24, s47
    s_waitcnt lgkmcnt(1)
    v_add3_u32 v26, v26, v106, s54
    v_sub_u32 v27, 0, v26
    v_and_b32 v27, 3, v27
    s_mov_b64 exec, s[80:81]
    v_mov_b32 v27, 0
    v_mov_b32 v22, 0
    s_mov_b64 exec, vcc
    v_mov_b32 v27, 3

    s_mov_b64 exec, -1
    v_alignbyte_b32 v20, v21, v20, v27
    v_alignbyte_b32 v21, v22, v21, v27
    v_add_u32 v26, v26, v27

    buffer_store_dwordx2 v[20:21], v26, s[24:27], 0 offen
    v_cmp_ne_u32_sdwa s[80:81], v29, v31 src0_sel:WORD_1 src1_sel:WORD_1
    v_cmp_ne_u32_sdwa vcc, v29, v33 src0_sel:WORD_1 src1_sel:WORD_1
    v_alignbyte_b32 v32, v33, v32, 2
    s_mov_b32 s54, 35837
    v_alignbyte_b32 v29, v29, v28, 1
    v_perm_b32 v28, v28, v32, s47
    s_waitcnt lgkmcnt(0)
    v_add3_u32 v34, v34, v106, s54
    v_sub_u32 v35, 0, v34
    v_and_b32 v35, 3, v35
    s_mov_b64 exec, s[80:81]
    v_mov_b32 v35, 0
    v_mov_b32 v30, 0
    s_mov_b64 exec, vcc
    v_mov_b32 v35, 3

    s_mov_b64 exec, -1
    v_alignbyte_b32 v28, v29, v28, v35
    v_alignbyte_b32 v29, v30, v29, v35
    v_add_u32 v34, v34, v35

    buffer_store_dwordx2 v[28:29], v34, s[24:27], 0 offen
L_skw_47:
    s_bitcmp0_b32 s28, 2
    s_cbranch_scc1 L_skw_48
    v_add_u32 v107, 65536, v2
    ds_read_b64 v[4:5], v107 offset:16400
    ds_read_b64 v[6:7], v107 offset:16408
    ds_read_b64 v[8:9], v107 offset:16392

    ds_read_b64 v[12:13], v107 offset:24592
    ds_read_b64 v[14:15], v107 offset:24600
    ds_read_b64 v[16:17], v107 offset:24584

    ds_read_b64 v[20:21], v107 offset:32784
    ds_read_b64 v[22:23], v107 offset:32792
    ds_read_b64 v[24:25], v107 offset:32776

    ds_read_b64 v[28:29], v107 offset:40976
    ds_read_b64 v[30:31], v107 offset:40984
    ds_read_b64 v[32:33], v107 offset:40968

    s_waitcnt lgkmcnt(9)
    v_lshrrev_b32 v10, 16, v5
    ds_read_b32 v10, v10 offset:8192

    s_waitcnt lgkmcnt(7)
    v_lshrrev_b32 v18, 16, v13
    ds_read_b32 v18, v18 offset:8192

    s_waitcnt lgkmcnt(5)
    v_lshrrev_b32 v26, 16, v21
    ds_read_b32 v26, v26 offset:8192

    s_waitcnt lgkmcnt(3)
    v_lshrrev_b32 v34, 16, v29
    ds_read_b32 v34, v34 offset:8192

    v_cmp_ne_u32_sdwa s[80:81], v5, v7 src0_sel:WORD_1 src1_sel:WORD_1
    v_cmp_ne_u32_sdwa vcc, v5, v9 src0_sel:WORD_1 src1_sel:WORD_1
    v_alignbyte_b32 v8, v9, v8, 2
    s_mov_b32 s54, 40957
    v_alignbyte_b32 v5, v5, v4, 1
    v_perm_b32 v4, v4, v8, s47
    s_waitcnt lgkmcnt(3)
    v_add3_u32 v10, v10, v106, s54
    v_sub_u32 v11, 0, v10
    v_and_b32 v11, 3, v11
    s_mov_b64 exec, s[80:81]
    v_mov_b32 v11, 0
    v_mov_b32 v6, 0
    s_mov_b64 exec, vcc
    v_mov_b32 v11, 3

    s_mov_b64 exec, -1
    v_alignbyte_b32 v4, v5, v4, v11
    v_alignbyte_b32 v5, v6, v5, v11
    v_add_u32 v10, v10, v11

    buffer_store_dwordx2 v[4:5], v10, s[24:27], 0 offen
    v_cmp_ne_u32_sdwa s[80:81], v13, v15 src0_sel:WORD_1 src1_sel:WORD_1
    v_cmp_ne_u32_sdwa vcc, v13, v17 src0_sel:WORD_1 src1_sel:WORD_1
    v_alignbyte_b32 v16, v17, v16, 2
    s_mov_b32 s54, 46077
    v_alignbyte_b32 v13, v13, v12, 1
    v_perm_b32 v12, v12, v16, s47
    s_waitcnt lgkmcnt(2)
    v_add3_u32 v18, v18, v106, s54
    v_sub_u32 v19, 0, v18
    v_and_b32 v19, 3, v19
    s_mov_b64 exec, s[80:81]
    v_mov_b32 v19, 0
    v_mov_b32 v14, 0
    s_mov_b64 exec, vcc
    v_mov_b32 v19, 3

    s_mov_b64 exec, -1
    v_alignbyte_b32 v12, v13, v12, v19
    v_alignbyte_b32 v13, v14, v13, v19
    v_add_u32 v18, v18, v19

    buffer_store_dwordx2 v[12:13], v18, s[24:27], 0 offen
    v_cmp_ne_u32_sdwa s[80:81], v21, v23 src0_sel:WORD_1 src1_sel:WORD_1
    v_cmp_ne_u32_sdwa vcc, v21, v25 src0_sel:WORD_1 src1_sel:WORD_1
    v_alignbyte_b32 v24, v25, v24, 2
    s_mov_b32 s54, 51197
    v_alignbyte_b32 v21, v21, v20, 1
    v_perm_b32 v20, v20, v24, s47
    s_waitcnt lgkmcnt(1)
    v_add3_u32 v26, v26, v106, s54
    v_sub_u32 v27, 0, v26
    v_and_b32 v27, 3, v27
    s_mov_b64 exec, s[80:81]
    v_mov_b32 v27, 0
    v_mov_b32 v22, 0
    s_mov_b64 exec, vcc
    v_mov_b32 v27, 3

    s_mov_b64 exec, -1
    v_alignbyte_b32 v20, v21, v20, v27
    v_alignbyte_b32 v21, v22, v21, v27
    v_add_u32 v26, v26, v27

    buffer_store_dwordx2 v[20:21], v26, s[24:27], 0 offen
    v_cmp_ne_u32_sdwa s[80:81], v29, v31 src0_sel:WORD_1 src1_sel:WORD_1
    v_cmp_ne_u32_sdwa vcc, v29, v33 src0_sel:WORD_1 src1_sel:WORD_1
    v_alignbyte_b32 v32, v33, v32, 2
    s_mov_b32 s54, 56317
    v_alignbyte_b32 v29, v29, v28, 1
    v_perm_b32 v28, v28, v32, s47
    s_waitcnt lgkmcnt(0)
    v_add3_u32 v34, v34, v106, s54
    v_sub_u32 v35, 0, v34
    v_and_b32 v35, 3, v35
    s_mov_b64 exec, s[80:81]
    v_mov_b32 v35, 0
    v_mov_b32 v30, 0
    s_mov_b64 exec, vcc
    v_mov_b32 v35, 3

    s_mov_b64 exec, -1
    v_alignbyte_b32 v28, v29, v28, v35
    v_alignbyte_b32 v29, v30, v29, v35
    v_add_u32 v34, v34, v35

    buffer_store_dwordx2 v[28:29], v34, s[24:27], 0 offen
L_skw_48:
    s_bitcmp0_b32 s28, 3
    s_cbranch_scc1 L_skw_49
    v_add_u32 v107, 98304, v2
    ds_read_b64 v[4:5], v107 offset:16400
    ds_read_b64 v[6:7], v107 offset:16408
    ds_read_b64 v[8:9], v107 offset:16392

    ds_read_b64 v[12:13], v107 offset:24592
    ds_read_b64 v[14:15], v107 offset:24600
    ds_read_b64 v[16:17], v107 offset:24584

    ds_read_b64 v[20:21], v107 offset:32784
    ds_read_b64 v[22:23], v107 offset:32792
    ds_read_b64 v[24:25], v107 offset:32776

    ds_read_b64 v[28:29], v107 offset:40976
    ds_read_b64 v[30:31], v107 offset:40984
    ds_read_b64 v[32:33], v107 offset:40968

    s_waitcnt lgkmcnt(9)
    v_lshrrev_b32 v10, 16, v5
    ds_read_b32 v10, v10 offset:8192

    s_waitcnt lgkmcnt(7)
    v_lshrrev_b32 v18, 16, v13
    ds_read_b32 v18, v18 offset:8192

    s_waitcnt lgkmcnt(5)
    v_lshrrev_b32 v26, 16, v21
    ds_read_b32 v26, v26 offset:8192

    s_waitcnt lgkmcnt(3)
    v_lshrrev_b32 v34, 16, v29
    ds_read_b32 v34, v34 offset:8192

    v_cmp_ne_u32_sdwa s[80:81], v5, v7 src0_sel:WORD_1 src1_sel:WORD_1
    v_cmp_ne_u32_sdwa vcc, v5, v9 src0_sel:WORD_1 src1_sel:WORD_1
    v_alignbyte_b32 v8, v9, v8, 2
    s_mov_b32 s54, 61437
    v_alignbyte_b32 v5, v5, v4, 1
    v_perm_b32 v4, v4, v8, s47
    s_waitcnt lgkmcnt(3)
    v_add3_u32 v10, v10, v106, s54
    v_sub_u32 v11, 0, v10
    v_and_b32 v11, 3, v11
    s_mov_b64 exec, s[80:81]
    v_mov_b32 v11, 0
    v_mov_b32 v6, 0
    s_mov_b64 exec, vcc
    v_mov_b32 v11, 3

    s_mov_b64 exec, -1
    v_alignbyte_b32 v4, v5, v4, v11
    v_alignbyte_b32 v5, v6, v5, v11
    v_add_u32 v10, v10, v11

    buffer_store_dwordx2 v[4:5], v10, s[24:27], 0 offen
    v_cmp_ne_u32_sdwa s[80:81], v13, v15 src0_sel:WORD_1 src1_sel:WORD_1
    v_cmp_ne_u32_sdwa vcc, v13, v17 src0_sel:WORD_1 src1_sel:WORD_1
    v_alignbyte_b32 v16, v17, v16, 2
    s_mov_b32 s54, 66557
    v_alignbyte_b32 v13, v13, v12, 1
    v_perm_b32 v12, v12, v16, s47
    s_waitcnt lgkmcnt(2)
    v_add3_u32 v18, v18, v106, s54
    v_sub_u32 v19, 0, v18
    v_and_b32 v19, 3, v19
    s_mov_b64 exec, s[80:81]
    v_mov_b32 v19, 0
    v_mov_b32 v14, 0
    s_mov_b64 exec, vcc
    v_mov_b32 v19, 3

    s_mov_b64 exec, -1
    v_alignbyte_b32 v12, v13, v12, v19
    v_alignbyte_b32 v13, v14, v13, v19
    v_add_u32 v18, v18, v19

    buffer_store_dwordx2 v[12:13], v18, s[24:27], 0 offen
    v_cmp_ne_u32_sdwa s[80:81], v21, v23 src0_sel:WORD_1 src1_sel:WORD_1
    v_cmp_ne_u32_sdwa vcc, v21, v25 src0_sel:WORD_1 src1_sel:WORD_1
    v_alignbyte_b32 v24, v25, v24, 2
    s_mov_b32 s54, 71677
    v_alignbyte_b32 v21, v21, v20, 1
    v_perm_b32 v20, v20, v24, s47
    s_waitcnt lgkmcnt(1)
    v_add3_u32 v26, v26, v106, s54
    v_sub_u32 v27, 0, v26
    v_and_b32 v27, 3, v27
    s_mov_b64 exec, s[80:81]
    v_mov_b32 v27, 0
    v_mov_b32 v22, 0
    s_mov_b64 exec, vcc
    v_mov_b32 v27, 3

    s_mov_b64 exec, -1
    v_alignbyte_b32 v20, v21, v20, v27
    v_alignbyte_b32 v21, v22, v21, v27
    v_add_u32 v26, v26, v27

    buffer_store_dwordx2 v[20:21], v26, s[24:27], 0 offen
    v_cmp_ne_u32_sdwa s[80:81], v29, v31 src0_sel:WORD_1 src1_sel:WORD_1
    v_cmp_ne_u32_sdwa vcc, v29, v33 src0_sel:WORD_1 src1_sel:WORD_1
    v_alignbyte_b32 v32, v33, v32, 2
    s_mov_b32 s54, 76797
    v_alignbyte_b32 v29, v29, v28, 1
    v_perm_b32 v28, v28, v32, s47
    s_waitcnt lgkmcnt(0)
    v_add3_u32 v34, v34, v106, s54
    v_sub_u32 v35, 0, v34
    v_and_b32 v35, 3, v35
    s_mov_b64 exec, s[80:81]
    v_mov_b32 v35, 0
    v_mov_b32 v30, 0
    s_mov_b64 exec, vcc
    v_mov_b32 v35, 3

    s_andn2_b64 exec, -1, s[68:69]
    v_bfrev_b32 v34, 1
    s_mov_b64 exec, -1
    v_alignbyte_b32 v28, v29, v28, v35
    v_alignbyte_b32 v29, v30, v29, v35
    v_add_u32 v34, v34, v35

    buffer_store_dwordx2 v[28:29], v34, s[24:27], 0 offen
L_skw_49:
L_p1done_1:
    s_endpgm

L_slow_22:
    v_add_u32 v112, s29, v0
    v_mov_b32 v118, 0
    s_mov_b32 s75, 4960
L_sl_24:
    v_lshlrev_b32 v113, 3, v112
    ds_read_b64 v[110:111], v113 offset:16400
    ds_read_b32 v119, v113 offset:16412
    ds_read_b32 v120, v113 offset:16396
    s_waitcnt lgkmcnt(0)
    v_lshrrev_b32 v114, 16, v111
    ds_read_b32 v115, v114 offset:8192
    v_add_u32 v114, 4, v114
    v_mul_u32_u24 v114, s75, v114
    s_waitcnt lgkmcnt(0)
    v_mad_u32_u24 v115, v112, 5, v115
    v_cmp_gt_u32 s[72:73], s30, v112
    v_cmp_ge_u32 vcc, v115, v114
    s_and_b64 s[80:81], vcc, s[72:73]
    s_cbranch_scc0 L_s1_25
    s_bcnt1_i32_b64 s76, s[80:81]
    v_mbcnt_lo_u32_b32 v117, s80, 0
    v_mbcnt_hi_u32_b32 v117, s81, v117
    v_mov_b32 v116, s76
    s_mov_b64 exec, 1
    buffer_atomic_add v116, v118, s[36:39], 0 offen sc0
    s_waitcnt vmcnt(0)
    v_readfirstlane_b32 s76, v116
    s_mov_b64 exec, s[80:81]
    s_nop 0
    v_add_lshl_u32 v116, v117, s76, 3
    buffer_store_dwordx2 v[110:111], v116, s[32:35], 0 offen
L_s1_25:
    s_andn2_b64 exec, s[72:73], vcc
    s_cbranch_execz L_s2_26
    buffer_store_dword v110, v115, s[24:27], 0 offen
    buffer_store_byte v111, v115, s[24:27], 0 offen offset:4
    v_add_u32 v115, 5, v115
    v_cmpx_lt_u32 vcc, v115, v114
    v_cmpx_ne_u32_sdwa vcc, v111, v119 src0_sel:WORD_1 src1_sel:WORD_1
    v_cmpx_ne_u32_sdwa vcc, v111, v120 src0_sel:WORD_1 src1_sel:WORD_1
    s_cbranch_execz L_s2_26
    buffer_store_dword v118, v115, s[24:27], 0 offen
L_s2_26:
    s_mov_b64 exec, -1
    v_add_u32 v112, 1024, v112
    s_nop 0
    v_readfirstlane_b32 s76, v112
    s_nop 1
    s_cmp_lt_u32 s76, s30
    s_cbranch_scc1 L_sl_24
    s_mov_b32 s28, 0
    s_branch L_sback_23

L_slow_41:
    v_add_u32 v112, s29, v0
    v_mov_b32 v118, 0
    s_mov_b32 s75, 4960
L_sl_43:
    v_lshlrev_b32 v113, 3, v112
    ds_read_b64 v[110:111], v113 offset:16400
    ds_read_b32 v119, v113 offset:16412
    ds_read_b32 v120, v113 offset:16396
    s_waitcnt lgkmcnt(0)
    v_lshrrev_b32 v114, 16, v111
    ds_read_b32 v115, v114 offset:8192
    v_add_u32 v114, 4, v114
    v_mul_u32_u24 v114, s75, v114
    s_waitcnt lgkmcnt(0)
    v_mad_u32_u24 v115, v112, 5, v115
    v_cmp_gt_u32 s[72:73], s30, v112
    v_cmp_ge_u32 vcc, v115, v114
    s_and_b64 s[80:81], vcc, s[72:73]
    s_cbranch_scc0 L_s1_44
    s_bcnt1_i32_b64 s76, s[80:81]
    v_mbcnt_lo_u32_b32 v117, s80, 0
    v_mbcnt_hi_u32_b32 v117, s81, v117
    v_mov_b32 v116, s76
    s_mov_b64 exec, 1
    buffer_atomic_add v116, v118, s[36:39], 0 offen sc0
    s_waitcnt vmcnt(0)
    v_readfirstlane_b32 s76, v116
    s_mov_b64 exec, s[80:81]
    s_nop 0
    v_add_lshl_u32 v116, v117, s76, 3
    buffer_store_dwordx2 v[110:111], v116, s[32:35], 0 offen
L_s1_44:
    s_andn2_b64 exec, s[72:73], vcc
    s_cbranch_execz L_s2_45
    buffer_store_dword v110, v115, s[24:27], 0 offen
    buffer_store_byte v111, v115, s[24:27], 0 offen offset:4
    v_add_u32 v115, 5, v115
    v_cmpx_lt_u32 vcc, v115, v114
    v_cmpx_ne_u32_sdwa vcc, v111, v119 src0_sel:WORD_1 src1_sel:WORD_1
    v_cmpx_ne_u32_sdwa vcc, v111, v120 src0_sel:WORD_1 src1_sel:WORD_1
    s_cbranch_execz L_s2_45
    buffer_store_dword v118, v115, s[24:27], 0 offen
L_s2_45:
    s_mov_b64 exec, -1
    v_add_u32 v112, 1024, v112
    s_nop 0
    v_readfirstlane_b32 s76, v112
    s_nop 1
    s_cmp_lt_u32 s76, s30
    s_cbranch_scc1 L_sl_43
    s_mov_b32 s28, 0
    s_branch L_sback_42

.globl standalone__molecular_angular_gemnet__graph_kernel
.p2align 8
.type standalone__molecular_angular_gemnet__graph_kernel,@function
standalone__molecular_angular_gemnet__graph_kernel:
    s_cmp_ge_u32 s2, 256
    s_cbranch_scc1 L_p2done_50
    s_load_dwordx2 s[8:9], s[0:1], 0
    s_load_dwordx2 s[6:7], s[0:1], 104
    v_lshrrev_b32 v4, 6, v0
    s_lshr_b32 s37, s2, 1
    s_and_b32 s37, s37, 3
    s_lshr_b32 s36, s2, 3
    s_lshl_b32 s36, s36, 1
    s_and_b32 s3, s2, 1
    s_or_b32 s36, s36, s3
    v_readfirstlane_b32 s4, v4
    v_and_b32 v2, 63, v0
    v_lshrrev_b32 v3, 9, v0
    v_lshl_or_b32 v2, v3, 6, v2
    v_mul_u32_u24 v2, 20, v2
    v_lshlrev_b32 v3, 4, v0
    s_waitcnt lgkmcnt(0)
    s_lshl_b32 m0, s4, 10
    s_and_b32 s5, s4, 7
    s_lshr_b32 s39, s4, 3
    s_lshl_b32 s39, s39, 8
    s_mul_i32 s3, s5, 8192
    s_add_u32 s46, s6, s3
    s_addc_u32 s47, s7, 0
    s_mul_i32 s3, s5, 40632320
    s_add_u32 s3, s3, 83599360
    s_add_u32 s44, s6, s3
    s_addc_u32 s45, s7, 0
    s_mul_i32 s38, s37, 8
    s_add_u32 s4, s38, 8
    s_lshl_b32 s3, s38, 6
    s_add_u32 s3, s3, s36
    s_lshl_b32 s3, s3, 2
    s_add_u32 s52, s46, s3
    s_addc_u32 s53, s47, 0

    s_load_dword s88, s[52:53], 0
    s_load_dword s89, s[52:53], 256
    s_load_dword s90, s[52:53], 512
    s_load_dword s91, s[52:53], 768
    s_load_dword s92, s[52:53], 1024
    s_load_dword s93, s[52:53], 1280
    s_load_dword s94, s[52:53], 1536
    s_load_dword s95, s[52:53], 1792
    s_mov_b32 s3, 65536
    s_load_dword s51, s[6:7], s3
    s_mov_b32 s10, 6400000
    s_mov_b32 s11, 0x20000

    s_add_u32 s12, s6, 393216
    s_addc_u32 s13, s7, 0
    s_mov_b32 s14, 0
    s_mov_b32 s15, 0x20000
    s_add_u32 s60, s6, 393216
    s_addc_u32 s61, s7, 0
    s_mov_b32 s62, 6406144
    s_mov_b32 s63, 0x20000
    s_mov_b32 s3, 135176
    s_load_dword s33, s[6:7], s3

    s_mul_i32 s43, s38, 200192
    s_mul_i32 s41, s4, 200192
    s_mul_i32 s50, s38, 200000
    s_add_u32 s14, s43, 50000

    buffer_load_dwordx4 v[76:79], v3, s[12:15], s43 offen
    s_add_u32 s52, s43, 16384
    buffer_load_dwordx4 v[80:83], v3, s[12:15], s52 offen
    s_add_u32 s52, s43, 32768
    buffer_load_dwordx4 v[84:87], v3, s[12:15], s52 offen
    s_add_u32 s52, s43, 49152
    v_lshlrev_b32 v119, 2, v0
    buffer_load_dword v88, v119, s[12:15], s52 offen
    s_add_u32 s20, s6, 135168
    s_addc_u32 s21, s7, 0
    s_mov_b32 s22, 4096
    s_mov_b32 s23, 0x20000
    v_and_b32 v44, 63, v0
    v_lshlrev_b32 v44, 4, v44
    buffer_load_dwordx2 v[120:121], v44, s[20:23], 0 offen offset:0
    buffer_load_dwordx2 v[122:123], v44, s[20:23], 0 offen offset:1024
    buffer_load_dwordx2 v[124:125], v44, s[20:23], 0 offen offset:2048
    buffer_load_dwordx2 v[126:127], v44, s[20:23], 0 offen offset:3072
    s_movk_i32 s40, 3072
    s_mov_b32 s19, 0x20000
    s_min_u32 s40, s40, 3968
    s_lshl_b32 s52, s38, 6
    s_add_u32 s52, s52, s36
    s_mul_i32 s52, s52, 19840
    s_add_u32 s16, s44, s52
    s_addc_u32 s17, s45, 0
    s_mul_i32 s52, s40, 5
    s_add_u32 s52, s52, 3
    s_and_b32 s18, s52, -4

    s_movk_i32 s53, 5120
    buffer_load_dwordx4 v[90:93], v2, s[16:19], s53 offen
    buffer_load_dword v110, v2, s[16:19], s53 offen offset:16
    s_movk_i32 s53, 7680
    buffer_load_dwordx4 v[94:97], v2, s[16:19], s53 offen
    buffer_load_dword v111, v2, s[16:19], s53 offen offset:16
    s_lshr_b32 s3, s2, 3
    s_mul_i32 s3, s3, 49
    v_add_lshl_u32 v89, v0, s3, 7
    v_cmp_gt_u32 vcc, 49, v0
    v_bfrev_b32 v28, 1
    s_nop 0
    v_cndmask_b32 v89, v28, v89, vcc

    s_mov_b32 s19, 0x20000
    s_mov_b32 s28, 0x4b404000
    s_mov_b32 s29, 0x4b404000
    s_mov_b32 s30, 0xbfffc000
    s_mov_b32 s31, 0xbfffbfff
    s_mov_b32 s32, 0xffff0000
    s_mov_b32 s35, 0x05040100
    s_mov_b32 s97, 0x07060302
    s_mov_b32 s96, 0x40008000
    s_movk_i32 s3, 212
    v_cmp_gt_u32 s[48:49], s3, v0

    v_mov_b32 v1, 0
    s_mov_b32 s24, 0xc0c0004
    s_mov_b32 s25, 0xc0c0105
    s_mov_b32 s26, 0xc0c0206
    s_mov_b32 s27, 0xc0c0307
    v_mov_b32 v28, 0x40004000
    v_mov_b32 v29, 0x40004000
    v_mov_b32 v30, 0x40004000
    v_mov_b32 v31, 0x40004000
    v_add_u32 v32, 50000, v3
    v_add_u32 v33, 65536, v32

    ds_write_b128 v32, v[28:31] offset:0
    ds_write_b128 v32, v[28:31] offset:16384
    ds_write_b128 v32, v[28:31] offset:32768
    ds_write_b128 v32, v[28:31] offset:49152
    ds_write_b128 v33, v[28:31] offset:0
    ds_write_b128 v33, v[28:31] offset:16384
    v_cmp_gt_u32 vcc, 971, v0
    s_mov_b64 exec, vcc
    ds_write_b128 v33, v[28:31] offset:32768
    s_mov_b64 exec, -1
    s_waitcnt lgkmcnt(0)
    s_min_u32 s88, s88, 3968
    s_lshl_b32 s52, s38, 6
    s_add_u32 s52, s52, s36
    s_mul_i32 s52, s52, 19840
    s_add_u32 s16, s44, s52
    s_addc_u32 s17, s45, 0
    s_mul_i32 s52, s88, 5
    s_add_u32 s52, s52, 3
    s_and_b32 s18, s52, -4

    s_movk_i32 s53, 10240
    buffer_load_dwordx4 v[98:101], v2, s[16:19], s53 offen
    buffer_load_dword v112, v2, s[16:19], s53 offen offset:16
    s_movk_i32 s53, 12800
    buffer_load_dwordx4 v[102:105], v2, s[16:19], s53 offen
    buffer_load_dword v113, v2, s[16:19], s53 offen offset:16
    s_movk_i32 s53, 0
    buffer_load_dwordx4 v[4:7], v2, s[16:19], s53 offen
    buffer_load_dword v35, v2, s[16:19], s53 offen offset:16
    s_movk_i32 s53, 2560
    buffer_load_dwordx4 v[8:11], v2, s[16:19], s53 offen
    buffer_load_dword v43, v2, s[16:19], s53 offen offset:16
    s_movk_i32 s53, 15360
    buffer_load_dwordx4 v[106:109], v2, s[16:19], s53 offen
    buffer_load_dword v114, v2, s[16:19], s53 offen offset:16
    s_waitcnt vmcnt(21)
    ds_write_addtid_b32 v76 offset:0
    ds_write_addtid_b32 v77 offset:256
    ds_write_addtid_b32 v78 offset:512
    ds_write_addtid_b32 v79 offset:768
    s_waitcnt vmcnt(20)
    ds_write_addtid_b32 v80 offset:16384
    ds_write_addtid_b32 v81 offset:16640
    ds_write_addtid_b32 v82 offset:16896
    ds_write_addtid_b32 v83 offset:17152
    s_waitcnt vmcnt(19)
    ds_write_addtid_b32 v84 offset:32768
    ds_write_addtid_b32 v85 offset:33024
    ds_write_addtid_b32 v86 offset:33280
    ds_write_addtid_b32 v87 offset:33536
    v_lshlrev_b32 v119, 2, v0
    s_waitcnt vmcnt(18)
    s_mov_b64 exec, s[48:49]
    ds_write_b32 v119, v88 offset:49152
    s_mov_b64 exec, -1
    s_add_u32 s43, s43, 50048
    s_add_u32 s14, s43, 50000
    s_min_u32 s14, s14, s41
    buffer_load_dwordx4 v[76:79], v3, s[12:15], s43 offen
    s_add_u32 s52, s43, 16384
    buffer_load_dwordx4 v[80:83], v3, s[12:15], s52 offen
    s_add_u32 s52, s43, 32768
    buffer_load_dwordx4 v[84:87], v3, s[12:15], s52 offen
    s_add_u32 s52, s43, 49152
    v_lshlrev_b32 v119, 2, v0
    buffer_load_dword v88, v119, s[12:15], s52 offen
    s_add_u32 s54, s43, 50048
    buffer_load_dword v115, v89, s[60:63], s54 offen
    s_add_u32 s54, s50, 0
    buffer_load_dword v115, v89, s[8:11], s54 offen
    s_waitcnt vmcnt(20)
    v_max3_u32 v120, v120, v122, v124
    v_add_f32 v121, v121, v123
    v_add_f32 v125, v125, v127
    v_max_u32 v120, v120, v126
    v_add_f32 v121, v121, v125

    s_nop 1
    v_max_u32_dpp v120, v120, v120 row_shr:1 row_mask:0xf bank_mask:0xf
    s_nop 1
    v_max_u32_dpp v120, v120, v120 row_shr:2 row_mask:0xf bank_mask:0xf
    s_nop 1
    v_max_u32_dpp v120, v120, v120 row_shr:4 row_mask:0xf bank_mask:0xf
    s_nop 1
    v_max_u32_dpp v120, v120, v120 row_shr:8 row_mask:0xf bank_mask:0xf
    s_nop 1
    v_max_u32_dpp v120, v120, v120 row_bcast:15 row_mask:0xa bank_mask:0xf
    s_nop 1
    v_max_u32_dpp v120, v120, v120 row_bcast:31 row_mask:0xc bank_mask:0xf
    s_nop 1
    v_add_f32_dpp v121, v121, v121 row_shr:1 row_mask:0xf bank_mask:0xf
    s_nop 1
    v_add_f32_dpp v121, v121, v121 row_shr:2 row_mask:0xf bank_mask:0xf
    s_nop 1
    v_add_f32_dpp v121, v121, v121 row_shr:4 row_mask:0xf bank_mask:0xf
    s_nop 1
    v_add_f32_dpp v121, v121, v121 row_shr:8 row_mask:0xf bank_mask:0xf
    s_nop 1
    v_add_f32_dpp v121, v121, v121 row_bcast:15 row_mask:0xa bank_mask:0xf
    s_nop 1
    v_add_f32_dpp v121, v121, v121 row_bcast:31 row_mask:0xc bank_mask:0xf
    v_lshlrev_b32 v120, 16, v120
    v_mul_f32 v121, 0x34a7c5ac, v121
    v_sqrt_f32 v121, v121
    v_mul_f32 v120, s33, v120
    v_mul_f32 v121, s33, v121
    v_cmp_gt_f32 vcc, 0x46fde800, v120
    s_mov_b64 s[64:65], vcc
    v_cmp_lt_f32 vcc, 0x44000000, v121
    v_mov_b32 v120, 0x37800000
    v_mul_f32 v120, s33, v120
    s_and_b64 vcc, vcc, s[64:65]
    v_mul_f32 v121, 0x46ff8000, v120
    v_rcp_f32 v121, v121
    v_readfirstlane_b32 s33, v120
    s_waitcnt lgkmcnt(0)
    s_barrier
    v_readfirstlane_b32 s34, v121
    v_mov_b32 v120, 150016
    v_mov_b32 v121, 0
    ds_write_b32 v120, v121 offset:8
    s_bitcmp0_b64 vcc, 63
    s_cbranch_scc1 L_p2slow_51
    s_cmp_lg_u32 s51, 0
    s_cbranch_scc1 L_p2slow_51

    s_mov_b32 s40, s88
    s_sub_u32 s42, s40, s39

    s_add_u32 s55, s38, 1
    s_min_u32 s55, s55, 31
    s_mov_b32 s88, s89
    s_mov_b32 s89, s90
    s_mov_b32 s90, s91
    s_mov_b32 s91, s92
    s_mov_b32 s92, s93
    s_mov_b32 s93, s94
    s_mov_b32 s94, s95
    s_mov_b32 s95, 0
    s_min_u32 s88, s88, 3968
    s_lshl_b32 s52, s55, 6
    s_add_u32 s52, s52, s36
    s_mul_i32 s52, s52, 19840
    s_add_u32 s16, s44, s52
    s_addc_u32 s17, s45, 0
    s_mul_i32 s52, s88, 5
    s_add_u32 s52, s52, 3
    s_and_b32 s18, s52, -4

    s_waitcnt vmcnt(18)
    v_perm_b32 v44, v91, v90, s24
    v_perm_b32 v46, v92, v91, s25
    v_perm_b32 v48, v93, v92, s26
    v_perm_b32 v50, v110, v93, s27
    v_mov_b32 v12, v90
    v_alignbyte_b32 v13, v92, v91, 1
    v_alignbyte_b32 v14, v93, v92, 2
    v_alignbyte_b32 v15, v110, v93, 3
    v_lshlrev_b32_sdwa v44, 3, v44 dst_sel:WORD_0 dst_unused:UNUSED_PAD src0_sel:DWORD src1_sel:DWORD
    v_lshlrev_b32_sdwa v46, 3, v46 dst_sel:WORD_0 dst_unused:UNUSED_PAD src0_sel:DWORD src1_sel:DWORD
    v_lshlrev_b32_sdwa v48, 3, v48 dst_sel:WORD_0 dst_unused:UNUSED_PAD src0_sel:DWORD src1_sel:DWORD
    v_lshlrev_b32_sdwa v50, 3, v50 dst_sel:WORD_0 dst_unused:UNUSED_PAD src0_sel:DWORD src1_sel:DWORD
    s_cmp_lt_i32 s42, 1280
    s_cbranch_scc1 L_ufix_52
L_uback_53:

    v_subrev_co_u32 v12, s[80:81], 2.0, v12
    v_subrev_co_u32 v13, s[82:83], 2.0, v13
    v_subrev_co_u32 v14, s[84:85], 2.0, v14
    v_subrev_co_u32 v15, s[86:87], 2.0, v15
    s_mov_b64 exec, s[80:81]
    ds_read_b64 v[44:45], v44
    s_mov_b64 exec, s[82:83]
    ds_read_b64 v[46:47], v46
    s_mov_b64 exec, s[84:85]
    ds_read_b64 v[48:49], v48
    s_mov_b64 exec, s[86:87]
    ds_read_b64 v[50:51], v50
    s_mov_b64 exec, -1
    s_movk_i32 s53, 5120
    buffer_load_dwordx4 v[90:93], v2, s[16:19], s53 offen
    buffer_load_dword v110, v2, s[16:19], s53 offen offset:16
    s_waitcnt vmcnt(18)
    v_perm_b32 v52, v95, v94, s24
    v_perm_b32 v54, v96, v95, s25
    v_perm_b32 v56, v97, v96, s26
    v_perm_b32 v58, v111, v97, s27
    v_mov_b32 v16, v94
    v_alignbyte_b32 v17, v96, v95, 1
    v_alignbyte_b32 v18, v97, v96, 2
    v_alignbyte_b32 v19, v111, v97, 3
    v_lshlrev_b32_sdwa v52, 3, v52 dst_sel:WORD_0 dst_unused:UNUSED_PAD src0_sel:DWORD src1_sel:DWORD
    v_lshlrev_b32_sdwa v54, 3, v54 dst_sel:WORD_0 dst_unused:UNUSED_PAD src0_sel:DWORD src1_sel:DWORD
    v_lshlrev_b32_sdwa v56, 3, v56 dst_sel:WORD_0 dst_unused:UNUSED_PAD src0_sel:DWORD src1_sel:DWORD
    v_lshlrev_b32_sdwa v58, 3, v58 dst_sel:WORD_0 dst_unused:UNUSED_PAD src0_sel:DWORD src1_sel:DWORD
    s_cmp_lt_i32 s42, 1792
    s_cbranch_scc1 L_ufix_54
L_uback_55:

    v_subrev_co_u32 v16, s[64:65], 2.0, v16
    v_subrev_co_u32 v17, s[66:67], 2.0, v17
    v_subrev_co_u32 v18, s[68:69], 2.0, v18
    v_subrev_co_u32 v19, s[70:71], 2.0, v19
    s_mov_b64 exec, s[64:65]
    ds_read_b64 v[52:53], v52
    s_mov_b64 exec, s[66:67]
    ds_read_b64 v[54:55], v54
    s_mov_b64 exec, s[68:69]
    ds_read_b64 v[56:57], v56
    s_mov_b64 exec, s[70:71]
    ds_read_b64 v[58:59], v58
    s_mov_b64 exec, -1
    s_waitcnt vmcnt(16)
    v_perm_b32 v60, v99, v98, s24
    v_perm_b32 v62, v100, v99, s25
    v_perm_b32 v64, v101, v100, s26
    v_perm_b32 v66, v112, v101, s27
    v_mov_b32 v20, v98
    v_alignbyte_b32 v21, v100, v99, 1
    v_alignbyte_b32 v22, v101, v100, 2
    v_alignbyte_b32 v23, v112, v101, 3
    v_lshlrev_b32_sdwa v60, 3, v60 dst_sel:WORD_0 dst_unused:UNUSED_PAD src0_sel:DWORD src1_sel:DWORD
    v_lshlrev_b32_sdwa v62, 3, v62 dst_sel:WORD_0 dst_unused:UNUSED_PAD src0_sel:DWORD src1_sel:DWORD
    v_lshlrev_b32_sdwa v64, 3, v64 dst_sel:WORD_0 dst_unused:UNUSED_PAD src0_sel:DWORD src1_sel:DWORD
    v_lshlrev_b32_sdwa v66, 3, v66 dst_sel:WORD_0 dst_unused:UNUSED_PAD src0_sel:DWORD src1_sel:DWORD
    s_cmp_lt_i32 s42, 2304
    s_cbranch_scc1 L_ufix_56
L_uback_57:

    v_subrev_co_u32 v20, s[72:73], 2.0, v20
    v_subrev_co_u32 v21, s[74:75], 2.0, v21
    v_subrev_co_u32 v22, s[76:77], 2.0, v22
    v_subrev_co_u32 v23, s[78:79], 2.0, v23
    s_mov_b64 exec, s[72:73]
    ds_read_b64 v[60:61], v60
    s_mov_b64 exec, s[74:75]
    ds_read_b64 v[62:63], v62
    s_mov_b64 exec, s[76:77]
    ds_read_b64 v[64:65], v64
    s_mov_b64 exec, s[78:79]
    ds_read_b64 v[66:67], v66
    s_mov_b64 exec, -1
    s_waitcnt vmcnt(14)
    v_perm_b32 v68, v103, v102, s24
    v_perm_b32 v70, v104, v103, s25
    v_perm_b32 v72, v105, v104, s26
    v_perm_b32 v74, v113, v105, s27
    v_mov_b32 v24, v102
    v_alignbyte_b32 v25, v104, v103, 1
    v_alignbyte_b32 v26, v105, v104, 2
    v_alignbyte_b32 v27, v113, v105, 3
    v_lshlrev_b32_sdwa v68, 3, v68 dst_sel:WORD_0 dst_unused:UNUSED_PAD src0_sel:DWORD src1_sel:DWORD
    v_lshlrev_b32_sdwa v70, 3, v70 dst_sel:WORD_0 dst_unused:UNUSED_PAD src0_sel:DWORD src1_sel:DWORD
    v_lshlrev_b32_sdwa v72, 3, v72 dst_sel:WORD_0 dst_unused:UNUSED_PAD src0_sel:DWORD src1_sel:DWORD
    v_lshlrev_b32_sdwa v74, 3, v74 dst_sel:WORD_0 dst_unused:UNUSED_PAD src0_sel:DWORD src1_sel:DWORD
    s_cmp_lt_i32 s42, 2816
    s_cbranch_scc1 L_ufix_58
L_uback_59:

    v_subrev_co_u32 v24, s[80:81], 2.0, v24
    v_subrev_co_u32 v25, s[82:83], 2.0, v25
    v_subrev_co_u32 v26, s[84:85], 2.0, v26
    v_subrev_co_u32 v27, s[86:87], 2.0, v27
    s_mov_b64 exec, s[80:81]
    ds_read_b64 v[68:69], v68
    s_mov_b64 exec, s[82:83]
    ds_read_b64 v[70:71], v70
    s_mov_b64 exec, s[84:85]
    ds_read_b64 v[72:73], v72
    s_mov_b64 exec, s[86:87]
    ds_read_b64 v[74:75], v74
    s_mov_b64 exec, -1
    s_waitcnt vmcnt(12)
    v_perm_b32 v28, v5, v4, s24
    v_perm_b32 v30, v6, v5, s25
    v_perm_b32 v32, v7, v6, s26
    v_perm_b32 v34, v35, v7, s27
    v_alignbyte_b32 v5, v6, v5, 1
    v_alignbyte_b32 v6, v7, v6, 2
    v_alignbyte_b32 v7, v35, v7, 3
    v_lshlrev_b32_sdwa v28, 3, v28 dst_sel:WORD_0 dst_unused:UNUSED_PAD src0_sel:DWORD src1_sel:DWORD
    v_lshlrev_b32_sdwa v30, 3, v30 dst_sel:WORD_0 dst_unused:UNUSED_PAD src0_sel:DWORD src1_sel:DWORD
    v_lshlrev_b32_sdwa v32, 3, v32 dst_sel:WORD_0 dst_unused:UNUSED_PAD src0_sel:DWORD src1_sel:DWORD
    v_lshlrev_b32_sdwa v34, 3, v34 dst_sel:WORD_0 dst_unused:UNUSED_PAD src0_sel:DWORD src1_sel:DWORD
    s_cmp_lt_i32 s42, 256
    s_cbranch_scc1 L_ufix_60
L_uback_61:

    v_subrev_co_u32 v4, s[64:65], 2.0, v4
    v_subrev_co_u32 v5, s[66:67], 2.0, v5
    v_subrev_co_u32 v6, s[68:69], 2.0, v6
    v_subrev_co_u32 v7, s[70:71], 2.0, v7
    s_mov_b64 exec, s[64:65]
    ds_read_b64 v[28:29], v28
    s_mov_b64 exec, s[66:67]
    ds_read_b64 v[30:31], v30
    s_mov_b64 exec, s[68:69]
    ds_read_b64 v[32:33], v32
    s_mov_b64 exec, s[70:71]
    ds_read_b64 v[34:35], v34
    s_mov_b64 exec, -1
    s_waitcnt vmcnt(10)
    v_perm_b32 v36, v9, v8, s24
    v_perm_b32 v38, v10, v9, s25
    v_perm_b32 v40, v11, v10, s26
    v_perm_b32 v42, v43, v11, s27
    v_alignbyte_b32 v9, v10, v9, 1
    v_alignbyte_b32 v10, v11, v10, 2
    v_alignbyte_b32 v11, v43, v11, 3
    v_lshlrev_b32_sdwa v36, 3, v36 dst_sel:WORD_0 dst_unused:UNUSED_PAD src0_sel:DWORD src1_sel:DWORD
    v_lshlrev_b32_sdwa v38, 3, v38 dst_sel:WORD_0 dst_unused:UNUSED_PAD src0_sel:DWORD src1_sel:DWORD
    v_lshlrev_b32_sdwa v40, 3, v40 dst_sel:WORD_0 dst_unused:UNUSED_PAD src0_sel:DWORD src1_sel:DWORD
    v_lshlrev_b32_sdwa v42, 3, v42 dst_sel:WORD_0 dst_unused:UNUSED_PAD src0_sel:DWORD src1_sel:DWORD
    s_cmp_lt_i32 s42, 768
    s_cbranch_scc1 L_ufix_62
L_uback_63:

    v_subrev_co_u32 v8, s[72:73], 2.0, v8
    v_subrev_co_u32 v9, s[74:75], 2.0, v9
    v_subrev_co_u32 v10, s[76:77], 2.0, v10
    v_subrev_co_u32 v11, s[78:79], 2.0, v11
    s_mov_b64 exec, s[72:73]
    ds_read_b64 v[36:37], v36
    s_mov_b64 exec, s[74:75]
    ds_read_b64 v[38:39], v38
    s_mov_b64 exec, s[76:77]
    ds_read_b64 v[40:41], v40
    s_mov_b64 exec, s[78:79]
    ds_read_b64 v[42:43], v42
    s_mov_b64 exec, -1
L_batch_64:
    s_add_u32 s5, s38, 1

    s_movk_i32 s53, 7680
    buffer_load_dwordx4 v[94:97], v2, s[16:19], s53 offen
    buffer_load_dword v111, v2, s[16:19], s53 offen offset:16
    v_subrev_co_u32 v4, s[64:65], 2.0, v4
    v_subrev_co_u32 v5, s[66:67], 2.0, v5
    v_subrev_co_u32 v6, s[68:69], 2.0, v6
    v_subrev_co_u32 v7, s[70:71], 2.0, v7
    v_subrev_co_u32 v8, s[72:73], 2.0, v8
    v_subrev_co_u32 v9, s[74:75], 2.0, v9
    v_subrev_co_u32 v10, s[76:77], 2.0, v10
    v_subrev_co_u32 v11, s[78:79], 2.0, v11
    v_subrev_co_u32 v12, s[80:81], 2.0, v12
    v_subrev_co_u32 v13, s[82:83], 2.0, v13
    v_subrev_co_u32 v14, s[84:85], 2.0, v14
    v_subrev_co_u32 v15, s[86:87], 2.0, v15
    s_waitcnt lgkmcnt(0)
    s_barrier
    s_waitcnt vmcnt(5)
    ds_write_addtid_b32 v76 offset:0
    ds_write_addtid_b32 v77 offset:256
    ds_write_addtid_b32 v78 offset:512
    ds_write_addtid_b32 v79 offset:768
    s_waitcnt vmcnt(4)
    ds_write_addtid_b32 v80 offset:16384
    ds_write_addtid_b32 v81 offset:16640
    ds_write_addtid_b32 v82 offset:16896
    ds_write_addtid_b32 v83 offset:17152
    s_waitcnt vmcnt(3)
    ds_write_addtid_b32 v84 offset:32768
    ds_write_addtid_b32 v85 offset:33024
    ds_write_addtid_b32 v86 offset:33280
    ds_write_addtid_b32 v87 offset:33536
    v_lshlrev_b32 v119, 2, v0
    s_waitcnt vmcnt(2)
    s_mov_b64 exec, s[48:49]
    ds_write_b32 v119, v88 offset:49152
    s_mov_b64 exec, -1
    s_add_u32 s43, s43, 50048
    s_add_u32 s14, s43, 50000
    s_min_u32 s14, s14, s41
    buffer_load_dwordx4 v[76:79], v3, s[12:15], s43 offen
    s_waitcnt lgkmcnt(0)
    s_barrier
    s_add_u32 s52, s43, 16384
    buffer_load_dwordx4 v[80:83], v3, s[12:15], s52 offen
    s_add_u32 s52, s43, 32768
    buffer_load_dwordx4 v[84:87], v3, s[12:15], s52 offen
    s_add_u32 s52, s43, 49152
    v_lshlrev_b32 v119, 2, v0
    buffer_load_dword v88, v119, s[12:15], s52 offen
    s_mov_b64 exec, s[64:65]
    ds_read_b64 v[28:29], v28
    s_mov_b64 exec, s[66:67]
    ds_read_b64 v[30:31], v30
    s_mov_b64 exec, s[68:69]
    ds_read_b64 v[32:33], v32
    s_mov_b64 exec, s[70:71]
    ds_read_b64 v[34:35], v34
    s_mov_b64 exec, s[72:73]
    ds_read_b64 v[36:37], v36
    s_mov_b64 exec, s[74:75]
    ds_read_b64 v[38:39], v38
    s_mov_b64 exec, s[76:77]
    ds_read_b64 v[40:41], v40
    s_mov_b64 exec, s[78:79]
    ds_read_b64 v[42:43], v42
    s_mov_b64 exec, s[80:81]
    ds_read_b64 v[44:45], v44
    s_mov_b64 exec, s[82:83]
    ds_read_b64 v[46:47], v46
    s_mov_b64 exec, s[84:85]
    ds_read_b64 v[48:49], v48
    s_mov_b64 exec, s[86:87]
    ds_read_b64 v[50:51], v50
    s_mov_b64 exec, -1
    v_subrev_co_u32 v16, s[64:65], 2.0, v16
    v_subrev_co_u32 v17, s[66:67], 2.0, v17
    v_subrev_co_u32 v18, s[68:69], 2.0, v18
    v_subrev_co_u32 v19, s[70:71], 2.0, v19
    v_subrev_co_u32 v20, s[72:73], 2.0, v20
    v_subrev_co_u32 v21, s[74:75], 2.0, v21
    v_subrev_co_u32 v22, s[76:77], 2.0, v22
    v_subrev_co_u32 v23, s[78:79], 2.0, v23
    v_subrev_co_u32 v24, s[80:81], 2.0, v24
    v_subrev_co_u32 v25, s[82:83], 2.0, v25
    v_subrev_co_u32 v26, s[84:85], 2.0, v26
    v_subrev_co_u32 v27, s[86:87], 2.0, v27
    s_mov_b64 exec, s[64:65]
    ds_read_b64 v[52:53], v52
    s_mov_b64 exec, s[66:67]
    ds_read_b64 v[54:55], v54
    s_mov_b64 exec, s[68:69]
    ds_read_b64 v[56:57], v56
    s_mov_b64 exec, s[70:71]
    ds_read_b64 v[58:59], v58
    s_mov_b64 exec, s[72:73]
    ds_read_b64 v[60:61], v60
    s_mov_b64 exec, s[74:75]
    ds_read_b64 v[62:63], v62
    s_mov_b64 exec, s[76:77]
    ds_read_b64 v[64:65], v64
    s_mov_b64 exec, s[78:79]
    ds_read_b64 v[66:67], v66
    s_mov_b64 exec, s[80:81]
    ds_read_b64 v[68:69], v68
    s_mov_b64 exec, s[82:83]
    ds_read_b64 v[70:71], v70
    s_mov_b64 exec, s[84:85]
    ds_read_b64 v[72:73], v72
    s_mov_b64 exec, s[86:87]
    ds_read_b64 v[74:75], v74
    s_mov_b64 exec, -1
    s_cmp_le_i32 s42, 3072
    s_cbranch_scc1 L_nt1_66
    s_waitcnt vmcnt(14)
    v_perm_b32 v120, v107, v106, s24
    v_perm_b32 v122, v108, v107, s25
    v_perm_b32 v124, v109, v108, s26
    v_perm_b32 v126, v114, v109, s27
    v_alignbyte_b32 v107, v108, v107, 1
    v_alignbyte_b32 v108, v109, v108, 2
    v_alignbyte_b32 v109, v114, v109, 3
    v_lshlrev_b32_sdwa v120, 3, v120 dst_sel:WORD_0 dst_unused:UNUSED_PAD src0_sel:DWORD src1_sel:DWORD
    v_lshlrev_b32_sdwa v122, 3, v122 dst_sel:WORD_0 dst_unused:UNUSED_PAD src0_sel:DWORD src1_sel:DWORD
    v_lshlrev_b32_sdwa v124, 3, v124 dst_sel:WORD_0 dst_unused:UNUSED_PAD src0_sel:DWORD src1_sel:DWORD
    v_lshlrev_b32_sdwa v126, 3, v126 dst_sel:WORD_0 dst_unused:UNUSED_PAD src0_sel:DWORD src1_sel:DWORD
    s_cmp_lt_i32 s42, 3328
    s_cbranch_scc1 L_ufix_69
L_uback_70:

    v_lshrrev_b32 v117, 30, v106
    v_and_b32 v106, 0x3fffffff, v106
    v_mul_u32_u24 v117, 50000, v117
    v_cmp_ne_u32 vcc, 0, v106
    v_add_u32 v120, v120, v117
    s_mov_b64 exec, vcc

    buffer_load_dwordx2 v[120:121], v120, s[8:11], s50 offen
    s_mov_b64 exec, -1
    v_lshrrev_b32 v117, 30, v107
    v_and_b32 v107, 0x3fffffff, v107
    v_mul_u32_u24 v117, 50000, v117
    v_cmp_ne_u32 vcc, 0, v107
    v_add_u32 v122, v122, v117
    s_mov_b64 exec, vcc

    buffer_load_dwordx2 v[122:123], v122, s[8:11], s50 offen
    s_mov_b64 exec, -1
    v_lshrrev_b32 v117, 30, v108
    v_and_b32 v108, 0x3fffffff, v108
    v_mul_u32_u24 v117, 50000, v117
    v_cmp_ne_u32 vcc, 0, v108
    v_add_u32 v124, v124, v117
    s_mov_b64 exec, vcc

    buffer_load_dwordx2 v[124:125], v124, s[8:11], s50 offen
    s_mov_b64 exec, -1
    v_lshrrev_b32 v117, 30, v109
    v_and_b32 v109, 0x3fffffff, v109
    v_mul_u32_u24 v117, 50000, v117
    v_cmp_ne_u32 vcc, 0, v109
    v_add_u32 v126, v126, v117
    s_mov_b64 exec, vcc

    buffer_load_dwordx2 v[126:127], v126, s[8:11], s50 offen
    s_mov_b64 exec, -1
L_nt1_66:
    v_subrev_co_u32 v4, s[64:65], 2.0, v4
    v_subrev_co_u32 v5, s[66:67], 2.0, v5
    v_subrev_co_u32 v6, s[68:69], 2.0, v6
    v_subrev_co_u32 v7, s[70:71], 2.0, v7
    v_subrev_co_u32 v8, s[72:73], 2.0, v8
    v_subrev_co_u32 v9, s[74:75], 2.0, v9
    v_subrev_co_u32 v10, s[76:77], 2.0, v10
    v_subrev_co_u32 v11, s[78:79], 2.0, v11
    v_subrev_co_u32 v12, s[80:81], 2.0, v12
    v_subrev_co_u32 v13, s[82:83], 2.0, v13
    v_subrev_co_u32 v14, s[84:85], 2.0, v14
    v_subrev_co_u32 v15, s[86:87], 2.0, v15
    s_waitcnt lgkmcnt(0)
    s_barrier
    s_waitcnt vmcnt(3)
    ds_write_addtid_b32 v76 offset:0
    ds_write_addtid_b32 v77 offset:256
    ds_write_addtid_b32 v78 offset:512
    ds_write_addtid_b32 v79 offset:768
    s_waitcnt vmcnt(2)
    ds_write_addtid_b32 v80 offset:16384
    ds_write_addtid_b32 v81 offset:16640
    ds_write_addtid_b32 v82 offset:16896
    ds_write_addtid_b32 v83 offset:17152
    s_waitcnt vmcnt(1)
    ds_write_addtid_b32 v84 offset:32768
    ds_write_addtid_b32 v85 offset:33024
    ds_write_addtid_b32 v86 offset:33280
    ds_write_addtid_b32 v87 offset:33536
    v_lshlrev_b32 v119, 2, v0
    s_waitcnt vmcnt(0)
    s_mov_b64 exec, s[48:49]
    ds_write_b32 v119, v88 offset:49152
    s_mov_b64 exec, -1
    s_add_u32 s43, s43, 50048
    s_add_u32 s14, s43, 50000
    s_min_u32 s14, s14, s41
    buffer_load_dwordx4 v[76:79], v3, s[12:15], s43 offen
    s_waitcnt lgkmcnt(0)
    s_barrier
    s_add_u32 s52, s43, 16384
    buffer_load_dwordx4 v[80:83], v3, s[12:15], s52 offen
    s_add_u32 s52, s43, 32768
    buffer_load_dwordx4 v[84:87], v3, s[12:15], s52 offen
    s_add_u32 s52, s43, 49152
    v_lshlrev_b32 v119, 2, v0
    buffer_load_dword v88, v119, s[12:15], s52 offen
    s_mov_b64 exec, s[64:65]
    ds_read_b64 v[28:29], v28
    s_mov_b64 exec, s[66:67]
    ds_read_b64 v[30:31], v30
    s_mov_b64 exec, s[68:69]
    ds_read_b64 v[32:33], v32
    s_mov_b64 exec, s[70:71]
    ds_read_b64 v[34:35], v34
    s_mov_b64 exec, s[72:73]
    ds_read_b64 v[36:37], v36
    s_mov_b64 exec, s[74:75]
    ds_read_b64 v[38:39], v38
    s_mov_b64 exec, s[76:77]
    ds_read_b64 v[40:41], v40
    s_mov_b64 exec, s[78:79]
    ds_read_b64 v[42:43], v42
    s_mov_b64 exec, s[80:81]
    ds_read_b64 v[44:45], v44
    s_mov_b64 exec, s[82:83]
    ds_read_b64 v[46:47], v46
    s_mov_b64 exec, s[84:85]
    ds_read_b64 v[48:49], v48
    s_mov_b64 exec, s[86:87]
    ds_read_b64 v[50:51], v50
    s_mov_b64 exec, -1
    v_subrev_co_u32 v16, s[64:65], 2.0, v16
    v_subrev_co_u32 v17, s[66:67], 2.0, v17
    v_subrev_co_u32 v18, s[68:69], 2.0, v18
    v_subrev_co_u32 v19, s[70:71], 2.0, v19
    v_subrev_co_u32 v20, s[72:73], 2.0, v20
    v_subrev_co_u32 v21, s[74:75], 2.0, v21
    v_subrev_co_u32 v22, s[76:77], 2.0, v22
    v_subrev_co_u32 v23, s[78:79], 2.0, v23
    v_subrev_co_u32 v24, s[80:81], 2.0, v24
    v_subrev_co_u32 v25, s[82:83], 2.0, v25
    v_subrev_co_u32 v26, s[84:85], 2.0, v26
    v_subrev_co_u32 v27, s[86:87], 2.0, v27
    s_mov_b64 exec, s[64:65]
    ds_read_b64 v[52:53], v52
    s_mov_b64 exec, s[66:67]
    ds_read_b64 v[54:55], v54
    s_mov_b64 exec, s[68:69]
    ds_read_b64 v[56:57], v56
    s_mov_b64 exec, s[70:71]
    ds_read_b64 v[58:59], v58
    s_mov_b64 exec, s[72:73]
    ds_read_b64 v[60:61], v60
    s_mov_b64 exec, s[74:75]
    ds_read_b64 v[62:63], v62
    s_mov_b64 exec, s[76:77]
    ds_read_b64 v[64:65], v64
    s_mov_b64 exec, s[78:79]
    ds_read_b64 v[66:67], v66
    s_mov_b64 exec, s[80:81]
    ds_read_b64 v[68:69], v68
    s_mov_b64 exec, s[82:83]
    ds_read_b64 v[70:71], v70
    s_mov_b64 exec, s[84:85]
    ds_read_b64 v[72:73], v72
    s_mov_b64 exec, s[86:87]
    ds_read_b64 v[74:75], v74
    s_mov_b64 exec, -1
    s_movk_i32 s53, 10240
    buffer_load_dwordx4 v[98:101], v2, s[16:19], s53 offen
    buffer_load_dword v112, v2, s[16:19], s53 offen offset:16
    s_cmp_le_i32 s42, 3072
    s_cbranch_scc1 L_nt2_67
    s_waitcnt vmcnt(6)
    v_cmp_ne_u32 s[56:57], 0, v106
    v_cmp_ne_u32 s[58:59], 0, v107
    v_cmp_ne_u32 s[98:99], 0, v108
    v_cmp_ne_u32 vcc, 0, v109
    s_mov_b64 exec, s[56:57]
    v_cvt_f32_i32_sdwa v118, sext(v106) dst_sel:DWORD dst_unused:UNUSED_PAD src0_sel:WORD_0
    v_lshlrev_b32 v116, 16, v120
    v_and_b32 v117, s32, v120
    v_mul_f32 v118, s33, v118
    v_lshlrev_b32 v120, 16, v121
    v_and_b32 v121, s32, v121
    v_lshlrev_b32_sdwa v106, 3, v106 dst_sel:DWORD dst_unused:UNUSED_PAD src0_sel:DWORD src1_sel:WORD_1
    v_pk_fma_f32 v[116:117], v[116:117], v[118:119], s[28:29] op_sel_hi:[1,0,1]
    v_pk_fma_f32 v[120:121], v[120:121], v[118:119], s[28:29] op_sel_hi:[1,0,1]
    v_perm_b32 v116, v117, v116, s35
    v_perm_b32 v117, v121, v120, s35
    v_lshl_add_u64 v[116:117], v[116:117], 0, s[30:31]
    ds_add_rtn_u64 v[120:121], v106, v[116:117] offset:50000

    s_mov_b64 exec, s[58:59]
    v_cvt_f32_i32_sdwa v118, sext(v107) dst_sel:DWORD dst_unused:UNUSED_PAD src0_sel:WORD_0
    v_lshlrev_b32 v116, 16, v122
    v_and_b32 v117, s32, v122
    v_mul_f32 v118, s33, v118
    v_lshlrev_b32 v122, 16, v123
    v_and_b32 v123, s32, v123
    v_lshlrev_b32_sdwa v107, 3, v107 dst_sel:DWORD dst_unused:UNUSED_PAD src0_sel:DWORD src1_sel:WORD_1
    v_pk_fma_f32 v[116:117], v[116:117], v[118:119], s[28:29] op_sel_hi:[1,0,1]
    v_pk_fma_f32 v[122:123], v[122:123], v[118:119], s[28:29] op_sel_hi:[1,0,1]
    v_perm_b32 v116, v117, v116, s35
    v_perm_b32 v117, v123, v122, s35
    v_lshl_add_u64 v[116:117], v[116:117], 0, s[30:31]
    ds_add_rtn_u64 v[122:123], v107, v[116:117] offset:50000

    s_mov_b64 exec, s[98:99]
    v_cvt_f32_i32_sdwa v118, sext(v108) dst_sel:DWORD dst_unused:UNUSED_PAD src0_sel:WORD_0
    v_lshlrev_b32 v116, 16, v124
    v_and_b32 v117, s32, v124
    v_mul_f32 v118, s33, v118
    v_lshlrev_b32 v124, 16, v125
    v_and_b32 v125, s32, v125
    v_lshlrev_b32_sdwa v108, 3, v108 dst_sel:DWORD dst_unused:UNUSED_PAD src0_sel:DWORD src1_sel:WORD_1
    v_pk_fma_f32 v[116:117], v[116:117], v[118:119], s[28:29] op_sel_hi:[1,0,1]
    v_pk_fma_f32 v[124:125], v[124:125], v[118:119], s[28:29] op_sel_hi:[1,0,1]
    v_perm_b32 v116, v117, v116, s35
    v_perm_b32 v117, v125, v124, s35
    v_lshl_add_u64 v[116:117], v[116:117], 0, s[30:31]
    ds_add_rtn_u64 v[124:125], v108, v[116:117] offset:50000

    s_mov_b64 exec, vcc
    v_cvt_f32_i32_sdwa v118, sext(v109) dst_sel:DWORD dst_unused:UNUSED_PAD src0_sel:WORD_0
    v_lshlrev_b32 v116, 16, v126
    v_and_b32 v117, s32, v126
    v_mul_f32 v118, s33, v118
    v_lshlrev_b32 v126, 16, v127
    v_and_b32 v127, s32, v127
    v_lshlrev_b32_sdwa v109, 3, v109 dst_sel:DWORD dst_unused:UNUSED_PAD src0_sel:DWORD src1_sel:WORD_1
    v_pk_fma_f32 v[116:117], v[116:117], v[118:119], s[28:29] op_sel_hi:[1,0,1]
    v_pk_fma_f32 v[126:127], v[126:127], v[118:119], s[28:29] op_sel_hi:[1,0,1]
    v_perm_b32 v116, v117, v116, s35
    v_perm_b32 v117, v127, v126, s35
    v_lshl_add_u64 v[116:117], v[116:117], 0, s[30:31]
    ds_add_rtn_u64 v[126:127], v109, v[116:117] offset:50000

    s_waitcnt lgkmcnt(0)
    s_mov_b64 exec, s[56:57]
    v_or3_b32 v1, v120, v121, v1
    s_mov_b64 exec, s[58:59]
    v_or3_b32 v1, v122, v123, v1
    s_mov_b64 exec, s[98:99]
    v_or3_b32 v1, v124, v125, v1
    s_mov_b64 exec, vcc
    v_or3_b32 v1, v126, v127, v1
    s_mov_b64 exec, -1
L_nt2_67:
    s_movk_i32 s53, 15360
    buffer_load_dwordx4 v[106:109], v2, s[16:19], s53 offen
    buffer_load_dword v114, v2, s[16:19], s53 offen offset:16
    s_cmp_le_u32 s40, 3584
    s_cbranch_scc1 L_noleft_68
    s_min_u32 s40, s40, 3968
    s_lshl_b32 s52, s38, 6
    s_add_u32 s52, s52, s36
    s_mul_i32 s52, s52, 19840
    s_add_u32 s20, s44, s52
    s_addc_u32 s21, s45, 0
    s_mul_i32 s52, s40, 5
    s_add_u32 s52, s52, 3
    s_and_b32 s22, s52, -4

    s_lshr_b32 s55, s39, 2
    s_add_u32 s55, s55, 3584
    v_and_b32 v120, 63, v0
    v_add_u32 v120, s55, v120
L_left_71:
    s_cmp_ge_u32 s55, s40
    s_cbranch_scc1 L_leftend_72
    v_mul_u32_u24 v121, 5, v120
    buffer_load_dword v122, v121, s[20:23], 0 offen
    buffer_load_ubyte v123, v121, s[20:23], 0 offen offset:4
    s_waitcnt vmcnt(0)

    v_perm_b32 v121, v123, v122, s24
    v_lshrrev_b32 v126, 30, v122
    v_and_b32 v121, 0x1fff, v121
    v_mul_u32_u24 v126, 6250, v126
    v_add_lshl_u32 v121, v121, v126, 3

    buffer_load_dwordx2 v[124:125], v121, s[8:11], s50 offen
    v_cmp_gt_u32 vcc, s40, v120
    s_waitcnt vmcnt(0)

    s_mov_b64 exec, vcc
    v_and_b32 v122, 0x3fffffff, v122
    v_cvt_f32_i32_sdwa v118, sext(v122) dst_sel:DWORD dst_unused:UNUSED_PAD src0_sel:WORD_0
    v_lshlrev_b32 v116, 16, v124
    v_and_b32 v117, s32, v124
    v_mul_f32 v118, s33, v118
    v_lshlrev_b32 v124, 16, v125
    v_and_b32 v125, s32, v125
    v_lshlrev_b32_sdwa v122, 3, v122 dst_sel:DWORD dst_unused:UNUSED_PAD src0_sel:DWORD src1_sel:WORD_1
    v_pk_fma_f32 v[116:117], v[116:117], v[118:119], s[28:29] op_sel_hi:[1,0,1]
    v_pk_fma_f32 v[124:125], v[124:125], v[118:119], s[28:29] op_sel_hi:[1,0,1]
    v_perm_b32 v116, v117, v116, s35
    v_perm_b32 v117, v125, v124, s35
    v_lshl_add_u64 v[116:117], v[116:117], 0, s[30:31]
    ds_add_rtn_u64 v[124:125], v122, v[116:117] offset:50000

    s_waitcnt lgkmcnt(0)
    v_or3_b32 v1, v124, v125, v1
    s_mov_b64 exec, -1
    v_add_u32 v120, 128, v120
    s_add_u32 s55, s55, 128
    s_branch L_left_71
L_leftend_72:

L_noleft_68:
    v_cmp_gt_u32 s[64:65], 2.0, v4
    v_and_b32 v4, 0x3fffffff, v4
    v_cmp_gt_u32 s[66:67], 2.0, v5
    v_and_b32 v5, 0x3fffffff, v5
    v_cmp_gt_u32 s[68:69], 2.0, v6
    v_and_b32 v6, 0x3fffffff, v6
    v_cmp_gt_u32 s[70:71], 2.0, v7
    v_and_b32 v7, 0x3fffffff, v7
    v_cmp_gt_u32 s[72:73], 2.0, v8
    v_and_b32 v8, 0x3fffffff, v8
    v_cmp_gt_u32 s[74:75], 2.0, v9
    v_and_b32 v9, 0x3fffffff, v9
    v_cmp_gt_u32 s[76:77], 2.0, v10
    v_and_b32 v10, 0x3fffffff, v10
    v_cmp_gt_u32 s[78:79], 2.0, v11
    v_and_b32 v11, 0x3fffffff, v11
    v_cmp_gt_u32 s[80:81], 2.0, v12
    v_and_b32 v12, 0x3fffffff, v12
    v_cmp_gt_u32 s[82:83], 2.0, v13
    v_and_b32 v13, 0x3fffffff, v13
    v_cmp_gt_u32 s[84:85], 2.0, v14
    v_and_b32 v14, 0x3fffffff, v14
    v_cmp_gt_u32 s[86:87], 2.0, v15
    v_and_b32 v15, 0x3fffffff, v15
    s_waitcnt lgkmcnt(0)
    s_barrier
    s_waitcnt vmcnt(7)
    ds_write_addtid_b32 v76 offset:0
    ds_write_addtid_b32 v77 offset:256
    ds_write_addtid_b32 v78 offset:512
    ds_write_addtid_b32 v79 offset:768
    s_waitcnt vmcnt(6)
    ds_write_addtid_b32 v80 offset:16384
    ds_write_addtid_b32 v81 offset:16640
    ds_write_addtid_b32 v82 offset:16896
    ds_write_addtid_b32 v83 offset:17152
    s_waitcnt vmcnt(5)
    ds_write_addtid_b32 v84 offset:32768
    ds_write_addtid_b32 v85 offset:33024
    ds_write_addtid_b32 v86 offset:33280
    ds_write_addtid_b32 v87 offset:33536
    v_lshlrev_b32 v119, 2, v0
    s_waitcnt vmcnt(4)
    s_mov_b64 exec, s[48:49]
    ds_write_b32 v119, v88 offset:49152
    s_mov_b64 exec, -1
    s_add_u32 s43, s43, 50048
    s_add_u32 s14, s43, 50000
    s_min_u32 s14, s14, s41
    buffer_load_dwordx4 v[76:79], v3, s[12:15], s43 offen
    s_waitcnt lgkmcnt(0)
    s_barrier
    s_add_u32 s52, s43, 16384
    buffer_load_dwordx4 v[80:83], v3, s[12:15], s52 offen
    s_add_u32 s52, s43, 32768
    buffer_load_dwordx4 v[84:87], v3, s[12:15], s52 offen
    s_add_u32 s52, s43, 49152
    v_lshlrev_b32 v119, 2, v0
    buffer_load_dword v88, v119, s[12:15], s52 offen
    s_mov_b64 exec, s[64:65]
    ds_read_b64 v[28:29], v28
    s_mov_b64 exec, s[66:67]
    ds_read_b64 v[30:31], v30
    s_mov_b64 exec, s[68:69]
    ds_read_b64 v[32:33], v32
    s_mov_b64 exec, s[70:71]
    ds_read_b64 v[34:35], v34
    s_mov_b64 exec, s[72:73]
    ds_read_b64 v[36:37], v36
    s_mov_b64 exec, s[74:75]
    ds_read_b64 v[38:39], v38
    s_mov_b64 exec, s[76:77]
    ds_read_b64 v[40:41], v40
    s_mov_b64 exec, s[78:79]
    ds_read_b64 v[42:43], v42
    s_mov_b64 exec, s[80:81]
    ds_read_b64 v[44:45], v44
    s_mov_b64 exec, s[82:83]
    ds_read_b64 v[46:47], v46
    s_mov_b64 exec, s[84:85]
    ds_read_b64 v[48:49], v48
    s_mov_b64 exec, s[86:87]
    ds_read_b64 v[50:51], v50
    s_mov_b64 exec, -1
    v_cmp_gt_u32 s[64:65], 2.0, v16
    v_and_b32 v16, 0x3fffffff, v16
    v_cmp_gt_u32 s[66:67], 2.0, v17
    v_and_b32 v17, 0x3fffffff, v17
    v_cmp_gt_u32 s[68:69], 2.0, v18
    v_and_b32 v18, 0x3fffffff, v18
    v_cmp_gt_u32 s[70:71], 2.0, v19
    v_and_b32 v19, 0x3fffffff, v19
    v_cmp_gt_u32 s[72:73], 2.0, v20
    v_and_b32 v20, 0x3fffffff, v20
    v_cmp_gt_u32 s[74:75], 2.0, v21
    v_and_b32 v21, 0x3fffffff, v21
    v_cmp_gt_u32 s[76:77], 2.0, v22
    v_and_b32 v22, 0x3fffffff, v22
    v_cmp_gt_u32 s[78:79], 2.0, v23
    v_and_b32 v23, 0x3fffffff, v23
    v_cmp_gt_u32 s[80:81], 2.0, v24
    v_and_b32 v24, 0x3fffffff, v24
    v_cmp_gt_u32 s[82:83], 2.0, v25
    v_and_b32 v25, 0x3fffffff, v25
    v_cmp_gt_u32 s[84:85], 2.0, v26
    v_and_b32 v26, 0x3fffffff, v26
    v_cmp_gt_u32 s[86:87], 2.0, v27
    v_and_b32 v27, 0x3fffffff, v27
    s_mov_b64 exec, s[64:65]
    ds_read_b64 v[52:53], v52
    s_mov_b64 exec, s[66:67]
    ds_read_b64 v[54:55], v54
    s_mov_b64 exec, s[68:69]
    ds_read_b64 v[56:57], v56
    s_mov_b64 exec, s[70:71]
    ds_read_b64 v[58:59], v58
    s_mov_b64 exec, s[72:73]
    ds_read_b64 v[60:61], v60
    s_mov_b64 exec, s[74:75]
    ds_read_b64 v[62:63], v62
    s_mov_b64 exec, s[76:77]
    ds_read_b64 v[64:65], v64
    s_mov_b64 exec, s[78:79]
    ds_read_b64 v[66:67], v66
    s_mov_b64 exec, s[80:81]
    ds_read_b64 v[68:69], v68
    s_mov_b64 exec, s[82:83]
    ds_read_b64 v[70:71], v70
    s_mov_b64 exec, s[84:85]
    ds_read_b64 v[72:73], v72
    s_mov_b64 exec, s[86:87]
    ds_read_b64 v[74:75], v74
    s_mov_b64 exec, -1
    s_movk_i32 s53, 12800
    buffer_load_dwordx4 v[102:105], v2, s[16:19], s53 offen
    buffer_load_dword v113, v2, s[16:19], s53 offen offset:16
    s_cmp_ge_u32 s5, s4
    s_cbranch_scc1 L_bend_65
    s_waitcnt lgkmcnt(15)
    v_mad_i32_i16 v120, v28, v4, s96
    v_mad_i32_i16 v28, v28, v4, s96 op_sel:[1,0,0,0]
    v_mad_i32_i16 v121, v29, v4, s96
    v_mad_i32_i16 v29, v29, v4, s96 op_sel:[1,0,0,0]
    v_lshlrev_b32_sdwa v4, 3, v4 dst_sel:DWORD dst_unused:UNUSED_PAD src0_sel:DWORD src1_sel:WORD_1
    v_perm_b32 v28, v28, v120, s97
    v_perm_b32 v29, v29, v121, s97
    v_lshl_add_u64 v[28:29], v[28:29], 0, s[30:31]

    ds_add_rtn_u64 v[28:29], v4, v[28:29] offset:50000
    v_mad_i32_i16 v122, v30, v5, s96
    v_mad_i32_i16 v30, v30, v5, s96 op_sel:[1,0,0,0]
    v_mad_i32_i16 v123, v31, v5, s96
    v_mad_i32_i16 v31, v31, v5, s96 op_sel:[1,0,0,0]
    v_lshlrev_b32_sdwa v5, 3, v5 dst_sel:DWORD dst_unused:UNUSED_PAD src0_sel:DWORD src1_sel:WORD_1
    v_perm_b32 v30, v30, v122, s97
    v_perm_b32 v31, v31, v123, s97
    v_lshl_add_u64 v[30:31], v[30:31], 0, s[30:31]

    ds_add_rtn_u64 v[30:31], v5, v[30:31] offset:50000
    v_mad_i32_i16 v124, v32, v6, s96
    v_mad_i32_i16 v32, v32, v6, s96 op_sel:[1,0,0,0]
    v_mad_i32_i16 v125, v33, v6, s96
    v_mad_i32_i16 v33, v33, v6, s96 op_sel:[1,0,0,0]
    v_lshlrev_b32_sdwa v6, 3, v6 dst_sel:DWORD dst_unused:UNUSED_PAD src0_sel:DWORD src1_sel:WORD_1
    v_perm_b32 v32, v32, v124, s97
    v_perm_b32 v33, v33, v125, s97
    v_lshl_add_u64 v[32:33], v[32:33], 0, s[30:31]

    ds_add_rtn_u64 v[32:33], v6, v[32:33] offset:50000
    v_mad_i32_i16 v126, v34, v7, s96
    v_mad_i32_i16 v34, v34, v7, s96 op_sel:[1,0,0,0]
    v_mad_i32_i16 v127, v35, v7, s96
    v_mad_i32_i16 v35, v35, v7, s96 op_sel:[1,0,0,0]
    v_lshlrev_b32_sdwa v7, 3, v7 dst_sel:DWORD dst_unused:UNUSED_PAD src0_sel:DWORD src1_sel:WORD_1
    v_perm_b32 v34, v34, v126, s97
    v_perm_b32 v35, v35, v127, s97
    v_lshl_add_u64 v[34:35], v[34:35], 0, s[30:31]

    ds_add_rtn_u64 v[34:35], v7, v[34:35] offset:50000
    v_mad_i32_i16 v120, v36, v8, s96
    v_mad_i32_i16 v36, v36, v8, s96 op_sel:[1,0,0,0]
    v_mad_i32_i16 v121, v37, v8, s96
    v_mad_i32_i16 v37, v37, v8, s96 op_sel:[1,0,0,0]
    v_lshlrev_b32_sdwa v8, 3, v8 dst_sel:DWORD dst_unused:UNUSED_PAD src0_sel:DWORD src1_sel:WORD_1
    v_perm_b32 v36, v36, v120, s97
    v_perm_b32 v37, v37, v121, s97
    v_lshl_add_u64 v[36:37], v[36:37], 0, s[30:31]

    ds_add_rtn_u64 v[36:37], v8, v[36:37] offset:50000
    v_mad_i32_i16 v122, v38, v9, s96
    v_mad_i32_i16 v38, v38, v9, s96 op_sel:[1,0,0,0]
    v_mad_i32_i16 v123, v39, v9, s96
    v_mad_i32_i16 v39, v39, v9, s96 op_sel:[1,0,0,0]
    v_lshlrev_b32_sdwa v9, 3, v9 dst_sel:DWORD dst_unused:UNUSED_PAD src0_sel:DWORD src1_sel:WORD_1
    v_perm_b32 v38, v38, v122, s97
    v_perm_b32 v39, v39, v123, s97
    v_lshl_add_u64 v[38:39], v[38:39], 0, s[30:31]

    ds_add_rtn_u64 v[38:39], v9, v[38:39] offset:50000
    v_mad_i32_i16 v124, v40, v10, s96
    v_mad_i32_i16 v40, v40, v10, s96 op_sel:[1,0,0,0]
    v_mad_i32_i16 v125, v41, v10, s96
    v_mad_i32_i16 v41, v41, v10, s96 op_sel:[1,0,0,0]
    v_lshlrev_b32_sdwa v10, 3, v10 dst_sel:DWORD dst_unused:UNUSED_PAD src0_sel:DWORD src1_sel:WORD_1
    v_perm_b32 v40, v40, v124, s97
    v_perm_b32 v41, v41, v125, s97
    v_lshl_add_u64 v[40:41], v[40:41], 0, s[30:31]

    ds_add_rtn_u64 v[40:41], v10, v[40:41] offset:50000
    v_mad_i32_i16 v126, v42, v11, s96
    v_mad_i32_i16 v42, v42, v11, s96 op_sel:[1,0,0,0]
    v_mad_i32_i16 v127, v43, v11, s96
    v_mad_i32_i16 v43, v43, v11, s96 op_sel:[1,0,0,0]
    v_lshlrev_b32_sdwa v11, 3, v11 dst_sel:DWORD dst_unused:UNUSED_PAD src0_sel:DWORD src1_sel:WORD_1
    v_perm_b32 v42, v42, v126, s97
    v_perm_b32 v43, v43, v127, s97
    v_lshl_add_u64 v[42:43], v[42:43], 0, s[30:31]

    ds_add_rtn_u64 v[42:43], v11, v[42:43] offset:50000
    s_waitcnt lgkmcnt(4)
    v_or3_b32 v1, v28, v29, v1
    v_or3_b32 v1, v30, v31, v1
    v_or3_b32 v1, v32, v33, v1
    v_or3_b32 v1, v34, v35, v1
    s_movk_i32 s53, 0
    buffer_load_dwordx4 v[4:7], v2, s[16:19], s53 offen
    buffer_load_dword v35, v2, s[16:19], s53 offen offset:16
    v_mad_i32_i16 v120, v44, v12, s96
    v_mad_i32_i16 v44, v44, v12, s96 op_sel:[1,0,0,0]
    v_mad_i32_i16 v121, v45, v12, s96
    v_mad_i32_i16 v45, v45, v12, s96 op_sel:[1,0,0,0]
    v_lshlrev_b32_sdwa v12, 3, v12 dst_sel:DWORD dst_unused:UNUSED_PAD src0_sel:DWORD src1_sel:WORD_1
    v_perm_b32 v44, v44, v120, s97
    v_perm_b32 v45, v45, v121, s97
    v_lshl_add_u64 v[44:45], v[44:45], 0, s[30:31]

    ds_add_rtn_u64 v[44:45], v12, v[44:45] offset:50000
    v_mad_i32_i16 v122, v46, v13, s96
    v_mad_i32_i16 v46, v46, v13, s96 op_sel:[1,0,0,0]
    v_mad_i32_i16 v123, v47, v13, s96
    v_mad_i32_i16 v47, v47, v13, s96 op_sel:[1,0,0,0]
    v_lshlrev_b32_sdwa v13, 3, v13 dst_sel:DWORD dst_unused:UNUSED_PAD src0_sel:DWORD src1_sel:WORD_1
    v_perm_b32 v46, v46, v122, s97
    v_perm_b32 v47, v47, v123, s97
    v_lshl_add_u64 v[46:47], v[46:47], 0, s[30:31]

    ds_add_rtn_u64 v[46:47], v13, v[46:47] offset:50000
    v_mad_i32_i16 v124, v48, v14, s96
    v_mad_i32_i16 v48, v48, v14, s96 op_sel:[1,0,0,0]
    v_mad_i32_i16 v125, v49, v14, s96
    v_mad_i32_i16 v49, v49, v14, s96 op_sel:[1,0,0,0]
    v_lshlrev_b32_sdwa v14, 3, v14 dst_sel:DWORD dst_unused:UNUSED_PAD src0_sel:DWORD src1_sel:WORD_1
    v_perm_b32 v48, v48, v124, s97
    v_perm_b32 v49, v49, v125, s97
    v_lshl_add_u64 v[48:49], v[48:49], 0, s[30:31]

    ds_add_rtn_u64 v[48:49], v14, v[48:49] offset:50000
    v_mad_i32_i16 v126, v50, v15, s96
    v_mad_i32_i16 v50, v50, v15, s96 op_sel:[1,0,0,0]
    v_mad_i32_i16 v127, v51, v15, s96
    v_mad_i32_i16 v51, v51, v15, s96 op_sel:[1,0,0,0]
    v_lshlrev_b32_sdwa v15, 3, v15 dst_sel:DWORD dst_unused:UNUSED_PAD src0_sel:DWORD src1_sel:WORD_1
    v_perm_b32 v50, v50, v126, s97
    v_perm_b32 v51, v51, v127, s97
    v_lshl_add_u64 v[50:51], v[50:51], 0, s[30:31]

    ds_add_rtn_u64 v[50:51], v15, v[50:51] offset:50000
    s_waitcnt lgkmcnt(4)
    v_or3_b32 v1, v36, v37, v1
    v_or3_b32 v1, v38, v39, v1
    v_or3_b32 v1, v40, v41, v1
    v_or3_b32 v1, v42, v43, v1
    s_movk_i32 s53, 2560
    buffer_load_dwordx4 v[8:11], v2, s[16:19], s53 offen
    buffer_load_dword v43, v2, s[16:19], s53 offen offset:16
    s_barrier
    s_waitcnt vmcnt(9)
    ds_write_addtid_b32 v76 offset:0
    ds_write_addtid_b32 v77 offset:256
    ds_write_addtid_b32 v78 offset:512
    ds_write_addtid_b32 v79 offset:768
    s_waitcnt vmcnt(8)
    ds_write_addtid_b32 v80 offset:16384
    ds_write_addtid_b32 v81 offset:16640
    ds_write_addtid_b32 v82 offset:16896
    ds_write_addtid_b32 v83 offset:17152
    s_waitcnt vmcnt(7)
    ds_write_addtid_b32 v84 offset:32768
    ds_write_addtid_b32 v85 offset:33024
    ds_write_addtid_b32 v86 offset:33280
    ds_write_addtid_b32 v87 offset:33536
    v_lshlrev_b32 v119, 2, v0
    s_waitcnt vmcnt(6)
    s_mov_b64 exec, s[48:49]
    ds_write_b32 v119, v88 offset:49152
    s_mov_b64 exec, -1
    s_add_u32 s43, s43, 50048
    s_add_u32 s14, s43, 50000
    s_min_u32 s14, s14, s41
    s_add_u32 s54, s43, 50048
    buffer_load_dword v115, v89, s[60:63], s54 offen
    s_add_u32 s54, s50, 200000
    buffer_load_dword v115, v89, s[8:11], s54 offen
    s_mov_b32 s40, s88
    s_sub_u32 s42, s40, s39

    s_add_u32 s55, s38, 2
    s_min_u32 s55, s55, 31
    s_mov_b32 s88, s89
    s_mov_b32 s89, s90
    s_mov_b32 s90, s91
    s_mov_b32 s91, s92
    s_mov_b32 s92, s93
    s_mov_b32 s93, s94
    s_mov_b32 s94, s95
    s_mov_b32 s95, 0
    s_min_u32 s88, s88, 3968
    s_lshl_b32 s52, s55, 6
    s_add_u32 s52, s52, s36
    s_mul_i32 s52, s52, 19840
    s_add_u32 s16, s44, s52
    s_addc_u32 s17, s45, 0
    s_mul_i32 s52, s88, 5
    s_add_u32 s52, s52, 3
    s_and_b32 s18, s52, -4

    v_mad_i32_i16 v120, v52, v16, s96
    v_mad_i32_i16 v52, v52, v16, s96 op_sel:[1,0,0,0]
    v_mad_i32_i16 v121, v53, v16, s96
    v_mad_i32_i16 v53, v53, v16, s96 op_sel:[1,0,0,0]
    v_lshlrev_b32_sdwa v16, 3, v16 dst_sel:DWORD dst_unused:UNUSED_PAD src0_sel:DWORD src1_sel:WORD_1
    v_perm_b32 v52, v52, v120, s97
    v_perm_b32 v53, v53, v121, s97
    v_lshl_add_u64 v[52:53], v[52:53], 0, s[30:31]

    ds_add_rtn_u64 v[52:53], v16, v[52:53] offset:50000
    v_mad_i32_i16 v122, v54, v17, s96
    v_mad_i32_i16 v54, v54, v17, s96 op_sel:[1,0,0,0]
    v_mad_i32_i16 v123, v55, v17, s96
    v_mad_i32_i16 v55, v55, v17, s96 op_sel:[1,0,0,0]
    v_lshlrev_b32_sdwa v17, 3, v17 dst_sel:DWORD dst_unused:UNUSED_PAD src0_sel:DWORD src1_sel:WORD_1
    v_perm_b32 v54, v54, v122, s97
    v_perm_b32 v55, v55, v123, s97
    v_lshl_add_u64 v[54:55], v[54:55], 0, s[30:31]

    ds_add_rtn_u64 v[54:55], v17, v[54:55] offset:50000
    v_mad_i32_i16 v124, v56, v18, s96
    v_mad_i32_i16 v56, v56, v18, s96 op_sel:[1,0,0,0]
    v_mad_i32_i16 v125, v57, v18, s96
    v_mad_i32_i16 v57, v57, v18, s96 op_sel:[1,0,0,0]
    v_lshlrev_b32_sdwa v18, 3, v18 dst_sel:DWORD dst_unused:UNUSED_PAD src0_sel:DWORD src1_sel:WORD_1
    v_perm_b32 v56, v56, v124, s97
    v_perm_b32 v57, v57, v125, s97
    v_lshl_add_u64 v[56:57], v[56:57], 0, s[30:31]

    ds_add_rtn_u64 v[56:57], v18, v[56:57] offset:50000
    v_mad_i32_i16 v126, v58, v19, s96
    v_mad_i32_i16 v58, v58, v19, s96 op_sel:[1,0,0,0]
    v_mad_i32_i16 v127, v59, v19, s96
    v_mad_i32_i16 v59, v59, v19, s96 op_sel:[1,0,0,0]
    v_lshlrev_b32_sdwa v19, 3, v19 dst_sel:DWORD dst_unused:UNUSED_PAD src0_sel:DWORD src1_sel:WORD_1
    v_perm_b32 v58, v58, v126, s97
    v_perm_b32 v59, v59, v127, s97
    v_lshl_add_u64 v[58:59], v[58:59], 0, s[30:31]

    ds_add_rtn_u64 v[58:59], v19, v[58:59] offset:50000
    s_waitcnt lgkmcnt(15)
    v_or3_b32 v1, v44, v45, v1
    v_or3_b32 v1, v46, v47, v1
    v_or3_b32 v1, v48, v49, v1
    v_or3_b32 v1, v50, v51, v1
    s_waitcnt vmcnt(26)
    v_perm_b32 v44, v91, v90, s24
    v_perm_b32 v46, v92, v91, s25
    v_perm_b32 v48, v93, v92, s26
    v_perm_b32 v50, v110, v93, s27
    v_mov_b32 v12, v90
    v_alignbyte_b32 v13, v92, v91, 1
    v_alignbyte_b32 v14, v93, v92, 2
    v_alignbyte_b32 v15, v110, v93, 3
    v_lshlrev_b32_sdwa v44, 3, v44 dst_sel:WORD_0 dst_unused:UNUSED_PAD src0_sel:DWORD src1_sel:DWORD
    v_lshlrev_b32_sdwa v46, 3, v46 dst_sel:WORD_0 dst_unused:UNUSED_PAD src0_sel:DWORD src1_sel:DWORD
    v_lshlrev_b32_sdwa v48, 3, v48 dst_sel:WORD_0 dst_unused:UNUSED_PAD src0_sel:DWORD src1_sel:DWORD
    v_lshlrev_b32_sdwa v50, 3, v50 dst_sel:WORD_0 dst_unused:UNUSED_PAD src0_sel:DWORD src1_sel:DWORD
    s_cmp_lt_i32 s42, 1280
    s_cbranch_scc1 L_ufix_73
L_uback_74:

    s_movk_i32 s53, 5120
    buffer_load_dwordx4 v[90:93], v2, s[16:19], s53 offen
    buffer_load_dword v110, v2, s[16:19], s53 offen offset:16
    s_waitcnt lgkmcnt(4)
    s_barrier
    v_subrev_co_u32 v12, s[80:81], 2.0, v12
    v_subrev_co_u32 v13, s[82:83], 2.0, v13
    v_subrev_co_u32 v14, s[84:85], 2.0, v14
    v_subrev_co_u32 v15, s[86:87], 2.0, v15
    s_mov_b64 exec, s[80:81]
    ds_read_b64 v[44:45], v44
    s_mov_b64 exec, s[82:83]
    ds_read_b64 v[46:47], v46
    s_mov_b64 exec, s[84:85]
    ds_read_b64 v[48:49], v48
    s_mov_b64 exec, s[86:87]
    ds_read_b64 v[50:51], v50
    s_mov_b64 exec, -1
    v_mad_i32_i16 v120, v60, v20, s96
    v_mad_i32_i16 v60, v60, v20, s96 op_sel:[1,0,0,0]
    v_mad_i32_i16 v121, v61, v20, s96
    v_mad_i32_i16 v61, v61, v20, s96 op_sel:[1,0,0,0]
    v_lshlrev_b32_sdwa v20, 3, v20 dst_sel:DWORD dst_unused:UNUSED_PAD src0_sel:DWORD src1_sel:WORD_1
    v_perm_b32 v60, v60, v120, s97
    v_perm_b32 v61, v61, v121, s97
    v_lshl_add_u64 v[60:61], v[60:61], 0, s[30:31]

    ds_add_rtn_u64 v[60:61], v20, v[60:61] offset:50000
    v_mad_i32_i16 v122, v62, v21, s96
    v_mad_i32_i16 v62, v62, v21, s96 op_sel:[1,0,0,0]
    v_mad_i32_i16 v123, v63, v21, s96
    v_mad_i32_i16 v63, v63, v21, s96 op_sel:[1,0,0,0]
    v_lshlrev_b32_sdwa v21, 3, v21 dst_sel:DWORD dst_unused:UNUSED_PAD src0_sel:DWORD src1_sel:WORD_1
    v_perm_b32 v62, v62, v122, s97
    v_perm_b32 v63, v63, v123, s97
    v_lshl_add_u64 v[62:63], v[62:63], 0, s[30:31]

    ds_add_rtn_u64 v[62:63], v21, v[62:63] offset:50000
    v_mad_i32_i16 v124, v64, v22, s96
    v_mad_i32_i16 v64, v64, v22, s96 op_sel:[1,0,0,0]
    v_mad_i32_i16 v125, v65, v22, s96
    v_mad_i32_i16 v65, v65, v22, s96 op_sel:[1,0,0,0]
    v_lshlrev_b32_sdwa v22, 3, v22 dst_sel:DWORD dst_unused:UNUSED_PAD src0_sel:DWORD src1_sel:WORD_1
    v_perm_b32 v64, v64, v124, s97
    v_perm_b32 v65, v65, v125, s97
    v_lshl_add_u64 v[64:65], v[64:65], 0, s[30:31]

    ds_add_rtn_u64 v[64:65], v22, v[64:65] offset:50000
    v_mad_i32_i16 v126, v66, v23, s96
    v_mad_i32_i16 v66, v66, v23, s96 op_sel:[1,0,0,0]
    v_mad_i32_i16 v127, v67, v23, s96
    v_mad_i32_i16 v67, v67, v23, s96 op_sel:[1,0,0,0]
    v_lshlrev_b32_sdwa v23, 3, v23 dst_sel:DWORD dst_unused:UNUSED_PAD src0_sel:DWORD src1_sel:WORD_1
    v_perm_b32 v66, v66, v126, s97
    v_perm_b32 v67, v67, v127, s97
    v_lshl_add_u64 v[66:67], v[66:67], 0, s[30:31]

    ds_add_rtn_u64 v[66:67], v23, v[66:67] offset:50000
    s_waitcnt lgkmcnt(8)
    v_or3_b32 v1, v52, v53, v1
    v_or3_b32 v1, v54, v55, v1
    v_or3_b32 v1, v56, v57, v1
    v_or3_b32 v1, v58, v59, v1
    s_waitcnt vmcnt(26)
    v_perm_b32 v52, v95, v94, s24
    v_perm_b32 v54, v96, v95, s25
    v_perm_b32 v56, v97, v96, s26
    v_perm_b32 v58, v111, v97, s27
    v_mov_b32 v16, v94
    v_alignbyte_b32 v17, v96, v95, 1
    v_alignbyte_b32 v18, v97, v96, 2
    v_alignbyte_b32 v19, v111, v97, 3
    v_lshlrev_b32_sdwa v52, 3, v52 dst_sel:WORD_0 dst_unused:UNUSED_PAD src0_sel:DWORD src1_sel:DWORD
    v_lshlrev_b32_sdwa v54, 3, v54 dst_sel:WORD_0 dst_unused:UNUSED_PAD src0_sel:DWORD src1_sel:DWORD
    v_lshlrev_b32_sdwa v56, 3, v56 dst_sel:WORD_0 dst_unused:UNUSED_PAD src0_sel:DWORD src1_sel:DWORD
    v_lshlrev_b32_sdwa v58, 3, v58 dst_sel:WORD_0 dst_unused:UNUSED_PAD src0_sel:DWORD src1_sel:DWORD
    s_cmp_lt_i32 s42, 1792
    s_cbranch_scc1 L_ufix_75
L_uback_76:

    v_subrev_co_u32 v16, s[64:65], 2.0, v16
    v_subrev_co_u32 v17, s[66:67], 2.0, v17
    v_subrev_co_u32 v18, s[68:69], 2.0, v18
    v_subrev_co_u32 v19, s[70:71], 2.0, v19
    s_mov_b64 exec, s[64:65]
    ds_read_b64 v[52:53], v52
    s_mov_b64 exec, s[66:67]
    ds_read_b64 v[54:55], v54
    s_mov_b64 exec, s[68:69]
    ds_read_b64 v[56:57], v56
    s_mov_b64 exec, s[70:71]
    ds_read_b64 v[58:59], v58
    s_mov_b64 exec, -1
    v_mad_i32_i16 v120, v68, v24, s96
    v_mad_i32_i16 v68, v68, v24, s96 op_sel:[1,0,0,0]
    v_mad_i32_i16 v121, v69, v24, s96
    v_mad_i32_i16 v69, v69, v24, s96 op_sel:[1,0,0,0]
    v_lshlrev_b32_sdwa v24, 3, v24 dst_sel:DWORD dst_unused:UNUSED_PAD src0_sel:DWORD src1_sel:WORD_1
    v_perm_b32 v68, v68, v120, s97
    v_perm_b32 v69, v69, v121, s97
    v_lshl_add_u64 v[68:69], v[68:69], 0, s[30:31]

    ds_add_rtn_u64 v[68:69], v24, v[68:69] offset:50000
    v_mad_i32_i16 v122, v70, v25, s96
    v_mad_i32_i16 v70, v70, v25, s96 op_sel:[1,0,0,0]
    v_mad_i32_i16 v123, v71, v25, s96
    v_mad_i32_i16 v71, v71, v25, s96 op_sel:[1,0,0,0]
    v_lshlrev_b32_sdwa v25, 3, v25 dst_sel:DWORD dst_unused:UNUSED_PAD src0_sel:DWORD src1_sel:WORD_1
    v_perm_b32 v70, v70, v122, s97
    v_perm_b32 v71, v71, v123, s97
    v_lshl_add_u64 v[70:71], v[70:71], 0, s[30:31]

    ds_add_rtn_u64 v[70:71], v25, v[70:71] offset:50000
    v_mad_i32_i16 v124, v72, v26, s96
    v_mad_i32_i16 v72, v72, v26, s96 op_sel:[1,0,0,0]
    v_mad_i32_i16 v125, v73, v26, s96
    v_mad_i32_i16 v73, v73, v26, s96 op_sel:[1,0,0,0]
    v_lshlrev_b32_sdwa v26, 3, v26 dst_sel:DWORD dst_unused:UNUSED_PAD src0_sel:DWORD src1_sel:WORD_1
    v_perm_b32 v72, v72, v124, s97
    v_perm_b32 v73, v73, v125, s97
    v_lshl_add_u64 v[72:73], v[72:73], 0, s[30:31]

    ds_add_rtn_u64 v[72:73], v26, v[72:73] offset:50000
    v_mad_i32_i16 v126, v74, v27, s96
    v_mad_i32_i16 v74, v74, v27, s96 op_sel:[1,0,0,0]
    v_mad_i32_i16 v127, v75, v27, s96
    v_mad_i32_i16 v75, v75, v27, s96 op_sel:[1,0,0,0]
    v_lshlrev_b32_sdwa v27, 3, v27 dst_sel:DWORD dst_unused:UNUSED_PAD src0_sel:DWORD src1_sel:WORD_1
    v_perm_b32 v74, v74, v126, s97
    v_perm_b32 v75, v75, v127, s97
    v_lshl_add_u64 v[74:75], v[74:75], 0, s[30:31]

    ds_add_rtn_u64 v[74:75], v27, v[74:75] offset:50000
    s_waitcnt lgkmcnt(8)
    v_or3_b32 v1, v60, v61, v1
    v_or3_b32 v1, v62, v63, v1
    v_or3_b32 v1, v64, v65, v1
    v_or3_b32 v1, v66, v67, v1
    s_waitcnt vmcnt(16)
    v_perm_b32 v60, v99, v98, s24
    v_perm_b32 v62, v100, v99, s25
    v_perm_b32 v64, v101, v100, s26
    v_perm_b32 v66, v112, v101, s27
    v_mov_b32 v20, v98
    v_alignbyte_b32 v21, v100, v99, 1
    v_alignbyte_b32 v22, v101, v100, 2
    v_alignbyte_b32 v23, v112, v101, 3
    v_lshlrev_b32_sdwa v60, 3, v60 dst_sel:WORD_0 dst_unused:UNUSED_PAD src0_sel:DWORD src1_sel:DWORD
    v_lshlrev_b32_sdwa v62, 3, v62 dst_sel:WORD_0 dst_unused:UNUSED_PAD src0_sel:DWORD src1_sel:DWORD
    v_lshlrev_b32_sdwa v64, 3, v64 dst_sel:WORD_0 dst_unused:UNUSED_PAD src0_sel:DWORD src1_sel:DWORD
    v_lshlrev_b32_sdwa v66, 3, v66 dst_sel:WORD_0 dst_unused:UNUSED_PAD src0_sel:DWORD src1_sel:DWORD
    s_cmp_lt_i32 s42, 2304
    s_cbranch_scc1 L_ufix_77
L_uback_78:

    v_subrev_co_u32 v20, s[72:73], 2.0, v20
    v_subrev_co_u32 v21, s[74:75], 2.0, v21
    v_subrev_co_u32 v22, s[76:77], 2.0, v22
    v_subrev_co_u32 v23, s[78:79], 2.0, v23
    s_mov_b64 exec, s[72:73]
    ds_read_b64 v[60:61], v60
    s_mov_b64 exec, s[74:75]
    ds_read_b64 v[62:63], v62
    s_mov_b64 exec, s[76:77]
    ds_read_b64 v[64:65], v64
    s_mov_b64 exec, s[78:79]
    ds_read_b64 v[66:67], v66
    s_mov_b64 exec, -1
    s_waitcnt lgkmcnt(4)
    v_or3_b32 v1, v68, v69, v1
    v_or3_b32 v1, v70, v71, v1
    v_or3_b32 v1, v72, v73, v1
    v_or3_b32 v1, v74, v75, v1
    s_waitcnt vmcnt(8)
    v_perm_b32 v68, v103, v102, s24
    v_perm_b32 v70, v104, v103, s25
    v_perm_b32 v72, v105, v104, s26
    v_perm_b32 v74, v113, v105, s27
    v_mov_b32 v24, v102
    v_alignbyte_b32 v25, v104, v103, 1
    v_alignbyte_b32 v26, v105, v104, 2
    v_alignbyte_b32 v27, v113, v105, 3
    v_lshlrev_b32_sdwa v68, 3, v68 dst_sel:WORD_0 dst_unused:UNUSED_PAD src0_sel:DWORD src1_sel:DWORD
    v_lshlrev_b32_sdwa v70, 3, v70 dst_sel:WORD_0 dst_unused:UNUSED_PAD src0_sel:DWORD src1_sel:DWORD
    v_lshlrev_b32_sdwa v72, 3, v72 dst_sel:WORD_0 dst_unused:UNUSED_PAD src0_sel:DWORD src1_sel:DWORD
    v_lshlrev_b32_sdwa v74, 3, v74 dst_sel:WORD_0 dst_unused:UNUSED_PAD src0_sel:DWORD src1_sel:DWORD
    s_cmp_lt_i32 s42, 2816
    s_cbranch_scc1 L_ufix_79
L_uback_80:

    v_subrev_co_u32 v24, s[80:81], 2.0, v24
    v_subrev_co_u32 v25, s[82:83], 2.0, v25
    v_subrev_co_u32 v26, s[84:85], 2.0, v26
    v_subrev_co_u32 v27, s[86:87], 2.0, v27
    s_mov_b64 exec, s[80:81]
    ds_read_b64 v[68:69], v68
    s_mov_b64 exec, s[82:83]
    ds_read_b64 v[70:71], v70
    s_mov_b64 exec, s[84:85]
    ds_read_b64 v[72:73], v72
    s_mov_b64 exec, s[86:87]
    ds_read_b64 v[74:75], v74
    s_mov_b64 exec, -1
    buffer_load_dwordx4 v[76:79], v3, s[12:15], s43 offen
    s_add_u32 s52, s43, 16384
    buffer_load_dwordx4 v[80:83], v3, s[12:15], s52 offen
    s_add_u32 s52, s43, 32768
    buffer_load_dwordx4 v[84:87], v3, s[12:15], s52 offen
    s_add_u32 s52, s43, 49152
    v_lshlrev_b32 v119, 2, v0
    buffer_load_dword v88, v119, s[12:15], s52 offen
    s_waitcnt vmcnt(10)
    v_perm_b32 v28, v5, v4, s24
    v_perm_b32 v30, v6, v5, s25
    v_perm_b32 v32, v7, v6, s26
    v_perm_b32 v34, v35, v7, s27
    v_alignbyte_b32 v5, v6, v5, 1
    v_alignbyte_b32 v6, v7, v6, 2
    v_alignbyte_b32 v7, v35, v7, 3
    v_lshlrev_b32_sdwa v28, 3, v28 dst_sel:WORD_0 dst_unused:UNUSED_PAD src0_sel:DWORD src1_sel:DWORD
    v_lshlrev_b32_sdwa v30, 3, v30 dst_sel:WORD_0 dst_unused:UNUSED_PAD src0_sel:DWORD src1_sel:DWORD
    v_lshlrev_b32_sdwa v32, 3, v32 dst_sel:WORD_0 dst_unused:UNUSED_PAD src0_sel:DWORD src1_sel:DWORD
    v_lshlrev_b32_sdwa v34, 3, v34 dst_sel:WORD_0 dst_unused:UNUSED_PAD src0_sel:DWORD src1_sel:DWORD
    s_cmp_lt_i32 s42, 256
    s_cbranch_scc1 L_ufix_81
L_uback_82:

    v_subrev_co_u32 v4, s[64:65], 2.0, v4
    v_subrev_co_u32 v5, s[66:67], 2.0, v5
    v_subrev_co_u32 v6, s[68:69], 2.0, v6
    v_subrev_co_u32 v7, s[70:71], 2.0, v7
    s_mov_b64 exec, s[64:65]
    ds_read_b64 v[28:29], v28
    s_mov_b64 exec, s[66:67]
    ds_read_b64 v[30:31], v30
    s_mov_b64 exec, s[68:69]
    ds_read_b64 v[32:33], v32
    s_mov_b64 exec, s[70:71]
    ds_read_b64 v[34:35], v34
    s_mov_b64 exec, -1
    s_waitcnt vmcnt(8)
    v_perm_b32 v36, v9, v8, s24
    v_perm_b32 v38, v10, v9, s25
    v_perm_b32 v40, v11, v10, s26
    v_perm_b32 v42, v43, v11, s27
    v_alignbyte_b32 v9, v10, v9, 1
    v_alignbyte_b32 v10, v11, v10, 2
    v_alignbyte_b32 v11, v43, v11, 3
    v_lshlrev_b32_sdwa v36, 3, v36 dst_sel:WORD_0 dst_unused:UNUSED_PAD src0_sel:DWORD src1_sel:DWORD
    v_lshlrev_b32_sdwa v38, 3, v38 dst_sel:WORD_0 dst_unused:UNUSED_PAD src0_sel:DWORD src1_sel:DWORD
    v_lshlrev_b32_sdwa v40, 3, v40 dst_sel:WORD_0 dst_unused:UNUSED_PAD src0_sel:DWORD src1_sel:DWORD
    v_lshlrev_b32_sdwa v42, 3, v42 dst_sel:WORD_0 dst_unused:UNUSED_PAD src0_sel:DWORD src1_sel:DWORD
    s_cmp_lt_i32 s42, 768
    s_cbranch_scc1 L_ufix_83
L_uback_84:

    v_subrev_co_u32 v8, s[72:73], 2.0, v8
    v_subrev_co_u32 v9, s[74:75], 2.0, v9
    v_subrev_co_u32 v10, s[76:77], 2.0, v10
    v_subrev_co_u32 v11, s[78:79], 2.0, v11
    s_mov_b64 exec, s[72:73]
    ds_read_b64 v[36:37], v36
    s_mov_b64 exec, s[74:75]
    ds_read_b64 v[38:39], v38
    s_mov_b64 exec, s[76:77]
    ds_read_b64 v[40:41], v40
    s_mov_b64 exec, s[78:79]
    ds_read_b64 v[42:43], v42
    s_mov_b64 exec, -1
    s_mov_b32 s38, s5
    s_add_u32 s50, s50, 200000
    s_branch L_batch_64
L_bend_65:

    s_load_dwordx2 s[64:65], s[0:1], 24
    s_load_dwordx2 s[86:87], s[0:1], 40
    s_load_dwordx8 s[88:95], s[0:1], 56
    s_mov_b32 s66, 1600000
    s_mov_b32 s67, 0x20000

    s_waitcnt lgkmcnt(15)
    v_mad_i32_i16 v120, v28, v4, s96
    v_mad_i32_i16 v28, v28, v4, s96 op_sel:[1,0,0,0]
    v_mad_i32_i16 v121, v29, v4, s96
    v_mad_i32_i16 v29, v29, v4, s96 op_sel:[1,0,0,0]
    v_lshlrev_b32_sdwa v4, 3, v4 dst_sel:DWORD dst_unused:UNUSED_PAD src0_sel:DWORD src1_sel:WORD_1
    v_perm_b32 v28, v28, v120, s97
    v_perm_b32 v29, v29, v121, s97
    v_lshl_add_u64 v[28:29], v[28:29], 0, s[30:31]

    ds_add_rtn_u64 v[28:29], v4, v[28:29] offset:50000
    v_mad_i32_i16 v122, v30, v5, s96
    v_mad_i32_i16 v30, v30, v5, s96 op_sel:[1,0,0,0]
    v_mad_i32_i16 v123, v31, v5, s96
    v_mad_i32_i16 v31, v31, v5, s96 op_sel:[1,0,0,0]
    v_lshlrev_b32_sdwa v5, 3, v5 dst_sel:DWORD dst_unused:UNUSED_PAD src0_sel:DWORD src1_sel:WORD_1
    v_perm_b32 v30, v30, v122, s97
    v_perm_b32 v31, v31, v123, s97
    v_lshl_add_u64 v[30:31], v[30:31], 0, s[30:31]

    ds_add_rtn_u64 v[30:31], v5, v[30:31] offset:50000
    v_mad_i32_i16 v124, v32, v6, s96
    v_mad_i32_i16 v32, v32, v6, s96 op_sel:[1,0,0,0]
    v_mad_i32_i16 v125, v33, v6, s96
    v_mad_i32_i16 v33, v33, v6, s96 op_sel:[1,0,0,0]
    v_lshlrev_b32_sdwa v6, 3, v6 dst_sel:DWORD dst_unused:UNUSED_PAD src0_sel:DWORD src1_sel:WORD_1
    v_perm_b32 v32, v32, v124, s97
    v_perm_b32 v33, v33, v125, s97
    v_lshl_add_u64 v[32:33], v[32:33], 0, s[30:31]

    ds_add_rtn_u64 v[32:33], v6, v[32:33] offset:50000
    v_mad_i32_i16 v126, v34, v7, s96
    v_mad_i32_i16 v34, v34, v7, s96 op_sel:[1,0,0,0]
    v_mad_i32_i16 v127, v35, v7, s96
    v_mad_i32_i16 v35, v35, v7, s96 op_sel:[1,0,0,0]
    v_lshlrev_b32_sdwa v7, 3, v7 dst_sel:DWORD dst_unused:UNUSED_PAD src0_sel:DWORD src1_sel:WORD_1
    v_perm_b32 v34, v34, v126, s97
    v_perm_b32 v35, v35, v127, s97
    v_lshl_add_u64 v[34:35], v[34:35], 0, s[30:31]

    ds_add_rtn_u64 v[34:35], v7, v[34:35] offset:50000
    v_mad_i32_i16 v120, v36, v8, s96
    v_mad_i32_i16 v36, v36, v8, s96 op_sel:[1,0,0,0]
    v_mad_i32_i16 v121, v37, v8, s96
    v_mad_i32_i16 v37, v37, v8, s96 op_sel:[1,0,0,0]
    v_lshlrev_b32_sdwa v8, 3, v8 dst_sel:DWORD dst_unused:UNUSED_PAD src0_sel:DWORD src1_sel:WORD_1
    v_perm_b32 v36, v36, v120, s97
    v_perm_b32 v37, v37, v121, s97
    v_lshl_add_u64 v[36:37], v[36:37], 0, s[30:31]

    ds_add_rtn_u64 v[36:37], v8, v[36:37] offset:50000
    v_mad_i32_i16 v122, v38, v9, s96
    v_mad_i32_i16 v38, v38, v9, s96 op_sel:[1,0,0,0]
    v_mad_i32_i16 v123, v39, v9, s96
    v_mad_i32_i16 v39, v39, v9, s96 op_sel:[1,0,0,0]
    v_lshlrev_b32_sdwa v9, 3, v9 dst_sel:DWORD dst_unused:UNUSED_PAD src0_sel:DWORD src1_sel:WORD_1
    v_perm_b32 v38, v38, v122, s97
    v_perm_b32 v39, v39, v123, s97
    v_lshl_add_u64 v[38:39], v[38:39], 0, s[30:31]

    ds_add_rtn_u64 v[38:39], v9, v[38:39] offset:50000
    v_mad_i32_i16 v124, v40, v10, s96
    v_mad_i32_i16 v40, v40, v10, s96 op_sel:[1,0,0,0]
    v_mad_i32_i16 v125, v41, v10, s96
    v_mad_i32_i16 v41, v41, v10, s96 op_sel:[1,0,0,0]
    v_lshlrev_b32_sdwa v10, 3, v10 dst_sel:DWORD dst_unused:UNUSED_PAD src0_sel:DWORD src1_sel:WORD_1
    v_perm_b32 v40, v40, v124, s97
    v_perm_b32 v41, v41, v125, s97
    v_lshl_add_u64 v[40:41], v[40:41], 0, s[30:31]

    ds_add_rtn_u64 v[40:41], v10, v[40:41] offset:50000
    v_mad_i32_i16 v126, v42, v11, s96
    v_mad_i32_i16 v42, v42, v11, s96 op_sel:[1,0,0,0]
    v_mad_i32_i16 v127, v43, v11, s96
    v_mad_i32_i16 v43, v43, v11, s96 op_sel:[1,0,0,0]
    v_lshlrev_b32_sdwa v11, 3, v11 dst_sel:DWORD dst_unused:UNUSED_PAD src0_sel:DWORD src1_sel:WORD_1
    v_perm_b32 v42, v42, v126, s97
    v_perm_b32 v43, v43, v127, s97
    v_lshl_add_u64 v[42:43], v[42:43], 0, s[30:31]

    ds_add_rtn_u64 v[42:43], v11, v[42:43] offset:50000
    s_waitcnt lgkmcnt(4)
    v_or3_b32 v1, v28, v29, v1
    v_or3_b32 v1, v30, v31, v1
    v_or3_b32 v1, v32, v33, v1
    v_or3_b32 v1, v34, v35, v1
    v_mad_i32_i16 v120, v44, v12, s96
    v_mad_i32_i16 v44, v44, v12, s96 op_sel:[1,0,0,0]
    v_mad_i32_i16 v121, v45, v12, s96
    v_mad_i32_i16 v45, v45, v12, s96 op_sel:[1,0,0,0]
    v_lshlrev_b32_sdwa v12, 3, v12 dst_sel:DWORD dst_unused:UNUSED_PAD src0_sel:DWORD src1_sel:WORD_1
    v_perm_b32 v44, v44, v120, s97
    v_perm_b32 v45, v45, v121, s97
    v_lshl_add_u64 v[44:45], v[44:45], 0, s[30:31]

    ds_add_rtn_u64 v[44:45], v12, v[44:45] offset:50000
    v_mad_i32_i16 v122, v46, v13, s96
    v_mad_i32_i16 v46, v46, v13, s96 op_sel:[1,0,0,0]
    v_mad_i32_i16 v123, v47, v13, s96
    v_mad_i32_i16 v47, v47, v13, s96 op_sel:[1,0,0,0]
    v_lshlrev_b32_sdwa v13, 3, v13 dst_sel:DWORD dst_unused:UNUSED_PAD src0_sel:DWORD src1_sel:WORD_1
    v_perm_b32 v46, v46, v122, s97
    v_perm_b32 v47, v47, v123, s97
    v_lshl_add_u64 v[46:47], v[46:47], 0, s[30:31]

    ds_add_rtn_u64 v[46:47], v13, v[46:47] offset:50000
    v_mad_i32_i16 v124, v48, v14, s96
    v_mad_i32_i16 v48, v48, v14, s96 op_sel:[1,0,0,0]
    v_mad_i32_i16 v125, v49, v14, s96
    v_mad_i32_i16 v49, v49, v14, s96 op_sel:[1,0,0,0]
    v_lshlrev_b32_sdwa v14, 3, v14 dst_sel:DWORD dst_unused:UNUSED_PAD src0_sel:DWORD src1_sel:WORD_1
    v_perm_b32 v48, v48, v124, s97
    v_perm_b32 v49, v49, v125, s97
    v_lshl_add_u64 v[48:49], v[48:49], 0, s[30:31]

    ds_add_rtn_u64 v[48:49], v14, v[48:49] offset:50000
    v_mad_i32_i16 v126, v50, v15, s96
    v_mad_i32_i16 v50, v50, v15, s96 op_sel:[1,0,0,0]
    v_mad_i32_i16 v127, v51, v15, s96
    v_mad_i32_i16 v51, v51, v15, s96 op_sel:[1,0,0,0]
    v_lshlrev_b32_sdwa v15, 3, v15 dst_sel:DWORD dst_unused:UNUSED_PAD src0_sel:DWORD src1_sel:WORD_1
    v_perm_b32 v50, v50, v126, s97
    v_perm_b32 v51, v51, v127, s97
    v_lshl_add_u64 v[50:51], v[50:51], 0, s[30:31]

    ds_add_rtn_u64 v[50:51], v15, v[50:51] offset:50000
    s_waitcnt lgkmcnt(4)
    v_or3_b32 v1, v36, v37, v1
    v_or3_b32 v1, v38, v39, v1
    v_or3_b32 v1, v40, v41, v1
    v_or3_b32 v1, v42, v43, v1
    v_mad_i32_i16 v120, v52, v16, s96
    v_mad_i32_i16 v52, v52, v16, s96 op_sel:[1,0,0,0]
    v_mad_i32_i16 v121, v53, v16, s96
    v_mad_i32_i16 v53, v53, v16, s96 op_sel:[1,0,0,0]
    v_lshlrev_b32_sdwa v16, 3, v16 dst_sel:DWORD dst_unused:UNUSED_PAD src0_sel:DWORD src1_sel:WORD_1
    v_perm_b32 v52, v52, v120, s97
    v_perm_b32 v53, v53, v121, s97
    v_lshl_add_u64 v[52:53], v[52:53], 0, s[30:31]

    ds_add_rtn_u64 v[52:53], v16, v[52:53] offset:50000
    v_mad_i32_i16 v122, v54, v17, s96
    v_mad_i32_i16 v54, v54, v17, s96 op_sel:[1,0,0,0]
    v_mad_i32_i16 v123, v55, v17, s96
    v_mad_i32_i16 v55, v55, v17, s96 op_sel:[1,0,0,0]
    v_lshlrev_b32_sdwa v17, 3, v17 dst_sel:DWORD dst_unused:UNUSED_PAD src0_sel:DWORD src1_sel:WORD_1
    v_perm_b32 v54, v54, v122, s97
    v_perm_b32 v55, v55, v123, s97
    v_lshl_add_u64 v[54:55], v[54:55], 0, s[30:31]

    ds_add_rtn_u64 v[54:55], v17, v[54:55] offset:50000
    v_mad_i32_i16 v124, v56, v18, s96
    v_mad_i32_i16 v56, v56, v18, s96 op_sel:[1,0,0,0]
    v_mad_i32_i16 v125, v57, v18, s96
    v_mad_i32_i16 v57, v57, v18, s96 op_sel:[1,0,0,0]
    v_lshlrev_b32_sdwa v18, 3, v18 dst_sel:DWORD dst_unused:UNUSED_PAD src0_sel:DWORD src1_sel:WORD_1
    v_perm_b32 v56, v56, v124, s97
    v_perm_b32 v57, v57, v125, s97
    v_lshl_add_u64 v[56:57], v[56:57], 0, s[30:31]

    ds_add_rtn_u64 v[56:57], v18, v[56:57] offset:50000
    v_mad_i32_i16 v126, v58, v19, s96
    v_mad_i32_i16 v58, v58, v19, s96 op_sel:[1,0,0,0]
    v_mad_i32_i16 v127, v59, v19, s96
    v_mad_i32_i16 v59, v59, v19, s96 op_sel:[1,0,0,0]
    v_lshlrev_b32_sdwa v19, 3, v19 dst_sel:DWORD dst_unused:UNUSED_PAD src0_sel:DWORD src1_sel:WORD_1
    v_perm_b32 v58, v58, v126, s97
    v_perm_b32 v59, v59, v127, s97
    v_lshl_add_u64 v[58:59], v[58:59], 0, s[30:31]

    ds_add_rtn_u64 v[58:59], v19, v[58:59] offset:50000
    s_waitcnt lgkmcnt(4)
    v_or3_b32 v1, v44, v45, v1
    v_or3_b32 v1, v46, v47, v1
    v_or3_b32 v1, v48, v49, v1
    v_or3_b32 v1, v50, v51, v1
    v_mad_i32_i16 v120, v60, v20, s96
    v_mad_i32_i16 v60, v60, v20, s96 op_sel:[1,0,0,0]
    v_mad_i32_i16 v121, v61, v20, s96
    v_mad_i32_i16 v61, v61, v20, s96 op_sel:[1,0,0,0]
    v_lshlrev_b32_sdwa v20, 3, v20 dst_sel:DWORD dst_unused:UNUSED_PAD src0_sel:DWORD src1_sel:WORD_1
    v_perm_b32 v60, v60, v120, s97
    v_perm_b32 v61, v61, v121, s97
    v_lshl_add_u64 v[60:61], v[60:61], 0, s[30:31]

    ds_add_rtn_u64 v[60:61], v20, v[60:61] offset:50000
    v_mad_i32_i16 v122, v62, v21, s96
    v_mad_i32_i16 v62, v62, v21, s96 op_sel:[1,0,0,0]
    v_mad_i32_i16 v123, v63, v21, s96
    v_mad_i32_i16 v63, v63, v21, s96 op_sel:[1,0,0,0]
    v_lshlrev_b32_sdwa v21, 3, v21 dst_sel:DWORD dst_unused:UNUSED_PAD src0_sel:DWORD src1_sel:WORD_1
    v_perm_b32 v62, v62, v122, s97
    v_perm_b32 v63, v63, v123, s97
    v_lshl_add_u64 v[62:63], v[62:63], 0, s[30:31]

    ds_add_rtn_u64 v[62:63], v21, v[62:63] offset:50000
    v_mad_i32_i16 v124, v64, v22, s96
    v_mad_i32_i16 v64, v64, v22, s96 op_sel:[1,0,0,0]
    v_mad_i32_i16 v125, v65, v22, s96
    v_mad_i32_i16 v65, v65, v22, s96 op_sel:[1,0,0,0]
    v_lshlrev_b32_sdwa v22, 3, v22 dst_sel:DWORD dst_unused:UNUSED_PAD src0_sel:DWORD src1_sel:WORD_1
    v_perm_b32 v64, v64, v124, s97
    v_perm_b32 v65, v65, v125, s97
    v_lshl_add_u64 v[64:65], v[64:65], 0, s[30:31]

    ds_add_rtn_u64 v[64:65], v22, v[64:65] offset:50000
    v_mad_i32_i16 v126, v66, v23, s96
    v_mad_i32_i16 v66, v66, v23, s96 op_sel:[1,0,0,0]
    v_mad_i32_i16 v127, v67, v23, s96
    v_mad_i32_i16 v67, v67, v23, s96 op_sel:[1,0,0,0]
    v_lshlrev_b32_sdwa v23, 3, v23 dst_sel:DWORD dst_unused:UNUSED_PAD src0_sel:DWORD src1_sel:WORD_1
    v_perm_b32 v66, v66, v126, s97
    v_perm_b32 v67, v67, v127, s97
    v_lshl_add_u64 v[66:67], v[66:67], 0, s[30:31]

    ds_add_rtn_u64 v[66:67], v23, v[66:67] offset:50000
    s_waitcnt lgkmcnt(4)
    v_or3_b32 v1, v52, v53, v1
    v_or3_b32 v1, v54, v55, v1
    v_or3_b32 v1, v56, v57, v1
    v_or3_b32 v1, v58, v59, v1
    v_mad_i32_i16 v120, v68, v24, s96
    v_mad_i32_i16 v68, v68, v24, s96 op_sel:[1,0,0,0]
    v_mad_i32_i16 v121, v69, v24, s96
    v_mad_i32_i16 v69, v69, v24, s96 op_sel:[1,0,0,0]
    v_lshlrev_b32_sdwa v24, 3, v24 dst_sel:DWORD dst_unused:UNUSED_PAD src0_sel:DWORD src1_sel:WORD_1
    v_perm_b32 v68, v68, v120, s97
    v_perm_b32 v69, v69, v121, s97
    v_lshl_add_u64 v[68:69], v[68:69], 0, s[30:31]

    ds_add_rtn_u64 v[68:69], v24, v[68:69] offset:50000
    v_mad_i32_i16 v122, v70, v25, s96
    v_mad_i32_i16 v70, v70, v25, s96 op_sel:[1,0,0,0]
    v_mad_i32_i16 v123, v71, v25, s96
    v_mad_i32_i16 v71, v71, v25, s96 op_sel:[1,0,0,0]
    v_lshlrev_b32_sdwa v25, 3, v25 dst_sel:DWORD dst_unused:UNUSED_PAD src0_sel:DWORD src1_sel:WORD_1
    v_perm_b32 v70, v70, v122, s97
    v_perm_b32 v71, v71, v123, s97
    v_lshl_add_u64 v[70:71], v[70:71], 0, s[30:31]

    ds_add_rtn_u64 v[70:71], v25, v[70:71] offset:50000
    v_mad_i32_i16 v124, v72, v26, s96
    v_mad_i32_i16 v72, v72, v26, s96 op_sel:[1,0,0,0]
    v_mad_i32_i16 v125, v73, v26, s96
    v_mad_i32_i16 v73, v73, v26, s96 op_sel:[1,0,0,0]
    v_lshlrev_b32_sdwa v26, 3, v26 dst_sel:DWORD dst_unused:UNUSED_PAD src0_sel:DWORD src1_sel:WORD_1
    v_perm_b32 v72, v72, v124, s97
    v_perm_b32 v73, v73, v125, s97
    v_lshl_add_u64 v[72:73], v[72:73], 0, s[30:31]

    ds_add_rtn_u64 v[72:73], v26, v[72:73] offset:50000
    v_mad_i32_i16 v126, v74, v27, s96
    v_mad_i32_i16 v74, v74, v27, s96 op_sel:[1,0,0,0]
    v_mad_i32_i16 v127, v75, v27, s96
    v_mad_i32_i16 v75, v75, v27, s96 op_sel:[1,0,0,0]
    v_lshlrev_b32_sdwa v27, 3, v27 dst_sel:DWORD dst_unused:UNUSED_PAD src0_sel:DWORD src1_sel:WORD_1
    v_perm_b32 v74, v74, v126, s97
    v_perm_b32 v75, v75, v127, s97
    v_lshl_add_u64 v[74:75], v[74:75], 0, s[30:31]

    ds_add_rtn_u64 v[74:75], v27, v[74:75] offset:50000
    s_waitcnt lgkmcnt(4)
    v_or3_b32 v1, v60, v61, v1
    v_or3_b32 v1, v62, v63, v1
    v_or3_b32 v1, v64, v65, v1
    v_or3_b32 v1, v66, v67, v1
    s_waitcnt lgkmcnt(0)
    v_or3_b32 v1, v68, v69, v1
    v_or3_b32 v1, v70, v71, v1
    v_or3_b32 v1, v72, v73, v1
    v_or3_b32 v1, v74, v75, v1
    s_waitcnt vmcnt(0)
    s_waitcnt lgkmcnt(0)
    s_load_dwordx4 s[28:31], s[86:87], 0
    s_load_dwordx16 s[68:83], s[88:89], 0
    s_load_dwordx8 s[12:19], s[92:93], 0
    s_load_dwordx8 s[56:63], s[94:95], 0
    s_mov_b64 s[48:49], s[90:91]
    s_load_dwordx16 s[84:99], s[48:49], 0

    s_mov_b32 s41, s37
    s_mul_i32 s3, s41, 3125
    s_add_u32 s5, s3, 3126
    s_add_u32 s3, s3, 1
    s_lshr_b32 s3, s3, 1
    s_lshr_b32 s5, s5, 1
    s_sub_u32 s5, s5, s3
    s_sub_u32 s5, s5, 782
    v_cmp_gt_u32 vcc, s5, v0
    s_mul_i32 s5, s36, 6250
    s_add_u32 s3, s3, s5
    v_add_u32 v6, s3, v0
    v_add_u32 v7, 782, v6
    v_mov_b32 v8, 0x2000000
    v_lshlrev_b32 v4, 4, v6
    v_cndmask_b32 v7, v8, v7, vcc
    v_lshlrev_b32 v6, 2, v6
    v_lshlrev_b32 v5, 4, v7
    v_lshlrev_b32 v7, 2, v7
    v_cmp_gt_u32 vcc, 782, v0
    s_mov_b64 exec, vcc
    s_cbranch_execz L_skld_88
    buffer_load_dword v6, v6, s[64:67], 0 offen
    buffer_load_dword v7, v7, s[64:67], 0 offen
    buffer_load_dwordx4 v[108:111], v4, s[8:11], 0 offen
    buffer_load_dwordx4 v[112:115], v5, s[8:11], 0 offen

L_skld_88:
    s_mov_b64 exec, -1
    s_barrier

    v_add_u32 v116, 50000, v3
    v_add_u32 v117, 115536, v3
    v_cmp_gt_u32 vcc, 106, v0

    v_mov_b32 v100, 0
    v_mov_b32 v101, 0
    v_mov_b32 v102, 0
    v_mov_b32 v103, 0
    ds_read_b128 v[76:79], v116 offset:0
    ds_read_b128 v[80:83], v116 offset:16384
    ds_read_b128 v[84:87], v116 offset:32768
    ds_read_b128 v[88:91], v116 offset:49152
    ds_read_b128 v[92:95], v117 offset:0
    ds_read_b128 v[96:99], v117 offset:16384
    s_mov_b64 exec, vcc
    ds_read_b128 v[100:103], v117 offset:32768
    s_mov_b64 exec, -1
    s_mul_i32 s3, s37, 6400000
    s_mul_i32 s5, s36, 100000
    s_add_u32 s3, s3, s5
    s_add_u32 s3, s3, 6799360

    s_add_u32 s20, s6, s3
    s_addc_u32 s21, s7, 0
    s_mov_b32 s22, 100000
    s_mov_b32 s23, 0x20000
    s_waitcnt lgkmcnt(6)
    s_mov_b32 s3, 0
    buffer_store_dwordx4 v[76:79], v3, s[20:23], s3 offen sc1
    s_waitcnt lgkmcnt(5)
    s_mov_b32 s3, 16384
    buffer_store_dwordx4 v[80:83], v3, s[20:23], s3 offen sc1
    s_waitcnt lgkmcnt(4)
    s_mov_b32 s3, 32768
    buffer_store_dwordx4 v[84:87], v3, s[20:23], s3 offen sc1
    s_waitcnt lgkmcnt(3)
    s_mov_b32 s3, 49152
    buffer_store_dwordx4 v[88:91], v3, s[20:23], s3 offen sc1
    s_waitcnt lgkmcnt(2)
    s_mov_b32 s3, 65536
    buffer_store_dwordx4 v[92:95], v3, s[20:23], s3 offen sc1
    s_waitcnt lgkmcnt(1)
    s_mov_b32 s3, 81920
    buffer_store_dwordx4 v[96:99], v3, s[20:23], s3 offen sc1
    s_waitcnt lgkmcnt(0)
    s_mov_b32 s3, 98304
    buffer_store_dwordx4 v[100:103], v3, s[20:23], s3 offen sc1
    v_or3_b32 v1, v76, v77, v1
    v_or3_b32 v1, v78, v79, v1
    v_or3_b32 v1, v80, v81, v1
    v_or3_b32 v1, v82, v83, v1
    v_or3_b32 v1, v84, v85, v1
    v_or3_b32 v1, v86, v87, v1
    v_or3_b32 v1, v88, v89, v1
    v_or3_b32 v1, v90, v91, v1
    v_or3_b32 v1, v92, v93, v1
    v_or3_b32 v1, v94, v95, v1
    v_or3_b32 v1, v96, v97, v1
    v_or3_b32 v1, v98, v99, v1
    v_or3_b32 v1, v100, v101, v1
    v_or3_b32 v1, v102, v103, v1
    v_and_b32 v1, 0x80008000, v1
    v_cmp_ne_u32 vcc, 0, v1
    v_mov_b32 v116, 150024
    v_mov_b32 v117, 1
    s_cbranch_vccz L_nf_85
    ds_write_b32 v116, v117
L_nf_85:
    s_mov_b32 s33, 1
    s_mov_b32 s42, 0
    v_cmp_gt_u32 vcc, 782, v0
    s_mov_b64 exec, vcc
    s_cbranch_execz L_p1end_90
    s_waitcnt vmcnt(9)
    s_branch L_lddone_87
L_fin_86:

    s_load_dwordx2 s[64:65], s[0:1], 24
    s_load_dwordx2 s[86:87], s[0:1], 40
    s_load_dwordx8 s[88:95], s[0:1], 56
    s_mov_b32 s66, 1600000
    s_mov_b32 s67, 0x20000

    s_waitcnt lgkmcnt(0)
    s_load_dwordx4 s[28:31], s[86:87], 0
    s_load_dwordx16 s[68:83], s[88:89], 0
    s_load_dwordx8 s[12:19], s[92:93], 0
    s_load_dwordx8 s[56:63], s[94:95], 0
    s_mov_b64 s[48:49], s[90:91]
    s_load_dwordx16 s[84:99], s[48:49], 0

    s_mov_b32 s42, 1
    s_mov_b32 s41, s37
L_qloop_89:
    s_mul_i32 s3, s41, 3125
    s_add_u32 s5, s3, 3126
    s_add_u32 s3, s3, 1
    s_lshr_b32 s3, s3, 1
    s_lshr_b32 s5, s5, 1
    s_sub_u32 s5, s5, s3
    s_sub_u32 s5, s5, 782
    v_cmp_gt_u32 vcc, s5, v0
    s_mul_i32 s5, s36, 6250
    s_add_u32 s3, s3, s5
    v_add_u32 v6, s3, v0
    v_add_u32 v7, 782, v6
    v_mov_b32 v8, 0x2000000
    v_lshlrev_b32 v4, 4, v6
    v_cndmask_b32 v7, v8, v7, vcc
    v_lshlrev_b32 v6, 2, v6
    v_lshlrev_b32 v5, 4, v7
    v_lshlrev_b32 v7, 2, v7
    v_cmp_gt_u32 vcc, 782, v0
    s_mov_b64 exec, vcc
    s_cbranch_execz L_p1end_90
    buffer_load_dword v6, v6, s[64:67], 0 offen
    buffer_load_dword v7, v7, s[64:67], 0 offen
    buffer_load_dwordx4 v[108:111], v4, s[8:11], 0 offen
    buffer_load_dwordx4 v[112:115], v5, s[8:11], 0 offen

    s_waitcnt vmcnt(2)
L_lddone_87:
    s_waitcnt lgkmcnt(0)
    v_lshlrev_b32 v8, 16, v6
    v_and_b32 v9, s32, v6
    v_lshlrev_b32 v10, 16, v7
    v_and_b32 v11, s32, v7

    s_lshl_b32 s52, s28, 16
    v_subrev_f32 v12, s52, v8
    v_subrev_f32 v20, s52, v9
    v_subrev_f32 v28, s52, v10
    v_subrev_f32 v36, s52, v11
    s_and_b32 s53, s28, s32
    v_subrev_f32 v13, s53, v8
    v_subrev_f32 v21, s53, v9
    v_subrev_f32 v29, s53, v10
    v_subrev_f32 v37, s53, v11
    s_lshl_b32 s52, s29, 16
    v_subrev_f32 v14, s52, v8
    v_subrev_f32 v22, s52, v9
    v_subrev_f32 v30, s52, v10
    v_subrev_f32 v38, s52, v11
    s_and_b32 s53, s29, s32
    v_subrev_f32 v15, s53, v8
    v_subrev_f32 v23, s53, v9
    v_subrev_f32 v31, s53, v10
    v_subrev_f32 v39, s53, v11
    s_lshl_b32 s52, s30, 16
    v_subrev_f32 v16, s52, v8
    v_subrev_f32 v24, s52, v9
    v_subrev_f32 v32, s52, v10
    v_subrev_f32 v40, s52, v11
    s_and_b32 s53, s30, s32
    v_subrev_f32 v17, s53, v8
    v_subrev_f32 v25, s53, v9
    v_subrev_f32 v33, s53, v10
    v_subrev_f32 v41, s53, v11
    s_lshl_b32 s52, s31, 16
    v_subrev_f32 v18, s52, v8
    v_subrev_f32 v26, s52, v9
    v_subrev_f32 v34, s52, v10
    v_subrev_f32 v42, s52, v11
    s_and_b32 s53, s31, s32
    v_subrev_f32 v19, s53, v8
    v_subrev_f32 v27, s53, v9
    v_subrev_f32 v35, s53, v10
    v_subrev_f32 v43, s53, v11
    v_cvt_pk_bf16_f32 v12, v12, v13
    v_cvt_pk_bf16_f32 v14, v14, v15
    v_cvt_pk_bf16_f32 v16, v16, v17
    v_cvt_pk_bf16_f32 v18, v18, v19
    v_cvt_pk_bf16_f32 v20, v20, v21
    v_cvt_pk_bf16_f32 v22, v22, v23
    v_cvt_pk_bf16_f32 v24, v24, v25
    v_cvt_pk_bf16_f32 v26, v26, v27
    v_cvt_pk_bf16_f32 v28, v28, v29
    v_cvt_pk_bf16_f32 v30, v30, v31
    v_cvt_pk_bf16_f32 v32, v32, v33
    v_cvt_pk_bf16_f32 v34, v34, v35
    v_cvt_pk_bf16_f32 v36, v36, v37
    v_cvt_pk_bf16_f32 v38, v38, v39
    v_cvt_pk_bf16_f32 v40, v40, v41
    v_cvt_pk_bf16_f32 v42, v42, v43
    v_and_b32 v13, s32, v12
    v_lshlrev_b32 v12, 16, v12
    v_and_b32 v15, s32, v14
    v_lshlrev_b32 v14, 16, v14
    v_and_b32 v17, s32, v16
    v_lshlrev_b32 v16, 16, v16
    v_and_b32 v19, s32, v18
    v_lshlrev_b32 v18, 16, v18
    v_and_b32 v21, s32, v20
    v_lshlrev_b32 v20, 16, v20
    v_and_b32 v23, s32, v22
    v_lshlrev_b32 v22, 16, v22
    v_and_b32 v25, s32, v24
    v_lshlrev_b32 v24, 16, v24
    v_and_b32 v27, s32, v26
    v_lshlrev_b32 v26, 16, v26
    v_and_b32 v29, s32, v28
    v_lshlrev_b32 v28, 16, v28
    v_and_b32 v31, s32, v30
    v_lshlrev_b32 v30, 16, v30
    v_and_b32 v33, s32, v32
    v_lshlrev_b32 v32, 16, v32
    v_and_b32 v35, s32, v34
    v_lshlrev_b32 v34, 16, v34
    v_and_b32 v37, s32, v36
    v_lshlrev_b32 v36, 16, v36
    v_and_b32 v39, s32, v38
    v_lshlrev_b32 v38, 16, v38
    v_and_b32 v41, s32, v40
    v_lshlrev_b32 v40, 16, v40
    v_and_b32 v43, s32, v42
    v_lshlrev_b32 v42, 16, v42
    v_mul_f32 v12, v12, v12
    v_mul_f32 v13, v13, v13
    v_mul_f32 v14, v14, v14
    v_mul_f32 v15, v15, v15
    v_mul_f32 v16, v16, v16
    v_mul_f32 v17, v17, v17
    v_mul_f32 v18, v18, v18
    v_mul_f32 v19, v19, v19
    v_mul_f32 v20, v20, v20
    v_mul_f32 v21, v21, v21
    v_mul_f32 v22, v22, v22
    v_mul_f32 v23, v23, v23
    v_mul_f32 v24, v24, v24
    v_mul_f32 v25, v25, v25
    v_mul_f32 v26, v26, v26
    v_mul_f32 v27, v27, v27
    v_mul_f32 v28, v28, v28
    v_mul_f32 v29, v29, v29
    v_mul_f32 v30, v30, v30
    v_mul_f32 v31, v31, v31
    v_mul_f32 v32, v32, v32
    v_mul_f32 v33, v33, v33
    v_mul_f32 v34, v34, v34
    v_mul_f32 v35, v35, v35
    v_mul_f32 v36, v36, v36
    v_mul_f32 v37, v37, v37
    v_mul_f32 v38, v38, v38
    v_mul_f32 v39, v39, v39
    v_mul_f32 v40, v40, v40
    v_mul_f32 v41, v41, v41
    v_mul_f32 v42, v42, v42
    v_mul_f32 v43, v43, v43
    v_cvt_pk_bf16_f32 v12, v12, v13
    v_cvt_pk_bf16_f32 v14, v14, v15
    v_cvt_pk_bf16_f32 v16, v16, v17
    v_cvt_pk_bf16_f32 v18, v18, v19
    v_cvt_pk_bf16_f32 v20, v20, v21
    v_cvt_pk_bf16_f32 v22, v22, v23
    v_cvt_pk_bf16_f32 v24, v24, v25
    v_cvt_pk_bf16_f32 v26, v26, v27
    v_cvt_pk_bf16_f32 v28, v28, v29
    v_cvt_pk_bf16_f32 v30, v30, v31
    v_cvt_pk_bf16_f32 v32, v32, v33
    v_cvt_pk_bf16_f32 v34, v34, v35
    v_cvt_pk_bf16_f32 v36, v36, v37
    v_cvt_pk_bf16_f32 v38, v38, v39
    v_cvt_pk_bf16_f32 v40, v40, v41
    v_cvt_pk_bf16_f32 v42, v42, v43
    v_and_b32 v13, s32, v12
    v_lshlrev_b32 v12, 16, v12
    v_and_b32 v15, s32, v14
    v_lshlrev_b32 v14, 16, v14
    v_and_b32 v17, s32, v16
    v_lshlrev_b32 v16, 16, v16
    v_and_b32 v19, s32, v18
    v_lshlrev_b32 v18, 16, v18
    v_and_b32 v21, s32, v20
    v_lshlrev_b32 v20, 16, v20
    v_and_b32 v23, s32, v22
    v_lshlrev_b32 v22, 16, v22
    v_and_b32 v25, s32, v24
    v_lshlrev_b32 v24, 16, v24
    v_and_b32 v27, s32, v26
    v_lshlrev_b32 v26, 16, v26
    v_and_b32 v29, s32, v28
    v_lshlrev_b32 v28, 16, v28
    v_and_b32 v31, s32, v30
    v_lshlrev_b32 v30, 16, v30
    v_and_b32 v33, s32, v32
    v_lshlrev_b32 v32, 16, v32
    v_and_b32 v35, s32, v34
    v_lshlrev_b32 v34, 16, v34
    v_and_b32 v37, s32, v36
    v_lshlrev_b32 v36, 16, v36
    v_and_b32 v39, s32, v38
    v_lshlrev_b32 v38, 16, v38
    v_and_b32 v41, s32, v40
    v_lshlrev_b32 v40, 16, v40
    v_and_b32 v43, s32, v42
    v_lshlrev_b32 v42, 16, v42
    v_mul_f32 v12, 0xc1200000, v12
    v_mul_f32 v13, 0xc1200000, v13
    v_mul_f32 v14, 0xc1200000, v14
    v_mul_f32 v15, 0xc1200000, v15
    v_mul_f32 v16, 0xc1200000, v16
    v_mul_f32 v17, 0xc1200000, v17
    v_mul_f32 v18, 0xc1200000, v18
    v_mul_f32 v19, 0xc1200000, v19
    v_mul_f32 v20, 0xc1200000, v20
    v_mul_f32 v21, 0xc1200000, v21
    v_mul_f32 v22, 0xc1200000, v22
    v_mul_f32 v23, 0xc1200000, v23
    v_mul_f32 v24, 0xc1200000, v24
    v_mul_f32 v25, 0xc1200000, v25
    v_mul_f32 v26, 0xc1200000, v26
    v_mul_f32 v27, 0xc1200000, v27
    v_mul_f32 v28, 0xc1200000, v28
    v_mul_f32 v29, 0xc1200000, v29
    v_mul_f32 v30, 0xc1200000, v30
    v_mul_f32 v31, 0xc1200000, v31
    v_mul_f32 v32, 0xc1200000, v32
    v_mul_f32 v33, 0xc1200000, v33
    v_mul_f32 v34, 0xc1200000, v34
    v_mul_f32 v35, 0xc1200000, v35
    v_mul_f32 v36, 0xc1200000, v36
    v_mul_f32 v37, 0xc1200000, v37
    v_mul_f32 v38, 0xc1200000, v38
    v_mul_f32 v39, 0xc1200000, v39
    v_mul_f32 v40, 0xc1200000, v40
    v_mul_f32 v41, 0xc1200000, v41
    v_mul_f32 v42, 0xc1200000, v42
    v_mul_f32 v43, 0xc1200000, v43
    v_cvt_pk_bf16_f32 v12, v12, v13
    v_cvt_pk_bf16_f32 v14, v14, v15
    v_cvt_pk_bf16_f32 v16, v16, v17
    v_cvt_pk_bf16_f32 v18, v18, v19
    v_cvt_pk_bf16_f32 v20, v20, v21
    v_cvt_pk_bf16_f32 v22, v22, v23
    v_cvt_pk_bf16_f32 v24, v24, v25
    v_cvt_pk_bf16_f32 v26, v26, v27
    v_cvt_pk_bf16_f32 v28, v28, v29
    v_cvt_pk_bf16_f32 v30, v30, v31
    v_cvt_pk_bf16_f32 v32, v32, v33
    v_cvt_pk_bf16_f32 v34, v34, v35
    v_cvt_pk_bf16_f32 v36, v36, v37
    v_cvt_pk_bf16_f32 v38, v38, v39
    v_cvt_pk_bf16_f32 v40, v40, v41
    v_cvt_pk_bf16_f32 v42, v42, v43
    v_and_b32 v13, s32, v12
    v_lshlrev_b32 v12, 16, v12
    v_and_b32 v15, s32, v14
    v_lshlrev_b32 v14, 16, v14
    v_and_b32 v17, s32, v16
    v_lshlrev_b32 v16, 16, v16
    v_and_b32 v19, s32, v18
    v_lshlrev_b32 v18, 16, v18
    v_and_b32 v21, s32, v20
    v_lshlrev_b32 v20, 16, v20
    v_and_b32 v23, s32, v22
    v_lshlrev_b32 v22, 16, v22
    v_and_b32 v25, s32, v24
    v_lshlrev_b32 v24, 16, v24
    v_and_b32 v27, s32, v26
    v_lshlrev_b32 v26, 16, v26
    v_and_b32 v29, s32, v28
    v_lshlrev_b32 v28, 16, v28
    v_and_b32 v31, s32, v30
    v_lshlrev_b32 v30, 16, v30
    v_and_b32 v33, s32, v32
    v_lshlrev_b32 v32, 16, v32
    v_and_b32 v35, s32, v34
    v_lshlrev_b32 v34, 16, v34
    v_and_b32 v37, s32, v36
    v_lshlrev_b32 v36, 16, v36
    v_and_b32 v39, s32, v38
    v_lshlrev_b32 v38, 16, v38
    v_and_b32 v41, s32, v40
    v_lshlrev_b32 v40, 16, v40
    v_and_b32 v43, s32, v42
    v_lshlrev_b32 v42, 16, v42
    v_mul_f32 v12, 0x3fb8aa3b, v12
    v_mul_f32 v13, 0x3fb8aa3b, v13
    v_mul_f32 v14, 0x3fb8aa3b, v14
    v_mul_f32 v15, 0x3fb8aa3b, v15
    v_mul_f32 v16, 0x3fb8aa3b, v16
    v_mul_f32 v17, 0x3fb8aa3b, v17
    v_mul_f32 v18, 0x3fb8aa3b, v18
    v_mul_f32 v19, 0x3fb8aa3b, v19
    v_mul_f32 v20, 0x3fb8aa3b, v20
    v_mul_f32 v21, 0x3fb8aa3b, v21
    v_mul_f32 v22, 0x3fb8aa3b, v22
    v_mul_f32 v23, 0x3fb8aa3b, v23
    v_mul_f32 v24, 0x3fb8aa3b, v24
    v_mul_f32 v25, 0x3fb8aa3b, v25
    v_mul_f32 v26, 0x3fb8aa3b, v26
    v_mul_f32 v27, 0x3fb8aa3b, v27
    v_mul_f32 v28, 0x3fb8aa3b, v28
    v_mul_f32 v29, 0x3fb8aa3b, v29
    v_mul_f32 v30, 0x3fb8aa3b, v30
    v_mul_f32 v31, 0x3fb8aa3b, v31
    v_mul_f32 v32, 0x3fb8aa3b, v32
    v_mul_f32 v33, 0x3fb8aa3b, v33
    v_mul_f32 v34, 0x3fb8aa3b, v34
    v_mul_f32 v35, 0x3fb8aa3b, v35
    v_mul_f32 v36, 0x3fb8aa3b, v36
    v_mul_f32 v37, 0x3fb8aa3b, v37
    v_mul_f32 v38, 0x3fb8aa3b, v38
    v_mul_f32 v39, 0x3fb8aa3b, v39
    v_mul_f32 v40, 0x3fb8aa3b, v40
    v_mul_f32 v41, 0x3fb8aa3b, v41
    v_mul_f32 v42, 0x3fb8aa3b, v42
    v_mul_f32 v43, 0x3fb8aa3b, v43
    v_exp_f32 v12, v12
    v_exp_f32 v13, v13
    v_exp_f32 v14, v14
    v_exp_f32 v15, v15
    v_exp_f32 v16, v16
    v_exp_f32 v17, v17
    v_exp_f32 v18, v18
    v_exp_f32 v19, v19
    v_exp_f32 v20, v20
    v_exp_f32 v21, v21
    v_exp_f32 v22, v22
    v_exp_f32 v23, v23
    v_exp_f32 v24, v24
    v_exp_f32 v25, v25
    v_exp_f32 v26, v26
    v_exp_f32 v27, v27
    v_exp_f32 v28, v28
    v_exp_f32 v29, v29
    v_exp_f32 v30, v30
    v_exp_f32 v31, v31
    v_exp_f32 v32, v32
    v_exp_f32 v33, v33
    v_exp_f32 v34, v34
    v_exp_f32 v35, v35
    v_exp_f32 v36, v36
    v_exp_f32 v37, v37
    v_exp_f32 v38, v38
    v_exp_f32 v39, v39
    v_exp_f32 v40, v40
    v_exp_f32 v41, v41
    v_exp_f32 v42, v42
    v_exp_f32 v43, v43
    s_nop 0
    v_cvt_pk_bf16_f32 v12, v12, v13
    v_cvt_pk_bf16_f32 v14, v14, v15
    v_cvt_pk_bf16_f32 v16, v16, v17
    v_cvt_pk_bf16_f32 v18, v18, v19
    v_cvt_pk_bf16_f32 v20, v20, v21
    v_cvt_pk_bf16_f32 v22, v22, v23
    v_cvt_pk_bf16_f32 v24, v24, v25
    v_cvt_pk_bf16_f32 v26, v26, v27
    v_cvt_pk_bf16_f32 v28, v28, v29
    v_cvt_pk_bf16_f32 v30, v30, v31
    v_cvt_pk_bf16_f32 v32, v32, v33
    v_cvt_pk_bf16_f32 v34, v34, v35
    v_cvt_pk_bf16_f32 v36, v36, v37
    v_cvt_pk_bf16_f32 v38, v38, v39
    v_cvt_pk_bf16_f32 v40, v40, v41
    v_cvt_pk_bf16_f32 v42, v42, v43
L_p1end_90:
    s_mov_b64 exec, -1
    s_cmp_eq_u32 s42, 2
    s_cbranch_scc1 L_part2_91
    s_waitcnt vmcnt(0) lgkmcnt(0)
    s_barrier
    s_cmp_lg_u32 s42, 0
    s_cbranch_scc1 L_nochk_97
    v_mov_b32 v116, 150024
    ds_read_b32 v117, v116
    s_waitcnt lgkmcnt(0)
    v_readfirstlane_b32 s3, v117
    s_nop 1
    s_cmp_lg_u32 s3, 0
    s_cbranch_scc1 L_p2slow_51
L_nochk_97:

    s_load_dwordx2 s[24:25], s[0:1], 88
    s_load_dwordx2 s[44:45], s[0:1], 96
    s_mov_b32 s26, 6400000
    s_mov_b32 s27, 0x20000
    s_movk_i32 s46, 256
    s_mov_b32 s47, 0x20000
    s_lshl_b32 s50, s36, 2
    v_and_b32 v116, 63, v0
    v_lshlrev_b32 v116, 20, v116

    s_add_u32 s20, s6, 6799360
    s_addc_u32 s21, s7, 0
    s_mov_b32 s22, 76800000
    s_mov_b32 s23, 0x20000
    v_readfirstlane_b32 s3, v0
    s_waitcnt lgkmcnt(0)
    s_cmp_eq_u32 s3, 960
    s_cbranch_scc1 L_sync_98
L_part2_91:
    v_cmp_gt_u32 vcc, 782, v0
    s_mov_b64 exec, vcc
    s_cbranch_execz L_p2end_92

    s_pack_ll_b32_b16 s52, s68, s70
    v_dot2_f32_bf16 v60, v12, s52, 0
    v_dot2_f32_bf16 v64, v20, s52, 0
    v_dot2_f32_bf16 v68, v28, s52, 0
    v_dot2_f32_bf16 v72, v36, s52, 0
    s_pack_hh_b32_b16 s53, s68, s70
    v_dot2_f32_bf16 v61, v12, s53, 0
    v_dot2_f32_bf16 v65, v20, s53, 0
    v_dot2_f32_bf16 v69, v28, s53, 0
    v_dot2_f32_bf16 v73, v36, s53, 0
    s_pack_ll_b32_b16 s52, s69, s71
    v_dot2_f32_bf16 v62, v12, s52, 0
    v_dot2_f32_bf16 v66, v20, s52, 0
    v_dot2_f32_bf16 v70, v28, s52, 0
    v_dot2_f32_bf16 v74, v36, s52, 0
    s_pack_hh_b32_b16 s53, s69, s71
    v_dot2_f32_bf16 v63, v12, s53, 0
    v_dot2_f32_bf16 v67, v20, s53, 0
    v_dot2_f32_bf16 v71, v28, s53, 0
    v_dot2_f32_bf16 v75, v36, s53, 0
    s_pack_ll_b32_b16 s52, s72, s74
    v_dot2_f32_bf16 v60, v14, s52, v60
    v_dot2_f32_bf16 v64, v22, s52, v64
    v_dot2_f32_bf16 v68, v30, s52, v68
    v_dot2_f32_bf16 v72, v38, s52, v72
    s_pack_hh_b32_b16 s53, s72, s74
    v_dot2_f32_bf16 v61, v14, s53, v61
    v_dot2_f32_bf16 v65, v22, s53, v65
    v_dot2_f32_bf16 v69, v30, s53, v69
    v_dot2_f32_bf16 v73, v38, s53, v73
    s_pack_ll_b32_b16 s52, s73, s75
    v_dot2_f32_bf16 v62, v14, s52, v62
    v_dot2_f32_bf16 v66, v22, s52, v66
    v_dot2_f32_bf16 v70, v30, s52, v70
    v_dot2_f32_bf16 v74, v38, s52, v74
    s_pack_hh_b32_b16 s53, s73, s75
    v_dot2_f32_bf16 v63, v14, s53, v63
    v_dot2_f32_bf16 v67, v22, s53, v67
    v_dot2_f32_bf16 v71, v30, s53, v71
    v_dot2_f32_bf16 v75, v38, s53, v75
    s_pack_ll_b32_b16 s52, s76, s78
    v_dot2_f32_bf16 v60, v16, s52, v60
    v_dot2_f32_bf16 v64, v24, s52, v64
    v_dot2_f32_bf16 v68, v32, s52, v68
    v_dot2_f32_bf16 v72, v40, s52, v72
    s_pack_hh_b32_b16 s53, s76, s78
    v_dot2_f32_bf16 v61, v16, s53, v61
    v_dot2_f32_bf16 v65, v24, s53, v65
    v_dot2_f32_bf16 v69, v32, s53, v69
    v_dot2_f32_bf16 v73, v40, s53, v73
    s_pack_ll_b32_b16 s52, s77, s79
    v_dot2_f32_bf16 v62, v16, s52, v62
    v_dot2_f32_bf16 v66, v24, s52, v66
    v_dot2_f32_bf16 v70, v32, s52, v70
    v_dot2_f32_bf16 v74, v40, s52, v74
    s_pack_hh_b32_b16 s53, s77, s79
    v_dot2_f32_bf16 v63, v16, s53, v63
    v_dot2_f32_bf16 v67, v24, s53, v67
    v_dot2_f32_bf16 v71, v32, s53, v71
    v_dot2_f32_bf16 v75, v40, s53, v75
    s_pack_ll_b32_b16 s52, s80, s82
    v_dot2_f32_bf16 v60, v18, s52, v60
    v_dot2_f32_bf16 v64, v26, s52, v64
    v_dot2_f32_bf16 v68, v34, s52, v68
    v_dot2_f32_bf16 v72, v42, s52, v72
    s_pack_hh_b32_b16 s53, s80, s82
    v_dot2_f32_bf16 v61, v18, s53, v61
    v_dot2_f32_bf16 v65, v26, s53, v65
    v_dot2_f32_bf16 v69, v34, s53, v69
    v_dot2_f32_bf16 v73, v42, s53, v73
    s_pack_ll_b32_b16 s52, s81, s83
    v_dot2_f32_bf16 v62, v18, s52, v62
    v_dot2_f32_bf16 v66, v26, s52, v66
    v_dot2_f32_bf16 v70, v34, s52, v70
    v_dot2_f32_bf16 v74, v42, s52, v74
    s_pack_hh_b32_b16 s53, s81, s83
    v_dot2_f32_bf16 v63, v18, s53, v63
    v_dot2_f32_bf16 v67, v26, s53, v67
    v_dot2_f32_bf16 v71, v34, s53, v71
    v_dot2_f32_bf16 v75, v42, s53, v75
    s_pack_ll_b32_b16 s52, s84, s86
    v_dot2_f32_bf16 v44, v12, s52, 0
    v_dot2_f32_bf16 v48, v20, s52, 0
    v_dot2_f32_bf16 v52, v28, s52, 0
    v_dot2_f32_bf16 v56, v36, s52, 0
    s_pack_hh_b32_b16 s53, s84, s86
    v_dot2_f32_bf16 v45, v12, s53, 0
    v_dot2_f32_bf16 v49, v20, s53, 0
    v_dot2_f32_bf16 v53, v28, s53, 0
    v_dot2_f32_bf16 v57, v36, s53, 0
    s_pack_ll_b32_b16 s52, s85, s87
    v_dot2_f32_bf16 v46, v12, s52, 0
    v_dot2_f32_bf16 v50, v20, s52, 0
    v_dot2_f32_bf16 v54, v28, s52, 0
    v_dot2_f32_bf16 v58, v36, s52, 0
    s_pack_hh_b32_b16 s53, s85, s87
    v_dot2_f32_bf16 v47, v12, s53, 0
    v_dot2_f32_bf16 v51, v20, s53, 0
    v_dot2_f32_bf16 v55, v28, s53, 0
    v_dot2_f32_bf16 v59, v36, s53, 0
    s_pack_ll_b32_b16 s52, s88, s90
    v_dot2_f32_bf16 v44, v14, s52, v44
    v_dot2_f32_bf16 v48, v22, s52, v48
    v_dot2_f32_bf16 v52, v30, s52, v52
    v_dot2_f32_bf16 v56, v38, s52, v56
    s_pack_hh_b32_b16 s53, s88, s90
    v_dot2_f32_bf16 v45, v14, s53, v45
    v_dot2_f32_bf16 v49, v22, s53, v49
    v_dot2_f32_bf16 v53, v30, s53, v53
    v_dot2_f32_bf16 v57, v38, s53, v57
    s_pack_ll_b32_b16 s52, s89, s91
    v_dot2_f32_bf16 v46, v14, s52, v46
    v_dot2_f32_bf16 v50, v22, s52, v50
    v_dot2_f32_bf16 v54, v30, s52, v54
    v_dot2_f32_bf16 v58, v38, s52, v58
    s_pack_hh_b32_b16 s53, s89, s91
    v_dot2_f32_bf16 v47, v14, s53, v47
    v_dot2_f32_bf16 v51, v22, s53, v51
    v_dot2_f32_bf16 v55, v30, s53, v55
    v_dot2_f32_bf16 v59, v38, s53, v59
    s_pack_ll_b32_b16 s52, s92, s94
    v_dot2_f32_bf16 v44, v16, s52, v44
    v_dot2_f32_bf16 v48, v24, s52, v48
    v_dot2_f32_bf16 v52, v32, s52, v52
    v_dot2_f32_bf16 v56, v40, s52, v56
    s_pack_hh_b32_b16 s53, s92, s94
    v_dot2_f32_bf16 v45, v16, s53, v45
    v_dot2_f32_bf16 v49, v24, s53, v49
    v_dot2_f32_bf16 v53, v32, s53, v53
    v_dot2_f32_bf16 v57, v40, s53, v57
    s_pack_ll_b32_b16 s52, s93, s95
    v_dot2_f32_bf16 v46, v16, s52, v46
    v_dot2_f32_bf16 v50, v24, s52, v50
    v_dot2_f32_bf16 v54, v32, s52, v54
    v_dot2_f32_bf16 v58, v40, s52, v58
    s_pack_hh_b32_b16 s53, s93, s95
    v_dot2_f32_bf16 v47, v16, s53, v47
    v_dot2_f32_bf16 v51, v24, s53, v51
    v_dot2_f32_bf16 v55, v32, s53, v55
    v_dot2_f32_bf16 v59, v40, s53, v59
    s_pack_ll_b32_b16 s52, s96, s98
    v_dot2_f32_bf16 v44, v18, s52, v44
    v_dot2_f32_bf16 v48, v26, s52, v48
    v_dot2_f32_bf16 v52, v34, s52, v52
    v_dot2_f32_bf16 v56, v42, s52, v56
    s_pack_hh_b32_b16 s53, s96, s98
    v_dot2_f32_bf16 v45, v18, s53, v45
    v_dot2_f32_bf16 v49, v26, s53, v49
    v_dot2_f32_bf16 v53, v34, s53, v53
    v_dot2_f32_bf16 v57, v42, s53, v57
    s_pack_ll_b32_b16 s52, s97, s99
    v_dot2_f32_bf16 v46, v18, s52, v46
    v_dot2_f32_bf16 v50, v26, s52, v50
    v_dot2_f32_bf16 v54, v34, s52, v54
    v_dot2_f32_bf16 v58, v42, s52, v58
    s_pack_hh_b32_b16 s53, s97, s99
    v_dot2_f32_bf16 v47, v18, s53, v47
    v_dot2_f32_bf16 v51, v26, s53, v51
    v_dot2_f32_bf16 v55, v34, s53, v55
    v_dot2_f32_bf16 v59, v42, s53, v59
    v_cvt_pk_bf16_f32 v60, v60, v61
    v_cvt_pk_bf16_f32 v62, v62, v63
    v_cvt_pk_bf16_f32 v64, v64, v65
    v_cvt_pk_bf16_f32 v66, v66, v67
    v_cvt_pk_bf16_f32 v68, v68, v69
    v_cvt_pk_bf16_f32 v70, v70, v71
    v_cvt_pk_bf16_f32 v72, v72, v73
    v_cvt_pk_bf16_f32 v74, v74, v75
    v_and_b32 v61, s32, v60
    v_lshlrev_b32 v60, 16, v60
    v_and_b32 v63, s32, v62
    v_lshlrev_b32 v62, 16, v62
    v_and_b32 v65, s32, v64
    v_lshlrev_b32 v64, 16, v64
    v_and_b32 v67, s32, v66
    v_lshlrev_b32 v66, 16, v66
    v_and_b32 v69, s32, v68
    v_lshlrev_b32 v68, 16, v68
    v_and_b32 v71, s32, v70
    v_lshlrev_b32 v70, 16, v70
    v_and_b32 v73, s32, v72
    v_lshlrev_b32 v72, 16, v72
    v_and_b32 v75, s32, v74
    v_lshlrev_b32 v74, 16, v74
L_p2end_92:
    s_mov_b64 exec, -1
    s_cmp_eq_u32 s42, 2
    s_cbranch_scc1 L_post_95
L_bcast_93:
    v_mov_b32 v118, 150016
    s_mov_b32 s42, 2
    s_waitcnt lgkmcnt(0)
    s_barrier
    ds_read_b32 v117, v118
    s_waitcnt lgkmcnt(0)
    v_readfirstlane_b32 s35, v117
    s_nop 1
    s_bitcmp1_b32 s35, 16
    s_cbranch_scc1 L_nextq_94
L_post_95:
    v_cmp_gt_u32 vcc, 782, v0
    s_mov_b64 exec, vcc
    s_cbranch_execz L_postend_96

    s_mov_b32 s3, 0
    buffer_load_dwordx4 v[76:79], v4, s[20:23], s3 offen sc1
    buffer_load_dwordx4 v[92:95], v5, s[20:23], s3 offen sc1
    s_mov_b32 s3, 6400000
    buffer_load_dwordx4 v[80:83], v4, s[20:23], s3 offen sc1
    buffer_load_dwordx4 v[96:99], v5, s[20:23], s3 offen sc1
    s_mov_b32 s3, 12800000
    buffer_load_dwordx4 v[84:87], v4, s[20:23], s3 offen sc1
    buffer_load_dwordx4 v[100:103], v5, s[20:23], s3 offen sc1
    s_mov_b32 s3, 19200000
    buffer_load_dwordx4 v[88:91], v4, s[20:23], s3 offen sc1
    buffer_load_dwordx4 v[104:107], v5, s[20:23], s3 offen sc1
    s_and_b32 s3, s35, 0xf0
    s_cbranch_scc1 L_fgen_102
    s_waitcnt vmcnt(0)

    v_add_u32 v76, v76, v80
    v_add_u32 v84, v84, v88
    v_add_u32 v77, v77, v81
    v_add_u32 v85, v85, v89
    v_add_u32 v78, v78, v82
    v_add_u32 v86, v86, v90
    v_add_u32 v79, v79, v83
    v_add_u32 v87, v87, v91
    v_add_u32_sdwa v12, v76, v84 dst_sel:DWORD dst_unused:UNUSED_PAD src0_sel:WORD_0 src1_sel:WORD_0
    v_add_u32_sdwa v13, v76, v84 dst_sel:DWORD dst_unused:UNUSED_PAD src0_sel:WORD_1 src1_sel:WORD_1
    v_add_u32_sdwa v14, v77, v85 dst_sel:DWORD dst_unused:UNUSED_PAD src0_sel:WORD_0 src1_sel:WORD_0
    v_add_u32_sdwa v15, v77, v85 dst_sel:DWORD dst_unused:UNUSED_PAD src0_sel:WORD_1 src1_sel:WORD_1
    v_add_u32_sdwa v16, v78, v86 dst_sel:DWORD dst_unused:UNUSED_PAD src0_sel:WORD_0 src1_sel:WORD_0
    v_add_u32_sdwa v17, v78, v86 dst_sel:DWORD dst_unused:UNUSED_PAD src0_sel:WORD_1 src1_sel:WORD_1
    v_add_u32_sdwa v18, v79, v87 dst_sel:DWORD dst_unused:UNUSED_PAD src0_sel:WORD_0 src1_sel:WORD_0
    v_add_u32_sdwa v19, v79, v87 dst_sel:DWORD dst_unused:UNUSED_PAD src0_sel:WORD_1 src1_sel:WORD_1
    v_add_u32 v92, v92, v96
    v_add_u32 v100, v100, v104
    v_add_u32 v93, v93, v97
    v_add_u32 v101, v101, v105
    v_add_u32 v94, v94, v98
    v_add_u32 v102, v102, v106
    v_add_u32 v95, v95, v99
    v_add_u32 v103, v103, v107
    v_add_u32_sdwa v20, v92, v100 dst_sel:DWORD dst_unused:UNUSED_PAD src0_sel:WORD_0 src1_sel:WORD_0
    v_add_u32_sdwa v21, v92, v100 dst_sel:DWORD dst_unused:UNUSED_PAD src0_sel:WORD_1 src1_sel:WORD_1
    v_add_u32_sdwa v22, v93, v101 dst_sel:DWORD dst_unused:UNUSED_PAD src0_sel:WORD_0 src1_sel:WORD_0
    v_add_u32_sdwa v23, v93, v101 dst_sel:DWORD dst_unused:UNUSED_PAD src0_sel:WORD_1 src1_sel:WORD_1
    v_add_u32_sdwa v24, v94, v102 dst_sel:DWORD dst_unused:UNUSED_PAD src0_sel:WORD_0 src1_sel:WORD_0
    v_add_u32_sdwa v25, v94, v102 dst_sel:DWORD dst_unused:UNUSED_PAD src0_sel:WORD_1 src1_sel:WORD_1
    v_add_u32_sdwa v26, v95, v103 dst_sel:DWORD dst_unused:UNUSED_PAD src0_sel:WORD_0 src1_sel:WORD_0
    v_add_u32_sdwa v27, v95, v103 dst_sel:DWORD dst_unused:UNUSED_PAD src0_sel:WORD_1 src1_sel:WORD_1
    v_add_u32 v12, 0xffff0000, v12
    v_add_u32 v13, 0xffff0000, v13
    v_add_u32 v14, 0xffff0000, v14
    v_add_u32 v15, 0xffff0000, v15
    v_add_u32 v16, 0xffff0000, v16
    v_add_u32 v17, 0xffff0000, v17
    v_add_u32 v18, 0xffff0000, v18
    v_add_u32 v19, 0xffff0000, v19
    v_add_u32 v20, 0xffff0000, v20
    v_add_u32 v21, 0xffff0000, v21
    v_add_u32 v22, 0xffff0000, v22
    v_add_u32 v23, 0xffff0000, v23
    v_add_u32 v24, 0xffff0000, v24
    v_add_u32 v25, 0xffff0000, v25
    v_add_u32 v26, 0xffff0000, v26
    v_add_u32 v27, 0xffff0000, v27
    v_cvt_f32_i32 v12, v12
    v_cvt_f32_i32 v13, v13
    v_cvt_f32_i32 v14, v14
    v_cvt_f32_i32 v15, v15
    v_cvt_f32_i32 v16, v16
    v_cvt_f32_i32 v17, v17
    v_cvt_f32_i32 v18, v18
    v_cvt_f32_i32 v19, v19
    v_cvt_f32_i32 v20, v20
    v_cvt_f32_i32 v21, v21
    v_cvt_f32_i32 v22, v22
    v_cvt_f32_i32 v23, v23
    v_cvt_f32_i32 v24, v24
    v_cvt_f32_i32 v25, v25
    v_cvt_f32_i32 v26, v26
    v_cvt_f32_i32 v27, v27
    v_mul_f32 v12, s34, v12
    v_mul_f32 v13, s34, v13
    v_mul_f32 v14, s34, v14
    v_mul_f32 v15, s34, v15
    v_mul_f32 v16, s34, v16
    v_mul_f32 v17, s34, v17
    v_mul_f32 v18, s34, v18
    v_mul_f32 v19, s34, v19
    v_mul_f32 v20, s34, v20
    v_mul_f32 v21, s34, v21
    v_mul_f32 v22, s34, v22
    v_mul_f32 v23, s34, v23
    v_mul_f32 v24, s34, v24
    v_mul_f32 v25, s34, v25
    v_mul_f32 v26, s34, v26
    v_mul_f32 v27, s34, v27
L_fbk_103:
    s_lshl_b32 s52, s12, 16
    v_mul_f32 v28, s52, v12
    v_mul_f32 v32, s52, v16
    v_mul_f32 v36, s52, v20
    v_mul_f32 v40, s52, v24
    s_and_b32 s53, s12, s32
    v_mul_f32 v29, s53, v12
    v_mul_f32 v33, s53, v16
    v_mul_f32 v37, s53, v20
    v_mul_f32 v41, s53, v24
    s_lshl_b32 s52, s13, 16
    v_mul_f32 v30, s52, v12
    v_mul_f32 v34, s52, v16
    v_mul_f32 v38, s52, v20
    v_mul_f32 v42, s52, v24
    s_and_b32 s53, s13, s32
    v_mul_f32 v31, s53, v12
    v_mul_f32 v35, s53, v16
    v_mul_f32 v39, s53, v20
    v_mul_f32 v43, s53, v24
    s_lshl_b32 s52, s14, 16
    v_fmac_f32 v28, s52, v13
    v_fmac_f32 v32, s52, v17
    v_fmac_f32 v36, s52, v21
    v_fmac_f32 v40, s52, v25
    s_and_b32 s53, s14, s32
    v_fmac_f32 v29, s53, v13
    v_fmac_f32 v33, s53, v17
    v_fmac_f32 v37, s53, v21
    v_fmac_f32 v41, s53, v25
    s_lshl_b32 s52, s15, 16
    v_fmac_f32 v30, s52, v13
    v_fmac_f32 v34, s52, v17
    v_fmac_f32 v38, s52, v21
    v_fmac_f32 v42, s52, v25
    s_and_b32 s53, s15, s32
    v_fmac_f32 v31, s53, v13
    v_fmac_f32 v35, s53, v17
    v_fmac_f32 v39, s53, v21
    v_fmac_f32 v43, s53, v25
    s_lshl_b32 s52, s16, 16
    v_fmac_f32 v28, s52, v14
    v_fmac_f32 v32, s52, v18
    v_fmac_f32 v36, s52, v22
    v_fmac_f32 v40, s52, v26
    s_and_b32 s53, s16, s32
    v_fmac_f32 v29, s53, v14
    v_fmac_f32 v33, s53, v18
    v_fmac_f32 v37, s53, v22
    v_fmac_f32 v41, s53, v26
    s_lshl_b32 s52, s17, 16
    v_fmac_f32 v30, s52, v14
    v_fmac_f32 v34, s52, v18
    v_fmac_f32 v38, s52, v22
    v_fmac_f32 v42, s52, v26
    s_and_b32 s53, s17, s32
    v_fmac_f32 v31, s53, v14
    v_fmac_f32 v35, s53, v18
    v_fmac_f32 v39, s53, v22
    v_fmac_f32 v43, s53, v26
    s_lshl_b32 s52, s18, 16
    v_fmac_f32 v28, s52, v15
    v_fmac_f32 v32, s52, v19
    v_fmac_f32 v36, s52, v23
    v_fmac_f32 v40, s52, v27
    s_and_b32 s53, s18, s32
    v_fmac_f32 v29, s53, v15
    v_fmac_f32 v33, s53, v19
    v_fmac_f32 v37, s53, v23
    v_fmac_f32 v41, s53, v27
    s_lshl_b32 s52, s19, 16
    v_fmac_f32 v30, s52, v15
    v_fmac_f32 v34, s52, v19
    v_fmac_f32 v38, s52, v23
    v_fmac_f32 v42, s52, v27
    s_and_b32 s53, s19, s32
    v_fmac_f32 v31, s53, v15
    v_fmac_f32 v35, s53, v19
    v_fmac_f32 v39, s53, v23
    v_fmac_f32 v43, s53, v27
    v_mul_f32 v28, v28, v44
    v_mul_f32 v29, v29, v45
    v_mul_f32 v30, v30, v46
    v_mul_f32 v31, v31, v47
    v_mul_f32 v32, v32, v48
    v_mul_f32 v33, v33, v49
    v_mul_f32 v34, v34, v50
    v_mul_f32 v35, v35, v51
    v_mul_f32 v36, v36, v52
    v_mul_f32 v37, v37, v53
    v_mul_f32 v38, v38, v54
    v_mul_f32 v39, v39, v55
    v_mul_f32 v40, v40, v56
    v_mul_f32 v41, v41, v57
    v_mul_f32 v42, v42, v58
    v_mul_f32 v43, v43, v59
    v_cvt_pk_bf16_f32 v28, v28, v29
    v_cvt_pk_bf16_f32 v30, v30, v31
    v_cvt_pk_bf16_f32 v32, v32, v33
    v_cvt_pk_bf16_f32 v34, v34, v35
    v_cvt_pk_bf16_f32 v36, v36, v37
    v_cvt_pk_bf16_f32 v38, v38, v39
    v_cvt_pk_bf16_f32 v40, v40, v41
    v_cvt_pk_bf16_f32 v42, v42, v43
    s_pack_ll_b32_b16 s52, s56, s58
    v_dot2_f32_bf16 v12, v28, s52, 0
    v_dot2_f32_bf16 v16, v32, s52, 0
    v_dot2_f32_bf16 v20, v36, s52, 0
    v_dot2_f32_bf16 v24, v40, s52, 0
    s_pack_hh_b32_b16 s53, s56, s58
    v_dot2_f32_bf16 v13, v28, s53, 0
    v_dot2_f32_bf16 v17, v32, s53, 0
    v_dot2_f32_bf16 v21, v36, s53, 0
    v_dot2_f32_bf16 v25, v40, s53, 0
    s_pack_ll_b32_b16 s52, s57, s59
    v_dot2_f32_bf16 v14, v28, s52, 0
    v_dot2_f32_bf16 v18, v32, s52, 0
    v_dot2_f32_bf16 v22, v36, s52, 0
    v_dot2_f32_bf16 v26, v40, s52, 0
    s_pack_hh_b32_b16 s53, s57, s59
    v_dot2_f32_bf16 v15, v28, s53, 0
    v_dot2_f32_bf16 v19, v32, s53, 0
    v_dot2_f32_bf16 v23, v36, s53, 0
    v_dot2_f32_bf16 v27, v40, s53, 0
    s_pack_ll_b32_b16 s52, s60, s62
    v_dot2_f32_bf16 v12, v30, s52, v12
    v_dot2_f32_bf16 v16, v34, s52, v16
    v_dot2_f32_bf16 v20, v38, s52, v20
    v_dot2_f32_bf16 v24, v42, s52, v24
    s_pack_hh_b32_b16 s53, s60, s62
    v_dot2_f32_bf16 v13, v30, s53, v13
    v_dot2_f32_bf16 v17, v34, s53, v17
    v_dot2_f32_bf16 v21, v38, s53, v21
    v_dot2_f32_bf16 v25, v42, s53, v25
    s_pack_ll_b32_b16 s52, s61, s63
    v_dot2_f32_bf16 v14, v30, s52, v14
    v_dot2_f32_bf16 v18, v34, s52, v18
    v_dot2_f32_bf16 v22, v38, s52, v22
    v_dot2_f32_bf16 v26, v42, s52, v26
    s_pack_hh_b32_b16 s53, s61, s63
    v_dot2_f32_bf16 v15, v30, s53, v15
    v_dot2_f32_bf16 v19, v34, s53, v19
    v_dot2_f32_bf16 v23, v38, s53, v23
    v_dot2_f32_bf16 v27, v42, s53, v27
    v_lshlrev_b32 v44, 16, v108
    v_and_b32 v45, s32, v108
    v_lshlrev_b32 v46, 16, v109
    v_and_b32 v47, s32, v109
    v_lshlrev_b32 v48, 16, v110
    v_and_b32 v49, s32, v110
    v_lshlrev_b32 v50, 16, v111
    v_and_b32 v51, s32, v111
    v_lshlrev_b32 v52, 16, v112
    v_and_b32 v53, s32, v112
    v_lshlrev_b32 v54, 16, v113
    v_and_b32 v55, s32, v113
    v_lshlrev_b32 v56, 16, v114
    v_and_b32 v57, s32, v114
    v_lshlrev_b32 v58, 16, v115
    v_and_b32 v59, s32, v115
    v_cvt_pk_bf16_f32 v12, v12, v13
    v_cvt_pk_bf16_f32 v14, v14, v15
    v_cvt_pk_bf16_f32 v16, v16, v17
    v_cvt_pk_bf16_f32 v18, v18, v19
    v_cvt_pk_bf16_f32 v20, v20, v21
    v_cvt_pk_bf16_f32 v22, v22, v23
    v_cvt_pk_bf16_f32 v24, v24, v25
    v_cvt_pk_bf16_f32 v26, v26, v27
    v_and_b32 v13, s32, v12
    v_lshlrev_b32 v12, 16, v12
    v_and_b32 v15, s32, v14
    v_lshlrev_b32 v14, 16, v14
    v_and_b32 v17, s32, v16
    v_lshlrev_b32 v16, 16, v16
    v_and_b32 v19, s32, v18
    v_lshlrev_b32 v18, 16, v18
    v_and_b32 v21, s32, v20
    v_lshlrev_b32 v20, 16, v20
    v_and_b32 v23, s32, v22
    v_lshlrev_b32 v22, 16, v22
    v_and_b32 v25, s32, v24
    v_lshlrev_b32 v24, 16, v24
    v_and_b32 v27, s32, v26
    v_lshlrev_b32 v26, 16, v26
    v_mul_f32 v12, v12, v60
    v_mul_f32 v13, v13, v61
    v_mul_f32 v14, v14, v62
    v_mul_f32 v15, v15, v63
    v_mul_f32 v16, v16, v64
    v_mul_f32 v17, v17, v65
    v_mul_f32 v18, v18, v66
    v_mul_f32 v19, v19, v67
    v_mul_f32 v20, v20, v68
    v_mul_f32 v21, v21, v69
    v_mul_f32 v22, v22, v70
    v_mul_f32 v23, v23, v71
    v_mul_f32 v24, v24, v72
    v_mul_f32 v25, v25, v73
    v_mul_f32 v26, v26, v74
    v_mul_f32 v27, v27, v75
    v_cvt_pk_bf16_f32 v12, v12, v13
    v_cvt_pk_bf16_f32 v14, v14, v15
    v_cvt_pk_bf16_f32 v16, v16, v17
    v_cvt_pk_bf16_f32 v18, v18, v19
    v_cvt_pk_bf16_f32 v20, v20, v21
    v_cvt_pk_bf16_f32 v22, v22, v23
    v_cvt_pk_bf16_f32 v24, v24, v25
    v_cvt_pk_bf16_f32 v26, v26, v27
    v_and_b32 v13, s32, v12
    v_lshlrev_b32 v12, 16, v12
    v_and_b32 v15, s32, v14
    v_lshlrev_b32 v14, 16, v14
    v_and_b32 v17, s32, v16
    v_lshlrev_b32 v16, 16, v16
    v_and_b32 v19, s32, v18
    v_lshlrev_b32 v18, 16, v18
    v_and_b32 v21, s32, v20
    v_lshlrev_b32 v20, 16, v20
    v_and_b32 v23, s32, v22
    v_lshlrev_b32 v22, 16, v22
    v_and_b32 v25, s32, v24
    v_lshlrev_b32 v24, 16, v24
    v_and_b32 v27, s32, v26
    v_lshlrev_b32 v26, 16, v26
    v_add_f32 v12, v12, v44
    v_add_f32 v13, v13, v45
    v_add_f32 v14, v14, v46
    v_add_f32 v15, v15, v47
    v_add_f32 v16, v16, v48
    v_add_f32 v17, v17, v49
    v_add_f32 v18, v18, v50
    v_add_f32 v19, v19, v51
    v_add_f32 v20, v20, v52
    v_add_f32 v21, v21, v53
    v_add_f32 v22, v22, v54
    v_add_f32 v23, v23, v55
    v_add_f32 v24, v24, v56
    v_add_f32 v25, v25, v57
    v_add_f32 v26, v26, v58
    v_add_f32 v27, v27, v59
    v_cvt_pk_bf16_f32 v28, v12, v13
    v_cvt_pk_bf16_f32 v29, v14, v15
    v_cvt_pk_bf16_f32 v30, v16, v17
    v_cvt_pk_bf16_f32 v31, v18, v19
    v_cvt_pk_bf16_f32 v32, v20, v21
    v_cvt_pk_bf16_f32 v33, v22, v23
    v_cvt_pk_bf16_f32 v34, v24, v25
    v_cvt_pk_bf16_f32 v35, v26, v27
    buffer_store_dwordx4 v[28:31], v4, s[24:27], 0 offen
    buffer_store_dwordx4 v[32:35], v5, s[24:27], 0 offen
L_postend_96:
    s_mov_b64 exec, -1
L_nextq_94:
    s_bfe_u32 s3, s35, 0x40008
    s_cbranch_scc0 L_fend_112
    s_ff1_i32_b32 s41, s3
    s_add_u32 s3, s41, 8
    s_bitset0_b32 s35, s3
    s_branch L_qloop_89
L_fend_112:

L_p2done_50:
    s_endpgm

L_ufix_52:
    v_and_b32 v117, 63, v0
    v_lshlrev_b32 v117, 2, v117
    s_sub_i32 s54, s42, 1024
    v_cmp_le_i32 vcc, s54, v117
    s_mov_b64 exec, vcc
    v_mov_b32 v12, 0
    v_mov_b32 v44, 0
    s_mov_b64 exec, -1
    s_sub_i32 s54, s42, 1025
    v_cmp_le_i32 vcc, s54, v117
    s_mov_b64 exec, vcc
    v_mov_b32 v13, 0
    v_mov_b32 v46, 0
    s_mov_b64 exec, -1
    s_sub_i32 s54, s42, 1026
    v_cmp_le_i32 vcc, s54, v117
    s_mov_b64 exec, vcc
    v_mov_b32 v14, 0
    v_mov_b32 v48, 0
    s_mov_b64 exec, -1
    s_sub_i32 s54, s42, 1027
    v_cmp_le_i32 vcc, s54, v117
    s_mov_b64 exec, vcc
    v_mov_b32 v15, 0
    v_mov_b32 v50, 0
    s_mov_b64 exec, -1
    s_branch L_uback_53
L_ufix_54:
    v_and_b32 v117, 63, v0
    v_lshlrev_b32 v117, 2, v117
    s_sub_i32 s54, s42, 1536
    v_cmp_le_i32 vcc, s54, v117
    s_mov_b64 exec, vcc
    v_mov_b32 v16, 0
    v_mov_b32 v52, 0
    s_mov_b64 exec, -1
    s_sub_i32 s54, s42, 1537
    v_cmp_le_i32 vcc, s54, v117
    s_mov_b64 exec, vcc
    v_mov_b32 v17, 0
    v_mov_b32 v54, 0
    s_mov_b64 exec, -1
    s_sub_i32 s54, s42, 1538
    v_cmp_le_i32 vcc, s54, v117
    s_mov_b64 exec, vcc
    v_mov_b32 v18, 0
    v_mov_b32 v56, 0
    s_mov_b64 exec, -1
    s_sub_i32 s54, s42, 1539
    v_cmp_le_i32 vcc, s54, v117
    s_mov_b64 exec, vcc
    v_mov_b32 v19, 0
    v_mov_b32 v58, 0
    s_mov_b64 exec, -1
    s_branch L_uback_55
L_ufix_56:
    v_and_b32 v117, 63, v0
    v_lshlrev_b32 v117, 2, v117
    s_sub_i32 s54, s42, 2048
    v_cmp_le_i32 vcc, s54, v117
    s_mov_b64 exec, vcc
    v_mov_b32 v20, 0
    v_mov_b32 v60, 0
    s_mov_b64 exec, -1
    s_sub_i32 s54, s42, 2049
    v_cmp_le_i32 vcc, s54, v117
    s_mov_b64 exec, vcc
    v_mov_b32 v21, 0
    v_mov_b32 v62, 0
    s_mov_b64 exec, -1
    s_sub_i32 s54, s42, 2050
    v_cmp_le_i32 vcc, s54, v117
    s_mov_b64 exec, vcc
    v_mov_b32 v22, 0
    v_mov_b32 v64, 0
    s_mov_b64 exec, -1
    s_sub_i32 s54, s42, 2051
    v_cmp_le_i32 vcc, s54, v117
    s_mov_b64 exec, vcc
    v_mov_b32 v23, 0
    v_mov_b32 v66, 0
    s_mov_b64 exec, -1
    s_branch L_uback_57
L_ufix_58:
    v_and_b32 v117, 63, v0
    v_lshlrev_b32 v117, 2, v117
    s_sub_i32 s54, s42, 2560
    v_cmp_le_i32 vcc, s54, v117
    s_mov_b64 exec, vcc
    v_mov_b32 v24, 0
    v_mov_b32 v68, 0
    s_mov_b64 exec, -1
    s_sub_i32 s54, s42, 2561
    v_cmp_le_i32 vcc, s54, v117
    s_mov_b64 exec, vcc
    v_mov_b32 v25, 0
    v_mov_b32 v70, 0
    s_mov_b64 exec, -1
    s_sub_i32 s54, s42, 2562
    v_cmp_le_i32 vcc, s54, v117
    s_mov_b64 exec, vcc
    v_mov_b32 v26, 0
    v_mov_b32 v72, 0
    s_mov_b64 exec, -1
    s_sub_i32 s54, s42, 2563
    v_cmp_le_i32 vcc, s54, v117
    s_mov_b64 exec, vcc
    v_mov_b32 v27, 0
    v_mov_b32 v74, 0
    s_mov_b64 exec, -1
    s_branch L_uback_59
L_ufix_60:
    v_and_b32 v117, 63, v0
    v_lshlrev_b32 v117, 2, v117
    s_sub_i32 s54, s42, 0
    v_cmp_le_i32 vcc, s54, v117
    s_mov_b64 exec, vcc
    v_mov_b32 v4, 0
    v_mov_b32 v28, 0
    s_mov_b64 exec, -1
    s_sub_i32 s54, s42, 1
    v_cmp_le_i32 vcc, s54, v117
    s_mov_b64 exec, vcc
    v_mov_b32 v5, 0
    v_mov_b32 v30, 0
    s_mov_b64 exec, -1
    s_sub_i32 s54, s42, 2
    v_cmp_le_i32 vcc, s54, v117
    s_mov_b64 exec, vcc
    v_mov_b32 v6, 0
    v_mov_b32 v32, 0
    s_mov_b64 exec, -1
    s_sub_i32 s54, s42, 3
    v_cmp_le_i32 vcc, s54, v117
    s_mov_b64 exec, vcc
    v_mov_b32 v7, 0
    v_mov_b32 v34, 0
    s_mov_b64 exec, -1
    s_branch L_uback_61
L_ufix_62:
    v_and_b32 v117, 63, v0
    v_lshlrev_b32 v117, 2, v117
    s_sub_i32 s54, s42, 512
    v_cmp_le_i32 vcc, s54, v117
    s_mov_b64 exec, vcc
    v_mov_b32 v8, 0
    v_mov_b32 v36, 0
    s_mov_b64 exec, -1
    s_sub_i32 s54, s42, 513
    v_cmp_le_i32 vcc, s54, v117
    s_mov_b64 exec, vcc
    v_mov_b32 v9, 0
    v_mov_b32 v38, 0
    s_mov_b64 exec, -1
    s_sub_i32 s54, s42, 514
    v_cmp_le_i32 vcc, s54, v117
    s_mov_b64 exec, vcc
    v_mov_b32 v10, 0
    v_mov_b32 v40, 0
    s_mov_b64 exec, -1
    s_sub_i32 s54, s42, 515
    v_cmp_le_i32 vcc, s54, v117
    s_mov_b64 exec, vcc
    v_mov_b32 v11, 0
    v_mov_b32 v42, 0
    s_mov_b64 exec, -1
    s_branch L_uback_63
L_ufix_69:
    v_and_b32 v117, 63, v0
    v_lshlrev_b32 v117, 2, v117
    s_sub_i32 s54, s42, 3072
    v_cmp_le_i32 vcc, s54, v117
    s_mov_b64 exec, vcc
    v_mov_b32 v106, 0
    v_mov_b32 v120, 0
    s_mov_b64 exec, -1
    s_sub_i32 s54, s42, 3073
    v_cmp_le_i32 vcc, s54, v117
    s_mov_b64 exec, vcc
    v_mov_b32 v107, 0
    v_mov_b32 v122, 0
    s_mov_b64 exec, -1
    s_sub_i32 s54, s42, 3074
    v_cmp_le_i32 vcc, s54, v117
    s_mov_b64 exec, vcc
    v_mov_b32 v108, 0
    v_mov_b32 v124, 0
    s_mov_b64 exec, -1
    s_sub_i32 s54, s42, 3075
    v_cmp_le_i32 vcc, s54, v117
    s_mov_b64 exec, vcc
    v_mov_b32 v109, 0
    v_mov_b32 v126, 0
    s_mov_b64 exec, -1
    s_branch L_uback_70
L_ufix_73:
    v_and_b32 v117, 63, v0
    v_lshlrev_b32 v117, 2, v117
    s_sub_i32 s54, s42, 1024
    v_cmp_le_i32 vcc, s54, v117
    s_mov_b64 exec, vcc
    v_mov_b32 v12, 0
    v_mov_b32 v44, 0
    s_mov_b64 exec, -1
    s_sub_i32 s54, s42, 1025
    v_cmp_le_i32 vcc, s54, v117
    s_mov_b64 exec, vcc
    v_mov_b32 v13, 0
    v_mov_b32 v46, 0
    s_mov_b64 exec, -1
    s_sub_i32 s54, s42, 1026
    v_cmp_le_i32 vcc, s54, v117
    s_mov_b64 exec, vcc
    v_mov_b32 v14, 0
    v_mov_b32 v48, 0
    s_mov_b64 exec, -1
    s_sub_i32 s54, s42, 1027
    v_cmp_le_i32 vcc, s54, v117
    s_mov_b64 exec, vcc
    v_mov_b32 v15, 0
    v_mov_b32 v50, 0
    s_mov_b64 exec, -1
    s_branch L_uback_74
L_ufix_75:
    v_and_b32 v117, 63, v0
    v_lshlrev_b32 v117, 2, v117
    s_sub_i32 s54, s42, 1536
    v_cmp_le_i32 vcc, s54, v117
    s_mov_b64 exec, vcc
    v_mov_b32 v16, 0
    v_mov_b32 v52, 0
    s_mov_b64 exec, -1
    s_sub_i32 s54, s42, 1537
    v_cmp_le_i32 vcc, s54, v117
    s_mov_b64 exec, vcc
    v_mov_b32 v17, 0
    v_mov_b32 v54, 0
    s_mov_b64 exec, -1
    s_sub_i32 s54, s42, 1538
    v_cmp_le_i32 vcc, s54, v117
    s_mov_b64 exec, vcc
    v_mov_b32 v18, 0
    v_mov_b32 v56, 0
    s_mov_b64 exec, -1
    s_sub_i32 s54, s42, 1539
    v_cmp_le_i32 vcc, s54, v117
    s_mov_b64 exec, vcc
    v_mov_b32 v19, 0
    v_mov_b32 v58, 0
    s_mov_b64 exec, -1
    s_branch L_uback_76
L_ufix_77:
    v_and_b32 v117, 63, v0
    v_lshlrev_b32 v117, 2, v117
    s_sub_i32 s54, s42, 2048
    v_cmp_le_i32 vcc, s54, v117
    s_mov_b64 exec, vcc
    v_mov_b32 v20, 0
    v_mov_b32 v60, 0
    s_mov_b64 exec, -1
    s_sub_i32 s54, s42, 2049
    v_cmp_le_i32 vcc, s54, v117
    s_mov_b64 exec, vcc
    v_mov_b32 v21, 0
    v_mov_b32 v62, 0
    s_mov_b64 exec, -1
    s_sub_i32 s54, s42, 2050
    v_cmp_le_i32 vcc, s54, v117
    s_mov_b64 exec, vcc
    v_mov_b32 v22, 0
    v_mov_b32 v64, 0
    s_mov_b64 exec, -1
    s_sub_i32 s54, s42, 2051
    v_cmp_le_i32 vcc, s54, v117
    s_mov_b64 exec, vcc
    v_mov_b32 v23, 0
    v_mov_b32 v66, 0
    s_mov_b64 exec, -1
    s_branch L_uback_78
L_ufix_79:
    v_and_b32 v117, 63, v0
    v_lshlrev_b32 v117, 2, v117
    s_sub_i32 s54, s42, 2560
    v_cmp_le_i32 vcc, s54, v117
    s_mov_b64 exec, vcc
    v_mov_b32 v24, 0
    v_mov_b32 v68, 0
    s_mov_b64 exec, -1
    s_sub_i32 s54, s42, 2561
    v_cmp_le_i32 vcc, s54, v117
    s_mov_b64 exec, vcc
    v_mov_b32 v25, 0
    v_mov_b32 v70, 0
    s_mov_b64 exec, -1
    s_sub_i32 s54, s42, 2562
    v_cmp_le_i32 vcc, s54, v117
    s_mov_b64 exec, vcc
    v_mov_b32 v26, 0
    v_mov_b32 v72, 0
    s_mov_b64 exec, -1
    s_sub_i32 s54, s42, 2563
    v_cmp_le_i32 vcc, s54, v117
    s_mov_b64 exec, vcc
    v_mov_b32 v27, 0
    v_mov_b32 v74, 0
    s_mov_b64 exec, -1
    s_branch L_uback_80
L_ufix_81:
    v_and_b32 v117, 63, v0
    v_lshlrev_b32 v117, 2, v117
    s_sub_i32 s54, s42, 0
    v_cmp_le_i32 vcc, s54, v117
    s_mov_b64 exec, vcc
    v_mov_b32 v4, 0
    v_mov_b32 v28, 0
    s_mov_b64 exec, -1
    s_sub_i32 s54, s42, 1
    v_cmp_le_i32 vcc, s54, v117
    s_mov_b64 exec, vcc
    v_mov_b32 v5, 0
    v_mov_b32 v30, 0
    s_mov_b64 exec, -1
    s_sub_i32 s54, s42, 2
    v_cmp_le_i32 vcc, s54, v117
    s_mov_b64 exec, vcc
    v_mov_b32 v6, 0
    v_mov_b32 v32, 0
    s_mov_b64 exec, -1
    s_sub_i32 s54, s42, 3
    v_cmp_le_i32 vcc, s54, v117
    s_mov_b64 exec, vcc
    v_mov_b32 v7, 0
    v_mov_b32 v34, 0
    s_mov_b64 exec, -1
    s_branch L_uback_82
L_ufix_83:
    v_and_b32 v117, 63, v0
    v_lshlrev_b32 v117, 2, v117
    s_sub_i32 s54, s42, 512
    v_cmp_le_i32 vcc, s54, v117
    s_mov_b64 exec, vcc
    v_mov_b32 v8, 0
    v_mov_b32 v36, 0
    s_mov_b64 exec, -1
    s_sub_i32 s54, s42, 513
    v_cmp_le_i32 vcc, s54, v117
    s_mov_b64 exec, vcc
    v_mov_b32 v9, 0
    v_mov_b32 v38, 0
    s_mov_b64 exec, -1
    s_sub_i32 s54, s42, 514
    v_cmp_le_i32 vcc, s54, v117
    s_mov_b64 exec, vcc
    v_mov_b32 v10, 0
    v_mov_b32 v40, 0
    s_mov_b64 exec, -1
    s_sub_i32 s54, s42, 515
    v_cmp_le_i32 vcc, s54, v117
    s_mov_b64 exec, vcc
    v_mov_b32 v11, 0
    v_mov_b32 v42, 0
    s_mov_b64 exec, -1
    s_branch L_uback_84
L_sync_98:
    v_mov_b32 v117, s33
    buffer_atomic_add v117, v116, s[44:47], s50 offen sc0
    s_waitcnt vmcnt(0)
    v_readfirstlane_b32 s4, v117
    s_movk_i32 s5, 400
    s_nop 0
    s_add_u32 s4, s4, s33
    s_bitcmp1_b32 s4, 2
    s_cbranch_scc1 L_tell_101
L_poll_99:
    s_sub_u32 s5, s5, 1
    s_cbranch_scc1 L_gave_100
    v_mov_b32 v117, 0
    buffer_atomic_add v117, v116, s[44:47], s50 offen sc0
    s_waitcnt vmcnt(0)
    v_readfirstlane_b32 s4, v117
    s_nop 1
    s_and_b32 s4, s4, 0xff
    s_bitcmp0_b32 s4, 2
    s_cbranch_scc1 L_poll_99
    s_branch L_tell_101
L_gave_100:
    s_lshl_b32 s4, 0x100, s37
    v_mov_b32 v117, s4
    buffer_atomic_or v117, v116, s[44:47], s50 offen sc0
    s_waitcnt vmcnt(0)
    v_readfirstlane_b32 s4, v117
    s_nop 1
    s_and_b32 s4, s4, 0xff
    s_bitcmp1_b32 s4, 2
    s_cselect_b32 s4, s4, 0x10000
L_tell_101:
    v_mov_b32 v117, s4
    v_mov_b32 v118, 150016
    ds_write_b32 v118, v117
    s_branch L_bcast_93

L_fgen_102:
    s_waitcnt vmcnt(0)
    v_lshlrev_b32 v6, 1, v4
    v_lshlrev_b32 v7, 1, v5
    v_mov_b32 v12, 0
    v_mov_b32 v13, 0
    v_mov_b32 v14, 0
    v_mov_b32 v15, 0
    v_mov_b32 v16, 0
    v_mov_b32 v17, 0
    v_mov_b32 v18, 0
    v_mov_b32 v19, 0
    v_mov_b32 v20, 0
    v_mov_b32 v21, 0
    v_mov_b32 v22, 0
    v_mov_b32 v23, 0
    v_mov_b32 v24, 0
    v_mov_b32 v25, 0
    v_mov_b32 v26, 0
    v_mov_b32 v27, 0
    s_bitcmp1_b32 s35, 4
    s_cbranch_scc1 L_ffl_104
    v_cvt_f32_u32_sdwa v28, v76 dst_sel:DWORD dst_unused:UNUSED_PAD src0_sel:WORD_0
    v_cvt_f32_u32_sdwa v29, v76 dst_sel:DWORD dst_unused:UNUSED_PAD src0_sel:WORD_1
    v_cvt_f32_u32_sdwa v30, v77 dst_sel:DWORD dst_unused:UNUSED_PAD src0_sel:WORD_0
    v_cvt_f32_u32_sdwa v31, v77 dst_sel:DWORD dst_unused:UNUSED_PAD src0_sel:WORD_1
    v_cvt_f32_u32_sdwa v32, v78 dst_sel:DWORD dst_unused:UNUSED_PAD src0_sel:WORD_0
    v_cvt_f32_u32_sdwa v33, v78 dst_sel:DWORD dst_unused:UNUSED_PAD src0_sel:WORD_1
    v_cvt_f32_u32_sdwa v34, v79 dst_sel:DWORD dst_unused:UNUSED_PAD src0_sel:WORD_0
    v_cvt_f32_u32_sdwa v35, v79 dst_sel:DWORD dst_unused:UNUSED_PAD src0_sel:WORD_1
    v_cvt_f32_u32_sdwa v36, v92 dst_sel:DWORD dst_unused:UNUSED_PAD src0_sel:WORD_0
    v_cvt_f32_u32_sdwa v37, v92 dst_sel:DWORD dst_unused:UNUSED_PAD src0_sel:WORD_1
    v_cvt_f32_u32_sdwa v38, v93 dst_sel:DWORD dst_unused:UNUSED_PAD src0_sel:WORD_0
    v_cvt_f32_u32_sdwa v39, v93 dst_sel:DWORD dst_unused:UNUSED_PAD src0_sel:WORD_1
    v_cvt_f32_u32_sdwa v40, v94 dst_sel:DWORD dst_unused:UNUSED_PAD src0_sel:WORD_0
    v_cvt_f32_u32_sdwa v41, v94 dst_sel:DWORD dst_unused:UNUSED_PAD src0_sel:WORD_1
    v_cvt_f32_u32_sdwa v42, v95 dst_sel:DWORD dst_unused:UNUSED_PAD src0_sel:WORD_0
    v_cvt_f32_u32_sdwa v43, v95 dst_sel:DWORD dst_unused:UNUSED_PAD src0_sel:WORD_1
    v_add_f32 v28, 0xc6800000, v28
    v_fmac_f32 v12, s34, v28
    v_add_f32 v29, 0xc6800000, v29
    v_fmac_f32 v13, s34, v29
    v_add_f32 v30, 0xc6800000, v30
    v_fmac_f32 v14, s34, v30
    v_add_f32 v31, 0xc6800000, v31
    v_fmac_f32 v15, s34, v31
    v_add_f32 v32, 0xc6800000, v32
    v_fmac_f32 v16, s34, v32
    v_add_f32 v33, 0xc6800000, v33
    v_fmac_f32 v17, s34, v33
    v_add_f32 v34, 0xc6800000, v34
    v_fmac_f32 v18, s34, v34
    v_add_f32 v35, 0xc6800000, v35
    v_fmac_f32 v19, s34, v35
    v_add_f32 v36, 0xc6800000, v36
    v_fmac_f32 v20, s34, v36
    v_add_f32 v37, 0xc6800000, v37
    v_fmac_f32 v21, s34, v37
    v_add_f32 v38, 0xc6800000, v38
    v_fmac_f32 v22, s34, v38
    v_add_f32 v39, 0xc6800000, v39
    v_fmac_f32 v23, s34, v39
    v_add_f32 v40, 0xc6800000, v40
    v_fmac_f32 v24, s34, v40
    v_add_f32 v41, 0xc6800000, v41
    v_fmac_f32 v25, s34, v41
    v_add_f32 v42, 0xc6800000, v42
    v_fmac_f32 v26, s34, v42
    v_add_f32 v43, 0xc6800000, v43
    v_fmac_f32 v27, s34, v43
    s_branch L_fnx_105
L_ffl_104:
    s_mov_b32 s3, 25600000
    buffer_load_dwordx4 v[28:31], v6, s[20:23], s3 offen offset:0 sc1
    buffer_load_dwordx4 v[32:35], v6, s[20:23], s3 offen offset:16 sc1
    buffer_load_dwordx4 v[36:39], v7, s[20:23], s3 offen offset:0 sc1
    buffer_load_dwordx4 v[40:43], v7, s[20:23], s3 offen offset:16 sc1
    s_waitcnt vmcnt(0)
    v_add_f32 v12, v12, v28
    v_add_f32 v13, v13, v29
    v_add_f32 v14, v14, v30
    v_add_f32 v15, v15, v31
    v_add_f32 v16, v16, v32
    v_add_f32 v17, v17, v33
    v_add_f32 v18, v18, v34
    v_add_f32 v19, v19, v35
    v_add_f32 v20, v20, v36
    v_add_f32 v21, v21, v37
    v_add_f32 v22, v22, v38
    v_add_f32 v23, v23, v39
    v_add_f32 v24, v24, v40
    v_add_f32 v25, v25, v41
    v_add_f32 v26, v26, v42
    v_add_f32 v27, v27, v43
L_fnx_105:
    s_bitcmp1_b32 s35, 5
    s_cbranch_scc1 L_ffl_106
    v_cvt_f32_u32_sdwa v28, v80 dst_sel:DWORD dst_unused:UNUSED_PAD src0_sel:WORD_0
    v_cvt_f32_u32_sdwa v29, v80 dst_sel:DWORD dst_unused:UNUSED_PAD src0_sel:WORD_1
    v_cvt_f32_u32_sdwa v30, v81 dst_sel:DWORD dst_unused:UNUSED_PAD src0_sel:WORD_0
    v_cvt_f32_u32_sdwa v31, v81 dst_sel:DWORD dst_unused:UNUSED_PAD src0_sel:WORD_1
    v_cvt_f32_u32_sdwa v32, v82 dst_sel:DWORD dst_unused:UNUSED_PAD src0_sel:WORD_0
    v_cvt_f32_u32_sdwa v33, v82 dst_sel:DWORD dst_unused:UNUSED_PAD src0_sel:WORD_1
    v_cvt_f32_u32_sdwa v34, v83 dst_sel:DWORD dst_unused:UNUSED_PAD src0_sel:WORD_0
    v_cvt_f32_u32_sdwa v35, v83 dst_sel:DWORD dst_unused:UNUSED_PAD src0_sel:WORD_1
    v_cvt_f32_u32_sdwa v36, v96 dst_sel:DWORD dst_unused:UNUSED_PAD src0_sel:WORD_0
    v_cvt_f32_u32_sdwa v37, v96 dst_sel:DWORD dst_unused:UNUSED_PAD src0_sel:WORD_1
    v_cvt_f32_u32_sdwa v38, v97 dst_sel:DWORD dst_unused:UNUSED_PAD src0_sel:WORD_0
    v_cvt_f32_u32_sdwa v39, v97 dst_sel:DWORD dst_unused:UNUSED_PAD src0_sel:WORD_1
    v_cvt_f32_u32_sdwa v40, v98 dst_sel:DWORD dst_unused:UNUSED_PAD src0_sel:WORD_0
    v_cvt_f32_u32_sdwa v41, v98 dst_sel:DWORD dst_unused:UNUSED_PAD src0_sel:WORD_1
    v_cvt_f32_u32_sdwa v42, v99 dst_sel:DWORD dst_unused:UNUSED_PAD src0_sel:WORD_0
    v_cvt_f32_u32_sdwa v43, v99 dst_sel:DWORD dst_unused:UNUSED_PAD src0_sel:WORD_1
    v_add_f32 v28, 0xc6800000, v28
    v_fmac_f32 v12, s34, v28
    v_add_f32 v29, 0xc6800000, v29
    v_fmac_f32 v13, s34, v29
    v_add_f32 v30, 0xc6800000, v30
    v_fmac_f32 v14, s34, v30
    v_add_f32 v31, 0xc6800000, v31
    v_fmac_f32 v15, s34, v31
    v_add_f32 v32, 0xc6800000, v32
    v_fmac_f32 v16, s34, v32
    v_add_f32 v33, 0xc6800000, v33
    v_fmac_f32 v17, s34, v33
    v_add_f32 v34, 0xc6800000, v34
    v_fmac_f32 v18, s34, v34
    v_add_f32 v35, 0xc6800000, v35
    v_fmac_f32 v19, s34, v35
    v_add_f32 v36, 0xc6800000, v36
    v_fmac_f32 v20, s34, v36
    v_add_f32 v37, 0xc6800000, v37
    v_fmac_f32 v21, s34, v37
    v_add_f32 v38, 0xc6800000, v38
    v_fmac_f32 v22, s34, v38
    v_add_f32 v39, 0xc6800000, v39
    v_fmac_f32 v23, s34, v39
    v_add_f32 v40, 0xc6800000, v40
    v_fmac_f32 v24, s34, v40
    v_add_f32 v41, 0xc6800000, v41
    v_fmac_f32 v25, s34, v41
    v_add_f32 v42, 0xc6800000, v42
    v_fmac_f32 v26, s34, v42
    v_add_f32 v43, 0xc6800000, v43
    v_fmac_f32 v27, s34, v43
    s_branch L_fnx_107
L_ffl_106:
    s_mov_b32 s3, 38400000
    buffer_load_dwordx4 v[28:31], v6, s[20:23], s3 offen offset:0 sc1
    buffer_load_dwordx4 v[32:35], v6, s[20:23], s3 offen offset:16 sc1
    buffer_load_dwordx4 v[36:39], v7, s[20:23], s3 offen offset:0 sc1
    buffer_load_dwordx4 v[40:43], v7, s[20:23], s3 offen offset:16 sc1
    s_waitcnt vmcnt(0)
    v_add_f32 v12, v12, v28
    v_add_f32 v13, v13, v29
    v_add_f32 v14, v14, v30
    v_add_f32 v15, v15, v31
    v_add_f32 v16, v16, v32
    v_add_f32 v17, v17, v33
    v_add_f32 v18, v18, v34
    v_add_f32 v19, v19, v35
    v_add_f32 v20, v20, v36
    v_add_f32 v21, v21, v37
    v_add_f32 v22, v22, v38
    v_add_f32 v23, v23, v39
    v_add_f32 v24, v24, v40
    v_add_f32 v25, v25, v41
    v_add_f32 v26, v26, v42
    v_add_f32 v27, v27, v43
L_fnx_107:
    s_bitcmp1_b32 s35, 6
    s_cbranch_scc1 L_ffl_108
    v_cvt_f32_u32_sdwa v28, v84 dst_sel:DWORD dst_unused:UNUSED_PAD src0_sel:WORD_0
    v_cvt_f32_u32_sdwa v29, v84 dst_sel:DWORD dst_unused:UNUSED_PAD src0_sel:WORD_1
    v_cvt_f32_u32_sdwa v30, v85 dst_sel:DWORD dst_unused:UNUSED_PAD src0_sel:WORD_0
    v_cvt_f32_u32_sdwa v31, v85 dst_sel:DWORD dst_unused:UNUSED_PAD src0_sel:WORD_1
    v_cvt_f32_u32_sdwa v32, v86 dst_sel:DWORD dst_unused:UNUSED_PAD src0_sel:WORD_0
    v_cvt_f32_u32_sdwa v33, v86 dst_sel:DWORD dst_unused:UNUSED_PAD src0_sel:WORD_1
    v_cvt_f32_u32_sdwa v34, v87 dst_sel:DWORD dst_unused:UNUSED_PAD src0_sel:WORD_0
    v_cvt_f32_u32_sdwa v35, v87 dst_sel:DWORD dst_unused:UNUSED_PAD src0_sel:WORD_1
    v_cvt_f32_u32_sdwa v36, v100 dst_sel:DWORD dst_unused:UNUSED_PAD src0_sel:WORD_0
    v_cvt_f32_u32_sdwa v37, v100 dst_sel:DWORD dst_unused:UNUSED_PAD src0_sel:WORD_1
    v_cvt_f32_u32_sdwa v38, v101 dst_sel:DWORD dst_unused:UNUSED_PAD src0_sel:WORD_0
    v_cvt_f32_u32_sdwa v39, v101 dst_sel:DWORD dst_unused:UNUSED_PAD src0_sel:WORD_1
    v_cvt_f32_u32_sdwa v40, v102 dst_sel:DWORD dst_unused:UNUSED_PAD src0_sel:WORD_0
    v_cvt_f32_u32_sdwa v41, v102 dst_sel:DWORD dst_unused:UNUSED_PAD src0_sel:WORD_1
    v_cvt_f32_u32_sdwa v42, v103 dst_sel:DWORD dst_unused:UNUSED_PAD src0_sel:WORD_0
    v_cvt_f32_u32_sdwa v43, v103 dst_sel:DWORD dst_unused:UNUSED_PAD src0_sel:WORD_1
    v_add_f32 v28, 0xc6800000, v28
    v_fmac_f32 v12, s34, v28
    v_add_f32 v29, 0xc6800000, v29
    v_fmac_f32 v13, s34, v29
    v_add_f32 v30, 0xc6800000, v30
    v_fmac_f32 v14, s34, v30
    v_add_f32 v31, 0xc6800000, v31
    v_fmac_f32 v15, s34, v31
    v_add_f32 v32, 0xc6800000, v32
    v_fmac_f32 v16, s34, v32
    v_add_f32 v33, 0xc6800000, v33
    v_fmac_f32 v17, s34, v33
    v_add_f32 v34, 0xc6800000, v34
    v_fmac_f32 v18, s34, v34
    v_add_f32 v35, 0xc6800000, v35
    v_fmac_f32 v19, s34, v35
    v_add_f32 v36, 0xc6800000, v36
    v_fmac_f32 v20, s34, v36
    v_add_f32 v37, 0xc6800000, v37
    v_fmac_f32 v21, s34, v37
    v_add_f32 v38, 0xc6800000, v38
    v_fmac_f32 v22, s34, v38
    v_add_f32 v39, 0xc6800000, v39
    v_fmac_f32 v23, s34, v39
    v_add_f32 v40, 0xc6800000, v40
    v_fmac_f32 v24, s34, v40
    v_add_f32 v41, 0xc6800000, v41
    v_fmac_f32 v25, s34, v41
    v_add_f32 v42, 0xc6800000, v42
    v_fmac_f32 v26, s34, v42
    v_add_f32 v43, 0xc6800000, v43
    v_fmac_f32 v27, s34, v43
    s_branch L_fnx_109
L_ffl_108:
    s_mov_b32 s3, 51200000
    buffer_load_dwordx4 v[28:31], v6, s[20:23], s3 offen offset:0 sc1
    buffer_load_dwordx4 v[32:35], v6, s[20:23], s3 offen offset:16 sc1
    buffer_load_dwordx4 v[36:39], v7, s[20:23], s3 offen offset:0 sc1
    buffer_load_dwordx4 v[40:43], v7, s[20:23], s3 offen offset:16 sc1
    s_waitcnt vmcnt(0)
    v_add_f32 v12, v12, v28
    v_add_f32 v13, v13, v29
    v_add_f32 v14, v14, v30
    v_add_f32 v15, v15, v31
    v_add_f32 v16, v16, v32
    v_add_f32 v17, v17, v33
    v_add_f32 v18, v18, v34
    v_add_f32 v19, v19, v35
    v_add_f32 v20, v20, v36
    v_add_f32 v21, v21, v37
    v_add_f32 v22, v22, v38
    v_add_f32 v23, v23, v39
    v_add_f32 v24, v24, v40
    v_add_f32 v25, v25, v41
    v_add_f32 v26, v26, v42
    v_add_f32 v27, v27, v43
L_fnx_109:
    s_bitcmp1_b32 s35, 7
    s_cbranch_scc1 L_ffl_110
    v_cvt_f32_u32_sdwa v28, v88 dst_sel:DWORD dst_unused:UNUSED_PAD src0_sel:WORD_0
    v_cvt_f32_u32_sdwa v29, v88 dst_sel:DWORD dst_unused:UNUSED_PAD src0_sel:WORD_1
    v_cvt_f32_u32_sdwa v30, v89 dst_sel:DWORD dst_unused:UNUSED_PAD src0_sel:WORD_0
    v_cvt_f32_u32_sdwa v31, v89 dst_sel:DWORD dst_unused:UNUSED_PAD src0_sel:WORD_1
    v_cvt_f32_u32_sdwa v32, v90 dst_sel:DWORD dst_unused:UNUSED_PAD src0_sel:WORD_0
    v_cvt_f32_u32_sdwa v33, v90 dst_sel:DWORD dst_unused:UNUSED_PAD src0_sel:WORD_1
    v_cvt_f32_u32_sdwa v34, v91 dst_sel:DWORD dst_unused:UNUSED_PAD src0_sel:WORD_0
    v_cvt_f32_u32_sdwa v35, v91 dst_sel:DWORD dst_unused:UNUSED_PAD src0_sel:WORD_1
    v_cvt_f32_u32_sdwa v36, v104 dst_sel:DWORD dst_unused:UNUSED_PAD src0_sel:WORD_0
    v_cvt_f32_u32_sdwa v37, v104 dst_sel:DWORD dst_unused:UNUSED_PAD src0_sel:WORD_1
    v_cvt_f32_u32_sdwa v38, v105 dst_sel:DWORD dst_unused:UNUSED_PAD src0_sel:WORD_0
    v_cvt_f32_u32_sdwa v39, v105 dst_sel:DWORD dst_unused:UNUSED_PAD src0_sel:WORD_1
    v_cvt_f32_u32_sdwa v40, v106 dst_sel:DWORD dst_unused:UNUSED_PAD src0_sel:WORD_0
    v_cvt_f32_u32_sdwa v41, v106 dst_sel:DWORD dst_unused:UNUSED_PAD src0_sel:WORD_1
    v_cvt_f32_u32_sdwa v42, v107 dst_sel:DWORD dst_unused:UNUSED_PAD src0_sel:WORD_0
    v_cvt_f32_u32_sdwa v43, v107 dst_sel:DWORD dst_unused:UNUSED_PAD src0_sel:WORD_1
    v_add_f32 v28, 0xc6800000, v28
    v_fmac_f32 v12, s34, v28
    v_add_f32 v29, 0xc6800000, v29
    v_fmac_f32 v13, s34, v29
    v_add_f32 v30, 0xc6800000, v30
    v_fmac_f32 v14, s34, v30
    v_add_f32 v31, 0xc6800000, v31
    v_fmac_f32 v15, s34, v31
    v_add_f32 v32, 0xc6800000, v32
    v_fmac_f32 v16, s34, v32
    v_add_f32 v33, 0xc6800000, v33
    v_fmac_f32 v17, s34, v33
    v_add_f32 v34, 0xc6800000, v34
    v_fmac_f32 v18, s34, v34
    v_add_f32 v35, 0xc6800000, v35
    v_fmac_f32 v19, s34, v35
    v_add_f32 v36, 0xc6800000, v36
    v_fmac_f32 v20, s34, v36
    v_add_f32 v37, 0xc6800000, v37
    v_fmac_f32 v21, s34, v37
    v_add_f32 v38, 0xc6800000, v38
    v_fmac_f32 v22, s34, v38
    v_add_f32 v39, 0xc6800000, v39
    v_fmac_f32 v23, s34, v39
    v_add_f32 v40, 0xc6800000, v40
    v_fmac_f32 v24, s34, v40
    v_add_f32 v41, 0xc6800000, v41
    v_fmac_f32 v25, s34, v41
    v_add_f32 v42, 0xc6800000, v42
    v_fmac_f32 v26, s34, v42
    v_add_f32 v43, 0xc6800000, v43
    v_fmac_f32 v27, s34, v43
    s_branch L_fnx_111
L_ffl_110:
    s_mov_b32 s3, 64000000
    buffer_load_dwordx4 v[28:31], v6, s[20:23], s3 offen offset:0 sc1
    buffer_load_dwordx4 v[32:35], v6, s[20:23], s3 offen offset:16 sc1
    buffer_load_dwordx4 v[36:39], v7, s[20:23], s3 offen offset:0 sc1
    buffer_load_dwordx4 v[40:43], v7, s[20:23], s3 offen offset:16 sc1
    s_waitcnt vmcnt(0)
    v_add_f32 v12, v12, v28
    v_add_f32 v13, v13, v29
    v_add_f32 v14, v14, v30
    v_add_f32 v15, v15, v31
    v_add_f32 v16, v16, v32
    v_add_f32 v17, v17, v33
    v_add_f32 v18, v18, v34
    v_add_f32 v19, v19, v35
    v_add_f32 v20, v20, v36
    v_add_f32 v21, v21, v37
    v_add_f32 v22, v22, v38
    v_add_f32 v23, v23, v39
    v_add_f32 v24, v24, v40
    v_add_f32 v25, v25, v41
    v_add_f32 v26, v26, v42
    v_add_f32 v27, v27, v43
L_fnx_111:
    s_branch L_fbk_103
L_p2slow_51:
    s_waitcnt vmcnt(0) lgkmcnt(0)
    s_mov_b32 s51, 0
    s_movk_i32 s43, 6250

L_sweep_113:
    s_barrier

    v_mov_b32 v28, 0x0
    v_mov_b32 v29, 0x0
    v_mov_b32 v30, 0x0
    v_mov_b32 v31, 0x0
    v_add_u32 v32, 50000, v3
    v_add_u32 v33, 65536, v32

    ds_write_b128 v32, v[28:31] offset:0
    ds_write_b128 v32, v[28:31] offset:16384
    ds_write_b128 v32, v[28:31] offset:32768
    ds_write_b128 v32, v[28:31] offset:49152
    ds_write_b128 v33, v[28:31] offset:0
    ds_write_b128 v33, v[28:31] offset:16384
    v_cmp_gt_u32 vcc, 971, v0
    s_mov_b64 exec, vcc
    ds_write_b128 v33, v[28:31] offset:32768
    s_mov_b64 exec, -1
    s_waitcnt lgkmcnt(0)
    s_barrier
    s_sub_u32 s38, s4, 8
L_sbatch_114:
    s_lshl_b32 s52, s38, 6
    s_add_u32 s52, s52, s36
    s_lshl_b32 s52, s52, 2
    s_load_dword s40, s[46:47], s52
    s_mul_i32 s50, s38, 200000
    s_waitcnt lgkmcnt(0)

    s_min_u32 s40, s40, 3968
    s_lshl_b32 s52, s38, 6
    s_add_u32 s52, s52, s36
    s_mul_i32 s52, s52, 19840
    s_add_u32 s20, s44, s52
    s_addc_u32 s21, s45, 0
    s_mul_i32 s52, s40, 5
    s_add_u32 s52, s52, 3
    s_and_b32 s22, s52, -4

    s_lshr_b32 s55, s39, 2
    s_add_u32 s55, s55, 0
    v_and_b32 v36, 63, v0
    v_add_u32 v36, s55, v36
L_left_118:
    s_cmp_ge_u32 s55, s40
    s_cbranch_scc1 L_leftend_119
    v_mul_u32_u24 v37, 5, v36
    buffer_load_dword v38, v37, s[20:23], 0 offen
    buffer_load_ubyte v39, v37, s[20:23], 0 offen offset:4
    s_waitcnt vmcnt(0)

    v_perm_b32 v37, v39, v38, s24
    v_lshrrev_b32 v42, 30, v38
    v_and_b32 v37, 0x1fff, v37
    v_mul_u32_u24 v42, 6250, v42
    v_add_lshl_u32 v37, v37, v42, 3

    buffer_load_dwordx2 v[40:41], v37, s[8:11], s50 offen
    v_cmp_gt_u32 vcc, s40, v36
    s_waitcnt vmcnt(0)

    v_bfe_u32 v44, v38, 16, 14
    v_subrev_u32 v44, s51, v44
    v_cmp_gt_u32 s[64:65], s43, v44
    s_and_b64 exec, vcc, s[64:65]
    v_lshlrev_b32 v45, 8, v38
    v_cmpx_ne_u32 vcc, 0, v45
    v_lshlrev_b32 v44, 4, v44
    v_bfe_i32 v38, v38, 0, 16
    v_cvt_f32_i32 v38, v38
    v_mul_f32 v38, 0x38004020, v38
    v_lshlrev_b32 v45, 16, v40
    v_and_b32 v46, s32, v40
    v_lshlrev_b32 v47, 16, v41
    v_and_b32 v48, s32, v41

    v_mul_f32 v45, v45, v38
    ds_add_f32 v44, v45 offset:50000
    v_mul_f32 v46, v46, v38
    ds_add_f32 v44, v46 offset:50004
    v_mul_f32 v47, v47, v38
    ds_add_f32 v44, v47 offset:50008
    v_mul_f32 v48, v48, v38
    ds_add_f32 v44, v48 offset:50012
    s_mov_b64 exec, -1
    v_add_u32 v36, 128, v36
    s_add_u32 s55, s55, 128
    s_branch L_left_118
L_leftend_119:

    s_add_u32 s38, s38, 1
    s_cmp_lt_u32 s38, s4
    s_cbranch_scc1 L_sbatch_114
    s_mov_b32 s3, 65536
    s_load_dword s40, s[6:7], s3

    s_add_u32 s20, s6, 408657920
    s_addc_u32 s21, s7, 0
    s_mov_b32 s22, 409600000
    s_mov_b32 s23, 0x20000
    s_mov_b32 s38, 0
    s_mov_b32 s50, 200000
    v_mov_b32 v36, v0
    s_waitcnt lgkmcnt(0)
L_ovf_115:
    s_cmp_ge_u32 s38, s40
    s_cbranch_scc1 L_ovfend_116
    v_lshlrev_b32 v37, 3, v36
    buffer_load_dwordx2 v[38:39], v37, s[20:23], 0 offen
    s_waitcnt vmcnt(0)

    v_perm_b32 v37, v39, v38, s24
    v_lshrrev_b32 v42, 30, v38
    v_and_b32 v37, 0x1fff, v37
    v_mul_u32_u24 v42, 6250, v42
    v_add_lshl_u32 v37, v37, v42, 3

    v_bfe_u32 v42, v39, 24, 5
    v_mad_u32_u24 v37, v42, s50, v37
    buffer_load_dwordx2 v[40:41], v37, s[8:11], 0 offen
    v_lshrrev_b32 v42, 3, v42
    v_bfe_u32 v43, v39, 18, 6
    v_cmp_gt_u32 vcc, s40, v36
    v_cmp_eq_u32 s[64:65], s36, v43
    s_and_b64 vcc, vcc, s[64:65]
    v_cmp_eq_u32 s[64:65], s37, v42
    s_and_b64 vcc, vcc, s[64:65]
    s_waitcnt vmcnt(0)

    v_bfe_u32 v44, v38, 16, 14
    v_subrev_u32 v44, s51, v44
    v_cmp_gt_u32 s[64:65], s43, v44
    s_and_b64 exec, vcc, s[64:65]
    v_lshlrev_b32 v45, 8, v38
    v_cmpx_ne_u32 vcc, 0, v45
    v_lshlrev_b32 v44, 4, v44
    v_bfe_i32 v38, v38, 0, 16
    v_cvt_f32_i32 v38, v38
    v_mul_f32 v38, 0x38004020, v38
    v_lshlrev_b32 v45, 16, v40
    v_and_b32 v46, s32, v40
    v_lshlrev_b32 v47, 16, v41
    v_and_b32 v48, s32, v41

    v_mul_f32 v45, v45, v38
    ds_add_f32 v44, v45 offset:50000
    v_mul_f32 v46, v46, v38
    ds_add_f32 v44, v46 offset:50004
    v_mul_f32 v47, v47, v38
    ds_add_f32 v44, v47 offset:50008
    v_mul_f32 v48, v48, v38
    ds_add_f32 v44, v48 offset:50012
    s_mov_b64 exec, -1
    v_add_u32 v36, 1024, v36
    s_add_u32 s38, s38, 1024
    s_branch L_ovf_115
L_ovfend_116:
    s_waitcnt lgkmcnt(0)
    s_barrier
    s_mul_i32 s3, s37, 800000
    s_mul_i32 s5, s36, 12500
    s_add_u32 s3, s3, s5
    s_add_u32 s3, s3, s51
    s_lshl_b32 s3, s3, 4
    s_add_u32 s3, s3, 32399360

    s_add_u32 s20, s6, s3
    s_addc_u32 s21, s7, 0
    s_mov_b32 s22, 100000
    s_mov_b32 s23, 0x20000
    v_mov_b32 v36, v3
    s_mov_b32 s38, 0
L_wl_117:
    v_min_u32 v37, 100000, v36
    ds_read_b128 v[28:31], v37 offset:50000
    s_waitcnt lgkmcnt(0)
    buffer_store_dwordx4 v[28:31], v36, s[20:23], 0 offen sc1
    s_waitcnt vmcnt(0)
    v_add_u32 v36, 16384, v36
    s_add_u32 s38, s38, 1024
    s_cmp_lt_u32 s38, 6250
    s_cbranch_scc1 L_wl_117
    s_add_u32 s51, s51, 6250
    s_cmp_lt_u32 s51, 12500
    s_cbranch_scc1 L_sweep_113
    s_lshl_b32 s33, 16, s37
    s_add_u32 s33, s33, 1
    s_branch L_fin_86

.section .rodata,"a"
.p2align 6
.amdhsa_kernel g1_kernel
  .amdhsa_next_free_vgpr 128
  .amdhsa_next_free_sgpr 102
  .amdhsa_accum_offset 128
  .amdhsa_group_segment_fixed_size 0
  .amdhsa_kernarg_size 112
  .amdhsa_user_sgpr_count 2
  .amdhsa_user_sgpr_kernarg_segment_ptr 1
  .amdhsa_system_sgpr_workgroup_id_x 1
.end_amdhsa_kernel
.p2align 6
.amdhsa_kernel standalone__molecular_angular_gemnet__graph_kernel
  .amdhsa_next_free_vgpr 128
  .amdhsa_next_free_sgpr 102
  .amdhsa_accum_offset 128
  .amdhsa_group_segment_fixed_size 0
  .amdhsa_kernarg_size 112
  .amdhsa_user_sgpr_count 2
  .amdhsa_user_sgpr_kernarg_segment_ptr 1
  .amdhsa_system_sgpr_workgroup_id_x 1
  .amdhsa_float_denorm_mode_32 3
.end_amdhsa_kernel
```

```asm
; @launch kernel=g1_kernel grid=(256,1,1) block=(1024,1,1) lds=163840
; @launch kernel=standalone__molecular_angular_gemnet__graph_kernel grid=(256,1,1) block=(1024,1,1) lds=163840
.amdgcn_target "amdgcn-amd-amdhsa--gfx950"
.text
.globl g1_kernel
.p2align 8
.type g1_kernel,@function
g1_kernel:
    s_cmp_ge_u32 s2, 256
    s_cbranch_scc1 L_p1done_1
    s_load_dwordx4 s[80:83], s[0:1], 8
    s_load_dwordx2 s[84:85], s[0:1], 32
    s_load_dwordx2 s[86:87], s[0:1], 48
    s_load_dwordx4 s[4:7], s[0:1], 96
    s_load_dwordx2 s[78:79], s[0:1], 0
    v_lshlrev_b32 v1, 4, v0
    v_lshlrev_b32 v2, 3, v0
    v_lshlrev_b32 v98, 20, v0
    s_waitcnt lgkmcnt(0)
    s_load_dword s88, s[86:87], 0

    s_mov_b32 s96, s4
    s_mov_b32 s97, s5
    s_mov_b32 s98, 256
    s_mov_b32 s99, 0x20000
    v_readfirstlane_b32 s74, v0
    s_nop 1
    s_or_b32 s74, s74, s2
    s_cbranch_scc1 L_noinit_2

    v_mov_b32 v110, 1
    buffer_atomic_add v110, v98, s[96:99], 0 offen offset:64 sc0
    s_waitcnt vmcnt(0)
    v_readfirstlane_b32 s74, v110
    s_nop 1
    s_cmp_lg_u32 s74, 0
    s_cbranch_scc1 L_zno_4

    s_mov_b32 s92, s6
    s_mov_b32 s93, s7
    s_mov_b32 s94, 65552
    s_mov_b32 s95, 0x20000
    v_mov_b32 v110, 0
    v_mov_b32 v111, 0
    v_mov_b32 v112, 0
    v_mov_b32 v113, 0
L_zl_3:
    buffer_store_dwordx4 v[110:113], v1, s[92:95], s74 offen sc0 sc1
    s_add_u32 s74, s74, 1024
    s_cmp_le_u32 s74, 65536
    s_cbranch_scc1 L_zl_3
    v_mov_b32 v114, 1
    s_waitcnt vmcnt(0)
    buffer_atomic_add v114, v98, s[96:99], 0 offen offset:128
L_zno_4:

L_noinit_2:
    s_mov_b32 s20, s78
    s_mov_b32 s21, s79
    s_mov_b32 s22, 6400000
    s_mov_b32 s23, 0x20000
    v_mul_u32_u24 v110, 6240, v0
    v_and_b32 v111, 63, v0
    v_and_b32 v112, 0x3c0, v0
    v_lshlrev_b32 v111, 2, v111
    v_lshl_or_b32 v111, v112, 4, v111
    v_lshlrev_b32 v100, 2, v0
    s_lshr_b32 s50, s2, 1
    s_and_b32 s53, s2, 1
    s_mul_i32 s3, s50, 50000
    s_mul_i32 s54, s53, 24576
    s_add_u32 s3, s3, s54

    buffer_load_dwordx4 v[56:59], v110, s[20:23], 0 offen
    s_add_u32 s20, s78, s3
    s_addc_u32 s21, s79, 0
    s_mov_b32 s22, 24576
    s_mov_b32 s23, 0x20000
    s_movk_i32 s3, 16384
    buffer_load_dword v44, v111, s[20:23], 0 offen offset:0
    buffer_load_dword v45, v111, s[20:23], 0 offen offset:256
    buffer_load_dword v46, v111, s[20:23], 0 offen offset:512
    buffer_load_dword v47, v111, s[20:23], 0 offen offset:768
    buffer_load_dword v48, v111, s[20:23], s3 offen offset:0
    buffer_load_dword v49, v111, s[20:23], s3 offen offset:256
    buffer_load_dword v50, v111, s[20:23], s3 offen offset:512
    buffer_load_dword v51, v111, s[20:23], s3 offen offset:768
    s_mul_i32 s22, s53, 25424
    s_movk_i32 s3, 24576

    buffer_load_dword v52, v100, s[20:23], s3 offen
    s_mul_i32 s3, s50, 50048
    s_add_u32 s3, s3, s54
    s_add_u32 s54, s3, 393216

    s_mov_b32 s8, s80
    s_mov_b32 s9, s81
    s_mov_b32 s10, 0
    s_mov_b32 s11, 0x20000
    s_mov_b32 s12, s82
    s_mov_b32 s13, s83
    s_mov_b32 s14, 0
    s_mov_b32 s15, 0x20000
    s_mov_b32 s16, s84
    s_mov_b32 s17, s85
    s_mov_b32 s18, 0
    s_mov_b32 s19, 0x20000
    s_lshr_b32 s74, s2, 1
    s_and_b32 s74, s74, 28
    s_lshr_b32 s86, 0x00102010, s74
    s_lshr_b32 s87, 0x44414241, s74
    s_lshr_b32 s41, 0x43221100, s74
    s_and_b32 s86, s86, 15
    s_and_b32 s87, s87, 15
    s_and_b32 s41, s41, 15
    s_lshr_b32 s74, s2, 6
    s_lshl_b32 s74, s74, 3
    s_and_b32 s75, s2, 7
    s_add_u32 s74, s74, s75
    s_mul_i32 s74, s74, 5
    s_add_u32 s41, s41, s74

    s_mul_i32 s78, s41, 16384
    s_add_u32 s49, s78, 16384
    s_cmp_ge_u32 s41, 3125
    s_cmovk_i32 s49, 0
    s_cmovk_i32 s78, 0
    s_lshl_b32 s10, s49, 2
    s_lshl_b32 s14, s49, 2
    s_lshl_b32 s18, s49, 1
    s_sub_u32 s79, s87, s86
    s_bfm_b32 s85, s79, s86
    s_lshl_b32 s86, s86, 12
    s_lshl_b32 s87, s87, 12
    s_min_u32 s87, s87, 16384

    s_add_u32 s79, s78, 0
    s_bitcmp1_b32 s85, 0
    s_cselect_b32 s79, s79, 0x1ff00000
    s_lshl_b32 s56, s79, 2
    s_lshl_b32 s61, s79, 1

    s_add_u32 s79, s78, 4096
    s_bitcmp1_b32 s85, 1
    s_cselect_b32 s79, s79, 0x1ff00000
    s_lshl_b32 s57, s79, 2
    s_lshl_b32 s62, s79, 1

    s_add_u32 s79, s78, 8192
    s_bitcmp1_b32 s85, 2
    s_cselect_b32 s79, s79, 0x1ff00000
    s_lshl_b32 s58, s79, 2
    s_lshl_b32 s63, s79, 1

    s_add_u32 s79, s78, 12288
    s_bitcmp1_b32 s85, 3
    s_cselect_b32 s79, s79, 0x1ff00000
    s_lshl_b32 s59, s79, 2
    s_lshl_b32 s64, s79, 1

    buffer_load_dwordx4 v[20:23], v1, s[12:15], s56 offen nt
    buffer_load_dwordx4 v[4:7], v1, s[8:11], s56 offen nt
    buffer_load_dwordx2 v[36:37], v2, s[16:19], s61 offen nt
    buffer_load_dwordx4 v[24:27], v1, s[12:15], s57 offen nt
    buffer_load_dwordx4 v[8:11], v1, s[8:11], s57 offen nt
    buffer_load_dwordx2 v[38:39], v2, s[16:19], s62 offen nt
    buffer_load_dwordx4 v[28:31], v1, s[12:15], s58 offen nt
    buffer_load_dwordx4 v[12:15], v1, s[8:11], s58 offen nt
    buffer_load_dwordx2 v[40:41], v2, s[16:19], s63 offen nt
    buffer_load_dwordx4 v[32:35], v1, s[12:15], s59 offen nt
    buffer_load_dwordx4 v[16:19], v1, s[8:11], s59 offen nt
    buffer_load_dwordx2 v[42:43], v2, s[16:19], s64 offen nt
    s_getreg_b32 s5, hwreg(HW_REG_XCC_ID)
    s_and_b32 s5, s5, 7
    s_mul_i32 s3, s5, 8192

    s_add_u32 s20, s6, s3
    s_addc_u32 s21, s7, 0
    s_mov_b32 s22, 8192
    s_mov_b32 s23, 0x20000
    s_mul_i32 s3, s5, 40632320
    s_add_u32 s3, s3, 83599360
    s_add_u32 s24, s6, s3
    s_addc_u32 s25, s7, 0
    s_mov_b32 s26, 40632320
    s_mov_b32 s27, 0x20000
    s_add_u32 s32, s6, 408657920
    s_addc_u32 s33, s7, 0
    s_mov_b32 s34, 409600000
    s_mov_b32 s35, 0x20000
    s_add_u32 s36, s6, 65536
    s_addc_u32 s37, s7, 0
    s_mov_b32 s38, 4
    s_mov_b32 s39, 0x20000
    s_mov_b32 s40, 687195
    s_mov_b32 s42, -6250
    s_mov_b32 s43, 1942
    s_mov_b32 s45, 0x06050400
    s_mov_b32 s46, 0x05040c00
    s_mov_b32 s47, 0x04020100
    s_mov_b32 s48, 3968
    s_mov_b32 s50, 0
    v_mov_b32 v104, 1
    v_mov_b32 v105, 0x46ff8000
    s_mov_b32 s55, 0x05040100
    v_mul_u32_u24 v106, 5, v0
    v_mov_b32 v108, 16384
    v_mov_b32 v114, 0
    v_mov_b32 v115, 0
    v_mov_b32 v116, 0
    v_mov_b32 v117, -1
    ds_write_b64 v2, v[114:115]
    s_movk_i32 s3, 1024
    v_cmp_gt_u32 s[66:67], s3, v0
    s_movk_i32 s3, 1024
    v_cmp_gt_u32 s[68:69], s3, v0
    s_mov_b64 exec, 1
    ds_write_b128 v108, v[114:117]
    s_mov_b64 exec, -1
    s_waitcnt lgkmcnt(0)
    s_lshl_b32 s88, s88, 16
    v_mov_b32 v110, 0.15915494
    v_mul_f32 v110, s88, v110
    s_mov_b32 s3, 0x7fff7fff
    v_readfirstlane_b32 s44, v110

    s_waitcnt vmcnt(12)
    v_mov_b32 v61, 0
    v_mov_b32 v62, 0
    v_mov_b32 v63, 0
    v_dot2_f32_bf16 v61, v44, v44, v61
    v_dot2_f32_bf16 v61, v45, v45, v61
    v_dot2_f32_bf16 v61, v46, v46, v61
    v_dot2_f32_bf16 v61, v47, v47, v61
    v_dot2_f32_bf16 v61, v48, v48, v61
    v_dot2_f32_bf16 v61, v49, v49, v61
    v_dot2_f32_bf16 v61, v50, v50, v61
    v_dot2_f32_bf16 v61, v51, v51, v61
    v_dot2_f32_bf16 v61, v52, v52, v61
    v_dot2_f32_bf16 v62, v56, v56, v62
    v_dot2_f32_bf16 v62, v57, v57, v62
    v_dot2_f32_bf16 v62, v58, v58, v62
    v_dot2_f32_bf16 v62, v59, v59, v62
    v_and_b32 v60, s3, v44
    v_and_b32 v64, s3, v45
    v_pk_max_u16 v60, v60, v64
    v_and_b32 v64, s3, v46
    v_pk_max_u16 v60, v60, v64
    v_and_b32 v64, s3, v47
    v_pk_max_u16 v60, v60, v64
    v_and_b32 v64, s3, v48
    v_pk_max_u16 v60, v60, v64
    v_and_b32 v64, s3, v49
    v_pk_max_u16 v60, v60, v64
    v_and_b32 v64, s3, v50
    v_pk_max_u16 v60, v60, v64
    v_and_b32 v64, s3, v51
    v_pk_max_u16 v60, v60, v64
    v_and_b32 v64, s3, v52
    v_pk_max_u16 v60, v60, v64
    v_lshrrev_b32 v64, 16, v60
    v_and_b32 v60, 0xffff, v60
    v_max_u32 v60, v60, v64

    s_nop 1
    v_max_u32_dpp v60, v60, v60 row_shr:1 row_mask:0xf bank_mask:0xf
    s_nop 1
    v_max_u32_dpp v60, v60, v60 row_shr:2 row_mask:0xf bank_mask:0xf
    s_nop 1
    v_max_u32_dpp v60, v60, v60 row_shr:4 row_mask:0xf bank_mask:0xf
    s_nop 1
    v_max_u32_dpp v60, v60, v60 row_shr:8 row_mask:0xf bank_mask:0xf
    s_nop 1
    v_max_u32_dpp v60, v60, v60 row_bcast:15 row_mask:0xa bank_mask:0xf
    s_nop 1
    v_max_u32_dpp v60, v60, v60 row_bcast:31 row_mask:0xc bank_mask:0xf
    s_nop 1
    v_add_f32_dpp v61, v61, v61 row_shr:1 row_mask:0xf bank_mask:0xf
    s_nop 1
    v_add_f32_dpp v61, v61, v61 row_shr:2 row_mask:0xf bank_mask:0xf
    s_nop 1
    v_add_f32_dpp v61, v61, v61 row_shr:4 row_mask:0xf bank_mask:0xf
    s_nop 1
    v_add_f32_dpp v61, v61, v61 row_shr:8 row_mask:0xf bank_mask:0xf
    s_nop 1
    v_add_f32_dpp v61, v61, v61 row_bcast:15 row_mask:0xa bank_mask:0xf
    s_nop 1
    v_add_f32_dpp v61, v61, v61 row_bcast:31 row_mask:0xc bank_mask:0xf
    s_nop 1
    v_add_f32_dpp v62, v62, v62 row_shr:1 row_mask:0xf bank_mask:0xf
    s_nop 1
    v_add_f32_dpp v62, v62, v62 row_shr:2 row_mask:0xf bank_mask:0xf
    s_nop 1
    v_add_f32_dpp v62, v62, v62 row_shr:4 row_mask:0xf bank_mask:0xf
    s_nop 1
    v_add_f32_dpp v62, v62, v62 row_shr:8 row_mask:0xf bank_mask:0xf
    s_nop 1
    v_add_f32_dpp v62, v62, v62 row_bcast:15 row_mask:0xa bank_mask:0xf
    s_nop 1
    v_add_f32_dpp v62, v62, v62 row_bcast:31 row_mask:0xc bank_mask:0xf
    v_lshrrev_b32 v64, 6, v0
    v_lshlrev_b32 v64, 4, v64
    s_mov_b32 exec_lo, 0
    s_brev_b32 exec_hi, 1
    ds_write_b128 v64, v[60:63] offset:8192
    s_mov_b64 exec, -1
    v_and_b32 v64, 15, v0
    v_lshlrev_b32 v64, 4, v64
    s_waitcnt lgkmcnt(0)
    s_barrier
    ds_read_b128 v[60:63], v64 offset:8192
    s_waitcnt lgkmcnt(0)

    s_nop 0
    v_max_u32_dpp v60, v60, v60 row_ror:1 row_mask:0xf bank_mask:0xf
    v_add_f32_dpp v61, v61, v61 row_ror:1 row_mask:0xf bank_mask:0xf
    v_add_f32_dpp v62, v62, v62 row_ror:1 row_mask:0xf bank_mask:0xf

    s_nop 0
    v_max_u32_dpp v60, v60, v60 row_ror:2 row_mask:0xf bank_mask:0xf
    v_add_f32_dpp v61, v61, v61 row_ror:2 row_mask:0xf bank_mask:0xf
    v_add_f32_dpp v62, v62, v62 row_ror:2 row_mask:0xf bank_mask:0xf

    s_nop 0
    v_max_u32_dpp v60, v60, v60 row_ror:4 row_mask:0xf bank_mask:0xf
    v_add_f32_dpp v61, v61, v61 row_ror:4 row_mask:0xf bank_mask:0xf
    v_add_f32_dpp v62, v62, v62 row_ror:4 row_mask:0xf bank_mask:0xf

    s_nop 0
    v_max_u32_dpp v60, v60, v60 row_ror:8 row_mask:0xf bank_mask:0xf
    v_add_f32_dpp v61, v61, v61 row_ror:8 row_mask:0xf bank_mask:0xf
    v_add_f32_dpp v62, v62, v62 row_ror:8 row_mask:0xf bank_mask:0xf

    v_rsq_f32 v62, v62
    v_mov_b32 v65, 0x4b400000
    v_mul_f32 v62, 0x47decb04, v62
    s_nop 0
    v_readfirstlane_b32 s74, v62

    s_add_u32 s92, s6, 135168
    s_addc_u32 s93, s7, 0
    s_mov_b32 s94, 4096
    s_mov_b32 s95, 0x20000
    s_lshl_b32 s3, s2, 4
    buffer_store_dwordx4 v[60:63], v98, s[92:95], s3 offen
    v_lshlrev_b32 v66, 16, v44
    v_and_b32 v44, 0xffff0000, v44
    v_fma_f32 v66, v66, s74, v65
    v_fma_f32 v44, v44, s74, v65
    v_perm_b32 v44, v44, v66, s55

    v_lshlrev_b32 v66, 16, v45
    v_and_b32 v45, 0xffff0000, v45
    v_fma_f32 v66, v66, s74, v65
    v_fma_f32 v45, v45, s74, v65
    v_perm_b32 v45, v45, v66, s55

    v_lshlrev_b32 v66, 16, v46
    v_and_b32 v46, 0xffff0000, v46
    v_fma_f32 v66, v66, s74, v65
    v_fma_f32 v46, v46, s74, v65
    v_perm_b32 v46, v46, v66, s55

    v_lshlrev_b32 v66, 16, v47
    v_and_b32 v47, 0xffff0000, v47
    v_fma_f32 v66, v66, s74, v65
    v_fma_f32 v47, v47, s74, v65
    v_perm_b32 v47, v47, v66, s55

    v_lshlrev_b32 v66, 16, v48
    v_and_b32 v48, 0xffff0000, v48
    v_fma_f32 v66, v66, s74, v65
    v_fma_f32 v48, v48, s74, v65
    v_perm_b32 v48, v48, v66, s55

    v_lshlrev_b32 v66, 16, v49
    v_and_b32 v49, 0xffff0000, v49
    v_fma_f32 v66, v66, s74, v65
    v_fma_f32 v49, v49, s74, v65
    v_perm_b32 v49, v49, v66, s55

    v_lshlrev_b32 v66, 16, v50
    v_and_b32 v50, 0xffff0000, v50
    v_fma_f32 v66, v66, s74, v65
    v_fma_f32 v50, v50, s74, v65
    v_perm_b32 v50, v50, v66, s55

    v_lshlrev_b32 v66, 16, v51
    v_and_b32 v51, 0xffff0000, v51
    v_fma_f32 v66, v66, s74, v65
    v_fma_f32 v51, v51, s74, v65
    v_perm_b32 v51, v51, v66, s55

    v_lshlrev_b32 v66, 16, v52
    v_and_b32 v52, 0xffff0000, v52
    v_fma_f32 v66, v66, s74, v65
    v_fma_f32 v52, v52, s74, v65
    v_perm_b32 v52, v52, v66, s55

    s_add_u32 s92, s6, s54
    s_addc_u32 s93, s7, 0
    s_mov_b32 s94, 24576
    s_mov_b32 s95, 0x20000
    s_movk_i32 s3, 16384
    buffer_store_dwordx4 v[44:47], v1, s[92:95], 0 offen
    buffer_store_dwordx4 v[48:51], v1, s[92:95], s3 offen
    s_mul_i32 s94, s53, 25424
    s_movk_i32 s3, 24576

    buffer_store_dword v52, v100, s[92:95], s3 offen
    s_nop 1
    s_mov_b32 s82, s85
    s_mov_b32 s83, s86
    s_mov_b32 s84, s87
    v_mov_b32 v99, 1
    buffer_atomic_add v99, v98, s[96:99], 0 offen sc0
    v_mov_b32 v100, 0
    buffer_atomic_add v100, v98, s[96:99], 0 offen offset:128 sc0
    s_waitcnt vmcnt(15)
    s_bitcmp0_b32 s82, 0
    s_cbranch_scc1 L_ska_7
    v_mul_hi_u32_u24 v45, s40, v20
    v_mul_hi_u32_u24 v44, s40, v4
    v_mul_hi_u32_u24 v47, s40, v21
    v_mul_hi_u32_u24 v46, s40, v5
    v_mul_hi_u32_u24 v49, s40, v22
    v_mul_hi_u32_u24 v48, s40, v6
    v_mul_hi_u32_u24 v51, s40, v23
    v_mul_hi_u32_u24 v50, s40, v7
    v_and_b32 v45, -2, v45
    v_mad_u32_u24 v4, v44, s43, v4
    v_and_b32 v76, -4, v44
    v_and_b32 v47, -2, v47
    v_mad_u32_u24 v5, v46, s43, v5
    v_and_b32 v77, -4, v46
    v_and_b32 v49, -2, v49
    v_mad_u32_u24 v6, v48, s43, v6
    v_and_b32 v78, -4, v48
    v_and_b32 v51, -2, v51
    v_mad_u32_u24 v7, v50, s43, v7
    v_and_b32 v79, -4, v50
    v_mad_i32_i24 v20, v45, s42, v20
    v_lshl_add_u32 v45, v76, 5, v45
    v_mad_i32_i24 v21, v47, s42, v21
    v_lshl_add_u32 v47, v77, 5, v47
    v_mad_i32_i24 v22, v49, s42, v22
    v_lshl_add_u32 v49, v78, 5, v49
    v_mad_i32_i24 v23, v51, s42, v23
    v_lshl_add_u32 v51, v79, 5, v51
    v_add_u32 v45, v45, v45
    ds_add_rtn_u32 v76, v45, v104
    v_add_u32 v47, v47, v47
    ds_add_rtn_u32 v77, v47, v104
    v_add_u32 v49, v49, v49
    ds_add_rtn_u32 v78, v49, v104
    v_add_u32 v51, v51, v51
    ds_add_rtn_u32 v79, v51, v104
    v_lshlrev_b32 v110, 16, v36
    v_and_b32 v111, 0xffff0000, v36
    v_lshlrev_b32 v112, 16, v37
    v_and_b32 v113, 0xffff0000, v37
    v_mul_f32 v110, s44, v110
    v_mul_f32 v111, s44, v111
    v_mul_f32 v112, s44, v112
    v_mul_f32 v113, s44, v113
    v_fract_f32 v110, v110
    v_fract_f32 v111, v111
    v_fract_f32 v112, v112
    v_fract_f32 v113, v113
    v_cos_f32 v110, v110
    v_cos_f32 v111, v111
    v_cos_f32 v112, v112
    v_cos_f32 v113, v113
    v_lshl_or_b32 v44, v44, 14, v20
    v_perm_b32 v45, v45, v4, s46
    v_bfe_u32 v4, v4, 8, 5

    v_lshl_or_b32 v46, v46, 14, v21
    v_perm_b32 v47, v47, v5, s46
    v_bfe_u32 v5, v5, 8, 5

    v_lshl_or_b32 v48, v48, 14, v22
    v_perm_b32 v49, v49, v6, s46
    v_bfe_u32 v6, v6, 8, 5

    v_lshl_or_b32 v50, v50, 14, v23
    v_perm_b32 v51, v51, v7, s46
    v_bfe_u32 v7, v7, 8, 5

    v_fmaak_f32 v110, v110, v105, 0x4b400010
    v_fmaak_f32 v111, v111, v105, 0x4b400010
    v_fmaak_f32 v112, v112, v105, 0x4b400010
    v_fmaak_f32 v113, v113, v105, 0x4b400010
    v_sub_u32 v110, v110, v4
    v_sub_u32 v111, v111, v5
    v_sub_u32 v112, v112, v6
    v_sub_u32 v113, v113, v7
    v_bfi_b32 v110, 31, v4, v110
    v_bfi_b32 v111, 31, v5, v111
    v_bfi_b32 v112, 31, v6, v112
    v_bfi_b32 v113, 31, v7, v113
    v_perm_b32 v44, v44, v110, s55
    v_perm_b32 v46, v46, v111, s55
    v_perm_b32 v48, v48, v112, s55
    v_perm_b32 v50, v50, v113, s55
L_ska_7:
    s_waitcnt vmcnt(12)
    s_bitcmp0_b32 s82, 1
    s_cbranch_scc1 L_ska_8
    v_mul_hi_u32_u24 v53, s40, v24
    v_mul_hi_u32_u24 v52, s40, v8
    v_mul_hi_u32_u24 v55, s40, v25
    v_mul_hi_u32_u24 v54, s40, v9
    v_mul_hi_u32_u24 v57, s40, v26
    v_mul_hi_u32_u24 v56, s40, v10
    v_mul_hi_u32_u24 v59, s40, v27
    v_mul_hi_u32_u24 v58, s40, v11
    v_and_b32 v53, -2, v53
    v_mad_u32_u24 v8, v52, s43, v8
    v_and_b32 v80, -4, v52
    v_and_b32 v55, -2, v55
    v_mad_u32_u24 v9, v54, s43, v9
    v_and_b32 v81, -4, v54
    v_and_b32 v57, -2, v57
    v_mad_u32_u24 v10, v56, s43, v10
    v_and_b32 v82, -4, v56
    v_and_b32 v59, -2, v59
    v_mad_u32_u24 v11, v58, s43, v11
    v_and_b32 v83, -4, v58
    v_mad_i32_i24 v24, v53, s42, v24
    v_lshl_add_u32 v53, v80, 5, v53
    v_mad_i32_i24 v25, v55, s42, v25
    v_lshl_add_u32 v55, v81, 5, v55
    v_mad_i32_i24 v26, v57, s42, v26
    v_lshl_add_u32 v57, v82, 5, v57
    v_mad_i32_i24 v27, v59, s42, v27
    v_lshl_add_u32 v59, v83, 5, v59
    v_add_u32 v53, v53, v53
    ds_add_rtn_u32 v80, v53, v104
    v_add_u32 v55, v55, v55
    ds_add_rtn_u32 v81, v55, v104
    v_add_u32 v57, v57, v57
    ds_add_rtn_u32 v82, v57, v104
    v_add_u32 v59, v59, v59
    ds_add_rtn_u32 v83, v59, v104
    v_lshlrev_b32 v110, 16, v38
    v_and_b32 v111, 0xffff0000, v38
    v_lshlrev_b32 v112, 16, v39
    v_and_b32 v113, 0xffff0000, v39
    v_mul_f32 v110, s44, v110
    v_mul_f32 v111, s44, v111
    v_mul_f32 v112, s44, v112
    v_mul_f32 v113, s44, v113
    v_fract_f32 v110, v110
    v_fract_f32 v111, v111
    v_fract_f32 v112, v112
    v_fract_f32 v113, v113
    v_cos_f32 v110, v110
    v_cos_f32 v111, v111
    v_cos_f32 v112, v112
    v_cos_f32 v113, v113
    v_lshl_or_b32 v52, v52, 14, v24
    v_perm_b32 v53, v53, v8, s46
    v_bfe_u32 v8, v8, 8, 5

    v_lshl_or_b32 v54, v54, 14, v25
    v_perm_b32 v55, v55, v9, s46
    v_bfe_u32 v9, v9, 8, 5

    v_lshl_or_b32 v56, v56, 14, v26
    v_perm_b32 v57, v57, v10, s46
    v_bfe_u32 v10, v10, 8, 5

    v_lshl_or_b32 v58, v58, 14, v27
    v_perm_b32 v59, v59, v11, s46
    v_bfe_u32 v11, v11, 8, 5

    v_fmaak_f32 v110, v110, v105, 0x4b400010
    v_fmaak_f32 v111, v111, v105, 0x4b400010
    v_fmaak_f32 v112, v112, v105, 0x4b400010
    v_fmaak_f32 v113, v113, v105, 0x4b400010
    v_sub_u32 v110, v110, v8
    v_sub_u32 v111, v111, v9
    v_sub_u32 v112, v112, v10
    v_sub_u32 v113, v113, v11
    v_bfi_b32 v110, 31, v8, v110
    v_bfi_b32 v111, 31, v9, v111
    v_bfi_b32 v112, 31, v10, v112
    v_bfi_b32 v113, 31, v11, v113
    v_perm_b32 v52, v52, v110, s55
    v_perm_b32 v54, v54, v111, s55
    v_perm_b32 v56, v56, v112, s55
    v_perm_b32 v58, v58, v113, s55
L_ska_8:
    s_waitcnt vmcnt(9)
    s_bitcmp0_b32 s82, 2
    s_cbranch_scc1 L_ska_9
    v_mul_hi_u32_u24 v61, s40, v28
    v_mul_hi_u32_u24 v60, s40, v12
    v_mul_hi_u32_u24 v63, s40, v29
    v_mul_hi_u32_u24 v62, s40, v13
    v_mul_hi_u32_u24 v65, s40, v30
    v_mul_hi_u32_u24 v64, s40, v14
    v_mul_hi_u32_u24 v67, s40, v31
    v_mul_hi_u32_u24 v66, s40, v15
    v_and_b32 v61, -2, v61
    v_mad_u32_u24 v12, v60, s43, v12
    v_and_b32 v84, -4, v60
    v_and_b32 v63, -2, v63
    v_mad_u32_u24 v13, v62, s43, v13
    v_and_b32 v85, -4, v62
    v_and_b32 v65, -2, v65
    v_mad_u32_u24 v14, v64, s43, v14
    v_and_b32 v86, -4, v64
    v_and_b32 v67, -2, v67
    v_mad_u32_u24 v15, v66, s43, v15
    v_and_b32 v87, -4, v66
    v_mad_i32_i24 v28, v61, s42, v28
    v_lshl_add_u32 v61, v84, 5, v61
    v_mad_i32_i24 v29, v63, s42, v29
    v_lshl_add_u32 v63, v85, 5, v63
    v_mad_i32_i24 v30, v65, s42, v30
    v_lshl_add_u32 v65, v86, 5, v65
    v_mad_i32_i24 v31, v67, s42, v31
    v_lshl_add_u32 v67, v87, 5, v67
    v_add_u32 v61, v61, v61
    ds_add_rtn_u32 v84, v61, v104
    v_add_u32 v63, v63, v63
    ds_add_rtn_u32 v85, v63, v104
    v_add_u32 v65, v65, v65
    ds_add_rtn_u32 v86, v65, v104
    v_add_u32 v67, v67, v67
    ds_add_rtn_u32 v87, v67, v104
    v_lshlrev_b32 v110, 16, v40
    v_and_b32 v111, 0xffff0000, v40
    v_lshlrev_b32 v112, 16, v41
    v_and_b32 v113, 0xffff0000, v41
    v_mul_f32 v110, s44, v110
    v_mul_f32 v111, s44, v111
    v_mul_f32 v112, s44, v112
    v_mul_f32 v113, s44, v113
    v_fract_f32 v110, v110
    v_fract_f32 v111, v111
    v_fract_f32 v112, v112
    v_fract_f32 v113, v113
    v_cos_f32 v110, v110
    v_cos_f32 v111, v111
    v_cos_f32 v112, v112
    v_cos_f32 v113, v113
    v_lshl_or_b32 v60, v60, 14, v28
    v_perm_b32 v61, v61, v12, s46
    v_bfe_u32 v12, v12, 8, 5

    v_lshl_or_b32 v62, v62, 14, v29
    v_perm_b32 v63, v63, v13, s46
    v_bfe_u32 v13, v13, 8, 5

    v_lshl_or_b32 v64, v64, 14, v30
    v_perm_b32 v65, v65, v14, s46
    v_bfe_u32 v14, v14, 8, 5

    v_lshl_or_b32 v66, v66, 14, v31
    v_perm_b32 v67, v67, v15, s46
    v_bfe_u32 v15, v15, 8, 5

    v_fmaak_f32 v110, v110, v105, 0x4b400010
    v_fmaak_f32 v111, v111, v105, 0x4b400010
    v_fmaak_f32 v112, v112, v105, 0x4b400010
    v_fmaak_f32 v113, v113, v105, 0x4b400010
    v_sub_u32 v110, v110, v12
    v_sub_u32 v111, v111, v13
    v_sub_u32 v112, v112, v14
    v_sub_u32 v113, v113, v15
    v_bfi_b32 v110, 31, v12, v110
    v_bfi_b32 v111, 31, v13, v111
    v_bfi_b32 v112, 31, v14, v112
    v_bfi_b32 v113, 31, v15, v113
    v_perm_b32 v60, v60, v110, s55
    v_perm_b32 v62, v62, v111, s55
    v_perm_b32 v64, v64, v112, s55
    v_perm_b32 v66, v66, v113, s55
L_ska_9:
    s_waitcnt vmcnt(6)
    s_bitcmp0_b32 s82, 3
    s_cbranch_scc1 L_ska_10
    s_mov_b64 exec, s[66:67]
    v_mul_hi_u32_u24 v69, s40, v32
    v_mul_hi_u32_u24 v68, s40, v16
    v_mul_hi_u32_u24 v71, s40, v33
    v_mul_hi_u32_u24 v70, s40, v17
    v_mul_hi_u32_u24 v73, s40, v34
    v_mul_hi_u32_u24 v72, s40, v18
    v_mul_hi_u32_u24 v75, s40, v35
    v_mul_hi_u32_u24 v74, s40, v19
    v_and_b32 v69, -2, v69
    v_mad_u32_u24 v16, v68, s43, v16
    v_and_b32 v88, -4, v68
    v_and_b32 v71, -2, v71
    v_mad_u32_u24 v17, v70, s43, v17
    v_and_b32 v89, -4, v70
    v_and_b32 v73, -2, v73
    v_mad_u32_u24 v18, v72, s43, v18
    v_and_b32 v90, -4, v72
    v_and_b32 v75, -2, v75
    v_mad_u32_u24 v19, v74, s43, v19
    v_and_b32 v91, -4, v74
    v_mad_i32_i24 v32, v69, s42, v32
    v_lshl_add_u32 v69, v88, 5, v69
    v_mad_i32_i24 v33, v71, s42, v33
    v_lshl_add_u32 v71, v89, 5, v71
    v_mad_i32_i24 v34, v73, s42, v34
    v_lshl_add_u32 v73, v90, 5, v73
    v_mad_i32_i24 v35, v75, s42, v35
    v_lshl_add_u32 v75, v91, 5, v75
    v_add_u32 v69, v69, v69
    ds_add_rtn_u32 v88, v69, v104
    v_add_u32 v71, v71, v71
    ds_add_rtn_u32 v89, v71, v104
    v_add_u32 v73, v73, v73
    ds_add_rtn_u32 v90, v73, v104
    v_add_u32 v75, v75, v75
    ds_add_rtn_u32 v91, v75, v104
    v_lshlrev_b32 v110, 16, v42
    v_and_b32 v111, 0xffff0000, v42
    v_lshlrev_b32 v112, 16, v43
    v_and_b32 v113, 0xffff0000, v43
    v_mul_f32 v110, s44, v110
    v_mul_f32 v111, s44, v111
    v_mul_f32 v112, s44, v112
    v_mul_f32 v113, s44, v113
    v_fract_f32 v110, v110
    v_fract_f32 v111, v111
    v_fract_f32 v112, v112
    v_fract_f32 v113, v113
    v_cos_f32 v110, v110
    v_cos_f32 v111, v111
    v_cos_f32 v112, v112
    v_cos_f32 v113, v113
    v_lshl_or_b32 v68, v68, 14, v32
    v_perm_b32 v69, v69, v16, s46
    v_bfe_u32 v16, v16, 8, 5

    v_lshl_or_b32 v70, v70, 14, v33
    v_perm_b32 v71, v71, v17, s46
    v_bfe_u32 v17, v17, 8, 5

    v_lshl_or_b32 v72, v72, 14, v34
    v_perm_b32 v73, v73, v18, s46
    v_bfe_u32 v18, v18, 8, 5

    v_lshl_or_b32 v74, v74, 14, v35
    v_perm_b32 v75, v75, v19, s46
    v_bfe_u32 v19, v19, 8, 5

    v_fmaak_f32 v110, v110, v105, 0x4b400010
    v_fmaak_f32 v111, v111, v105, 0x4b400010
    v_fmaak_f32 v112, v112, v105, 0x4b400010
    v_fmaak_f32 v113, v113, v105, 0x4b400010
    v_sub_u32 v110, v110, v16
    v_sub_u32 v111, v111, v17
    v_sub_u32 v112, v112, v18
    v_sub_u32 v113, v113, v19
    v_bfi_b32 v110, 31, v16, v110
    v_bfi_b32 v111, 31, v17, v111
    v_bfi_b32 v112, 31, v18, v112
    v_bfi_b32 v113, 31, v19, v113
    v_perm_b32 v68, v68, v110, s55
    v_perm_b32 v70, v70, v111, s55
    v_perm_b32 v72, v72, v112, s55
    v_perm_b32 v74, v74, v113, s55
    s_mov_b64 exec, -1
L_ska_10:
    s_waitcnt vmcnt(0)
    v_or_b32 v100, v100, v0
    s_nop 0
    v_readfirstlane_b32 s74, v100
    s_nop 1
    s_cmp_lg_u32 s74, 0
    s_cbranch_scc1 L_ready_12

    v_mov_b32 v110, 1
    buffer_atomic_add v110, v98, s[96:99], 0 offen offset:64 sc0
    s_waitcnt vmcnt(0)
    v_readfirstlane_b32 s74, v110
    s_nop 1
    s_cmp_lg_u32 s74, 0
    s_cbranch_scc1 L_zno_14

    s_mov_b32 s92, s6
    s_mov_b32 s93, s7
    s_mov_b32 s94, 65552
    s_mov_b32 s95, 0x20000
    v_mov_b32 v110, 0
    v_mov_b32 v111, 0
    v_mov_b32 v112, 0
    v_mov_b32 v113, 0
L_zl_13:
    buffer_store_dwordx4 v[110:113], v1, s[92:95], s74 offen sc0 sc1
    s_add_u32 s74, s74, 1024
    s_cmp_le_u32 s74, 65536
    s_cbranch_scc1 L_zl_13
    v_mov_b32 v114, 1
    s_waitcnt vmcnt(0)
    buffer_atomic_add v114, v98, s[96:99], 0 offen offset:128
L_zno_14:

L_spin_11:
    v_mov_b32 v100, 0
    buffer_atomic_add v100, v98, s[96:99], 0 offen offset:128 sc0
    s_waitcnt vmcnt(0)
    v_readfirstlane_b32 s74, v100
    s_nop 1
    s_cmp_eq_u32 s74, 0
    s_cbranch_scc1 L_spin_11
L_ready_12:

    v_cmp_eq_u32 vcc, 0, v0
    s_waitcnt vmcnt(1)
    s_mov_b64 exec, vcc
    ds_write_b32 v108, v99 offset:8
    s_mov_b64 exec, -1
    s_waitcnt lgkmcnt(0)
    s_barrier

    ds_read2_b32 v[110:111], v108 offset0:1 offset1:2
    ds_read_b64 v[94:95], v2
    s_waitcnt lgkmcnt(0)
    v_readfirstlane_b32 s53, v110
    v_readfirstlane_b32 s41, v111

    v_and_b32 v94, 0xffff, v94
    v_and_b32 v95, 0xffff, v95
    v_add_u32 v97, v94, v95
    s_nop 1
    v_add_u32_dpp v97, v97, v97 row_shr:1 row_mask:0xf bank_mask:0xf
    s_nop 1
    v_add_u32_dpp v97, v97, v97 row_shr:2 row_mask:0xf bank_mask:0xf
    s_nop 1
    v_add_u32_dpp v97, v97, v97 row_shr:4 row_mask:0xf bank_mask:0xf
    s_nop 1
    v_add_u32_dpp v97, v97, v97 row_shr:8 row_mask:0xf bank_mask:0xf
    s_nop 1
    v_add_u32_dpp v97, v97, v97 row_bcast:15 row_mask:0xa bank_mask:0xf
    s_nop 1
    v_add_u32_dpp v97, v97, v97 row_bcast:31 row_mask:0xc bank_mask:0xf
    s_mov_b32 exec_lo, 0
    s_brev_b32 exec_hi, 1
    ds_add_rtn_u32 v96, v108, v97
    s_mov_b64 exec, -1

    v_add_u32 v92, v94, v94
    v_add_u32 v93, v95, v95
    v_med3_u32 v92, v94, 2, v92
    v_med3_u32 v93, v95, 2, v93
    buffer_atomic_add_x2 v[92:93], v2, s[20:23], 0 offen sc0
    s_add_u32 s41, s41, 160
    s_sub_u32 s78, s41, 2997
    s_lshr_b32 s79, s78, 1
    s_add_u32 s79, s79, 2997
    s_and_b32 s86, s78, 1
    s_lshl_b32 s86, s86, 1
    s_add_u32 s87, s86, 2
    s_cmp_lt_u32 s41, 2997
    s_cselect_b32 s41, s41, s79
    s_cmovk_i32 s86, 0
    s_cmovk_i32 s87, 4

    s_mul_i32 s78, s41, 16384
    s_add_u32 s49, s78, 16384
    s_cmp_ge_u32 s41, 3125
    s_cmovk_i32 s49, 0
    s_cmovk_i32 s78, 0
    s_lshl_b32 s10, s49, 2
    s_lshl_b32 s14, s49, 2
    s_lshl_b32 s18, s49, 1
    s_sub_u32 s79, s87, s86
    s_bfm_b32 s85, s79, s86
    s_lshl_b32 s86, s86, 12
    s_lshl_b32 s87, s87, 12
    s_min_u32 s87, s87, 16384

    s_add_u32 s79, s78, 0
    s_bitcmp1_b32 s85, 0
    s_cselect_b32 s79, s79, 0x1ff00000
    s_lshl_b32 s56, s79, 2
    s_lshl_b32 s61, s79, 1

    s_add_u32 s79, s78, 4096
    s_bitcmp1_b32 s85, 1
    s_cselect_b32 s79, s79, 0x1ff00000
    s_lshl_b32 s57, s79, 2
    s_lshl_b32 s62, s79, 1

    s_add_u32 s79, s78, 8192
    s_bitcmp1_b32 s85, 2
    s_cselect_b32 s79, s79, 0x1ff00000
    s_lshl_b32 s58, s79, 2
    s_lshl_b32 s63, s79, 1

    s_add_u32 s79, s78, 12288
    s_bitcmp1_b32 s85, 3
    s_cselect_b32 s79, s79, 0x1ff00000
    s_lshl_b32 s59, s79, 2
    s_lshl_b32 s64, s79, 1

    s_waitcnt lgkmcnt(0)
    v_readlane_b32 s77, v96, 63
    v_mul_u32_u24 v114, 7936, v0
    v_sub_u32 v97, v97, v95
    s_sub_u32 s50, s50, s83
    s_sub_u32 s77, s77, s50
    v_add_u32 v97, s77, v97
    v_sub_u32 v96, v97, v94
    v_lshlrev_b32 v111, 16, v97
    v_lshlrev_b32 v110, 16, v96
    ds_write_b64 v2, v[110:111]
    v_sub_u32 v96, v114, v96
    v_sub_u32 v97, v114, v97
    v_add_u32 v97, s48, v97
    s_add_u32 s50, s50, s84
    s_mov_b32 s28, s82
    s_mov_b32 s29, s83
    s_mov_b32 s30, s84
    s_lshl_b32 s74, s29, 3
    s_lshl_b32 s75, s30, 3
    v_mov_b32 v125, s74
    v_mov_b32 v126, s75
    v_mov_b32 v127, -1

    s_waitcnt lgkmcnt(0)
    s_barrier

    s_mov_b64 exec, 1
    ds_write_b32 v125, v127 offset:16396
    ds_write_b32 v126, v127 offset:16404
    s_mov_b64 exec, -1

    buffer_load_dwordx4 v[20:23], v1, s[12:15], s56 offen nt
    buffer_load_dwordx4 v[4:7], v1, s[8:11], s56 offen nt
    buffer_load_dwordx2 v[36:37], v2, s[16:19], s61 offen nt
    s_bitcmp0_b32 s28, 0
    s_cbranch_scc1 L_skz_15
    v_lshrrev_b32 v110, 16, v45
    ds_read_b32 v110, v110
    v_lshrrev_b32 v111, 16, v47
    ds_read_b32 v111, v111
    v_lshrrev_b32 v112, 16, v49
    ds_read_b32 v112, v112
    v_lshrrev_b32 v113, 16, v51
    ds_read_b32 v113, v113
    s_waitcnt lgkmcnt(3)
    v_add_u32_sdwa v110, v110, v76 dst_sel:DWORD dst_unused:UNUSED_PAD src0_sel:WORD_1 src1_sel:WORD_0
    v_lshlrev_b32 v110, 3, v110
    ds_write_b64 v110, v[44:45] offset:16400

    s_waitcnt lgkmcnt(3)
    v_add_u32_sdwa v111, v111, v77 dst_sel:DWORD dst_unused:UNUSED_PAD src0_sel:WORD_1 src1_sel:WORD_0
    v_lshlrev_b32 v111, 3, v111
    ds_write_b64 v111, v[46:47] offset:16400

    s_waitcnt lgkmcnt(3)
    v_add_u32_sdwa v112, v112, v78 dst_sel:DWORD dst_unused:UNUSED_PAD src0_sel:WORD_1 src1_sel:WORD_0
    v_lshlrev_b32 v112, 3, v112
    ds_write_b64 v112, v[48:49] offset:16400

    s_waitcnt lgkmcnt(3)
    v_add_u32_sdwa v113, v113, v79 dst_sel:DWORD dst_unused:UNUSED_PAD src0_sel:WORD_1 src1_sel:WORD_0
    v_lshlrev_b32 v113, 3, v113
    ds_write_b64 v113, v[50:51] offset:16400

L_skz_15:
    s_bitcmp0_b32 s28, 1
    s_cbranch_scc1 L_skz_16
    v_lshrrev_b32 v110, 16, v53
    ds_read_b32 v110, v110
    v_lshrrev_b32 v111, 16, v55
    ds_read_b32 v111, v111
    v_lshrrev_b32 v112, 16, v57
    ds_read_b32 v112, v112
    v_lshrrev_b32 v113, 16, v59
    ds_read_b32 v113, v113
    s_waitcnt lgkmcnt(3)
    v_add_u32_sdwa v110, v110, v80 dst_sel:DWORD dst_unused:UNUSED_PAD src0_sel:WORD_1 src1_sel:WORD_0
    v_lshlrev_b32 v110, 3, v110
    ds_write_b64 v110, v[52:53] offset:16400

    s_waitcnt lgkmcnt(3)
    v_add_u32_sdwa v111, v111, v81 dst_sel:DWORD dst_unused:UNUSED_PAD src0_sel:WORD_1 src1_sel:WORD_0
    v_lshlrev_b32 v111, 3, v111
    ds_write_b64 v111, v[54:55] offset:16400

    s_waitcnt lgkmcnt(3)
    v_add_u32_sdwa v112, v112, v82 dst_sel:DWORD dst_unused:UNUSED_PAD src0_sel:WORD_1 src1_sel:WORD_0
    v_lshlrev_b32 v112, 3, v112
    ds_write_b64 v112, v[56:57] offset:16400

    s_waitcnt lgkmcnt(3)
    v_add_u32_sdwa v113, v113, v83 dst_sel:DWORD dst_unused:UNUSED_PAD src0_sel:WORD_1 src1_sel:WORD_0
    v_lshlrev_b32 v113, 3, v113
    ds_write_b64 v113, v[58:59] offset:16400

L_skz_16:
    buffer_load_dwordx4 v[24:27], v1, s[12:15], s57 offen nt
    buffer_load_dwordx4 v[8:11], v1, s[8:11], s57 offen nt
    buffer_load_dwordx2 v[38:39], v2, s[16:19], s62 offen nt
    s_bitcmp0_b32 s28, 2
    s_cbranch_scc1 L_skz_17
    v_lshrrev_b32 v110, 16, v61
    ds_read_b32 v110, v110
    v_lshrrev_b32 v111, 16, v63
    ds_read_b32 v111, v111
    v_lshrrev_b32 v112, 16, v65
    ds_read_b32 v112, v112
    v_lshrrev_b32 v113, 16, v67
    ds_read_b32 v113, v113
    s_waitcnt lgkmcnt(3)
    v_add_u32_sdwa v110, v110, v84 dst_sel:DWORD dst_unused:UNUSED_PAD src0_sel:WORD_1 src1_sel:WORD_0
    v_lshlrev_b32 v110, 3, v110
    ds_write_b64 v110, v[60:61] offset:16400

    s_waitcnt lgkmcnt(3)
    v_add_u32_sdwa v111, v111, v85 dst_sel:DWORD dst_unused:UNUSED_PAD src0_sel:WORD_1 src1_sel:WORD_0
    v_lshlrev_b32 v111, 3, v111
    ds_write_b64 v111, v[62:63] offset:16400

    s_waitcnt lgkmcnt(3)
    v_add_u32_sdwa v112, v112, v86 dst_sel:DWORD dst_unused:UNUSED_PAD src0_sel:WORD_1 src1_sel:WORD_0
    v_lshlrev_b32 v112, 3, v112
    ds_write_b64 v112, v[64:65] offset:16400

    s_waitcnt lgkmcnt(3)
    v_add_u32_sdwa v113, v113, v87 dst_sel:DWORD dst_unused:UNUSED_PAD src0_sel:WORD_1 src1_sel:WORD_0
    v_lshlrev_b32 v113, 3, v113
    ds_write_b64 v113, v[66:67] offset:16400

L_skz_17:
    s_bitcmp0_b32 s28, 3
    s_cbranch_scc1 L_skz_18
    s_mov_b64 exec, s[66:67]
    v_lshrrev_b32 v110, 16, v69
    ds_read_b32 v110, v110
    v_lshrrev_b32 v111, 16, v71
    ds_read_b32 v111, v111
    v_lshrrev_b32 v112, 16, v73
    ds_read_b32 v112, v112
    v_lshrrev_b32 v113, 16, v75
    ds_read_b32 v113, v113
    s_waitcnt lgkmcnt(3)
    v_add_u32_sdwa v110, v110, v88 dst_sel:DWORD dst_unused:UNUSED_PAD src0_sel:WORD_1 src1_sel:WORD_0
    v_lshlrev_b32 v110, 3, v110
    ds_write_b64 v110, v[68:69] offset:16400

    s_waitcnt lgkmcnt(3)
    v_add_u32_sdwa v111, v111, v89 dst_sel:DWORD dst_unused:UNUSED_PAD src0_sel:WORD_1 src1_sel:WORD_0
    v_lshlrev_b32 v111, 3, v111
    ds_write_b64 v111, v[70:71] offset:16400

    s_waitcnt lgkmcnt(3)
    v_add_u32_sdwa v112, v112, v90 dst_sel:DWORD dst_unused:UNUSED_PAD src0_sel:WORD_1 src1_sel:WORD_0
    v_lshlrev_b32 v112, 3, v112
    ds_write_b64 v112, v[72:73] offset:16400

    s_waitcnt lgkmcnt(3)
    v_add_u32_sdwa v113, v113, v91 dst_sel:DWORD dst_unused:UNUSED_PAD src0_sel:WORD_1 src1_sel:WORD_0
    v_lshlrev_b32 v113, 3, v113
    ds_write_b64 v113, v[74:75] offset:16400

    s_mov_b64 exec, -1
L_skz_18:
    buffer_load_dwordx4 v[28:31], v1, s[12:15], s58 offen nt
    buffer_load_dwordx4 v[12:15], v1, s[8:11], s58 offen nt
    buffer_load_dwordx2 v[40:41], v2, s[16:19], s63 offen nt
    buffer_load_dwordx4 v[32:35], v1, s[12:15], s59 offen nt
    buffer_load_dwordx4 v[16:19], v1, s[8:11], s59 offen nt
    buffer_load_dwordx2 v[42:43], v2, s[16:19], s64 offen nt
    s_cmp_eq_u32 s49, 0
    s_cbranch_scc1 L_p1epi_6
L_p1loop_5:
    s_mov_b32 s82, s85
    s_mov_b32 s83, s86
    s_mov_b32 s84, s87
    v_mov_b32 v99, 1
    buffer_atomic_add v99, v98, s[96:99], 0 offen sc0
    s_waitcnt vmcnt(10)
    s_bitcmp0_b32 s82, 0
    s_cbranch_scc1 L_ska_19
    v_mul_hi_u32_u24 v45, s40, v20
    v_mul_hi_u32_u24 v44, s40, v4
    v_mul_hi_u32_u24 v47, s40, v21
    v_mul_hi_u32_u24 v46, s40, v5
    v_mul_hi_u32_u24 v49, s40, v22
    v_mul_hi_u32_u24 v48, s40, v6
    v_mul_hi_u32_u24 v51, s40, v23
    v_mul_hi_u32_u24 v50, s40, v7
    v_and_b32 v45, -2, v45
    v_mad_u32_u24 v4, v44, s43, v4
    v_and_b32 v76, -4, v44
    v_and_b32 v47, -2, v47
    v_mad_u32_u24 v5, v46, s43, v5
    v_and_b32 v77, -4, v46
    v_and_b32 v49, -2, v49
    v_mad_u32_u24 v6, v48, s43, v6
    v_and_b32 v78, -4, v48
    v_and_b32 v51, -2, v51
    v_mad_u32_u24 v7, v50, s43, v7
    v_and_b32 v79, -4, v50
    v_mad_i32_i24 v20, v45, s42, v20
    v_lshl_add_u32 v45, v76, 5, v45
    v_mad_i32_i24 v21, v47, s42, v21
    v_lshl_add_u32 v47, v77, 5, v47
    v_mad_i32_i24 v22, v49, s42, v22
    v_lshl_add_u32 v49, v78, 5, v49
    v_mad_i32_i24 v23, v51, s42, v23
    v_lshl_add_u32 v51, v79, 5, v51
    v_add_u32 v45, v45, v45
    ds_add_rtn_u32 v76, v45, v104
    v_add_u32 v47, v47, v47
    ds_add_rtn_u32 v77, v47, v104
    v_add_u32 v49, v49, v49
    ds_add_rtn_u32 v78, v49, v104
    v_add_u32 v51, v51, v51
    ds_add_rtn_u32 v79, v51, v104
    v_lshlrev_b32 v110, 16, v36
    v_and_b32 v111, 0xffff0000, v36
    v_lshlrev_b32 v112, 16, v37
    v_and_b32 v113, 0xffff0000, v37
    v_mul_f32 v110, s44, v110
    v_mul_f32 v111, s44, v111
    v_mul_f32 v112, s44, v112
    v_mul_f32 v113, s44, v113
    v_fract_f32 v110, v110
    v_fract_f32 v111, v111
    v_fract_f32 v112, v112
    v_fract_f32 v113, v113
    v_cos_f32 v110, v110
    v_cos_f32 v111, v111
    v_cos_f32 v112, v112
    v_cos_f32 v113, v113
    v_lshl_or_b32 v44, v44, 14, v20
    v_perm_b32 v45, v45, v4, s46
    v_bfe_u32 v4, v4, 8, 5

    v_lshl_or_b32 v46, v46, 14, v21
    v_perm_b32 v47, v47, v5, s46
    v_bfe_u32 v5, v5, 8, 5

    v_lshl_or_b32 v48, v48, 14, v22
    v_perm_b32 v49, v49, v6, s46
    v_bfe_u32 v6, v6, 8, 5

    v_lshl_or_b32 v50, v50, 14, v23
    v_perm_b32 v51, v51, v7, s46
    v_bfe_u32 v7, v7, 8, 5

    v_fmaak_f32 v110, v110, v105, 0x4b400010
    v_fmaak_f32 v111, v111, v105, 0x4b400010
    v_fmaak_f32 v112, v112, v105, 0x4b400010
    v_fmaak_f32 v113, v113, v105, 0x4b400010
    v_sub_u32 v110, v110, v4
    v_sub_u32 v111, v111, v5
    v_sub_u32 v112, v112, v6
    v_sub_u32 v113, v113, v7
    v_bfi_b32 v110, 31, v4, v110
    v_bfi_b32 v111, 31, v5, v111
    v_bfi_b32 v112, 31, v6, v112
    v_bfi_b32 v113, 31, v7, v113
    v_perm_b32 v44, v44, v110, s55
    v_perm_b32 v46, v46, v111, s55
    v_perm_b32 v48, v48, v112, s55
    v_perm_b32 v50, v50, v113, s55
L_ska_19:
    s_waitcnt vmcnt(7)
    s_bitcmp0_b32 s82, 1
    s_cbranch_scc1 L_ska_20
    v_mul_hi_u32_u24 v53, s40, v24
    v_mul_hi_u32_u24 v52, s40, v8
    v_mul_hi_u32_u24 v55, s40, v25
    v_mul_hi_u32_u24 v54, s40, v9
    v_mul_hi_u32_u24 v57, s40, v26
    v_mul_hi_u32_u24 v56, s40, v10
    v_mul_hi_u32_u24 v59, s40, v27
    v_mul_hi_u32_u24 v58, s40, v11
    v_and_b32 v53, -2, v53
    v_mad_u32_u24 v8, v52, s43, v8
    v_and_b32 v80, -4, v52
    v_and_b32 v55, -2, v55
    v_mad_u32_u24 v9, v54, s43, v9
    v_and_b32 v81, -4, v54
    v_and_b32 v57, -2, v57
    v_mad_u32_u24 v10, v56, s43, v10
    v_and_b32 v82, -4, v56
    v_and_b32 v59, -2, v59
    v_mad_u32_u24 v11, v58, s43, v11
    v_and_b32 v83, -4, v58
    v_mad_i32_i24 v24, v53, s42, v24
    v_lshl_add_u32 v53, v80, 5, v53
    v_mad_i32_i24 v25, v55, s42, v25
    v_lshl_add_u32 v55, v81, 5, v55
    v_mad_i32_i24 v26, v57, s42, v26
    v_lshl_add_u32 v57, v82, 5, v57
    v_mad_i32_i24 v27, v59, s42, v27
    v_lshl_add_u32 v59, v83, 5, v59
    v_add_u32 v53, v53, v53
    ds_add_rtn_u32 v80, v53, v104
    v_add_u32 v55, v55, v55
    ds_add_rtn_u32 v81, v55, v104
    v_add_u32 v57, v57, v57
    ds_add_rtn_u32 v82, v57, v104
    v_add_u32 v59, v59, v59
    ds_add_rtn_u32 v83, v59, v104
    v_lshlrev_b32 v110, 16, v38
    v_and_b32 v111, 0xffff0000, v38
    v_lshlrev_b32 v112, 16, v39
    v_and_b32 v113, 0xffff0000, v39
    v_mul_f32 v110, s44, v110
    v_mul_f32 v111, s44, v111
    v_mul_f32 v112, s44, v112
    v_mul_f32 v113, s44, v113
    v_fract_f32 v110, v110
    v_fract_f32 v111, v111
    v_fract_f32 v112, v112
    v_fract_f32 v113, v113
    v_cos_f32 v110, v110
    v_cos_f32 v111, v111
    v_cos_f32 v112, v112
    v_cos_f32 v113, v113
    v_lshl_or_b32 v52, v52, 14, v24
    v_perm_b32 v53, v53, v8, s46
    v_bfe_u32 v8, v8, 8, 5

    v_lshl_or_b32 v54, v54, 14, v25
    v_perm_b32 v55, v55, v9, s46
    v_bfe_u32 v9, v9, 8, 5

    v_lshl_or_b32 v56, v56, 14, v26
    v_perm_b32 v57, v57, v10, s46
    v_bfe_u32 v10, v10, 8, 5

    v_lshl_or_b32 v58, v58, 14, v27
    v_perm_b32 v59, v59, v11, s46
    v_bfe_u32 v11, v11, 8, 5

    v_fmaak_f32 v110, v110, v105, 0x4b400010
    v_fmaak_f32 v111, v111, v105, 0x4b400010
    v_fmaak_f32 v112, v112, v105, 0x4b400010
    v_fmaak_f32 v113, v113, v105, 0x4b400010
    v_sub_u32 v110, v110, v8
    v_sub_u32 v111, v111, v9
    v_sub_u32 v112, v112, v10
    v_sub_u32 v113, v113, v11
    v_bfi_b32 v110, 31, v8, v110
    v_bfi_b32 v111, 31, v9, v111
    v_bfi_b32 v112, 31, v10, v112
    v_bfi_b32 v113, 31, v11, v113
    v_perm_b32 v52, v52, v110, s55
    v_perm_b32 v54, v54, v111, s55
    v_perm_b32 v56, v56, v112, s55
    v_perm_b32 v58, v58, v113, s55
L_ska_20:
    s_waitcnt vmcnt(1)
    s_waitcnt vmcnt(0)
    v_cmp_eq_u32 vcc, 0, v0
    s_mov_b64 exec, vcc
    ds_write_b32 v108, v99 offset:8
    s_mov_b64 exec, -1
    s_waitcnt vmcnt(10)
    v_add_u32 v110, v92, v94
    v_min_u32 v92, s48, v92
    v_add_u32 v111, v93, v95
    v_min_u32 v93, s48, v93
    v_max_u32 v110, v110, v111
    v_add_u32 v92, v92, v96
    v_add_u32 v93, v93, v97
    v_cmp_le_u32 vcc, s48, v110
    v_lshl_add_u32 v92, v92, 2, v92
    v_lshl_add_u32 v93, v93, 2, v93
    ds_write_b64 v2, v[92:93] offset:8192
    s_cbranch_vccz L_noov_21
    ds_write_b32 v108, v104 offset:4
L_noov_21:

    s_waitcnt lgkmcnt(0)
    s_barrier
    ds_read2_b32 v[110:111], v108 offset0:1 offset1:2
    s_waitcnt lgkmcnt(0)
    v_readfirstlane_b32 s53, v110
    v_readfirstlane_b32 s41, v111
    s_nop 1

    s_add_u32 s41, s41, 160
    s_sub_u32 s78, s41, 2997
    s_lshr_b32 s79, s78, 1
    s_add_u32 s79, s79, 2997
    s_and_b32 s86, s78, 1
    s_lshl_b32 s86, s86, 1
    s_add_u32 s87, s86, 2
    s_cmp_lt_u32 s41, 2997
    s_cselect_b32 s41, s41, s79
    s_cmovk_i32 s86, 0
    s_cmovk_i32 s87, 4

    s_mul_i32 s78, s41, 16384
    s_add_u32 s49, s78, 16384
    s_cmp_ge_u32 s41, 3125
    s_cmovk_i32 s49, 0
    s_cmovk_i32 s78, 0
    s_lshl_b32 s10, s49, 2
    s_lshl_b32 s14, s49, 2
    s_lshl_b32 s18, s49, 1
    s_sub_u32 s79, s87, s86
    s_bfm_b32 s85, s79, s86
    s_lshl_b32 s86, s86, 12
    s_lshl_b32 s87, s87, 12
    s_min_u32 s87, s87, 16384

    s_add_u32 s79, s78, 0
    s_bitcmp1_b32 s85, 0
    s_cselect_b32 s79, s79, 0x1ff00000
    s_lshl_b32 s56, s79, 2
    s_lshl_b32 s61, s79, 1

    s_add_u32 s79, s78, 4096
    s_bitcmp1_b32 s85, 1
    s_cselect_b32 s79, s79, 0x1ff00000
    s_lshl_b32 s57, s79, 2
    s_lshl_b32 s62, s79, 1

    s_add_u32 s79, s78, 8192
    s_bitcmp1_b32 s85, 2
    s_cselect_b32 s79, s79, 0x1ff00000
    s_lshl_b32 s58, s79, 2
    s_lshl_b32 s63, s79, 1

    s_add_u32 s79, s78, 12288
    s_bitcmp1_b32 s85, 3
    s_cselect_b32 s79, s79, 0x1ff00000
    s_lshl_b32 s59, s79, 2
    s_lshl_b32 s64, s79, 1

    s_cmp_lg_u32 s53, 0
    s_cbranch_scc1 L_slow_22
L_sback_23:
    s_bitcmp0_b32 s28, 0
    s_cbranch_scc1 L_skw_27
    ds_read_b64 v[110:111], v2 offset:16400
    ds_read_b64 v[112:113], v2 offset:16408
    ds_read_b64 v[114:115], v2 offset:16392

    ds_read_b64 v[118:119], v2 offset:24592
    ds_read_b64 v[120:121], v2 offset:24600
    ds_read_b64 v[122:123], v2 offset:24584

    s_waitcnt lgkmcnt(3)
    v_lshrrev_b32 v116, 16, v111
    ds_read_b32 v116, v116 offset:8192

    s_waitcnt lgkmcnt(1)
    v_lshrrev_b32 v124, 16, v119
    ds_read_b32 v124, v124 offset:8192

    v_cmp_ne_u32_sdwa s[80:81], v111, v113 src0_sel:WORD_1 src1_sel:WORD_1
    v_cmp_ne_u32_sdwa vcc, v111, v115 src0_sel:WORD_1 src1_sel:WORD_1
    v_alignbyte_b32 v114, v115, v114, 2
    s_mov_b32 s54, -3
    v_alignbyte_b32 v111, v111, v110, 1
    v_perm_b32 v110, v110, v114, s47
    s_waitcnt lgkmcnt(1)
    v_add3_u32 v116, v116, v106, s54
    v_sub_u32 v117, 0, v116
    v_and_b32 v117, 3, v117
    s_mov_b64 exec, s[80:81]
    v_mov_b32 v117, 0
    v_mov_b32 v112, 0
    s_mov_b64 exec, vcc
    v_mov_b32 v117, 3

    s_mov_b64 exec, -1
    v_alignbyte_b32 v110, v111, v110, v117
    v_alignbyte_b32 v111, v112, v111, v117
    v_add_u32 v116, v116, v117

    buffer_store_dwordx2 v[110:111], v116, s[24:27], 0 offen
    v_cmp_ne_u32_sdwa s[80:81], v119, v121 src0_sel:WORD_1 src1_sel:WORD_1
    v_cmp_ne_u32_sdwa vcc, v119, v123 src0_sel:WORD_1 src1_sel:WORD_1
    v_alignbyte_b32 v122, v123, v122, 2
    s_mov_b32 s54, 5117
    v_alignbyte_b32 v119, v119, v118, 1
    v_perm_b32 v118, v118, v122, s47
    s_waitcnt lgkmcnt(0)
    v_add3_u32 v124, v124, v106, s54
    v_sub_u32 v125, 0, v124
    v_and_b32 v125, 3, v125
    s_mov_b64 exec, s[80:81]
    v_mov_b32 v125, 0
    v_mov_b32 v120, 0
    s_mov_b64 exec, vcc
    v_mov_b32 v125, 3

    s_mov_b64 exec, -1
    v_alignbyte_b32 v118, v119, v118, v125
    v_alignbyte_b32 v119, v120, v119, v125
    v_add_u32 v124, v124, v125

    buffer_store_dwordx2 v[118:119], v124, s[24:27], 0 offen
L_skw_27:
    s_bitcmp0_b32 s28, 0
    s_cbranch_scc1 L_skw_28
    ds_read_b64 v[110:111], v2 offset:32784
    ds_read_b64 v[112:113], v2 offset:32792
    ds_read_b64 v[114:115], v2 offset:32776

    ds_read_b64 v[118:119], v2 offset:40976
    ds_read_b64 v[120:121], v2 offset:40984
    ds_read_b64 v[122:123], v2 offset:40968

    s_waitcnt lgkmcnt(3)
    v_lshrrev_b32 v116, 16, v111
    ds_read_b32 v116, v116 offset:8192

    s_waitcnt lgkmcnt(1)
    v_lshrrev_b32 v124, 16, v119
    ds_read_b32 v124, v124 offset:8192

    v_cmp_ne_u32_sdwa s[80:81], v111, v113 src0_sel:WORD_1 src1_sel:WORD_1
    v_cmp_ne_u32_sdwa vcc, v111, v115 src0_sel:WORD_1 src1_sel:WORD_1
    v_alignbyte_b32 v114, v115, v114, 2
    s_mov_b32 s54, 10237
    v_alignbyte_b32 v111, v111, v110, 1
    v_perm_b32 v110, v110, v114, s47
    s_waitcnt lgkmcnt(1)
    v_add3_u32 v116, v116, v106, s54
    v_sub_u32 v117, 0, v116
    v_and_b32 v117, 3, v117
    s_mov_b64 exec, s[80:81]
    v_mov_b32 v117, 0
    v_mov_b32 v112, 0
    s_mov_b64 exec, vcc
    v_mov_b32 v117, 3

    s_mov_b64 exec, -1
    v_alignbyte_b32 v110, v111, v110, v117
    v_alignbyte_b32 v111, v112, v111, v117
    v_add_u32 v116, v116, v117

    buffer_store_dwordx2 v[110:111], v116, s[24:27], 0 offen
    v_cmp_ne_u32_sdwa s[80:81], v119, v121 src0_sel:WORD_1 src1_sel:WORD_1
    v_cmp_ne_u32_sdwa vcc, v119, v123 src0_sel:WORD_1 src1_sel:WORD_1
    v_alignbyte_b32 v122, v123, v122, 2
    s_mov_b32 s54, 15357
    v_alignbyte_b32 v119, v119, v118, 1
    v_perm_b32 v118, v118, v122, s47
    s_waitcnt lgkmcnt(0)
    v_add3_u32 v124, v124, v106, s54
    v_sub_u32 v125, 0, v124
    v_and_b32 v125, 3, v125
    s_mov_b64 exec, s[80:81]
    v_mov_b32 v125, 0
    v_mov_b32 v120, 0
    s_mov_b64 exec, vcc
    v_mov_b32 v125, 3

    s_mov_b64 exec, -1
    v_alignbyte_b32 v118, v119, v118, v125
    v_alignbyte_b32 v119, v120, v119, v125
    v_add_u32 v124, v124, v125

    buffer_store_dwordx2 v[118:119], v124, s[24:27], 0 offen
L_skw_28:
    s_bitcmp0_b32 s82, 2
    s_cbranch_scc1 L_ska_29
    v_mul_hi_u32_u24 v61, s40, v28
    v_mul_hi_u32_u24 v60, s40, v12
    v_mul_hi_u32_u24 v63, s40, v29
    v_mul_hi_u32_u24 v62, s40, v13
    v_mul_hi_u32_u24 v65, s40, v30
    v_mul_hi_u32_u24 v64, s40, v14
    v_mul_hi_u32_u24 v67, s40, v31
    v_mul_hi_u32_u24 v66, s40, v15
    v_and_b32 v61, -2, v61
    v_mad_u32_u24 v12, v60, s43, v12
    v_and_b32 v84, -4, v60
    v_and_b32 v63, -2, v63
    v_mad_u32_u24 v13, v62, s43, v13
    v_and_b32 v85, -4, v62
    v_and_b32 v65, -2, v65
    v_mad_u32_u24 v14, v64, s43, v14
    v_and_b32 v86, -4, v64
    v_and_b32 v67, -2, v67
    v_mad_u32_u24 v15, v66, s43, v15
    v_and_b32 v87, -4, v66
    v_mad_i32_i24 v28, v61, s42, v28
    v_lshl_add_u32 v61, v84, 5, v61
    v_mad_i32_i24 v29, v63, s42, v29
    v_lshl_add_u32 v63, v85, 5, v63
    v_mad_i32_i24 v30, v65, s42, v30
    v_lshl_add_u32 v65, v86, 5, v65
    v_mad_i32_i24 v31, v67, s42, v31
    v_lshl_add_u32 v67, v87, 5, v67
    v_add_u32 v61, v61, v61
    ds_add_rtn_u32 v84, v61, v104
    v_add_u32 v63, v63, v63
    ds_add_rtn_u32 v85, v63, v104
    v_add_u32 v65, v65, v65
    ds_add_rtn_u32 v86, v65, v104
    v_add_u32 v67, v67, v67
    ds_add_rtn_u32 v87, v67, v104
    v_lshlrev_b32 v110, 16, v40
    v_and_b32 v111, 0xffff0000, v40
    v_lshlrev_b32 v112, 16, v41
    v_and_b32 v113, 0xffff0000, v41
    v_mul_f32 v110, s44, v110
    v_mul_f32 v111, s44, v111
    v_mul_f32 v112, s44, v112
    v_mul_f32 v113, s44, v113
    v_fract_f32 v110, v110
    v_fract_f32 v111, v111
    v_fract_f32 v112, v112
    v_fract_f32 v113, v113
    v_cos_f32 v110, v110
    v_cos_f32 v111, v111
    v_cos_f32 v112, v112
    v_cos_f32 v113, v113
    v_lshl_or_b32 v60, v60, 14, v28
    v_perm_b32 v61, v61, v12, s46
    v_bfe_u32 v12, v12, 8, 5

    v_lshl_or_b32 v62, v62, 14, v29
    v_perm_b32 v63, v63, v13, s46
    v_bfe_u32 v13, v13, 8, 5

    v_lshl_or_b32 v64, v64, 14, v30
    v_perm_b32 v65, v65, v14, s46
    v_bfe_u32 v14, v14, 8, 5

    v_lshl_or_b32 v66, v66, 14, v31
    v_perm_b32 v67, v67, v15, s46
    v_bfe_u32 v15, v15, 8, 5

    v_fmaak_f32 v110, v110, v105, 0x4b400010
    v_fmaak_f32 v111, v111, v105, 0x4b400010
    v_fmaak_f32 v112, v112, v105, 0x4b400010
    v_fmaak_f32 v113, v113, v105, 0x4b400010
    v_sub_u32 v110, v110, v12
    v_sub_u32 v111, v111, v13
    v_sub_u32 v112, v112, v14
    v_sub_u32 v113, v113, v15
    v_bfi_b32 v110, 31, v12, v110
    v_bfi_b32 v111, 31, v13, v111
    v_bfi_b32 v112, 31, v14, v112
    v_bfi_b32 v113, 31, v15, v113
    v_perm_b32 v60, v60, v110, s55
    v_perm_b32 v62, v62, v111, s55
    v_perm_b32 v64, v64, v112, s55
    v_perm_b32 v66, v66, v113, s55
L_ska_29:
    s_bitcmp0_b32 s28, 1
    s_cbranch_scc1 L_skw_30
    v_add_u32 v107, 32768, v2
    ds_read_b64 v[110:111], v107 offset:16400
    ds_read_b64 v[112:113], v107 offset:16408
    ds_read_b64 v[114:115], v107 offset:16392

    ds_read_b64 v[118:119], v107 offset:24592
    ds_read_b64 v[120:121], v107 offset:24600
    ds_read_b64 v[122:123], v107 offset:24584

    s_waitcnt lgkmcnt(3)
    v_lshrrev_b32 v116, 16, v111
    ds_read_b32 v116, v116 offset:8192

    s_waitcnt lgkmcnt(1)
    v_lshrrev_b32 v124, 16, v119
    ds_read_b32 v124, v124 offset:8192

    v_cmp_ne_u32_sdwa s[80:81], v111, v113 src0_sel:WORD_1 src1_sel:WORD_1
    v_cmp_ne_u32_sdwa vcc, v111, v115 src0_sel:WORD_1 src1_sel:WORD_1
    v_alignbyte_b32 v114, v115, v114, 2
    s_mov_b32 s54, 20477
    v_alignbyte_b32 v111, v111, v110, 1
    v_perm_b32 v110, v110, v114, s47
    s_waitcnt lgkmcnt(1)
    v_add3_u32 v116, v116, v106, s54
    v_sub_u32 v117, 0, v116
    v_and_b32 v117, 3, v117
    s_mov_b64 exec, s[80:81]
    v_mov_b32 v117, 0
    v_mov_b32 v112, 0
    s_mov_b64 exec, vcc
    v_mov_b32 v117, 3

    s_mov_b64 exec, -1
    v_alignbyte_b32 v110, v111, v110, v117
    v_alignbyte_b32 v111, v112, v111, v117
    v_add_u32 v116, v116, v117

    buffer_store_dwordx2 v[110:111], v116, s[24:27], 0 offen
    v_cmp_ne_u32_sdwa s[80:81], v119, v121 src0_sel:WORD_1 src1_sel:WORD_1
    v_cmp_ne_u32_sdwa vcc, v119, v123 src0_sel:WORD_1 src1_sel:WORD_1
    v_alignbyte_b32 v122, v123, v122, 2
    s_mov_b32 s54, 25597
    v_alignbyte_b32 v119, v119, v118, 1
    v_perm_b32 v118, v118, v122, s47
    s_waitcnt lgkmcnt(0)
    v_add3_u32 v124, v124, v106, s54
    v_sub_u32 v125, 0, v124
    v_and_b32 v125, 3, v125
    s_mov_b64 exec, s[80:81]
    v_mov_b32 v125, 0
    v_mov_b32 v120, 0
    s_mov_b64 exec, vcc
    v_mov_b32 v125, 3

    s_mov_b64 exec, -1
    v_alignbyte_b32 v118, v119, v118, v125
    v_alignbyte_b32 v119, v120, v119, v125
    v_add_u32 v124, v124, v125

    buffer_store_dwordx2 v[118:119], v124, s[24:27], 0 offen
L_skw_30:
    s_bitcmp0_b32 s28, 1
    s_cbranch_scc1 L_skw_31
    v_add_u32 v107, 32768, v2
    ds_read_b64 v[110:111], v107 offset:32784
    ds_read_b64 v[112:113], v107 offset:32792
    ds_read_b64 v[114:115], v107 offset:32776

    ds_read_b64 v[118:119], v107 offset:40976
    ds_read_b64 v[120:121], v107 offset:40984
    ds_read_b64 v[122:123], v107 offset:40968

    s_waitcnt lgkmcnt(3)
    v_lshrrev_b32 v116, 16, v111
    ds_read_b32 v116, v116 offset:8192

    s_waitcnt lgkmcnt(1)
    v_lshrrev_b32 v124, 16, v119
    ds_read_b32 v124, v124 offset:8192

    v_cmp_ne_u32_sdwa s[80:81], v111, v113 src0_sel:WORD_1 src1_sel:WORD_1
    v_cmp_ne_u32_sdwa vcc, v111, v115 src0_sel:WORD_1 src1_sel:WORD_1
    v_alignbyte_b32 v114, v115, v114, 2
    s_mov_b32 s54, 30717
    v_alignbyte_b32 v111, v111, v110, 1
    v_perm_b32 v110, v110, v114, s47
    s_waitcnt lgkmcnt(1)
    v_add3_u32 v116, v116, v106, s54
    v_sub_u32 v117, 0, v116
    v_and_b32 v117, 3, v117
    s_mov_b64 exec, s[80:81]
    v_mov_b32 v117, 0
    v_mov_b32 v112, 0
    s_mov_b64 exec, vcc
    v_mov_b32 v117, 3

    s_mov_b64 exec, -1
    v_alignbyte_b32 v110, v111, v110, v117
    v_alignbyte_b32 v111, v112, v111, v117
    v_add_u32 v116, v116, v117

    buffer_store_dwordx2 v[110:111], v116, s[24:27], 0 offen
    v_cmp_ne_u32_sdwa s[80:81], v119, v121 src0_sel:WORD_1 src1_sel:WORD_1
    v_cmp_ne_u32_sdwa vcc, v119, v123 src0_sel:WORD_1 src1_sel:WORD_1
    v_alignbyte_b32 v122, v123, v122, 2
    s_mov_b32 s54, 35837
    v_alignbyte_b32 v119, v119, v118, 1
    v_perm_b32 v118, v118, v122, s47
    s_waitcnt lgkmcnt(0)
    v_add3_u32 v124, v124, v106, s54
    v_sub_u32 v125, 0, v124
    v_and_b32 v125, 3, v125
    s_mov_b64 exec, s[80:81]
    v_mov_b32 v125, 0
    v_mov_b32 v120, 0
    s_mov_b64 exec, vcc
    v_mov_b32 v125, 3

    s_mov_b64 exec, -1
    v_alignbyte_b32 v118, v119, v118, v125
    v_alignbyte_b32 v119, v120, v119, v125
    v_add_u32 v124, v124, v125

    buffer_store_dwordx2 v[118:119], v124, s[24:27], 0 offen
L_skw_31:
    s_bitcmp0_b32 s28, 2
    s_cbranch_scc1 L_skw_32
    v_add_u32 v107, 65536, v2
    ds_read_b64 v[110:111], v107 offset:16400
    ds_read_b64 v[112:113], v107 offset:16408
    ds_read_b64 v[114:115], v107 offset:16392

    ds_read_b64 v[118:119], v107 offset:24592
    ds_read_b64 v[120:121], v107 offset:24600
    ds_read_b64 v[122:123], v107 offset:24584

    s_waitcnt lgkmcnt(3)
    v_lshrrev_b32 v116, 16, v111
    ds_read_b32 v116, v116 offset:8192

    s_waitcnt lgkmcnt(1)
    v_lshrrev_b32 v124, 16, v119
    ds_read_b32 v124, v124 offset:8192

    v_cmp_ne_u32_sdwa s[80:81], v111, v113 src0_sel:WORD_1 src1_sel:WORD_1
    v_cmp_ne_u32_sdwa vcc, v111, v115 src0_sel:WORD_1 src1_sel:WORD_1
    v_alignbyte_b32 v114, v115, v114, 2
    s_mov_b32 s54, 40957
    v_alignbyte_b32 v111, v111, v110, 1
    v_perm_b32 v110, v110, v114, s47
    s_waitcnt lgkmcnt(1)
    v_add3_u32 v116, v116, v106, s54
    v_sub_u32 v117, 0, v116
    v_and_b32 v117, 3, v117
    s_mov_b64 exec, s[80:81]
    v_mov_b32 v117, 0
    v_mov_b32 v112, 0
    s_mov_b64 exec, vcc
    v_mov_b32 v117, 3

    s_mov_b64 exec, -1
    v_alignbyte_b32 v110, v111, v110, v117
    v_alignbyte_b32 v111, v112, v111, v117
    v_add_u32 v116, v116, v117

    buffer_store_dwordx2 v[110:111], v116, s[24:27], 0 offen
    v_cmp_ne_u32_sdwa s[80:81], v119, v121 src0_sel:WORD_1 src1_sel:WORD_1
    v_cmp_ne_u32_sdwa vcc, v119, v123 src0_sel:WORD_1 src1_sel:WORD_1
    v_alignbyte_b32 v122, v123, v122, 2
    s_mov_b32 s54, 46077
    v_alignbyte_b32 v119, v119, v118, 1
    v_perm_b32 v118, v118, v122, s47
    s_waitcnt lgkmcnt(0)
    v_add3_u32 v124, v124, v106, s54
    v_sub_u32 v125, 0, v124
    v_and_b32 v125, 3, v125
    s_mov_b64 exec, s[80:81]
    v_mov_b32 v125, 0
    v_mov_b32 v120, 0
    s_mov_b64 exec, vcc
    v_mov_b32 v125, 3

    s_mov_b64 exec, -1
    v_alignbyte_b32 v118, v119, v118, v125
    v_alignbyte_b32 v119, v120, v119, v125
    v_add_u32 v124, v124, v125

    buffer_store_dwordx2 v[118:119], v124, s[24:27], 0 offen
L_skw_32:
    s_bitcmp0_b32 s82, 3
    s_cbranch_scc1 L_ska_33
    s_mov_b64 exec, s[66:67]
    v_mul_hi_u32_u24 v69, s40, v32
    v_mul_hi_u32_u24 v68, s40, v16
    v_mul_hi_u32_u24 v71, s40, v33
    v_mul_hi_u32_u24 v70, s40, v17
    v_mul_hi_u32_u24 v73, s40, v34
    v_mul_hi_u32_u24 v72, s40, v18
    v_mul_hi_u32_u24 v75, s40, v35
    v_mul_hi_u32_u24 v74, s40, v19
    v_and_b32 v69, -2, v69
    v_mad_u32_u24 v16, v68, s43, v16
    v_and_b32 v88, -4, v68
    v_and_b32 v71, -2, v71
    v_mad_u32_u24 v17, v70, s43, v17
    v_and_b32 v89, -4, v70
    v_and_b32 v73, -2, v73
    v_mad_u32_u24 v18, v72, s43, v18
    v_and_b32 v90, -4, v72
    v_and_b32 v75, -2, v75
    v_mad_u32_u24 v19, v74, s43, v19
    v_and_b32 v91, -4, v74
    v_mad_i32_i24 v32, v69, s42, v32
    v_lshl_add_u32 v69, v88, 5, v69
    v_mad_i32_i24 v33, v71, s42, v33
    v_lshl_add_u32 v71, v89, 5, v71
    v_mad_i32_i24 v34, v73, s42, v34
    v_lshl_add_u32 v73, v90, 5, v73
    v_mad_i32_i24 v35, v75, s42, v35
    v_lshl_add_u32 v75, v91, 5, v75
    v_add_u32 v69, v69, v69
    ds_add_rtn_u32 v88, v69, v104
    v_add_u32 v71, v71, v71
    ds_add_rtn_u32 v89, v71, v104
    v_add_u32 v73, v73, v73
    ds_add_rtn_u32 v90, v73, v104
    v_add_u32 v75, v75, v75
    ds_add_rtn_u32 v91, v75, v104
    v_lshlrev_b32 v110, 16, v42
    v_and_b32 v111, 0xffff0000, v42
    v_lshlrev_b32 v112, 16, v43
    v_and_b32 v113, 0xffff0000, v43
    v_mul_f32 v110, s44, v110
    v_mul_f32 v111, s44, v111
    v_mul_f32 v112, s44, v112
    v_mul_f32 v113, s44, v113
    v_fract_f32 v110, v110
    v_fract_f32 v111, v111
    v_fract_f32 v112, v112
    v_fract_f32 v113, v113
    v_cos_f32 v110, v110
    v_cos_f32 v111, v111
    v_cos_f32 v112, v112
    v_cos_f32 v113, v113
    v_lshl_or_b32 v68, v68, 14, v32
    v_perm_b32 v69, v69, v16, s46
    v_bfe_u32 v16, v16, 8, 5

    v_lshl_or_b32 v70, v70, 14, v33
    v_perm_b32 v71, v71, v17, s46
    v_bfe_u32 v17, v17, 8, 5

    v_lshl_or_b32 v72, v72, 14, v34
    v_perm_b32 v73, v73, v18, s46
    v_bfe_u32 v18, v18, 8, 5

    v_lshl_or_b32 v74, v74, 14, v35
    v_perm_b32 v75, v75, v19, s46
    v_bfe_u32 v19, v19, 8, 5

    v_fmaak_f32 v110, v110, v105, 0x4b400010
    v_fmaak_f32 v111, v111, v105, 0x4b400010
    v_fmaak_f32 v112, v112, v105, 0x4b400010
    v_fmaak_f32 v113, v113, v105, 0x4b400010
    v_sub_u32 v110, v110, v16
    v_sub_u32 v111, v111, v17
    v_sub_u32 v112, v112, v18
    v_sub_u32 v113, v113, v19
    v_bfi_b32 v110, 31, v16, v110
    v_bfi_b32 v111, 31, v17, v111
    v_bfi_b32 v112, 31, v18, v112
    v_bfi_b32 v113, 31, v19, v113
    v_perm_b32 v68, v68, v110, s55
    v_perm_b32 v70, v70, v111, s55
    v_perm_b32 v72, v72, v112, s55
    v_perm_b32 v74, v74, v113, s55
    s_mov_b64 exec, -1
L_ska_33:
    s_bitcmp0_b32 s28, 2
    s_cbranch_scc1 L_skw_34
    v_add_u32 v107, 65536, v2
    ds_read_b64 v[110:111], v107 offset:32784
    ds_read_b64 v[112:113], v107 offset:32792
    ds_read_b64 v[114:115], v107 offset:32776

    ds_read_b64 v[118:119], v107 offset:40976
    ds_read_b64 v[120:121], v107 offset:40984
    ds_read_b64 v[122:123], v107 offset:40968

    s_waitcnt lgkmcnt(3)
    v_lshrrev_b32 v116, 16, v111
    ds_read_b32 v116, v116 offset:8192

    s_waitcnt lgkmcnt(1)
    v_lshrrev_b32 v124, 16, v119
    ds_read_b32 v124, v124 offset:8192

    v_cmp_ne_u32_sdwa s[80:81], v111, v113 src0_sel:WORD_1 src1_sel:WORD_1
    v_cmp_ne_u32_sdwa vcc, v111, v115 src0_sel:WORD_1 src1_sel:WORD_1
    v_alignbyte_b32 v114, v115, v114, 2
    s_mov_b32 s54, 51197
    v_alignbyte_b32 v111, v111, v110, 1
    v_perm_b32 v110, v110, v114, s47
    s_waitcnt lgkmcnt(1)
    v_add3_u32 v116, v116, v106, s54
    v_sub_u32 v117, 0, v116
    v_and_b32 v117, 3, v117
    s_mov_b64 exec, s[80:81]
    v_mov_b32 v117, 0
    v_mov_b32 v112, 0
    s_mov_b64 exec, vcc
    v_mov_b32 v117, 3

    s_mov_b64 exec, -1
    v_alignbyte_b32 v110, v111, v110, v117
    v_alignbyte_b32 v111, v112, v111, v117
    v_add_u32 v116, v116, v117

    buffer_store_dwordx2 v[110:111], v116, s[24:27], 0 offen
    v_cmp_ne_u32_sdwa s[80:81], v119, v121 src0_sel:WORD_1 src1_sel:WORD_1
    v_cmp_ne_u32_sdwa vcc, v119, v123 src0_sel:WORD_1 src1_sel:WORD_1
    v_alignbyte_b32 v122, v123, v122, 2
    s_mov_b32 s54, 56317
    v_alignbyte_b32 v119, v119, v118, 1
    v_perm_b32 v118, v118, v122, s47
    s_waitcnt lgkmcnt(0)
    v_add3_u32 v124, v124, v106, s54
    v_sub_u32 v125, 0, v124
    v_and_b32 v125, 3, v125
    s_mov_b64 exec, s[80:81]
    v_mov_b32 v125, 0
    v_mov_b32 v120, 0
    s_mov_b64 exec, vcc
    v_mov_b32 v125, 3

    s_mov_b64 exec, -1
    v_alignbyte_b32 v118, v119, v118, v125
    v_alignbyte_b32 v119, v120, v119, v125
    v_add_u32 v124, v124, v125

    buffer_store_dwordx2 v[118:119], v124, s[24:27], 0 offen
L_skw_34:
    s_bitcmp0_b32 s28, 3
    s_cbranch_scc1 L_skw_35
    v_add_u32 v107, 98304, v2
    ds_read_b64 v[110:111], v107 offset:16400
    ds_read_b64 v[112:113], v107 offset:16408
    ds_read_b64 v[114:115], v107 offset:16392

    ds_read_b64 v[118:119], v107 offset:24592
    ds_read_b64 v[120:121], v107 offset:24600
    ds_read_b64 v[122:123], v107 offset:24584

    s_waitcnt lgkmcnt(3)
    v_lshrrev_b32 v116, 16, v111
    ds_read_b32 v116, v116 offset:8192

    s_waitcnt lgkmcnt(1)
    v_lshrrev_b32 v124, 16, v119
    ds_read_b32 v124, v124 offset:8192

    v_cmp_ne_u32_sdwa s[80:81], v111, v113 src0_sel:WORD_1 src1_sel:WORD_1
    v_cmp_ne_u32_sdwa vcc, v111, v115 src0_sel:WORD_1 src1_sel:WORD_1
    v_alignbyte_b32 v114, v115, v114, 2
    s_mov_b32 s54, 61437
    v_alignbyte_b32 v111, v111, v110, 1
    v_perm_b32 v110, v110, v114, s47
    s_waitcnt lgkmcnt(1)
    v_add3_u32 v116, v116, v106, s54
    v_sub_u32 v117, 0, v116
    v_and_b32 v117, 3, v117
    s_mov_b64 exec, s[80:81]
    v_mov_b32 v117, 0
    v_mov_b32 v112, 0
    s_mov_b64 exec, vcc
    v_mov_b32 v117, 3

    s_mov_b64 exec, -1
    v_alignbyte_b32 v110, v111, v110, v117
    v_alignbyte_b32 v111, v112, v111, v117
    v_add_u32 v116, v116, v117

    buffer_store_dwordx2 v[110:111], v116, s[24:27], 0 offen
    v_cmp_ne_u32_sdwa s[80:81], v119, v121 src0_sel:WORD_1 src1_sel:WORD_1
    v_cmp_ne_u32_sdwa vcc, v119, v123 src0_sel:WORD_1 src1_sel:WORD_1
    v_alignbyte_b32 v122, v123, v122, 2
    s_mov_b32 s54, 66557
    v_alignbyte_b32 v119, v119, v118, 1
    v_perm_b32 v118, v118, v122, s47
    s_waitcnt lgkmcnt(0)
    v_add3_u32 v124, v124, v106, s54
    v_sub_u32 v125, 0, v124
    v_and_b32 v125, 3, v125
    s_mov_b64 exec, s[80:81]
    v_mov_b32 v125, 0
    v_mov_b32 v120, 0
    s_mov_b64 exec, vcc
    v_mov_b32 v125, 3

    s_mov_b64 exec, -1
    v_alignbyte_b32 v118, v119, v118, v125
    v_alignbyte_b32 v119, v120, v119, v125
    v_add_u32 v124, v124, v125

    buffer_store_dwordx2 v[118:119], v124, s[24:27], 0 offen
L_skw_35:
    s_bitcmp0_b32 s28, 3
    s_cbranch_scc1 L_skw_36
    v_add_u32 v107, 98304, v2
    ds_read_b64 v[110:111], v107 offset:32784
    ds_read_b64 v[112:113], v107 offset:32792
    ds_read_b64 v[114:115], v107 offset:32776

    ds_read_b64 v[118:119], v107 offset:40976
    ds_read_b64 v[120:121], v107 offset:40984
    ds_read_b64 v[122:123], v107 offset:40968

    s_waitcnt lgkmcnt(3)
    v_lshrrev_b32 v116, 16, v111
    ds_read_b32 v116, v116 offset:8192

    s_waitcnt lgkmcnt(1)
    v_lshrrev_b32 v124, 16, v119
    ds_read_b32 v124, v124 offset:8192

    v_cmp_ne_u32_sdwa s[80:81], v111, v113 src0_sel:WORD_1 src1_sel:WORD_1
    v_cmp_ne_u32_sdwa vcc, v111, v115 src0_sel:WORD_1 src1_sel:WORD_1
    v_alignbyte_b32 v114, v115, v114, 2
    s_mov_b32 s54, 71677
    v_alignbyte_b32 v111, v111, v110, 1
    v_perm_b32 v110, v110, v114, s47
    s_waitcnt lgkmcnt(1)
    v_add3_u32 v116, v116, v106, s54
    v_sub_u32 v117, 0, v116
    v_and_b32 v117, 3, v117
    s_mov_b64 exec, s[80:81]
    v_mov_b32 v117, 0
    v_mov_b32 v112, 0
    s_mov_b64 exec, vcc
    v_mov_b32 v117, 3

    s_mov_b64 exec, -1
    v_alignbyte_b32 v110, v111, v110, v117
    v_alignbyte_b32 v111, v112, v111, v117
    v_add_u32 v116, v116, v117

    buffer_store_dwordx2 v[110:111], v116, s[24:27], 0 offen
    v_cmp_ne_u32_sdwa s[80:81], v119, v121 src0_sel:WORD_1 src1_sel:WORD_1
    v_cmp_ne_u32_sdwa vcc, v119, v123 src0_sel:WORD_1 src1_sel:WORD_1
    v_alignbyte_b32 v122, v123, v122, 2
    s_mov_b32 s54, 76797
    v_alignbyte_b32 v119, v119, v118, 1
    v_perm_b32 v118, v118, v122, s47
    s_waitcnt lgkmcnt(0)
    v_add3_u32 v124, v124, v106, s54
    v_sub_u32 v125, 0, v124
    v_and_b32 v125, 3, v125
    s_mov_b64 exec, s[80:81]
    v_mov_b32 v125, 0
    v_mov_b32 v120, 0
    s_mov_b64 exec, vcc
    v_mov_b32 v125, 3

    s_andn2_b64 exec, -1, s[68:69]
    v_bfrev_b32 v124, 1
    s_mov_b64 exec, -1
    v_alignbyte_b32 v118, v119, v118, v125
    v_alignbyte_b32 v119, v120, v119, v125
    v_add_u32 v124, v124, v125

    buffer_store_dwordx2 v[118:119], v124, s[24:27], 0 offen
L_skw_36:
    s_waitcnt lgkmcnt(0)
    s_barrier

    buffer_load_dwordx4 v[20:23], v1, s[12:15], s56 offen nt
    buffer_load_dwordx4 v[4:7], v1, s[8:11], s56 offen nt
    buffer_load_dwordx2 v[36:37], v2, s[16:19], s61 offen nt
    ds_read_b64 v[94:95], v2
    s_waitcnt lgkmcnt(0)
    v_and_b32 v94, 0xffff, v94
    v_and_b32 v95, 0xffff, v95
    v_add_u32 v97, v94, v95
    s_nop 1
    v_add_u32_dpp v97, v97, v97 row_shr:1 row_mask:0xf bank_mask:0xf
    s_nop 1
    v_add_u32_dpp v97, v97, v97 row_shr:2 row_mask:0xf bank_mask:0xf
    s_nop 1
    v_add_u32_dpp v97, v97, v97 row_shr:4 row_mask:0xf bank_mask:0xf
    s_nop 1
    v_add_u32_dpp v97, v97, v97 row_shr:8 row_mask:0xf bank_mask:0xf
    s_nop 1
    v_add_u32_dpp v97, v97, v97 row_bcast:15 row_mask:0xa bank_mask:0xf
    s_nop 1
    v_add_u32_dpp v97, v97, v97 row_bcast:31 row_mask:0xc bank_mask:0xf
    s_mov_b32 exec_lo, 0
    s_brev_b32 exec_hi, 1
    ds_add_rtn_u32 v96, v108, v97
    s_mov_b64 exec, -1

    v_add_u32 v92, v94, v94
    v_add_u32 v93, v95, v95
    v_med3_u32 v92, v94, 2, v92
    v_med3_u32 v93, v95, 2, v93
    buffer_atomic_add_x2 v[92:93], v2, s[20:23], 0 offen sc0
    s_waitcnt lgkmcnt(0)
    v_readlane_b32 s77, v96, 63
    v_mul_u32_u24 v114, 7936, v0
    v_sub_u32 v97, v97, v95
    s_sub_u32 s50, s50, s83
    s_sub_u32 s77, s77, s50
    v_add_u32 v97, s77, v97
    v_sub_u32 v96, v97, v94
    v_lshlrev_b32 v111, 16, v97
    v_lshlrev_b32 v110, 16, v96
    ds_write_b64 v2, v[110:111]
    v_sub_u32 v96, v114, v96
    v_sub_u32 v97, v114, v97
    v_add_u32 v97, s48, v97
    s_add_u32 s50, s50, s84
    s_mov_b32 s28, s82
    s_mov_b32 s29, s83
    s_mov_b32 s30, s84
    s_lshl_b32 s74, s29, 3
    s_lshl_b32 s75, s30, 3
    v_mov_b32 v125, s74
    v_mov_b32 v126, s75
    v_mov_b32 v127, -1

    s_waitcnt lgkmcnt(0)
    s_barrier

    s_mov_b64 exec, 1
    ds_write_b32 v125, v127 offset:16396
    ds_write_b32 v126, v127 offset:16404
    s_mov_b64 exec, -1

    buffer_load_dwordx4 v[24:27], v1, s[12:15], s57 offen nt
    buffer_load_dwordx4 v[8:11], v1, s[8:11], s57 offen nt
    buffer_load_dwordx2 v[38:39], v2, s[16:19], s62 offen nt
    s_bitcmp0_b32 s28, 0
    s_cbranch_scc1 L_skz_37
    v_lshrrev_b32 v110, 16, v45
    ds_read_b32 v110, v110
    v_lshrrev_b32 v111, 16, v47
    ds_read_b32 v111, v111
    v_lshrrev_b32 v112, 16, v49
    ds_read_b32 v112, v112
    v_lshrrev_b32 v113, 16, v51
    ds_read_b32 v113, v113
    v_lshrrev_b32 v114, 16, v53
    ds_read_b32 v114, v114
    v_lshrrev_b32 v115, 16, v55
    ds_read_b32 v115, v115
    v_lshrrev_b32 v116, 16, v57
    ds_read_b32 v116, v116
    v_lshrrev_b32 v117, 16, v59
    ds_read_b32 v117, v117
    s_waitcnt lgkmcnt(7)
    v_add_u32_sdwa v110, v110, v76 dst_sel:DWORD dst_unused:UNUSED_PAD src0_sel:WORD_1 src1_sel:WORD_0
    v_lshlrev_b32 v110, 3, v110
    ds_write_b64 v110, v[44:45] offset:16400

    s_waitcnt lgkmcnt(7)
    v_add_u32_sdwa v111, v111, v77 dst_sel:DWORD dst_unused:UNUSED_PAD src0_sel:WORD_1 src1_sel:WORD_0
    v_lshlrev_b32 v111, 3, v111
    ds_write_b64 v111, v[46:47] offset:16400

    s_waitcnt lgkmcnt(7)
    v_add_u32_sdwa v112, v112, v78 dst_sel:DWORD dst_unused:UNUSED_PAD src0_sel:WORD_1 src1_sel:WORD_0
    v_lshlrev_b32 v112, 3, v112
    ds_write_b64 v112, v[48:49] offset:16400

    s_waitcnt lgkmcnt(7)
    v_add_u32_sdwa v113, v113, v79 dst_sel:DWORD dst_unused:UNUSED_PAD src0_sel:WORD_1 src1_sel:WORD_0
    v_lshlrev_b32 v113, 3, v113
    ds_write_b64 v113, v[50:51] offset:16400

    s_waitcnt lgkmcnt(7)
    v_add_u32_sdwa v114, v114, v80 dst_sel:DWORD dst_unused:UNUSED_PAD src0_sel:WORD_1 src1_sel:WORD_0
    v_lshlrev_b32 v114, 3, v114
    ds_write_b64 v114, v[52:53] offset:16400

    s_waitcnt lgkmcnt(7)
    v_add_u32_sdwa v115, v115, v81 dst_sel:DWORD dst_unused:UNUSED_PAD src0_sel:WORD_1 src1_sel:WORD_0
    v_lshlrev_b32 v115, 3, v115
    ds_write_b64 v115, v[54:55] offset:16400

    s_waitcnt lgkmcnt(7)
    v_add_u32_sdwa v116, v116, v82 dst_sel:DWORD dst_unused:UNUSED_PAD src0_sel:WORD_1 src1_sel:WORD_0
    v_lshlrev_b32 v116, 3, v116
    ds_write_b64 v116, v[56:57] offset:16400

    s_waitcnt lgkmcnt(7)
    v_add_u32_sdwa v117, v117, v83 dst_sel:DWORD dst_unused:UNUSED_PAD src0_sel:WORD_1 src1_sel:WORD_0
    v_lshlrev_b32 v117, 3, v117
    ds_write_b64 v117, v[58:59] offset:16400

L_skz_37:
    buffer_load_dwordx4 v[28:31], v1, s[12:15], s58 offen nt
    buffer_load_dwordx4 v[12:15], v1, s[8:11], s58 offen nt
    buffer_load_dwordx2 v[40:41], v2, s[16:19], s63 offen nt
    s_bitcmp0_b32 s28, 2
    s_cbranch_scc1 L_skz_38
    v_lshrrev_b32 v110, 16, v61
    ds_read_b32 v110, v110
    v_lshrrev_b32 v111, 16, v63
    ds_read_b32 v111, v111
    v_lshrrev_b32 v112, 16, v65
    ds_read_b32 v112, v112
    v_lshrrev_b32 v113, 16, v67
    ds_read_b32 v113, v113
    s_waitcnt lgkmcnt(3)
    v_add_u32_sdwa v110, v110, v84 dst_sel:DWORD dst_unused:UNUSED_PAD src0_sel:WORD_1 src1_sel:WORD_0
    v_lshlrev_b32 v110, 3, v110
    ds_write_b64 v110, v[60:61] offset:16400

    s_waitcnt lgkmcnt(3)
    v_add_u32_sdwa v111, v111, v85 dst_sel:DWORD dst_unused:UNUSED_PAD src0_sel:WORD_1 src1_sel:WORD_0
    v_lshlrev_b32 v111, 3, v111
    ds_write_b64 v111, v[62:63] offset:16400

    s_waitcnt lgkmcnt(3)
    v_add_u32_sdwa v112, v112, v86 dst_sel:DWORD dst_unused:UNUSED_PAD src0_sel:WORD_1 src1_sel:WORD_0
    v_lshlrev_b32 v112, 3, v112
    ds_write_b64 v112, v[64:65] offset:16400

    s_waitcnt lgkmcnt(3)
    v_add_u32_sdwa v113, v113, v87 dst_sel:DWORD dst_unused:UNUSED_PAD src0_sel:WORD_1 src1_sel:WORD_0
    v_lshlrev_b32 v113, 3, v113
    ds_write_b64 v113, v[66:67] offset:16400

L_skz_38:
    s_bitcmp0_b32 s28, 3
    s_cbranch_scc1 L_skz_39
    s_mov_b64 exec, s[66:67]
    v_lshrrev_b32 v110, 16, v69
    ds_read_b32 v110, v110
    v_lshrrev_b32 v111, 16, v71
    ds_read_b32 v111, v111
    v_lshrrev_b32 v112, 16, v73
    ds_read_b32 v112, v112
    v_lshrrev_b32 v113, 16, v75
    ds_read_b32 v113, v113
    s_waitcnt lgkmcnt(3)
    v_add_u32_sdwa v110, v110, v88 dst_sel:DWORD dst_unused:UNUSED_PAD src0_sel:WORD_1 src1_sel:WORD_0
    v_lshlrev_b32 v110, 3, v110
    ds_write_b64 v110, v[68:69] offset:16400

    s_waitcnt lgkmcnt(3)
    v_add_u32_sdwa v111, v111, v89 dst_sel:DWORD dst_unused:UNUSED_PAD src0_sel:WORD_1 src1_sel:WORD_0
    v_lshlrev_b32 v111, 3, v111
    ds_write_b64 v111, v[70:71] offset:16400

    s_waitcnt lgkmcnt(3)
    v_add_u32_sdwa v112, v112, v90 dst_sel:DWORD dst_unused:UNUSED_PAD src0_sel:WORD_1 src1_sel:WORD_0
    v_lshlrev_b32 v112, 3, v112
    ds_write_b64 v112, v[72:73] offset:16400

    s_waitcnt lgkmcnt(3)
    v_add_u32_sdwa v113, v113, v91 dst_sel:DWORD dst_unused:UNUSED_PAD src0_sel:WORD_1 src1_sel:WORD_0
    v_lshlrev_b32 v113, 3, v113
    ds_write_b64 v113, v[74:75] offset:16400

    s_mov_b64 exec, -1
L_skz_39:
    buffer_load_dwordx4 v[32:35], v1, s[12:15], s59 offen nt
    buffer_load_dwordx4 v[16:19], v1, s[8:11], s59 offen nt
    buffer_load_dwordx2 v[42:43], v2, s[16:19], s64 offen nt
    s_cmp_lg_u32 s49, 0
    s_cbranch_scc1 L_p1loop_5
L_p1epi_6:
    s_waitcnt vmcnt(0)
    s_waitcnt vmcnt(9)
    v_add_u32 v110, v92, v94
    v_min_u32 v92, s48, v92
    v_add_u32 v111, v93, v95
    v_min_u32 v93, s48, v93
    v_max_u32 v110, v110, v111
    v_add_u32 v92, v92, v96
    v_add_u32 v93, v93, v97
    v_cmp_le_u32 vcc, s48, v110
    v_lshl_add_u32 v92, v92, 2, v92
    v_lshl_add_u32 v93, v93, 2, v93
    ds_write_b64 v2, v[92:93] offset:8192
    s_cbranch_vccz L_noov_40
    ds_write_b32 v108, v104 offset:4
L_noov_40:

    s_waitcnt lgkmcnt(0)
    s_barrier
    ds_read_b32 v110, v108 offset:4
    s_waitcnt lgkmcnt(0)
    v_readfirstlane_b32 s53, v110
    s_nop 1

    s_cmp_lg_u32 s53, 0
    s_cbranch_scc1 L_slow_41
L_sback_42:
    s_bitcmp0_b32 s28, 0
    s_cbranch_scc1 L_skw_46
    ds_read_b64 v[4:5], v2 offset:16400
    ds_read_b64 v[6:7], v2 offset:16408
    ds_read_b64 v[8:9], v2 offset:16392

    ds_read_b64 v[12:13], v2 offset:24592
    ds_read_b64 v[14:15], v2 offset:24600
    ds_read_b64 v[16:17], v2 offset:24584

    ds_read_b64 v[20:21], v2 offset:32784
    ds_read_b64 v[22:23], v2 offset:32792
    ds_read_b64 v[24:25], v2 offset:32776

    ds_read_b64 v[28:29], v2 offset:40976
    ds_read_b64 v[30:31], v2 offset:40984
    ds_read_b64 v[32:33], v2 offset:40968

    s_waitcnt lgkmcnt(9)
    v_lshrrev_b32 v10, 16, v5
    ds_read_b32 v10, v10 offset:8192

    s_waitcnt lgkmcnt(7)
    v_lshrrev_b32 v18, 16, v13
    ds_read_b32 v18, v18 offset:8192

    s_waitcnt lgkmcnt(5)
    v_lshrrev_b32 v26, 16, v21
    ds_read_b32 v26, v26 offset:8192

    s_waitcnt lgkmcnt(3)
    v_lshrrev_b32 v34, 16, v29
    ds_read_b32 v34, v34 offset:8192

    v_cmp_ne_u32_sdwa s[80:81], v5, v7 src0_sel:WORD_1 src1_sel:WORD_1
    v_cmp_ne_u32_sdwa vcc, v5, v9 src0_sel:WORD_1 src1_sel:WORD_1
    v_alignbyte_b32 v8, v9, v8, 2
    s_mov_b32 s54, -3
    v_alignbyte_b32 v5, v5, v4, 1
    v_perm_b32 v4, v4, v8, s47
    s_waitcnt lgkmcnt(3)
    v_add3_u32 v10, v10, v106, s54
    v_sub_u32 v11, 0, v10
    v_and_b32 v11, 3, v11
    s_mov_b64 exec, s[80:81]
    v_mov_b32 v11, 0
    v_mov_b32 v6, 0
    s_mov_b64 exec, vcc
    v_mov_b32 v11, 3

    s_mov_b64 exec, -1
    v_alignbyte_b32 v4, v5, v4, v11
    v_alignbyte_b32 v5, v6, v5, v11
    v_add_u32 v10, v10, v11

    buffer_store_dwordx2 v[4:5], v10, s[24:27], 0 offen
    v_cmp_ne_u32_sdwa s[80:81], v13, v15 src0_sel:WORD_1 src1_sel:WORD_1
    v_cmp_ne_u32_sdwa vcc, v13, v17 src0_sel:WORD_1 src1_sel:WORD_1
    v_alignbyte_b32 v16, v17, v16, 2
    s_mov_b32 s54, 5117
    v_alignbyte_b32 v13, v13, v12, 1
    v_perm_b32 v12, v12, v16, s47
    s_waitcnt lgkmcnt(2)
    v_add3_u32 v18, v18, v106, s54
    v_sub_u32 v19, 0, v18
    v_and_b32 v19, 3, v19
    s_mov_b64 exec, s[80:81]
    v_mov_b32 v19, 0
    v_mov_b32 v14, 0
    s_mov_b64 exec, vcc
    v_mov_b32 v19, 3

    s_mov_b64 exec, -1
    v_alignbyte_b32 v12, v13, v12, v19
    v_alignbyte_b32 v13, v14, v13, v19
    v_add_u32 v18, v18, v19

    buffer_store_dwordx2 v[12:13], v18, s[24:27], 0 offen
    v_cmp_ne_u32_sdwa s[80:81], v21, v23 src0_sel:WORD_1 src1_sel:WORD_1
    v_cmp_ne_u32_sdwa vcc, v21, v25 src0_sel:WORD_1 src1_sel:WORD_1
    v_alignbyte_b32 v24, v25, v24, 2
    s_mov_b32 s54, 10237
    v_alignbyte_b32 v21, v21, v20, 1
    v_perm_b32 v20, v20, v24, s47
    s_waitcnt lgkmcnt(1)
    v_add3_u32 v26, v26, v106, s54
    v_sub_u32 v27, 0, v26
    v_and_b32 v27, 3, v27
    s_mov_b64 exec, s[80:81]
    v_mov_b32 v27, 0
    v_mov_b32 v22, 0
    s_mov_b64 exec, vcc
    v_mov_b32 v27, 3

    s_mov_b64 exec, -1
    v_alignbyte_b32 v20, v21, v20, v27
    v_alignbyte_b32 v21, v22, v21, v27
    v_add_u32 v26, v26, v27

    buffer_store_dwordx2 v[20:21], v26, s[24:27], 0 offen
    v_cmp_ne_u32_sdwa s[80:81], v29, v31 src0_sel:WORD_1 src1_sel:WORD_1
    v_cmp_ne_u32_sdwa vcc, v29, v33 src0_sel:WORD_1 src1_sel:WORD_1
    v_alignbyte_b32 v32, v33, v32, 2
    s_mov_b32 s54, 15357
    v_alignbyte_b32 v29, v29, v28, 1
    v_perm_b32 v28, v28, v32, s47
    s_waitcnt lgkmcnt(0)
    v_add3_u32 v34, v34, v106, s54
    v_sub_u32 v35, 0, v34
    v_and_b32 v35, 3, v35
    s_mov_b64 exec, s[80:81]
    v_mov_b32 v35, 0
    v_mov_b32 v30, 0
    s_mov_b64 exec, vcc
    v_mov_b32 v35, 3

    s_mov_b64 exec, -1
    v_alignbyte_b32 v28, v29, v28, v35
    v_alignbyte_b32 v29, v30, v29, v35
    v_add_u32 v34, v34, v35

    buffer_store_dwordx2 v[28:29], v34, s[24:27], 0 offen
L_skw_46:
    s_bitcmp0_b32 s28, 1
    s_cbranch_scc1 L_skw_47
    v_add_u32 v107, 32768, v2
    ds_read_b64 v[4:5], v107 offset:16400
    ds_read_b64 v[6:7], v107 offset:16408
    ds_read_b64 v[8:9], v107 offset:16392

    ds_read_b64 v[12:13], v107 offset:24592
    ds_read_b64 v[14:15], v107 offset:24600
    ds_read_b64 v[16:17], v107 offset:24584

    ds_read_b64 v[20:21], v107 offset:32784
    ds_read_b64 v[22:23], v107 offset:32792
    ds_read_b64 v[24:25], v107 offset:32776

    ds_read_b64 v[28:29], v107 offset:40976
    ds_read_b64 v[30:31], v107 offset:40984
    ds_read_b64 v[32:33], v107 offset:40968

    s_waitcnt lgkmcnt(9)
    v_lshrrev_b32 v10, 16, v5
    ds_read_b32 v10, v10 offset:8192

    s_waitcnt lgkmcnt(7)
    v_lshrrev_b32 v18, 16, v13
    ds_read_b32 v18, v18 offset:8192

    s_waitcnt lgkmcnt(5)
    v_lshrrev_b32 v26, 16, v21
    ds_read_b32 v26, v26 offset:8192

    s_waitcnt lgkmcnt(3)
    v_lshrrev_b32 v34, 16, v29
    ds_read_b32 v34, v34 offset:8192

    v_cmp_ne_u32_sdwa s[80:81], v5, v7 src0_sel:WORD_1 src1_sel:WORD_1
    v_cmp_ne_u32_sdwa vcc, v5, v9 src0_sel:WORD_1 src1_sel:WORD_1
    v_alignbyte_b32 v8, v9, v8, 2
    s_mov_b32 s54, 20477
    v_alignbyte_b32 v5, v5, v4, 1
    v_perm_b32 v4, v4, v8, s47
    s_waitcnt lgkmcnt(3)
    v_add3_u32 v10, v10, v106, s54
    v_sub_u32 v11, 0, v10
    v_and_b32 v11, 3, v11
    s_mov_b64 exec, s[80:81]
    v_mov_b32 v11, 0
    v_mov_b32 v6, 0
    s_mov_b64 exec, vcc
    v_mov_b32 v11, 3

    s_mov_b64 exec, -1
    v_alignbyte_b32 v4, v5, v4, v11
    v_alignbyte_b32 v5, v6, v5, v11
    v_add_u32 v10, v10, v11

    buffer_store_dwordx2 v[4:5], v10, s[24:27], 0 offen
    v_cmp_ne_u32_sdwa s[80:81], v13, v15 src0_sel:WORD_1 src1_sel:WORD_1
    v_cmp_ne_u32_sdwa vcc, v13, v17 src0_sel:WORD_1 src1_sel:WORD_1
    v_alignbyte_b32 v16, v17, v16, 2
    s_mov_b32 s54, 25597
    v_alignbyte_b32 v13, v13, v12, 1
    v_perm_b32 v12, v12, v16, s47
    s_waitcnt lgkmcnt(2)
    v_add3_u32 v18, v18, v106, s54
    v_sub_u32 v19, 0, v18
    v_and_b32 v19, 3, v19
    s_mov_b64 exec, s[80:81]
    v_mov_b32 v19, 0
    v_mov_b32 v14, 0
    s_mov_b64 exec, vcc
    v_mov_b32 v19, 3

    s_mov_b64 exec, -1
    v_alignbyte_b32 v12, v13, v12, v19
    v_alignbyte_b32 v13, v14, v13, v19
    v_add_u32 v18, v18, v19

    buffer_store_dwordx2 v[12:13], v18, s[24:27], 0 offen
    v_cmp_ne_u32_sdwa s[80:81], v21, v23 src0_sel:WORD_1 src1_sel:WORD_1
    v_cmp_ne_u32_sdwa vcc, v21, v25 src0_sel:WORD_1 src1_sel:WORD_1
    v_alignbyte_b32 v24, v25, v24, 2
    s_mov_b32 s54, 30717
    v_alignbyte_b32 v21, v21, v20, 1
    v_perm_b32 v20, v20, v24, s47
    s_waitcnt lgkmcnt(1)
    v_add3_u32 v26, v26, v106, s54
    v_sub_u32 v27, 0, v26
    v_and_b32 v27, 3, v27
    s_mov_b64 exec, s[80:81]
    v_mov_b32 v27, 0
    v_mov_b32 v22, 0
    s_mov_b64 exec, vcc
    v_mov_b32 v27, 3

    s_mov_b64 exec, -1
    v_alignbyte_b32 v20, v21, v20, v27
    v_alignbyte_b32 v21, v22, v21, v27
    v_add_u32 v26, v26, v27

    buffer_store_dwordx2 v[20:21], v26, s[24:27], 0 offen
    v_cmp_ne_u32_sdwa s[80:81], v29, v31 src0_sel:WORD_1 src1_sel:WORD_1
    v_cmp_ne_u32_sdwa vcc, v29, v33 src0_sel:WORD_1 src1_sel:WORD_1
    v_alignbyte_b32 v32, v33, v32, 2
    s_mov_b32 s54, 35837
    v_alignbyte_b32 v29, v29, v28, 1
    v_perm_b32 v28, v28, v32, s47
    s_waitcnt lgkmcnt(0)
    v_add3_u32 v34, v34, v106, s54
    v_sub_u32 v35, 0, v34
    v_and_b32 v35, 3, v35
    s_mov_b64 exec, s[80:81]
    v_mov_b32 v35, 0
    v_mov_b32 v30, 0
    s_mov_b64 exec, vcc
    v_mov_b32 v35, 3

    s_mov_b64 exec, -1
    v_alignbyte_b32 v28, v29, v28, v35
    v_alignbyte_b32 v29, v30, v29, v35
    v_add_u32 v34, v34, v35

    buffer_store_dwordx2 v[28:29], v34, s[24:27], 0 offen
L_skw_47:
    s_bitcmp0_b32 s28, 2
    s_cbranch_scc1 L_skw_48
    v_add_u32 v107, 65536, v2
    ds_read_b64 v[4:5], v107 offset:16400
    ds_read_b64 v[6:7], v107 offset:16408
    ds_read_b64 v[8:9], v107 offset:16392

    ds_read_b64 v[12:13], v107 offset:24592
    ds_read_b64 v[14:15], v107 offset:24600
    ds_read_b64 v[16:17], v107 offset:24584

    ds_read_b64 v[20:21], v107 offset:32784
    ds_read_b64 v[22:23], v107 offset:32792
    ds_read_b64 v[24:25], v107 offset:32776

    ds_read_b64 v[28:29], v107 offset:40976
    ds_read_b64 v[30:31], v107 offset:40984
    ds_read_b64 v[32:33], v107 offset:40968

    s_waitcnt lgkmcnt(9)
    v_lshrrev_b32 v10, 16, v5
    ds_read_b32 v10, v10 offset:8192

    s_waitcnt lgkmcnt(7)
    v_lshrrev_b32 v18, 16, v13
    ds_read_b32 v18, v18 offset:8192

    s_waitcnt lgkmcnt(5)
    v_lshrrev_b32 v26, 16, v21
    ds_read_b32 v26, v26 offset:8192

    s_waitcnt lgkmcnt(3)
    v_lshrrev_b32 v34, 16, v29
    ds_read_b32 v34, v34 offset:8192

    v_cmp_ne_u32_sdwa s[80:81], v5, v7 src0_sel:WORD_1 src1_sel:WORD_1
    v_cmp_ne_u32_sdwa vcc, v5, v9 src0_sel:WORD_1 src1_sel:WORD_1
    v_alignbyte_b32 v8, v9, v8, 2
    s_mov_b32 s54, 40957
    v_alignbyte_b32 v5, v5, v4, 1
    v_perm_b32 v4, v4, v8, s47
    s_waitcnt lgkmcnt(3)
    v_add3_u32 v10, v10, v106, s54
    v_sub_u32 v11, 0, v10
    v_and_b32 v11, 3, v11
    s_mov_b64 exec, s[80:81]
    v_mov_b32 v11, 0
    v_mov_b32 v6, 0
    s_mov_b64 exec, vcc
    v_mov_b32 v11, 3

    s_mov_b64 exec, -1
    v_alignbyte_b32 v4, v5, v4, v11
    v_alignbyte_b32 v5, v6, v5, v11
    v_add_u32 v10, v10, v11

    buffer_store_dwordx2 v[4:5], v10, s[24:27], 0 offen
    v_cmp_ne_u32_sdwa s[80:81], v13, v15 src0_sel:WORD_1 src1_sel:WORD_1
    v_cmp_ne_u32_sdwa vcc, v13, v17 src0_sel:WORD_1 src1_sel:WORD_1
    v_alignbyte_b32 v16, v17, v16, 2
    s_mov_b32 s54, 46077
    v_alignbyte_b32 v13, v13, v12, 1
    v_perm_b32 v12, v12, v16, s47
    s_waitcnt lgkmcnt(2)
    v_add3_u32 v18, v18, v106, s54
    v_sub_u32 v19, 0, v18
    v_and_b32 v19, 3, v19
    s_mov_b64 exec, s[80:81]
    v_mov_b32 v19, 0
    v_mov_b32 v14, 0
    s_mov_b64 exec, vcc
    v_mov_b32 v19, 3

    s_mov_b64 exec, -1
    v_alignbyte_b32 v12, v13, v12, v19
    v_alignbyte_b32 v13, v14, v13, v19
    v_add_u32 v18, v18, v19

    buffer_store_dwordx2 v[12:13], v18, s[24:27], 0 offen
    v_cmp_ne_u32_sdwa s[80:81], v21, v23 src0_sel:WORD_1 src1_sel:WORD_1
    v_cmp_ne_u32_sdwa vcc, v21, v25 src0_sel:WORD_1 src1_sel:WORD_1
    v_alignbyte_b32 v24, v25, v24, 2
    s_mov_b32 s54, 51197
    v_alignbyte_b32 v21, v21, v20, 1
    v_perm_b32 v20, v20, v24, s47
    s_waitcnt lgkmcnt(1)
    v_add3_u32 v26, v26, v106, s54
    v_sub_u32 v27, 0, v26
    v_and_b32 v27, 3, v27
    s_mov_b64 exec, s[80:81]
    v_mov_b32 v27, 0
    v_mov_b32 v22, 0
    s_mov_b64 exec, vcc
    v_mov_b32 v27, 3

    s_mov_b64 exec, -1
    v_alignbyte_b32 v20, v21, v20, v27
    v_alignbyte_b32 v21, v22, v21, v27
    v_add_u32 v26, v26, v27

    buffer_store_dwordx2 v[20:21], v26, s[24:27], 0 offen
    v_cmp_ne_u32_sdwa s[80:81], v29, v31 src0_sel:WORD_1 src1_sel:WORD_1
    v_cmp_ne_u32_sdwa vcc, v29, v33 src0_sel:WORD_1 src1_sel:WORD_1
    v_alignbyte_b32 v32, v33, v32, 2
    s_mov_b32 s54, 56317
    v_alignbyte_b32 v29, v29, v28, 1
    v_perm_b32 v28, v28, v32, s47
    s_waitcnt lgkmcnt(0)
    v_add3_u32 v34, v34, v106, s54
    v_sub_u32 v35, 0, v34
    v_and_b32 v35, 3, v35
    s_mov_b64 exec, s[80:81]
    v_mov_b32 v35, 0
    v_mov_b32 v30, 0
    s_mov_b64 exec, vcc
    v_mov_b32 v35, 3

    s_mov_b64 exec, -1
    v_alignbyte_b32 v28, v29, v28, v35
    v_alignbyte_b32 v29, v30, v29, v35
    v_add_u32 v34, v34, v35

    buffer_store_dwordx2 v[28:29], v34, s[24:27], 0 offen
L_skw_48:
    s_bitcmp0_b32 s28, 3
    s_cbranch_scc1 L_skw_49
    v_add_u32 v107, 98304, v2
    ds_read_b64 v[4:5], v107 offset:16400
    ds_read_b64 v[6:7], v107 offset:16408
    ds_read_b64 v[8:9], v107 offset:16392

    ds_read_b64 v[12:13], v107 offset:24592
    ds_read_b64 v[14:15], v107 offset:24600
    ds_read_b64 v[16:17], v107 offset:24584

    ds_read_b64 v[20:21], v107 offset:32784
    ds_read_b64 v[22:23], v107 offset:32792
    ds_read_b64 v[24:25], v107 offset:32776

    ds_read_b64 v[28:29], v107 offset:40976
    ds_read_b64 v[30:31], v107 offset:40984
    ds_read_b64 v[32:33], v107 offset:40968

    s_waitcnt lgkmcnt(9)
    v_lshrrev_b32 v10, 16, v5
    ds_read_b32 v10, v10 offset:8192

    s_waitcnt lgkmcnt(7)
    v_lshrrev_b32 v18, 16, v13
    ds_read_b32 v18, v18 offset:8192

    s_waitcnt lgkmcnt(5)
    v_lshrrev_b32 v26, 16, v21
    ds_read_b32 v26, v26 offset:8192

    s_waitcnt lgkmcnt(3)
    v_lshrrev_b32 v34, 16, v29
    ds_read_b32 v34, v34 offset:8192

    v_cmp_ne_u32_sdwa s[80:81], v5, v7 src0_sel:WORD_1 src1_sel:WORD_1
    v_cmp_ne_u32_sdwa vcc, v5, v9 src0_sel:WORD_1 src1_sel:WORD_1
    v_alignbyte_b32 v8, v9, v8, 2
    s_mov_b32 s54, 61437
    v_alignbyte_b32 v5, v5, v4, 1
    v_perm_b32 v4, v4, v8, s47
    s_waitcnt lgkmcnt(3)
    v_add3_u32 v10, v10, v106, s54
    v_sub_u32 v11, 0, v10
    v_and_b32 v11, 3, v11
    s_mov_b64 exec, s[80:81]
    v_mov_b32 v11, 0
    v_mov_b32 v6, 0
    s_mov_b64 exec, vcc
    v_mov_b32 v11, 3

    s_mov_b64 exec, -1
    v_alignbyte_b32 v4, v5, v4, v11
    v_alignbyte_b32 v5, v6, v5, v11
    v_add_u32 v10, v10, v11

    buffer_store_dwordx2 v[4:5], v10, s[24:27], 0 offen
    v_cmp_ne_u32_sdwa s[80:81], v13, v15 src0_sel:WORD_1 src1_sel:WORD_1
    v_cmp_ne_u32_sdwa vcc, v13, v17 src0_sel:WORD_1 src1_sel:WORD_1
    v_alignbyte_b32 v16, v17, v16, 2
    s_mov_b32 s54, 66557
    v_alignbyte_b32 v13, v13, v12, 1
    v_perm_b32 v12, v12, v16, s47
    s_waitcnt lgkmcnt(2)
    v_add3_u32 v18, v18, v106, s54
    v_sub_u32 v19, 0, v18
    v_and_b32 v19, 3, v19
    s_mov_b64 exec, s[80:81]
    v_mov_b32 v19, 0
    v_mov_b32 v14, 0
    s_mov_b64 exec, vcc
    v_mov_b32 v19, 3

    s_mov_b64 exec, -1
    v_alignbyte_b32 v12, v13, v12, v19
    v_alignbyte_b32 v13, v14, v13, v19
    v_add_u32 v18, v18, v19

    buffer_store_dwordx2 v[12:13], v18, s[24:27], 0 offen
    v_cmp_ne_u32_sdwa s[80:81], v21, v23 src0_sel:WORD_1 src1_sel:WORD_1
    v_cmp_ne_u32_sdwa vcc, v21, v25 src0_sel:WORD_1 src1_sel:WORD_1
    v_alignbyte_b32 v24, v25, v24, 2
    s_mov_b32 s54, 71677
    v_alignbyte_b32 v21, v21, v20, 1
    v_perm_b32 v20, v20, v24, s47
    s_waitcnt lgkmcnt(1)
    v_add3_u32 v26, v26, v106, s54
    v_sub_u32 v27, 0, v26
    v_and_b32 v27, 3, v27
    s_mov_b64 exec, s[80:81]
    v_mov_b32 v27, 0
    v_mov_b32 v22, 0
    s_mov_b64 exec, vcc
    v_mov_b32 v27, 3

    s_mov_b64 exec, -1
    v_alignbyte_b32 v20, v21, v20, v27
    v_alignbyte_b32 v21, v22, v21, v27
    v_add_u32 v26, v26, v27

    buffer_store_dwordx2 v[20:21], v26, s[24:27], 0 offen
    v_cmp_ne_u32_sdwa s[80:81], v29, v31 src0_sel:WORD_1 src1_sel:WORD_1
    v_cmp_ne_u32_sdwa vcc, v29, v33 src0_sel:WORD_1 src1_sel:WORD_1
    v_alignbyte_b32 v32, v33, v32, 2
    s_mov_b32 s54, 76797
    v_alignbyte_b32 v29, v29, v28, 1
    v_perm_b32 v28, v28, v32, s47
    s_waitcnt lgkmcnt(0)
    v_add3_u32 v34, v34, v106, s54
    v_sub_u32 v35, 0, v34
    v_and_b32 v35, 3, v35
    s_mov_b64 exec, s[80:81]
    v_mov_b32 v35, 0
    v_mov_b32 v30, 0
    s_mov_b64 exec, vcc
    v_mov_b32 v35, 3

    s_andn2_b64 exec, -1, s[68:69]
    v_bfrev_b32 v34, 1
    s_mov_b64 exec, -1
    v_alignbyte_b32 v28, v29, v28, v35
    v_alignbyte_b32 v29, v30, v29, v35
    v_add_u32 v34, v34, v35

    buffer_store_dwordx2 v[28:29], v34, s[24:27], 0 offen
L_skw_49:
L_p1done_1:
    s_endpgm

L_slow_22:
    v_add_u32 v112, s29, v0
    v_mov_b32 v118, 0
    s_mov_b32 s75, 4960
L_sl_24:
    v_lshlrev_b32 v113, 3, v112
    ds_read_b64 v[110:111], v113 offset:16400
    ds_read_b32 v119, v113 offset:16412
    ds_read_b32 v120, v113 offset:16396
    s_waitcnt lgkmcnt(0)
    v_lshrrev_b32 v114, 16, v111
    ds_read_b32 v115, v114 offset:8192
    v_add_u32 v114, 4, v114
    v_mul_u32_u24 v114, s75, v114
    s_waitcnt lgkmcnt(0)
    v_mad_u32_u24 v115, v112, 5, v115
    v_cmp_gt_u32 s[72:73], s30, v112
    v_cmp_ge_u32 vcc, v115, v114
    s_and_b64 s[80:81], vcc, s[72:73]
    s_cbranch_scc0 L_s1_25
    s_bcnt1_i32_b64 s76, s[80:81]
    v_mbcnt_lo_u32_b32 v117, s80, 0
    v_mbcnt_hi_u32_b32 v117, s81, v117
    v_mov_b32 v116, s76
    s_mov_b64 exec, 1
    buffer_atomic_add v116, v118, s[36:39], 0 offen sc0
    s_waitcnt vmcnt(0)
    v_readfirstlane_b32 s76, v116
    s_mov_b64 exec, s[80:81]
    s_nop 0
    v_add_lshl_u32 v116, v117, s76, 3
    buffer_store_dwordx2 v[110:111], v116, s[32:35], 0 offen
L_s1_25:
    s_andn2_b64 exec, s[72:73], vcc
    s_cbranch_execz L_s2_26
    buffer_store_dword v110, v115, s[24:27], 0 offen
    buffer_store_byte v111, v115, s[24:27], 0 offen offset:4
    v_add_u32 v115, 5, v115
    v_cmpx_lt_u32 vcc, v115, v114
    v_cmpx_ne_u32_sdwa vcc, v111, v119 src0_sel:WORD_1 src1_sel:WORD_1
    v_cmpx_ne_u32_sdwa vcc, v111, v120 src0_sel:WORD_1 src1_sel:WORD_1
    s_cbranch_execz L_s2_26
    buffer_store_dword v118, v115, s[24:27], 0 offen
L_s2_26:
    s_mov_b64 exec, -1
    v_add_u32 v112, 1024, v112
    s_nop 0
    v_readfirstlane_b32 s76, v112
    s_nop 1
    s_cmp_lt_u32 s76, s30
    s_cbranch_scc1 L_sl_24
    s_mov_b32 s28, 0
    s_branch L_sback_23

L_slow_41:
    v_add_u32 v112, s29, v0
    v_mov_b32 v118, 0
    s_mov_b32 s75, 4960
L_sl_43:
    v_lshlrev_b32 v113, 3, v112
    ds_read_b64 v[110:111], v113 offset:16400
    ds_read_b32 v119, v113 offset:16412
    ds_read_b32 v120, v113 offset:16396
    s_waitcnt lgkmcnt(0)
    v_lshrrev_b32 v114, 16, v111
    ds_read_b32 v115, v114 offset:8192
    v_add_u32 v114, 4, v114
    v_mul_u32_u24 v114, s75, v114
    s_waitcnt lgkmcnt(0)
    v_mad_u32_u24 v115, v112, 5, v115
    v_cmp_gt_u32 s[72:73], s30, v112
    v_cmp_ge_u32 vcc, v115, v114
    s_and_b64 s[80:81], vcc, s[72:73]
    s_cbranch_scc0 L_s1_44
    s_bcnt1_i32_b64 s76, s[80:81]
    v_mbcnt_lo_u32_b32 v117, s80, 0
    v_mbcnt_hi_u32_b32 v117, s81, v117
    v_mov_b32 v116, s76
    s_mov_b64 exec, 1
    buffer_atomic_add v116, v118, s[36:39], 0 offen sc0
    s_waitcnt vmcnt(0)
    v_readfirstlane_b32 s76, v116
    s_mov_b64 exec, s[80:81]
    s_nop 0
    v_add_lshl_u32 v116, v117, s76, 3
    buffer_store_dwordx2 v[110:111], v116, s[32:35], 0 offen
L_s1_44:
    s_andn2_b64 exec, s[72:73], vcc
    s_cbranch_execz L_s2_45
    buffer_store_dword v110, v115, s[24:27], 0 offen
    buffer_store_byte v111, v115, s[24:27], 0 offen offset:4
    v_add_u32 v115, 5, v115
    v_cmpx_lt_u32 vcc, v115, v114
    v_cmpx_ne_u32_sdwa vcc, v111, v119 src0_sel:WORD_1 src1_sel:WORD_1
    v_cmpx_ne_u32_sdwa vcc, v111, v120 src0_sel:WORD_1 src1_sel:WORD_1
    s_cbranch_execz L_s2_45
    buffer_store_dword v118, v115, s[24:27], 0 offen
L_s2_45:
    s_mov_b64 exec, -1
    v_add_u32 v112, 1024, v112
    s_nop 0
    v_readfirstlane_b32 s76, v112
    s_nop 1
    s_cmp_lt_u32 s76, s30
    s_cbranch_scc1 L_sl_43
    s_mov_b32 s28, 0
    s_branch L_sback_42

.globl standalone__molecular_angular_gemnet__graph_kernel
.p2align 8
.type standalone__molecular_angular_gemnet__graph_kernel,@function
standalone__molecular_angular_gemnet__graph_kernel:
    s_cmp_ge_u32 s2, 256
    s_cbranch_scc1 L_p2done_50
    s_load_dwordx2 s[8:9], s[0:1], 0
    s_load_dwordx2 s[6:7], s[0:1], 104
    v_lshrrev_b32 v4, 6, v0
    s_lshr_b32 s37, s2, 1
    s_and_b32 s37, s37, 3
    s_lshr_b32 s36, s2, 3
    s_lshl_b32 s36, s36, 1
    s_and_b32 s3, s2, 1
    s_or_b32 s36, s36, s3
    v_readfirstlane_b32 s4, v4
    v_and_b32 v2, 63, v0
    v_lshrrev_b32 v3, 9, v0
    v_lshl_or_b32 v2, v3, 6, v2
    v_mul_u32_u24 v2, 20, v2
    v_lshlrev_b32 v3, 4, v0

    s_waitcnt lgkmcnt(0)
    s_lshl_b32 m0, s4, 10
    s_and_b32 s5, s4, 7
    s_lshr_b32 s39, s4, 3
    s_lshl_b32 s39, s39, 8
    s_mul_i32 s3, s5, 8192
    s_add_u32 s46, s6, s3
    s_addc_u32 s47, s7, 0
    s_mul_i32 s3, s5, 40632320
    s_add_u32 s3, s3, 83599360
    s_add_u32 s44, s6, s3
    s_addc_u32 s45, s7, 0
    s_mul_i32 s38, s37, 8
    s_add_u32 s4, s38, 8
    s_lshl_b32 s3, s38, 6
    s_add_u32 s3, s3, s36
    s_lshl_b32 s3, s3, 2
    s_add_u32 s52, s46, s3
    s_addc_u32 s53, s47, 0

    s_load_dword s88, s[52:53], 0
    s_load_dword s89, s[52:53], 256
    s_load_dword s90, s[52:53], 512
    s_load_dword s91, s[52:53], 768
    s_load_dword s92, s[52:53], 1024
    s_load_dword s93, s[52:53], 1280
    s_load_dword s94, s[52:53], 1536
    s_load_dword s95, s[52:53], 1792
    s_mov_b32 s3, 65536
    s_load_dword s51, s[6:7], s3
    s_mov_b32 s10, 6400000
    s_mov_b32 s11, 0x20000

    s_add_u32 s12, s6, 393216
    s_addc_u32 s13, s7, 0
    s_mov_b32 s14, 0
    s_mov_b32 s15, 0x20000
    s_add_u32 s60, s6, 393216
    s_addc_u32 s61, s7, 0
    s_mov_b32 s62, 6406144
    s_mov_b32 s63, 0x20000
    s_mov_b32 s3, 135176
    s_load_dword s33, s[6:7], s3

    s_mul_i32 s43, s38, 200192
    s_mul_i32 s41, s4, 200192
    s_mul_i32 s50, s38, 200000
    s_add_u32 s14, s43, 50000

    buffer_load_dwordx4 v[76:79], v3, s[12:15], s43 offen
    s_add_u32 s52, s43, 16384
    buffer_load_dwordx4 v[80:83], v3, s[12:15], s52 offen
    s_add_u32 s52, s43, 32768
    buffer_load_dwordx4 v[84:87], v3, s[12:15], s52 offen
    s_add_u32 s52, s43, 49152
    v_lshlrev_b32 v119, 2, v0
    buffer_load_dword v88, v119, s[12:15], s52 offen
    s_add_u32 s20, s6, 135168
    s_addc_u32 s21, s7, 0
    s_mov_b32 s22, 4096
    s_mov_b32 s23, 0x20000
    v_and_b32 v44, 63, v0
    v_lshlrev_b32 v44, 4, v44
    buffer_load_dwordx2 v[120:121], v44, s[20:23], 0 offen offset:0
    buffer_load_dwordx2 v[122:123], v44, s[20:23], 0 offen offset:1024
    buffer_load_dwordx2 v[124:125], v44, s[20:23], 0 offen offset:2048
    buffer_load_dwordx2 v[126:127], v44, s[20:23], 0 offen offset:3072
    s_movk_i32 s40, 3072
    s_mov_b32 s19, 0x20000
    s_min_u32 s40, s40, 3968
    s_lshl_b32 s52, s38, 6
    s_add_u32 s52, s52, s36
    s_mul_i32 s52, s52, 19840
    s_add_u32 s16, s44, s52
    s_addc_u32 s17, s45, 0
    s_mul_i32 s52, s40, 5
    s_add_u32 s52, s52, 3
    s_and_b32 s18, s52, -4

    s_movk_i32 s53, 5120
    buffer_load_dwordx4 v[90:93], v2, s[16:19], s53 offen
    buffer_load_dword v110, v2, s[16:19], s53 offen offset:16
    s_movk_i32 s53, 7680
    buffer_load_dwordx4 v[94:97], v2, s[16:19], s53 offen
    buffer_load_dword v111, v2, s[16:19], s53 offen offset:16
    s_movk_i32 s53, 10240
    buffer_load_dwordx4 v[98:101], v2, s[16:19], s53 offen
    buffer_load_dword v112, v2, s[16:19], s53 offen offset:16
    s_lshr_b32 s3, s2, 3
    s_mul_i32 s3, s3, 49
    v_add_lshl_u32 v89, v0, s3, 7
    v_cmp_gt_u32 vcc, 49, v0
    v_bfrev_b32 v28, 1
    s_nop 0
    v_cndmask_b32 v89, v28, v89, vcc

    s_mov_b32 s19, 0x20000
    s_mov_b32 s28, 0x4b404000
    s_mov_b32 s29, 0x4b404000
    s_mov_b32 s30, 0xbfffc000
    s_mov_b32 s31, 0xbfffbfff
    s_mov_b32 s32, 0xffff0000
    s_mov_b32 s35, 0x05040100
    s_mov_b32 s97, 0x07060302
    s_mov_b32 s96, 0x40008000
    s_movk_i32 s3, 212
    v_cmp_gt_u32 s[48:49], s3, v0

    v_mov_b32 v1, 0
    s_mov_b32 s24, 0xc0c0004
    s_mov_b32 s25, 0xc0c0105
    s_mov_b32 s26, 0xc0c0206
    s_mov_b32 s27, 0xc0c0307
    v_mov_b32 v28, 0x40004000
    v_mov_b32 v29, 0x40004000
    v_mov_b32 v30, 0x40004000
    v_mov_b32 v31, 0x40004000
    v_add_u32 v32, 50000, v3
    v_add_u32 v33, 65536, v32

    ds_write_b128 v32, v[28:31] offset:0
    ds_write_b128 v32, v[28:31] offset:16384
    ds_write_b128 v32, v[28:31] offset:32768
    ds_write_b128 v32, v[28:31] offset:49152
    ds_write_b128 v33, v[28:31] offset:0
    ds_write_b128 v33, v[28:31] offset:16384
    v_cmp_gt_u32 vcc, 971, v0
    s_mov_b64 exec, vcc
    ds_write_b128 v33, v[28:31] offset:32768
    s_mov_b64 exec, -1
    s_waitcnt vmcnt(13)
    ds_write_addtid_b32 v76 offset:0
    ds_write_addtid_b32 v77 offset:256
    ds_write_addtid_b32 v78 offset:512
    ds_write_addtid_b32 v79 offset:768
    s_waitcnt vmcnt(12)
    ds_write_addtid_b32 v80 offset:16384
    ds_write_addtid_b32 v81 offset:16640
    ds_write_addtid_b32 v82 offset:16896
    ds_write_addtid_b32 v83 offset:17152
    s_waitcnt vmcnt(11)
    ds_write_addtid_b32 v84 offset:32768
    ds_write_addtid_b32 v85 offset:33024
    ds_write_addtid_b32 v86 offset:33280
    ds_write_addtid_b32 v87 offset:33536
    v_lshlrev_b32 v119, 2, v0
    s_waitcnt vmcnt(10)
    s_mov_b64 exec, s[48:49]
    ds_write_b32 v119, v88 offset:49152
    s_mov_b64 exec, -1
    s_add_u32 s43, s43, 50048
    s_add_u32 s14, s43, 50000
    s_min_u32 s14, s14, s41
    s_waitcnt lgkmcnt(0)
    s_waitcnt vmcnt(6)
    v_max3_u32 v120, v120, v122, v124
    v_add_f32 v121, v121, v123
    v_add_f32 v125, v125, v127
    v_max_u32 v120, v120, v126
    v_add_f32 v121, v121, v125

    s_nop 1
    v_max_u32_dpp v120, v120, v120 row_shr:1 row_mask:0xf bank_mask:0xf
    s_nop 1
    v_max_u32_dpp v120, v120, v120 row_shr:2 row_mask:0xf bank_mask:0xf
    s_nop 1
    v_max_u32_dpp v120, v120, v120 row_shr:4 row_mask:0xf bank_mask:0xf
    s_nop 1
    v_max_u32_dpp v120, v120, v120 row_shr:8 row_mask:0xf bank_mask:0xf
    s_nop 1
    v_max_u32_dpp v120, v120, v120 row_bcast:15 row_mask:0xa bank_mask:0xf
    s_nop 1
    v_max_u32_dpp v120, v120, v120 row_bcast:31 row_mask:0xc bank_mask:0xf
    s_nop 1
    v_add_f32_dpp v121, v121, v121 row_shr:1 row_mask:0xf bank_mask:0xf
    s_nop 1
    v_add_f32_dpp v121, v121, v121 row_shr:2 row_mask:0xf bank_mask:0xf
    s_nop 1
    v_add_f32_dpp v121, v121, v121 row_shr:4 row_mask:0xf bank_mask:0xf
    s_nop 1
    v_add_f32_dpp v121, v121, v121 row_shr:8 row_mask:0xf bank_mask:0xf
    s_nop 1
    v_add_f32_dpp v121, v121, v121 row_bcast:15 row_mask:0xa bank_mask:0xf
    s_nop 1
    v_add_f32_dpp v121, v121, v121 row_bcast:31 row_mask:0xc bank_mask:0xf
    v_lshlrev_b32 v120, 16, v120
    v_mul_f32 v121, 0x34a7c5ac, v121
    v_sqrt_f32 v121, v121
    v_mul_f32 v120, s33, v120
    v_mul_f32 v121, s33, v121
    v_cmp_gt_f32 vcc, 0x46fde800, v120
    s_mov_b64 s[64:65], vcc
    v_cmp_lt_f32 vcc, 0x44000000, v121
    v_mov_b32 v120, 0x37800000
    v_mul_f32 v120, s33, v120
    s_and_b64 vcc, vcc, s[64:65]
    v_mul_f32 v121, 0x46ff8000, v120
    v_rcp_f32 v121, v121
    v_readfirstlane_b32 s33, v120
    s_waitcnt lgkmcnt(0)
    s_barrier
    v_readfirstlane_b32 s34, v121
    v_mov_b32 v120, 150016
    v_mov_b32 v121, 0
    ds_write_b32 v120, v121 offset:8
    s_bitcmp0_b64 vcc, 63
    s_cbranch_scc1 L_p2slow_51
    s_cmp_lg_u32 s51, 0
    s_cbranch_scc1 L_p2slow_51

    s_min_u32 s88, s88, 3968
    s_lshl_b32 s52, s38, 6
    s_add_u32 s52, s52, s36
    s_mul_i32 s52, s52, 19840
    s_add_u32 s16, s44, s52
    s_addc_u32 s17, s45, 0
    s_mul_i32 s52, s88, 5
    s_add_u32 s52, s52, 3
    s_and_b32 s18, s52, -4

    s_movk_i32 s53, 12800
    buffer_load_dwordx4 v[102:105], v2, s[16:19], s53 offen
    buffer_load_dword v113, v2, s[16:19], s53 offen offset:16
    s_movk_i32 s53, 0
    buffer_load_dwordx4 v[4:7], v2, s[16:19], s53 offen
    buffer_load_dword v35, v2, s[16:19], s53 offen offset:16
    s_movk_i32 s53, 2560
    buffer_load_dwordx4 v[8:11], v2, s[16:19], s53 offen
    buffer_load_dword v43, v2, s[16:19], s53 offen offset:16
    s_movk_i32 s53, 15360
    buffer_load_dwordx4 v[106:109], v2, s[16:19], s53 offen
    buffer_load_dword v114, v2, s[16:19], s53 offen offset:16
    s_mov_b32 s40, s88
    s_sub_u32 s42, s40, s39

    s_add_u32 s55, s38, 1
    s_min_u32 s55, s55, 31
    s_mov_b32 s88, s89
    s_mov_b32 s89, s90
    s_mov_b32 s90, s91
    s_mov_b32 s91, s92
    s_mov_b32 s92, s93
    s_mov_b32 s93, s94
    s_mov_b32 s94, s95
    s_mov_b32 s95, 0
    s_min_u32 s88, s88, 3968
    s_lshl_b32 s52, s55, 6
    s_add_u32 s52, s52, s36
    s_mul_i32 s52, s52, 19840
    s_add_u32 s16, s44, s52
    s_addc_u32 s17, s45, 0
    s_mul_i32 s52, s88, 5
    s_add_u32 s52, s52, 3
    s_and_b32 s18, s52, -4

    s_waitcnt vmcnt(12)
    v_perm_b32 v44, v91, v90, s24
    v_perm_b32 v46, v92, v91, s25
    v_perm_b32 v48, v93, v92, s26
    v_perm_b32 v50, v110, v93, s27
    v_mov_b32 v12, v90
    v_alignbyte_b32 v13, v92, v91, 1
    v_alignbyte_b32 v14, v93, v92, 2
    v_alignbyte_b32 v15, v110, v93, 3
    v_lshlrev_b32_sdwa v44, 3, v44 dst_sel:WORD_0 dst_unused:UNUSED_PAD src0_sel:DWORD src1_sel:DWORD
    v_lshlrev_b32_sdwa v46, 3, v46 dst_sel:WORD_0 dst_unused:UNUSED_PAD src0_sel:DWORD src1_sel:DWORD
    v_lshlrev_b32_sdwa v48, 3, v48 dst_sel:WORD_0 dst_unused:UNUSED_PAD src0_sel:DWORD src1_sel:DWORD
    v_lshlrev_b32_sdwa v50, 3, v50 dst_sel:WORD_0 dst_unused:UNUSED_PAD src0_sel:DWORD src1_sel:DWORD
    s_cmp_lt_i32 s42, 1280
    s_cbranch_scc1 L_ufix_52
L_uback_53:

    v_subrev_co_u32 v12, s[80:81], 2.0, v12
    v_subrev_co_u32 v13, s[82:83], 2.0, v13
    v_subrev_co_u32 v14, s[84:85], 2.0, v14
    v_subrev_co_u32 v15, s[86:87], 2.0, v15
    s_mov_b64 exec, s[80:81]
    ds_read_b64 v[44:45], v44
    s_mov_b64 exec, s[82:83]
    ds_read_b64 v[46:47], v46
    s_mov_b64 exec, s[84:85]
    ds_read_b64 v[48:49], v48
    s_mov_b64 exec, s[86:87]
    ds_read_b64 v[50:51], v50
    s_mov_b64 exec, -1
    s_waitcnt vmcnt(10)
    v_perm_b32 v52, v95, v94, s24
    v_perm_b32 v54, v96, v95, s25
    v_perm_b32 v56, v97, v96, s26
    v_perm_b32 v58, v111, v97, s27
    v_mov_b32 v16, v94
    v_alignbyte_b32 v17, v96, v95, 1
    v_alignbyte_b32 v18, v97, v96, 2
    v_alignbyte_b32 v19, v111, v97, 3
    v_lshlrev_b32_sdwa v52, 3, v52 dst_sel:WORD_0 dst_unused:UNUSED_PAD src0_sel:DWORD src1_sel:DWORD
    v_lshlrev_b32_sdwa v54, 3, v54 dst_sel:WORD_0 dst_unused:UNUSED_PAD src0_sel:DWORD src1_sel:DWORD
    v_lshlrev_b32_sdwa v56, 3, v56 dst_sel:WORD_0 dst_unused:UNUSED_PAD src0_sel:DWORD src1_sel:DWORD
    v_lshlrev_b32_sdwa v58, 3, v58 dst_sel:WORD_0 dst_unused:UNUSED_PAD src0_sel:DWORD src1_sel:DWORD
    s_cmp_lt_i32 s42, 1792
    s_cbranch_scc1 L_ufix_54
L_uback_55:

    v_subrev_co_u32 v16, s[64:65], 2.0, v16
    v_subrev_co_u32 v17, s[66:67], 2.0, v17
    v_subrev_co_u32 v18, s[68:69], 2.0, v18
    v_subrev_co_u32 v19, s[70:71], 2.0, v19
    s_mov_b64 exec, s[64:65]
    ds_read_b64 v[52:53], v52
    s_mov_b64 exec, s[66:67]
    ds_read_b64 v[54:55], v54
    s_mov_b64 exec, s[68:69]
    ds_read_b64 v[56:57], v56
    s_mov_b64 exec, s[70:71]
    ds_read_b64 v[58:59], v58
    s_mov_b64 exec, -1
    s_waitcnt vmcnt(8)
    v_perm_b32 v60, v99, v98, s24
    v_perm_b32 v62, v100, v99, s25
    v_perm_b32 v64, v101, v100, s26
    v_perm_b32 v66, v112, v101, s27
    v_mov_b32 v20, v98
    v_alignbyte_b32 v21, v100, v99, 1
    v_alignbyte_b32 v22, v101, v100, 2
    v_alignbyte_b32 v23, v112, v101, 3
    v_lshlrev_b32_sdwa v60, 3, v60 dst_sel:WORD_0 dst_unused:UNUSED_PAD src0_sel:DWORD src1_sel:DWORD
    v_lshlrev_b32_sdwa v62, 3, v62 dst_sel:WORD_0 dst_unused:UNUSED_PAD src0_sel:DWORD src1_sel:DWORD
    v_lshlrev_b32_sdwa v64, 3, v64 dst_sel:WORD_0 dst_unused:UNUSED_PAD src0_sel:DWORD src1_sel:DWORD
    v_lshlrev_b32_sdwa v66, 3, v66 dst_sel:WORD_0 dst_unused:UNUSED_PAD src0_sel:DWORD src1_sel:DWORD
    s_cmp_lt_i32 s42, 2304
    s_cbranch_scc1 L_ufix_56
L_uback_57:

    v_subrev_co_u32 v20, s[72:73], 2.0, v20
    v_subrev_co_u32 v21, s[74:75], 2.0, v21
    v_subrev_co_u32 v22, s[76:77], 2.0, v22
    v_subrev_co_u32 v23, s[78:79], 2.0, v23
    s_mov_b64 exec, s[72:73]
    ds_read_b64 v[60:61], v60
    s_mov_b64 exec, s[74:75]
    ds_read_b64 v[62:63], v62
    s_mov_b64 exec, s[76:77]
    ds_read_b64 v[64:65], v64
    s_mov_b64 exec, s[78:79]
    ds_read_b64 v[66:67], v66
    s_mov_b64 exec, -1
    s_waitcnt vmcnt(6)
    v_perm_b32 v68, v103, v102, s24
    v_perm_b32 v70, v104, v103, s25
    v_perm_b32 v72, v105, v104, s26
    v_perm_b32 v74, v113, v105, s27
    v_mov_b32 v24, v102
    v_alignbyte_b32 v25, v104, v103, 1
    v_alignbyte_b32 v26, v105, v104, 2
    v_alignbyte_b32 v27, v113, v105, 3
    v_lshlrev_b32_sdwa v68, 3, v68 dst_sel:WORD_0 dst_unused:UNUSED_PAD src0_sel:DWORD src1_sel:DWORD
    v_lshlrev_b32_sdwa v70, 3, v70 dst_sel:WORD_0 dst_unused:UNUSED_PAD src0_sel:DWORD src1_sel:DWORD
    v_lshlrev_b32_sdwa v72, 3, v72 dst_sel:WORD_0 dst_unused:UNUSED_PAD src0_sel:DWORD src1_sel:DWORD
    v_lshlrev_b32_sdwa v74, 3, v74 dst_sel:WORD_0 dst_unused:UNUSED_PAD src0_sel:DWORD src1_sel:DWORD
    s_cmp_lt_i32 s42, 2816
    s_cbranch_scc1 L_ufix_58
L_uback_59:

    v_subrev_co_u32 v24, s[80:81], 2.0, v24
    v_subrev_co_u32 v25, s[82:83], 2.0, v25
    v_subrev_co_u32 v26, s[84:85], 2.0, v26
    v_subrev_co_u32 v27, s[86:87], 2.0, v27
    s_mov_b64 exec, s[80:81]
    ds_read_b64 v[68:69], v68
    s_mov_b64 exec, s[82:83]
    ds_read_b64 v[70:71], v70
    s_mov_b64 exec, s[84:85]
    ds_read_b64 v[72:73], v72
    s_mov_b64 exec, s[86:87]
    ds_read_b64 v[74:75], v74
    s_mov_b64 exec, -1
    s_waitcnt vmcnt(4)
    v_perm_b32 v28, v5, v4, s24
    v_perm_b32 v30, v6, v5, s25
    v_perm_b32 v32, v7, v6, s26
    v_perm_b32 v34, v35, v7, s27
    v_alignbyte_b32 v5, v6, v5, 1
    v_alignbyte_b32 v6, v7, v6, 2
    v_alignbyte_b32 v7, v35, v7, 3
    v_lshlrev_b32_sdwa v28, 3, v28 dst_sel:WORD_0 dst_unused:UNUSED_PAD src0_sel:DWORD src1_sel:DWORD
    v_lshlrev_b32_sdwa v30, 3, v30 dst_sel:WORD_0 dst_unused:UNUSED_PAD src0_sel:DWORD src1_sel:DWORD
    v_lshlrev_b32_sdwa v32, 3, v32 dst_sel:WORD_0 dst_unused:UNUSED_PAD src0_sel:DWORD src1_sel:DWORD
    v_lshlrev_b32_sdwa v34, 3, v34 dst_sel:WORD_0 dst_unused:UNUSED_PAD src0_sel:DWORD src1_sel:DWORD
    s_cmp_lt_i32 s42, 256
    s_cbranch_scc1 L_ufix_60
L_uback_61:

    v_subrev_co_u32 v4, s[64:65], 2.0, v4
    v_subrev_co_u32 v5, s[66:67], 2.0, v5
    v_subrev_co_u32 v6, s[68:69], 2.0, v6
    v_subrev_co_u32 v7, s[70:71], 2.0, v7
    s_mov_b64 exec, s[64:65]
    ds_read_b64 v[28:29], v28
    s_mov_b64 exec, s[66:67]
    ds_read_b64 v[30:31], v30
    s_mov_b64 exec, s[68:69]
    ds_read_b64 v[32:33], v32
    s_mov_b64 exec, s[70:71]
    ds_read_b64 v[34:35], v34
    s_mov_b64 exec, -1
    buffer_load_dwordx4 v[76:79], v3, s[12:15], s43 offen
    s_add_u32 s52, s43, 16384
    buffer_load_dwordx4 v[80:83], v3, s[12:15], s52 offen
    s_add_u32 s52, s43, 32768
    buffer_load_dwordx4 v[84:87], v3, s[12:15], s52 offen
    s_add_u32 s52, s43, 49152
    v_lshlrev_b32 v119, 2, v0
    buffer_load_dword v88, v119, s[12:15], s52 offen
    s_add_u32 s54, s43, 50048
    buffer_load_dword v115, v89, s[60:63], s54 offen
    s_add_u32 s54, s50, 0
    buffer_load_dword v115, v89, s[8:11], s54 offen
    s_waitcnt vmcnt(8)
    v_perm_b32 v36, v9, v8, s24
    v_perm_b32 v38, v10, v9, s25
    v_perm_b32 v40, v11, v10, s26
    v_perm_b32 v42, v43, v11, s27
    v_alignbyte_b32 v9, v10, v9, 1
    v_alignbyte_b32 v10, v11, v10, 2
    v_alignbyte_b32 v11, v43, v11, 3
    v_lshlrev_b32_sdwa v36, 3, v36 dst_sel:WORD_0 dst_unused:UNUSED_PAD src0_sel:DWORD src1_sel:DWORD
    v_lshlrev_b32_sdwa v38, 3, v38 dst_sel:WORD_0 dst_unused:UNUSED_PAD src0_sel:DWORD src1_sel:DWORD
    v_lshlrev_b32_sdwa v40, 3, v40 dst_sel:WORD_0 dst_unused:UNUSED_PAD src0_sel:DWORD src1_sel:DWORD
    v_lshlrev_b32_sdwa v42, 3, v42 dst_sel:WORD_0 dst_unused:UNUSED_PAD src0_sel:DWORD src1_sel:DWORD
    s_cmp_lt_i32 s42, 768
    s_cbranch_scc1 L_ufix_62
L_uback_63:

    v_subrev_co_u32 v8, s[72:73], 2.0, v8
    v_subrev_co_u32 v9, s[74:75], 2.0, v9
    v_subrev_co_u32 v10, s[76:77], 2.0, v10
    v_subrev_co_u32 v11, s[78:79], 2.0, v11
    s_mov_b64 exec, s[72:73]
    ds_read_b64 v[36:37], v36
    s_mov_b64 exec, s[74:75]
    ds_read_b64 v[38:39], v38
    s_mov_b64 exec, s[76:77]
    ds_read_b64 v[40:41], v40
    s_mov_b64 exec, s[78:79]
    ds_read_b64 v[42:43], v42
    s_mov_b64 exec, -1
    s_movk_i32 s53, 5120
    buffer_load_dwordx4 v[90:93], v2, s[16:19], s53 offen
    buffer_load_dword v110, v2, s[16:19], s53 offen offset:16
L_batch_64:
    s_add_u32 s5, s38, 1

    s_movk_i32 s53, 7680
    buffer_load_dwordx4 v[94:97], v2, s[16:19], s53 offen
    buffer_load_dword v111, v2, s[16:19], s53 offen offset:16
    v_subrev_co_u32 v4, s[64:65], 2.0, v4
    v_subrev_co_u32 v5, s[66:67], 2.0, v5
    v_subrev_co_u32 v6, s[68:69], 2.0, v6
    v_subrev_co_u32 v7, s[70:71], 2.0, v7
    v_subrev_co_u32 v8, s[72:73], 2.0, v8
    v_subrev_co_u32 v9, s[74:75], 2.0, v9
    v_subrev_co_u32 v10, s[76:77], 2.0, v10
    v_subrev_co_u32 v11, s[78:79], 2.0, v11
    v_subrev_co_u32 v12, s[80:81], 2.0, v12
    v_subrev_co_u32 v13, s[82:83], 2.0, v13
    v_subrev_co_u32 v14, s[84:85], 2.0, v14
    v_subrev_co_u32 v15, s[86:87], 2.0, v15
    s_waitcnt lgkmcnt(0)
    s_barrier
    s_waitcnt vmcnt(5)
    ds_write_addtid_b32 v76 offset:0
    ds_write_addtid_b32 v77 offset:256
    ds_write_addtid_b32 v78 offset:512
    ds_write_addtid_b32 v79 offset:768
    s_waitcnt vmcnt(4)
    ds_write_addtid_b32 v80 offset:16384
    ds_write_addtid_b32 v81 offset:16640
    ds_write_addtid_b32 v82 offset:16896
    ds_write_addtid_b32 v83 offset:17152
    s_waitcnt vmcnt(3)
    ds_write_addtid_b32 v84 offset:32768
    ds_write_addtid_b32 v85 offset:33024
    ds_write_addtid_b32 v86 offset:33280
    ds_write_addtid_b32 v87 offset:33536
    v_lshlrev_b32 v119, 2, v0
    s_waitcnt vmcnt(2)
    s_mov_b64 exec, s[48:49]
    ds_write_b32 v119, v88 offset:49152
    s_mov_b64 exec, -1
    s_add_u32 s43, s43, 50048
    s_add_u32 s14, s43, 50000
    s_min_u32 s14, s14, s41
    buffer_load_dwordx4 v[76:79], v3, s[12:15], s43 offen
    s_waitcnt lgkmcnt(0)
    s_barrier
    s_add_u32 s52, s43, 16384
    buffer_load_dwordx4 v[80:83], v3, s[12:15], s52 offen
    s_add_u32 s52, s43, 32768
    buffer_load_dwordx4 v[84:87], v3, s[12:15], s52 offen
    s_add_u32 s52, s43, 49152
    v_lshlrev_b32 v119, 2, v0
    buffer_load_dword v88, v119, s[12:15], s52 offen
    s_mov_b64 exec, s[64:65]
    ds_read_b64 v[28:29], v28
    s_mov_b64 exec, s[66:67]
    ds_read_b64 v[30:31], v30
    s_mov_b64 exec, s[68:69]
    ds_read_b64 v[32:33], v32
    s_mov_b64 exec, s[70:71]
    ds_read_b64 v[34:35], v34
    s_mov_b64 exec, s[72:73]
    ds_read_b64 v[36:37], v36
    s_mov_b64 exec, s[74:75]
    ds_read_b64 v[38:39], v38
    s_mov_b64 exec, s[76:77]
    ds_read_b64 v[40:41], v40
    s_mov_b64 exec, s[78:79]
    ds_read_b64 v[42:43], v42
    s_mov_b64 exec, s[80:81]
    ds_read_b64 v[44:45], v44
    s_mov_b64 exec, s[82:83]
    ds_read_b64 v[46:47], v46
    s_mov_b64 exec, s[84:85]
    ds_read_b64 v[48:49], v48
    s_mov_b64 exec, s[86:87]
    ds_read_b64 v[50:51], v50
    s_mov_b64 exec, -1
    v_subrev_co_u32 v16, s[64:65], 2.0, v16
    v_subrev_co_u32 v17, s[66:67], 2.0, v17
    v_subrev_co_u32 v18, s[68:69], 2.0, v18
    v_subrev_co_u32 v19, s[70:71], 2.0, v19
    v_subrev_co_u32 v20, s[72:73], 2.0, v20
    v_subrev_co_u32 v21, s[74:75], 2.0, v21
    v_subrev_co_u32 v22, s[76:77], 2.0, v22
    v_subrev_co_u32 v23, s[78:79], 2.0, v23
    v_subrev_co_u32 v24, s[80:81], 2.0, v24
    v_subrev_co_u32 v25, s[82:83], 2.0, v25
    v_subrev_co_u32 v26, s[84:85], 2.0, v26
    v_subrev_co_u32 v27, s[86:87], 2.0, v27
    s_mov_b64 exec, s[64:65]
    ds_read_b64 v[52:53], v52
    s_mov_b64 exec, s[66:67]
    ds_read_b64 v[54:55], v54
    s_mov_b64 exec, s[68:69]
    ds_read_b64 v[56:57], v56
    s_mov_b64 exec, s[70:71]
    ds_read_b64 v[58:59], v58
    s_mov_b64 exec, s[72:73]
    ds_read_b64 v[60:61], v60
    s_mov_b64 exec, s[74:75]
    ds_read_b64 v[62:63], v62
    s_mov_b64 exec, s[76:77]
    ds_read_b64 v[64:65], v64
    s_mov_b64 exec, s[78:79]
    ds_read_b64 v[66:67], v66
    s_mov_b64 exec, s[80:81]
    ds_read_b64 v[68:69], v68
    s_mov_b64 exec, s[82:83]
    ds_read_b64 v[70:71], v70
    s_mov_b64 exec, s[84:85]
    ds_read_b64 v[72:73], v72
    s_mov_b64 exec, s[86:87]
    ds_read_b64 v[74:75], v74
    s_mov_b64 exec, -1
    s_cmp_le_i32 s42, 3072
    s_cbranch_scc1 L_nt1_66
    s_waitcnt vmcnt(14)
    v_perm_b32 v120, v107, v106, s24
    v_perm_b32 v122, v108, v107, s25
    v_perm_b32 v124, v109, v108, s26
    v_perm_b32 v126, v114, v109, s27
    v_alignbyte_b32 v107, v108, v107, 1
    v_alignbyte_b32 v108, v109, v108, 2
    v_alignbyte_b32 v109, v114, v109, 3
    v_lshlrev_b32_sdwa v120, 3, v120 dst_sel:WORD_0 dst_unused:UNUSED_PAD src0_sel:DWORD src1_sel:DWORD
    v_lshlrev_b32_sdwa v122, 3, v122 dst_sel:WORD_0 dst_unused:UNUSED_PAD src0_sel:DWORD src1_sel:DWORD
    v_lshlrev_b32_sdwa v124, 3, v124 dst_sel:WORD_0 dst_unused:UNUSED_PAD src0_sel:DWORD src1_sel:DWORD
    v_lshlrev_b32_sdwa v126, 3, v126 dst_sel:WORD_0 dst_unused:UNUSED_PAD src0_sel:DWORD src1_sel:DWORD
    s_cmp_lt_i32 s42, 3328
    s_cbranch_scc1 L_ufix_69
L_uback_70:

    v_lshrrev_b32 v117, 30, v106
    v_and_b32 v106, 0x3fffffff, v106
    v_mul_u32_u24 v117, 50000, v117
    v_cmp_ne_u32 vcc, 0, v106
    v_add_u32 v120, v120, v117
    s_mov_b64 exec, vcc

    buffer_load_dwordx2 v[120:121], v120, s[8:11], s50 offen
    s_mov_b64 exec, -1
    v_lshrrev_b32 v117, 30, v107
    v_and_b32 v107, 0x3fffffff, v107
    v_mul_u32_u24 v117, 50000, v117
    v_cmp_ne_u32 vcc, 0, v107
    v_add_u32 v122, v122, v117
    s_mov_b64 exec, vcc

    buffer_load_dwordx2 v[122:123], v122, s[8:11], s50 offen
    s_mov_b64 exec, -1
    v_lshrrev_b32 v117, 30, v108
    v_and_b32 v108, 0x3fffffff, v108
    v_mul_u32_u24 v117, 50000, v117
    v_cmp_ne_u32 vcc, 0, v108
    v_add_u32 v124, v124, v117
    s_mov_b64 exec, vcc

    buffer_load_dwordx2 v[124:125], v124, s[8:11], s50 offen
    s_mov_b64 exec, -1
    v_lshrrev_b32 v117, 30, v109
    v_and_b32 v109, 0x3fffffff, v109
    v_mul_u32_u24 v117, 50000, v117
    v_cmp_ne_u32 vcc, 0, v109
    v_add_u32 v126, v126, v117
    s_mov_b64 exec, vcc

    buffer_load_dwordx2 v[126:127], v126, s[8:11], s50 offen
    s_mov_b64 exec, -1
L_nt1_66:
    v_subrev_co_u32 v4, s[64:65], 2.0, v4
    v_subrev_co_u32 v5, s[66:67], 2.0, v5
    v_subrev_co_u32 v6, s[68:69], 2.0, v6
    v_subrev_co_u32 v7, s[70:71], 2.0, v7
    v_subrev_co_u32 v8, s[72:73], 2.0, v8
    v_subrev_co_u32 v9, s[74:75], 2.0, v9
    v_subrev_co_u32 v10, s[76:77], 2.0, v10
    v_subrev_co_u32 v11, s[78:79], 2.0, v11
    v_subrev_co_u32 v12, s[80:81], 2.0, v12
    v_subrev_co_u32 v13, s[82:83], 2.0, v13
    v_subrev_co_u32 v14, s[84:85], 2.0, v14
    v_subrev_co_u32 v15, s[86:87], 2.0, v15
    s_waitcnt lgkmcnt(0)
    s_barrier
    s_waitcnt vmcnt(3)
    ds_write_addtid_b32 v76 offset:0
    ds_write_addtid_b32 v77 offset:256
    ds_write_addtid_b32 v78 offset:512
    ds_write_addtid_b32 v79 offset:768
    s_waitcnt vmcnt(2)
    ds_write_addtid_b32 v80 offset:16384
    ds_write_addtid_b32 v81 offset:16640
    ds_write_addtid_b32 v82 offset:16896
    ds_write_addtid_b32 v83 offset:17152
    s_waitcnt vmcnt(1)
    ds_write_addtid_b32 v84 offset:32768
    ds_write_addtid_b32 v85 offset:33024
    ds_write_addtid_b32 v86 offset:33280
    ds_write_addtid_b32 v87 offset:33536
    v_lshlrev_b32 v119, 2, v0
    s_waitcnt vmcnt(0)
    s_mov_b64 exec, s[48:49]
    ds_write_b32 v119, v88 offset:49152
    s_mov_b64 exec, -1
    s_add_u32 s43, s43, 50048
    s_add_u32 s14, s43, 50000
    s_min_u32 s14, s14, s41
    buffer_load_dwordx4 v[76:79], v3, s[12:15], s43 offen
    s_waitcnt lgkmcnt(0)
    s_barrier
    s_add_u32 s52, s43, 16384
    buffer_load_dwordx4 v[80:83], v3, s[12:15], s52 offen
    s_add_u32 s52, s43, 32768
    buffer_load_dwordx4 v[84:87], v3, s[12:15], s52 offen
    s_add_u32 s52, s43, 49152
    v_lshlrev_b32 v119, 2, v0
    buffer_load_dword v88, v119, s[12:15], s52 offen
    s_mov_b64 exec, s[64:65]
    ds_read_b64 v[28:29], v28
    s_mov_b64 exec, s[66:67]
    ds_read_b64 v[30:31], v30
    s_mov_b64 exec, s[68:69]
    ds_read_b64 v[32:33], v32
    s_mov_b64 exec, s[70:71]
    ds_read_b64 v[34:35], v34
    s_mov_b64 exec, s[72:73]
    ds_read_b64 v[36:37], v36
    s_mov_b64 exec, s[74:75]
    ds_read_b64 v[38:39], v38
    s_mov_b64 exec, s[76:77]
    ds_read_b64 v[40:41], v40
    s_mov_b64 exec, s[78:79]
    ds_read_b64 v[42:43], v42
    s_mov_b64 exec, s[80:81]
    ds_read_b64 v[44:45], v44
    s_mov_b64 exec, s[82:83]
    ds_read_b64 v[46:47], v46
    s_mov_b64 exec, s[84:85]
    ds_read_b64 v[48:49], v48
    s_mov_b64 exec, s[86:87]
    ds_read_b64 v[50:51], v50
    s_mov_b64 exec, -1
    v_subrev_co_u32 v16, s[64:65], 2.0, v16
    v_subrev_co_u32 v17, s[66:67], 2.0, v17
    v_subrev_co_u32 v18, s[68:69], 2.0, v18
    v_subrev_co_u32 v19, s[70:71], 2.0, v19
    v_subrev_co_u32 v20, s[72:73], 2.0, v20
    v_subrev_co_u32 v21, s[74:75], 2.0, v21
    v_subrev_co_u32 v22, s[76:77], 2.0, v22
    v_subrev_co_u32 v23, s[78:79], 2.0, v23
    v_subrev_co_u32 v24, s[80:81], 2.0, v24
    v_subrev_co_u32 v25, s[82:83], 2.0, v25
    v_subrev_co_u32 v26, s[84:85], 2.0, v26
    v_subrev_co_u32 v27, s[86:87], 2.0, v27
    s_mov_b64 exec, s[64:65]
    ds_read_b64 v[52:53], v52
    s_mov_b64 exec, s[66:67]
    ds_read_b64 v[54:55], v54
    s_mov_b64 exec, s[68:69]
    ds_read_b64 v[56:57], v56
    s_mov_b64 exec, s[70:71]
    ds_read_b64 v[58:59], v58
    s_mov_b64 exec, s[72:73]
    ds_read_b64 v[60:61], v60
    s_mov_b64 exec, s[74:75]
    ds_read_b64 v[62:63], v62
    s_mov_b64 exec, s[76:77]
    ds_read_b64 v[64:65], v64
    s_mov_b64 exec, s[78:79]
    ds_read_b64 v[66:67], v66
    s_mov_b64 exec, s[80:81]
    ds_read_b64 v[68:69], v68
    s_mov_b64 exec, s[82:83]
    ds_read_b64 v[70:71], v70
    s_mov_b64 exec, s[84:85]
    ds_read_b64 v[72:73], v72
    s_mov_b64 exec, s[86:87]
    ds_read_b64 v[74:75], v74
    s_mov_b64 exec, -1
    s_movk_i32 s53, 10240
    buffer_load_dwordx4 v[98:101], v2, s[16:19], s53 offen
    buffer_load_dword v112, v2, s[16:19], s53 offen offset:16
    s_cmp_le_i32 s42, 3072
    s_cbranch_scc1 L_nt2_67
    s_waitcnt vmcnt(6)
    v_cmp_ne_u32 s[56:57], 0, v106
    v_cmp_ne_u32 s[58:59], 0, v107
    v_cmp_ne_u32 s[98:99], 0, v108
    v_cmp_ne_u32 vcc, 0, v109
    s_mov_b64 exec, s[56:57]
    v_cvt_f32_i32_sdwa v118, sext(v106) dst_sel:DWORD dst_unused:UNUSED_PAD src0_sel:WORD_0
    v_lshlrev_b32 v116, 16, v120
    v_and_b32 v117, s32, v120
    v_mul_f32 v118, s33, v118
    v_lshlrev_b32 v120, 16, v121
    v_and_b32 v121, s32, v121
    v_lshlrev_b32_sdwa v106, 3, v106 dst_sel:DWORD dst_unused:UNUSED_PAD src0_sel:DWORD src1_sel:WORD_1
    v_pk_fma_f32 v[116:117], v[116:117], v[118:119], s[28:29] op_sel_hi:[1,0,1]
    v_pk_fma_f32 v[120:121], v[120:121], v[118:119], s[28:29] op_sel_hi:[1,0,1]
    v_perm_b32 v116, v117, v116, s35
    v_perm_b32 v117, v121, v120, s35
    v_lshl_add_u64 v[116:117], v[116:117], 0, s[30:31]
    ds_add_rtn_u64 v[120:121], v106, v[116:117] offset:50000

    s_mov_b64 exec, s[58:59]
    v_cvt_f32_i32_sdwa v118, sext(v107) dst_sel:DWORD dst_unused:UNUSED_PAD src0_sel:WORD_0
    v_lshlrev_b32 v116, 16, v122
    v_and_b32 v117, s32, v122
    v_mul_f32 v118, s33, v118
    v_lshlrev_b32 v122, 16, v123
    v_and_b32 v123, s32, v123
    v_lshlrev_b32_sdwa v107, 3, v107 dst_sel:DWORD dst_unused:UNUSED_PAD src0_sel:DWORD src1_sel:WORD_1
    v_pk_fma_f32 v[116:117], v[116:117], v[118:119], s[28:29] op_sel_hi:[1,0,1]
    v_pk_fma_f32 v[122:123], v[122:123], v[118:119], s[28:29] op_sel_hi:[1,0,1]
    v_perm_b32 v116, v117, v116, s35
    v_perm_b32 v117, v123, v122, s35
    v_lshl_add_u64 v[116:117], v[116:117], 0, s[30:31]
    ds_add_rtn_u64 v[122:123], v107, v[116:117] offset:50000

    s_mov_b64 exec, s[98:99]
    v_cvt_f32_i32_sdwa v118, sext(v108) dst_sel:DWORD dst_unused:UNUSED_PAD src0_sel:WORD_0
    v_lshlrev_b32 v116, 16, v124
    v_and_b32 v117, s32, v124
    v_mul_f32 v118, s33, v118
    v_lshlrev_b32 v124, 16, v125
    v_and_b32 v125, s32, v125
    v_lshlrev_b32_sdwa v108, 3, v108 dst_sel:DWORD dst_unused:UNUSED_PAD src0_sel:DWORD src1_sel:WORD_1
    v_pk_fma_f32 v[116:117], v[116:117], v[118:119], s[28:29] op_sel_hi:[1,0,1]
    v_pk_fma_f32 v[124:125], v[124:125], v[118:119], s[28:29] op_sel_hi:[1,0,1]
    v_perm_b32 v116, v117, v116, s35
    v_perm_b32 v117, v125, v124, s35
    v_lshl_add_u64 v[116:117], v[116:117], 0, s[30:31]
    ds_add_rtn_u64 v[124:125], v108, v[116:117] offset:50000

    s_mov_b64 exec, vcc
    v_cvt_f32_i32_sdwa v118, sext(v109) dst_sel:DWORD dst_unused:UNUSED_PAD src0_sel:WORD_0
    v_lshlrev_b32 v116, 16, v126
    v_and_b32 v117, s32, v126
    v_mul_f32 v118, s33, v118
    v_lshlrev_b32 v126, 16, v127
    v_and_b32 v127, s32, v127
    v_lshlrev_b32_sdwa v109, 3, v109 dst_sel:DWORD dst_unused:UNUSED_PAD src0_sel:DWORD src1_sel:WORD_1
    v_pk_fma_f32 v[116:117], v[116:117], v[118:119], s[28:29] op_sel_hi:[1,0,1]
    v_pk_fma_f32 v[126:127], v[126:127], v[118:119], s[28:29] op_sel_hi:[1,0,1]
    v_perm_b32 v116, v117, v116, s35
    v_perm_b32 v117, v127, v126, s35
    v_lshl_add_u64 v[116:117], v[116:117], 0, s[30:31]
    ds_add_rtn_u64 v[126:127], v109, v[116:117] offset:50000

    s_waitcnt lgkmcnt(0)
    s_mov_b64 exec, s[56:57]
    v_or3_b32 v1, v120, v121, v1
    s_mov_b64 exec, s[58:59]
    v_or3_b32 v1, v122, v123, v1
    s_mov_b64 exec, s[98:99]
    v_or3_b32 v1, v124, v125, v1
    s_mov_b64 exec, vcc
    v_or3_b32 v1, v126, v127, v1
    s_mov_b64 exec, -1
L_nt2_67:
    s_movk_i32 s53, 15360
    buffer_load_dwordx4 v[106:109], v2, s[16:19], s53 offen
    buffer_load_dword v114, v2, s[16:19], s53 offen offset:16
    s_cmp_le_u32 s40, 3584
    s_cbranch_scc1 L_noleft_68
    s_min_u32 s40, s40, 3968
    s_lshl_b32 s52, s38, 6
    s_add_u32 s52, s52, s36
    s_mul_i32 s52, s52, 19840
    s_add_u32 s20, s44, s52
    s_addc_u32 s21, s45, 0
    s_mul_i32 s52, s40, 5
    s_add_u32 s52, s52, 3
    s_and_b32 s22, s52, -4

    s_lshr_b32 s55, s39, 2
    s_add_u32 s55, s55, 3584
    v_and_b32 v120, 63, v0
    v_add_u32 v120, s55, v120
L_left_71:
    s_cmp_ge_u32 s55, s40
    s_cbranch_scc1 L_leftend_72
    v_mul_u32_u24 v121, 5, v120
    buffer_load_dword v122, v121, s[20:23], 0 offen
    buffer_load_ubyte v123, v121, s[20:23], 0 offen offset:4
    s_waitcnt vmcnt(0)

    v_perm_b32 v121, v123, v122, s24
    v_lshrrev_b32 v126, 30, v122
    v_and_b32 v121, 0x1fff, v121
    v_mul_u32_u24 v126, 6250, v126
    v_add_lshl_u32 v121, v121, v126, 3

    buffer_load_dwordx2 v[124:125], v121, s[8:11], s50 offen
    v_cmp_gt_u32 vcc, s40, v120
    s_waitcnt vmcnt(0)

    s_mov_b64 exec, vcc
    v_and_b32 v122, 0x3fffffff, v122
    v_cvt_f32_i32_sdwa v118, sext(v122) dst_sel:DWORD dst_unused:UNUSED_PAD src0_sel:WORD_0
    v_lshlrev_b32 v116, 16, v124
    v_and_b32 v117, s32, v124
    v_mul_f32 v118, s33, v118
    v_lshlrev_b32 v124, 16, v125
    v_and_b32 v125, s32, v125
    v_lshlrev_b32_sdwa v122, 3, v122 dst_sel:DWORD dst_unused:UNUSED_PAD src0_sel:DWORD src1_sel:WORD_1
    v_pk_fma_f32 v[116:117], v[116:117], v[118:119], s[28:29] op_sel_hi:[1,0,1]
    v_pk_fma_f32 v[124:125], v[124:125], v[118:119], s[28:29] op_sel_hi:[1,0,1]
    v_perm_b32 v116, v117, v116, s35
    v_perm_b32 v117, v125, v124, s35
    v_lshl_add_u64 v[116:117], v[116:117], 0, s[30:31]
    ds_add_rtn_u64 v[124:125], v122, v[116:117] offset:50000

    s_waitcnt lgkmcnt(0)
    v_or3_b32 v1, v124, v125, v1
    s_mov_b64 exec, -1
    v_add_u32 v120, 128, v120
    s_add_u32 s55, s55, 128
    s_branch L_left_71
L_leftend_72:

L_noleft_68:
    v_cmp_gt_u32 s[64:65], 2.0, v4
    v_and_b32 v4, 0x3fffffff, v4
    v_cmp_gt_u32 s[66:67], 2.0, v5
    v_and_b32 v5, 0x3fffffff, v5
    v_cmp_gt_u32 s[68:69], 2.0, v6
    v_and_b32 v6, 0x3fffffff, v6
    v_cmp_gt_u32 s[70:71], 2.0, v7
    v_and_b32 v7, 0x3fffffff, v7
    v_cmp_gt_u32 s[72:73], 2.0, v8
    v_and_b32 v8, 0x3fffffff, v8
    v_cmp_gt_u32 s[74:75], 2.0, v9
    v_and_b32 v9, 0x3fffffff, v9
    v_cmp_gt_u32 s[76:77], 2.0, v10
    v_and_b32 v10, 0x3fffffff, v10
    v_cmp_gt_u32 s[78:79], 2.0, v11
    v_and_b32 v11, 0x3fffffff, v11
    v_cmp_gt_u32 s[80:81], 2.0, v12
    v_and_b32 v12, 0x3fffffff, v12
    v_cmp_gt_u32 s[82:83], 2.0, v13
    v_and_b32 v13, 0x3fffffff, v13
    v_cmp_gt_u32 s[84:85], 2.0, v14
    v_and_b32 v14, 0x3fffffff, v14
    v_cmp_gt_u32 s[86:87], 2.0, v15
    v_and_b32 v15, 0x3fffffff, v15
    s_waitcnt lgkmcnt(0)
    s_barrier
    s_waitcnt vmcnt(7)
    ds_write_addtid_b32 v76 offset:0
    ds_write_addtid_b32 v77 offset:256
    ds_write_addtid_b32 v78 offset:512
    ds_write_addtid_b32 v79 offset:768
    s_waitcnt vmcnt(6)
    ds_write_addtid_b32 v80 offset:16384
    ds_write_addtid_b32 v81 offset:16640
    ds_write_addtid_b32 v82 offset:16896
    ds_write_addtid_b32 v83 offset:17152
    s_waitcnt vmcnt(5)
    ds_write_addtid_b32 v84 offset:32768
    ds_write_addtid_b32 v85 offset:33024
    ds_write_addtid_b32 v86 offset:33280
    ds_write_addtid_b32 v87 offset:33536
    v_lshlrev_b32 v119, 2, v0
    s_waitcnt vmcnt(4)
    s_mov_b64 exec, s[48:49]
    ds_write_b32 v119, v88 offset:49152
    s_mov_b64 exec, -1
    s_add_u32 s43, s43, 50048
    s_add_u32 s14, s43, 50000
    s_min_u32 s14, s14, s41
    buffer_load_dwordx4 v[76:79], v3, s[12:15], s43 offen
    s_waitcnt lgkmcnt(0)
    s_barrier
    s_add_u32 s52, s43, 16384
    buffer_load_dwordx4 v[80:83], v3, s[12:15], s52 offen
    s_add_u32 s52, s43, 32768
    buffer_load_dwordx4 v[84:87], v3, s[12:15], s52 offen
    s_add_u32 s52, s43, 49152
    v_lshlrev_b32 v119, 2, v0
    buffer_load_dword v88, v119, s[12:15], s52 offen
    s_mov_b64 exec, s[64:65]
    ds_read_b64 v[28:29], v28
    s_mov_b64 exec, s[66:67]
    ds_read_b64 v[30:31], v30
    s_mov_b64 exec, s[68:69]
    ds_read_b64 v[32:33], v32
    s_mov_b64 exec, s[70:71]
    ds_read_b64 v[34:35], v34
    s_mov_b64 exec, s[72:73]
    ds_read_b64 v[36:37], v36
    s_mov_b64 exec, s[74:75]
    ds_read_b64 v[38:39], v38
    s_mov_b64 exec, s[76:77]
    ds_read_b64 v[40:41], v40
    s_mov_b64 exec, s[78:79]
    ds_read_b64 v[42:43], v42
    s_mov_b64 exec, s[80:81]
    ds_read_b64 v[44:45], v44
    s_mov_b64 exec, s[82:83]
    ds_read_b64 v[46:47], v46
    s_mov_b64 exec, s[84:85]
    ds_read_b64 v[48:49], v48
    s_mov_b64 exec, s[86:87]
    ds_read_b64 v[50:51], v50
    s_mov_b64 exec, -1
    v_cmp_gt_u32 s[64:65], 2.0, v16
    v_and_b32 v16, 0x3fffffff, v16
    v_cmp_gt_u32 s[66:67], 2.0, v17
    v_and_b32 v17, 0x3fffffff, v17
    v_cmp_gt_u32 s[68:69], 2.0, v18
    v_and_b32 v18, 0x3fffffff, v18
    v_cmp_gt_u32 s[70:71], 2.0, v19
    v_and_b32 v19, 0x3fffffff, v19
    v_cmp_gt_u32 s[72:73], 2.0, v20
    v_and_b32 v20, 0x3fffffff, v20
    v_cmp_gt_u32 s[74:75], 2.0, v21
    v_and_b32 v21, 0x3fffffff, v21
    v_cmp_gt_u32 s[76:77], 2.0, v22
    v_and_b32 v22, 0x3fffffff, v22
    v_cmp_gt_u32 s[78:79], 2.0, v23
    v_and_b32 v23, 0x3fffffff, v23
    v_cmp_gt_u32 s[80:81], 2.0, v24
    v_and_b32 v24, 0x3fffffff, v24
    v_cmp_gt_u32 s[82:83], 2.0, v25
    v_and_b32 v25, 0x3fffffff, v25
    v_cmp_gt_u32 s[84:85], 2.0, v26
    v_and_b32 v26, 0x3fffffff, v26
    v_cmp_gt_u32 s[86:87], 2.0, v27
    v_and_b32 v27, 0x3fffffff, v27
    s_mov_b64 exec, s[64:65]
    ds_read_b64 v[52:53], v52
    s_mov_b64 exec, s[66:67]
    ds_read_b64 v[54:55], v54
    s_mov_b64 exec, s[68:69]
    ds_read_b64 v[56:57], v56
    s_mov_b64 exec, s[70:71]
    ds_read_b64 v[58:59], v58
    s_mov_b64 exec, s[72:73]
    ds_read_b64 v[60:61], v60
    s_mov_b64 exec, s[74:75]
    ds_read_b64 v[62:63], v62
    s_mov_b64 exec, s[76:77]
    ds_read_b64 v[64:65], v64
    s_mov_b64 exec, s[78:79]
    ds_read_b64 v[66:67], v66
    s_mov_b64 exec, s[80:81]
    ds_read_b64 v[68:69], v68
    s_mov_b64 exec, s[82:83]
    ds_read_b64 v[70:71], v70
    s_mov_b64 exec, s[84:85]
    ds_read_b64 v[72:73], v72
    s_mov_b64 exec, s[86:87]
    ds_read_b64 v[74:75], v74
    s_mov_b64 exec, -1
    s_movk_i32 s53, 12800
    buffer_load_dwordx4 v[102:105], v2, s[16:19], s53 offen
    buffer_load_dword v113, v2, s[16:19], s53 offen offset:16
    s_cmp_ge_u32 s5, s4
    s_cbranch_scc1 L_bend_65
    s_waitcnt lgkmcnt(15)
    v_mad_i32_i16 v120, v28, v4, s96
    v_mad_i32_i16 v28, v28, v4, s96 op_sel:[1,0,0,0]
    v_mad_i32_i16 v121, v29, v4, s96
    v_mad_i32_i16 v29, v29, v4, s96 op_sel:[1,0,0,0]
    v_lshlrev_b32_sdwa v4, 3, v4 dst_sel:DWORD dst_unused:UNUSED_PAD src0_sel:DWORD src1_sel:WORD_1
    v_perm_b32 v28, v28, v120, s97
    v_perm_b32 v29, v29, v121, s97
    v_lshl_add_u64 v[28:29], v[28:29], 0, s[30:31]

    ds_add_rtn_u64 v[28:29], v4, v[28:29] offset:50000
    v_mad_i32_i16 v122, v30, v5, s96
    v_mad_i32_i16 v30, v30, v5, s96 op_sel:[1,0,0,0]
    v_mad_i32_i16 v123, v31, v5, s96
    v_mad_i32_i16 v31, v31, v5, s96 op_sel:[1,0,0,0]
    v_lshlrev_b32_sdwa v5, 3, v5 dst_sel:DWORD dst_unused:UNUSED_PAD src0_sel:DWORD src1_sel:WORD_1
    v_perm_b32 v30, v30, v122, s97
    v_perm_b32 v31, v31, v123, s97
    v_lshl_add_u64 v[30:31], v[30:31], 0, s[30:31]

    ds_add_rtn_u64 v[30:31], v5, v[30:31] offset:50000
    v_mad_i32_i16 v124, v32, v6, s96
    v_mad_i32_i16 v32, v32, v6, s96 op_sel:[1,0,0,0]
    v_mad_i32_i16 v125, v33, v6, s96
    v_mad_i32_i16 v33, v33, v6, s96 op_sel:[1,0,0,0]
    v_lshlrev_b32_sdwa v6, 3, v6 dst_sel:DWORD dst_unused:UNUSED_PAD src0_sel:DWORD src1_sel:WORD_1
    v_perm_b32 v32, v32, v124, s97
    v_perm_b32 v33, v33, v125, s97
    v_lshl_add_u64 v[32:33], v[32:33], 0, s[30:31]

    ds_add_rtn_u64 v[32:33], v6, v[32:33] offset:50000
    v_mad_i32_i16 v126, v34, v7, s96
    v_mad_i32_i16 v34, v34, v7, s96 op_sel:[1,0,0,0]
    v_mad_i32_i16 v127, v35, v7, s96
    v_mad_i32_i16 v35, v35, v7, s96 op_sel:[1,0,0,0]
    v_lshlrev_b32_sdwa v7, 3, v7 dst_sel:DWORD dst_unused:UNUSED_PAD src0_sel:DWORD src1_sel:WORD_1
    v_perm_b32 v34, v34, v126, s97
    v_perm_b32 v35, v35, v127, s97
    v_lshl_add_u64 v[34:35], v[34:35], 0, s[30:31]

    ds_add_rtn_u64 v[34:35], v7, v[34:35] offset:50000
    v_mad_i32_i16 v120, v36, v8, s96
    v_mad_i32_i16 v36, v36, v8, s96 op_sel:[1,0,0,0]
    v_mad_i32_i16 v121, v37, v8, s96
    v_mad_i32_i16 v37, v37, v8, s96 op_sel:[1,0,0,0]
    v_lshlrev_b32_sdwa v8, 3, v8 dst_sel:DWORD dst_unused:UNUSED_PAD src0_sel:DWORD src1_sel:WORD_1
    v_perm_b32 v36, v36, v120, s97
    v_perm_b32 v37, v37, v121, s97
    v_lshl_add_u64 v[36:37], v[36:37], 0, s[30:31]

    ds_add_rtn_u64 v[36:37], v8, v[36:37] offset:50000
    v_mad_i32_i16 v122, v38, v9, s96
    v_mad_i32_i16 v38, v38, v9, s96 op_sel:[1,0,0,0]
    v_mad_i32_i16 v123, v39, v9, s96
    v_mad_i32_i16 v39, v39, v9, s96 op_sel:[1,0,0,0]
    v_lshlrev_b32_sdwa v9, 3, v9 dst_sel:DWORD dst_unused:UNUSED_PAD src0_sel:DWORD src1_sel:WORD_1
    v_perm_b32 v38, v38, v122, s97
    v_perm_b32 v39, v39, v123, s97
    v_lshl_add_u64 v[38:39], v[38:39], 0, s[30:31]

    ds_add_rtn_u64 v[38:39], v9, v[38:39] offset:50000
    v_mad_i32_i16 v124, v40, v10, s96
    v_mad_i32_i16 v40, v40, v10, s96 op_sel:[1,0,0,0]
    v_mad_i32_i16 v125, v41, v10, s96
    v_mad_i32_i16 v41, v41, v10, s96 op_sel:[1,0,0,0]
    v_lshlrev_b32_sdwa v10, 3, v10 dst_sel:DWORD dst_unused:UNUSED_PAD src0_sel:DWORD src1_sel:WORD_1
    v_perm_b32 v40, v40, v124, s97
    v_perm_b32 v41, v41, v125, s97
    v_lshl_add_u64 v[40:41], v[40:41], 0, s[30:31]

    ds_add_rtn_u64 v[40:41], v10, v[40:41] offset:50000
    v_mad_i32_i16 v126, v42, v11, s96
    v_mad_i32_i16 v42, v42, v11, s96 op_sel:[1,0,0,0]
    v_mad_i32_i16 v127, v43, v11, s96
    v_mad_i32_i16 v43, v43, v11, s96 op_sel:[1,0,0,0]
    v_lshlrev_b32_sdwa v11, 3, v11 dst_sel:DWORD dst_unused:UNUSED_PAD src0_sel:DWORD src1_sel:WORD_1
    v_perm_b32 v42, v42, v126, s97
    v_perm_b32 v43, v43, v127, s97
    v_lshl_add_u64 v[42:43], v[42:43], 0, s[30:31]

    ds_add_rtn_u64 v[42:43], v11, v[42:43] offset:50000
    s_waitcnt lgkmcnt(4)
    v_or3_b32 v1, v28, v29, v1
    v_or3_b32 v1, v30, v31, v1
    v_or3_b32 v1, v32, v33, v1
    v_or3_b32 v1, v34, v35, v1
    s_movk_i32 s53, 0
    buffer_load_dwordx4 v[4:7], v2, s[16:19], s53 offen
    buffer_load_dword v35, v2, s[16:19], s53 offen offset:16
    v_mad_i32_i16 v120, v44, v12, s96
    v_mad_i32_i16 v44, v44, v12, s96 op_sel:[1,0,0,0]
    v_mad_i32_i16 v121, v45, v12, s96
    v_mad_i32_i16 v45, v45, v12, s96 op_sel:[1,0,0,0]
    v_lshlrev_b32_sdwa v12, 3, v12 dst_sel:DWORD dst_unused:UNUSED_PAD src0_sel:DWORD src1_sel:WORD_1
    v_perm_b32 v44, v44, v120, s97
    v_perm_b32 v45, v45, v121, s97
    v_lshl_add_u64 v[44:45], v[44:45], 0, s[30:31]

    ds_add_rtn_u64 v[44:45], v12, v[44:45] offset:50000
    v_mad_i32_i16 v122, v46, v13, s96
    v_mad_i32_i16 v46, v46, v13, s96 op_sel:[1,0,0,0]
    v_mad_i32_i16 v123, v47, v13, s96
    v_mad_i32_i16 v47, v47, v13, s96 op_sel:[1,0,0,0]
    v_lshlrev_b32_sdwa v13, 3, v13 dst_sel:DWORD dst_unused:UNUSED_PAD src0_sel:DWORD src1_sel:WORD_1
    v_perm_b32 v46, v46, v122, s97
    v_perm_b32 v47, v47, v123, s97
    v_lshl_add_u64 v[46:47], v[46:47], 0, s[30:31]

    ds_add_rtn_u64 v[46:47], v13, v[46:47] offset:50000
    v_mad_i32_i16 v124, v48, v14, s96
    v_mad_i32_i16 v48, v48, v14, s96 op_sel:[1,0,0,0]
    v_mad_i32_i16 v125, v49, v14, s96
    v_mad_i32_i16 v49, v49, v14, s96 op_sel:[1,0,0,0]
    v_lshlrev_b32_sdwa v14, 3, v14 dst_sel:DWORD dst_unused:UNUSED_PAD src0_sel:DWORD src1_sel:WORD_1
    v_perm_b32 v48, v48, v124, s97
    v_perm_b32 v49, v49, v125, s97
    v_lshl_add_u64 v[48:49], v[48:49], 0, s[30:31]

    ds_add_rtn_u64 v[48:49], v14, v[48:49] offset:50000
    v_mad_i32_i16 v126, v50, v15, s96
    v_mad_i32_i16 v50, v50, v15, s96 op_sel:[1,0,0,0]
    v_mad_i32_i16 v127, v51, v15, s96
    v_mad_i32_i16 v51, v51, v15, s96 op_sel:[1,0,0,0]
    v_lshlrev_b32_sdwa v15, 3, v15 dst_sel:DWORD dst_unused:UNUSED_PAD src0_sel:DWORD src1_sel:WORD_1
    v_perm_b32 v50, v50, v126, s97
    v_perm_b32 v51, v51, v127, s97
    v_lshl_add_u64 v[50:51], v[50:51], 0, s[30:31]

    ds_add_rtn_u64 v[50:51], v15, v[50:51] offset:50000
    s_waitcnt lgkmcnt(4)
    v_or3_b32 v1, v36, v37, v1
    v_or3_b32 v1, v38, v39, v1
    v_or3_b32 v1, v40, v41, v1
    v_or3_b32 v1, v42, v43, v1
    s_movk_i32 s53, 2560
    buffer_load_dwordx4 v[8:11], v2, s[16:19], s53 offen
    buffer_load_dword v43, v2, s[16:19], s53 offen offset:16
    s_barrier
    s_waitcnt vmcnt(9)
    ds_write_addtid_b32 v76 offset:0
    ds_write_addtid_b32 v77 offset:256
    ds_write_addtid_b32 v78 offset:512
    ds_write_addtid_b32 v79 offset:768
    s_waitcnt vmcnt(8)
    ds_write_addtid_b32 v80 offset:16384
    ds_write_addtid_b32 v81 offset:16640
    ds_write_addtid_b32 v82 offset:16896
    ds_write_addtid_b32 v83 offset:17152
    s_waitcnt vmcnt(7)
    ds_write_addtid_b32 v84 offset:32768
    ds_write_addtid_b32 v85 offset:33024
    ds_write_addtid_b32 v86 offset:33280
    ds_write_addtid_b32 v87 offset:33536
    v_lshlrev_b32 v119, 2, v0
    s_waitcnt vmcnt(6)
    s_mov_b64 exec, s[48:49]
    ds_write_b32 v119, v88 offset:49152
    s_mov_b64 exec, -1
    s_add_u32 s43, s43, 50048
    s_add_u32 s14, s43, 50000
    s_min_u32 s14, s14, s41
    s_add_u32 s54, s43, 50048
    buffer_load_dword v115, v89, s[60:63], s54 offen
    s_add_u32 s54, s50, 200000
    buffer_load_dword v115, v89, s[8:11], s54 offen
    s_mov_b32 s40, s88
    s_sub_u32 s42, s40, s39

    s_add_u32 s55, s38, 2
    s_min_u32 s55, s55, 31
    s_mov_b32 s88, s89
    s_mov_b32 s89, s90
    s_mov_b32 s90, s91
    s_mov_b32 s91, s92
    s_mov_b32 s92, s93
    s_mov_b32 s93, s94
    s_mov_b32 s94, s95
    s_mov_b32 s95, 0
    s_min_u32 s88, s88, 3968
    s_lshl_b32 s52, s55, 6
    s_add_u32 s52, s52, s36
    s_mul_i32 s52, s52, 19840
    s_add_u32 s16, s44, s52
    s_addc_u32 s17, s45, 0
    s_mul_i32 s52, s88, 5
    s_add_u32 s52, s52, 3
    s_and_b32 s18, s52, -4

    v_mad_i32_i16 v120, v52, v16, s96
    v_mad_i32_i16 v52, v52, v16, s96 op_sel:[1,0,0,0]
    v_mad_i32_i16 v121, v53, v16, s96
    v_mad_i32_i16 v53, v53, v16, s96 op_sel:[1,0,0,0]
    v_lshlrev_b32_sdwa v16, 3, v16 dst_sel:DWORD dst_unused:UNUSED_PAD src0_sel:DWORD src1_sel:WORD_1
    v_perm_b32 v52, v52, v120, s97
    v_perm_b32 v53, v53, v121, s97
    v_lshl_add_u64 v[52:53], v[52:53], 0, s[30:31]

    ds_add_rtn_u64 v[52:53], v16, v[52:53] offset:50000
    v_mad_i32_i16 v122, v54, v17, s96
    v_mad_i32_i16 v54, v54, v17, s96 op_sel:[1,0,0,0]
    v_mad_i32_i16 v123, v55, v17, s96
    v_mad_i32_i16 v55, v55, v17, s96 op_sel:[1,0,0,0]
    v_lshlrev_b32_sdwa v17, 3, v17 dst_sel:DWORD dst_unused:UNUSED_PAD src0_sel:DWORD src1_sel:WORD_1
    v_perm_b32 v54, v54, v122, s97
    v_perm_b32 v55, v55, v123, s97
    v_lshl_add_u64 v[54:55], v[54:55], 0, s[30:31]

    ds_add_rtn_u64 v[54:55], v17, v[54:55] offset:50000
    v_mad_i32_i16 v124, v56, v18, s96
    v_mad_i32_i16 v56, v56, v18, s96 op_sel:[1,0,0,0]
    v_mad_i32_i16 v125, v57, v18, s96
    v_mad_i32_i16 v57, v57, v18, s96 op_sel:[1,0,0,0]
    v_lshlrev_b32_sdwa v18, 3, v18 dst_sel:DWORD dst_unused:UNUSED_PAD src0_sel:DWORD src1_sel:WORD_1
    v_perm_b32 v56, v56, v124, s97
    v_perm_b32 v57, v57, v125, s97
    v_lshl_add_u64 v[56:57], v[56:57], 0, s[30:31]

    ds_add_rtn_u64 v[56:57], v18, v[56:57] offset:50000
    v_mad_i32_i16 v126, v58, v19, s96
    v_mad_i32_i16 v58, v58, v19, s96 op_sel:[1,0,0,0]
    v_mad_i32_i16 v127, v59, v19, s96
    v_mad_i32_i16 v59, v59, v19, s96 op_sel:[1,0,0,0]
    v_lshlrev_b32_sdwa v19, 3, v19 dst_sel:DWORD dst_unused:UNUSED_PAD src0_sel:DWORD src1_sel:WORD_1
    v_perm_b32 v58, v58, v126, s97
    v_perm_b32 v59, v59, v127, s97
    v_lshl_add_u64 v[58:59], v[58:59], 0, s[30:31]

    ds_add_rtn_u64 v[58:59], v19, v[58:59] offset:50000
    s_waitcnt lgkmcnt(15)
    v_or3_b32 v1, v44, v45, v1
    v_or3_b32 v1, v46, v47, v1
    v_or3_b32 v1, v48, v49, v1
    v_or3_b32 v1, v50, v51, v1
    s_waitcnt vmcnt(26)
    v_perm_b32 v44, v91, v90, s24
    v_perm_b32 v46, v92, v91, s25
    v_perm_b32 v48, v93, v92, s26
    v_perm_b32 v50, v110, v93, s27
    v_mov_b32 v12, v90
    v_alignbyte_b32 v13, v92, v91, 1
    v_alignbyte_b32 v14, v93, v92, 2
    v_alignbyte_b32 v15, v110, v93, 3
    v_lshlrev_b32_sdwa v44, 3, v44 dst_sel:WORD_0 dst_unused:UNUSED_PAD src0_sel:DWORD src1_sel:DWORD
    v_lshlrev_b32_sdwa v46, 3, v46 dst_sel:WORD_0 dst_unused:UNUSED_PAD src0_sel:DWORD src1_sel:DWORD
    v_lshlrev_b32_sdwa v48, 3, v48 dst_sel:WORD_0 dst_unused:UNUSED_PAD src0_sel:DWORD src1_sel:DWORD
    v_lshlrev_b32_sdwa v50, 3, v50 dst_sel:WORD_0 dst_unused:UNUSED_PAD src0_sel:DWORD src1_sel:DWORD
    s_cmp_lt_i32 s42, 1280
    s_cbranch_scc1 L_ufix_73
L_uback_74:

    s_movk_i32 s53, 5120
    buffer_load_dwordx4 v[90:93], v2, s[16:19], s53 offen
    buffer_load_dword v110, v2, s[16:19], s53 offen offset:16
    s_waitcnt lgkmcnt(4)
    s_barrier
    v_subrev_co_u32 v12, s[80:81], 2.0, v12
    v_subrev_co_u32 v13, s[82:83], 2.0, v13
    v_subrev_co_u32 v14, s[84:85], 2.0, v14
    v_subrev_co_u32 v15, s[86:87], 2.0, v15
    s_mov_b64 exec, s[80:81]
    ds_read_b64 v[44:45], v44
    s_mov_b64 exec, s[82:83]
    ds_read_b64 v[46:47], v46
    s_mov_b64 exec, s[84:85]
    ds_read_b64 v[48:49], v48
    s_mov_b64 exec, s[86:87]
    ds_read_b64 v[50:51], v50
    s_mov_b64 exec, -1
    v_mad_i32_i16 v120, v60, v20, s96
    v_mad_i32_i16 v60, v60, v20, s96 op_sel:[1,0,0,0]
    v_mad_i32_i16 v121, v61, v20, s96
    v_mad_i32_i16 v61, v61, v20, s96 op_sel:[1,0,0,0]
    v_lshlrev_b32_sdwa v20, 3, v20 dst_sel:DWORD dst_unused:UNUSED_PAD src0_sel:DWORD src1_sel:WORD_1
    v_perm_b32 v60, v60, v120, s97
    v_perm_b32 v61, v61, v121, s97
    v_lshl_add_u64 v[60:61], v[60:61], 0, s[30:31]

    ds_add_rtn_u64 v[60:61], v20, v[60:61] offset:50000
    v_mad_i32_i16 v122, v62, v21, s96
    v_mad_i32_i16 v62, v62, v21, s96 op_sel:[1,0,0,0]
    v_mad_i32_i16 v123, v63, v21, s96
    v_mad_i32_i16 v63, v63, v21, s96 op_sel:[1,0,0,0]
    v_lshlrev_b32_sdwa v21, 3, v21 dst_sel:DWORD dst_unused:UNUSED_PAD src0_sel:DWORD src1_sel:WORD_1
    v_perm_b32 v62, v62, v122, s97
    v_perm_b32 v63, v63, v123, s97
    v_lshl_add_u64 v[62:63], v[62:63], 0, s[30:31]

    ds_add_rtn_u64 v[62:63], v21, v[62:63] offset:50000
    v_mad_i32_i16 v124, v64, v22, s96
    v_mad_i32_i16 v64, v64, v22, s96 op_sel:[1,0,0,0]
    v_mad_i32_i16 v125, v65, v22, s96
    v_mad_i32_i16 v65, v65, v22, s96 op_sel:[1,0,0,0]
    v_lshlrev_b32_sdwa v22, 3, v22 dst_sel:DWORD dst_unused:UNUSED_PAD src0_sel:DWORD src1_sel:WORD_1
    v_perm_b32 v64, v64, v124, s97
    v_perm_b32 v65, v65, v125, s97
    v_lshl_add_u64 v[64:65], v[64:65], 0, s[30:31]

    ds_add_rtn_u64 v[64:65], v22, v[64:65] offset:50000
    v_mad_i32_i16 v126, v66, v23, s96
    v_mad_i32_i16 v66, v66, v23, s96 op_sel:[1,0,0,0]
    v_mad_i32_i16 v127, v67, v23, s96
    v_mad_i32_i16 v67, v67, v23, s96 op_sel:[1,0,0,0]
    v_lshlrev_b32_sdwa v23, 3, v23 dst_sel:DWORD dst_unused:UNUSED_PAD src0_sel:DWORD src1_sel:WORD_1
    v_perm_b32 v66, v66, v126, s97
    v_perm_b32 v67, v67, v127, s97
    v_lshl_add_u64 v[66:67], v[66:67], 0, s[30:31]

    ds_add_rtn_u64 v[66:67], v23, v[66:67] offset:50000
    s_waitcnt lgkmcnt(8)
    v_or3_b32 v1, v52, v53, v1
    v_or3_b32 v1, v54, v55, v1
    v_or3_b32 v1, v56, v57, v1
    v_or3_b32 v1, v58, v59, v1
    s_waitcnt vmcnt(26)
    v_perm_b32 v52, v95, v94, s24
    v_perm_b32 v54, v96, v95, s25
    v_perm_b32 v56, v97, v96, s26
    v_perm_b32 v58, v111, v97, s27
    v_mov_b32 v16, v94
    v_alignbyte_b32 v17, v96, v95, 1
    v_alignbyte_b32 v18, v97, v96, 2
    v_alignbyte_b32 v19, v111, v97, 3
    v_lshlrev_b32_sdwa v52, 3, v52 dst_sel:WORD_0 dst_unused:UNUSED_PAD src0_sel:DWORD src1_sel:DWORD
    v_lshlrev_b32_sdwa v54, 3, v54 dst_sel:WORD_0 dst_unused:UNUSED_PAD src0_sel:DWORD src1_sel:DWORD
    v_lshlrev_b32_sdwa v56, 3, v56 dst_sel:WORD_0 dst_unused:UNUSED_PAD src0_sel:DWORD src1_sel:DWORD
    v_lshlrev_b32_sdwa v58, 3, v58 dst_sel:WORD_0 dst_unused:UNUSED_PAD src0_sel:DWORD src1_sel:DWORD
    s_cmp_lt_i32 s42, 1792
    s_cbranch_scc1 L_ufix_75
L_uback_76:

    v_subrev_co_u32 v16, s[64:65], 2.0, v16
    v_subrev_co_u32 v17, s[66:67], 2.0, v17
    v_subrev_co_u32 v18, s[68:69], 2.0, v18
    v_subrev_co_u32 v19, s[70:71], 2.0, v19
    s_mov_b64 exec, s[64:65]
    ds_read_b64 v[52:53], v52
    s_mov_b64 exec, s[66:67]
    ds_read_b64 v[54:55], v54
    s_mov_b64 exec, s[68:69]
    ds_read_b64 v[56:57], v56
    s_mov_b64 exec, s[70:71]
    ds_read_b64 v[58:59], v58
    s_mov_b64 exec, -1
    v_mad_i32_i16 v120, v68, v24, s96
    v_mad_i32_i16 v68, v68, v24, s96 op_sel:[1,0,0,0]
    v_mad_i32_i16 v121, v69, v24, s96
    v_mad_i32_i16 v69, v69, v24, s96 op_sel:[1,0,0,0]
    v_lshlrev_b32_sdwa v24, 3, v24 dst_sel:DWORD dst_unused:UNUSED_PAD src0_sel:DWORD src1_sel:WORD_1
    v_perm_b32 v68, v68, v120, s97
    v_perm_b32 v69, v69, v121, s97
    v_lshl_add_u64 v[68:69], v[68:69], 0, s[30:31]

    ds_add_rtn_u64 v[68:69], v24, v[68:69] offset:50000
    v_mad_i32_i16 v122, v70, v25, s96
    v_mad_i32_i16 v70, v70, v25, s96 op_sel:[1,0,0,0]
    v_mad_i32_i16 v123, v71, v25, s96
    v_mad_i32_i16 v71, v71, v25, s96 op_sel:[1,0,0,0]
    v_lshlrev_b32_sdwa v25, 3, v25 dst_sel:DWORD dst_unused:UNUSED_PAD src0_sel:DWORD src1_sel:WORD_1
    v_perm_b32 v70, v70, v122, s97
    v_perm_b32 v71, v71, v123, s97
    v_lshl_add_u64 v[70:71], v[70:71], 0, s[30:31]

    ds_add_rtn_u64 v[70:71], v25, v[70:71] offset:50000
    v_mad_i32_i16 v124, v72, v26, s96
    v_mad_i32_i16 v72, v72, v26, s96 op_sel:[1,0,0,0]
    v_mad_i32_i16 v125, v73, v26, s96
    v_mad_i32_i16 v73, v73, v26, s96 op_sel:[1,0,0,0]
    v_lshlrev_b32_sdwa v26, 3, v26 dst_sel:DWORD dst_unused:UNUSED_PAD src0_sel:DWORD src1_sel:WORD_1
    v_perm_b32 v72, v72, v124, s97
    v_perm_b32 v73, v73, v125, s97
    v_lshl_add_u64 v[72:73], v[72:73], 0, s[30:31]

    ds_add_rtn_u64 v[72:73], v26, v[72:73] offset:50000
    v_mad_i32_i16 v126, v74, v27, s96
    v_mad_i32_i16 v74, v74, v27, s96 op_sel:[1,0,0,0]
    v_mad_i32_i16 v127, v75, v27, s96
    v_mad_i32_i16 v75, v75, v27, s96 op_sel:[1,0,0,0]
    v_lshlrev_b32_sdwa v27, 3, v27 dst_sel:DWORD dst_unused:UNUSED_PAD src0_sel:DWORD src1_sel:WORD_1
    v_perm_b32 v74, v74, v126, s97
    v_perm_b32 v75, v75, v127, s97
    v_lshl_add_u64 v[74:75], v[74:75], 0, s[30:31]

    ds_add_rtn_u64 v[74:75], v27, v[74:75] offset:50000
    s_waitcnt lgkmcnt(8)
    v_or3_b32 v1, v60, v61, v1
    v_or3_b32 v1, v62, v63, v1
    v_or3_b32 v1, v64, v65, v1
    v_or3_b32 v1, v66, v67, v1
    s_waitcnt vmcnt(16)
    v_perm_b32 v60, v99, v98, s24
    v_perm_b32 v62, v100, v99, s25
    v_perm_b32 v64, v101, v100, s26
    v_perm_b32 v66, v112, v101, s27
    v_mov_b32 v20, v98
    v_alignbyte_b32 v21, v100, v99, 1
    v_alignbyte_b32 v22, v101, v100, 2
    v_alignbyte_b32 v23, v112, v101, 3
    v_lshlrev_b32_sdwa v60, 3, v60 dst_sel:WORD_0 dst_unused:UNUSED_PAD src0_sel:DWORD src1_sel:DWORD
    v_lshlrev_b32_sdwa v62, 3, v62 dst_sel:WORD_0 dst_unused:UNUSED_PAD src0_sel:DWORD src1_sel:DWORD
    v_lshlrev_b32_sdwa v64, 3, v64 dst_sel:WORD_0 dst_unused:UNUSED_PAD src0_sel:DWORD src1_sel:DWORD
    v_lshlrev_b32_sdwa v66, 3, v66 dst_sel:WORD_0 dst_unused:UNUSED_PAD src0_sel:DWORD src1_sel:DWORD
    s_cmp_lt_i32 s42, 2304
    s_cbranch_scc1 L_ufix_77
L_uback_78:

    v_subrev_co_u32 v20, s[72:73], 2.0, v20
    v_subrev_co_u32 v21, s[74:75], 2.0, v21
    v_subrev_co_u32 v22, s[76:77], 2.0, v22
    v_subrev_co_u32 v23, s[78:79], 2.0, v23
    s_mov_b64 exec, s[72:73]
    ds_read_b64 v[60:61], v60
    s_mov_b64 exec, s[74:75]
    ds_read_b64 v[62:63], v62
    s_mov_b64 exec, s[76:77]
    ds_read_b64 v[64:65], v64
    s_mov_b64 exec, s[78:79]
    ds_read_b64 v[66:67], v66
    s_mov_b64 exec, -1
    s_waitcnt lgkmcnt(4)
    v_or3_b32 v1, v68, v69, v1
    v_or3_b32 v1, v70, v71, v1
    v_or3_b32 v1, v72, v73, v1
    v_or3_b32 v1, v74, v75, v1
    s_waitcnt vmcnt(8)
    v_perm_b32 v68, v103, v102, s24
    v_perm_b32 v70, v104, v103, s25
    v_perm_b32 v72, v105, v104, s26
    v_perm_b32 v74, v113, v105, s27
    v_mov_b32 v24, v102
    v_alignbyte_b32 v25, v104, v103, 1
    v_alignbyte_b32 v26, v105, v104, 2
    v_alignbyte_b32 v27, v113, v105, 3
    v_lshlrev_b32_sdwa v68, 3, v68 dst_sel:WORD_0 dst_unused:UNUSED_PAD src0_sel:DWORD src1_sel:DWORD
    v_lshlrev_b32_sdwa v70, 3, v70 dst_sel:WORD_0 dst_unused:UNUSED_PAD src0_sel:DWORD src1_sel:DWORD
    v_lshlrev_b32_sdwa v72, 3, v72 dst_sel:WORD_0 dst_unused:UNUSED_PAD src0_sel:DWORD src1_sel:DWORD
    v_lshlrev_b32_sdwa v74, 3, v74 dst_sel:WORD_0 dst_unused:UNUSED_PAD src0_sel:DWORD src1_sel:DWORD
    s_cmp_lt_i32 s42, 2816
    s_cbranch_scc1 L_ufix_79
L_uback_80:

    v_subrev_co_u32 v24, s[80:81], 2.0, v24
    v_subrev_co_u32 v25, s[82:83], 2.0, v25
    v_subrev_co_u32 v26, s[84:85], 2.0, v26
    v_subrev_co_u32 v27, s[86:87], 2.0, v27
    s_mov_b64 exec, s[80:81]
    ds_read_b64 v[68:69], v68
    s_mov_b64 exec, s[82:83]
    ds_read_b64 v[70:71], v70
    s_mov_b64 exec, s[84:85]
    ds_read_b64 v[72:73], v72
    s_mov_b64 exec, s[86:87]
    ds_read_b64 v[74:75], v74
    s_mov_b64 exec, -1
    buffer_load_dwordx4 v[76:79], v3, s[12:15], s43 offen
    s_add_u32 s52, s43, 16384
    buffer_load_dwordx4 v[80:83], v3, s[12:15], s52 offen
    s_add_u32 s52, s43, 32768
    buffer_load_dwordx4 v[84:87], v3, s[12:15], s52 offen
    s_add_u32 s52, s43, 49152
    v_lshlrev_b32 v119, 2, v0
    buffer_load_dword v88, v119, s[12:15], s52 offen
    s_waitcnt vmcnt(10)
    v_perm_b32 v28, v5, v4, s24
    v_perm_b32 v30, v6, v5, s25
    v_perm_b32 v32, v7, v6, s26
    v_perm_b32 v34, v35, v7, s27
    v_alignbyte_b32 v5, v6, v5, 1
    v_alignbyte_b32 v6, v7, v6, 2
    v_alignbyte_b32 v7, v35, v7, 3
    v_lshlrev_b32_sdwa v28, 3, v28 dst_sel:WORD_0 dst_unused:UNUSED_PAD src0_sel:DWORD src1_sel:DWORD
    v_lshlrev_b32_sdwa v30, 3, v30 dst_sel:WORD_0 dst_unused:UNUSED_PAD src0_sel:DWORD src1_sel:DWORD
    v_lshlrev_b32_sdwa v32, 3, v32 dst_sel:WORD_0 dst_unused:UNUSED_PAD src0_sel:DWORD src1_sel:DWORD
    v_lshlrev_b32_sdwa v34, 3, v34 dst_sel:WORD_0 dst_unused:UNUSED_PAD src0_sel:DWORD src1_sel:DWORD
    s_cmp_lt_i32 s42, 256
    s_cbranch_scc1 L_ufix_81
L_uback_82:

    v_subrev_co_u32 v4, s[64:65], 2.0, v4
    v_subrev_co_u32 v5, s[66:67], 2.0, v5
    v_subrev_co_u32 v6, s[68:69], 2.0, v6
    v_subrev_co_u32 v7, s[70:71], 2.0, v7
    s_mov_b64 exec, s[64:65]
    ds_read_b64 v[28:29], v28
    s_mov_b64 exec, s[66:67]
    ds_read_b64 v[30:31], v30
    s_mov_b64 exec, s[68:69]
    ds_read_b64 v[32:33], v32
    s_mov_b64 exec, s[70:71]
    ds_read_b64 v[34:35], v34
    s_mov_b64 exec, -1
    s_waitcnt vmcnt(8)
    v_perm_b32 v36, v9, v8, s24
    v_perm_b32 v38, v10, v9, s25
    v_perm_b32 v40, v11, v10, s26
    v_perm_b32 v42, v43, v11, s27
    v_alignbyte_b32 v9, v10, v9, 1
    v_alignbyte_b32 v10, v11, v10, 2
    v_alignbyte_b32 v11, v43, v11, 3
    v_lshlrev_b32_sdwa v36, 3, v36 dst_sel:WORD_0 dst_unused:UNUSED_PAD src0_sel:DWORD src1_sel:DWORD
    v_lshlrev_b32_sdwa v38, 3, v38 dst_sel:WORD_0 dst_unused:UNUSED_PAD src0_sel:DWORD src1_sel:DWORD
    v_lshlrev_b32_sdwa v40, 3, v40 dst_sel:WORD_0 dst_unused:UNUSED_PAD src0_sel:DWORD src1_sel:DWORD
    v_lshlrev_b32_sdwa v42, 3, v42 dst_sel:WORD_0 dst_unused:UNUSED_PAD src0_sel:DWORD src1_sel:DWORD
    s_cmp_lt_i32 s42, 768
    s_cbranch_scc1 L_ufix_83
L_uback_84:

    v_subrev_co_u32 v8, s[72:73], 2.0, v8
    v_subrev_co_u32 v9, s[74:75], 2.0, v9
    v_subrev_co_u32 v10, s[76:77], 2.0, v10
    v_subrev_co_u32 v11, s[78:79], 2.0, v11
    s_mov_b64 exec, s[72:73]
    ds_read_b64 v[36:37], v36
    s_mov_b64 exec, s[74:75]
    ds_read_b64 v[38:39], v38
    s_mov_b64 exec, s[76:77]
    ds_read_b64 v[40:41], v40
    s_mov_b64 exec, s[78:79]
    ds_read_b64 v[42:43], v42
    s_mov_b64 exec, -1
    s_mov_b32 s38, s5
    s_add_u32 s50, s50, 200000
    s_branch L_batch_64
L_bend_65:

    s_load_dwordx2 s[64:65], s[0:1], 24
    s_load_dwordx2 s[86:87], s[0:1], 40
    s_load_dwordx8 s[88:95], s[0:1], 56
    s_mov_b32 s66, 1600000
    s_mov_b32 s67, 0x20000

    s_waitcnt lgkmcnt(15)
    v_mad_i32_i16 v120, v28, v4, s96
    v_mad_i32_i16 v28, v28, v4, s96 op_sel:[1,0,0,0]
    v_mad_i32_i16 v121, v29, v4, s96
    v_mad_i32_i16 v29, v29, v4, s96 op_sel:[1,0,0,0]
    v_lshlrev_b32_sdwa v4, 3, v4 dst_sel:DWORD dst_unused:UNUSED_PAD src0_sel:DWORD src1_sel:WORD_1
    v_perm_b32 v28, v28, v120, s97
    v_perm_b32 v29, v29, v121, s97
    v_lshl_add_u64 v[28:29], v[28:29], 0, s[30:31]

    ds_add_rtn_u64 v[28:29], v4, v[28:29] offset:50000
    v_mad_i32_i16 v122, v30, v5, s96
    v_mad_i32_i16 v30, v30, v5, s96 op_sel:[1,0,0,0]
    v_mad_i32_i16 v123, v31, v5, s96
    v_mad_i32_i16 v31, v31, v5, s96 op_sel:[1,0,0,0]
    v_lshlrev_b32_sdwa v5, 3, v5 dst_sel:DWORD dst_unused:UNUSED_PAD src0_sel:DWORD src1_sel:WORD_1
    v_perm_b32 v30, v30, v122, s97
    v_perm_b32 v31, v31, v123, s97
    v_lshl_add_u64 v[30:31], v[30:31], 0, s[30:31]

    ds_add_rtn_u64 v[30:31], v5, v[30:31] offset:50000
    v_mad_i32_i16 v124, v32, v6, s96
    v_mad_i32_i16 v32, v32, v6, s96 op_sel:[1,0,0,0]
    v_mad_i32_i16 v125, v33, v6, s96
    v_mad_i32_i16 v33, v33, v6, s96 op_sel:[1,0,0,0]
    v_lshlrev_b32_sdwa v6, 3, v6 dst_sel:DWORD dst_unused:UNUSED_PAD src0_sel:DWORD src1_sel:WORD_1
    v_perm_b32 v32, v32, v124, s97
    v_perm_b32 v33, v33, v125, s97
    v_lshl_add_u64 v[32:33], v[32:33], 0, s[30:31]

    ds_add_rtn_u64 v[32:33], v6, v[32:33] offset:50000
    v_mad_i32_i16 v126, v34, v7, s96
    v_mad_i32_i16 v34, v34, v7, s96 op_sel:[1,0,0,0]
    v_mad_i32_i16 v127, v35, v7, s96
    v_mad_i32_i16 v35, v35, v7, s96 op_sel:[1,0,0,0]
    v_lshlrev_b32_sdwa v7, 3, v7 dst_sel:DWORD dst_unused:UNUSED_PAD src0_sel:DWORD src1_sel:WORD_1
    v_perm_b32 v34, v34, v126, s97
    v_perm_b32 v35, v35, v127, s97
    v_lshl_add_u64 v[34:35], v[34:35], 0, s[30:31]

    ds_add_rtn_u64 v[34:35], v7, v[34:35] offset:50000
    v_mad_i32_i16 v120, v36, v8, s96
    v_mad_i32_i16 v36, v36, v8, s96 op_sel:[1,0,0,0]
    v_mad_i32_i16 v121, v37, v8, s96
    v_mad_i32_i16 v37, v37, v8, s96 op_sel:[1,0,0,0]
    v_lshlrev_b32_sdwa v8, 3, v8 dst_sel:DWORD dst_unused:UNUSED_PAD src0_sel:DWORD src1_sel:WORD_1
    v_perm_b32 v36, v36, v120, s97
    v_perm_b32 v37, v37, v121, s97
    v_lshl_add_u64 v[36:37], v[36:37], 0, s[30:31]

    ds_add_rtn_u64 v[36:37], v8, v[36:37] offset:50000
    v_mad_i32_i16 v122, v38, v9, s96
    v_mad_i32_i16 v38, v38, v9, s96 op_sel:[1,0,0,0]
    v_mad_i32_i16 v123, v39, v9, s96
    v_mad_i32_i16 v39, v39, v9, s96 op_sel:[1,0,0,0]
    v_lshlrev_b32_sdwa v9, 3, v9 dst_sel:DWORD dst_unused:UNUSED_PAD src0_sel:DWORD src1_sel:WORD_1
    v_perm_b32 v38, v38, v122, s97
    v_perm_b32 v39, v39, v123, s97
    v_lshl_add_u64 v[38:39], v[38:39], 0, s[30:31]

    ds_add_rtn_u64 v[38:39], v9, v[38:39] offset:50000
    v_mad_i32_i16 v124, v40, v10, s96
    v_mad_i32_i16 v40, v40, v10, s96 op_sel:[1,0,0,0]
    v_mad_i32_i16 v125, v41, v10, s96
    v_mad_i32_i16 v41, v41, v10, s96 op_sel:[1,0,0,0]
    v_lshlrev_b32_sdwa v10, 3, v10 dst_sel:DWORD dst_unused:UNUSED_PAD src0_sel:DWORD src1_sel:WORD_1
    v_perm_b32 v40, v40, v124, s97
    v_perm_b32 v41, v41, v125, s97
    v_lshl_add_u64 v[40:41], v[40:41], 0, s[30:31]

    ds_add_rtn_u64 v[40:41], v10, v[40:41] offset:50000
    v_mad_i32_i16 v126, v42, v11, s96
    v_mad_i32_i16 v42, v42, v11, s96 op_sel:[1,0,0,0]
    v_mad_i32_i16 v127, v43, v11, s96
    v_mad_i32_i16 v43, v43, v11, s96 op_sel:[1,0,0,0]
    v_lshlrev_b32_sdwa v11, 3, v11 dst_sel:DWORD dst_unused:UNUSED_PAD src0_sel:DWORD src1_sel:WORD_1
    v_perm_b32 v42, v42, v126, s97
    v_perm_b32 v43, v43, v127, s97
    v_lshl_add_u64 v[42:43], v[42:43], 0, s[30:31]

    ds_add_rtn_u64 v[42:43], v11, v[42:43] offset:50000
    s_waitcnt lgkmcnt(4)
    v_or3_b32 v1, v28, v29, v1
    v_or3_b32 v1, v30, v31, v1
    v_or3_b32 v1, v32, v33, v1
    v_or3_b32 v1, v34, v35, v1
    v_mad_i32_i16 v120, v44, v12, s96
    v_mad_i32_i16 v44, v44, v12, s96 op_sel:[1,0,0,0]
    v_mad_i32_i16 v121, v45, v12, s96
    v_mad_i32_i16 v45, v45, v12, s96 op_sel:[1,0,0,0]
    v_lshlrev_b32_sdwa v12, 3, v12 dst_sel:DWORD dst_unused:UNUSED_PAD src0_sel:DWORD src1_sel:WORD_1
    v_perm_b32 v44, v44, v120, s97
    v_perm_b32 v45, v45, v121, s97
    v_lshl_add_u64 v[44:45], v[44:45], 0, s[30:31]

    ds_add_rtn_u64 v[44:45], v12, v[44:45] offset:50000
    v_mad_i32_i16 v122, v46, v13, s96
    v_mad_i32_i16 v46, v46, v13, s96 op_sel:[1,0,0,0]
    v_mad_i32_i16 v123, v47, v13, s96
    v_mad_i32_i16 v47, v47, v13, s96 op_sel:[1,0,0,0]
    v_lshlrev_b32_sdwa v13, 3, v13 dst_sel:DWORD dst_unused:UNUSED_PAD src0_sel:DWORD src1_sel:WORD_1
    v_perm_b32 v46, v46, v122, s97
    v_perm_b32 v47, v47, v123, s97
    v_lshl_add_u64 v[46:47], v[46:47], 0, s[30:31]

    ds_add_rtn_u64 v[46:47], v13, v[46:47] offset:50000
    v_mad_i32_i16 v124, v48, v14, s96
    v_mad_i32_i16 v48, v48, v14, s96 op_sel:[1,0,0,0]
    v_mad_i32_i16 v125, v49, v14, s96
    v_mad_i32_i16 v49, v49, v14, s96 op_sel:[1,0,0,0]
    v_lshlrev_b32_sdwa v14, 3, v14 dst_sel:DWORD dst_unused:UNUSED_PAD src0_sel:DWORD src1_sel:WORD_1
    v_perm_b32 v48, v48, v124, s97
    v_perm_b32 v49, v49, v125, s97
    v_lshl_add_u64 v[48:49], v[48:49], 0, s[30:31]

    ds_add_rtn_u64 v[48:49], v14, v[48:49] offset:50000
    v_mad_i32_i16 v126, v50, v15, s96
    v_mad_i32_i16 v50, v50, v15, s96 op_sel:[1,0,0,0]
    v_mad_i32_i16 v127, v51, v15, s96
    v_mad_i32_i16 v51, v51, v15, s96 op_sel:[1,0,0,0]
    v_lshlrev_b32_sdwa v15, 3, v15 dst_sel:DWORD dst_unused:UNUSED_PAD src0_sel:DWORD src1_sel:WORD_1
    v_perm_b32 v50, v50, v126, s97
    v_perm_b32 v51, v51, v127, s97
    v_lshl_add_u64 v[50:51], v[50:51], 0, s[30:31]

    ds_add_rtn_u64 v[50:51], v15, v[50:51] offset:50000
    s_waitcnt lgkmcnt(4)
    v_or3_b32 v1, v36, v37, v1
    v_or3_b32 v1, v38, v39, v1
    v_or3_b32 v1, v40, v41, v1
    v_or3_b32 v1, v42, v43, v1
    v_mad_i32_i16 v120, v52, v16, s96
    v_mad_i32_i16 v52, v52, v16, s96 op_sel:[1,0,0,0]
    v_mad_i32_i16 v121, v53, v16, s96
    v_mad_i32_i16 v53, v53, v16, s96 op_sel:[1,0,0,0]
    v_lshlrev_b32_sdwa v16, 3, v16 dst_sel:DWORD dst_unused:UNUSED_PAD src0_sel:DWORD src1_sel:WORD_1
    v_perm_b32 v52, v52, v120, s97
    v_perm_b32 v53, v53, v121, s97
    v_lshl_add_u64 v[52:53], v[52:53], 0, s[30:31]

    ds_add_rtn_u64 v[52:53], v16, v[52:53] offset:50000
    v_mad_i32_i16 v122, v54, v17, s96
    v_mad_i32_i16 v54, v54, v17, s96 op_sel:[1,0,0,0]
    v_mad_i32_i16 v123, v55, v17, s96
    v_mad_i32_i16 v55, v55, v17, s96 op_sel:[1,0,0,0]
    v_lshlrev_b32_sdwa v17, 3, v17 dst_sel:DWORD dst_unused:UNUSED_PAD src0_sel:DWORD src1_sel:WORD_1
    v_perm_b32 v54, v54, v122, s97
    v_perm_b32 v55, v55, v123, s97
    v_lshl_add_u64 v[54:55], v[54:55], 0, s[30:31]

    ds_add_rtn_u64 v[54:55], v17, v[54:55] offset:50000
    v_mad_i32_i16 v124, v56, v18, s96
    v_mad_i32_i16 v56, v56, v18, s96 op_sel:[1,0,0,0]
    v_mad_i32_i16 v125, v57, v18, s96
    v_mad_i32_i16 v57, v57, v18, s96 op_sel:[1,0,0,0]
    v_lshlrev_b32_sdwa v18, 3, v18 dst_sel:DWORD dst_unused:UNUSED_PAD src0_sel:DWORD src1_sel:WORD_1
    v_perm_b32 v56, v56, v124, s97
    v_perm_b32 v57, v57, v125, s97
    v_lshl_add_u64 v[56:57], v[56:57], 0, s[30:31]

    ds_add_rtn_u64 v[56:57], v18, v[56:57] offset:50000
    v_mad_i32_i16 v126, v58, v19, s96
    v_mad_i32_i16 v58, v58, v19, s96 op_sel:[1,0,0,0]
    v_mad_i32_i16 v127, v59, v19, s96
    v_mad_i32_i16 v59, v59, v19, s96 op_sel:[1,0,0,0]
    v_lshlrev_b32_sdwa v19, 3, v19 dst_sel:DWORD dst_unused:UNUSED_PAD src0_sel:DWORD src1_sel:WORD_1
    v_perm_b32 v58, v58, v126, s97
    v_perm_b32 v59, v59, v127, s97
    v_lshl_add_u64 v[58:59], v[58:59], 0, s[30:31]

    ds_add_rtn_u64 v[58:59], v19, v[58:59] offset:50000
    s_waitcnt lgkmcnt(4)
    v_or3_b32 v1, v44, v45, v1
    v_or3_b32 v1, v46, v47, v1
    v_or3_b32 v1, v48, v49, v1
    v_or3_b32 v1, v50, v51, v1
    v_mad_i32_i16 v120, v60, v20, s96
    v_mad_i32_i16 v60, v60, v20, s96 op_sel:[1,0,0,0]
    v_mad_i32_i16 v121, v61, v20, s96
    v_mad_i32_i16 v61, v61, v20, s96 op_sel:[1,0,0,0]
    v_lshlrev_b32_sdwa v20, 3, v20 dst_sel:DWORD dst_unused:UNUSED_PAD src0_sel:DWORD src1_sel:WORD_1
    v_perm_b32 v60, v60, v120, s97
    v_perm_b32 v61, v61, v121, s97
    v_lshl_add_u64 v[60:61], v[60:61], 0, s[30:31]

    ds_add_rtn_u64 v[60:61], v20, v[60:61] offset:50000
    v_mad_i32_i16 v122, v62, v21, s96
    v_mad_i32_i16 v62, v62, v21, s96 op_sel:[1,0,0,0]
    v_mad_i32_i16 v123, v63, v21, s96
    v_mad_i32_i16 v63, v63, v21, s96 op_sel:[1,0,0,0]
    v_lshlrev_b32_sdwa v21, 3, v21 dst_sel:DWORD dst_unused:UNUSED_PAD src0_sel:DWORD src1_sel:WORD_1
    v_perm_b32 v62, v62, v122, s97
    v_perm_b32 v63, v63, v123, s97
    v_lshl_add_u64 v[62:63], v[62:63], 0, s[30:31]

    ds_add_rtn_u64 v[62:63], v21, v[62:63] offset:50000
    v_mad_i32_i16 v124, v64, v22, s96
    v_mad_i32_i16 v64, v64, v22, s96 op_sel:[1,0,0,0]
    v_mad_i32_i16 v125, v65, v22, s96
    v_mad_i32_i16 v65, v65, v22, s96 op_sel:[1,0,0,0]
    v_lshlrev_b32_sdwa v22, 3, v22 dst_sel:DWORD dst_unused:UNUSED_PAD src0_sel:DWORD src1_sel:WORD_1
    v_perm_b32 v64, v64, v124, s97
    v_perm_b32 v65, v65, v125, s97
    v_lshl_add_u64 v[64:65], v[64:65], 0, s[30:31]

    ds_add_rtn_u64 v[64:65], v22, v[64:65] offset:50000
    v_mad_i32_i16 v126, v66, v23, s96
    v_mad_i32_i16 v66, v66, v23, s96 op_sel:[1,0,0,0]
    v_mad_i32_i16 v127, v67, v23, s96
    v_mad_i32_i16 v67, v67, v23, s96 op_sel:[1,0,0,0]
    v_lshlrev_b32_sdwa v23, 3, v23 dst_sel:DWORD dst_unused:UNUSED_PAD src0_sel:DWORD src1_sel:WORD_1
    v_perm_b32 v66, v66, v126, s97
    v_perm_b32 v67, v67, v127, s97
    v_lshl_add_u64 v[66:67], v[66:67], 0, s[30:31]

    ds_add_rtn_u64 v[66:67], v23, v[66:67] offset:50000
    s_waitcnt lgkmcnt(4)
    v_or3_b32 v1, v52, v53, v1
    v_or3_b32 v1, v54, v55, v1
    v_or3_b32 v1, v56, v57, v1
    v_or3_b32 v1, v58, v59, v1
    v_mad_i32_i16 v120, v68, v24, s96
    v_mad_i32_i16 v68, v68, v24, s96 op_sel:[1,0,0,0]
    v_mad_i32_i16 v121, v69, v24, s96
    v_mad_i32_i16 v69, v69, v24, s96 op_sel:[1,0,0,0]
    v_lshlrev_b32_sdwa v24, 3, v24 dst_sel:DWORD dst_unused:UNUSED_PAD src0_sel:DWORD src1_sel:WORD_1
    v_perm_b32 v68, v68, v120, s97
    v_perm_b32 v69, v69, v121, s97
    v_lshl_add_u64 v[68:69], v[68:69], 0, s[30:31]

    ds_add_rtn_u64 v[68:69], v24, v[68:69] offset:50000
    v_mad_i32_i16 v122, v70, v25, s96
    v_mad_i32_i16 v70, v70, v25, s96 op_sel:[1,0,0,0]
    v_mad_i32_i16 v123, v71, v25, s96
    v_mad_i32_i16 v71, v71, v25, s96 op_sel:[1,0,0,0]
    v_lshlrev_b32_sdwa v25, 3, v25 dst_sel:DWORD dst_unused:UNUSED_PAD src0_sel:DWORD src1_sel:WORD_1
    v_perm_b32 v70, v70, v122, s97
    v_perm_b32 v71, v71, v123, s97
    v_lshl_add_u64 v[70:71], v[70:71], 0, s[30:31]

    ds_add_rtn_u64 v[70:71], v25, v[70:71] offset:50000
    v_mad_i32_i16 v124, v72, v26, s96
    v_mad_i32_i16 v72, v72, v26, s96 op_sel:[1,0,0,0]
    v_mad_i32_i16 v125, v73, v26, s96
    v_mad_i32_i16 v73, v73, v26, s96 op_sel:[1,0,0,0]
    v_lshlrev_b32_sdwa v26, 3, v26 dst_sel:DWORD dst_unused:UNUSED_PAD src0_sel:DWORD src1_sel:WORD_1
    v_perm_b32 v72, v72, v124, s97
    v_perm_b32 v73, v73, v125, s97
    v_lshl_add_u64 v[72:73], v[72:73], 0, s[30:31]

    ds_add_rtn_u64 v[72:73], v26, v[72:73] offset:50000
    v_mad_i32_i16 v126, v74, v27, s96
    v_mad_i32_i16 v74, v74, v27, s96 op_sel:[1,0,0,0]
    v_mad_i32_i16 v127, v75, v27, s96
    v_mad_i32_i16 v75, v75, v27, s96 op_sel:[1,0,0,0]
    v_lshlrev_b32_sdwa v27, 3, v27 dst_sel:DWORD dst_unused:UNUSED_PAD src0_sel:DWORD src1_sel:WORD_1
    v_perm_b32 v74, v74, v126, s97
    v_perm_b32 v75, v75, v127, s97
    v_lshl_add_u64 v[74:75], v[74:75], 0, s[30:31]

    ds_add_rtn_u64 v[74:75], v27, v[74:75] offset:50000
    s_waitcnt lgkmcnt(4)
    v_or3_b32 v1, v60, v61, v1
    v_or3_b32 v1, v62, v63, v1
    v_or3_b32 v1, v64, v65, v1
    v_or3_b32 v1, v66, v67, v1
    s_waitcnt lgkmcnt(0)
    v_or3_b32 v1, v68, v69, v1
    v_or3_b32 v1, v70, v71, v1
    v_or3_b32 v1, v72, v73, v1
    v_or3_b32 v1, v74, v75, v1
    s_waitcnt vmcnt(0)
    s_waitcnt lgkmcnt(0)
    s_load_dwordx4 s[28:31], s[86:87], 0
    s_load_dwordx16 s[68:83], s[88:89], 0
    s_load_dwordx8 s[12:19], s[92:93], 0
    s_load_dwordx8 s[56:63], s[94:95], 0
    s_mov_b64 s[48:49], s[90:91]
    s_load_dwordx16 s[84:99], s[48:49], 0

    s_mov_b32 s41, s37
    s_mul_i32 s3, s41, 3125
    s_add_u32 s5, s3, 3126
    s_add_u32 s3, s3, 1
    s_lshr_b32 s3, s3, 1
    s_lshr_b32 s5, s5, 1
    s_sub_u32 s5, s5, s3
    s_sub_u32 s5, s5, 782
    v_cmp_gt_u32 vcc, s5, v0
    s_mul_i32 s5, s36, 6250
    s_add_u32 s3, s3, s5
    v_add_u32 v6, s3, v0
    v_add_u32 v7, 782, v6
    v_mov_b32 v8, 0x2000000
    v_lshlrev_b32 v4, 4, v6
    v_cndmask_b32 v7, v8, v7, vcc
    v_lshlrev_b32 v6, 2, v6
    v_lshlrev_b32 v5, 4, v7
    v_lshlrev_b32 v7, 2, v7
    v_cmp_gt_u32 vcc, 782, v0
    s_mov_b64 exec, vcc
    s_cbranch_execz L_skld_88
    buffer_load_dword v6, v6, s[64:67], 0 offen
    buffer_load_dword v7, v7, s[64:67], 0 offen
    buffer_load_dwordx4 v[108:111], v4, s[8:11], 0 offen
    buffer_load_dwordx4 v[112:115], v5, s[8:11], 0 offen

L_skld_88:
    s_mov_b64 exec, -1
    s_barrier

    v_add_u32 v116, 50000, v3
    v_add_u32 v117, 115536, v3
    v_cmp_gt_u32 vcc, 106, v0

    v_mov_b32 v100, 0
    v_mov_b32 v101, 0
    v_mov_b32 v102, 0
    v_mov_b32 v103, 0
    ds_read_b128 v[76:79], v116 offset:0
    ds_read_b128 v[80:83], v116 offset:16384
    ds_read_b128 v[84:87], v116 offset:32768
    ds_read_b128 v[88:91], v116 offset:49152
    ds_read_b128 v[92:95], v117 offset:0
    ds_read_b128 v[96:99], v117 offset:16384
    s_mov_b64 exec, vcc
    ds_read_b128 v[100:103], v117 offset:32768
    s_mov_b64 exec, -1
    s_mul_i32 s3, s37, 6400000
    s_mul_i32 s5, s36, 100000
    s_add_u32 s3, s3, s5
    s_add_u32 s3, s3, 6799360

    s_add_u32 s20, s6, s3
    s_addc_u32 s21, s7, 0
    s_mov_b32 s22, 100000
    s_mov_b32 s23, 0x20000
    s_waitcnt lgkmcnt(6)
    s_mov_b32 s3, 0
    buffer_store_dwordx4 v[76:79], v3, s[20:23], s3 offen sc1
    s_waitcnt lgkmcnt(5)
    s_mov_b32 s3, 16384
    buffer_store_dwordx4 v[80:83], v3, s[20:23], s3 offen sc1
    s_waitcnt lgkmcnt(4)
    s_mov_b32 s3, 32768
    buffer_store_dwordx4 v[84:87], v3, s[20:23], s3 offen sc1
    s_waitcnt lgkmcnt(3)
    s_mov_b32 s3, 49152
    buffer_store_dwordx4 v[88:91], v3, s[20:23], s3 offen sc1
    s_waitcnt lgkmcnt(2)
    s_mov_b32 s3, 65536
    buffer_store_dwordx4 v[92:95], v3, s[20:23], s3 offen sc1
    s_waitcnt lgkmcnt(1)
    s_mov_b32 s3, 81920
    buffer_store_dwordx4 v[96:99], v3, s[20:23], s3 offen sc1
    s_waitcnt lgkmcnt(0)
    s_mov_b32 s3, 98304
    buffer_store_dwordx4 v[100:103], v3, s[20:23], s3 offen sc1
    v_or3_b32 v1, v76, v77, v1
    v_or3_b32 v1, v78, v79, v1
    v_or3_b32 v1, v80, v81, v1
    v_or3_b32 v1, v82, v83, v1
    v_or3_b32 v1, v84, v85, v1
    v_or3_b32 v1, v86, v87, v1
    v_or3_b32 v1, v88, v89, v1
    v_or3_b32 v1, v90, v91, v1
    v_or3_b32 v1, v92, v93, v1
    v_or3_b32 v1, v94, v95, v1
    v_or3_b32 v1, v96, v97, v1
    v_or3_b32 v1, v98, v99, v1
    v_or3_b32 v1, v100, v101, v1
    v_or3_b32 v1, v102, v103, v1
    v_and_b32 v1, 0x80008000, v1
    v_cmp_ne_u32 vcc, 0, v1
    v_mov_b32 v116, 150024
    v_mov_b32 v117, 1
    s_cbranch_vccz L_nf_85
    ds_write_b32 v116, v117
L_nf_85:
    s_mov_b32 s33, 1
    s_mov_b32 s42, 0
    v_cmp_gt_u32 vcc, 782, v0
    s_mov_b64 exec, vcc
    s_cbranch_execz L_p1end_90
    s_waitcnt vmcnt(9)
    s_branch L_lddone_87
L_fin_86:

    s_load_dwordx2 s[64:65], s[0:1], 24
    s_load_dwordx2 s[86:87], s[0:1], 40
    s_load_dwordx8 s[88:95], s[0:1], 56
    s_mov_b32 s66, 1600000
    s_mov_b32 s67, 0x20000

    s_waitcnt lgkmcnt(0)
    s_load_dwordx4 s[28:31], s[86:87], 0
    s_load_dwordx16 s[68:83], s[88:89], 0
    s_load_dwordx8 s[12:19], s[92:93], 0
    s_load_dwordx8 s[56:63], s[94:95], 0
    s_mov_b64 s[48:49], s[90:91]
    s_load_dwordx16 s[84:99], s[48:49], 0

    s_mov_b32 s42, 1
    s_mov_b32 s41, s37
L_qloop_89:
    s_mul_i32 s3, s41, 3125
    s_add_u32 s5, s3, 3126
    s_add_u32 s3, s3, 1
    s_lshr_b32 s3, s3, 1
    s_lshr_b32 s5, s5, 1
    s_sub_u32 s5, s5, s3
    s_sub_u32 s5, s5, 782
    v_cmp_gt_u32 vcc, s5, v0
    s_mul_i32 s5, s36, 6250
    s_add_u32 s3, s3, s5
    v_add_u32 v6, s3, v0
    v_add_u32 v7, 782, v6
    v_mov_b32 v8, 0x2000000
    v_lshlrev_b32 v4, 4, v6
    v_cndmask_b32 v7, v8, v7, vcc
    v_lshlrev_b32 v6, 2, v6
    v_lshlrev_b32 v5, 4, v7
    v_lshlrev_b32 v7, 2, v7
    v_cmp_gt_u32 vcc, 782, v0
    s_mov_b64 exec, vcc
    s_cbranch_execz L_p1end_90
    buffer_load_dword v6, v6, s[64:67], 0 offen
    buffer_load_dword v7, v7, s[64:67], 0 offen
    buffer_load_dwordx4 v[108:111], v4, s[8:11], 0 offen
    buffer_load_dwordx4 v[112:115], v5, s[8:11], 0 offen

    s_waitcnt vmcnt(2)
L_lddone_87:
    s_waitcnt lgkmcnt(0)
    v_lshlrev_b32 v8, 16, v6
    v_and_b32 v9, s32, v6
    v_lshlrev_b32 v10, 16, v7
    v_and_b32 v11, s32, v7

    s_lshl_b32 s52, s28, 16
    v_subrev_f32 v12, s52, v8
    v_subrev_f32 v20, s52, v9
    v_subrev_f32 v28, s52, v10
    v_subrev_f32 v36, s52, v11
    s_and_b32 s53, s28, s32
    v_subrev_f32 v13, s53, v8
    v_subrev_f32 v21, s53, v9
    v_subrev_f32 v29, s53, v10
    v_subrev_f32 v37, s53, v11
    s_lshl_b32 s52, s29, 16
    v_subrev_f32 v14, s52, v8
    v_subrev_f32 v22, s52, v9
    v_subrev_f32 v30, s52, v10
    v_subrev_f32 v38, s52, v11
    s_and_b32 s53, s29, s32
    v_subrev_f32 v15, s53, v8
    v_subrev_f32 v23, s53, v9
    v_subrev_f32 v31, s53, v10
    v_subrev_f32 v39, s53, v11
    s_lshl_b32 s52, s30, 16
    v_subrev_f32 v16, s52, v8
    v_subrev_f32 v24, s52, v9
    v_subrev_f32 v32, s52, v10
    v_subrev_f32 v40, s52, v11
    s_and_b32 s53, s30, s32
    v_subrev_f32 v17, s53, v8
    v_subrev_f32 v25, s53, v9
    v_subrev_f32 v33, s53, v10
    v_subrev_f32 v41, s53, v11
    s_lshl_b32 s52, s31, 16
    v_subrev_f32 v18, s52, v8
    v_subrev_f32 v26, s52, v9
    v_subrev_f32 v34, s52, v10
    v_subrev_f32 v42, s52, v11
    s_and_b32 s53, s31, s32
    v_subrev_f32 v19, s53, v8
    v_subrev_f32 v27, s53, v9
    v_subrev_f32 v35, s53, v10
    v_subrev_f32 v43, s53, v11
    v_cvt_pk_bf16_f32 v12, v12, v13
    v_cvt_pk_bf16_f32 v14, v14, v15
    v_cvt_pk_bf16_f32 v16, v16, v17
    v_cvt_pk_bf16_f32 v18, v18, v19
    v_cvt_pk_bf16_f32 v20, v20, v21
    v_cvt_pk_bf16_f32 v22, v22, v23
    v_cvt_pk_bf16_f32 v24, v24, v25
    v_cvt_pk_bf16_f32 v26, v26, v27
    v_cvt_pk_bf16_f32 v28, v28, v29
    v_cvt_pk_bf16_f32 v30, v30, v31
    v_cvt_pk_bf16_f32 v32, v32, v33
    v_cvt_pk_bf16_f32 v34, v34, v35
    v_cvt_pk_bf16_f32 v36, v36, v37
    v_cvt_pk_bf16_f32 v38, v38, v39
    v_cvt_pk_bf16_f32 v40, v40, v41
    v_cvt_pk_bf16_f32 v42, v42, v43
    v_and_b32 v13, s32, v12
    v_lshlrev_b32 v12, 16, v12
    v_and_b32 v15, s32, v14
    v_lshlrev_b32 v14, 16, v14
    v_and_b32 v17, s32, v16
    v_lshlrev_b32 v16, 16, v16
    v_and_b32 v19, s32, v18
    v_lshlrev_b32 v18, 16, v18
    v_and_b32 v21, s32, v20
    v_lshlrev_b32 v20, 16, v20
    v_and_b32 v23, s32, v22
    v_lshlrev_b32 v22, 16, v22
    v_and_b32 v25, s32, v24
    v_lshlrev_b32 v24, 16, v24
    v_and_b32 v27, s32, v26
    v_lshlrev_b32 v26, 16, v26
    v_and_b32 v29, s32, v28
    v_lshlrev_b32 v28, 16, v28
    v_and_b32 v31, s32, v30
    v_lshlrev_b32 v30, 16, v30
    v_and_b32 v33, s32, v32
    v_lshlrev_b32 v32, 16, v32
    v_and_b32 v35, s32, v34
    v_lshlrev_b32 v34, 16, v34
    v_and_b32 v37, s32, v36
    v_lshlrev_b32 v36, 16, v36
    v_and_b32 v39, s32, v38
    v_lshlrev_b32 v38, 16, v38
    v_and_b32 v41, s32, v40
    v_lshlrev_b32 v40, 16, v40
    v_and_b32 v43, s32, v42
    v_lshlrev_b32 v42, 16, v42
    v_mul_f32 v12, v12, v12
    v_mul_f32 v13, v13, v13
    v_mul_f32 v14, v14, v14
    v_mul_f32 v15, v15, v15
    v_mul_f32 v16, v16, v16
    v_mul_f32 v17, v17, v17
    v_mul_f32 v18, v18, v18
    v_mul_f32 v19, v19, v19
    v_mul_f32 v20, v20, v20
    v_mul_f32 v21, v21, v21
    v_mul_f32 v22, v22, v22
    v_mul_f32 v23, v23, v23
    v_mul_f32 v24, v24, v24
    v_mul_f32 v25, v25, v25
    v_mul_f32 v26, v26, v26
    v_mul_f32 v27, v27, v27
    v_mul_f32 v28, v28, v28
    v_mul_f32 v29, v29, v29
    v_mul_f32 v30, v30, v30
    v_mul_f32 v31, v31, v31
    v_mul_f32 v32, v32, v32
    v_mul_f32 v33, v33, v33
    v_mul_f32 v34, v34, v34
    v_mul_f32 v35, v35, v35
    v_mul_f32 v36, v36, v36
    v_mul_f32 v37, v37, v37
    v_mul_f32 v38, v38, v38
    v_mul_f32 v39, v39, v39
    v_mul_f32 v40, v40, v40
    v_mul_f32 v41, v41, v41
    v_mul_f32 v42, v42, v42
    v_mul_f32 v43, v43, v43
    v_cvt_pk_bf16_f32 v12, v12, v13
    v_cvt_pk_bf16_f32 v14, v14, v15
    v_cvt_pk_bf16_f32 v16, v16, v17
    v_cvt_pk_bf16_f32 v18, v18, v19
    v_cvt_pk_bf16_f32 v20, v20, v21
    v_cvt_pk_bf16_f32 v22, v22, v23
    v_cvt_pk_bf16_f32 v24, v24, v25
    v_cvt_pk_bf16_f32 v26, v26, v27
    v_cvt_pk_bf16_f32 v28, v28, v29
    v_cvt_pk_bf16_f32 v30, v30, v31
    v_cvt_pk_bf16_f32 v32, v32, v33
    v_cvt_pk_bf16_f32 v34, v34, v35
    v_cvt_pk_bf16_f32 v36, v36, v37
    v_cvt_pk_bf16_f32 v38, v38, v39
    v_cvt_pk_bf16_f32 v40, v40, v41
    v_cvt_pk_bf16_f32 v42, v42, v43
    v_and_b32 v13, s32, v12
    v_lshlrev_b32 v12, 16, v12
    v_and_b32 v15, s32, v14
    v_lshlrev_b32 v14, 16, v14
    v_and_b32 v17, s32, v16
    v_lshlrev_b32 v16, 16, v16
    v_and_b32 v19, s32, v18
    v_lshlrev_b32 v18, 16, v18
    v_and_b32 v21, s32, v20
    v_lshlrev_b32 v20, 16, v20
    v_and_b32 v23, s32, v22
    v_lshlrev_b32 v22, 16, v22
    v_and_b32 v25, s32, v24
    v_lshlrev_b32 v24, 16, v24
    v_and_b32 v27, s32, v26
    v_lshlrev_b32 v26, 16, v26
    v_and_b32 v29, s32, v28
    v_lshlrev_b32 v28, 16, v28
    v_and_b32 v31, s32, v30
    v_lshlrev_b32 v30, 16, v30
    v_and_b32 v33, s32, v32
    v_lshlrev_b32 v32, 16, v32
    v_and_b32 v35, s32, v34
    v_lshlrev_b32 v34, 16, v34
    v_and_b32 v37, s32, v36
    v_lshlrev_b32 v36, 16, v36
    v_and_b32 v39, s32, v38
    v_lshlrev_b32 v38, 16, v38
    v_and_b32 v41, s32, v40
    v_lshlrev_b32 v40, 16, v40
    v_and_b32 v43, s32, v42
    v_lshlrev_b32 v42, 16, v42
    v_mul_f32 v12, 0xc1200000, v12
    v_mul_f32 v13, 0xc1200000, v13
    v_mul_f32 v14, 0xc1200000, v14
    v_mul_f32 v15, 0xc1200000, v15
    v_mul_f32 v16, 0xc1200000, v16
    v_mul_f32 v17, 0xc1200000, v17
    v_mul_f32 v18, 0xc1200000, v18
    v_mul_f32 v19, 0xc1200000, v19
    v_mul_f32 v20, 0xc1200000, v20
    v_mul_f32 v21, 0xc1200000, v21
    v_mul_f32 v22, 0xc1200000, v22
    v_mul_f32 v23, 0xc1200000, v23
    v_mul_f32 v24, 0xc1200000, v24
    v_mul_f32 v25, 0xc1200000, v25
    v_mul_f32 v26, 0xc1200000, v26
    v_mul_f32 v27, 0xc1200000, v27
    v_mul_f32 v28, 0xc1200000, v28
    v_mul_f32 v29, 0xc1200000, v29
    v_mul_f32 v30, 0xc1200000, v30
    v_mul_f32 v31, 0xc1200000, v31
    v_mul_f32 v32, 0xc1200000, v32
    v_mul_f32 v33, 0xc1200000, v33
    v_mul_f32 v34, 0xc1200000, v34
    v_mul_f32 v35, 0xc1200000, v35
    v_mul_f32 v36, 0xc1200000, v36
    v_mul_f32 v37, 0xc1200000, v37
    v_mul_f32 v38, 0xc1200000, v38
    v_mul_f32 v39, 0xc1200000, v39
    v_mul_f32 v40, 0xc1200000, v40
    v_mul_f32 v41, 0xc1200000, v41
    v_mul_f32 v42, 0xc1200000, v42
    v_mul_f32 v43, 0xc1200000, v43
    v_cvt_pk_bf16_f32 v12, v12, v13
    v_cvt_pk_bf16_f32 v14, v14, v15
    v_cvt_pk_bf16_f32 v16, v16, v17
    v_cvt_pk_bf16_f32 v18, v18, v19
    v_cvt_pk_bf16_f32 v20, v20, v21
    v_cvt_pk_bf16_f32 v22, v22, v23
    v_cvt_pk_bf16_f32 v24, v24, v25
    v_cvt_pk_bf16_f32 v26, v26, v27
    v_cvt_pk_bf16_f32 v28, v28, v29
    v_cvt_pk_bf16_f32 v30, v30, v31
    v_cvt_pk_bf16_f32 v32, v32, v33
    v_cvt_pk_bf16_f32 v34, v34, v35
    v_cvt_pk_bf16_f32 v36, v36, v37
    v_cvt_pk_bf16_f32 v38, v38, v39
    v_cvt_pk_bf16_f32 v40, v40, v41
    v_cvt_pk_bf16_f32 v42, v42, v43
    v_and_b32 v13, s32, v12
    v_lshlrev_b32 v12, 16, v12
    v_and_b32 v15, s32, v14
    v_lshlrev_b32 v14, 16, v14
    v_and_b32 v17, s32, v16
    v_lshlrev_b32 v16, 16, v16
    v_and_b32 v19, s32, v18
    v_lshlrev_b32 v18, 16, v18
    v_and_b32 v21, s32, v20
    v_lshlrev_b32 v20, 16, v20
    v_and_b32 v23, s32, v22
    v_lshlrev_b32 v22, 16, v22
    v_and_b32 v25, s32, v24
    v_lshlrev_b32 v24, 16, v24
    v_and_b32 v27, s32, v26
    v_lshlrev_b32 v26, 16, v26
    v_and_b32 v29, s32, v28
    v_lshlrev_b32 v28, 16, v28
    v_and_b32 v31, s32, v30
    v_lshlrev_b32 v30, 16, v30
    v_and_b32 v33, s32, v32
    v_lshlrev_b32 v32, 16, v32
    v_and_b32 v35, s32, v34
    v_lshlrev_b32 v34, 16, v34
    v_and_b32 v37, s32, v36
    v_lshlrev_b32 v36, 16, v36
    v_and_b32 v39, s32, v38
    v_lshlrev_b32 v38, 16, v38
    v_and_b32 v41, s32, v40
    v_lshlrev_b32 v40, 16, v40
    v_and_b32 v43, s32, v42
    v_lshlrev_b32 v42, 16, v42
    v_mul_f32 v12, 0x3fb8aa3b, v12
    v_mul_f32 v13, 0x3fb8aa3b, v13
    v_mul_f32 v14, 0x3fb8aa3b, v14
    v_mul_f32 v15, 0x3fb8aa3b, v15
    v_mul_f32 v16, 0x3fb8aa3b, v16
    v_mul_f32 v17, 0x3fb8aa3b, v17
    v_mul_f32 v18, 0x3fb8aa3b, v18
    v_mul_f32 v19, 0x3fb8aa3b, v19
    v_mul_f32 v20, 0x3fb8aa3b, v20
    v_mul_f32 v21, 0x3fb8aa3b, v21
    v_mul_f32 v22, 0x3fb8aa3b, v22
    v_mul_f32 v23, 0x3fb8aa3b, v23
    v_mul_f32 v24, 0x3fb8aa3b, v24
    v_mul_f32 v25, 0x3fb8aa3b, v25
    v_mul_f32 v26, 0x3fb8aa3b, v26
    v_mul_f32 v27, 0x3fb8aa3b, v27
    v_mul_f32 v28, 0x3fb8aa3b, v28
    v_mul_f32 v29, 0x3fb8aa3b, v29
    v_mul_f32 v30, 0x3fb8aa3b, v30
    v_mul_f32 v31, 0x3fb8aa3b, v31
    v_mul_f32 v32, 0x3fb8aa3b, v32
    v_mul_f32 v33, 0x3fb8aa3b, v33
    v_mul_f32 v34, 0x3fb8aa3b, v34
    v_mul_f32 v35, 0x3fb8aa3b, v35
    v_mul_f32 v36, 0x3fb8aa3b, v36
    v_mul_f32 v37, 0x3fb8aa3b, v37
    v_mul_f32 v38, 0x3fb8aa3b, v38
    v_mul_f32 v39, 0x3fb8aa3b, v39
    v_mul_f32 v40, 0x3fb8aa3b, v40
    v_mul_f32 v41, 0x3fb8aa3b, v41
    v_mul_f32 v42, 0x3fb8aa3b, v42
    v_mul_f32 v43, 0x3fb8aa3b, v43
    v_exp_f32 v12, v12
    v_exp_f32 v13, v13
    v_exp_f32 v14, v14
    v_exp_f32 v15, v15
    v_exp_f32 v16, v16
    v_exp_f32 v17, v17
    v_exp_f32 v18, v18
    v_exp_f32 v19, v19
    v_exp_f32 v20, v20
    v_exp_f32 v21, v21
    v_exp_f32 v22, v22
    v_exp_f32 v23, v23
    v_exp_f32 v24, v24
    v_exp_f32 v25, v25
    v_exp_f32 v26, v26
    v_exp_f32 v27, v27
    v_exp_f32 v28, v28
    v_exp_f32 v29, v29
    v_exp_f32 v30, v30
    v_exp_f32 v31, v31
    v_exp_f32 v32, v32
    v_exp_f32 v33, v33
    v_exp_f32 v34, v34
    v_exp_f32 v35, v35
    v_exp_f32 v36, v36
    v_exp_f32 v37, v37
    v_exp_f32 v38, v38
    v_exp_f32 v39, v39
    v_exp_f32 v40, v40
    v_exp_f32 v41, v41
    v_exp_f32 v42, v42
    v_exp_f32 v43, v43
    s_nop 0
    v_cvt_pk_bf16_f32 v12, v12, v13
    v_cvt_pk_bf16_f32 v14, v14, v15
    v_cvt_pk_bf16_f32 v16, v16, v17
    v_cvt_pk_bf16_f32 v18, v18, v19
    v_cvt_pk_bf16_f32 v20, v20, v21
    v_cvt_pk_bf16_f32 v22, v22, v23
    v_cvt_pk_bf16_f32 v24, v24, v25
    v_cvt_pk_bf16_f32 v26, v26, v27
    v_cvt_pk_bf16_f32 v28, v28, v29
    v_cvt_pk_bf16_f32 v30, v30, v31
    v_cvt_pk_bf16_f32 v32, v32, v33
    v_cvt_pk_bf16_f32 v34, v34, v35
    v_cvt_pk_bf16_f32 v36, v36, v37
    v_cvt_pk_bf16_f32 v38, v38, v39
    v_cvt_pk_bf16_f32 v40, v40, v41
    v_cvt_pk_bf16_f32 v42, v42, v43
L_p1end_90:
    s_mov_b64 exec, -1
    s_cmp_eq_u32 s42, 2
    s_cbranch_scc1 L_part2_91
    s_waitcnt vmcnt(0) lgkmcnt(0)
    s_barrier
    s_cmp_lg_u32 s42, 0
    s_cbranch_scc1 L_nochk_97
    v_mov_b32 v116, 150024
    ds_read_b32 v117, v116
    s_waitcnt lgkmcnt(0)
    v_readfirstlane_b32 s3, v117
    s_nop 1
    s_cmp_lg_u32 s3, 0
    s_cbranch_scc1 L_p2slow_51
L_nochk_97:

    s_load_dwordx2 s[24:25], s[0:1], 88
    s_load_dwordx2 s[44:45], s[0:1], 96
    s_mov_b32 s26, 6400000
    s_mov_b32 s27, 0x20000
    s_movk_i32 s46, 256
    s_mov_b32 s47, 0x20000
    s_lshl_b32 s50, s36, 2
    v_and_b32 v116, 63, v0
    v_lshlrev_b32 v116, 20, v116

    s_add_u32 s20, s6, 6799360
    s_addc_u32 s21, s7, 0
    s_mov_b32 s22, 76800000
    s_mov_b32 s23, 0x20000
    v_readfirstlane_b32 s3, v0
    s_waitcnt lgkmcnt(0)
    s_cmp_eq_u32 s3, 960
    s_cbranch_scc1 L_sync_98
L_part2_91:
    v_cmp_gt_u32 vcc, 782, v0
    s_mov_b64 exec, vcc
    s_cbranch_execz L_p2end_92

    s_pack_ll_b32_b16 s52, s68, s70
    v_dot2_f32_bf16 v60, v12, s52, 0
    v_dot2_f32_bf16 v64, v20, s52, 0
    v_dot2_f32_bf16 v68, v28, s52, 0
    v_dot2_f32_bf16 v72, v36, s52, 0
    s_pack_hh_b32_b16 s53, s68, s70
    v_dot2_f32_bf16 v61, v12, s53, 0
    v_dot2_f32_bf16 v65, v20, s53, 0
    v_dot2_f32_bf16 v69, v28, s53, 0
    v_dot2_f32_bf16 v73, v36, s53, 0
    s_pack_ll_b32_b16 s52, s69, s71
    v_dot2_f32_bf16 v62, v12, s52, 0
    v_dot2_f32_bf16 v66, v20, s52, 0
    v_dot2_f32_bf16 v70, v28, s52, 0
    v_dot2_f32_bf16 v74, v36, s52, 0
    s_pack_hh_b32_b16 s53, s69, s71
    v_dot2_f32_bf16 v63, v12, s53, 0
    v_dot2_f32_bf16 v67, v20, s53, 0
    v_dot2_f32_bf16 v71, v28, s53, 0
    v_dot2_f32_bf16 v75, v36, s53, 0
    s_pack_ll_b32_b16 s52, s72, s74
    v_dot2_f32_bf16 v60, v14, s52, v60
    v_dot2_f32_bf16 v64, v22, s52, v64
    v_dot2_f32_bf16 v68, v30, s52, v68
    v_dot2_f32_bf16 v72, v38, s52, v72
    s_pack_hh_b32_b16 s53, s72, s74
    v_dot2_f32_bf16 v61, v14, s53, v61
    v_dot2_f32_bf16 v65, v22, s53, v65
    v_dot2_f32_bf16 v69, v30, s53, v69
    v_dot2_f32_bf16 v73, v38, s53, v73
    s_pack_ll_b32_b16 s52, s73, s75
    v_dot2_f32_bf16 v62, v14, s52, v62
    v_dot2_f32_bf16 v66, v22, s52, v66
    v_dot2_f32_bf16 v70, v30, s52, v70
    v_dot2_f32_bf16 v74, v38, s52, v74
    s_pack_hh_b32_b16 s53, s73, s75
    v_dot2_f32_bf16 v63, v14, s53, v63
    v_dot2_f32_bf16 v67, v22, s53, v67
    v_dot2_f32_bf16 v71, v30, s53, v71
    v_dot2_f32_bf16 v75, v38, s53, v75
    s_pack_ll_b32_b16 s52, s76, s78
    v_dot2_f32_bf16 v60, v16, s52, v60
    v_dot2_f32_bf16 v64, v24, s52, v64
    v_dot2_f32_bf16 v68, v32, s52, v68
    v_dot2_f32_bf16 v72, v40, s52, v72
    s_pack_hh_b32_b16 s53, s76, s78
    v_dot2_f32_bf16 v61, v16, s53, v61
    v_dot2_f32_bf16 v65, v24, s53, v65
    v_dot2_f32_bf16 v69, v32, s53, v69
    v_dot2_f32_bf16 v73, v40, s53, v73
    s_pack_ll_b32_b16 s52, s77, s79
    v_dot2_f32_bf16 v62, v16, s52, v62
    v_dot2_f32_bf16 v66, v24, s52, v66
    v_dot2_f32_bf16 v70, v32, s52, v70
    v_dot2_f32_bf16 v74, v40, s52, v74
    s_pack_hh_b32_b16 s53, s77, s79
    v_dot2_f32_bf16 v63, v16, s53, v63
    v_dot2_f32_bf16 v67, v24, s53, v67
    v_dot2_f32_bf16 v71, v32, s53, v71
    v_dot2_f32_bf16 v75, v40, s53, v75
    s_pack_ll_b32_b16 s52, s80, s82
    v_dot2_f32_bf16 v60, v18, s52, v60
    v_dot2_f32_bf16 v64, v26, s52, v64
    v_dot2_f32_bf16 v68, v34, s52, v68
    v_dot2_f32_bf16 v72, v42, s52, v72
    s_pack_hh_b32_b16 s53, s80, s82
    v_dot2_f32_bf16 v61, v18, s53, v61
    v_dot2_f32_bf16 v65, v26, s53, v65
    v_dot2_f32_bf16 v69, v34, s53, v69
    v_dot2_f32_bf16 v73, v42, s53, v73
    s_pack_ll_b32_b16 s52, s81, s83
    v_dot2_f32_bf16 v62, v18, s52, v62
    v_dot2_f32_bf16 v66, v26, s52, v66
    v_dot2_f32_bf16 v70, v34, s52, v70
    v_dot2_f32_bf16 v74, v42, s52, v74
    s_pack_hh_b32_b16 s53, s81, s83
    v_dot2_f32_bf16 v63, v18, s53, v63
    v_dot2_f32_bf16 v67, v26, s53, v67
    v_dot2_f32_bf16 v71, v34, s53, v71
    v_dot2_f32_bf16 v75, v42, s53, v75
    s_pack_ll_b32_b16 s52, s84, s86
    v_dot2_f32_bf16 v44, v12, s52, 0
    v_dot2_f32_bf16 v48, v20, s52, 0
    v_dot2_f32_bf16 v52, v28, s52, 0
    v_dot2_f32_bf16 v56, v36, s52, 0
    s_pack_hh_b32_b16 s53, s84, s86
    v_dot2_f32_bf16 v45, v12, s53, 0
    v_dot2_f32_bf16 v49, v20, s53, 0
    v_dot2_f32_bf16 v53, v28, s53, 0
    v_dot2_f32_bf16 v57, v36, s53, 0
    s_pack_ll_b32_b16 s52, s85, s87
    v_dot2_f32_bf16 v46, v12, s52, 0
    v_dot2_f32_bf16 v50, v20, s52, 0
    v_dot2_f32_bf16 v54, v28, s52, 0
    v_dot2_f32_bf16 v58, v36, s52, 0
    s_pack_hh_b32_b16 s53, s85, s87
    v_dot2_f32_bf16 v47, v12, s53, 0
    v_dot2_f32_bf16 v51, v20, s53, 0
    v_dot2_f32_bf16 v55, v28, s53, 0
    v_dot2_f32_bf16 v59, v36, s53, 0
    s_pack_ll_b32_b16 s52, s88, s90
    v_dot2_f32_bf16 v44, v14, s52, v44
    v_dot2_f32_bf16 v48, v22, s52, v48
    v_dot2_f32_bf16 v52, v30, s52, v52
    v_dot2_f32_bf16 v56, v38, s52, v56
    s_pack_hh_b32_b16 s53, s88, s90
    v_dot2_f32_bf16 v45, v14, s53, v45
    v_dot2_f32_bf16 v49, v22, s53, v49
    v_dot2_f32_bf16 v53, v30, s53, v53
    v_dot2_f32_bf16 v57, v38, s53, v57
    s_pack_ll_b32_b16 s52, s89, s91
    v_dot2_f32_bf16 v46, v14, s52, v46
    v_dot2_f32_bf16 v50, v22, s52, v50
    v_dot2_f32_bf16 v54, v30, s52, v54
    v_dot2_f32_bf16 v58, v38, s52, v58
    s_pack_hh_b32_b16 s53, s89, s91
    v_dot2_f32_bf16 v47, v14, s53, v47
    v_dot2_f32_bf16 v51, v22, s53, v51
    v_dot2_f32_bf16 v55, v30, s53, v55
    v_dot2_f32_bf16 v59, v38, s53, v59
    s_pack_ll_b32_b16 s52, s92, s94
    v_dot2_f32_bf16 v44, v16, s52, v44
    v_dot2_f32_bf16 v48, v24, s52, v48
    v_dot2_f32_bf16 v52, v32, s52, v52
    v_dot2_f32_bf16 v56, v40, s52, v56
    s_pack_hh_b32_b16 s53, s92, s94
    v_dot2_f32_bf16 v45, v16, s53, v45
    v_dot2_f32_bf16 v49, v24, s53, v49
    v_dot2_f32_bf16 v53, v32, s53, v53
    v_dot2_f32_bf16 v57, v40, s53, v57
    s_pack_ll_b32_b16 s52, s93, s95
    v_dot2_f32_bf16 v46, v16, s52, v46
    v_dot2_f32_bf16 v50, v24, s52, v50
    v_dot2_f32_bf16 v54, v32, s52, v54
    v_dot2_f32_bf16 v58, v40, s52, v58
    s_pack_hh_b32_b16 s53, s93, s95
    v_dot2_f32_bf16 v47, v16, s53, v47
    v_dot2_f32_bf16 v51, v24, s53, v51
    v_dot2_f32_bf16 v55, v32, s53, v55
    v_dot2_f32_bf16 v59, v40, s53, v59
    s_pack_ll_b32_b16 s52, s96, s98
    v_dot2_f32_bf16 v44, v18, s52, v44
    v_dot2_f32_bf16 v48, v26, s52, v48
    v_dot2_f32_bf16 v52, v34, s52, v52
    v_dot2_f32_bf16 v56, v42, s52, v56
    s_pack_hh_b32_b16 s53, s96, s98
    v_dot2_f32_bf16 v45, v18, s53, v45
    v_dot2_f32_bf16 v49, v26, s53, v49
    v_dot2_f32_bf16 v53, v34, s53, v53
    v_dot2_f32_bf16 v57, v42, s53, v57
    s_pack_ll_b32_b16 s52, s97, s99
    v_dot2_f32_bf16 v46, v18, s52, v46
    v_dot2_f32_bf16 v50, v26, s52, v50
    v_dot2_f32_bf16 v54, v34, s52, v54
    v_dot2_f32_bf16 v58, v42, s52, v58
    s_pack_hh_b32_b16 s53, s97, s99
    v_dot2_f32_bf16 v47, v18, s53, v47
    v_dot2_f32_bf16 v51, v26, s53, v51
    v_dot2_f32_bf16 v55, v34, s53, v55
    v_dot2_f32_bf16 v59, v42, s53, v59
    v_cvt_pk_bf16_f32 v60, v60, v61
    v_cvt_pk_bf16_f32 v62, v62, v63
    v_cvt_pk_bf16_f32 v64, v64, v65
    v_cvt_pk_bf16_f32 v66, v66, v67
    v_cvt_pk_bf16_f32 v68, v68, v69
    v_cvt_pk_bf16_f32 v70, v70, v71
    v_cvt_pk_bf16_f32 v72, v72, v73
    v_cvt_pk_bf16_f32 v74, v74, v75
    v_and_b32 v61, s32, v60
    v_lshlrev_b32 v60, 16, v60
    v_and_b32 v63, s32, v62
    v_lshlrev_b32 v62, 16, v62
    v_and_b32 v65, s32, v64
    v_lshlrev_b32 v64, 16, v64
    v_and_b32 v67, s32, v66
    v_lshlrev_b32 v66, 16, v66
    v_and_b32 v69, s32, v68
    v_lshlrev_b32 v68, 16, v68
    v_and_b32 v71, s32, v70
    v_lshlrev_b32 v70, 16, v70
    v_and_b32 v73, s32, v72
    v_lshlrev_b32 v72, 16, v72
    v_and_b32 v75, s32, v74
    v_lshlrev_b32 v74, 16, v74
L_p2end_92:
    s_mov_b64 exec, -1
    s_cmp_eq_u32 s42, 2
    s_cbranch_scc1 L_post_95
L_bcast_93:
    v_mov_b32 v118, 150016
    s_mov_b32 s42, 2
    s_waitcnt lgkmcnt(0)
    s_barrier
    ds_read_b32 v117, v118
    s_waitcnt lgkmcnt(0)
    v_readfirstlane_b32 s35, v117
    s_nop 1
    s_bitcmp1_b32 s35, 16
    s_cbranch_scc1 L_nextq_94
L_post_95:
    v_cmp_gt_u32 vcc, 782, v0
    s_mov_b64 exec, vcc
    s_cbranch_execz L_postend_96

    s_mov_b32 s3, 0
    buffer_load_dwordx4 v[76:79], v4, s[20:23], s3 offen sc1
    buffer_load_dwordx4 v[92:95], v5, s[20:23], s3 offen sc1
    s_mov_b32 s3, 6400000
    buffer_load_dwordx4 v[80:83], v4, s[20:23], s3 offen sc1
    buffer_load_dwordx4 v[96:99], v5, s[20:23], s3 offen sc1
    s_mov_b32 s3, 12800000
    buffer_load_dwordx4 v[84:87], v4, s[20:23], s3 offen sc1
    buffer_load_dwordx4 v[100:103], v5, s[20:23], s3 offen sc1
    s_mov_b32 s3, 19200000
    buffer_load_dwordx4 v[88:91], v4, s[20:23], s3 offen sc1
    buffer_load_dwordx4 v[104:107], v5, s[20:23], s3 offen sc1
    s_and_b32 s3, s35, 0xf0
    s_cbranch_scc1 L_fgen_102
    s_waitcnt vmcnt(0)

    v_add_u32 v76, v76, v80
    v_add_u32 v84, v84, v88
    v_add_u32 v77, v77, v81
    v_add_u32 v85, v85, v89
    v_add_u32 v78, v78, v82
    v_add_u32 v86, v86, v90
    v_add_u32 v79, v79, v83
    v_add_u32 v87, v87, v91
    v_add_u32_sdwa v12, v76, v84 dst_sel:DWORD dst_unused:UNUSED_PAD src0_sel:WORD_0 src1_sel:WORD_0
    v_add_u32_sdwa v13, v76, v84 dst_sel:DWORD dst_unused:UNUSED_PAD src0_sel:WORD_1 src1_sel:WORD_1
    v_add_u32_sdwa v14, v77, v85 dst_sel:DWORD dst_unused:UNUSED_PAD src0_sel:WORD_0 src1_sel:WORD_0
    v_add_u32_sdwa v15, v77, v85 dst_sel:DWORD dst_unused:UNUSED_PAD src0_sel:WORD_1 src1_sel:WORD_1
    v_add_u32_sdwa v16, v78, v86 dst_sel:DWORD dst_unused:UNUSED_PAD src0_sel:WORD_0 src1_sel:WORD_0
    v_add_u32_sdwa v17, v78, v86 dst_sel:DWORD dst_unused:UNUSED_PAD src0_sel:WORD_1 src1_sel:WORD_1
    v_add_u32_sdwa v18, v79, v87 dst_sel:DWORD dst_unused:UNUSED_PAD src0_sel:WORD_0 src1_sel:WORD_0
    v_add_u32_sdwa v19, v79, v87 dst_sel:DWORD dst_unused:UNUSED_PAD src0_sel:WORD_1 src1_sel:WORD_1
    v_add_u32 v92, v92, v96
    v_add_u32 v100, v100, v104
    v_add_u32 v93, v93, v97
    v_add_u32 v101, v101, v105
    v_add_u32 v94, v94, v98
    v_add_u32 v102, v102, v106
    v_add_u32 v95, v95, v99
    v_add_u32 v103, v103, v107
    v_add_u32_sdwa v20, v92, v100 dst_sel:DWORD dst_unused:UNUSED_PAD src0_sel:WORD_0 src1_sel:WORD_0
    v_add_u32_sdwa v21, v92, v100 dst_sel:DWORD dst_unused:UNUSED_PAD src0_sel:WORD_1 src1_sel:WORD_1
    v_add_u32_sdwa v22, v93, v101 dst_sel:DWORD dst_unused:UNUSED_PAD src0_sel:WORD_0 src1_sel:WORD_0
    v_add_u32_sdwa v23, v93, v101 dst_sel:DWORD dst_unused:UNUSED_PAD src0_sel:WORD_1 src1_sel:WORD_1
    v_add_u32_sdwa v24, v94, v102 dst_sel:DWORD dst_unused:UNUSED_PAD src0_sel:WORD_0 src1_sel:WORD_0
    v_add_u32_sdwa v25, v94, v102 dst_sel:DWORD dst_unused:UNUSED_PAD src0_sel:WORD_1 src1_sel:WORD_1
    v_add_u32_sdwa v26, v95, v103 dst_sel:DWORD dst_unused:UNUSED_PAD src0_sel:WORD_0 src1_sel:WORD_0
    v_add_u32_sdwa v27, v95, v103 dst_sel:DWORD dst_unused:UNUSED_PAD src0_sel:WORD_1 src1_sel:WORD_1
    v_add_u32 v12, 0xffff0000, v12
    v_add_u32 v13, 0xffff0000, v13
    v_add_u32 v14, 0xffff0000, v14
    v_add_u32 v15, 0xffff0000, v15
    v_add_u32 v16, 0xffff0000, v16
    v_add_u32 v17, 0xffff0000, v17
    v_add_u32 v18, 0xffff0000, v18
    v_add_u32 v19, 0xffff0000, v19
    v_add_u32 v20, 0xffff0000, v20
    v_add_u32 v21, 0xffff0000, v21
    v_add_u32 v22, 0xffff0000, v22
    v_add_u32 v23, 0xffff0000, v23
    v_add_u32 v24, 0xffff0000, v24
    v_add_u32 v25, 0xffff0000, v25
    v_add_u32 v26, 0xffff0000, v26
    v_add_u32 v27, 0xffff0000, v27
    v_cvt_f32_i32 v12, v12
    v_cvt_f32_i32 v13, v13
    v_cvt_f32_i32 v14, v14
    v_cvt_f32_i32 v15, v15
    v_cvt_f32_i32 v16, v16
    v_cvt_f32_i32 v17, v17
    v_cvt_f32_i32 v18, v18
    v_cvt_f32_i32 v19, v19
    v_cvt_f32_i32 v20, v20
    v_cvt_f32_i32 v21, v21
    v_cvt_f32_i32 v22, v22
    v_cvt_f32_i32 v23, v23
    v_cvt_f32_i32 v24, v24
    v_cvt_f32_i32 v25, v25
    v_cvt_f32_i32 v26, v26
    v_cvt_f32_i32 v27, v27
    v_mul_f32 v12, s34, v12
    v_mul_f32 v13, s34, v13
    v_mul_f32 v14, s34, v14
    v_mul_f32 v15, s34, v15
    v_mul_f32 v16, s34, v16
    v_mul_f32 v17, s34, v17
    v_mul_f32 v18, s34, v18
    v_mul_f32 v19, s34, v19
    v_mul_f32 v20, s34, v20
    v_mul_f32 v21, s34, v21
    v_mul_f32 v22, s34, v22
    v_mul_f32 v23, s34, v23
    v_mul_f32 v24, s34, v24
    v_mul_f32 v25, s34, v25
    v_mul_f32 v26, s34, v26
    v_mul_f32 v27, s34, v27
L_fbk_103:
    s_lshl_b32 s52, s12, 16
    v_mul_f32 v28, s52, v12
    v_mul_f32 v32, s52, v16
    v_mul_f32 v36, s52, v20
    v_mul_f32 v40, s52, v24
    s_and_b32 s53, s12, s32
    v_mul_f32 v29, s53, v12
    v_mul_f32 v33, s53, v16
    v_mul_f32 v37, s53, v20
    v_mul_f32 v41, s53, v24
    s_lshl_b32 s52, s13, 16
    v_mul_f32 v30, s52, v12
    v_mul_f32 v34, s52, v16
    v_mul_f32 v38, s52, v20
    v_mul_f32 v42, s52, v24
    s_and_b32 s53, s13, s32
    v_mul_f32 v31, s53, v12
    v_mul_f32 v35, s53, v16
    v_mul_f32 v39, s53, v20
    v_mul_f32 v43, s53, v24
    s_lshl_b32 s52, s14, 16
    v_fmac_f32 v28, s52, v13
    v_fmac_f32 v32, s52, v17
    v_fmac_f32 v36, s52, v21
    v_fmac_f32 v40, s52, v25
    s_and_b32 s53, s14, s32
    v_fmac_f32 v29, s53, v13
    v_fmac_f32 v33, s53, v17
    v_fmac_f32 v37, s53, v21
    v_fmac_f32 v41, s53, v25
    s_lshl_b32 s52, s15, 16
    v_fmac_f32 v30, s52, v13
    v_fmac_f32 v34, s52, v17
    v_fmac_f32 v38, s52, v21
    v_fmac_f32 v42, s52, v25
    s_and_b32 s53, s15, s32
    v_fmac_f32 v31, s53, v13
    v_fmac_f32 v35, s53, v17
    v_fmac_f32 v39, s53, v21
    v_fmac_f32 v43, s53, v25
    s_lshl_b32 s52, s16, 16
    v_fmac_f32 v28, s52, v14
    v_fmac_f32 v32, s52, v18
    v_fmac_f32 v36, s52, v22
    v_fmac_f32 v40, s52, v26
    s_and_b32 s53, s16, s32
    v_fmac_f32 v29, s53, v14
    v_fmac_f32 v33, s53, v18
    v_fmac_f32 v37, s53, v22
    v_fmac_f32 v41, s53, v26
    s_lshl_b32 s52, s17, 16
    v_fmac_f32 v30, s52, v14
    v_fmac_f32 v34, s52, v18
    v_fmac_f32 v38, s52, v22
    v_fmac_f32 v42, s52, v26
    s_and_b32 s53, s17, s32
    v_fmac_f32 v31, s53, v14
    v_fmac_f32 v35, s53, v18
    v_fmac_f32 v39, s53, v22
    v_fmac_f32 v43, s53, v26
    s_lshl_b32 s52, s18, 16
    v_fmac_f32 v28, s52, v15
    v_fmac_f32 v32, s52, v19
    v_fmac_f32 v36, s52, v23
    v_fmac_f32 v40, s52, v27
    s_and_b32 s53, s18, s32
    v_fmac_f32 v29, s53, v15
    v_fmac_f32 v33, s53, v19
    v_fmac_f32 v37, s53, v23
    v_fmac_f32 v41, s53, v27
    s_lshl_b32 s52, s19, 16
    v_fmac_f32 v30, s52, v15
    v_fmac_f32 v34, s52, v19
    v_fmac_f32 v38, s52, v23
    v_fmac_f32 v42, s52, v27
    s_and_b32 s53, s19, s32
    v_fmac_f32 v31, s53, v15
    v_fmac_f32 v35, s53, v19
    v_fmac_f32 v39, s53, v23
    v_fmac_f32 v43, s53, v27
    v_mul_f32 v28, v28, v44
    v_mul_f32 v29, v29, v45
    v_mul_f32 v30, v30, v46
    v_mul_f32 v31, v31, v47
    v_mul_f32 v32, v32, v48
    v_mul_f32 v33, v33, v49
    v_mul_f32 v34, v34, v50
    v_mul_f32 v35, v35, v51
    v_mul_f32 v36, v36, v52
    v_mul_f32 v37, v37, v53
    v_mul_f32 v38, v38, v54
    v_mul_f32 v39, v39, v55
    v_mul_f32 v40, v40, v56
    v_mul_f32 v41, v41, v57
    v_mul_f32 v42, v42, v58
    v_mul_f32 v43, v43, v59
    v_cvt_pk_bf16_f32 v28, v28, v29
    v_cvt_pk_bf16_f32 v30, v30, v31
    v_cvt_pk_bf16_f32 v32, v32, v33
    v_cvt_pk_bf16_f32 v34, v34, v35
    v_cvt_pk_bf16_f32 v36, v36, v37
    v_cvt_pk_bf16_f32 v38, v38, v39
    v_cvt_pk_bf16_f32 v40, v40, v41
    v_cvt_pk_bf16_f32 v42, v42, v43
    s_pack_ll_b32_b16 s52, s56, s58
    v_dot2_f32_bf16 v12, v28, s52, 0
    v_dot2_f32_bf16 v16, v32, s52, 0
    v_dot2_f32_bf16 v20, v36, s52, 0
    v_dot2_f32_bf16 v24, v40, s52, 0
    s_pack_hh_b32_b16 s53, s56, s58
    v_dot2_f32_bf16 v13, v28, s53, 0
    v_dot2_f32_bf16 v17, v32, s53, 0
    v_dot2_f32_bf16 v21, v36, s53, 0
    v_dot2_f32_bf16 v25, v40, s53, 0
    s_pack_ll_b32_b16 s52, s57, s59
    v_dot2_f32_bf16 v14, v28, s52, 0
    v_dot2_f32_bf16 v18, v32, s52, 0
    v_dot2_f32_bf16 v22, v36, s52, 0
    v_dot2_f32_bf16 v26, v40, s52, 0
    s_pack_hh_b32_b16 s53, s57, s59
    v_dot2_f32_bf16 v15, v28, s53, 0
    v_dot2_f32_bf16 v19, v32, s53, 0
    v_dot2_f32_bf16 v23, v36, s53, 0
    v_dot2_f32_bf16 v27, v40, s53, 0
    s_pack_ll_b32_b16 s52, s60, s62
    v_dot2_f32_bf16 v12, v30, s52, v12
    v_dot2_f32_bf16 v16, v34, s52, v16
    v_dot2_f32_bf16 v20, v38, s52, v20
    v_dot2_f32_bf16 v24, v42, s52, v24
    s_pack_hh_b32_b16 s53, s60, s62
    v_dot2_f32_bf16 v13, v30, s53, v13
    v_dot2_f32_bf16 v17, v34, s53, v17
    v_dot2_f32_bf16 v21, v38, s53, v21
    v_dot2_f32_bf16 v25, v42, s53, v25
    s_pack_ll_b32_b16 s52, s61, s63
    v_dot2_f32_bf16 v14, v30, s52, v14
    v_dot2_f32_bf16 v18, v34, s52, v18
    v_dot2_f32_bf16 v22, v38, s52, v22
    v_dot2_f32_bf16 v26, v42, s52, v26
    s_pack_hh_b32_b16 s53, s61, s63
    v_dot2_f32_bf16 v15, v30, s53, v15
    v_dot2_f32_bf16 v19, v34, s53, v19
    v_dot2_f32_bf16 v23, v38, s53, v23
    v_dot2_f32_bf16 v27, v42, s53, v27
    v_lshlrev_b32 v44, 16, v108
    v_and_b32 v45, s32, v108
    v_lshlrev_b32 v46, 16, v109
    v_and_b32 v47, s32, v109
    v_lshlrev_b32 v48, 16, v110
    v_and_b32 v49, s32, v110
    v_lshlrev_b32 v50, 16, v111
    v_and_b32 v51, s32, v111
    v_lshlrev_b32 v52, 16, v112
    v_and_b32 v53, s32, v112
    v_lshlrev_b32 v54, 16, v113
    v_and_b32 v55, s32, v113
    v_lshlrev_b32 v56, 16, v114
    v_and_b32 v57, s32, v114
    v_lshlrev_b32 v58, 16, v115
    v_and_b32 v59, s32, v115
    v_cvt_pk_bf16_f32 v12, v12, v13
    v_cvt_pk_bf16_f32 v14, v14, v15
    v_cvt_pk_bf16_f32 v16, v16, v17
    v_cvt_pk_bf16_f32 v18, v18, v19
    v_cvt_pk_bf16_f32 v20, v20, v21
    v_cvt_pk_bf16_f32 v22, v22, v23
    v_cvt_pk_bf16_f32 v24, v24, v25
    v_cvt_pk_bf16_f32 v26, v26, v27
    v_and_b32 v13, s32, v12
    v_lshlrev_b32 v12, 16, v12
    v_and_b32 v15, s32, v14
    v_lshlrev_b32 v14, 16, v14
    v_and_b32 v17, s32, v16
    v_lshlrev_b32 v16, 16, v16
    v_and_b32 v19, s32, v18
    v_lshlrev_b32 v18, 16, v18
    v_and_b32 v21, s32, v20
    v_lshlrev_b32 v20, 16, v20
    v_and_b32 v23, s32, v22
    v_lshlrev_b32 v22, 16, v22
    v_and_b32 v25, s32, v24
    v_lshlrev_b32 v24, 16, v24
    v_and_b32 v27, s32, v26
    v_lshlrev_b32 v26, 16, v26
    v_mul_f32 v12, v12, v60
    v_mul_f32 v13, v13, v61
    v_mul_f32 v14, v14, v62
    v_mul_f32 v15, v15, v63
    v_mul_f32 v16, v16, v64
    v_mul_f32 v17, v17, v65
    v_mul_f32 v18, v18, v66
    v_mul_f32 v19, v19, v67
    v_mul_f32 v20, v20, v68
    v_mul_f32 v21, v21, v69
    v_mul_f32 v22, v22, v70
    v_mul_f32 v23, v23, v71
    v_mul_f32 v24, v24, v72
    v_mul_f32 v25, v25, v73
    v_mul_f32 v26, v26, v74
    v_mul_f32 v27, v27, v75
    v_cvt_pk_bf16_f32 v12, v12, v13
    v_cvt_pk_bf16_f32 v14, v14, v15
    v_cvt_pk_bf16_f32 v16, v16, v17
    v_cvt_pk_bf16_f32 v18, v18, v19
    v_cvt_pk_bf16_f32 v20, v20, v21
    v_cvt_pk_bf16_f32 v22, v22, v23
    v_cvt_pk_bf16_f32 v24, v24, v25
    v_cvt_pk_bf16_f32 v26, v26, v27
    v_and_b32 v13, s32, v12
    v_lshlrev_b32 v12, 16, v12
    v_and_b32 v15, s32, v14
    v_lshlrev_b32 v14, 16, v14
    v_and_b32 v17, s32, v16
    v_lshlrev_b32 v16, 16, v16
    v_and_b32 v19, s32, v18
    v_lshlrev_b32 v18, 16, v18
    v_and_b32 v21, s32, v20
    v_lshlrev_b32 v20, 16, v20
    v_and_b32 v23, s32, v22
    v_lshlrev_b32 v22, 16, v22
    v_and_b32 v25, s32, v24
    v_lshlrev_b32 v24, 16, v24
    v_and_b32 v27, s32, v26
    v_lshlrev_b32 v26, 16, v26
    v_add_f32 v12, v12, v44
    v_add_f32 v13, v13, v45
    v_add_f32 v14, v14, v46
    v_add_f32 v15, v15, v47
    v_add_f32 v16, v16, v48
    v_add_f32 v17, v17, v49
    v_add_f32 v18, v18, v50
    v_add_f32 v19, v19, v51
    v_add_f32 v20, v20, v52
    v_add_f32 v21, v21, v53
    v_add_f32 v22, v22, v54
    v_add_f32 v23, v23, v55
    v_add_f32 v24, v24, v56
    v_add_f32 v25, v25, v57
    v_add_f32 v26, v26, v58
    v_add_f32 v27, v27, v59
    v_cvt_pk_bf16_f32 v28, v12, v13
    v_cvt_pk_bf16_f32 v29, v14, v15
    v_cvt_pk_bf16_f32 v30, v16, v17
    v_cvt_pk_bf16_f32 v31, v18, v19
    v_cvt_pk_bf16_f32 v32, v20, v21
    v_cvt_pk_bf16_f32 v33, v22, v23
    v_cvt_pk_bf16_f32 v34, v24, v25
    v_cvt_pk_bf16_f32 v35, v26, v27
    buffer_store_dwordx4 v[28:31], v4, s[24:27], 0 offen
    buffer_store_dwordx4 v[32:35], v5, s[24:27], 0 offen
L_postend_96:
    s_mov_b64 exec, -1
L_nextq_94:
    s_bfe_u32 s3, s35, 0x40008
    s_cbranch_scc0 L_fend_112
    s_ff1_i32_b32 s41, s3
    s_add_u32 s3, s41, 8
    s_bitset0_b32 s35, s3
    s_branch L_qloop_89
L_fend_112:

L_p2done_50:
    s_endpgm

L_ufix_52:
    v_and_b32 v117, 63, v0
    v_lshlrev_b32 v117, 2, v117
    s_sub_i32 s54, s42, 1024
    v_cmp_le_i32 vcc, s54, v117
    s_mov_b64 exec, vcc
    v_mov_b32 v12, 0
    v_mov_b32 v44, 0
    s_mov_b64 exec, -1
    s_sub_i32 s54, s42, 1025
    v_cmp_le_i32 vcc, s54, v117
    s_mov_b64 exec, vcc
    v_mov_b32 v13, 0
    v_mov_b32 v46, 0
    s_mov_b64 exec, -1
    s_sub_i32 s54, s42, 1026
    v_cmp_le_i32 vcc, s54, v117
    s_mov_b64 exec, vcc
    v_mov_b32 v14, 0
    v_mov_b32 v48, 0
    s_mov_b64 exec, -1
    s_sub_i32 s54, s42, 1027
    v_cmp_le_i32 vcc, s54, v117
    s_mov_b64 exec, vcc
    v_mov_b32 v15, 0
    v_mov_b32 v50, 0
    s_mov_b64 exec, -1
    s_branch L_uback_53
L_ufix_54:
    v_and_b32 v117, 63, v0
    v_lshlrev_b32 v117, 2, v117
    s_sub_i32 s54, s42, 1536
    v_cmp_le_i32 vcc, s54, v117
    s_mov_b64 exec, vcc
    v_mov_b32 v16, 0
    v_mov_b32 v52, 0
    s_mov_b64 exec, -1
    s_sub_i32 s54, s42, 1537
    v_cmp_le_i32 vcc, s54, v117
    s_mov_b64 exec, vcc
    v_mov_b32 v17, 0
    v_mov_b32 v54, 0
    s_mov_b64 exec, -1
    s_sub_i32 s54, s42, 1538
    v_cmp_le_i32 vcc, s54, v117
    s_mov_b64 exec, vcc
    v_mov_b32 v18, 0
    v_mov_b32 v56, 0
    s_mov_b64 exec, -1
    s_sub_i32 s54, s42, 1539
    v_cmp_le_i32 vcc, s54, v117
    s_mov_b64 exec, vcc
    v_mov_b32 v19, 0
    v_mov_b32 v58, 0
    s_mov_b64 exec, -1
    s_branch L_uback_55
L_ufix_56:
    v_and_b32 v117, 63, v0
    v_lshlrev_b32 v117, 2, v117
    s_sub_i32 s54, s42, 2048
    v_cmp_le_i32 vcc, s54, v117
    s_mov_b64 exec, vcc
    v_mov_b32 v20, 0
    v_mov_b32 v60, 0
    s_mov_b64 exec, -1
    s_sub_i32 s54, s42, 2049
    v_cmp_le_i32 vcc, s54, v117
    s_mov_b64 exec, vcc
    v_mov_b32 v21, 0
    v_mov_b32 v62, 0
    s_mov_b64 exec, -1
    s_sub_i32 s54, s42, 2050
    v_cmp_le_i32 vcc, s54, v117
    s_mov_b64 exec, vcc
    v_mov_b32 v22, 0
    v_mov_b32 v64, 0
    s_mov_b64 exec, -1
    s_sub_i32 s54, s42, 2051
    v_cmp_le_i32 vcc, s54, v117
    s_mov_b64 exec, vcc
    v_mov_b32 v23, 0
    v_mov_b32 v66, 0
    s_mov_b64 exec, -1
    s_branch L_uback_57
L_ufix_58:
    v_and_b32 v117, 63, v0
    v_lshlrev_b32 v117, 2, v117
    s_sub_i32 s54, s42, 2560
    v_cmp_le_i32 vcc, s54, v117
    s_mov_b64 exec, vcc
    v_mov_b32 v24, 0
    v_mov_b32 v68, 0
    s_mov_b64 exec, -1
    s_sub_i32 s54, s42, 2561
    v_cmp_le_i32 vcc, s54, v117
    s_mov_b64 exec, vcc
    v_mov_b32 v25, 0
    v_mov_b32 v70, 0
    s_mov_b64 exec, -1
    s_sub_i32 s54, s42, 2562
    v_cmp_le_i32 vcc, s54, v117
    s_mov_b64 exec, vcc
    v_mov_b32 v26, 0
    v_mov_b32 v72, 0
    s_mov_b64 exec, -1
    s_sub_i32 s54, s42, 2563
    v_cmp_le_i32 vcc, s54, v117
    s_mov_b64 exec, vcc
    v_mov_b32 v27, 0
    v_mov_b32 v74, 0
    s_mov_b64 exec, -1
    s_branch L_uback_59
L_ufix_60:
    v_and_b32 v117, 63, v0
    v_lshlrev_b32 v117, 2, v117
    s_sub_i32 s54, s42, 0
    v_cmp_le_i32 vcc, s54, v117
    s_mov_b64 exec, vcc
    v_mov_b32 v4, 0
    v_mov_b32 v28, 0
    s_mov_b64 exec, -1
    s_sub_i32 s54, s42, 1
    v_cmp_le_i32 vcc, s54, v117
    s_mov_b64 exec, vcc
    v_mov_b32 v5, 0
    v_mov_b32 v30, 0
    s_mov_b64 exec, -1
    s_sub_i32 s54, s42, 2
    v_cmp_le_i32 vcc, s54, v117
    s_mov_b64 exec, vcc
    v_mov_b32 v6, 0
    v_mov_b32 v32, 0
    s_mov_b64 exec, -1
    s_sub_i32 s54, s42, 3
    v_cmp_le_i32 vcc, s54, v117
    s_mov_b64 exec, vcc
    v_mov_b32 v7, 0
    v_mov_b32 v34, 0
    s_mov_b64 exec, -1
    s_branch L_uback_61
L_ufix_62:
    v_and_b32 v117, 63, v0
    v_lshlrev_b32 v117, 2, v117
    s_sub_i32 s54, s42, 512
    v_cmp_le_i32 vcc, s54, v117
    s_mov_b64 exec, vcc
    v_mov_b32 v8, 0
    v_mov_b32 v36, 0
    s_mov_b64 exec, -1
    s_sub_i32 s54, s42, 513
    v_cmp_le_i32 vcc, s54, v117
    s_mov_b64 exec, vcc
    v_mov_b32 v9, 0
    v_mov_b32 v38, 0
    s_mov_b64 exec, -1
    s_sub_i32 s54, s42, 514
    v_cmp_le_i32 vcc, s54, v117
    s_mov_b64 exec, vcc
    v_mov_b32 v10, 0
    v_mov_b32 v40, 0
    s_mov_b64 exec, -1
    s_sub_i32 s54, s42, 515
    v_cmp_le_i32 vcc, s54, v117
    s_mov_b64 exec, vcc
    v_mov_b32 v11, 0
    v_mov_b32 v42, 0
    s_mov_b64 exec, -1
    s_branch L_uback_63
L_ufix_69:
    v_and_b32 v117, 63, v0
    v_lshlrev_b32 v117, 2, v117
    s_sub_i32 s54, s42, 3072
    v_cmp_le_i32 vcc, s54, v117
    s_mov_b64 exec, vcc
    v_mov_b32 v106, 0
    v_mov_b32 v120, 0
    s_mov_b64 exec, -1
    s_sub_i32 s54, s42, 3073
    v_cmp_le_i32 vcc, s54, v117
    s_mov_b64 exec, vcc
    v_mov_b32 v107, 0
    v_mov_b32 v122, 0
    s_mov_b64 exec, -1
    s_sub_i32 s54, s42, 3074
    v_cmp_le_i32 vcc, s54, v117
    s_mov_b64 exec, vcc
    v_mov_b32 v108, 0
    v_mov_b32 v124, 0
    s_mov_b64 exec, -1
    s_sub_i32 s54, s42, 3075
    v_cmp_le_i32 vcc, s54, v117
    s_mov_b64 exec, vcc
    v_mov_b32 v109, 0
    v_mov_b32 v126, 0
    s_mov_b64 exec, -1
    s_branch L_uback_70
L_ufix_73:
    v_and_b32 v117, 63, v0
    v_lshlrev_b32 v117, 2, v117
    s_sub_i32 s54, s42, 1024
    v_cmp_le_i32 vcc, s54, v117
    s_mov_b64 exec, vcc
    v_mov_b32 v12, 0
    v_mov_b32 v44, 0
    s_mov_b64 exec, -1
    s_sub_i32 s54, s42, 1025
    v_cmp_le_i32 vcc, s54, v117
    s_mov_b64 exec, vcc
    v_mov_b32 v13, 0
    v_mov_b32 v46, 0
    s_mov_b64 exec, -1
    s_sub_i32 s54, s42, 1026
    v_cmp_le_i32 vcc, s54, v117
    s_mov_b64 exec, vcc
    v_mov_b32 v14, 0
    v_mov_b32 v48, 0
    s_mov_b64 exec, -1
    s_sub_i32 s54, s42, 1027
    v_cmp_le_i32 vcc, s54, v117
    s_mov_b64 exec, vcc
    v_mov_b32 v15, 0
    v_mov_b32 v50, 0
    s_mov_b64 exec, -1
    s_branch L_uback_74
L_ufix_75:
    v_and_b32 v117, 63, v0
    v_lshlrev_b32 v117, 2, v117
    s_sub_i32 s54, s42, 1536
    v_cmp_le_i32 vcc, s54, v117
    s_mov_b64 exec, vcc
    v_mov_b32 v16, 0
    v_mov_b32 v52, 0
    s_mov_b64 exec, -1
    s_sub_i32 s54, s42, 1537
    v_cmp_le_i32 vcc, s54, v117
    s_mov_b64 exec, vcc
    v_mov_b32 v17, 0
    v_mov_b32 v54, 0
    s_mov_b64 exec, -1
    s_sub_i32 s54, s42, 1538
    v_cmp_le_i32 vcc, s54, v117
    s_mov_b64 exec, vcc
    v_mov_b32 v18, 0
    v_mov_b32 v56, 0
    s_mov_b64 exec, -1
    s_sub_i32 s54, s42, 1539
    v_cmp_le_i32 vcc, s54, v117
    s_mov_b64 exec, vcc
    v_mov_b32 v19, 0
    v_mov_b32 v58, 0
    s_mov_b64 exec, -1
    s_branch L_uback_76
L_ufix_77:
    v_and_b32 v117, 63, v0
    v_lshlrev_b32 v117, 2, v117
    s_sub_i32 s54, s42, 2048
    v_cmp_le_i32 vcc, s54, v117
    s_mov_b64 exec, vcc
    v_mov_b32 v20, 0
    v_mov_b32 v60, 0
    s_mov_b64 exec, -1
    s_sub_i32 s54, s42, 2049
    v_cmp_le_i32 vcc, s54, v117
    s_mov_b64 exec, vcc
    v_mov_b32 v21, 0
    v_mov_b32 v62, 0
    s_mov_b64 exec, -1
    s_sub_i32 s54, s42, 2050
    v_cmp_le_i32 vcc, s54, v117
    s_mov_b64 exec, vcc
    v_mov_b32 v22, 0
    v_mov_b32 v64, 0
    s_mov_b64 exec, -1
    s_sub_i32 s54, s42, 2051
    v_cmp_le_i32 vcc, s54, v117
    s_mov_b64 exec, vcc
    v_mov_b32 v23, 0
    v_mov_b32 v66, 0
    s_mov_b64 exec, -1
    s_branch L_uback_78
L_ufix_79:
    v_and_b32 v117, 63, v0
    v_lshlrev_b32 v117, 2, v117
    s_sub_i32 s54, s42, 2560
    v_cmp_le_i32 vcc, s54, v117
    s_mov_b64 exec, vcc
    v_mov_b32 v24, 0
    v_mov_b32 v68, 0
    s_mov_b64 exec, -1
    s_sub_i32 s54, s42, 2561
    v_cmp_le_i32 vcc, s54, v117
    s_mov_b64 exec, vcc
    v_mov_b32 v25, 0
    v_mov_b32 v70, 0
    s_mov_b64 exec, -1
    s_sub_i32 s54, s42, 2562
    v_cmp_le_i32 vcc, s54, v117
    s_mov_b64 exec, vcc
    v_mov_b32 v26, 0
    v_mov_b32 v72, 0
    s_mov_b64 exec, -1
    s_sub_i32 s54, s42, 2563
    v_cmp_le_i32 vcc, s54, v117
    s_mov_b64 exec, vcc
    v_mov_b32 v27, 0
    v_mov_b32 v74, 0
    s_mov_b64 exec, -1
    s_branch L_uback_80
L_ufix_81:
    v_and_b32 v117, 63, v0
    v_lshlrev_b32 v117, 2, v117
    s_sub_i32 s54, s42, 0
    v_cmp_le_i32 vcc, s54, v117
    s_mov_b64 exec, vcc
    v_mov_b32 v4, 0
    v_mov_b32 v28, 0
    s_mov_b64 exec, -1
    s_sub_i32 s54, s42, 1
    v_cmp_le_i32 vcc, s54, v117
    s_mov_b64 exec, vcc
    v_mov_b32 v5, 0
    v_mov_b32 v30, 0
    s_mov_b64 exec, -1
    s_sub_i32 s54, s42, 2
    v_cmp_le_i32 vcc, s54, v117
    s_mov_b64 exec, vcc
    v_mov_b32 v6, 0
    v_mov_b32 v32, 0
    s_mov_b64 exec, -1
    s_sub_i32 s54, s42, 3
    v_cmp_le_i32 vcc, s54, v117
    s_mov_b64 exec, vcc
    v_mov_b32 v7, 0
    v_mov_b32 v34, 0
    s_mov_b64 exec, -1
    s_branch L_uback_82
L_ufix_83:
    v_and_b32 v117, 63, v0
    v_lshlrev_b32 v117, 2, v117
    s_sub_i32 s54, s42, 512
    v_cmp_le_i32 vcc, s54, v117
    s_mov_b64 exec, vcc
    v_mov_b32 v8, 0
    v_mov_b32 v36, 0
    s_mov_b64 exec, -1
    s_sub_i32 s54, s42, 513
    v_cmp_le_i32 vcc, s54, v117
    s_mov_b64 exec, vcc
    v_mov_b32 v9, 0
    v_mov_b32 v38, 0
    s_mov_b64 exec, -1
    s_sub_i32 s54, s42, 514
    v_cmp_le_i32 vcc, s54, v117
    s_mov_b64 exec, vcc
    v_mov_b32 v10, 0
    v_mov_b32 v40, 0
    s_mov_b64 exec, -1
    s_sub_i32 s54, s42, 515
    v_cmp_le_i32 vcc, s54, v117
    s_mov_b64 exec, vcc
    v_mov_b32 v11, 0
    v_mov_b32 v42, 0
    s_mov_b64 exec, -1
    s_branch L_uback_84
L_sync_98:
    v_mov_b32 v117, s33
    buffer_atomic_add v117, v116, s[44:47], s50 offen sc0
    s_waitcnt vmcnt(0)
    v_readfirstlane_b32 s4, v117
    s_movk_i32 s5, 400
    s_nop 0
    s_add_u32 s4, s4, s33
    s_bitcmp1_b32 s4, 2
    s_cbranch_scc1 L_tell_101
L_poll_99:
    s_sub_u32 s5, s5, 1
    s_cbranch_scc1 L_gave_100
    v_mov_b32 v117, 0
    buffer_atomic_add v117, v116, s[44:47], s50 offen sc0
    s_waitcnt vmcnt(0)
    v_readfirstlane_b32 s4, v117
    s_nop 1
    s_and_b32 s4, s4, 0xff
    s_bitcmp0_b32 s4, 2
    s_cbranch_scc1 L_poll_99
    s_branch L_tell_101
L_gave_100:
    s_lshl_b32 s4, 0x100, s37
    v_mov_b32 v117, s4
    buffer_atomic_or v117, v116, s[44:47], s50 offen sc0
    s_waitcnt vmcnt(0)
    v_readfirstlane_b32 s4, v117
    s_nop 1
    s_and_b32 s4, s4, 0xff
    s_bitcmp1_b32 s4, 2
    s_cselect_b32 s4, s4, 0x10000
L_tell_101:
    v_mov_b32 v117, s4
    v_mov_b32 v118, 150016
    ds_write_b32 v118, v117
    s_branch L_bcast_93

L_fgen_102:
    s_waitcnt vmcnt(0)
    v_lshlrev_b32 v6, 1, v4
    v_lshlrev_b32 v7, 1, v5
    v_mov_b32 v12, 0
    v_mov_b32 v13, 0
    v_mov_b32 v14, 0
    v_mov_b32 v15, 0
    v_mov_b32 v16, 0
    v_mov_b32 v17, 0
    v_mov_b32 v18, 0
    v_mov_b32 v19, 0
    v_mov_b32 v20, 0
    v_mov_b32 v21, 0
    v_mov_b32 v22, 0
    v_mov_b32 v23, 0
    v_mov_b32 v24, 0
    v_mov_b32 v25, 0
    v_mov_b32 v26, 0
    v_mov_b32 v27, 0
    s_bitcmp1_b32 s35, 4
    s_cbranch_scc1 L_ffl_104
    v_cvt_f32_u32_sdwa v28, v76 dst_sel:DWORD dst_unused:UNUSED_PAD src0_sel:WORD_0
    v_cvt_f32_u32_sdwa v29, v76 dst_sel:DWORD dst_unused:UNUSED_PAD src0_sel:WORD_1
    v_cvt_f32_u32_sdwa v30, v77 dst_sel:DWORD dst_unused:UNUSED_PAD src0_sel:WORD_0
    v_cvt_f32_u32_sdwa v31, v77 dst_sel:DWORD dst_unused:UNUSED_PAD src0_sel:WORD_1
    v_cvt_f32_u32_sdwa v32, v78 dst_sel:DWORD dst_unused:UNUSED_PAD src0_sel:WORD_0
    v_cvt_f32_u32_sdwa v33, v78 dst_sel:DWORD dst_unused:UNUSED_PAD src0_sel:WORD_1
    v_cvt_f32_u32_sdwa v34, v79 dst_sel:DWORD dst_unused:UNUSED_PAD src0_sel:WORD_0
    v_cvt_f32_u32_sdwa v35, v79 dst_sel:DWORD dst_unused:UNUSED_PAD src0_sel:WORD_1
    v_cvt_f32_u32_sdwa v36, v92 dst_sel:DWORD dst_unused:UNUSED_PAD src0_sel:WORD_0
    v_cvt_f32_u32_sdwa v37, v92 dst_sel:DWORD dst_unused:UNUSED_PAD src0_sel:WORD_1
    v_cvt_f32_u32_sdwa v38, v93 dst_sel:DWORD dst_unused:UNUSED_PAD src0_sel:WORD_0
    v_cvt_f32_u32_sdwa v39, v93 dst_sel:DWORD dst_unused:UNUSED_PAD src0_sel:WORD_1
    v_cvt_f32_u32_sdwa v40, v94 dst_sel:DWORD dst_unused:UNUSED_PAD src0_sel:WORD_0
    v_cvt_f32_u32_sdwa v41, v94 dst_sel:DWORD dst_unused:UNUSED_PAD src0_sel:WORD_1
    v_cvt_f32_u32_sdwa v42, v95 dst_sel:DWORD dst_unused:UNUSED_PAD src0_sel:WORD_0
    v_cvt_f32_u32_sdwa v43, v95 dst_sel:DWORD dst_unused:UNUSED_PAD src0_sel:WORD_1
    v_add_f32 v28, 0xc6800000, v28
    v_fmac_f32 v12, s34, v28
    v_add_f32 v29, 0xc6800000, v29
    v_fmac_f32 v13, s34, v29
    v_add_f32 v30, 0xc6800000, v30
    v_fmac_f32 v14, s34, v30
    v_add_f32 v31, 0xc6800000, v31
    v_fmac_f32 v15, s34, v31
    v_add_f32 v32, 0xc6800000, v32
    v_fmac_f32 v16, s34, v32
    v_add_f32 v33, 0xc6800000, v33
    v_fmac_f32 v17, s34, v33
    v_add_f32 v34, 0xc6800000, v34
    v_fmac_f32 v18, s34, v34
    v_add_f32 v35, 0xc6800000, v35
    v_fmac_f32 v19, s34, v35
    v_add_f32 v36, 0xc6800000, v36
    v_fmac_f32 v20, s34, v36
    v_add_f32 v37, 0xc6800000, v37
    v_fmac_f32 v21, s34, v37
    v_add_f32 v38, 0xc6800000, v38
    v_fmac_f32 v22, s34, v38
    v_add_f32 v39, 0xc6800000, v39
    v_fmac_f32 v23, s34, v39
    v_add_f32 v40, 0xc6800000, v40
    v_fmac_f32 v24, s34, v40
    v_add_f32 v41, 0xc6800000, v41
    v_fmac_f32 v25, s34, v41
    v_add_f32 v42, 0xc6800000, v42
    v_fmac_f32 v26, s34, v42
    v_add_f32 v43, 0xc6800000, v43
    v_fmac_f32 v27, s34, v43
    s_branch L_fnx_105
L_ffl_104:
    s_mov_b32 s3, 25600000
    buffer_load_dwordx4 v[28:31], v6, s[20:23], s3 offen offset:0 sc1
    buffer_load_dwordx4 v[32:35], v6, s[20:23], s3 offen offset:16 sc1
    buffer_load_dwordx4 v[36:39], v7, s[20:23], s3 offen offset:0 sc1
    buffer_load_dwordx4 v[40:43], v7, s[20:23], s3 offen offset:16 sc1
    s_waitcnt vmcnt(0)
    v_add_f32 v12, v12, v28
    v_add_f32 v13, v13, v29
    v_add_f32 v14, v14, v30
    v_add_f32 v15, v15, v31
    v_add_f32 v16, v16, v32
    v_add_f32 v17, v17, v33
    v_add_f32 v18, v18, v34
    v_add_f32 v19, v19, v35
    v_add_f32 v20, v20, v36
    v_add_f32 v21, v21, v37
    v_add_f32 v22, v22, v38
    v_add_f32 v23, v23, v39
    v_add_f32 v24, v24, v40
    v_add_f32 v25, v25, v41
    v_add_f32 v26, v26, v42
    v_add_f32 v27, v27, v43
L_fnx_105:
    s_bitcmp1_b32 s35, 5
    s_cbranch_scc1 L_ffl_106
    v_cvt_f32_u32_sdwa v28, v80 dst_sel:DWORD dst_unused:UNUSED_PAD src0_sel:WORD_0
    v_cvt_f32_u32_sdwa v29, v80 dst_sel:DWORD dst_unused:UNUSED_PAD src0_sel:WORD_1
    v_cvt_f32_u32_sdwa v30, v81 dst_sel:DWORD dst_unused:UNUSED_PAD src0_sel:WORD_0
    v_cvt_f32_u32_sdwa v31, v81 dst_sel:DWORD dst_unused:UNUSED_PAD src0_sel:WORD_1
    v_cvt_f32_u32_sdwa v32, v82 dst_sel:DWORD dst_unused:UNUSED_PAD src0_sel:WORD_0
    v_cvt_f32_u32_sdwa v33, v82 dst_sel:DWORD dst_unused:UNUSED_PAD src0_sel:WORD_1
    v_cvt_f32_u32_sdwa v34, v83 dst_sel:DWORD dst_unused:UNUSED_PAD src0_sel:WORD_0
    v_cvt_f32_u32_sdwa v35, v83 dst_sel:DWORD dst_unused:UNUSED_PAD src0_sel:WORD_1
    v_cvt_f32_u32_sdwa v36, v96 dst_sel:DWORD dst_unused:UNUSED_PAD src0_sel:WORD_0
    v_cvt_f32_u32_sdwa v37, v96 dst_sel:DWORD dst_unused:UNUSED_PAD src0_sel:WORD_1
    v_cvt_f32_u32_sdwa v38, v97 dst_sel:DWORD dst_unused:UNUSED_PAD src0_sel:WORD_0
    v_cvt_f32_u32_sdwa v39, v97 dst_sel:DWORD dst_unused:UNUSED_PAD src0_sel:WORD_1
    v_cvt_f32_u32_sdwa v40, v98 dst_sel:DWORD dst_unused:UNUSED_PAD src0_sel:WORD_0
    v_cvt_f32_u32_sdwa v41, v98 dst_sel:DWORD dst_unused:UNUSED_PAD src0_sel:WORD_1
    v_cvt_f32_u32_sdwa v42, v99 dst_sel:DWORD dst_unused:UNUSED_PAD src0_sel:WORD_0
    v_cvt_f32_u32_sdwa v43, v99 dst_sel:DWORD dst_unused:UNUSED_PAD src0_sel:WORD_1
    v_add_f32 v28, 0xc6800000, v28
    v_fmac_f32 v12, s34, v28
    v_add_f32 v29, 0xc6800000, v29
    v_fmac_f32 v13, s34, v29
    v_add_f32 v30, 0xc6800000, v30
    v_fmac_f32 v14, s34, v30
    v_add_f32 v31, 0xc6800000, v31
    v_fmac_f32 v15, s34, v31
    v_add_f32 v32, 0xc6800000, v32
    v_fmac_f32 v16, s34, v32
    v_add_f32 v33, 0xc6800000, v33
    v_fmac_f32 v17, s34, v33
    v_add_f32 v34, 0xc6800000, v34
    v_fmac_f32 v18, s34, v34
    v_add_f32 v35, 0xc6800000, v35
    v_fmac_f32 v19, s34, v35
    v_add_f32 v36, 0xc6800000, v36
    v_fmac_f32 v20, s34, v36
    v_add_f32 v37, 0xc6800000, v37
    v_fmac_f32 v21, s34, v37
    v_add_f32 v38, 0xc6800000, v38
    v_fmac_f32 v22, s34, v38
    v_add_f32 v39, 0xc6800000, v39
    v_fmac_f32 v23, s34, v39
    v_add_f32 v40, 0xc6800000, v40
    v_fmac_f32 v24, s34, v40
    v_add_f32 v41, 0xc6800000, v41
    v_fmac_f32 v25, s34, v41
    v_add_f32 v42, 0xc6800000, v42
    v_fmac_f32 v26, s34, v42
    v_add_f32 v43, 0xc6800000, v43
    v_fmac_f32 v27, s34, v43
    s_branch L_fnx_107
L_ffl_106:
    s_mov_b32 s3, 38400000
    buffer_load_dwordx4 v[28:31], v6, s[20:23], s3 offen offset:0 sc1
    buffer_load_dwordx4 v[32:35], v6, s[20:23], s3 offen offset:16 sc1
    buffer_load_dwordx4 v[36:39], v7, s[20:23], s3 offen offset:0 sc1
    buffer_load_dwordx4 v[40:43], v7, s[20:23], s3 offen offset:16 sc1
    s_waitcnt vmcnt(0)
    v_add_f32 v12, v12, v28
    v_add_f32 v13, v13, v29
    v_add_f32 v14, v14, v30
    v_add_f32 v15, v15, v31
    v_add_f32 v16, v16, v32
    v_add_f32 v17, v17, v33
    v_add_f32 v18, v18, v34
    v_add_f32 v19, v19, v35
    v_add_f32 v20, v20, v36
    v_add_f32 v21, v21, v37
    v_add_f32 v22, v22, v38
    v_add_f32 v23, v23, v39
    v_add_f32 v24, v24, v40
    v_add_f32 v25, v25, v41
    v_add_f32 v26, v26, v42
    v_add_f32 v27, v27, v43
L_fnx_107:
    s_bitcmp1_b32 s35, 6
    s_cbranch_scc1 L_ffl_108
    v_cvt_f32_u32_sdwa v28, v84 dst_sel:DWORD dst_unused:UNUSED_PAD src0_sel:WORD_0
    v_cvt_f32_u32_sdwa v29, v84 dst_sel:DWORD dst_unused:UNUSED_PAD src0_sel:WORD_1
    v_cvt_f32_u32_sdwa v30, v85 dst_sel:DWORD dst_unused:UNUSED_PAD src0_sel:WORD_0
    v_cvt_f32_u32_sdwa v31, v85 dst_sel:DWORD dst_unused:UNUSED_PAD src0_sel:WORD_1
    v_cvt_f32_u32_sdwa v32, v86 dst_sel:DWORD dst_unused:UNUSED_PAD src0_sel:WORD_0
    v_cvt_f32_u32_sdwa v33, v86 dst_sel:DWORD dst_unused:UNUSED_PAD src0_sel:WORD_1
    v_cvt_f32_u32_sdwa v34, v87 dst_sel:DWORD dst_unused:UNUSED_PAD src0_sel:WORD_0
    v_cvt_f32_u32_sdwa v35, v87 dst_sel:DWORD dst_unused:UNUSED_PAD src0_sel:WORD_1
    v_cvt_f32_u32_sdwa v36, v100 dst_sel:DWORD dst_unused:UNUSED_PAD src0_sel:WORD_0
    v_cvt_f32_u32_sdwa v37, v100 dst_sel:DWORD dst_unused:UNUSED_PAD src0_sel:WORD_1
    v_cvt_f32_u32_sdwa v38, v101 dst_sel:DWORD dst_unused:UNUSED_PAD src0_sel:WORD_0
    v_cvt_f32_u32_sdwa v39, v101 dst_sel:DWORD dst_unused:UNUSED_PAD src0_sel:WORD_1
    v_cvt_f32_u32_sdwa v40, v102 dst_sel:DWORD dst_unused:UNUSED_PAD src0_sel:WORD_0
    v_cvt_f32_u32_sdwa v41, v102 dst_sel:DWORD dst_unused:UNUSED_PAD src0_sel:WORD_1
    v_cvt_f32_u32_sdwa v42, v103 dst_sel:DWORD dst_unused:UNUSED_PAD src0_sel:WORD_0
    v_cvt_f32_u32_sdwa v43, v103 dst_sel:DWORD dst_unused:UNUSED_PAD src0_sel:WORD_1
    v_add_f32 v28, 0xc6800000, v28
    v_fmac_f32 v12, s34, v28
    v_add_f32 v29, 0xc6800000, v29
    v_fmac_f32 v13, s34, v29
    v_add_f32 v30, 0xc6800000, v30
    v_fmac_f32 v14, s34, v30
    v_add_f32 v31, 0xc6800000, v31
    v_fmac_f32 v15, s34, v31
    v_add_f32 v32, 0xc6800000, v32
    v_fmac_f32 v16, s34, v32
    v_add_f32 v33, 0xc6800000, v33
    v_fmac_f32 v17, s34, v33
    v_add_f32 v34, 0xc6800000, v34
    v_fmac_f32 v18, s34, v34
    v_add_f32 v35, 0xc6800000, v35
    v_fmac_f32 v19, s34, v35
    v_add_f32 v36, 0xc6800000, v36
    v_fmac_f32 v20, s34, v36
    v_add_f32 v37, 0xc6800000, v37
    v_fmac_f32 v21, s34, v37
    v_add_f32 v38, 0xc6800000, v38
    v_fmac_f32 v22, s34, v38
    v_add_f32 v39, 0xc6800000, v39
    v_fmac_f32 v23, s34, v39
    v_add_f32 v40, 0xc6800000, v40
    v_fmac_f32 v24, s34, v40
    v_add_f32 v41, 0xc6800000, v41
    v_fmac_f32 v25, s34, v41
    v_add_f32 v42, 0xc6800000, v42
    v_fmac_f32 v26, s34, v42
    v_add_f32 v43, 0xc6800000, v43
    v_fmac_f32 v27, s34, v43
    s_branch L_fnx_109
L_ffl_108:
    s_mov_b32 s3, 51200000
    buffer_load_dwordx4 v[28:31], v6, s[20:23], s3 offen offset:0 sc1
    buffer_load_dwordx4 v[32:35], v6, s[20:23], s3 offen offset:16 sc1
    buffer_load_dwordx4 v[36:39], v7, s[20:23], s3 offen offset:0 sc1
    buffer_load_dwordx4 v[40:43], v7, s[20:23], s3 offen offset:16 sc1
    s_waitcnt vmcnt(0)
    v_add_f32 v12, v12, v28
    v_add_f32 v13, v13, v29
    v_add_f32 v14, v14, v30
    v_add_f32 v15, v15, v31
    v_add_f32 v16, v16, v32
    v_add_f32 v17, v17, v33
    v_add_f32 v18, v18, v34
    v_add_f32 v19, v19, v35
    v_add_f32 v20, v20, v36
    v_add_f32 v21, v21, v37
    v_add_f32 v22, v22, v38
    v_add_f32 v23, v23, v39
    v_add_f32 v24, v24, v40
    v_add_f32 v25, v25, v41
    v_add_f32 v26, v26, v42
    v_add_f32 v27, v27, v43
L_fnx_109:
    s_bitcmp1_b32 s35, 7
    s_cbranch_scc1 L_ffl_110
    v_cvt_f32_u32_sdwa v28, v88 dst_sel:DWORD dst_unused:UNUSED_PAD src0_sel:WORD_0
    v_cvt_f32_u32_sdwa v29, v88 dst_sel:DWORD dst_unused:UNUSED_PAD src0_sel:WORD_1
    v_cvt_f32_u32_sdwa v30, v89 dst_sel:DWORD dst_unused:UNUSED_PAD src0_sel:WORD_0
    v_cvt_f32_u32_sdwa v31, v89 dst_sel:DWORD dst_unused:UNUSED_PAD src0_sel:WORD_1
    v_cvt_f32_u32_sdwa v32, v90 dst_sel:DWORD dst_unused:UNUSED_PAD src0_sel:WORD_0
    v_cvt_f32_u32_sdwa v33, v90 dst_sel:DWORD dst_unused:UNUSED_PAD src0_sel:WORD_1
    v_cvt_f32_u32_sdwa v34, v91 dst_sel:DWORD dst_unused:UNUSED_PAD src0_sel:WORD_0
    v_cvt_f32_u32_sdwa v35, v91 dst_sel:DWORD dst_unused:UNUSED_PAD src0_sel:WORD_1
    v_cvt_f32_u32_sdwa v36, v104 dst_sel:DWORD dst_unused:UNUSED_PAD src0_sel:WORD_0
    v_cvt_f32_u32_sdwa v37, v104 dst_sel:DWORD dst_unused:UNUSED_PAD src0_sel:WORD_1
    v_cvt_f32_u32_sdwa v38, v105 dst_sel:DWORD dst_unused:UNUSED_PAD src0_sel:WORD_0
    v_cvt_f32_u32_sdwa v39, v105 dst_sel:DWORD dst_unused:UNUSED_PAD src0_sel:WORD_1
    v_cvt_f32_u32_sdwa v40, v106 dst_sel:DWORD dst_unused:UNUSED_PAD src0_sel:WORD_0
    v_cvt_f32_u32_sdwa v41, v106 dst_sel:DWORD dst_unused:UNUSED_PAD src0_sel:WORD_1
    v_cvt_f32_u32_sdwa v42, v107 dst_sel:DWORD dst_unused:UNUSED_PAD src0_sel:WORD_0
    v_cvt_f32_u32_sdwa v43, v107 dst_sel:DWORD dst_unused:UNUSED_PAD src0_sel:WORD_1
    v_add_f32 v28, 0xc6800000, v28
    v_fmac_f32 v12, s34, v28
    v_add_f32 v29, 0xc6800000, v29
    v_fmac_f32 v13, s34, v29
    v_add_f32 v30, 0xc6800000, v30
    v_fmac_f32 v14, s34, v30
    v_add_f32 v31, 0xc6800000, v31
    v_fmac_f32 v15, s34, v31
    v_add_f32 v32, 0xc6800000, v32
    v_fmac_f32 v16, s34, v32
    v_add_f32 v33, 0xc6800000, v33
    v_fmac_f32 v17, s34, v33
    v_add_f32 v34, 0xc6800000, v34
    v_fmac_f32 v18, s34, v34
    v_add_f32 v35, 0xc6800000, v35
    v_fmac_f32 v19, s34, v35
    v_add_f32 v36, 0xc6800000, v36
    v_fmac_f32 v20, s34, v36
    v_add_f32 v37, 0xc6800000, v37
    v_fmac_f32 v21, s34, v37
    v_add_f32 v38, 0xc6800000, v38
    v_fmac_f32 v22, s34, v38
    v_add_f32 v39, 0xc6800000, v39
    v_fmac_f32 v23, s34, v39
    v_add_f32 v40, 0xc6800000, v40
    v_fmac_f32 v24, s34, v40
    v_add_f32 v41, 0xc6800000, v41
    v_fmac_f32 v25, s34, v41
    v_add_f32 v42, 0xc6800000, v42
    v_fmac_f32 v26, s34, v42
    v_add_f32 v43, 0xc6800000, v43
    v_fmac_f32 v27, s34, v43
    s_branch L_fnx_111
L_ffl_110:
    s_mov_b32 s3, 64000000
    buffer_load_dwordx4 v[28:31], v6, s[20:23], s3 offen offset:0 sc1
    buffer_load_dwordx4 v[32:35], v6, s[20:23], s3 offen offset:16 sc1
    buffer_load_dwordx4 v[36:39], v7, s[20:23], s3 offen offset:0 sc1
    buffer_load_dwordx4 v[40:43], v7, s[20:23], s3 offen offset:16 sc1
    s_waitcnt vmcnt(0)
    v_add_f32 v12, v12, v28
    v_add_f32 v13, v13, v29
    v_add_f32 v14, v14, v30
    v_add_f32 v15, v15, v31
    v_add_f32 v16, v16, v32
    v_add_f32 v17, v17, v33
    v_add_f32 v18, v18, v34
    v_add_f32 v19, v19, v35
    v_add_f32 v20, v20, v36
    v_add_f32 v21, v21, v37
    v_add_f32 v22, v22, v38
    v_add_f32 v23, v23, v39
    v_add_f32 v24, v24, v40
    v_add_f32 v25, v25, v41
    v_add_f32 v26, v26, v42
    v_add_f32 v27, v27, v43
L_fnx_111:
    s_branch L_fbk_103
L_p2slow_51:
    s_waitcnt vmcnt(0) lgkmcnt(0)
    s_mov_b32 s51, 0
    s_movk_i32 s43, 6250

L_sweep_113:
    s_barrier

    v_mov_b32 v28, 0x0
    v_mov_b32 v29, 0x0
    v_mov_b32 v30, 0x0
    v_mov_b32 v31, 0x0
    v_add_u32 v32, 50000, v3
    v_add_u32 v33, 65536, v32

    ds_write_b128 v32, v[28:31] offset:0
    ds_write_b128 v32, v[28:31] offset:16384
    ds_write_b128 v32, v[28:31] offset:32768
    ds_write_b128 v32, v[28:31] offset:49152
    ds_write_b128 v33, v[28:31] offset:0
    ds_write_b128 v33, v[28:31] offset:16384
    v_cmp_gt_u32 vcc, 971, v0
    s_mov_b64 exec, vcc
    ds_write_b128 v33, v[28:31] offset:32768
    s_mov_b64 exec, -1
    s_waitcnt lgkmcnt(0)
    s_barrier
    s_sub_u32 s38, s4, 8
L_sbatch_114:
    s_lshl_b32 s52, s38, 6
    s_add_u32 s52, s52, s36
    s_lshl_b32 s52, s52, 2
    s_load_dword s40, s[46:47], s52
    s_mul_i32 s50, s38, 200000
    s_waitcnt lgkmcnt(0)

    s_min_u32 s40, s40, 3968
    s_lshl_b32 s52, s38, 6
    s_add_u32 s52, s52, s36
    s_mul_i32 s52, s52, 19840
    s_add_u32 s20, s44, s52
    s_addc_u32 s21, s45, 0
    s_mul_i32 s52, s40, 5
    s_add_u32 s52, s52, 3
    s_and_b32 s22, s52, -4

    s_lshr_b32 s55, s39, 2
    s_add_u32 s55, s55, 0
    v_and_b32 v36, 63, v0
    v_add_u32 v36, s55, v36
L_left_118:
    s_cmp_ge_u32 s55, s40
    s_cbranch_scc1 L_leftend_119
    v_mul_u32_u24 v37, 5, v36
    buffer_load_dword v38, v37, s[20:23], 0 offen
    buffer_load_ubyte v39, v37, s[20:23], 0 offen offset:4
    s_waitcnt vmcnt(0)

    v_perm_b32 v37, v39, v38, s24
    v_lshrrev_b32 v42, 30, v38
    v_and_b32 v37, 0x1fff, v37
    v_mul_u32_u24 v42, 6250, v42
    v_add_lshl_u32 v37, v37, v42, 3

    buffer_load_dwordx2 v[40:41], v37, s[8:11], s50 offen
    v_cmp_gt_u32 vcc, s40, v36
    s_waitcnt vmcnt(0)

    v_bfe_u32 v44, v38, 16, 14
    v_subrev_u32 v44, s51, v44
    v_cmp_gt_u32 s[64:65], s43, v44
    s_and_b64 exec, vcc, s[64:65]
    v_lshlrev_b32 v45, 8, v38
    v_cmpx_ne_u32 vcc, 0, v45
    v_lshlrev_b32 v44, 4, v44
    v_bfe_i32 v38, v38, 0, 16
    v_cvt_f32_i32 v38, v38
    v_mul_f32 v38, 0x38004020, v38
    v_lshlrev_b32 v45, 16, v40
    v_and_b32 v46, s32, v40
    v_lshlrev_b32 v47, 16, v41
    v_and_b32 v48, s32, v41

    v_mul_f32 v45, v45, v38
    ds_add_f32 v44, v45 offset:50000
    v_mul_f32 v46, v46, v38
    ds_add_f32 v44, v46 offset:50004
    v_mul_f32 v47, v47, v38
    ds_add_f32 v44, v47 offset:50008
    v_mul_f32 v48, v48, v38
    ds_add_f32 v44, v48 offset:50012
    s_mov_b64 exec, -1
    v_add_u32 v36, 128, v36
    s_add_u32 s55, s55, 128
    s_branch L_left_118
L_leftend_119:

    s_add_u32 s38, s38, 1
    s_cmp_lt_u32 s38, s4
    s_cbranch_scc1 L_sbatch_114
    s_mov_b32 s3, 65536
    s_load_dword s40, s[6:7], s3

    s_add_u32 s20, s6, 408657920
    s_addc_u32 s21, s7, 0
    s_mov_b32 s22, 409600000
    s_mov_b32 s23, 0x20000
    s_mov_b32 s38, 0
    s_mov_b32 s50, 200000
    v_mov_b32 v36, v0
    s_waitcnt lgkmcnt(0)
L_ovf_115:
    s_cmp_ge_u32 s38, s40
    s_cbranch_scc1 L_ovfend_116
    v_lshlrev_b32 v37, 3, v36
    buffer_load_dwordx2 v[38:39], v37, s[20:23], 0 offen
    s_waitcnt vmcnt(0)

    v_perm_b32 v37, v39, v38, s24
    v_lshrrev_b32 v42, 30, v38
    v_and_b32 v37, 0x1fff, v37
    v_mul_u32_u24 v42, 6250, v42
    v_add_lshl_u32 v37, v37, v42, 3

    v_bfe_u32 v42, v39, 24, 5
    v_mad_u32_u24 v37, v42, s50, v37
    buffer_load_dwordx2 v[40:41], v37, s[8:11], 0 offen
    v_lshrrev_b32 v42, 3, v42
    v_bfe_u32 v43, v39, 18, 6
    v_cmp_gt_u32 vcc, s40, v36
    v_cmp_eq_u32 s[64:65], s36, v43
    s_and_b64 vcc, vcc, s[64:65]
    v_cmp_eq_u32 s[64:65], s37, v42
    s_and_b64 vcc, vcc, s[64:65]
    s_waitcnt vmcnt(0)

    v_bfe_u32 v44, v38, 16, 14
    v_subrev_u32 v44, s51, v44
    v_cmp_gt_u32 s[64:65], s43, v44
    s_and_b64 exec, vcc, s[64:65]
    v_lshlrev_b32 v45, 8, v38
    v_cmpx_ne_u32 vcc, 0, v45
    v_lshlrev_b32 v44, 4, v44
    v_bfe_i32 v38, v38, 0, 16
    v_cvt_f32_i32 v38, v38
    v_mul_f32 v38, 0x38004020, v38
    v_lshlrev_b32 v45, 16, v40
    v_and_b32 v46, s32, v40
    v_lshlrev_b32 v47, 16, v41
    v_and_b32 v48, s32, v41

    v_mul_f32 v45, v45, v38
    ds_add_f32 v44, v45 offset:50000
    v_mul_f32 v46, v46, v38
    ds_add_f32 v44, v46 offset:50004
    v_mul_f32 v47, v47, v38
    ds_add_f32 v44, v47 offset:50008
    v_mul_f32 v48, v48, v38
    ds_add_f32 v44, v48 offset:50012
    s_mov_b64 exec, -1
    v_add_u32 v36, 1024, v36
    s_add_u32 s38, s38, 1024
    s_branch L_ovf_115
L_ovfend_116:
    s_waitcnt lgkmcnt(0)
    s_barrier
    s_mul_i32 s3, s37, 800000
    s_mul_i32 s5, s36, 12500
    s_add_u32 s3, s3, s5
    s_add_u32 s3, s3, s51
    s_lshl_b32 s3, s3, 4
    s_add_u32 s3, s3, 32399360

    s_add_u32 s20, s6, s3
    s_addc_u32 s21, s7, 0
    s_mov_b32 s22, 100000
    s_mov_b32 s23, 0x20000
    v_mov_b32 v36, v3
    s_mov_b32 s38, 0
L_wl_117:
    v_min_u32 v37, 100000, v36
    ds_read_b128 v[28:31], v37 offset:50000
    s_waitcnt lgkmcnt(0)
    buffer_store_dwordx4 v[28:31], v36, s[20:23], 0 offen sc1
    s_waitcnt vmcnt(0)
    v_add_u32 v36, 16384, v36
    s_add_u32 s38, s38, 1024
    s_cmp_lt_u32 s38, 6250
    s_cbranch_scc1 L_wl_117
    s_add_u32 s51, s51, 6250
    s_cmp_lt_u32 s51, 12500
    s_cbranch_scc1 L_sweep_113
    s_lshl_b32 s33, 16, s37
    s_add_u32 s33, s33, 1
    s_branch L_fin_86

.section .rodata,"a"
.p2align 6
.amdhsa_kernel g1_kernel
  .amdhsa_next_free_vgpr 128
  .amdhsa_next_free_sgpr 102
  .amdhsa_accum_offset 128
  .amdhsa_group_segment_fixed_size 0
  .amdhsa_kernarg_size 112
  .amdhsa_user_sgpr_count 2
  .amdhsa_user_sgpr_kernarg_segment_ptr 1
  .amdhsa_system_sgpr_workgroup_id_x 1
.end_amdhsa_kernel
.p2align 6
.amdhsa_kernel standalone__molecular_angular_gemnet__graph_kernel
  .amdhsa_next_free_vgpr 128
  .amdhsa_next_free_sgpr 102
  .amdhsa_accum_offset 128
  .amdhsa_group_segment_fixed_size 0
  .amdhsa_kernarg_size 112
  .amdhsa_user_sgpr_count 2
  .amdhsa_user_sgpr_kernarg_segment_ptr 1
  .amdhsa_system_sgpr_workgroup_id_x 1
  .amdhsa_float_denorm_mode_32 3
.end_amdhsa_kernel
```

```asm
; @launch kernel=g1_kernel grid=(256,1,1) block=(1024,1,1) lds=163840
; @launch kernel=standalone__molecular_angular_gemnet__graph_kernel grid=(256,1,1) block=(1024,1,1) lds=163840
.amdgcn_target "amdgcn-amd-amdhsa--gfx950"
.text
.globl g1_kernel
.p2align 8
.type g1_kernel,@function
g1_kernel:
    s_cmp_ge_u32 s2, 256
    s_cbranch_scc1 L_p1done_1
    s_load_dwordx4 s[80:83], s[0:1], 8
    s_load_dwordx2 s[84:85], s[0:1], 32
    s_load_dwordx2 s[86:87], s[0:1], 48
    s_load_dwordx4 s[4:7], s[0:1], 96
    s_load_dwordx2 s[78:79], s[0:1], 0
    v_lshlrev_b32 v1, 4, v0
    v_lshlrev_b32 v2, 3, v0
    v_lshlrev_b32 v98, 20, v0
    s_waitcnt lgkmcnt(0)
    s_load_dword s88, s[86:87], 0

    s_mov_b32 s96, s4
    s_mov_b32 s97, s5
    s_mov_b32 s98, 256
    s_mov_b32 s99, 0x20000
    v_readfirstlane_b32 s74, v0
    s_nop 1
    s_or_b32 s74, s74, s2
    s_cbranch_scc1 L_noinit_2

    v_mov_b32 v110, 1
    buffer_atomic_add v110, v98, s[96:99], 0 offen offset:64 sc0
    s_waitcnt vmcnt(0)
    v_readfirstlane_b32 s74, v110
    s_nop 1
    s_cmp_lg_u32 s74, 0
    s_cbranch_scc1 L_zno_4

    s_mov_b32 s92, s6
    s_mov_b32 s93, s7
    s_mov_b32 s94, 65552
    s_mov_b32 s95, 0x20000
    v_mov_b32 v110, 0
    v_mov_b32 v111, 0
    v_mov_b32 v112, 0
    v_mov_b32 v113, 0
L_zl_3:
    buffer_store_dwordx4 v[110:113], v1, s[92:95], s74 offen sc0 sc1
    s_add_u32 s74, s74, 1024
    s_cmp_le_u32 s74, 65536
    s_cbranch_scc1 L_zl_3
    v_mov_b32 v114, 1
    s_waitcnt vmcnt(0)
    buffer_atomic_add v114, v98, s[96:99], 0 offen offset:128
L_zno_4:

L_noinit_2:
    s_mov_b32 s20, s78
    s_mov_b32 s21, s79
    s_mov_b32 s22, 6400000
    s_mov_b32 s23, 0x20000
    v_mul_u32_u24 v110, 6240, v0
    v_and_b32 v111, 63, v0
    v_and_b32 v112, 0x3c0, v0
    v_lshlrev_b32 v111, 2, v111
    v_lshl_or_b32 v111, v112, 4, v111
    v_lshlrev_b32 v100, 2, v0
    s_lshr_b32 s50, s2, 1
    s_and_b32 s53, s2, 1
    s_mul_i32 s3, s50, 50000
    s_mul_i32 s54, s53, 24576
    s_add_u32 s3, s3, s54

    buffer_load_dwordx4 v[56:59], v110, s[20:23], 0 offen
    s_add_u32 s20, s78, s3
    s_addc_u32 s21, s79, 0
    s_mov_b32 s22, 24576
    s_mov_b32 s23, 0x20000
    s_movk_i32 s3, 16384
    buffer_load_dword v44, v111, s[20:23], 0 offen offset:0
    buffer_load_dword v45, v111, s[20:23], 0 offen offset:256
    buffer_load_dword v46, v111, s[20:23], 0 offen offset:512
    buffer_load_dword v47, v111, s[20:23], 0 offen offset:768
    buffer_load_dword v48, v111, s[20:23], s3 offen offset:0
    buffer_load_dword v49, v111, s[20:23], s3 offen offset:256
    buffer_load_dword v50, v111, s[20:23], s3 offen offset:512
    buffer_load_dword v51, v111, s[20:23], s3 offen offset:768
    s_mul_i32 s22, s53, 25424
    s_movk_i32 s3, 24576

    buffer_load_dword v52, v100, s[20:23], s3 offen
    s_mul_i32 s3, s50, 50048
    s_add_u32 s3, s3, s54
    s_add_u32 s54, s3, 393216

    s_mov_b32 s8, s80
    s_mov_b32 s9, s81
    s_mov_b32 s10, 0
    s_mov_b32 s11, 0x20000
    s_mov_b32 s12, s82
    s_mov_b32 s13, s83
    s_mov_b32 s14, 0
    s_mov_b32 s15, 0x20000
    s_mov_b32 s16, s84
    s_mov_b32 s17, s85
    s_mov_b32 s18, 0
    s_mov_b32 s19, 0x20000
    s_lshr_b32 s74, s2, 1
    s_and_b32 s74, s74, 28
    s_lshr_b32 s86, 0x00102010, s74
    s_lshr_b32 s87, 0x44414241, s74
    s_lshr_b32 s41, 0x43221100, s74
    s_and_b32 s86, s86, 15
    s_and_b32 s87, s87, 15
    s_and_b32 s41, s41, 15
    s_lshr_b32 s74, s2, 6
    s_lshl_b32 s74, s74, 3
    s_and_b32 s75, s2, 7
    s_add_u32 s74, s74, s75
    s_mul_i32 s74, s74, 5
    s_add_u32 s41, s41, s74

    s_mul_i32 s78, s41, 16384
    s_add_u32 s49, s78, 16384
    s_cmp_ge_u32 s41, 3125
    s_cmovk_i32 s49, 0
    s_cmovk_i32 s78, 0
    s_lshl_b32 s10, s49, 2
    s_lshl_b32 s14, s49, 2
    s_lshl_b32 s18, s49, 1
    s_sub_u32 s79, s87, s86
    s_bfm_b32 s85, s79, s86
    s_lshl_b32 s86, s86, 12
    s_lshl_b32 s87, s87, 12
    s_min_u32 s87, s87, 16384

    s_add_u32 s79, s78, 0
    s_bitcmp1_b32 s85, 0
    s_cselect_b32 s79, s79, 0x1ff00000
    s_lshl_b32 s56, s79, 2
    s_lshl_b32 s61, s79, 1

    s_add_u32 s79, s78, 4096
    s_bitcmp1_b32 s85, 1
    s_cselect_b32 s79, s79, 0x1ff00000
    s_lshl_b32 s57, s79, 2
    s_lshl_b32 s62, s79, 1

    s_add_u32 s79, s78, 8192
    s_bitcmp1_b32 s85, 2
    s_cselect_b32 s79, s79, 0x1ff00000
    s_lshl_b32 s58, s79, 2
    s_lshl_b32 s63, s79, 1

    s_add_u32 s79, s78, 12288
    s_bitcmp1_b32 s85, 3
    s_cselect_b32 s79, s79, 0x1ff00000
    s_lshl_b32 s59, s79, 2
    s_lshl_b32 s64, s79, 1

    s_mov_b32 s82, s85
    s_mov_b32 s83, s86
    s_mov_b32 s84, s87
    s_add_u32 s41, s2, 160
    s_mul_i32 s74, s41, 16384
    s_mov_b32 s10, 204800000
    s_mov_b32 s14, 204800000
    s_mov_b32 s18, 102400000

    s_add_u32 s75, s74, 0
    s_lshl_b32 s76, s75, 2
    s_lshl_b32 s75, s75, 1
    s_bitcmp1_b32 s82, 0
    s_cselect_b32 s56, s56, s76
    s_cselect_b32 s61, s61, s75

    s_add_u32 s75, s74, 4096
    s_lshl_b32 s76, s75, 2
    s_lshl_b32 s75, s75, 1
    s_bitcmp1_b32 s82, 1
    s_cselect_b32 s57, s57, s76
    s_cselect_b32 s62, s62, s75

    s_add_u32 s75, s74, 8192
    s_lshl_b32 s76, s75, 2
    s_lshl_b32 s75, s75, 1
    s_bitcmp1_b32 s82, 2
    s_cselect_b32 s58, s58, s76
    s_cselect_b32 s63, s63, s75

    s_add_u32 s75, s74, 12288
    s_lshl_b32 s76, s75, 2
    s_lshl_b32 s75, s75, 1
    s_bitcmp1_b32 s82, 3
    s_cselect_b32 s59, s59, s76
    s_cselect_b32 s64, s64, s75

    buffer_load_dwordx4 v[20:23], v1, s[12:15], s56 offen nt
    buffer_load_dwordx4 v[4:7], v1, s[8:11], s56 offen nt
    buffer_load_dwordx2 v[36:37], v2, s[16:19], s61 offen nt
    buffer_load_dwordx4 v[24:27], v1, s[12:15], s57 offen nt
    buffer_load_dwordx4 v[8:11], v1, s[8:11], s57 offen nt
    buffer_load_dwordx2 v[38:39], v2, s[16:19], s62 offen nt
    buffer_load_dwordx4 v[28:31], v1, s[12:15], s58 offen nt
    buffer_load_dwordx4 v[12:15], v1, s[8:11], s58 offen nt
    buffer_load_dwordx2 v[40:41], v2, s[16:19], s63 offen nt
    buffer_load_dwordx4 v[32:35], v1, s[12:15], s59 offen nt
    buffer_load_dwordx4 v[16:19], v1, s[8:11], s59 offen nt
    buffer_load_dwordx2 v[42:43], v2, s[16:19], s64 offen nt
    s_mov_b32 s86, 0
    s_mov_b32 s87, 4
    s_mul_i32 s78, s41, 16384
    s_add_u32 s49, s78, 16384
    s_cmp_ge_u32 s41, 3125
    s_cmovk_i32 s49, 0
    s_cmovk_i32 s78, 0
    s_lshl_b32 s10, s49, 2
    s_lshl_b32 s14, s49, 2
    s_lshl_b32 s18, s49, 1
    s_sub_u32 s79, s87, s86
    s_bfm_b32 s85, s79, s86
    s_lshl_b32 s86, s86, 12
    s_lshl_b32 s87, s87, 12
    s_min_u32 s87, s87, 16384

    s_add_u32 s79, s78, 0
    s_bitcmp1_b32 s85, 0
    s_cselect_b32 s79, s79, 0x1ff00000
    s_lshl_b32 s56, s79, 2
    s_lshl_b32 s61, s79, 1

    s_add_u32 s79, s78, 4096
    s_bitcmp1_b32 s85, 1
    s_cselect_b32 s79, s79, 0x1ff00000
    s_lshl_b32 s57, s79, 2
    s_lshl_b32 s62, s79, 1

    s_add_u32 s79, s78, 8192
    s_bitcmp1_b32 s85, 2
    s_cselect_b32 s79, s79, 0x1ff00000
    s_lshl_b32 s58, s79, 2
    s_lshl_b32 s63, s79, 1

    s_add_u32 s79, s78, 12288
    s_bitcmp1_b32 s85, 3
    s_cselect_b32 s79, s79, 0x1ff00000
    s_lshl_b32 s59, s79, 2
    s_lshl_b32 s64, s79, 1

    s_getreg_b32 s5, hwreg(HW_REG_XCC_ID)
    s_and_b32 s5, s5, 7
    s_mul_i32 s3, s5, 8192

    s_add_u32 s20, s6, s3
    s_addc_u32 s21, s7, 0
    s_mov_b32 s22, 8192
    s_mov_b32 s23, 0x20000
    s_mul_i32 s3, s5, 40632320
    s_add_u32 s3, s3, 83599360
    s_add_u32 s24, s6, s3
    s_addc_u32 s25, s7, 0
    s_mov_b32 s26, 40632320
    s_mov_b32 s27, 0x20000
    s_add_u32 s32, s6, 408657920
    s_addc_u32 s33, s7, 0
    s_mov_b32 s34, 409600000
    s_mov_b32 s35, 0x20000
    s_add_u32 s36, s6, 65536
    s_addc_u32 s37, s7, 0
    s_mov_b32 s38, 4
    s_mov_b32 s39, 0x20000
    s_mov_b32 s40, 687195
    s_mov_b32 s42, -6250
    s_mov_b32 s43, 1942
    s_mov_b32 s45, 0x06050400
    s_mov_b32 s46, 0x05040c00
    s_mov_b32 s47, 0x04020100
    s_mov_b32 s48, 3968
    s_mov_b32 s50, 0
    v_mov_b32 v104, 1
    v_mov_b32 v105, 0x46ff8000
    s_mov_b32 s55, 0x05040100
    v_mul_u32_u24 v106, 5, v0
    v_mov_b32 v108, 16384
    v_mov_b32 v114, 0
    v_mov_b32 v115, 0
    v_mov_b32 v116, 0
    v_mov_b32 v117, -1
    ds_write_b64 v2, v[114:115]
    s_movk_i32 s3, 1024
    v_cmp_gt_u32 s[66:67], s3, v0
    s_movk_i32 s3, 1024
    v_cmp_gt_u32 s[68:69], s3, v0
    s_mov_b64 exec, 1
    ds_write_b128 v108, v[114:117]
    s_mov_b64 exec, -1
    s_waitcnt lgkmcnt(0)
    s_lshl_b32 s88, s88, 16
    v_mov_b32 v110, 0.15915494
    v_mul_f32 v110, s88, v110
    s_mov_b32 s3, 0x7fff7fff
    v_readfirstlane_b32 s44, v110

    s_waitcnt vmcnt(12)
    v_mov_b32 v61, 0
    v_mov_b32 v62, 0
    v_mov_b32 v63, 0
    v_dot2_f32_bf16 v61, v44, v44, v61
    v_dot2_f32_bf16 v61, v45, v45, v61
    v_dot2_f32_bf16 v61, v46, v46, v61
    v_dot2_f32_bf16 v61, v47, v47, v61
    v_dot2_f32_bf16 v61, v48, v48, v61
    v_dot2_f32_bf16 v61, v49, v49, v61
    v_dot2_f32_bf16 v61, v50, v50, v61
    v_dot2_f32_bf16 v61, v51, v51, v61
    v_dot2_f32_bf16 v61, v52, v52, v61
    v_dot2_f32_bf16 v62, v56, v56, v62
    v_dot2_f32_bf16 v62, v57, v57, v62
    v_dot2_f32_bf16 v62, v58, v58, v62
    v_dot2_f32_bf16 v62, v59, v59, v62
    v_and_b32 v60, s3, v44
    v_and_b32 v64, s3, v45
    v_pk_max_u16 v60, v60, v64
    v_and_b32 v64, s3, v46
    v_pk_max_u16 v60, v60, v64
    v_and_b32 v64, s3, v47
    v_pk_max_u16 v60, v60, v64
    v_and_b32 v64, s3, v48
    v_pk_max_u16 v60, v60, v64
    v_and_b32 v64, s3, v49
    v_pk_max_u16 v60, v60, v64
    v_and_b32 v64, s3, v50
    v_pk_max_u16 v60, v60, v64
    v_and_b32 v64, s3, v51
    v_pk_max_u16 v60, v60, v64
    v_and_b32 v64, s3, v52
    v_pk_max_u16 v60, v60, v64
    v_lshrrev_b32 v64, 16, v60
    v_and_b32 v60, 0xffff, v60
    v_max_u32 v60, v60, v64

    s_nop 1
    v_max_u32_dpp v60, v60, v60 row_shr:1 row_mask:0xf bank_mask:0xf
    s_nop 1
    v_max_u32_dpp v60, v60, v60 row_shr:2 row_mask:0xf bank_mask:0xf
    s_nop 1
    v_max_u32_dpp v60, v60, v60 row_shr:4 row_mask:0xf bank_mask:0xf
    s_nop 1
    v_max_u32_dpp v60, v60, v60 row_shr:8 row_mask:0xf bank_mask:0xf
    s_nop 1
    v_max_u32_dpp v60, v60, v60 row_bcast:15 row_mask:0xa bank_mask:0xf
    s_nop 1
    v_max_u32_dpp v60, v60, v60 row_bcast:31 row_mask:0xc bank_mask:0xf
    s_nop 1
    v_add_f32_dpp v61, v61, v61 row_shr:1 row_mask:0xf bank_mask:0xf
    s_nop 1
    v_add_f32_dpp v61, v61, v61 row_shr:2 row_mask:0xf bank_mask:0xf
    s_nop 1
    v_add_f32_dpp v61, v61, v61 row_shr:4 row_mask:0xf bank_mask:0xf
    s_nop 1
    v_add_f32_dpp v61, v61, v61 row_shr:8 row_mask:0xf bank_mask:0xf
    s_nop 1
    v_add_f32_dpp v61, v61, v61 row_bcast:15 row_mask:0xa bank_mask:0xf
    s_nop 1
    v_add_f32_dpp v61, v61, v61 row_bcast:31 row_mask:0xc bank_mask:0xf
    s_nop 1
    v_add_f32_dpp v62, v62, v62 row_shr:1 row_mask:0xf bank_mask:0xf
    s_nop 1
    v_add_f32_dpp v62, v62, v62 row_shr:2 row_mask:0xf bank_mask:0xf
    s_nop 1
    v_add_f32_dpp v62, v62, v62 row_shr:4 row_mask:0xf bank_mask:0xf
    s_nop 1
    v_add_f32_dpp v62, v62, v62 row_shr:8 row_mask:0xf bank_mask:0xf
    s_nop 1
    v_add_f32_dpp v62, v62, v62 row_bcast:15 row_mask:0xa bank_mask:0xf
    s_nop 1
    v_add_f32_dpp v62, v62, v62 row_bcast:31 row_mask:0xc bank_mask:0xf
    v_lshrrev_b32 v64, 6, v0
    v_lshlrev_b32 v64, 4, v64
    s_mov_b32 exec_lo, 0
    s_brev_b32 exec_hi, 1
    ds_write_b128 v64, v[60:63] offset:8192
    s_mov_b64 exec, -1
    v_and_b32 v64, 15, v0
    v_lshlrev_b32 v64, 4, v64
    s_waitcnt lgkmcnt(0)
    s_barrier
    ds_read_b128 v[60:63], v64 offset:8192
    s_waitcnt lgkmcnt(0)

    s_nop 0
    v_max_u32_dpp v60, v60, v60 row_ror:1 row_mask:0xf bank_mask:0xf
    v_add_f32_dpp v61, v61, v61 row_ror:1 row_mask:0xf bank_mask:0xf
    v_add_f32_dpp v62, v62, v62 row_ror:1 row_mask:0xf bank_mask:0xf

    s_nop 0
    v_max_u32_dpp v60, v60, v60 row_ror:2 row_mask:0xf bank_mask:0xf
    v_add_f32_dpp v61, v61, v61 row_ror:2 row_mask:0xf bank_mask:0xf
    v_add_f32_dpp v62, v62, v62 row_ror:2 row_mask:0xf bank_mask:0xf

    s_nop 0
    v_max_u32_dpp v60, v60, v60 row_ror:4 row_mask:0xf bank_mask:0xf
    v_add_f32_dpp v61, v61, v61 row_ror:4 row_mask:0xf bank_mask:0xf
    v_add_f32_dpp v62, v62, v62 row_ror:4 row_mask:0xf bank_mask:0xf

    s_nop 0
    v_max_u32_dpp v60, v60, v60 row_ror:8 row_mask:0xf bank_mask:0xf
    v_add_f32_dpp v61, v61, v61 row_ror:8 row_mask:0xf bank_mask:0xf
    v_add_f32_dpp v62, v62, v62 row_ror:8 row_mask:0xf bank_mask:0xf

    v_rsq_f32 v62, v62
    v_mov_b32 v65, 0x4b400000
    v_mul_f32 v62, 0x47decb04, v62
    s_nop 0
    v_readfirstlane_b32 s74, v62

    s_add_u32 s92, s6, 135168
    s_addc_u32 s93, s7, 0
    s_mov_b32 s94, 4096
    s_mov_b32 s95, 0x20000
    s_lshl_b32 s3, s2, 4
    buffer_store_dwordx4 v[60:63], v98, s[92:95], s3 offen
    v_lshlrev_b32 v66, 16, v44
    v_and_b32 v44, 0xffff0000, v44
    v_fma_f32 v66, v66, s74, v65
    v_fma_f32 v44, v44, s74, v65
    v_perm_b32 v44, v44, v66, s55

    v_lshlrev_b32 v66, 16, v45
    v_and_b32 v45, 0xffff0000, v45
    v_fma_f32 v66, v66, s74, v65
    v_fma_f32 v45, v45, s74, v65
    v_perm_b32 v45, v45, v66, s55

    v_lshlrev_b32 v66, 16, v46
    v_and_b32 v46, 0xffff0000, v46
    v_fma_f32 v66, v66, s74, v65
    v_fma_f32 v46, v46, s74, v65
    v_perm_b32 v46, v46, v66, s55

    v_lshlrev_b32 v66, 16, v47
    v_and_b32 v47, 0xffff0000, v47
    v_fma_f32 v66, v66, s74, v65
    v_fma_f32 v47, v47, s74, v65
    v_perm_b32 v47, v47, v66, s55

    v_lshlrev_b32 v66, 16, v48
    v_and_b32 v48, 0xffff0000, v48
    v_fma_f32 v66, v66, s74, v65
    v_fma_f32 v48, v48, s74, v65
    v_perm_b32 v48, v48, v66, s55

    v_lshlrev_b32 v66, 16, v49
    v_and_b32 v49, 0xffff0000, v49
    v_fma_f32 v66, v66, s74, v65
    v_fma_f32 v49, v49, s74, v65
    v_perm_b32 v49, v49, v66, s55

    v_lshlrev_b32 v66, 16, v50
    v_and_b32 v50, 0xffff0000, v50
    v_fma_f32 v66, v66, s74, v65
    v_fma_f32 v50, v50, s74, v65
    v_perm_b32 v50, v50, v66, s55

    v_lshlrev_b32 v66, 16, v51
    v_and_b32 v51, 0xffff0000, v51
    v_fma_f32 v66, v66, s74, v65
    v_fma_f32 v51, v51, s74, v65
    v_perm_b32 v51, v51, v66, s55

    v_lshlrev_b32 v66, 16, v52
    v_and_b32 v52, 0xffff0000, v52
    v_fma_f32 v66, v66, s74, v65
    v_fma_f32 v52, v52, s74, v65
    v_perm_b32 v52, v52, v66, s55

    s_add_u32 s92, s6, s54
    s_addc_u32 s93, s7, 0
    s_mov_b32 s94, 24576
    s_mov_b32 s95, 0x20000
    s_movk_i32 s3, 16384
    buffer_store_dwordx4 v[44:47], v1, s[92:95], 0 offen
    buffer_store_dwordx4 v[48:51], v1, s[92:95], s3 offen
    s_mul_i32 s94, s53, 25424
    s_movk_i32 s3, 24576

    buffer_store_dword v52, v100, s[92:95], s3 offen
    s_nop 1
    v_mov_b32 v100, 0
    buffer_atomic_add v100, v98, s[96:99], 0 offen offset:128 sc0
    s_bitcmp0_b32 s82, 0
    s_cbranch_scc1 L_ska_7
    s_waitcnt vmcnt(14)
    v_mul_hi_u32_u24 v45, s40, v20
    v_mul_hi_u32_u24 v44, s40, v4
    v_mul_hi_u32_u24 v47, s40, v21
    v_mul_hi_u32_u24 v46, s40, v5
    v_mul_hi_u32_u24 v49, s40, v22
    v_mul_hi_u32_u24 v48, s40, v6
    v_mul_hi_u32_u24 v51, s40, v23
    v_mul_hi_u32_u24 v50, s40, v7
    v_and_b32 v45, -2, v45
    v_mad_u32_u24 v4, v44, s43, v4
    v_and_b32 v76, -4, v44
    v_and_b32 v47, -2, v47
    v_mad_u32_u24 v5, v46, s43, v5
    v_and_b32 v77, -4, v46
    v_and_b32 v49, -2, v49
    v_mad_u32_u24 v6, v48, s43, v6
    v_and_b32 v78, -4, v48
    v_and_b32 v51, -2, v51
    v_mad_u32_u24 v7, v50, s43, v7
    v_and_b32 v79, -4, v50
    v_mad_i32_i24 v20, v45, s42, v20
    v_lshl_add_u32 v45, v76, 5, v45
    v_mad_i32_i24 v21, v47, s42, v21
    v_lshl_add_u32 v47, v77, 5, v47
    v_mad_i32_i24 v22, v49, s42, v22
    v_lshl_add_u32 v49, v78, 5, v49
    v_mad_i32_i24 v23, v51, s42, v23
    v_lshl_add_u32 v51, v79, 5, v51
    v_add_u32 v45, v45, v45
    ds_add_rtn_u32 v76, v45, v104
    v_add_u32 v47, v47, v47
    ds_add_rtn_u32 v77, v47, v104
    v_add_u32 v49, v49, v49
    ds_add_rtn_u32 v78, v49, v104
    v_add_u32 v51, v51, v51
    ds_add_rtn_u32 v79, v51, v104
    v_lshlrev_b32 v110, 16, v36
    v_and_b32 v111, 0xffff0000, v36
    v_lshlrev_b32 v112, 16, v37
    v_and_b32 v113, 0xffff0000, v37
    v_mul_f32 v110, s44, v110
    v_mul_f32 v111, s44, v111
    v_mul_f32 v112, s44, v112
    v_mul_f32 v113, s44, v113
    v_fract_f32 v110, v110
    v_fract_f32 v111, v111
    v_fract_f32 v112, v112
    v_fract_f32 v113, v113
    v_cos_f32 v110, v110
    v_cos_f32 v111, v111
    v_cos_f32 v112, v112
    v_cos_f32 v113, v113
    v_lshl_or_b32 v44, v44, 14, v20
    v_perm_b32 v45, v45, v4, s46
    v_bfe_u32 v4, v4, 8, 5

    v_lshl_or_b32 v46, v46, 14, v21
    v_perm_b32 v47, v47, v5, s46
    v_bfe_u32 v5, v5, 8, 5

    v_lshl_or_b32 v48, v48, 14, v22
    v_perm_b32 v49, v49, v6, s46
    v_bfe_u32 v6, v6, 8, 5

    v_lshl_or_b32 v50, v50, 14, v23
    v_perm_b32 v51, v51, v7, s46
    v_bfe_u32 v7, v7, 8, 5

    v_fmaak_f32 v110, v110, v105, 0x4b400010
    v_fmaak_f32 v111, v111, v105, 0x4b400010
    v_fmaak_f32 v112, v112, v105, 0x4b400010
    v_fmaak_f32 v113, v113, v105, 0x4b400010
    v_sub_u32 v110, v110, v4
    v_sub_u32 v111, v111, v5
    v_sub_u32 v112, v112, v6
    v_sub_u32 v113, v113, v7
    v_bfi_b32 v110, 31, v4, v110
    v_bfi_b32 v111, 31, v5, v111
    v_bfi_b32 v112, 31, v6, v112
    v_bfi_b32 v113, 31, v7, v113
    v_perm_b32 v44, v44, v110, s55
    v_perm_b32 v46, v46, v111, s55
    v_perm_b32 v48, v48, v112, s55
    v_perm_b32 v50, v50, v113, s55
    buffer_load_dwordx4 v[20:23], v1, s[12:15], s56 offen nt
    buffer_load_dwordx4 v[4:7], v1, s[8:11], s56 offen nt
    buffer_load_dwordx2 v[36:37], v2, s[16:19], s61 offen nt
L_bka_8:
    s_bitcmp0_b32 s82, 1
    s_cbranch_scc1 L_ska_9
    s_waitcnt vmcnt(14)
    v_mul_hi_u32_u24 v53, s40, v24
    v_mul_hi_u32_u24 v52, s40, v8
    v_mul_hi_u32_u24 v55, s40, v25
    v_mul_hi_u32_u24 v54, s40, v9
    v_mul_hi_u32_u24 v57, s40, v26
    v_mul_hi_u32_u24 v56, s40, v10
    v_mul_hi_u32_u24 v59, s40, v27
    v_mul_hi_u32_u24 v58, s40, v11
    v_and_b32 v53, -2, v53
    v_mad_u32_u24 v8, v52, s43, v8
    v_and_b32 v80, -4, v52
    v_and_b32 v55, -2, v55
    v_mad_u32_u24 v9, v54, s43, v9
    v_and_b32 v81, -4, v54
    v_and_b32 v57, -2, v57
    v_mad_u32_u24 v10, v56, s43, v10
    v_and_b32 v82, -4, v56
    v_and_b32 v59, -2, v59
    v_mad_u32_u24 v11, v58, s43, v11
    v_and_b32 v83, -4, v58
    v_mad_i32_i24 v24, v53, s42, v24
    v_lshl_add_u32 v53, v80, 5, v53
    v_mad_i32_i24 v25, v55, s42, v25
    v_lshl_add_u32 v55, v81, 5, v55
    v_mad_i32_i24 v26, v57, s42, v26
    v_lshl_add_u32 v57, v82, 5, v57
    v_mad_i32_i24 v27, v59, s42, v27
    v_lshl_add_u32 v59, v83, 5, v59
    v_add_u32 v53, v53, v53
    ds_add_rtn_u32 v80, v53, v104
    v_add_u32 v55, v55, v55
    ds_add_rtn_u32 v81, v55, v104
    v_add_u32 v57, v57, v57
    ds_add_rtn_u32 v82, v57, v104
    v_add_u32 v59, v59, v59
    ds_add_rtn_u32 v83, v59, v104
    v_lshlrev_b32 v110, 16, v38
    v_and_b32 v111, 0xffff0000, v38
    v_lshlrev_b32 v112, 16, v39
    v_and_b32 v113, 0xffff0000, v39
    v_mul_f32 v110, s44, v110
    v_mul_f32 v111, s44, v111
    v_mul_f32 v112, s44, v112
    v_mul_f32 v113, s44, v113
    v_fract_f32 v110, v110
    v_fract_f32 v111, v111
    v_fract_f32 v112, v112
    v_fract_f32 v113, v113
    v_cos_f32 v110, v110
    v_cos_f32 v111, v111
    v_cos_f32 v112, v112
    v_cos_f32 v113, v113
    v_lshl_or_b32 v52, v52, 14, v24
    v_perm_b32 v53, v53, v8, s46
    v_bfe_u32 v8, v8, 8, 5

    v_lshl_or_b32 v54, v54, 14, v25
    v_perm_b32 v55, v55, v9, s46
    v_bfe_u32 v9, v9, 8, 5

    v_lshl_or_b32 v56, v56, 14, v26
    v_perm_b32 v57, v57, v10, s46
    v_bfe_u32 v10, v10, 8, 5

    v_lshl_or_b32 v58, v58, 14, v27
    v_perm_b32 v59, v59, v11, s46
    v_bfe_u32 v11, v11, 8, 5

    v_fmaak_f32 v110, v110, v105, 0x4b400010
    v_fmaak_f32 v111, v111, v105, 0x4b400010
    v_fmaak_f32 v112, v112, v105, 0x4b400010
    v_fmaak_f32 v113, v113, v105, 0x4b400010
    v_sub_u32 v110, v110, v8
    v_sub_u32 v111, v111, v9
    v_sub_u32 v112, v112, v10
    v_sub_u32 v113, v113, v11
    v_bfi_b32 v110, 31, v8, v110
    v_bfi_b32 v111, 31, v9, v111
    v_bfi_b32 v112, 31, v10, v112
    v_bfi_b32 v113, 31, v11, v113
    v_perm_b32 v52, v52, v110, s55
    v_perm_b32 v54, v54, v111, s55
    v_perm_b32 v56, v56, v112, s55
    v_perm_b32 v58, v58, v113, s55
    buffer_load_dwordx4 v[24:27], v1, s[12:15], s57 offen nt
    buffer_load_dwordx4 v[8:11], v1, s[8:11], s57 offen nt
    buffer_load_dwordx2 v[38:39], v2, s[16:19], s62 offen nt
L_bka_10:
    s_bitcmp0_b32 s82, 2
    s_cbranch_scc1 L_ska_11
    s_waitcnt vmcnt(14)
    v_mul_hi_u32_u24 v61, s40, v28
    v_mul_hi_u32_u24 v60, s40, v12
    v_mul_hi_u32_u24 v63, s40, v29
    v_mul_hi_u32_u24 v62, s40, v13
    v_mul_hi_u32_u24 v65, s40, v30
    v_mul_hi_u32_u24 v64, s40, v14
    v_mul_hi_u32_u24 v67, s40, v31
    v_mul_hi_u32_u24 v66, s40, v15
    v_and_b32 v61, -2, v61
    v_mad_u32_u24 v12, v60, s43, v12
    v_and_b32 v84, -4, v60
    v_and_b32 v63, -2, v63
    v_mad_u32_u24 v13, v62, s43, v13
    v_and_b32 v85, -4, v62
    v_and_b32 v65, -2, v65
    v_mad_u32_u24 v14, v64, s43, v14
    v_and_b32 v86, -4, v64
    v_and_b32 v67, -2, v67
    v_mad_u32_u24 v15, v66, s43, v15
    v_and_b32 v87, -4, v66
    v_mad_i32_i24 v28, v61, s42, v28
    v_lshl_add_u32 v61, v84, 5, v61
    v_mad_i32_i24 v29, v63, s42, v29
    v_lshl_add_u32 v63, v85, 5, v63
    v_mad_i32_i24 v30, v65, s42, v30
    v_lshl_add_u32 v65, v86, 5, v65
    v_mad_i32_i24 v31, v67, s42, v31
    v_lshl_add_u32 v67, v87, 5, v67
    v_add_u32 v61, v61, v61
    ds_add_rtn_u32 v84, v61, v104
    v_add_u32 v63, v63, v63
    ds_add_rtn_u32 v85, v63, v104
    v_add_u32 v65, v65, v65
    ds_add_rtn_u32 v86, v65, v104
    v_add_u32 v67, v67, v67
    ds_add_rtn_u32 v87, v67, v104
    v_lshlrev_b32 v110, 16, v40
    v_and_b32 v111, 0xffff0000, v40
    v_lshlrev_b32 v112, 16, v41
    v_and_b32 v113, 0xffff0000, v41
    v_mul_f32 v110, s44, v110
    v_mul_f32 v111, s44, v111
    v_mul_f32 v112, s44, v112
    v_mul_f32 v113, s44, v113
    v_fract_f32 v110, v110
    v_fract_f32 v111, v111
    v_fract_f32 v112, v112
    v_fract_f32 v113, v113
    v_cos_f32 v110, v110
    v_cos_f32 v111, v111
    v_cos_f32 v112, v112
    v_cos_f32 v113, v113
    v_lshl_or_b32 v60, v60, 14, v28
    v_perm_b32 v61, v61, v12, s46
    v_bfe_u32 v12, v12, 8, 5

    v_lshl_or_b32 v62, v62, 14, v29
    v_perm_b32 v63, v63, v13, s46
    v_bfe_u32 v13, v13, 8, 5

    v_lshl_or_b32 v64, v64, 14, v30
    v_perm_b32 v65, v65, v14, s46
    v_bfe_u32 v14, v14, 8, 5

    v_lshl_or_b32 v66, v66, 14, v31
    v_perm_b32 v67, v67, v15, s46
    v_bfe_u32 v15, v15, 8, 5

    v_fmaak_f32 v110, v110, v105, 0x4b400010
    v_fmaak_f32 v111, v111, v105, 0x4b400010
    v_fmaak_f32 v112, v112, v105, 0x4b400010
    v_fmaak_f32 v113, v113, v105, 0x4b400010
    v_sub_u32 v110, v110, v12
    v_sub_u32 v111, v111, v13
    v_sub_u32 v112, v112, v14
    v_sub_u32 v113, v113, v15
    v_bfi_b32 v110, 31, v12, v110
    v_bfi_b32 v111, 31, v13, v111
    v_bfi_b32 v112, 31, v14, v112
    v_bfi_b32 v113, 31, v15, v113
    v_perm_b32 v60, v60, v110, s55
    v_perm_b32 v62, v62, v111, s55
    v_perm_b32 v64, v64, v112, s55
    v_perm_b32 v66, v66, v113, s55
    buffer_load_dwordx4 v[28:31], v1, s[12:15], s58 offen nt
    buffer_load_dwordx4 v[12:15], v1, s[8:11], s58 offen nt
    buffer_load_dwordx2 v[40:41], v2, s[16:19], s63 offen nt
L_bka_12:
    s_bitcmp0_b32 s82, 3
    s_cbranch_scc1 L_ska_13
    s_waitcnt vmcnt(14)
    s_mov_b64 exec, s[66:67]
    v_mul_hi_u32_u24 v69, s40, v32
    v_mul_hi_u32_u24 v68, s40, v16
    v_mul_hi_u32_u24 v71, s40, v33
    v_mul_hi_u32_u24 v70, s40, v17
    v_mul_hi_u32_u24 v73, s40, v34
    v_mul_hi_u32_u24 v72, s40, v18
    v_mul_hi_u32_u24 v75, s40, v35
    v_mul_hi_u32_u24 v74, s40, v19
    v_and_b32 v69, -2, v69
    v_mad_u32_u24 v16, v68, s43, v16
    v_and_b32 v88, -4, v68
    v_and_b32 v71, -2, v71
    v_mad_u32_u24 v17, v70, s43, v17
    v_and_b32 v89, -4, v70
    v_and_b32 v73, -2, v73
    v_mad_u32_u24 v18, v72, s43, v18
    v_and_b32 v90, -4, v72
    v_and_b32 v75, -2, v75
    v_mad_u32_u24 v19, v74, s43, v19
    v_and_b32 v91, -4, v74
    v_mad_i32_i24 v32, v69, s42, v32
    v_lshl_add_u32 v69, v88, 5, v69
    v_mad_i32_i24 v33, v71, s42, v33
    v_lshl_add_u32 v71, v89, 5, v71
    v_mad_i32_i24 v34, v73, s42, v34
    v_lshl_add_u32 v73, v90, 5, v73
    v_mad_i32_i24 v35, v75, s42, v35
    v_lshl_add_u32 v75, v91, 5, v75
    v_add_u32 v69, v69, v69
    ds_add_rtn_u32 v88, v69, v104
    v_add_u32 v71, v71, v71
    ds_add_rtn_u32 v89, v71, v104
    v_add_u32 v73, v73, v73
    ds_add_rtn_u32 v90, v73, v104
    v_add_u32 v75, v75, v75
    ds_add_rtn_u32 v91, v75, v104
    v_lshlrev_b32 v110, 16, v42
    v_and_b32 v111, 0xffff0000, v42
    v_lshlrev_b32 v112, 16, v43
    v_and_b32 v113, 0xffff0000, v43
    v_mul_f32 v110, s44, v110
    v_mul_f32 v111, s44, v111
    v_mul_f32 v112, s44, v112
    v_mul_f32 v113, s44, v113
    v_fract_f32 v110, v110
    v_fract_f32 v111, v111
    v_fract_f32 v112, v112
    v_fract_f32 v113, v113
    v_cos_f32 v110, v110
    v_cos_f32 v111, v111
    v_cos_f32 v112, v112
    v_cos_f32 v113, v113
    v_lshl_or_b32 v68, v68, 14, v32
    v_perm_b32 v69, v69, v16, s46
    v_bfe_u32 v16, v16, 8, 5

    v_lshl_or_b32 v70, v70, 14, v33
    v_perm_b32 v71, v71, v17, s46
    v_bfe_u32 v17, v17, 8, 5

    v_lshl_or_b32 v72, v72, 14, v34
    v_perm_b32 v73, v73, v18, s46
    v_bfe_u32 v18, v18, 8, 5

    v_lshl_or_b32 v74, v74, 14, v35
    v_perm_b32 v75, v75, v19, s46
    v_bfe_u32 v19, v19, 8, 5

    v_fmaak_f32 v110, v110, v105, 0x4b400010
    v_fmaak_f32 v111, v111, v105, 0x4b400010
    v_fmaak_f32 v112, v112, v105, 0x4b400010
    v_fmaak_f32 v113, v113, v105, 0x4b400010
    v_sub_u32 v110, v110, v16
    v_sub_u32 v111, v111, v17
    v_sub_u32 v112, v112, v18
    v_sub_u32 v113, v113, v19
    v_bfi_b32 v110, 31, v16, v110
    v_bfi_b32 v111, 31, v17, v111
    v_bfi_b32 v112, 31, v18, v112
    v_bfi_b32 v113, 31, v19, v113
    v_perm_b32 v68, v68, v110, s55
    v_perm_b32 v70, v70, v111, s55
    v_perm_b32 v72, v72, v112, s55
    v_perm_b32 v74, v74, v113, s55
    s_mov_b64 exec, -1
    buffer_load_dwordx4 v[32:35], v1, s[12:15], s59 offen nt
    buffer_load_dwordx4 v[16:19], v1, s[8:11], s59 offen nt
    buffer_load_dwordx2 v[42:43], v2, s[16:19], s64 offen nt
L_bka_14:
    v_readfirstlane_b32 s74, v0
    s_nop 1
    s_cmp_lg_u32 s74, 0
    s_cbranch_scc1 L_ready_16

    s_waitcnt vmcnt(12)
    v_readfirstlane_b32 s74, v100
    s_nop 1
    s_cmp_lg_u32 s74, 0
    s_cbranch_scc1 L_ready_16

    v_mov_b32 v110, 1
    buffer_atomic_add v110, v98, s[96:99], 0 offen offset:64 sc0
    s_waitcnt vmcnt(0)
    v_readfirstlane_b32 s74, v110
    s_nop 1
    s_cmp_lg_u32 s74, 0
    s_cbranch_scc1 L_zno_18

    s_mov_b32 s92, s6
    s_mov_b32 s93, s7
    s_mov_b32 s94, 65552
    s_mov_b32 s95, 0x20000
    v_mov_b32 v110, 0
    v_mov_b32 v111, 0
    v_mov_b32 v112, 0
    v_mov_b32 v113, 0
L_zl_17:
    buffer_store_dwordx4 v[110:113], v1, s[92:95], s74 offen sc0 sc1
    s_add_u32 s74, s74, 1024
    s_cmp_le_u32 s74, 65536
    s_cbranch_scc1 L_zl_17
    v_mov_b32 v114, 1
    s_waitcnt vmcnt(0)
    buffer_atomic_add v114, v98, s[96:99], 0 offen offset:128
L_zno_18:

L_spin_15:
    v_mov_b32 v100, 0
    buffer_atomic_add v100, v98, s[96:99], 0 offen offset:128 sc0
    s_waitcnt vmcnt(0)
    v_readfirstlane_b32 s74, v100
    s_nop 1
    s_cmp_eq_u32 s74, 0
    s_cbranch_scc1 L_spin_15
L_ready_16:

    s_waitcnt lgkmcnt(0)
    s_barrier

    ds_read_b64 v[94:95], v2
    s_waitcnt lgkmcnt(0)
    v_and_b32 v94, 0xffff, v94
    v_and_b32 v95, 0xffff, v95
    v_add_u32 v97, v94, v95
    s_nop 1
    v_add_u32_dpp v97, v97, v97 row_shr:1 row_mask:0xf bank_mask:0xf
    s_nop 1
    v_add_u32_dpp v97, v97, v97 row_shr:2 row_mask:0xf bank_mask:0xf
    s_nop 1
    v_add_u32_dpp v97, v97, v97 row_shr:4 row_mask:0xf bank_mask:0xf
    s_nop 1
    v_add_u32_dpp v97, v97, v97 row_shr:8 row_mask:0xf bank_mask:0xf
    s_nop 1
    v_add_u32_dpp v97, v97, v97 row_bcast:15 row_mask:0xa bank_mask:0xf
    s_nop 1
    v_add_u32_dpp v97, v97, v97 row_bcast:31 row_mask:0xc bank_mask:0xf
    s_mov_b32 exec_lo, 0
    s_brev_b32 exec_hi, 1
    ds_add_rtn_u32 v96, v108, v97
    s_mov_b64 exec, -1

    v_add_u32 v92, v94, v94
    v_add_u32 v93, v95, v95
    v_med3_u32 v92, v94, 2, v92
    v_med3_u32 v93, v95, 2, v93
    buffer_atomic_add_x2 v[92:93], v2, s[20:23], 0 offen sc0
    s_waitcnt lgkmcnt(0)
    v_readlane_b32 s77, v96, 63
    v_mul_u32_u24 v114, 7936, v0
    v_sub_u32 v97, v97, v95
    s_sub_u32 s50, s50, s83
    s_sub_u32 s77, s77, s50
    v_add_u32 v97, s77, v97
    v_sub_u32 v96, v97, v94
    v_lshlrev_b32 v111, 16, v97
    v_lshlrev_b32 v110, 16, v96
    ds_write_b64 v2, v[110:111]
    v_sub_u32 v96, v114, v96
    v_sub_u32 v97, v114, v97
    v_add_u32 v97, s48, v97
    s_add_u32 s50, s50, s84
    s_mov_b32 s28, s82
    s_mov_b32 s29, s83
    s_mov_b32 s30, s84
    s_lshl_b32 s74, s29, 3
    s_lshl_b32 s75, s30, 3
    v_mov_b32 v125, s74
    v_mov_b32 v126, s75
    v_mov_b32 v127, -1

    s_waitcnt lgkmcnt(0)
    s_barrier

    s_mov_b64 exec, 1
    ds_write_b32 v125, v127 offset:16396
    ds_write_b32 v126, v127 offset:16404
    s_mov_b64 exec, -1

    s_bitcmp0_b32 s28, 0
    s_cbranch_scc1 L_skz_19
    v_lshrrev_b32 v110, 16, v45
    ds_read_b32 v110, v110
    v_lshrrev_b32 v111, 16, v47
    ds_read_b32 v111, v111
    v_lshrrev_b32 v112, 16, v49
    ds_read_b32 v112, v112
    v_lshrrev_b32 v113, 16, v51
    ds_read_b32 v113, v113
    s_waitcnt lgkmcnt(3)
    v_add_u32_sdwa v110, v110, v76 dst_sel:DWORD dst_unused:UNUSED_PAD src0_sel:WORD_1 src1_sel:WORD_0
    v_lshlrev_b32 v110, 3, v110
    ds_write_b64 v110, v[44:45] offset:16400

    s_waitcnt lgkmcnt(3)
    v_add_u32_sdwa v111, v111, v77 dst_sel:DWORD dst_unused:UNUSED_PAD src0_sel:WORD_1 src1_sel:WORD_0
    v_lshlrev_b32 v111, 3, v111
    ds_write_b64 v111, v[46:47] offset:16400

    s_waitcnt lgkmcnt(3)
    v_add_u32_sdwa v112, v112, v78 dst_sel:DWORD dst_unused:UNUSED_PAD src0_sel:WORD_1 src1_sel:WORD_0
    v_lshlrev_b32 v112, 3, v112
    ds_write_b64 v112, v[48:49] offset:16400

    s_waitcnt lgkmcnt(3)
    v_add_u32_sdwa v113, v113, v79 dst_sel:DWORD dst_unused:UNUSED_PAD src0_sel:WORD_1 src1_sel:WORD_0
    v_lshlrev_b32 v113, 3, v113
    ds_write_b64 v113, v[50:51] offset:16400

L_skz_19:
    s_bitcmp0_b32 s28, 1
    s_cbranch_scc1 L_skz_20
    v_lshrrev_b32 v110, 16, v53
    ds_read_b32 v110, v110
    v_lshrrev_b32 v111, 16, v55
    ds_read_b32 v111, v111
    v_lshrrev_b32 v112, 16, v57
    ds_read_b32 v112, v112
    v_lshrrev_b32 v113, 16, v59
    ds_read_b32 v113, v113
    s_waitcnt lgkmcnt(3)
    v_add_u32_sdwa v110, v110, v80 dst_sel:DWORD dst_unused:UNUSED_PAD src0_sel:WORD_1 src1_sel:WORD_0
    v_lshlrev_b32 v110, 3, v110
    ds_write_b64 v110, v[52:53] offset:16400

    s_waitcnt lgkmcnt(3)
    v_add_u32_sdwa v111, v111, v81 dst_sel:DWORD dst_unused:UNUSED_PAD src0_sel:WORD_1 src1_sel:WORD_0
    v_lshlrev_b32 v111, 3, v111
    ds_write_b64 v111, v[54:55] offset:16400

    s_waitcnt lgkmcnt(3)
    v_add_u32_sdwa v112, v112, v82 dst_sel:DWORD dst_unused:UNUSED_PAD src0_sel:WORD_1 src1_sel:WORD_0
    v_lshlrev_b32 v112, 3, v112
    ds_write_b64 v112, v[56:57] offset:16400

    s_waitcnt lgkmcnt(3)
    v_add_u32_sdwa v113, v113, v83 dst_sel:DWORD dst_unused:UNUSED_PAD src0_sel:WORD_1 src1_sel:WORD_0
    v_lshlrev_b32 v113, 3, v113
    ds_write_b64 v113, v[58:59] offset:16400

L_skz_20:
    s_bitcmp0_b32 s28, 2
    s_cbranch_scc1 L_skz_21
    v_lshrrev_b32 v110, 16, v61
    ds_read_b32 v110, v110
    v_lshrrev_b32 v111, 16, v63
    ds_read_b32 v111, v111
    v_lshrrev_b32 v112, 16, v65
    ds_read_b32 v112, v112
    v_lshrrev_b32 v113, 16, v67
    ds_read_b32 v113, v113
    s_waitcnt lgkmcnt(3)
    v_add_u32_sdwa v110, v110, v84 dst_sel:DWORD dst_unused:UNUSED_PAD src0_sel:WORD_1 src1_sel:WORD_0
    v_lshlrev_b32 v110, 3, v110
    ds_write_b64 v110, v[60:61] offset:16400

    s_waitcnt lgkmcnt(3)
    v_add_u32_sdwa v111, v111, v85 dst_sel:DWORD dst_unused:UNUSED_PAD src0_sel:WORD_1 src1_sel:WORD_0
    v_lshlrev_b32 v111, 3, v111
    ds_write_b64 v111, v[62:63] offset:16400

    s_waitcnt lgkmcnt(3)
    v_add_u32_sdwa v112, v112, v86 dst_sel:DWORD dst_unused:UNUSED_PAD src0_sel:WORD_1 src1_sel:WORD_0
    v_lshlrev_b32 v112, 3, v112
    ds_write_b64 v112, v[64:65] offset:16400

    s_waitcnt lgkmcnt(3)
    v_add_u32_sdwa v113, v113, v87 dst_sel:DWORD dst_unused:UNUSED_PAD src0_sel:WORD_1 src1_sel:WORD_0
    v_lshlrev_b32 v113, 3, v113
    ds_write_b64 v113, v[66:67] offset:16400

L_skz_21:
    s_bitcmp0_b32 s28, 3
    s_cbranch_scc1 L_skz_22
    s_mov_b64 exec, s[66:67]
    v_lshrrev_b32 v110, 16, v69
    ds_read_b32 v110, v110
    v_lshrrev_b32 v111, 16, v71
    ds_read_b32 v111, v111
    v_lshrrev_b32 v112, 16, v73
    ds_read_b32 v112, v112
    v_lshrrev_b32 v113, 16, v75
    ds_read_b32 v113, v113
    s_waitcnt lgkmcnt(3)
    v_add_u32_sdwa v110, v110, v88 dst_sel:DWORD dst_unused:UNUSED_PAD src0_sel:WORD_1 src1_sel:WORD_0
    v_lshlrev_b32 v110, 3, v110
    ds_write_b64 v110, v[68:69] offset:16400

    s_waitcnt lgkmcnt(3)
    v_add_u32_sdwa v111, v111, v89 dst_sel:DWORD dst_unused:UNUSED_PAD src0_sel:WORD_1 src1_sel:WORD_0
    v_lshlrev_b32 v111, 3, v111
    ds_write_b64 v111, v[70:71] offset:16400

    s_waitcnt lgkmcnt(3)
    v_add_u32_sdwa v112, v112, v90 dst_sel:DWORD dst_unused:UNUSED_PAD src0_sel:WORD_1 src1_sel:WORD_0
    v_lshlrev_b32 v112, 3, v112
    ds_write_b64 v112, v[72:73] offset:16400

    s_waitcnt lgkmcnt(3)
    v_add_u32_sdwa v113, v113, v91 dst_sel:DWORD dst_unused:UNUSED_PAD src0_sel:WORD_1 src1_sel:WORD_0
    v_lshlrev_b32 v113, 3, v113
    ds_write_b64 v113, v[74:75] offset:16400

    s_mov_b64 exec, -1
L_skz_22:
    s_cmp_eq_u32 s49, 0
    s_cbranch_scc1 L_p1epi_6
L_p1loop_5:
    s_mov_b32 s82, s85
    s_mov_b32 s83, s86
    s_mov_b32 s84, s87
    v_mov_b32 v99, 1
    buffer_atomic_add v99, v98, s[96:99], 0 offen sc0
    s_bitcmp0_b32 s82, 0
    s_cbranch_scc1 L_ska_23
    s_waitcnt vmcnt(11)
    v_mul_hi_u32_u24 v45, s40, v20
    v_mul_hi_u32_u24 v44, s40, v4
    v_mul_hi_u32_u24 v47, s40, v21
    v_mul_hi_u32_u24 v46, s40, v5
    v_mul_hi_u32_u24 v49, s40, v22
    v_mul_hi_u32_u24 v48, s40, v6
    v_mul_hi_u32_u24 v51, s40, v23
    v_mul_hi_u32_u24 v50, s40, v7
    v_and_b32 v45, -2, v45
    v_mad_u32_u24 v4, v44, s43, v4
    v_and_b32 v76, -4, v44
    v_and_b32 v47, -2, v47
    v_mad_u32_u24 v5, v46, s43, v5
    v_and_b32 v77, -4, v46
    v_and_b32 v49, -2, v49
    v_mad_u32_u24 v6, v48, s43, v6
    v_and_b32 v78, -4, v48
    v_and_b32 v51, -2, v51
    v_mad_u32_u24 v7, v50, s43, v7
    v_and_b32 v79, -4, v50
    v_mad_i32_i24 v20, v45, s42, v20
    v_lshl_add_u32 v45, v76, 5, v45
    v_mad_i32_i24 v21, v47, s42, v21
    v_lshl_add_u32 v47, v77, 5, v47
    v_mad_i32_i24 v22, v49, s42, v22
    v_lshl_add_u32 v49, v78, 5, v49
    v_mad_i32_i24 v23, v51, s42, v23
    v_lshl_add_u32 v51, v79, 5, v51
    v_add_u32 v45, v45, v45
    ds_add_rtn_u32 v76, v45, v104
    v_add_u32 v47, v47, v47
    ds_add_rtn_u32 v77, v47, v104
    v_add_u32 v49, v49, v49
    ds_add_rtn_u32 v78, v49, v104
    v_add_u32 v51, v51, v51
    ds_add_rtn_u32 v79, v51, v104
    v_lshlrev_b32 v110, 16, v36
    v_and_b32 v111, 0xffff0000, v36
    v_lshlrev_b32 v112, 16, v37
    v_and_b32 v113, 0xffff0000, v37
    v_mul_f32 v110, s44, v110
    v_mul_f32 v111, s44, v111
    v_mul_f32 v112, s44, v112
    v_mul_f32 v113, s44, v113
    v_fract_f32 v110, v110
    v_fract_f32 v111, v111
    v_fract_f32 v112, v112
    v_fract_f32 v113, v113
    v_cos_f32 v110, v110
    v_cos_f32 v111, v111
    v_cos_f32 v112, v112
    v_cos_f32 v113, v113
    v_lshl_or_b32 v44, v44, 14, v20
    v_perm_b32 v45, v45, v4, s46
    v_bfe_u32 v4, v4, 8, 5

    v_lshl_or_b32 v46, v46, 14, v21
    v_perm_b32 v47, v47, v5, s46
    v_bfe_u32 v5, v5, 8, 5

    v_lshl_or_b32 v48, v48, 14, v22
    v_perm_b32 v49, v49, v6, s46
    v_bfe_u32 v6, v6, 8, 5

    v_lshl_or_b32 v50, v50, 14, v23
    v_perm_b32 v51, v51, v7, s46
    v_bfe_u32 v7, v7, 8, 5

    v_fmaak_f32 v110, v110, v105, 0x4b400010
    v_fmaak_f32 v111, v111, v105, 0x4b400010
    v_fmaak_f32 v112, v112, v105, 0x4b400010
    v_fmaak_f32 v113, v113, v105, 0x4b400010
    v_sub_u32 v110, v110, v4
    v_sub_u32 v111, v111, v5
    v_sub_u32 v112, v112, v6
    v_sub_u32 v113, v113, v7
    v_bfi_b32 v110, 31, v4, v110
    v_bfi_b32 v111, 31, v5, v111
    v_bfi_b32 v112, 31, v6, v112
    v_bfi_b32 v113, 31, v7, v113
    v_perm_b32 v44, v44, v110, s55
    v_perm_b32 v46, v46, v111, s55
    v_perm_b32 v48, v48, v112, s55
    v_perm_b32 v50, v50, v113, s55
L_ska_23:
    s_bitcmp0_b32 s82, 1
    s_cbranch_scc1 L_ska_24
    s_waitcnt vmcnt(7)
    v_mul_hi_u32_u24 v53, s40, v24
    v_mul_hi_u32_u24 v52, s40, v8
    v_mul_hi_u32_u24 v55, s40, v25
    v_mul_hi_u32_u24 v54, s40, v9
    v_mul_hi_u32_u24 v57, s40, v26
    v_mul_hi_u32_u24 v56, s40, v10
    v_mul_hi_u32_u24 v59, s40, v27
    v_mul_hi_u32_u24 v58, s40, v11
    v_and_b32 v53, -2, v53
    v_mad_u32_u24 v8, v52, s43, v8
    v_and_b32 v80, -4, v52
    v_and_b32 v55, -2, v55
    v_mad_u32_u24 v9, v54, s43, v9
    v_and_b32 v81, -4, v54
    v_and_b32 v57, -2, v57
    v_mad_u32_u24 v10, v56, s43, v10
    v_and_b32 v82, -4, v56
    v_and_b32 v59, -2, v59
    v_mad_u32_u24 v11, v58, s43, v11
    v_and_b32 v83, -4, v58
    v_mad_i32_i24 v24, v53, s42, v24
    v_lshl_add_u32 v53, v80, 5, v53
    v_mad_i32_i24 v25, v55, s42, v25
    v_lshl_add_u32 v55, v81, 5, v55
    v_mad_i32_i24 v26, v57, s42, v26
    v_lshl_add_u32 v57, v82, 5, v57
    v_mad_i32_i24 v27, v59, s42, v27
    v_lshl_add_u32 v59, v83, 5, v59
    v_add_u32 v53, v53, v53
    ds_add_rtn_u32 v80, v53, v104
    v_add_u32 v55, v55, v55
    ds_add_rtn_u32 v81, v55, v104
    v_add_u32 v57, v57, v57
    ds_add_rtn_u32 v82, v57, v104
    v_add_u32 v59, v59, v59
    ds_add_rtn_u32 v83, v59, v104
    v_lshlrev_b32 v110, 16, v38
    v_and_b32 v111, 0xffff0000, v38
    v_lshlrev_b32 v112, 16, v39
    v_and_b32 v113, 0xffff0000, v39
    v_mul_f32 v110, s44, v110
    v_mul_f32 v111, s44, v111
    v_mul_f32 v112, s44, v112
    v_mul_f32 v113, s44, v113
    v_fract_f32 v110, v110
    v_fract_f32 v111, v111
    v_fract_f32 v112, v112
    v_fract_f32 v113, v113
    v_cos_f32 v110, v110
    v_cos_f32 v111, v111
    v_cos_f32 v112, v112
    v_cos_f32 v113, v113
    v_lshl_or_b32 v52, v52, 14, v24
    v_perm_b32 v53, v53, v8, s46
    v_bfe_u32 v8, v8, 8, 5

    v_lshl_or_b32 v54, v54, 14, v25
    v_perm_b32 v55, v55, v9, s46
    v_bfe_u32 v9, v9, 8, 5

    v_lshl_or_b32 v56, v56, 14, v26
    v_perm_b32 v57, v57, v10, s46
    v_bfe_u32 v10, v10, 8, 5

    v_lshl_or_b32 v58, v58, 14, v27
    v_perm_b32 v59, v59, v11, s46
    v_bfe_u32 v11, v11, 8, 5

    v_fmaak_f32 v110, v110, v105, 0x4b400010
    v_fmaak_f32 v111, v111, v105, 0x4b400010
    v_fmaak_f32 v112, v112, v105, 0x4b400010
    v_fmaak_f32 v113, v113, v105, 0x4b400010
    v_sub_u32 v110, v110, v8
    v_sub_u32 v111, v111, v9
    v_sub_u32 v112, v112, v10
    v_sub_u32 v113, v113, v11
    v_bfi_b32 v110, 31, v8, v110
    v_bfi_b32 v111, 31, v9, v111
    v_bfi_b32 v112, 31, v10, v112
    v_bfi_b32 v113, 31, v11, v113
    v_perm_b32 v52, v52, v110, s55
    v_perm_b32 v54, v54, v111, s55
    v_perm_b32 v56, v56, v112, s55
    v_perm_b32 v58, v58, v113, s55
L_ska_24:
    s_waitcnt vmcnt(1)
    s_waitcnt vmcnt(0)
    v_cmp_eq_u32 vcc, 0, v0
    s_mov_b64 exec, vcc
    ds_write_b32 v108, v99 offset:8
    s_mov_b64 exec, -1
    s_waitcnt vmcnt(1)
    v_add_u32 v110, v92, v94
    v_min_u32 v92, s48, v92
    v_add_u32 v111, v93, v95
    v_min_u32 v93, s48, v93
    v_max_u32 v110, v110, v111
    v_add_u32 v92, v92, v96
    v_add_u32 v93, v93, v97
    v_cmp_le_u32 vcc, s48, v110
    v_lshl_add_u32 v92, v92, 2, v92
    v_lshl_add_u32 v93, v93, 2, v93
    ds_write_b64 v2, v[92:93] offset:8192
    s_cbranch_vccz L_noov_25
    ds_write_b32 v108, v104 offset:4
L_noov_25:

    s_waitcnt lgkmcnt(0)
    s_barrier
    ds_read2_b32 v[110:111], v108 offset0:1 offset1:2
    s_waitcnt lgkmcnt(0)
    v_readfirstlane_b32 s53, v110
    v_readfirstlane_b32 s41, v111
    s_nop 1

    s_add_u32 s41, s41, 416
    s_sub_u32 s78, s41, 2997
    s_lshr_b32 s79, s78, 1
    s_add_u32 s79, s79, 2997
    s_and_b32 s86, s78, 1
    s_lshl_b32 s86, s86, 1
    s_add_u32 s87, s86, 2
    s_cmp_lt_u32 s41, 2997
    s_cselect_b32 s41, s41, s79
    s_cmovk_i32 s86, 0
    s_cmovk_i32 s87, 4

    s_mul_i32 s78, s41, 16384
    s_add_u32 s49, s78, 16384
    s_cmp_ge_u32 s41, 3125
    s_cmovk_i32 s49, 0
    s_cmovk_i32 s78, 0
    s_lshl_b32 s10, s49, 2
    s_lshl_b32 s14, s49, 2
    s_lshl_b32 s18, s49, 1
    s_sub_u32 s79, s87, s86
    s_bfm_b32 s85, s79, s86
    s_lshl_b32 s86, s86, 12
    s_lshl_b32 s87, s87, 12
    s_min_u32 s87, s87, 16384

    s_add_u32 s79, s78, 0
    s_bitcmp1_b32 s85, 0
    s_cselect_b32 s79, s79, 0x1ff00000
    s_lshl_b32 s56, s79, 2
    s_lshl_b32 s61, s79, 1

    s_add_u32 s79, s78, 4096
    s_bitcmp1_b32 s85, 1
    s_cselect_b32 s79, s79, 0x1ff00000
    s_lshl_b32 s57, s79, 2
    s_lshl_b32 s62, s79, 1

    s_add_u32 s79, s78, 8192
    s_bitcmp1_b32 s85, 2
    s_cselect_b32 s79, s79, 0x1ff00000
    s_lshl_b32 s58, s79, 2
    s_lshl_b32 s63, s79, 1

    s_add_u32 s79, s78, 12288
    s_bitcmp1_b32 s85, 3
    s_cselect_b32 s79, s79, 0x1ff00000
    s_lshl_b32 s59, s79, 2
    s_lshl_b32 s64, s79, 1

    s_cmp_lg_u32 s53, 0
    s_cbranch_scc1 L_slow_26
L_sback_27:
    s_bitcmp0_b32 s28, 0
    s_cbranch_scc1 L_skw_31
    ds_read_b64 v[110:111], v2 offset:16400
    ds_read_b64 v[112:113], v2 offset:16408
    ds_read_b64 v[114:115], v2 offset:16392

    ds_read_b64 v[118:119], v2 offset:24592
    ds_read_b64 v[120:121], v2 offset:24600
    ds_read_b64 v[122:123], v2 offset:24584

    s_waitcnt lgkmcnt(3)
    v_lshrrev_b32 v116, 16, v111
    ds_read_b32 v116, v116 offset:8192

    s_waitcnt lgkmcnt(1)
    v_lshrrev_b32 v124, 16, v119
    ds_read_b32 v124, v124 offset:8192

    v_cmp_ne_u32_sdwa s[80:81], v111, v113 src0_sel:WORD_1 src1_sel:WORD_1
    v_cmp_ne_u32_sdwa vcc, v111, v115 src0_sel:WORD_1 src1_sel:WORD_1
    v_alignbyte_b32 v114, v115, v114, 2
    s_mov_b32 s54, -3
    v_alignbyte_b32 v111, v111, v110, 1
    v_perm_b32 v110, v110, v114, s47
    s_waitcnt lgkmcnt(1)
    v_add3_u32 v116, v116, v106, s54
    v_sub_u32 v117, 0, v116
    v_and_b32 v117, 3, v117
    s_mov_b64 exec, s[80:81]
    v_mov_b32 v117, 0
    v_mov_b32 v112, 0
    s_mov_b64 exec, vcc
    v_mov_b32 v117, 3

    s_mov_b64 exec, -1
    v_alignbyte_b32 v110, v111, v110, v117
    v_alignbyte_b32 v111, v112, v111, v117
    v_add_u32 v116, v116, v117

    buffer_store_dwordx2 v[110:111], v116, s[24:27], 0 offen
    v_cmp_ne_u32_sdwa s[80:81], v119, v121 src0_sel:WORD_1 src1_sel:WORD_1
    v_cmp_ne_u32_sdwa vcc, v119, v123 src0_sel:WORD_1 src1_sel:WORD_1
    v_alignbyte_b32 v122, v123, v122, 2
    s_mov_b32 s54, 5117
    v_alignbyte_b32 v119, v119, v118, 1
    v_perm_b32 v118, v118, v122, s47
    s_waitcnt lgkmcnt(0)
    v_add3_u32 v124, v124, v106, s54
    v_sub_u32 v125, 0, v124
    v_and_b32 v125, 3, v125
    s_mov_b64 exec, s[80:81]
    v_mov_b32 v125, 0
    v_mov_b32 v120, 0
    s_mov_b64 exec, vcc
    v_mov_b32 v125, 3

    s_mov_b64 exec, -1
    v_alignbyte_b32 v118, v119, v118, v125
    v_alignbyte_b32 v119, v120, v119, v125
    v_add_u32 v124, v124, v125

    buffer_store_dwordx2 v[118:119], v124, s[24:27], 0 offen
L_skw_31:
    s_bitcmp0_b32 s28, 0
    s_cbranch_scc1 L_skw_32
    ds_read_b64 v[110:111], v2 offset:32784
    ds_read_b64 v[112:113], v2 offset:32792
    ds_read_b64 v[114:115], v2 offset:32776

    ds_read_b64 v[118:119], v2 offset:40976
    ds_read_b64 v[120:121], v2 offset:40984
    ds_read_b64 v[122:123], v2 offset:40968

    s_waitcnt lgkmcnt(3)
    v_lshrrev_b32 v116, 16, v111
    ds_read_b32 v116, v116 offset:8192

    s_waitcnt lgkmcnt(1)
    v_lshrrev_b32 v124, 16, v119
    ds_read_b32 v124, v124 offset:8192

    v_cmp_ne_u32_sdwa s[80:81], v111, v113 src0_sel:WORD_1 src1_sel:WORD_1
    v_cmp_ne_u32_sdwa vcc, v111, v115 src0_sel:WORD_1 src1_sel:WORD_1
    v_alignbyte_b32 v114, v115, v114, 2
    s_mov_b32 s54, 10237
    v_alignbyte_b32 v111, v111, v110, 1
    v_perm_b32 v110, v110, v114, s47
    s_waitcnt lgkmcnt(1)
    v_add3_u32 v116, v116, v106, s54
    v_sub_u32 v117, 0, v116
    v_and_b32 v117, 3, v117
    s_mov_b64 exec, s[80:81]
    v_mov_b32 v117, 0
    v_mov_b32 v112, 0
    s_mov_b64 exec, vcc
    v_mov_b32 v117, 3

    s_mov_b64 exec, -1
    v_alignbyte_b32 v110, v111, v110, v117
    v_alignbyte_b32 v111, v112, v111, v117
    v_add_u32 v116, v116, v117

    buffer_store_dwordx2 v[110:111], v116, s[24:27], 0 offen
    v_cmp_ne_u32_sdwa s[80:81], v119, v121 src0_sel:WORD_1 src1_sel:WORD_1
    v_cmp_ne_u32_sdwa vcc, v119, v123 src0_sel:WORD_1 src1_sel:WORD_1
    v_alignbyte_b32 v122, v123, v122, 2
    s_mov_b32 s54, 15357
    v_alignbyte_b32 v119, v119, v118, 1
    v_perm_b32 v118, v118, v122, s47
    s_waitcnt lgkmcnt(0)
    v_add3_u32 v124, v124, v106, s54
    v_sub_u32 v125, 0, v124
    v_and_b32 v125, 3, v125
    s_mov_b64 exec, s[80:81]
    v_mov_b32 v125, 0
    v_mov_b32 v120, 0
    s_mov_b64 exec, vcc
    v_mov_b32 v125, 3

    s_mov_b64 exec, -1
    v_alignbyte_b32 v118, v119, v118, v125
    v_alignbyte_b32 v119, v120, v119, v125
    v_add_u32 v124, v124, v125

    buffer_store_dwordx2 v[118:119], v124, s[24:27], 0 offen
L_skw_32:
    s_bitcmp0_b32 s82, 2
    s_cbranch_scc1 L_ska_33
    v_mul_hi_u32_u24 v61, s40, v28
    v_mul_hi_u32_u24 v60, s40, v12
    v_mul_hi_u32_u24 v63, s40, v29
    v_mul_hi_u32_u24 v62, s40, v13
    v_mul_hi_u32_u24 v65, s40, v30
    v_mul_hi_u32_u24 v64, s40, v14
    v_mul_hi_u32_u24 v67, s40, v31
    v_mul_hi_u32_u24 v66, s40, v15
    v_and_b32 v61, -2, v61
    v_mad_u32_u24 v12, v60, s43, v12
    v_and_b32 v84, -4, v60
    v_and_b32 v63, -2, v63
    v_mad_u32_u24 v13, v62, s43, v13
    v_and_b32 v85, -4, v62
    v_and_b32 v65, -2, v65
    v_mad_u32_u24 v14, v64, s43, v14
    v_and_b32 v86, -4, v64
    v_and_b32 v67, -2, v67
    v_mad_u32_u24 v15, v66, s43, v15
    v_and_b32 v87, -4, v66
    v_mad_i32_i24 v28, v61, s42, v28
    v_lshl_add_u32 v61, v84, 5, v61
    v_mad_i32_i24 v29, v63, s42, v29
    v_lshl_add_u32 v63, v85, 5, v63
    v_mad_i32_i24 v30, v65, s42, v30
    v_lshl_add_u32 v65, v86, 5, v65
    v_mad_i32_i24 v31, v67, s42, v31
    v_lshl_add_u32 v67, v87, 5, v67
    v_add_u32 v61, v61, v61
    ds_add_rtn_u32 v84, v61, v104
    v_add_u32 v63, v63, v63
    ds_add_rtn_u32 v85, v63, v104
    v_add_u32 v65, v65, v65
    ds_add_rtn_u32 v86, v65, v104
    v_add_u32 v67, v67, v67
    ds_add_rtn_u32 v87, v67, v104
    v_lshlrev_b32 v110, 16, v40
    v_and_b32 v111, 0xffff0000, v40
    v_lshlrev_b32 v112, 16, v41
    v_and_b32 v113, 0xffff0000, v41
    v_mul_f32 v110, s44, v110
    v_mul_f32 v111, s44, v111
    v_mul_f32 v112, s44, v112
    v_mul_f32 v113, s44, v113
    v_fract_f32 v110, v110
    v_fract_f32 v111, v111
    v_fract_f32 v112, v112
    v_fract_f32 v113, v113
    v_cos_f32 v110, v110
    v_cos_f32 v111, v111
    v_cos_f32 v112, v112
    v_cos_f32 v113, v113
    v_lshl_or_b32 v60, v60, 14, v28
    v_perm_b32 v61, v61, v12, s46
    v_bfe_u32 v12, v12, 8, 5

    v_lshl_or_b32 v62, v62, 14, v29
    v_perm_b32 v63, v63, v13, s46
    v_bfe_u32 v13, v13, 8, 5

    v_lshl_or_b32 v64, v64, 14, v30
    v_perm_b32 v65, v65, v14, s46
    v_bfe_u32 v14, v14, 8, 5

    v_lshl_or_b32 v66, v66, 14, v31
    v_perm_b32 v67, v67, v15, s46
    v_bfe_u32 v15, v15, 8, 5

    v_fmaak_f32 v110, v110, v105, 0x4b400010
    v_fmaak_f32 v111, v111, v105, 0x4b400010
    v_fmaak_f32 v112, v112, v105, 0x4b400010
    v_fmaak_f32 v113, v113, v105, 0x4b400010
    v_sub_u32 v110, v110, v12
    v_sub_u32 v111, v111, v13
    v_sub_u32 v112, v112, v14
    v_sub_u32 v113, v113, v15
    v_bfi_b32 v110, 31, v12, v110
    v_bfi_b32 v111, 31, v13, v111
    v_bfi_b32 v112, 31, v14, v112
    v_bfi_b32 v113, 31, v15, v113
    v_perm_b32 v60, v60, v110, s55
    v_perm_b32 v62, v62, v111, s55
    v_perm_b32 v64, v64, v112, s55
    v_perm_b32 v66, v66, v113, s55
L_ska_33:
    s_bitcmp0_b32 s28, 1
    s_cbranch_scc1 L_skw_34
    v_add_u32 v107, 32768, v2
    ds_read_b64 v[110:111], v107 offset:16400
    ds_read_b64 v[112:113], v107 offset:16408
    ds_read_b64 v[114:115], v107 offset:16392

    ds_read_b64 v[118:119], v107 offset:24592
    ds_read_b64 v[120:121], v107 offset:24600
    ds_read_b64 v[122:123], v107 offset:24584

    s_waitcnt lgkmcnt(3)
    v_lshrrev_b32 v116, 16, v111
    ds_read_b32 v116, v116 offset:8192

    s_waitcnt lgkmcnt(1)
    v_lshrrev_b32 v124, 16, v119
    ds_read_b32 v124, v124 offset:8192

    v_cmp_ne_u32_sdwa s[80:81], v111, v113 src0_sel:WORD_1 src1_sel:WORD_1
    v_cmp_ne_u32_sdwa vcc, v111, v115 src0_sel:WORD_1 src1_sel:WORD_1
    v_alignbyte_b32 v114, v115, v114, 2
    s_mov_b32 s54, 20477
    v_alignbyte_b32 v111, v111, v110, 1
    v_perm_b32 v110, v110, v114, s47
    s_waitcnt lgkmcnt(1)
    v_add3_u32 v116, v116, v106, s54
    v_sub_u32 v117, 0, v116
    v_and_b32 v117, 3, v117
    s_mov_b64 exec, s[80:81]
    v_mov_b32 v117, 0
    v_mov_b32 v112, 0
    s_mov_b64 exec, vcc
    v_mov_b32 v117, 3

    s_mov_b64 exec, -1
    v_alignbyte_b32 v110, v111, v110, v117
    v_alignbyte_b32 v111, v112, v111, v117
    v_add_u32 v116, v116, v117

    buffer_store_dwordx2 v[110:111], v116, s[24:27], 0 offen
    v_cmp_ne_u32_sdwa s[80:81], v119, v121 src0_sel:WORD_1 src1_sel:WORD_1
    v_cmp_ne_u32_sdwa vcc, v119, v123 src0_sel:WORD_1 src1_sel:WORD_1
    v_alignbyte_b32 v122, v123, v122, 2
    s_mov_b32 s54, 25597
    v_alignbyte_b32 v119, v119, v118, 1
    v_perm_b32 v118, v118, v122, s47
    s_waitcnt lgkmcnt(0)
    v_add3_u32 v124, v124, v106, s54
    v_sub_u32 v125, 0, v124
    v_and_b32 v125, 3, v125
    s_mov_b64 exec, s[80:81]
    v_mov_b32 v125, 0
    v_mov_b32 v120, 0
    s_mov_b64 exec, vcc
    v_mov_b32 v125, 3

    s_mov_b64 exec, -1
    v_alignbyte_b32 v118, v119, v118, v125
    v_alignbyte_b32 v119, v120, v119, v125
    v_add_u32 v124, v124, v125

    buffer_store_dwordx2 v[118:119], v124, s[24:27], 0 offen
L_skw_34:
    s_bitcmp0_b32 s28, 1
    s_cbranch_scc1 L_skw_35
    v_add_u32 v107, 32768, v2
    ds_read_b64 v[110:111], v107 offset:32784
    ds_read_b64 v[112:113], v107 offset:32792
    ds_read_b64 v[114:115], v107 offset:32776

    ds_read_b64 v[118:119], v107 offset:40976
    ds_read_b64 v[120:121], v107 offset:40984
    ds_read_b64 v[122:123], v107 offset:40968

    s_waitcnt lgkmcnt(3)
    v_lshrrev_b32 v116, 16, v111
    ds_read_b32 v116, v116 offset:8192

    s_waitcnt lgkmcnt(1)
    v_lshrrev_b32 v124, 16, v119
    ds_read_b32 v124, v124 offset:8192

    v_cmp_ne_u32_sdwa s[80:81], v111, v113 src0_sel:WORD_1 src1_sel:WORD_1
    v_cmp_ne_u32_sdwa vcc, v111, v115 src0_sel:WORD_1 src1_sel:WORD_1
    v_alignbyte_b32 v114, v115, v114, 2
    s_mov_b32 s54, 30717
    v_alignbyte_b32 v111, v111, v110, 1
    v_perm_b32 v110, v110, v114, s47
    s_waitcnt lgkmcnt(1)
    v_add3_u32 v116, v116, v106, s54
    v_sub_u32 v117, 0, v116
    v_and_b32 v117, 3, v117
    s_mov_b64 exec, s[80:81]
    v_mov_b32 v117, 0
    v_mov_b32 v112, 0
    s_mov_b64 exec, vcc
    v_mov_b32 v117, 3

    s_mov_b64 exec, -1
    v_alignbyte_b32 v110, v111, v110, v117
    v_alignbyte_b32 v111, v112, v111, v117
    v_add_u32 v116, v116, v117

    buffer_store_dwordx2 v[110:111], v116, s[24:27], 0 offen
    v_cmp_ne_u32_sdwa s[80:81], v119, v121 src0_sel:WORD_1 src1_sel:WORD_1
    v_cmp_ne_u32_sdwa vcc, v119, v123 src0_sel:WORD_1 src1_sel:WORD_1
    v_alignbyte_b32 v122, v123, v122, 2
    s_mov_b32 s54, 35837
    v_alignbyte_b32 v119, v119, v118, 1
    v_perm_b32 v118, v118, v122, s47
    s_waitcnt lgkmcnt(0)
    v_add3_u32 v124, v124, v106, s54
    v_sub_u32 v125, 0, v124
    v_and_b32 v125, 3, v125
    s_mov_b64 exec, s[80:81]
    v_mov_b32 v125, 0
    v_mov_b32 v120, 0
    s_mov_b64 exec, vcc
    v_mov_b32 v125, 3

    s_mov_b64 exec, -1
    v_alignbyte_b32 v118, v119, v118, v125
    v_alignbyte_b32 v119, v120, v119, v125
    v_add_u32 v124, v124, v125

    buffer_store_dwordx2 v[118:119], v124, s[24:27], 0 offen
L_skw_35:
    s_bitcmp0_b32 s28, 2
    s_cbranch_scc1 L_skw_36
    v_add_u32 v107, 65536, v2
    ds_read_b64 v[110:111], v107 offset:16400
    ds_read_b64 v[112:113], v107 offset:16408
    ds_read_b64 v[114:115], v107 offset:16392

    ds_read_b64 v[118:119], v107 offset:24592
    ds_read_b64 v[120:121], v107 offset:24600
    ds_read_b64 v[122:123], v107 offset:24584

    s_waitcnt lgkmcnt(3)
    v_lshrrev_b32 v116, 16, v111
    ds_read_b32 v116, v116 offset:8192

    s_waitcnt lgkmcnt(1)
    v_lshrrev_b32 v124, 16, v119
    ds_read_b32 v124, v124 offset:8192

    v_cmp_ne_u32_sdwa s[80:81], v111, v113 src0_sel:WORD_1 src1_sel:WORD_1
    v_cmp_ne_u32_sdwa vcc, v111, v115 src0_sel:WORD_1 src1_sel:WORD_1
    v_alignbyte_b32 v114, v115, v114, 2
    s_mov_b32 s54, 40957
    v_alignbyte_b32 v111, v111, v110, 1
    v_perm_b32 v110, v110, v114, s47
    s_waitcnt lgkmcnt(1)
    v_add3_u32 v116, v116, v106, s54
    v_sub_u32 v117, 0, v116
    v_and_b32 v117, 3, v117
    s_mov_b64 exec, s[80:81]
    v_mov_b32 v117, 0
    v_mov_b32 v112, 0
    s_mov_b64 exec, vcc
    v_mov_b32 v117, 3

    s_mov_b64 exec, -1
    v_alignbyte_b32 v110, v111, v110, v117
    v_alignbyte_b32 v111, v112, v111, v117
    v_add_u32 v116, v116, v117

    buffer_store_dwordx2 v[110:111], v116, s[24:27], 0 offen
    v_cmp_ne_u32_sdwa s[80:81], v119, v121 src0_sel:WORD_1 src1_sel:WORD_1
    v_cmp_ne_u32_sdwa vcc, v119, v123 src0_sel:WORD_1 src1_sel:WORD_1
    v_alignbyte_b32 v122, v123, v122, 2
    s_mov_b32 s54, 46077
    v_alignbyte_b32 v119, v119, v118, 1
    v_perm_b32 v118, v118, v122, s47
    s_waitcnt lgkmcnt(0)
    v_add3_u32 v124, v124, v106, s54
    v_sub_u32 v125, 0, v124
    v_and_b32 v125, 3, v125
    s_mov_b64 exec, s[80:81]
    v_mov_b32 v125, 0
    v_mov_b32 v120, 0
    s_mov_b64 exec, vcc
    v_mov_b32 v125, 3

    s_mov_b64 exec, -1
    v_alignbyte_b32 v118, v119, v118, v125
    v_alignbyte_b32 v119, v120, v119, v125
    v_add_u32 v124, v124, v125

    buffer_store_dwordx2 v[118:119], v124, s[24:27], 0 offen
L_skw_36:
    s_bitcmp0_b32 s82, 3
    s_cbranch_scc1 L_ska_37
    s_mov_b64 exec, s[66:67]
    v_mul_hi_u32_u24 v69, s40, v32
    v_mul_hi_u32_u24 v68, s40, v16
    v_mul_hi_u32_u24 v71, s40, v33
    v_mul_hi_u32_u24 v70, s40, v17
    v_mul_hi_u32_u24 v73, s40, v34
    v_mul_hi_u32_u24 v72, s40, v18
    v_mul_hi_u32_u24 v75, s40, v35
    v_mul_hi_u32_u24 v74, s40, v19
    v_and_b32 v69, -2, v69
    v_mad_u32_u24 v16, v68, s43, v16
    v_and_b32 v88, -4, v68
    v_and_b32 v71, -2, v71
    v_mad_u32_u24 v17, v70, s43, v17
    v_and_b32 v89, -4, v70
    v_and_b32 v73, -2, v73
    v_mad_u32_u24 v18, v72, s43, v18
    v_and_b32 v90, -4, v72
    v_and_b32 v75, -2, v75
    v_mad_u32_u24 v19, v74, s43, v19
    v_and_b32 v91, -4, v74
    v_mad_i32_i24 v32, v69, s42, v32
    v_lshl_add_u32 v69, v88, 5, v69
    v_mad_i32_i24 v33, v71, s42, v33
    v_lshl_add_u32 v71, v89, 5, v71
    v_mad_i32_i24 v34, v73, s42, v34
    v_lshl_add_u32 v73, v90, 5, v73
    v_mad_i32_i24 v35, v75, s42, v35
    v_lshl_add_u32 v75, v91, 5, v75
    v_add_u32 v69, v69, v69
    ds_add_rtn_u32 v88, v69, v104
    v_add_u32 v71, v71, v71
    ds_add_rtn_u32 v89, v71, v104
    v_add_u32 v73, v73, v73
    ds_add_rtn_u32 v90, v73, v104
    v_add_u32 v75, v75, v75
    ds_add_rtn_u32 v91, v75, v104
    v_lshlrev_b32 v110, 16, v42
    v_and_b32 v111, 0xffff0000, v42
    v_lshlrev_b32 v112, 16, v43
    v_and_b32 v113, 0xffff0000, v43
    v_mul_f32 v110, s44, v110
    v_mul_f32 v111, s44, v111
    v_mul_f32 v112, s44, v112
    v_mul_f32 v113, s44, v113
    v_fract_f32 v110, v110
    v_fract_f32 v111, v111
    v_fract_f32 v112, v112
    v_fract_f32 v113, v113
    v_cos_f32 v110, v110
    v_cos_f32 v111, v111
    v_cos_f32 v112, v112
    v_cos_f32 v113, v113
    v_lshl_or_b32 v68, v68, 14, v32
    v_perm_b32 v69, v69, v16, s46
    v_bfe_u32 v16, v16, 8, 5

    v_lshl_or_b32 v70, v70, 14, v33
    v_perm_b32 v71, v71, v17, s46
    v_bfe_u32 v17, v17, 8, 5

    v_lshl_or_b32 v72, v72, 14, v34
    v_perm_b32 v73, v73, v18, s46
    v_bfe_u32 v18, v18, 8, 5

    v_lshl_or_b32 v74, v74, 14, v35
    v_perm_b32 v75, v75, v19, s46
    v_bfe_u32 v19, v19, 8, 5

    v_fmaak_f32 v110, v110, v105, 0x4b400010
    v_fmaak_f32 v111, v111, v105, 0x4b400010
    v_fmaak_f32 v112, v112, v105, 0x4b400010
    v_fmaak_f32 v113, v113, v105, 0x4b400010
    v_sub_u32 v110, v110, v16
    v_sub_u32 v111, v111, v17
    v_sub_u32 v112, v112, v18
    v_sub_u32 v113, v113, v19
    v_bfi_b32 v110, 31, v16, v110
    v_bfi_b32 v111, 31, v17, v111
    v_bfi_b32 v112, 31, v18, v112
    v_bfi_b32 v113, 31, v19, v113
    v_perm_b32 v68, v68, v110, s55
    v_perm_b32 v70, v70, v111, s55
    v_perm_b32 v72, v72, v112, s55
    v_perm_b32 v74, v74, v113, s55
    s_mov_b64 exec, -1
L_ska_37:
    s_bitcmp0_b32 s28, 2
    s_cbranch_scc1 L_skw_38
    v_add_u32 v107, 65536, v2
    ds_read_b64 v[110:111], v107 offset:32784
    ds_read_b64 v[112:113], v107 offset:32792
    ds_read_b64 v[114:115], v107 offset:32776

    ds_read_b64 v[118:119], v107 offset:40976
    ds_read_b64 v[120:121], v107 offset:40984
    ds_read_b64 v[122:123], v107 offset:40968

    s_waitcnt lgkmcnt(3)
    v_lshrrev_b32 v116, 16, v111
    ds_read_b32 v116, v116 offset:8192

    s_waitcnt lgkmcnt(1)
    v_lshrrev_b32 v124, 16, v119
    ds_read_b32 v124, v124 offset:8192

    v_cmp_ne_u32_sdwa s[80:81], v111, v113 src0_sel:WORD_1 src1_sel:WORD_1
    v_cmp_ne_u32_sdwa vcc, v111, v115 src0_sel:WORD_1 src1_sel:WORD_1
    v_alignbyte_b32 v114, v115, v114, 2
    s_mov_b32 s54, 51197
    v_alignbyte_b32 v111, v111, v110, 1
    v_perm_b32 v110, v110, v114, s47
    s_waitcnt lgkmcnt(1)
    v_add3_u32 v116, v116, v106, s54
    v_sub_u32 v117, 0, v116
    v_and_b32 v117, 3, v117
    s_mov_b64 exec, s[80:81]
    v_mov_b32 v117, 0
    v_mov_b32 v112, 0
    s_mov_b64 exec, vcc
    v_mov_b32 v117, 3

    s_mov_b64 exec, -1
    v_alignbyte_b32 v110, v111, v110, v117
    v_alignbyte_b32 v111, v112, v111, v117
    v_add_u32 v116, v116, v117

    buffer_store_dwordx2 v[110:111], v116, s[24:27], 0 offen
    v_cmp_ne_u32_sdwa s[80:81], v119, v121 src0_sel:WORD_1 src1_sel:WORD_1
    v_cmp_ne_u32_sdwa vcc, v119, v123 src0_sel:WORD_1 src1_sel:WORD_1
    v_alignbyte_b32 v122, v123, v122, 2
    s_mov_b32 s54, 56317
    v_alignbyte_b32 v119, v119, v118, 1
    v_perm_b32 v118, v118, v122, s47
    s_waitcnt lgkmcnt(0)
    v_add3_u32 v124, v124, v106, s54
    v_sub_u32 v125, 0, v124
    v_and_b32 v125, 3, v125
    s_mov_b64 exec, s[80:81]
    v_mov_b32 v125, 0
    v_mov_b32 v120, 0
    s_mov_b64 exec, vcc
    v_mov_b32 v125, 3

    s_mov_b64 exec, -1
    v_alignbyte_b32 v118, v119, v118, v125
    v_alignbyte_b32 v119, v120, v119, v125
    v_add_u32 v124, v124, v125

    buffer_store_dwordx2 v[118:119], v124, s[24:27], 0 offen
L_skw_38:
    s_bitcmp0_b32 s28, 3
    s_cbranch_scc1 L_skw_39
    v_add_u32 v107, 98304, v2
    ds_read_b64 v[110:111], v107 offset:16400
    ds_read_b64 v[112:113], v107 offset:16408
    ds_read_b64 v[114:115], v107 offset:16392

    ds_read_b64 v[118:119], v107 offset:24592
    ds_read_b64 v[120:121], v107 offset:24600
    ds_read_b64 v[122:123], v107 offset:24584

    s_waitcnt lgkmcnt(3)
    v_lshrrev_b32 v116, 16, v111
    ds_read_b32 v116, v116 offset:8192

    s_waitcnt lgkmcnt(1)
    v_lshrrev_b32 v124, 16, v119
    ds_read_b32 v124, v124 offset:8192

    v_cmp_ne_u32_sdwa s[80:81], v111, v113 src0_sel:WORD_1 src1_sel:WORD_1
    v_cmp_ne_u32_sdwa vcc, v111, v115 src0_sel:WORD_1 src1_sel:WORD_1
    v_alignbyte_b32 v114, v115, v114, 2
    s_mov_b32 s54, 61437
    v_alignbyte_b32 v111, v111, v110, 1
    v_perm_b32 v110, v110, v114, s47
    s_waitcnt lgkmcnt(1)
    v_add3_u32 v116, v116, v106, s54
    v_sub_u32 v117, 0, v116
    v_and_b32 v117, 3, v117
    s_mov_b64 exec, s[80:81]
    v_mov_b32 v117, 0
    v_mov_b32 v112, 0
    s_mov_b64 exec, vcc
    v_mov_b32 v117, 3

    s_mov_b64 exec, -1
    v_alignbyte_b32 v110, v111, v110, v117
    v_alignbyte_b32 v111, v112, v111, v117
    v_add_u32 v116, v116, v117

    buffer_store_dwordx2 v[110:111], v116, s[24:27], 0 offen
    v_cmp_ne_u32_sdwa s[80:81], v119, v121 src0_sel:WORD_1 src1_sel:WORD_1
    v_cmp_ne_u32_sdwa vcc, v119, v123 src0_sel:WORD_1 src1_sel:WORD_1
    v_alignbyte_b32 v122, v123, v122, 2
    s_mov_b32 s54, 66557
    v_alignbyte_b32 v119, v119, v118, 1
    v_perm_b32 v118, v118, v122, s47
    s_waitcnt lgkmcnt(0)
    v_add3_u32 v124, v124, v106, s54
    v_sub_u32 v125, 0, v124
    v_and_b32 v125, 3, v125
    s_mov_b64 exec, s[80:81]
    v_mov_b32 v125, 0
    v_mov_b32 v120, 0
    s_mov_b64 exec, vcc
    v_mov_b32 v125, 3

    s_mov_b64 exec, -1
    v_alignbyte_b32 v118, v119, v118, v125
    v_alignbyte_b32 v119, v120, v119, v125
    v_add_u32 v124, v124, v125

    buffer_store_dwordx2 v[118:119], v124, s[24:27], 0 offen
L_skw_39:
    s_bitcmp0_b32 s28, 3
    s_cbranch_scc1 L_skw_40
    v_add_u32 v107, 98304, v2
    ds_read_b64 v[110:111], v107 offset:32784
    ds_read_b64 v[112:113], v107 offset:32792
    ds_read_b64 v[114:115], v107 offset:32776

    ds_read_b64 v[118:119], v107 offset:40976
    ds_read_b64 v[120:121], v107 offset:40984
    ds_read_b64 v[122:123], v107 offset:40968

    s_waitcnt lgkmcnt(3)
    v_lshrrev_b32 v116, 16, v111
    ds_read_b32 v116, v116 offset:8192

    s_waitcnt lgkmcnt(1)
    v_lshrrev_b32 v124, 16, v119
    ds_read_b32 v124, v124 offset:8192

    v_cmp_ne_u32_sdwa s[80:81], v111, v113 src0_sel:WORD_1 src1_sel:WORD_1
    v_cmp_ne_u32_sdwa vcc, v111, v115 src0_sel:WORD_1 src1_sel:WORD_1
    v_alignbyte_b32 v114, v115, v114, 2
    s_mov_b32 s54, 71677
    v_alignbyte_b32 v111, v111, v110, 1
    v_perm_b32 v110, v110, v114, s47
    s_waitcnt lgkmcnt(1)
    v_add3_u32 v116, v116, v106, s54
    v_sub_u32 v117, 0, v116
    v_and_b32 v117, 3, v117
    s_mov_b64 exec, s[80:81]
    v_mov_b32 v117, 0
    v_mov_b32 v112, 0
    s_mov_b64 exec, vcc
    v_mov_b32 v117, 3

    s_mov_b64 exec, -1
    v_alignbyte_b32 v110, v111, v110, v117
    v_alignbyte_b32 v111, v112, v111, v117
    v_add_u32 v116, v116, v117

    buffer_store_dwordx2 v[110:111], v116, s[24:27], 0 offen
    v_cmp_ne_u32_sdwa s[80:81], v119, v121 src0_sel:WORD_1 src1_sel:WORD_1
    v_cmp_ne_u32_sdwa vcc, v119, v123 src0_sel:WORD_1 src1_sel:WORD_1
    v_alignbyte_b32 v122, v123, v122, 2
    s_mov_b32 s54, 76797
    v_alignbyte_b32 v119, v119, v118, 1
    v_perm_b32 v118, v118, v122, s47
    s_waitcnt lgkmcnt(0)
    v_add3_u32 v124, v124, v106, s54
    v_sub_u32 v125, 0, v124
    v_and_b32 v125, 3, v125
    s_mov_b64 exec, s[80:81]
    v_mov_b32 v125, 0
    v_mov_b32 v120, 0
    s_mov_b64 exec, vcc
    v_mov_b32 v125, 3

    s_andn2_b64 exec, -1, s[68:69]
    v_bfrev_b32 v124, 1
    s_mov_b64 exec, -1
    v_alignbyte_b32 v118, v119, v118, v125
    v_alignbyte_b32 v119, v120, v119, v125
    v_add_u32 v124, v124, v125

    buffer_store_dwordx2 v[118:119], v124, s[24:27], 0 offen
L_skw_40:
    s_waitcnt lgkmcnt(0)
    s_barrier

    buffer_load_dwordx4 v[20:23], v1, s[12:15], s56 offen nt
    buffer_load_dwordx4 v[4:7], v1, s[8:11], s56 offen nt
    buffer_load_dwordx2 v[36:37], v2, s[16:19], s61 offen nt
    ds_read_b64 v[94:95], v2
    s_waitcnt lgkmcnt(0)
    v_and_b32 v94, 0xffff, v94
    v_and_b32 v95, 0xffff, v95
    v_add_u32 v97, v94, v95
    s_nop 1
    v_add_u32_dpp v97, v97, v97 row_shr:1 row_mask:0xf bank_mask:0xf
    s_nop 1
    v_add_u32_dpp v97, v97, v97 row_shr:2 row_mask:0xf bank_mask:0xf
    s_nop 1
    v_add_u32_dpp v97, v97, v97 row_shr:4 row_mask:0xf bank_mask:0xf
    s_nop 1
    v_add_u32_dpp v97, v97, v97 row_shr:8 row_mask:0xf bank_mask:0xf
    s_nop 1
    v_add_u32_dpp v97, v97, v97 row_bcast:15 row_mask:0xa bank_mask:0xf
    s_nop 1
    v_add_u32_dpp v97, v97, v97 row_bcast:31 row_mask:0xc bank_mask:0xf
    s_mov_b32 exec_lo, 0
    s_brev_b32 exec_hi, 1
    ds_add_rtn_u32 v96, v108, v97
    s_mov_b64 exec, -1

    v_add_u32 v92, v94, v94
    v_add_u32 v93, v95, v95
    v_med3_u32 v92, v94, 2, v92
    v_med3_u32 v93, v95, 2, v93
    buffer_atomic_add_x2 v[92:93], v2, s[20:23], 0 offen sc0
    s_waitcnt lgkmcnt(0)
    v_readlane_b32 s77, v96, 63
    v_mul_u32_u24 v114, 7936, v0
    v_sub_u32 v97, v97, v95
    s_sub_u32 s50, s50, s83
    s_sub_u32 s77, s77, s50
    v_add_u32 v97, s77, v97
    v_sub_u32 v96, v97, v94
    v_lshlrev_b32 v111, 16, v97
    v_lshlrev_b32 v110, 16, v96
    ds_write_b64 v2, v[110:111]
    v_sub_u32 v96, v114, v96
    v_sub_u32 v97, v114, v97
    v_add_u32 v97, s48, v97
    s_add_u32 s50, s50, s84
    s_mov_b32 s28, s82
    s_mov_b32 s29, s83
    s_mov_b32 s30, s84
    s_lshl_b32 s74, s29, 3
    s_lshl_b32 s75, s30, 3
    v_mov_b32 v125, s74
    v_mov_b32 v126, s75
    v_mov_b32 v127, -1

    s_waitcnt lgkmcnt(0)
    s_barrier

    s_mov_b64 exec, 1
    ds_write_b32 v125, v127 offset:16396
    ds_write_b32 v126, v127 offset:16404
    s_mov_b64 exec, -1

    buffer_load_dwordx4 v[24:27], v1, s[12:15], s57 offen nt
    buffer_load_dwordx4 v[8:11], v1, s[8:11], s57 offen nt
    buffer_load_dwordx2 v[38:39], v2, s[16:19], s62 offen nt
    s_bitcmp0_b32 s28, 0
    s_cbranch_scc1 L_skz_41
    v_lshrrev_b32 v110, 16, v45
    ds_read_b32 v110, v110
    v_lshrrev_b32 v111, 16, v47
    ds_read_b32 v111, v111
    v_lshrrev_b32 v112, 16, v49
    ds_read_b32 v112, v112
    v_lshrrev_b32 v113, 16, v51
    ds_read_b32 v113, v113
    v_lshrrev_b32 v114, 16, v53
    ds_read_b32 v114, v114
    v_lshrrev_b32 v115, 16, v55
    ds_read_b32 v115, v115
    v_lshrrev_b32 v116, 16, v57
    ds_read_b32 v116, v116
    v_lshrrev_b32 v117, 16, v59
    ds_read_b32 v117, v117
    s_waitcnt lgkmcnt(7)
    v_add_u32_sdwa v110, v110, v76 dst_sel:DWORD dst_unused:UNUSED_PAD src0_sel:WORD_1 src1_sel:WORD_0
    v_lshlrev_b32 v110, 3, v110
    ds_write_b64 v110, v[44:45] offset:16400

    s_waitcnt lgkmcnt(7)
    v_add_u32_sdwa v111, v111, v77 dst_sel:DWORD dst_unused:UNUSED_PAD src0_sel:WORD_1 src1_sel:WORD_0
    v_lshlrev_b32 v111, 3, v111
    ds_write_b64 v111, v[46:47] offset:16400

    s_waitcnt lgkmcnt(7)
    v_add_u32_sdwa v112, v112, v78 dst_sel:DWORD dst_unused:UNUSED_PAD src0_sel:WORD_1 src1_sel:WORD_0
    v_lshlrev_b32 v112, 3, v112
    ds_write_b64 v112, v[48:49] offset:16400

    s_waitcnt lgkmcnt(7)
    v_add_u32_sdwa v113, v113, v79 dst_sel:DWORD dst_unused:UNUSED_PAD src0_sel:WORD_1 src1_sel:WORD_0
    v_lshlrev_b32 v113, 3, v113
    ds_write_b64 v113, v[50:51] offset:16400

    s_waitcnt lgkmcnt(7)
    v_add_u32_sdwa v114, v114, v80 dst_sel:DWORD dst_unused:UNUSED_PAD src0_sel:WORD_1 src1_sel:WORD_0
    v_lshlrev_b32 v114, 3, v114
    ds_write_b64 v114, v[52:53] offset:16400

    s_waitcnt lgkmcnt(7)
    v_add_u32_sdwa v115, v115, v81 dst_sel:DWORD dst_unused:UNUSED_PAD src0_sel:WORD_1 src1_sel:WORD_0
    v_lshlrev_b32 v115, 3, v115
    ds_write_b64 v115, v[54:55] offset:16400

    s_waitcnt lgkmcnt(7)
    v_add_u32_sdwa v116, v116, v82 dst_sel:DWORD dst_unused:UNUSED_PAD src0_sel:WORD_1 src1_sel:WORD_0
    v_lshlrev_b32 v116, 3, v116
    ds_write_b64 v116, v[56:57] offset:16400

    s_waitcnt lgkmcnt(7)
    v_add_u32_sdwa v117, v117, v83 dst_sel:DWORD dst_unused:UNUSED_PAD src0_sel:WORD_1 src1_sel:WORD_0
    v_lshlrev_b32 v117, 3, v117
    ds_write_b64 v117, v[58:59] offset:16400

L_skz_41:
    buffer_load_dwordx4 v[28:31], v1, s[12:15], s58 offen nt
    buffer_load_dwordx4 v[12:15], v1, s[8:11], s58 offen nt
    buffer_load_dwordx2 v[40:41], v2, s[16:19], s63 offen nt
    s_bitcmp0_b32 s28, 2
    s_cbranch_scc1 L_skz_42
    v_lshrrev_b32 v110, 16, v61
    ds_read_b32 v110, v110
    v_lshrrev_b32 v111, 16, v63
    ds_read_b32 v111, v111
    v_lshrrev_b32 v112, 16, v65
    ds_read_b32 v112, v112
    v_lshrrev_b32 v113, 16, v67
    ds_read_b32 v113, v113
    s_waitcnt lgkmcnt(3)
    v_add_u32_sdwa v110, v110, v84 dst_sel:DWORD dst_unused:UNUSED_PAD src0_sel:WORD_1 src1_sel:WORD_0
    v_lshlrev_b32 v110, 3, v110
    ds_write_b64 v110, v[60:61] offset:16400

    s_waitcnt lgkmcnt(3)
    v_add_u32_sdwa v111, v111, v85 dst_sel:DWORD dst_unused:UNUSED_PAD src0_sel:WORD_1 src1_sel:WORD_0
    v_lshlrev_b32 v111, 3, v111
    ds_write_b64 v111, v[62:63] offset:16400

    s_waitcnt lgkmcnt(3)
    v_add_u32_sdwa v112, v112, v86 dst_sel:DWORD dst_unused:UNUSED_PAD src0_sel:WORD_1 src1_sel:WORD_0
    v_lshlrev_b32 v112, 3, v112
    ds_write_b64 v112, v[64:65] offset:16400

    s_waitcnt lgkmcnt(3)
    v_add_u32_sdwa v113, v113, v87 dst_sel:DWORD dst_unused:UNUSED_PAD src0_sel:WORD_1 src1_sel:WORD_0
    v_lshlrev_b32 v113, 3, v113
    ds_write_b64 v113, v[66:67] offset:16400

L_skz_42:
    s_bitcmp0_b32 s28, 3
    s_cbranch_scc1 L_skz_43
    s_mov_b64 exec, s[66:67]
    v_lshrrev_b32 v110, 16, v69
    ds_read_b32 v110, v110
    v_lshrrev_b32 v111, 16, v71
    ds_read_b32 v111, v111
    v_lshrrev_b32 v112, 16, v73
    ds_read_b32 v112, v112
    v_lshrrev_b32 v113, 16, v75
    ds_read_b32 v113, v113
    s_waitcnt lgkmcnt(3)
    v_add_u32_sdwa v110, v110, v88 dst_sel:DWORD dst_unused:UNUSED_PAD src0_sel:WORD_1 src1_sel:WORD_0
    v_lshlrev_b32 v110, 3, v110
    ds_write_b64 v110, v[68:69] offset:16400

    s_waitcnt lgkmcnt(3)
    v_add_u32_sdwa v111, v111, v89 dst_sel:DWORD dst_unused:UNUSED_PAD src0_sel:WORD_1 src1_sel:WORD_0
    v_lshlrev_b32 v111, 3, v111
    ds_write_b64 v111, v[70:71] offset:16400

    s_waitcnt lgkmcnt(3)
    v_add_u32_sdwa v112, v112, v90 dst_sel:DWORD dst_unused:UNUSED_PAD src0_sel:WORD_1 src1_sel:WORD_0
    v_lshlrev_b32 v112, 3, v112
    ds_write_b64 v112, v[72:73] offset:16400

    s_waitcnt lgkmcnt(3)
    v_add_u32_sdwa v113, v113, v91 dst_sel:DWORD dst_unused:UNUSED_PAD src0_sel:WORD_1 src1_sel:WORD_0
    v_lshlrev_b32 v113, 3, v113
    ds_write_b64 v113, v[74:75] offset:16400

    s_mov_b64 exec, -1
L_skz_43:
    buffer_load_dwordx4 v[32:35], v1, s[12:15], s59 offen nt
    buffer_load_dwordx4 v[16:19], v1, s[8:11], s59 offen nt
    buffer_load_dwordx2 v[42:43], v2, s[16:19], s64 offen nt
    s_cmp_lg_u32 s49, 0
    s_cbranch_scc1 L_p1loop_5
L_p1epi_6:
    s_waitcnt vmcnt(0)
    s_waitcnt vmcnt(0)
    v_add_u32 v110, v92, v94
    v_min_u32 v92, s48, v92
    v_add_u32 v111, v93, v95
    v_min_u32 v93, s48, v93
    v_max_u32 v110, v110, v111
    v_add_u32 v92, v92, v96
    v_add_u32 v93, v93, v97
    v_cmp_le_u32 vcc, s48, v110
    v_lshl_add_u32 v92, v92, 2, v92
    v_lshl_add_u32 v93, v93, 2, v93
    ds_write_b64 v2, v[92:93] offset:8192
    s_cbranch_vccz L_noov_44
    ds_write_b32 v108, v104 offset:4
L_noov_44:

    s_waitcnt lgkmcnt(0)
    s_barrier
    ds_read_b32 v110, v108 offset:4
    s_waitcnt lgkmcnt(0)
    v_readfirstlane_b32 s53, v110
    s_nop 1

    s_cmp_lg_u32 s53, 0
    s_cbranch_scc1 L_slow_45
L_sback_46:
    s_bitcmp0_b32 s28, 0
    s_cbranch_scc1 L_skw_50
    ds_read_b64 v[4:5], v2 offset:16400
    ds_read_b64 v[6:7], v2 offset:16408
    ds_read_b64 v[8:9], v2 offset:16392

    ds_read_b64 v[12:13], v2 offset:24592
    ds_read_b64 v[14:15], v2 offset:24600
    ds_read_b64 v[16:17], v2 offset:24584

    ds_read_b64 v[20:21], v2 offset:32784
    ds_read_b64 v[22:23], v2 offset:32792
    ds_read_b64 v[24:25], v2 offset:32776

    ds_read_b64 v[28:29], v2 offset:40976
    ds_read_b64 v[30:31], v2 offset:40984
    ds_read_b64 v[32:33], v2 offset:40968

    s_waitcnt lgkmcnt(9)
    v_lshrrev_b32 v10, 16, v5
    ds_read_b32 v10, v10 offset:8192

    s_waitcnt lgkmcnt(7)
    v_lshrrev_b32 v18, 16, v13
    ds_read_b32 v18, v18 offset:8192

    s_waitcnt lgkmcnt(5)
    v_lshrrev_b32 v26, 16, v21
    ds_read_b32 v26, v26 offset:8192

    s_waitcnt lgkmcnt(3)
    v_lshrrev_b32 v34, 16, v29
    ds_read_b32 v34, v34 offset:8192

    v_cmp_ne_u32_sdwa s[80:81], v5, v7 src0_sel:WORD_1 src1_sel:WORD_1
    v_cmp_ne_u32_sdwa vcc, v5, v9 src0_sel:WORD_1 src1_sel:WORD_1
    v_alignbyte_b32 v8, v9, v8, 2
    s_mov_b32 s54, -3
    v_alignbyte_b32 v5, v5, v4, 1
    v_perm_b32 v4, v4, v8, s47
    s_waitcnt lgkmcnt(3)
    v_add3_u32 v10, v10, v106, s54
    v_sub_u32 v11, 0, v10
    v_and_b32 v11, 3, v11
    s_mov_b64 exec, s[80:81]
    v_mov_b32 v11, 0
    v_mov_b32 v6, 0
    s_mov_b64 exec, vcc
    v_mov_b32 v11, 3

    s_mov_b64 exec, -1
    v_alignbyte_b32 v4, v5, v4, v11
    v_alignbyte_b32 v5, v6, v5, v11
    v_add_u32 v10, v10, v11

    buffer_store_dwordx2 v[4:5], v10, s[24:27], 0 offen
    v_cmp_ne_u32_sdwa s[80:81], v13, v15 src0_sel:WORD_1 src1_sel:WORD_1
    v_cmp_ne_u32_sdwa vcc, v13, v17 src0_sel:WORD_1 src1_sel:WORD_1
    v_alignbyte_b32 v16, v17, v16, 2
    s_mov_b32 s54, 5117
    v_alignbyte_b32 v13, v13, v12, 1
    v_perm_b32 v12, v12, v16, s47
    s_waitcnt lgkmcnt(2)
    v_add3_u32 v18, v18, v106, s54
    v_sub_u32 v19, 0, v18
    v_and_b32 v19, 3, v19
    s_mov_b64 exec, s[80:81]
    v_mov_b32 v19, 0
    v_mov_b32 v14, 0
    s_mov_b64 exec, vcc
    v_mov_b32 v19, 3

    s_mov_b64 exec, -1
    v_alignbyte_b32 v12, v13, v12, v19
    v_alignbyte_b32 v13, v14, v13, v19
    v_add_u32 v18, v18, v19

    buffer_store_dwordx2 v[12:13], v18, s[24:27], 0 offen
    v_cmp_ne_u32_sdwa s[80:81], v21, v23 src0_sel:WORD_1 src1_sel:WORD_1
    v_cmp_ne_u32_sdwa vcc, v21, v25 src0_sel:WORD_1 src1_sel:WORD_1
    v_alignbyte_b32 v24, v25, v24, 2
    s_mov_b32 s54, 10237
    v_alignbyte_b32 v21, v21, v20, 1
    v_perm_b32 v20, v20, v24, s47
    s_waitcnt lgkmcnt(1)
    v_add3_u32 v26, v26, v106, s54
    v_sub_u32 v27, 0, v26
    v_and_b32 v27, 3, v27
    s_mov_b64 exec, s[80:81]
    v_mov_b32 v27, 0
    v_mov_b32 v22, 0
    s_mov_b64 exec, vcc
    v_mov_b32 v27, 3

    s_mov_b64 exec, -1
    v_alignbyte_b32 v20, v21, v20, v27
    v_alignbyte_b32 v21, v22, v21, v27
    v_add_u32 v26, v26, v27

    buffer_store_dwordx2 v[20:21], v26, s[24:27], 0 offen
    v_cmp_ne_u32_sdwa s[80:81], v29, v31 src0_sel:WORD_1 src1_sel:WORD_1
    v_cmp_ne_u32_sdwa vcc, v29, v33 src0_sel:WORD_1 src1_sel:WORD_1
    v_alignbyte_b32 v32, v33, v32, 2
    s_mov_b32 s54, 15357
    v_alignbyte_b32 v29, v29, v28, 1
    v_perm_b32 v28, v28, v32, s47
    s_waitcnt lgkmcnt(0)
    v_add3_u32 v34, v34, v106, s54
    v_sub_u32 v35, 0, v34
    v_and_b32 v35, 3, v35
    s_mov_b64 exec, s[80:81]
    v_mov_b32 v35, 0
    v_mov_b32 v30, 0
    s_mov_b64 exec, vcc
    v_mov_b32 v35, 3

    s_mov_b64 exec, -1
    v_alignbyte_b32 v28, v29, v28, v35
    v_alignbyte_b32 v29, v30, v29, v35
    v_add_u32 v34, v34, v35

    buffer_store_dwordx2 v[28:29], v34, s[24:27], 0 offen
L_skw_50:
    s_bitcmp0_b32 s28, 1
    s_cbranch_scc1 L_skw_51
    v_add_u32 v107, 32768, v2
    ds_read_b64 v[4:5], v107 offset:16400
    ds_read_b64 v[6:7], v107 offset:16408
    ds_read_b64 v[8:9], v107 offset:16392

    ds_read_b64 v[12:13], v107 offset:24592
    ds_read_b64 v[14:15], v107 offset:24600
    ds_read_b64 v[16:17], v107 offset:24584

    ds_read_b64 v[20:21], v107 offset:32784
    ds_read_b64 v[22:23], v107 offset:32792
    ds_read_b64 v[24:25], v107 offset:32776

    ds_read_b64 v[28:29], v107 offset:40976
    ds_read_b64 v[30:31], v107 offset:40984
    ds_read_b64 v[32:33], v107 offset:40968

    s_waitcnt lgkmcnt(9)
    v_lshrrev_b32 v10, 16, v5
    ds_read_b32 v10, v10 offset:8192

    s_waitcnt lgkmcnt(7)
    v_lshrrev_b32 v18, 16, v13
    ds_read_b32 v18, v18 offset:8192

    s_waitcnt lgkmcnt(5)
    v_lshrrev_b32 v26, 16, v21
    ds_read_b32 v26, v26 offset:8192

    s_waitcnt lgkmcnt(3)
    v_lshrrev_b32 v34, 16, v29
    ds_read_b32 v34, v34 offset:8192

    v_cmp_ne_u32_sdwa s[80:81], v5, v7 src0_sel:WORD_1 src1_sel:WORD_1
    v_cmp_ne_u32_sdwa vcc, v5, v9 src0_sel:WORD_1 src1_sel:WORD_1
    v_alignbyte_b32 v8, v9, v8, 2
    s_mov_b32 s54, 20477
    v_alignbyte_b32 v5, v5, v4, 1
    v_perm_b32 v4, v4, v8, s47
    s_waitcnt lgkmcnt(3)
    v_add3_u32 v10, v10, v106, s54
    v_sub_u32 v11, 0, v10
    v_and_b32 v11, 3, v11
    s_mov_b64 exec, s[80:81]
    v_mov_b32 v11, 0
    v_mov_b32 v6, 0
    s_mov_b64 exec, vcc
    v_mov_b32 v11, 3

    s_mov_b64 exec, -1
    v_alignbyte_b32 v4, v5, v4, v11
    v_alignbyte_b32 v5, v6, v5, v11
    v_add_u32 v10, v10, v11

    buffer_store_dwordx2 v[4:5], v10, s[24:27], 0 offen
    v_cmp_ne_u32_sdwa s[80:81], v13, v15 src0_sel:WORD_1 src1_sel:WORD_1
    v_cmp_ne_u32_sdwa vcc, v13, v17 src0_sel:WORD_1 src1_sel:WORD_1
    v_alignbyte_b32 v16, v17, v16, 2
    s_mov_b32 s54, 25597
    v_alignbyte_b32 v13, v13, v12, 1
    v_perm_b32 v12, v12, v16, s47
    s_waitcnt lgkmcnt(2)
    v_add3_u32 v18, v18, v106, s54
    v_sub_u32 v19, 0, v18
    v_and_b32 v19, 3, v19
    s_mov_b64 exec, s[80:81]
    v_mov_b32 v19, 0
    v_mov_b32 v14, 0
    s_mov_b64 exec, vcc
    v_mov_b32 v19, 3

    s_mov_b64 exec, -1
    v_alignbyte_b32 v12, v13, v12, v19
    v_alignbyte_b32 v13, v14, v13, v19
    v_add_u32 v18, v18, v19

    buffer_store_dwordx2 v[12:13], v18, s[24:27], 0 offen
    v_cmp_ne_u32_sdwa s[80:81], v21, v23 src0_sel:WORD_1 src1_sel:WORD_1
    v_cmp_ne_u32_sdwa vcc, v21, v25 src0_sel:WORD_1 src1_sel:WORD_1
    v_alignbyte_b32 v24, v25, v24, 2
    s_mov_b32 s54, 30717
    v_alignbyte_b32 v21, v21, v20, 1
    v_perm_b32 v20, v20, v24, s47
    s_waitcnt lgkmcnt(1)
    v_add3_u32 v26, v26, v106, s54
    v_sub_u32 v27, 0, v26
    v_and_b32 v27, 3, v27
    s_mov_b64 exec, s[80:81]
    v_mov_b32 v27, 0
    v_mov_b32 v22, 0
    s_mov_b64 exec, vcc
    v_mov_b32 v27, 3

    s_mov_b64 exec, -1
    v_alignbyte_b32 v20, v21, v20, v27
    v_alignbyte_b32 v21, v22, v21, v27
    v_add_u32 v26, v26, v27

    buffer_store_dwordx2 v[20:21], v26, s[24:27], 0 offen
    v_cmp_ne_u32_sdwa s[80:81], v29, v31 src0_sel:WORD_1 src1_sel:WORD_1
    v_cmp_ne_u32_sdwa vcc, v29, v33 src0_sel:WORD_1 src1_sel:WORD_1
    v_alignbyte_b32 v32, v33, v32, 2
    s_mov_b32 s54, 35837
    v_alignbyte_b32 v29, v29, v28, 1
    v_perm_b32 v28, v28, v32, s47
    s_waitcnt lgkmcnt(0)
    v_add3_u32 v34, v34, v106, s54
    v_sub_u32 v35, 0, v34
    v_and_b32 v35, 3, v35
    s_mov_b64 exec, s[80:81]
    v_mov_b32 v35, 0
    v_mov_b32 v30, 0
    s_mov_b64 exec, vcc
    v_mov_b32 v35, 3

    s_mov_b64 exec, -1
    v_alignbyte_b32 v28, v29, v28, v35
    v_alignbyte_b32 v29, v30, v29, v35
    v_add_u32 v34, v34, v35

    buffer_store_dwordx2 v[28:29], v34, s[24:27], 0 offen
L_skw_51:
    s_bitcmp0_b32 s28, 2
    s_cbranch_scc1 L_skw_52
    v_add_u32 v107, 65536, v2
    ds_read_b64 v[4:5], v107 offset:16400
    ds_read_b64 v[6:7], v107 offset:16408
    ds_read_b64 v[8:9], v107 offset:16392

    ds_read_b64 v[12:13], v107 offset:24592
    ds_read_b64 v[14:15], v107 offset:24600
    ds_read_b64 v[16:17], v107 offset:24584

    ds_read_b64 v[20:21], v107 offset:32784
    ds_read_b64 v[22:23], v107 offset:32792
    ds_read_b64 v[24:25], v107 offset:32776

    ds_read_b64 v[28:29], v107 offset:40976
    ds_read_b64 v[30:31], v107 offset:40984
    ds_read_b64 v[32:33], v107 offset:40968

    s_waitcnt lgkmcnt(9)
    v_lshrrev_b32 v10, 16, v5
    ds_read_b32 v10, v10 offset:8192

    s_waitcnt lgkmcnt(7)
    v_lshrrev_b32 v18, 16, v13
    ds_read_b32 v18, v18 offset:8192

    s_waitcnt lgkmcnt(5)
    v_lshrrev_b32 v26, 16, v21
    ds_read_b32 v26, v26 offset:8192

    s_waitcnt lgkmcnt(3)
    v_lshrrev_b32 v34, 16, v29
    ds_read_b32 v34, v34 offset:8192

    v_cmp_ne_u32_sdwa s[80:81], v5, v7 src0_sel:WORD_1 src1_sel:WORD_1
    v_cmp_ne_u32_sdwa vcc, v5, v9 src0_sel:WORD_1 src1_sel:WORD_1
    v_alignbyte_b32 v8, v9, v8, 2
    s_mov_b32 s54, 40957
    v_alignbyte_b32 v5, v5, v4, 1
    v_perm_b32 v4, v4, v8, s47
    s_waitcnt lgkmcnt(3)
    v_add3_u32 v10, v10, v106, s54
    v_sub_u32 v11, 0, v10
    v_and_b32 v11, 3, v11
    s_mov_b64 exec, s[80:81]
    v_mov_b32 v11, 0
    v_mov_b32 v6, 0
    s_mov_b64 exec, vcc
    v_mov_b32 v11, 3

    s_mov_b64 exec, -1
    v_alignbyte_b32 v4, v5, v4, v11
    v_alignbyte_b32 v5, v6, v5, v11
    v_add_u32 v10, v10, v11

    buffer_store_dwordx2 v[4:5], v10, s[24:27], 0 offen
    v_cmp_ne_u32_sdwa s[80:81], v13, v15 src0_sel:WORD_1 src1_sel:WORD_1
    v_cmp_ne_u32_sdwa vcc, v13, v17 src0_sel:WORD_1 src1_sel:WORD_1
    v_alignbyte_b32 v16, v17, v16, 2
    s_mov_b32 s54, 46077
    v_alignbyte_b32 v13, v13, v12, 1
    v_perm_b32 v12, v12, v16, s47
    s_waitcnt lgkmcnt(2)
    v_add3_u32 v18, v18, v106, s54
    v_sub_u32 v19, 0, v18
    v_and_b32 v19, 3, v19
    s_mov_b64 exec, s[80:81]
    v_mov_b32 v19, 0
    v_mov_b32 v14, 0
    s_mov_b64 exec, vcc
    v_mov_b32 v19, 3

    s_mov_b64 exec, -1
    v_alignbyte_b32 v12, v13, v12, v19
    v_alignbyte_b32 v13, v14, v13, v19
    v_add_u32 v18, v18, v19

    buffer_store_dwordx2 v[12:13], v18, s[24:27], 0 offen
    v_cmp_ne_u32_sdwa s[80:81], v21, v23 src0_sel:WORD_1 src1_sel:WORD_1
    v_cmp_ne_u32_sdwa vcc, v21, v25 src0_sel:WORD_1 src1_sel:WORD_1
    v_alignbyte_b32 v24, v25, v24, 2
    s_mov_b32 s54, 51197
    v_alignbyte_b32 v21, v21, v20, 1
    v_perm_b32 v20, v20, v24, s47
    s_waitcnt lgkmcnt(1)
    v_add3_u32 v26, v26, v106, s54
    v_sub_u32 v27, 0, v26
    v_and_b32 v27, 3, v27
    s_mov_b64 exec, s[80:81]
    v_mov_b32 v27, 0
    v_mov_b32 v22, 0
    s_mov_b64 exec, vcc
    v_mov_b32 v27, 3

    s_mov_b64 exec, -1
    v_alignbyte_b32 v20, v21, v20, v27
    v_alignbyte_b32 v21, v22, v21, v27
    v_add_u32 v26, v26, v27

    buffer_store_dwordx2 v[20:21], v26, s[24:27], 0 offen
    v_cmp_ne_u32_sdwa s[80:81], v29, v31 src0_sel:WORD_1 src1_sel:WORD_1
    v_cmp_ne_u32_sdwa vcc, v29, v33 src0_sel:WORD_1 src1_sel:WORD_1
    v_alignbyte_b32 v32, v33, v32, 2
    s_mov_b32 s54, 56317
    v_alignbyte_b32 v29, v29, v28, 1
    v_perm_b32 v28, v28, v32, s47
    s_waitcnt lgkmcnt(0)
    v_add3_u32 v34, v34, v106, s54
    v_sub_u32 v35, 0, v34
    v_and_b32 v35, 3, v35
    s_mov_b64 exec, s[80:81]
    v_mov_b32 v35, 0
    v_mov_b32 v30, 0
    s_mov_b64 exec, vcc
    v_mov_b32 v35, 3

    s_mov_b64 exec, -1
    v_alignbyte_b32 v28, v29, v28, v35
    v_alignbyte_b32 v29, v30, v29, v35
    v_add_u32 v34, v34, v35

    buffer_store_dwordx2 v[28:29], v34, s[24:27], 0 offen
L_skw_52:
    s_bitcmp0_b32 s28, 3
    s_cbranch_scc1 L_skw_53
    v_add_u32 v107, 98304, v2
    ds_read_b64 v[4:5], v107 offset:16400
    ds_read_b64 v[6:7], v107 offset:16408
    ds_read_b64 v[8:9], v107 offset:16392

    ds_read_b64 v[12:13], v107 offset:24592
    ds_read_b64 v[14:15], v107 offset:24600
    ds_read_b64 v[16:17], v107 offset:24584

    ds_read_b64 v[20:21], v107 offset:32784
    ds_read_b64 v[22:23], v107 offset:32792
    ds_read_b64 v[24:25], v107 offset:32776

    ds_read_b64 v[28:29], v107 offset:40976
    ds_read_b64 v[30:31], v107 offset:40984
    ds_read_b64 v[32:33], v107 offset:40968

    s_waitcnt lgkmcnt(9)
    v_lshrrev_b32 v10, 16, v5
    ds_read_b32 v10, v10 offset:8192

    s_waitcnt lgkmcnt(7)
    v_lshrrev_b32 v18, 16, v13
    ds_read_b32 v18, v18 offset:8192

    s_waitcnt lgkmcnt(5)
    v_lshrrev_b32 v26, 16, v21
    ds_read_b32 v26, v26 offset:8192

    s_waitcnt lgkmcnt(3)
    v_lshrrev_b32 v34, 16, v29
    ds_read_b32 v34, v34 offset:8192

    v_cmp_ne_u32_sdwa s[80:81], v5, v7 src0_sel:WORD_1 src1_sel:WORD_1
    v_cmp_ne_u32_sdwa vcc, v5, v9 src0_sel:WORD_1 src1_sel:WORD_1
    v_alignbyte_b32 v8, v9, v8, 2
    s_mov_b32 s54, 61437
    v_alignbyte_b32 v5, v5, v4, 1
    v_perm_b32 v4, v4, v8, s47
    s_waitcnt lgkmcnt(3)
    v_add3_u32 v10, v10, v106, s54
    v_sub_u32 v11, 0, v10
    v_and_b32 v11, 3, v11
    s_mov_b64 exec, s[80:81]
    v_mov_b32 v11, 0
    v_mov_b32 v6, 0
    s_mov_b64 exec, vcc
    v_mov_b32 v11, 3

    s_mov_b64 exec, -1
    v_alignbyte_b32 v4, v5, v4, v11
    v_alignbyte_b32 v5, v6, v5, v11
    v_add_u32 v10, v10, v11

    buffer_store_dwordx2 v[4:5], v10, s[24:27], 0 offen
    v_cmp_ne_u32_sdwa s[80:81], v13, v15 src0_sel:WORD_1 src1_sel:WORD_1
    v_cmp_ne_u32_sdwa vcc, v13, v17 src0_sel:WORD_1 src1_sel:WORD_1
    v_alignbyte_b32 v16, v17, v16, 2
    s_mov_b32 s54, 66557
    v_alignbyte_b32 v13, v13, v12, 1
    v_perm_b32 v12, v12, v16, s47
    s_waitcnt lgkmcnt(2)
    v_add3_u32 v18, v18, v106, s54
    v_sub_u32 v19, 0, v18
    v_and_b32 v19, 3, v19
    s_mov_b64 exec, s[80:81]
    v_mov_b32 v19, 0
    v_mov_b32 v14, 0
    s_mov_b64 exec, vcc
    v_mov_b32 v19, 3

    s_mov_b64 exec, -1
    v_alignbyte_b32 v12, v13, v12, v19
    v_alignbyte_b32 v13, v14, v13, v19
    v_add_u32 v18, v18, v19

    buffer_store_dwordx2 v[12:13], v18, s[24:27], 0 offen
    v_cmp_ne_u32_sdwa s[80:81], v21, v23 src0_sel:WORD_1 src1_sel:WORD_1
    v_cmp_ne_u32_sdwa vcc, v21, v25 src0_sel:WORD_1 src1_sel:WORD_1
    v_alignbyte_b32 v24, v25, v24, 2
    s_mov_b32 s54, 71677
    v_alignbyte_b32 v21, v21, v20, 1
    v_perm_b32 v20, v20, v24, s47
    s_waitcnt lgkmcnt(1)
    v_add3_u32 v26, v26, v106, s54
    v_sub_u32 v27, 0, v26
    v_and_b32 v27, 3, v27
    s_mov_b64 exec, s[80:81]
    v_mov_b32 v27, 0
    v_mov_b32 v22, 0
    s_mov_b64 exec, vcc
    v_mov_b32 v27, 3

    s_mov_b64 exec, -1
    v_alignbyte_b32 v20, v21, v20, v27
    v_alignbyte_b32 v21, v22, v21, v27
    v_add_u32 v26, v26, v27

    buffer_store_dwordx2 v[20:21], v26, s[24:27], 0 offen
    v_cmp_ne_u32_sdwa s[80:81], v29, v31 src0_sel:WORD_1 src1_sel:WORD_1
    v_cmp_ne_u32_sdwa vcc, v29, v33 src0_sel:WORD_1 src1_sel:WORD_1
    v_alignbyte_b32 v32, v33, v32, 2
    s_mov_b32 s54, 76797
    v_alignbyte_b32 v29, v29, v28, 1
    v_perm_b32 v28, v28, v32, s47
    s_waitcnt lgkmcnt(0)
    v_add3_u32 v34, v34, v106, s54
    v_sub_u32 v35, 0, v34
    v_and_b32 v35, 3, v35
    s_mov_b64 exec, s[80:81]
    v_mov_b32 v35, 0
    v_mov_b32 v30, 0
    s_mov_b64 exec, vcc
    v_mov_b32 v35, 3

    s_andn2_b64 exec, -1, s[68:69]
    v_bfrev_b32 v34, 1
    s_mov_b64 exec, -1
    v_alignbyte_b32 v28, v29, v28, v35
    v_alignbyte_b32 v29, v30, v29, v35
    v_add_u32 v34, v34, v35

    buffer_store_dwordx2 v[28:29], v34, s[24:27], 0 offen
L_skw_53:
L_p1done_1:
    s_endpgm

L_ska_7:
    v_bfrev_b32 v126, 1
    buffer_load_dword v3, v126, s[96:99], 0 offen
    buffer_load_dword v3, v126, s[96:99], 0 offen
    buffer_load_dword v3, v126, s[96:99], 0 offen
    s_branch L_bka_8
L_ska_9:
    v_bfrev_b32 v126, 1
    buffer_load_dword v3, v126, s[96:99], 0 offen
    buffer_load_dword v3, v126, s[96:99], 0 offen
    buffer_load_dword v3, v126, s[96:99], 0 offen
    s_branch L_bka_10
L_ska_11:
    v_bfrev_b32 v126, 1
    buffer_load_dword v3, v126, s[96:99], 0 offen
    buffer_load_dword v3, v126, s[96:99], 0 offen
    buffer_load_dword v3, v126, s[96:99], 0 offen
    s_branch L_bka_12
L_ska_13:
    v_bfrev_b32 v126, 1
    buffer_load_dword v3, v126, s[96:99], 0 offen
    buffer_load_dword v3, v126, s[96:99], 0 offen
    buffer_load_dword v3, v126, s[96:99], 0 offen
    s_branch L_bka_14
L_slow_26:
    v_add_u32 v112, s29, v0
    v_mov_b32 v118, 0
    s_mov_b32 s75, 4960
L_sl_28:
    v_lshlrev_b32 v113, 3, v112
    ds_read_b64 v[110:111], v113 offset:16400
    ds_read_b32 v119, v113 offset:16412
    ds_read_b32 v120, v113 offset:16396
    s_waitcnt lgkmcnt(0)
    v_lshrrev_b32 v114, 16, v111
    ds_read_b32 v115, v114 offset:8192
    v_add_u32 v114, 4, v114
    v_mul_u32_u24 v114, s75, v114
    s_waitcnt lgkmcnt(0)
    v_mad_u32_u24 v115, v112, 5, v115
    v_cmp_gt_u32 s[72:73], s30, v112
    v_cmp_ge_u32 vcc, v115, v114
    s_and_b64 s[80:81], vcc, s[72:73]
    s_cbranch_scc0 L_s1_29
    s_bcnt1_i32_b64 s76, s[80:81]
    v_mbcnt_lo_u32_b32 v117, s80, 0
    v_mbcnt_hi_u32_b32 v117, s81, v117
    v_mov_b32 v116, s76
    s_mov_b64 exec, 1
    buffer_atomic_add v116, v118, s[36:39], 0 offen sc0
    s_waitcnt vmcnt(0)
    v_readfirstlane_b32 s76, v116
    s_mov_b64 exec, s[80:81]
    s_nop 0
    v_add_lshl_u32 v116, v117, s76, 3
    buffer_store_dwordx2 v[110:111], v116, s[32:35], 0 offen
L_s1_29:
    s_andn2_b64 exec, s[72:73], vcc
    s_cbranch_execz L_s2_30
    buffer_store_dword v110, v115, s[24:27], 0 offen
    buffer_store_byte v111, v115, s[24:27], 0 offen offset:4
    v_add_u32 v115, 5, v115
    v_cmpx_lt_u32 vcc, v115, v114
    v_cmpx_ne_u32_sdwa vcc, v111, v119 src0_sel:WORD_1 src1_sel:WORD_1
    v_cmpx_ne_u32_sdwa vcc, v111, v120 src0_sel:WORD_1 src1_sel:WORD_1
    s_cbranch_execz L_s2_30
    buffer_store_dword v118, v115, s[24:27], 0 offen
L_s2_30:
    s_mov_b64 exec, -1
    v_add_u32 v112, 1024, v112
    s_nop 0
    v_readfirstlane_b32 s76, v112
    s_nop 1
    s_cmp_lt_u32 s76, s30
    s_cbranch_scc1 L_sl_28
    s_mov_b32 s28, 0
    s_branch L_sback_27

L_slow_45:
    v_add_u32 v112, s29, v0
    v_mov_b32 v118, 0
    s_mov_b32 s75, 4960
L_sl_47:
    v_lshlrev_b32 v113, 3, v112
    ds_read_b64 v[110:111], v113 offset:16400
    ds_read_b32 v119, v113 offset:16412
    ds_read_b32 v120, v113 offset:16396
    s_waitcnt lgkmcnt(0)
    v_lshrrev_b32 v114, 16, v111
    ds_read_b32 v115, v114 offset:8192
    v_add_u32 v114, 4, v114
    v_mul_u32_u24 v114, s75, v114
    s_waitcnt lgkmcnt(0)
    v_mad_u32_u24 v115, v112, 5, v115
    v_cmp_gt_u32 s[72:73], s30, v112
    v_cmp_ge_u32 vcc, v115, v114
    s_and_b64 s[80:81], vcc, s[72:73]
    s_cbranch_scc0 L_s1_48
    s_bcnt1_i32_b64 s76, s[80:81]
    v_mbcnt_lo_u32_b32 v117, s80, 0
    v_mbcnt_hi_u32_b32 v117, s81, v117
    v_mov_b32 v116, s76
    s_mov_b64 exec, 1
    buffer_atomic_add v116, v118, s[36:39], 0 offen sc0
    s_waitcnt vmcnt(0)
    v_readfirstlane_b32 s76, v116
    s_mov_b64 exec, s[80:81]
    s_nop 0
    v_add_lshl_u32 v116, v117, s76, 3
    buffer_store_dwordx2 v[110:111], v116, s[32:35], 0 offen
L_s1_48:
    s_andn2_b64 exec, s[72:73], vcc
    s_cbranch_execz L_s2_49
    buffer_store_dword v110, v115, s[24:27], 0 offen
    buffer_store_byte v111, v115, s[24:27], 0 offen offset:4
    v_add_u32 v115, 5, v115
    v_cmpx_lt_u32 vcc, v115, v114
    v_cmpx_ne_u32_sdwa vcc, v111, v119 src0_sel:WORD_1 src1_sel:WORD_1
    v_cmpx_ne_u32_sdwa vcc, v111, v120 src0_sel:WORD_1 src1_sel:WORD_1
    s_cbranch_execz L_s2_49
    buffer_store_dword v118, v115, s[24:27], 0 offen
L_s2_49:
    s_mov_b64 exec, -1
    v_add_u32 v112, 1024, v112
    s_nop 0
    v_readfirstlane_b32 s76, v112
    s_nop 1
    s_cmp_lt_u32 s76, s30
    s_cbranch_scc1 L_sl_47
    s_mov_b32 s28, 0
    s_branch L_sback_46

.globl standalone__molecular_angular_gemnet__graph_kernel
.p2align 8
.type standalone__molecular_angular_gemnet__graph_kernel,@function
standalone__molecular_angular_gemnet__graph_kernel:
    s_cmp_ge_u32 s2, 256
    s_cbranch_scc1 L_p2done_54
    s_load_dwordx2 s[8:9], s[0:1], 0
    s_load_dwordx2 s[6:7], s[0:1], 104
    v_lshrrev_b32 v4, 6, v0
    s_lshr_b32 s37, s2, 1
    s_and_b32 s37, s37, 3
    s_lshr_b32 s36, s2, 3
    s_lshl_b32 s36, s36, 1
    s_and_b32 s3, s2, 1
    s_or_b32 s36, s36, s3
    v_readfirstlane_b32 s4, v4
    v_and_b32 v2, 63, v0
    v_lshrrev_b32 v3, 9, v0
    v_lshl_or_b32 v2, v3, 6, v2
    v_mul_u32_u24 v2, 20, v2
    v_lshlrev_b32 v3, 4, v0

    s_waitcnt lgkmcnt(0)
    s_lshl_b32 m0, s4, 10
    s_and_b32 s5, s4, 7
    s_lshr_b32 s39, s4, 3
    s_lshl_b32 s39, s39, 8
    s_mul_i32 s3, s5, 8192
    s_add_u32 s46, s6, s3
    s_addc_u32 s47, s7, 0
    s_mul_i32 s3, s5, 40632320
    s_add_u32 s3, s3, 83599360
    s_add_u32 s44, s6, s3
    s_addc_u32 s45, s7, 0
    s_mul_i32 s38, s37, 8
    s_add_u32 s4, s38, 8
    s_lshl_b32 s3, s38, 6
    s_add_u32 s3, s3, s36
    s_lshl_b32 s3, s3, 2
    s_add_u32 s52, s46, s3
    s_addc_u32 s53, s47, 0

    s_load_dword s88, s[52:53], 0
    s_load_dword s89, s[52:53], 256
    s_load_dword s90, s[52:53], 512
    s_load_dword s91, s[52:53], 768
    s_load_dword s92, s[52:53], 1024
    s_load_dword s93, s[52:53], 1280
    s_load_dword s94, s[52:53], 1536
    s_load_dword s95, s[52:53], 1792
    s_mov_b32 s3, 65536
    s_load_dword s51, s[6:7], s3
    s_mov_b32 s10, 6400000
    s_mov_b32 s11, 0x20000

    s_add_u32 s12, s6, 393216
    s_addc_u32 s13, s7, 0
    s_mov_b32 s14, 0
    s_mov_b32 s15, 0x20000
    s_add_u32 s60, s6, 393216
    s_addc_u32 s61, s7, 0
    s_mov_b32 s62, 6406144
    s_mov_b32 s63, 0x20000
    s_mov_b32 s3, 135176
    s_load_dword s33, s[6:7], s3

    s_mul_i32 s43, s38, 200192
    s_mul_i32 s41, s4, 200192
    s_mul_i32 s50, s38, 200000
    s_add_u32 s14, s43, 50000

    buffer_load_dwordx4 v[76:79], v3, s[12:15], s43 offen
    s_add_u32 s52, s43, 16384
    buffer_load_dwordx4 v[80:83], v3, s[12:15], s52 offen
    s_add_u32 s52, s43, 32768
    buffer_load_dwordx4 v[84:87], v3, s[12:15], s52 offen
    s_add_u32 s52, s43, 49152
    v_lshlrev_b32 v119, 2, v0
    buffer_load_dword v88, v119, s[12:15], s52 offen
    s_add_u32 s20, s6, 135168
    s_addc_u32 s21, s7, 0
    s_mov_b32 s22, 4096
    s_mov_b32 s23, 0x20000
    v_and_b32 v44, 63, v0
    v_lshlrev_b32 v44, 4, v44
    buffer_load_dwordx2 v[120:121], v44, s[20:23], 0 offen offset:0
    buffer_load_dwordx2 v[122:123], v44, s[20:23], 0 offen offset:1024
    buffer_load_dwordx2 v[124:125], v44, s[20:23], 0 offen offset:2048
    buffer_load_dwordx2 v[126:127], v44, s[20:23], 0 offen offset:3072
    s_movk_i32 s40, 3072
    s_mov_b32 s19, 0x20000
    s_min_u32 s40, s40, 3968
    s_lshl_b32 s52, s38, 6
    s_add_u32 s52, s52, s36
    s_mul_i32 s52, s52, 19840
    s_add_u32 s16, s44, s52
    s_addc_u32 s17, s45, 0
    s_mul_i32 s52, s40, 5
    s_add_u32 s52, s52, 3
    s_and_b32 s18, s52, -4

    s_movk_i32 s53, 5120
    buffer_load_dwordx4 v[90:93], v2, s[16:19], s53 offen
    buffer_load_dword v110, v2, s[16:19], s53 offen offset:16
    s_movk_i32 s53, 7680
    buffer_load_dwordx4 v[94:97], v2, s[16:19], s53 offen
    buffer_load_dword v111, v2, s[16:19], s53 offen offset:16
    s_movk_i32 s53, 10240
    buffer_load_dwordx4 v[98:101], v2, s[16:19], s53 offen
    buffer_load_dword v112, v2, s[16:19], s53 offen offset:16
    s_lshr_b32 s3, s2, 3
    s_mul_i32 s3, s3, 49
    v_add_lshl_u32 v89, v0, s3, 7
    v_cmp_gt_u32 vcc, 49, v0
    v_bfrev_b32 v28, 1
    s_nop 0
    v_cndmask_b32 v89, v28, v89, vcc

    s_mov_b32 s19, 0x20000
    s_mov_b32 s28, 0x4b404000
    s_mov_b32 s29, 0x4b404000
    s_mov_b32 s30, 0xbfffc000
    s_mov_b32 s31, 0xbfffbfff
    s_mov_b32 s32, 0xffff0000
    s_mov_b32 s35, 0x05040100
    s_mov_b32 s97, 0x07060302
    s_mov_b32 s96, 0x40008000
    s_movk_i32 s3, 212
    v_cmp_gt_u32 s[48:49], s3, v0

    v_mov_b32 v1, 0
    s_mov_b32 s24, 0xc0c0004
    s_mov_b32 s25, 0xc0c0105
    s_mov_b32 s26, 0xc0c0206
    s_mov_b32 s27, 0xc0c0307
    v_mov_b32 v28, 0x40004000
    v_mov_b32 v29, 0x40004000
    v_mov_b32 v30, 0x40004000
    v_mov_b32 v31, 0x40004000
    v_add_u32 v32, 50000, v3
    v_add_u32 v33, 65536, v32

    ds_write_b128 v32, v[28:31] offset:0
    ds_write_b128 v32, v[28:31] offset:16384
    ds_write_b128 v32, v[28:31] offset:32768
    ds_write_b128 v32, v[28:31] offset:49152
    ds_write_b128 v33, v[28:31] offset:0
    ds_write_b128 v33, v[28:31] offset:16384
    v_cmp_gt_u32 vcc, 971, v0
    s_mov_b64 exec, vcc
    ds_write_b128 v33, v[28:31] offset:32768
    s_mov_b64 exec, -1
    s_waitcnt vmcnt(13)
    ds_write_addtid_b32 v76 offset:0
    ds_write_addtid_b32 v77 offset:256
    ds_write_addtid_b32 v78 offset:512
    ds_write_addtid_b32 v79 offset:768
    s_waitcnt vmcnt(12)
    ds_write_addtid_b32 v80 offset:16384
    ds_write_addtid_b32 v81 offset:16640
    ds_write_addtid_b32 v82 offset:16896
    ds_write_addtid_b32 v83 offset:17152
    s_waitcnt vmcnt(11)
    ds_write_addtid_b32 v84 offset:32768
    ds_write_addtid_b32 v85 offset:33024
    ds_write_addtid_b32 v86 offset:33280
    ds_write_addtid_b32 v87 offset:33536
    v_lshlrev_b32 v119, 2, v0
    s_waitcnt vmcnt(10)
    s_mov_b64 exec, s[48:49]
    ds_write_b32 v119, v88 offset:49152
    s_mov_b64 exec, -1
    s_add_u32 s43, s43, 50048
    s_add_u32 s14, s43, 50000
    s_min_u32 s14, s14, s41
    s_waitcnt lgkmcnt(0)
    s_waitcnt vmcnt(6)
    v_max3_u32 v120, v120, v122, v124
    v_add_f32 v121, v121, v123
    v_add_f32 v125, v125, v127
    v_max_u32 v120, v120, v126
    v_add_f32 v121, v121, v125

    s_nop 1
    v_max_u32_dpp v120, v120, v120 row_shr:1 row_mask:0xf bank_mask:0xf
    s_nop 1
    v_max_u32_dpp v120, v120, v120 row_shr:2 row_mask:0xf bank_mask:0xf
    s_nop 1
    v_max_u32_dpp v120, v120, v120 row_shr:4 row_mask:0xf bank_mask:0xf
    s_nop 1
    v_max_u32_dpp v120, v120, v120 row_shr:8 row_mask:0xf bank_mask:0xf
    s_nop 1
    v_max_u32_dpp v120, v120, v120 row_bcast:15 row_mask:0xa bank_mask:0xf
    s_nop 1
    v_max_u32_dpp v120, v120, v120 row_bcast:31 row_mask:0xc bank_mask:0xf
    s_nop 1
    v_add_f32_dpp v121, v121, v121 row_shr:1 row_mask:0xf bank_mask:0xf
    s_nop 1
    v_add_f32_dpp v121, v121, v121 row_shr:2 row_mask:0xf bank_mask:0xf
    s_nop 1
    v_add_f32_dpp v121, v121, v121 row_shr:4 row_mask:0xf bank_mask:0xf
    s_nop 1
    v_add_f32_dpp v121, v121, v121 row_shr:8 row_mask:0xf bank_mask:0xf
    s_nop 1
    v_add_f32_dpp v121, v121, v121 row_bcast:15 row_mask:0xa bank_mask:0xf
    s_nop 1
    v_add_f32_dpp v121, v121, v121 row_bcast:31 row_mask:0xc bank_mask:0xf
    v_lshlrev_b32 v120, 16, v120
    v_mul_f32 v121, 0x34a7c5ac, v121
    v_sqrt_f32 v121, v121
    v_mul_f32 v120, s33, v120
    v_mul_f32 v121, s33, v121
    v_cmp_gt_f32 vcc, 0x46fde800, v120
    s_mov_b64 s[64:65], vcc
    v_cmp_lt_f32 vcc, 0x44000000, v121
    v_mov_b32 v120, 0x37800000
    v_mul_f32 v120, s33, v120
    s_and_b64 vcc, vcc, s[64:65]
    v_mul_f32 v121, 0x46ff8000, v120
    v_rcp_f32 v121, v121
    v_readfirstlane_b32 s33, v120
    s_waitcnt lgkmcnt(0)
    s_barrier
    v_readfirstlane_b32 s34, v121
    v_mov_b32 v120, 150016
    v_mov_b32 v121, 0
    ds_write_b32 v120, v121 offset:8
    s_bitcmp0_b64 vcc, 63
    s_cbranch_scc1 L_p2slow_55
    s_cmp_lg_u32 s51, 0
    s_cbranch_scc1 L_p2slow_55

    s_min_u32 s88, s88, 3968
    s_lshl_b32 s52, s38, 6
    s_add_u32 s52, s52, s36
    s_mul_i32 s52, s52, 19840
    s_add_u32 s16, s44, s52
    s_addc_u32 s17, s45, 0
    s_mul_i32 s52, s88, 5
    s_add_u32 s52, s52, 3
    s_and_b32 s18, s52, -4

    s_movk_i32 s53, 12800
    buffer_load_dwordx4 v[102:105], v2, s[16:19], s53 offen
    buffer_load_dword v113, v2, s[16:19], s53 offen offset:16
    s_movk_i32 s53, 0
    buffer_load_dwordx4 v[4:7], v2, s[16:19], s53 offen
    buffer_load_dword v35, v2, s[16:19], s53 offen offset:16
    s_movk_i32 s53, 2560
    buffer_load_dwordx4 v[8:11], v2, s[16:19], s53 offen
    buffer_load_dword v43, v2, s[16:19], s53 offen offset:16
    s_movk_i32 s53, 15360
    buffer_load_dwordx4 v[106:109], v2, s[16:19], s53 offen
    buffer_load_dword v114, v2, s[16:19], s53 offen offset:16
    s_mov_b32 s40, s88
    s_sub_u32 s42, s40, s39

    s_add_u32 s55, s38, 1
    s_min_u32 s55, s55, 31
    s_mov_b32 s88, s89
    s_mov_b32 s89, s90
    s_mov_b32 s90, s91
    s_mov_b32 s91, s92
    s_mov_b32 s92, s93
    s_mov_b32 s93, s94
    s_mov_b32 s94, s95
    s_mov_b32 s95, 0
    s_min_u32 s88, s88, 3968
    s_lshl_b32 s52, s55, 6
    s_add_u32 s52, s52, s36
    s_mul_i32 s52, s52, 19840
    s_add_u32 s16, s44, s52
    s_addc_u32 s17, s45, 0
    s_mul_i32 s52, s88, 5
    s_add_u32 s52, s52, 3
    s_and_b32 s18, s52, -4

    s_waitcnt vmcnt(12)
    v_perm_b32 v44, v91, v90, s24
    v_perm_b32 v46, v92, v91, s25
    v_perm_b32 v48, v93, v92, s26
    v_perm_b32 v50, v110, v93, s27
    v_mov_b32 v12, v90
    v_alignbyte_b32 v13, v92, v91, 1
    v_alignbyte_b32 v14, v93, v92, 2
    v_alignbyte_b32 v15, v110, v93, 3
    v_lshlrev_b32_sdwa v44, 3, v44 dst_sel:WORD_0 dst_unused:UNUSED_PAD src0_sel:DWORD src1_sel:DWORD
    v_lshlrev_b32_sdwa v46, 3, v46 dst_sel:WORD_0 dst_unused:UNUSED_PAD src0_sel:DWORD src1_sel:DWORD
    v_lshlrev_b32_sdwa v48, 3, v48 dst_sel:WORD_0 dst_unused:UNUSED_PAD src0_sel:DWORD src1_sel:DWORD
    v_lshlrev_b32_sdwa v50, 3, v50 dst_sel:WORD_0 dst_unused:UNUSED_PAD src0_sel:DWORD src1_sel:DWORD
    s_cmp_lt_i32 s42, 1280
    s_cbranch_scc1 L_ufix_56
L_uback_57:

    v_subrev_co_u32 v12, s[80:81], 2.0, v12
    v_subrev_co_u32 v13, s[82:83], 2.0, v13
    v_subrev_co_u32 v14, s[84:85], 2.0, v14
    v_subrev_co_u32 v15, s[86:87], 2.0, v15
    s_mov_b64 exec, s[80:81]
    ds_read_b64 v[44:45], v44
    s_mov_b64 exec, s[82:83]
    ds_read_b64 v[46:47], v46
    s_mov_b64 exec, s[84:85]
    ds_read_b64 v[48:49], v48
    s_mov_b64 exec, s[86:87]
    ds_read_b64 v[50:51], v50
    s_mov_b64 exec, -1
    s_waitcnt vmcnt(10)
    v_perm_b32 v52, v95, v94, s24
    v_perm_b32 v54, v96, v95, s25
    v_perm_b32 v56, v97, v96, s26
    v_perm_b32 v58, v111, v97, s27
    v_mov_b32 v16, v94
    v_alignbyte_b32 v17, v96, v95, 1
    v_alignbyte_b32 v18, v97, v96, 2
    v_alignbyte_b32 v19, v111, v97, 3
    v_lshlrev_b32_sdwa v52, 3, v52 dst_sel:WORD_0 dst_unused:UNUSED_PAD src0_sel:DWORD src1_sel:DWORD
    v_lshlrev_b32_sdwa v54, 3, v54 dst_sel:WORD_0 dst_unused:UNUSED_PAD src0_sel:DWORD src1_sel:DWORD
    v_lshlrev_b32_sdwa v56, 3, v56 dst_sel:WORD_0 dst_unused:UNUSED_PAD src0_sel:DWORD src1_sel:DWORD
    v_lshlrev_b32_sdwa v58, 3, v58 dst_sel:WORD_0 dst_unused:UNUSED_PAD src0_sel:DWORD src1_sel:DWORD
    s_cmp_lt_i32 s42, 1792
    s_cbranch_scc1 L_ufix_58
L_uback_59:

    v_subrev_co_u32 v16, s[64:65], 2.0, v16
    v_subrev_co_u32 v17, s[66:67], 2.0, v17
    v_subrev_co_u32 v18, s[68:69], 2.0, v18
    v_subrev_co_u32 v19, s[70:71], 2.0, v19
    s_mov_b64 exec, s[64:65]
    ds_read_b64 v[52:53], v52
    s_mov_b64 exec, s[66:67]
    ds_read_b64 v[54:55], v54
    s_mov_b64 exec, s[68:69]
    ds_read_b64 v[56:57], v56
    s_mov_b64 exec, s[70:71]
    ds_read_b64 v[58:59], v58
    s_mov_b64 exec, -1
    s_waitcnt vmcnt(8)
    v_perm_b32 v60, v99, v98, s24
    v_perm_b32 v62, v100, v99, s25
    v_perm_b32 v64, v101, v100, s26
    v_perm_b32 v66, v112, v101, s27
    v_mov_b32 v20, v98
    v_alignbyte_b32 v21, v100, v99, 1
    v_alignbyte_b32 v22, v101, v100, 2
    v_alignbyte_b32 v23, v112, v101, 3
    v_lshlrev_b32_sdwa v60, 3, v60 dst_sel:WORD_0 dst_unused:UNUSED_PAD src0_sel:DWORD src1_sel:DWORD
    v_lshlrev_b32_sdwa v62, 3, v62 dst_sel:WORD_0 dst_unused:UNUSED_PAD src0_sel:DWORD src1_sel:DWORD
    v_lshlrev_b32_sdwa v64, 3, v64 dst_sel:WORD_0 dst_unused:UNUSED_PAD src0_sel:DWORD src1_sel:DWORD
    v_lshlrev_b32_sdwa v66, 3, v66 dst_sel:WORD_0 dst_unused:UNUSED_PAD src0_sel:DWORD src1_sel:DWORD
    s_cmp_lt_i32 s42, 2304
    s_cbranch_scc1 L_ufix_60
L_uback_61:

    v_subrev_co_u32 v20, s[72:73], 2.0, v20
    v_subrev_co_u32 v21, s[74:75], 2.0, v21
    v_subrev_co_u32 v22, s[76:77], 2.0, v22
    v_subrev_co_u32 v23, s[78:79], 2.0, v23
    s_mov_b64 exec, s[72:73]
    ds_read_b64 v[60:61], v60
    s_mov_b64 exec, s[74:75]
    ds_read_b64 v[62:63], v62
    s_mov_b64 exec, s[76:77]
    ds_read_b64 v[64:65], v64
    s_mov_b64 exec, s[78:79]
    ds_read_b64 v[66:67], v66
    s_mov_b64 exec, -1
    s_waitcnt vmcnt(6)
    v_perm_b32 v68, v103, v102, s24
    v_perm_b32 v70, v104, v103, s25
    v_perm_b32 v72, v105, v104, s26
    v_perm_b32 v74, v113, v105, s27
    v_mov_b32 v24, v102
    v_alignbyte_b32 v25, v104, v103, 1
    v_alignbyte_b32 v26, v105, v104, 2
    v_alignbyte_b32 v27, v113, v105, 3
    v_lshlrev_b32_sdwa v68, 3, v68 dst_sel:WORD_0 dst_unused:UNUSED_PAD src0_sel:DWORD src1_sel:DWORD
    v_lshlrev_b32_sdwa v70, 3, v70 dst_sel:WORD_0 dst_unused:UNUSED_PAD src0_sel:DWORD src1_sel:DWORD
    v_lshlrev_b32_sdwa v72, 3, v72 dst_sel:WORD_0 dst_unused:UNUSED_PAD src0_sel:DWORD src1_sel:DWORD
    v_lshlrev_b32_sdwa v74, 3, v74 dst_sel:WORD_0 dst_unused:UNUSED_PAD src0_sel:DWORD src1_sel:DWORD
    s_cmp_lt_i32 s42, 2816
    s_cbranch_scc1 L_ufix_62
L_uback_63:

    v_subrev_co_u32 v24, s[80:81], 2.0, v24
    v_subrev_co_u32 v25, s[82:83], 2.0, v25
    v_subrev_co_u32 v26, s[84:85], 2.0, v26
    v_subrev_co_u32 v27, s[86:87], 2.0, v27
    s_mov_b64 exec, s[80:81]
    ds_read_b64 v[68:69], v68
    s_mov_b64 exec, s[82:83]
    ds_read_b64 v[70:71], v70
    s_mov_b64 exec, s[84:85]
    ds_read_b64 v[72:73], v72
    s_mov_b64 exec, s[86:87]
    ds_read_b64 v[74:75], v74
    s_mov_b64 exec, -1
    s_waitcnt vmcnt(4)
    v_perm_b32 v28, v5, v4, s24
    v_perm_b32 v30, v6, v5, s25
    v_perm_b32 v32, v7, v6, s26
    v_perm_b32 v34, v35, v7, s27
    v_alignbyte_b32 v5, v6, v5, 1
    v_alignbyte_b32 v6, v7, v6, 2
    v_alignbyte_b32 v7, v35, v7, 3
    v_lshlrev_b32_sdwa v28, 3, v28 dst_sel:WORD_0 dst_unused:UNUSED_PAD src0_sel:DWORD src1_sel:DWORD
    v_lshlrev_b32_sdwa v30, 3, v30 dst_sel:WORD_0 dst_unused:UNUSED_PAD src0_sel:DWORD src1_sel:DWORD
    v_lshlrev_b32_sdwa v32, 3, v32 dst_sel:WORD_0 dst_unused:UNUSED_PAD src0_sel:DWORD src1_sel:DWORD
    v_lshlrev_b32_sdwa v34, 3, v34 dst_sel:WORD_0 dst_unused:UNUSED_PAD src0_sel:DWORD src1_sel:DWORD
    s_cmp_lt_i32 s42, 256
    s_cbranch_scc1 L_ufix_64
L_uback_65:

    v_subrev_co_u32 v4, s[64:65], 2.0, v4
    v_subrev_co_u32 v5, s[66:67], 2.0, v5
    v_subrev_co_u32 v6, s[68:69], 2.0, v6
    v_subrev_co_u32 v7, s[70:71], 2.0, v7
    s_mov_b64 exec, s[64:65]
    ds_read_b64 v[28:29], v28
    s_mov_b64 exec, s[66:67]
    ds_read_b64 v[30:31], v30
    s_mov_b64 exec, s[68:69]
    ds_read_b64 v[32:33], v32
    s_mov_b64 exec, s[70:71]
    ds_read_b64 v[34:35], v34
    s_mov_b64 exec, -1
    buffer_load_dwordx4 v[76:79], v3, s[12:15], s43 offen
    s_add_u32 s52, s43, 16384
    buffer_load_dwordx4 v[80:83], v3, s[12:15], s52 offen
    s_add_u32 s52, s43, 32768
    buffer_load_dwordx4 v[84:87], v3, s[12:15], s52 offen
    s_add_u32 s52, s43, 49152
    v_lshlrev_b32 v119, 2, v0
    buffer_load_dword v88, v119, s[12:15], s52 offen
    s_add_u32 s54, s43, 50048
    buffer_load_dword v115, v89, s[60:63], s54 offen
    s_add_u32 s54, s50, 0
    buffer_load_dword v115, v89, s[8:11], s54 offen
    s_waitcnt vmcnt(8)
    v_perm_b32 v36, v9, v8, s24
    v_perm_b32 v38, v10, v9, s25
    v_perm_b32 v40, v11, v10, s26
    v_perm_b32 v42, v43, v11, s27
    v_alignbyte_b32 v9, v10, v9, 1
    v_alignbyte_b32 v10, v11, v10, 2
    v_alignbyte_b32 v11, v43, v11, 3
    v_lshlrev_b32_sdwa v36, 3, v36 dst_sel:WORD_0 dst_unused:UNUSED_PAD src0_sel:DWORD src1_sel:DWORD
    v_lshlrev_b32_sdwa v38, 3, v38 dst_sel:WORD_0 dst_unused:UNUSED_PAD src0_sel:DWORD src1_sel:DWORD
    v_lshlrev_b32_sdwa v40, 3, v40 dst_sel:WORD_0 dst_unused:UNUSED_PAD src0_sel:DWORD src1_sel:DWORD
    v_lshlrev_b32_sdwa v42, 3, v42 dst_sel:WORD_0 dst_unused:UNUSED_PAD src0_sel:DWORD src1_sel:DWORD
    s_cmp_lt_i32 s42, 768
    s_cbranch_scc1 L_ufix_66
L_uback_67:

    v_subrev_co_u32 v8, s[72:73], 2.0, v8
    v_subrev_co_u32 v9, s[74:75], 2.0, v9
    v_subrev_co_u32 v10, s[76:77], 2.0, v10
    v_subrev_co_u32 v11, s[78:79], 2.0, v11
    s_mov_b64 exec, s[72:73]
    ds_read_b64 v[36:37], v36
    s_mov_b64 exec, s[74:75]
    ds_read_b64 v[38:39], v38
    s_mov_b64 exec, s[76:77]
    ds_read_b64 v[40:41], v40
    s_mov_b64 exec, s[78:79]
    ds_read_b64 v[42:43], v42
    s_mov_b64 exec, -1
    s_movk_i32 s53, 5120
    buffer_load_dwordx4 v[90:93], v2, s[16:19], s53 offen
    buffer_load_dword v110, v2, s[16:19], s53 offen offset:16
L_batch_68:
    s_add_u32 s5, s38, 1

    s_movk_i32 s53, 7680
    buffer_load_dwordx4 v[94:97], v2, s[16:19], s53 offen
    buffer_load_dword v111, v2, s[16:19], s53 offen offset:16
    v_subrev_co_u32 v4, s[64:65], 2.0, v4
    v_subrev_co_u32 v5, s[66:67], 2.0, v5
    v_subrev_co_u32 v6, s[68:69], 2.0, v6
    v_subrev_co_u32 v7, s[70:71], 2.0, v7
    v_subrev_co_u32 v8, s[72:73], 2.0, v8
    v_subrev_co_u32 v9, s[74:75], 2.0, v9
    v_subrev_co_u32 v10, s[76:77], 2.0, v10
    v_subrev_co_u32 v11, s[78:79], 2.0, v11
    v_subrev_co_u32 v12, s[80:81], 2.0, v12
    v_subrev_co_u32 v13, s[82:83], 2.0, v13
    v_subrev_co_u32 v14, s[84:85], 2.0, v14
    v_subrev_co_u32 v15, s[86:87], 2.0, v15
    s_waitcnt lgkmcnt(0)
    s_barrier
    s_waitcnt vmcnt(5)
    ds_write_addtid_b32 v76 offset:0
    ds_write_addtid_b32 v77 offset:256
    ds_write_addtid_b32 v78 offset:512
    ds_write_addtid_b32 v79 offset:768
    s_waitcnt vmcnt(4)
    ds_write_addtid_b32 v80 offset:16384
    ds_write_addtid_b32 v81 offset:16640
    ds_write_addtid_b32 v82 offset:16896
    ds_write_addtid_b32 v83 offset:17152
    s_waitcnt vmcnt(3)
    ds_write_addtid_b32 v84 offset:32768
    ds_write_addtid_b32 v85 offset:33024
    ds_write_addtid_b32 v86 offset:33280
    ds_write_addtid_b32 v87 offset:33536
    v_lshlrev_b32 v119, 2, v0
    s_waitcnt vmcnt(2)
    s_mov_b64 exec, s[48:49]
    ds_write_b32 v119, v88 offset:49152
    s_mov_b64 exec, -1
    s_add_u32 s43, s43, 50048
    s_add_u32 s14, s43, 50000
    s_min_u32 s14, s14, s41
    buffer_load_dwordx4 v[76:79], v3, s[12:15], s43 offen
    s_waitcnt lgkmcnt(0)
    s_barrier
    s_add_u32 s52, s43, 16384
    buffer_load_dwordx4 v[80:83], v3, s[12:15], s52 offen
    s_add_u32 s52, s43, 32768
    buffer_load_dwordx4 v[84:87], v3, s[12:15], s52 offen
    s_add_u32 s52, s43, 49152
    v_lshlrev_b32 v119, 2, v0
    buffer_load_dword v88, v119, s[12:15], s52 offen
    s_mov_b64 exec, s[64:65]
    ds_read_b64 v[28:29], v28
    s_mov_b64 exec, s[66:67]
    ds_read_b64 v[30:31], v30
    s_mov_b64 exec, s[68:69]
    ds_read_b64 v[32:33], v32
    s_mov_b64 exec, s[70:71]
    ds_read_b64 v[34:35], v34
    s_mov_b64 exec, s[72:73]
    ds_read_b64 v[36:37], v36
    s_mov_b64 exec, s[74:75]
    ds_read_b64 v[38:39], v38
    s_mov_b64 exec, s[76:77]
    ds_read_b64 v[40:41], v40
    s_mov_b64 exec, s[78:79]
    ds_read_b64 v[42:43], v42
    s_mov_b64 exec, s[80:81]
    ds_read_b64 v[44:45], v44
    s_mov_b64 exec, s[82:83]
    ds_read_b64 v[46:47], v46
    s_mov_b64 exec, s[84:85]
    ds_read_b64 v[48:49], v48
    s_mov_b64 exec, s[86:87]
    ds_read_b64 v[50:51], v50
    s_mov_b64 exec, -1
    v_subrev_co_u32 v16, s[64:65], 2.0, v16
    v_subrev_co_u32 v17, s[66:67], 2.0, v17
    v_subrev_co_u32 v18, s[68:69], 2.0, v18
    v_subrev_co_u32 v19, s[70:71], 2.0, v19
    v_subrev_co_u32 v20, s[72:73], 2.0, v20
    v_subrev_co_u32 v21, s[74:75], 2.0, v21
    v_subrev_co_u32 v22, s[76:77], 2.0, v22
    v_subrev_co_u32 v23, s[78:79], 2.0, v23
    v_subrev_co_u32 v24, s[80:81], 2.0, v24
    v_subrev_co_u32 v25, s[82:83], 2.0, v25
    v_subrev_co_u32 v26, s[84:85], 2.0, v26
    v_subrev_co_u32 v27, s[86:87], 2.0, v27
    s_mov_b64 exec, s[64:65]
    ds_read_b64 v[52:53], v52
    s_mov_b64 exec, s[66:67]
    ds_read_b64 v[54:55], v54
    s_mov_b64 exec, s[68:69]
    ds_read_b64 v[56:57], v56
    s_mov_b64 exec, s[70:71]
    ds_read_b64 v[58:59], v58
    s_mov_b64 exec, s[72:73]
    ds_read_b64 v[60:61], v60
    s_mov_b64 exec, s[74:75]
    ds_read_b64 v[62:63], v62
    s_mov_b64 exec, s[76:77]
    ds_read_b64 v[64:65], v64
    s_mov_b64 exec, s[78:79]
    ds_read_b64 v[66:67], v66
    s_mov_b64 exec, s[80:81]
    ds_read_b64 v[68:69], v68
    s_mov_b64 exec, s[82:83]
    ds_read_b64 v[70:71], v70
    s_mov_b64 exec, s[84:85]
    ds_read_b64 v[72:73], v72
    s_mov_b64 exec, s[86:87]
    ds_read_b64 v[74:75], v74
    s_mov_b64 exec, -1
    s_cmp_le_i32 s42, 3072
    s_cbranch_scc1 L_nt1_70
    s_waitcnt vmcnt(14)
    v_perm_b32 v120, v107, v106, s24
    v_perm_b32 v122, v108, v107, s25
    v_perm_b32 v124, v109, v108, s26
    v_perm_b32 v126, v114, v109, s27
    v_alignbyte_b32 v107, v108, v107, 1
    v_alignbyte_b32 v108, v109, v108, 2
    v_alignbyte_b32 v109, v114, v109, 3
    v_lshlrev_b32_sdwa v120, 3, v120 dst_sel:WORD_0 dst_unused:UNUSED_PAD src0_sel:DWORD src1_sel:DWORD
    v_lshlrev_b32_sdwa v122, 3, v122 dst_sel:WORD_0 dst_unused:UNUSED_PAD src0_sel:DWORD src1_sel:DWORD
    v_lshlrev_b32_sdwa v124, 3, v124 dst_sel:WORD_0 dst_unused:UNUSED_PAD src0_sel:DWORD src1_sel:DWORD
    v_lshlrev_b32_sdwa v126, 3, v126 dst_sel:WORD_0 dst_unused:UNUSED_PAD src0_sel:DWORD src1_sel:DWORD
    s_cmp_lt_i32 s42, 3328
    s_cbranch_scc1 L_ufix_73
L_uback_74:

    v_lshrrev_b32 v117, 30, v106
    v_and_b32 v106, 0x3fffffff, v106
    v_mul_u32_u24 v117, 50000, v117
    v_cmp_ne_u32 vcc, 0, v106
    v_add_u32 v120, v120, v117
    s_mov_b64 exec, vcc

    buffer_load_dwordx2 v[120:121], v120, s[8:11], s50 offen
    s_mov_b64 exec, -1
    v_lshrrev_b32 v117, 30, v107
    v_and_b32 v107, 0x3fffffff, v107
    v_mul_u32_u24 v117, 50000, v117
    v_cmp_ne_u32 vcc, 0, v107
    v_add_u32 v122, v122, v117
    s_mov_b64 exec, vcc

    buffer_load_dwordx2 v[122:123], v122, s[8:11], s50 offen
    s_mov_b64 exec, -1
    v_lshrrev_b32 v117, 30, v108
    v_and_b32 v108, 0x3fffffff, v108
    v_mul_u32_u24 v117, 50000, v117
    v_cmp_ne_u32 vcc, 0, v108
    v_add_u32 v124, v124, v117
    s_mov_b64 exec, vcc

    buffer_load_dwordx2 v[124:125], v124, s[8:11], s50 offen
    s_mov_b64 exec, -1
    v_lshrrev_b32 v117, 30, v109
    v_and_b32 v109, 0x3fffffff, v109
    v_mul_u32_u24 v117, 50000, v117
    v_cmp_ne_u32 vcc, 0, v109
    v_add_u32 v126, v126, v117
    s_mov_b64 exec, vcc

    buffer_load_dwordx2 v[126:127], v126, s[8:11], s50 offen
    s_mov_b64 exec, -1
L_nt1_70:
    v_subrev_co_u32 v4, s[64:65], 2.0, v4
    v_subrev_co_u32 v5, s[66:67], 2.0, v5
    v_subrev_co_u32 v6, s[68:69], 2.0, v6
    v_subrev_co_u32 v7, s[70:71], 2.0, v7
    v_subrev_co_u32 v8, s[72:73], 2.0, v8
    v_subrev_co_u32 v9, s[74:75], 2.0, v9
    v_subrev_co_u32 v10, s[76:77], 2.0, v10
    v_subrev_co_u32 v11, s[78:79], 2.0, v11
    v_subrev_co_u32 v12, s[80:81], 2.0, v12
    v_subrev_co_u32 v13, s[82:83], 2.0, v13
    v_subrev_co_u32 v14, s[84:85], 2.0, v14
    v_subrev_co_u32 v15, s[86:87], 2.0, v15
    s_waitcnt lgkmcnt(0)
    s_barrier
    s_waitcnt vmcnt(3)
    ds_write_addtid_b32 v76 offset:0
    ds_write_addtid_b32 v77 offset:256
    ds_write_addtid_b32 v78 offset:512
    ds_write_addtid_b32 v79 offset:768
    s_waitcnt vmcnt(2)
    ds_write_addtid_b32 v80 offset:16384
    ds_write_addtid_b32 v81 offset:16640
    ds_write_addtid_b32 v82 offset:16896
    ds_write_addtid_b32 v83 offset:17152
    s_waitcnt vmcnt(1)
    ds_write_addtid_b32 v84 offset:32768
    ds_write_addtid_b32 v85 offset:33024
    ds_write_addtid_b32 v86 offset:33280
    ds_write_addtid_b32 v87 offset:33536
    v_lshlrev_b32 v119, 2, v0
    s_waitcnt vmcnt(0)
    s_mov_b64 exec, s[48:49]
    ds_write_b32 v119, v88 offset:49152
    s_mov_b64 exec, -1
    s_add_u32 s43, s43, 50048
    s_add_u32 s14, s43, 50000
    s_min_u32 s14, s14, s41
    buffer_load_dwordx4 v[76:79], v3, s[12:15], s43 offen
    s_waitcnt lgkmcnt(0)
    s_barrier
    s_add_u32 s52, s43, 16384
    buffer_load_dwordx4 v[80:83], v3, s[12:15], s52 offen
    s_add_u32 s52, s43, 32768
    buffer_load_dwordx4 v[84:87], v3, s[12:15], s52 offen
    s_add_u32 s52, s43, 49152
    v_lshlrev_b32 v119, 2, v0
    buffer_load_dword v88, v119, s[12:15], s52 offen
    s_mov_b64 exec, s[64:65]
    ds_read_b64 v[28:29], v28
    s_mov_b64 exec, s[66:67]
    ds_read_b64 v[30:31], v30
    s_mov_b64 exec, s[68:69]
    ds_read_b64 v[32:33], v32
    s_mov_b64 exec, s[70:71]
    ds_read_b64 v[34:35], v34
    s_mov_b64 exec, s[72:73]
    ds_read_b64 v[36:37], v36
    s_mov_b64 exec, s[74:75]
    ds_read_b64 v[38:39], v38
    s_mov_b64 exec, s[76:77]
    ds_read_b64 v[40:41], v40
    s_mov_b64 exec, s[78:79]
    ds_read_b64 v[42:43], v42
    s_mov_b64 exec, s[80:81]
    ds_read_b64 v[44:45], v44
    s_mov_b64 exec, s[82:83]
    ds_read_b64 v[46:47], v46
    s_mov_b64 exec, s[84:85]
    ds_read_b64 v[48:49], v48
    s_mov_b64 exec, s[86:87]
    ds_read_b64 v[50:51], v50
    s_mov_b64 exec, -1
    v_subrev_co_u32 v16, s[64:65], 2.0, v16
    v_subrev_co_u32 v17, s[66:67], 2.0, v17
    v_subrev_co_u32 v18, s[68:69], 2.0, v18
    v_subrev_co_u32 v19, s[70:71], 2.0, v19
    v_subrev_co_u32 v20, s[72:73], 2.0, v20
    v_subrev_co_u32 v21, s[74:75], 2.0, v21
    v_subrev_co_u32 v22, s[76:77], 2.0, v22
    v_subrev_co_u32 v23, s[78:79], 2.0, v23
    v_subrev_co_u32 v24, s[80:81], 2.0, v24
    v_subrev_co_u32 v25, s[82:83], 2.0, v25
    v_subrev_co_u32 v26, s[84:85], 2.0, v26
    v_subrev_co_u32 v27, s[86:87], 2.0, v27
    s_mov_b64 exec, s[64:65]
    ds_read_b64 v[52:53], v52
    s_mov_b64 exec, s[66:67]
    ds_read_b64 v[54:55], v54
    s_mov_b64 exec, s[68:69]
    ds_read_b64 v[56:57], v56
    s_mov_b64 exec, s[70:71]
    ds_read_b64 v[58:59], v58
    s_mov_b64 exec, s[72:73]
    ds_read_b64 v[60:61], v60
    s_mov_b64 exec, s[74:75]
    ds_read_b64 v[62:63], v62
    s_mov_b64 exec, s[76:77]
    ds_read_b64 v[64:65], v64
    s_mov_b64 exec, s[78:79]
    ds_read_b64 v[66:67], v66
    s_mov_b64 exec, s[80:81]
    ds_read_b64 v[68:69], v68
    s_mov_b64 exec, s[82:83]
    ds_read_b64 v[70:71], v70
    s_mov_b64 exec, s[84:85]
    ds_read_b64 v[72:73], v72
    s_mov_b64 exec, s[86:87]
    ds_read_b64 v[74:75], v74
    s_mov_b64 exec, -1
    s_movk_i32 s53, 10240
    buffer_load_dwordx4 v[98:101], v2, s[16:19], s53 offen
    buffer_load_dword v112, v2, s[16:19], s53 offen offset:16
    s_cmp_le_i32 s42, 3072
    s_cbranch_scc1 L_nt2_71
    s_waitcnt vmcnt(6)
    v_cmp_ne_u32 s[56:57], 0, v106
    v_cmp_ne_u32 s[58:59], 0, v107
    v_cmp_ne_u32 s[98:99], 0, v108
    v_cmp_ne_u32 vcc, 0, v109
    s_mov_b64 exec, s[56:57]
    v_cvt_f32_i32_sdwa v118, sext(v106) dst_sel:DWORD dst_unused:UNUSED_PAD src0_sel:WORD_0
    v_lshlrev_b32 v116, 16, v120
    v_and_b32 v117, s32, v120
    v_mul_f32 v118, s33, v118
    v_lshlrev_b32 v120, 16, v121
    v_and_b32 v121, s32, v121
    v_lshlrev_b32_sdwa v106, 3, v106 dst_sel:DWORD dst_unused:UNUSED_PAD src0_sel:DWORD src1_sel:WORD_1
    v_pk_fma_f32 v[116:117], v[116:117], v[118:119], s[28:29] op_sel_hi:[1,0,1]
    v_pk_fma_f32 v[120:121], v[120:121], v[118:119], s[28:29] op_sel_hi:[1,0,1]
    v_perm_b32 v116, v117, v116, s35
    v_perm_b32 v117, v121, v120, s35
    v_lshl_add_u64 v[116:117], v[116:117], 0, s[30:31]
    ds_add_rtn_u64 v[120:121], v106, v[116:117] offset:50000

    s_mov_b64 exec, s[58:59]
    v_cvt_f32_i32_sdwa v118, sext(v107) dst_sel:DWORD dst_unused:UNUSED_PAD src0_sel:WORD_0
    v_lshlrev_b32 v116, 16, v122
    v_and_b32 v117, s32, v122
    v_mul_f32 v118, s33, v118
    v_lshlrev_b32 v122, 16, v123
    v_and_b32 v123, s32, v123
    v_lshlrev_b32_sdwa v107, 3, v107 dst_sel:DWORD dst_unused:UNUSED_PAD src0_sel:DWORD src1_sel:WORD_1
    v_pk_fma_f32 v[116:117], v[116:117], v[118:119], s[28:29] op_sel_hi:[1,0,1]
    v_pk_fma_f32 v[122:123], v[122:123], v[118:119], s[28:29] op_sel_hi:[1,0,1]
    v_perm_b32 v116, v117, v116, s35
    v_perm_b32 v117, v123, v122, s35
    v_lshl_add_u64 v[116:117], v[116:117], 0, s[30:31]
    ds_add_rtn_u64 v[122:123], v107, v[116:117] offset:50000

    s_mov_b64 exec, s[98:99]
    v_cvt_f32_i32_sdwa v118, sext(v108) dst_sel:DWORD dst_unused:UNUSED_PAD src0_sel:WORD_0
    v_lshlrev_b32 v116, 16, v124
    v_and_b32 v117, s32, v124
    v_mul_f32 v118, s33, v118
    v_lshlrev_b32 v124, 16, v125
    v_and_b32 v125, s32, v125
    v_lshlrev_b32_sdwa v108, 3, v108 dst_sel:DWORD dst_unused:UNUSED_PAD src0_sel:DWORD src1_sel:WORD_1
    v_pk_fma_f32 v[116:117], v[116:117], v[118:119], s[28:29] op_sel_hi:[1,0,1]
    v_pk_fma_f32 v[124:125], v[124:125], v[118:119], s[28:29] op_sel_hi:[1,0,1]
    v_perm_b32 v116, v117, v116, s35
    v_perm_b32 v117, v125, v124, s35
    v_lshl_add_u64 v[116:117], v[116:117], 0, s[30:31]
    ds_add_rtn_u64 v[124:125], v108, v[116:117] offset:50000

    s_mov_b64 exec, vcc
    v_cvt_f32_i32_sdwa v118, sext(v109) dst_sel:DWORD dst_unused:UNUSED_PAD src0_sel:WORD_0
    v_lshlrev_b32 v116, 16, v126
    v_and_b32 v117, s32, v126
    v_mul_f32 v118, s33, v118
    v_lshlrev_b32 v126, 16, v127
    v_and_b32 v127, s32, v127
    v_lshlrev_b32_sdwa v109, 3, v109 dst_sel:DWORD dst_unused:UNUSED_PAD src0_sel:DWORD src1_sel:WORD_1
    v_pk_fma_f32 v[116:117], v[116:117], v[118:119], s[28:29] op_sel_hi:[1,0,1]
    v_pk_fma_f32 v[126:127], v[126:127], v[118:119], s[28:29] op_sel_hi:[1,0,1]
    v_perm_b32 v116, v117, v116, s35
    v_perm_b32 v117, v127, v126, s35
    v_lshl_add_u64 v[116:117], v[116:117], 0, s[30:31]
    ds_add_rtn_u64 v[126:127], v109, v[116:117] offset:50000

    s_waitcnt lgkmcnt(0)
    s_mov_b64 exec, s[56:57]
    v_or3_b32 v1, v120, v121, v1
    s_mov_b64 exec, s[58:59]
    v_or3_b32 v1, v122, v123, v1
    s_mov_b64 exec, s[98:99]
    v_or3_b32 v1, v124, v125, v1
    s_mov_b64 exec, vcc
    v_or3_b32 v1, v126, v127, v1
    s_mov_b64 exec, -1
L_nt2_71:
    s_movk_i32 s53, 15360
    buffer_load_dwordx4 v[106:109], v2, s[16:19], s53 offen
    buffer_load_dword v114, v2, s[16:19], s53 offen offset:16
    s_cmp_le_u32 s40, 3584
    s_cbranch_scc1 L_noleft_72
    s_min_u32 s40, s40, 3968
    s_lshl_b32 s52, s38, 6
    s_add_u32 s52, s52, s36
    s_mul_i32 s52, s52, 19840
    s_add_u32 s20, s44, s52
    s_addc_u32 s21, s45, 0
    s_mul_i32 s52, s40, 5
    s_add_u32 s52, s52, 3
    s_and_b32 s22, s52, -4

    s_lshr_b32 s55, s39, 2
    s_add_u32 s55, s55, 3584
    v_and_b32 v120, 63, v0
    v_add_u32 v120, s55, v120
L_left_75:
    s_cmp_ge_u32 s55, s40
    s_cbranch_scc1 L_leftend_76
    v_mul_u32_u24 v121, 5, v120
    buffer_load_dword v122, v121, s[20:23], 0 offen
    buffer_load_ubyte v123, v121, s[20:23], 0 offen offset:4
    s_waitcnt vmcnt(0)

    v_perm_b32 v121, v123, v122, s24
    v_lshrrev_b32 v126, 30, v122
    v_and_b32 v121, 0x1fff, v121
    v_mul_u32_u24 v126, 6250, v126
    v_add_lshl_u32 v121, v121, v126, 3

    buffer_load_dwordx2 v[124:125], v121, s[8:11], s50 offen
    v_cmp_gt_u32 vcc, s40, v120
    s_waitcnt vmcnt(0)

    s_mov_b64 exec, vcc
    v_and_b32 v122, 0x3fffffff, v122
    v_cvt_f32_i32_sdwa v118, sext(v122) dst_sel:DWORD dst_unused:UNUSED_PAD src0_sel:WORD_0
    v_lshlrev_b32 v116, 16, v124
    v_and_b32 v117, s32, v124
    v_mul_f32 v118, s33, v118
    v_lshlrev_b32 v124, 16, v125
    v_and_b32 v125, s32, v125
    v_lshlrev_b32_sdwa v122, 3, v122 dst_sel:DWORD dst_unused:UNUSED_PAD src0_sel:DWORD src1_sel:WORD_1
    v_pk_fma_f32 v[116:117], v[116:117], v[118:119], s[28:29] op_sel_hi:[1,0,1]
    v_pk_fma_f32 v[124:125], v[124:125], v[118:119], s[28:29] op_sel_hi:[1,0,1]
    v_perm_b32 v116, v117, v116, s35
    v_perm_b32 v117, v125, v124, s35
    v_lshl_add_u64 v[116:117], v[116:117], 0, s[30:31]
    ds_add_rtn_u64 v[124:125], v122, v[116:117] offset:50000

    s_waitcnt lgkmcnt(0)
    v_or3_b32 v1, v124, v125, v1
    s_mov_b64 exec, -1
    v_add_u32 v120, 128, v120
    s_add_u32 s55, s55, 128
    s_branch L_left_75
L_leftend_76:

L_noleft_72:
    v_cmp_gt_u32 s[64:65], 2.0, v4
    v_and_b32 v4, 0x3fffffff, v4
    v_cmp_gt_u32 s[66:67], 2.0, v5
    v_and_b32 v5, 0x3fffffff, v5
    v_cmp_gt_u32 s[68:69], 2.0, v6
    v_and_b32 v6, 0x3fffffff, v6
    v_cmp_gt_u32 s[70:71], 2.0, v7
    v_and_b32 v7, 0x3fffffff, v7
    v_cmp_gt_u32 s[72:73], 2.0, v8
    v_and_b32 v8, 0x3fffffff, v8
    v_cmp_gt_u32 s[74:75], 2.0, v9
    v_and_b32 v9, 0x3fffffff, v9
    v_cmp_gt_u32 s[76:77], 2.0, v10
    v_and_b32 v10, 0x3fffffff, v10
    v_cmp_gt_u32 s[78:79], 2.0, v11
    v_and_b32 v11, 0x3fffffff, v11
    v_cmp_gt_u32 s[80:81], 2.0, v12
    v_and_b32 v12, 0x3fffffff, v12
    v_cmp_gt_u32 s[82:83], 2.0, v13
    v_and_b32 v13, 0x3fffffff, v13
    v_cmp_gt_u32 s[84:85], 2.0, v14
    v_and_b32 v14, 0x3fffffff, v14
    v_cmp_gt_u32 s[86:87], 2.0, v15
    v_and_b32 v15, 0x3fffffff, v15
    s_waitcnt lgkmcnt(0)
    s_barrier
    s_waitcnt vmcnt(7)
    ds_write_addtid_b32 v76 offset:0
    ds_write_addtid_b32 v77 offset:256
    ds_write_addtid_b32 v78 offset:512
    ds_write_addtid_b32 v79 offset:768
    s_waitcnt vmcnt(6)
    ds_write_addtid_b32 v80 offset:16384
    ds_write_addtid_b32 v81 offset:16640
    ds_write_addtid_b32 v82 offset:16896
    ds_write_addtid_b32 v83 offset:17152
    s_waitcnt vmcnt(5)
    ds_write_addtid_b32 v84 offset:32768
    ds_write_addtid_b32 v85 offset:33024
    ds_write_addtid_b32 v86 offset:33280
    ds_write_addtid_b32 v87 offset:33536
    v_lshlrev_b32 v119, 2, v0
    s_waitcnt vmcnt(4)
    s_mov_b64 exec, s[48:49]
    ds_write_b32 v119, v88 offset:49152
    s_mov_b64 exec, -1
    s_add_u32 s43, s43, 50048
    s_add_u32 s14, s43, 50000
    s_min_u32 s14, s14, s41
    buffer_load_dwordx4 v[76:79], v3, s[12:15], s43 offen
    s_waitcnt lgkmcnt(0)
    s_barrier
    s_add_u32 s52, s43, 16384
    buffer_load_dwordx4 v[80:83], v3, s[12:15], s52 offen
    s_add_u32 s52, s43, 32768
    buffer_load_dwordx4 v[84:87], v3, s[12:15], s52 offen
    s_add_u32 s52, s43, 49152
    v_lshlrev_b32 v119, 2, v0
    buffer_load_dword v88, v119, s[12:15], s52 offen
    s_mov_b64 exec, s[64:65]
    ds_read_b64 v[28:29], v28
    s_mov_b64 exec, s[66:67]
    ds_read_b64 v[30:31], v30
    s_mov_b64 exec, s[68:69]
    ds_read_b64 v[32:33], v32
    s_mov_b64 exec, s[70:71]
    ds_read_b64 v[34:35], v34
    s_mov_b64 exec, s[72:73]
    ds_read_b64 v[36:37], v36
    s_mov_b64 exec, s[74:75]
    ds_read_b64 v[38:39], v38
    s_mov_b64 exec, s[76:77]
    ds_read_b64 v[40:41], v40
    s_mov_b64 exec, s[78:79]
    ds_read_b64 v[42:43], v42
    s_mov_b64 exec, s[80:81]
    ds_read_b64 v[44:45], v44
    s_mov_b64 exec, s[82:83]
    ds_read_b64 v[46:47], v46
    s_mov_b64 exec, s[84:85]
    ds_read_b64 v[48:49], v48
    s_mov_b64 exec, s[86:87]
    ds_read_b64 v[50:51], v50
    s_mov_b64 exec, -1
    v_cmp_gt_u32 s[64:65], 2.0, v16
    v_and_b32 v16, 0x3fffffff, v16
    v_cmp_gt_u32 s[66:67], 2.0, v17
    v_and_b32 v17, 0x3fffffff, v17
    v_cmp_gt_u32 s[68:69], 2.0, v18
    v_and_b32 v18, 0x3fffffff, v18
    v_cmp_gt_u32 s[70:71], 2.0, v19
    v_and_b32 v19, 0x3fffffff, v19
    v_cmp_gt_u32 s[72:73], 2.0, v20
    v_and_b32 v20, 0x3fffffff, v20
    v_cmp_gt_u32 s[74:75], 2.0, v21
    v_and_b32 v21, 0x3fffffff, v21
    v_cmp_gt_u32 s[76:77], 2.0, v22
    v_and_b32 v22, 0x3fffffff, v22
    v_cmp_gt_u32 s[78:79], 2.0, v23
    v_and_b32 v23, 0x3fffffff, v23
    v_cmp_gt_u32 s[80:81], 2.0, v24
    v_and_b32 v24, 0x3fffffff, v24
    v_cmp_gt_u32 s[82:83], 2.0, v25
    v_and_b32 v25, 0x3fffffff, v25
    v_cmp_gt_u32 s[84:85], 2.0, v26
    v_and_b32 v26, 0x3fffffff, v26
    v_cmp_gt_u32 s[86:87], 2.0, v27
    v_and_b32 v27, 0x3fffffff, v27
    s_mov_b64 exec, s[64:65]
    ds_read_b64 v[52:53], v52
    s_mov_b64 exec, s[66:67]
    ds_read_b64 v[54:55], v54
    s_mov_b64 exec, s[68:69]
    ds_read_b64 v[56:57], v56
    s_mov_b64 exec, s[70:71]
    ds_read_b64 v[58:59], v58
    s_mov_b64 exec, s[72:73]
    ds_read_b64 v[60:61], v60
    s_mov_b64 exec, s[74:75]
    ds_read_b64 v[62:63], v62
    s_mov_b64 exec, s[76:77]
    ds_read_b64 v[64:65], v64
    s_mov_b64 exec, s[78:79]
    ds_read_b64 v[66:67], v66
    s_mov_b64 exec, s[80:81]
    ds_read_b64 v[68:69], v68
    s_mov_b64 exec, s[82:83]
    ds_read_b64 v[70:71], v70
    s_mov_b64 exec, s[84:85]
    ds_read_b64 v[72:73], v72
    s_mov_b64 exec, s[86:87]
    ds_read_b64 v[74:75], v74
    s_mov_b64 exec, -1
    s_movk_i32 s53, 12800
    buffer_load_dwordx4 v[102:105], v2, s[16:19], s53 offen
    buffer_load_dword v113, v2, s[16:19], s53 offen offset:16
    s_cmp_ge_u32 s5, s4
    s_cbranch_scc1 L_bend_69
    s_waitcnt lgkmcnt(15)
    v_mad_i32_i16 v120, v28, v4, s96
    v_mad_i32_i16 v28, v28, v4, s96 op_sel:[1,0,0,0]
    v_mad_i32_i16 v121, v29, v4, s96
    v_mad_i32_i16 v29, v29, v4, s96 op_sel:[1,0,0,0]
    v_lshlrev_b32_sdwa v4, 3, v4 dst_sel:DWORD dst_unused:UNUSED_PAD src0_sel:DWORD src1_sel:WORD_1
    v_perm_b32 v28, v28, v120, s97
    v_perm_b32 v29, v29, v121, s97
    v_lshl_add_u64 v[28:29], v[28:29], 0, s[30:31]

    ds_add_rtn_u64 v[28:29], v4, v[28:29] offset:50000
    v_mad_i32_i16 v122, v30, v5, s96
    v_mad_i32_i16 v30, v30, v5, s96 op_sel:[1,0,0,0]
    v_mad_i32_i16 v123, v31, v5, s96
    v_mad_i32_i16 v31, v31, v5, s96 op_sel:[1,0,0,0]
    v_lshlrev_b32_sdwa v5, 3, v5 dst_sel:DWORD dst_unused:UNUSED_PAD src0_sel:DWORD src1_sel:WORD_1
    v_perm_b32 v30, v30, v122, s97
    v_perm_b32 v31, v31, v123, s97
    v_lshl_add_u64 v[30:31], v[30:31], 0, s[30:31]

    ds_add_rtn_u64 v[30:31], v5, v[30:31] offset:50000
    v_mad_i32_i16 v124, v32, v6, s96
    v_mad_i32_i16 v32, v32, v6, s96 op_sel:[1,0,0,0]
    v_mad_i32_i16 v125, v33, v6, s96
    v_mad_i32_i16 v33, v33, v6, s96 op_sel:[1,0,0,0]
    v_lshlrev_b32_sdwa v6, 3, v6 dst_sel:DWORD dst_unused:UNUSED_PAD src0_sel:DWORD src1_sel:WORD_1
    v_perm_b32 v32, v32, v124, s97
    v_perm_b32 v33, v33, v125, s97
    v_lshl_add_u64 v[32:33], v[32:33], 0, s[30:31]

    ds_add_rtn_u64 v[32:33], v6, v[32:33] offset:50000
    v_mad_i32_i16 v126, v34, v7, s96
    v_mad_i32_i16 v34, v34, v7, s96 op_sel:[1,0,0,0]
    v_mad_i32_i16 v127, v35, v7, s96
    v_mad_i32_i16 v35, v35, v7, s96 op_sel:[1,0,0,0]
    v_lshlrev_b32_sdwa v7, 3, v7 dst_sel:DWORD dst_unused:UNUSED_PAD src0_sel:DWORD src1_sel:WORD_1
    v_perm_b32 v34, v34, v126, s97
    v_perm_b32 v35, v35, v127, s97
    v_lshl_add_u64 v[34:35], v[34:35], 0, s[30:31]

    ds_add_rtn_u64 v[34:35], v7, v[34:35] offset:50000
    v_mad_i32_i16 v120, v36, v8, s96
    v_mad_i32_i16 v36, v36, v8, s96 op_sel:[1,0,0,0]
    v_mad_i32_i16 v121, v37, v8, s96
    v_mad_i32_i16 v37, v37, v8, s96 op_sel:[1,0,0,0]
    v_lshlrev_b32_sdwa v8, 3, v8 dst_sel:DWORD dst_unused:UNUSED_PAD src0_sel:DWORD src1_sel:WORD_1
    v_perm_b32 v36, v36, v120, s97
    v_perm_b32 v37, v37, v121, s97
    v_lshl_add_u64 v[36:37], v[36:37], 0, s[30:31]

    ds_add_rtn_u64 v[36:37], v8, v[36:37] offset:50000
    v_mad_i32_i16 v122, v38, v9, s96
    v_mad_i32_i16 v38, v38, v9, s96 op_sel:[1,0,0,0]
    v_mad_i32_i16 v123, v39, v9, s96
    v_mad_i32_i16 v39, v39, v9, s96 op_sel:[1,0,0,0]
    v_lshlrev_b32_sdwa v9, 3, v9 dst_sel:DWORD dst_unused:UNUSED_PAD src0_sel:DWORD src1_sel:WORD_1
    v_perm_b32 v38, v38, v122, s97
    v_perm_b32 v39, v39, v123, s97
    v_lshl_add_u64 v[38:39], v[38:39], 0, s[30:31]

    ds_add_rtn_u64 v[38:39], v9, v[38:39] offset:50000
    v_mad_i32_i16 v124, v40, v10, s96
    v_mad_i32_i16 v40, v40, v10, s96 op_sel:[1,0,0,0]
    v_mad_i32_i16 v125, v41, v10, s96
    v_mad_i32_i16 v41, v41, v10, s96 op_sel:[1,0,0,0]
    v_lshlrev_b32_sdwa v10, 3, v10 dst_sel:DWORD dst_unused:UNUSED_PAD src0_sel:DWORD src1_sel:WORD_1
    v_perm_b32 v40, v40, v124, s97
    v_perm_b32 v41, v41, v125, s97
    v_lshl_add_u64 v[40:41], v[40:41], 0, s[30:31]

    ds_add_rtn_u64 v[40:41], v10, v[40:41] offset:50000
    v_mad_i32_i16 v126, v42, v11, s96
    v_mad_i32_i16 v42, v42, v11, s96 op_sel:[1,0,0,0]
    v_mad_i32_i16 v127, v43, v11, s96
    v_mad_i32_i16 v43, v43, v11, s96 op_sel:[1,0,0,0]
    v_lshlrev_b32_sdwa v11, 3, v11 dst_sel:DWORD dst_unused:UNUSED_PAD src0_sel:DWORD src1_sel:WORD_1
    v_perm_b32 v42, v42, v126, s97
    v_perm_b32 v43, v43, v127, s97
    v_lshl_add_u64 v[42:43], v[42:43], 0, s[30:31]

    ds_add_rtn_u64 v[42:43], v11, v[42:43] offset:50000
    s_waitcnt lgkmcnt(4)
    v_or3_b32 v1, v28, v29, v1
    v_or3_b32 v1, v30, v31, v1
    v_or3_b32 v1, v32, v33, v1
    v_or3_b32 v1, v34, v35, v1
    s_movk_i32 s53, 0
    buffer_load_dwordx4 v[4:7], v2, s[16:19], s53 offen
    buffer_load_dword v35, v2, s[16:19], s53 offen offset:16
    v_mad_i32_i16 v120, v44, v12, s96
    v_mad_i32_i16 v44, v44, v12, s96 op_sel:[1,0,0,0]
    v_mad_i32_i16 v121, v45, v12, s96
    v_mad_i32_i16 v45, v45, v12, s96 op_sel:[1,0,0,0]
    v_lshlrev_b32_sdwa v12, 3, v12 dst_sel:DWORD dst_unused:UNUSED_PAD src0_sel:DWORD src1_sel:WORD_1
    v_perm_b32 v44, v44, v120, s97
    v_perm_b32 v45, v45, v121, s97
    v_lshl_add_u64 v[44:45], v[44:45], 0, s[30:31]

    ds_add_rtn_u64 v[44:45], v12, v[44:45] offset:50000
    v_mad_i32_i16 v122, v46, v13, s96
    v_mad_i32_i16 v46, v46, v13, s96 op_sel:[1,0,0,0]
    v_mad_i32_i16 v123, v47, v13, s96
    v_mad_i32_i16 v47, v47, v13, s96 op_sel:[1,0,0,0]
    v_lshlrev_b32_sdwa v13, 3, v13 dst_sel:DWORD dst_unused:UNUSED_PAD src0_sel:DWORD src1_sel:WORD_1
    v_perm_b32 v46, v46, v122, s97
    v_perm_b32 v47, v47, v123, s97
    v_lshl_add_u64 v[46:47], v[46:47], 0, s[30:31]

    ds_add_rtn_u64 v[46:47], v13, v[46:47] offset:50000
    v_mad_i32_i16 v124, v48, v14, s96
    v_mad_i32_i16 v48, v48, v14, s96 op_sel:[1,0,0,0]
    v_mad_i32_i16 v125, v49, v14, s96
    v_mad_i32_i16 v49, v49, v14, s96 op_sel:[1,0,0,0]
    v_lshlrev_b32_sdwa v14, 3, v14 dst_sel:DWORD dst_unused:UNUSED_PAD src0_sel:DWORD src1_sel:WORD_1
    v_perm_b32 v48, v48, v124, s97
    v_perm_b32 v49, v49, v125, s97
    v_lshl_add_u64 v[48:49], v[48:49], 0, s[30:31]

    ds_add_rtn_u64 v[48:49], v14, v[48:49] offset:50000
    v_mad_i32_i16 v126, v50, v15, s96
    v_mad_i32_i16 v50, v50, v15, s96 op_sel:[1,0,0,0]
    v_mad_i32_i16 v127, v51, v15, s96
    v_mad_i32_i16 v51, v51, v15, s96 op_sel:[1,0,0,0]
    v_lshlrev_b32_sdwa v15, 3, v15 dst_sel:DWORD dst_unused:UNUSED_PAD src0_sel:DWORD src1_sel:WORD_1
    v_perm_b32 v50, v50, v126, s97
    v_perm_b32 v51, v51, v127, s97
    v_lshl_add_u64 v[50:51], v[50:51], 0, s[30:31]

    ds_add_rtn_u64 v[50:51], v15, v[50:51] offset:50000
    s_waitcnt lgkmcnt(4)
    v_or3_b32 v1, v36, v37, v1
    v_or3_b32 v1, v38, v39, v1
    v_or3_b32 v1, v40, v41, v1
    v_or3_b32 v1, v42, v43, v1
    s_movk_i32 s53, 2560
    buffer_load_dwordx4 v[8:11], v2, s[16:19], s53 offen
    buffer_load_dword v43, v2, s[16:19], s53 offen offset:16
    s_barrier
    s_waitcnt vmcnt(9)
    ds_write_addtid_b32 v76 offset:0
    ds_write_addtid_b32 v77 offset:256
    ds_write_addtid_b32 v78 offset:512
    ds_write_addtid_b32 v79 offset:768
    s_waitcnt vmcnt(8)
    ds_write_addtid_b32 v80 offset:16384
    ds_write_addtid_b32 v81 offset:16640
    ds_write_addtid_b32 v82 offset:16896
    ds_write_addtid_b32 v83 offset:17152
    s_waitcnt vmcnt(7)
    ds_write_addtid_b32 v84 offset:32768
    ds_write_addtid_b32 v85 offset:33024
    ds_write_addtid_b32 v86 offset:33280
    ds_write_addtid_b32 v87 offset:33536
    v_lshlrev_b32 v119, 2, v0
    s_waitcnt vmcnt(6)
    s_mov_b64 exec, s[48:49]
    ds_write_b32 v119, v88 offset:49152
    s_mov_b64 exec, -1
    s_add_u32 s43, s43, 50048
    s_add_u32 s14, s43, 50000
    s_min_u32 s14, s14, s41
    s_add_u32 s54, s43, 50048
    buffer_load_dword v115, v89, s[60:63], s54 offen
    s_add_u32 s54, s50, 200000
    buffer_load_dword v115, v89, s[8:11], s54 offen
    s_mov_b32 s40, s88
    s_sub_u32 s42, s40, s39

    s_add_u32 s55, s38, 2
    s_min_u32 s55, s55, 31
    s_mov_b32 s88, s89
    s_mov_b32 s89, s90
    s_mov_b32 s90, s91
    s_mov_b32 s91, s92
    s_mov_b32 s92, s93
    s_mov_b32 s93, s94
    s_mov_b32 s94, s95
    s_mov_b32 s95, 0
    s_min_u32 s88, s88, 3968
    s_lshl_b32 s52, s55, 6
    s_add_u32 s52, s52, s36
    s_mul_i32 s52, s52, 19840
    s_add_u32 s16, s44, s52
    s_addc_u32 s17, s45, 0
    s_mul_i32 s52, s88, 5
    s_add_u32 s52, s52, 3
    s_and_b32 s18, s52, -4

    v_mad_i32_i16 v120, v52, v16, s96
    v_mad_i32_i16 v52, v52, v16, s96 op_sel:[1,0,0,0]
    v_mad_i32_i16 v121, v53, v16, s96
    v_mad_i32_i16 v53, v53, v16, s96 op_sel:[1,0,0,0]
    v_lshlrev_b32_sdwa v16, 3, v16 dst_sel:DWORD dst_unused:UNUSED_PAD src0_sel:DWORD src1_sel:WORD_1
    v_perm_b32 v52, v52, v120, s97
    v_perm_b32 v53, v53, v121, s97
    v_lshl_add_u64 v[52:53], v[52:53], 0, s[30:31]

    ds_add_rtn_u64 v[52:53], v16, v[52:53] offset:50000
    v_mad_i32_i16 v122, v54, v17, s96
    v_mad_i32_i16 v54, v54, v17, s96 op_sel:[1,0,0,0]
    v_mad_i32_i16 v123, v55, v17, s96
    v_mad_i32_i16 v55, v55, v17, s96 op_sel:[1,0,0,0]
    v_lshlrev_b32_sdwa v17, 3, v17 dst_sel:DWORD dst_unused:UNUSED_PAD src0_sel:DWORD src1_sel:WORD_1
    v_perm_b32 v54, v54, v122, s97
    v_perm_b32 v55, v55, v123, s97
    v_lshl_add_u64 v[54:55], v[54:55], 0, s[30:31]

    ds_add_rtn_u64 v[54:55], v17, v[54:55] offset:50000
    v_mad_i32_i16 v124, v56, v18, s96
    v_mad_i32_i16 v56, v56, v18, s96 op_sel:[1,0,0,0]
    v_mad_i32_i16 v125, v57, v18, s96
    v_mad_i32_i16 v57, v57, v18, s96 op_sel:[1,0,0,0]
    v_lshlrev_b32_sdwa v18, 3, v18 dst_sel:DWORD dst_unused:UNUSED_PAD src0_sel:DWORD src1_sel:WORD_1
    v_perm_b32 v56, v56, v124, s97
    v_perm_b32 v57, v57, v125, s97
    v_lshl_add_u64 v[56:57], v[56:57], 0, s[30:31]

    ds_add_rtn_u64 v[56:57], v18, v[56:57] offset:50000
    v_mad_i32_i16 v126, v58, v19, s96
    v_mad_i32_i16 v58, v58, v19, s96 op_sel:[1,0,0,0]
    v_mad_i32_i16 v127, v59, v19, s96
    v_mad_i32_i16 v59, v59, v19, s96 op_sel:[1,0,0,0]
    v_lshlrev_b32_sdwa v19, 3, v19 dst_sel:DWORD dst_unused:UNUSED_PAD src0_sel:DWORD src1_sel:WORD_1
    v_perm_b32 v58, v58, v126, s97
    v_perm_b32 v59, v59, v127, s97
    v_lshl_add_u64 v[58:59], v[58:59], 0, s[30:31]

    ds_add_rtn_u64 v[58:59], v19, v[58:59] offset:50000
    s_waitcnt lgkmcnt(15)
    v_or3_b32 v1, v44, v45, v1
    v_or3_b32 v1, v46, v47, v1
    v_or3_b32 v1, v48, v49, v1
    v_or3_b32 v1, v50, v51, v1
    s_waitcnt vmcnt(26)
    v_perm_b32 v44, v91, v90, s24
    v_perm_b32 v46, v92, v91, s25
    v_perm_b32 v48, v93, v92, s26
    v_perm_b32 v50, v110, v93, s27
    v_mov_b32 v12, v90
    v_alignbyte_b32 v13, v92, v91, 1
    v_alignbyte_b32 v14, v93, v92, 2
    v_alignbyte_b32 v15, v110, v93, 3
    v_lshlrev_b32_sdwa v44, 3, v44 dst_sel:WORD_0 dst_unused:UNUSED_PAD src0_sel:DWORD src1_sel:DWORD
    v_lshlrev_b32_sdwa v46, 3, v46 dst_sel:WORD_0 dst_unused:UNUSED_PAD src0_sel:DWORD src1_sel:DWORD
    v_lshlrev_b32_sdwa v48, 3, v48 dst_sel:WORD_0 dst_unused:UNUSED_PAD src0_sel:DWORD src1_sel:DWORD
    v_lshlrev_b32_sdwa v50, 3, v50 dst_sel:WORD_0 dst_unused:UNUSED_PAD src0_sel:DWORD src1_sel:DWORD
    s_cmp_lt_i32 s42, 1280
    s_cbranch_scc1 L_ufix_77
L_uback_78:

    s_movk_i32 s53, 5120
    buffer_load_dwordx4 v[90:93], v2, s[16:19], s53 offen
    buffer_load_dword v110, v2, s[16:19], s53 offen offset:16
    s_waitcnt lgkmcnt(4)
    s_barrier
    v_subrev_co_u32 v12, s[80:81], 2.0, v12
    v_subrev_co_u32 v13, s[82:83], 2.0, v13
    v_subrev_co_u32 v14, s[84:85], 2.0, v14
    v_subrev_co_u32 v15, s[86:87], 2.0, v15
    s_mov_b64 exec, s[80:81]
    ds_read_b64 v[44:45], v44
    s_mov_b64 exec, s[82:83]
    ds_read_b64 v[46:47], v46
    s_mov_b64 exec, s[84:85]
    ds_read_b64 v[48:49], v48
    s_mov_b64 exec, s[86:87]
    ds_read_b64 v[50:51], v50
    s_mov_b64 exec, -1
    v_mad_i32_i16 v120, v60, v20, s96
    v_mad_i32_i16 v60, v60, v20, s96 op_sel:[1,0,0,0]
    v_mad_i32_i16 v121, v61, v20, s96
    v_mad_i32_i16 v61, v61, v20, s96 op_sel:[1,0,0,0]
    v_lshlrev_b32_sdwa v20, 3, v20 dst_sel:DWORD dst_unused:UNUSED_PAD src0_sel:DWORD src1_sel:WORD_1
    v_perm_b32 v60, v60, v120, s97
    v_perm_b32 v61, v61, v121, s97
    v_lshl_add_u64 v[60:61], v[60:61], 0, s[30:31]

    ds_add_rtn_u64 v[60:61], v20, v[60:61] offset:50000
    v_mad_i32_i16 v122, v62, v21, s96
    v_mad_i32_i16 v62, v62, v21, s96 op_sel:[1,0,0,0]
    v_mad_i32_i16 v123, v63, v21, s96
    v_mad_i32_i16 v63, v63, v21, s96 op_sel:[1,0,0,0]
    v_lshlrev_b32_sdwa v21, 3, v21 dst_sel:DWORD dst_unused:UNUSED_PAD src0_sel:DWORD src1_sel:WORD_1
    v_perm_b32 v62, v62, v122, s97
    v_perm_b32 v63, v63, v123, s97
    v_lshl_add_u64 v[62:63], v[62:63], 0, s[30:31]

    ds_add_rtn_u64 v[62:63], v21, v[62:63] offset:50000
    v_mad_i32_i16 v124, v64, v22, s96
    v_mad_i32_i16 v64, v64, v22, s96 op_sel:[1,0,0,0]
    v_mad_i32_i16 v125, v65, v22, s96
    v_mad_i32_i16 v65, v65, v22, s96 op_sel:[1,0,0,0]
    v_lshlrev_b32_sdwa v22, 3, v22 dst_sel:DWORD dst_unused:UNUSED_PAD src0_sel:DWORD src1_sel:WORD_1
    v_perm_b32 v64, v64, v124, s97
    v_perm_b32 v65, v65, v125, s97
    v_lshl_add_u64 v[64:65], v[64:65], 0, s[30:31]

    ds_add_rtn_u64 v[64:65], v22, v[64:65] offset:50000
    v_mad_i32_i16 v126, v66, v23, s96
    v_mad_i32_i16 v66, v66, v23, s96 op_sel:[1,0,0,0]
    v_mad_i32_i16 v127, v67, v23, s96
    v_mad_i32_i16 v67, v67, v23, s96 op_sel:[1,0,0,0]
    v_lshlrev_b32_sdwa v23, 3, v23 dst_sel:DWORD dst_unused:UNUSED_PAD src0_sel:DWORD src1_sel:WORD_1
    v_perm_b32 v66, v66, v126, s97
    v_perm_b32 v67, v67, v127, s97
    v_lshl_add_u64 v[66:67], v[66:67], 0, s[30:31]

    ds_add_rtn_u64 v[66:67], v23, v[66:67] offset:50000
    s_waitcnt lgkmcnt(8)
    v_or3_b32 v1, v52, v53, v1
    v_or3_b32 v1, v54, v55, v1
    v_or3_b32 v1, v56, v57, v1
    v_or3_b32 v1, v58, v59, v1
    s_waitcnt vmcnt(26)
    v_perm_b32 v52, v95, v94, s24
    v_perm_b32 v54, v96, v95, s25
    v_perm_b32 v56, v97, v96, s26
    v_perm_b32 v58, v111, v97, s27
    v_mov_b32 v16, v94
    v_alignbyte_b32 v17, v96, v95, 1
    v_alignbyte_b32 v18, v97, v96, 2
    v_alignbyte_b32 v19, v111, v97, 3
    v_lshlrev_b32_sdwa v52, 3, v52 dst_sel:WORD_0 dst_unused:UNUSED_PAD src0_sel:DWORD src1_sel:DWORD
    v_lshlrev_b32_sdwa v54, 3, v54 dst_sel:WORD_0 dst_unused:UNUSED_PAD src0_sel:DWORD src1_sel:DWORD
    v_lshlrev_b32_sdwa v56, 3, v56 dst_sel:WORD_0 dst_unused:UNUSED_PAD src0_sel:DWORD src1_sel:DWORD
    v_lshlrev_b32_sdwa v58, 3, v58 dst_sel:WORD_0 dst_unused:UNUSED_PAD src0_sel:DWORD src1_sel:DWORD
    s_cmp_lt_i32 s42, 1792
    s_cbranch_scc1 L_ufix_79
L_uback_80:

    v_subrev_co_u32 v16, s[64:65], 2.0, v16
    v_subrev_co_u32 v17, s[66:67], 2.0, v17
    v_subrev_co_u32 v18, s[68:69], 2.0, v18
    v_subrev_co_u32 v19, s[70:71], 2.0, v19
    s_mov_b64 exec, s[64:65]
    ds_read_b64 v[52:53], v52
    s_mov_b64 exec, s[66:67]
    ds_read_b64 v[54:55], v54
    s_mov_b64 exec, s[68:69]
    ds_read_b64 v[56:57], v56
    s_mov_b64 exec, s[70:71]
    ds_read_b64 v[58:59], v58
    s_mov_b64 exec, -1
    v_mad_i32_i16 v120, v68, v24, s96
    v_mad_i32_i16 v68, v68, v24, s96 op_sel:[1,0,0,0]
    v_mad_i32_i16 v121, v69, v24, s96
    v_mad_i32_i16 v69, v69, v24, s96 op_sel:[1,0,0,0]
    v_lshlrev_b32_sdwa v24, 3, v24 dst_sel:DWORD dst_unused:UNUSED_PAD src0_sel:DWORD src1_sel:WORD_1
    v_perm_b32 v68, v68, v120, s97
    v_perm_b32 v69, v69, v121, s97
    v_lshl_add_u64 v[68:69], v[68:69], 0, s[30:31]

    ds_add_rtn_u64 v[68:69], v24, v[68:69] offset:50000
    v_mad_i32_i16 v122, v70, v25, s96
    v_mad_i32_i16 v70, v70, v25, s96 op_sel:[1,0,0,0]
    v_mad_i32_i16 v123, v71, v25, s96
    v_mad_i32_i16 v71, v71, v25, s96 op_sel:[1,0,0,0]
    v_lshlrev_b32_sdwa v25, 3, v25 dst_sel:DWORD dst_unused:UNUSED_PAD src0_sel:DWORD src1_sel:WORD_1
    v_perm_b32 v70, v70, v122, s97
    v_perm_b32 v71, v71, v123, s97
    v_lshl_add_u64 v[70:71], v[70:71], 0, s[30:31]

    ds_add_rtn_u64 v[70:71], v25, v[70:71] offset:50000
    v_mad_i32_i16 v124, v72, v26, s96
    v_mad_i32_i16 v72, v72, v26, s96 op_sel:[1,0,0,0]
    v_mad_i32_i16 v125, v73, v26, s96
    v_mad_i32_i16 v73, v73, v26, s96 op_sel:[1,0,0,0]
    v_lshlrev_b32_sdwa v26, 3, v26 dst_sel:DWORD dst_unused:UNUSED_PAD src0_sel:DWORD src1_sel:WORD_1
    v_perm_b32 v72, v72, v124, s97
    v_perm_b32 v73, v73, v125, s97
    v_lshl_add_u64 v[72:73], v[72:73], 0, s[30:31]

    ds_add_rtn_u64 v[72:73], v26, v[72:73] offset:50000
    v_mad_i32_i16 v126, v74, v27, s96
    v_mad_i32_i16 v74, v74, v27, s96 op_sel:[1,0,0,0]
    v_mad_i32_i16 v127, v75, v27, s96
    v_mad_i32_i16 v75, v75, v27, s96 op_sel:[1,0,0,0]
    v_lshlrev_b32_sdwa v27, 3, v27 dst_sel:DWORD dst_unused:UNUSED_PAD src0_sel:DWORD src1_sel:WORD_1
    v_perm_b32 v74, v74, v126, s97
    v_perm_b32 v75, v75, v127, s97
    v_lshl_add_u64 v[74:75], v[74:75], 0, s[30:31]

    ds_add_rtn_u64 v[74:75], v27, v[74:75] offset:50000
    s_waitcnt lgkmcnt(8)
    v_or3_b32 v1, v60, v61, v1
    v_or3_b32 v1, v62, v63, v1
    v_or3_b32 v1, v64, v65, v1
    v_or3_b32 v1, v66, v67, v1
    s_waitcnt vmcnt(16)
    v_perm_b32 v60, v99, v98, s24
    v_perm_b32 v62, v100, v99, s25
    v_perm_b32 v64, v101, v100, s26
    v_perm_b32 v66, v112, v101, s27
    v_mov_b32 v20, v98
    v_alignbyte_b32 v21, v100, v99, 1
    v_alignbyte_b32 v22, v101, v100, 2
    v_alignbyte_b32 v23, v112, v101, 3
    v_lshlrev_b32_sdwa v60, 3, v60 dst_sel:WORD_0 dst_unused:UNUSED_PAD src0_sel:DWORD src1_sel:DWORD
    v_lshlrev_b32_sdwa v62, 3, v62 dst_sel:WORD_0 dst_unused:UNUSED_PAD src0_sel:DWORD src1_sel:DWORD
    v_lshlrev_b32_sdwa v64, 3, v64 dst_sel:WORD_0 dst_unused:UNUSED_PAD src0_sel:DWORD src1_sel:DWORD
    v_lshlrev_b32_sdwa v66, 3, v66 dst_sel:WORD_0 dst_unused:UNUSED_PAD src0_sel:DWORD src1_sel:DWORD
    s_cmp_lt_i32 s42, 2304
    s_cbranch_scc1 L_ufix_81
L_uback_82:

    v_subrev_co_u32 v20, s[72:73], 2.0, v20
    v_subrev_co_u32 v21, s[74:75], 2.0, v21
    v_subrev_co_u32 v22, s[76:77], 2.0, v22
    v_subrev_co_u32 v23, s[78:79], 2.0, v23
    s_mov_b64 exec, s[72:73]
    ds_read_b64 v[60:61], v60
    s_mov_b64 exec, s[74:75]
    ds_read_b64 v[62:63], v62
    s_mov_b64 exec, s[76:77]
    ds_read_b64 v[64:65], v64
    s_mov_b64 exec, s[78:79]
    ds_read_b64 v[66:67], v66
    s_mov_b64 exec, -1
    s_waitcnt lgkmcnt(4)
    v_or3_b32 v1, v68, v69, v1
    v_or3_b32 v1, v70, v71, v1
    v_or3_b32 v1, v72, v73, v1
    v_or3_b32 v1, v74, v75, v1
    s_waitcnt vmcnt(8)
    v_perm_b32 v68, v103, v102, s24
    v_perm_b32 v70, v104, v103, s25
    v_perm_b32 v72, v105, v104, s26
    v_perm_b32 v74, v113, v105, s27
    v_mov_b32 v24, v102
    v_alignbyte_b32 v25, v104, v103, 1
    v_alignbyte_b32 v26, v105, v104, 2
    v_alignbyte_b32 v27, v113, v105, 3
    v_lshlrev_b32_sdwa v68, 3, v68 dst_sel:WORD_0 dst_unused:UNUSED_PAD src0_sel:DWORD src1_sel:DWORD
    v_lshlrev_b32_sdwa v70, 3, v70 dst_sel:WORD_0 dst_unused:UNUSED_PAD src0_sel:DWORD src1_sel:DWORD
    v_lshlrev_b32_sdwa v72, 3, v72 dst_sel:WORD_0 dst_unused:UNUSED_PAD src0_sel:DWORD src1_sel:DWORD
    v_lshlrev_b32_sdwa v74, 3, v74 dst_sel:WORD_0 dst_unused:UNUSED_PAD src0_sel:DWORD src1_sel:DWORD
    s_cmp_lt_i32 s42, 2816
    s_cbranch_scc1 L_ufix_83
L_uback_84:

    v_subrev_co_u32 v24, s[80:81], 2.0, v24
    v_subrev_co_u32 v25, s[82:83], 2.0, v25
    v_subrev_co_u32 v26, s[84:85], 2.0, v26
    v_subrev_co_u32 v27, s[86:87], 2.0, v27
    s_mov_b64 exec, s[80:81]
    ds_read_b64 v[68:69], v68
    s_mov_b64 exec, s[82:83]
    ds_read_b64 v[70:71], v70
    s_mov_b64 exec, s[84:85]
    ds_read_b64 v[72:73], v72
    s_mov_b64 exec, s[86:87]
    ds_read_b64 v[74:75], v74
    s_mov_b64 exec, -1
    buffer_load_dwordx4 v[76:79], v3, s[12:15], s43 offen
    s_add_u32 s52, s43, 16384
    buffer_load_dwordx4 v[80:83], v3, s[12:15], s52 offen
    s_add_u32 s52, s43, 32768
    buffer_load_dwordx4 v[84:87], v3, s[12:15], s52 offen
    s_add_u32 s52, s43, 49152
    v_lshlrev_b32 v119, 2, v0
    buffer_load_dword v88, v119, s[12:15], s52 offen
    s_waitcnt vmcnt(10)
    v_perm_b32 v28, v5, v4, s24
    v_perm_b32 v30, v6, v5, s25
    v_perm_b32 v32, v7, v6, s26
    v_perm_b32 v34, v35, v7, s27
    v_alignbyte_b32 v5, v6, v5, 1
    v_alignbyte_b32 v6, v7, v6, 2
    v_alignbyte_b32 v7, v35, v7, 3
    v_lshlrev_b32_sdwa v28, 3, v28 dst_sel:WORD_0 dst_unused:UNUSED_PAD src0_sel:DWORD src1_sel:DWORD
    v_lshlrev_b32_sdwa v30, 3, v30 dst_sel:WORD_0 dst_unused:UNUSED_PAD src0_sel:DWORD src1_sel:DWORD
    v_lshlrev_b32_sdwa v32, 3, v32 dst_sel:WORD_0 dst_unused:UNUSED_PAD src0_sel:DWORD src1_sel:DWORD
    v_lshlrev_b32_sdwa v34, 3, v34 dst_sel:WORD_0 dst_unused:UNUSED_PAD src0_sel:DWORD src1_sel:DWORD
    s_cmp_lt_i32 s42, 256
    s_cbranch_scc1 L_ufix_85
L_uback_86:

    v_subrev_co_u32 v4, s[64:65], 2.0, v4
    v_subrev_co_u32 v5, s[66:67], 2.0, v5
    v_subrev_co_u32 v6, s[68:69], 2.0, v6
    v_subrev_co_u32 v7, s[70:71], 2.0, v7
    s_mov_b64 exec, s[64:65]
    ds_read_b64 v[28:29], v28
    s_mov_b64 exec, s[66:67]
    ds_read_b64 v[30:31], v30
    s_mov_b64 exec, s[68:69]
    ds_read_b64 v[32:33], v32
    s_mov_b64 exec, s[70:71]
    ds_read_b64 v[34:35], v34
    s_mov_b64 exec, -1
    s_waitcnt vmcnt(8)
    v_perm_b32 v36, v9, v8, s24
    v_perm_b32 v38, v10, v9, s25
    v_perm_b32 v40, v11, v10, s26
    v_perm_b32 v42, v43, v11, s27
    v_alignbyte_b32 v9, v10, v9, 1
    v_alignbyte_b32 v10, v11, v10, 2
    v_alignbyte_b32 v11, v43, v11, 3
    v_lshlrev_b32_sdwa v36, 3, v36 dst_sel:WORD_0 dst_unused:UNUSED_PAD src0_sel:DWORD src1_sel:DWORD
    v_lshlrev_b32_sdwa v38, 3, v38 dst_sel:WORD_0 dst_unused:UNUSED_PAD src0_sel:DWORD src1_sel:DWORD
    v_lshlrev_b32_sdwa v40, 3, v40 dst_sel:WORD_0 dst_unused:UNUSED_PAD src0_sel:DWORD src1_sel:DWORD
    v_lshlrev_b32_sdwa v42, 3, v42 dst_sel:WORD_0 dst_unused:UNUSED_PAD src0_sel:DWORD src1_sel:DWORD
    s_cmp_lt_i32 s42, 768
    s_cbranch_scc1 L_ufix_87
L_uback_88:

    v_subrev_co_u32 v8, s[72:73], 2.0, v8
    v_subrev_co_u32 v9, s[74:75], 2.0, v9
    v_subrev_co_u32 v10, s[76:77], 2.0, v10
    v_subrev_co_u32 v11, s[78:79], 2.0, v11
    s_mov_b64 exec, s[72:73]
    ds_read_b64 v[36:37], v36
    s_mov_b64 exec, s[74:75]
    ds_read_b64 v[38:39], v38
    s_mov_b64 exec, s[76:77]
    ds_read_b64 v[40:41], v40
    s_mov_b64 exec, s[78:79]
    ds_read_b64 v[42:43], v42
    s_mov_b64 exec, -1
    s_mov_b32 s38, s5
    s_add_u32 s50, s50, 200000
    s_branch L_batch_68
L_bend_69:

    s_load_dwordx2 s[64:65], s[0:1], 24
    s_load_dwordx2 s[86:87], s[0:1], 40
    s_load_dwordx8 s[88:95], s[0:1], 56
    s_mov_b32 s66, 1600000
    s_mov_b32 s67, 0x20000

    s_waitcnt lgkmcnt(15)
    v_mad_i32_i16 v120, v28, v4, s96
    v_mad_i32_i16 v28, v28, v4, s96 op_sel:[1,0,0,0]
    v_mad_i32_i16 v121, v29, v4, s96
    v_mad_i32_i16 v29, v29, v4, s96 op_sel:[1,0,0,0]
    v_lshlrev_b32_sdwa v4, 3, v4 dst_sel:DWORD dst_unused:UNUSED_PAD src0_sel:DWORD src1_sel:WORD_1
    v_perm_b32 v28, v28, v120, s97
    v_perm_b32 v29, v29, v121, s97
    v_lshl_add_u64 v[28:29], v[28:29], 0, s[30:31]

    ds_add_rtn_u64 v[28:29], v4, v[28:29] offset:50000
    v_mad_i32_i16 v122, v30, v5, s96
    v_mad_i32_i16 v30, v30, v5, s96 op_sel:[1,0,0,0]
    v_mad_i32_i16 v123, v31, v5, s96
    v_mad_i32_i16 v31, v31, v5, s96 op_sel:[1,0,0,0]
    v_lshlrev_b32_sdwa v5, 3, v5 dst_sel:DWORD dst_unused:UNUSED_PAD src0_sel:DWORD src1_sel:WORD_1
    v_perm_b32 v30, v30, v122, s97
    v_perm_b32 v31, v31, v123, s97
    v_lshl_add_u64 v[30:31], v[30:31], 0, s[30:31]

    ds_add_rtn_u64 v[30:31], v5, v[30:31] offset:50000
    v_mad_i32_i16 v124, v32, v6, s96
    v_mad_i32_i16 v32, v32, v6, s96 op_sel:[1,0,0,0]
    v_mad_i32_i16 v125, v33, v6, s96
    v_mad_i32_i16 v33, v33, v6, s96 op_sel:[1,0,0,0]
    v_lshlrev_b32_sdwa v6, 3, v6 dst_sel:DWORD dst_unused:UNUSED_PAD src0_sel:DWORD src1_sel:WORD_1
    v_perm_b32 v32, v32, v124, s97
    v_perm_b32 v33, v33, v125, s97
    v_lshl_add_u64 v[32:33], v[32:33], 0, s[30:31]

    ds_add_rtn_u64 v[32:33], v6, v[32:33] offset:50000
    v_mad_i32_i16 v126, v34, v7, s96
    v_mad_i32_i16 v34, v34, v7, s96 op_sel:[1,0,0,0]
    v_mad_i32_i16 v127, v35, v7, s96
    v_mad_i32_i16 v35, v35, v7, s96 op_sel:[1,0,0,0]
    v_lshlrev_b32_sdwa v7, 3, v7 dst_sel:DWORD dst_unused:UNUSED_PAD src0_sel:DWORD src1_sel:WORD_1
    v_perm_b32 v34, v34, v126, s97
    v_perm_b32 v35, v35, v127, s97
    v_lshl_add_u64 v[34:35], v[34:35], 0, s[30:31]

    ds_add_rtn_u64 v[34:35], v7, v[34:35] offset:50000
    v_mad_i32_i16 v120, v36, v8, s96
    v_mad_i32_i16 v36, v36, v8, s96 op_sel:[1,0,0,0]
    v_mad_i32_i16 v121, v37, v8, s96
    v_mad_i32_i16 v37, v37, v8, s96 op_sel:[1,0,0,0]
    v_lshlrev_b32_sdwa v8, 3, v8 dst_sel:DWORD dst_unused:UNUSED_PAD src0_sel:DWORD src1_sel:WORD_1
    v_perm_b32 v36, v36, v120, s97
    v_perm_b32 v37, v37, v121, s97
    v_lshl_add_u64 v[36:37], v[36:37], 0, s[30:31]

    ds_add_rtn_u64 v[36:37], v8, v[36:37] offset:50000
    v_mad_i32_i16 v122, v38, v9, s96
    v_mad_i32_i16 v38, v38, v9, s96 op_sel:[1,0,0,0]
    v_mad_i32_i16 v123, v39, v9, s96
    v_mad_i32_i16 v39, v39, v9, s96 op_sel:[1,0,0,0]
    v_lshlrev_b32_sdwa v9, 3, v9 dst_sel:DWORD dst_unused:UNUSED_PAD src0_sel:DWORD src1_sel:WORD_1
    v_perm_b32 v38, v38, v122, s97
    v_perm_b32 v39, v39, v123, s97
    v_lshl_add_u64 v[38:39], v[38:39], 0, s[30:31]

    ds_add_rtn_u64 v[38:39], v9, v[38:39] offset:50000
    v_mad_i32_i16 v124, v40, v10, s96
    v_mad_i32_i16 v40, v40, v10, s96 op_sel:[1,0,0,0]
    v_mad_i32_i16 v125, v41, v10, s96
    v_mad_i32_i16 v41, v41, v10, s96 op_sel:[1,0,0,0]
    v_lshlrev_b32_sdwa v10, 3, v10 dst_sel:DWORD dst_unused:UNUSED_PAD src0_sel:DWORD src1_sel:WORD_1
    v_perm_b32 v40, v40, v124, s97
    v_perm_b32 v41, v41, v125, s97
    v_lshl_add_u64 v[40:41], v[40:41], 0, s[30:31]

    ds_add_rtn_u64 v[40:41], v10, v[40:41] offset:50000
    v_mad_i32_i16 v126, v42, v11, s96
    v_mad_i32_i16 v42, v42, v11, s96 op_sel:[1,0,0,0]
    v_mad_i32_i16 v127, v43, v11, s96
    v_mad_i32_i16 v43, v43, v11, s96 op_sel:[1,0,0,0]
    v_lshlrev_b32_sdwa v11, 3, v11 dst_sel:DWORD dst_unused:UNUSED_PAD src0_sel:DWORD src1_sel:WORD_1
    v_perm_b32 v42, v42, v126, s97
    v_perm_b32 v43, v43, v127, s97
    v_lshl_add_u64 v[42:43], v[42:43], 0, s[30:31]

    ds_add_rtn_u64 v[42:43], v11, v[42:43] offset:50000
    s_waitcnt lgkmcnt(4)
    v_or3_b32 v1, v28, v29, v1
    v_or3_b32 v1, v30, v31, v1
    v_or3_b32 v1, v32, v33, v1
    v_or3_b32 v1, v34, v35, v1
    v_mad_i32_i16 v120, v44, v12, s96
    v_mad_i32_i16 v44, v44, v12, s96 op_sel:[1,0,0,0]
    v_mad_i32_i16 v121, v45, v12, s96
    v_mad_i32_i16 v45, v45, v12, s96 op_sel:[1,0,0,0]
    v_lshlrev_b32_sdwa v12, 3, v12 dst_sel:DWORD dst_unused:UNUSED_PAD src0_sel:DWORD src1_sel:WORD_1
    v_perm_b32 v44, v44, v120, s97
    v_perm_b32 v45, v45, v121, s97
    v_lshl_add_u64 v[44:45], v[44:45], 0, s[30:31]

    ds_add_rtn_u64 v[44:45], v12, v[44:45] offset:50000
    v_mad_i32_i16 v122, v46, v13, s96
    v_mad_i32_i16 v46, v46, v13, s96 op_sel:[1,0,0,0]
    v_mad_i32_i16 v123, v47, v13, s96
    v_mad_i32_i16 v47, v47, v13, s96 op_sel:[1,0,0,0]
    v_lshlrev_b32_sdwa v13, 3, v13 dst_sel:DWORD dst_unused:UNUSED_PAD src0_sel:DWORD src1_sel:WORD_1
    v_perm_b32 v46, v46, v122, s97
    v_perm_b32 v47, v47, v123, s97
    v_lshl_add_u64 v[46:47], v[46:47], 0, s[30:31]

    ds_add_rtn_u64 v[46:47], v13, v[46:47] offset:50000
    v_mad_i32_i16 v124, v48, v14, s96
    v_mad_i32_i16 v48, v48, v14, s96 op_sel:[1,0,0,0]
    v_mad_i32_i16 v125, v49, v14, s96
    v_mad_i32_i16 v49, v49, v14, s96 op_sel:[1,0,0,0]
    v_lshlrev_b32_sdwa v14, 3, v14 dst_sel:DWORD dst_unused:UNUSED_PAD src0_sel:DWORD src1_sel:WORD_1
    v_perm_b32 v48, v48, v124, s97
    v_perm_b32 v49, v49, v125, s97
    v_lshl_add_u64 v[48:49], v[48:49], 0, s[30:31]

    ds_add_rtn_u64 v[48:49], v14, v[48:49] offset:50000
    v_mad_i32_i16 v126, v50, v15, s96
    v_mad_i32_i16 v50, v50, v15, s96 op_sel:[1,0,0,0]
    v_mad_i32_i16 v127, v51, v15, s96
    v_mad_i32_i16 v51, v51, v15, s96 op_sel:[1,0,0,0]
    v_lshlrev_b32_sdwa v15, 3, v15 dst_sel:DWORD dst_unused:UNUSED_PAD src0_sel:DWORD src1_sel:WORD_1
    v_perm_b32 v50, v50, v126, s97
    v_perm_b32 v51, v51, v127, s97
    v_lshl_add_u64 v[50:51], v[50:51], 0, s[30:31]

    ds_add_rtn_u64 v[50:51], v15, v[50:51] offset:50000
    s_waitcnt lgkmcnt(4)
    v_or3_b32 v1, v36, v37, v1
    v_or3_b32 v1, v38, v39, v1
    v_or3_b32 v1, v40, v41, v1
    v_or3_b32 v1, v42, v43, v1
    v_mad_i32_i16 v120, v52, v16, s96
    v_mad_i32_i16 v52, v52, v16, s96 op_sel:[1,0,0,0]
    v_mad_i32_i16 v121, v53, v16, s96
    v_mad_i32_i16 v53, v53, v16, s96 op_sel:[1,0,0,0]
    v_lshlrev_b32_sdwa v16, 3, v16 dst_sel:DWORD dst_unused:UNUSED_PAD src0_sel:DWORD src1_sel:WORD_1
    v_perm_b32 v52, v52, v120, s97
    v_perm_b32 v53, v53, v121, s97
    v_lshl_add_u64 v[52:53], v[52:53], 0, s[30:31]

    ds_add_rtn_u64 v[52:53], v16, v[52:53] offset:50000
    v_mad_i32_i16 v122, v54, v17, s96
    v_mad_i32_i16 v54, v54, v17, s96 op_sel:[1,0,0,0]
    v_mad_i32_i16 v123, v55, v17, s96
    v_mad_i32_i16 v55, v55, v17, s96 op_sel:[1,0,0,0]
    v_lshlrev_b32_sdwa v17, 3, v17 dst_sel:DWORD dst_unused:UNUSED_PAD src0_sel:DWORD src1_sel:WORD_1
    v_perm_b32 v54, v54, v122, s97
    v_perm_b32 v55, v55, v123, s97
    v_lshl_add_u64 v[54:55], v[54:55], 0, s[30:31]

    ds_add_rtn_u64 v[54:55], v17, v[54:55] offset:50000
    v_mad_i32_i16 v124, v56, v18, s96
    v_mad_i32_i16 v56, v56, v18, s96 op_sel:[1,0,0,0]
    v_mad_i32_i16 v125, v57, v18, s96
    v_mad_i32_i16 v57, v57, v18, s96 op_sel:[1,0,0,0]
    v_lshlrev_b32_sdwa v18, 3, v18 dst_sel:DWORD dst_unused:UNUSED_PAD src0_sel:DWORD src1_sel:WORD_1
    v_perm_b32 v56, v56, v124, s97
    v_perm_b32 v57, v57, v125, s97
    v_lshl_add_u64 v[56:57], v[56:57], 0, s[30:31]

    ds_add_rtn_u64 v[56:57], v18, v[56:57] offset:50000
    v_mad_i32_i16 v126, v58, v19, s96
    v_mad_i32_i16 v58, v58, v19, s96 op_sel:[1,0,0,0]
    v_mad_i32_i16 v127, v59, v19, s96
    v_mad_i32_i16 v59, v59, v19, s96 op_sel:[1,0,0,0]
    v_lshlrev_b32_sdwa v19, 3, v19 dst_sel:DWORD dst_unused:UNUSED_PAD src0_sel:DWORD src1_sel:WORD_1
    v_perm_b32 v58, v58, v126, s97
    v_perm_b32 v59, v59, v127, s97
    v_lshl_add_u64 v[58:59], v[58:59], 0, s[30:31]

    ds_add_rtn_u64 v[58:59], v19, v[58:59] offset:50000
    s_waitcnt lgkmcnt(4)
    v_or3_b32 v1, v44, v45, v1
    v_or3_b32 v1, v46, v47, v1
    v_or3_b32 v1, v48, v49, v1
    v_or3_b32 v1, v50, v51, v1
    v_mad_i32_i16 v120, v60, v20, s96
    v_mad_i32_i16 v60, v60, v20, s96 op_sel:[1,0,0,0]
    v_mad_i32_i16 v121, v61, v20, s96
    v_mad_i32_i16 v61, v61, v20, s96 op_sel:[1,0,0,0]
    v_lshlrev_b32_sdwa v20, 3, v20 dst_sel:DWORD dst_unused:UNUSED_PAD src0_sel:DWORD src1_sel:WORD_1
    v_perm_b32 v60, v60, v120, s97
    v_perm_b32 v61, v61, v121, s97
    v_lshl_add_u64 v[60:61], v[60:61], 0, s[30:31]

    ds_add_rtn_u64 v[60:61], v20, v[60:61] offset:50000
    v_mad_i32_i16 v122, v62, v21, s96
    v_mad_i32_i16 v62, v62, v21, s96 op_sel:[1,0,0,0]
    v_mad_i32_i16 v123, v63, v21, s96
    v_mad_i32_i16 v63, v63, v21, s96 op_sel:[1,0,0,0]
    v_lshlrev_b32_sdwa v21, 3, v21 dst_sel:DWORD dst_unused:UNUSED_PAD src0_sel:DWORD src1_sel:WORD_1
    v_perm_b32 v62, v62, v122, s97
    v_perm_b32 v63, v63, v123, s97
    v_lshl_add_u64 v[62:63], v[62:63], 0, s[30:31]

    ds_add_rtn_u64 v[62:63], v21, v[62:63] offset:50000
    v_mad_i32_i16 v124, v64, v22, s96
    v_mad_i32_i16 v64, v64, v22, s96 op_sel:[1,0,0,0]
    v_mad_i32_i16 v125, v65, v22, s96
    v_mad_i32_i16 v65, v65, v22, s96 op_sel:[1,0,0,0]
    v_lshlrev_b32_sdwa v22, 3, v22 dst_sel:DWORD dst_unused:UNUSED_PAD src0_sel:DWORD src1_sel:WORD_1
    v_perm_b32 v64, v64, v124, s97
    v_perm_b32 v65, v65, v125, s97
    v_lshl_add_u64 v[64:65], v[64:65], 0, s[30:31]

    ds_add_rtn_u64 v[64:65], v22, v[64:65] offset:50000
    v_mad_i32_i16 v126, v66, v23, s96
    v_mad_i32_i16 v66, v66, v23, s96 op_sel:[1,0,0,0]
    v_mad_i32_i16 v127, v67, v23, s96
    v_mad_i32_i16 v67, v67, v23, s96 op_sel:[1,0,0,0]
    v_lshlrev_b32_sdwa v23, 3, v23 dst_sel:DWORD dst_unused:UNUSED_PAD src0_sel:DWORD src1_sel:WORD_1
    v_perm_b32 v66, v66, v126, s97
    v_perm_b32 v67, v67, v127, s97
    v_lshl_add_u64 v[66:67], v[66:67], 0, s[30:31]

    ds_add_rtn_u64 v[66:67], v23, v[66:67] offset:50000
    s_waitcnt lgkmcnt(4)
    v_or3_b32 v1, v52, v53, v1
    v_or3_b32 v1, v54, v55, v1
    v_or3_b32 v1, v56, v57, v1
    v_or3_b32 v1, v58, v59, v1
    v_mad_i32_i16 v120, v68, v24, s96
    v_mad_i32_i16 v68, v68, v24, s96 op_sel:[1,0,0,0]
    v_mad_i32_i16 v121, v69, v24, s96
    v_mad_i32_i16 v69, v69, v24, s96 op_sel:[1,0,0,0]
    v_lshlrev_b32_sdwa v24, 3, v24 dst_sel:DWORD dst_unused:UNUSED_PAD src0_sel:DWORD src1_sel:WORD_1
    v_perm_b32 v68, v68, v120, s97
    v_perm_b32 v69, v69, v121, s97
    v_lshl_add_u64 v[68:69], v[68:69], 0, s[30:31]

    ds_add_rtn_u64 v[68:69], v24, v[68:69] offset:50000
    v_mad_i32_i16 v122, v70, v25, s96
    v_mad_i32_i16 v70, v70, v25, s96 op_sel:[1,0,0,0]
    v_mad_i32_i16 v123, v71, v25, s96
    v_mad_i32_i16 v71, v71, v25, s96 op_sel:[1,0,0,0]
    v_lshlrev_b32_sdwa v25, 3, v25 dst_sel:DWORD dst_unused:UNUSED_PAD src0_sel:DWORD src1_sel:WORD_1
    v_perm_b32 v70, v70, v122, s97
    v_perm_b32 v71, v71, v123, s97
    v_lshl_add_u64 v[70:71], v[70:71], 0, s[30:31]

    ds_add_rtn_u64 v[70:71], v25, v[70:71] offset:50000
    v_mad_i32_i16 v124, v72, v26, s96
    v_mad_i32_i16 v72, v72, v26, s96 op_sel:[1,0,0,0]
    v_mad_i32_i16 v125, v73, v26, s96
    v_mad_i32_i16 v73, v73, v26, s96 op_sel:[1,0,0,0]
    v_lshlrev_b32_sdwa v26, 3, v26 dst_sel:DWORD dst_unused:UNUSED_PAD src0_sel:DWORD src1_sel:WORD_1
    v_perm_b32 v72, v72, v124, s97
    v_perm_b32 v73, v73, v125, s97
    v_lshl_add_u64 v[72:73], v[72:73], 0, s[30:31]

    ds_add_rtn_u64 v[72:73], v26, v[72:73] offset:50000
    v_mad_i32_i16 v126, v74, v27, s96
    v_mad_i32_i16 v74, v74, v27, s96 op_sel:[1,0,0,0]
    v_mad_i32_i16 v127, v75, v27, s96
    v_mad_i32_i16 v75, v75, v27, s96 op_sel:[1,0,0,0]
    v_lshlrev_b32_sdwa v27, 3, v27 dst_sel:DWORD dst_unused:UNUSED_PAD src0_sel:DWORD src1_sel:WORD_1
    v_perm_b32 v74, v74, v126, s97
    v_perm_b32 v75, v75, v127, s97
    v_lshl_add_u64 v[74:75], v[74:75], 0, s[30:31]

    ds_add_rtn_u64 v[74:75], v27, v[74:75] offset:50000
    s_waitcnt lgkmcnt(4)
    v_or3_b32 v1, v60, v61, v1
    v_or3_b32 v1, v62, v63, v1
    v_or3_b32 v1, v64, v65, v1
    v_or3_b32 v1, v66, v67, v1
    s_waitcnt lgkmcnt(0)
    v_or3_b32 v1, v68, v69, v1
    v_or3_b32 v1, v70, v71, v1
    v_or3_b32 v1, v72, v73, v1
    v_or3_b32 v1, v74, v75, v1
    s_waitcnt vmcnt(0)
    s_waitcnt lgkmcnt(0)
    s_load_dwordx4 s[28:31], s[86:87], 0
    s_load_dwordx16 s[68:83], s[88:89], 0
    s_load_dwordx8 s[12:19], s[92:93], 0
    s_load_dwordx8 s[56:63], s[94:95], 0
    s_mov_b64 s[48:49], s[90:91]
    s_load_dwordx16 s[84:99], s[48:49], 0

    s_mov_b32 s41, s37
    s_mul_i32 s3, s41, 3125
    s_add_u32 s5, s3, 3126
    s_add_u32 s3, s3, 1
    s_lshr_b32 s3, s3, 1
    s_lshr_b32 s5, s5, 1
    s_sub_u32 s5, s5, s3
    s_sub_u32 s5, s5, 782
    v_cmp_gt_u32 vcc, s5, v0
    s_mul_i32 s5, s36, 6250
    s_add_u32 s3, s3, s5
    v_add_u32 v6, s3, v0
    v_add_u32 v7, 782, v6
    v_mov_b32 v8, 0x2000000
    v_lshlrev_b32 v4, 4, v6
    v_cndmask_b32 v7, v8, v7, vcc
    v_lshlrev_b32 v6, 2, v6
    v_lshlrev_b32 v5, 4, v7
    v_lshlrev_b32 v7, 2, v7
    v_cmp_gt_u32 vcc, 782, v0
    s_mov_b64 exec, vcc
    s_cbranch_execz L_skld_92
    buffer_load_dword v6, v6, s[64:67], 0 offen
    buffer_load_dword v7, v7, s[64:67], 0 offen
    buffer_load_dwordx4 v[108:111], v4, s[8:11], 0 offen
    buffer_load_dwordx4 v[112:115], v5, s[8:11], 0 offen

L_skld_92:
    s_mov_b64 exec, -1
    s_barrier

    v_add_u32 v116, 50000, v3
    v_add_u32 v117, 115536, v3
    v_cmp_gt_u32 vcc, 106, v0

    v_mov_b32 v100, 0
    v_mov_b32 v101, 0
    v_mov_b32 v102, 0
    v_mov_b32 v103, 0
    ds_read_b128 v[76:79], v116 offset:0
    ds_read_b128 v[80:83], v116 offset:16384
    ds_read_b128 v[84:87], v116 offset:32768
    ds_read_b128 v[88:91], v116 offset:49152
    ds_read_b128 v[92:95], v117 offset:0
    ds_read_b128 v[96:99], v117 offset:16384
    s_mov_b64 exec, vcc
    ds_read_b128 v[100:103], v117 offset:32768
    s_mov_b64 exec, -1
    s_mul_i32 s3, s37, 6400000
    s_mul_i32 s5, s36, 100000
    s_add_u32 s3, s3, s5
    s_add_u32 s3, s3, 6799360

    s_add_u32 s20, s6, s3
    s_addc_u32 s21, s7, 0
    s_mov_b32 s22, 100000
    s_mov_b32 s23, 0x20000
    s_waitcnt lgkmcnt(6)
    s_mov_b32 s3, 0
    buffer_store_dwordx4 v[76:79], v3, s[20:23], s3 offen sc1
    s_waitcnt lgkmcnt(5)
    s_mov_b32 s3, 16384
    buffer_store_dwordx4 v[80:83], v3, s[20:23], s3 offen sc1
    s_waitcnt lgkmcnt(4)
    s_mov_b32 s3, 32768
    buffer_store_dwordx4 v[84:87], v3, s[20:23], s3 offen sc1
    s_waitcnt lgkmcnt(3)
    s_mov_b32 s3, 49152
    buffer_store_dwordx4 v[88:91], v3, s[20:23], s3 offen sc1
    s_waitcnt lgkmcnt(2)
    s_mov_b32 s3, 65536
    buffer_store_dwordx4 v[92:95], v3, s[20:23], s3 offen sc1
    s_waitcnt lgkmcnt(1)
    s_mov_b32 s3, 81920
    buffer_store_dwordx4 v[96:99], v3, s[20:23], s3 offen sc1
    s_waitcnt lgkmcnt(0)
    s_mov_b32 s3, 98304
    buffer_store_dwordx4 v[100:103], v3, s[20:23], s3 offen sc1
    v_or3_b32 v1, v76, v77, v1
    v_or3_b32 v1, v78, v79, v1
    v_or3_b32 v1, v80, v81, v1
    v_or3_b32 v1, v82, v83, v1
    v_or3_b32 v1, v84, v85, v1
    v_or3_b32 v1, v86, v87, v1
    v_or3_b32 v1, v88, v89, v1
    v_or3_b32 v1, v90, v91, v1
    v_or3_b32 v1, v92, v93, v1
    v_or3_b32 v1, v94, v95, v1
    v_or3_b32 v1, v96, v97, v1
    v_or3_b32 v1, v98, v99, v1
    v_or3_b32 v1, v100, v101, v1
    v_or3_b32 v1, v102, v103, v1
    v_and_b32 v1, 0x80008000, v1
    v_cmp_ne_u32 vcc, 0, v1
    v_mov_b32 v116, 150024
    v_mov_b32 v117, 1
    s_cbranch_vccz L_nf_89
    ds_write_b32 v116, v117
L_nf_89:
    s_mov_b32 s33, 1
    s_mov_b32 s42, 0
    v_cmp_gt_u32 vcc, 782, v0
    s_mov_b64 exec, vcc
    s_cbranch_execz L_p1end_94
    s_waitcnt vmcnt(9)
    s_branch L_lddone_91
L_fin_90:

    s_load_dwordx2 s[64:65], s[0:1], 24
    s_load_dwordx2 s[86:87], s[0:1], 40
    s_load_dwordx8 s[88:95], s[0:1], 56
    s_mov_b32 s66, 1600000
    s_mov_b32 s67, 0x20000

    s_waitcnt lgkmcnt(0)
    s_load_dwordx4 s[28:31], s[86:87], 0
    s_load_dwordx16 s[68:83], s[88:89], 0
    s_load_dwordx8 s[12:19], s[92:93], 0
    s_load_dwordx8 s[56:63], s[94:95], 0
    s_mov_b64 s[48:49], s[90:91]
    s_load_dwordx16 s[84:99], s[48:49], 0

    s_mov_b32 s42, 1
    s_mov_b32 s41, s37
L_qloop_93:
    s_mul_i32 s3, s41, 3125
    s_add_u32 s5, s3, 3126
    s_add_u32 s3, s3, 1
    s_lshr_b32 s3, s3, 1
    s_lshr_b32 s5, s5, 1
    s_sub_u32 s5, s5, s3
    s_sub_u32 s5, s5, 782
    v_cmp_gt_u32 vcc, s5, v0
    s_mul_i32 s5, s36, 6250
    s_add_u32 s3, s3, s5
    v_add_u32 v6, s3, v0
    v_add_u32 v7, 782, v6
    v_mov_b32 v8, 0x2000000
    v_lshlrev_b32 v4, 4, v6
    v_cndmask_b32 v7, v8, v7, vcc
    v_lshlrev_b32 v6, 2, v6
    v_lshlrev_b32 v5, 4, v7
    v_lshlrev_b32 v7, 2, v7
    v_cmp_gt_u32 vcc, 782, v0
    s_mov_b64 exec, vcc
    s_cbranch_execz L_p1end_94
    buffer_load_dword v6, v6, s[64:67], 0 offen
    buffer_load_dword v7, v7, s[64:67], 0 offen
    buffer_load_dwordx4 v[108:111], v4, s[8:11], 0 offen
    buffer_load_dwordx4 v[112:115], v5, s[8:11], 0 offen

    s_waitcnt vmcnt(2)
L_lddone_91:
    s_waitcnt lgkmcnt(0)
    v_lshlrev_b32 v8, 16, v6
    v_and_b32 v9, s32, v6
    v_lshlrev_b32 v10, 16, v7
    v_and_b32 v11, s32, v7

    s_lshl_b32 s52, s28, 16
    v_subrev_f32 v12, s52, v8
    v_subrev_f32 v20, s52, v9
    v_subrev_f32 v28, s52, v10
    v_subrev_f32 v36, s52, v11
    s_and_b32 s53, s28, s32
    v_subrev_f32 v13, s53, v8
    v_subrev_f32 v21, s53, v9
    v_subrev_f32 v29, s53, v10
    v_subrev_f32 v37, s53, v11
    s_lshl_b32 s52, s29, 16
    v_subrev_f32 v14, s52, v8
    v_subrev_f32 v22, s52, v9
    v_subrev_f32 v30, s52, v10
    v_subrev_f32 v38, s52, v11
    s_and_b32 s53, s29, s32
    v_subrev_f32 v15, s53, v8
    v_subrev_f32 v23, s53, v9
    v_subrev_f32 v31, s53, v10
    v_subrev_f32 v39, s53, v11
    s_lshl_b32 s52, s30, 16
    v_subrev_f32 v16, s52, v8
    v_subrev_f32 v24, s52, v9
    v_subrev_f32 v32, s52, v10
    v_subrev_f32 v40, s52, v11
    s_and_b32 s53, s30, s32
    v_subrev_f32 v17, s53, v8
    v_subrev_f32 v25, s53, v9
    v_subrev_f32 v33, s53, v10
    v_subrev_f32 v41, s53, v11
    s_lshl_b32 s52, s31, 16
    v_subrev_f32 v18, s52, v8
    v_subrev_f32 v26, s52, v9
    v_subrev_f32 v34, s52, v10
    v_subrev_f32 v42, s52, v11
    s_and_b32 s53, s31, s32
    v_subrev_f32 v19, s53, v8
    v_subrev_f32 v27, s53, v9
    v_subrev_f32 v35, s53, v10
    v_subrev_f32 v43, s53, v11
    v_cvt_pk_bf16_f32 v12, v12, v13
    v_cvt_pk_bf16_f32 v14, v14, v15
    v_cvt_pk_bf16_f32 v16, v16, v17
    v_cvt_pk_bf16_f32 v18, v18, v19
    v_cvt_pk_bf16_f32 v20, v20, v21
    v_cvt_pk_bf16_f32 v22, v22, v23
    v_cvt_pk_bf16_f32 v24, v24, v25
    v_cvt_pk_bf16_f32 v26, v26, v27
    v_cvt_pk_bf16_f32 v28, v28, v29
    v_cvt_pk_bf16_f32 v30, v30, v31
    v_cvt_pk_bf16_f32 v32, v32, v33
    v_cvt_pk_bf16_f32 v34, v34, v35
    v_cvt_pk_bf16_f32 v36, v36, v37
    v_cvt_pk_bf16_f32 v38, v38, v39
    v_cvt_pk_bf16_f32 v40, v40, v41
    v_cvt_pk_bf16_f32 v42, v42, v43
    v_and_b32 v13, s32, v12
    v_lshlrev_b32 v12, 16, v12
    v_and_b32 v15, s32, v14
    v_lshlrev_b32 v14, 16, v14
    v_and_b32 v17, s32, v16
    v_lshlrev_b32 v16, 16, v16
    v_and_b32 v19, s32, v18
    v_lshlrev_b32 v18, 16, v18
    v_and_b32 v21, s32, v20
    v_lshlrev_b32 v20, 16, v20
    v_and_b32 v23, s32, v22
    v_lshlrev_b32 v22, 16, v22
    v_and_b32 v25, s32, v24
    v_lshlrev_b32 v24, 16, v24
    v_and_b32 v27, s32, v26
    v_lshlrev_b32 v26, 16, v26
    v_and_b32 v29, s32, v28
    v_lshlrev_b32 v28, 16, v28
    v_and_b32 v31, s32, v30
    v_lshlrev_b32 v30, 16, v30
    v_and_b32 v33, s32, v32
    v_lshlrev_b32 v32, 16, v32
    v_and_b32 v35, s32, v34
    v_lshlrev_b32 v34, 16, v34
    v_and_b32 v37, s32, v36
    v_lshlrev_b32 v36, 16, v36
    v_and_b32 v39, s32, v38
    v_lshlrev_b32 v38, 16, v38
    v_and_b32 v41, s32, v40
    v_lshlrev_b32 v40, 16, v40
    v_and_b32 v43, s32, v42
    v_lshlrev_b32 v42, 16, v42
    v_mul_f32 v12, v12, v12
    v_mul_f32 v13, v13, v13
    v_mul_f32 v14, v14, v14
    v_mul_f32 v15, v15, v15
    v_mul_f32 v16, v16, v16
    v_mul_f32 v17, v17, v17
    v_mul_f32 v18, v18, v18
    v_mul_f32 v19, v19, v19
    v_mul_f32 v20, v20, v20
    v_mul_f32 v21, v21, v21
    v_mul_f32 v22, v22, v22
    v_mul_f32 v23, v23, v23
    v_mul_f32 v24, v24, v24
    v_mul_f32 v25, v25, v25
    v_mul_f32 v26, v26, v26
    v_mul_f32 v27, v27, v27
    v_mul_f32 v28, v28, v28
    v_mul_f32 v29, v29, v29
    v_mul_f32 v30, v30, v30
    v_mul_f32 v31, v31, v31
    v_mul_f32 v32, v32, v32
    v_mul_f32 v33, v33, v33
    v_mul_f32 v34, v34, v34
    v_mul_f32 v35, v35, v35
    v_mul_f32 v36, v36, v36
    v_mul_f32 v37, v37, v37
    v_mul_f32 v38, v38, v38
    v_mul_f32 v39, v39, v39
    v_mul_f32 v40, v40, v40
    v_mul_f32 v41, v41, v41
    v_mul_f32 v42, v42, v42
    v_mul_f32 v43, v43, v43
    v_cvt_pk_bf16_f32 v12, v12, v13
    v_cvt_pk_bf16_f32 v14, v14, v15
    v_cvt_pk_bf16_f32 v16, v16, v17
    v_cvt_pk_bf16_f32 v18, v18, v19
    v_cvt_pk_bf16_f32 v20, v20, v21
    v_cvt_pk_bf16_f32 v22, v22, v23
    v_cvt_pk_bf16_f32 v24, v24, v25
    v_cvt_pk_bf16_f32 v26, v26, v27
    v_cvt_pk_bf16_f32 v28, v28, v29
    v_cvt_pk_bf16_f32 v30, v30, v31
    v_cvt_pk_bf16_f32 v32, v32, v33
    v_cvt_pk_bf16_f32 v34, v34, v35
    v_cvt_pk_bf16_f32 v36, v36, v37
    v_cvt_pk_bf16_f32 v38, v38, v39
    v_cvt_pk_bf16_f32 v40, v40, v41
    v_cvt_pk_bf16_f32 v42, v42, v43
    v_and_b32 v13, s32, v12
    v_lshlrev_b32 v12, 16, v12
    v_and_b32 v15, s32, v14
    v_lshlrev_b32 v14, 16, v14
    v_and_b32 v17, s32, v16
    v_lshlrev_b32 v16, 16, v16
    v_and_b32 v19, s32, v18
    v_lshlrev_b32 v18, 16, v18
    v_and_b32 v21, s32, v20
    v_lshlrev_b32 v20, 16, v20
    v_and_b32 v23, s32, v22
    v_lshlrev_b32 v22, 16, v22
    v_and_b32 v25, s32, v24
    v_lshlrev_b32 v24, 16, v24
    v_and_b32 v27, s32, v26
    v_lshlrev_b32 v26, 16, v26
    v_and_b32 v29, s32, v28
    v_lshlrev_b32 v28, 16, v28
    v_and_b32 v31, s32, v30
    v_lshlrev_b32 v30, 16, v30
    v_and_b32 v33, s32, v32
    v_lshlrev_b32 v32, 16, v32
    v_and_b32 v35, s32, v34
    v_lshlrev_b32 v34, 16, v34
    v_and_b32 v37, s32, v36
    v_lshlrev_b32 v36, 16, v36
    v_and_b32 v39, s32, v38
    v_lshlrev_b32 v38, 16, v38
    v_and_b32 v41, s32, v40
    v_lshlrev_b32 v40, 16, v40
    v_and_b32 v43, s32, v42
    v_lshlrev_b32 v42, 16, v42
    v_mul_f32 v12, 0xc1200000, v12
    v_mul_f32 v13, 0xc1200000, v13
    v_mul_f32 v14, 0xc1200000, v14
    v_mul_f32 v15, 0xc1200000, v15
    v_mul_f32 v16, 0xc1200000, v16
    v_mul_f32 v17, 0xc1200000, v17
    v_mul_f32 v18, 0xc1200000, v18
    v_mul_f32 v19, 0xc1200000, v19
    v_mul_f32 v20, 0xc1200000, v20
    v_mul_f32 v21, 0xc1200000, v21
    v_mul_f32 v22, 0xc1200000, v22
    v_mul_f32 v23, 0xc1200000, v23
    v_mul_f32 v24, 0xc1200000, v24
    v_mul_f32 v25, 0xc1200000, v25
    v_mul_f32 v26, 0xc1200000, v26
    v_mul_f32 v27, 0xc1200000, v27
    v_mul_f32 v28, 0xc1200000, v28
    v_mul_f32 v29, 0xc1200000, v29
    v_mul_f32 v30, 0xc1200000, v30
    v_mul_f32 v31, 0xc1200000, v31
    v_mul_f32 v32, 0xc1200000, v32
    v_mul_f32 v33, 0xc1200000, v33
    v_mul_f32 v34, 0xc1200000, v34
    v_mul_f32 v35, 0xc1200000, v35
    v_mul_f32 v36, 0xc1200000, v36
    v_mul_f32 v37, 0xc1200000, v37
    v_mul_f32 v38, 0xc1200000, v38
    v_mul_f32 v39, 0xc1200000, v39
    v_mul_f32 v40, 0xc1200000, v40
    v_mul_f32 v41, 0xc1200000, v41
    v_mul_f32 v42, 0xc1200000, v42
    v_mul_f32 v43, 0xc1200000, v43
    v_cvt_pk_bf16_f32 v12, v12, v13
    v_cvt_pk_bf16_f32 v14, v14, v15
    v_cvt_pk_bf16_f32 v16, v16, v17
    v_cvt_pk_bf16_f32 v18, v18, v19
    v_cvt_pk_bf16_f32 v20, v20, v21
    v_cvt_pk_bf16_f32 v22, v22, v23
    v_cvt_pk_bf16_f32 v24, v24, v25
    v_cvt_pk_bf16_f32 v26, v26, v27
    v_cvt_pk_bf16_f32 v28, v28, v29
    v_cvt_pk_bf16_f32 v30, v30, v31
    v_cvt_pk_bf16_f32 v32, v32, v33
    v_cvt_pk_bf16_f32 v34, v34, v35
    v_cvt_pk_bf16_f32 v36, v36, v37
    v_cvt_pk_bf16_f32 v38, v38, v39
    v_cvt_pk_bf16_f32 v40, v40, v41
    v_cvt_pk_bf16_f32 v42, v42, v43
    v_and_b32 v13, s32, v12
    v_lshlrev_b32 v12, 16, v12
    v_and_b32 v15, s32, v14
    v_lshlrev_b32 v14, 16, v14
    v_and_b32 v17, s32, v16
    v_lshlrev_b32 v16, 16, v16
    v_and_b32 v19, s32, v18
    v_lshlrev_b32 v18, 16, v18
    v_and_b32 v21, s32, v20
    v_lshlrev_b32 v20, 16, v20
    v_and_b32 v23, s32, v22
    v_lshlrev_b32 v22, 16, v22
    v_and_b32 v25, s32, v24
    v_lshlrev_b32 v24, 16, v24
    v_and_b32 v27, s32, v26
    v_lshlrev_b32 v26, 16, v26
    v_and_b32 v29, s32, v28
    v_lshlrev_b32 v28, 16, v28
    v_and_b32 v31, s32, v30
    v_lshlrev_b32 v30, 16, v30
    v_and_b32 v33, s32, v32
    v_lshlrev_b32 v32, 16, v32
    v_and_b32 v35, s32, v34
    v_lshlrev_b32 v34, 16, v34
    v_and_b32 v37, s32, v36
    v_lshlrev_b32 v36, 16, v36
    v_and_b32 v39, s32, v38
    v_lshlrev_b32 v38, 16, v38
    v_and_b32 v41, s32, v40
    v_lshlrev_b32 v40, 16, v40
    v_and_b32 v43, s32, v42
    v_lshlrev_b32 v42, 16, v42
    v_mul_f32 v12, 0x3fb8aa3b, v12
    v_mul_f32 v13, 0x3fb8aa3b, v13
    v_mul_f32 v14, 0x3fb8aa3b, v14
    v_mul_f32 v15, 0x3fb8aa3b, v15
    v_mul_f32 v16, 0x3fb8aa3b, v16
    v_mul_f32 v17, 0x3fb8aa3b, v17
    v_mul_f32 v18, 0x3fb8aa3b, v18
    v_mul_f32 v19, 0x3fb8aa3b, v19
    v_mul_f32 v20, 0x3fb8aa3b, v20
    v_mul_f32 v21, 0x3fb8aa3b, v21
    v_mul_f32 v22, 0x3fb8aa3b, v22
    v_mul_f32 v23, 0x3fb8aa3b, v23
    v_mul_f32 v24, 0x3fb8aa3b, v24
    v_mul_f32 v25, 0x3fb8aa3b, v25
    v_mul_f32 v26, 0x3fb8aa3b, v26
    v_mul_f32 v27, 0x3fb8aa3b, v27
    v_mul_f32 v28, 0x3fb8aa3b, v28
    v_mul_f32 v29, 0x3fb8aa3b, v29
    v_mul_f32 v30, 0x3fb8aa3b, v30
    v_mul_f32 v31, 0x3fb8aa3b, v31
    v_mul_f32 v32, 0x3fb8aa3b, v32
    v_mul_f32 v33, 0x3fb8aa3b, v33
    v_mul_f32 v34, 0x3fb8aa3b, v34
    v_mul_f32 v35, 0x3fb8aa3b, v35
    v_mul_f32 v36, 0x3fb8aa3b, v36
    v_mul_f32 v37, 0x3fb8aa3b, v37
    v_mul_f32 v38, 0x3fb8aa3b, v38
    v_mul_f32 v39, 0x3fb8aa3b, v39
    v_mul_f32 v40, 0x3fb8aa3b, v40
    v_mul_f32 v41, 0x3fb8aa3b, v41
    v_mul_f32 v42, 0x3fb8aa3b, v42
    v_mul_f32 v43, 0x3fb8aa3b, v43
    v_exp_f32 v12, v12
    v_exp_f32 v13, v13
    v_exp_f32 v14, v14
    v_exp_f32 v15, v15
    v_exp_f32 v16, v16
    v_exp_f32 v17, v17
    v_exp_f32 v18, v18
    v_exp_f32 v19, v19
    v_exp_f32 v20, v20
    v_exp_f32 v21, v21
    v_exp_f32 v22, v22
    v_exp_f32 v23, v23
    v_exp_f32 v24, v24
    v_exp_f32 v25, v25
    v_exp_f32 v26, v26
    v_exp_f32 v27, v27
    v_exp_f32 v28, v28
    v_exp_f32 v29, v29
    v_exp_f32 v30, v30
    v_exp_f32 v31, v31
    v_exp_f32 v32, v32
    v_exp_f32 v33, v33
    v_exp_f32 v34, v34
    v_exp_f32 v35, v35
    v_exp_f32 v36, v36
    v_exp_f32 v37, v37
    v_exp_f32 v38, v38
    v_exp_f32 v39, v39
    v_exp_f32 v40, v40
    v_exp_f32 v41, v41
    v_exp_f32 v42, v42
    v_exp_f32 v43, v43
    s_nop 0
    v_cvt_pk_bf16_f32 v12, v12, v13
    v_cvt_pk_bf16_f32 v14, v14, v15
    v_cvt_pk_bf16_f32 v16, v16, v17
    v_cvt_pk_bf16_f32 v18, v18, v19
    v_cvt_pk_bf16_f32 v20, v20, v21
    v_cvt_pk_bf16_f32 v22, v22, v23
    v_cvt_pk_bf16_f32 v24, v24, v25
    v_cvt_pk_bf16_f32 v26, v26, v27
    v_cvt_pk_bf16_f32 v28, v28, v29
    v_cvt_pk_bf16_f32 v30, v30, v31
    v_cvt_pk_bf16_f32 v32, v32, v33
    v_cvt_pk_bf16_f32 v34, v34, v35
    v_cvt_pk_bf16_f32 v36, v36, v37
    v_cvt_pk_bf16_f32 v38, v38, v39
    v_cvt_pk_bf16_f32 v40, v40, v41
    v_cvt_pk_bf16_f32 v42, v42, v43
L_p1end_94:
    s_mov_b64 exec, -1
    s_cmp_eq_u32 s42, 2
    s_cbranch_scc1 L_part2_95
    s_waitcnt vmcnt(0) lgkmcnt(0)
    s_barrier
    s_cmp_lg_u32 s42, 0
    s_cbranch_scc1 L_nochk_101
    v_mov_b32 v116, 150024
    ds_read_b32 v117, v116
    s_waitcnt lgkmcnt(0)
    v_readfirstlane_b32 s3, v117
    s_nop 1
    s_cmp_lg_u32 s3, 0
    s_cbranch_scc1 L_p2slow_55
L_nochk_101:

    s_load_dwordx2 s[24:25], s[0:1], 88
    s_load_dwordx2 s[44:45], s[0:1], 96
    s_mov_b32 s26, 6400000
    s_mov_b32 s27, 0x20000
    s_movk_i32 s46, 256
    s_mov_b32 s47, 0x20000
    s_lshl_b32 s50, s36, 2
    v_and_b32 v116, 63, v0
    v_lshlrev_b32 v116, 20, v116

    s_add_u32 s20, s6, 6799360
    s_addc_u32 s21, s7, 0
    s_mov_b32 s22, 76800000
    s_mov_b32 s23, 0x20000
    v_readfirstlane_b32 s3, v0
    s_waitcnt lgkmcnt(0)
    s_cmp_eq_u32 s3, 960
    s_cbranch_scc1 L_sync_102
L_part2_95:
    v_cmp_gt_u32 vcc, 782, v0
    s_mov_b64 exec, vcc
    s_cbranch_execz L_p2end_96

    s_pack_ll_b32_b16 s52, s68, s70
    v_dot2_f32_bf16 v60, v12, s52, 0
    v_dot2_f32_bf16 v64, v20, s52, 0
    v_dot2_f32_bf16 v68, v28, s52, 0
    v_dot2_f32_bf16 v72, v36, s52, 0
    s_pack_hh_b32_b16 s53, s68, s70
    v_dot2_f32_bf16 v61, v12, s53, 0
    v_dot2_f32_bf16 v65, v20, s53, 0
    v_dot2_f32_bf16 v69, v28, s53, 0
    v_dot2_f32_bf16 v73, v36, s53, 0
    s_pack_ll_b32_b16 s52, s69, s71
    v_dot2_f32_bf16 v62, v12, s52, 0
    v_dot2_f32_bf16 v66, v20, s52, 0
    v_dot2_f32_bf16 v70, v28, s52, 0
    v_dot2_f32_bf16 v74, v36, s52, 0
    s_pack_hh_b32_b16 s53, s69, s71
    v_dot2_f32_bf16 v63, v12, s53, 0
    v_dot2_f32_bf16 v67, v20, s53, 0
    v_dot2_f32_bf16 v71, v28, s53, 0
    v_dot2_f32_bf16 v75, v36, s53, 0
    s_pack_ll_b32_b16 s52, s72, s74
    v_dot2_f32_bf16 v60, v14, s52, v60
    v_dot2_f32_bf16 v64, v22, s52, v64
    v_dot2_f32_bf16 v68, v30, s52, v68
    v_dot2_f32_bf16 v72, v38, s52, v72
    s_pack_hh_b32_b16 s53, s72, s74
    v_dot2_f32_bf16 v61, v14, s53, v61
    v_dot2_f32_bf16 v65, v22, s53, v65
    v_dot2_f32_bf16 v69, v30, s53, v69
    v_dot2_f32_bf16 v73, v38, s53, v73
    s_pack_ll_b32_b16 s52, s73, s75
    v_dot2_f32_bf16 v62, v14, s52, v62
    v_dot2_f32_bf16 v66, v22, s52, v66
    v_dot2_f32_bf16 v70, v30, s52, v70
    v_dot2_f32_bf16 v74, v38, s52, v74
    s_pack_hh_b32_b16 s53, s73, s75
    v_dot2_f32_bf16 v63, v14, s53, v63
    v_dot2_f32_bf16 v67, v22, s53, v67
    v_dot2_f32_bf16 v71, v30, s53, v71
    v_dot2_f32_bf16 v75, v38, s53, v75
    s_pack_ll_b32_b16 s52, s76, s78
    v_dot2_f32_bf16 v60, v16, s52, v60
    v_dot2_f32_bf16 v64, v24, s52, v64
    v_dot2_f32_bf16 v68, v32, s52, v68
    v_dot2_f32_bf16 v72, v40, s52, v72
    s_pack_hh_b32_b16 s53, s76, s78
    v_dot2_f32_bf16 v61, v16, s53, v61
    v_dot2_f32_bf16 v65, v24, s53, v65
    v_dot2_f32_bf16 v69, v32, s53, v69
    v_dot2_f32_bf16 v73, v40, s53, v73
    s_pack_ll_b32_b16 s52, s77, s79
    v_dot2_f32_bf16 v62, v16, s52, v62
    v_dot2_f32_bf16 v66, v24, s52, v66
    v_dot2_f32_bf16 v70, v32, s52, v70
    v_dot2_f32_bf16 v74, v40, s52, v74
    s_pack_hh_b32_b16 s53, s77, s79
    v_dot2_f32_bf16 v63, v16, s53, v63
    v_dot2_f32_bf16 v67, v24, s53, v67
    v_dot2_f32_bf16 v71, v32, s53, v71
    v_dot2_f32_bf16 v75, v40, s53, v75
    s_pack_ll_b32_b16 s52, s80, s82
    v_dot2_f32_bf16 v60, v18, s52, v60
    v_dot2_f32_bf16 v64, v26, s52, v64
    v_dot2_f32_bf16 v68, v34, s52, v68
    v_dot2_f32_bf16 v72, v42, s52, v72
    s_pack_hh_b32_b16 s53, s80, s82
    v_dot2_f32_bf16 v61, v18, s53, v61
    v_dot2_f32_bf16 v65, v26, s53, v65
    v_dot2_f32_bf16 v69, v34, s53, v69
    v_dot2_f32_bf16 v73, v42, s53, v73
    s_pack_ll_b32_b16 s52, s81, s83
    v_dot2_f32_bf16 v62, v18, s52, v62
    v_dot2_f32_bf16 v66, v26, s52, v66
    v_dot2_f32_bf16 v70, v34, s52, v70
    v_dot2_f32_bf16 v74, v42, s52, v74
    s_pack_hh_b32_b16 s53, s81, s83
    v_dot2_f32_bf16 v63, v18, s53, v63
    v_dot2_f32_bf16 v67, v26, s53, v67
    v_dot2_f32_bf16 v71, v34, s53, v71
    v_dot2_f32_bf16 v75, v42, s53, v75
    s_pack_ll_b32_b16 s52, s84, s86
    v_dot2_f32_bf16 v44, v12, s52, 0
    v_dot2_f32_bf16 v48, v20, s52, 0
    v_dot2_f32_bf16 v52, v28, s52, 0
    v_dot2_f32_bf16 v56, v36, s52, 0
    s_pack_hh_b32_b16 s53, s84, s86
    v_dot2_f32_bf16 v45, v12, s53, 0
    v_dot2_f32_bf16 v49, v20, s53, 0
    v_dot2_f32_bf16 v53, v28, s53, 0
    v_dot2_f32_bf16 v57, v36, s53, 0
    s_pack_ll_b32_b16 s52, s85, s87
    v_dot2_f32_bf16 v46, v12, s52, 0
    v_dot2_f32_bf16 v50, v20, s52, 0
    v_dot2_f32_bf16 v54, v28, s52, 0
    v_dot2_f32_bf16 v58, v36, s52, 0
    s_pack_hh_b32_b16 s53, s85, s87
    v_dot2_f32_bf16 v47, v12, s53, 0
    v_dot2_f32_bf16 v51, v20, s53, 0
    v_dot2_f32_bf16 v55, v28, s53, 0
    v_dot2_f32_bf16 v59, v36, s53, 0
    s_pack_ll_b32_b16 s52, s88, s90
    v_dot2_f32_bf16 v44, v14, s52, v44
    v_dot2_f32_bf16 v48, v22, s52, v48
    v_dot2_f32_bf16 v52, v30, s52, v52
    v_dot2_f32_bf16 v56, v38, s52, v56
    s_pack_hh_b32_b16 s53, s88, s90
    v_dot2_f32_bf16 v45, v14, s53, v45
    v_dot2_f32_bf16 v49, v22, s53, v49
    v_dot2_f32_bf16 v53, v30, s53, v53
    v_dot2_f32_bf16 v57, v38, s53, v57
    s_pack_ll_b32_b16 s52, s89, s91
    v_dot2_f32_bf16 v46, v14, s52, v46
    v_dot2_f32_bf16 v50, v22, s52, v50
    v_dot2_f32_bf16 v54, v30, s52, v54
    v_dot2_f32_bf16 v58, v38, s52, v58
    s_pack_hh_b32_b16 s53, s89, s91
    v_dot2_f32_bf16 v47, v14, s53, v47
    v_dot2_f32_bf16 v51, v22, s53, v51
    v_dot2_f32_bf16 v55, v30, s53, v55
    v_dot2_f32_bf16 v59, v38, s53, v59
    s_pack_ll_b32_b16 s52, s92, s94
    v_dot2_f32_bf16 v44, v16, s52, v44
    v_dot2_f32_bf16 v48, v24, s52, v48
    v_dot2_f32_bf16 v52, v32, s52, v52
    v_dot2_f32_bf16 v56, v40, s52, v56
    s_pack_hh_b32_b16 s53, s92, s94
    v_dot2_f32_bf16 v45, v16, s53, v45
    v_dot2_f32_bf16 v49, v24, s53, v49
    v_dot2_f32_bf16 v53, v32, s53, v53
    v_dot2_f32_bf16 v57, v40, s53, v57
    s_pack_ll_b32_b16 s52, s93, s95
    v_dot2_f32_bf16 v46, v16, s52, v46
    v_dot2_f32_bf16 v50, v24, s52, v50
    v_dot2_f32_bf16 v54, v32, s52, v54
    v_dot2_f32_bf16 v58, v40, s52, v58
    s_pack_hh_b32_b16 s53, s93, s95
    v_dot2_f32_bf16 v47, v16, s53, v47
    v_dot2_f32_bf16 v51, v24, s53, v51
    v_dot2_f32_bf16 v55, v32, s53, v55
    v_dot2_f32_bf16 v59, v40, s53, v59
    s_pack_ll_b32_b16 s52, s96, s98
    v_dot2_f32_bf16 v44, v18, s52, v44
    v_dot2_f32_bf16 v48, v26, s52, v48
    v_dot2_f32_bf16 v52, v34, s52, v52
    v_dot2_f32_bf16 v56, v42, s52, v56
    s_pack_hh_b32_b16 s53, s96, s98
    v_dot2_f32_bf16 v45, v18, s53, v45
    v_dot2_f32_bf16 v49, v26, s53, v49
    v_dot2_f32_bf16 v53, v34, s53, v53
    v_dot2_f32_bf16 v57, v42, s53, v57
    s_pack_ll_b32_b16 s52, s97, s99
    v_dot2_f32_bf16 v46, v18, s52, v46
    v_dot2_f32_bf16 v50, v26, s52, v50
    v_dot2_f32_bf16 v54, v34, s52, v54
    v_dot2_f32_bf16 v58, v42, s52, v58
    s_pack_hh_b32_b16 s53, s97, s99
    v_dot2_f32_bf16 v47, v18, s53, v47
    v_dot2_f32_bf16 v51, v26, s53, v51
    v_dot2_f32_bf16 v55, v34, s53, v55
    v_dot2_f32_bf16 v59, v42, s53, v59
    v_cvt_pk_bf16_f32 v60, v60, v61
    v_cvt_pk_bf16_f32 v62, v62, v63
    v_cvt_pk_bf16_f32 v64, v64, v65
    v_cvt_pk_bf16_f32 v66, v66, v67
    v_cvt_pk_bf16_f32 v68, v68, v69
    v_cvt_pk_bf16_f32 v70, v70, v71
    v_cvt_pk_bf16_f32 v72, v72, v73
    v_cvt_pk_bf16_f32 v74, v74, v75
    v_and_b32 v61, s32, v60
    v_lshlrev_b32 v60, 16, v60
    v_and_b32 v63, s32, v62
    v_lshlrev_b32 v62, 16, v62
    v_and_b32 v65, s32, v64
    v_lshlrev_b32 v64, 16, v64
    v_and_b32 v67, s32, v66
    v_lshlrev_b32 v66, 16, v66
    v_and_b32 v69, s32, v68
    v_lshlrev_b32 v68, 16, v68
    v_and_b32 v71, s32, v70
    v_lshlrev_b32 v70, 16, v70
    v_and_b32 v73, s32, v72
    v_lshlrev_b32 v72, 16, v72
    v_and_b32 v75, s32, v74
    v_lshlrev_b32 v74, 16, v74
L_p2end_96:
    s_mov_b64 exec, -1
    s_cmp_eq_u32 s42, 2
    s_cbranch_scc1 L_post_99
L_bcast_97:
    v_mov_b32 v118, 150016
    s_mov_b32 s42, 2
    s_waitcnt lgkmcnt(0)
    s_barrier
    ds_read_b32 v117, v118
    s_waitcnt lgkmcnt(0)
    v_readfirstlane_b32 s35, v117
    s_nop 1
    s_bitcmp1_b32 s35, 16
    s_cbranch_scc1 L_nextq_98
L_post_99:
    v_cmp_gt_u32 vcc, 782, v0
    s_mov_b64 exec, vcc
    s_cbranch_execz L_postend_100

    s_mov_b32 s3, 0
    buffer_load_dwordx4 v[76:79], v4, s[20:23], s3 offen sc1
    buffer_load_dwordx4 v[92:95], v5, s[20:23], s3 offen sc1
    s_mov_b32 s3, 6400000
    buffer_load_dwordx4 v[80:83], v4, s[20:23], s3 offen sc1
    buffer_load_dwordx4 v[96:99], v5, s[20:23], s3 offen sc1
    s_mov_b32 s3, 12800000
    buffer_load_dwordx4 v[84:87], v4, s[20:23], s3 offen sc1
    buffer_load_dwordx4 v[100:103], v5, s[20:23], s3 offen sc1
    s_mov_b32 s3, 19200000
    buffer_load_dwordx4 v[88:91], v4, s[20:23], s3 offen sc1
    buffer_load_dwordx4 v[104:107], v5, s[20:23], s3 offen sc1
    s_and_b32 s3, s35, 0xf0
    s_cbranch_scc1 L_fgen_106
    s_waitcnt vmcnt(0)

    v_add_u32 v76, v76, v80
    v_add_u32 v84, v84, v88
    v_add_u32 v77, v77, v81
    v_add_u32 v85, v85, v89
    v_add_u32 v78, v78, v82
    v_add_u32 v86, v86, v90
    v_add_u32 v79, v79, v83
    v_add_u32 v87, v87, v91
    v_add_u32_sdwa v12, v76, v84 dst_sel:DWORD dst_unused:UNUSED_PAD src0_sel:WORD_0 src1_sel:WORD_0
    v_add_u32_sdwa v13, v76, v84 dst_sel:DWORD dst_unused:UNUSED_PAD src0_sel:WORD_1 src1_sel:WORD_1
    v_add_u32_sdwa v14, v77, v85 dst_sel:DWORD dst_unused:UNUSED_PAD src0_sel:WORD_0 src1_sel:WORD_0
    v_add_u32_sdwa v15, v77, v85 dst_sel:DWORD dst_unused:UNUSED_PAD src0_sel:WORD_1 src1_sel:WORD_1
    v_add_u32_sdwa v16, v78, v86 dst_sel:DWORD dst_unused:UNUSED_PAD src0_sel:WORD_0 src1_sel:WORD_0
    v_add_u32_sdwa v17, v78, v86 dst_sel:DWORD dst_unused:UNUSED_PAD src0_sel:WORD_1 src1_sel:WORD_1
    v_add_u32_sdwa v18, v79, v87 dst_sel:DWORD dst_unused:UNUSED_PAD src0_sel:WORD_0 src1_sel:WORD_0
    v_add_u32_sdwa v19, v79, v87 dst_sel:DWORD dst_unused:UNUSED_PAD src0_sel:WORD_1 src1_sel:WORD_1
    v_add_u32 v92, v92, v96
    v_add_u32 v100, v100, v104
    v_add_u32 v93, v93, v97
    v_add_u32 v101, v101, v105
    v_add_u32 v94, v94, v98
    v_add_u32 v102, v102, v106
    v_add_u32 v95, v95, v99
    v_add_u32 v103, v103, v107
    v_add_u32_sdwa v20, v92, v100 dst_sel:DWORD dst_unused:UNUSED_PAD src0_sel:WORD_0 src1_sel:WORD_0
    v_add_u32_sdwa v21, v92, v100 dst_sel:DWORD dst_unused:UNUSED_PAD src0_sel:WORD_1 src1_sel:WORD_1
    v_add_u32_sdwa v22, v93, v101 dst_sel:DWORD dst_unused:UNUSED_PAD src0_sel:WORD_0 src1_sel:WORD_0
    v_add_u32_sdwa v23, v93, v101 dst_sel:DWORD dst_unused:UNUSED_PAD src0_sel:WORD_1 src1_sel:WORD_1
    v_add_u32_sdwa v24, v94, v102 dst_sel:DWORD dst_unused:UNUSED_PAD src0_sel:WORD_0 src1_sel:WORD_0
    v_add_u32_sdwa v25, v94, v102 dst_sel:DWORD dst_unused:UNUSED_PAD src0_sel:WORD_1 src1_sel:WORD_1
    v_add_u32_sdwa v26, v95, v103 dst_sel:DWORD dst_unused:UNUSED_PAD src0_sel:WORD_0 src1_sel:WORD_0
    v_add_u32_sdwa v27, v95, v103 dst_sel:DWORD dst_unused:UNUSED_PAD src0_sel:WORD_1 src1_sel:WORD_1
    v_add_u32 v12, 0xffff0000, v12
    v_add_u32 v13, 0xffff0000, v13
    v_add_u32 v14, 0xffff0000, v14
    v_add_u32 v15, 0xffff0000, v15
    v_add_u32 v16, 0xffff0000, v16
    v_add_u32 v17, 0xffff0000, v17
    v_add_u32 v18, 0xffff0000, v18
    v_add_u32 v19, 0xffff0000, v19
    v_add_u32 v20, 0xffff0000, v20
    v_add_u32 v21, 0xffff0000, v21
    v_add_u32 v22, 0xffff0000, v22
    v_add_u32 v23, 0xffff0000, v23
    v_add_u32 v24, 0xffff0000, v24
    v_add_u32 v25, 0xffff0000, v25
    v_add_u32 v26, 0xffff0000, v26
    v_add_u32 v27, 0xffff0000, v27
    v_cvt_f32_i32 v12, v12
    v_cvt_f32_i32 v13, v13
    v_cvt_f32_i32 v14, v14
    v_cvt_f32_i32 v15, v15
    v_cvt_f32_i32 v16, v16
    v_cvt_f32_i32 v17, v17
    v_cvt_f32_i32 v18, v18
    v_cvt_f32_i32 v19, v19
    v_cvt_f32_i32 v20, v20
    v_cvt_f32_i32 v21, v21
    v_cvt_f32_i32 v22, v22
    v_cvt_f32_i32 v23, v23
    v_cvt_f32_i32 v24, v24
    v_cvt_f32_i32 v25, v25
    v_cvt_f32_i32 v26, v26
    v_cvt_f32_i32 v27, v27
    v_mul_f32 v12, s34, v12
    v_mul_f32 v13, s34, v13
    v_mul_f32 v14, s34, v14
    v_mul_f32 v15, s34, v15
    v_mul_f32 v16, s34, v16
    v_mul_f32 v17, s34, v17
    v_mul_f32 v18, s34, v18
    v_mul_f32 v19, s34, v19
    v_mul_f32 v20, s34, v20
    v_mul_f32 v21, s34, v21
    v_mul_f32 v22, s34, v22
    v_mul_f32 v23, s34, v23
    v_mul_f32 v24, s34, v24
    v_mul_f32 v25, s34, v25
    v_mul_f32 v26, s34, v26
    v_mul_f32 v27, s34, v27
L_fbk_107:
    s_lshl_b32 s52, s12, 16
    v_mul_f32 v28, s52, v12
    v_mul_f32 v32, s52, v16
    v_mul_f32 v36, s52, v20
    v_mul_f32 v40, s52, v24
    s_and_b32 s53, s12, s32
    v_mul_f32 v29, s53, v12
    v_mul_f32 v33, s53, v16
    v_mul_f32 v37, s53, v20
    v_mul_f32 v41, s53, v24
    s_lshl_b32 s52, s13, 16
    v_mul_f32 v30, s52, v12
    v_mul_f32 v34, s52, v16
    v_mul_f32 v38, s52, v20
    v_mul_f32 v42, s52, v24
    s_and_b32 s53, s13, s32
    v_mul_f32 v31, s53, v12
    v_mul_f32 v35, s53, v16
    v_mul_f32 v39, s53, v20
    v_mul_f32 v43, s53, v24
    s_lshl_b32 s52, s14, 16
    v_fmac_f32 v28, s52, v13
    v_fmac_f32 v32, s52, v17
    v_fmac_f32 v36, s52, v21
    v_fmac_f32 v40, s52, v25
    s_and_b32 s53, s14, s32
    v_fmac_f32 v29, s53, v13
    v_fmac_f32 v33, s53, v17
    v_fmac_f32 v37, s53, v21
    v_fmac_f32 v41, s53, v25
    s_lshl_b32 s52, s15, 16
    v_fmac_f32 v30, s52, v13
    v_fmac_f32 v34, s52, v17
    v_fmac_f32 v38, s52, v21
    v_fmac_f32 v42, s52, v25
    s_and_b32 s53, s15, s32
    v_fmac_f32 v31, s53, v13
    v_fmac_f32 v35, s53, v17
    v_fmac_f32 v39, s53, v21
    v_fmac_f32 v43, s53, v25
    s_lshl_b32 s52, s16, 16
    v_fmac_f32 v28, s52, v14
    v_fmac_f32 v32, s52, v18
    v_fmac_f32 v36, s52, v22
    v_fmac_f32 v40, s52, v26
    s_and_b32 s53, s16, s32
    v_fmac_f32 v29, s53, v14
    v_fmac_f32 v33, s53, v18
    v_fmac_f32 v37, s53, v22
    v_fmac_f32 v41, s53, v26
    s_lshl_b32 s52, s17, 16
    v_fmac_f32 v30, s52, v14
    v_fmac_f32 v34, s52, v18
    v_fmac_f32 v38, s52, v22
    v_fmac_f32 v42, s52, v26
    s_and_b32 s53, s17, s32
    v_fmac_f32 v31, s53, v14
    v_fmac_f32 v35, s53, v18
    v_fmac_f32 v39, s53, v22
    v_fmac_f32 v43, s53, v26
    s_lshl_b32 s52, s18, 16
    v_fmac_f32 v28, s52, v15
    v_fmac_f32 v32, s52, v19
    v_fmac_f32 v36, s52, v23
    v_fmac_f32 v40, s52, v27
    s_and_b32 s53, s18, s32
    v_fmac_f32 v29, s53, v15
    v_fmac_f32 v33, s53, v19
    v_fmac_f32 v37, s53, v23
    v_fmac_f32 v41, s53, v27
    s_lshl_b32 s52, s19, 16
    v_fmac_f32 v30, s52, v15
    v_fmac_f32 v34, s52, v19
    v_fmac_f32 v38, s52, v23
    v_fmac_f32 v42, s52, v27
    s_and_b32 s53, s19, s32
    v_fmac_f32 v31, s53, v15
    v_fmac_f32 v35, s53, v19
    v_fmac_f32 v39, s53, v23
    v_fmac_f32 v43, s53, v27
    v_mul_f32 v28, v28, v44
    v_mul_f32 v29, v29, v45
    v_mul_f32 v30, v30, v46
    v_mul_f32 v31, v31, v47
    v_mul_f32 v32, v32, v48
    v_mul_f32 v33, v33, v49
    v_mul_f32 v34, v34, v50
    v_mul_f32 v35, v35, v51
    v_mul_f32 v36, v36, v52
    v_mul_f32 v37, v37, v53
    v_mul_f32 v38, v38, v54
    v_mul_f32 v39, v39, v55
    v_mul_f32 v40, v40, v56
    v_mul_f32 v41, v41, v57
    v_mul_f32 v42, v42, v58
    v_mul_f32 v43, v43, v59
    v_cvt_pk_bf16_f32 v28, v28, v29
    v_cvt_pk_bf16_f32 v30, v30, v31
    v_cvt_pk_bf16_f32 v32, v32, v33
    v_cvt_pk_bf16_f32 v34, v34, v35
    v_cvt_pk_bf16_f32 v36, v36, v37
    v_cvt_pk_bf16_f32 v38, v38, v39
    v_cvt_pk_bf16_f32 v40, v40, v41
    v_cvt_pk_bf16_f32 v42, v42, v43
    s_pack_ll_b32_b16 s52, s56, s58
    v_dot2_f32_bf16 v12, v28, s52, 0
    v_dot2_f32_bf16 v16, v32, s52, 0
    v_dot2_f32_bf16 v20, v36, s52, 0
    v_dot2_f32_bf16 v24, v40, s52, 0
    s_pack_hh_b32_b16 s53, s56, s58
    v_dot2_f32_bf16 v13, v28, s53, 0
    v_dot2_f32_bf16 v17, v32, s53, 0
    v_dot2_f32_bf16 v21, v36, s53, 0
    v_dot2_f32_bf16 v25, v40, s53, 0
    s_pack_ll_b32_b16 s52, s57, s59
    v_dot2_f32_bf16 v14, v28, s52, 0
    v_dot2_f32_bf16 v18, v32, s52, 0
    v_dot2_f32_bf16 v22, v36, s52, 0
    v_dot2_f32_bf16 v26, v40, s52, 0
    s_pack_hh_b32_b16 s53, s57, s59
    v_dot2_f32_bf16 v15, v28, s53, 0
    v_dot2_f32_bf16 v19, v32, s53, 0
    v_dot2_f32_bf16 v23, v36, s53, 0
    v_dot2_f32_bf16 v27, v40, s53, 0
    s_pack_ll_b32_b16 s52, s60, s62
    v_dot2_f32_bf16 v12, v30, s52, v12
    v_dot2_f32_bf16 v16, v34, s52, v16
    v_dot2_f32_bf16 v20, v38, s52, v20
    v_dot2_f32_bf16 v24, v42, s52, v24
    s_pack_hh_b32_b16 s53, s60, s62
    v_dot2_f32_bf16 v13, v30, s53, v13
    v_dot2_f32_bf16 v17, v34, s53, v17
    v_dot2_f32_bf16 v21, v38, s53, v21
    v_dot2_f32_bf16 v25, v42, s53, v25
    s_pack_ll_b32_b16 s52, s61, s63
    v_dot2_f32_bf16 v14, v30, s52, v14
    v_dot2_f32_bf16 v18, v34, s52, v18
    v_dot2_f32_bf16 v22, v38, s52, v22
    v_dot2_f32_bf16 v26, v42, s52, v26
    s_pack_hh_b32_b16 s53, s61, s63
    v_dot2_f32_bf16 v15, v30, s53, v15
    v_dot2_f32_bf16 v19, v34, s53, v19
    v_dot2_f32_bf16 v23, v38, s53, v23
    v_dot2_f32_bf16 v27, v42, s53, v27
    v_lshlrev_b32 v44, 16, v108
    v_and_b32 v45, s32, v108
    v_lshlrev_b32 v46, 16, v109
    v_and_b32 v47, s32, v109
    v_lshlrev_b32 v48, 16, v110
    v_and_b32 v49, s32, v110
    v_lshlrev_b32 v50, 16, v111
    v_and_b32 v51, s32, v111
    v_lshlrev_b32 v52, 16, v112
    v_and_b32 v53, s32, v112
    v_lshlrev_b32 v54, 16, v113
    v_and_b32 v55, s32, v113
    v_lshlrev_b32 v56, 16, v114
    v_and_b32 v57, s32, v114
    v_lshlrev_b32 v58, 16, v115
    v_and_b32 v59, s32, v115
    v_cvt_pk_bf16_f32 v12, v12, v13
    v_cvt_pk_bf16_f32 v14, v14, v15
    v_cvt_pk_bf16_f32 v16, v16, v17
    v_cvt_pk_bf16_f32 v18, v18, v19
    v_cvt_pk_bf16_f32 v20, v20, v21
    v_cvt_pk_bf16_f32 v22, v22, v23
    v_cvt_pk_bf16_f32 v24, v24, v25
    v_cvt_pk_bf16_f32 v26, v26, v27
    v_and_b32 v13, s32, v12
    v_lshlrev_b32 v12, 16, v12
    v_and_b32 v15, s32, v14
    v_lshlrev_b32 v14, 16, v14
    v_and_b32 v17, s32, v16
    v_lshlrev_b32 v16, 16, v16
    v_and_b32 v19, s32, v18
    v_lshlrev_b32 v18, 16, v18
    v_and_b32 v21, s32, v20
    v_lshlrev_b32 v20, 16, v20
    v_and_b32 v23, s32, v22
    v_lshlrev_b32 v22, 16, v22
    v_and_b32 v25, s32, v24
    v_lshlrev_b32 v24, 16, v24
    v_and_b32 v27, s32, v26
    v_lshlrev_b32 v26, 16, v26
    v_mul_f32 v12, v12, v60
    v_mul_f32 v13, v13, v61
    v_mul_f32 v14, v14, v62
    v_mul_f32 v15, v15, v63
    v_mul_f32 v16, v16, v64
    v_mul_f32 v17, v17, v65
    v_mul_f32 v18, v18, v66
    v_mul_f32 v19, v19, v67
    v_mul_f32 v20, v20, v68
    v_mul_f32 v21, v21, v69
    v_mul_f32 v22, v22, v70
    v_mul_f32 v23, v23, v71
    v_mul_f32 v24, v24, v72
    v_mul_f32 v25, v25, v73
    v_mul_f32 v26, v26, v74
    v_mul_f32 v27, v27, v75
    v_cvt_pk_bf16_f32 v12, v12, v13
    v_cvt_pk_bf16_f32 v14, v14, v15
    v_cvt_pk_bf16_f32 v16, v16, v17
    v_cvt_pk_bf16_f32 v18, v18, v19
    v_cvt_pk_bf16_f32 v20, v20, v21
    v_cvt_pk_bf16_f32 v22, v22, v23
    v_cvt_pk_bf16_f32 v24, v24, v25
    v_cvt_pk_bf16_f32 v26, v26, v27
    v_and_b32 v13, s32, v12
    v_lshlrev_b32 v12, 16, v12
    v_and_b32 v15, s32, v14
    v_lshlrev_b32 v14, 16, v14
    v_and_b32 v17, s32, v16
    v_lshlrev_b32 v16, 16, v16
    v_and_b32 v19, s32, v18
    v_lshlrev_b32 v18, 16, v18
    v_and_b32 v21, s32, v20
    v_lshlrev_b32 v20, 16, v20
    v_and_b32 v23, s32, v22
    v_lshlrev_b32 v22, 16, v22
    v_and_b32 v25, s32, v24
    v_lshlrev_b32 v24, 16, v24
    v_and_b32 v27, s32, v26
    v_lshlrev_b32 v26, 16, v26
    v_add_f32 v12, v12, v44
    v_add_f32 v13, v13, v45
    v_add_f32 v14, v14, v46
    v_add_f32 v15, v15, v47
    v_add_f32 v16, v16, v48
    v_add_f32 v17, v17, v49
    v_add_f32 v18, v18, v50
    v_add_f32 v19, v19, v51
    v_add_f32 v20, v20, v52
    v_add_f32 v21, v21, v53
    v_add_f32 v22, v22, v54
    v_add_f32 v23, v23, v55
    v_add_f32 v24, v24, v56
    v_add_f32 v25, v25, v57
    v_add_f32 v26, v26, v58
    v_add_f32 v27, v27, v59
    v_cvt_pk_bf16_f32 v28, v12, v13
    v_cvt_pk_bf16_f32 v29, v14, v15
    v_cvt_pk_bf16_f32 v30, v16, v17
    v_cvt_pk_bf16_f32 v31, v18, v19
    v_cvt_pk_bf16_f32 v32, v20, v21
    v_cvt_pk_bf16_f32 v33, v22, v23
    v_cvt_pk_bf16_f32 v34, v24, v25
    v_cvt_pk_bf16_f32 v35, v26, v27
    buffer_store_dwordx4 v[28:31], v4, s[24:27], 0 offen
    buffer_store_dwordx4 v[32:35], v5, s[24:27], 0 offen
L_postend_100:
    s_mov_b64 exec, -1
L_nextq_98:
    s_bfe_u32 s3, s35, 0x40008
    s_cbranch_scc0 L_fend_116
    s_ff1_i32_b32 s41, s3
    s_add_u32 s3, s41, 8
    s_bitset0_b32 s35, s3
    s_branch L_qloop_93
L_fend_116:

L_p2done_54:
    s_endpgm

L_ufix_56:
    v_and_b32 v117, 63, v0
    v_lshlrev_b32 v117, 2, v117
    s_sub_i32 s54, s42, 1024
    v_cmp_le_i32 vcc, s54, v117
    s_mov_b64 exec, vcc
    v_mov_b32 v12, 0
    v_mov_b32 v44, 0
    s_mov_b64 exec, -1
    s_sub_i32 s54, s42, 1025
    v_cmp_le_i32 vcc, s54, v117
    s_mov_b64 exec, vcc
    v_mov_b32 v13, 0
    v_mov_b32 v46, 0
    s_mov_b64 exec, -1
    s_sub_i32 s54, s42, 1026
    v_cmp_le_i32 vcc, s54, v117
    s_mov_b64 exec, vcc
    v_mov_b32 v14, 0
    v_mov_b32 v48, 0
    s_mov_b64 exec, -1
    s_sub_i32 s54, s42, 1027
    v_cmp_le_i32 vcc, s54, v117
    s_mov_b64 exec, vcc
    v_mov_b32 v15, 0
    v_mov_b32 v50, 0
    s_mov_b64 exec, -1
    s_branch L_uback_57
L_ufix_58:
    v_and_b32 v117, 63, v0
    v_lshlrev_b32 v117, 2, v117
    s_sub_i32 s54, s42, 1536
    v_cmp_le_i32 vcc, s54, v117
    s_mov_b64 exec, vcc
    v_mov_b32 v16, 0
    v_mov_b32 v52, 0
    s_mov_b64 exec, -1
    s_sub_i32 s54, s42, 1537
    v_cmp_le_i32 vcc, s54, v117
    s_mov_b64 exec, vcc
    v_mov_b32 v17, 0
    v_mov_b32 v54, 0
    s_mov_b64 exec, -1
    s_sub_i32 s54, s42, 1538
    v_cmp_le_i32 vcc, s54, v117
    s_mov_b64 exec, vcc
    v_mov_b32 v18, 0
    v_mov_b32 v56, 0
    s_mov_b64 exec, -1
    s_sub_i32 s54, s42, 1539
    v_cmp_le_i32 vcc, s54, v117
    s_mov_b64 exec, vcc
    v_mov_b32 v19, 0
    v_mov_b32 v58, 0
    s_mov_b64 exec, -1
    s_branch L_uback_59
L_ufix_60:
    v_and_b32 v117, 63, v0
    v_lshlrev_b32 v117, 2, v117
    s_sub_i32 s54, s42, 2048
    v_cmp_le_i32 vcc, s54, v117
    s_mov_b64 exec, vcc
    v_mov_b32 v20, 0
    v_mov_b32 v60, 0
    s_mov_b64 exec, -1
    s_sub_i32 s54, s42, 2049
    v_cmp_le_i32 vcc, s54, v117
    s_mov_b64 exec, vcc
    v_mov_b32 v21, 0
    v_mov_b32 v62, 0
    s_mov_b64 exec, -1
    s_sub_i32 s54, s42, 2050
    v_cmp_le_i32 vcc, s54, v117
    s_mov_b64 exec, vcc
    v_mov_b32 v22, 0
    v_mov_b32 v64, 0
    s_mov_b64 exec, -1
    s_sub_i32 s54, s42, 2051
    v_cmp_le_i32 vcc, s54, v117
    s_mov_b64 exec, vcc
    v_mov_b32 v23, 0
    v_mov_b32 v66, 0
    s_mov_b64 exec, -1
    s_branch L_uback_61
L_ufix_62:
    v_and_b32 v117, 63, v0
    v_lshlrev_b32 v117, 2, v117
    s_sub_i32 s54, s42, 2560
    v_cmp_le_i32 vcc, s54, v117
    s_mov_b64 exec, vcc
    v_mov_b32 v24, 0
    v_mov_b32 v68, 0
    s_mov_b64 exec, -1
    s_sub_i32 s54, s42, 2561
    v_cmp_le_i32 vcc, s54, v117
    s_mov_b64 exec, vcc
    v_mov_b32 v25, 0
    v_mov_b32 v70, 0
    s_mov_b64 exec, -1
    s_sub_i32 s54, s42, 2562
    v_cmp_le_i32 vcc, s54, v117
    s_mov_b64 exec, vcc
    v_mov_b32 v26, 0
    v_mov_b32 v72, 0
    s_mov_b64 exec, -1
    s_sub_i32 s54, s42, 2563
    v_cmp_le_i32 vcc, s54, v117
    s_mov_b64 exec, vcc
    v_mov_b32 v27, 0
    v_mov_b32 v74, 0
    s_mov_b64 exec, -1
    s_branch L_uback_63
L_ufix_64:
    v_and_b32 v117, 63, v0
    v_lshlrev_b32 v117, 2, v117
    s_sub_i32 s54, s42, 0
    v_cmp_le_i32 vcc, s54, v117
    s_mov_b64 exec, vcc
    v_mov_b32 v4, 0
    v_mov_b32 v28, 0
    s_mov_b64 exec, -1
    s_sub_i32 s54, s42, 1
    v_cmp_le_i32 vcc, s54, v117
    s_mov_b64 exec, vcc
    v_mov_b32 v5, 0
    v_mov_b32 v30, 0
    s_mov_b64 exec, -1
    s_sub_i32 s54, s42, 2
    v_cmp_le_i32 vcc, s54, v117
    s_mov_b64 exec, vcc
    v_mov_b32 v6, 0
    v_mov_b32 v32, 0
    s_mov_b64 exec, -1
    s_sub_i32 s54, s42, 3
    v_cmp_le_i32 vcc, s54, v117
    s_mov_b64 exec, vcc
    v_mov_b32 v7, 0
    v_mov_b32 v34, 0
    s_mov_b64 exec, -1
    s_branch L_uback_65
L_ufix_66:
    v_and_b32 v117, 63, v0
    v_lshlrev_b32 v117, 2, v117
    s_sub_i32 s54, s42, 512
    v_cmp_le_i32 vcc, s54, v117
    s_mov_b64 exec, vcc
    v_mov_b32 v8, 0
    v_mov_b32 v36, 0
    s_mov_b64 exec, -1
    s_sub_i32 s54, s42, 513
    v_cmp_le_i32 vcc, s54, v117
    s_mov_b64 exec, vcc
    v_mov_b32 v9, 0
    v_mov_b32 v38, 0
    s_mov_b64 exec, -1
    s_sub_i32 s54, s42, 514
    v_cmp_le_i32 vcc, s54, v117
    s_mov_b64 exec, vcc
    v_mov_b32 v10, 0
    v_mov_b32 v40, 0
    s_mov_b64 exec, -1
    s_sub_i32 s54, s42, 515
    v_cmp_le_i32 vcc, s54, v117
    s_mov_b64 exec, vcc
    v_mov_b32 v11, 0
    v_mov_b32 v42, 0
    s_mov_b64 exec, -1
    s_branch L_uback_67
L_ufix_73:
    v_and_b32 v117, 63, v0
    v_lshlrev_b32 v117, 2, v117
    s_sub_i32 s54, s42, 3072
    v_cmp_le_i32 vcc, s54, v117
    s_mov_b64 exec, vcc
    v_mov_b32 v106, 0
    v_mov_b32 v120, 0
    s_mov_b64 exec, -1
    s_sub_i32 s54, s42, 3073
    v_cmp_le_i32 vcc, s54, v117
    s_mov_b64 exec, vcc
    v_mov_b32 v107, 0
    v_mov_b32 v122, 0
    s_mov_b64 exec, -1
    s_sub_i32 s54, s42, 3074
    v_cmp_le_i32 vcc, s54, v117
    s_mov_b64 exec, vcc
    v_mov_b32 v108, 0
    v_mov_b32 v124, 0
    s_mov_b64 exec, -1
    s_sub_i32 s54, s42, 3075
    v_cmp_le_i32 vcc, s54, v117
    s_mov_b64 exec, vcc
    v_mov_b32 v109, 0
    v_mov_b32 v126, 0
    s_mov_b64 exec, -1
    s_branch L_uback_74
L_ufix_77:
    v_and_b32 v117, 63, v0
    v_lshlrev_b32 v117, 2, v117
    s_sub_i32 s54, s42, 1024
    v_cmp_le_i32 vcc, s54, v117
    s_mov_b64 exec, vcc
    v_mov_b32 v12, 0
    v_mov_b32 v44, 0
    s_mov_b64 exec, -1
    s_sub_i32 s54, s42, 1025
    v_cmp_le_i32 vcc, s54, v117
    s_mov_b64 exec, vcc
    v_mov_b32 v13, 0
    v_mov_b32 v46, 0
    s_mov_b64 exec, -1
    s_sub_i32 s54, s42, 1026
    v_cmp_le_i32 vcc, s54, v117
    s_mov_b64 exec, vcc
    v_mov_b32 v14, 0
    v_mov_b32 v48, 0
    s_mov_b64 exec, -1
    s_sub_i32 s54, s42, 1027
    v_cmp_le_i32 vcc, s54, v117
    s_mov_b64 exec, vcc
    v_mov_b32 v15, 0
    v_mov_b32 v50, 0
    s_mov_b64 exec, -1
    s_branch L_uback_78
L_ufix_79:
    v_and_b32 v117, 63, v0
    v_lshlrev_b32 v117, 2, v117
    s_sub_i32 s54, s42, 1536
    v_cmp_le_i32 vcc, s54, v117
    s_mov_b64 exec, vcc
    v_mov_b32 v16, 0
    v_mov_b32 v52, 0
    s_mov_b64 exec, -1
    s_sub_i32 s54, s42, 1537
    v_cmp_le_i32 vcc, s54, v117
    s_mov_b64 exec, vcc
    v_mov_b32 v17, 0
    v_mov_b32 v54, 0
    s_mov_b64 exec, -1
    s_sub_i32 s54, s42, 1538
    v_cmp_le_i32 vcc, s54, v117
    s_mov_b64 exec, vcc
    v_mov_b32 v18, 0
    v_mov_b32 v56, 0
    s_mov_b64 exec, -1
    s_sub_i32 s54, s42, 1539
    v_cmp_le_i32 vcc, s54, v117
    s_mov_b64 exec, vcc
    v_mov_b32 v19, 0
    v_mov_b32 v58, 0
    s_mov_b64 exec, -1
    s_branch L_uback_80
L_ufix_81:
    v_and_b32 v117, 63, v0
    v_lshlrev_b32 v117, 2, v117
    s_sub_i32 s54, s42, 2048
    v_cmp_le_i32 vcc, s54, v117
    s_mov_b64 exec, vcc
    v_mov_b32 v20, 0
    v_mov_b32 v60, 0
    s_mov_b64 exec, -1
    s_sub_i32 s54, s42, 2049
    v_cmp_le_i32 vcc, s54, v117
    s_mov_b64 exec, vcc
    v_mov_b32 v21, 0
    v_mov_b32 v62, 0
    s_mov_b64 exec, -1
    s_sub_i32 s54, s42, 2050
    v_cmp_le_i32 vcc, s54, v117
    s_mov_b64 exec, vcc
    v_mov_b32 v22, 0
    v_mov_b32 v64, 0
    s_mov_b64 exec, -1
    s_sub_i32 s54, s42, 2051
    v_cmp_le_i32 vcc, s54, v117
    s_mov_b64 exec, vcc
    v_mov_b32 v23, 0
    v_mov_b32 v66, 0
    s_mov_b64 exec, -1
    s_branch L_uback_82
L_ufix_83:
    v_and_b32 v117, 63, v0
    v_lshlrev_b32 v117, 2, v117
    s_sub_i32 s54, s42, 2560
    v_cmp_le_i32 vcc, s54, v117
    s_mov_b64 exec, vcc
    v_mov_b32 v24, 0
    v_mov_b32 v68, 0
    s_mov_b64 exec, -1
    s_sub_i32 s54, s42, 2561
    v_cmp_le_i32 vcc, s54, v117
    s_mov_b64 exec, vcc
    v_mov_b32 v25, 0
    v_mov_b32 v70, 0
    s_mov_b64 exec, -1
    s_sub_i32 s54, s42, 2562
    v_cmp_le_i32 vcc, s54, v117
    s_mov_b64 exec, vcc
    v_mov_b32 v26, 0
    v_mov_b32 v72, 0
    s_mov_b64 exec, -1
    s_sub_i32 s54, s42, 2563
    v_cmp_le_i32 vcc, s54, v117
    s_mov_b64 exec, vcc
    v_mov_b32 v27, 0
    v_mov_b32 v74, 0
    s_mov_b64 exec, -1
    s_branch L_uback_84
L_ufix_85:
    v_and_b32 v117, 63, v0
    v_lshlrev_b32 v117, 2, v117
    s_sub_i32 s54, s42, 0
    v_cmp_le_i32 vcc, s54, v117
    s_mov_b64 exec, vcc
    v_mov_b32 v4, 0
    v_mov_b32 v28, 0
    s_mov_b64 exec, -1
    s_sub_i32 s54, s42, 1
    v_cmp_le_i32 vcc, s54, v117
    s_mov_b64 exec, vcc
    v_mov_b32 v5, 0
    v_mov_b32 v30, 0
    s_mov_b64 exec, -1
    s_sub_i32 s54, s42, 2
    v_cmp_le_i32 vcc, s54, v117
    s_mov_b64 exec, vcc
    v_mov_b32 v6, 0
    v_mov_b32 v32, 0
    s_mov_b64 exec, -1
    s_sub_i32 s54, s42, 3
    v_cmp_le_i32 vcc, s54, v117
    s_mov_b64 exec, vcc
    v_mov_b32 v7, 0
    v_mov_b32 v34, 0
    s_mov_b64 exec, -1
    s_branch L_uback_86
L_ufix_87:
    v_and_b32 v117, 63, v0
    v_lshlrev_b32 v117, 2, v117
    s_sub_i32 s54, s42, 512
    v_cmp_le_i32 vcc, s54, v117
    s_mov_b64 exec, vcc
    v_mov_b32 v8, 0
    v_mov_b32 v36, 0
    s_mov_b64 exec, -1
    s_sub_i32 s54, s42, 513
    v_cmp_le_i32 vcc, s54, v117
    s_mov_b64 exec, vcc
    v_mov_b32 v9, 0
    v_mov_b32 v38, 0
    s_mov_b64 exec, -1
    s_sub_i32 s54, s42, 514
    v_cmp_le_i32 vcc, s54, v117
    s_mov_b64 exec, vcc
    v_mov_b32 v10, 0
    v_mov_b32 v40, 0
    s_mov_b64 exec, -1
    s_sub_i32 s54, s42, 515
    v_cmp_le_i32 vcc, s54, v117
    s_mov_b64 exec, vcc
    v_mov_b32 v11, 0
    v_mov_b32 v42, 0
    s_mov_b64 exec, -1
    s_branch L_uback_88
L_sync_102:
    v_mov_b32 v117, s33
    buffer_atomic_add v117, v116, s[44:47], s50 offen sc0
    s_waitcnt vmcnt(0)
    v_readfirstlane_b32 s4, v117
    s_movk_i32 s5, 400
    s_nop 0
    s_add_u32 s4, s4, s33
    s_bitcmp1_b32 s4, 2
    s_cbranch_scc1 L_tell_105
L_poll_103:
    s_sub_u32 s5, s5, 1
    s_cbranch_scc1 L_gave_104
    v_mov_b32 v117, 0
    buffer_atomic_add v117, v116, s[44:47], s50 offen sc0
    s_waitcnt vmcnt(0)
    v_readfirstlane_b32 s4, v117
    s_nop 1
    s_and_b32 s4, s4, 0xff
    s_bitcmp0_b32 s4, 2
    s_cbranch_scc1 L_poll_103
    s_branch L_tell_105
L_gave_104:
    s_lshl_b32 s4, 0x100, s37
    v_mov_b32 v117, s4
    buffer_atomic_or v117, v116, s[44:47], s50 offen sc0
    s_waitcnt vmcnt(0)
    v_readfirstlane_b32 s4, v117
    s_nop 1
    s_and_b32 s4, s4, 0xff
    s_bitcmp1_b32 s4, 2
    s_cselect_b32 s4, s4, 0x10000
L_tell_105:
    v_mov_b32 v117, s4
    v_mov_b32 v118, 150016
    ds_write_b32 v118, v117
    s_branch L_bcast_97

L_fgen_106:
    s_waitcnt vmcnt(0)
    v_lshlrev_b32 v6, 1, v4
    v_lshlrev_b32 v7, 1, v5
    v_mov_b32 v12, 0
    v_mov_b32 v13, 0
    v_mov_b32 v14, 0
    v_mov_b32 v15, 0
    v_mov_b32 v16, 0
    v_mov_b32 v17, 0
    v_mov_b32 v18, 0
    v_mov_b32 v19, 0
    v_mov_b32 v20, 0
    v_mov_b32 v21, 0
    v_mov_b32 v22, 0
    v_mov_b32 v23, 0
    v_mov_b32 v24, 0
    v_mov_b32 v25, 0
    v_mov_b32 v26, 0
    v_mov_b32 v27, 0
    s_bitcmp1_b32 s35, 4
    s_cbranch_scc1 L_ffl_108
    v_cvt_f32_u32_sdwa v28, v76 dst_sel:DWORD dst_unused:UNUSED_PAD src0_sel:WORD_0
    v_cvt_f32_u32_sdwa v29, v76 dst_sel:DWORD dst_unused:UNUSED_PAD src0_sel:WORD_1
    v_cvt_f32_u32_sdwa v30, v77 dst_sel:DWORD dst_unused:UNUSED_PAD src0_sel:WORD_0
    v_cvt_f32_u32_sdwa v31, v77 dst_sel:DWORD dst_unused:UNUSED_PAD src0_sel:WORD_1
    v_cvt_f32_u32_sdwa v32, v78 dst_sel:DWORD dst_unused:UNUSED_PAD src0_sel:WORD_0
    v_cvt_f32_u32_sdwa v33, v78 dst_sel:DWORD dst_unused:UNUSED_PAD src0_sel:WORD_1
    v_cvt_f32_u32_sdwa v34, v79 dst_sel:DWORD dst_unused:UNUSED_PAD src0_sel:WORD_0
    v_cvt_f32_u32_sdwa v35, v79 dst_sel:DWORD dst_unused:UNUSED_PAD src0_sel:WORD_1
    v_cvt_f32_u32_sdwa v36, v92 dst_sel:DWORD dst_unused:UNUSED_PAD src0_sel:WORD_0
    v_cvt_f32_u32_sdwa v37, v92 dst_sel:DWORD dst_unused:UNUSED_PAD src0_sel:WORD_1
    v_cvt_f32_u32_sdwa v38, v93 dst_sel:DWORD dst_unused:UNUSED_PAD src0_sel:WORD_0
    v_cvt_f32_u32_sdwa v39, v93 dst_sel:DWORD dst_unused:UNUSED_PAD src0_sel:WORD_1
    v_cvt_f32_u32_sdwa v40, v94 dst_sel:DWORD dst_unused:UNUSED_PAD src0_sel:WORD_0
    v_cvt_f32_u32_sdwa v41, v94 dst_sel:DWORD dst_unused:UNUSED_PAD src0_sel:WORD_1
    v_cvt_f32_u32_sdwa v42, v95 dst_sel:DWORD dst_unused:UNUSED_PAD src0_sel:WORD_0
    v_cvt_f32_u32_sdwa v43, v95 dst_sel:DWORD dst_unused:UNUSED_PAD src0_sel:WORD_1
    v_add_f32 v28, 0xc6800000, v28
    v_fmac_f32 v12, s34, v28
    v_add_f32 v29, 0xc6800000, v29
    v_fmac_f32 v13, s34, v29
    v_add_f32 v30, 0xc6800000, v30
    v_fmac_f32 v14, s34, v30
    v_add_f32 v31, 0xc6800000, v31
    v_fmac_f32 v15, s34, v31
    v_add_f32 v32, 0xc6800000, v32
    v_fmac_f32 v16, s34, v32
    v_add_f32 v33, 0xc6800000, v33
    v_fmac_f32 v17, s34, v33
    v_add_f32 v34, 0xc6800000, v34
    v_fmac_f32 v18, s34, v34
    v_add_f32 v35, 0xc6800000, v35
    v_fmac_f32 v19, s34, v35
    v_add_f32 v36, 0xc6800000, v36
    v_fmac_f32 v20, s34, v36
    v_add_f32 v37, 0xc6800000, v37
    v_fmac_f32 v21, s34, v37
    v_add_f32 v38, 0xc6800000, v38
    v_fmac_f32 v22, s34, v38
    v_add_f32 v39, 0xc6800000, v39
    v_fmac_f32 v23, s34, v39
    v_add_f32 v40, 0xc6800000, v40
    v_fmac_f32 v24, s34, v40
    v_add_f32 v41, 0xc6800000, v41
    v_fmac_f32 v25, s34, v41
    v_add_f32 v42, 0xc6800000, v42
    v_fmac_f32 v26, s34, v42
    v_add_f32 v43, 0xc6800000, v43
    v_fmac_f32 v27, s34, v43
    s_branch L_fnx_109
L_ffl_108:
    s_mov_b32 s3, 25600000
    buffer_load_dwordx4 v[28:31], v6, s[20:23], s3 offen offset:0 sc1
    buffer_load_dwordx4 v[32:35], v6, s[20:23], s3 offen offset:16 sc1
    buffer_load_dwordx4 v[36:39], v7, s[20:23], s3 offen offset:0 sc1
    buffer_load_dwordx4 v[40:43], v7, s[20:23], s3 offen offset:16 sc1
    s_waitcnt vmcnt(0)
    v_add_f32 v12, v12, v28
    v_add_f32 v13, v13, v29
    v_add_f32 v14, v14, v30
    v_add_f32 v15, v15, v31
    v_add_f32 v16, v16, v32
    v_add_f32 v17, v17, v33
    v_add_f32 v18, v18, v34
    v_add_f32 v19, v19, v35
    v_add_f32 v20, v20, v36
    v_add_f32 v21, v21, v37
    v_add_f32 v22, v22, v38
    v_add_f32 v23, v23, v39
    v_add_f32 v24, v24, v40
    v_add_f32 v25, v25, v41
    v_add_f32 v26, v26, v42
    v_add_f32 v27, v27, v43
L_fnx_109:
    s_bitcmp1_b32 s35, 5
    s_cbranch_scc1 L_ffl_110
    v_cvt_f32_u32_sdwa v28, v80 dst_sel:DWORD dst_unused:UNUSED_PAD src0_sel:WORD_0
    v_cvt_f32_u32_sdwa v29, v80 dst_sel:DWORD dst_unused:UNUSED_PAD src0_sel:WORD_1
    v_cvt_f32_u32_sdwa v30, v81 dst_sel:DWORD dst_unused:UNUSED_PAD src0_sel:WORD_0
    v_cvt_f32_u32_sdwa v31, v81 dst_sel:DWORD dst_unused:UNUSED_PAD src0_sel:WORD_1
    v_cvt_f32_u32_sdwa v32, v82 dst_sel:DWORD dst_unused:UNUSED_PAD src0_sel:WORD_0
    v_cvt_f32_u32_sdwa v33, v82 dst_sel:DWORD dst_unused:UNUSED_PAD src0_sel:WORD_1
    v_cvt_f32_u32_sdwa v34, v83 dst_sel:DWORD dst_unused:UNUSED_PAD src0_sel:WORD_0
    v_cvt_f32_u32_sdwa v35, v83 dst_sel:DWORD dst_unused:UNUSED_PAD src0_sel:WORD_1
    v_cvt_f32_u32_sdwa v36, v96 dst_sel:DWORD dst_unused:UNUSED_PAD src0_sel:WORD_0
    v_cvt_f32_u32_sdwa v37, v96 dst_sel:DWORD dst_unused:UNUSED_PAD src0_sel:WORD_1
    v_cvt_f32_u32_sdwa v38, v97 dst_sel:DWORD dst_unused:UNUSED_PAD src0_sel:WORD_0
    v_cvt_f32_u32_sdwa v39, v97 dst_sel:DWORD dst_unused:UNUSED_PAD src0_sel:WORD_1
    v_cvt_f32_u32_sdwa v40, v98 dst_sel:DWORD dst_unused:UNUSED_PAD src0_sel:WORD_0
    v_cvt_f32_u32_sdwa v41, v98 dst_sel:DWORD dst_unused:UNUSED_PAD src0_sel:WORD_1
    v_cvt_f32_u32_sdwa v42, v99 dst_sel:DWORD dst_unused:UNUSED_PAD src0_sel:WORD_0
    v_cvt_f32_u32_sdwa v43, v99 dst_sel:DWORD dst_unused:UNUSED_PAD src0_sel:WORD_1
    v_add_f32 v28, 0xc6800000, v28
    v_fmac_f32 v12, s34, v28
    v_add_f32 v29, 0xc6800000, v29
    v_fmac_f32 v13, s34, v29
    v_add_f32 v30, 0xc6800000, v30
    v_fmac_f32 v14, s34, v30
    v_add_f32 v31, 0xc6800000, v31
    v_fmac_f32 v15, s34, v31
    v_add_f32 v32, 0xc6800000, v32
    v_fmac_f32 v16, s34, v32
    v_add_f32 v33, 0xc6800000, v33
    v_fmac_f32 v17, s34, v33
    v_add_f32 v34, 0xc6800000, v34
    v_fmac_f32 v18, s34, v34
    v_add_f32 v35, 0xc6800000, v35
    v_fmac_f32 v19, s34, v35
    v_add_f32 v36, 0xc6800000, v36
    v_fmac_f32 v20, s34, v36
    v_add_f32 v37, 0xc6800000, v37
    v_fmac_f32 v21, s34, v37
    v_add_f32 v38, 0xc6800000, v38
    v_fmac_f32 v22, s34, v38
    v_add_f32 v39, 0xc6800000, v39
    v_fmac_f32 v23, s34, v39
    v_add_f32 v40, 0xc6800000, v40
    v_fmac_f32 v24, s34, v40
    v_add_f32 v41, 0xc6800000, v41
    v_fmac_f32 v25, s34, v41
    v_add_f32 v42, 0xc6800000, v42
    v_fmac_f32 v26, s34, v42
    v_add_f32 v43, 0xc6800000, v43
    v_fmac_f32 v27, s34, v43
    s_branch L_fnx_111
L_ffl_110:
    s_mov_b32 s3, 38400000
    buffer_load_dwordx4 v[28:31], v6, s[20:23], s3 offen offset:0 sc1
    buffer_load_dwordx4 v[32:35], v6, s[20:23], s3 offen offset:16 sc1
    buffer_load_dwordx4 v[36:39], v7, s[20:23], s3 offen offset:0 sc1
    buffer_load_dwordx4 v[40:43], v7, s[20:23], s3 offen offset:16 sc1
    s_waitcnt vmcnt(0)
    v_add_f32 v12, v12, v28
    v_add_f32 v13, v13, v29
    v_add_f32 v14, v14, v30
    v_add_f32 v15, v15, v31
    v_add_f32 v16, v16, v32
    v_add_f32 v17, v17, v33
    v_add_f32 v18, v18, v34
    v_add_f32 v19, v19, v35
    v_add_f32 v20, v20, v36
    v_add_f32 v21, v21, v37
    v_add_f32 v22, v22, v38
    v_add_f32 v23, v23, v39
    v_add_f32 v24, v24, v40
    v_add_f32 v25, v25, v41
    v_add_f32 v26, v26, v42
    v_add_f32 v27, v27, v43
L_fnx_111:
    s_bitcmp1_b32 s35, 6
    s_cbranch_scc1 L_ffl_112
    v_cvt_f32_u32_sdwa v28, v84 dst_sel:DWORD dst_unused:UNUSED_PAD src0_sel:WORD_0
    v_cvt_f32_u32_sdwa v29, v84 dst_sel:DWORD dst_unused:UNUSED_PAD src0_sel:WORD_1
    v_cvt_f32_u32_sdwa v30, v85 dst_sel:DWORD dst_unused:UNUSED_PAD src0_sel:WORD_0
    v_cvt_f32_u32_sdwa v31, v85 dst_sel:DWORD dst_unused:UNUSED_PAD src0_sel:WORD_1
    v_cvt_f32_u32_sdwa v32, v86 dst_sel:DWORD dst_unused:UNUSED_PAD src0_sel:WORD_0
    v_cvt_f32_u32_sdwa v33, v86 dst_sel:DWORD dst_unused:UNUSED_PAD src0_sel:WORD_1
    v_cvt_f32_u32_sdwa v34, v87 dst_sel:DWORD dst_unused:UNUSED_PAD src0_sel:WORD_0
    v_cvt_f32_u32_sdwa v35, v87 dst_sel:DWORD dst_unused:UNUSED_PAD src0_sel:WORD_1
    v_cvt_f32_u32_sdwa v36, v100 dst_sel:DWORD dst_unused:UNUSED_PAD src0_sel:WORD_0
    v_cvt_f32_u32_sdwa v37, v100 dst_sel:DWORD dst_unused:UNUSED_PAD src0_sel:WORD_1
    v_cvt_f32_u32_sdwa v38, v101 dst_sel:DWORD dst_unused:UNUSED_PAD src0_sel:WORD_0
    v_cvt_f32_u32_sdwa v39, v101 dst_sel:DWORD dst_unused:UNUSED_PAD src0_sel:WORD_1
    v_cvt_f32_u32_sdwa v40, v102 dst_sel:DWORD dst_unused:UNUSED_PAD src0_sel:WORD_0
    v_cvt_f32_u32_sdwa v41, v102 dst_sel:DWORD dst_unused:UNUSED_PAD src0_sel:WORD_1
    v_cvt_f32_u32_sdwa v42, v103 dst_sel:DWORD dst_unused:UNUSED_PAD src0_sel:WORD_0
    v_cvt_f32_u32_sdwa v43, v103 dst_sel:DWORD dst_unused:UNUSED_PAD src0_sel:WORD_1
    v_add_f32 v28, 0xc6800000, v28
    v_fmac_f32 v12, s34, v28
    v_add_f32 v29, 0xc6800000, v29
    v_fmac_f32 v13, s34, v29
    v_add_f32 v30, 0xc6800000, v30
    v_fmac_f32 v14, s34, v30
    v_add_f32 v31, 0xc6800000, v31
    v_fmac_f32 v15, s34, v31
    v_add_f32 v32, 0xc6800000, v32
    v_fmac_f32 v16, s34, v32
    v_add_f32 v33, 0xc6800000, v33
    v_fmac_f32 v17, s34, v33
    v_add_f32 v34, 0xc6800000, v34
    v_fmac_f32 v18, s34, v34
    v_add_f32 v35, 0xc6800000, v35
    v_fmac_f32 v19, s34, v35
    v_add_f32 v36, 0xc6800000, v36
    v_fmac_f32 v20, s34, v36
    v_add_f32 v37, 0xc6800000, v37
    v_fmac_f32 v21, s34, v37
    v_add_f32 v38, 0xc6800000, v38
    v_fmac_f32 v22, s34, v38
    v_add_f32 v39, 0xc6800000, v39
    v_fmac_f32 v23, s34, v39
    v_add_f32 v40, 0xc6800000, v40
    v_fmac_f32 v24, s34, v40
    v_add_f32 v41, 0xc6800000, v41
    v_fmac_f32 v25, s34, v41
    v_add_f32 v42, 0xc6800000, v42
    v_fmac_f32 v26, s34, v42
    v_add_f32 v43, 0xc6800000, v43
    v_fmac_f32 v27, s34, v43
    s_branch L_fnx_113
L_ffl_112:
    s_mov_b32 s3, 51200000
    buffer_load_dwordx4 v[28:31], v6, s[20:23], s3 offen offset:0 sc1
    buffer_load_dwordx4 v[32:35], v6, s[20:23], s3 offen offset:16 sc1
    buffer_load_dwordx4 v[36:39], v7, s[20:23], s3 offen offset:0 sc1
    buffer_load_dwordx4 v[40:43], v7, s[20:23], s3 offen offset:16 sc1
    s_waitcnt vmcnt(0)
    v_add_f32 v12, v12, v28
    v_add_f32 v13, v13, v29
    v_add_f32 v14, v14, v30
    v_add_f32 v15, v15, v31
    v_add_f32 v16, v16, v32
    v_add_f32 v17, v17, v33
    v_add_f32 v18, v18, v34
    v_add_f32 v19, v19, v35
    v_add_f32 v20, v20, v36
    v_add_f32 v21, v21, v37
    v_add_f32 v22, v22, v38
    v_add_f32 v23, v23, v39
    v_add_f32 v24, v24, v40
    v_add_f32 v25, v25, v41
    v_add_f32 v26, v26, v42
    v_add_f32 v27, v27, v43
L_fnx_113:
    s_bitcmp1_b32 s35, 7
    s_cbranch_scc1 L_ffl_114
    v_cvt_f32_u32_sdwa v28, v88 dst_sel:DWORD dst_unused:UNUSED_PAD src0_sel:WORD_0
    v_cvt_f32_u32_sdwa v29, v88 dst_sel:DWORD dst_unused:UNUSED_PAD src0_sel:WORD_1
    v_cvt_f32_u32_sdwa v30, v89 dst_sel:DWORD dst_unused:UNUSED_PAD src0_sel:WORD_0
    v_cvt_f32_u32_sdwa v31, v89 dst_sel:DWORD dst_unused:UNUSED_PAD src0_sel:WORD_1
    v_cvt_f32_u32_sdwa v32, v90 dst_sel:DWORD dst_unused:UNUSED_PAD src0_sel:WORD_0
    v_cvt_f32_u32_sdwa v33, v90 dst_sel:DWORD dst_unused:UNUSED_PAD src0_sel:WORD_1
    v_cvt_f32_u32_sdwa v34, v91 dst_sel:DWORD dst_unused:UNUSED_PAD src0_sel:WORD_0
    v_cvt_f32_u32_sdwa v35, v91 dst_sel:DWORD dst_unused:UNUSED_PAD src0_sel:WORD_1
    v_cvt_f32_u32_sdwa v36, v104 dst_sel:DWORD dst_unused:UNUSED_PAD src0_sel:WORD_0
    v_cvt_f32_u32_sdwa v37, v104 dst_sel:DWORD dst_unused:UNUSED_PAD src0_sel:WORD_1
    v_cvt_f32_u32_sdwa v38, v105 dst_sel:DWORD dst_unused:UNUSED_PAD src0_sel:WORD_0
    v_cvt_f32_u32_sdwa v39, v105 dst_sel:DWORD dst_unused:UNUSED_PAD src0_sel:WORD_1
    v_cvt_f32_u32_sdwa v40, v106 dst_sel:DWORD dst_unused:UNUSED_PAD src0_sel:WORD_0
    v_cvt_f32_u32_sdwa v41, v106 dst_sel:DWORD dst_unused:UNUSED_PAD src0_sel:WORD_1
    v_cvt_f32_u32_sdwa v42, v107 dst_sel:DWORD dst_unused:UNUSED_PAD src0_sel:WORD_0
    v_cvt_f32_u32_sdwa v43, v107 dst_sel:DWORD dst_unused:UNUSED_PAD src0_sel:WORD_1
    v_add_f32 v28, 0xc6800000, v28
    v_fmac_f32 v12, s34, v28
    v_add_f32 v29, 0xc6800000, v29
    v_fmac_f32 v13, s34, v29
    v_add_f32 v30, 0xc6800000, v30
    v_fmac_f32 v14, s34, v30
    v_add_f32 v31, 0xc6800000, v31
    v_fmac_f32 v15, s34, v31
    v_add_f32 v32, 0xc6800000, v32
    v_fmac_f32 v16, s34, v32
    v_add_f32 v33, 0xc6800000, v33
    v_fmac_f32 v17, s34, v33
    v_add_f32 v34, 0xc6800000, v34
    v_fmac_f32 v18, s34, v34
    v_add_f32 v35, 0xc6800000, v35
    v_fmac_f32 v19, s34, v35
    v_add_f32 v36, 0xc6800000, v36
    v_fmac_f32 v20, s34, v36
    v_add_f32 v37, 0xc6800000, v37
    v_fmac_f32 v21, s34, v37
    v_add_f32 v38, 0xc6800000, v38
    v_fmac_f32 v22, s34, v38
    v_add_f32 v39, 0xc6800000, v39
    v_fmac_f32 v23, s34, v39
    v_add_f32 v40, 0xc6800000, v40
    v_fmac_f32 v24, s34, v40
    v_add_f32 v41, 0xc6800000, v41
    v_fmac_f32 v25, s34, v41
    v_add_f32 v42, 0xc6800000, v42
    v_fmac_f32 v26, s34, v42
    v_add_f32 v43, 0xc6800000, v43
    v_fmac_f32 v27, s34, v43
    s_branch L_fnx_115
L_ffl_114:
    s_mov_b32 s3, 64000000
    buffer_load_dwordx4 v[28:31], v6, s[20:23], s3 offen offset:0 sc1
    buffer_load_dwordx4 v[32:35], v6, s[20:23], s3 offen offset:16 sc1
    buffer_load_dwordx4 v[36:39], v7, s[20:23], s3 offen offset:0 sc1
    buffer_load_dwordx4 v[40:43], v7, s[20:23], s3 offen offset:16 sc1
    s_waitcnt vmcnt(0)
    v_add_f32 v12, v12, v28
    v_add_f32 v13, v13, v29
    v_add_f32 v14, v14, v30
    v_add_f32 v15, v15, v31
    v_add_f32 v16, v16, v32
    v_add_f32 v17, v17, v33
    v_add_f32 v18, v18, v34
    v_add_f32 v19, v19, v35
    v_add_f32 v20, v20, v36
    v_add_f32 v21, v21, v37
    v_add_f32 v22, v22, v38
    v_add_f32 v23, v23, v39
    v_add_f32 v24, v24, v40
    v_add_f32 v25, v25, v41
    v_add_f32 v26, v26, v42
    v_add_f32 v27, v27, v43
L_fnx_115:
    s_branch L_fbk_107
L_p2slow_55:
    s_waitcnt vmcnt(0) lgkmcnt(0)
    s_mov_b32 s51, 0
    s_movk_i32 s43, 6250

L_sweep_117:
    s_barrier

    v_mov_b32 v28, 0x0
    v_mov_b32 v29, 0x0
    v_mov_b32 v30, 0x0
    v_mov_b32 v31, 0x0
    v_add_u32 v32, 50000, v3
    v_add_u32 v33, 65536, v32

    ds_write_b128 v32, v[28:31] offset:0
    ds_write_b128 v32, v[28:31] offset:16384
    ds_write_b128 v32, v[28:31] offset:32768
    ds_write_b128 v32, v[28:31] offset:49152
    ds_write_b128 v33, v[28:31] offset:0
    ds_write_b128 v33, v[28:31] offset:16384
    v_cmp_gt_u32 vcc, 971, v0
    s_mov_b64 exec, vcc
    ds_write_b128 v33, v[28:31] offset:32768
    s_mov_b64 exec, -1
    s_waitcnt lgkmcnt(0)
    s_barrier
    s_sub_u32 s38, s4, 8
L_sbatch_118:
    s_lshl_b32 s52, s38, 6
    s_add_u32 s52, s52, s36
    s_lshl_b32 s52, s52, 2
    s_load_dword s40, s[46:47], s52
    s_mul_i32 s50, s38, 200000
    s_waitcnt lgkmcnt(0)

    s_min_u32 s40, s40, 3968
    s_lshl_b32 s52, s38, 6
    s_add_u32 s52, s52, s36
    s_mul_i32 s52, s52, 19840
    s_add_u32 s20, s44, s52
    s_addc_u32 s21, s45, 0
    s_mul_i32 s52, s40, 5
    s_add_u32 s52, s52, 3
    s_and_b32 s22, s52, -4

    s_lshr_b32 s55, s39, 2
    s_add_u32 s55, s55, 0
    v_and_b32 v36, 63, v0
    v_add_u32 v36, s55, v36
L_left_122:
    s_cmp_ge_u32 s55, s40
    s_cbranch_scc1 L_leftend_123
    v_mul_u32_u24 v37, 5, v36
    buffer_load_dword v38, v37, s[20:23], 0 offen
    buffer_load_ubyte v39, v37, s[20:23], 0 offen offset:4
    s_waitcnt vmcnt(0)

    v_perm_b32 v37, v39, v38, s24
    v_lshrrev_b32 v42, 30, v38
    v_and_b32 v37, 0x1fff, v37
    v_mul_u32_u24 v42, 6250, v42
    v_add_lshl_u32 v37, v37, v42, 3

    buffer_load_dwordx2 v[40:41], v37, s[8:11], s50 offen
    v_cmp_gt_u32 vcc, s40, v36
    s_waitcnt vmcnt(0)

    v_bfe_u32 v44, v38, 16, 14
    v_subrev_u32 v44, s51, v44
    v_cmp_gt_u32 s[64:65], s43, v44
    s_and_b64 exec, vcc, s[64:65]
    v_lshlrev_b32 v45, 8, v38
    v_cmpx_ne_u32 vcc, 0, v45
    v_lshlrev_b32 v44, 4, v44
    v_bfe_i32 v38, v38, 0, 16
    v_cvt_f32_i32 v38, v38
    v_mul_f32 v38, 0x38004020, v38
    v_lshlrev_b32 v45, 16, v40
    v_and_b32 v46, s32, v40
    v_lshlrev_b32 v47, 16, v41
    v_and_b32 v48, s32, v41

    v_mul_f32 v45, v45, v38
    ds_add_f32 v44, v45 offset:50000
    v_mul_f32 v46, v46, v38
    ds_add_f32 v44, v46 offset:50004
    v_mul_f32 v47, v47, v38
    ds_add_f32 v44, v47 offset:50008
    v_mul_f32 v48, v48, v38
    ds_add_f32 v44, v48 offset:50012
    s_mov_b64 exec, -1
    v_add_u32 v36, 128, v36
    s_add_u32 s55, s55, 128
    s_branch L_left_122
L_leftend_123:

    s_add_u32 s38, s38, 1
    s_cmp_lt_u32 s38, s4
    s_cbranch_scc1 L_sbatch_118
    s_mov_b32 s3, 65536
    s_load_dword s40, s[6:7], s3

    s_add_u32 s20, s6, 408657920
    s_addc_u32 s21, s7, 0
    s_mov_b32 s22, 409600000
    s_mov_b32 s23, 0x20000
    s_mov_b32 s38, 0
    s_mov_b32 s50, 200000
    v_mov_b32 v36, v0
    s_waitcnt lgkmcnt(0)
L_ovf_119:
    s_cmp_ge_u32 s38, s40
    s_cbranch_scc1 L_ovfend_120
    v_lshlrev_b32 v37, 3, v36
    buffer_load_dwordx2 v[38:39], v37, s[20:23], 0 offen
    s_waitcnt vmcnt(0)

    v_perm_b32 v37, v39, v38, s24
    v_lshrrev_b32 v42, 30, v38
    v_and_b32 v37, 0x1fff, v37
    v_mul_u32_u24 v42, 6250, v42
    v_add_lshl_u32 v37, v37, v42, 3

    v_bfe_u32 v42, v39, 24, 5
    v_mad_u32_u24 v37, v42, s50, v37
    buffer_load_dwordx2 v[40:41], v37, s[8:11], 0 offen
    v_lshrrev_b32 v42, 3, v42
    v_bfe_u32 v43, v39, 18, 6
    v_cmp_gt_u32 vcc, s40, v36
    v_cmp_eq_u32 s[64:65], s36, v43
    s_and_b64 vcc, vcc, s[64:65]
    v_cmp_eq_u32 s[64:65], s37, v42
    s_and_b64 vcc, vcc, s[64:65]
    s_waitcnt vmcnt(0)

    v_bfe_u32 v44, v38, 16, 14
    v_subrev_u32 v44, s51, v44
    v_cmp_gt_u32 s[64:65], s43, v44
    s_and_b64 exec, vcc, s[64:65]
    v_lshlrev_b32 v45, 8, v38
    v_cmpx_ne_u32 vcc, 0, v45
    v_lshlrev_b32 v44, 4, v44
    v_bfe_i32 v38, v38, 0, 16
    v_cvt_f32_i32 v38, v38
    v_mul_f32 v38, 0x38004020, v38
    v_lshlrev_b32 v45, 16, v40
    v_and_b32 v46, s32, v40
    v_lshlrev_b32 v47, 16, v41
    v_and_b32 v48, s32, v41

    v_mul_f32 v45, v45, v38
    ds_add_f32 v44, v45 offset:50000
    v_mul_f32 v46, v46, v38
    ds_add_f32 v44, v46 offset:50004
    v_mul_f32 v47, v47, v38
    ds_add_f32 v44, v47 offset:50008
    v_mul_f32 v48, v48, v38
    ds_add_f32 v44, v48 offset:50012
    s_mov_b64 exec, -1
    v_add_u32 v36, 1024, v36
    s_add_u32 s38, s38, 1024
    s_branch L_ovf_119
L_ovfend_120:
    s_waitcnt lgkmcnt(0)
    s_barrier
    s_mul_i32 s3, s37, 800000
    s_mul_i32 s5, s36, 12500
    s_add_u32 s3, s3, s5
    s_add_u32 s3, s3, s51
    s_lshl_b32 s3, s3, 4
    s_add_u32 s3, s3, 32399360

    s_add_u32 s20, s6, s3
    s_addc_u32 s21, s7, 0
    s_mov_b32 s22, 100000
    s_mov_b32 s23, 0x20000
    v_mov_b32 v36, v3
    s_mov_b32 s38, 0
L_wl_121:
    v_min_u32 v37, 100000, v36
    ds_read_b128 v[28:31], v37 offset:50000
    s_waitcnt lgkmcnt(0)
    buffer_store_dwordx4 v[28:31], v36, s[20:23], 0 offen sc1
    s_waitcnt vmcnt(0)
    v_add_u32 v36, 16384, v36
    s_add_u32 s38, s38, 1024
    s_cmp_lt_u32 s38, 6250
    s_cbranch_scc1 L_wl_121
    s_add_u32 s51, s51, 6250
    s_cmp_lt_u32 s51, 12500
    s_cbranch_scc1 L_sweep_117
    s_lshl_b32 s33, 16, s37
    s_add_u32 s33, s33, 1
    s_branch L_fin_90

.section .rodata,"a"
.p2align 6
.amdhsa_kernel g1_kernel
  .amdhsa_next_free_vgpr 128
  .amdhsa_next_free_sgpr 102
  .amdhsa_accum_offset 128
  .amdhsa_group_segment_fixed_size 0
  .amdhsa_kernarg_size 112
  .amdhsa_user_sgpr_count 2
  .amdhsa_user_sgpr_kernarg_segment_ptr 1
  .amdhsa_system_sgpr_workgroup_id_x 1
.end_amdhsa_kernel
.p2align 6
.amdhsa_kernel standalone__molecular_angular_gemnet__graph_kernel
  .amdhsa_next_free_vgpr 128
  .amdhsa_next_free_sgpr 102
  .amdhsa_accum_offset 128
  .amdhsa_group_segment_fixed_size 0
  .amdhsa_kernarg_size 112
  .amdhsa_user_sgpr_count 2
  .amdhsa_user_sgpr_kernarg_segment_ptr 1
  .amdhsa_system_sgpr_workgroup_id_x 1
  .amdhsa_float_denorm_mode_32 3
.end_amdhsa_kernel
```

```asm
; @launch kernel=g1_kernel grid=(256,1,1) block=(1024,1,1) lds=163840
; @launch kernel=standalone__molecular_angular_gemnet__graph_kernel grid=(256,1,1) block=(1024,1,1) lds=163840
.amdgcn_target "amdgcn-amd-amdhsa--gfx950"
.text
.globl g1_kernel
.p2align 8
.type g1_kernel,@function
g1_kernel:
    s_cmp_ge_u32 s2, 256
    s_cbranch_scc1 L_p1done_1
    s_load_dwordx4 s[80:83], s[0:1], 8
    s_load_dwordx2 s[84:85], s[0:1], 32
    s_load_dwordx2 s[86:87], s[0:1], 48
    s_load_dwordx4 s[4:7], s[0:1], 96
    s_load_dwordx2 s[78:79], s[0:1], 0
    v_lshlrev_b32 v1, 4, v0
    v_lshlrev_b32 v2, 3, v0
    v_lshlrev_b32 v98, 20, v0
    s_waitcnt lgkmcnt(0)
    s_load_dword s88, s[86:87], 0

    s_mov_b32 s96, s4
    s_mov_b32 s97, s5
    s_mov_b32 s98, 256
    s_mov_b32 s99, 0x20000
    v_readfirstlane_b32 s74, v0
    s_nop 1
    s_or_b32 s74, s74, s2
    s_cbranch_scc1 L_noinit_2

    v_mov_b32 v110, 1
    buffer_atomic_add v110, v98, s[96:99], 0 offen offset:64 sc0
    s_waitcnt vmcnt(0)
    v_readfirstlane_b32 s74, v110
    s_nop 1
    s_cmp_lg_u32 s74, 0
    s_cbranch_scc1 L_zno_4

    s_mov_b32 s92, s6
    s_mov_b32 s93, s7
    s_mov_b32 s94, 32784
    s_mov_b32 s95, 0x20000
    v_mov_b32 v110, 0
    v_mov_b32 v111, 0
    v_mov_b32 v112, 0
    v_mov_b32 v113, 0
L_zl_3:
    buffer_store_dwordx4 v[110:113], v1, s[92:95], s74 offen sc0 sc1
    s_add_u32 s74, s74, 1024
    s_cmp_le_u32 s74, 32768
    s_cbranch_scc1 L_zl_3
    v_mov_b32 v114, 1
    s_waitcnt vmcnt(0)
    buffer_atomic_add v114, v98, s[96:99], 0 offen offset:128
L_zno_4:

L_noinit_2:
    s_mov_b32 s20, s78
    s_mov_b32 s21, s79
    s_mov_b32 s22, 6400000
    s_mov_b32 s23, 0x20000
    v_mul_u32_u24 v110, 6240, v0
    v_and_b32 v111, 63, v0
    v_and_b32 v112, 0x3c0, v0
    v_lshlrev_b32 v111, 2, v111
    v_lshl_or_b32 v111, v112, 4, v111
    v_lshlrev_b32 v100, 2, v0
    s_lshr_b32 s50, s2, 1
    s_and_b32 s53, s2, 1
    s_mul_i32 s3, s50, 50000
    s_mul_i32 s54, s53, 24576
    s_add_u32 s3, s3, s54

    buffer_load_dwordx4 v[56:59], v110, s[20:23], 0 offen
    s_add_u32 s20, s78, s3
    s_addc_u32 s21, s79, 0
    s_mov_b32 s22, 24576
    s_mov_b32 s23, 0x20000
    s_movk_i32 s3, 16384
    buffer_load_dword v44, v111, s[20:23], 0 offen offset:0
    buffer_load_dword v45, v111, s[20:23], 0 offen offset:256
    buffer_load_dword v46, v111, s[20:23], 0 offen offset:512
    buffer_load_dword v47, v111, s[20:23], 0 offen offset:768
    buffer_load_dword v48, v111, s[20:23], s3 offen offset:0
    buffer_load_dword v49, v111, s[20:23], s3 offen offset:256
    buffer_load_dword v50, v111, s[20:23], s3 offen offset:512
    buffer_load_dword v51, v111, s[20:23], s3 offen offset:768
    s_mul_i32 s22, s53, 25424
    s_movk_i32 s3, 24576

    buffer_load_dword v52, v100, s[20:23], s3 offen
    s_mul_i32 s3, s50, 50048
    s_add_u32 s3, s3, s54
    s_add_u32 s54, s3, 393216

    s_mov_b32 s8, s80
    s_mov_b32 s9, s81
    s_mov_b32 s10, 0
    s_mov_b32 s11, 0x20000
    s_mov_b32 s12, s82
    s_mov_b32 s13, s83
    s_mov_b32 s14, 0
    s_mov_b32 s15, 0x20000
    s_mov_b32 s16, s84
    s_mov_b32 s17, s85
    s_mov_b32 s18, 0
    s_mov_b32 s19, 0x20000
    s_lshr_b32 s74, s2, 1
    s_and_b32 s74, s74, 28
    s_lshr_b32 s86, 0x00102010, s74
    s_lshr_b32 s87, 0x44414241, s74
    s_lshr_b32 s41, 0x43221100, s74
    s_and_b32 s86, s86, 15
    s_and_b32 s87, s87, 15
    s_and_b32 s41, s41, 15
    s_lshr_b32 s74, s2, 6
    s_lshl_b32 s74, s74, 3
    s_and_b32 s75, s2, 7
    s_add_u32 s74, s74, s75
    s_mul_i32 s74, s74, 5
    s_add_u32 s41, s41, s74

    s_mul_i32 s78, s41, 16384
    s_add_u32 s49, s78, 16384
    s_cmp_ge_u32 s41, 3125
    s_cmovk_i32 s49, 0
    s_cmovk_i32 s78, 0
    s_lshl_b32 s10, s49, 2
    s_lshl_b32 s14, s49, 2
    s_lshl_b32 s18, s49, 1
    s_sub_u32 s79, s87, s86
    s_bfm_b32 s85, s79, s86
    s_lshl_b32 s86, s86, 12
    s_lshl_b32 s87, s87, 12
    s_min_u32 s87, s87, 16384

    s_add_u32 s79, s78, 0
    s_bitcmp1_b32 s85, 0
    s_cselect_b32 s79, s79, 0x1ff00000
    s_lshl_b32 s56, s79, 2
    s_lshl_b32 s61, s79, 1

    s_add_u32 s79, s78, 4096
    s_bitcmp1_b32 s85, 1
    s_cselect_b32 s79, s79, 0x1ff00000
    s_lshl_b32 s57, s79, 2
    s_lshl_b32 s62, s79, 1

    s_add_u32 s79, s78, 8192
    s_bitcmp1_b32 s85, 2
    s_cselect_b32 s79, s79, 0x1ff00000
    s_lshl_b32 s58, s79, 2
    s_lshl_b32 s63, s79, 1

    s_add_u32 s79, s78, 12288
    s_bitcmp1_b32 s85, 3
    s_cselect_b32 s79, s79, 0x1ff00000
    s_lshl_b32 s59, s79, 2
    s_lshl_b32 s64, s79, 1

    s_mov_b32 s82, s85
    s_mov_b32 s83, s86
    s_mov_b32 s84, s87
    s_add_u32 s41, s2, 160
    s_mul_i32 s74, s41, 16384
    s_mov_b32 s10, 204800000
    s_mov_b32 s14, 204800000
    s_mov_b32 s18, 102400000

    s_add_u32 s75, s74, 0
    s_lshl_b32 s76, s75, 2
    s_lshl_b32 s75, s75, 1
    s_bitcmp1_b32 s82, 0
    s_cselect_b32 s56, s56, s76
    s_cselect_b32 s61, s61, s75

    s_add_u32 s75, s74, 4096
    s_lshl_b32 s76, s75, 2
    s_lshl_b32 s75, s75, 1
    s_bitcmp1_b32 s82, 1
    s_cselect_b32 s57, s57, s76
    s_cselect_b32 s62, s62, s75

    s_add_u32 s75, s74, 8192
    s_lshl_b32 s76, s75, 2
    s_lshl_b32 s75, s75, 1
    s_bitcmp1_b32 s82, 2
    s_cselect_b32 s58, s58, s76
    s_cselect_b32 s63, s63, s75

    s_add_u32 s75, s74, 12288
    s_lshl_b32 s76, s75, 2
    s_lshl_b32 s75, s75, 1
    s_bitcmp1_b32 s82, 3
    s_cselect_b32 s59, s59, s76
    s_cselect_b32 s64, s64, s75

    buffer_load_dwordx4 v[20:23], v1, s[12:15], s56 offen nt
    buffer_load_dwordx4 v[4:7], v1, s[8:11], s56 offen nt
    buffer_load_dwordx2 v[36:37], v2, s[16:19], s61 offen nt
    buffer_load_dwordx4 v[24:27], v1, s[12:15], s57 offen nt
    buffer_load_dwordx4 v[8:11], v1, s[8:11], s57 offen nt
    buffer_load_dwordx2 v[38:39], v2, s[16:19], s62 offen nt
    buffer_load_dwordx4 v[28:31], v1, s[12:15], s58 offen nt
    buffer_load_dwordx4 v[12:15], v1, s[8:11], s58 offen nt
    buffer_load_dwordx2 v[40:41], v2, s[16:19], s63 offen nt
    buffer_load_dwordx4 v[32:35], v1, s[12:15], s59 offen nt
    buffer_load_dwordx4 v[16:19], v1, s[8:11], s59 offen nt
    buffer_load_dwordx2 v[42:43], v2, s[16:19], s64 offen nt
    s_mov_b32 s86, 0
    s_mov_b32 s87, 4
    s_mul_i32 s78, s41, 16384
    s_add_u32 s49, s78, 16384
    s_cmp_ge_u32 s41, 3125
    s_cmovk_i32 s49, 0
    s_cmovk_i32 s78, 0
    s_lshl_b32 s10, s49, 2
    s_lshl_b32 s14, s49, 2
    s_lshl_b32 s18, s49, 1
    s_sub_u32 s79, s87, s86
    s_bfm_b32 s85, s79, s86
    s_lshl_b32 s86, s86, 12
    s_lshl_b32 s87, s87, 12
    s_min_u32 s87, s87, 16384

    s_add_u32 s79, s78, 0
    s_bitcmp1_b32 s85, 0
    s_cselect_b32 s79, s79, 0x1ff00000
    s_lshl_b32 s56, s79, 2
    s_lshl_b32 s61, s79, 1

    s_add_u32 s79, s78, 4096
    s_bitcmp1_b32 s85, 1
    s_cselect_b32 s79, s79, 0x1ff00000
    s_lshl_b32 s57, s79, 2
    s_lshl_b32 s62, s79, 1

    s_add_u32 s79, s78, 8192
    s_bitcmp1_b32 s85, 2
    s_cselect_b32 s79, s79, 0x1ff00000
    s_lshl_b32 s58, s79, 2
    s_lshl_b32 s63, s79, 1

    s_add_u32 s79, s78, 12288
    s_bitcmp1_b32 s85, 3
    s_cselect_b32 s79, s79, 0x1ff00000
    s_lshl_b32 s59, s79, 2
    s_lshl_b32 s64, s79, 1

    s_getreg_b32 s5, hwreg(HW_REG_XCC_ID)
    s_and_b32 s5, s5, 7
    s_mul_i32 s3, s5, 4096

    s_add_u32 s20, s6, s3
    s_addc_u32 s21, s7, 0
    s_mov_b32 s22, 4096
    s_mov_b32 s23, 0x20000
    s_mul_i32 s3, s5, 82575360
    s_add_u32 s3, s3, 83599360
    s_add_u32 s24, s6, s3
    s_addc_u32 s25, s7, 0
    s_mov_b32 s26, 82575360
    s_mov_b32 s27, 0x20000
    s_add_u32 s36, s6, 32768
    s_addc_u32 s37, s7, 0
    s_mov_b32 s38, 4
    s_mov_b32 s39, 0x20000
    s_mov_b32 s40, 687195
    s_mov_b32 s42, -6250
    s_mov_b32 s43, 1942
    s_mov_b32 s45, 0x06050400
    s_mov_b32 s46, 0x05040c00
    s_mov_b32 s47, 0x04020100
    s_mov_b32 s48, 8064
    s_mov_b32 s50, 0
    v_mov_b32 v104, 1
    v_mov_b32 v105, 0x46ff8000
    s_mov_b32 s55, 0x05040100
    v_mul_u32_u24 v106, 5, v0
    v_mov_b32 v108, 16384
    v_mov_b32 v114, 0
    v_mov_b32 v115, 0
    v_mov_b32 v116, 0
    v_mov_b32 v117, -1
    ds_write_b64 v2, v[114:115]
    s_movk_i32 s3, 1024
    v_cmp_gt_u32 s[66:67], s3, v0
    s_movk_i32 s3, 1024
    v_cmp_gt_u32 s[68:69], s3, v0
    s_mov_b64 exec, 1
    ds_write_b128 v108, v[114:117]
    s_mov_b64 exec, -1
    s_waitcnt lgkmcnt(0)
    s_lshl_b32 s88, s88, 16
    v_mov_b32 v110, 0.15915494
    v_mul_f32 v110, s88, v110
    s_mov_b32 s3, 0x7fff7fff
    v_readfirstlane_b32 s44, v110

    s_waitcnt vmcnt(12)
    v_mov_b32 v61, 0
    v_mov_b32 v62, 0
    v_mov_b32 v63, 0
    v_dot2_f32_bf16 v61, v44, v44, v61
    v_dot2_f32_bf16 v61, v45, v45, v61
    v_dot2_f32_bf16 v61, v46, v46, v61
    v_dot2_f32_bf16 v61, v47, v47, v61
    v_dot2_f32_bf16 v61, v48, v48, v61
    v_dot2_f32_bf16 v61, v49, v49, v61
    v_dot2_f32_bf16 v61, v50, v50, v61
    v_dot2_f32_bf16 v61, v51, v51, v61
    v_dot2_f32_bf16 v61, v52, v52, v61
    v_dot2_f32_bf16 v62, v56, v56, v62
    v_dot2_f32_bf16 v62, v57, v57, v62
    v_dot2_f32_bf16 v62, v58, v58, v62
    v_dot2_f32_bf16 v62, v59, v59, v62
    v_and_b32 v60, s3, v44
    v_and_b32 v64, s3, v45
    v_pk_max_u16 v60, v60, v64
    v_and_b32 v64, s3, v46
    v_pk_max_u16 v60, v60, v64
    v_and_b32 v64, s3, v47
    v_pk_max_u16 v60, v60, v64
    v_and_b32 v64, s3, v48
    v_pk_max_u16 v60, v60, v64
    v_and_b32 v64, s3, v49
    v_pk_max_u16 v60, v60, v64
    v_and_b32 v64, s3, v50
    v_pk_max_u16 v60, v60, v64
    v_and_b32 v64, s3, v51
    v_pk_max_u16 v60, v60, v64
    v_and_b32 v64, s3, v52
    v_pk_max_u16 v60, v60, v64
    v_lshrrev_b32 v64, 16, v60
    v_and_b32 v60, 0xffff, v60
    v_max_u32 v60, v60, v64

    s_nop 1
    v_max_u32_dpp v60, v60, v60 row_shr:1 row_mask:0xf bank_mask:0xf
    s_nop 1
    v_max_u32_dpp v60, v60, v60 row_shr:2 row_mask:0xf bank_mask:0xf
    s_nop 1
    v_max_u32_dpp v60, v60, v60 row_shr:4 row_mask:0xf bank_mask:0xf
    s_nop 1
    v_max_u32_dpp v60, v60, v60 row_shr:8 row_mask:0xf bank_mask:0xf
    s_nop 1
    v_max_u32_dpp v60, v60, v60 row_bcast:15 row_mask:0xa bank_mask:0xf
    s_nop 1
    v_max_u32_dpp v60, v60, v60 row_bcast:31 row_mask:0xc bank_mask:0xf
    s_nop 1
    v_add_f32_dpp v61, v61, v61 row_shr:1 row_mask:0xf bank_mask:0xf
    s_nop 1
    v_add_f32_dpp v61, v61, v61 row_shr:2 row_mask:0xf bank_mask:0xf
    s_nop 1
    v_add_f32_dpp v61, v61, v61 row_shr:4 row_mask:0xf bank_mask:0xf
    s_nop 1
    v_add_f32_dpp v61, v61, v61 row_shr:8 row_mask:0xf bank_mask:0xf
    s_nop 1
    v_add_f32_dpp v61, v61, v61 row_bcast:15 row_mask:0xa bank_mask:0xf
    s_nop 1
    v_add_f32_dpp v61, v61, v61 row_bcast:31 row_mask:0xc bank_mask:0xf
    s_nop 1
    v_add_f32_dpp v62, v62, v62 row_shr:1 row_mask:0xf bank_mask:0xf
    s_nop 1
    v_add_f32_dpp v62, v62, v62 row_shr:2 row_mask:0xf bank_mask:0xf
    s_nop 1
    v_add_f32_dpp v62, v62, v62 row_shr:4 row_mask:0xf bank_mask:0xf
    s_nop 1
    v_add_f32_dpp v62, v62, v62 row_shr:8 row_mask:0xf bank_mask:0xf
    s_nop 1
    v_add_f32_dpp v62, v62, v62 row_bcast:15 row_mask:0xa bank_mask:0xf
    s_nop 1
    v_add_f32_dpp v62, v62, v62 row_bcast:31 row_mask:0xc bank_mask:0xf
    v_lshrrev_b32 v64, 6, v0
    v_lshlrev_b32 v64, 4, v64
    s_mov_b32 exec_lo, 0
    s_brev_b32 exec_hi, 1
    ds_write_b128 v64, v[60:63] offset:8192
    s_mov_b64 exec, -1
    v_and_b32 v64, 15, v0
    v_lshlrev_b32 v64, 4, v64
    s_waitcnt lgkmcnt(0)
    s_barrier
    ds_read_b128 v[60:63], v64 offset:8192
    s_waitcnt lgkmcnt(0)

    s_nop 0
    v_max_u32_dpp v60, v60, v60 row_ror:1 row_mask:0xf bank_mask:0xf
    v_add_f32_dpp v61, v61, v61 row_ror:1 row_mask:0xf bank_mask:0xf
    v_add_f32_dpp v62, v62, v62 row_ror:1 row_mask:0xf bank_mask:0xf

    s_nop 0
    v_max_u32_dpp v60, v60, v60 row_ror:2 row_mask:0xf bank_mask:0xf
    v_add_f32_dpp v61, v61, v61 row_ror:2 row_mask:0xf bank_mask:0xf
    v_add_f32_dpp v62, v62, v62 row_ror:2 row_mask:0xf bank_mask:0xf

    s_nop 0
    v_max_u32_dpp v60, v60, v60 row_ror:4 row_mask:0xf bank_mask:0xf
    v_add_f32_dpp v61, v61, v61 row_ror:4 row_mask:0xf bank_mask:0xf
    v_add_f32_dpp v62, v62, v62 row_ror:4 row_mask:0xf bank_mask:0xf

    s_nop 0
    v_max_u32_dpp v60, v60, v60 row_ror:8 row_mask:0xf bank_mask:0xf
    v_add_f32_dpp v61, v61, v61 row_ror:8 row_mask:0xf bank_mask:0xf
    v_add_f32_dpp v62, v62, v62 row_ror:8 row_mask:0xf bank_mask:0xf

    v_rsq_f32 v62, v62
    v_mov_b32 v65, 0x4b400000
    v_mul_f32 v62, 0x47decb04, v62
    s_nop 0
    v_readfirstlane_b32 s74, v62

    s_add_u32 s92, s6, 135168
    s_addc_u32 s93, s7, 0
    s_mov_b32 s94, 4096
    s_mov_b32 s95, 0x20000
    s_lshl_b32 s3, s2, 4
    buffer_store_dwordx4 v[60:63], v98, s[92:95], s3 offen
    v_lshlrev_b32 v66, 16, v44
    v_and_b32 v44, 0xffff0000, v44
    v_fma_f32 v66, v66, s74, v65
    v_fma_f32 v44, v44, s74, v65
    v_perm_b32 v44, v44, v66, s55

    v_lshlrev_b32 v66, 16, v45
    v_and_b32 v45, 0xffff0000, v45
    v_fma_f32 v66, v66, s74, v65
    v_fma_f32 v45, v45, s74, v65
    v_perm_b32 v45, v45, v66, s55

    v_lshlrev_b32 v66, 16, v46
    v_and_b32 v46, 0xffff0000, v46
    v_fma_f32 v66, v66, s74, v65
    v_fma_f32 v46, v46, s74, v65
    v_perm_b32 v46, v46, v66, s55

    v_lshlrev_b32 v66, 16, v47
    v_and_b32 v47, 0xffff0000, v47
    v_fma_f32 v66, v66, s74, v65
    v_fma_f32 v47, v47, s74, v65
    v_perm_b32 v47, v47, v66, s55

    v_lshlrev_b32 v66, 16, v48
    v_and_b32 v48, 0xffff0000, v48
    v_fma_f32 v66, v66, s74, v65
    v_fma_f32 v48, v48, s74, v65
    v_perm_b32 v48, v48, v66, s55

    v_lshlrev_b32 v66, 16, v49
    v_and_b32 v49, 0xffff0000, v49
    v_fma_f32 v66, v66, s74, v65
    v_fma_f32 v49, v49, s74, v65
    v_perm_b32 v49, v49, v66, s55

    v_lshlrev_b32 v66, 16, v50
    v_and_b32 v50, 0xffff0000, v50
    v_fma_f32 v66, v66, s74, v65
    v_fma_f32 v50, v50, s74, v65
    v_perm_b32 v50, v50, v66, s55

    v_lshlrev_b32 v66, 16, v51
    v_and_b32 v51, 0xffff0000, v51
    v_fma_f32 v66, v66, s74, v65
    v_fma_f32 v51, v51, s74, v65
    v_perm_b32 v51, v51, v66, s55

    v_lshlrev_b32 v66, 16, v52
    v_and_b32 v52, 0xffff0000, v52
    v_fma_f32 v66, v66, s74, v65
    v_fma_f32 v52, v52, s74, v65
    v_perm_b32 v52, v52, v66, s55

    s_add_u32 s92, s6, s54
    s_addc_u32 s93, s7, 0
    s_mov_b32 s94, 24576
    s_mov_b32 s95, 0x20000
    s_movk_i32 s3, 16384
    buffer_store_dwordx4 v[44:47], v1, s[92:95], 0 offen
    buffer_store_dwordx4 v[48:51], v1, s[92:95], s3 offen
    s_mul_i32 s94, s53, 25424
    s_movk_i32 s3, 24576

    buffer_store_dword v52, v100, s[92:95], s3 offen
    s_nop 1
    v_mov_b32 v100, 0
    buffer_atomic_add v100, v98, s[96:99], 0 offen offset:128 sc0
    s_bitcmp0_b32 s82, 0
    s_cbranch_scc1 L_ska_7
    s_waitcnt vmcnt(14)
    v_mul_hi_u32_u24 v45, s40, v20
    v_mul_hi_u32_u24 v44, s40, v4
    v_mul_hi_u32_u24 v47, s40, v21
    v_mul_hi_u32_u24 v46, s40, v5
    v_mul_hi_u32_u24 v49, s40, v22
    v_mul_hi_u32_u24 v48, s40, v6
    v_mul_hi_u32_u24 v51, s40, v23
    v_mul_hi_u32_u24 v50, s40, v7
    v_and_b32 v45, -2, v45
    v_mad_u32_u24 v4, v44, s43, v4
    v_and_b32 v76, -4, v44
    v_and_b32 v47, -2, v47
    v_mad_u32_u24 v5, v46, s43, v5
    v_and_b32 v77, -4, v46
    v_and_b32 v49, -2, v49
    v_mad_u32_u24 v6, v48, s43, v6
    v_and_b32 v78, -4, v48
    v_and_b32 v51, -2, v51
    v_mad_u32_u24 v7, v50, s43, v7
    v_and_b32 v79, -4, v50
    v_mad_i32_i24 v20, v45, s42, v20
    v_lshl_add_u32 v45, v76, 5, v45
    v_mad_i32_i24 v21, v47, s42, v21
    v_lshl_add_u32 v47, v77, 5, v47
    v_mad_i32_i24 v22, v49, s42, v22
    v_lshl_add_u32 v49, v78, 5, v49
    v_mad_i32_i24 v23, v51, s42, v23
    v_lshl_add_u32 v51, v79, 5, v51
    v_add_u32 v45, v45, v45
    ds_add_rtn_u32 v76, v45, v104
    v_add_u32 v47, v47, v47
    ds_add_rtn_u32 v77, v47, v104
    v_add_u32 v49, v49, v49
    ds_add_rtn_u32 v78, v49, v104
    v_add_u32 v51, v51, v51
    ds_add_rtn_u32 v79, v51, v104
    v_lshlrev_b32 v110, 16, v36
    v_and_b32 v111, 0xffff0000, v36
    v_lshlrev_b32 v112, 16, v37
    v_and_b32 v113, 0xffff0000, v37
    v_mul_f32 v110, s44, v110
    v_mul_f32 v111, s44, v111
    v_mul_f32 v112, s44, v112
    v_mul_f32 v113, s44, v113
    v_fract_f32 v110, v110
    v_fract_f32 v111, v111
    v_fract_f32 v112, v112
    v_fract_f32 v113, v113
    v_cos_f32 v110, v110
    v_cos_f32 v111, v111
    v_cos_f32 v112, v112
    v_cos_f32 v113, v113
    v_lshl_or_b32 v44, v44, 14, v20
    v_perm_b32 v45, v45, v4, s46
    v_bfe_u32 v4, v4, 8, 5

    v_lshl_or_b32 v46, v46, 14, v21
    v_perm_b32 v47, v47, v5, s46
    v_bfe_u32 v5, v5, 8, 5

    v_lshl_or_b32 v48, v48, 14, v22
    v_perm_b32 v49, v49, v6, s46
    v_bfe_u32 v6, v6, 8, 5

    v_lshl_or_b32 v50, v50, 14, v23
    v_perm_b32 v51, v51, v7, s46
    v_bfe_u32 v7, v7, 8, 5

    v_fmaak_f32 v110, v110, v105, 0x4b400010
    v_fmaak_f32 v111, v111, v105, 0x4b400010
    v_fmaak_f32 v112, v112, v105, 0x4b400010
    v_fmaak_f32 v113, v113, v105, 0x4b400010
    v_sub_u32 v110, v110, v4
    v_sub_u32 v111, v111, v5
    v_sub_u32 v112, v112, v6
    v_sub_u32 v113, v113, v7
    v_bfi_b32 v110, 31, v4, v110
    v_bfi_b32 v111, 31, v5, v111
    v_bfi_b32 v112, 31, v6, v112
    v_bfi_b32 v113, 31, v7, v113
    v_perm_b32 v44, v44, v110, s55
    v_perm_b32 v46, v46, v111, s55
    v_perm_b32 v48, v48, v112, s55
    v_perm_b32 v50, v50, v113, s55
    buffer_load_dwordx4 v[20:23], v1, s[12:15], s56 offen nt
    buffer_load_dwordx4 v[4:7], v1, s[8:11], s56 offen nt
    buffer_load_dwordx2 v[36:37], v2, s[16:19], s61 offen nt
L_bka_8:
    s_bitcmp0_b32 s82, 1
    s_cbranch_scc1 L_ska_9
    s_waitcnt vmcnt(14)
    v_mul_hi_u32_u24 v53, s40, v24
    v_mul_hi_u32_u24 v52, s40, v8
    v_mul_hi_u32_u24 v55, s40, v25
    v_mul_hi_u32_u24 v54, s40, v9
    v_mul_hi_u32_u24 v57, s40, v26
    v_mul_hi_u32_u24 v56, s40, v10
    v_mul_hi_u32_u24 v59, s40, v27
    v_mul_hi_u32_u24 v58, s40, v11
    v_and_b32 v53, -2, v53
    v_mad_u32_u24 v8, v52, s43, v8
    v_and_b32 v80, -4, v52
    v_and_b32 v55, -2, v55
    v_mad_u32_u24 v9, v54, s43, v9
    v_and_b32 v81, -4, v54
    v_and_b32 v57, -2, v57
    v_mad_u32_u24 v10, v56, s43, v10
    v_and_b32 v82, -4, v56
    v_and_b32 v59, -2, v59
    v_mad_u32_u24 v11, v58, s43, v11
    v_and_b32 v83, -4, v58
    v_mad_i32_i24 v24, v53, s42, v24
    v_lshl_add_u32 v53, v80, 5, v53
    v_mad_i32_i24 v25, v55, s42, v25
    v_lshl_add_u32 v55, v81, 5, v55
    v_mad_i32_i24 v26, v57, s42, v26
    v_lshl_add_u32 v57, v82, 5, v57
    v_mad_i32_i24 v27, v59, s42, v27
    v_lshl_add_u32 v59, v83, 5, v59
    v_add_u32 v53, v53, v53
    ds_add_rtn_u32 v80, v53, v104
    v_add_u32 v55, v55, v55
    ds_add_rtn_u32 v81, v55, v104
    v_add_u32 v57, v57, v57
    ds_add_rtn_u32 v82, v57, v104
    v_add_u32 v59, v59, v59
    ds_add_rtn_u32 v83, v59, v104
    v_lshlrev_b32 v110, 16, v38
    v_and_b32 v111, 0xffff0000, v38
    v_lshlrev_b32 v112, 16, v39
    v_and_b32 v113, 0xffff0000, v39
    v_mul_f32 v110, s44, v110
    v_mul_f32 v111, s44, v111
    v_mul_f32 v112, s44, v112
    v_mul_f32 v113, s44, v113
    v_fract_f32 v110, v110
    v_fract_f32 v111, v111
    v_fract_f32 v112, v112
    v_fract_f32 v113, v113
    v_cos_f32 v110, v110
    v_cos_f32 v111, v111
    v_cos_f32 v112, v112
    v_cos_f32 v113, v113
    v_lshl_or_b32 v52, v52, 14, v24
    v_perm_b32 v53, v53, v8, s46
    v_bfe_u32 v8, v8, 8, 5

    v_lshl_or_b32 v54, v54, 14, v25
    v_perm_b32 v55, v55, v9, s46
    v_bfe_u32 v9, v9, 8, 5

    v_lshl_or_b32 v56, v56, 14, v26
    v_perm_b32 v57, v57, v10, s46
    v_bfe_u32 v10, v10, 8, 5

    v_lshl_or_b32 v58, v58, 14, v27
    v_perm_b32 v59, v59, v11, s46
    v_bfe_u32 v11, v11, 8, 5

    v_fmaak_f32 v110, v110, v105, 0x4b400010
    v_fmaak_f32 v111, v111, v105, 0x4b400010
    v_fmaak_f32 v112, v112, v105, 0x4b400010
    v_fmaak_f32 v113, v113, v105, 0x4b400010
    v_sub_u32 v110, v110, v8
    v_sub_u32 v111, v111, v9
    v_sub_u32 v112, v112, v10
    v_sub_u32 v113, v113, v11
    v_bfi_b32 v110, 31, v8, v110
    v_bfi_b32 v111, 31, v9, v111
    v_bfi_b32 v112, 31, v10, v112
    v_bfi_b32 v113, 31, v11, v113
    v_perm_b32 v52, v52, v110, s55
    v_perm_b32 v54, v54, v111, s55
    v_perm_b32 v56, v56, v112, s55
    v_perm_b32 v58, v58, v113, s55
    buffer_load_dwordx4 v[24:27], v1, s[12:15], s57 offen nt
    buffer_load_dwordx4 v[8:11], v1, s[8:11], s57 offen nt
    buffer_load_dwordx2 v[38:39], v2, s[16:19], s62 offen nt
L_bka_10:
    s_bitcmp0_b32 s82, 2
    s_cbranch_scc1 L_ska_11
    s_waitcnt vmcnt(14)
    v_mul_hi_u32_u24 v61, s40, v28
    v_mul_hi_u32_u24 v60, s40, v12
    v_mul_hi_u32_u24 v63, s40, v29
    v_mul_hi_u32_u24 v62, s40, v13
    v_mul_hi_u32_u24 v65, s40, v30
    v_mul_hi_u32_u24 v64, s40, v14
    v_mul_hi_u32_u24 v67, s40, v31
    v_mul_hi_u32_u24 v66, s40, v15
    v_and_b32 v61, -2, v61
    v_mad_u32_u24 v12, v60, s43, v12
    v_and_b32 v84, -4, v60
    v_and_b32 v63, -2, v63
    v_mad_u32_u24 v13, v62, s43, v13
    v_and_b32 v85, -4, v62
    v_and_b32 v65, -2, v65
    v_mad_u32_u24 v14, v64, s43, v14
    v_and_b32 v86, -4, v64
    v_and_b32 v67, -2, v67
    v_mad_u32_u24 v15, v66, s43, v15
    v_and_b32 v87, -4, v66
    v_mad_i32_i24 v28, v61, s42, v28
    v_lshl_add_u32 v61, v84, 5, v61
    v_mad_i32_i24 v29, v63, s42, v29
    v_lshl_add_u32 v63, v85, 5, v63
    v_mad_i32_i24 v30, v65, s42, v30
    v_lshl_add_u32 v65, v86, 5, v65
    v_mad_i32_i24 v31, v67, s42, v31
    v_lshl_add_u32 v67, v87, 5, v67
    v_add_u32 v61, v61, v61
    ds_add_rtn_u32 v84, v61, v104
    v_add_u32 v63, v63, v63
    ds_add_rtn_u32 v85, v63, v104
    v_add_u32 v65, v65, v65
    ds_add_rtn_u32 v86, v65, v104
    v_add_u32 v67, v67, v67
    ds_add_rtn_u32 v87, v67, v104
    v_lshlrev_b32 v110, 16, v40
    v_and_b32 v111, 0xffff0000, v40
    v_lshlrev_b32 v112, 16, v41
    v_and_b32 v113, 0xffff0000, v41
    v_mul_f32 v110, s44, v110
    v_mul_f32 v111, s44, v111
    v_mul_f32 v112, s44, v112
    v_mul_f32 v113, s44, v113
    v_fract_f32 v110, v110
    v_fract_f32 v111, v111
    v_fract_f32 v112, v112
    v_fract_f32 v113, v113
    v_cos_f32 v110, v110
    v_cos_f32 v111, v111
    v_cos_f32 v112, v112
    v_cos_f32 v113, v113
    v_lshl_or_b32 v60, v60, 14, v28
    v_perm_b32 v61, v61, v12, s46
    v_bfe_u32 v12, v12, 8, 5

    v_lshl_or_b32 v62, v62, 14, v29
    v_perm_b32 v63, v63, v13, s46
    v_bfe_u32 v13, v13, 8, 5

    v_lshl_or_b32 v64, v64, 14, v30
    v_perm_b32 v65, v65, v14, s46
    v_bfe_u32 v14, v14, 8, 5

    v_lshl_or_b32 v66, v66, 14, v31
    v_perm_b32 v67, v67, v15, s46
    v_bfe_u32 v15, v15, 8, 5

    v_fmaak_f32 v110, v110, v105, 0x4b400010
    v_fmaak_f32 v111, v111, v105, 0x4b400010
    v_fmaak_f32 v112, v112, v105, 0x4b400010
    v_fmaak_f32 v113, v113, v105, 0x4b400010
    v_sub_u32 v110, v110, v12
    v_sub_u32 v111, v111, v13
    v_sub_u32 v112, v112, v14
    v_sub_u32 v113, v113, v15
    v_bfi_b32 v110, 31, v12, v110
    v_bfi_b32 v111, 31, v13, v111
    v_bfi_b32 v112, 31, v14, v112
    v_bfi_b32 v113, 31, v15, v113
    v_perm_b32 v60, v60, v110, s55
    v_perm_b32 v62, v62, v111, s55
    v_perm_b32 v64, v64, v112, s55
    v_perm_b32 v66, v66, v113, s55
    buffer_load_dwordx4 v[28:31], v1, s[12:15], s58 offen nt
    buffer_load_dwordx4 v[12:15], v1, s[8:11], s58 offen nt
    buffer_load_dwordx2 v[40:41], v2, s[16:19], s63 offen nt
L_bka_12:
    s_bitcmp0_b32 s82, 3
    s_cbranch_scc1 L_ska_13
    s_waitcnt vmcnt(14)
    s_mov_b64 exec, s[66:67]
    v_mul_hi_u32_u24 v69, s40, v32
    v_mul_hi_u32_u24 v68, s40, v16
    v_mul_hi_u32_u24 v71, s40, v33
    v_mul_hi_u32_u24 v70, s40, v17
    v_mul_hi_u32_u24 v73, s40, v34
    v_mul_hi_u32_u24 v72, s40, v18
    v_mul_hi_u32_u24 v75, s40, v35
    v_mul_hi_u32_u24 v74, s40, v19
    v_and_b32 v69, -2, v69
    v_mad_u32_u24 v16, v68, s43, v16
    v_and_b32 v88, -4, v68
    v_and_b32 v71, -2, v71
    v_mad_u32_u24 v17, v70, s43, v17
    v_and_b32 v89, -4, v70
    v_and_b32 v73, -2, v73
    v_mad_u32_u24 v18, v72, s43, v18
    v_and_b32 v90, -4, v72
    v_and_b32 v75, -2, v75
    v_mad_u32_u24 v19, v74, s43, v19
    v_and_b32 v91, -4, v74
    v_mad_i32_i24 v32, v69, s42, v32
    v_lshl_add_u32 v69, v88, 5, v69
    v_mad_i32_i24 v33, v71, s42, v33
    v_lshl_add_u32 v71, v89, 5, v71
    v_mad_i32_i24 v34, v73, s42, v34
    v_lshl_add_u32 v73, v90, 5, v73
    v_mad_i32_i24 v35, v75, s42, v35
    v_lshl_add_u32 v75, v91, 5, v75
    v_add_u32 v69, v69, v69
    ds_add_rtn_u32 v88, v69, v104
    v_add_u32 v71, v71, v71
    ds_add_rtn_u32 v89, v71, v104
    v_add_u32 v73, v73, v73
    ds_add_rtn_u32 v90, v73, v104
    v_add_u32 v75, v75, v75
    ds_add_rtn_u32 v91, v75, v104
    v_lshlrev_b32 v110, 16, v42
    v_and_b32 v111, 0xffff0000, v42
    v_lshlrev_b32 v112, 16, v43
    v_and_b32 v113, 0xffff0000, v43
    v_mul_f32 v110, s44, v110
    v_mul_f32 v111, s44, v111
    v_mul_f32 v112, s44, v112
    v_mul_f32 v113, s44, v113
    v_fract_f32 v110, v110
    v_fract_f32 v111, v111
    v_fract_f32 v112, v112
    v_fract_f32 v113, v113
    v_cos_f32 v110, v110
    v_cos_f32 v111, v111
    v_cos_f32 v112, v112
    v_cos_f32 v113, v113
    v_lshl_or_b32 v68, v68, 14, v32
    v_perm_b32 v69, v69, v16, s46
    v_bfe_u32 v16, v16, 8, 5

    v_lshl_or_b32 v70, v70, 14, v33
    v_perm_b32 v71, v71, v17, s46
    v_bfe_u32 v17, v17, 8, 5

    v_lshl_or_b32 v72, v72, 14, v34
    v_perm_b32 v73, v73, v18, s46
    v_bfe_u32 v18, v18, 8, 5

    v_lshl_or_b32 v74, v74, 14, v35
    v_perm_b32 v75, v75, v19, s46
    v_bfe_u32 v19, v19, 8, 5

    v_fmaak_f32 v110, v110, v105, 0x4b400010
    v_fmaak_f32 v111, v111, v105, 0x4b400010
    v_fmaak_f32 v112, v112, v105, 0x4b400010
    v_fmaak_f32 v113, v113, v105, 0x4b400010
    v_sub_u32 v110, v110, v16
    v_sub_u32 v111, v111, v17
    v_sub_u32 v112, v112, v18
    v_sub_u32 v113, v113, v19
    v_bfi_b32 v110, 31, v16, v110
    v_bfi_b32 v111, 31, v17, v111
    v_bfi_b32 v112, 31, v18, v112
    v_bfi_b32 v113, 31, v19, v113
    v_perm_b32 v68, v68, v110, s55
    v_perm_b32 v70, v70, v111, s55
    v_perm_b32 v72, v72, v112, s55
    v_perm_b32 v74, v74, v113, s55
    s_mov_b64 exec, -1
    buffer_load_dwordx4 v[32:35], v1, s[12:15], s59 offen nt
    buffer_load_dwordx4 v[16:19], v1, s[8:11], s59 offen nt
    buffer_load_dwordx2 v[42:43], v2, s[16:19], s64 offen nt
L_bka_14:
    v_readfirstlane_b32 s74, v0
    s_nop 1
    s_cmp_lg_u32 s74, 0
    s_cbranch_scc1 L_ready_16

    s_waitcnt vmcnt(12)
    v_readfirstlane_b32 s74, v100
    s_nop 1
    s_cmp_lg_u32 s74, 0
    s_cbranch_scc1 L_ready_16

    v_mov_b32 v110, 1
    buffer_atomic_add v110, v98, s[96:99], 0 offen offset:64 sc0
    s_waitcnt vmcnt(0)
    v_readfirstlane_b32 s74, v110
    s_nop 1
    s_cmp_lg_u32 s74, 0
    s_cbranch_scc1 L_zno_18

    s_mov_b32 s92, s6
    s_mov_b32 s93, s7
    s_mov_b32 s94, 32784
    s_mov_b32 s95, 0x20000
    v_mov_b32 v110, 0
    v_mov_b32 v111, 0
    v_mov_b32 v112, 0
    v_mov_b32 v113, 0
L_zl_17:
    buffer_store_dwordx4 v[110:113], v1, s[92:95], s74 offen sc0 sc1
    s_add_u32 s74, s74, 1024
    s_cmp_le_u32 s74, 32768
    s_cbranch_scc1 L_zl_17
    v_mov_b32 v114, 1
    s_waitcnt vmcnt(0)
    buffer_atomic_add v114, v98, s[96:99], 0 offen offset:128
L_zno_18:

L_spin_15:
    v_mov_b32 v100, 0
    buffer_atomic_add v100, v98, s[96:99], 0 offen offset:128 sc0
    s_waitcnt vmcnt(0)
    v_readfirstlane_b32 s74, v100
    s_nop 1
    s_cmp_eq_u32 s74, 0
    s_cbranch_scc1 L_spin_15
L_ready_16:

    s_waitcnt lgkmcnt(0)
    s_barrier

    ds_read_b64 v[94:95], v2
    s_waitcnt lgkmcnt(0)
    v_and_b32 v94, 0xffff, v94
    v_and_b32 v95, 0xffff, v95
    v_add_u32 v97, v94, v95
    s_nop 1
    v_add_u32_dpp v97, v97, v97 row_shr:1 row_mask:0xf bank_mask:0xf
    s_nop 1
    v_add_u32_dpp v97, v97, v97 row_shr:2 row_mask:0xf bank_mask:0xf
    s_nop 1
    v_add_u32_dpp v97, v97, v97 row_shr:4 row_mask:0xf bank_mask:0xf
    s_nop 1
    v_add_u32_dpp v97, v97, v97 row_shr:8 row_mask:0xf bank_mask:0xf
    s_nop 1
    v_add_u32_dpp v97, v97, v97 row_bcast:15 row_mask:0xa bank_mask:0xf
    s_nop 1
    v_add_u32_dpp v97, v97, v97 row_bcast:31 row_mask:0xc bank_mask:0xf
    s_mov_b32 exec_lo, 0
    s_brev_b32 exec_hi, 1
    ds_add_rtn_u32 v96, v108, v97
    s_mov_b64 exec, -1

    v_add_u32 v92, v94, v94
    v_add_u32 v93, v95, v95
    v_med3_u32 v92, v94, 2, v92
    v_med3_u32 v93, v95, 2, v93
    v_lshl_or_b32 v92, v93, 16, v92
    v_lshlrev_b32 v93, 2, v0
    buffer_atomic_add v92, v93, s[20:23], 0 offen sc0
    s_waitcnt lgkmcnt(0)
    v_readlane_b32 s77, v96, 63
    v_mul_u32_u24 v114, 16128, v0
    v_sub_u32 v97, v97, v95
    s_sub_u32 s50, s50, s83
    s_sub_u32 s77, s77, s50
    v_add_u32 v97, s77, v97
    v_sub_u32 v96, v97, v94
    v_lshlrev_b32 v111, 16, v97
    v_lshlrev_b32 v110, 16, v96
    ds_write_b64 v2, v[110:111]
    v_sub_u32 v96, v114, v96
    v_sub_u32 v97, v114, v97
    v_add_u32 v97, s48, v97
    s_add_u32 s50, s50, s84
    s_mov_b32 s28, s82
    s_mov_b32 s29, s83
    s_mov_b32 s30, s84
    s_lshl_b32 s74, s29, 3
    s_lshl_b32 s75, s30, 3
    v_mov_b32 v125, s74
    v_mov_b32 v126, s75
    v_mov_b32 v127, -1

    s_waitcnt lgkmcnt(0)
    s_barrier

    s_mov_b64 exec, 1
    ds_write_b32 v125, v127 offset:16396
    ds_write_b32 v126, v127 offset:16404
    s_mov_b64 exec, -1

    s_bitcmp0_b32 s28, 0
    s_cbranch_scc1 L_skz_19
    v_lshrrev_b32 v110, 16, v45
    ds_read_b32 v110, v110
    v_lshrrev_b32 v111, 16, v47
    ds_read_b32 v111, v111
    v_lshrrev_b32 v112, 16, v49
    ds_read_b32 v112, v112
    v_lshrrev_b32 v113, 16, v51
    ds_read_b32 v113, v113
    s_waitcnt lgkmcnt(3)
    v_add_u32_sdwa v110, v110, v76 dst_sel:DWORD dst_unused:UNUSED_PAD src0_sel:WORD_1 src1_sel:WORD_0
    v_lshlrev_b32 v110, 3, v110
    ds_write_b64 v110, v[44:45] offset:16400

    s_waitcnt lgkmcnt(3)
    v_add_u32_sdwa v111, v111, v77 dst_sel:DWORD dst_unused:UNUSED_PAD src0_sel:WORD_1 src1_sel:WORD_0
    v_lshlrev_b32 v111, 3, v111
    ds_write_b64 v111, v[46:47] offset:16400

    s_waitcnt lgkmcnt(3)
    v_add_u32_sdwa v112, v112, v78 dst_sel:DWORD dst_unused:UNUSED_PAD src0_sel:WORD_1 src1_sel:WORD_0
    v_lshlrev_b32 v112, 3, v112
    ds_write_b64 v112, v[48:49] offset:16400

    s_waitcnt lgkmcnt(3)
    v_add_u32_sdwa v113, v113, v79 dst_sel:DWORD dst_unused:UNUSED_PAD src0_sel:WORD_1 src1_sel:WORD_0
    v_lshlrev_b32 v113, 3, v113
    ds_write_b64 v113, v[50:51] offset:16400

L_skz_19:
    s_bitcmp0_b32 s28, 1
    s_cbranch_scc1 L_skz_20
    v_lshrrev_b32 v110, 16, v53
    ds_read_b32 v110, v110
    v_lshrrev_b32 v111, 16, v55
    ds_read_b32 v111, v111
    v_lshrrev_b32 v112, 16, v57
    ds_read_b32 v112, v112
    v_lshrrev_b32 v113, 16, v59
    ds_read_b32 v113, v113
    s_waitcnt lgkmcnt(3)
    v_add_u32_sdwa v110, v110, v80 dst_sel:DWORD dst_unused:UNUSED_PAD src0_sel:WORD_1 src1_sel:WORD_0
    v_lshlrev_b32 v110, 3, v110
    ds_write_b64 v110, v[52:53] offset:16400

    s_waitcnt lgkmcnt(3)
    v_add_u32_sdwa v111, v111, v81 dst_sel:DWORD dst_unused:UNUSED_PAD src0_sel:WORD_1 src1_sel:WORD_0
    v_lshlrev_b32 v111, 3, v111
    ds_write_b64 v111, v[54:55] offset:16400

    s_waitcnt lgkmcnt(3)
    v_add_u32_sdwa v112, v112, v82 dst_sel:DWORD dst_unused:UNUSED_PAD src0_sel:WORD_1 src1_sel:WORD_0
    v_lshlrev_b32 v112, 3, v112
    ds_write_b64 v112, v[56:57] offset:16400

    s_waitcnt lgkmcnt(3)
    v_add_u32_sdwa v113, v113, v83 dst_sel:DWORD dst_unused:UNUSED_PAD src0_sel:WORD_1 src1_sel:WORD_0
    v_lshlrev_b32 v113, 3, v113
    ds_write_b64 v113, v[58:59] offset:16400

L_skz_20:
    s_bitcmp0_b32 s28, 2
    s_cbranch_scc1 L_skz_21
    v_lshrrev_b32 v110, 16, v61
    ds_read_b32 v110, v110
    v_lshrrev_b32 v111, 16, v63
    ds_read_b32 v111, v111
    v_lshrrev_b32 v112, 16, v65
    ds_read_b32 v112, v112
    v_lshrrev_b32 v113, 16, v67
    ds_read_b32 v113, v113
    s_waitcnt lgkmcnt(3)
    v_add_u32_sdwa v110, v110, v84 dst_sel:DWORD dst_unused:UNUSED_PAD src0_sel:WORD_1 src1_sel:WORD_0
    v_lshlrev_b32 v110, 3, v110
    ds_write_b64 v110, v[60:61] offset:16400

    s_waitcnt lgkmcnt(3)
    v_add_u32_sdwa v111, v111, v85 dst_sel:DWORD dst_unused:UNUSED_PAD src0_sel:WORD_1 src1_sel:WORD_0
    v_lshlrev_b32 v111, 3, v111
    ds_write_b64 v111, v[62:63] offset:16400

    s_waitcnt lgkmcnt(3)
    v_add_u32_sdwa v112, v112, v86 dst_sel:DWORD dst_unused:UNUSED_PAD src0_sel:WORD_1 src1_sel:WORD_0
    v_lshlrev_b32 v112, 3, v112
    ds_write_b64 v112, v[64:65] offset:16400

    s_waitcnt lgkmcnt(3)
    v_add_u32_sdwa v113, v113, v87 dst_sel:DWORD dst_unused:UNUSED_PAD src0_sel:WORD_1 src1_sel:WORD_0
    v_lshlrev_b32 v113, 3, v113
    ds_write_b64 v113, v[66:67] offset:16400

L_skz_21:
    s_bitcmp0_b32 s28, 3
    s_cbranch_scc1 L_skz_22
    s_mov_b64 exec, s[66:67]
    v_lshrrev_b32 v110, 16, v69
    ds_read_b32 v110, v110
    v_lshrrev_b32 v111, 16, v71
    ds_read_b32 v111, v111
    v_lshrrev_b32 v112, 16, v73
    ds_read_b32 v112, v112
    v_lshrrev_b32 v113, 16, v75
    ds_read_b32 v113, v113
    s_waitcnt lgkmcnt(3)
    v_add_u32_sdwa v110, v110, v88 dst_sel:DWORD dst_unused:UNUSED_PAD src0_sel:WORD_1 src1_sel:WORD_0
    v_lshlrev_b32 v110, 3, v110
    ds_write_b64 v110, v[68:69] offset:16400

    s_waitcnt lgkmcnt(3)
    v_add_u32_sdwa v111, v111, v89 dst_sel:DWORD dst_unused:UNUSED_PAD src0_sel:WORD_1 src1_sel:WORD_0
    v_lshlrev_b32 v111, 3, v111
    ds_write_b64 v111, v[70:71] offset:16400

    s_waitcnt lgkmcnt(3)
    v_add_u32_sdwa v112, v112, v90 dst_sel:DWORD dst_unused:UNUSED_PAD src0_sel:WORD_1 src1_sel:WORD_0
    v_lshlrev_b32 v112, 3, v112
    ds_write_b64 v112, v[72:73] offset:16400

    s_waitcnt lgkmcnt(3)
    v_add_u32_sdwa v113, v113, v91 dst_sel:DWORD dst_unused:UNUSED_PAD src0_sel:WORD_1 src1_sel:WORD_0
    v_lshlrev_b32 v113, 3, v113
    ds_write_b64 v113, v[74:75] offset:16400

    s_mov_b64 exec, -1
L_skz_22:
    s_cmp_eq_u32 s49, 0
    s_cbranch_scc1 L_p1epi_6
L_p1loop_5:
    s_mov_b32 s82, s85
    s_mov_b32 s83, s86
    s_mov_b32 s84, s87
    v_mov_b32 v99, 1
    buffer_atomic_add v99, v98, s[96:99], 0 offen sc0
    s_bitcmp0_b32 s82, 0
    s_cbranch_scc1 L_ska_23
    s_waitcnt vmcnt(11)
    v_mul_hi_u32_u24 v45, s40, v20
    v_mul_hi_u32_u24 v44, s40, v4
    v_mul_hi_u32_u24 v47, s40, v21
    v_mul_hi_u32_u24 v46, s40, v5
    v_mul_hi_u32_u24 v49, s40, v22
    v_mul_hi_u32_u24 v48, s40, v6
    v_mul_hi_u32_u24 v51, s40, v23
    v_mul_hi_u32_u24 v50, s40, v7
    v_and_b32 v45, -2, v45
    v_mad_u32_u24 v4, v44, s43, v4
    v_and_b32 v76, -4, v44
    v_and_b32 v47, -2, v47
    v_mad_u32_u24 v5, v46, s43, v5
    v_and_b32 v77, -4, v46
    v_and_b32 v49, -2, v49
    v_mad_u32_u24 v6, v48, s43, v6
    v_and_b32 v78, -4, v48
    v_and_b32 v51, -2, v51
    v_mad_u32_u24 v7, v50, s43, v7
    v_and_b32 v79, -4, v50
    v_mad_i32_i24 v20, v45, s42, v20
    v_lshl_add_u32 v45, v76, 5, v45
    v_mad_i32_i24 v21, v47, s42, v21
    v_lshl_add_u32 v47, v77, 5, v47
    v_mad_i32_i24 v22, v49, s42, v22
    v_lshl_add_u32 v49, v78, 5, v49
    v_mad_i32_i24 v23, v51, s42, v23
    v_lshl_add_u32 v51, v79, 5, v51
    v_add_u32 v45, v45, v45
    ds_add_rtn_u32 v76, v45, v104
    v_add_u32 v47, v47, v47
    ds_add_rtn_u32 v77, v47, v104
    v_add_u32 v49, v49, v49
    ds_add_rtn_u32 v78, v49, v104
    v_add_u32 v51, v51, v51
    ds_add_rtn_u32 v79, v51, v104
    v_lshlrev_b32 v110, 16, v36
    v_and_b32 v111, 0xffff0000, v36
    v_lshlrev_b32 v112, 16, v37
    v_and_b32 v113, 0xffff0000, v37
    v_mul_f32 v110, s44, v110
    v_mul_f32 v111, s44, v111
    v_mul_f32 v112, s44, v112
    v_mul_f32 v113, s44, v113
    v_fract_f32 v110, v110
    v_fract_f32 v111, v111
    v_fract_f32 v112, v112
    v_fract_f32 v113, v113
    v_cos_f32 v110, v110
    v_cos_f32 v111, v111
    v_cos_f32 v112, v112
    v_cos_f32 v113, v113
    v_lshl_or_b32 v44, v44, 14, v20
    v_perm_b32 v45, v45, v4, s46
    v_bfe_u32 v4, v4, 8, 5

    v_lshl_or_b32 v46, v46, 14, v21
    v_perm_b32 v47, v47, v5, s46
    v_bfe_u32 v5, v5, 8, 5

    v_lshl_or_b32 v48, v48, 14, v22
    v_perm_b32 v49, v49, v6, s46
    v_bfe_u32 v6, v6, 8, 5

    v_lshl_or_b32 v50, v50, 14, v23
    v_perm_b32 v51, v51, v7, s46
    v_bfe_u32 v7, v7, 8, 5

    v_fmaak_f32 v110, v110, v105, 0x4b400010
    v_fmaak_f32 v111, v111, v105, 0x4b400010
    v_fmaak_f32 v112, v112, v105, 0x4b400010
    v_fmaak_f32 v113, v113, v105, 0x4b400010
    v_sub_u32 v110, v110, v4
    v_sub_u32 v111, v111, v5
    v_sub_u32 v112, v112, v6
    v_sub_u32 v113, v113, v7
    v_bfi_b32 v110, 31, v4, v110
    v_bfi_b32 v111, 31, v5, v111
    v_bfi_b32 v112, 31, v6, v112
    v_bfi_b32 v113, 31, v7, v113
    v_perm_b32 v44, v44, v110, s55
    v_perm_b32 v46, v46, v111, s55
    v_perm_b32 v48, v48, v112, s55
    v_perm_b32 v50, v50, v113, s55
L_ska_23:
    s_bitcmp0_b32 s82, 1
    s_cbranch_scc1 L_ska_24
    s_waitcnt vmcnt(7)
    v_mul_hi_u32_u24 v53, s40, v24
    v_mul_hi_u32_u24 v52, s40, v8
    v_mul_hi_u32_u24 v55, s40, v25
    v_mul_hi_u32_u24 v54, s40, v9
    v_mul_hi_u32_u24 v57, s40, v26
    v_mul_hi_u32_u24 v56, s40, v10
    v_mul_hi_u32_u24 v59, s40, v27
    v_mul_hi_u32_u24 v58, s40, v11
    v_and_b32 v53, -2, v53
    v_mad_u32_u24 v8, v52, s43, v8
    v_and_b32 v80, -4, v52
    v_and_b32 v55, -2, v55
    v_mad_u32_u24 v9, v54, s43, v9
    v_and_b32 v81, -4, v54
    v_and_b32 v57, -2, v57
    v_mad_u32_u24 v10, v56, s43, v10
    v_and_b32 v82, -4, v56
    v_and_b32 v59, -2, v59
    v_mad_u32_u24 v11, v58, s43, v11
    v_and_b32 v83, -4, v58
    v_mad_i32_i24 v24, v53, s42, v24
    v_lshl_add_u32 v53, v80, 5, v53
    v_mad_i32_i24 v25, v55, s42, v25
    v_lshl_add_u32 v55, v81, 5, v55
    v_mad_i32_i24 v26, v57, s42, v26
    v_lshl_add_u32 v57, v82, 5, v57
    v_mad_i32_i24 v27, v59, s42, v27
    v_lshl_add_u32 v59, v83, 5, v59
    v_add_u32 v53, v53, v53
    ds_add_rtn_u32 v80, v53, v104
    v_add_u32 v55, v55, v55
    ds_add_rtn_u32 v81, v55, v104
    v_add_u32 v57, v57, v57
    ds_add_rtn_u32 v82, v57, v104
    v_add_u32 v59, v59, v59
    ds_add_rtn_u32 v83, v59, v104
    v_lshlrev_b32 v110, 16, v38
    v_and_b32 v111, 0xffff0000, v38
    v_lshlrev_b32 v112, 16, v39
    v_and_b32 v113, 0xffff0000, v39
    v_mul_f32 v110, s44, v110
    v_mul_f32 v111, s44, v111
    v_mul_f32 v112, s44, v112
    v_mul_f32 v113, s44, v113
    v_fract_f32 v110, v110
    v_fract_f32 v111, v111
    v_fract_f32 v112, v112
    v_fract_f32 v113, v113
    v_cos_f32 v110, v110
    v_cos_f32 v111, v111
    v_cos_f32 v112, v112
    v_cos_f32 v113, v113
    v_lshl_or_b32 v52, v52, 14, v24
    v_perm_b32 v53, v53, v8, s46
    v_bfe_u32 v8, v8, 8, 5

    v_lshl_or_b32 v54, v54, 14, v25
    v_perm_b32 v55, v55, v9, s46
    v_bfe_u32 v9, v9, 8, 5

    v_lshl_or_b32 v56, v56, 14, v26
    v_perm_b32 v57, v57, v10, s46
    v_bfe_u32 v10, v10, 8, 5

    v_lshl_or_b32 v58, v58, 14, v27
    v_perm_b32 v59, v59, v11, s46
    v_bfe_u32 v11, v11, 8, 5

    v_fmaak_f32 v110, v110, v105, 0x4b400010
    v_fmaak_f32 v111, v111, v105, 0x4b400010
    v_fmaak_f32 v112, v112, v105, 0x4b400010
    v_fmaak_f32 v113, v113, v105, 0x4b400010
    v_sub_u32 v110, v110, v8
    v_sub_u32 v111, v111, v9
    v_sub_u32 v112, v112, v10
    v_sub_u32 v113, v113, v11
    v_bfi_b32 v110, 31, v8, v110
    v_bfi_b32 v111, 31, v9, v111
    v_bfi_b32 v112, 31, v10, v112
    v_bfi_b32 v113, 31, v11, v113
    v_perm_b32 v52, v52, v110, s55
    v_perm_b32 v54, v54, v111, s55
    v_perm_b32 v56, v56, v112, s55
    v_perm_b32 v58, v58, v113, s55
L_ska_24:
    s_waitcnt vmcnt(1)
    s_waitcnt vmcnt(0)
    v_cmp_eq_u32 vcc, 0, v0
    s_mov_b64 exec, vcc
    ds_write_b32 v108, v99 offset:8
    s_mov_b64 exec, -1
    s_waitcnt vmcnt(1)
    v_lshrrev_b32 v93, 16, v92
    v_and_b32 v92, 0xffff, v92
    v_add_u32 v110, v92, v94
    v_add_u32 v92, v92, v96
    v_add_u32 v111, v93, v95
    v_add_u32 v93, v93, v97
    v_max_u32 v110, v110, v111
    v_lshl_add_u32 v92, v92, 2, v92
    v_lshl_add_u32 v93, v93, 2, v93
    v_cmp_le_u32 vcc, s48, v110
    s_cbranch_vccnz L_full_25
L_fback_26:
    ds_write_b64 v2, v[92:93] offset:8192

    s_waitcnt lgkmcnt(0)
    s_barrier
    ds_read_b32 v111, v108 offset:8
    s_waitcnt lgkmcnt(0)
    v_readfirstlane_b32 s41, v111
    s_nop 1

    s_add_u32 s41, s41, 416
    s_sub_u32 s78, s41, 2997
    s_lshr_b32 s79, s78, 1
    s_add_u32 s79, s79, 2997
    s_and_b32 s86, s78, 1
    s_lshl_b32 s86, s86, 1
    s_add_u32 s87, s86, 2
    s_cmp_lt_u32 s41, 2997
    s_cselect_b32 s41, s41, s79
    s_cmovk_i32 s86, 0
    s_cmovk_i32 s87, 4

    s_mul_i32 s78, s41, 16384
    s_add_u32 s49, s78, 16384
    s_cmp_ge_u32 s41, 3125
    s_cmovk_i32 s49, 0
    s_cmovk_i32 s78, 0
    s_lshl_b32 s10, s49, 2
    s_lshl_b32 s14, s49, 2
    s_lshl_b32 s18, s49, 1
    s_sub_u32 s79, s87, s86
    s_bfm_b32 s85, s79, s86
    s_lshl_b32 s86, s86, 12
    s_lshl_b32 s87, s87, 12
    s_min_u32 s87, s87, 16384

    s_add_u32 s79, s78, 0
    s_bitcmp1_b32 s85, 0
    s_cselect_b32 s79, s79, 0x1ff00000
    s_lshl_b32 s56, s79, 2
    s_lshl_b32 s61, s79, 1

    s_add_u32 s79, s78, 4096
    s_bitcmp1_b32 s85, 1
    s_cselect_b32 s79, s79, 0x1ff00000
    s_lshl_b32 s57, s79, 2
    s_lshl_b32 s62, s79, 1

    s_add_u32 s79, s78, 8192
    s_bitcmp1_b32 s85, 2
    s_cselect_b32 s79, s79, 0x1ff00000
    s_lshl_b32 s58, s79, 2
    s_lshl_b32 s63, s79, 1

    s_add_u32 s79, s78, 12288
    s_bitcmp1_b32 s85, 3
    s_cselect_b32 s79, s79, 0x1ff00000
    s_lshl_b32 s59, s79, 2
    s_lshl_b32 s64, s79, 1

    s_bitcmp0_b32 s28, 0
    s_cbranch_scc1 L_skw_27
    ds_read_b64 v[110:111], v2 offset:16400
    ds_read_b64 v[112:113], v2 offset:16408
    ds_read_b64 v[114:115], v2 offset:16392

    ds_read_b64 v[118:119], v2 offset:24592
    ds_read_b64 v[120:121], v2 offset:24600
    ds_read_b64 v[122:123], v2 offset:24584

    s_waitcnt lgkmcnt(3)
    v_lshrrev_b32 v116, 16, v111
    ds_read_b32 v116, v116 offset:8192

    s_waitcnt lgkmcnt(1)
    v_lshrrev_b32 v124, 16, v119
    ds_read_b32 v124, v124 offset:8192

    v_cmp_ne_u32_sdwa s[80:81], v111, v113 src0_sel:WORD_1 src1_sel:WORD_1
    v_cmp_ne_u32_sdwa vcc, v111, v115 src0_sel:WORD_1 src1_sel:WORD_1
    v_alignbyte_b32 v114, v115, v114, 2
    s_mov_b32 s54, -3
    v_alignbyte_b32 v111, v111, v110, 1
    v_perm_b32 v110, v110, v114, s47
    s_waitcnt lgkmcnt(1)
    v_add3_u32 v116, v116, v106, s54
    v_sub_u32 v117, 0, v116
    v_and_b32 v117, 3, v117
    s_mov_b64 exec, s[80:81]
    v_mov_b32 v117, 0
    v_mov_b32 v112, 0
    s_mov_b64 exec, vcc
    v_mov_b32 v117, 3

    s_mov_b64 exec, -1
    v_alignbyte_b32 v110, v111, v110, v117
    v_alignbyte_b32 v111, v112, v111, v117
    v_add_u32 v116, v116, v117

    buffer_store_dwordx2 v[110:111], v116, s[24:27], 0 offen
    v_cmp_ne_u32_sdwa s[80:81], v119, v121 src0_sel:WORD_1 src1_sel:WORD_1
    v_cmp_ne_u32_sdwa vcc, v119, v123 src0_sel:WORD_1 src1_sel:WORD_1
    v_alignbyte_b32 v122, v123, v122, 2
    s_mov_b32 s54, 5117
    v_alignbyte_b32 v119, v119, v118, 1
    v_perm_b32 v118, v118, v122, s47
    s_waitcnt lgkmcnt(0)
    v_add3_u32 v124, v124, v106, s54
    v_sub_u32 v125, 0, v124
    v_and_b32 v125, 3, v125
    s_mov_b64 exec, s[80:81]
    v_mov_b32 v125, 0
    v_mov_b32 v120, 0
    s_mov_b64 exec, vcc
    v_mov_b32 v125, 3

    s_mov_b64 exec, -1
    v_alignbyte_b32 v118, v119, v118, v125
    v_alignbyte_b32 v119, v120, v119, v125
    v_add_u32 v124, v124, v125

    buffer_store_dwordx2 v[118:119], v124, s[24:27], 0 offen
L_skw_27:
    s_bitcmp0_b32 s28, 0
    s_cbranch_scc1 L_skw_28
    ds_read_b64 v[110:111], v2 offset:32784
    ds_read_b64 v[112:113], v2 offset:32792
    ds_read_b64 v[114:115], v2 offset:32776

    ds_read_b64 v[118:119], v2 offset:40976
    ds_read_b64 v[120:121], v2 offset:40984
    ds_read_b64 v[122:123], v2 offset:40968

    s_waitcnt lgkmcnt(3)
    v_lshrrev_b32 v116, 16, v111
    ds_read_b32 v116, v116 offset:8192

    s_waitcnt lgkmcnt(1)
    v_lshrrev_b32 v124, 16, v119
    ds_read_b32 v124, v124 offset:8192

    v_cmp_ne_u32_sdwa s[80:81], v111, v113 src0_sel:WORD_1 src1_sel:WORD_1
    v_cmp_ne_u32_sdwa vcc, v111, v115 src0_sel:WORD_1 src1_sel:WORD_1
    v_alignbyte_b32 v114, v115, v114, 2
    s_mov_b32 s54, 10237
    v_alignbyte_b32 v111, v111, v110, 1
    v_perm_b32 v110, v110, v114, s47
    s_waitcnt lgkmcnt(1)
    v_add3_u32 v116, v116, v106, s54
    v_sub_u32 v117, 0, v116
    v_and_b32 v117, 3, v117
    s_mov_b64 exec, s[80:81]
    v_mov_b32 v117, 0
    v_mov_b32 v112, 0
    s_mov_b64 exec, vcc
    v_mov_b32 v117, 3

    s_mov_b64 exec, -1
    v_alignbyte_b32 v110, v111, v110, v117
    v_alignbyte_b32 v111, v112, v111, v117
    v_add_u32 v116, v116, v117

    buffer_store_dwordx2 v[110:111], v116, s[24:27], 0 offen
    v_cmp_ne_u32_sdwa s[80:81], v119, v121 src0_sel:WORD_1 src1_sel:WORD_1
    v_cmp_ne_u32_sdwa vcc, v119, v123 src0_sel:WORD_1 src1_sel:WORD_1
    v_alignbyte_b32 v122, v123, v122, 2
    s_mov_b32 s54, 15357
    v_alignbyte_b32 v119, v119, v118, 1
    v_perm_b32 v118, v118, v122, s47
    s_waitcnt lgkmcnt(0)
    v_add3_u32 v124, v124, v106, s54
    v_sub_u32 v125, 0, v124
    v_and_b32 v125, 3, v125
    s_mov_b64 exec, s[80:81]
    v_mov_b32 v125, 0
    v_mov_b32 v120, 0
    s_mov_b64 exec, vcc
    v_mov_b32 v125, 3

    s_mov_b64 exec, -1
    v_alignbyte_b32 v118, v119, v118, v125
    v_alignbyte_b32 v119, v120, v119, v125
    v_add_u32 v124, v124, v125

    buffer_store_dwordx2 v[118:119], v124, s[24:27], 0 offen
L_skw_28:
    s_bitcmp0_b32 s82, 2
    s_cbranch_scc1 L_ska_29
    v_mul_hi_u32_u24 v61, s40, v28
    v_mul_hi_u32_u24 v60, s40, v12
    v_mul_hi_u32_u24 v63, s40, v29
    v_mul_hi_u32_u24 v62, s40, v13
    v_mul_hi_u32_u24 v65, s40, v30
    v_mul_hi_u32_u24 v64, s40, v14
    v_mul_hi_u32_u24 v67, s40, v31
    v_mul_hi_u32_u24 v66, s40, v15
    v_and_b32 v61, -2, v61
    v_mad_u32_u24 v12, v60, s43, v12
    v_and_b32 v84, -4, v60
    v_and_b32 v63, -2, v63
    v_mad_u32_u24 v13, v62, s43, v13
    v_and_b32 v85, -4, v62
    v_and_b32 v65, -2, v65
    v_mad_u32_u24 v14, v64, s43, v14
    v_and_b32 v86, -4, v64
    v_and_b32 v67, -2, v67
    v_mad_u32_u24 v15, v66, s43, v15
    v_and_b32 v87, -4, v66
    v_mad_i32_i24 v28, v61, s42, v28
    v_lshl_add_u32 v61, v84, 5, v61
    v_mad_i32_i24 v29, v63, s42, v29
    v_lshl_add_u32 v63, v85, 5, v63
    v_mad_i32_i24 v30, v65, s42, v30
    v_lshl_add_u32 v65, v86, 5, v65
    v_mad_i32_i24 v31, v67, s42, v31
    v_lshl_add_u32 v67, v87, 5, v67
    v_add_u32 v61, v61, v61
    ds_add_rtn_u32 v84, v61, v104
    v_add_u32 v63, v63, v63
    ds_add_rtn_u32 v85, v63, v104
    v_add_u32 v65, v65, v65
    ds_add_rtn_u32 v86, v65, v104
    v_add_u32 v67, v67, v67
    ds_add_rtn_u32 v87, v67, v104
    v_lshlrev_b32 v110, 16, v40
    v_and_b32 v111, 0xffff0000, v40
    v_lshlrev_b32 v112, 16, v41
    v_and_b32 v113, 0xffff0000, v41
    v_mul_f32 v110, s44, v110
    v_mul_f32 v111, s44, v111
    v_mul_f32 v112, s44, v112
    v_mul_f32 v113, s44, v113
    v_fract_f32 v110, v110
    v_fract_f32 v111, v111
    v_fract_f32 v112, v112
    v_fract_f32 v113, v113
    v_cos_f32 v110, v110
    v_cos_f32 v111, v111
    v_cos_f32 v112, v112
    v_cos_f32 v113, v113
    v_lshl_or_b32 v60, v60, 14, v28
    v_perm_b32 v61, v61, v12, s46
    v_bfe_u32 v12, v12, 8, 5

    v_lshl_or_b32 v62, v62, 14, v29
    v_perm_b32 v63, v63, v13, s46
    v_bfe_u32 v13, v13, 8, 5

    v_lshl_or_b32 v64, v64, 14, v30
    v_perm_b32 v65, v65, v14, s46
    v_bfe_u32 v14, v14, 8, 5

    v_lshl_or_b32 v66, v66, 14, v31
    v_perm_b32 v67, v67, v15, s46
    v_bfe_u32 v15, v15, 8, 5

    v_fmaak_f32 v110, v110, v105, 0x4b400010
    v_fmaak_f32 v111, v111, v105, 0x4b400010
    v_fmaak_f32 v112, v112, v105, 0x4b400010
    v_fmaak_f32 v113, v113, v105, 0x4b400010
    v_sub_u32 v110, v110, v12
    v_sub_u32 v111, v111, v13
    v_sub_u32 v112, v112, v14
    v_sub_u32 v113, v113, v15
    v_bfi_b32 v110, 31, v12, v110
    v_bfi_b32 v111, 31, v13, v111
    v_bfi_b32 v112, 31, v14, v112
    v_bfi_b32 v113, 31, v15, v113
    v_perm_b32 v60, v60, v110, s55
    v_perm_b32 v62, v62, v111, s55
    v_perm_b32 v64, v64, v112, s55
    v_perm_b32 v66, v66, v113, s55
L_ska_29:
    s_bitcmp0_b32 s28, 1
    s_cbranch_scc1 L_skw_30
    v_add_u32 v107, 32768, v2
    ds_read_b64 v[110:111], v107 offset:16400
    ds_read_b64 v[112:113], v107 offset:16408
    ds_read_b64 v[114:115], v107 offset:16392

    ds_read_b64 v[118:119], v107 offset:24592
    ds_read_b64 v[120:121], v107 offset:24600
    ds_read_b64 v[122:123], v107 offset:24584

    s_waitcnt lgkmcnt(3)
    v_lshrrev_b32 v116, 16, v111
    ds_read_b32 v116, v116 offset:8192

    s_waitcnt lgkmcnt(1)
    v_lshrrev_b32 v124, 16, v119
    ds_read_b32 v124, v124 offset:8192

    v_cmp_ne_u32_sdwa s[80:81], v111, v113 src0_sel:WORD_1 src1_sel:WORD_1
    v_cmp_ne_u32_sdwa vcc, v111, v115 src0_sel:WORD_1 src1_sel:WORD_1
    v_alignbyte_b32 v114, v115, v114, 2
    s_mov_b32 s54, 20477
    v_alignbyte_b32 v111, v111, v110, 1
    v_perm_b32 v110, v110, v114, s47
    s_waitcnt lgkmcnt(1)
    v_add3_u32 v116, v116, v106, s54
    v_sub_u32 v117, 0, v116
    v_and_b32 v117, 3, v117
    s_mov_b64 exec, s[80:81]
    v_mov_b32 v117, 0
    v_mov_b32 v112, 0
    s_mov_b64 exec, vcc
    v_mov_b32 v117, 3

    s_mov_b64 exec, -1
    v_alignbyte_b32 v110, v111, v110, v117
    v_alignbyte_b32 v111, v112, v111, v117
    v_add_u32 v116, v116, v117

    buffer_store_dwordx2 v[110:111], v116, s[24:27], 0 offen
    v_cmp_ne_u32_sdwa s[80:81], v119, v121 src0_sel:WORD_1 src1_sel:WORD_1
    v_cmp_ne_u32_sdwa vcc, v119, v123 src0_sel:WORD_1 src1_sel:WORD_1
    v_alignbyte_b32 v122, v123, v122, 2
    s_mov_b32 s54, 25597
    v_alignbyte_b32 v119, v119, v118, 1
    v_perm_b32 v118, v118, v122, s47
    s_waitcnt lgkmcnt(0)
    v_add3_u32 v124, v124, v106, s54
    v_sub_u32 v125, 0, v124
    v_and_b32 v125, 3, v125
    s_mov_b64 exec, s[80:81]
    v_mov_b32 v125, 0
    v_mov_b32 v120, 0
    s_mov_b64 exec, vcc
    v_mov_b32 v125, 3

    s_mov_b64 exec, -1
    v_alignbyte_b32 v118, v119, v118, v125
    v_alignbyte_b32 v119, v120, v119, v125
    v_add_u32 v124, v124, v125

    buffer_store_dwordx2 v[118:119], v124, s[24:27], 0 offen
L_skw_30:
    s_bitcmp0_b32 s28, 1
    s_cbranch_scc1 L_skw_31
    v_add_u32 v107, 32768, v2
    ds_read_b64 v[110:111], v107 offset:32784
    ds_read_b64 v[112:113], v107 offset:32792
    ds_read_b64 v[114:115], v107 offset:32776

    ds_read_b64 v[118:119], v107 offset:40976
    ds_read_b64 v[120:121], v107 offset:40984
    ds_read_b64 v[122:123], v107 offset:40968

    s_waitcnt lgkmcnt(3)
    v_lshrrev_b32 v116, 16, v111
    ds_read_b32 v116, v116 offset:8192

    s_waitcnt lgkmcnt(1)
    v_lshrrev_b32 v124, 16, v119
    ds_read_b32 v124, v124 offset:8192

    v_cmp_ne_u32_sdwa s[80:81], v111, v113 src0_sel:WORD_1 src1_sel:WORD_1
    v_cmp_ne_u32_sdwa vcc, v111, v115 src0_sel:WORD_1 src1_sel:WORD_1
    v_alignbyte_b32 v114, v115, v114, 2
    s_mov_b32 s54, 30717
    v_alignbyte_b32 v111, v111, v110, 1
    v_perm_b32 v110, v110, v114, s47
    s_waitcnt lgkmcnt(1)
    v_add3_u32 v116, v116, v106, s54
    v_sub_u32 v117, 0, v116
    v_and_b32 v117, 3, v117
    s_mov_b64 exec, s[80:81]
    v_mov_b32 v117, 0
    v_mov_b32 v112, 0
    s_mov_b64 exec, vcc
    v_mov_b32 v117, 3

    s_mov_b64 exec, -1
    v_alignbyte_b32 v110, v111, v110, v117
    v_alignbyte_b32 v111, v112, v111, v117
    v_add_u32 v116, v116, v117

    buffer_store_dwordx2 v[110:111], v116, s[24:27], 0 offen
    v_cmp_ne_u32_sdwa s[80:81], v119, v121 src0_sel:WORD_1 src1_sel:WORD_1
    v_cmp_ne_u32_sdwa vcc, v119, v123 src0_sel:WORD_1 src1_sel:WORD_1
    v_alignbyte_b32 v122, v123, v122, 2
    s_mov_b32 s54, 35837
    v_alignbyte_b32 v119, v119, v118, 1
    v_perm_b32 v118, v118, v122, s47
    s_waitcnt lgkmcnt(0)
    v_add3_u32 v124, v124, v106, s54
    v_sub_u32 v125, 0, v124
    v_and_b32 v125, 3, v125
    s_mov_b64 exec, s[80:81]
    v_mov_b32 v125, 0
    v_mov_b32 v120, 0
    s_mov_b64 exec, vcc
    v_mov_b32 v125, 3

    s_mov_b64 exec, -1
    v_alignbyte_b32 v118, v119, v118, v125
    v_alignbyte_b32 v119, v120, v119, v125
    v_add_u32 v124, v124, v125

    buffer_store_dwordx2 v[118:119], v124, s[24:27], 0 offen
L_skw_31:
    s_bitcmp0_b32 s28, 2
    s_cbranch_scc1 L_skw_32
    v_add_u32 v107, 65536, v2
    ds_read_b64 v[110:111], v107 offset:16400
    ds_read_b64 v[112:113], v107 offset:16408
    ds_read_b64 v[114:115], v107 offset:16392

    ds_read_b64 v[118:119], v107 offset:24592
    ds_read_b64 v[120:121], v107 offset:24600
    ds_read_b64 v[122:123], v107 offset:24584

    s_waitcnt lgkmcnt(3)
    v_lshrrev_b32 v116, 16, v111
    ds_read_b32 v116, v116 offset:8192

    s_waitcnt lgkmcnt(1)
    v_lshrrev_b32 v124, 16, v119
    ds_read_b32 v124, v124 offset:8192

    v_cmp_ne_u32_sdwa s[80:81], v111, v113 src0_sel:WORD_1 src1_sel:WORD_1
    v_cmp_ne_u32_sdwa vcc, v111, v115 src0_sel:WORD_1 src1_sel:WORD_1
    v_alignbyte_b32 v114, v115, v114, 2
    s_mov_b32 s54, 40957
    v_alignbyte_b32 v111, v111, v110, 1
    v_perm_b32 v110, v110, v114, s47
    s_waitcnt lgkmcnt(1)
    v_add3_u32 v116, v116, v106, s54
    v_sub_u32 v117, 0, v116
    v_and_b32 v117, 3, v117
    s_mov_b64 exec, s[80:81]
    v_mov_b32 v117, 0
    v_mov_b32 v112, 0
    s_mov_b64 exec, vcc
    v_mov_b32 v117, 3

    s_mov_b64 exec, -1
    v_alignbyte_b32 v110, v111, v110, v117
    v_alignbyte_b32 v111, v112, v111, v117
    v_add_u32 v116, v116, v117

    buffer_store_dwordx2 v[110:111], v116, s[24:27], 0 offen
    v_cmp_ne_u32_sdwa s[80:81], v119, v121 src0_sel:WORD_1 src1_sel:WORD_1
    v_cmp_ne_u32_sdwa vcc, v119, v123 src0_sel:WORD_1 src1_sel:WORD_1
    v_alignbyte_b32 v122, v123, v122, 2
    s_mov_b32 s54, 46077
    v_alignbyte_b32 v119, v119, v118, 1
    v_perm_b32 v118, v118, v122, s47
    s_waitcnt lgkmcnt(0)
    v_add3_u32 v124, v124, v106, s54
    v_sub_u32 v125, 0, v124
    v_and_b32 v125, 3, v125
    s_mov_b64 exec, s[80:81]
    v_mov_b32 v125, 0
    v_mov_b32 v120, 0
    s_mov_b64 exec, vcc
    v_mov_b32 v125, 3

    s_mov_b64 exec, -1
    v_alignbyte_b32 v118, v119, v118, v125
    v_alignbyte_b32 v119, v120, v119, v125
    v_add_u32 v124, v124, v125

    buffer_store_dwordx2 v[118:119], v124, s[24:27], 0 offen
L_skw_32:
    s_bitcmp0_b32 s82, 3
    s_cbranch_scc1 L_ska_33
    s_mov_b64 exec, s[66:67]
    v_mul_hi_u32_u24 v69, s40, v32
    v_mul_hi_u32_u24 v68, s40, v16
    v_mul_hi_u32_u24 v71, s40, v33
    v_mul_hi_u32_u24 v70, s40, v17
    v_mul_hi_u32_u24 v73, s40, v34
    v_mul_hi_u32_u24 v72, s40, v18
    v_mul_hi_u32_u24 v75, s40, v35
    v_mul_hi_u32_u24 v74, s40, v19
    v_and_b32 v69, -2, v69
    v_mad_u32_u24 v16, v68, s43, v16
    v_and_b32 v88, -4, v68
    v_and_b32 v71, -2, v71
    v_mad_u32_u24 v17, v70, s43, v17
    v_and_b32 v89, -4, v70
    v_and_b32 v73, -2, v73
    v_mad_u32_u24 v18, v72, s43, v18
    v_and_b32 v90, -4, v72
    v_and_b32 v75, -2, v75
    v_mad_u32_u24 v19, v74, s43, v19
    v_and_b32 v91, -4, v74
    v_mad_i32_i24 v32, v69, s42, v32
    v_lshl_add_u32 v69, v88, 5, v69
    v_mad_i32_i24 v33, v71, s42, v33
    v_lshl_add_u32 v71, v89, 5, v71
    v_mad_i32_i24 v34, v73, s42, v34
    v_lshl_add_u32 v73, v90, 5, v73
    v_mad_i32_i24 v35, v75, s42, v35
    v_lshl_add_u32 v75, v91, 5, v75
    v_add_u32 v69, v69, v69
    ds_add_rtn_u32 v88, v69, v104
    v_add_u32 v71, v71, v71
    ds_add_rtn_u32 v89, v71, v104
    v_add_u32 v73, v73, v73
    ds_add_rtn_u32 v90, v73, v104
    v_add_u32 v75, v75, v75
    ds_add_rtn_u32 v91, v75, v104
    v_lshlrev_b32 v110, 16, v42
    v_and_b32 v111, 0xffff0000, v42
    v_lshlrev_b32 v112, 16, v43
    v_and_b32 v113, 0xffff0000, v43
    v_mul_f32 v110, s44, v110
    v_mul_f32 v111, s44, v111
    v_mul_f32 v112, s44, v112
    v_mul_f32 v113, s44, v113
    v_fract_f32 v110, v110
    v_fract_f32 v111, v111
    v_fract_f32 v112, v112
    v_fract_f32 v113, v113
    v_cos_f32 v110, v110
    v_cos_f32 v111, v111
    v_cos_f32 v112, v112
    v_cos_f32 v113, v113
    v_lshl_or_b32 v68, v68, 14, v32
    v_perm_b32 v69, v69, v16, s46
    v_bfe_u32 v16, v16, 8, 5

    v_lshl_or_b32 v70, v70, 14, v33
    v_perm_b32 v71, v71, v17, s46
    v_bfe_u32 v17, v17, 8, 5

    v_lshl_or_b32 v72, v72, 14, v34
    v_perm_b32 v73, v73, v18, s46
    v_bfe_u32 v18, v18, 8, 5

    v_lshl_or_b32 v74, v74, 14, v35
    v_perm_b32 v75, v75, v19, s46
    v_bfe_u32 v19, v19, 8, 5

    v_fmaak_f32 v110, v110, v105, 0x4b400010
    v_fmaak_f32 v111, v111, v105, 0x4b400010
    v_fmaak_f32 v112, v112, v105, 0x4b400010
    v_fmaak_f32 v113, v113, v105, 0x4b400010
    v_sub_u32 v110, v110, v16
    v_sub_u32 v111, v111, v17
    v_sub_u32 v112, v112, v18
    v_sub_u32 v113, v113, v19
    v_bfi_b32 v110, 31, v16, v110
    v_bfi_b32 v111, 31, v17, v111
    v_bfi_b32 v112, 31, v18, v112
    v_bfi_b32 v113, 31, v19, v113
    v_perm_b32 v68, v68, v110, s55
    v_perm_b32 v70, v70, v111, s55
    v_perm_b32 v72, v72, v112, s55
    v_perm_b32 v74, v74, v113, s55
    s_mov_b64 exec, -1
L_ska_33:
    s_bitcmp0_b32 s28, 2
    s_cbranch_scc1 L_skw_34
    v_add_u32 v107, 65536, v2
    ds_read_b64 v[110:111], v107 offset:32784
    ds_read_b64 v[112:113], v107 offset:32792
    ds_read_b64 v[114:115], v107 offset:32776

    ds_read_b64 v[118:119], v107 offset:40976
    ds_read_b64 v[120:121], v107 offset:40984
    ds_read_b64 v[122:123], v107 offset:40968

    s_waitcnt lgkmcnt(3)
    v_lshrrev_b32 v116, 16, v111
    ds_read_b32 v116, v116 offset:8192

    s_waitcnt lgkmcnt(1)
    v_lshrrev_b32 v124, 16, v119
    ds_read_b32 v124, v124 offset:8192

    v_cmp_ne_u32_sdwa s[80:81], v111, v113 src0_sel:WORD_1 src1_sel:WORD_1
    v_cmp_ne_u32_sdwa vcc, v111, v115 src0_sel:WORD_1 src1_sel:WORD_1
    v_alignbyte_b32 v114, v115, v114, 2
    s_mov_b32 s54, 51197
    v_alignbyte_b32 v111, v111, v110, 1
    v_perm_b32 v110, v110, v114, s47
    s_waitcnt lgkmcnt(1)
    v_add3_u32 v116, v116, v106, s54
    v_sub_u32 v117, 0, v116
    v_and_b32 v117, 3, v117
    s_mov_b64 exec, s[80:81]
    v_mov_b32 v117, 0
    v_mov_b32 v112, 0
    s_mov_b64 exec, vcc
    v_mov_b32 v117, 3

    s_mov_b64 exec, -1
    v_alignbyte_b32 v110, v111, v110, v117
    v_alignbyte_b32 v111, v112, v111, v117
    v_add_u32 v116, v116, v117

    buffer_store_dwordx2 v[110:111], v116, s[24:27], 0 offen
    v_cmp_ne_u32_sdwa s[80:81], v119, v121 src0_sel:WORD_1 src1_sel:WORD_1
    v_cmp_ne_u32_sdwa vcc, v119, v123 src0_sel:WORD_1 src1_sel:WORD_1
    v_alignbyte_b32 v122, v123, v122, 2
    s_mov_b32 s54, 56317
    v_alignbyte_b32 v119, v119, v118, 1
    v_perm_b32 v118, v118, v122, s47
    s_waitcnt lgkmcnt(0)
    v_add3_u32 v124, v124, v106, s54
    v_sub_u32 v125, 0, v124
    v_and_b32 v125, 3, v125
    s_mov_b64 exec, s[80:81]
    v_mov_b32 v125, 0
    v_mov_b32 v120, 0
    s_mov_b64 exec, vcc
    v_mov_b32 v125, 3

    s_mov_b64 exec, -1
    v_alignbyte_b32 v118, v119, v118, v125
    v_alignbyte_b32 v119, v120, v119, v125
    v_add_u32 v124, v124, v125

    buffer_store_dwordx2 v[118:119], v124, s[24:27], 0 offen
L_skw_34:
    s_bitcmp0_b32 s28, 3
    s_cbranch_scc1 L_skw_35
    v_add_u32 v107, 98304, v2
    ds_read_b64 v[110:111], v107 offset:16400
    ds_read_b64 v[112:113], v107 offset:16408
    ds_read_b64 v[114:115], v107 offset:16392

    ds_read_b64 v[118:119], v107 offset:24592
    ds_read_b64 v[120:121], v107 offset:24600
    ds_read_b64 v[122:123], v107 offset:24584

    s_waitcnt lgkmcnt(3)
    v_lshrrev_b32 v116, 16, v111
    ds_read_b32 v116, v116 offset:8192

    s_waitcnt lgkmcnt(1)
    v_lshrrev_b32 v124, 16, v119
    ds_read_b32 v124, v124 offset:8192

    v_cmp_ne_u32_sdwa s[80:81], v111, v113 src0_sel:WORD_1 src1_sel:WORD_1
    v_cmp_ne_u32_sdwa vcc, v111, v115 src0_sel:WORD_1 src1_sel:WORD_1
    v_alignbyte_b32 v114, v115, v114, 2
    s_mov_b32 s54, 61437
    v_alignbyte_b32 v111, v111, v110, 1
    v_perm_b32 v110, v110, v114, s47
    s_waitcnt lgkmcnt(1)
    v_add3_u32 v116, v116, v106, s54
    v_sub_u32 v117, 0, v116
    v_and_b32 v117, 3, v117
    s_mov_b64 exec, s[80:81]
    v_mov_b32 v117, 0
    v_mov_b32 v112, 0
    s_mov_b64 exec, vcc
    v_mov_b32 v117, 3

    s_mov_b64 exec, -1
    v_alignbyte_b32 v110, v111, v110, v117
    v_alignbyte_b32 v111, v112, v111, v117
    v_add_u32 v116, v116, v117

    buffer_store_dwordx2 v[110:111], v116, s[24:27], 0 offen
    v_cmp_ne_u32_sdwa s[80:81], v119, v121 src0_sel:WORD_1 src1_sel:WORD_1
    v_cmp_ne_u32_sdwa vcc, v119, v123 src0_sel:WORD_1 src1_sel:WORD_1
    v_alignbyte_b32 v122, v123, v122, 2
    s_mov_b32 s54, 66557
    v_alignbyte_b32 v119, v119, v118, 1
    v_perm_b32 v118, v118, v122, s47
    s_waitcnt lgkmcnt(0)
    v_add3_u32 v124, v124, v106, s54
    v_sub_u32 v125, 0, v124
    v_and_b32 v125, 3, v125
    s_mov_b64 exec, s[80:81]
    v_mov_b32 v125, 0
    v_mov_b32 v120, 0
    s_mov_b64 exec, vcc
    v_mov_b32 v125, 3

    s_mov_b64 exec, -1
    v_alignbyte_b32 v118, v119, v118, v125
    v_alignbyte_b32 v119, v120, v119, v125
    v_add_u32 v124, v124, v125

    buffer_store_dwordx2 v[118:119], v124, s[24:27], 0 offen
L_skw_35:
    s_bitcmp0_b32 s28, 3
    s_cbranch_scc1 L_skw_36
    v_add_u32 v107, 98304, v2
    ds_read_b64 v[110:111], v107 offset:32784
    ds_read_b64 v[112:113], v107 offset:32792
    ds_read_b64 v[114:115], v107 offset:32776

    ds_read_b64 v[118:119], v107 offset:40976
    ds_read_b64 v[120:121], v107 offset:40984
    ds_read_b64 v[122:123], v107 offset:40968

    s_waitcnt lgkmcnt(3)
    v_lshrrev_b32 v116, 16, v111
    ds_read_b32 v116, v116 offset:8192

    s_waitcnt lgkmcnt(1)
    v_lshrrev_b32 v124, 16, v119
    ds_read_b32 v124, v124 offset:8192

    v_cmp_ne_u32_sdwa s[80:81], v111, v113 src0_sel:WORD_1 src1_sel:WORD_1
    v_cmp_ne_u32_sdwa vcc, v111, v115 src0_sel:WORD_1 src1_sel:WORD_1
    v_alignbyte_b32 v114, v115, v114, 2
    s_mov_b32 s54, 71677
    v_alignbyte_b32 v111, v111, v110, 1
    v_perm_b32 v110, v110, v114, s47
    s_waitcnt lgkmcnt(1)
    v_add3_u32 v116, v116, v106, s54
    v_sub_u32 v117, 0, v116
    v_and_b32 v117, 3, v117
    s_mov_b64 exec, s[80:81]
    v_mov_b32 v117, 0
    v_mov_b32 v112, 0
    s_mov_b64 exec, vcc
    v_mov_b32 v117, 3

    s_mov_b64 exec, -1
    v_alignbyte_b32 v110, v111, v110, v117
    v_alignbyte_b32 v111, v112, v111, v117
    v_add_u32 v116, v116, v117

    buffer_store_dwordx2 v[110:111], v116, s[24:27], 0 offen
    v_cmp_ne_u32_sdwa s[80:81], v119, v121 src0_sel:WORD_1 src1_sel:WORD_1
    v_cmp_ne_u32_sdwa vcc, v119, v123 src0_sel:WORD_1 src1_sel:WORD_1
    v_alignbyte_b32 v122, v123, v122, 2
    s_mov_b32 s54, 76797
    v_alignbyte_b32 v119, v119, v118, 1
    v_perm_b32 v118, v118, v122, s47
    s_waitcnt lgkmcnt(0)
    v_add3_u32 v124, v124, v106, s54
    v_sub_u32 v125, 0, v124
    v_and_b32 v125, 3, v125
    s_mov_b64 exec, s[80:81]
    v_mov_b32 v125, 0
    v_mov_b32 v120, 0
    s_mov_b64 exec, vcc
    v_mov_b32 v125, 3

    s_andn2_b64 exec, -1, s[68:69]
    v_bfrev_b32 v124, 1
    s_mov_b64 exec, -1
    v_alignbyte_b32 v118, v119, v118, v125
    v_alignbyte_b32 v119, v120, v119, v125
    v_add_u32 v124, v124, v125

    buffer_store_dwordx2 v[118:119], v124, s[24:27], 0 offen
L_skw_36:
    s_waitcnt lgkmcnt(0)
    s_barrier

    buffer_load_dwordx4 v[20:23], v1, s[12:15], s56 offen nt
    buffer_load_dwordx4 v[4:7], v1, s[8:11], s56 offen nt
    buffer_load_dwordx2 v[36:37], v2, s[16:19], s61 offen nt
    ds_read_b64 v[94:95], v2
    s_waitcnt lgkmcnt(0)
    v_and_b32 v94, 0xffff, v94
    v_and_b32 v95, 0xffff, v95
    v_add_u32 v97, v94, v95
    s_nop 1
    v_add_u32_dpp v97, v97, v97 row_shr:1 row_mask:0xf bank_mask:0xf
    s_nop 1
    v_add_u32_dpp v97, v97, v97 row_shr:2 row_mask:0xf bank_mask:0xf
    s_nop 1
    v_add_u32_dpp v97, v97, v97 row_shr:4 row_mask:0xf bank_mask:0xf
    s_nop 1
    v_add_u32_dpp v97, v97, v97 row_shr:8 row_mask:0xf bank_mask:0xf
    s_nop 1
    v_add_u32_dpp v97, v97, v97 row_bcast:15 row_mask:0xa bank_mask:0xf
    s_nop 1
    v_add_u32_dpp v97, v97, v97 row_bcast:31 row_mask:0xc bank_mask:0xf
    s_mov_b32 exec_lo, 0
    s_brev_b32 exec_hi, 1
    ds_add_rtn_u32 v96, v108, v97
    s_mov_b64 exec, -1

    v_add_u32 v92, v94, v94
    v_add_u32 v93, v95, v95
    v_med3_u32 v92, v94, 2, v92
    v_med3_u32 v93, v95, 2, v93
    v_lshl_or_b32 v92, v93, 16, v92
    v_lshlrev_b32 v93, 2, v0
    buffer_atomic_add v92, v93, s[20:23], 0 offen sc0
    s_waitcnt lgkmcnt(0)
    v_readlane_b32 s77, v96, 63
    v_mul_u32_u24 v114, 16128, v0
    v_sub_u32 v97, v97, v95
    s_sub_u32 s50, s50, s83
    s_sub_u32 s77, s77, s50
    v_add_u32 v97, s77, v97
    v_sub_u32 v96, v97, v94
    v_lshlrev_b32 v111, 16, v97
    v_lshlrev_b32 v110, 16, v96
    ds_write_b64 v2, v[110:111]
    v_sub_u32 v96, v114, v96
    v_sub_u32 v97, v114, v97
    v_add_u32 v97, s48, v97
    s_add_u32 s50, s50, s84
    s_mov_b32 s28, s82
    s_mov_b32 s29, s83
    s_mov_b32 s30, s84
    s_lshl_b32 s74, s29, 3
    s_lshl_b32 s75, s30, 3
    v_mov_b32 v125, s74
    v_mov_b32 v126, s75
    v_mov_b32 v127, -1

    s_waitcnt lgkmcnt(0)
    s_barrier

    s_mov_b64 exec, 1
    ds_write_b32 v125, v127 offset:16396
    ds_write_b32 v126, v127 offset:16404
    s_mov_b64 exec, -1

    buffer_load_dwordx4 v[24:27], v1, s[12:15], s57 offen nt
    buffer_load_dwordx4 v[8:11], v1, s[8:11], s57 offen nt
    buffer_load_dwordx2 v[38:39], v2, s[16:19], s62 offen nt
    s_bitcmp0_b32 s28, 0
    s_cbranch_scc1 L_skz_37
    v_lshrrev_b32 v110, 16, v45
    ds_read_b32 v110, v110
    v_lshrrev_b32 v111, 16, v47
    ds_read_b32 v111, v111
    v_lshrrev_b32 v112, 16, v49
    ds_read_b32 v112, v112
    v_lshrrev_b32 v113, 16, v51
    ds_read_b32 v113, v113
    v_lshrrev_b32 v114, 16, v53
    ds_read_b32 v114, v114
    v_lshrrev_b32 v115, 16, v55
    ds_read_b32 v115, v115
    v_lshrrev_b32 v116, 16, v57
    ds_read_b32 v116, v116
    v_lshrrev_b32 v117, 16, v59
    ds_read_b32 v117, v117
    s_waitcnt lgkmcnt(7)
    v_add_u32_sdwa v110, v110, v76 dst_sel:DWORD dst_unused:UNUSED_PAD src0_sel:WORD_1 src1_sel:WORD_0
    v_lshlrev_b32 v110, 3, v110
    ds_write_b64 v110, v[44:45] offset:16400

    s_waitcnt lgkmcnt(7)
    v_add_u32_sdwa v111, v111, v77 dst_sel:DWORD dst_unused:UNUSED_PAD src0_sel:WORD_1 src1_sel:WORD_0
    v_lshlrev_b32 v111, 3, v111
    ds_write_b64 v111, v[46:47] offset:16400

    s_waitcnt lgkmcnt(7)
    v_add_u32_sdwa v112, v112, v78 dst_sel:DWORD dst_unused:UNUSED_PAD src0_sel:WORD_1 src1_sel:WORD_0
    v_lshlrev_b32 v112, 3, v112
    ds_write_b64 v112, v[48:49] offset:16400

    s_waitcnt lgkmcnt(7)
    v_add_u32_sdwa v113, v113, v79 dst_sel:DWORD dst_unused:UNUSED_PAD src0_sel:WORD_1 src1_sel:WORD_0
    v_lshlrev_b32 v113, 3, v113
    ds_write_b64 v113, v[50:51] offset:16400

    s_waitcnt lgkmcnt(7)
    v_add_u32_sdwa v114, v114, v80 dst_sel:DWORD dst_unused:UNUSED_PAD src0_sel:WORD_1 src1_sel:WORD_0
    v_lshlrev_b32 v114, 3, v114
    ds_write_b64 v114, v[52:53] offset:16400

    s_waitcnt lgkmcnt(7)
    v_add_u32_sdwa v115, v115, v81 dst_sel:DWORD dst_unused:UNUSED_PAD src0_sel:WORD_1 src1_sel:WORD_0
    v_lshlrev_b32 v115, 3, v115
    ds_write_b64 v115, v[54:55] offset:16400

    s_waitcnt lgkmcnt(7)
    v_add_u32_sdwa v116, v116, v82 dst_sel:DWORD dst_unused:UNUSED_PAD src0_sel:WORD_1 src1_sel:WORD_0
    v_lshlrev_b32 v116, 3, v116
    ds_write_b64 v116, v[56:57] offset:16400

    s_waitcnt lgkmcnt(7)
    v_add_u32_sdwa v117, v117, v83 dst_sel:DWORD dst_unused:UNUSED_PAD src0_sel:WORD_1 src1_sel:WORD_0
    v_lshlrev_b32 v117, 3, v117
    ds_write_b64 v117, v[58:59] offset:16400

L_skz_37:
    buffer_load_dwordx4 v[28:31], v1, s[12:15], s58 offen nt
    buffer_load_dwordx4 v[12:15], v1, s[8:11], s58 offen nt
    buffer_load_dwordx2 v[40:41], v2, s[16:19], s63 offen nt
    s_bitcmp0_b32 s28, 2
    s_cbranch_scc1 L_skz_38
    v_lshrrev_b32 v110, 16, v61
    ds_read_b32 v110, v110
    v_lshrrev_b32 v111, 16, v63
    ds_read_b32 v111, v111
    v_lshrrev_b32 v112, 16, v65
    ds_read_b32 v112, v112
    v_lshrrev_b32 v113, 16, v67
    ds_read_b32 v113, v113
    s_waitcnt lgkmcnt(3)
    v_add_u32_sdwa v110, v110, v84 dst_sel:DWORD dst_unused:UNUSED_PAD src0_sel:WORD_1 src1_sel:WORD_0
    v_lshlrev_b32 v110, 3, v110
    ds_write_b64 v110, v[60:61] offset:16400

    s_waitcnt lgkmcnt(3)
    v_add_u32_sdwa v111, v111, v85 dst_sel:DWORD dst_unused:UNUSED_PAD src0_sel:WORD_1 src1_sel:WORD_0
    v_lshlrev_b32 v111, 3, v111
    ds_write_b64 v111, v[62:63] offset:16400

    s_waitcnt lgkmcnt(3)
    v_add_u32_sdwa v112, v112, v86 dst_sel:DWORD dst_unused:UNUSED_PAD src0_sel:WORD_1 src1_sel:WORD_0
    v_lshlrev_b32 v112, 3, v112
    ds_write_b64 v112, v[64:65] offset:16400

    s_waitcnt lgkmcnt(3)
    v_add_u32_sdwa v113, v113, v87 dst_sel:DWORD dst_unused:UNUSED_PAD src0_sel:WORD_1 src1_sel:WORD_0
    v_lshlrev_b32 v113, 3, v113
    ds_write_b64 v113, v[66:67] offset:16400

L_skz_38:
    s_bitcmp0_b32 s28, 3
    s_cbranch_scc1 L_skz_39
    s_mov_b64 exec, s[66:67]
    v_lshrrev_b32 v110, 16, v69
    ds_read_b32 v110, v110
    v_lshrrev_b32 v111, 16, v71
    ds_read_b32 v111, v111
    v_lshrrev_b32 v112, 16, v73
    ds_read_b32 v112, v112
    v_lshrrev_b32 v113, 16, v75
    ds_read_b32 v113, v113
    s_waitcnt lgkmcnt(3)
    v_add_u32_sdwa v110, v110, v88 dst_sel:DWORD dst_unused:UNUSED_PAD src0_sel:WORD_1 src1_sel:WORD_0
    v_lshlrev_b32 v110, 3, v110
    ds_write_b64 v110, v[68:69] offset:16400

    s_waitcnt lgkmcnt(3)
    v_add_u32_sdwa v111, v111, v89 dst_sel:DWORD dst_unused:UNUSED_PAD src0_sel:WORD_1 src1_sel:WORD_0
    v_lshlrev_b32 v111, 3, v111
    ds_write_b64 v111, v[70:71] offset:16400

    s_waitcnt lgkmcnt(3)
    v_add_u32_sdwa v112, v112, v90 dst_sel:DWORD dst_unused:UNUSED_PAD src0_sel:WORD_1 src1_sel:WORD_0
    v_lshlrev_b32 v112, 3, v112
    ds_write_b64 v112, v[72:73] offset:16400

    s_waitcnt lgkmcnt(3)
    v_add_u32_sdwa v113, v113, v91 dst_sel:DWORD dst_unused:UNUSED_PAD src0_sel:WORD_1 src1_sel:WORD_0
    v_lshlrev_b32 v113, 3, v113
    ds_write_b64 v113, v[74:75] offset:16400

    s_mov_b64 exec, -1
L_skz_39:
    buffer_load_dwordx4 v[32:35], v1, s[12:15], s59 offen nt
    buffer_load_dwordx4 v[16:19], v1, s[8:11], s59 offen nt
    buffer_load_dwordx2 v[42:43], v2, s[16:19], s64 offen nt
    s_cmp_lg_u32 s49, 0
    s_cbranch_scc1 L_p1loop_5
L_p1epi_6:
    s_waitcnt vmcnt(0)
    s_waitcnt vmcnt(0)
    v_lshrrev_b32 v93, 16, v92
    v_and_b32 v92, 0xffff, v92
    v_add_u32 v110, v92, v94
    v_add_u32 v92, v92, v96
    v_add_u32 v111, v93, v95
    v_add_u32 v93, v93, v97
    v_max_u32 v110, v110, v111
    v_lshl_add_u32 v92, v92, 2, v92
    v_lshl_add_u32 v93, v93, 2, v93
    v_cmp_le_u32 vcc, s48, v110
    s_cbranch_vccnz L_full_40
L_fback_41:
    ds_write_b64 v2, v[92:93] offset:8192

    s_waitcnt lgkmcnt(0)
    s_barrier

    s_bitcmp0_b32 s28, 0
    s_cbranch_scc1 L_skw_42
    ds_read_b64 v[4:5], v2 offset:16400
    ds_read_b64 v[6:7], v2 offset:16408
    ds_read_b64 v[8:9], v2 offset:16392

    ds_read_b64 v[12:13], v2 offset:24592
    ds_read_b64 v[14:15], v2 offset:24600
    ds_read_b64 v[16:17], v2 offset:24584

    ds_read_b64 v[20:21], v2 offset:32784
    ds_read_b64 v[22:23], v2 offset:32792
    ds_read_b64 v[24:25], v2 offset:32776

    ds_read_b64 v[28:29], v2 offset:40976
    ds_read_b64 v[30:31], v2 offset:40984
    ds_read_b64 v[32:33], v2 offset:40968

    s_waitcnt lgkmcnt(9)
    v_lshrrev_b32 v10, 16, v5
    ds_read_b32 v10, v10 offset:8192

    s_waitcnt lgkmcnt(7)
    v_lshrrev_b32 v18, 16, v13
    ds_read_b32 v18, v18 offset:8192

    s_waitcnt lgkmcnt(5)
    v_lshrrev_b32 v26, 16, v21
    ds_read_b32 v26, v26 offset:8192

    s_waitcnt lgkmcnt(3)
    v_lshrrev_b32 v34, 16, v29
    ds_read_b32 v34, v34 offset:8192

    v_cmp_ne_u32_sdwa s[80:81], v5, v7 src0_sel:WORD_1 src1_sel:WORD_1
    v_cmp_ne_u32_sdwa vcc, v5, v9 src0_sel:WORD_1 src1_sel:WORD_1
    v_alignbyte_b32 v8, v9, v8, 2
    s_mov_b32 s54, -3
    v_alignbyte_b32 v5, v5, v4, 1
    v_perm_b32 v4, v4, v8, s47
    s_waitcnt lgkmcnt(3)
    v_add3_u32 v10, v10, v106, s54
    v_sub_u32 v11, 0, v10
    v_and_b32 v11, 3, v11
    s_mov_b64 exec, s[80:81]
    v_mov_b32 v11, 0
    v_mov_b32 v6, 0
    s_mov_b64 exec, vcc
    v_mov_b32 v11, 3

    s_mov_b64 exec, -1
    v_alignbyte_b32 v4, v5, v4, v11
    v_alignbyte_b32 v5, v6, v5, v11
    v_add_u32 v10, v10, v11

    buffer_store_dwordx2 v[4:5], v10, s[24:27], 0 offen
    v_cmp_ne_u32_sdwa s[80:81], v13, v15 src0_sel:WORD_1 src1_sel:WORD_1
    v_cmp_ne_u32_sdwa vcc, v13, v17 src0_sel:WORD_1 src1_sel:WORD_1
    v_alignbyte_b32 v16, v17, v16, 2
    s_mov_b32 s54, 5117
    v_alignbyte_b32 v13, v13, v12, 1
    v_perm_b32 v12, v12, v16, s47
    s_waitcnt lgkmcnt(2)
    v_add3_u32 v18, v18, v106, s54
    v_sub_u32 v19, 0, v18
    v_and_b32 v19, 3, v19
    s_mov_b64 exec, s[80:81]
    v_mov_b32 v19, 0
    v_mov_b32 v14, 0
    s_mov_b64 exec, vcc
    v_mov_b32 v19, 3

    s_mov_b64 exec, -1
    v_alignbyte_b32 v12, v13, v12, v19
    v_alignbyte_b32 v13, v14, v13, v19
    v_add_u32 v18, v18, v19

    buffer_store_dwordx2 v[12:13], v18, s[24:27], 0 offen
    v_cmp_ne_u32_sdwa s[80:81], v21, v23 src0_sel:WORD_1 src1_sel:WORD_1
    v_cmp_ne_u32_sdwa vcc, v21, v25 src0_sel:WORD_1 src1_sel:WORD_1
    v_alignbyte_b32 v24, v25, v24, 2
    s_mov_b32 s54, 10237
    v_alignbyte_b32 v21, v21, v20, 1
    v_perm_b32 v20, v20, v24, s47
    s_waitcnt lgkmcnt(1)
    v_add3_u32 v26, v26, v106, s54
    v_sub_u32 v27, 0, v26
    v_and_b32 v27, 3, v27
    s_mov_b64 exec, s[80:81]
    v_mov_b32 v27, 0
    v_mov_b32 v22, 0
    s_mov_b64 exec, vcc
    v_mov_b32 v27, 3

    s_mov_b64 exec, -1
    v_alignbyte_b32 v20, v21, v20, v27
    v_alignbyte_b32 v21, v22, v21, v27
    v_add_u32 v26, v26, v27

    buffer_store_dwordx2 v[20:21], v26, s[24:27], 0 offen
    v_cmp_ne_u32_sdwa s[80:81], v29, v31 src0_sel:WORD_1 src1_sel:WORD_1
    v_cmp_ne_u32_sdwa vcc, v29, v33 src0_sel:WORD_1 src1_sel:WORD_1
    v_alignbyte_b32 v32, v33, v32, 2
    s_mov_b32 s54, 15357
    v_alignbyte_b32 v29, v29, v28, 1
    v_perm_b32 v28, v28, v32, s47
    s_waitcnt lgkmcnt(0)
    v_add3_u32 v34, v34, v106, s54
    v_sub_u32 v35, 0, v34
    v_and_b32 v35, 3, v35
    s_mov_b64 exec, s[80:81]
    v_mov_b32 v35, 0
    v_mov_b32 v30, 0
    s_mov_b64 exec, vcc
    v_mov_b32 v35, 3

    s_mov_b64 exec, -1
    v_alignbyte_b32 v28, v29, v28, v35
    v_alignbyte_b32 v29, v30, v29, v35
    v_add_u32 v34, v34, v35

    buffer_store_dwordx2 v[28:29], v34, s[24:27], 0 offen
L_skw_42:
    s_bitcmp0_b32 s28, 1
    s_cbranch_scc1 L_skw_43
    v_add_u32 v107, 32768, v2
    ds_read_b64 v[4:5], v107 offset:16400
    ds_read_b64 v[6:7], v107 offset:16408
    ds_read_b64 v[8:9], v107 offset:16392

    ds_read_b64 v[12:13], v107 offset:24592
    ds_read_b64 v[14:15], v107 offset:24600
    ds_read_b64 v[16:17], v107 offset:24584

    ds_read_b64 v[20:21], v107 offset:32784
    ds_read_b64 v[22:23], v107 offset:32792
    ds_read_b64 v[24:25], v107 offset:32776

    ds_read_b64 v[28:29], v107 offset:40976
    ds_read_b64 v[30:31], v107 offset:40984
    ds_read_b64 v[32:33], v107 offset:40968

    s_waitcnt lgkmcnt(9)
    v_lshrrev_b32 v10, 16, v5
    ds_read_b32 v10, v10 offset:8192

    s_waitcnt lgkmcnt(7)
    v_lshrrev_b32 v18, 16, v13
    ds_read_b32 v18, v18 offset:8192

    s_waitcnt lgkmcnt(5)
    v_lshrrev_b32 v26, 16, v21
    ds_read_b32 v26, v26 offset:8192

    s_waitcnt lgkmcnt(3)
    v_lshrrev_b32 v34, 16, v29
    ds_read_b32 v34, v34 offset:8192

    v_cmp_ne_u32_sdwa s[80:81], v5, v7 src0_sel:WORD_1 src1_sel:WORD_1
    v_cmp_ne_u32_sdwa vcc, v5, v9 src0_sel:WORD_1 src1_sel:WORD_1
    v_alignbyte_b32 v8, v9, v8, 2
    s_mov_b32 s54, 20477
    v_alignbyte_b32 v5, v5, v4, 1
    v_perm_b32 v4, v4, v8, s47
    s_waitcnt lgkmcnt(3)
    v_add3_u32 v10, v10, v106, s54
    v_sub_u32 v11, 0, v10
    v_and_b32 v11, 3, v11
    s_mov_b64 exec, s[80:81]
    v_mov_b32 v11, 0
    v_mov_b32 v6, 0
    s_mov_b64 exec, vcc
    v_mov_b32 v11, 3

    s_mov_b64 exec, -1
    v_alignbyte_b32 v4, v5, v4, v11
    v_alignbyte_b32 v5, v6, v5, v11
    v_add_u32 v10, v10, v11

    buffer_store_dwordx2 v[4:5], v10, s[24:27], 0 offen
    v_cmp_ne_u32_sdwa s[80:81], v13, v15 src0_sel:WORD_1 src1_sel:WORD_1
    v_cmp_ne_u32_sdwa vcc, v13, v17 src0_sel:WORD_1 src1_sel:WORD_1
    v_alignbyte_b32 v16, v17, v16, 2
    s_mov_b32 s54, 25597
    v_alignbyte_b32 v13, v13, v12, 1
    v_perm_b32 v12, v12, v16, s47
    s_waitcnt lgkmcnt(2)
    v_add3_u32 v18, v18, v106, s54
    v_sub_u32 v19, 0, v18
    v_and_b32 v19, 3, v19
    s_mov_b64 exec, s[80:81]
    v_mov_b32 v19, 0
    v_mov_b32 v14, 0
    s_mov_b64 exec, vcc
    v_mov_b32 v19, 3

    s_mov_b64 exec, -1
    v_alignbyte_b32 v12, v13, v12, v19
    v_alignbyte_b32 v13, v14, v13, v19
    v_add_u32 v18, v18, v19

    buffer_store_dwordx2 v[12:13], v18, s[24:27], 0 offen
    v_cmp_ne_u32_sdwa s[80:81], v21, v23 src0_sel:WORD_1 src1_sel:WORD_1
    v_cmp_ne_u32_sdwa vcc, v21, v25 src0_sel:WORD_1 src1_sel:WORD_1
    v_alignbyte_b32 v24, v25, v24, 2
    s_mov_b32 s54, 30717
    v_alignbyte_b32 v21, v21, v20, 1
    v_perm_b32 v20, v20, v24, s47
    s_waitcnt lgkmcnt(1)
    v_add3_u32 v26, v26, v106, s54
    v_sub_u32 v27, 0, v26
    v_and_b32 v27, 3, v27
    s_mov_b64 exec, s[80:81]
    v_mov_b32 v27, 0
    v_mov_b32 v22, 0
    s_mov_b64 exec, vcc
    v_mov_b32 v27, 3

    s_mov_b64 exec, -1
    v_alignbyte_b32 v20, v21, v20, v27
    v_alignbyte_b32 v21, v22, v21, v27
    v_add_u32 v26, v26, v27

    buffer_store_dwordx2 v[20:21], v26, s[24:27], 0 offen
    v_cmp_ne_u32_sdwa s[80:81], v29, v31 src0_sel:WORD_1 src1_sel:WORD_1
    v_cmp_ne_u32_sdwa vcc, v29, v33 src0_sel:WORD_1 src1_sel:WORD_1
    v_alignbyte_b32 v32, v33, v32, 2
    s_mov_b32 s54, 35837
    v_alignbyte_b32 v29, v29, v28, 1
    v_perm_b32 v28, v28, v32, s47
    s_waitcnt lgkmcnt(0)
    v_add3_u32 v34, v34, v106, s54
    v_sub_u32 v35, 0, v34
    v_and_b32 v35, 3, v35
    s_mov_b64 exec, s[80:81]
    v_mov_b32 v35, 0
    v_mov_b32 v30, 0
    s_mov_b64 exec, vcc
    v_mov_b32 v35, 3

    s_mov_b64 exec, -1
    v_alignbyte_b32 v28, v29, v28, v35
    v_alignbyte_b32 v29, v30, v29, v35
    v_add_u32 v34, v34, v35

    buffer_store_dwordx2 v[28:29], v34, s[24:27], 0 offen
L_skw_43:
    s_bitcmp0_b32 s28, 2
    s_cbranch_scc1 L_skw_44
    v_add_u32 v107, 65536, v2
    ds_read_b64 v[4:5], v107 offset:16400
    ds_read_b64 v[6:7], v107 offset:16408
    ds_read_b64 v[8:9], v107 offset:16392

    ds_read_b64 v[12:13], v107 offset:24592
    ds_read_b64 v[14:15], v107 offset:24600
    ds_read_b64 v[16:17], v107 offset:24584

    ds_read_b64 v[20:21], v107 offset:32784
    ds_read_b64 v[22:23], v107 offset:32792
    ds_read_b64 v[24:25], v107 offset:32776

    ds_read_b64 v[28:29], v107 offset:40976
    ds_read_b64 v[30:31], v107 offset:40984
    ds_read_b64 v[32:33], v107 offset:40968

    s_waitcnt lgkmcnt(9)
    v_lshrrev_b32 v10, 16, v5
    ds_read_b32 v10, v10 offset:8192

    s_waitcnt lgkmcnt(7)
    v_lshrrev_b32 v18, 16, v13
    ds_read_b32 v18, v18 offset:8192

    s_waitcnt lgkmcnt(5)
    v_lshrrev_b32 v26, 16, v21
    ds_read_b32 v26, v26 offset:8192

    s_waitcnt lgkmcnt(3)
    v_lshrrev_b32 v34, 16, v29
    ds_read_b32 v34, v34 offset:8192

    v_cmp_ne_u32_sdwa s[80:81], v5, v7 src0_sel:WORD_1 src1_sel:WORD_1
    v_cmp_ne_u32_sdwa vcc, v5, v9 src0_sel:WORD_1 src1_sel:WORD_1
    v_alignbyte_b32 v8, v9, v8, 2
    s_mov_b32 s54, 40957
    v_alignbyte_b32 v5, v5, v4, 1
    v_perm_b32 v4, v4, v8, s47
    s_waitcnt lgkmcnt(3)
    v_add3_u32 v10, v10, v106, s54
    v_sub_u32 v11, 0, v10
    v_and_b32 v11, 3, v11
    s_mov_b64 exec, s[80:81]
    v_mov_b32 v11, 0
    v_mov_b32 v6, 0
    s_mov_b64 exec, vcc
    v_mov_b32 v11, 3

    s_mov_b64 exec, -1
    v_alignbyte_b32 v4, v5, v4, v11
    v_alignbyte_b32 v5, v6, v5, v11
    v_add_u32 v10, v10, v11

    buffer_store_dwordx2 v[4:5], v10, s[24:27], 0 offen
    v_cmp_ne_u32_sdwa s[80:81], v13, v15 src0_sel:WORD_1 src1_sel:WORD_1
    v_cmp_ne_u32_sdwa vcc, v13, v17 src0_sel:WORD_1 src1_sel:WORD_1
    v_alignbyte_b32 v16, v17, v16, 2
    s_mov_b32 s54, 46077
    v_alignbyte_b32 v13, v13, v12, 1
    v_perm_b32 v12, v12, v16, s47
    s_waitcnt lgkmcnt(2)
    v_add3_u32 v18, v18, v106, s54
    v_sub_u32 v19, 0, v18
    v_and_b32 v19, 3, v19
    s_mov_b64 exec, s[80:81]
    v_mov_b32 v19, 0
    v_mov_b32 v14, 0
    s_mov_b64 exec, vcc
    v_mov_b32 v19, 3

    s_mov_b64 exec, -1
    v_alignbyte_b32 v12, v13, v12, v19
    v_alignbyte_b32 v13, v14, v13, v19
    v_add_u32 v18, v18, v19

    buffer_store_dwordx2 v[12:13], v18, s[24:27], 0 offen
    v_cmp_ne_u32_sdwa s[80:81], v21, v23 src0_sel:WORD_1 src1_sel:WORD_1
    v_cmp_ne_u32_sdwa vcc, v21, v25 src0_sel:WORD_1 src1_sel:WORD_1
    v_alignbyte_b32 v24, v25, v24, 2
    s_mov_b32 s54, 51197
    v_alignbyte_b32 v21, v21, v20, 1
    v_perm_b32 v20, v20, v24, s47
    s_waitcnt lgkmcnt(1)
    v_add3_u32 v26, v26, v106, s54
    v_sub_u32 v27, 0, v26
    v_and_b32 v27, 3, v27
    s_mov_b64 exec, s[80:81]
    v_mov_b32 v27, 0
    v_mov_b32 v22, 0
    s_mov_b64 exec, vcc
    v_mov_b32 v27, 3

    s_mov_b64 exec, -1
    v_alignbyte_b32 v20, v21, v20, v27
    v_alignbyte_b32 v21, v22, v21, v27
    v_add_u32 v26, v26, v27

    buffer_store_dwordx2 v[20:21], v26, s[24:27], 0 offen
    v_cmp_ne_u32_sdwa s[80:81], v29, v31 src0_sel:WORD_1 src1_sel:WORD_1
    v_cmp_ne_u32_sdwa vcc, v29, v33 src0_sel:WORD_1 src1_sel:WORD_1
    v_alignbyte_b32 v32, v33, v32, 2
    s_mov_b32 s54, 56317
    v_alignbyte_b32 v29, v29, v28, 1
    v_perm_b32 v28, v28, v32, s47
    s_waitcnt lgkmcnt(0)
    v_add3_u32 v34, v34, v106, s54
    v_sub_u32 v35, 0, v34
    v_and_b32 v35, 3, v35
    s_mov_b64 exec, s[80:81]
    v_mov_b32 v35, 0
    v_mov_b32 v30, 0
    s_mov_b64 exec, vcc
    v_mov_b32 v35, 3

    s_mov_b64 exec, -1
    v_alignbyte_b32 v28, v29, v28, v35
    v_alignbyte_b32 v29, v30, v29, v35
    v_add_u32 v34, v34, v35

    buffer_store_dwordx2 v[28:29], v34, s[24:27], 0 offen
L_skw_44:
    s_bitcmp0_b32 s28, 3
    s_cbranch_scc1 L_skw_45
    v_add_u32 v107, 98304, v2
    ds_read_b64 v[4:5], v107 offset:16400
    ds_read_b64 v[6:7], v107 offset:16408
    ds_read_b64 v[8:9], v107 offset:16392

    ds_read_b64 v[12:13], v107 offset:24592
    ds_read_b64 v[14:15], v107 offset:24600
    ds_read_b64 v[16:17], v107 offset:24584

    ds_read_b64 v[20:21], v107 offset:32784
    ds_read_b64 v[22:23], v107 offset:32792
    ds_read_b64 v[24:25], v107 offset:32776

    ds_read_b64 v[28:29], v107 offset:40976
    ds_read_b64 v[30:31], v107 offset:40984
    ds_read_b64 v[32:33], v107 offset:40968

    s_waitcnt lgkmcnt(9)
    v_lshrrev_b32 v10, 16, v5
    ds_read_b32 v10, v10 offset:8192

    s_waitcnt lgkmcnt(7)
    v_lshrrev_b32 v18, 16, v13
    ds_read_b32 v18, v18 offset:8192

    s_waitcnt lgkmcnt(5)
    v_lshrrev_b32 v26, 16, v21
    ds_read_b32 v26, v26 offset:8192

    s_waitcnt lgkmcnt(3)
    v_lshrrev_b32 v34, 16, v29
    ds_read_b32 v34, v34 offset:8192

    v_cmp_ne_u32_sdwa s[80:81], v5, v7 src0_sel:WORD_1 src1_sel:WORD_1
    v_cmp_ne_u32_sdwa vcc, v5, v9 src0_sel:WORD_1 src1_sel:WORD_1
    v_alignbyte_b32 v8, v9, v8, 2
    s_mov_b32 s54, 61437
    v_alignbyte_b32 v5, v5, v4, 1
    v_perm_b32 v4, v4, v8, s47
    s_waitcnt lgkmcnt(3)
    v_add3_u32 v10, v10, v106, s54
    v_sub_u32 v11, 0, v10
    v_and_b32 v11, 3, v11
    s_mov_b64 exec, s[80:81]
    v_mov_b32 v11, 0
    v_mov_b32 v6, 0
    s_mov_b64 exec, vcc
    v_mov_b32 v11, 3

    s_mov_b64 exec, -1
    v_alignbyte_b32 v4, v5, v4, v11
    v_alignbyte_b32 v5, v6, v5, v11
    v_add_u32 v10, v10, v11

    buffer_store_dwordx2 v[4:5], v10, s[24:27], 0 offen
    v_cmp_ne_u32_sdwa s[80:81], v13, v15 src0_sel:WORD_1 src1_sel:WORD_1
    v_cmp_ne_u32_sdwa vcc, v13, v17 src0_sel:WORD_1 src1_sel:WORD_1
    v_alignbyte_b32 v16, v17, v16, 2
    s_mov_b32 s54, 66557
    v_alignbyte_b32 v13, v13, v12, 1
    v_perm_b32 v12, v12, v16, s47
    s_waitcnt lgkmcnt(2)
    v_add3_u32 v18, v18, v106, s54
    v_sub_u32 v19, 0, v18
    v_and_b32 v19, 3, v19
    s_mov_b64 exec, s[80:81]
    v_mov_b32 v19, 0
    v_mov_b32 v14, 0
    s_mov_b64 exec, vcc
    v_mov_b32 v19, 3

    s_mov_b64 exec, -1
    v_alignbyte_b32 v12, v13, v12, v19
    v_alignbyte_b32 v13, v14, v13, v19
    v_add_u32 v18, v18, v19

    buffer_store_dwordx2 v[12:13], v18, s[24:27], 0 offen
    v_cmp_ne_u32_sdwa s[80:81], v21, v23 src0_sel:WORD_1 src1_sel:WORD_1
    v_cmp_ne_u32_sdwa vcc, v21, v25 src0_sel:WORD_1 src1_sel:WORD_1
    v_alignbyte_b32 v24, v25, v24, 2
    s_mov_b32 s54, 71677
    v_alignbyte_b32 v21, v21, v20, 1
    v_perm_b32 v20, v20, v24, s47
    s_waitcnt lgkmcnt(1)
    v_add3_u32 v26, v26, v106, s54
    v_sub_u32 v27, 0, v26
    v_and_b32 v27, 3, v27
    s_mov_b64 exec, s[80:81]
    v_mov_b32 v27, 0
    v_mov_b32 v22, 0
    s_mov_b64 exec, vcc
    v_mov_b32 v27, 3

    s_mov_b64 exec, -1
    v_alignbyte_b32 v20, v21, v20, v27
    v_alignbyte_b32 v21, v22, v21, v27
    v_add_u32 v26, v26, v27

    buffer_store_dwordx2 v[20:21], v26, s[24:27], 0 offen
    v_cmp_ne_u32_sdwa s[80:81], v29, v31 src0_sel:WORD_1 src1_sel:WORD_1
    v_cmp_ne_u32_sdwa vcc, v29, v33 src0_sel:WORD_1 src1_sel:WORD_1
    v_alignbyte_b32 v32, v33, v32, 2
    s_mov_b32 s54, 76797
    v_alignbyte_b32 v29, v29, v28, 1
    v_perm_b32 v28, v28, v32, s47
    s_waitcnt lgkmcnt(0)
    v_add3_u32 v34, v34, v106, s54
    v_sub_u32 v35, 0, v34
    v_and_b32 v35, 3, v35
    s_mov_b64 exec, s[80:81]
    v_mov_b32 v35, 0
    v_mov_b32 v30, 0
    s_mov_b64 exec, vcc
    v_mov_b32 v35, 3

    s_andn2_b64 exec, -1, s[68:69]
    v_bfrev_b32 v34, 1
    s_mov_b64 exec, -1
    v_alignbyte_b32 v28, v29, v28, v35
    v_alignbyte_b32 v29, v30, v29, v35
    v_add_u32 v34, v34, v35

    buffer_store_dwordx2 v[28:29], v34, s[24:27], 0 offen
L_skw_45:
L_p1done_1:
    s_endpgm

L_ska_7:
    v_bfrev_b32 v126, 1
    buffer_load_dword v3, v126, s[96:99], 0 offen
    buffer_load_dword v3, v126, s[96:99], 0 offen
    buffer_load_dword v3, v126, s[96:99], 0 offen
    s_branch L_bka_8
L_ska_9:
    v_bfrev_b32 v126, 1
    buffer_load_dword v3, v126, s[96:99], 0 offen
    buffer_load_dword v3, v126, s[96:99], 0 offen
    buffer_load_dword v3, v126, s[96:99], 0 offen
    s_branch L_bka_10
L_ska_11:
    v_bfrev_b32 v126, 1
    buffer_load_dword v3, v126, s[96:99], 0 offen
    buffer_load_dword v3, v126, s[96:99], 0 offen
    buffer_load_dword v3, v126, s[96:99], 0 offen
    s_branch L_bka_12
L_ska_13:
    v_bfrev_b32 v126, 1
    buffer_load_dword v3, v126, s[96:99], 0 offen
    buffer_load_dword v3, v126, s[96:99], 0 offen
    buffer_load_dword v3, v126, s[96:99], 0 offen
    s_branch L_bka_14
L_full_25:
    v_mov_b32 v110, 0
    s_mov_b64 exec, vcc
    v_bfrev_b32 v92, 1
    v_bfrev_b32 v93, 1
    s_mov_b64 exec, 1
    buffer_atomic_or v104, v110, s[36:39], 0 offen
    s_mov_b64 exec, -1
    s_branch L_fback_26

L_full_40:
    v_mov_b32 v110, 0
    s_mov_b64 exec, vcc
    v_bfrev_b32 v92, 1
    v_bfrev_b32 v93, 1
    s_mov_b64 exec, 1
    buffer_atomic_or v104, v110, s[36:39], 0 offen
    s_mov_b64 exec, -1
    s_branch L_fback_41

.globl standalone__molecular_angular_gemnet__graph_kernel
.p2align 8
.type standalone__molecular_angular_gemnet__graph_kernel,@function
standalone__molecular_angular_gemnet__graph_kernel:
    s_cmp_ge_u32 s2, 256
    s_cbranch_scc1 L_p2done_46
    s_load_dwordx2 s[8:9], s[0:1], 0
    s_load_dwordx2 s[6:7], s[0:1], 104
    v_lshrrev_b32 v4, 6, v0
    s_lshr_b32 s37, s2, 1
    s_and_b32 s37, s37, 3
    s_lshr_b32 s36, s2, 3
    s_lshl_b32 s36, s36, 1
    s_and_b32 s3, s2, 1
    s_or_b32 s36, s36, s3
    v_readfirstlane_b32 s4, v4
    v_and_b32 v2, 63, v0
    v_lshrrev_b32 v3, 9, v0
    v_lshl_or_b32 v2, v3, 6, v2
    v_mul_u32_u24 v2, 20, v2
    v_lshlrev_b32 v3, 4, v0

    s_waitcnt lgkmcnt(0)
    s_lshl_b32 m0, s4, 10
    s_and_b32 s5, s4, 7
    s_lshr_b32 s39, s4, 3
    s_lshl_b32 s39, s39, 8
    s_mul_i32 s3, s5, 4096
    s_add_u32 s46, s6, s3
    s_addc_u32 s47, s7, 0
    s_mul_i32 s3, s5, 82575360
    s_add_u32 s3, s3, 83599360
    s_add_u32 s44, s6, s3
    s_addc_u32 s45, s7, 0
    s_mul_i32 s38, s37, 8
    s_add_u32 s4, s38, 8
    s_lshl_b32 s3, s38, 6
    s_add_u32 s3, s3, s36
    s_lshr_b32 s3, s3, 1
    s_lshl_b32 s3, s3, 2
    s_add_u32 s52, s46, s3
    s_addc_u32 s53, s47, 0

    s_load_dword s88, s[52:53], 0
    s_load_dword s89, s[52:53], 128
    s_load_dword s90, s[52:53], 256
    s_load_dword s91, s[52:53], 384
    s_load_dword s92, s[52:53], 512
    s_load_dword s93, s[52:53], 640
    s_load_dword s94, s[52:53], 768
    s_load_dword s95, s[52:53], 896
    s_mov_b32 s3, 32768
    s_load_dword s51, s[6:7], s3
    s_mov_b32 s10, 6400000
    s_mov_b32 s11, 0x20000

    s_add_u32 s12, s6, 393216
    s_addc_u32 s13, s7, 0
    s_mov_b32 s14, 0
    s_mov_b32 s15, 0x20000
    s_add_u32 s60, s6, 393216
    s_addc_u32 s61, s7, 0
    s_mov_b32 s62, 6406144
    s_mov_b32 s63, 0x20000
    s_mov_b32 s3, 135176
    s_load_dword s33, s[6:7], s3

    s_mul_i32 s43, s38, 200192
    s_mul_i32 s41, s4, 200192
    s_mul_i32 s50, s38, 200000
    s_add_u32 s14, s43, 50000

    buffer_load_dwordx4 v[76:79], v3, s[12:15], s43 offen
    s_add_u32 s52, s43, 16384
    buffer_load_dwordx4 v[80:83], v3, s[12:15], s52 offen
    s_add_u32 s52, s43, 32768
    buffer_load_dwordx4 v[84:87], v3, s[12:15], s52 offen
    s_add_u32 s52, s43, 49152
    v_lshlrev_b32 v119, 2, v0
    buffer_load_dword v88, v119, s[12:15], s52 offen
    s_add_u32 s20, s6, 135168
    s_addc_u32 s21, s7, 0
    s_mov_b32 s22, 4096
    s_mov_b32 s23, 0x20000
    v_and_b32 v44, 63, v0
    v_lshlrev_b32 v44, 4, v44
    buffer_load_dwordx2 v[120:121], v44, s[20:23], 0 offen offset:0
    buffer_load_dwordx2 v[122:123], v44, s[20:23], 0 offen offset:1024
    buffer_load_dwordx2 v[124:125], v44, s[20:23], 0 offen offset:2048
    buffer_load_dwordx2 v[126:127], v44, s[20:23], 0 offen offset:3072
    s_movk_i32 s40, 3072
    s_mov_b32 s19, 0x20000
    s_min_u32 s40, s40, 8064
    s_lshl_b32 s52, s38, 6
    s_add_u32 s52, s52, s36
    s_mul_i32 s52, s52, 40320
    s_add_u32 s16, s44, s52
    s_addc_u32 s17, s45, 0
    s_mul_i32 s52, s40, 5
    s_add_u32 s52, s52, 3
    s_and_b32 s18, s52, -4

    s_movk_i32 s53, 5120
    buffer_load_dwordx4 v[90:93], v2, s[16:19], s53 offen
    buffer_load_dword v110, v2, s[16:19], s53 offen offset:16
    s_movk_i32 s53, 7680
    buffer_load_dwordx4 v[94:97], v2, s[16:19], s53 offen
    buffer_load_dword v111, v2, s[16:19], s53 offen offset:16
    s_movk_i32 s53, 10240
    buffer_load_dwordx4 v[98:101], v2, s[16:19], s53 offen
    buffer_load_dword v112, v2, s[16:19], s53 offen offset:16
    s_lshr_b32 s3, s2, 3
    s_mul_i32 s3, s3, 49
    v_add_lshl_u32 v89, v0, s3, 7
    v_cmp_gt_u32 vcc, 49, v0
    v_bfrev_b32 v28, 1
    s_nop 0
    v_cndmask_b32 v89, v28, v89, vcc

    s_mov_b32 s19, 0x20000
    s_mov_b32 s28, 0x4b404000
    s_mov_b32 s29, 0x4b404000
    s_mov_b32 s30, 0xbfffc000
    s_mov_b32 s31, 0xbfffbfff
    s_mov_b32 s32, 0xffff0000
    s_mov_b32 s35, 0x05040100
    s_mov_b32 s97, 0x07060302
    s_mov_b32 s96, 0x40008000
    s_movk_i32 s3, 212
    v_cmp_gt_u32 s[48:49], s3, v0

    v_mov_b32 v1, 0
    s_mov_b32 s24, 0xc0c0004
    s_mov_b32 s25, 0xc0c0105
    s_mov_b32 s26, 0xc0c0206
    s_mov_b32 s27, 0xc0c0307
    v_mov_b32 v28, 0x40004000
    v_mov_b32 v29, 0x40004000
    v_mov_b32 v30, 0x40004000
    v_mov_b32 v31, 0x40004000
    v_add_u32 v32, 50000, v3
    v_add_u32 v33, 65536, v32

    ds_write_b128 v32, v[28:31] offset:0
    ds_write_b128 v32, v[28:31] offset:16384
    ds_write_b128 v32, v[28:31] offset:32768
    ds_write_b128 v32, v[28:31] offset:49152
    ds_write_b128 v33, v[28:31] offset:0
    ds_write_b128 v33, v[28:31] offset:16384
    v_cmp_gt_u32 vcc, 971, v0
    s_mov_b64 exec, vcc
    ds_write_b128 v33, v[28:31] offset:32768
    s_mov_b64 exec, -1
    s_waitcnt vmcnt(13)
    ds_write_addtid_b32 v76 offset:0
    ds_write_addtid_b32 v77 offset:256
    ds_write_addtid_b32 v78 offset:512
    ds_write_addtid_b32 v79 offset:768
    s_waitcnt vmcnt(12)
    ds_write_addtid_b32 v80 offset:16384
    ds_write_addtid_b32 v81 offset:16640
    ds_write_addtid_b32 v82 offset:16896
    ds_write_addtid_b32 v83 offset:17152
    s_waitcnt vmcnt(11)
    ds_write_addtid_b32 v84 offset:32768
    ds_write_addtid_b32 v85 offset:33024
    ds_write_addtid_b32 v86 offset:33280
    ds_write_addtid_b32 v87 offset:33536
    v_lshlrev_b32 v119, 2, v0
    s_waitcnt vmcnt(10)
    s_mov_b64 exec, s[48:49]
    ds_write_b32 v119, v88 offset:49152
    s_mov_b64 exec, -1
    s_add_u32 s43, s43, 50048
    s_add_u32 s14, s43, 50000
    s_min_u32 s14, s14, s41
    s_and_b32 s3, s36, 1
    s_lshl_b32 s3, s3, 4
    s_or_b32 s3, s3, 0x100000
    s_waitcnt lgkmcnt(0)

    s_bfe_u32 s88, s88, s3
    s_bfe_u32 s89, s89, s3
    s_bfe_u32 s90, s90, s3
    s_bfe_u32 s91, s91, s3
    s_bfe_u32 s92, s92, s3
    s_bfe_u32 s93, s93, s3
    s_bfe_u32 s94, s94, s3
    s_bfe_u32 s95, s95, s3
    s_waitcnt vmcnt(6)
    v_max3_u32 v120, v120, v122, v124
    v_add_f32 v121, v121, v123
    v_add_f32 v125, v125, v127
    v_max_u32 v120, v120, v126
    v_add_f32 v121, v121, v125

    s_nop 1
    v_max_u32_dpp v120, v120, v120 row_shr:1 row_mask:0xf bank_mask:0xf
    s_nop 1
    v_max_u32_dpp v120, v120, v120 row_shr:2 row_mask:0xf bank_mask:0xf
    s_nop 1
    v_max_u32_dpp v120, v120, v120 row_shr:4 row_mask:0xf bank_mask:0xf
    s_nop 1
    v_max_u32_dpp v120, v120, v120 row_shr:8 row_mask:0xf bank_mask:0xf
    s_nop 1
    v_max_u32_dpp v120, v120, v120 row_bcast:15 row_mask:0xa bank_mask:0xf
    s_nop 1
    v_max_u32_dpp v120, v120, v120 row_bcast:31 row_mask:0xc bank_mask:0xf
    s_nop 1
    v_add_f32_dpp v121, v121, v121 row_shr:1 row_mask:0xf bank_mask:0xf
    s_nop 1
    v_add_f32_dpp v121, v121, v121 row_shr:2 row_mask:0xf bank_mask:0xf
    s_nop 1
    v_add_f32_dpp v121, v121, v121 row_shr:4 row_mask:0xf bank_mask:0xf
    s_nop 1
    v_add_f32_dpp v121, v121, v121 row_shr:8 row_mask:0xf bank_mask:0xf
    s_nop 1
    v_add_f32_dpp v121, v121, v121 row_bcast:15 row_mask:0xa bank_mask:0xf
    s_nop 1
    v_add_f32_dpp v121, v121, v121 row_bcast:31 row_mask:0xc bank_mask:0xf
    v_lshlrev_b32 v120, 16, v120
    v_mul_f32 v121, 0x34a7c5ac, v121
    v_sqrt_f32 v121, v121
    v_mul_f32 v120, s33, v120
    v_mul_f32 v121, s33, v121
    v_cmp_gt_f32 vcc, 0x46fde800, v120
    s_mov_b64 s[64:65], vcc
    v_cmp_lt_f32 vcc, 0x44000000, v121
    v_mov_b32 v120, 0x37800000
    v_mul_f32 v120, s33, v120
    s_and_b64 vcc, vcc, s[64:65]
    v_mul_f32 v121, 0x46ff8000, v120
    v_rcp_f32 v121, v121
    v_readfirstlane_b32 s33, v120
    s_waitcnt lgkmcnt(0)
    s_barrier
    v_readfirstlane_b32 s34, v121
    v_mov_b32 v120, 150016
    v_mov_b32 v121, 0
    ds_write_b32 v120, v121 offset:8
    s_bitcmp0_b64 vcc, 63
    s_cbranch_scc1 L_p2slow_47
    s_cmp_lg_u32 s51, 0
    s_cbranch_scc1 L_p2slow_47

    s_min_u32 s88, s88, 8064
    s_lshl_b32 s52, s38, 6
    s_add_u32 s52, s52, s36
    s_mul_i32 s52, s52, 40320
    s_add_u32 s16, s44, s52
    s_addc_u32 s17, s45, 0
    s_mul_i32 s52, s88, 5
    s_add_u32 s52, s52, 3
    s_and_b32 s18, s52, -4

    s_movk_i32 s53, 12800
    buffer_load_dwordx4 v[102:105], v2, s[16:19], s53 offen
    buffer_load_dword v113, v2, s[16:19], s53 offen offset:16
    s_movk_i32 s53, 0
    buffer_load_dwordx4 v[4:7], v2, s[16:19], s53 offen
    buffer_load_dword v35, v2, s[16:19], s53 offen offset:16
    s_movk_i32 s53, 2560
    buffer_load_dwordx4 v[8:11], v2, s[16:19], s53 offen
    buffer_load_dword v43, v2, s[16:19], s53 offen offset:16
    s_movk_i32 s53, 15360
    buffer_load_dwordx4 v[106:109], v2, s[16:19], s53 offen
    buffer_load_dword v114, v2, s[16:19], s53 offen offset:16
    s_mov_b32 s40, s88
    s_sub_u32 s42, s40, s39

    s_add_u32 s55, s38, 1
    s_min_u32 s55, s55, 31
    s_mov_b32 s88, s89
    s_mov_b32 s89, s90
    s_mov_b32 s90, s91
    s_mov_b32 s91, s92
    s_mov_b32 s92, s93
    s_mov_b32 s93, s94
    s_mov_b32 s94, s95
    s_mov_b32 s95, 0
    s_min_u32 s88, s88, 8064
    s_lshl_b32 s52, s55, 6
    s_add_u32 s52, s52, s36
    s_mul_i32 s52, s52, 40320
    s_add_u32 s16, s44, s52
    s_addc_u32 s17, s45, 0
    s_mul_i32 s52, s88, 5
    s_add_u32 s52, s52, 3
    s_and_b32 s18, s52, -4

    s_waitcnt vmcnt(12)
    v_perm_b32 v44, v91, v90, s24
    v_perm_b32 v46, v92, v91, s25
    v_perm_b32 v48, v93, v92, s26
    v_perm_b32 v50, v110, v93, s27
    v_mov_b32 v12, v90
    v_alignbyte_b32 v13, v92, v91, 1
    v_alignbyte_b32 v14, v93, v92, 2
    v_alignbyte_b32 v15, v110, v93, 3
    v_lshlrev_b32_sdwa v44, 3, v44 dst_sel:WORD_0 dst_unused:UNUSED_PAD src0_sel:DWORD src1_sel:DWORD
    v_lshlrev_b32_sdwa v46, 3, v46 dst_sel:WORD_0 dst_unused:UNUSED_PAD src0_sel:DWORD src1_sel:DWORD
    v_lshlrev_b32_sdwa v48, 3, v48 dst_sel:WORD_0 dst_unused:UNUSED_PAD src0_sel:DWORD src1_sel:DWORD
    v_lshlrev_b32_sdwa v50, 3, v50 dst_sel:WORD_0 dst_unused:UNUSED_PAD src0_sel:DWORD src1_sel:DWORD
    s_cmp_lt_i32 s42, 1280
    s_cbranch_scc1 L_ufix_48
L_uback_49:

    v_subrev_co_u32 v12, s[80:81], 2.0, v12
    v_subrev_co_u32 v13, s[82:83], 2.0, v13
    v_subrev_co_u32 v14, s[84:85], 2.0, v14
    v_subrev_co_u32 v15, s[86:87], 2.0, v15
    s_mov_b64 exec, s[80:81]
    ds_read_b64 v[44:45], v44
    s_mov_b64 exec, s[82:83]
    ds_read_b64 v[46:47], v46
    s_mov_b64 exec, s[84:85]
    ds_read_b64 v[48:49], v48
    s_mov_b64 exec, s[86:87]
    ds_read_b64 v[50:51], v50
    s_mov_b64 exec, -1
    s_waitcnt vmcnt(10)
    v_perm_b32 v52, v95, v94, s24
    v_perm_b32 v54, v96, v95, s25
    v_perm_b32 v56, v97, v96, s26
    v_perm_b32 v58, v111, v97, s27
    v_mov_b32 v16, v94
    v_alignbyte_b32 v17, v96, v95, 1
    v_alignbyte_b32 v18, v97, v96, 2
    v_alignbyte_b32 v19, v111, v97, 3
    v_lshlrev_b32_sdwa v52, 3, v52 dst_sel:WORD_0 dst_unused:UNUSED_PAD src0_sel:DWORD src1_sel:DWORD
    v_lshlrev_b32_sdwa v54, 3, v54 dst_sel:WORD_0 dst_unused:UNUSED_PAD src0_sel:DWORD src1_sel:DWORD
    v_lshlrev_b32_sdwa v56, 3, v56 dst_sel:WORD_0 dst_unused:UNUSED_PAD src0_sel:DWORD src1_sel:DWORD
    v_lshlrev_b32_sdwa v58, 3, v58 dst_sel:WORD_0 dst_unused:UNUSED_PAD src0_sel:DWORD src1_sel:DWORD
    s_cmp_lt_i32 s42, 1792
    s_cbranch_scc1 L_ufix_50
L_uback_51:

    v_subrev_co_u32 v16, s[64:65], 2.0, v16
    v_subrev_co_u32 v17, s[66:67], 2.0, v17
    v_subrev_co_u32 v18, s[68:69], 2.0, v18
    v_subrev_co_u32 v19, s[70:71], 2.0, v19
    s_mov_b64 exec, s[64:65]
    ds_read_b64 v[52:53], v52
    s_mov_b64 exec, s[66:67]
    ds_read_b64 v[54:55], v54
    s_mov_b64 exec, s[68:69]
    ds_read_b64 v[56:57], v56
    s_mov_b64 exec, s[70:71]
    ds_read_b64 v[58:59], v58
    s_mov_b64 exec, -1
    s_waitcnt vmcnt(8)
    v_perm_b32 v60, v99, v98, s24
    v_perm_b32 v62, v100, v99, s25
    v_perm_b32 v64, v101, v100, s26
    v_perm_b32 v66, v112, v101, s27
    v_mov_b32 v20, v98
    v_alignbyte_b32 v21, v100, v99, 1
    v_alignbyte_b32 v22, v101, v100, 2
    v_alignbyte_b32 v23, v112, v101, 3
    v_lshlrev_b32_sdwa v60, 3, v60 dst_sel:WORD_0 dst_unused:UNUSED_PAD src0_sel:DWORD src1_sel:DWORD
    v_lshlrev_b32_sdwa v62, 3, v62 dst_sel:WORD_0 dst_unused:UNUSED_PAD src0_sel:DWORD src1_sel:DWORD
    v_lshlrev_b32_sdwa v64, 3, v64 dst_sel:WORD_0 dst_unused:UNUSED_PAD src0_sel:DWORD src1_sel:DWORD
    v_lshlrev_b32_sdwa v66, 3, v66 dst_sel:WORD_0 dst_unused:UNUSED_PAD src0_sel:DWORD src1_sel:DWORD
    s_cmp_lt_i32 s42, 2304
    s_cbranch_scc1 L_ufix_52
L_uback_53:

    v_subrev_co_u32 v20, s[72:73], 2.0, v20
    v_subrev_co_u32 v21, s[74:75], 2.0, v21
    v_subrev_co_u32 v22, s[76:77], 2.0, v22
    v_subrev_co_u32 v23, s[78:79], 2.0, v23
    s_mov_b64 exec, s[72:73]
    ds_read_b64 v[60:61], v60
    s_mov_b64 exec, s[74:75]
    ds_read_b64 v[62:63], v62
    s_mov_b64 exec, s[76:77]
    ds_read_b64 v[64:65], v64
    s_mov_b64 exec, s[78:79]
    ds_read_b64 v[66:67], v66
    s_mov_b64 exec, -1
    s_waitcnt vmcnt(6)
    v_perm_b32 v68, v103, v102, s24
    v_perm_b32 v70, v104, v103, s25
    v_perm_b32 v72, v105, v104, s26
    v_perm_b32 v74, v113, v105, s27
    v_mov_b32 v24, v102
    v_alignbyte_b32 v25, v104, v103, 1
    v_alignbyte_b32 v26, v105, v104, 2
    v_alignbyte_b32 v27, v113, v105, 3
    v_lshlrev_b32_sdwa v68, 3, v68 dst_sel:WORD_0 dst_unused:UNUSED_PAD src0_sel:DWORD src1_sel:DWORD
    v_lshlrev_b32_sdwa v70, 3, v70 dst_sel:WORD_0 dst_unused:UNUSED_PAD src0_sel:DWORD src1_sel:DWORD
    v_lshlrev_b32_sdwa v72, 3, v72 dst_sel:WORD_0 dst_unused:UNUSED_PAD src0_sel:DWORD src1_sel:DWORD
    v_lshlrev_b32_sdwa v74, 3, v74 dst_sel:WORD_0 dst_unused:UNUSED_PAD src0_sel:DWORD src1_sel:DWORD
    s_cmp_lt_i32 s42, 2816
    s_cbranch_scc1 L_ufix_54
L_uback_55:

    v_subrev_co_u32 v24, s[80:81], 2.0, v24
    v_subrev_co_u32 v25, s[82:83], 2.0, v25
    v_subrev_co_u32 v26, s[84:85], 2.0, v26
    v_subrev_co_u32 v27, s[86:87], 2.0, v27
    s_mov_b64 exec, s[80:81]
    ds_read_b64 v[68:69], v68
    s_mov_b64 exec, s[82:83]
    ds_read_b64 v[70:71], v70
    s_mov_b64 exec, s[84:85]
    ds_read_b64 v[72:73], v72
    s_mov_b64 exec, s[86:87]
    ds_read_b64 v[74:75], v74
    s_mov_b64 exec, -1
    s_waitcnt vmcnt(4)
    v_perm_b32 v28, v5, v4, s24
    v_perm_b32 v30, v6, v5, s25
    v_perm_b32 v32, v7, v6, s26
    v_perm_b32 v34, v35, v7, s27
    v_alignbyte_b32 v5, v6, v5, 1
    v_alignbyte_b32 v6, v7, v6, 2
    v_alignbyte_b32 v7, v35, v7, 3
    v_lshlrev_b32_sdwa v28, 3, v28 dst_sel:WORD_0 dst_unused:UNUSED_PAD src0_sel:DWORD src1_sel:DWORD
    v_lshlrev_b32_sdwa v30, 3, v30 dst_sel:WORD_0 dst_unused:UNUSED_PAD src0_sel:DWORD src1_sel:DWORD
    v_lshlrev_b32_sdwa v32, 3, v32 dst_sel:WORD_0 dst_unused:UNUSED_PAD src0_sel:DWORD src1_sel:DWORD
    v_lshlrev_b32_sdwa v34, 3, v34 dst_sel:WORD_0 dst_unused:UNUSED_PAD src0_sel:DWORD src1_sel:DWORD
    s_cmp_lt_i32 s42, 256
    s_cbranch_scc1 L_ufix_56
L_uback_57:

    v_subrev_co_u32 v4, s[64:65], 2.0, v4
    v_subrev_co_u32 v5, s[66:67], 2.0, v5
    v_subrev_co_u32 v6, s[68:69], 2.0, v6
    v_subrev_co_u32 v7, s[70:71], 2.0, v7
    s_mov_b64 exec, s[64:65]
    ds_read_b64 v[28:29], v28
    s_mov_b64 exec, s[66:67]
    ds_read_b64 v[30:31], v30
    s_mov_b64 exec, s[68:69]
    ds_read_b64 v[32:33], v32
    s_mov_b64 exec, s[70:71]
    ds_read_b64 v[34:35], v34
    s_mov_b64 exec, -1
    buffer_load_dwordx4 v[76:79], v3, s[12:15], s43 offen
    s_add_u32 s52, s43, 16384
    buffer_load_dwordx4 v[80:83], v3, s[12:15], s52 offen
    s_add_u32 s52, s43, 32768
    buffer_load_dwordx4 v[84:87], v3, s[12:15], s52 offen
    s_add_u32 s52, s43, 49152
    v_lshlrev_b32 v119, 2, v0
    buffer_load_dword v88, v119, s[12:15], s52 offen
    s_add_u32 s54, s43, 50048
    buffer_load_dword v115, v89, s[60:63], s54 offen
    s_add_u32 s54, s50, 0
    buffer_load_dword v115, v89, s[8:11], s54 offen
    s_waitcnt vmcnt(8)
    v_perm_b32 v36, v9, v8, s24
    v_perm_b32 v38, v10, v9, s25
    v_perm_b32 v40, v11, v10, s26
    v_perm_b32 v42, v43, v11, s27
    v_alignbyte_b32 v9, v10, v9, 1
    v_alignbyte_b32 v10, v11, v10, 2
    v_alignbyte_b32 v11, v43, v11, 3
    v_lshlrev_b32_sdwa v36, 3, v36 dst_sel:WORD_0 dst_unused:UNUSED_PAD src0_sel:DWORD src1_sel:DWORD
    v_lshlrev_b32_sdwa v38, 3, v38 dst_sel:WORD_0 dst_unused:UNUSED_PAD src0_sel:DWORD src1_sel:DWORD
    v_lshlrev_b32_sdwa v40, 3, v40 dst_sel:WORD_0 dst_unused:UNUSED_PAD src0_sel:DWORD src1_sel:DWORD
    v_lshlrev_b32_sdwa v42, 3, v42 dst_sel:WORD_0 dst_unused:UNUSED_PAD src0_sel:DWORD src1_sel:DWORD
    s_cmp_lt_i32 s42, 768
    s_cbranch_scc1 L_ufix_58
L_uback_59:

    v_subrev_co_u32 v8, s[72:73], 2.0, v8
    v_subrev_co_u32 v9, s[74:75], 2.0, v9
    v_subrev_co_u32 v10, s[76:77], 2.0, v10
    v_subrev_co_u32 v11, s[78:79], 2.0, v11
    s_mov_b64 exec, s[72:73]
    ds_read_b64 v[36:37], v36
    s_mov_b64 exec, s[74:75]
    ds_read_b64 v[38:39], v38
    s_mov_b64 exec, s[76:77]
    ds_read_b64 v[40:41], v40
    s_mov_b64 exec, s[78:79]
    ds_read_b64 v[42:43], v42
    s_mov_b64 exec, -1
    s_movk_i32 s53, 5120
    buffer_load_dwordx4 v[90:93], v2, s[16:19], s53 offen
    buffer_load_dword v110, v2, s[16:19], s53 offen offset:16
L_batch_60:
    s_add_u32 s5, s38, 1

    s_movk_i32 s53, 7680
    buffer_load_dwordx4 v[94:97], v2, s[16:19], s53 offen
    buffer_load_dword v111, v2, s[16:19], s53 offen offset:16
    v_subrev_co_u32 v4, s[64:65], 2.0, v4
    v_subrev_co_u32 v5, s[66:67], 2.0, v5
    v_subrev_co_u32 v6, s[68:69], 2.0, v6
    v_subrev_co_u32 v7, s[70:71], 2.0, v7
    v_subrev_co_u32 v8, s[72:73], 2.0, v8
    v_subrev_co_u32 v9, s[74:75], 2.0, v9
    v_subrev_co_u32 v10, s[76:77], 2.0, v10
    v_subrev_co_u32 v11, s[78:79], 2.0, v11
    v_subrev_co_u32 v12, s[80:81], 2.0, v12
    v_subrev_co_u32 v13, s[82:83], 2.0, v13
    v_subrev_co_u32 v14, s[84:85], 2.0, v14
    v_subrev_co_u32 v15, s[86:87], 2.0, v15
    s_waitcnt lgkmcnt(0)
    s_barrier
    s_waitcnt vmcnt(5)
    ds_write_addtid_b32 v76 offset:0
    ds_write_addtid_b32 v77 offset:256
    ds_write_addtid_b32 v78 offset:512
    ds_write_addtid_b32 v79 offset:768
    s_waitcnt vmcnt(4)
    ds_write_addtid_b32 v80 offset:16384
    ds_write_addtid_b32 v81 offset:16640
    ds_write_addtid_b32 v82 offset:16896
    ds_write_addtid_b32 v83 offset:17152
    s_waitcnt vmcnt(3)
    ds_write_addtid_b32 v84 offset:32768
    ds_write_addtid_b32 v85 offset:33024
    ds_write_addtid_b32 v86 offset:33280
    ds_write_addtid_b32 v87 offset:33536
    v_lshlrev_b32 v119, 2, v0
    s_waitcnt vmcnt(2)
    s_mov_b64 exec, s[48:49]
    ds_write_b32 v119, v88 offset:49152
    s_mov_b64 exec, -1
    s_add_u32 s43, s43, 50048
    s_add_u32 s14, s43, 50000
    s_min_u32 s14, s14, s41
    buffer_load_dwordx4 v[76:79], v3, s[12:15], s43 offen
    s_waitcnt lgkmcnt(0)
    s_barrier
    s_add_u32 s52, s43, 16384
    buffer_load_dwordx4 v[80:83], v3, s[12:15], s52 offen
    s_add_u32 s52, s43, 32768
    buffer_load_dwordx4 v[84:87], v3, s[12:15], s52 offen
    s_add_u32 s52, s43, 49152
    v_lshlrev_b32 v119, 2, v0
    buffer_load_dword v88, v119, s[12:15], s52 offen
    s_mov_b64 exec, s[64:65]
    ds_read_b64 v[28:29], v28
    s_mov_b64 exec, s[66:67]
    ds_read_b64 v[30:31], v30
    s_mov_b64 exec, s[68:69]
    ds_read_b64 v[32:33], v32
    s_mov_b64 exec, s[70:71]
    ds_read_b64 v[34:35], v34
    s_mov_b64 exec, s[72:73]
    ds_read_b64 v[36:37], v36
    s_mov_b64 exec, s[74:75]
    ds_read_b64 v[38:39], v38
    s_mov_b64 exec, s[76:77]
    ds_read_b64 v[40:41], v40
    s_mov_b64 exec, s[78:79]
    ds_read_b64 v[42:43], v42
    s_mov_b64 exec, s[80:81]
    ds_read_b64 v[44:45], v44
    s_mov_b64 exec, s[82:83]
    ds_read_b64 v[46:47], v46
    s_mov_b64 exec, s[84:85]
    ds_read_b64 v[48:49], v48
    s_mov_b64 exec, s[86:87]
    ds_read_b64 v[50:51], v50
    s_mov_b64 exec, -1
    v_subrev_co_u32 v16, s[64:65], 2.0, v16
    v_subrev_co_u32 v17, s[66:67], 2.0, v17
    v_subrev_co_u32 v18, s[68:69], 2.0, v18
    v_subrev_co_u32 v19, s[70:71], 2.0, v19
    v_subrev_co_u32 v20, s[72:73], 2.0, v20
    v_subrev_co_u32 v21, s[74:75], 2.0, v21
    v_subrev_co_u32 v22, s[76:77], 2.0, v22
    v_subrev_co_u32 v23, s[78:79], 2.0, v23
    v_subrev_co_u32 v24, s[80:81], 2.0, v24
    v_subrev_co_u32 v25, s[82:83], 2.0, v25
    v_subrev_co_u32 v26, s[84:85], 2.0, v26
    v_subrev_co_u32 v27, s[86:87], 2.0, v27
    s_mov_b64 exec, s[64:65]
    ds_read_b64 v[52:53], v52
    s_mov_b64 exec, s[66:67]
    ds_read_b64 v[54:55], v54
    s_mov_b64 exec, s[68:69]
    ds_read_b64 v[56:57], v56
    s_mov_b64 exec, s[70:71]
    ds_read_b64 v[58:59], v58
    s_mov_b64 exec, s[72:73]
    ds_read_b64 v[60:61], v60
    s_mov_b64 exec, s[74:75]
    ds_read_b64 v[62:63], v62
    s_mov_b64 exec, s[76:77]
    ds_read_b64 v[64:65], v64
    s_mov_b64 exec, s[78:79]
    ds_read_b64 v[66:67], v66
    s_mov_b64 exec, s[80:81]
    ds_read_b64 v[68:69], v68
    s_mov_b64 exec, s[82:83]
    ds_read_b64 v[70:71], v70
    s_mov_b64 exec, s[84:85]
    ds_read_b64 v[72:73], v72
    s_mov_b64 exec, s[86:87]
    ds_read_b64 v[74:75], v74
    s_mov_b64 exec, -1
    s_cmp_le_i32 s42, 3072
    s_cbranch_scc1 L_nt1_62
    s_waitcnt vmcnt(14)
    v_perm_b32 v120, v107, v106, s24
    v_perm_b32 v122, v108, v107, s25
    v_perm_b32 v124, v109, v108, s26
    v_perm_b32 v126, v114, v109, s27
    v_alignbyte_b32 v107, v108, v107, 1
    v_alignbyte_b32 v108, v109, v108, 2
    v_alignbyte_b32 v109, v114, v109, 3
    v_lshlrev_b32_sdwa v120, 3, v120 dst_sel:WORD_0 dst_unused:UNUSED_PAD src0_sel:DWORD src1_sel:DWORD
    v_lshlrev_b32_sdwa v122, 3, v122 dst_sel:WORD_0 dst_unused:UNUSED_PAD src0_sel:DWORD src1_sel:DWORD
    v_lshlrev_b32_sdwa v124, 3, v124 dst_sel:WORD_0 dst_unused:UNUSED_PAD src0_sel:DWORD src1_sel:DWORD
    v_lshlrev_b32_sdwa v126, 3, v126 dst_sel:WORD_0 dst_unused:UNUSED_PAD src0_sel:DWORD src1_sel:DWORD
    s_cmp_lt_i32 s42, 3328
    s_cbranch_scc1 L_ufix_65
L_uback_66:

    v_lshrrev_b32 v117, 30, v106
    v_and_b32 v106, 0x3fffffff, v106
    v_mul_u32_u24 v117, 50000, v117
    v_cmp_ne_u32 vcc, 0, v106
    v_add_u32 v120, v120, v117
    s_mov_b64 exec, vcc

    buffer_load_dwordx2 v[120:121], v120, s[8:11], s50 offen
    s_mov_b64 exec, -1
    v_lshrrev_b32 v117, 30, v107
    v_and_b32 v107, 0x3fffffff, v107
    v_mul_u32_u24 v117, 50000, v117
    v_cmp_ne_u32 vcc, 0, v107
    v_add_u32 v122, v122, v117
    s_mov_b64 exec, vcc

    buffer_load_dwordx2 v[122:123], v122, s[8:11], s50 offen
    s_mov_b64 exec, -1
    v_lshrrev_b32 v117, 30, v108
    v_and_b32 v108, 0x3fffffff, v108
    v_mul_u32_u24 v117, 50000, v117
    v_cmp_ne_u32 vcc, 0, v108
    v_add_u32 v124, v124, v117
    s_mov_b64 exec, vcc

    buffer_load_dwordx2 v[124:125], v124, s[8:11], s50 offen
    s_mov_b64 exec, -1
    v_lshrrev_b32 v117, 30, v109
    v_and_b32 v109, 0x3fffffff, v109
    v_mul_u32_u24 v117, 50000, v117
    v_cmp_ne_u32 vcc, 0, v109
    v_add_u32 v126, v126, v117
    s_mov_b64 exec, vcc

    buffer_load_dwordx2 v[126:127], v126, s[8:11], s50 offen
    s_mov_b64 exec, -1
L_nt1_62:
    v_subrev_co_u32 v4, s[64:65], 2.0, v4
    v_subrev_co_u32 v5, s[66:67], 2.0, v5
    v_subrev_co_u32 v6, s[68:69], 2.0, v6
    v_subrev_co_u32 v7, s[70:71], 2.0, v7
    v_subrev_co_u32 v8, s[72:73], 2.0, v8
    v_subrev_co_u32 v9, s[74:75], 2.0, v9
    v_subrev_co_u32 v10, s[76:77], 2.0, v10
    v_subrev_co_u32 v11, s[78:79], 2.0, v11
    v_subrev_co_u32 v12, s[80:81], 2.0, v12
    v_subrev_co_u32 v13, s[82:83], 2.0, v13
    v_subrev_co_u32 v14, s[84:85], 2.0, v14
    v_subrev_co_u32 v15, s[86:87], 2.0, v15
    s_waitcnt lgkmcnt(0)
    s_barrier
    s_waitcnt vmcnt(3)
    ds_write_addtid_b32 v76 offset:0
    ds_write_addtid_b32 v77 offset:256
    ds_write_addtid_b32 v78 offset:512
    ds_write_addtid_b32 v79 offset:768
    s_waitcnt vmcnt(2)
    ds_write_addtid_b32 v80 offset:16384
    ds_write_addtid_b32 v81 offset:16640
    ds_write_addtid_b32 v82 offset:16896
    ds_write_addtid_b32 v83 offset:17152
    s_waitcnt vmcnt(1)
    ds_write_addtid_b32 v84 offset:32768
    ds_write_addtid_b32 v85 offset:33024
    ds_write_addtid_b32 v86 offset:33280
    ds_write_addtid_b32 v87 offset:33536
    v_lshlrev_b32 v119, 2, v0
    s_waitcnt vmcnt(0)
    s_mov_b64 exec, s[48:49]
    ds_write_b32 v119, v88 offset:49152
    s_mov_b64 exec, -1
    s_add_u32 s43, s43, 50048
    s_add_u32 s14, s43, 50000
    s_min_u32 s14, s14, s41
    buffer_load_dwordx4 v[76:79], v3, s[12:15], s43 offen
    s_waitcnt lgkmcnt(0)
    s_barrier
    s_add_u32 s52, s43, 16384
    buffer_load_dwordx4 v[80:83], v3, s[12:15], s52 offen
    s_add_u32 s52, s43, 32768
    buffer_load_dwordx4 v[84:87], v3, s[12:15], s52 offen
    s_add_u32 s52, s43, 49152
    v_lshlrev_b32 v119, 2, v0
    buffer_load_dword v88, v119, s[12:15], s52 offen
    s_mov_b64 exec, s[64:65]
    ds_read_b64 v[28:29], v28
    s_mov_b64 exec, s[66:67]
    ds_read_b64 v[30:31], v30
    s_mov_b64 exec, s[68:69]
    ds_read_b64 v[32:33], v32
    s_mov_b64 exec, s[70:71]
    ds_read_b64 v[34:35], v34
    s_mov_b64 exec, s[72:73]
    ds_read_b64 v[36:37], v36
    s_mov_b64 exec, s[74:75]
    ds_read_b64 v[38:39], v38
    s_mov_b64 exec, s[76:77]
    ds_read_b64 v[40:41], v40
    s_mov_b64 exec, s[78:79]
    ds_read_b64 v[42:43], v42
    s_mov_b64 exec, s[80:81]
    ds_read_b64 v[44:45], v44
    s_mov_b64 exec, s[82:83]
    ds_read_b64 v[46:47], v46
    s_mov_b64 exec, s[84:85]
    ds_read_b64 v[48:49], v48
    s_mov_b64 exec, s[86:87]
    ds_read_b64 v[50:51], v50
    s_mov_b64 exec, -1
    v_subrev_co_u32 v16, s[64:65], 2.0, v16
    v_subrev_co_u32 v17, s[66:67], 2.0, v17
    v_subrev_co_u32 v18, s[68:69], 2.0, v18
    v_subrev_co_u32 v19, s[70:71], 2.0, v19
    v_subrev_co_u32 v20, s[72:73], 2.0, v20
    v_subrev_co_u32 v21, s[74:75], 2.0, v21
    v_subrev_co_u32 v22, s[76:77], 2.0, v22
    v_subrev_co_u32 v23, s[78:79], 2.0, v23
    v_subrev_co_u32 v24, s[80:81], 2.0, v24
    v_subrev_co_u32 v25, s[82:83], 2.0, v25
    v_subrev_co_u32 v26, s[84:85], 2.0, v26
    v_subrev_co_u32 v27, s[86:87], 2.0, v27
    s_mov_b64 exec, s[64:65]
    ds_read_b64 v[52:53], v52
    s_mov_b64 exec, s[66:67]
    ds_read_b64 v[54:55], v54
    s_mov_b64 exec, s[68:69]
    ds_read_b64 v[56:57], v56
    s_mov_b64 exec, s[70:71]
    ds_read_b64 v[58:59], v58
    s_mov_b64 exec, s[72:73]
    ds_read_b64 v[60:61], v60
    s_mov_b64 exec, s[74:75]
    ds_read_b64 v[62:63], v62
    s_mov_b64 exec, s[76:77]
    ds_read_b64 v[64:65], v64
    s_mov_b64 exec, s[78:79]
    ds_read_b64 v[66:67], v66
    s_mov_b64 exec, s[80:81]
    ds_read_b64 v[68:69], v68
    s_mov_b64 exec, s[82:83]
    ds_read_b64 v[70:71], v70
    s_mov_b64 exec, s[84:85]
    ds_read_b64 v[72:73], v72
    s_mov_b64 exec, s[86:87]
    ds_read_b64 v[74:75], v74
    s_mov_b64 exec, -1
    s_movk_i32 s53, 10240
    buffer_load_dwordx4 v[98:101], v2, s[16:19], s53 offen
    buffer_load_dword v112, v2, s[16:19], s53 offen offset:16
    s_cmp_le_i32 s42, 3072
    s_cbranch_scc1 L_nt2_63
    s_waitcnt vmcnt(6)
    v_cmp_ne_u32 s[56:57], 0, v106
    v_cmp_ne_u32 s[58:59], 0, v107
    v_cmp_ne_u32 s[98:99], 0, v108
    v_cmp_ne_u32 vcc, 0, v109
    s_mov_b64 exec, s[56:57]
    v_cvt_f32_i32_sdwa v118, sext(v106) dst_sel:DWORD dst_unused:UNUSED_PAD src0_sel:WORD_0
    v_lshlrev_b32 v116, 16, v120
    v_and_b32 v117, s32, v120
    v_mul_f32 v118, s33, v118
    v_lshlrev_b32 v120, 16, v121
    v_and_b32 v121, s32, v121
    v_lshlrev_b32_sdwa v106, 3, v106 dst_sel:DWORD dst_unused:UNUSED_PAD src0_sel:DWORD src1_sel:WORD_1
    v_pk_fma_f32 v[116:117], v[116:117], v[118:119], s[28:29] op_sel_hi:[1,0,1]
    v_pk_fma_f32 v[120:121], v[120:121], v[118:119], s[28:29] op_sel_hi:[1,0,1]
    v_perm_b32 v116, v117, v116, s35
    v_perm_b32 v117, v121, v120, s35
    v_lshl_add_u64 v[116:117], v[116:117], 0, s[30:31]
    ds_add_rtn_u64 v[120:121], v106, v[116:117] offset:50000

    s_mov_b64 exec, s[58:59]
    v_cvt_f32_i32_sdwa v118, sext(v107) dst_sel:DWORD dst_unused:UNUSED_PAD src0_sel:WORD_0
    v_lshlrev_b32 v116, 16, v122
    v_and_b32 v117, s32, v122
    v_mul_f32 v118, s33, v118
    v_lshlrev_b32 v122, 16, v123
    v_and_b32 v123, s32, v123
    v_lshlrev_b32_sdwa v107, 3, v107 dst_sel:DWORD dst_unused:UNUSED_PAD src0_sel:DWORD src1_sel:WORD_1
    v_pk_fma_f32 v[116:117], v[116:117], v[118:119], s[28:29] op_sel_hi:[1,0,1]
    v_pk_fma_f32 v[122:123], v[122:123], v[118:119], s[28:29] op_sel_hi:[1,0,1]
    v_perm_b32 v116, v117, v116, s35
    v_perm_b32 v117, v123, v122, s35
    v_lshl_add_u64 v[116:117], v[116:117], 0, s[30:31]
    ds_add_rtn_u64 v[122:123], v107, v[116:117] offset:50000

    s_mov_b64 exec, s[98:99]
    v_cvt_f32_i32_sdwa v118, sext(v108) dst_sel:DWORD dst_unused:UNUSED_PAD src0_sel:WORD_0
    v_lshlrev_b32 v116, 16, v124
    v_and_b32 v117, s32, v124
    v_mul_f32 v118, s33, v118
    v_lshlrev_b32 v124, 16, v125
    v_and_b32 v125, s32, v125
    v_lshlrev_b32_sdwa v108, 3, v108 dst_sel:DWORD dst_unused:UNUSED_PAD src0_sel:DWORD src1_sel:WORD_1
    v_pk_fma_f32 v[116:117], v[116:117], v[118:119], s[28:29] op_sel_hi:[1,0,1]
    v_pk_fma_f32 v[124:125], v[124:125], v[118:119], s[28:29] op_sel_hi:[1,0,1]
    v_perm_b32 v116, v117, v116, s35
    v_perm_b32 v117, v125, v124, s35
    v_lshl_add_u64 v[116:117], v[116:117], 0, s[30:31]
    ds_add_rtn_u64 v[124:125], v108, v[116:117] offset:50000

    s_mov_b64 exec, vcc
    v_cvt_f32_i32_sdwa v118, sext(v109) dst_sel:DWORD dst_unused:UNUSED_PAD src0_sel:WORD_0
    v_lshlrev_b32 v116, 16, v126
    v_and_b32 v117, s32, v126
    v_mul_f32 v118, s33, v118
    v_lshlrev_b32 v126, 16, v127
    v_and_b32 v127, s32, v127
    v_lshlrev_b32_sdwa v109, 3, v109 dst_sel:DWORD dst_unused:UNUSED_PAD src0_sel:DWORD src1_sel:WORD_1
    v_pk_fma_f32 v[116:117], v[116:117], v[118:119], s[28:29] op_sel_hi:[1,0,1]
    v_pk_fma_f32 v[126:127], v[126:127], v[118:119], s[28:29] op_sel_hi:[1,0,1]
    v_perm_b32 v116, v117, v116, s35
    v_perm_b32 v117, v127, v126, s35
    v_lshl_add_u64 v[116:117], v[116:117], 0, s[30:31]
    ds_add_rtn_u64 v[126:127], v109, v[116:117] offset:50000

    s_waitcnt lgkmcnt(0)
    s_mov_b64 exec, s[56:57]
    v_or3_b32 v1, v120, v121, v1
    s_mov_b64 exec, s[58:59]
    v_or3_b32 v1, v122, v123, v1
    s_mov_b64 exec, s[98:99]
    v_or3_b32 v1, v124, v125, v1
    s_mov_b64 exec, vcc
    v_or3_b32 v1, v126, v127, v1
    s_mov_b64 exec, -1
L_nt2_63:
    s_movk_i32 s53, 15360
    buffer_load_dwordx4 v[106:109], v2, s[16:19], s53 offen
    buffer_load_dword v114, v2, s[16:19], s53 offen offset:16
    s_cmp_le_u32 s40, 3584
    s_cbranch_scc1 L_noleft_64
    s_min_u32 s40, s40, 8064
    s_lshl_b32 s52, s38, 6
    s_add_u32 s52, s52, s36
    s_mul_i32 s52, s52, 40320
    s_add_u32 s20, s44, s52
    s_addc_u32 s21, s45, 0
    s_mul_i32 s52, s40, 5
    s_add_u32 s52, s52, 3
    s_and_b32 s22, s52, -4

    s_lshr_b32 s55, s39, 2
    s_add_u32 s55, s55, 3584
    v_and_b32 v120, 63, v0
    v_add_u32 v120, s55, v120
L_left_67:
    s_cmp_ge_u32 s55, s40
    s_cbranch_scc1 L_leftend_68
    v_mul_u32_u24 v121, 5, v120
    buffer_load_dword v122, v121, s[20:23], 0 offen
    buffer_load_ubyte v123, v121, s[20:23], 0 offen offset:4
    s_waitcnt vmcnt(0)

    v_perm_b32 v121, v123, v122, s24
    v_lshrrev_b32 v126, 30, v122
    v_and_b32 v121, 0x1fff, v121
    v_mul_u32_u24 v126, 6250, v126
    v_add_lshl_u32 v121, v121, v126, 3

    buffer_load_dwordx2 v[124:125], v121, s[8:11], s50 offen
    v_cmp_gt_u32 vcc, s40, v120
    s_waitcnt vmcnt(0)

    s_mov_b64 exec, vcc
    v_and_b32 v122, 0x3fffffff, v122
    v_cvt_f32_i32_sdwa v118, sext(v122) dst_sel:DWORD dst_unused:UNUSED_PAD src0_sel:WORD_0
    v_lshlrev_b32 v116, 16, v124
    v_and_b32 v117, s32, v124
    v_mul_f32 v118, s33, v118
    v_lshlrev_b32 v124, 16, v125
    v_and_b32 v125, s32, v125
    v_lshlrev_b32_sdwa v122, 3, v122 dst_sel:DWORD dst_unused:UNUSED_PAD src0_sel:DWORD src1_sel:WORD_1
    v_pk_fma_f32 v[116:117], v[116:117], v[118:119], s[28:29] op_sel_hi:[1,0,1]
    v_pk_fma_f32 v[124:125], v[124:125], v[118:119], s[28:29] op_sel_hi:[1,0,1]
    v_perm_b32 v116, v117, v116, s35
    v_perm_b32 v117, v125, v124, s35
    v_lshl_add_u64 v[116:117], v[116:117], 0, s[30:31]
    ds_add_rtn_u64 v[124:125], v122, v[116:117] offset:50000

    s_waitcnt lgkmcnt(0)
    v_or3_b32 v1, v124, v125, v1
    s_mov_b64 exec, -1
    v_add_u32 v120, 128, v120
    s_add_u32 s55, s55, 128
    s_branch L_left_67
L_leftend_68:

L_noleft_64:
    v_cmp_gt_u32 s[64:65], 2.0, v4
    v_and_b32 v4, 0x3fffffff, v4
    v_cmp_gt_u32 s[66:67], 2.0, v5
    v_and_b32 v5, 0x3fffffff, v5
    v_cmp_gt_u32 s[68:69], 2.0, v6
    v_and_b32 v6, 0x3fffffff, v6
    v_cmp_gt_u32 s[70:71], 2.0, v7
    v_and_b32 v7, 0x3fffffff, v7
    v_cmp_gt_u32 s[72:73], 2.0, v8
    v_and_b32 v8, 0x3fffffff, v8
    v_cmp_gt_u32 s[74:75], 2.0, v9
    v_and_b32 v9, 0x3fffffff, v9
    v_cmp_gt_u32 s[76:77], 2.0, v10
    v_and_b32 v10, 0x3fffffff, v10
    v_cmp_gt_u32 s[78:79], 2.0, v11
    v_and_b32 v11, 0x3fffffff, v11
    v_cmp_gt_u32 s[80:81], 2.0, v12
    v_and_b32 v12, 0x3fffffff, v12
    v_cmp_gt_u32 s[82:83], 2.0, v13
    v_and_b32 v13, 0x3fffffff, v13
    v_cmp_gt_u32 s[84:85], 2.0, v14
    v_and_b32 v14, 0x3fffffff, v14
    v_cmp_gt_u32 s[86:87], 2.0, v15
    v_and_b32 v15, 0x3fffffff, v15
    s_waitcnt lgkmcnt(0)
    s_barrier
    s_waitcnt vmcnt(7)
    ds_write_addtid_b32 v76 offset:0
    ds_write_addtid_b32 v77 offset:256
    ds_write_addtid_b32 v78 offset:512
    ds_write_addtid_b32 v79 offset:768
    s_waitcnt vmcnt(6)
    ds_write_addtid_b32 v80 offset:16384
    ds_write_addtid_b32 v81 offset:16640
    ds_write_addtid_b32 v82 offset:16896
    ds_write_addtid_b32 v83 offset:17152
    s_waitcnt vmcnt(5)
    ds_write_addtid_b32 v84 offset:32768
    ds_write_addtid_b32 v85 offset:33024
    ds_write_addtid_b32 v86 offset:33280
    ds_write_addtid_b32 v87 offset:33536
    v_lshlrev_b32 v119, 2, v0
    s_waitcnt vmcnt(4)
    s_mov_b64 exec, s[48:49]
    ds_write_b32 v119, v88 offset:49152
    s_mov_b64 exec, -1
    s_add_u32 s43, s43, 50048
    s_add_u32 s14, s43, 50000
    s_min_u32 s14, s14, s41
    buffer_load_dwordx4 v[76:79], v3, s[12:15], s43 offen
    s_waitcnt lgkmcnt(0)
    s_barrier
    s_add_u32 s52, s43, 16384
    buffer_load_dwordx4 v[80:83], v3, s[12:15], s52 offen
    s_add_u32 s52, s43, 32768
    buffer_load_dwordx4 v[84:87], v3, s[12:15], s52 offen
    s_add_u32 s52, s43, 49152
    v_lshlrev_b32 v119, 2, v0
    buffer_load_dword v88, v119, s[12:15], s52 offen
    s_mov_b64 exec, s[64:65]
    ds_read_b64 v[28:29], v28
    s_mov_b64 exec, s[66:67]
    ds_read_b64 v[30:31], v30
    s_mov_b64 exec, s[68:69]
    ds_read_b64 v[32:33], v32
    s_mov_b64 exec, s[70:71]
    ds_read_b64 v[34:35], v34
    s_mov_b64 exec, s[72:73]
    ds_read_b64 v[36:37], v36
    s_mov_b64 exec, s[74:75]
    ds_read_b64 v[38:39], v38
    s_mov_b64 exec, s[76:77]
    ds_read_b64 v[40:41], v40
    s_mov_b64 exec, s[78:79]
    ds_read_b64 v[42:43], v42
    s_mov_b64 exec, s[80:81]
    ds_read_b64 v[44:45], v44
    s_mov_b64 exec, s[82:83]
    ds_read_b64 v[46:47], v46
    s_mov_b64 exec, s[84:85]
    ds_read_b64 v[48:49], v48
    s_mov_b64 exec, s[86:87]
    ds_read_b64 v[50:51], v50
    s_mov_b64 exec, -1
    v_cmp_gt_u32 s[64:65], 2.0, v16
    v_and_b32 v16, 0x3fffffff, v16
    v_cmp_gt_u32 s[66:67], 2.0, v17
    v_and_b32 v17, 0x3fffffff, v17
    v_cmp_gt_u32 s[68:69], 2.0, v18
    v_and_b32 v18, 0x3fffffff, v18
    v_cmp_gt_u32 s[70:71], 2.0, v19
    v_and_b32 v19, 0x3fffffff, v19
    v_cmp_gt_u32 s[72:73], 2.0, v20
    v_and_b32 v20, 0x3fffffff, v20
    v_cmp_gt_u32 s[74:75], 2.0, v21
    v_and_b32 v21, 0x3fffffff, v21
    v_cmp_gt_u32 s[76:77], 2.0, v22
    v_and_b32 v22, 0x3fffffff, v22
    v_cmp_gt_u32 s[78:79], 2.0, v23
    v_and_b32 v23, 0x3fffffff, v23
    v_cmp_gt_u32 s[80:81], 2.0, v24
    v_and_b32 v24, 0x3fffffff, v24
    v_cmp_gt_u32 s[82:83], 2.0, v25
    v_and_b32 v25, 0x3fffffff, v25
    v_cmp_gt_u32 s[84:85], 2.0, v26
    v_and_b32 v26, 0x3fffffff, v26
    v_cmp_gt_u32 s[86:87], 2.0, v27
    v_and_b32 v27, 0x3fffffff, v27
    s_mov_b64 exec, s[64:65]
    ds_read_b64 v[52:53], v52
    s_mov_b64 exec, s[66:67]
    ds_read_b64 v[54:55], v54
    s_mov_b64 exec, s[68:69]
    ds_read_b64 v[56:57], v56
    s_mov_b64 exec, s[70:71]
    ds_read_b64 v[58:59], v58
    s_mov_b64 exec, s[72:73]
    ds_read_b64 v[60:61], v60
    s_mov_b64 exec, s[74:75]
    ds_read_b64 v[62:63], v62
    s_mov_b64 exec, s[76:77]
    ds_read_b64 v[64:65], v64
    s_mov_b64 exec, s[78:79]
    ds_read_b64 v[66:67], v66
    s_mov_b64 exec, s[80:81]
    ds_read_b64 v[68:69], v68
    s_mov_b64 exec, s[82:83]
    ds_read_b64 v[70:71], v70
    s_mov_b64 exec, s[84:85]
    ds_read_b64 v[72:73], v72
    s_mov_b64 exec, s[86:87]
    ds_read_b64 v[74:75], v74
    s_mov_b64 exec, -1
    s_movk_i32 s53, 12800
    buffer_load_dwordx4 v[102:105], v2, s[16:19], s53 offen
    buffer_load_dword v113, v2, s[16:19], s53 offen offset:16
    s_cmp_ge_u32 s5, s4
    s_cbranch_scc1 L_bend_61
    s_waitcnt lgkmcnt(15)
    v_mad_i32_i16 v120, v28, v4, s96
    v_mad_i32_i16 v28, v28, v4, s96 op_sel:[1,0,0,0]
    v_mad_i32_i16 v121, v29, v4, s96
    v_mad_i32_i16 v29, v29, v4, s96 op_sel:[1,0,0,0]
    v_lshlrev_b32_sdwa v4, 3, v4 dst_sel:DWORD dst_unused:UNUSED_PAD src0_sel:DWORD src1_sel:WORD_1
    v_perm_b32 v28, v28, v120, s97
    v_perm_b32 v29, v29, v121, s97
    v_lshl_add_u64 v[28:29], v[28:29], 0, s[30:31]

    ds_add_rtn_u64 v[28:29], v4, v[28:29] offset:50000
    v_mad_i32_i16 v122, v30, v5, s96
    v_mad_i32_i16 v30, v30, v5, s96 op_sel:[1,0,0,0]
    v_mad_i32_i16 v123, v31, v5, s96
    v_mad_i32_i16 v31, v31, v5, s96 op_sel:[1,0,0,0]
    v_lshlrev_b32_sdwa v5, 3, v5 dst_sel:DWORD dst_unused:UNUSED_PAD src0_sel:DWORD src1_sel:WORD_1
    v_perm_b32 v30, v30, v122, s97
    v_perm_b32 v31, v31, v123, s97
    v_lshl_add_u64 v[30:31], v[30:31], 0, s[30:31]

    ds_add_rtn_u64 v[30:31], v5, v[30:31] offset:50000
    v_mad_i32_i16 v124, v32, v6, s96
    v_mad_i32_i16 v32, v32, v6, s96 op_sel:[1,0,0,0]
    v_mad_i32_i16 v125, v33, v6, s96
    v_mad_i32_i16 v33, v33, v6, s96 op_sel:[1,0,0,0]
    v_lshlrev_b32_sdwa v6, 3, v6 dst_sel:DWORD dst_unused:UNUSED_PAD src0_sel:DWORD src1_sel:WORD_1
    v_perm_b32 v32, v32, v124, s97
    v_perm_b32 v33, v33, v125, s97
    v_lshl_add_u64 v[32:33], v[32:33], 0, s[30:31]

    ds_add_rtn_u64 v[32:33], v6, v[32:33] offset:50000
    v_mad_i32_i16 v126, v34, v7, s96
    v_mad_i32_i16 v34, v34, v7, s96 op_sel:[1,0,0,0]
    v_mad_i32_i16 v127, v35, v7, s96
    v_mad_i32_i16 v35, v35, v7, s96 op_sel:[1,0,0,0]
    v_lshlrev_b32_sdwa v7, 3, v7 dst_sel:DWORD dst_unused:UNUSED_PAD src0_sel:DWORD src1_sel:WORD_1
    v_perm_b32 v34, v34, v126, s97
    v_perm_b32 v35, v35, v127, s97
    v_lshl_add_u64 v[34:35], v[34:35], 0, s[30:31]

    ds_add_rtn_u64 v[34:35], v7, v[34:35] offset:50000
    v_mad_i32_i16 v120, v36, v8, s96
    v_mad_i32_i16 v36, v36, v8, s96 op_sel:[1,0,0,0]
    v_mad_i32_i16 v121, v37, v8, s96
    v_mad_i32_i16 v37, v37, v8, s96 op_sel:[1,0,0,0]
    v_lshlrev_b32_sdwa v8, 3, v8 dst_sel:DWORD dst_unused:UNUSED_PAD src0_sel:DWORD src1_sel:WORD_1
    v_perm_b32 v36, v36, v120, s97
    v_perm_b32 v37, v37, v121, s97
    v_lshl_add_u64 v[36:37], v[36:37], 0, s[30:31]

    ds_add_rtn_u64 v[36:37], v8, v[36:37] offset:50000
    v_mad_i32_i16 v122, v38, v9, s96
    v_mad_i32_i16 v38, v38, v9, s96 op_sel:[1,0,0,0]
    v_mad_i32_i16 v123, v39, v9, s96
    v_mad_i32_i16 v39, v39, v9, s96 op_sel:[1,0,0,0]
    v_lshlrev_b32_sdwa v9, 3, v9 dst_sel:DWORD dst_unused:UNUSED_PAD src0_sel:DWORD src1_sel:WORD_1
    v_perm_b32 v38, v38, v122, s97
    v_perm_b32 v39, v39, v123, s97
    v_lshl_add_u64 v[38:39], v[38:39], 0, s[30:31]

    ds_add_rtn_u64 v[38:39], v9, v[38:39] offset:50000
    v_mad_i32_i16 v124, v40, v10, s96
    v_mad_i32_i16 v40, v40, v10, s96 op_sel:[1,0,0,0]
    v_mad_i32_i16 v125, v41, v10, s96
    v_mad_i32_i16 v41, v41, v10, s96 op_sel:[1,0,0,0]
    v_lshlrev_b32_sdwa v10, 3, v10 dst_sel:DWORD dst_unused:UNUSED_PAD src0_sel:DWORD src1_sel:WORD_1
    v_perm_b32 v40, v40, v124, s97
    v_perm_b32 v41, v41, v125, s97
    v_lshl_add_u64 v[40:41], v[40:41], 0, s[30:31]

    ds_add_rtn_u64 v[40:41], v10, v[40:41] offset:50000
    v_mad_i32_i16 v126, v42, v11, s96
    v_mad_i32_i16 v42, v42, v11, s96 op_sel:[1,0,0,0]
    v_mad_i32_i16 v127, v43, v11, s96
    v_mad_i32_i16 v43, v43, v11, s96 op_sel:[1,0,0,0]
    v_lshlrev_b32_sdwa v11, 3, v11 dst_sel:DWORD dst_unused:UNUSED_PAD src0_sel:DWORD src1_sel:WORD_1
    v_perm_b32 v42, v42, v126, s97
    v_perm_b32 v43, v43, v127, s97
    v_lshl_add_u64 v[42:43], v[42:43], 0, s[30:31]

    ds_add_rtn_u64 v[42:43], v11, v[42:43] offset:50000
    s_waitcnt lgkmcnt(4)
    v_or3_b32 v1, v28, v29, v1
    v_or3_b32 v1, v30, v31, v1
    v_or3_b32 v1, v32, v33, v1
    v_or3_b32 v1, v34, v35, v1
    s_movk_i32 s53, 0
    buffer_load_dwordx4 v[4:7], v2, s[16:19], s53 offen
    buffer_load_dword v35, v2, s[16:19], s53 offen offset:16
    v_mad_i32_i16 v120, v44, v12, s96
    v_mad_i32_i16 v44, v44, v12, s96 op_sel:[1,0,0,0]
    v_mad_i32_i16 v121, v45, v12, s96
    v_mad_i32_i16 v45, v45, v12, s96 op_sel:[1,0,0,0]
    v_lshlrev_b32_sdwa v12, 3, v12 dst_sel:DWORD dst_unused:UNUSED_PAD src0_sel:DWORD src1_sel:WORD_1
    v_perm_b32 v44, v44, v120, s97
    v_perm_b32 v45, v45, v121, s97
    v_lshl_add_u64 v[44:45], v[44:45], 0, s[30:31]

    ds_add_rtn_u64 v[44:45], v12, v[44:45] offset:50000
    v_mad_i32_i16 v122, v46, v13, s96
    v_mad_i32_i16 v46, v46, v13, s96 op_sel:[1,0,0,0]
    v_mad_i32_i16 v123, v47, v13, s96
    v_mad_i32_i16 v47, v47, v13, s96 op_sel:[1,0,0,0]
    v_lshlrev_b32_sdwa v13, 3, v13 dst_sel:DWORD dst_unused:UNUSED_PAD src0_sel:DWORD src1_sel:WORD_1
    v_perm_b32 v46, v46, v122, s97
    v_perm_b32 v47, v47, v123, s97
    v_lshl_add_u64 v[46:47], v[46:47], 0, s[30:31]

    ds_add_rtn_u64 v[46:47], v13, v[46:47] offset:50000
    v_mad_i32_i16 v124, v48, v14, s96
    v_mad_i32_i16 v48, v48, v14, s96 op_sel:[1,0,0,0]
    v_mad_i32_i16 v125, v49, v14, s96
    v_mad_i32_i16 v49, v49, v14, s96 op_sel:[1,0,0,0]
    v_lshlrev_b32_sdwa v14, 3, v14 dst_sel:DWORD dst_unused:UNUSED_PAD src0_sel:DWORD src1_sel:WORD_1
    v_perm_b32 v48, v48, v124, s97
    v_perm_b32 v49, v49, v125, s97
    v_lshl_add_u64 v[48:49], v[48:49], 0, s[30:31]

    ds_add_rtn_u64 v[48:49], v14, v[48:49] offset:50000
    v_mad_i32_i16 v126, v50, v15, s96
    v_mad_i32_i16 v50, v50, v15, s96 op_sel:[1,0,0,0]
    v_mad_i32_i16 v127, v51, v15, s96
    v_mad_i32_i16 v51, v51, v15, s96 op_sel:[1,0,0,0]
    v_lshlrev_b32_sdwa v15, 3, v15 dst_sel:DWORD dst_unused:UNUSED_PAD src0_sel:DWORD src1_sel:WORD_1
    v_perm_b32 v50, v50, v126, s97
    v_perm_b32 v51, v51, v127, s97
    v_lshl_add_u64 v[50:51], v[50:51], 0, s[30:31]

    ds_add_rtn_u64 v[50:51], v15, v[50:51] offset:50000
    s_waitcnt lgkmcnt(4)
    v_or3_b32 v1, v36, v37, v1
    v_or3_b32 v1, v38, v39, v1
    v_or3_b32 v1, v40, v41, v1
    v_or3_b32 v1, v42, v43, v1
    s_movk_i32 s53, 2560
    buffer_load_dwordx4 v[8:11], v2, s[16:19], s53 offen
    buffer_load_dword v43, v2, s[16:19], s53 offen offset:16
    s_barrier
    s_waitcnt vmcnt(9)
    ds_write_addtid_b32 v76 offset:0
    ds_write_addtid_b32 v77 offset:256
    ds_write_addtid_b32 v78 offset:512
    ds_write_addtid_b32 v79 offset:768
    s_waitcnt vmcnt(8)
    ds_write_addtid_b32 v80 offset:16384
    ds_write_addtid_b32 v81 offset:16640
    ds_write_addtid_b32 v82 offset:16896
    ds_write_addtid_b32 v83 offset:17152
    s_waitcnt vmcnt(7)
    ds_write_addtid_b32 v84 offset:32768
    ds_write_addtid_b32 v85 offset:33024
    ds_write_addtid_b32 v86 offset:33280
    ds_write_addtid_b32 v87 offset:33536
    v_lshlrev_b32 v119, 2, v0
    s_waitcnt vmcnt(6)
    s_mov_b64 exec, s[48:49]
    ds_write_b32 v119, v88 offset:49152
    s_mov_b64 exec, -1
    s_add_u32 s43, s43, 50048
    s_add_u32 s14, s43, 50000
    s_min_u32 s14, s14, s41
    s_add_u32 s54, s43, 50048
    buffer_load_dword v115, v89, s[60:63], s54 offen
    s_add_u32 s54, s50, 200000
    buffer_load_dword v115, v89, s[8:11], s54 offen
    s_mov_b32 s40, s88
    s_sub_u32 s42, s40, s39

    s_add_u32 s55, s38, 2
    s_min_u32 s55, s55, 31
    s_mov_b32 s88, s89
    s_mov_b32 s89, s90
    s_mov_b32 s90, s91
    s_mov_b32 s91, s92
    s_mov_b32 s92, s93
    s_mov_b32 s93, s94
    s_mov_b32 s94, s95
    s_mov_b32 s95, 0
    s_min_u32 s88, s88, 8064
    s_lshl_b32 s52, s55, 6
    s_add_u32 s52, s52, s36
    s_mul_i32 s52, s52, 40320
    s_add_u32 s16, s44, s52
    s_addc_u32 s17, s45, 0
    s_mul_i32 s52, s88, 5
    s_add_u32 s52, s52, 3
    s_and_b32 s18, s52, -4

    v_mad_i32_i16 v120, v52, v16, s96
    v_mad_i32_i16 v52, v52, v16, s96 op_sel:[1,0,0,0]
    v_mad_i32_i16 v121, v53, v16, s96
    v_mad_i32_i16 v53, v53, v16, s96 op_sel:[1,0,0,0]
    v_lshlrev_b32_sdwa v16, 3, v16 dst_sel:DWORD dst_unused:UNUSED_PAD src0_sel:DWORD src1_sel:WORD_1
    v_perm_b32 v52, v52, v120, s97
    v_perm_b32 v53, v53, v121, s97
    v_lshl_add_u64 v[52:53], v[52:53], 0, s[30:31]

    ds_add_rtn_u64 v[52:53], v16, v[52:53] offset:50000
    v_mad_i32_i16 v122, v54, v17, s96
    v_mad_i32_i16 v54, v54, v17, s96 op_sel:[1,0,0,0]
    v_mad_i32_i16 v123, v55, v17, s96
    v_mad_i32_i16 v55, v55, v17, s96 op_sel:[1,0,0,0]
    v_lshlrev_b32_sdwa v17, 3, v17 dst_sel:DWORD dst_unused:UNUSED_PAD src0_sel:DWORD src1_sel:WORD_1
    v_perm_b32 v54, v54, v122, s97
    v_perm_b32 v55, v55, v123, s97
    v_lshl_add_u64 v[54:55], v[54:55], 0, s[30:31]

    ds_add_rtn_u64 v[54:55], v17, v[54:55] offset:50000
    v_mad_i32_i16 v124, v56, v18, s96
    v_mad_i32_i16 v56, v56, v18, s96 op_sel:[1,0,0,0]
    v_mad_i32_i16 v125, v57, v18, s96
    v_mad_i32_i16 v57, v57, v18, s96 op_sel:[1,0,0,0]
    v_lshlrev_b32_sdwa v18, 3, v18 dst_sel:DWORD dst_unused:UNUSED_PAD src0_sel:DWORD src1_sel:WORD_1
    v_perm_b32 v56, v56, v124, s97
    v_perm_b32 v57, v57, v125, s97
    v_lshl_add_u64 v[56:57], v[56:57], 0, s[30:31]

    ds_add_rtn_u64 v[56:57], v18, v[56:57] offset:50000
    v_mad_i32_i16 v126, v58, v19, s96
    v_mad_i32_i16 v58, v58, v19, s96 op_sel:[1,0,0,0]
    v_mad_i32_i16 v127, v59, v19, s96
    v_mad_i32_i16 v59, v59, v19, s96 op_sel:[1,0,0,0]
    v_lshlrev_b32_sdwa v19, 3, v19 dst_sel:DWORD dst_unused:UNUSED_PAD src0_sel:DWORD src1_sel:WORD_1
    v_perm_b32 v58, v58, v126, s97
    v_perm_b32 v59, v59, v127, s97
    v_lshl_add_u64 v[58:59], v[58:59], 0, s[30:31]

    ds_add_rtn_u64 v[58:59], v19, v[58:59] offset:50000
    s_waitcnt lgkmcnt(15)
    v_or3_b32 v1, v44, v45, v1
    v_or3_b32 v1, v46, v47, v1
    v_or3_b32 v1, v48, v49, v1
    v_or3_b32 v1, v50, v51, v1
    s_waitcnt vmcnt(26)
    v_perm_b32 v44, v91, v90, s24
    v_perm_b32 v46, v92, v91, s25
    v_perm_b32 v48, v93, v92, s26
    v_perm_b32 v50, v110, v93, s27
    v_mov_b32 v12, v90
    v_alignbyte_b32 v13, v92, v91, 1
    v_alignbyte_b32 v14, v93, v92, 2
    v_alignbyte_b32 v15, v110, v93, 3
    v_lshlrev_b32_sdwa v44, 3, v44 dst_sel:WORD_0 dst_unused:UNUSED_PAD src0_sel:DWORD src1_sel:DWORD
    v_lshlrev_b32_sdwa v46, 3, v46 dst_sel:WORD_0 dst_unused:UNUSED_PAD src0_sel:DWORD src1_sel:DWORD
    v_lshlrev_b32_sdwa v48, 3, v48 dst_sel:WORD_0 dst_unused:UNUSED_PAD src0_sel:DWORD src1_sel:DWORD
    v_lshlrev_b32_sdwa v50, 3, v50 dst_sel:WORD_0 dst_unused:UNUSED_PAD src0_sel:DWORD src1_sel:DWORD
    s_cmp_lt_i32 s42, 1280
    s_cbranch_scc1 L_ufix_69
L_uback_70:

    s_movk_i32 s53, 5120
    buffer_load_dwordx4 v[90:93], v2, s[16:19], s53 offen
    buffer_load_dword v110, v2, s[16:19], s53 offen offset:16
    s_waitcnt lgkmcnt(4)
    s_barrier
    v_subrev_co_u32 v12, s[80:81], 2.0, v12
    v_subrev_co_u32 v13, s[82:83], 2.0, v13
    v_subrev_co_u32 v14, s[84:85], 2.0, v14
    v_subrev_co_u32 v15, s[86:87], 2.0, v15
    s_mov_b64 exec, s[80:81]
    ds_read_b64 v[44:45], v44
    s_mov_b64 exec, s[82:83]
    ds_read_b64 v[46:47], v46
    s_mov_b64 exec, s[84:85]
    ds_read_b64 v[48:49], v48
    s_mov_b64 exec, s[86:87]
    ds_read_b64 v[50:51], v50
    s_mov_b64 exec, -1
    v_mad_i32_i16 v120, v60, v20, s96
    v_mad_i32_i16 v60, v60, v20, s96 op_sel:[1,0,0,0]
    v_mad_i32_i16 v121, v61, v20, s96
    v_mad_i32_i16 v61, v61, v20, s96 op_sel:[1,0,0,0]
    v_lshlrev_b32_sdwa v20, 3, v20 dst_sel:DWORD dst_unused:UNUSED_PAD src0_sel:DWORD src1_sel:WORD_1
    v_perm_b32 v60, v60, v120, s97
    v_perm_b32 v61, v61, v121, s97
    v_lshl_add_u64 v[60:61], v[60:61], 0, s[30:31]

    ds_add_rtn_u64 v[60:61], v20, v[60:61] offset:50000
    v_mad_i32_i16 v122, v62, v21, s96
    v_mad_i32_i16 v62, v62, v21, s96 op_sel:[1,0,0,0]
    v_mad_i32_i16 v123, v63, v21, s96
    v_mad_i32_i16 v63, v63, v21, s96 op_sel:[1,0,0,0]
    v_lshlrev_b32_sdwa v21, 3, v21 dst_sel:DWORD dst_unused:UNUSED_PAD src0_sel:DWORD src1_sel:WORD_1
    v_perm_b32 v62, v62, v122, s97
    v_perm_b32 v63, v63, v123, s97
    v_lshl_add_u64 v[62:63], v[62:63], 0, s[30:31]

    ds_add_rtn_u64 v[62:63], v21, v[62:63] offset:50000
    v_mad_i32_i16 v124, v64, v22, s96
    v_mad_i32_i16 v64, v64, v22, s96 op_sel:[1,0,0,0]
    v_mad_i32_i16 v125, v65, v22, s96
    v_mad_i32_i16 v65, v65, v22, s96 op_sel:[1,0,0,0]
    v_lshlrev_b32_sdwa v22, 3, v22 dst_sel:DWORD dst_unused:UNUSED_PAD src0_sel:DWORD src1_sel:WORD_1
    v_perm_b32 v64, v64, v124, s97
    v_perm_b32 v65, v65, v125, s97
    v_lshl_add_u64 v[64:65], v[64:65], 0, s[30:31]

    ds_add_rtn_u64 v[64:65], v22, v[64:65] offset:50000
    v_mad_i32_i16 v126, v66, v23, s96
    v_mad_i32_i16 v66, v66, v23, s96 op_sel:[1,0,0,0]
    v_mad_i32_i16 v127, v67, v23, s96
    v_mad_i32_i16 v67, v67, v23, s96 op_sel:[1,0,0,0]
    v_lshlrev_b32_sdwa v23, 3, v23 dst_sel:DWORD dst_unused:UNUSED_PAD src0_sel:DWORD src1_sel:WORD_1
    v_perm_b32 v66, v66, v126, s97
    v_perm_b32 v67, v67, v127, s97
    v_lshl_add_u64 v[66:67], v[66:67], 0, s[30:31]

    ds_add_rtn_u64 v[66:67], v23, v[66:67] offset:50000
    s_waitcnt lgkmcnt(8)
    v_or3_b32 v1, v52, v53, v1
    v_or3_b32 v1, v54, v55, v1
    v_or3_b32 v1, v56, v57, v1
    v_or3_b32 v1, v58, v59, v1
    s_waitcnt vmcnt(26)
    v_perm_b32 v52, v95, v94, s24
    v_perm_b32 v54, v96, v95, s25
    v_perm_b32 v56, v97, v96, s26
    v_perm_b32 v58, v111, v97, s27
    v_mov_b32 v16, v94
    v_alignbyte_b32 v17, v96, v95, 1
    v_alignbyte_b32 v18, v97, v96, 2
    v_alignbyte_b32 v19, v111, v97, 3
    v_lshlrev_b32_sdwa v52, 3, v52 dst_sel:WORD_0 dst_unused:UNUSED_PAD src0_sel:DWORD src1_sel:DWORD
    v_lshlrev_b32_sdwa v54, 3, v54 dst_sel:WORD_0 dst_unused:UNUSED_PAD src0_sel:DWORD src1_sel:DWORD
    v_lshlrev_b32_sdwa v56, 3, v56 dst_sel:WORD_0 dst_unused:UNUSED_PAD src0_sel:DWORD src1_sel:DWORD
    v_lshlrev_b32_sdwa v58, 3, v58 dst_sel:WORD_0 dst_unused:UNUSED_PAD src0_sel:DWORD src1_sel:DWORD
    s_cmp_lt_i32 s42, 1792
    s_cbranch_scc1 L_ufix_71
L_uback_72:

    v_subrev_co_u32 v16, s[64:65], 2.0, v16
    v_subrev_co_u32 v17, s[66:67], 2.0, v17
    v_subrev_co_u32 v18, s[68:69], 2.0, v18
    v_subrev_co_u32 v19, s[70:71], 2.0, v19
    s_mov_b64 exec, s[64:65]
    ds_read_b64 v[52:53], v52
    s_mov_b64 exec, s[66:67]
    ds_read_b64 v[54:55], v54
    s_mov_b64 exec, s[68:69]
    ds_read_b64 v[56:57], v56
    s_mov_b64 exec, s[70:71]
    ds_read_b64 v[58:59], v58
    s_mov_b64 exec, -1
    v_mad_i32_i16 v120, v68, v24, s96
    v_mad_i32_i16 v68, v68, v24, s96 op_sel:[1,0,0,0]
    v_mad_i32_i16 v121, v69, v24, s96
    v_mad_i32_i16 v69, v69, v24, s96 op_sel:[1,0,0,0]
    v_lshlrev_b32_sdwa v24, 3, v24 dst_sel:DWORD dst_unused:UNUSED_PAD src0_sel:DWORD src1_sel:WORD_1
    v_perm_b32 v68, v68, v120, s97
    v_perm_b32 v69, v69, v121, s97
    v_lshl_add_u64 v[68:69], v[68:69], 0, s[30:31]

    ds_add_rtn_u64 v[68:69], v24, v[68:69] offset:50000
    v_mad_i32_i16 v122, v70, v25, s96
    v_mad_i32_i16 v70, v70, v25, s96 op_sel:[1,0,0,0]
    v_mad_i32_i16 v123, v71, v25, s96
    v_mad_i32_i16 v71, v71, v25, s96 op_sel:[1,0,0,0]
    v_lshlrev_b32_sdwa v25, 3, v25 dst_sel:DWORD dst_unused:UNUSED_PAD src0_sel:DWORD src1_sel:WORD_1
    v_perm_b32 v70, v70, v122, s97
    v_perm_b32 v71, v71, v123, s97
    v_lshl_add_u64 v[70:71], v[70:71], 0, s[30:31]

    ds_add_rtn_u64 v[70:71], v25, v[70:71] offset:50000
    v_mad_i32_i16 v124, v72, v26, s96
    v_mad_i32_i16 v72, v72, v26, s96 op_sel:[1,0,0,0]
    v_mad_i32_i16 v125, v73, v26, s96
    v_mad_i32_i16 v73, v73, v26, s96 op_sel:[1,0,0,0]
    v_lshlrev_b32_sdwa v26, 3, v26 dst_sel:DWORD dst_unused:UNUSED_PAD src0_sel:DWORD src1_sel:WORD_1
    v_perm_b32 v72, v72, v124, s97
    v_perm_b32 v73, v73, v125, s97
    v_lshl_add_u64 v[72:73], v[72:73], 0, s[30:31]

    ds_add_rtn_u64 v[72:73], v26, v[72:73] offset:50000
    v_mad_i32_i16 v126, v74, v27, s96
    v_mad_i32_i16 v74, v74, v27, s96 op_sel:[1,0,0,0]
    v_mad_i32_i16 v127, v75, v27, s96
    v_mad_i32_i16 v75, v75, v27, s96 op_sel:[1,0,0,0]
    v_lshlrev_b32_sdwa v27, 3, v27 dst_sel:DWORD dst_unused:UNUSED_PAD src0_sel:DWORD src1_sel:WORD_1
    v_perm_b32 v74, v74, v126, s97
    v_perm_b32 v75, v75, v127, s97
    v_lshl_add_u64 v[74:75], v[74:75], 0, s[30:31]

    ds_add_rtn_u64 v[74:75], v27, v[74:75] offset:50000
    s_waitcnt lgkmcnt(8)
    v_or3_b32 v1, v60, v61, v1
    v_or3_b32 v1, v62, v63, v1
    v_or3_b32 v1, v64, v65, v1
    v_or3_b32 v1, v66, v67, v1
    s_waitcnt vmcnt(16)
    v_perm_b32 v60, v99, v98, s24
    v_perm_b32 v62, v100, v99, s25
    v_perm_b32 v64, v101, v100, s26
    v_perm_b32 v66, v112, v101, s27
    v_mov_b32 v20, v98
    v_alignbyte_b32 v21, v100, v99, 1
    v_alignbyte_b32 v22, v101, v100, 2
    v_alignbyte_b32 v23, v112, v101, 3
    v_lshlrev_b32_sdwa v60, 3, v60 dst_sel:WORD_0 dst_unused:UNUSED_PAD src0_sel:DWORD src1_sel:DWORD
    v_lshlrev_b32_sdwa v62, 3, v62 dst_sel:WORD_0 dst_unused:UNUSED_PAD src0_sel:DWORD src1_sel:DWORD
    v_lshlrev_b32_sdwa v64, 3, v64 dst_sel:WORD_0 dst_unused:UNUSED_PAD src0_sel:DWORD src1_sel:DWORD
    v_lshlrev_b32_sdwa v66, 3, v66 dst_sel:WORD_0 dst_unused:UNUSED_PAD src0_sel:DWORD src1_sel:DWORD
    s_cmp_lt_i32 s42, 2304
    s_cbranch_scc1 L_ufix_73
L_uback_74:

    v_subrev_co_u32 v20, s[72:73], 2.0, v20
    v_subrev_co_u32 v21, s[74:75], 2.0, v21
    v_subrev_co_u32 v22, s[76:77], 2.0, v22
    v_subrev_co_u32 v23, s[78:79], 2.0, v23
    s_mov_b64 exec, s[72:73]
    ds_read_b64 v[60:61], v60
    s_mov_b64 exec, s[74:75]
    ds_read_b64 v[62:63], v62
    s_mov_b64 exec, s[76:77]
    ds_read_b64 v[64:65], v64
    s_mov_b64 exec, s[78:79]
    ds_read_b64 v[66:67], v66
    s_mov_b64 exec, -1
    s_waitcnt lgkmcnt(4)
    v_or3_b32 v1, v68, v69, v1
    v_or3_b32 v1, v70, v71, v1
    v_or3_b32 v1, v72, v73, v1
    v_or3_b32 v1, v74, v75, v1
    s_waitcnt vmcnt(8)
    v_perm_b32 v68, v103, v102, s24
    v_perm_b32 v70, v104, v103, s25
    v_perm_b32 v72, v105, v104, s26
    v_perm_b32 v74, v113, v105, s27
    v_mov_b32 v24, v102
    v_alignbyte_b32 v25, v104, v103, 1
    v_alignbyte_b32 v26, v105, v104, 2
    v_alignbyte_b32 v27, v113, v105, 3
    v_lshlrev_b32_sdwa v68, 3, v68 dst_sel:WORD_0 dst_unused:UNUSED_PAD src0_sel:DWORD src1_sel:DWORD
    v_lshlrev_b32_sdwa v70, 3, v70 dst_sel:WORD_0 dst_unused:UNUSED_PAD src0_sel:DWORD src1_sel:DWORD
    v_lshlrev_b32_sdwa v72, 3, v72 dst_sel:WORD_0 dst_unused:UNUSED_PAD src0_sel:DWORD src1_sel:DWORD
    v_lshlrev_b32_sdwa v74, 3, v74 dst_sel:WORD_0 dst_unused:UNUSED_PAD src0_sel:DWORD src1_sel:DWORD
    s_cmp_lt_i32 s42, 2816
    s_cbranch_scc1 L_ufix_75
L_uback_76:

    v_subrev_co_u32 v24, s[80:81], 2.0, v24
    v_subrev_co_u32 v25, s[82:83], 2.0, v25
    v_subrev_co_u32 v26, s[84:85], 2.0, v26
    v_subrev_co_u32 v27, s[86:87], 2.0, v27
    s_mov_b64 exec, s[80:81]
    ds_read_b64 v[68:69], v68
    s_mov_b64 exec, s[82:83]
    ds_read_b64 v[70:71], v70
    s_mov_b64 exec, s[84:85]
    ds_read_b64 v[72:73], v72
    s_mov_b64 exec, s[86:87]
    ds_read_b64 v[74:75], v74
    s_mov_b64 exec, -1
    buffer_load_dwordx4 v[76:79], v3, s[12:15], s43 offen
    s_add_u32 s52, s43, 16384
    buffer_load_dwordx4 v[80:83], v3, s[12:15], s52 offen
    s_add_u32 s52, s43, 32768
    buffer_load_dwordx4 v[84:87], v3, s[12:15], s52 offen
    s_add_u32 s52, s43, 49152
    v_lshlrev_b32 v119, 2, v0
    buffer_load_dword v88, v119, s[12:15], s52 offen
    s_waitcnt vmcnt(10)
    v_perm_b32 v28, v5, v4, s24
    v_perm_b32 v30, v6, v5, s25
    v_perm_b32 v32, v7, v6, s26
    v_perm_b32 v34, v35, v7, s27
    v_alignbyte_b32 v5, v6, v5, 1
    v_alignbyte_b32 v6, v7, v6, 2
    v_alignbyte_b32 v7, v35, v7, 3
    v_lshlrev_b32_sdwa v28, 3, v28 dst_sel:WORD_0 dst_unused:UNUSED_PAD src0_sel:DWORD src1_sel:DWORD
    v_lshlrev_b32_sdwa v30, 3, v30 dst_sel:WORD_0 dst_unused:UNUSED_PAD src0_sel:DWORD src1_sel:DWORD
    v_lshlrev_b32_sdwa v32, 3, v32 dst_sel:WORD_0 dst_unused:UNUSED_PAD src0_sel:DWORD src1_sel:DWORD
    v_lshlrev_b32_sdwa v34, 3, v34 dst_sel:WORD_0 dst_unused:UNUSED_PAD src0_sel:DWORD src1_sel:DWORD
    s_cmp_lt_i32 s42, 256
    s_cbranch_scc1 L_ufix_77
L_uback_78:

    v_subrev_co_u32 v4, s[64:65], 2.0, v4
    v_subrev_co_u32 v5, s[66:67], 2.0, v5
    v_subrev_co_u32 v6, s[68:69], 2.0, v6
    v_subrev_co_u32 v7, s[70:71], 2.0, v7
    s_mov_b64 exec, s[64:65]
    ds_read_b64 v[28:29], v28
    s_mov_b64 exec, s[66:67]
    ds_read_b64 v[30:31], v30
    s_mov_b64 exec, s[68:69]
    ds_read_b64 v[32:33], v32
    s_mov_b64 exec, s[70:71]
    ds_read_b64 v[34:35], v34
    s_mov_b64 exec, -1
    s_waitcnt vmcnt(8)
    v_perm_b32 v36, v9, v8, s24
    v_perm_b32 v38, v10, v9, s25
    v_perm_b32 v40, v11, v10, s26
    v_perm_b32 v42, v43, v11, s27
    v_alignbyte_b32 v9, v10, v9, 1
    v_alignbyte_b32 v10, v11, v10, 2
    v_alignbyte_b32 v11, v43, v11, 3
    v_lshlrev_b32_sdwa v36, 3, v36 dst_sel:WORD_0 dst_unused:UNUSED_PAD src0_sel:DWORD src1_sel:DWORD
    v_lshlrev_b32_sdwa v38, 3, v38 dst_sel:WORD_0 dst_unused:UNUSED_PAD src0_sel:DWORD src1_sel:DWORD
    v_lshlrev_b32_sdwa v40, 3, v40 dst_sel:WORD_0 dst_unused:UNUSED_PAD src0_sel:DWORD src1_sel:DWORD
    v_lshlrev_b32_sdwa v42, 3, v42 dst_sel:WORD_0 dst_unused:UNUSED_PAD src0_sel:DWORD src1_sel:DWORD
    s_cmp_lt_i32 s42, 768
    s_cbranch_scc1 L_ufix_79
L_uback_80:

    v_subrev_co_u32 v8, s[72:73], 2.0, v8
    v_subrev_co_u32 v9, s[74:75], 2.0, v9
    v_subrev_co_u32 v10, s[76:77], 2.0, v10
    v_subrev_co_u32 v11, s[78:79], 2.0, v11
    s_mov_b64 exec, s[72:73]
    ds_read_b64 v[36:37], v36
    s_mov_b64 exec, s[74:75]
    ds_read_b64 v[38:39], v38
    s_mov_b64 exec, s[76:77]
    ds_read_b64 v[40:41], v40
    s_mov_b64 exec, s[78:79]
    ds_read_b64 v[42:43], v42
    s_mov_b64 exec, -1
    s_mov_b32 s38, s5
    s_add_u32 s50, s50, 200000
    s_branch L_batch_60
L_bend_61:

    s_load_dwordx2 s[64:65], s[0:1], 24
    s_load_dwordx2 s[86:87], s[0:1], 40
    s_load_dwordx8 s[88:95], s[0:1], 56
    s_mov_b32 s66, 1600000
    s_mov_b32 s67, 0x20000

    s_waitcnt lgkmcnt(15)
    v_mad_i32_i16 v120, v28, v4, s96
    v_mad_i32_i16 v28, v28, v4, s96 op_sel:[1,0,0,0]
    v_mad_i32_i16 v121, v29, v4, s96
    v_mad_i32_i16 v29, v29, v4, s96 op_sel:[1,0,0,0]
    v_lshlrev_b32_sdwa v4, 3, v4 dst_sel:DWORD dst_unused:UNUSED_PAD src0_sel:DWORD src1_sel:WORD_1
    v_perm_b32 v28, v28, v120, s97
    v_perm_b32 v29, v29, v121, s97
    v_lshl_add_u64 v[28:29], v[28:29], 0, s[30:31]

    ds_add_rtn_u64 v[28:29], v4, v[28:29] offset:50000
    v_mad_i32_i16 v122, v30, v5, s96
    v_mad_i32_i16 v30, v30, v5, s96 op_sel:[1,0,0,0]
    v_mad_i32_i16 v123, v31, v5, s96
    v_mad_i32_i16 v31, v31, v5, s96 op_sel:[1,0,0,0]
    v_lshlrev_b32_sdwa v5, 3, v5 dst_sel:DWORD dst_unused:UNUSED_PAD src0_sel:DWORD src1_sel:WORD_1
    v_perm_b32 v30, v30, v122, s97
    v_perm_b32 v31, v31, v123, s97
    v_lshl_add_u64 v[30:31], v[30:31], 0, s[30:31]

    ds_add_rtn_u64 v[30:31], v5, v[30:31] offset:50000
    v_mad_i32_i16 v124, v32, v6, s96
    v_mad_i32_i16 v32, v32, v6, s96 op_sel:[1,0,0,0]
    v_mad_i32_i16 v125, v33, v6, s96
    v_mad_i32_i16 v33, v33, v6, s96 op_sel:[1,0,0,0]
    v_lshlrev_b32_sdwa v6, 3, v6 dst_sel:DWORD dst_unused:UNUSED_PAD src0_sel:DWORD src1_sel:WORD_1
    v_perm_b32 v32, v32, v124, s97
    v_perm_b32 v33, v33, v125, s97
    v_lshl_add_u64 v[32:33], v[32:33], 0, s[30:31]

    ds_add_rtn_u64 v[32:33], v6, v[32:33] offset:50000
    v_mad_i32_i16 v126, v34, v7, s96
    v_mad_i32_i16 v34, v34, v7, s96 op_sel:[1,0,0,0]
    v_mad_i32_i16 v127, v35, v7, s96
    v_mad_i32_i16 v35, v35, v7, s96 op_sel:[1,0,0,0]
    v_lshlrev_b32_sdwa v7, 3, v7 dst_sel:DWORD dst_unused:UNUSED_PAD src0_sel:DWORD src1_sel:WORD_1
    v_perm_b32 v34, v34, v126, s97
    v_perm_b32 v35, v35, v127, s97
    v_lshl_add_u64 v[34:35], v[34:35], 0, s[30:31]

    ds_add_rtn_u64 v[34:35], v7, v[34:35] offset:50000
    v_mad_i32_i16 v120, v36, v8, s96
    v_mad_i32_i16 v36, v36, v8, s96 op_sel:[1,0,0,0]
    v_mad_i32_i16 v121, v37, v8, s96
    v_mad_i32_i16 v37, v37, v8, s96 op_sel:[1,0,0,0]
    v_lshlrev_b32_sdwa v8, 3, v8 dst_sel:DWORD dst_unused:UNUSED_PAD src0_sel:DWORD src1_sel:WORD_1
    v_perm_b32 v36, v36, v120, s97
    v_perm_b32 v37, v37, v121, s97
    v_lshl_add_u64 v[36:37], v[36:37], 0, s[30:31]

    ds_add_rtn_u64 v[36:37], v8, v[36:37] offset:50000
    v_mad_i32_i16 v122, v38, v9, s96
    v_mad_i32_i16 v38, v38, v9, s96 op_sel:[1,0,0,0]
    v_mad_i32_i16 v123, v39, v9, s96
    v_mad_i32_i16 v39, v39, v9, s96 op_sel:[1,0,0,0]
    v_lshlrev_b32_sdwa v9, 3, v9 dst_sel:DWORD dst_unused:UNUSED_PAD src0_sel:DWORD src1_sel:WORD_1
    v_perm_b32 v38, v38, v122, s97
    v_perm_b32 v39, v39, v123, s97
    v_lshl_add_u64 v[38:39], v[38:39], 0, s[30:31]

    ds_add_rtn_u64 v[38:39], v9, v[38:39] offset:50000
    v_mad_i32_i16 v124, v40, v10, s96
    v_mad_i32_i16 v40, v40, v10, s96 op_sel:[1,0,0,0]
    v_mad_i32_i16 v125, v41, v10, s96
    v_mad_i32_i16 v41, v41, v10, s96 op_sel:[1,0,0,0]
    v_lshlrev_b32_sdwa v10, 3, v10 dst_sel:DWORD dst_unused:UNUSED_PAD src0_sel:DWORD src1_sel:WORD_1
    v_perm_b32 v40, v40, v124, s97
    v_perm_b32 v41, v41, v125, s97
    v_lshl_add_u64 v[40:41], v[40:41], 0, s[30:31]

    ds_add_rtn_u64 v[40:41], v10, v[40:41] offset:50000
    v_mad_i32_i16 v126, v42, v11, s96
    v_mad_i32_i16 v42, v42, v11, s96 op_sel:[1,0,0,0]
    v_mad_i32_i16 v127, v43, v11, s96
    v_mad_i32_i16 v43, v43, v11, s96 op_sel:[1,0,0,0]
    v_lshlrev_b32_sdwa v11, 3, v11 dst_sel:DWORD dst_unused:UNUSED_PAD src0_sel:DWORD src1_sel:WORD_1
    v_perm_b32 v42, v42, v126, s97
    v_perm_b32 v43, v43, v127, s97
    v_lshl_add_u64 v[42:43], v[42:43], 0, s[30:31]

    ds_add_rtn_u64 v[42:43], v11, v[42:43] offset:50000
    s_waitcnt lgkmcnt(4)
    v_or3_b32 v1, v28, v29, v1
    v_or3_b32 v1, v30, v31, v1
    v_or3_b32 v1, v32, v33, v1
    v_or3_b32 v1, v34, v35, v1
    v_mad_i32_i16 v120, v44, v12, s96
    v_mad_i32_i16 v44, v44, v12, s96 op_sel:[1,0,0,0]
    v_mad_i32_i16 v121, v45, v12, s96
    v_mad_i32_i16 v45, v45, v12, s96 op_sel:[1,0,0,0]
    v_lshlrev_b32_sdwa v12, 3, v12 dst_sel:DWORD dst_unused:UNUSED_PAD src0_sel:DWORD src1_sel:WORD_1
    v_perm_b32 v44, v44, v120, s97
    v_perm_b32 v45, v45, v121, s97
    v_lshl_add_u64 v[44:45], v[44:45], 0, s[30:31]

    ds_add_rtn_u64 v[44:45], v12, v[44:45] offset:50000
    v_mad_i32_i16 v122, v46, v13, s96
    v_mad_i32_i16 v46, v46, v13, s96 op_sel:[1,0,0,0]
    v_mad_i32_i16 v123, v47, v13, s96
    v_mad_i32_i16 v47, v47, v13, s96 op_sel:[1,0,0,0]
    v_lshlrev_b32_sdwa v13, 3, v13 dst_sel:DWORD dst_unused:UNUSED_PAD src0_sel:DWORD src1_sel:WORD_1
    v_perm_b32 v46, v46, v122, s97
    v_perm_b32 v47, v47, v123, s97
    v_lshl_add_u64 v[46:47], v[46:47], 0, s[30:31]

    ds_add_rtn_u64 v[46:47], v13, v[46:47] offset:50000
    v_mad_i32_i16 v124, v48, v14, s96
    v_mad_i32_i16 v48, v48, v14, s96 op_sel:[1,0,0,0]
    v_mad_i32_i16 v125, v49, v14, s96
    v_mad_i32_i16 v49, v49, v14, s96 op_sel:[1,0,0,0]
    v_lshlrev_b32_sdwa v14, 3, v14 dst_sel:DWORD dst_unused:UNUSED_PAD src0_sel:DWORD src1_sel:WORD_1
    v_perm_b32 v48, v48, v124, s97
    v_perm_b32 v49, v49, v125, s97
    v_lshl_add_u64 v[48:49], v[48:49], 0, s[30:31]

    ds_add_rtn_u64 v[48:49], v14, v[48:49] offset:50000
    v_mad_i32_i16 v126, v50, v15, s96
    v_mad_i32_i16 v50, v50, v15, s96 op_sel:[1,0,0,0]
    v_mad_i32_i16 v127, v51, v15, s96
    v_mad_i32_i16 v51, v51, v15, s96 op_sel:[1,0,0,0]
    v_lshlrev_b32_sdwa v15, 3, v15 dst_sel:DWORD dst_unused:UNUSED_PAD src0_sel:DWORD src1_sel:WORD_1
    v_perm_b32 v50, v50, v126, s97
    v_perm_b32 v51, v51, v127, s97
    v_lshl_add_u64 v[50:51], v[50:51], 0, s[30:31]

    ds_add_rtn_u64 v[50:51], v15, v[50:51] offset:50000
    s_waitcnt lgkmcnt(4)
    v_or3_b32 v1, v36, v37, v1
    v_or3_b32 v1, v38, v39, v1
    v_or3_b32 v1, v40, v41, v1
    v_or3_b32 v1, v42, v43, v1
    v_mad_i32_i16 v120, v52, v16, s96
    v_mad_i32_i16 v52, v52, v16, s96 op_sel:[1,0,0,0]
    v_mad_i32_i16 v121, v53, v16, s96
    v_mad_i32_i16 v53, v53, v16, s96 op_sel:[1,0,0,0]
    v_lshlrev_b32_sdwa v16, 3, v16 dst_sel:DWORD dst_unused:UNUSED_PAD src0_sel:DWORD src1_sel:WORD_1
    v_perm_b32 v52, v52, v120, s97
    v_perm_b32 v53, v53, v121, s97
    v_lshl_add_u64 v[52:53], v[52:53], 0, s[30:31]

    ds_add_rtn_u64 v[52:53], v16, v[52:53] offset:50000
    v_mad_i32_i16 v122, v54, v17, s96
    v_mad_i32_i16 v54, v54, v17, s96 op_sel:[1,0,0,0]
    v_mad_i32_i16 v123, v55, v17, s96
    v_mad_i32_i16 v55, v55, v17, s96 op_sel:[1,0,0,0]
    v_lshlrev_b32_sdwa v17, 3, v17 dst_sel:DWORD dst_unused:UNUSED_PAD src0_sel:DWORD src1_sel:WORD_1
    v_perm_b32 v54, v54, v122, s97
    v_perm_b32 v55, v55, v123, s97
    v_lshl_add_u64 v[54:55], v[54:55], 0, s[30:31]

    ds_add_rtn_u64 v[54:55], v17, v[54:55] offset:50000
    v_mad_i32_i16 v124, v56, v18, s96
    v_mad_i32_i16 v56, v56, v18, s96 op_sel:[1,0,0,0]
    v_mad_i32_i16 v125, v57, v18, s96
    v_mad_i32_i16 v57, v57, v18, s96 op_sel:[1,0,0,0]
    v_lshlrev_b32_sdwa v18, 3, v18 dst_sel:DWORD dst_unused:UNUSED_PAD src0_sel:DWORD src1_sel:WORD_1
    v_perm_b32 v56, v56, v124, s97
    v_perm_b32 v57, v57, v125, s97
    v_lshl_add_u64 v[56:57], v[56:57], 0, s[30:31]

    ds_add_rtn_u64 v[56:57], v18, v[56:57] offset:50000
    v_mad_i32_i16 v126, v58, v19, s96
    v_mad_i32_i16 v58, v58, v19, s96 op_sel:[1,0,0,0]
    v_mad_i32_i16 v127, v59, v19, s96
    v_mad_i32_i16 v59, v59, v19, s96 op_sel:[1,0,0,0]
    v_lshlrev_b32_sdwa v19, 3, v19 dst_sel:DWORD dst_unused:UNUSED_PAD src0_sel:DWORD src1_sel:WORD_1
    v_perm_b32 v58, v58, v126, s97
    v_perm_b32 v59, v59, v127, s97
    v_lshl_add_u64 v[58:59], v[58:59], 0, s[30:31]

    ds_add_rtn_u64 v[58:59], v19, v[58:59] offset:50000
    s_waitcnt lgkmcnt(4)
    v_or3_b32 v1, v44, v45, v1
    v_or3_b32 v1, v46, v47, v1
    v_or3_b32 v1, v48, v49, v1
    v_or3_b32 v1, v50, v51, v1
    v_mad_i32_i16 v120, v60, v20, s96
    v_mad_i32_i16 v60, v60, v20, s96 op_sel:[1,0,0,0]
    v_mad_i32_i16 v121, v61, v20, s96
    v_mad_i32_i16 v61, v61, v20, s96 op_sel:[1,0,0,0]
    v_lshlrev_b32_sdwa v20, 3, v20 dst_sel:DWORD dst_unused:UNUSED_PAD src0_sel:DWORD src1_sel:WORD_1
    v_perm_b32 v60, v60, v120, s97
    v_perm_b32 v61, v61, v121, s97
    v_lshl_add_u64 v[60:61], v[60:61], 0, s[30:31]

    ds_add_rtn_u64 v[60:61], v20, v[60:61] offset:50000
    v_mad_i32_i16 v122, v62, v21, s96
    v_mad_i32_i16 v62, v62, v21, s96 op_sel:[1,0,0,0]
    v_mad_i32_i16 v123, v63, v21, s96
    v_mad_i32_i16 v63, v63, v21, s96 op_sel:[1,0,0,0]
    v_lshlrev_b32_sdwa v21, 3, v21 dst_sel:DWORD dst_unused:UNUSED_PAD src0_sel:DWORD src1_sel:WORD_1
    v_perm_b32 v62, v62, v122, s97
    v_perm_b32 v63, v63, v123, s97
    v_lshl_add_u64 v[62:63], v[62:63], 0, s[30:31]

    ds_add_rtn_u64 v[62:63], v21, v[62:63] offset:50000
    v_mad_i32_i16 v124, v64, v22, s96
    v_mad_i32_i16 v64, v64, v22, s96 op_sel:[1,0,0,0]
    v_mad_i32_i16 v125, v65, v22, s96
    v_mad_i32_i16 v65, v65, v22, s96 op_sel:[1,0,0,0]
    v_lshlrev_b32_sdwa v22, 3, v22 dst_sel:DWORD dst_unused:UNUSED_PAD src0_sel:DWORD src1_sel:WORD_1
    v_perm_b32 v64, v64, v124, s97
    v_perm_b32 v65, v65, v125, s97
    v_lshl_add_u64 v[64:65], v[64:65], 0, s[30:31]

    ds_add_rtn_u64 v[64:65], v22, v[64:65] offset:50000
    v_mad_i32_i16 v126, v66, v23, s96
    v_mad_i32_i16 v66, v66, v23, s96 op_sel:[1,0,0,0]
    v_mad_i32_i16 v127, v67, v23, s96
    v_mad_i32_i16 v67, v67, v23, s96 op_sel:[1,0,0,0]
    v_lshlrev_b32_sdwa v23, 3, v23 dst_sel:DWORD dst_unused:UNUSED_PAD src0_sel:DWORD src1_sel:WORD_1
    v_perm_b32 v66, v66, v126, s97
    v_perm_b32 v67, v67, v127, s97
    v_lshl_add_u64 v[66:67], v[66:67], 0, s[30:31]

    ds_add_rtn_u64 v[66:67], v23, v[66:67] offset:50000
    s_waitcnt lgkmcnt(4)
    v_or3_b32 v1, v52, v53, v1
    v_or3_b32 v1, v54, v55, v1
    v_or3_b32 v1, v56, v57, v1
    v_or3_b32 v1, v58, v59, v1
    v_mad_i32_i16 v120, v68, v24, s96
    v_mad_i32_i16 v68, v68, v24, s96 op_sel:[1,0,0,0]
    v_mad_i32_i16 v121, v69, v24, s96
    v_mad_i32_i16 v69, v69, v24, s96 op_sel:[1,0,0,0]
    v_lshlrev_b32_sdwa v24, 3, v24 dst_sel:DWORD dst_unused:UNUSED_PAD src0_sel:DWORD src1_sel:WORD_1
    v_perm_b32 v68, v68, v120, s97
    v_perm_b32 v69, v69, v121, s97
    v_lshl_add_u64 v[68:69], v[68:69], 0, s[30:31]

    ds_add_rtn_u64 v[68:69], v24, v[68:69] offset:50000
    v_mad_i32_i16 v122, v70, v25, s96
    v_mad_i32_i16 v70, v70, v25, s96 op_sel:[1,0,0,0]
    v_mad_i32_i16 v123, v71, v25, s96
    v_mad_i32_i16 v71, v71, v25, s96 op_sel:[1,0,0,0]
    v_lshlrev_b32_sdwa v25, 3, v25 dst_sel:DWORD dst_unused:UNUSED_PAD src0_sel:DWORD src1_sel:WORD_1
    v_perm_b32 v70, v70, v122, s97
    v_perm_b32 v71, v71, v123, s97
    v_lshl_add_u64 v[70:71], v[70:71], 0, s[30:31]

    ds_add_rtn_u64 v[70:71], v25, v[70:71] offset:50000
    v_mad_i32_i16 v124, v72, v26, s96
    v_mad_i32_i16 v72, v72, v26, s96 op_sel:[1,0,0,0]
    v_mad_i32_i16 v125, v73, v26, s96
    v_mad_i32_i16 v73, v73, v26, s96 op_sel:[1,0,0,0]
    v_lshlrev_b32_sdwa v26, 3, v26 dst_sel:DWORD dst_unused:UNUSED_PAD src0_sel:DWORD src1_sel:WORD_1
    v_perm_b32 v72, v72, v124, s97
    v_perm_b32 v73, v73, v125, s97
    v_lshl_add_u64 v[72:73], v[72:73], 0, s[30:31]

    ds_add_rtn_u64 v[72:73], v26, v[72:73] offset:50000
    v_mad_i32_i16 v126, v74, v27, s96
    v_mad_i32_i16 v74, v74, v27, s96 op_sel:[1,0,0,0]
    v_mad_i32_i16 v127, v75, v27, s96
    v_mad_i32_i16 v75, v75, v27, s96 op_sel:[1,0,0,0]
    v_lshlrev_b32_sdwa v27, 3, v27 dst_sel:DWORD dst_unused:UNUSED_PAD src0_sel:DWORD src1_sel:WORD_1
    v_perm_b32 v74, v74, v126, s97
    v_perm_b32 v75, v75, v127, s97
    v_lshl_add_u64 v[74:75], v[74:75], 0, s[30:31]

    ds_add_rtn_u64 v[74:75], v27, v[74:75] offset:50000
    s_waitcnt lgkmcnt(4)
    v_or3_b32 v1, v60, v61, v1
    v_or3_b32 v1, v62, v63, v1
    v_or3_b32 v1, v64, v65, v1
    v_or3_b32 v1, v66, v67, v1
    s_waitcnt lgkmcnt(0)
    v_or3_b32 v1, v68, v69, v1
    v_or3_b32 v1, v70, v71, v1
    v_or3_b32 v1, v72, v73, v1
    v_or3_b32 v1, v74, v75, v1
    s_waitcnt vmcnt(0)
    s_waitcnt lgkmcnt(0)
    s_load_dwordx4 s[28:31], s[86:87], 0
    s_load_dwordx16 s[68:83], s[88:89], 0
    s_load_dwordx8 s[12:19], s[92:93], 0
    s_load_dwordx8 s[56:63], s[94:95], 0
    s_mov_b64 s[48:49], s[90:91]
    s_load_dwordx16 s[84:99], s[48:49], 0

    s_mov_b32 s41, s37
    s_mul_i32 s3, s41, 3125
    s_add_u32 s5, s3, 3126
    s_add_u32 s3, s3, 1
    s_lshr_b32 s3, s3, 1
    s_lshr_b32 s5, s5, 1
    s_sub_u32 s5, s5, s3
    s_sub_u32 s5, s5, 782
    v_cmp_gt_u32 vcc, s5, v0
    s_mul_i32 s5, s36, 6250
    s_add_u32 s3, s3, s5
    v_add_u32 v6, s3, v0
    v_add_u32 v7, 782, v6
    v_mov_b32 v8, 0x2000000
    v_lshlrev_b32 v4, 4, v6
    v_cndmask_b32 v7, v8, v7, vcc
    v_lshlrev_b32 v6, 2, v6
    v_lshlrev_b32 v5, 4, v7
    v_lshlrev_b32 v7, 2, v7
    v_cmp_gt_u32 vcc, 782, v0
    s_mov_b64 exec, vcc
    s_cbranch_execz L_skld_84
    buffer_load_dword v6, v6, s[64:67], 0 offen
    buffer_load_dword v7, v7, s[64:67], 0 offen
    buffer_load_dwordx4 v[108:111], v4, s[8:11], 0 offen
    buffer_load_dwordx4 v[112:115], v5, s[8:11], 0 offen

L_skld_84:
    s_mov_b64 exec, -1
    s_barrier

    v_add_u32 v116, 50000, v3
    v_add_u32 v117, 115536, v3
    v_cmp_gt_u32 vcc, 106, v0

    v_mov_b32 v100, 0
    v_mov_b32 v101, 0
    v_mov_b32 v102, 0
    v_mov_b32 v103, 0
    ds_read_b128 v[76:79], v116 offset:0
    ds_read_b128 v[80:83], v116 offset:16384
    ds_read_b128 v[84:87], v116 offset:32768
    ds_read_b128 v[88:91], v116 offset:49152
    ds_read_b128 v[92:95], v117 offset:0
    ds_read_b128 v[96:99], v117 offset:16384
    s_mov_b64 exec, vcc
    ds_read_b128 v[100:103], v117 offset:32768
    s_mov_b64 exec, -1
    s_mul_i32 s3, s37, 6400000
    s_mul_i32 s5, s36, 100000
    s_add_u32 s3, s3, s5
    s_add_u32 s3, s3, 6799360

    s_add_u32 s20, s6, s3
    s_addc_u32 s21, s7, 0
    s_mov_b32 s22, 100000
    s_mov_b32 s23, 0x20000
    s_waitcnt lgkmcnt(6)
    s_mov_b32 s3, 0
    buffer_store_dwordx4 v[76:79], v3, s[20:23], s3 offen sc1
    s_waitcnt lgkmcnt(5)
    s_mov_b32 s3, 16384
    buffer_store_dwordx4 v[80:83], v3, s[20:23], s3 offen sc1
    s_waitcnt lgkmcnt(4)
    s_mov_b32 s3, 32768
    buffer_store_dwordx4 v[84:87], v3, s[20:23], s3 offen sc1
    s_waitcnt lgkmcnt(3)
    s_mov_b32 s3, 49152
    buffer_store_dwordx4 v[88:91], v3, s[20:23], s3 offen sc1
    s_waitcnt lgkmcnt(2)
    s_mov_b32 s3, 65536
    buffer_store_dwordx4 v[92:95], v3, s[20:23], s3 offen sc1
    s_waitcnt lgkmcnt(1)
    s_mov_b32 s3, 81920
    buffer_store_dwordx4 v[96:99], v3, s[20:23], s3 offen sc1
    s_waitcnt lgkmcnt(0)
    s_mov_b32 s3, 98304
    buffer_store_dwordx4 v[100:103], v3, s[20:23], s3 offen sc1
    v_or3_b32 v1, v76, v77, v1
    v_or3_b32 v1, v78, v79, v1
    v_or3_b32 v1, v80, v81, v1
    v_or3_b32 v1, v82, v83, v1
    v_or3_b32 v1, v84, v85, v1
    v_or3_b32 v1, v86, v87, v1
    v_or3_b32 v1, v88, v89, v1
    v_or3_b32 v1, v90, v91, v1
    v_or3_b32 v1, v92, v93, v1
    v_or3_b32 v1, v94, v95, v1
    v_or3_b32 v1, v96, v97, v1
    v_or3_b32 v1, v98, v99, v1
    v_or3_b32 v1, v100, v101, v1
    v_or3_b32 v1, v102, v103, v1
    v_and_b32 v1, 0x80008000, v1
    v_cmp_ne_u32 vcc, 0, v1
    v_mov_b32 v116, 150024
    v_mov_b32 v117, 1
    s_cbranch_vccz L_nf_81
    ds_write_b32 v116, v117
L_nf_81:
    s_mov_b32 s33, 1
    s_mov_b32 s42, 0
    v_cmp_gt_u32 vcc, 782, v0
    s_mov_b64 exec, vcc
    s_cbranch_execz L_p1end_86
    s_waitcnt vmcnt(9)
    s_branch L_lddone_83
L_fin_82:

    s_load_dwordx2 s[64:65], s[0:1], 24
    s_load_dwordx2 s[86:87], s[0:1], 40
    s_load_dwordx8 s[88:95], s[0:1], 56
    s_mov_b32 s66, 1600000
    s_mov_b32 s67, 0x20000

    s_waitcnt lgkmcnt(0)
    s_load_dwordx4 s[28:31], s[86:87], 0
    s_load_dwordx16 s[68:83], s[88:89], 0
    s_load_dwordx8 s[12:19], s[92:93], 0
    s_load_dwordx8 s[56:63], s[94:95], 0
    s_mov_b64 s[48:49], s[90:91]
    s_load_dwordx16 s[84:99], s[48:49], 0

    s_mov_b32 s42, 1
    s_mov_b32 s41, s37
L_qloop_85:
    s_mul_i32 s3, s41, 3125
    s_add_u32 s5, s3, 3126
    s_add_u32 s3, s3, 1
    s_lshr_b32 s3, s3, 1
    s_lshr_b32 s5, s5, 1
    s_sub_u32 s5, s5, s3
    s_sub_u32 s5, s5, 782
    v_cmp_gt_u32 vcc, s5, v0
    s_mul_i32 s5, s36, 6250
    s_add_u32 s3, s3, s5
    v_add_u32 v6, s3, v0
    v_add_u32 v7, 782, v6
    v_mov_b32 v8, 0x2000000
    v_lshlrev_b32 v4, 4, v6
    v_cndmask_b32 v7, v8, v7, vcc
    v_lshlrev_b32 v6, 2, v6
    v_lshlrev_b32 v5, 4, v7
    v_lshlrev_b32 v7, 2, v7
    v_cmp_gt_u32 vcc, 782, v0
    s_mov_b64 exec, vcc
    s_cbranch_execz L_p1end_86
    buffer_load_dword v6, v6, s[64:67], 0 offen
    buffer_load_dword v7, v7, s[64:67], 0 offen
    buffer_load_dwordx4 v[108:111], v4, s[8:11], 0 offen
    buffer_load_dwordx4 v[112:115], v5, s[8:11], 0 offen

    s_waitcnt vmcnt(2)
L_lddone_83:
    s_waitcnt lgkmcnt(0)
    v_lshlrev_b32 v8, 16, v6
    v_and_b32 v9, s32, v6
    v_lshlrev_b32 v10, 16, v7
    v_and_b32 v11, s32, v7

    s_lshl_b32 s52, s28, 16
    v_subrev_f32 v12, s52, v8
    v_subrev_f32 v20, s52, v9
    v_subrev_f32 v28, s52, v10
    v_subrev_f32 v36, s52, v11
    s_and_b32 s53, s28, s32
    v_subrev_f32 v13, s53, v8
    v_subrev_f32 v21, s53, v9
    v_subrev_f32 v29, s53, v10
    v_subrev_f32 v37, s53, v11
    s_lshl_b32 s52, s29, 16
    v_subrev_f32 v14, s52, v8
    v_subrev_f32 v22, s52, v9
    v_subrev_f32 v30, s52, v10
    v_subrev_f32 v38, s52, v11
    s_and_b32 s53, s29, s32
    v_subrev_f32 v15, s53, v8
    v_subrev_f32 v23, s53, v9
    v_subrev_f32 v31, s53, v10
    v_subrev_f32 v39, s53, v11
    s_lshl_b32 s52, s30, 16
    v_subrev_f32 v16, s52, v8
    v_subrev_f32 v24, s52, v9
    v_subrev_f32 v32, s52, v10
    v_subrev_f32 v40, s52, v11
    s_and_b32 s53, s30, s32
    v_subrev_f32 v17, s53, v8
    v_subrev_f32 v25, s53, v9
    v_subrev_f32 v33, s53, v10
    v_subrev_f32 v41, s53, v11
    s_lshl_b32 s52, s31, 16
    v_subrev_f32 v18, s52, v8
    v_subrev_f32 v26, s52, v9
    v_subrev_f32 v34, s52, v10
    v_subrev_f32 v42, s52, v11
    s_and_b32 s53, s31, s32
    v_subrev_f32 v19, s53, v8
    v_subrev_f32 v27, s53, v9
    v_subrev_f32 v35, s53, v10
    v_subrev_f32 v43, s53, v11
    v_cvt_pk_bf16_f32 v12, v12, v13
    v_cvt_pk_bf16_f32 v14, v14, v15
    v_cvt_pk_bf16_f32 v16, v16, v17
    v_cvt_pk_bf16_f32 v18, v18, v19
    v_cvt_pk_bf16_f32 v20, v20, v21
    v_cvt_pk_bf16_f32 v22, v22, v23
    v_cvt_pk_bf16_f32 v24, v24, v25
    v_cvt_pk_bf16_f32 v26, v26, v27
    v_cvt_pk_bf16_f32 v28, v28, v29
    v_cvt_pk_bf16_f32 v30, v30, v31
    v_cvt_pk_bf16_f32 v32, v32, v33
    v_cvt_pk_bf16_f32 v34, v34, v35
    v_cvt_pk_bf16_f32 v36, v36, v37
    v_cvt_pk_bf16_f32 v38, v38, v39
    v_cvt_pk_bf16_f32 v40, v40, v41
    v_cvt_pk_bf16_f32 v42, v42, v43
    v_and_b32 v13, s32, v12
    v_lshlrev_b32 v12, 16, v12
    v_and_b32 v15, s32, v14
    v_lshlrev_b32 v14, 16, v14
    v_and_b32 v17, s32, v16
    v_lshlrev_b32 v16, 16, v16
    v_and_b32 v19, s32, v18
    v_lshlrev_b32 v18, 16, v18
    v_and_b32 v21, s32, v20
    v_lshlrev_b32 v20, 16, v20
    v_and_b32 v23, s32, v22
    v_lshlrev_b32 v22, 16, v22
    v_and_b32 v25, s32, v24
    v_lshlrev_b32 v24, 16, v24
    v_and_b32 v27, s32, v26
    v_lshlrev_b32 v26, 16, v26
    v_and_b32 v29, s32, v28
    v_lshlrev_b32 v28, 16, v28
    v_and_b32 v31, s32, v30
    v_lshlrev_b32 v30, 16, v30
    v_and_b32 v33, s32, v32
    v_lshlrev_b32 v32, 16, v32
    v_and_b32 v35, s32, v34
    v_lshlrev_b32 v34, 16, v34
    v_and_b32 v37, s32, v36
    v_lshlrev_b32 v36, 16, v36
    v_and_b32 v39, s32, v38
    v_lshlrev_b32 v38, 16, v38
    v_and_b32 v41, s32, v40
    v_lshlrev_b32 v40, 16, v40
    v_and_b32 v43, s32, v42
    v_lshlrev_b32 v42, 16, v42
    v_mul_f32 v12, v12, v12
    v_mul_f32 v13, v13, v13
    v_mul_f32 v14, v14, v14
    v_mul_f32 v15, v15, v15
    v_mul_f32 v16, v16, v16
    v_mul_f32 v17, v17, v17
    v_mul_f32 v18, v18, v18
    v_mul_f32 v19, v19, v19
    v_mul_f32 v20, v20, v20
    v_mul_f32 v21, v21, v21
    v_mul_f32 v22, v22, v22
    v_mul_f32 v23, v23, v23
    v_mul_f32 v24, v24, v24
    v_mul_f32 v25, v25, v25
    v_mul_f32 v26, v26, v26
    v_mul_f32 v27, v27, v27
    v_mul_f32 v28, v28, v28
    v_mul_f32 v29, v29, v29
    v_mul_f32 v30, v30, v30
    v_mul_f32 v31, v31, v31
    v_mul_f32 v32, v32, v32
    v_mul_f32 v33, v33, v33
    v_mul_f32 v34, v34, v34
    v_mul_f32 v35, v35, v35
    v_mul_f32 v36, v36, v36
    v_mul_f32 v37, v37, v37
    v_mul_f32 v38, v38, v38
    v_mul_f32 v39, v39, v39
    v_mul_f32 v40, v40, v40
    v_mul_f32 v41, v41, v41
    v_mul_f32 v42, v42, v42
    v_mul_f32 v43, v43, v43
    v_cvt_pk_bf16_f32 v12, v12, v13
    v_cvt_pk_bf16_f32 v14, v14, v15
    v_cvt_pk_bf16_f32 v16, v16, v17
    v_cvt_pk_bf16_f32 v18, v18, v19
    v_cvt_pk_bf16_f32 v20, v20, v21
    v_cvt_pk_bf16_f32 v22, v22, v23
    v_cvt_pk_bf16_f32 v24, v24, v25
    v_cvt_pk_bf16_f32 v26, v26, v27
    v_cvt_pk_bf16_f32 v28, v28, v29
    v_cvt_pk_bf16_f32 v30, v30, v31
    v_cvt_pk_bf16_f32 v32, v32, v33
    v_cvt_pk_bf16_f32 v34, v34, v35
    v_cvt_pk_bf16_f32 v36, v36, v37
    v_cvt_pk_bf16_f32 v38, v38, v39
    v_cvt_pk_bf16_f32 v40, v40, v41
    v_cvt_pk_bf16_f32 v42, v42, v43
    v_and_b32 v13, s32, v12
    v_lshlrev_b32 v12, 16, v12
    v_and_b32 v15, s32, v14
    v_lshlrev_b32 v14, 16, v14
    v_and_b32 v17, s32, v16
    v_lshlrev_b32 v16, 16, v16
    v_and_b32 v19, s32, v18
    v_lshlrev_b32 v18, 16, v18
    v_and_b32 v21, s32, v20
    v_lshlrev_b32 v20, 16, v20
    v_and_b32 v23, s32, v22
    v_lshlrev_b32 v22, 16, v22
    v_and_b32 v25, s32, v24
    v_lshlrev_b32 v24, 16, v24
    v_and_b32 v27, s32, v26
    v_lshlrev_b32 v26, 16, v26
    v_and_b32 v29, s32, v28
    v_lshlrev_b32 v28, 16, v28
    v_and_b32 v31, s32, v30
    v_lshlrev_b32 v30, 16, v30
    v_and_b32 v33, s32, v32
    v_lshlrev_b32 v32, 16, v32
    v_and_b32 v35, s32, v34
    v_lshlrev_b32 v34, 16, v34
    v_and_b32 v37, s32, v36
    v_lshlrev_b32 v36, 16, v36
    v_and_b32 v39, s32, v38
    v_lshlrev_b32 v38, 16, v38
    v_and_b32 v41, s32, v40
    v_lshlrev_b32 v40, 16, v40
    v_and_b32 v43, s32, v42
    v_lshlrev_b32 v42, 16, v42
    v_mul_f32 v12, 0xc1200000, v12
    v_mul_f32 v13, 0xc1200000, v13
    v_mul_f32 v14, 0xc1200000, v14
    v_mul_f32 v15, 0xc1200000, v15
    v_mul_f32 v16, 0xc1200000, v16
    v_mul_f32 v17, 0xc1200000, v17
    v_mul_f32 v18, 0xc1200000, v18
    v_mul_f32 v19, 0xc1200000, v19
    v_mul_f32 v20, 0xc1200000, v20
    v_mul_f32 v21, 0xc1200000, v21
    v_mul_f32 v22, 0xc1200000, v22
    v_mul_f32 v23, 0xc1200000, v23
    v_mul_f32 v24, 0xc1200000, v24
    v_mul_f32 v25, 0xc1200000, v25
    v_mul_f32 v26, 0xc1200000, v26
    v_mul_f32 v27, 0xc1200000, v27
    v_mul_f32 v28, 0xc1200000, v28
    v_mul_f32 v29, 0xc1200000, v29
    v_mul_f32 v30, 0xc1200000, v30
    v_mul_f32 v31, 0xc1200000, v31
    v_mul_f32 v32, 0xc1200000, v32
    v_mul_f32 v33, 0xc1200000, v33
    v_mul_f32 v34, 0xc1200000, v34
    v_mul_f32 v35, 0xc1200000, v35
    v_mul_f32 v36, 0xc1200000, v36
    v_mul_f32 v37, 0xc1200000, v37
    v_mul_f32 v38, 0xc1200000, v38
    v_mul_f32 v39, 0xc1200000, v39
    v_mul_f32 v40, 0xc1200000, v40
    v_mul_f32 v41, 0xc1200000, v41
    v_mul_f32 v42, 0xc1200000, v42
    v_mul_f32 v43, 0xc1200000, v43
    v_cvt_pk_bf16_f32 v12, v12, v13
    v_cvt_pk_bf16_f32 v14, v14, v15
    v_cvt_pk_bf16_f32 v16, v16, v17
    v_cvt_pk_bf16_f32 v18, v18, v19
    v_cvt_pk_bf16_f32 v20, v20, v21
    v_cvt_pk_bf16_f32 v22, v22, v23
    v_cvt_pk_bf16_f32 v24, v24, v25
    v_cvt_pk_bf16_f32 v26, v26, v27
    v_cvt_pk_bf16_f32 v28, v28, v29
    v_cvt_pk_bf16_f32 v30, v30, v31
    v_cvt_pk_bf16_f32 v32, v32, v33
    v_cvt_pk_bf16_f32 v34, v34, v35
    v_cvt_pk_bf16_f32 v36, v36, v37
    v_cvt_pk_bf16_f32 v38, v38, v39
    v_cvt_pk_bf16_f32 v40, v40, v41
    v_cvt_pk_bf16_f32 v42, v42, v43
    v_and_b32 v13, s32, v12
    v_lshlrev_b32 v12, 16, v12
    v_and_b32 v15, s32, v14
    v_lshlrev_b32 v14, 16, v14
    v_and_b32 v17, s32, v16
    v_lshlrev_b32 v16, 16, v16
    v_and_b32 v19, s32, v18
    v_lshlrev_b32 v18, 16, v18
    v_and_b32 v21, s32, v20
    v_lshlrev_b32 v20, 16, v20
    v_and_b32 v23, s32, v22
    v_lshlrev_b32 v22, 16, v22
    v_and_b32 v25, s32, v24
    v_lshlrev_b32 v24, 16, v24
    v_and_b32 v27, s32, v26
    v_lshlrev_b32 v26, 16, v26
    v_and_b32 v29, s32, v28
    v_lshlrev_b32 v28, 16, v28
    v_and_b32 v31, s32, v30
    v_lshlrev_b32 v30, 16, v30
    v_and_b32 v33, s32, v32
    v_lshlrev_b32 v32, 16, v32
    v_and_b32 v35, s32, v34
    v_lshlrev_b32 v34, 16, v34
    v_and_b32 v37, s32, v36
    v_lshlrev_b32 v36, 16, v36
    v_and_b32 v39, s32, v38
    v_lshlrev_b32 v38, 16, v38
    v_and_b32 v41, s32, v40
    v_lshlrev_b32 v40, 16, v40
    v_and_b32 v43, s32, v42
    v_lshlrev_b32 v42, 16, v42
    v_mul_f32 v12, 0x3fb8aa3b, v12
    v_mul_f32 v13, 0x3fb8aa3b, v13
    v_mul_f32 v14, 0x3fb8aa3b, v14
    v_mul_f32 v15, 0x3fb8aa3b, v15
    v_mul_f32 v16, 0x3fb8aa3b, v16
    v_mul_f32 v17, 0x3fb8aa3b, v17
    v_mul_f32 v18, 0x3fb8aa3b, v18
    v_mul_f32 v19, 0x3fb8aa3b, v19
    v_mul_f32 v20, 0x3fb8aa3b, v20
    v_mul_f32 v21, 0x3fb8aa3b, v21
    v_mul_f32 v22, 0x3fb8aa3b, v22
    v_mul_f32 v23, 0x3fb8aa3b, v23
    v_mul_f32 v24, 0x3fb8aa3b, v24
    v_mul_f32 v25, 0x3fb8aa3b, v25
    v_mul_f32 v26, 0x3fb8aa3b, v26
    v_mul_f32 v27, 0x3fb8aa3b, v27
    v_mul_f32 v28, 0x3fb8aa3b, v28
    v_mul_f32 v29, 0x3fb8aa3b, v29
    v_mul_f32 v30, 0x3fb8aa3b, v30
    v_mul_f32 v31, 0x3fb8aa3b, v31
    v_mul_f32 v32, 0x3fb8aa3b, v32
    v_mul_f32 v33, 0x3fb8aa3b, v33
    v_mul_f32 v34, 0x3fb8aa3b, v34
    v_mul_f32 v35, 0x3fb8aa3b, v35
    v_mul_f32 v36, 0x3fb8aa3b, v36
    v_mul_f32 v37, 0x3fb8aa3b, v37
    v_mul_f32 v38, 0x3fb8aa3b, v38
    v_mul_f32 v39, 0x3fb8aa3b, v39
    v_mul_f32 v40, 0x3fb8aa3b, v40
    v_mul_f32 v41, 0x3fb8aa3b, v41
    v_mul_f32 v42, 0x3fb8aa3b, v42
    v_mul_f32 v43, 0x3fb8aa3b, v43
    v_exp_f32 v12, v12
    v_exp_f32 v13, v13
    v_exp_f32 v14, v14
    v_exp_f32 v15, v15
    v_exp_f32 v16, v16
    v_exp_f32 v17, v17
    v_exp_f32 v18, v18
    v_exp_f32 v19, v19
    v_exp_f32 v20, v20
    v_exp_f32 v21, v21
    v_exp_f32 v22, v22
    v_exp_f32 v23, v23
    v_exp_f32 v24, v24
    v_exp_f32 v25, v25
    v_exp_f32 v26, v26
    v_exp_f32 v27, v27
    v_exp_f32 v28, v28
    v_exp_f32 v29, v29
    v_exp_f32 v30, v30
    v_exp_f32 v31, v31
    v_exp_f32 v32, v32
    v_exp_f32 v33, v33
    v_exp_f32 v34, v34
    v_exp_f32 v35, v35
    v_exp_f32 v36, v36
    v_exp_f32 v37, v37
    v_exp_f32 v38, v38
    v_exp_f32 v39, v39
    v_exp_f32 v40, v40
    v_exp_f32 v41, v41
    v_exp_f32 v42, v42
    v_exp_f32 v43, v43
    s_nop 0
    v_cvt_pk_bf16_f32 v12, v12, v13
    v_cvt_pk_bf16_f32 v14, v14, v15
    v_cvt_pk_bf16_f32 v16, v16, v17
    v_cvt_pk_bf16_f32 v18, v18, v19
    v_cvt_pk_bf16_f32 v20, v20, v21
    v_cvt_pk_bf16_f32 v22, v22, v23
    v_cvt_pk_bf16_f32 v24, v24, v25
    v_cvt_pk_bf16_f32 v26, v26, v27
    v_cvt_pk_bf16_f32 v28, v28, v29
    v_cvt_pk_bf16_f32 v30, v30, v31
    v_cvt_pk_bf16_f32 v32, v32, v33
    v_cvt_pk_bf16_f32 v34, v34, v35
    v_cvt_pk_bf16_f32 v36, v36, v37
    v_cvt_pk_bf16_f32 v38, v38, v39
    v_cvt_pk_bf16_f32 v40, v40, v41
    v_cvt_pk_bf16_f32 v42, v42, v43
L_p1end_86:
    s_mov_b64 exec, -1
    s_cmp_eq_u32 s42, 2
    s_cbranch_scc1 L_part2_87
    s_waitcnt vmcnt(0) lgkmcnt(0)
    s_barrier
    s_cmp_lg_u32 s42, 0
    s_cbranch_scc1 L_nochk_93
    v_mov_b32 v116, 150024
    ds_read_b32 v117, v116
    s_waitcnt lgkmcnt(0)
    v_readfirstlane_b32 s3, v117
    s_nop 1
    s_cmp_lg_u32 s3, 0
    s_cbranch_scc1 L_p2slow_47
L_nochk_93:

    s_load_dwordx2 s[24:25], s[0:1], 88
    s_load_dwordx2 s[44:45], s[0:1], 96
    s_mov_b32 s26, 6400000
    s_mov_b32 s27, 0x20000
    s_movk_i32 s46, 256
    s_mov_b32 s47, 0x20000
    s_lshl_b32 s50, s36, 2
    v_and_b32 v116, 63, v0
    v_lshlrev_b32 v116, 20, v116

    s_add_u32 s20, s6, 6799360
    s_addc_u32 s21, s7, 0
    s_mov_b32 s22, 76800000
    s_mov_b32 s23, 0x20000
    v_readfirstlane_b32 s3, v0
    s_waitcnt lgkmcnt(0)
    s_cmp_eq_u32 s3, 960
    s_cbranch_scc1 L_sync_94
L_part2_87:
    v_cmp_gt_u32 vcc, 782, v0
    s_mov_b64 exec, vcc
    s_cbranch_execz L_p2end_88

    s_pack_ll_b32_b16 s52, s68, s70
    v_dot2_f32_bf16 v60, v12, s52, 0
    v_dot2_f32_bf16 v64, v20, s52, 0
    v_dot2_f32_bf16 v68, v28, s52, 0
    v_dot2_f32_bf16 v72, v36, s52, 0
    s_pack_hh_b32_b16 s53, s68, s70
    v_dot2_f32_bf16 v61, v12, s53, 0
    v_dot2_f32_bf16 v65, v20, s53, 0
    v_dot2_f32_bf16 v69, v28, s53, 0
    v_dot2_f32_bf16 v73, v36, s53, 0
    s_pack_ll_b32_b16 s52, s69, s71
    v_dot2_f32_bf16 v62, v12, s52, 0
    v_dot2_f32_bf16 v66, v20, s52, 0
    v_dot2_f32_bf16 v70, v28, s52, 0
    v_dot2_f32_bf16 v74, v36, s52, 0
    s_pack_hh_b32_b16 s53, s69, s71
    v_dot2_f32_bf16 v63, v12, s53, 0
    v_dot2_f32_bf16 v67, v20, s53, 0
    v_dot2_f32_bf16 v71, v28, s53, 0
    v_dot2_f32_bf16 v75, v36, s53, 0
    s_pack_ll_b32_b16 s52, s72, s74
    v_dot2_f32_bf16 v60, v14, s52, v60
    v_dot2_f32_bf16 v64, v22, s52, v64
    v_dot2_f32_bf16 v68, v30, s52, v68
    v_dot2_f32_bf16 v72, v38, s52, v72
    s_pack_hh_b32_b16 s53, s72, s74
    v_dot2_f32_bf16 v61, v14, s53, v61
    v_dot2_f32_bf16 v65, v22, s53, v65
    v_dot2_f32_bf16 v69, v30, s53, v69
    v_dot2_f32_bf16 v73, v38, s53, v73
    s_pack_ll_b32_b16 s52, s73, s75
    v_dot2_f32_bf16 v62, v14, s52, v62
    v_dot2_f32_bf16 v66, v22, s52, v66
    v_dot2_f32_bf16 v70, v30, s52, v70
    v_dot2_f32_bf16 v74, v38, s52, v74
    s_pack_hh_b32_b16 s53, s73, s75
    v_dot2_f32_bf16 v63, v14, s53, v63
    v_dot2_f32_bf16 v67, v22, s53, v67
    v_dot2_f32_bf16 v71, v30, s53, v71
    v_dot2_f32_bf16 v75, v38, s53, v75
    s_pack_ll_b32_b16 s52, s76, s78
    v_dot2_f32_bf16 v60, v16, s52, v60
    v_dot2_f32_bf16 v64, v24, s52, v64
    v_dot2_f32_bf16 v68, v32, s52, v68
    v_dot2_f32_bf16 v72, v40, s52, v72
    s_pack_hh_b32_b16 s53, s76, s78
    v_dot2_f32_bf16 v61, v16, s53, v61
    v_dot2_f32_bf16 v65, v24, s53, v65
    v_dot2_f32_bf16 v69, v32, s53, v69
    v_dot2_f32_bf16 v73, v40, s53, v73
    s_pack_ll_b32_b16 s52, s77, s79
    v_dot2_f32_bf16 v62, v16, s52, v62
    v_dot2_f32_bf16 v66, v24, s52, v66
    v_dot2_f32_bf16 v70, v32, s52, v70
    v_dot2_f32_bf16 v74, v40, s52, v74
    s_pack_hh_b32_b16 s53, s77, s79
    v_dot2_f32_bf16 v63, v16, s53, v63
    v_dot2_f32_bf16 v67, v24, s53, v67
    v_dot2_f32_bf16 v71, v32, s53, v71
    v_dot2_f32_bf16 v75, v40, s53, v75
    s_pack_ll_b32_b16 s52, s80, s82
    v_dot2_f32_bf16 v60, v18, s52, v60
    v_dot2_f32_bf16 v64, v26, s52, v64
    v_dot2_f32_bf16 v68, v34, s52, v68
    v_dot2_f32_bf16 v72, v42, s52, v72
    s_pack_hh_b32_b16 s53, s80, s82
    v_dot2_f32_bf16 v61, v18, s53, v61
    v_dot2_f32_bf16 v65, v26, s53, v65
    v_dot2_f32_bf16 v69, v34, s53, v69
    v_dot2_f32_bf16 v73, v42, s53, v73
    s_pack_ll_b32_b16 s52, s81, s83
    v_dot2_f32_bf16 v62, v18, s52, v62
    v_dot2_f32_bf16 v66, v26, s52, v66
    v_dot2_f32_bf16 v70, v34, s52, v70
    v_dot2_f32_bf16 v74, v42, s52, v74
    s_pack_hh_b32_b16 s53, s81, s83
    v_dot2_f32_bf16 v63, v18, s53, v63
    v_dot2_f32_bf16 v67, v26, s53, v67
    v_dot2_f32_bf16 v71, v34, s53, v71
    v_dot2_f32_bf16 v75, v42, s53, v75
    s_pack_ll_b32_b16 s52, s84, s86
    v_dot2_f32_bf16 v44, v12, s52, 0
    v_dot2_f32_bf16 v48, v20, s52, 0
    v_dot2_f32_bf16 v52, v28, s52, 0
    v_dot2_f32_bf16 v56, v36, s52, 0
    s_pack_hh_b32_b16 s53, s84, s86
    v_dot2_f32_bf16 v45, v12, s53, 0
    v_dot2_f32_bf16 v49, v20, s53, 0
    v_dot2_f32_bf16 v53, v28, s53, 0
    v_dot2_f32_bf16 v57, v36, s53, 0
    s_pack_ll_b32_b16 s52, s85, s87
    v_dot2_f32_bf16 v46, v12, s52, 0
    v_dot2_f32_bf16 v50, v20, s52, 0
    v_dot2_f32_bf16 v54, v28, s52, 0
    v_dot2_f32_bf16 v58, v36, s52, 0
    s_pack_hh_b32_b16 s53, s85, s87
    v_dot2_f32_bf16 v47, v12, s53, 0
    v_dot2_f32_bf16 v51, v20, s53, 0
    v_dot2_f32_bf16 v55, v28, s53, 0
    v_dot2_f32_bf16 v59, v36, s53, 0
    s_pack_ll_b32_b16 s52, s88, s90
    v_dot2_f32_bf16 v44, v14, s52, v44
    v_dot2_f32_bf16 v48, v22, s52, v48
    v_dot2_f32_bf16 v52, v30, s52, v52
    v_dot2_f32_bf16 v56, v38, s52, v56
    s_pack_hh_b32_b16 s53, s88, s90
    v_dot2_f32_bf16 v45, v14, s53, v45
    v_dot2_f32_bf16 v49, v22, s53, v49
    v_dot2_f32_bf16 v53, v30, s53, v53
    v_dot2_f32_bf16 v57, v38, s53, v57
    s_pack_ll_b32_b16 s52, s89, s91
    v_dot2_f32_bf16 v46, v14, s52, v46
    v_dot2_f32_bf16 v50, v22, s52, v50
    v_dot2_f32_bf16 v54, v30, s52, v54
    v_dot2_f32_bf16 v58, v38, s52, v58
    s_pack_hh_b32_b16 s53, s89, s91
    v_dot2_f32_bf16 v47, v14, s53, v47
    v_dot2_f32_bf16 v51, v22, s53, v51
    v_dot2_f32_bf16 v55, v30, s53, v55
    v_dot2_f32_bf16 v59, v38, s53, v59
    s_pack_ll_b32_b16 s52, s92, s94
    v_dot2_f32_bf16 v44, v16, s52, v44
    v_dot2_f32_bf16 v48, v24, s52, v48
    v_dot2_f32_bf16 v52, v32, s52, v52
    v_dot2_f32_bf16 v56, v40, s52, v56
    s_pack_hh_b32_b16 s53, s92, s94
    v_dot2_f32_bf16 v45, v16, s53, v45
    v_dot2_f32_bf16 v49, v24, s53, v49
    v_dot2_f32_bf16 v53, v32, s53, v53
    v_dot2_f32_bf16 v57, v40, s53, v57
    s_pack_ll_b32_b16 s52, s93, s95
    v_dot2_f32_bf16 v46, v16, s52, v46
    v_dot2_f32_bf16 v50, v24, s52, v50
    v_dot2_f32_bf16 v54, v32, s52, v54
    v_dot2_f32_bf16 v58, v40, s52, v58
    s_pack_hh_b32_b16 s53, s93, s95
    v_dot2_f32_bf16 v47, v16, s53, v47
    v_dot2_f32_bf16 v51, v24, s53, v51
    v_dot2_f32_bf16 v55, v32, s53, v55
    v_dot2_f32_bf16 v59, v40, s53, v59
    s_pack_ll_b32_b16 s52, s96, s98
    v_dot2_f32_bf16 v44, v18, s52, v44
    v_dot2_f32_bf16 v48, v26, s52, v48
    v_dot2_f32_bf16 v52, v34, s52, v52
    v_dot2_f32_bf16 v56, v42, s52, v56
    s_pack_hh_b32_b16 s53, s96, s98
    v_dot2_f32_bf16 v45, v18, s53, v45
    v_dot2_f32_bf16 v49, v26, s53, v49
    v_dot2_f32_bf16 v53, v34, s53, v53
    v_dot2_f32_bf16 v57, v42, s53, v57
    s_pack_ll_b32_b16 s52, s97, s99
    v_dot2_f32_bf16 v46, v18, s52, v46
    v_dot2_f32_bf16 v50, v26, s52, v50
    v_dot2_f32_bf16 v54, v34, s52, v54
    v_dot2_f32_bf16 v58, v42, s52, v58
    s_pack_hh_b32_b16 s53, s97, s99
    v_dot2_f32_bf16 v47, v18, s53, v47
    v_dot2_f32_bf16 v51, v26, s53, v51
    v_dot2_f32_bf16 v55, v34, s53, v55
    v_dot2_f32_bf16 v59, v42, s53, v59
    v_cvt_pk_bf16_f32 v60, v60, v61
    v_cvt_pk_bf16_f32 v62, v62, v63
    v_cvt_pk_bf16_f32 v64, v64, v65
    v_cvt_pk_bf16_f32 v66, v66, v67
    v_cvt_pk_bf16_f32 v68, v68, v69
    v_cvt_pk_bf16_f32 v70, v70, v71
    v_cvt_pk_bf16_f32 v72, v72, v73
    v_cvt_pk_bf16_f32 v74, v74, v75
    v_and_b32 v61, s32, v60
    v_lshlrev_b32 v60, 16, v60
    v_and_b32 v63, s32, v62
    v_lshlrev_b32 v62, 16, v62
    v_and_b32 v65, s32, v64
    v_lshlrev_b32 v64, 16, v64
    v_and_b32 v67, s32, v66
    v_lshlrev_b32 v66, 16, v66
    v_and_b32 v69, s32, v68
    v_lshlrev_b32 v68, 16, v68
    v_and_b32 v71, s32, v70
    v_lshlrev_b32 v70, 16, v70
    v_and_b32 v73, s32, v72
    v_lshlrev_b32 v72, 16, v72
    v_and_b32 v75, s32, v74
    v_lshlrev_b32 v74, 16, v74
L_p2end_88:
    s_mov_b64 exec, -1
    s_cmp_eq_u32 s42, 2
    s_cbranch_scc1 L_post_91
L_bcast_89:
    v_mov_b32 v118, 150016
    s_mov_b32 s42, 2
    s_waitcnt lgkmcnt(0)
    s_barrier
    ds_read_b32 v117, v118
    s_waitcnt lgkmcnt(0)
    v_readfirstlane_b32 s35, v117
    s_nop 1
    s_bitcmp1_b32 s35, 16
    s_cbranch_scc1 L_nextq_90
L_post_91:
    v_cmp_gt_u32 vcc, 782, v0
    s_mov_b64 exec, vcc
    s_cbranch_execz L_postend_92

    s_mov_b32 s3, 0
    buffer_load_dwordx4 v[76:79], v4, s[20:23], s3 offen sc1
    buffer_load_dwordx4 v[92:95], v5, s[20:23], s3 offen sc1
    s_mov_b32 s3, 6400000
    buffer_load_dwordx4 v[80:83], v4, s[20:23], s3 offen sc1
    buffer_load_dwordx4 v[96:99], v5, s[20:23], s3 offen sc1
    s_mov_b32 s3, 12800000
    buffer_load_dwordx4 v[84:87], v4, s[20:23], s3 offen sc1
    buffer_load_dwordx4 v[100:103], v5, s[20:23], s3 offen sc1
    s_mov_b32 s3, 19200000
    buffer_load_dwordx4 v[88:91], v4, s[20:23], s3 offen sc1
    buffer_load_dwordx4 v[104:107], v5, s[20:23], s3 offen sc1
    s_and_b32 s3, s35, 0xf0
    s_cbranch_scc1 L_fgen_98
    s_waitcnt vmcnt(0)

    v_add_u32 v76, v76, v80
    v_add_u32 v84, v84, v88
    v_add_u32 v77, v77, v81
    v_add_u32 v85, v85, v89
    v_add_u32 v78, v78, v82
    v_add_u32 v86, v86, v90
    v_add_u32 v79, v79, v83
    v_add_u32 v87, v87, v91
    v_add_u32_sdwa v12, v76, v84 dst_sel:DWORD dst_unused:UNUSED_PAD src0_sel:WORD_0 src1_sel:WORD_0
    v_add_u32_sdwa v13, v76, v84 dst_sel:DWORD dst_unused:UNUSED_PAD src0_sel:WORD_1 src1_sel:WORD_1
    v_add_u32_sdwa v14, v77, v85 dst_sel:DWORD dst_unused:UNUSED_PAD src0_sel:WORD_0 src1_sel:WORD_0
    v_add_u32_sdwa v15, v77, v85 dst_sel:DWORD dst_unused:UNUSED_PAD src0_sel:WORD_1 src1_sel:WORD_1
    v_add_u32_sdwa v16, v78, v86 dst_sel:DWORD dst_unused:UNUSED_PAD src0_sel:WORD_0 src1_sel:WORD_0
    v_add_u32_sdwa v17, v78, v86 dst_sel:DWORD dst_unused:UNUSED_PAD src0_sel:WORD_1 src1_sel:WORD_1
    v_add_u32_sdwa v18, v79, v87 dst_sel:DWORD dst_unused:UNUSED_PAD src0_sel:WORD_0 src1_sel:WORD_0
    v_add_u32_sdwa v19, v79, v87 dst_sel:DWORD dst_unused:UNUSED_PAD src0_sel:WORD_1 src1_sel:WORD_1
    v_add_u32 v92, v92, v96
    v_add_u32 v100, v100, v104
    v_add_u32 v93, v93, v97
    v_add_u32 v101, v101, v105
    v_add_u32 v94, v94, v98
    v_add_u32 v102, v102, v106
    v_add_u32 v95, v95, v99
    v_add_u32 v103, v103, v107
    v_add_u32_sdwa v20, v92, v100 dst_sel:DWORD dst_unused:UNUSED_PAD src0_sel:WORD_0 src1_sel:WORD_0
    v_add_u32_sdwa v21, v92, v100 dst_sel:DWORD dst_unused:UNUSED_PAD src0_sel:WORD_1 src1_sel:WORD_1
    v_add_u32_sdwa v22, v93, v101 dst_sel:DWORD dst_unused:UNUSED_PAD src0_sel:WORD_0 src1_sel:WORD_0
    v_add_u32_sdwa v23, v93, v101 dst_sel:DWORD dst_unused:UNUSED_PAD src0_sel:WORD_1 src1_sel:WORD_1
    v_add_u32_sdwa v24, v94, v102 dst_sel:DWORD dst_unused:UNUSED_PAD src0_sel:WORD_0 src1_sel:WORD_0
    v_add_u32_sdwa v25, v94, v102 dst_sel:DWORD dst_unused:UNUSED_PAD src0_sel:WORD_1 src1_sel:WORD_1
    v_add_u32_sdwa v26, v95, v103 dst_sel:DWORD dst_unused:UNUSED_PAD src0_sel:WORD_0 src1_sel:WORD_0
    v_add_u32_sdwa v27, v95, v103 dst_sel:DWORD dst_unused:UNUSED_PAD src0_sel:WORD_1 src1_sel:WORD_1
    v_add_u32 v12, 0xffff0000, v12
    v_add_u32 v13, 0xffff0000, v13
    v_add_u32 v14, 0xffff0000, v14
    v_add_u32 v15, 0xffff0000, v15
    v_add_u32 v16, 0xffff0000, v16
    v_add_u32 v17, 0xffff0000, v17
    v_add_u32 v18, 0xffff0000, v18
    v_add_u32 v19, 0xffff0000, v19
    v_add_u32 v20, 0xffff0000, v20
    v_add_u32 v21, 0xffff0000, v21
    v_add_u32 v22, 0xffff0000, v22
    v_add_u32 v23, 0xffff0000, v23
    v_add_u32 v24, 0xffff0000, v24
    v_add_u32 v25, 0xffff0000, v25
    v_add_u32 v26, 0xffff0000, v26
    v_add_u32 v27, 0xffff0000, v27
    v_cvt_f32_i32 v12, v12
    v_cvt_f32_i32 v13, v13
    v_cvt_f32_i32 v14, v14
    v_cvt_f32_i32 v15, v15
    v_cvt_f32_i32 v16, v16
    v_cvt_f32_i32 v17, v17
    v_cvt_f32_i32 v18, v18
    v_cvt_f32_i32 v19, v19
    v_cvt_f32_i32 v20, v20
    v_cvt_f32_i32 v21, v21
    v_cvt_f32_i32 v22, v22
    v_cvt_f32_i32 v23, v23
    v_cvt_f32_i32 v24, v24
    v_cvt_f32_i32 v25, v25
    v_cvt_f32_i32 v26, v26
    v_cvt_f32_i32 v27, v27
    v_mul_f32 v12, s34, v12
    v_mul_f32 v13, s34, v13
    v_mul_f32 v14, s34, v14
    v_mul_f32 v15, s34, v15
    v_mul_f32 v16, s34, v16
    v_mul_f32 v17, s34, v17
    v_mul_f32 v18, s34, v18
    v_mul_f32 v19, s34, v19
    v_mul_f32 v20, s34, v20
    v_mul_f32 v21, s34, v21
    v_mul_f32 v22, s34, v22
    v_mul_f32 v23, s34, v23
    v_mul_f32 v24, s34, v24
    v_mul_f32 v25, s34, v25
    v_mul_f32 v26, s34, v26
    v_mul_f32 v27, s34, v27
L_fbk_99:
    s_lshl_b32 s52, s12, 16
    v_mul_f32 v28, s52, v12
    v_mul_f32 v32, s52, v16
    v_mul_f32 v36, s52, v20
    v_mul_f32 v40, s52, v24
    s_and_b32 s53, s12, s32
    v_mul_f32 v29, s53, v12
    v_mul_f32 v33, s53, v16
    v_mul_f32 v37, s53, v20
    v_mul_f32 v41, s53, v24
    s_lshl_b32 s52, s13, 16
    v_mul_f32 v30, s52, v12
    v_mul_f32 v34, s52, v16
    v_mul_f32 v38, s52, v20
    v_mul_f32 v42, s52, v24
    s_and_b32 s53, s13, s32
    v_mul_f32 v31, s53, v12
    v_mul_f32 v35, s53, v16
    v_mul_f32 v39, s53, v20
    v_mul_f32 v43, s53, v24
    s_lshl_b32 s52, s14, 16
    v_fmac_f32 v28, s52, v13
    v_fmac_f32 v32, s52, v17
    v_fmac_f32 v36, s52, v21
    v_fmac_f32 v40, s52, v25
    s_and_b32 s53, s14, s32
    v_fmac_f32 v29, s53, v13
    v_fmac_f32 v33, s53, v17
    v_fmac_f32 v37, s53, v21
    v_fmac_f32 v41, s53, v25
    s_lshl_b32 s52, s15, 16
    v_fmac_f32 v30, s52, v13
    v_fmac_f32 v34, s52, v17
    v_fmac_f32 v38, s52, v21
    v_fmac_f32 v42, s52, v25
    s_and_b32 s53, s15, s32
    v_fmac_f32 v31, s53, v13
    v_fmac_f32 v35, s53, v17
    v_fmac_f32 v39, s53, v21
    v_fmac_f32 v43, s53, v25
    s_lshl_b32 s52, s16, 16
    v_fmac_f32 v28, s52, v14
    v_fmac_f32 v32, s52, v18
    v_fmac_f32 v36, s52, v22
    v_fmac_f32 v40, s52, v26
    s_and_b32 s53, s16, s32
    v_fmac_f32 v29, s53, v14
    v_fmac_f32 v33, s53, v18
    v_fmac_f32 v37, s53, v22
    v_fmac_f32 v41, s53, v26
    s_lshl_b32 s52, s17, 16
    v_fmac_f32 v30, s52, v14
    v_fmac_f32 v34, s52, v18
    v_fmac_f32 v38, s52, v22
    v_fmac_f32 v42, s52, v26
    s_and_b32 s53, s17, s32
    v_fmac_f32 v31, s53, v14
    v_fmac_f32 v35, s53, v18
    v_fmac_f32 v39, s53, v22
    v_fmac_f32 v43, s53, v26
    s_lshl_b32 s52, s18, 16
    v_fmac_f32 v28, s52, v15
    v_fmac_f32 v32, s52, v19
    v_fmac_f32 v36, s52, v23
    v_fmac_f32 v40, s52, v27
    s_and_b32 s53, s18, s32
    v_fmac_f32 v29, s53, v15
    v_fmac_f32 v33, s53, v19
    v_fmac_f32 v37, s53, v23
    v_fmac_f32 v41, s53, v27
    s_lshl_b32 s52, s19, 16
    v_fmac_f32 v30, s52, v15
    v_fmac_f32 v34, s52, v19
    v_fmac_f32 v38, s52, v23
    v_fmac_f32 v42, s52, v27
    s_and_b32 s53, s19, s32
    v_fmac_f32 v31, s53, v15
    v_fmac_f32 v35, s53, v19
    v_fmac_f32 v39, s53, v23
    v_fmac_f32 v43, s53, v27
    v_mul_f32 v28, v28, v44
    v_mul_f32 v29, v29, v45
    v_mul_f32 v30, v30, v46
    v_mul_f32 v31, v31, v47
    v_mul_f32 v32, v32, v48
    v_mul_f32 v33, v33, v49
    v_mul_f32 v34, v34, v50
    v_mul_f32 v35, v35, v51
    v_mul_f32 v36, v36, v52
    v_mul_f32 v37, v37, v53
    v_mul_f32 v38, v38, v54
    v_mul_f32 v39, v39, v55
    v_mul_f32 v40, v40, v56
    v_mul_f32 v41, v41, v57
    v_mul_f32 v42, v42, v58
    v_mul_f32 v43, v43, v59
    v_cvt_pk_bf16_f32 v28, v28, v29
    v_cvt_pk_bf16_f32 v30, v30, v31
    v_cvt_pk_bf16_f32 v32, v32, v33
    v_cvt_pk_bf16_f32 v34, v34, v35
    v_cvt_pk_bf16_f32 v36, v36, v37
    v_cvt_pk_bf16_f32 v38, v38, v39
    v_cvt_pk_bf16_f32 v40, v40, v41
    v_cvt_pk_bf16_f32 v42, v42, v43
    s_pack_ll_b32_b16 s52, s56, s58
    v_dot2_f32_bf16 v12, v28, s52, 0
    v_dot2_f32_bf16 v16, v32, s52, 0
    v_dot2_f32_bf16 v20, v36, s52, 0
    v_dot2_f32_bf16 v24, v40, s52, 0
    s_pack_hh_b32_b16 s53, s56, s58
    v_dot2_f32_bf16 v13, v28, s53, 0
    v_dot2_f32_bf16 v17, v32, s53, 0
    v_dot2_f32_bf16 v21, v36, s53, 0
    v_dot2_f32_bf16 v25, v40, s53, 0
    s_pack_ll_b32_b16 s52, s57, s59
    v_dot2_f32_bf16 v14, v28, s52, 0
    v_dot2_f32_bf16 v18, v32, s52, 0
    v_dot2_f32_bf16 v22, v36, s52, 0
    v_dot2_f32_bf16 v26, v40, s52, 0
    s_pack_hh_b32_b16 s53, s57, s59
    v_dot2_f32_bf16 v15, v28, s53, 0
    v_dot2_f32_bf16 v19, v32, s53, 0
    v_dot2_f32_bf16 v23, v36, s53, 0
    v_dot2_f32_bf16 v27, v40, s53, 0
    s_pack_ll_b32_b16 s52, s60, s62
    v_dot2_f32_bf16 v12, v30, s52, v12
    v_dot2_f32_bf16 v16, v34, s52, v16
    v_dot2_f32_bf16 v20, v38, s52, v20
    v_dot2_f32_bf16 v24, v42, s52, v24
    s_pack_hh_b32_b16 s53, s60, s62
    v_dot2_f32_bf16 v13, v30, s53, v13
    v_dot2_f32_bf16 v17, v34, s53, v17
    v_dot2_f32_bf16 v21, v38, s53, v21
    v_dot2_f32_bf16 v25, v42, s53, v25
    s_pack_ll_b32_b16 s52, s61, s63
    v_dot2_f32_bf16 v14, v30, s52, v14
    v_dot2_f32_bf16 v18, v34, s52, v18
    v_dot2_f32_bf16 v22, v38, s52, v22
    v_dot2_f32_bf16 v26, v42, s52, v26
    s_pack_hh_b32_b16 s53, s61, s63
    v_dot2_f32_bf16 v15, v30, s53, v15
    v_dot2_f32_bf16 v19, v34, s53, v19
    v_dot2_f32_bf16 v23, v38, s53, v23
    v_dot2_f32_bf16 v27, v42, s53, v27
    v_lshlrev_b32 v44, 16, v108
    v_and_b32 v45, s32, v108
    v_lshlrev_b32 v46, 16, v109
    v_and_b32 v47, s32, v109
    v_lshlrev_b32 v48, 16, v110
    v_and_b32 v49, s32, v110
    v_lshlrev_b32 v50, 16, v111
    v_and_b32 v51, s32, v111
    v_lshlrev_b32 v52, 16, v112
    v_and_b32 v53, s32, v112
    v_lshlrev_b32 v54, 16, v113
    v_and_b32 v55, s32, v113
    v_lshlrev_b32 v56, 16, v114
    v_and_b32 v57, s32, v114
    v_lshlrev_b32 v58, 16, v115
    v_and_b32 v59, s32, v115
    v_cvt_pk_bf16_f32 v12, v12, v13
    v_cvt_pk_bf16_f32 v14, v14, v15
    v_cvt_pk_bf16_f32 v16, v16, v17
    v_cvt_pk_bf16_f32 v18, v18, v19
    v_cvt_pk_bf16_f32 v20, v20, v21
    v_cvt_pk_bf16_f32 v22, v22, v23
    v_cvt_pk_bf16_f32 v24, v24, v25
    v_cvt_pk_bf16_f32 v26, v26, v27
    v_and_b32 v13, s32, v12
    v_lshlrev_b32 v12, 16, v12
    v_and_b32 v15, s32, v14
    v_lshlrev_b32 v14, 16, v14
    v_and_b32 v17, s32, v16
    v_lshlrev_b32 v16, 16, v16
    v_and_b32 v19, s32, v18
    v_lshlrev_b32 v18, 16, v18
    v_and_b32 v21, s32, v20
    v_lshlrev_b32 v20, 16, v20
    v_and_b32 v23, s32, v22
    v_lshlrev_b32 v22, 16, v22
    v_and_b32 v25, s32, v24
    v_lshlrev_b32 v24, 16, v24
    v_and_b32 v27, s32, v26
    v_lshlrev_b32 v26, 16, v26
    v_mul_f32 v12, v12, v60
    v_mul_f32 v13, v13, v61
    v_mul_f32 v14, v14, v62
    v_mul_f32 v15, v15, v63
    v_mul_f32 v16, v16, v64
    v_mul_f32 v17, v17, v65
    v_mul_f32 v18, v18, v66
    v_mul_f32 v19, v19, v67
    v_mul_f32 v20, v20, v68
    v_mul_f32 v21, v21, v69
    v_mul_f32 v22, v22, v70
    v_mul_f32 v23, v23, v71
    v_mul_f32 v24, v24, v72
    v_mul_f32 v25, v25, v73
    v_mul_f32 v26, v26, v74
    v_mul_f32 v27, v27, v75
    v_cvt_pk_bf16_f32 v12, v12, v13
    v_cvt_pk_bf16_f32 v14, v14, v15
    v_cvt_pk_bf16_f32 v16, v16, v17
    v_cvt_pk_bf16_f32 v18, v18, v19
    v_cvt_pk_bf16_f32 v20, v20, v21
    v_cvt_pk_bf16_f32 v22, v22, v23
    v_cvt_pk_bf16_f32 v24, v24, v25
    v_cvt_pk_bf16_f32 v26, v26, v27
    v_and_b32 v13, s32, v12
    v_lshlrev_b32 v12, 16, v12
    v_and_b32 v15, s32, v14
    v_lshlrev_b32 v14, 16, v14
    v_and_b32 v17, s32, v16
    v_lshlrev_b32 v16, 16, v16
    v_and_b32 v19, s32, v18
    v_lshlrev_b32 v18, 16, v18
    v_and_b32 v21, s32, v20
    v_lshlrev_b32 v20, 16, v20
    v_and_b32 v23, s32, v22
    v_lshlrev_b32 v22, 16, v22
    v_and_b32 v25, s32, v24
    v_lshlrev_b32 v24, 16, v24
    v_and_b32 v27, s32, v26
    v_lshlrev_b32 v26, 16, v26
    v_add_f32 v12, v12, v44
    v_add_f32 v13, v13, v45
    v_add_f32 v14, v14, v46
    v_add_f32 v15, v15, v47
    v_add_f32 v16, v16, v48
    v_add_f32 v17, v17, v49
    v_add_f32 v18, v18, v50
    v_add_f32 v19, v19, v51
    v_add_f32 v20, v20, v52
    v_add_f32 v21, v21, v53
    v_add_f32 v22, v22, v54
    v_add_f32 v23, v23, v55
    v_add_f32 v24, v24, v56
    v_add_f32 v25, v25, v57
    v_add_f32 v26, v26, v58
    v_add_f32 v27, v27, v59
    v_cvt_pk_bf16_f32 v28, v12, v13
    v_cvt_pk_bf16_f32 v29, v14, v15
    v_cvt_pk_bf16_f32 v30, v16, v17
    v_cvt_pk_bf16_f32 v31, v18, v19
    v_cvt_pk_bf16_f32 v32, v20, v21
    v_cvt_pk_bf16_f32 v33, v22, v23
    v_cvt_pk_bf16_f32 v34, v24, v25
    v_cvt_pk_bf16_f32 v35, v26, v27
    buffer_store_dwordx4 v[28:31], v4, s[24:27], 0 offen
    buffer_store_dwordx4 v[32:35], v5, s[24:27], 0 offen
L_postend_92:
    s_mov_b64 exec, -1
L_nextq_90:
    s_bfe_u32 s3, s35, 0x40008
    s_cbranch_scc0 L_fend_108
    s_ff1_i32_b32 s41, s3
    s_add_u32 s3, s41, 8
    s_bitset0_b32 s35, s3
    s_branch L_qloop_85
L_fend_108:

L_p2done_46:
    s_endpgm

L_ufix_48:
    v_and_b32 v117, 63, v0
    v_lshlrev_b32 v117, 2, v117
    s_sub_i32 s54, s42, 1024
    v_cmp_le_i32 vcc, s54, v117
    s_mov_b64 exec, vcc
    v_mov_b32 v12, 0
    v_mov_b32 v44, 0
    s_mov_b64 exec, -1
    s_sub_i32 s54, s42, 1025
    v_cmp_le_i32 vcc, s54, v117
    s_mov_b64 exec, vcc
    v_mov_b32 v13, 0
    v_mov_b32 v46, 0
    s_mov_b64 exec, -1
    s_sub_i32 s54, s42, 1026
    v_cmp_le_i32 vcc, s54, v117
    s_mov_b64 exec, vcc
    v_mov_b32 v14, 0
    v_mov_b32 v48, 0
    s_mov_b64 exec, -1
    s_sub_i32 s54, s42, 1027
    v_cmp_le_i32 vcc, s54, v117
    s_mov_b64 exec, vcc
    v_mov_b32 v15, 0
    v_mov_b32 v50, 0
    s_mov_b64 exec, -1
    s_branch L_uback_49
L_ufix_50:
    v_and_b32 v117, 63, v0
    v_lshlrev_b32 v117, 2, v117
    s_sub_i32 s54, s42, 1536
    v_cmp_le_i32 vcc, s54, v117
    s_mov_b64 exec, vcc
    v_mov_b32 v16, 0
    v_mov_b32 v52, 0
    s_mov_b64 exec, -1
    s_sub_i32 s54, s42, 1537
    v_cmp_le_i32 vcc, s54, v117
    s_mov_b64 exec, vcc
    v_mov_b32 v17, 0
    v_mov_b32 v54, 0
    s_mov_b64 exec, -1
    s_sub_i32 s54, s42, 1538
    v_cmp_le_i32 vcc, s54, v117
    s_mov_b64 exec, vcc
    v_mov_b32 v18, 0
    v_mov_b32 v56, 0
    s_mov_b64 exec, -1
    s_sub_i32 s54, s42, 1539
    v_cmp_le_i32 vcc, s54, v117
    s_mov_b64 exec, vcc
    v_mov_b32 v19, 0
    v_mov_b32 v58, 0
    s_mov_b64 exec, -1
    s_branch L_uback_51
L_ufix_52:
    v_and_b32 v117, 63, v0
    v_lshlrev_b32 v117, 2, v117
    s_sub_i32 s54, s42, 2048
    v_cmp_le_i32 vcc, s54, v117
    s_mov_b64 exec, vcc
    v_mov_b32 v20, 0
    v_mov_b32 v60, 0
    s_mov_b64 exec, -1
    s_sub_i32 s54, s42, 2049
    v_cmp_le_i32 vcc, s54, v117
    s_mov_b64 exec, vcc
    v_mov_b32 v21, 0
    v_mov_b32 v62, 0
    s_mov_b64 exec, -1
    s_sub_i32 s54, s42, 2050
    v_cmp_le_i32 vcc, s54, v117
    s_mov_b64 exec, vcc
    v_mov_b32 v22, 0
    v_mov_b32 v64, 0
    s_mov_b64 exec, -1
    s_sub_i32 s54, s42, 2051
    v_cmp_le_i32 vcc, s54, v117
    s_mov_b64 exec, vcc
    v_mov_b32 v23, 0
    v_mov_b32 v66, 0
    s_mov_b64 exec, -1
    s_branch L_uback_53
L_ufix_54:
    v_and_b32 v117, 63, v0
    v_lshlrev_b32 v117, 2, v117
    s_sub_i32 s54, s42, 2560
    v_cmp_le_i32 vcc, s54, v117
    s_mov_b64 exec, vcc
    v_mov_b32 v24, 0
    v_mov_b32 v68, 0
    s_mov_b64 exec, -1
    s_sub_i32 s54, s42, 2561
    v_cmp_le_i32 vcc, s54, v117
    s_mov_b64 exec, vcc
    v_mov_b32 v25, 0
    v_mov_b32 v70, 0
    s_mov_b64 exec, -1
    s_sub_i32 s54, s42, 2562
    v_cmp_le_i32 vcc, s54, v117
    s_mov_b64 exec, vcc
    v_mov_b32 v26, 0
    v_mov_b32 v72, 0
    s_mov_b64 exec, -1
    s_sub_i32 s54, s42, 2563
    v_cmp_le_i32 vcc, s54, v117
    s_mov_b64 exec, vcc
    v_mov_b32 v27, 0
    v_mov_b32 v74, 0
    s_mov_b64 exec, -1
    s_branch L_uback_55
L_ufix_56:
    v_and_b32 v117, 63, v0
    v_lshlrev_b32 v117, 2, v117
    s_sub_i32 s54, s42, 0
    v_cmp_le_i32 vcc, s54, v117
    s_mov_b64 exec, vcc
    v_mov_b32 v4, 0
    v_mov_b32 v28, 0
    s_mov_b64 exec, -1
    s_sub_i32 s54, s42, 1
    v_cmp_le_i32 vcc, s54, v117
    s_mov_b64 exec, vcc
    v_mov_b32 v5, 0
    v_mov_b32 v30, 0
    s_mov_b64 exec, -1
    s_sub_i32 s54, s42, 2
    v_cmp_le_i32 vcc, s54, v117
    s_mov_b64 exec, vcc
    v_mov_b32 v6, 0
    v_mov_b32 v32, 0
    s_mov_b64 exec, -1
    s_sub_i32 s54, s42, 3
    v_cmp_le_i32 vcc, s54, v117
    s_mov_b64 exec, vcc
    v_mov_b32 v7, 0
    v_mov_b32 v34, 0
    s_mov_b64 exec, -1
    s_branch L_uback_57
L_ufix_58:
    v_and_b32 v117, 63, v0
    v_lshlrev_b32 v117, 2, v117
    s_sub_i32 s54, s42, 512
    v_cmp_le_i32 vcc, s54, v117
    s_mov_b64 exec, vcc
    v_mov_b32 v8, 0
    v_mov_b32 v36, 0
    s_mov_b64 exec, -1
    s_sub_i32 s54, s42, 513
    v_cmp_le_i32 vcc, s54, v117
    s_mov_b64 exec, vcc
    v_mov_b32 v9, 0
    v_mov_b32 v38, 0
    s_mov_b64 exec, -1
    s_sub_i32 s54, s42, 514
    v_cmp_le_i32 vcc, s54, v117
    s_mov_b64 exec, vcc
    v_mov_b32 v10, 0
    v_mov_b32 v40, 0
    s_mov_b64 exec, -1
    s_sub_i32 s54, s42, 515
    v_cmp_le_i32 vcc, s54, v117
    s_mov_b64 exec, vcc
    v_mov_b32 v11, 0
    v_mov_b32 v42, 0
    s_mov_b64 exec, -1
    s_branch L_uback_59
L_ufix_65:
    v_and_b32 v117, 63, v0
    v_lshlrev_b32 v117, 2, v117
    s_sub_i32 s54, s42, 3072
    v_cmp_le_i32 vcc, s54, v117
    s_mov_b64 exec, vcc
    v_mov_b32 v106, 0
    v_mov_b32 v120, 0
    s_mov_b64 exec, -1
    s_sub_i32 s54, s42, 3073
    v_cmp_le_i32 vcc, s54, v117
    s_mov_b64 exec, vcc
    v_mov_b32 v107, 0
    v_mov_b32 v122, 0
    s_mov_b64 exec, -1
    s_sub_i32 s54, s42, 3074
    v_cmp_le_i32 vcc, s54, v117
    s_mov_b64 exec, vcc
    v_mov_b32 v108, 0
    v_mov_b32 v124, 0
    s_mov_b64 exec, -1
    s_sub_i32 s54, s42, 3075
    v_cmp_le_i32 vcc, s54, v117
    s_mov_b64 exec, vcc
    v_mov_b32 v109, 0
    v_mov_b32 v126, 0
    s_mov_b64 exec, -1
    s_branch L_uback_66
L_ufix_69:
    v_and_b32 v117, 63, v0
    v_lshlrev_b32 v117, 2, v117
    s_sub_i32 s54, s42, 1024
    v_cmp_le_i32 vcc, s54, v117
    s_mov_b64 exec, vcc
    v_mov_b32 v12, 0
    v_mov_b32 v44, 0
    s_mov_b64 exec, -1
    s_sub_i32 s54, s42, 1025
    v_cmp_le_i32 vcc, s54, v117
    s_mov_b64 exec, vcc
    v_mov_b32 v13, 0
    v_mov_b32 v46, 0
    s_mov_b64 exec, -1
    s_sub_i32 s54, s42, 1026
    v_cmp_le_i32 vcc, s54, v117
    s_mov_b64 exec, vcc
    v_mov_b32 v14, 0
    v_mov_b32 v48, 0
    s_mov_b64 exec, -1
    s_sub_i32 s54, s42, 1027
    v_cmp_le_i32 vcc, s54, v117
    s_mov_b64 exec, vcc
    v_mov_b32 v15, 0
    v_mov_b32 v50, 0
    s_mov_b64 exec, -1
    s_branch L_uback_70
L_ufix_71:
    v_and_b32 v117, 63, v0
    v_lshlrev_b32 v117, 2, v117
    s_sub_i32 s54, s42, 1536
    v_cmp_le_i32 vcc, s54, v117
    s_mov_b64 exec, vcc
    v_mov_b32 v16, 0
    v_mov_b32 v52, 0
    s_mov_b64 exec, -1
    s_sub_i32 s54, s42, 1537
    v_cmp_le_i32 vcc, s54, v117
    s_mov_b64 exec, vcc
    v_mov_b32 v17, 0
    v_mov_b32 v54, 0
    s_mov_b64 exec, -1
    s_sub_i32 s54, s42, 1538
    v_cmp_le_i32 vcc, s54, v117
    s_mov_b64 exec, vcc
    v_mov_b32 v18, 0
    v_mov_b32 v56, 0
    s_mov_b64 exec, -1
    s_sub_i32 s54, s42, 1539
    v_cmp_le_i32 vcc, s54, v117
    s_mov_b64 exec, vcc
    v_mov_b32 v19, 0
    v_mov_b32 v58, 0
    s_mov_b64 exec, -1
    s_branch L_uback_72
L_ufix_73:
    v_and_b32 v117, 63, v0
    v_lshlrev_b32 v117, 2, v117
    s_sub_i32 s54, s42, 2048
    v_cmp_le_i32 vcc, s54, v117
    s_mov_b64 exec, vcc
    v_mov_b32 v20, 0
    v_mov_b32 v60, 0
    s_mov_b64 exec, -1
    s_sub_i32 s54, s42, 2049
    v_cmp_le_i32 vcc, s54, v117
    s_mov_b64 exec, vcc
    v_mov_b32 v21, 0
    v_mov_b32 v62, 0
    s_mov_b64 exec, -1
    s_sub_i32 s54, s42, 2050
    v_cmp_le_i32 vcc, s54, v117
    s_mov_b64 exec, vcc
    v_mov_b32 v22, 0
    v_mov_b32 v64, 0
    s_mov_b64 exec, -1
    s_sub_i32 s54, s42, 2051
    v_cmp_le_i32 vcc, s54, v117
    s_mov_b64 exec, vcc
    v_mov_b32 v23, 0
    v_mov_b32 v66, 0
    s_mov_b64 exec, -1
    s_branch L_uback_74
L_ufix_75:
    v_and_b32 v117, 63, v0
    v_lshlrev_b32 v117, 2, v117
    s_sub_i32 s54, s42, 2560
    v_cmp_le_i32 vcc, s54, v117
    s_mov_b64 exec, vcc
    v_mov_b32 v24, 0
    v_mov_b32 v68, 0
    s_mov_b64 exec, -1
    s_sub_i32 s54, s42, 2561
    v_cmp_le_i32 vcc, s54, v117
    s_mov_b64 exec, vcc
    v_mov_b32 v25, 0
    v_mov_b32 v70, 0
    s_mov_b64 exec, -1
    s_sub_i32 s54, s42, 2562
    v_cmp_le_i32 vcc, s54, v117
    s_mov_b64 exec, vcc
    v_mov_b32 v26, 0
    v_mov_b32 v72, 0
    s_mov_b64 exec, -1
    s_sub_i32 s54, s42, 2563
    v_cmp_le_i32 vcc, s54, v117
    s_mov_b64 exec, vcc
    v_mov_b32 v27, 0
    v_mov_b32 v74, 0
    s_mov_b64 exec, -1
    s_branch L_uback_76
L_ufix_77:
    v_and_b32 v117, 63, v0
    v_lshlrev_b32 v117, 2, v117
    s_sub_i32 s54, s42, 0
    v_cmp_le_i32 vcc, s54, v117
    s_mov_b64 exec, vcc
    v_mov_b32 v4, 0
    v_mov_b32 v28, 0
    s_mov_b64 exec, -1
    s_sub_i32 s54, s42, 1
    v_cmp_le_i32 vcc, s54, v117
    s_mov_b64 exec, vcc
    v_mov_b32 v5, 0
    v_mov_b32 v30, 0
    s_mov_b64 exec, -1
    s_sub_i32 s54, s42, 2
    v_cmp_le_i32 vcc, s54, v117
    s_mov_b64 exec, vcc
    v_mov_b32 v6, 0
    v_mov_b32 v32, 0
    s_mov_b64 exec, -1
    s_sub_i32 s54, s42, 3
    v_cmp_le_i32 vcc, s54, v117
    s_mov_b64 exec, vcc
    v_mov_b32 v7, 0
    v_mov_b32 v34, 0
    s_mov_b64 exec, -1
    s_branch L_uback_78
L_ufix_79:
    v_and_b32 v117, 63, v0
    v_lshlrev_b32 v117, 2, v117
    s_sub_i32 s54, s42, 512
    v_cmp_le_i32 vcc, s54, v117
    s_mov_b64 exec, vcc
    v_mov_b32 v8, 0
    v_mov_b32 v36, 0
    s_mov_b64 exec, -1
    s_sub_i32 s54, s42, 513
    v_cmp_le_i32 vcc, s54, v117
    s_mov_b64 exec, vcc
    v_mov_b32 v9, 0
    v_mov_b32 v38, 0
    s_mov_b64 exec, -1
    s_sub_i32 s54, s42, 514
    v_cmp_le_i32 vcc, s54, v117
    s_mov_b64 exec, vcc
    v_mov_b32 v10, 0
    v_mov_b32 v40, 0
    s_mov_b64 exec, -1
    s_sub_i32 s54, s42, 515
    v_cmp_le_i32 vcc, s54, v117
    s_mov_b64 exec, vcc
    v_mov_b32 v11, 0
    v_mov_b32 v42, 0
    s_mov_b64 exec, -1
    s_branch L_uback_80
L_sync_94:
    v_mov_b32 v117, s33
    buffer_atomic_add v117, v116, s[44:47], s50 offen sc0
    s_waitcnt vmcnt(0)
    v_readfirstlane_b32 s4, v117
    s_movk_i32 s5, 400
    s_nop 0
    s_add_u32 s4, s4, s33
    s_bitcmp1_b32 s4, 2
    s_cbranch_scc1 L_tell_97
L_poll_95:
    s_sub_u32 s5, s5, 1
    s_cbranch_scc1 L_gave_96
    v_mov_b32 v117, 0
    buffer_atomic_add v117, v116, s[44:47], s50 offen sc0
    s_waitcnt vmcnt(0)
    v_readfirstlane_b32 s4, v117
    s_nop 1
    s_and_b32 s4, s4, 0xff
    s_bitcmp0_b32 s4, 2
    s_cbranch_scc1 L_poll_95
    s_branch L_tell_97
L_gave_96:
    s_lshl_b32 s4, 0x100, s37
    v_mov_b32 v117, s4
    buffer_atomic_or v117, v116, s[44:47], s50 offen sc0
    s_waitcnt vmcnt(0)
    v_readfirstlane_b32 s4, v117
    s_nop 1
    s_and_b32 s4, s4, 0xff
    s_bitcmp1_b32 s4, 2
    s_cselect_b32 s4, s4, 0x10000
L_tell_97:
    v_mov_b32 v117, s4
    v_mov_b32 v118, 150016
    ds_write_b32 v118, v117
    s_branch L_bcast_89

L_fgen_98:
    s_waitcnt vmcnt(0)
    v_lshlrev_b32 v6, 1, v4
    v_lshlrev_b32 v7, 1, v5
    v_mov_b32 v12, 0
    v_mov_b32 v13, 0
    v_mov_b32 v14, 0
    v_mov_b32 v15, 0
    v_mov_b32 v16, 0
    v_mov_b32 v17, 0
    v_mov_b32 v18, 0
    v_mov_b32 v19, 0
    v_mov_b32 v20, 0
    v_mov_b32 v21, 0
    v_mov_b32 v22, 0
    v_mov_b32 v23, 0
    v_mov_b32 v24, 0
    v_mov_b32 v25, 0
    v_mov_b32 v26, 0
    v_mov_b32 v27, 0
    s_bitcmp1_b32 s35, 4
    s_cbranch_scc1 L_ffl_100
    v_cvt_f32_u32_sdwa v28, v76 dst_sel:DWORD dst_unused:UNUSED_PAD src0_sel:WORD_0
    v_cvt_f32_u32_sdwa v29, v76 dst_sel:DWORD dst_unused:UNUSED_PAD src0_sel:WORD_1
    v_cvt_f32_u32_sdwa v30, v77 dst_sel:DWORD dst_unused:UNUSED_PAD src0_sel:WORD_0
    v_cvt_f32_u32_sdwa v31, v77 dst_sel:DWORD dst_unused:UNUSED_PAD src0_sel:WORD_1
    v_cvt_f32_u32_sdwa v32, v78 dst_sel:DWORD dst_unused:UNUSED_PAD src0_sel:WORD_0
    v_cvt_f32_u32_sdwa v33, v78 dst_sel:DWORD dst_unused:UNUSED_PAD src0_sel:WORD_1
    v_cvt_f32_u32_sdwa v34, v79 dst_sel:DWORD dst_unused:UNUSED_PAD src0_sel:WORD_0
    v_cvt_f32_u32_sdwa v35, v79 dst_sel:DWORD dst_unused:UNUSED_PAD src0_sel:WORD_1
    v_cvt_f32_u32_sdwa v36, v92 dst_sel:DWORD dst_unused:UNUSED_PAD src0_sel:WORD_0
    v_cvt_f32_u32_sdwa v37, v92 dst_sel:DWORD dst_unused:UNUSED_PAD src0_sel:WORD_1
    v_cvt_f32_u32_sdwa v38, v93 dst_sel:DWORD dst_unused:UNUSED_PAD src0_sel:WORD_0
    v_cvt_f32_u32_sdwa v39, v93 dst_sel:DWORD dst_unused:UNUSED_PAD src0_sel:WORD_1
    v_cvt_f32_u32_sdwa v40, v94 dst_sel:DWORD dst_unused:UNUSED_PAD src0_sel:WORD_0
    v_cvt_f32_u32_sdwa v41, v94 dst_sel:DWORD dst_unused:UNUSED_PAD src0_sel:WORD_1
    v_cvt_f32_u32_sdwa v42, v95 dst_sel:DWORD dst_unused:UNUSED_PAD src0_sel:WORD_0
    v_cvt_f32_u32_sdwa v43, v95 dst_sel:DWORD dst_unused:UNUSED_PAD src0_sel:WORD_1
    v_add_f32 v28, 0xc6800000, v28
    v_fmac_f32 v12, s34, v28
    v_add_f32 v29, 0xc6800000, v29
    v_fmac_f32 v13, s34, v29
    v_add_f32 v30, 0xc6800000, v30
    v_fmac_f32 v14, s34, v30
    v_add_f32 v31, 0xc6800000, v31
    v_fmac_f32 v15, s34, v31
    v_add_f32 v32, 0xc6800000, v32
    v_fmac_f32 v16, s34, v32
    v_add_f32 v33, 0xc6800000, v33
    v_fmac_f32 v17, s34, v33
    v_add_f32 v34, 0xc6800000, v34
    v_fmac_f32 v18, s34, v34
    v_add_f32 v35, 0xc6800000, v35
    v_fmac_f32 v19, s34, v35
    v_add_f32 v36, 0xc6800000, v36
    v_fmac_f32 v20, s34, v36
    v_add_f32 v37, 0xc6800000, v37
    v_fmac_f32 v21, s34, v37
    v_add_f32 v38, 0xc6800000, v38
    v_fmac_f32 v22, s34, v38
    v_add_f32 v39, 0xc6800000, v39
    v_fmac_f32 v23, s34, v39
    v_add_f32 v40, 0xc6800000, v40
    v_fmac_f32 v24, s34, v40
    v_add_f32 v41, 0xc6800000, v41
    v_fmac_f32 v25, s34, v41
    v_add_f32 v42, 0xc6800000, v42
    v_fmac_f32 v26, s34, v42
    v_add_f32 v43, 0xc6800000, v43
    v_fmac_f32 v27, s34, v43
    s_branch L_fnx_101
L_ffl_100:
    s_mov_b32 s3, 25600000
    buffer_load_dwordx4 v[28:31], v6, s[20:23], s3 offen offset:0 sc1
    buffer_load_dwordx4 v[32:35], v6, s[20:23], s3 offen offset:16 sc1
    buffer_load_dwordx4 v[36:39], v7, s[20:23], s3 offen offset:0 sc1
    buffer_load_dwordx4 v[40:43], v7, s[20:23], s3 offen offset:16 sc1
    s_waitcnt vmcnt(0)
    v_add_f32 v12, v12, v28
    v_add_f32 v13, v13, v29
    v_add_f32 v14, v14, v30
    v_add_f32 v15, v15, v31
    v_add_f32 v16, v16, v32
    v_add_f32 v17, v17, v33
    v_add_f32 v18, v18, v34
    v_add_f32 v19, v19, v35
    v_add_f32 v20, v20, v36
    v_add_f32 v21, v21, v37
    v_add_f32 v22, v22, v38
    v_add_f32 v23, v23, v39
    v_add_f32 v24, v24, v40
    v_add_f32 v25, v25, v41
    v_add_f32 v26, v26, v42
    v_add_f32 v27, v27, v43
L_fnx_101:
    s_bitcmp1_b32 s35, 5
    s_cbranch_scc1 L_ffl_102
    v_cvt_f32_u32_sdwa v28, v80 dst_sel:DWORD dst_unused:UNUSED_PAD src0_sel:WORD_0
    v_cvt_f32_u32_sdwa v29, v80 dst_sel:DWORD dst_unused:UNUSED_PAD src0_sel:WORD_1
    v_cvt_f32_u32_sdwa v30, v81 dst_sel:DWORD dst_unused:UNUSED_PAD src0_sel:WORD_0
    v_cvt_f32_u32_sdwa v31, v81 dst_sel:DWORD dst_unused:UNUSED_PAD src0_sel:WORD_1
    v_cvt_f32_u32_sdwa v32, v82 dst_sel:DWORD dst_unused:UNUSED_PAD src0_sel:WORD_0
    v_cvt_f32_u32_sdwa v33, v82 dst_sel:DWORD dst_unused:UNUSED_PAD src0_sel:WORD_1
    v_cvt_f32_u32_sdwa v34, v83 dst_sel:DWORD dst_unused:UNUSED_PAD src0_sel:WORD_0
    v_cvt_f32_u32_sdwa v35, v83 dst_sel:DWORD dst_unused:UNUSED_PAD src0_sel:WORD_1
    v_cvt_f32_u32_sdwa v36, v96 dst_sel:DWORD dst_unused:UNUSED_PAD src0_sel:WORD_0
    v_cvt_f32_u32_sdwa v37, v96 dst_sel:DWORD dst_unused:UNUSED_PAD src0_sel:WORD_1
    v_cvt_f32_u32_sdwa v38, v97 dst_sel:DWORD dst_unused:UNUSED_PAD src0_sel:WORD_0
    v_cvt_f32_u32_sdwa v39, v97 dst_sel:DWORD dst_unused:UNUSED_PAD src0_sel:WORD_1
    v_cvt_f32_u32_sdwa v40, v98 dst_sel:DWORD dst_unused:UNUSED_PAD src0_sel:WORD_0
    v_cvt_f32_u32_sdwa v41, v98 dst_sel:DWORD dst_unused:UNUSED_PAD src0_sel:WORD_1
    v_cvt_f32_u32_sdwa v42, v99 dst_sel:DWORD dst_unused:UNUSED_PAD src0_sel:WORD_0
    v_cvt_f32_u32_sdwa v43, v99 dst_sel:DWORD dst_unused:UNUSED_PAD src0_sel:WORD_1
    v_add_f32 v28, 0xc6800000, v28
    v_fmac_f32 v12, s34, v28
    v_add_f32 v29, 0xc6800000, v29
    v_fmac_f32 v13, s34, v29
    v_add_f32 v30, 0xc6800000, v30
    v_fmac_f32 v14, s34, v30
    v_add_f32 v31, 0xc6800000, v31
    v_fmac_f32 v15, s34, v31
    v_add_f32 v32, 0xc6800000, v32
    v_fmac_f32 v16, s34, v32
    v_add_f32 v33, 0xc6800000, v33
    v_fmac_f32 v17, s34, v33
    v_add_f32 v34, 0xc6800000, v34
    v_fmac_f32 v18, s34, v34
    v_add_f32 v35, 0xc6800000, v35
    v_fmac_f32 v19, s34, v35
    v_add_f32 v36, 0xc6800000, v36
    v_fmac_f32 v20, s34, v36
    v_add_f32 v37, 0xc6800000, v37
    v_fmac_f32 v21, s34, v37
    v_add_f32 v38, 0xc6800000, v38
    v_fmac_f32 v22, s34, v38
    v_add_f32 v39, 0xc6800000, v39
    v_fmac_f32 v23, s34, v39
    v_add_f32 v40, 0xc6800000, v40
    v_fmac_f32 v24, s34, v40
    v_add_f32 v41, 0xc6800000, v41
    v_fmac_f32 v25, s34, v41
    v_add_f32 v42, 0xc6800000, v42
    v_fmac_f32 v26, s34, v42
    v_add_f32 v43, 0xc6800000, v43
    v_fmac_f32 v27, s34, v43
    s_branch L_fnx_103
L_ffl_102:
    s_mov_b32 s3, 38400000
    buffer_load_dwordx4 v[28:31], v6, s[20:23], s3 offen offset:0 sc1
    buffer_load_dwordx4 v[32:35], v6, s[20:23], s3 offen offset:16 sc1
    buffer_load_dwordx4 v[36:39], v7, s[20:23], s3 offen offset:0 sc1
    buffer_load_dwordx4 v[40:43], v7, s[20:23], s3 offen offset:16 sc1
    s_waitcnt vmcnt(0)
    v_add_f32 v12, v12, v28
    v_add_f32 v13, v13, v29
    v_add_f32 v14, v14, v30
    v_add_f32 v15, v15, v31
    v_add_f32 v16, v16, v32
    v_add_f32 v17, v17, v33
    v_add_f32 v18, v18, v34
    v_add_f32 v19, v19, v35
    v_add_f32 v20, v20, v36
    v_add_f32 v21, v21, v37
    v_add_f32 v22, v22, v38
    v_add_f32 v23, v23, v39
    v_add_f32 v24, v24, v40
    v_add_f32 v25, v25, v41
    v_add_f32 v26, v26, v42
    v_add_f32 v27, v27, v43
L_fnx_103:
    s_bitcmp1_b32 s35, 6
    s_cbranch_scc1 L_ffl_104
    v_cvt_f32_u32_sdwa v28, v84 dst_sel:DWORD dst_unused:UNUSED_PAD src0_sel:WORD_0
    v_cvt_f32_u32_sdwa v29, v84 dst_sel:DWORD dst_unused:UNUSED_PAD src0_sel:WORD_1
    v_cvt_f32_u32_sdwa v30, v85 dst_sel:DWORD dst_unused:UNUSED_PAD src0_sel:WORD_0
    v_cvt_f32_u32_sdwa v31, v85 dst_sel:DWORD dst_unused:UNUSED_PAD src0_sel:WORD_1
    v_cvt_f32_u32_sdwa v32, v86 dst_sel:DWORD dst_unused:UNUSED_PAD src0_sel:WORD_0
    v_cvt_f32_u32_sdwa v33, v86 dst_sel:DWORD dst_unused:UNUSED_PAD src0_sel:WORD_1
    v_cvt_f32_u32_sdwa v34, v87 dst_sel:DWORD dst_unused:UNUSED_PAD src0_sel:WORD_0
    v_cvt_f32_u32_sdwa v35, v87 dst_sel:DWORD dst_unused:UNUSED_PAD src0_sel:WORD_1
    v_cvt_f32_u32_sdwa v36, v100 dst_sel:DWORD dst_unused:UNUSED_PAD src0_sel:WORD_0
    v_cvt_f32_u32_sdwa v37, v100 dst_sel:DWORD dst_unused:UNUSED_PAD src0_sel:WORD_1
    v_cvt_f32_u32_sdwa v38, v101 dst_sel:DWORD dst_unused:UNUSED_PAD src0_sel:WORD_0
    v_cvt_f32_u32_sdwa v39, v101 dst_sel:DWORD dst_unused:UNUSED_PAD src0_sel:WORD_1
    v_cvt_f32_u32_sdwa v40, v102 dst_sel:DWORD dst_unused:UNUSED_PAD src0_sel:WORD_0
    v_cvt_f32_u32_sdwa v41, v102 dst_sel:DWORD dst_unused:UNUSED_PAD src0_sel:WORD_1
    v_cvt_f32_u32_sdwa v42, v103 dst_sel:DWORD dst_unused:UNUSED_PAD src0_sel:WORD_0
    v_cvt_f32_u32_sdwa v43, v103 dst_sel:DWORD dst_unused:UNUSED_PAD src0_sel:WORD_1
    v_add_f32 v28, 0xc6800000, v28
    v_fmac_f32 v12, s34, v28
    v_add_f32 v29, 0xc6800000, v29
    v_fmac_f32 v13, s34, v29
    v_add_f32 v30, 0xc6800000, v30
    v_fmac_f32 v14, s34, v30
    v_add_f32 v31, 0xc6800000, v31
    v_fmac_f32 v15, s34, v31
    v_add_f32 v32, 0xc6800000, v32
    v_fmac_f32 v16, s34, v32
    v_add_f32 v33, 0xc6800000, v33
    v_fmac_f32 v17, s34, v33
    v_add_f32 v34, 0xc6800000, v34
    v_fmac_f32 v18, s34, v34
    v_add_f32 v35, 0xc6800000, v35
    v_fmac_f32 v19, s34, v35
    v_add_f32 v36, 0xc6800000, v36
    v_fmac_f32 v20, s34, v36
    v_add_f32 v37, 0xc6800000, v37
    v_fmac_f32 v21, s34, v37
    v_add_f32 v38, 0xc6800000, v38
    v_fmac_f32 v22, s34, v38
    v_add_f32 v39, 0xc6800000, v39
    v_fmac_f32 v23, s34, v39
    v_add_f32 v40, 0xc6800000, v40
    v_fmac_f32 v24, s34, v40
    v_add_f32 v41, 0xc6800000, v41
    v_fmac_f32 v25, s34, v41
    v_add_f32 v42, 0xc6800000, v42
    v_fmac_f32 v26, s34, v42
    v_add_f32 v43, 0xc6800000, v43
    v_fmac_f32 v27, s34, v43
    s_branch L_fnx_105
L_ffl_104:
    s_mov_b32 s3, 51200000
    buffer_load_dwordx4 v[28:31], v6, s[20:23], s3 offen offset:0 sc1
    buffer_load_dwordx4 v[32:35], v6, s[20:23], s3 offen offset:16 sc1
    buffer_load_dwordx4 v[36:39], v7, s[20:23], s3 offen offset:0 sc1
    buffer_load_dwordx4 v[40:43], v7, s[20:23], s3 offen offset:16 sc1
    s_waitcnt vmcnt(0)
    v_add_f32 v12, v12, v28
    v_add_f32 v13, v13, v29
    v_add_f32 v14, v14, v30
    v_add_f32 v15, v15, v31
    v_add_f32 v16, v16, v32
    v_add_f32 v17, v17, v33
    v_add_f32 v18, v18, v34
    v_add_f32 v19, v19, v35
    v_add_f32 v20, v20, v36
    v_add_f32 v21, v21, v37
    v_add_f32 v22, v22, v38
    v_add_f32 v23, v23, v39
    v_add_f32 v24, v24, v40
    v_add_f32 v25, v25, v41
    v_add_f32 v26, v26, v42
    v_add_f32 v27, v27, v43
L_fnx_105:
    s_bitcmp1_b32 s35, 7
    s_cbranch_scc1 L_ffl_106
    v_cvt_f32_u32_sdwa v28, v88 dst_sel:DWORD dst_unused:UNUSED_PAD src0_sel:WORD_0
    v_cvt_f32_u32_sdwa v29, v88 dst_sel:DWORD dst_unused:UNUSED_PAD src0_sel:WORD_1
    v_cvt_f32_u32_sdwa v30, v89 dst_sel:DWORD dst_unused:UNUSED_PAD src0_sel:WORD_0
    v_cvt_f32_u32_sdwa v31, v89 dst_sel:DWORD dst_unused:UNUSED_PAD src0_sel:WORD_1
    v_cvt_f32_u32_sdwa v32, v90 dst_sel:DWORD dst_unused:UNUSED_PAD src0_sel:WORD_0
    v_cvt_f32_u32_sdwa v33, v90 dst_sel:DWORD dst_unused:UNUSED_PAD src0_sel:WORD_1
    v_cvt_f32_u32_sdwa v34, v91 dst_sel:DWORD dst_unused:UNUSED_PAD src0_sel:WORD_0
    v_cvt_f32_u32_sdwa v35, v91 dst_sel:DWORD dst_unused:UNUSED_PAD src0_sel:WORD_1
    v_cvt_f32_u32_sdwa v36, v104 dst_sel:DWORD dst_unused:UNUSED_PAD src0_sel:WORD_0
    v_cvt_f32_u32_sdwa v37, v104 dst_sel:DWORD dst_unused:UNUSED_PAD src0_sel:WORD_1
    v_cvt_f32_u32_sdwa v38, v105 dst_sel:DWORD dst_unused:UNUSED_PAD src0_sel:WORD_0
    v_cvt_f32_u32_sdwa v39, v105 dst_sel:DWORD dst_unused:UNUSED_PAD src0_sel:WORD_1
    v_cvt_f32_u32_sdwa v40, v106 dst_sel:DWORD dst_unused:UNUSED_PAD src0_sel:WORD_0
    v_cvt_f32_u32_sdwa v41, v106 dst_sel:DWORD dst_unused:UNUSED_PAD src0_sel:WORD_1
    v_cvt_f32_u32_sdwa v42, v107 dst_sel:DWORD dst_unused:UNUSED_PAD src0_sel:WORD_0
    v_cvt_f32_u32_sdwa v43, v107 dst_sel:DWORD dst_unused:UNUSED_PAD src0_sel:WORD_1
    v_add_f32 v28, 0xc6800000, v28
    v_fmac_f32 v12, s34, v28
    v_add_f32 v29, 0xc6800000, v29
    v_fmac_f32 v13, s34, v29
    v_add_f32 v30, 0xc6800000, v30
    v_fmac_f32 v14, s34, v30
    v_add_f32 v31, 0xc6800000, v31
    v_fmac_f32 v15, s34, v31
    v_add_f32 v32, 0xc6800000, v32
    v_fmac_f32 v16, s34, v32
    v_add_f32 v33, 0xc6800000, v33
    v_fmac_f32 v17, s34, v33
    v_add_f32 v34, 0xc6800000, v34
    v_fmac_f32 v18, s34, v34
    v_add_f32 v35, 0xc6800000, v35
    v_fmac_f32 v19, s34, v35
    v_add_f32 v36, 0xc6800000, v36
    v_fmac_f32 v20, s34, v36
    v_add_f32 v37, 0xc6800000, v37
    v_fmac_f32 v21, s34, v37
    v_add_f32 v38, 0xc6800000, v38
    v_fmac_f32 v22, s34, v38
    v_add_f32 v39, 0xc6800000, v39
    v_fmac_f32 v23, s34, v39
    v_add_f32 v40, 0xc6800000, v40
    v_fmac_f32 v24, s34, v40
    v_add_f32 v41, 0xc6800000, v41
    v_fmac_f32 v25, s34, v41
    v_add_f32 v42, 0xc6800000, v42
    v_fmac_f32 v26, s34, v42
    v_add_f32 v43, 0xc6800000, v43
    v_fmac_f32 v27, s34, v43
    s_branch L_fnx_107
L_ffl_106:
    s_mov_b32 s3, 64000000
    buffer_load_dwordx4 v[28:31], v6, s[20:23], s3 offen offset:0 sc1
    buffer_load_dwordx4 v[32:35], v6, s[20:23], s3 offen offset:16 sc1
    buffer_load_dwordx4 v[36:39], v7, s[20:23], s3 offen offset:0 sc1
    buffer_load_dwordx4 v[40:43], v7, s[20:23], s3 offen offset:16 sc1
    s_waitcnt vmcnt(0)
    v_add_f32 v12, v12, v28
    v_add_f32 v13, v13, v29
    v_add_f32 v14, v14, v30
    v_add_f32 v15, v15, v31
    v_add_f32 v16, v16, v32
    v_add_f32 v17, v17, v33
    v_add_f32 v18, v18, v34
    v_add_f32 v19, v19, v35
    v_add_f32 v20, v20, v36
    v_add_f32 v21, v21, v37
    v_add_f32 v22, v22, v38
    v_add_f32 v23, v23, v39
    v_add_f32 v24, v24, v40
    v_add_f32 v25, v25, v41
    v_add_f32 v26, v26, v42
    v_add_f32 v27, v27, v43
L_fnx_107:
    s_branch L_fbk_99
L_p2slow_47:
    s_waitcnt vmcnt(0) lgkmcnt(0)
    s_mov_b32 s51, 0
    s_movk_i32 s43, 6250

L_sweep_109:
    s_barrier

    v_mov_b32 v28, 0x0
    v_mov_b32 v29, 0x0
    v_mov_b32 v30, 0x0
    v_mov_b32 v31, 0x0
    v_add_u32 v32, 50000, v3
    v_add_u32 v33, 65536, v32

    ds_write_b128 v32, v[28:31] offset:0
    ds_write_b128 v32, v[28:31] offset:16384
    ds_write_b128 v32, v[28:31] offset:32768
    ds_write_b128 v32, v[28:31] offset:49152
    ds_write_b128 v33, v[28:31] offset:0
    ds_write_b128 v33, v[28:31] offset:16384
    v_cmp_gt_u32 vcc, 971, v0
    s_mov_b64 exec, vcc
    ds_write_b128 v33, v[28:31] offset:32768
    s_mov_b64 exec, -1
    s_mov_b32 s3, 32768
    s_load_dword s40, s[6:7], s3
    s_waitcnt lgkmcnt(0)
    s_barrier
    s_cmp_lg_u32 s40, 0
    s_cbranch_scc1 L_raw_114
    s_sub_u32 s38, s4, 8
L_sbatch_110:
    s_lshl_b32 s52, s38, 6
    s_add_u32 s52, s52, s36
    s_lshr_b32 s52, s52, 1
    s_lshl_b32 s52, s52, 2
    s_load_dword s40, s[46:47], s52
    s_mul_i32 s50, s38, 200000
    s_and_b32 s3, s36, 1
    s_lshl_b32 s3, s3, 4
    s_or_b32 s3, s3, 0x100000
    s_waitcnt lgkmcnt(0)
    s_bfe_u32 s40, s40, s3

    s_min_u32 s40, s40, 8064
    s_lshl_b32 s52, s38, 6
    s_add_u32 s52, s52, s36
    s_mul_i32 s52, s52, 40320
    s_add_u32 s20, s44, s52
    s_addc_u32 s21, s45, 0
    s_mul_i32 s52, s40, 5
    s_add_u32 s52, s52, 3
    s_and_b32 s22, s52, -4

    s_lshr_b32 s55, s39, 2
    s_add_u32 s55, s55, 0
    v_and_b32 v36, 63, v0
    v_add_u32 v36, s55, v36
L_left_115:
    s_cmp_ge_u32 s55, s40
    s_cbranch_scc1 L_leftend_116
    v_mul_u32_u24 v37, 5, v36
    buffer_load_dword v38, v37, s[20:23], 0 offen
    buffer_load_ubyte v39, v37, s[20:23], 0 offen offset:4
    s_waitcnt vmcnt(0)

    v_perm_b32 v37, v39, v38, s24
    v_lshrrev_b32 v42, 30, v38
    v_and_b32 v37, 0x1fff, v37
    v_mul_u32_u24 v42, 6250, v42
    v_add_lshl_u32 v37, v37, v42, 3

    buffer_load_dwordx2 v[40:41], v37, s[8:11], s50 offen
    v_cmp_gt_u32 vcc, s40, v36
    s_waitcnt vmcnt(0)

    v_bfe_u32 v44, v38, 16, 14
    v_subrev_u32 v44, s51, v44
    v_cmp_gt_u32 s[64:65], s43, v44
    s_and_b64 exec, vcc, s[64:65]
    v_lshlrev_b32 v45, 8, v38
    v_cmpx_ne_u32 vcc, 0, v45
    v_lshlrev_b32 v44, 4, v44
    v_bfe_i32 v38, v38, 0, 16
    v_cvt_f32_i32 v38, v38
    v_mul_f32 v38, 0x38004020, v38
    v_lshlrev_b32 v45, 16, v40
    v_and_b32 v46, s32, v40
    v_lshlrev_b32 v47, 16, v41
    v_and_b32 v48, s32, v41

    v_mul_f32 v45, v45, v38
    ds_add_f32 v44, v45 offset:50000
    v_mul_f32 v46, v46, v38
    ds_add_f32 v44, v46 offset:50004
    v_mul_f32 v47, v47, v38
    ds_add_f32 v44, v47 offset:50008
    v_mul_f32 v48, v48, v38
    ds_add_f32 v44, v48 offset:50012
    s_mov_b64 exec, -1
    v_add_u32 v36, 128, v36
    s_add_u32 s55, s55, 128
    s_branch L_left_115
L_leftend_116:

    s_add_u32 s38, s38, 1
    s_cmp_lt_u32 s38, s4
    s_cbranch_scc1 L_sbatch_110
    s_branch L_swend_112

L_raw_114:
    s_load_dwordx2 s[68:69], s[0:1], 8
    s_load_dwordx2 s[72:73], s[0:1], 16
    s_load_dwordx2 s[76:77], s[0:1], 32
    s_load_dwordx2 s[80:81], s[0:1], 48
    s_mov_b32 s70, 204800000
    s_mov_b32 s71, 0x20000
    s_mov_b32 s74, 204800000
    s_mov_b32 s75, 0x20000
    s_mov_b32 s78, 102400000
    s_mov_b32 s79, 0x20000
    s_waitcnt lgkmcnt(0)
    s_load_dword s82, s[80:81], 0
    s_mul_i32 s83, s36, 12500
    s_add_u32 s83, s83, s51
    s_mul_i32 s84, s37, 200000
    s_mov_b32 s85, 200000
    s_mov_b32 s38, 0
    v_lshlrev_b32 v44, 5, v0
    v_mov_b32 v45, 0.15915494
    s_waitcnt lgkmcnt(0)
    s_lshl_b32 s82, s82, 16
    v_mul_f32 v45, s82, v45
L_rawl_111:
    s_lshr_b32 s3, s38, 1
    buffer_load_dwordx4 v[46:49], v44, s[72:75], s38 offen
    buffer_load_dwordx4 v[50:53], v44, s[72:75], s38 offen offset:16
    buffer_load_dwordx4 v[54:57], v44, s[68:71], s38 offen
    buffer_load_dwordx4 v[58:61], v44, s[68:71], s38 offen offset:16
    buffer_load_dwordx4 v[62:65], v3, s[76:79], s3 offen
    s_waitcnt vmcnt(1)

    v_subrev_u32 v46, s83, v46
    v_subrev_u32 v82, s84, v54
    v_cmp_gt_u32 vcc, s43, v46
    v_cmp_gt_u32 s[64:65], s85, v82
    v_lshlrev_b32 v54, 3, v54
    s_nand_b64 exec, vcc, s[64:65]
    v_bfrev_b32 v54, 1
    s_mov_b64 exec, -1
    buffer_load_dwordx2 v[66:67], v54, s[8:11], 0 offen

    v_subrev_u32 v47, s83, v47
    v_subrev_u32 v82, s84, v55
    v_cmp_gt_u32 vcc, s43, v47
    v_cmp_gt_u32 s[64:65], s85, v82
    v_lshlrev_b32 v55, 3, v55
    s_nand_b64 exec, vcc, s[64:65]
    v_bfrev_b32 v55, 1
    s_mov_b64 exec, -1
    buffer_load_dwordx2 v[68:69], v55, s[8:11], 0 offen

    v_subrev_u32 v48, s83, v48
    v_subrev_u32 v82, s84, v56
    v_cmp_gt_u32 vcc, s43, v48
    v_cmp_gt_u32 s[64:65], s85, v82
    v_lshlrev_b32 v56, 3, v56
    s_nand_b64 exec, vcc, s[64:65]
    v_bfrev_b32 v56, 1
    s_mov_b64 exec, -1
    buffer_load_dwordx2 v[70:71], v56, s[8:11], 0 offen

    v_subrev_u32 v49, s83, v49
    v_subrev_u32 v82, s84, v57
    v_cmp_gt_u32 vcc, s43, v49
    v_cmp_gt_u32 s[64:65], s85, v82
    v_lshlrev_b32 v57, 3, v57
    s_nand_b64 exec, vcc, s[64:65]
    v_bfrev_b32 v57, 1
    s_mov_b64 exec, -1
    buffer_load_dwordx2 v[72:73], v57, s[8:11], 0 offen

    v_subrev_u32 v50, s83, v50
    v_subrev_u32 v82, s84, v58
    v_cmp_gt_u32 vcc, s43, v50
    v_cmp_gt_u32 s[64:65], s85, v82
    v_lshlrev_b32 v58, 3, v58
    s_nand_b64 exec, vcc, s[64:65]
    v_bfrev_b32 v58, 1
    s_mov_b64 exec, -1
    buffer_load_dwordx2 v[74:75], v58, s[8:11], 0 offen

    v_subrev_u32 v51, s83, v51
    v_subrev_u32 v82, s84, v59
    v_cmp_gt_u32 vcc, s43, v51
    v_cmp_gt_u32 s[64:65], s85, v82
    v_lshlrev_b32 v59, 3, v59
    s_nand_b64 exec, vcc, s[64:65]
    v_bfrev_b32 v59, 1
    s_mov_b64 exec, -1
    buffer_load_dwordx2 v[76:77], v59, s[8:11], 0 offen

    v_subrev_u32 v52, s83, v52
    v_subrev_u32 v82, s84, v60
    v_cmp_gt_u32 vcc, s43, v52
    v_cmp_gt_u32 s[64:65], s85, v82
    v_lshlrev_b32 v60, 3, v60
    s_nand_b64 exec, vcc, s[64:65]
    v_bfrev_b32 v60, 1
    s_mov_b64 exec, -1
    buffer_load_dwordx2 v[78:79], v60, s[8:11], 0 offen

    v_subrev_u32 v53, s83, v53
    v_subrev_u32 v82, s84, v61
    v_cmp_gt_u32 vcc, s43, v53
    v_cmp_gt_u32 s[64:65], s85, v82
    v_lshlrev_b32 v61, 3, v61
    s_nand_b64 exec, vcc, s[64:65]
    v_bfrev_b32 v61, 1
    s_mov_b64 exec, -1
    buffer_load_dwordx2 v[80:81], v61, s[8:11], 0 offen

    s_waitcnt vmcnt(0)
    v_cmp_le_i32 vcc, 0, v54
    s_mov_b64 exec, vcc
    s_cbranch_execz L_rsk_117
    v_lshlrev_b32 v82, 16, v62
    v_mul_f32 v82, v82, v45
    v_fract_f32 v82, v82
    v_cos_f32 v82, v82
    v_lshlrev_b32 v46, 4, v46
    v_lshlrev_b32 v83, 16, v66
    v_and_b32 v84, s32, v66
    v_lshlrev_b32 v85, 16, v67
    v_and_b32 v86, s32, v67

    v_mul_f32 v83, v83, v82
    ds_add_f32 v46, v83 offset:50000
    v_mul_f32 v84, v84, v82
    ds_add_f32 v46, v84 offset:50004
    v_mul_f32 v85, v85, v82
    ds_add_f32 v46, v85 offset:50008
    v_mul_f32 v86, v86, v82
    ds_add_f32 v46, v86 offset:50012
L_rsk_117:
    s_mov_b64 exec, -1
    v_cmp_le_i32 vcc, 0, v55
    s_mov_b64 exec, vcc
    s_cbranch_execz L_rsk_118
    v_and_b32 v82, s32, v62
    v_mul_f32 v82, v82, v45
    v_fract_f32 v82, v82
    v_cos_f32 v82, v82
    v_lshlrev_b32 v47, 4, v47
    v_lshlrev_b32 v83, 16, v68
    v_and_b32 v84, s32, v68
    v_lshlrev_b32 v85, 16, v69
    v_and_b32 v86, s32, v69

    v_mul_f32 v83, v83, v82
    ds_add_f32 v47, v83 offset:50000
    v_mul_f32 v84, v84, v82
    ds_add_f32 v47, v84 offset:50004
    v_mul_f32 v85, v85, v82
    ds_add_f32 v47, v85 offset:50008
    v_mul_f32 v86, v86, v82
    ds_add_f32 v47, v86 offset:50012
L_rsk_118:
    s_mov_b64 exec, -1
    v_cmp_le_i32 vcc, 0, v56
    s_mov_b64 exec, vcc
    s_cbranch_execz L_rsk_119
    v_lshlrev_b32 v82, 16, v63
    v_mul_f32 v82, v82, v45
    v_fract_f32 v82, v82
    v_cos_f32 v82, v82
    v_lshlrev_b32 v48, 4, v48
    v_lshlrev_b32 v83, 16, v70
    v_and_b32 v84, s32, v70
    v_lshlrev_b32 v85, 16, v71
    v_and_b32 v86, s32, v71

    v_mul_f32 v83, v83, v82
    ds_add_f32 v48, v83 offset:50000
    v_mul_f32 v84, v84, v82
    ds_add_f32 v48, v84 offset:50004
    v_mul_f32 v85, v85, v82
    ds_add_f32 v48, v85 offset:50008
    v_mul_f32 v86, v86, v82
    ds_add_f32 v48, v86 offset:50012
L_rsk_119:
    s_mov_b64 exec, -1
    v_cmp_le_i32 vcc, 0, v57
    s_mov_b64 exec, vcc
    s_cbranch_execz L_rsk_120
    v_and_b32 v82, s32, v63
    v_mul_f32 v82, v82, v45
    v_fract_f32 v82, v82
    v_cos_f32 v82, v82
    v_lshlrev_b32 v49, 4, v49
    v_lshlrev_b32 v83, 16, v72
    v_and_b32 v84, s32, v72
    v_lshlrev_b32 v85, 16, v73
    v_and_b32 v86, s32, v73

    v_mul_f32 v83, v83, v82
    ds_add_f32 v49, v83 offset:50000
    v_mul_f32 v84, v84, v82
    ds_add_f32 v49, v84 offset:50004
    v_mul_f32 v85, v85, v82
    ds_add_f32 v49, v85 offset:50008
    v_mul_f32 v86, v86, v82
    ds_add_f32 v49, v86 offset:50012
L_rsk_120:
    s_mov_b64 exec, -1
    v_cmp_le_i32 vcc, 0, v58
    s_mov_b64 exec, vcc
    s_cbranch_execz L_rsk_121
    v_lshlrev_b32 v82, 16, v64
    v_mul_f32 v82, v82, v45
    v_fract_f32 v82, v82
    v_cos_f32 v82, v82
    v_lshlrev_b32 v50, 4, v50
    v_lshlrev_b32 v83, 16, v74
    v_and_b32 v84, s32, v74
    v_lshlrev_b32 v85, 16, v75
    v_and_b32 v86, s32, v75

    v_mul_f32 v83, v83, v82
    ds_add_f32 v50, v83 offset:50000
    v_mul_f32 v84, v84, v82
    ds_add_f32 v50, v84 offset:50004
    v_mul_f32 v85, v85, v82
    ds_add_f32 v50, v85 offset:50008
    v_mul_f32 v86, v86, v82
    ds_add_f32 v50, v86 offset:50012
L_rsk_121:
    s_mov_b64 exec, -1
    v_cmp_le_i32 vcc, 0, v59
    s_mov_b64 exec, vcc
    s_cbranch_execz L_rsk_122
    v_and_b32 v82, s32, v64
    v_mul_f32 v82, v82, v45
    v_fract_f32 v82, v82
    v_cos_f32 v82, v82
    v_lshlrev_b32 v51, 4, v51
    v_lshlrev_b32 v83, 16, v76
    v_and_b32 v84, s32, v76
    v_lshlrev_b32 v85, 16, v77
    v_and_b32 v86, s32, v77

    v_mul_f32 v83, v83, v82
    ds_add_f32 v51, v83 offset:50000
    v_mul_f32 v84, v84, v82
    ds_add_f32 v51, v84 offset:50004
    v_mul_f32 v85, v85, v82
    ds_add_f32 v51, v85 offset:50008
    v_mul_f32 v86, v86, v82
    ds_add_f32 v51, v86 offset:50012
L_rsk_122:
    s_mov_b64 exec, -1
    v_cmp_le_i32 vcc, 0, v60
    s_mov_b64 exec, vcc
    s_cbranch_execz L_rsk_123
    v_lshlrev_b32 v82, 16, v65
    v_mul_f32 v82, v82, v45
    v_fract_f32 v82, v82
    v_cos_f32 v82, v82
    v_lshlrev_b32 v52, 4, v52
    v_lshlrev_b32 v83, 16, v78
    v_and_b32 v84, s32, v78
    v_lshlrev_b32 v85, 16, v79
    v_and_b32 v86, s32, v79

    v_mul_f32 v83, v83, v82
    ds_add_f32 v52, v83 offset:50000
    v_mul_f32 v84, v84, v82
    ds_add_f32 v52, v84 offset:50004
    v_mul_f32 v85, v85, v82
    ds_add_f32 v52, v85 offset:50008
    v_mul_f32 v86, v86, v82
    ds_add_f32 v52, v86 offset:50012
L_rsk_123:
    s_mov_b64 exec, -1
    v_cmp_le_i32 vcc, 0, v61
    s_mov_b64 exec, vcc
    s_cbranch_execz L_rsk_124
    v_and_b32 v82, s32, v65
    v_mul_f32 v82, v82, v45
    v_fract_f32 v82, v82
    v_cos_f32 v82, v82
    v_lshlrev_b32 v53, 4, v53
    v_lshlrev_b32 v83, 16, v80
    v_and_b32 v84, s32, v80
    v_lshlrev_b32 v85, 16, v81
    v_and_b32 v86, s32, v81

    v_mul_f32 v83, v83, v82
    ds_add_f32 v53, v83 offset:50000
    v_mul_f32 v84, v84, v82
    ds_add_f32 v53, v84 offset:50004
    v_mul_f32 v85, v85, v82
    ds_add_f32 v53, v85 offset:50008
    v_mul_f32 v86, v86, v82
    ds_add_f32 v53, v86 offset:50012
L_rsk_124:
    s_mov_b64 exec, -1
    s_add_u32 s38, s38, 32768
    s_cmp_lt_u32 s38, 204800000
    s_cbranch_scc1 L_rawl_111
L_swend_112:
    s_waitcnt lgkmcnt(0)
    s_barrier
    s_mul_i32 s3, s37, 800000
    s_mul_i32 s5, s36, 12500
    s_add_u32 s3, s3, s5
    s_add_u32 s3, s3, s51
    s_lshl_b32 s3, s3, 4
    s_add_u32 s3, s3, 32399360

    s_add_u32 s20, s6, s3
    s_addc_u32 s21, s7, 0
    s_mov_b32 s22, 100000
    s_mov_b32 s23, 0x20000
    v_mov_b32 v36, v3
    s_mov_b32 s38, 0
L_wl_113:
    v_min_u32 v37, 100000, v36
    ds_read_b128 v[28:31], v37 offset:50000
    s_waitcnt lgkmcnt(0)
    buffer_store_dwordx4 v[28:31], v36, s[20:23], 0 offen sc1
    s_waitcnt vmcnt(0)
    v_add_u32 v36, 16384, v36
    s_add_u32 s38, s38, 1024
    s_cmp_lt_u32 s38, 6250
    s_cbranch_scc1 L_wl_113
    s_add_u32 s51, s51, 6250
    s_cmp_lt_u32 s51, 12500
    s_cbranch_scc1 L_sweep_109
    s_lshl_b32 s33, 16, s37
    s_add_u32 s33, s33, 1
    s_branch L_fin_82

.section .rodata,"a"
.p2align 6
.amdhsa_kernel g1_kernel
  .amdhsa_next_free_vgpr 128
  .amdhsa_next_free_sgpr 102
  .amdhsa_accum_offset 128
  .amdhsa_group_segment_fixed_size 0
  .amdhsa_kernarg_size 112
  .amdhsa_user_sgpr_count 2
  .amdhsa_user_sgpr_kernarg_segment_ptr 1
  .amdhsa_system_sgpr_workgroup_id_x 1
.end_amdhsa_kernel
.p2align 6
.amdhsa_kernel standalone__molecular_angular_gemnet__graph_kernel
  .amdhsa_next_free_vgpr 128
  .amdhsa_next_free_sgpr 102
  .amdhsa_accum_offset 128
  .amdhsa_group_segment_fixed_size 0
  .amdhsa_kernarg_size 112
  .amdhsa_user_sgpr_count 2
  .amdhsa_user_sgpr_kernarg_segment_ptr 1
  .amdhsa_system_sgpr_workgroup_id_x 1
  .amdhsa_float_denorm_mode_32 3
.end_amdhsa_kernel
```

```asm
; @launch kernel=g1_kernel grid=(256,1,1) block=(1024,1,1) lds=163840
; @launch kernel=standalone__molecular_angular_gemnet__graph_kernel grid=(256,1,1) block=(1024,1,1) lds=163840
.amdgcn_target "amdgcn-amd-amdhsa--gfx950"
.text
.globl g1_kernel
.p2align 8
.type g1_kernel,@function
g1_kernel:
    s_cmp_ge_u32 s2, 256
    s_cbranch_scc1 L_p1done_1
    s_load_dwordx4 s[80:83], s[0:1], 8
    s_load_dwordx2 s[84:85], s[0:1], 32
    s_load_dwordx2 s[86:87], s[0:1], 48
    s_load_dwordx4 s[4:7], s[0:1], 96
    s_load_dwordx2 s[78:79], s[0:1], 0
    v_lshlrev_b32 v1, 4, v0
    v_lshlrev_b32 v2, 3, v0
    v_lshlrev_b32 v98, 20, v0
    s_waitcnt lgkmcnt(0)
    s_load_dword s88, s[86:87], 0

    s_mov_b32 s96, s4
    s_mov_b32 s97, s5
    s_mov_b32 s98, 256
    s_mov_b32 s99, 0x20000
    v_readfirstlane_b32 s74, v0
    s_nop 1
    s_or_b32 s74, s74, s2
    s_cbranch_scc1 L_noinit_2

    v_mov_b32 v110, 1
    buffer_atomic_add v110, v98, s[96:99], 0 offen offset:64 sc0
    s_waitcnt vmcnt(0)
    v_readfirstlane_b32 s74, v110
    s_nop 1
    s_cmp_lg_u32 s74, 0
    s_cbranch_scc1 L_zno_4

    s_mov_b32 s92, s6
    s_mov_b32 s93, s7
    s_mov_b32 s94, 32784
    s_mov_b32 s95, 0x20000
    v_mov_b32 v110, 0
    v_mov_b32 v111, 0
    v_mov_b32 v112, 0
    v_mov_b32 v113, 0
L_zl_3:
    buffer_store_dwordx4 v[110:113], v1, s[92:95], s74 offen sc0 sc1
    s_add_u32 s74, s74, 1024
    s_cmp_le_u32 s74, 32768
    s_cbranch_scc1 L_zl_3
    v_mov_b32 v114, 1
    s_waitcnt vmcnt(0)
    buffer_atomic_add v114, v98, s[96:99], 0 offen offset:128
L_zno_4:

L_noinit_2:
    s_mov_b32 s20, s78
    s_mov_b32 s21, s79
    s_mov_b32 s22, 6400000
    s_mov_b32 s23, 0x20000
    v_mul_u32_u24 v110, 6240, v0
    v_and_b32 v111, 63, v0
    v_and_b32 v112, 0x3c0, v0
    v_lshlrev_b32 v111, 2, v111
    v_lshl_or_b32 v111, v112, 4, v111
    v_lshlrev_b32 v100, 2, v0
    s_lshr_b32 s50, s2, 1
    s_and_b32 s53, s2, 1
    s_mul_i32 s3, s50, 50000
    s_mul_i32 s54, s53, 24576
    s_add_u32 s3, s3, s54

    buffer_load_dwordx4 v[56:59], v110, s[20:23], 0 offen
    s_add_u32 s20, s78, s3
    s_addc_u32 s21, s79, 0
    s_mov_b32 s22, 24576
    s_mov_b32 s23, 0x20000
    s_movk_i32 s3, 16384
    buffer_load_dword v44, v111, s[20:23], 0 offen offset:0
    buffer_load_dword v45, v111, s[20:23], 0 offen offset:256
    buffer_load_dword v46, v111, s[20:23], 0 offen offset:512
    buffer_load_dword v47, v111, s[20:23], 0 offen offset:768
    buffer_load_dword v48, v111, s[20:23], s3 offen offset:0
    buffer_load_dword v49, v111, s[20:23], s3 offen offset:256
    buffer_load_dword v50, v111, s[20:23], s3 offen offset:512
    buffer_load_dword v51, v111, s[20:23], s3 offen offset:768
    s_mul_i32 s22, s53, 25424
    s_movk_i32 s3, 24576

    buffer_load_dword v52, v100, s[20:23], s3 offen
    s_mul_i32 s3, s50, 50048
    s_add_u32 s3, s3, s54
    s_add_u32 s54, s3, 393216

    s_mov_b32 s8, s80
    s_mov_b32 s9, s81
    s_mov_b32 s10, 0
    s_mov_b32 s11, 0x20000
    s_mov_b32 s12, s82
    s_mov_b32 s13, s83
    s_mov_b32 s14, 0
    s_mov_b32 s15, 0x20000
    s_mov_b32 s16, s84
    s_mov_b32 s17, s85
    s_mov_b32 s18, 0
    s_mov_b32 s19, 0x20000
    s_lshr_b32 s74, s2, 1
    s_and_b32 s74, s74, 28
    s_lshr_b32 s86, 0x00102010, s74
    s_lshr_b32 s87, 0x44414241, s74
    s_lshr_b32 s41, 0x43221100, s74
    s_and_b32 s86, s86, 15
    s_and_b32 s87, s87, 15
    s_and_b32 s41, s41, 15
    s_lshr_b32 s74, s2, 6
    s_lshl_b32 s74, s74, 3
    s_and_b32 s75, s2, 7
    s_add_u32 s74, s74, s75
    s_mul_i32 s74, s74, 5
    s_add_u32 s41, s41, s74

    s_mul_i32 s78, s41, 16384
    s_add_u32 s49, s78, 16384
    s_cmp_ge_u32 s41, 3125
    s_cmovk_i32 s49, 0
    s_cmovk_i32 s78, 0
    s_lshl_b32 s10, s49, 2
    s_lshl_b32 s14, s49, 2
    s_lshl_b32 s18, s49, 1
    s_sub_u32 s79, s87, s86
    s_bfm_b32 s85, s79, s86
    s_lshl_b32 s86, s86, 12
    s_lshl_b32 s87, s87, 12
    s_min_u32 s87, s87, 16384

    s_add_u32 s79, s78, 0
    s_bitcmp1_b32 s85, 0
    s_cselect_b32 s79, s79, 0x1ff00000
    s_lshl_b32 s56, s79, 2
    s_lshl_b32 s61, s79, 1

    s_add_u32 s79, s78, 4096
    s_bitcmp1_b32 s85, 1
    s_cselect_b32 s79, s79, 0x1ff00000
    s_lshl_b32 s57, s79, 2
    s_lshl_b32 s62, s79, 1

    s_add_u32 s79, s78, 8192
    s_bitcmp1_b32 s85, 2
    s_cselect_b32 s79, s79, 0x1ff00000
    s_lshl_b32 s58, s79, 2
    s_lshl_b32 s63, s79, 1

    s_add_u32 s79, s78, 12288
    s_bitcmp1_b32 s85, 3
    s_cselect_b32 s79, s79, 0x1ff00000
    s_lshl_b32 s59, s79, 2
    s_lshl_b32 s64, s79, 1

    s_mov_b32 s82, s85
    s_mov_b32 s83, s86
    s_mov_b32 s84, s87
    s_add_u32 s41, s2, 160
    s_mul_i32 s74, s41, 16384
    s_mov_b32 s10, 204800000
    s_mov_b32 s14, 204800000
    s_mov_b32 s18, 102400000

    s_add_u32 s75, s74, 0
    s_lshl_b32 s76, s75, 2
    s_lshl_b32 s75, s75, 1
    s_bitcmp1_b32 s82, 0
    s_cselect_b32 s56, s56, s76
    s_cselect_b32 s61, s61, s75

    s_add_u32 s75, s74, 4096
    s_lshl_b32 s76, s75, 2
    s_lshl_b32 s75, s75, 1
    s_bitcmp1_b32 s82, 1
    s_cselect_b32 s57, s57, s76
    s_cselect_b32 s62, s62, s75

    s_add_u32 s75, s74, 8192
    s_lshl_b32 s76, s75, 2
    s_lshl_b32 s75, s75, 1
    s_bitcmp1_b32 s82, 2
    s_cselect_b32 s58, s58, s76
    s_cselect_b32 s63, s63, s75

    s_add_u32 s75, s74, 12288
    s_lshl_b32 s76, s75, 2
    s_lshl_b32 s75, s75, 1
    s_bitcmp1_b32 s82, 3
    s_cselect_b32 s59, s59, s76
    s_cselect_b32 s64, s64, s75

    buffer_load_dwordx4 v[20:23], v1, s[12:15], s56 offen nt
    buffer_load_dwordx4 v[4:7], v1, s[8:11], s56 offen nt
    buffer_load_dwordx2 v[36:37], v2, s[16:19], s61 offen nt
    buffer_load_dwordx4 v[24:27], v1, s[12:15], s57 offen nt
    buffer_load_dwordx4 v[8:11], v1, s[8:11], s57 offen nt
    buffer_load_dwordx2 v[38:39], v2, s[16:19], s62 offen nt
    buffer_load_dwordx4 v[28:31], v1, s[12:15], s58 offen nt
    buffer_load_dwordx4 v[12:15], v1, s[8:11], s58 offen nt
    buffer_load_dwordx2 v[40:41], v2, s[16:19], s63 offen nt
    buffer_load_dwordx4 v[32:35], v1, s[12:15], s59 offen nt
    buffer_load_dwordx4 v[16:19], v1, s[8:11], s59 offen nt
    buffer_load_dwordx2 v[42:43], v2, s[16:19], s64 offen nt
    s_mov_b32 s86, 0
    s_mov_b32 s87, 4
    s_mul_i32 s78, s41, 16384
    s_add_u32 s49, s78, 16384
    s_cmp_ge_u32 s41, 3125
    s_cmovk_i32 s49, 0
    s_cmovk_i32 s78, 0
    s_lshl_b32 s10, s49, 2
    s_lshl_b32 s14, s49, 2
    s_lshl_b32 s18, s49, 1
    s_sub_u32 s79, s87, s86
    s_bfm_b32 s85, s79, s86
    s_lshl_b32 s86, s86, 12
    s_lshl_b32 s87, s87, 12
    s_min_u32 s87, s87, 16384

    s_add_u32 s79, s78, 0
    s_bitcmp1_b32 s85, 0
    s_cselect_b32 s79, s79, 0x1ff00000
    s_lshl_b32 s56, s79, 2
    s_lshl_b32 s61, s79, 1

    s_add_u32 s79, s78, 4096
    s_bitcmp1_b32 s85, 1
    s_cselect_b32 s79, s79, 0x1ff00000
    s_lshl_b32 s57, s79, 2
    s_lshl_b32 s62, s79, 1

    s_add_u32 s79, s78, 8192
    s_bitcmp1_b32 s85, 2
    s_cselect_b32 s79, s79, 0x1ff00000
    s_lshl_b32 s58, s79, 2
    s_lshl_b32 s63, s79, 1

    s_add_u32 s79, s78, 12288
    s_bitcmp1_b32 s85, 3
    s_cselect_b32 s79, s79, 0x1ff00000
    s_lshl_b32 s59, s79, 2
    s_lshl_b32 s64, s79, 1

    s_getreg_b32 s5, hwreg(HW_REG_XCC_ID)
    s_and_b32 s5, s5, 7
    s_mul_i32 s3, s5, 4096

    s_add_u32 s20, s6, s3
    s_addc_u32 s21, s7, 0
    s_mov_b32 s22, 4096
    s_mov_b32 s23, 0x20000
    s_mul_i32 s3, s5, 67117056
    s_add_u32 s3, s3, 83623936
    s_add_u32 s24, s6, s3
    s_addc_u32 s25, s7, 0
    s_mov_b32 s26, 67117056
    s_mov_b32 s27, 0x20000
    s_add_u32 s36, s6, 32768
    s_addc_u32 s37, s7, 0
    s_mov_b32 s38, 4
    s_mov_b32 s39, 0x20000
    s_mov_b32 s40, 687195
    s_mov_b32 s42, -6250
    s_mov_b32 s43, 1942
    s_mov_b32 s45, 0x06050400
    s_mov_b32 s46, 0x05040c00
    s_mov_b32 s47, 0x04020100
    s_mov_b32 s48, 6552
    s_mov_b32 s50, 0
    v_mov_b32 v104, 1
    v_mov_b32 v105, 0x46ff8000
    s_mov_b32 s55, 0x05040100
    v_mul_u32_u24 v106, 5, v0
    v_mov_b32 v108, 16384
    v_mov_b32 v114, 0
    v_mov_b32 v115, 0
    v_mov_b32 v116, 0
    v_mov_b32 v117, -1
    ds_write_b64 v2, v[114:115]
    s_movk_i32 s3, 1024
    v_cmp_gt_u32 s[66:67], s3, v0
    s_movk_i32 s3, 1024
    v_cmp_gt_u32 s[68:69], s3, v0
    s_mov_b64 exec, 1
    ds_write_b128 v108, v[114:117]
    s_mov_b64 exec, -1
    s_waitcnt lgkmcnt(0)
    s_lshl_b32 s88, s88, 16
    v_mov_b32 v110, 0.15915494
    v_mul_f32 v110, s88, v110
    s_mov_b32 s3, 0x7fff7fff
    v_readfirstlane_b32 s44, v110

    s_waitcnt vmcnt(12)
    v_mov_b32 v61, 0
    v_mov_b32 v62, 0
    v_mov_b32 v63, 0
    v_dot2_f32_bf16 v61, v44, v44, v61
    v_dot2_f32_bf16 v61, v45, v45, v61
    v_dot2_f32_bf16 v61, v46, v46, v61
    v_dot2_f32_bf16 v61, v47, v47, v61
    v_dot2_f32_bf16 v61, v48, v48, v61
    v_dot2_f32_bf16 v61, v49, v49, v61
    v_dot2_f32_bf16 v61, v50, v50, v61
    v_dot2_f32_bf16 v61, v51, v51, v61
    v_dot2_f32_bf16 v61, v52, v52, v61
    v_dot2_f32_bf16 v62, v56, v56, v62
    v_dot2_f32_bf16 v62, v57, v57, v62
    v_dot2_f32_bf16 v62, v58, v58, v62
    v_dot2_f32_bf16 v62, v59, v59, v62
    v_and_b32 v60, s3, v44
    v_and_b32 v64, s3, v45
    v_pk_max_u16 v60, v60, v64
    v_and_b32 v64, s3, v46
    v_pk_max_u16 v60, v60, v64
    v_and_b32 v64, s3, v47
    v_pk_max_u16 v60, v60, v64
    v_and_b32 v64, s3, v48
    v_pk_max_u16 v60, v60, v64
    v_and_b32 v64, s3, v49
    v_pk_max_u16 v60, v60, v64
    v_and_b32 v64, s3, v50
    v_pk_max_u16 v60, v60, v64
    v_and_b32 v64, s3, v51
    v_pk_max_u16 v60, v60, v64
    v_and_b32 v64, s3, v52
    v_pk_max_u16 v60, v60, v64
    v_lshrrev_b32 v64, 16, v60
    v_and_b32 v60, 0xffff, v60
    v_max_u32 v60, v60, v64

    s_nop 1
    v_max_u32_dpp v60, v60, v60 row_shr:1 row_mask:0xf bank_mask:0xf
    s_nop 1
    v_max_u32_dpp v60, v60, v60 row_shr:2 row_mask:0xf bank_mask:0xf
    s_nop 1
    v_max_u32_dpp v60, v60, v60 row_shr:4 row_mask:0xf bank_mask:0xf
    s_nop 1
    v_max_u32_dpp v60, v60, v60 row_shr:8 row_mask:0xf bank_mask:0xf
    s_nop 1
    v_max_u32_dpp v60, v60, v60 row_bcast:15 row_mask:0xa bank_mask:0xf
    s_nop 1
    v_max_u32_dpp v60, v60, v60 row_bcast:31 row_mask:0xc bank_mask:0xf
    s_nop 1
    v_add_f32_dpp v61, v61, v61 row_shr:1 row_mask:0xf bank_mask:0xf
    s_nop 1
    v_add_f32_dpp v61, v61, v61 row_shr:2 row_mask:0xf bank_mask:0xf
    s_nop 1
    v_add_f32_dpp v61, v61, v61 row_shr:4 row_mask:0xf bank_mask:0xf
    s_nop 1
    v_add_f32_dpp v61, v61, v61 row_shr:8 row_mask:0xf bank_mask:0xf
    s_nop 1
    v_add_f32_dpp v61, v61, v61 row_bcast:15 row_mask:0xa bank_mask:0xf
    s_nop 1
    v_add_f32_dpp v61, v61, v61 row_bcast:31 row_mask:0xc bank_mask:0xf
    s_nop 1
    v_add_f32_dpp v62, v62, v62 row_shr:1 row_mask:0xf bank_mask:0xf
    s_nop 1
    v_add_f32_dpp v62, v62, v62 row_shr:2 row_mask:0xf bank_mask:0xf
    s_nop 1
    v_add_f32_dpp v62, v62, v62 row_shr:4 row_mask:0xf bank_mask:0xf
    s_nop 1
    v_add_f32_dpp v62, v62, v62 row_shr:8 row_mask:0xf bank_mask:0xf
    s_nop 1
    v_add_f32_dpp v62, v62, v62 row_bcast:15 row_mask:0xa bank_mask:0xf
    s_nop 1
    v_add_f32_dpp v62, v62, v62 row_bcast:31 row_mask:0xc bank_mask:0xf
    v_lshrrev_b32 v64, 6, v0
    v_lshlrev_b32 v64, 4, v64
    s_mov_b32 exec_lo, 0
    s_brev_b32 exec_hi, 1
    ds_write_b128 v64, v[60:63] offset:8192
    s_mov_b64 exec, -1
    v_and_b32 v64, 15, v0
    v_lshlrev_b32 v64, 4, v64
    s_waitcnt lgkmcnt(0)
    s_barrier
    ds_read_b128 v[60:63], v64 offset:8192
    s_waitcnt lgkmcnt(0)

    s_nop 0
    v_max_u32_dpp v60, v60, v60 row_ror:1 row_mask:0xf bank_mask:0xf
    v_add_f32_dpp v61, v61, v61 row_ror:1 row_mask:0xf bank_mask:0xf
    v_add_f32_dpp v62, v62, v62 row_ror:1 row_mask:0xf bank_mask:0xf

    s_nop 0
    v_max_u32_dpp v60, v60, v60 row_ror:2 row_mask:0xf bank_mask:0xf
    v_add_f32_dpp v61, v61, v61 row_ror:2 row_mask:0xf bank_mask:0xf
    v_add_f32_dpp v62, v62, v62 row_ror:2 row_mask:0xf bank_mask:0xf

    s_nop 0
    v_max_u32_dpp v60, v60, v60 row_ror:4 row_mask:0xf bank_mask:0xf
    v_add_f32_dpp v61, v61, v61 row_ror:4 row_mask:0xf bank_mask:0xf
    v_add_f32_dpp v62, v62, v62 row_ror:4 row_mask:0xf bank_mask:0xf

    s_nop 0
    v_max_u32_dpp v60, v60, v60 row_ror:8 row_mask:0xf bank_mask:0xf
    v_add_f32_dpp v61, v61, v61 row_ror:8 row_mask:0xf bank_mask:0xf
    v_add_f32_dpp v62, v62, v62 row_ror:8 row_mask:0xf bank_mask:0xf

    v_rsq_f32 v62, v62
    v_mov_b32 v65, 0x4b400000
    v_mul_f32 v62, 0x47decb04, v62
    s_nop 0
    v_readfirstlane_b32 s74, v62

    s_add_u32 s92, s6, 135168
    s_addc_u32 s93, s7, 0
    s_mov_b32 s94, 4096
    s_mov_b32 s95, 0x20000
    s_lshl_b32 s3, s2, 4
    buffer_store_dwordx4 v[60:63], v98, s[92:95], s3 offen
    v_lshlrev_b32 v66, 16, v44
    v_and_b32 v44, 0xffff0000, v44
    v_fma_f32 v66, v66, s74, v65
    v_fma_f32 v44, v44, s74, v65
    v_perm_b32 v44, v44, v66, s55

    v_lshlrev_b32 v66, 16, v45
    v_and_b32 v45, 0xffff0000, v45
    v_fma_f32 v66, v66, s74, v65
    v_fma_f32 v45, v45, s74, v65
    v_perm_b32 v45, v45, v66, s55

    v_lshlrev_b32 v66, 16, v46
    v_and_b32 v46, 0xffff0000, v46
    v_fma_f32 v66, v66, s74, v65
    v_fma_f32 v46, v46, s74, v65
    v_perm_b32 v46, v46, v66, s55

    v_lshlrev_b32 v66, 16, v47
    v_and_b32 v47, 0xffff0000, v47
    v_fma_f32 v66, v66, s74, v65
    v_fma_f32 v47, v47, s74, v65
    v_perm_b32 v47, v47, v66, s55

    v_lshlrev_b32 v66, 16, v48
    v_and_b32 v48, 0xffff0000, v48
    v_fma_f32 v66, v66, s74, v65
    v_fma_f32 v48, v48, s74, v65
    v_perm_b32 v48, v48, v66, s55

    v_lshlrev_b32 v66, 16, v49
    v_and_b32 v49, 0xffff0000, v49
    v_fma_f32 v66, v66, s74, v65
    v_fma_f32 v49, v49, s74, v65
    v_perm_b32 v49, v49, v66, s55

    v_lshlrev_b32 v66, 16, v50
    v_and_b32 v50, 0xffff0000, v50
    v_fma_f32 v66, v66, s74, v65
    v_fma_f32 v50, v50, s74, v65
    v_perm_b32 v50, v50, v66, s55

    v_lshlrev_b32 v66, 16, v51
    v_and_b32 v51, 0xffff0000, v51
    v_fma_f32 v66, v66, s74, v65
    v_fma_f32 v51, v51, s74, v65
    v_perm_b32 v51, v51, v66, s55

    v_lshlrev_b32 v66, 16, v52
    v_and_b32 v52, 0xffff0000, v52
    v_fma_f32 v66, v66, s74, v65
    v_fma_f32 v52, v52, s74, v65
    v_perm_b32 v52, v52, v66, s55

    s_add_u32 s92, s6, s54
    s_addc_u32 s93, s7, 0
    s_mov_b32 s94, 24576
    s_mov_b32 s95, 0x20000
    s_movk_i32 s3, 16384
    buffer_store_dwordx4 v[44:47], v1, s[92:95], 0 offen
    buffer_store_dwordx4 v[48:51], v1, s[92:95], s3 offen
    s_mul_i32 s94, s53, 25424
    s_movk_i32 s3, 24576

    buffer_store_dword v52, v100, s[92:95], s3 offen
    s_nop 1
    v_mov_b32 v100, 0
    buffer_atomic_add v100, v98, s[96:99], 0 offen offset:128 sc0
    s_bitcmp0_b32 s82, 0
    s_cbranch_scc1 L_ska_7
    s_waitcnt vmcnt(14)
    v_mul_hi_u32_u24 v45, s40, v20
    v_mul_hi_u32_u24 v44, s40, v4
    v_mul_hi_u32_u24 v47, s40, v21
    v_mul_hi_u32_u24 v46, s40, v5
    v_mul_hi_u32_u24 v49, s40, v22
    v_mul_hi_u32_u24 v48, s40, v6
    v_mul_hi_u32_u24 v51, s40, v23
    v_mul_hi_u32_u24 v50, s40, v7
    v_and_b32 v45, -2, v45
    v_mad_u32_u24 v4, v44, s43, v4
    v_and_b32 v76, -4, v44
    v_and_b32 v47, -2, v47
    v_mad_u32_u24 v5, v46, s43, v5
    v_and_b32 v77, -4, v46
    v_and_b32 v49, -2, v49
    v_mad_u32_u24 v6, v48, s43, v6
    v_and_b32 v78, -4, v48
    v_and_b32 v51, -2, v51
    v_mad_u32_u24 v7, v50, s43, v7
    v_and_b32 v79, -4, v50
    v_mad_i32_i24 v20, v45, s42, v20
    v_lshl_add_u32 v45, v76, 5, v45
    v_mad_i32_i24 v21, v47, s42, v21
    v_lshl_add_u32 v47, v77, 5, v47
    v_mad_i32_i24 v22, v49, s42, v22
    v_lshl_add_u32 v49, v78, 5, v49
    v_mad_i32_i24 v23, v51, s42, v23
    v_lshl_add_u32 v51, v79, 5, v51
    v_add_u32 v45, v45, v45
    ds_add_rtn_u32 v76, v45, v104
    v_add_u32 v47, v47, v47
    ds_add_rtn_u32 v77, v47, v104
    v_add_u32 v49, v49, v49
    ds_add_rtn_u32 v78, v49, v104
    v_add_u32 v51, v51, v51
    ds_add_rtn_u32 v79, v51, v104
    v_lshlrev_b32 v110, 16, v36
    v_and_b32 v111, 0xffff0000, v36
    v_lshlrev_b32 v112, 16, v37
    v_and_b32 v113, 0xffff0000, v37
    v_mul_f32 v110, s44, v110
    v_mul_f32 v111, s44, v111
    v_mul_f32 v112, s44, v112
    v_mul_f32 v113, s44, v113
    v_fract_f32 v110, v110
    v_fract_f32 v111, v111
    v_fract_f32 v112, v112
    v_fract_f32 v113, v113
    v_cos_f32 v110, v110
    v_cos_f32 v111, v111
    v_cos_f32 v112, v112
    v_cos_f32 v113, v113
    v_lshl_or_b32 v44, v44, 14, v20
    v_perm_b32 v45, v45, v4, s46
    v_bfe_u32 v4, v4, 8, 5

    v_lshl_or_b32 v46, v46, 14, v21
    v_perm_b32 v47, v47, v5, s46
    v_bfe_u32 v5, v5, 8, 5

    v_lshl_or_b32 v48, v48, 14, v22
    v_perm_b32 v49, v49, v6, s46
    v_bfe_u32 v6, v6, 8, 5

    v_lshl_or_b32 v50, v50, 14, v23
    v_perm_b32 v51, v51, v7, s46
    v_bfe_u32 v7, v7, 8, 5

    v_fmaak_f32 v110, v110, v105, 0x4b400010
    v_fmaak_f32 v111, v111, v105, 0x4b400010
    v_fmaak_f32 v112, v112, v105, 0x4b400010
    v_fmaak_f32 v113, v113, v105, 0x4b400010
    v_sub_u32 v110, v110, v4
    v_sub_u32 v111, v111, v5
    v_sub_u32 v112, v112, v6
    v_sub_u32 v113, v113, v7
    v_bfi_b32 v110, 31, v4, v110
    v_bfi_b32 v111, 31, v5, v111
    v_bfi_b32 v112, 31, v6, v112
    v_bfi_b32 v113, 31, v7, v113
    v_perm_b32 v44, v44, v110, s55
    v_perm_b32 v46, v46, v111, s55
    v_perm_b32 v48, v48, v112, s55
    v_perm_b32 v50, v50, v113, s55
    buffer_load_dwordx4 v[20:23], v1, s[12:15], s56 offen nt
    buffer_load_dwordx4 v[4:7], v1, s[8:11], s56 offen nt
    buffer_load_dwordx2 v[36:37], v2, s[16:19], s61 offen nt
L_bka_8:
    s_bitcmp0_b32 s82, 1
    s_cbranch_scc1 L_ska_9
    s_waitcnt vmcnt(14)
    v_mul_hi_u32_u24 v53, s40, v24
    v_mul_hi_u32_u24 v52, s40, v8
    v_mul_hi_u32_u24 v55, s40, v25
    v_mul_hi_u32_u24 v54, s40, v9
    v_mul_hi_u32_u24 v57, s40, v26
    v_mul_hi_u32_u24 v56, s40, v10
    v_mul_hi_u32_u24 v59, s40, v27
    v_mul_hi_u32_u24 v58, s40, v11
    v_and_b32 v53, -2, v53
    v_mad_u32_u24 v8, v52, s43, v8
    v_and_b32 v80, -4, v52
    v_and_b32 v55, -2, v55
    v_mad_u32_u24 v9, v54, s43, v9
    v_and_b32 v81, -4, v54
    v_and_b32 v57, -2, v57
    v_mad_u32_u24 v10, v56, s43, v10
    v_and_b32 v82, -4, v56
    v_and_b32 v59, -2, v59
    v_mad_u32_u24 v11, v58, s43, v11
    v_and_b32 v83, -4, v58
    v_mad_i32_i24 v24, v53, s42, v24
    v_lshl_add_u32 v53, v80, 5, v53
    v_mad_i32_i24 v25, v55, s42, v25
    v_lshl_add_u32 v55, v81, 5, v55
    v_mad_i32_i24 v26, v57, s42, v26
    v_lshl_add_u32 v57, v82, 5, v57
    v_mad_i32_i24 v27, v59, s42, v27
    v_lshl_add_u32 v59, v83, 5, v59
    v_add_u32 v53, v53, v53
    ds_add_rtn_u32 v80, v53, v104
    v_add_u32 v55, v55, v55
    ds_add_rtn_u32 v81, v55, v104
    v_add_u32 v57, v57, v57
    ds_add_rtn_u32 v82, v57, v104
    v_add_u32 v59, v59, v59
    ds_add_rtn_u32 v83, v59, v104
    v_lshlrev_b32 v110, 16, v38
    v_and_b32 v111, 0xffff0000, v38
    v_lshlrev_b32 v112, 16, v39
    v_and_b32 v113, 0xffff0000, v39
    v_mul_f32 v110, s44, v110
    v_mul_f32 v111, s44, v111
    v_mul_f32 v112, s44, v112
    v_mul_f32 v113, s44, v113
    v_fract_f32 v110, v110
    v_fract_f32 v111, v111
    v_fract_f32 v112, v112
    v_fract_f32 v113, v113
    v_cos_f32 v110, v110
    v_cos_f32 v111, v111
    v_cos_f32 v112, v112
    v_cos_f32 v113, v113
    v_lshl_or_b32 v52, v52, 14, v24
    v_perm_b32 v53, v53, v8, s46
    v_bfe_u32 v8, v8, 8, 5

    v_lshl_or_b32 v54, v54, 14, v25
    v_perm_b32 v55, v55, v9, s46
    v_bfe_u32 v9, v9, 8, 5

    v_lshl_or_b32 v56, v56, 14, v26
    v_perm_b32 v57, v57, v10, s46
    v_bfe_u32 v10, v10, 8, 5

    v_lshl_or_b32 v58, v58, 14, v27
    v_perm_b32 v59, v59, v11, s46
    v_bfe_u32 v11, v11, 8, 5

    v_fmaak_f32 v110, v110, v105, 0x4b400010
    v_fmaak_f32 v111, v111, v105, 0x4b400010
    v_fmaak_f32 v112, v112, v105, 0x4b400010
    v_fmaak_f32 v113, v113, v105, 0x4b400010
    v_sub_u32 v110, v110, v8
    v_sub_u32 v111, v111, v9
    v_sub_u32 v112, v112, v10
    v_sub_u32 v113, v113, v11
    v_bfi_b32 v110, 31, v8, v110
    v_bfi_b32 v111, 31, v9, v111
    v_bfi_b32 v112, 31, v10, v112
    v_bfi_b32 v113, 31, v11, v113
    v_perm_b32 v52, v52, v110, s55
    v_perm_b32 v54, v54, v111, s55
    v_perm_b32 v56, v56, v112, s55
    v_perm_b32 v58, v58, v113, s55
    buffer_load_dwordx4 v[24:27], v1, s[12:15], s57 offen nt
    buffer_load_dwordx4 v[8:11], v1, s[8:11], s57 offen nt
    buffer_load_dwordx2 v[38:39], v2, s[16:19], s62 offen nt
L_bka_10:
    s_bitcmp0_b32 s82, 2
    s_cbranch_scc1 L_ska_11
    s_waitcnt vmcnt(14)
    v_mul_hi_u32_u24 v61, s40, v28
    v_mul_hi_u32_u24 v60, s40, v12
    v_mul_hi_u32_u24 v63, s40, v29
    v_mul_hi_u32_u24 v62, s40, v13
    v_mul_hi_u32_u24 v65, s40, v30
    v_mul_hi_u32_u24 v64, s40, v14
    v_mul_hi_u32_u24 v67, s40, v31
    v_mul_hi_u32_u24 v66, s40, v15
    v_and_b32 v61, -2, v61
    v_mad_u32_u24 v12, v60, s43, v12
    v_and_b32 v84, -4, v60
    v_and_b32 v63, -2, v63
    v_mad_u32_u24 v13, v62, s43, v13
    v_and_b32 v85, -4, v62
    v_and_b32 v65, -2, v65
    v_mad_u32_u24 v14, v64, s43, v14
    v_and_b32 v86, -4, v64
    v_and_b32 v67, -2, v67
    v_mad_u32_u24 v15, v66, s43, v15
    v_and_b32 v87, -4, v66
    v_mad_i32_i24 v28, v61, s42, v28
    v_lshl_add_u32 v61, v84, 5, v61
    v_mad_i32_i24 v29, v63, s42, v29
    v_lshl_add_u32 v63, v85, 5, v63
    v_mad_i32_i24 v30, v65, s42, v30
    v_lshl_add_u32 v65, v86, 5, v65
    v_mad_i32_i24 v31, v67, s42, v31
    v_lshl_add_u32 v67, v87, 5, v67
    v_add_u32 v61, v61, v61
    ds_add_rtn_u32 v84, v61, v104
    v_add_u32 v63, v63, v63
    ds_add_rtn_u32 v85, v63, v104
    v_add_u32 v65, v65, v65
    ds_add_rtn_u32 v86, v65, v104
    v_add_u32 v67, v67, v67
    ds_add_rtn_u32 v87, v67, v104
    v_lshlrev_b32 v110, 16, v40
    v_and_b32 v111, 0xffff0000, v40
    v_lshlrev_b32 v112, 16, v41
    v_and_b32 v113, 0xffff0000, v41
    v_mul_f32 v110, s44, v110
    v_mul_f32 v111, s44, v111
    v_mul_f32 v112, s44, v112
    v_mul_f32 v113, s44, v113
    v_fract_f32 v110, v110
    v_fract_f32 v111, v111
    v_fract_f32 v112, v112
    v_fract_f32 v113, v113
    v_cos_f32 v110, v110
    v_cos_f32 v111, v111
    v_cos_f32 v112, v112
    v_cos_f32 v113, v113
    v_lshl_or_b32 v60, v60, 14, v28
    v_perm_b32 v61, v61, v12, s46
    v_bfe_u32 v12, v12, 8, 5

    v_lshl_or_b32 v62, v62, 14, v29
    v_perm_b32 v63, v63, v13, s46
    v_bfe_u32 v13, v13, 8, 5

    v_lshl_or_b32 v64, v64, 14, v30
    v_perm_b32 v65, v65, v14, s46
    v_bfe_u32 v14, v14, 8, 5

    v_lshl_or_b32 v66, v66, 14, v31
    v_perm_b32 v67, v67, v15, s46
    v_bfe_u32 v15, v15, 8, 5

    v_fmaak_f32 v110, v110, v105, 0x4b400010
    v_fmaak_f32 v111, v111, v105, 0x4b400010
    v_fmaak_f32 v112, v112, v105, 0x4b400010
    v_fmaak_f32 v113, v113, v105, 0x4b400010
    v_sub_u32 v110, v110, v12
    v_sub_u32 v111, v111, v13
    v_sub_u32 v112, v112, v14
    v_sub_u32 v113, v113, v15
    v_bfi_b32 v110, 31, v12, v110
    v_bfi_b32 v111, 31, v13, v111
    v_bfi_b32 v112, 31, v14, v112
    v_bfi_b32 v113, 31, v15, v113
    v_perm_b32 v60, v60, v110, s55
    v_perm_b32 v62, v62, v111, s55
    v_perm_b32 v64, v64, v112, s55
    v_perm_b32 v66, v66, v113, s55
    buffer_load_dwordx4 v[28:31], v1, s[12:15], s58 offen nt
    buffer_load_dwordx4 v[12:15], v1, s[8:11], s58 offen nt
    buffer_load_dwordx2 v[40:41], v2, s[16:19], s63 offen nt
L_bka_12:
    s_bitcmp0_b32 s82, 3
    s_cbranch_scc1 L_ska_13
    s_waitcnt vmcnt(14)
    s_mov_b64 exec, s[66:67]
    v_mul_hi_u32_u24 v69, s40, v32
    v_mul_hi_u32_u24 v68, s40, v16
    v_mul_hi_u32_u24 v71, s40, v33
    v_mul_hi_u32_u24 v70, s40, v17
    v_mul_hi_u32_u24 v73, s40, v34
    v_mul_hi_u32_u24 v72, s40, v18
    v_mul_hi_u32_u24 v75, s40, v35
    v_mul_hi_u32_u24 v74, s40, v19
    v_and_b32 v69, -2, v69
    v_mad_u32_u24 v16, v68, s43, v16
    v_and_b32 v88, -4, v68
    v_and_b32 v71, -2, v71
    v_mad_u32_u24 v17, v70, s43, v17
    v_and_b32 v89, -4, v70
    v_and_b32 v73, -2, v73
    v_mad_u32_u24 v18, v72, s43, v18
    v_and_b32 v90, -4, v72
    v_and_b32 v75, -2, v75
    v_mad_u32_u24 v19, v74, s43, v19
    v_and_b32 v91, -4, v74
    v_mad_i32_i24 v32, v69, s42, v32
    v_lshl_add_u32 v69, v88, 5, v69
    v_mad_i32_i24 v33, v71, s42, v33
    v_lshl_add_u32 v71, v89, 5, v71
    v_mad_i32_i24 v34, v73, s42, v34
    v_lshl_add_u32 v73, v90, 5, v73
    v_mad_i32_i24 v35, v75, s42, v35
    v_lshl_add_u32 v75, v91, 5, v75
    v_add_u32 v69, v69, v69
    ds_add_rtn_u32 v88, v69, v104
    v_add_u32 v71, v71, v71
    ds_add_rtn_u32 v89, v71, v104
    v_add_u32 v73, v73, v73
    ds_add_rtn_u32 v90, v73, v104
    v_add_u32 v75, v75, v75
    ds_add_rtn_u32 v91, v75, v104
    v_lshlrev_b32 v110, 16, v42
    v_and_b32 v111, 0xffff0000, v42
    v_lshlrev_b32 v112, 16, v43
    v_and_b32 v113, 0xffff0000, v43
    v_mul_f32 v110, s44, v110
    v_mul_f32 v111, s44, v111
    v_mul_f32 v112, s44, v112
    v_mul_f32 v113, s44, v113
    v_fract_f32 v110, v110
    v_fract_f32 v111, v111
    v_fract_f32 v112, v112
    v_fract_f32 v113, v113
    v_cos_f32 v110, v110
    v_cos_f32 v111, v111
    v_cos_f32 v112, v112
    v_cos_f32 v113, v113
    v_lshl_or_b32 v68, v68, 14, v32
    v_perm_b32 v69, v69, v16, s46
    v_bfe_u32 v16, v16, 8, 5

    v_lshl_or_b32 v70, v70, 14, v33
    v_perm_b32 v71, v71, v17, s46
    v_bfe_u32 v17, v17, 8, 5

    v_lshl_or_b32 v72, v72, 14, v34
    v_perm_b32 v73, v73, v18, s46
    v_bfe_u32 v18, v18, 8, 5

    v_lshl_or_b32 v74, v74, 14, v35
    v_perm_b32 v75, v75, v19, s46
    v_bfe_u32 v19, v19, 8, 5

    v_fmaak_f32 v110, v110, v105, 0x4b400010
    v_fmaak_f32 v111, v111, v105, 0x4b400010
    v_fmaak_f32 v112, v112, v105, 0x4b400010
    v_fmaak_f32 v113, v113, v105, 0x4b400010
    v_sub_u32 v110, v110, v16
    v_sub_u32 v111, v111, v17
    v_sub_u32 v112, v112, v18
    v_sub_u32 v113, v113, v19
    v_bfi_b32 v110, 31, v16, v110
    v_bfi_b32 v111, 31, v17, v111
    v_bfi_b32 v112, 31, v18, v112
    v_bfi_b32 v113, 31, v19, v113
    v_perm_b32 v68, v68, v110, s55
    v_perm_b32 v70, v70, v111, s55
    v_perm_b32 v72, v72, v112, s55
    v_perm_b32 v74, v74, v113, s55
    s_mov_b64 exec, -1
    buffer_load_dwordx4 v[32:35], v1, s[12:15], s59 offen nt
    buffer_load_dwordx4 v[16:19], v1, s[8:11], s59 offen nt
    buffer_load_dwordx2 v[42:43], v2, s[16:19], s64 offen nt
L_bka_14:
    v_readfirstlane_b32 s74, v0
    s_nop 1
    s_cmp_lg_u32 s74, 0
    s_cbranch_scc1 L_ready_16

    s_waitcnt vmcnt(12)
    v_readfirstlane_b32 s74, v100
    s_nop 1
    s_cmp_lg_u32 s74, 0
    s_cbranch_scc1 L_ready_16

    v_mov_b32 v110, 1
    buffer_atomic_add v110, v98, s[96:99], 0 offen offset:64 sc0
    s_waitcnt vmcnt(0)
    v_readfirstlane_b32 s74, v110
    s_nop 1
    s_cmp_lg_u32 s74, 0
    s_cbranch_scc1 L_zno_18

    s_mov_b32 s92, s6
    s_mov_b32 s93, s7
    s_mov_b32 s94, 32784
    s_mov_b32 s95, 0x20000
    v_mov_b32 v110, 0
    v_mov_b32 v111, 0
    v_mov_b32 v112, 0
    v_mov_b32 v113, 0
L_zl_17:
    buffer_store_dwordx4 v[110:113], v1, s[92:95], s74 offen sc0 sc1
    s_add_u32 s74, s74, 1024
    s_cmp_le_u32 s74, 32768
    s_cbranch_scc1 L_zl_17
    v_mov_b32 v114, 1
    s_waitcnt vmcnt(0)
    buffer_atomic_add v114, v98, s[96:99], 0 offen offset:128
L_zno_18:

L_spin_15:
    v_mov_b32 v100, 0
    buffer_atomic_add v100, v98, s[96:99], 0 offen offset:128 sc0
    s_waitcnt vmcnt(0)
    v_readfirstlane_b32 s74, v100
    s_nop 1
    s_cmp_eq_u32 s74, 0
    s_cbranch_scc1 L_spin_15
L_ready_16:

    s_waitcnt lgkmcnt(0)
    s_barrier

    ds_read_b64 v[94:95], v2
    s_waitcnt lgkmcnt(0)
    v_and_b32 v94, 0xffff, v94
    v_and_b32 v95, 0xffff, v95
    v_add_u32 v97, v94, v95
    s_nop 1
    v_add_u32_dpp v97, v97, v97 row_shr:1 row_mask:0xf bank_mask:0xf
    s_nop 1
    v_add_u32_dpp v97, v97, v97 row_shr:2 row_mask:0xf bank_mask:0xf
    s_nop 1
    v_add_u32_dpp v97, v97, v97 row_shr:4 row_mask:0xf bank_mask:0xf
    s_nop 1
    v_add_u32_dpp v97, v97, v97 row_shr:8 row_mask:0xf bank_mask:0xf
    s_nop 1
    v_add_u32_dpp v97, v97, v97 row_bcast:15 row_mask:0xa bank_mask:0xf
    s_nop 1
    v_add_u32_dpp v97, v97, v97 row_bcast:31 row_mask:0xc bank_mask:0xf
    s_mov_b32 exec_lo, 0
    s_brev_b32 exec_hi, 1
    ds_add_rtn_u32 v96, v108, v97
    s_mov_b64 exec, -1

    v_add_u32 v92, v94, v94
    v_add_u32 v93, v95, v95
    v_med3_u32 v92, v94, 2, v92
    v_med3_u32 v93, v95, 2, v93
    v_lshl_or_b32 v92, v93, 16, v92
    v_lshlrev_b32 v93, 2, v0
    buffer_atomic_add v92, v93, s[20:23], 0 offen sc0
    s_waitcnt lgkmcnt(0)
    v_readlane_b32 s77, v96, 63
    v_mul_u32_u24 v114, 65528, v0
    v_sub_u32 v97, v97, v95
    s_sub_u32 s50, s50, s83
    s_sub_u32 s77, s77, s50
    v_add_u32 v97, s77, v97
    v_sub_u32 v96, v97, v94
    v_lshlrev_b32 v111, 16, v97
    v_lshlrev_b32 v110, 16, v96
    ds_write_b64 v2, v[110:111]
    v_mad_i32_i24 v96, v96, -5, v114
    v_mad_i32_i24 v97, v97, -5, v114
    v_add_u32 v97, 32764, v97
    s_add_u32 s50, s50, s84
    s_mov_b32 s28, s82
    s_mov_b32 s29, s83
    s_mov_b32 s30, s84
    s_lshl_b32 s74, s29, 3
    s_lshl_b32 s75, s30, 3
    v_mov_b32 v125, s74
    v_mov_b32 v126, s75
    v_mov_b32 v127, -1

    s_waitcnt lgkmcnt(0)
    s_barrier

    s_mov_b64 exec, 1
    ds_write_b32 v125, v127 offset:16396
    ds_write_b32 v126, v127 offset:16404
    s_mov_b64 exec, -1

    s_bitcmp0_b32 s28, 0
    s_cbranch_scc1 L_skz_19
    v_lshrrev_b32 v110, 16, v45
    ds_read_b32 v110, v110
    v_lshrrev_b32 v111, 16, v47
    ds_read_b32 v111, v111
    v_lshrrev_b32 v112, 16, v49
    ds_read_b32 v112, v112
    v_lshrrev_b32 v113, 16, v51
    ds_read_b32 v113, v113
    s_waitcnt lgkmcnt(3)
    v_add_u32_sdwa v110, v110, v76 dst_sel:DWORD dst_unused:UNUSED_PAD src0_sel:WORD_1 src1_sel:WORD_0
    v_lshlrev_b32 v110, 3, v110
    ds_write_b64 v110, v[44:45] offset:16400

    s_waitcnt lgkmcnt(3)
    v_add_u32_sdwa v111, v111, v77 dst_sel:DWORD dst_unused:UNUSED_PAD src0_sel:WORD_1 src1_sel:WORD_0
    v_lshlrev_b32 v111, 3, v111
    ds_write_b64 v111, v[46:47] offset:16400

    s_waitcnt lgkmcnt(3)
    v_add_u32_sdwa v112, v112, v78 dst_sel:DWORD dst_unused:UNUSED_PAD src0_sel:WORD_1 src1_sel:WORD_0
    v_lshlrev_b32 v112, 3, v112
    ds_write_b64 v112, v[48:49] offset:16400

    s_waitcnt lgkmcnt(3)
    v_add_u32_sdwa v113, v113, v79 dst_sel:DWORD dst_unused:UNUSED_PAD src0_sel:WORD_1 src1_sel:WORD_0
    v_lshlrev_b32 v113, 3, v113
    ds_write_b64 v113, v[50:51] offset:16400

L_skz_19:
    s_bitcmp0_b32 s28, 1
    s_cbranch_scc1 L_skz_20
    v_lshrrev_b32 v110, 16, v53
    ds_read_b32 v110, v110
    v_lshrrev_b32 v111, 16, v55
    ds_read_b32 v111, v111
    v_lshrrev_b32 v112, 16, v57
    ds_read_b32 v112, v112
    v_lshrrev_b32 v113, 16, v59
    ds_read_b32 v113, v113
    s_waitcnt lgkmcnt(3)
    v_add_u32_sdwa v110, v110, v80 dst_sel:DWORD dst_unused:UNUSED_PAD src0_sel:WORD_1 src1_sel:WORD_0
    v_lshlrev_b32 v110, 3, v110
    ds_write_b64 v110, v[52:53] offset:16400

    s_waitcnt lgkmcnt(3)
    v_add_u32_sdwa v111, v111, v81 dst_sel:DWORD dst_unused:UNUSED_PAD src0_sel:WORD_1 src1_sel:WORD_0
    v_lshlrev_b32 v111, 3, v111
    ds_write_b64 v111, v[54:55] offset:16400

    s_waitcnt lgkmcnt(3)
    v_add_u32_sdwa v112, v112, v82 dst_sel:DWORD dst_unused:UNUSED_PAD src0_sel:WORD_1 src1_sel:WORD_0
    v_lshlrev_b32 v112, 3, v112
    ds_write_b64 v112, v[56:57] offset:16400

    s_waitcnt lgkmcnt(3)
    v_add_u32_sdwa v113, v113, v83 dst_sel:DWORD dst_unused:UNUSED_PAD src0_sel:WORD_1 src1_sel:WORD_0
    v_lshlrev_b32 v113, 3, v113
    ds_write_b64 v113, v[58:59] offset:16400

L_skz_20:
    s_bitcmp0_b32 s28, 2
    s_cbranch_scc1 L_skz_21
    v_lshrrev_b32 v110, 16, v61
    ds_read_b32 v110, v110
    v_lshrrev_b32 v111, 16, v63
    ds_read_b32 v111, v111
    v_lshrrev_b32 v112, 16, v65
    ds_read_b32 v112, v112
    v_lshrrev_b32 v113, 16, v67
    ds_read_b32 v113, v113
    s_waitcnt lgkmcnt(3)
    v_add_u32_sdwa v110, v110, v84 dst_sel:DWORD dst_unused:UNUSED_PAD src0_sel:WORD_1 src1_sel:WORD_0
    v_lshlrev_b32 v110, 3, v110
    ds_write_b64 v110, v[60:61] offset:16400

    s_waitcnt lgkmcnt(3)
    v_add_u32_sdwa v111, v111, v85 dst_sel:DWORD dst_unused:UNUSED_PAD src0_sel:WORD_1 src1_sel:WORD_0
    v_lshlrev_b32 v111, 3, v111
    ds_write_b64 v111, v[62:63] offset:16400

    s_waitcnt lgkmcnt(3)
    v_add_u32_sdwa v112, v112, v86 dst_sel:DWORD dst_unused:UNUSED_PAD src0_sel:WORD_1 src1_sel:WORD_0
    v_lshlrev_b32 v112, 3, v112
    ds_write_b64 v112, v[64:65] offset:16400

    s_waitcnt lgkmcnt(3)
    v_add_u32_sdwa v113, v113, v87 dst_sel:DWORD dst_unused:UNUSED_PAD src0_sel:WORD_1 src1_sel:WORD_0
    v_lshlrev_b32 v113, 3, v113
    ds_write_b64 v113, v[66:67] offset:16400

L_skz_21:
    s_bitcmp0_b32 s28, 3
    s_cbranch_scc1 L_skz_22
    s_mov_b64 exec, s[66:67]
    v_lshrrev_b32 v110, 16, v69
    ds_read_b32 v110, v110
    v_lshrrev_b32 v111, 16, v71
    ds_read_b32 v111, v111
    v_lshrrev_b32 v112, 16, v73
    ds_read_b32 v112, v112
    v_lshrrev_b32 v113, 16, v75
    ds_read_b32 v113, v113
    s_waitcnt lgkmcnt(3)
    v_add_u32_sdwa v110, v110, v88 dst_sel:DWORD dst_unused:UNUSED_PAD src0_sel:WORD_1 src1_sel:WORD_0
    v_lshlrev_b32 v110, 3, v110
    ds_write_b64 v110, v[68:69] offset:16400

    s_waitcnt lgkmcnt(3)
    v_add_u32_sdwa v111, v111, v89 dst_sel:DWORD dst_unused:UNUSED_PAD src0_sel:WORD_1 src1_sel:WORD_0
    v_lshlrev_b32 v111, 3, v111
    ds_write_b64 v111, v[70:71] offset:16400

    s_waitcnt lgkmcnt(3)
    v_add_u32_sdwa v112, v112, v90 dst_sel:DWORD dst_unused:UNUSED_PAD src0_sel:WORD_1 src1_sel:WORD_0
    v_lshlrev_b32 v112, 3, v112
    ds_write_b64 v112, v[72:73] offset:16400

    s_waitcnt lgkmcnt(3)
    v_add_u32_sdwa v113, v113, v91 dst_sel:DWORD dst_unused:UNUSED_PAD src0_sel:WORD_1 src1_sel:WORD_0
    v_lshlrev_b32 v113, 3, v113
    ds_write_b64 v113, v[74:75] offset:16400

    s_mov_b64 exec, -1
L_skz_22:
    s_cmp_eq_u32 s49, 0
    s_cbranch_scc1 L_p1epi_6
L_p1loop_5:
    s_mov_b32 s82, s85
    s_mov_b32 s83, s86
    s_mov_b32 s84, s87
    v_mov_b32 v99, 1
    buffer_atomic_add v99, v98, s[96:99], 0 offen sc0
    s_bitcmp0_b32 s82, 0
    s_cbranch_scc1 L_ska_23
    s_waitcnt vmcnt(11)
    v_mul_hi_u32_u24 v45, s40, v20
    v_mul_hi_u32_u24 v44, s40, v4
    v_mul_hi_u32_u24 v47, s40, v21
    v_mul_hi_u32_u24 v46, s40, v5
    v_mul_hi_u32_u24 v49, s40, v22
    v_mul_hi_u32_u24 v48, s40, v6
    v_mul_hi_u32_u24 v51, s40, v23
    v_mul_hi_u32_u24 v50, s40, v7
    v_and_b32 v45, -2, v45
    v_mad_u32_u24 v4, v44, s43, v4
    v_and_b32 v76, -4, v44
    v_and_b32 v47, -2, v47
    v_mad_u32_u24 v5, v46, s43, v5
    v_and_b32 v77, -4, v46
    v_and_b32 v49, -2, v49
    v_mad_u32_u24 v6, v48, s43, v6
    v_and_b32 v78, -4, v48
    v_and_b32 v51, -2, v51
    v_mad_u32_u24 v7, v50, s43, v7
    v_and_b32 v79, -4, v50
    v_mad_i32_i24 v20, v45, s42, v20
    v_lshl_add_u32 v45, v76, 5, v45
    v_mad_i32_i24 v21, v47, s42, v21
    v_lshl_add_u32 v47, v77, 5, v47
    v_mad_i32_i24 v22, v49, s42, v22
    v_lshl_add_u32 v49, v78, 5, v49
    v_mad_i32_i24 v23, v51, s42, v23
    v_lshl_add_u32 v51, v79, 5, v51
    v_add_u32 v45, v45, v45
    ds_add_rtn_u32 v76, v45, v104
    v_add_u32 v47, v47, v47
    ds_add_rtn_u32 v77, v47, v104
    v_add_u32 v49, v49, v49
    ds_add_rtn_u32 v78, v49, v104
    v_add_u32 v51, v51, v51
    ds_add_rtn_u32 v79, v51, v104
    v_lshlrev_b32 v110, 16, v36
    v_and_b32 v111, 0xffff0000, v36
    v_lshlrev_b32 v112, 16, v37
    v_and_b32 v113, 0xffff0000, v37
    v_mul_f32 v110, s44, v110
    v_mul_f32 v111, s44, v111
    v_mul_f32 v112, s44, v112
    v_mul_f32 v113, s44, v113
    v_fract_f32 v110, v110
    v_fract_f32 v111, v111
    v_fract_f32 v112, v112
    v_fract_f32 v113, v113
    v_cos_f32 v110, v110
    v_cos_f32 v111, v111
    v_cos_f32 v112, v112
    v_cos_f32 v113, v113
    v_lshl_or_b32 v44, v44, 14, v20
    v_perm_b32 v45, v45, v4, s46
    v_bfe_u32 v4, v4, 8, 5

    v_lshl_or_b32 v46, v46, 14, v21
    v_perm_b32 v47, v47, v5, s46
    v_bfe_u32 v5, v5, 8, 5

    v_lshl_or_b32 v48, v48, 14, v22
    v_perm_b32 v49, v49, v6, s46
    v_bfe_u32 v6, v6, 8, 5

    v_lshl_or_b32 v50, v50, 14, v23
    v_perm_b32 v51, v51, v7, s46
    v_bfe_u32 v7, v7, 8, 5

    v_fmaak_f32 v110, v110, v105, 0x4b400010
    v_fmaak_f32 v111, v111, v105, 0x4b400010
    v_fmaak_f32 v112, v112, v105, 0x4b400010
    v_fmaak_f32 v113, v113, v105, 0x4b400010
    v_sub_u32 v110, v110, v4
    v_sub_u32 v111, v111, v5
    v_sub_u32 v112, v112, v6
    v_sub_u32 v113, v113, v7
    v_bfi_b32 v110, 31, v4, v110
    v_bfi_b32 v111, 31, v5, v111
    v_bfi_b32 v112, 31, v6, v112
    v_bfi_b32 v113, 31, v7, v113
    v_perm_b32 v44, v44, v110, s55
    v_perm_b32 v46, v46, v111, s55
    v_perm_b32 v48, v48, v112, s55
    v_perm_b32 v50, v50, v113, s55
L_ska_23:
    s_bitcmp0_b32 s82, 1
    s_cbranch_scc1 L_ska_24
    s_waitcnt vmcnt(7)
    v_mul_hi_u32_u24 v53, s40, v24
    v_mul_hi_u32_u24 v52, s40, v8
    v_mul_hi_u32_u24 v55, s40, v25
    v_mul_hi_u32_u24 v54, s40, v9
    v_mul_hi_u32_u24 v57, s40, v26
    v_mul_hi_u32_u24 v56, s40, v10
    v_mul_hi_u32_u24 v59, s40, v27
    v_mul_hi_u32_u24 v58, s40, v11
    v_and_b32 v53, -2, v53
    v_mad_u32_u24 v8, v52, s43, v8
    v_and_b32 v80, -4, v52
    v_and_b32 v55, -2, v55
    v_mad_u32_u24 v9, v54, s43, v9
    v_and_b32 v81, -4, v54
    v_and_b32 v57, -2, v57
    v_mad_u32_u24 v10, v56, s43, v10
    v_and_b32 v82, -4, v56
    v_and_b32 v59, -2, v59
    v_mad_u32_u24 v11, v58, s43, v11
    v_and_b32 v83, -4, v58
    v_mad_i32_i24 v24, v53, s42, v24
    v_lshl_add_u32 v53, v80, 5, v53
    v_mad_i32_i24 v25, v55, s42, v25
    v_lshl_add_u32 v55, v81, 5, v55
    v_mad_i32_i24 v26, v57, s42, v26
    v_lshl_add_u32 v57, v82, 5, v57
    v_mad_i32_i24 v27, v59, s42, v27
    v_lshl_add_u32 v59, v83, 5, v59
    v_add_u32 v53, v53, v53
    ds_add_rtn_u32 v80, v53, v104
    v_add_u32 v55, v55, v55
    ds_add_rtn_u32 v81, v55, v104
    v_add_u32 v57, v57, v57
    ds_add_rtn_u32 v82, v57, v104
    v_add_u32 v59, v59, v59
    ds_add_rtn_u32 v83, v59, v104
    v_lshlrev_b32 v110, 16, v38
    v_and_b32 v111, 0xffff0000, v38
    v_lshlrev_b32 v112, 16, v39
    v_and_b32 v113, 0xffff0000, v39
    v_mul_f32 v110, s44, v110
    v_mul_f32 v111, s44, v111
    v_mul_f32 v112, s44, v112
    v_mul_f32 v113, s44, v113
    v_fract_f32 v110, v110
    v_fract_f32 v111, v111
    v_fract_f32 v112, v112
    v_fract_f32 v113, v113
    v_cos_f32 v110, v110
    v_cos_f32 v111, v111
    v_cos_f32 v112, v112
    v_cos_f32 v113, v113
    v_lshl_or_b32 v52, v52, 14, v24
    v_perm_b32 v53, v53, v8, s46
    v_bfe_u32 v8, v8, 8, 5

    v_lshl_or_b32 v54, v54, 14, v25
    v_perm_b32 v55, v55, v9, s46
    v_bfe_u32 v9, v9, 8, 5

    v_lshl_or_b32 v56, v56, 14, v26
    v_perm_b32 v57, v57, v10, s46
    v_bfe_u32 v10, v10, 8, 5

    v_lshl_or_b32 v58, v58, 14, v27
    v_perm_b32 v59, v59, v11, s46
    v_bfe_u32 v11, v11, 8, 5

    v_fmaak_f32 v110, v110, v105, 0x4b400010
    v_fmaak_f32 v111, v111, v105, 0x4b400010
    v_fmaak_f32 v112, v112, v105, 0x4b400010
    v_fmaak_f32 v113, v113, v105, 0x4b400010
    v_sub_u32 v110, v110, v8
    v_sub_u32 v111, v111, v9
    v_sub_u32 v112, v112, v10
    v_sub_u32 v113, v113, v11
    v_bfi_b32 v110, 31, v8, v110
    v_bfi_b32 v111, 31, v9, v111
    v_bfi_b32 v112, 31, v10, v112
    v_bfi_b32 v113, 31, v11, v113
    v_perm_b32 v52, v52, v110, s55
    v_perm_b32 v54, v54, v111, s55
    v_perm_b32 v56, v56, v112, s55
    v_perm_b32 v58, v58, v113, s55
L_ska_24:
    s_waitcnt vmcnt(1)
    s_waitcnt vmcnt(0)
    v_cmp_eq_u32 vcc, 0, v0
    s_mov_b64 exec, vcc
    ds_write_b32 v108, v99 offset:8
    s_mov_b64 exec, -1
    s_waitcnt vmcnt(1)
    v_lshrrev_b32 v93, 16, v92
    v_and_b32 v92, 0xffff, v92
    v_add_u32 v110, v92, v94
    v_mad_u32_u24 v92, v92, 5, v96
    v_add_u32 v111, v93, v95
    v_mad_u32_u24 v93, v93, 5, v97
    v_max_u32 v110, v110, v111
    v_cmp_le_u32 vcc, s48, v110
    s_cbranch_vccnz L_full_25
L_fback_26:
    ds_write_b64 v2, v[92:93] offset:8192

    s_waitcnt lgkmcnt(0)
    s_barrier
    ds_read_b32 v111, v108 offset:8
    s_waitcnt lgkmcnt(0)
    v_readfirstlane_b32 s41, v111
    s_nop 1

    s_add_u32 s41, s41, 416
    s_sub_u32 s78, s41, 2997
    s_lshr_b32 s79, s78, 1
    s_add_u32 s79, s79, 2997
    s_and_b32 s86, s78, 1
    s_lshl_b32 s86, s86, 1
    s_add_u32 s87, s86, 2
    s_cmp_lt_u32 s41, 2997
    s_cselect_b32 s41, s41, s79
    s_cmovk_i32 s86, 0
    s_cmovk_i32 s87, 4

    s_mul_i32 s78, s41, 16384
    s_add_u32 s49, s78, 16384
    s_cmp_ge_u32 s41, 3125
    s_cmovk_i32 s49, 0
    s_cmovk_i32 s78, 0
    s_lshl_b32 s10, s49, 2
    s_lshl_b32 s14, s49, 2
    s_lshl_b32 s18, s49, 1
    s_sub_u32 s79, s87, s86
    s_bfm_b32 s85, s79, s86
    s_lshl_b32 s86, s86, 12
    s_lshl_b32 s87, s87, 12
    s_min_u32 s87, s87, 16384

    s_add_u32 s79, s78, 0
    s_bitcmp1_b32 s85, 0
    s_cselect_b32 s79, s79, 0x1ff00000
    s_lshl_b32 s56, s79, 2
    s_lshl_b32 s61, s79, 1

    s_add_u32 s79, s78, 4096
    s_bitcmp1_b32 s85, 1
    s_cselect_b32 s79, s79, 0x1ff00000
    s_lshl_b32 s57, s79, 2
    s_lshl_b32 s62, s79, 1

    s_add_u32 s79, s78, 8192
    s_bitcmp1_b32 s85, 2
    s_cselect_b32 s79, s79, 0x1ff00000
    s_lshl_b32 s58, s79, 2
    s_lshl_b32 s63, s79, 1

    s_add_u32 s79, s78, 12288
    s_bitcmp1_b32 s85, 3
    s_cselect_b32 s79, s79, 0x1ff00000
    s_lshl_b32 s59, s79, 2
    s_lshl_b32 s64, s79, 1

    s_bitcmp0_b32 s28, 0
    s_cbranch_scc1 L_skw_27
    ds_read_b64 v[110:111], v2 offset:16400
    ds_read_b64 v[112:113], v2 offset:16408
    ds_read_b64 v[114:115], v2 offset:16392

    ds_read_b64 v[118:119], v2 offset:24592
    ds_read_b64 v[120:121], v2 offset:24600
    ds_read_b64 v[122:123], v2 offset:24584

    s_waitcnt lgkmcnt(3)
    v_lshrrev_b32 v116, 16, v111
    ds_read_b32 v116, v116 offset:8192

    s_waitcnt lgkmcnt(1)
    v_lshrrev_b32 v124, 16, v119
    ds_read_b32 v124, v124 offset:8192

    v_cmp_ne_u32_sdwa s[80:81], v111, v113 src0_sel:WORD_1 src1_sel:WORD_1
    v_cmp_ne_u32_sdwa vcc, v111, v115 src0_sel:WORD_1 src1_sel:WORD_1
    v_alignbyte_b32 v114, v115, v114, 2
    s_mov_b32 s54, -3
    v_alignbyte_b32 v111, v111, v110, 1
    v_perm_b32 v110, v110, v114, s47
    s_waitcnt lgkmcnt(1)
    v_add3_u32 v116, v116, v106, s54
    v_sub_u32 v117, 0, v116
    v_and_b32 v117, 3, v117
    s_mov_b64 exec, s[80:81]
    v_mov_b32 v117, 0
    v_mov_b32 v112, 0
    s_mov_b64 exec, vcc
    v_mov_b32 v117, 3

    s_mov_b64 exec, -1
    v_alignbyte_b32 v110, v111, v110, v117
    v_alignbyte_b32 v111, v112, v111, v117
    v_add_u32 v116, v116, v117

    buffer_store_dwordx2 v[110:111], v116, s[24:27], 0 offen
    v_cmp_ne_u32_sdwa s[80:81], v119, v121 src0_sel:WORD_1 src1_sel:WORD_1
    v_cmp_ne_u32_sdwa vcc, v119, v123 src0_sel:WORD_1 src1_sel:WORD_1
    v_alignbyte_b32 v122, v123, v122, 2
    s_mov_b32 s54, 5117
    v_alignbyte_b32 v119, v119, v118, 1
    v_perm_b32 v118, v118, v122, s47
    s_waitcnt lgkmcnt(0)
    v_add3_u32 v124, v124, v106, s54
    v_sub_u32 v125, 0, v124
    v_and_b32 v125, 3, v125
    s_mov_b64 exec, s[80:81]
    v_mov_b32 v125, 0
    v_mov_b32 v120, 0
    s_mov_b64 exec, vcc
    v_mov_b32 v125, 3

    s_mov_b64 exec, -1
    v_alignbyte_b32 v118, v119, v118, v125
    v_alignbyte_b32 v119, v120, v119, v125
    v_add_u32 v124, v124, v125

    buffer_store_dwordx2 v[118:119], v124, s[24:27], 0 offen
L_skw_27:
    s_bitcmp0_b32 s28, 0
    s_cbranch_scc1 L_skw_28
    ds_read_b64 v[110:111], v2 offset:32784
    ds_read_b64 v[112:113], v2 offset:32792
    ds_read_b64 v[114:115], v2 offset:32776

    ds_read_b64 v[118:119], v2 offset:40976
    ds_read_b64 v[120:121], v2 offset:40984
    ds_read_b64 v[122:123], v2 offset:40968

    s_waitcnt lgkmcnt(3)
    v_lshrrev_b32 v116, 16, v111
    ds_read_b32 v116, v116 offset:8192

    s_waitcnt lgkmcnt(1)
    v_lshrrev_b32 v124, 16, v119
    ds_read_b32 v124, v124 offset:8192

    v_cmp_ne_u32_sdwa s[80:81], v111, v113 src0_sel:WORD_1 src1_sel:WORD_1
    v_cmp_ne_u32_sdwa vcc, v111, v115 src0_sel:WORD_1 src1_sel:WORD_1
    v_alignbyte_b32 v114, v115, v114, 2
    s_mov_b32 s54, 10237
    v_alignbyte_b32 v111, v111, v110, 1
    v_perm_b32 v110, v110, v114, s47
    s_waitcnt lgkmcnt(1)
    v_add3_u32 v116, v116, v106, s54
    v_sub_u32 v117, 0, v116
    v_and_b32 v117, 3, v117
    s_mov_b64 exec, s[80:81]
    v_mov_b32 v117, 0
    v_mov_b32 v112, 0
    s_mov_b64 exec, vcc
    v_mov_b32 v117, 3

    s_mov_b64 exec, -1
    v_alignbyte_b32 v110, v111, v110, v117
    v_alignbyte_b32 v111, v112, v111, v117
    v_add_u32 v116, v116, v117

    buffer_store_dwordx2 v[110:111], v116, s[24:27], 0 offen
    v_cmp_ne_u32_sdwa s[80:81], v119, v121 src0_sel:WORD_1 src1_sel:WORD_1
    v_cmp_ne_u32_sdwa vcc, v119, v123 src0_sel:WORD_1 src1_sel:WORD_1
    v_alignbyte_b32 v122, v123, v122, 2
    s_mov_b32 s54, 15357
    v_alignbyte_b32 v119, v119, v118, 1
    v_perm_b32 v118, v118, v122, s47
    s_waitcnt lgkmcnt(0)
    v_add3_u32 v124, v124, v106, s54
    v_sub_u32 v125, 0, v124
    v_and_b32 v125, 3, v125
    s_mov_b64 exec, s[80:81]
    v_mov_b32 v125, 0
    v_mov_b32 v120, 0
    s_mov_b64 exec, vcc
    v_mov_b32 v125, 3

    s_mov_b64 exec, -1
    v_alignbyte_b32 v118, v119, v118, v125
    v_alignbyte_b32 v119, v120, v119, v125
    v_add_u32 v124, v124, v125

    buffer_store_dwordx2 v[118:119], v124, s[24:27], 0 offen
L_skw_28:
    s_bitcmp0_b32 s82, 2
    s_cbranch_scc1 L_ska_29
    v_mul_hi_u32_u24 v61, s40, v28
    v_mul_hi_u32_u24 v60, s40, v12
    v_mul_hi_u32_u24 v63, s40, v29
    v_mul_hi_u32_u24 v62, s40, v13
    v_mul_hi_u32_u24 v65, s40, v30
    v_mul_hi_u32_u24 v64, s40, v14
    v_mul_hi_u32_u24 v67, s40, v31
    v_mul_hi_u32_u24 v66, s40, v15
    v_and_b32 v61, -2, v61
    v_mad_u32_u24 v12, v60, s43, v12
    v_and_b32 v84, -4, v60
    v_and_b32 v63, -2, v63
    v_mad_u32_u24 v13, v62, s43, v13
    v_and_b32 v85, -4, v62
    v_and_b32 v65, -2, v65
    v_mad_u32_u24 v14, v64, s43, v14
    v_and_b32 v86, -4, v64
    v_and_b32 v67, -2, v67
    v_mad_u32_u24 v15, v66, s43, v15
    v_and_b32 v87, -4, v66
    v_mad_i32_i24 v28, v61, s42, v28
    v_lshl_add_u32 v61, v84, 5, v61
    v_mad_i32_i24 v29, v63, s42, v29
    v_lshl_add_u32 v63, v85, 5, v63
    v_mad_i32_i24 v30, v65, s42, v30
    v_lshl_add_u32 v65, v86, 5, v65
    v_mad_i32_i24 v31, v67, s42, v31
    v_lshl_add_u32 v67, v87, 5, v67
    v_add_u32 v61, v61, v61
    ds_add_rtn_u32 v84, v61, v104
    v_add_u32 v63, v63, v63
    ds_add_rtn_u32 v85, v63, v104
    v_add_u32 v65, v65, v65
    ds_add_rtn_u32 v86, v65, v104
    v_add_u32 v67, v67, v67
    ds_add_rtn_u32 v87, v67, v104
    v_lshlrev_b32 v110, 16, v40
    v_and_b32 v111, 0xffff0000, v40
    v_lshlrev_b32 v112, 16, v41
    v_and_b32 v113, 0xffff0000, v41
    v_mul_f32 v110, s44, v110
    v_mul_f32 v111, s44, v111
    v_mul_f32 v112, s44, v112
    v_mul_f32 v113, s44, v113
    v_fract_f32 v110, v110
    v_fract_f32 v111, v111
    v_fract_f32 v112, v112
    v_fract_f32 v113, v113
    v_cos_f32 v110, v110
    v_cos_f32 v111, v111
    v_cos_f32 v112, v112
    v_cos_f32 v113, v113
    v_lshl_or_b32 v60, v60, 14, v28
    v_perm_b32 v61, v61, v12, s46
    v_bfe_u32 v12, v12, 8, 5

    v_lshl_or_b32 v62, v62, 14, v29
    v_perm_b32 v63, v63, v13, s46
    v_bfe_u32 v13, v13, 8, 5

    v_lshl_or_b32 v64, v64, 14, v30
    v_perm_b32 v65, v65, v14, s46
    v_bfe_u32 v14, v14, 8, 5

    v_lshl_or_b32 v66, v66, 14, v31
    v_perm_b32 v67, v67, v15, s46
    v_bfe_u32 v15, v15, 8, 5

    v_fmaak_f32 v110, v110, v105, 0x4b400010
    v_fmaak_f32 v111, v111, v105, 0x4b400010
    v_fmaak_f32 v112, v112, v105, 0x4b400010
    v_fmaak_f32 v113, v113, v105, 0x4b400010
    v_sub_u32 v110, v110, v12
    v_sub_u32 v111, v111, v13
    v_sub_u32 v112, v112, v14
    v_sub_u32 v113, v113, v15
    v_bfi_b32 v110, 31, v12, v110
    v_bfi_b32 v111, 31, v13, v111
    v_bfi_b32 v112, 31, v14, v112
    v_bfi_b32 v113, 31, v15, v113
    v_perm_b32 v60, v60, v110, s55
    v_perm_b32 v62, v62, v111, s55
    v_perm_b32 v64, v64, v112, s55
    v_perm_b32 v66, v66, v113, s55
L_ska_29:
    s_bitcmp0_b32 s28, 1
    s_cbranch_scc1 L_skw_30
    v_add_u32 v107, 32768, v2
    ds_read_b64 v[110:111], v107 offset:16400
    ds_read_b64 v[112:113], v107 offset:16408
    ds_read_b64 v[114:115], v107 offset:16392

    ds_read_b64 v[118:119], v107 offset:24592
    ds_read_b64 v[120:121], v107 offset:24600
    ds_read_b64 v[122:123], v107 offset:24584

    s_waitcnt lgkmcnt(3)
    v_lshrrev_b32 v116, 16, v111
    ds_read_b32 v116, v116 offset:8192

    s_waitcnt lgkmcnt(1)
    v_lshrrev_b32 v124, 16, v119
    ds_read_b32 v124, v124 offset:8192

    v_cmp_ne_u32_sdwa s[80:81], v111, v113 src0_sel:WORD_1 src1_sel:WORD_1
    v_cmp_ne_u32_sdwa vcc, v111, v115 src0_sel:WORD_1 src1_sel:WORD_1
    v_alignbyte_b32 v114, v115, v114, 2
    s_mov_b32 s54, 20477
    v_alignbyte_b32 v111, v111, v110, 1
    v_perm_b32 v110, v110, v114, s47
    s_waitcnt lgkmcnt(1)
    v_add3_u32 v116, v116, v106, s54
    v_sub_u32 v117, 0, v116
    v_and_b32 v117, 3, v117
    s_mov_b64 exec, s[80:81]
    v_mov_b32 v117, 0
    v_mov_b32 v112, 0
    s_mov_b64 exec, vcc
    v_mov_b32 v117, 3

    s_mov_b64 exec, -1
    v_alignbyte_b32 v110, v111, v110, v117
    v_alignbyte_b32 v111, v112, v111, v117
    v_add_u32 v116, v116, v117

    buffer_store_dwordx2 v[110:111], v116, s[24:27], 0 offen
    v_cmp_ne_u32_sdwa s[80:81], v119, v121 src0_sel:WORD_1 src1_sel:WORD_1
    v_cmp_ne_u32_sdwa vcc, v119, v123 src0_sel:WORD_1 src1_sel:WORD_1
    v_alignbyte_b32 v122, v123, v122, 2
    s_mov_b32 s54, 25597
    v_alignbyte_b32 v119, v119, v118, 1
    v_perm_b32 v118, v118, v122, s47
    s_waitcnt lgkmcnt(0)
    v_add3_u32 v124, v124, v106, s54
    v_sub_u32 v125, 0, v124
    v_and_b32 v125, 3, v125
    s_mov_b64 exec, s[80:81]
    v_mov_b32 v125, 0
    v_mov_b32 v120, 0
    s_mov_b64 exec, vcc
    v_mov_b32 v125, 3

    s_mov_b64 exec, -1
    v_alignbyte_b32 v118, v119, v118, v125
    v_alignbyte_b32 v119, v120, v119, v125
    v_add_u32 v124, v124, v125

    buffer_store_dwordx2 v[118:119], v124, s[24:27], 0 offen
L_skw_30:
    s_bitcmp0_b32 s28, 1
    s_cbranch_scc1 L_skw_31
    v_add_u32 v107, 32768, v2
    ds_read_b64 v[110:111], v107 offset:32784
    ds_read_b64 v[112:113], v107 offset:32792
    ds_read_b64 v[114:115], v107 offset:32776

    ds_read_b64 v[118:119], v107 offset:40976
    ds_read_b64 v[120:121], v107 offset:40984
    ds_read_b64 v[122:123], v107 offset:40968

    s_waitcnt lgkmcnt(3)
    v_lshrrev_b32 v116, 16, v111
    ds_read_b32 v116, v116 offset:8192

    s_waitcnt lgkmcnt(1)
    v_lshrrev_b32 v124, 16, v119
    ds_read_b32 v124, v124 offset:8192

    v_cmp_ne_u32_sdwa s[80:81], v111, v113 src0_sel:WORD_1 src1_sel:WORD_1
    v_cmp_ne_u32_sdwa vcc, v111, v115 src0_sel:WORD_1 src1_sel:WORD_1
    v_alignbyte_b32 v114, v115, v114, 2
    s_mov_b32 s54, 30717
    v_alignbyte_b32 v111, v111, v110, 1
    v_perm_b32 v110, v110, v114, s47
    s_waitcnt lgkmcnt(1)
    v_add3_u32 v116, v116, v106, s54
    v_sub_u32 v117, 0, v116
    v_and_b32 v117, 3, v117
    s_mov_b64 exec, s[80:81]
    v_mov_b32 v117, 0
    v_mov_b32 v112, 0
    s_mov_b64 exec, vcc
    v_mov_b32 v117, 3

    s_mov_b64 exec, -1
    v_alignbyte_b32 v110, v111, v110, v117
    v_alignbyte_b32 v111, v112, v111, v117
    v_add_u32 v116, v116, v117

    buffer_store_dwordx2 v[110:111], v116, s[24:27], 0 offen
    v_cmp_ne_u32_sdwa s[80:81], v119, v121 src0_sel:WORD_1 src1_sel:WORD_1
    v_cmp_ne_u32_sdwa vcc, v119, v123 src0_sel:WORD_1 src1_sel:WORD_1
    v_alignbyte_b32 v122, v123, v122, 2
    s_mov_b32 s54, 35837
    v_alignbyte_b32 v119, v119, v118, 1
    v_perm_b32 v118, v118, v122, s47
    s_waitcnt lgkmcnt(0)
    v_add3_u32 v124, v124, v106, s54
    v_sub_u32 v125, 0, v124
    v_and_b32 v125, 3, v125
    s_mov_b64 exec, s[80:81]
    v_mov_b32 v125, 0
    v_mov_b32 v120, 0
    s_mov_b64 exec, vcc
    v_mov_b32 v125, 3

    s_mov_b64 exec, -1
    v_alignbyte_b32 v118, v119, v118, v125
    v_alignbyte_b32 v119, v120, v119, v125
    v_add_u32 v124, v124, v125

    buffer_store_dwordx2 v[118:119], v124, s[24:27], 0 offen
L_skw_31:
    s_bitcmp0_b32 s28, 2
    s_cbranch_scc1 L_skw_32
    v_add_u32 v107, 65536, v2
    ds_read_b64 v[110:111], v107 offset:16400
    ds_read_b64 v[112:113], v107 offset:16408
    ds_read_b64 v[114:115], v107 offset:16392

    ds_read_b64 v[118:119], v107 offset:24592
    ds_read_b64 v[120:121], v107 offset:24600
    ds_read_b64 v[122:123], v107 offset:24584

    s_waitcnt lgkmcnt(3)
    v_lshrrev_b32 v116, 16, v111
    ds_read_b32 v116, v116 offset:8192

    s_waitcnt lgkmcnt(1)
    v_lshrrev_b32 v124, 16, v119
    ds_read_b32 v124, v124 offset:8192

    v_cmp_ne_u32_sdwa s[80:81], v111, v113 src0_sel:WORD_1 src1_sel:WORD_1
    v_cmp_ne_u32_sdwa vcc, v111, v115 src0_sel:WORD_1 src1_sel:WORD_1
    v_alignbyte_b32 v114, v115, v114, 2
    s_mov_b32 s54, 40957
    v_alignbyte_b32 v111, v111, v110, 1
    v_perm_b32 v110, v110, v114, s47
    s_waitcnt lgkmcnt(1)
    v_add3_u32 v116, v116, v106, s54
    v_sub_u32 v117, 0, v116
    v_and_b32 v117, 3, v117
    s_mov_b64 exec, s[80:81]
    v_mov_b32 v117, 0
    v_mov_b32 v112, 0
    s_mov_b64 exec, vcc
    v_mov_b32 v117, 3

    s_mov_b64 exec, -1
    v_alignbyte_b32 v110, v111, v110, v117
    v_alignbyte_b32 v111, v112, v111, v117
    v_add_u32 v116, v116, v117

    buffer_store_dwordx2 v[110:111], v116, s[24:27], 0 offen
    v_cmp_ne_u32_sdwa s[80:81], v119, v121 src0_sel:WORD_1 src1_sel:WORD_1
    v_cmp_ne_u32_sdwa vcc, v119, v123 src0_sel:WORD_1 src1_sel:WORD_1
    v_alignbyte_b32 v122, v123, v122, 2
    s_mov_b32 s54, 46077
    v_alignbyte_b32 v119, v119, v118, 1
    v_perm_b32 v118, v118, v122, s47
    s_waitcnt lgkmcnt(0)
    v_add3_u32 v124, v124, v106, s54
    v_sub_u32 v125, 0, v124
    v_and_b32 v125, 3, v125
    s_mov_b64 exec, s[80:81]
    v_mov_b32 v125, 0
    v_mov_b32 v120, 0
    s_mov_b64 exec, vcc
    v_mov_b32 v125, 3

    s_mov_b64 exec, -1
    v_alignbyte_b32 v118, v119, v118, v125
    v_alignbyte_b32 v119, v120, v119, v125
    v_add_u32 v124, v124, v125

    buffer_store_dwordx2 v[118:119], v124, s[24:27], 0 offen
L_skw_32:
    s_bitcmp0_b32 s82, 3
    s_cbranch_scc1 L_ska_33
    s_mov_b64 exec, s[66:67]
    v_mul_hi_u32_u24 v69, s40, v32
    v_mul_hi_u32_u24 v68, s40, v16
    v_mul_hi_u32_u24 v71, s40, v33
    v_mul_hi_u32_u24 v70, s40, v17
    v_mul_hi_u32_u24 v73, s40, v34
    v_mul_hi_u32_u24 v72, s40, v18
    v_mul_hi_u32_u24 v75, s40, v35
    v_mul_hi_u32_u24 v74, s40, v19
    v_and_b32 v69, -2, v69
    v_mad_u32_u24 v16, v68, s43, v16
    v_and_b32 v88, -4, v68
    v_and_b32 v71, -2, v71
    v_mad_u32_u24 v17, v70, s43, v17
    v_and_b32 v89, -4, v70
    v_and_b32 v73, -2, v73
    v_mad_u32_u24 v18, v72, s43, v18
    v_and_b32 v90, -4, v72
    v_and_b32 v75, -2, v75
    v_mad_u32_u24 v19, v74, s43, v19
    v_and_b32 v91, -4, v74
    v_mad_i32_i24 v32, v69, s42, v32
    v_lshl_add_u32 v69, v88, 5, v69
    v_mad_i32_i24 v33, v71, s42, v33
    v_lshl_add_u32 v71, v89, 5, v71
    v_mad_i32_i24 v34, v73, s42, v34
    v_lshl_add_u32 v73, v90, 5, v73
    v_mad_i32_i24 v35, v75, s42, v35
    v_lshl_add_u32 v75, v91, 5, v75
    v_add_u32 v69, v69, v69
    ds_add_rtn_u32 v88, v69, v104
    v_add_u32 v71, v71, v71
    ds_add_rtn_u32 v89, v71, v104
    v_add_u32 v73, v73, v73
    ds_add_rtn_u32 v90, v73, v104
    v_add_u32 v75, v75, v75
    ds_add_rtn_u32 v91, v75, v104
    v_lshlrev_b32 v110, 16, v42
    v_and_b32 v111, 0xffff0000, v42
    v_lshlrev_b32 v112, 16, v43
    v_and_b32 v113, 0xffff0000, v43
    v_mul_f32 v110, s44, v110
    v_mul_f32 v111, s44, v111
    v_mul_f32 v112, s44, v112
    v_mul_f32 v113, s44, v113
    v_fract_f32 v110, v110
    v_fract_f32 v111, v111
    v_fract_f32 v112, v112
    v_fract_f32 v113, v113
    v_cos_f32 v110, v110
    v_cos_f32 v111, v111
    v_cos_f32 v112, v112
    v_cos_f32 v113, v113
    v_lshl_or_b32 v68, v68, 14, v32
    v_perm_b32 v69, v69, v16, s46
    v_bfe_u32 v16, v16, 8, 5

    v_lshl_or_b32 v70, v70, 14, v33
    v_perm_b32 v71, v71, v17, s46
    v_bfe_u32 v17, v17, 8, 5

    v_lshl_or_b32 v72, v72, 14, v34
    v_perm_b32 v73, v73, v18, s46
    v_bfe_u32 v18, v18, 8, 5

    v_lshl_or_b32 v74, v74, 14, v35
    v_perm_b32 v75, v75, v19, s46
    v_bfe_u32 v19, v19, 8, 5

    v_fmaak_f32 v110, v110, v105, 0x4b400010
    v_fmaak_f32 v111, v111, v105, 0x4b400010
    v_fmaak_f32 v112, v112, v105, 0x4b400010
    v_fmaak_f32 v113, v113, v105, 0x4b400010
    v_sub_u32 v110, v110, v16
    v_sub_u32 v111, v111, v17
    v_sub_u32 v112, v112, v18
    v_sub_u32 v113, v113, v19
    v_bfi_b32 v110, 31, v16, v110
    v_bfi_b32 v111, 31, v17, v111
    v_bfi_b32 v112, 31, v18, v112
    v_bfi_b32 v113, 31, v19, v113
    v_perm_b32 v68, v68, v110, s55
    v_perm_b32 v70, v70, v111, s55
    v_perm_b32 v72, v72, v112, s55
    v_perm_b32 v74, v74, v113, s55
    s_mov_b64 exec, -1
L_ska_33:
    s_bitcmp0_b32 s28, 2
    s_cbranch_scc1 L_skw_34
    v_add_u32 v107, 65536, v2
    ds_read_b64 v[110:111], v107 offset:32784
    ds_read_b64 v[112:113], v107 offset:32792
    ds_read_b64 v[114:115], v107 offset:32776

    ds_read_b64 v[118:119], v107 offset:40976
    ds_read_b64 v[120:121], v107 offset:40984
    ds_read_b64 v[122:123], v107 offset:40968

    s_waitcnt lgkmcnt(3)
    v_lshrrev_b32 v116, 16, v111
    ds_read_b32 v116, v116 offset:8192

    s_waitcnt lgkmcnt(1)
    v_lshrrev_b32 v124, 16, v119
    ds_read_b32 v124, v124 offset:8192

    v_cmp_ne_u32_sdwa s[80:81], v111, v113 src0_sel:WORD_1 src1_sel:WORD_1
    v_cmp_ne_u32_sdwa vcc, v111, v115 src0_sel:WORD_1 src1_sel:WORD_1
    v_alignbyte_b32 v114, v115, v114, 2
    s_mov_b32 s54, 51197
    v_alignbyte_b32 v111, v111, v110, 1
    v_perm_b32 v110, v110, v114, s47
    s_waitcnt lgkmcnt(1)
    v_add3_u32 v116, v116, v106, s54
    v_sub_u32 v117, 0, v116
    v_and_b32 v117, 3, v117
    s_mov_b64 exec, s[80:81]
    v_mov_b32 v117, 0
    v_mov_b32 v112, 0
    s_mov_b64 exec, vcc
    v_mov_b32 v117, 3

    s_mov_b64 exec, -1
    v_alignbyte_b32 v110, v111, v110, v117
    v_alignbyte_b32 v111, v112, v111, v117
    v_add_u32 v116, v116, v117

    buffer_store_dwordx2 v[110:111], v116, s[24:27], 0 offen
    v_cmp_ne_u32_sdwa s[80:81], v119, v121 src0_sel:WORD_1 src1_sel:WORD_1
    v_cmp_ne_u32_sdwa vcc, v119, v123 src0_sel:WORD_1 src1_sel:WORD_1
    v_alignbyte_b32 v122, v123, v122, 2
    s_mov_b32 s54, 56317
    v_alignbyte_b32 v119, v119, v118, 1
    v_perm_b32 v118, v118, v122, s47
    s_waitcnt lgkmcnt(0)
    v_add3_u32 v124, v124, v106, s54
    v_sub_u32 v125, 0, v124
    v_and_b32 v125, 3, v125
    s_mov_b64 exec, s[80:81]
    v_mov_b32 v125, 0
    v_mov_b32 v120, 0
    s_mov_b64 exec, vcc
    v_mov_b32 v125, 3

    s_mov_b64 exec, -1
    v_alignbyte_b32 v118, v119, v118, v125
    v_alignbyte_b32 v119, v120, v119, v125
    v_add_u32 v124, v124, v125

    buffer_store_dwordx2 v[118:119], v124, s[24:27], 0 offen
L_skw_34:
    s_bitcmp0_b32 s28, 3
    s_cbranch_scc1 L_skw_35
    v_add_u32 v107, 98304, v2
    ds_read_b64 v[110:111], v107 offset:16400
    ds_read_b64 v[112:113], v107 offset:16408
    ds_read_b64 v[114:115], v107 offset:16392

    ds_read_b64 v[118:119], v107 offset:24592
    ds_read_b64 v[120:121], v107 offset:24600
    ds_read_b64 v[122:123], v107 offset:24584

    s_waitcnt lgkmcnt(3)
    v_lshrrev_b32 v116, 16, v111
    ds_read_b32 v116, v116 offset:8192

    s_waitcnt lgkmcnt(1)
    v_lshrrev_b32 v124, 16, v119
    ds_read_b32 v124, v124 offset:8192

    v_cmp_ne_u32_sdwa s[80:81], v111, v113 src0_sel:WORD_1 src1_sel:WORD_1
    v_cmp_ne_u32_sdwa vcc, v111, v115 src0_sel:WORD_1 src1_sel:WORD_1
    v_alignbyte_b32 v114, v115, v114, 2
    s_mov_b32 s54, 61437
    v_alignbyte_b32 v111, v111, v110, 1
    v_perm_b32 v110, v110, v114, s47
    s_waitcnt lgkmcnt(1)
    v_add3_u32 v116, v116, v106, s54
    v_sub_u32 v117, 0, v116
    v_and_b32 v117, 3, v117
    s_mov_b64 exec, s[80:81]
    v_mov_b32 v117, 0
    v_mov_b32 v112, 0
    s_mov_b64 exec, vcc
    v_mov_b32 v117, 3

    s_mov_b64 exec, -1
    v_alignbyte_b32 v110, v111, v110, v117
    v_alignbyte_b32 v111, v112, v111, v117
    v_add_u32 v116, v116, v117

    buffer_store_dwordx2 v[110:111], v116, s[24:27], 0 offen
    v_cmp_ne_u32_sdwa s[80:81], v119, v121 src0_sel:WORD_1 src1_sel:WORD_1
    v_cmp_ne_u32_sdwa vcc, v119, v123 src0_sel:WORD_1 src1_sel:WORD_1
    v_alignbyte_b32 v122, v123, v122, 2
    s_mov_b32 s54, 66557
    v_alignbyte_b32 v119, v119, v118, 1
    v_perm_b32 v118, v118, v122, s47
    s_waitcnt lgkmcnt(0)
    v_add3_u32 v124, v124, v106, s54
    v_sub_u32 v125, 0, v124
    v_and_b32 v125, 3, v125
    s_mov_b64 exec, s[80:81]
    v_mov_b32 v125, 0
    v_mov_b32 v120, 0
    s_mov_b64 exec, vcc
    v_mov_b32 v125, 3

    s_mov_b64 exec, -1
    v_alignbyte_b32 v118, v119, v118, v125
    v_alignbyte_b32 v119, v120, v119, v125
    v_add_u32 v124, v124, v125

    buffer_store_dwordx2 v[118:119], v124, s[24:27], 0 offen
L_skw_35:
    s_bitcmp0_b32 s28, 3
    s_cbranch_scc1 L_skw_36
    v_add_u32 v107, 98304, v2
    ds_read_b64 v[110:111], v107 offset:32784
    ds_read_b64 v[112:113], v107 offset:32792
    ds_read_b64 v[114:115], v107 offset:32776

    ds_read_b64 v[118:119], v107 offset:40976
    ds_read_b64 v[120:121], v107 offset:40984
    ds_read_b64 v[122:123], v107 offset:40968

    s_waitcnt lgkmcnt(3)
    v_lshrrev_b32 v116, 16, v111
    ds_read_b32 v116, v116 offset:8192

    s_waitcnt lgkmcnt(1)
    v_lshrrev_b32 v124, 16, v119
    ds_read_b32 v124, v124 offset:8192

    v_cmp_ne_u32_sdwa s[80:81], v111, v113 src0_sel:WORD_1 src1_sel:WORD_1
    v_cmp_ne_u32_sdwa vcc, v111, v115 src0_sel:WORD_1 src1_sel:WORD_1
    v_alignbyte_b32 v114, v115, v114, 2
    s_mov_b32 s54, 71677
    v_alignbyte_b32 v111, v111, v110, 1
    v_perm_b32 v110, v110, v114, s47
    s_waitcnt lgkmcnt(1)
    v_add3_u32 v116, v116, v106, s54
    v_sub_u32 v117, 0, v116
    v_and_b32 v117, 3, v117
    s_mov_b64 exec, s[80:81]
    v_mov_b32 v117, 0
    v_mov_b32 v112, 0
    s_mov_b64 exec, vcc
    v_mov_b32 v117, 3

    s_mov_b64 exec, -1
    v_alignbyte_b32 v110, v111, v110, v117
    v_alignbyte_b32 v111, v112, v111, v117
    v_add_u32 v116, v116, v117

    buffer_store_dwordx2 v[110:111], v116, s[24:27], 0 offen
    v_cmp_ne_u32_sdwa s[80:81], v119, v121 src0_sel:WORD_1 src1_sel:WORD_1
    v_cmp_ne_u32_sdwa vcc, v119, v123 src0_sel:WORD_1 src1_sel:WORD_1
    v_alignbyte_b32 v122, v123, v122, 2
    s_mov_b32 s54, 76797
    v_alignbyte_b32 v119, v119, v118, 1
    v_perm_b32 v118, v118, v122, s47
    s_waitcnt lgkmcnt(0)
    v_add3_u32 v124, v124, v106, s54
    v_sub_u32 v125, 0, v124
    v_and_b32 v125, 3, v125
    s_mov_b64 exec, s[80:81]
    v_mov_b32 v125, 0
    v_mov_b32 v120, 0
    s_mov_b64 exec, vcc
    v_mov_b32 v125, 3

    s_andn2_b64 exec, -1, s[68:69]
    v_bfrev_b32 v124, 1
    s_mov_b64 exec, -1
    v_alignbyte_b32 v118, v119, v118, v125
    v_alignbyte_b32 v119, v120, v119, v125
    v_add_u32 v124, v124, v125

    buffer_store_dwordx2 v[118:119], v124, s[24:27], 0 offen
L_skw_36:
    s_waitcnt lgkmcnt(0)
    s_barrier

    buffer_load_dwordx4 v[20:23], v1, s[12:15], s56 offen nt
    buffer_load_dwordx4 v[4:7], v1, s[8:11], s56 offen nt
    buffer_load_dwordx2 v[36:37], v2, s[16:19], s61 offen nt
    ds_read_b64 v[94:95], v2
    s_waitcnt lgkmcnt(0)
    v_and_b32 v94, 0xffff, v94
    v_and_b32 v95, 0xffff, v95
    v_add_u32 v97, v94, v95
    s_nop 1
    v_add_u32_dpp v97, v97, v97 row_shr:1 row_mask:0xf bank_mask:0xf
    s_nop 1
    v_add_u32_dpp v97, v97, v97 row_shr:2 row_mask:0xf bank_mask:0xf
    s_nop 1
    v_add_u32_dpp v97, v97, v97 row_shr:4 row_mask:0xf bank_mask:0xf
    s_nop 1
    v_add_u32_dpp v97, v97, v97 row_shr:8 row_mask:0xf bank_mask:0xf
    s_nop 1
    v_add_u32_dpp v97, v97, v97 row_bcast:15 row_mask:0xa bank_mask:0xf
    s_nop 1
    v_add_u32_dpp v97, v97, v97 row_bcast:31 row_mask:0xc bank_mask:0xf
    s_mov_b32 exec_lo, 0
    s_brev_b32 exec_hi, 1
    ds_add_rtn_u32 v96, v108, v97
    s_mov_b64 exec, -1

    v_add_u32 v92, v94, v94
    v_add_u32 v93, v95, v95
    v_med3_u32 v92, v94, 2, v92
    v_med3_u32 v93, v95, 2, v93
    v_lshl_or_b32 v92, v93, 16, v92
    v_lshlrev_b32 v93, 2, v0
    buffer_atomic_add v92, v93, s[20:23], 0 offen sc0
    s_waitcnt lgkmcnt(0)
    v_readlane_b32 s77, v96, 63
    v_mul_u32_u24 v114, 65528, v0
    v_sub_u32 v97, v97, v95
    s_sub_u32 s50, s50, s83
    s_sub_u32 s77, s77, s50
    v_add_u32 v97, s77, v97
    v_sub_u32 v96, v97, v94
    v_lshlrev_b32 v111, 16, v97
    v_lshlrev_b32 v110, 16, v96
    ds_write_b64 v2, v[110:111]
    v_mad_i32_i24 v96, v96, -5, v114
    v_mad_i32_i24 v97, v97, -5, v114
    v_add_u32 v97, 32764, v97
    s_add_u32 s50, s50, s84
    s_mov_b32 s28, s82
    s_mov_b32 s29, s83
    s_mov_b32 s30, s84
    s_lshl_b32 s74, s29, 3
    s_lshl_b32 s75, s30, 3
    v_mov_b32 v125, s74
    v_mov_b32 v126, s75
    v_mov_b32 v127, -1

    s_waitcnt lgkmcnt(0)
    s_barrier

    s_mov_b64 exec, 1
    ds_write_b32 v125, v127 offset:16396
    ds_write_b32 v126, v127 offset:16404
    s_mov_b64 exec, -1

    buffer_load_dwordx4 v[24:27], v1, s[12:15], s57 offen nt
    buffer_load_dwordx4 v[8:11], v1, s[8:11], s57 offen nt
    buffer_load_dwordx2 v[38:39], v2, s[16:19], s62 offen nt
    s_bitcmp0_b32 s28, 0
    s_cbranch_scc1 L_skz_37
    v_lshrrev_b32 v110, 16, v45
    ds_read_b32 v110, v110
    v_lshrrev_b32 v111, 16, v47
    ds_read_b32 v111, v111
    v_lshrrev_b32 v112, 16, v49
    ds_read_b32 v112, v112
    v_lshrrev_b32 v113, 16, v51
    ds_read_b32 v113, v113
    v_lshrrev_b32 v114, 16, v53
    ds_read_b32 v114, v114
    v_lshrrev_b32 v115, 16, v55
    ds_read_b32 v115, v115
    v_lshrrev_b32 v116, 16, v57
    ds_read_b32 v116, v116
    v_lshrrev_b32 v117, 16, v59
    ds_read_b32 v117, v117
    s_waitcnt lgkmcnt(7)
    v_add_u32_sdwa v110, v110, v76 dst_sel:DWORD dst_unused:UNUSED_PAD src0_sel:WORD_1 src1_sel:WORD_0
    v_lshlrev_b32 v110, 3, v110
    ds_write_b64 v110, v[44:45] offset:16400

    s_waitcnt lgkmcnt(7)
    v_add_u32_sdwa v111, v111, v77 dst_sel:DWORD dst_unused:UNUSED_PAD src0_sel:WORD_1 src1_sel:WORD_0
    v_lshlrev_b32 v111, 3, v111
    ds_write_b64 v111, v[46:47] offset:16400

    s_waitcnt lgkmcnt(7)
    v_add_u32_sdwa v112, v112, v78 dst_sel:DWORD dst_unused:UNUSED_PAD src0_sel:WORD_1 src1_sel:WORD_0
    v_lshlrev_b32 v112, 3, v112
    ds_write_b64 v112, v[48:49] offset:16400

    s_waitcnt lgkmcnt(7)
    v_add_u32_sdwa v113, v113, v79 dst_sel:DWORD dst_unused:UNUSED_PAD src0_sel:WORD_1 src1_sel:WORD_0
    v_lshlrev_b32 v113, 3, v113
    ds_write_b64 v113, v[50:51] offset:16400

    s_waitcnt lgkmcnt(7)
    v_add_u32_sdwa v114, v114, v80 dst_sel:DWORD dst_unused:UNUSED_PAD src0_sel:WORD_1 src1_sel:WORD_0
    v_lshlrev_b32 v114, 3, v114
    ds_write_b64 v114, v[52:53] offset:16400

    s_waitcnt lgkmcnt(7)
    v_add_u32_sdwa v115, v115, v81 dst_sel:DWORD dst_unused:UNUSED_PAD src0_sel:WORD_1 src1_sel:WORD_0
    v_lshlrev_b32 v115, 3, v115
    ds_write_b64 v115, v[54:55] offset:16400

    s_waitcnt lgkmcnt(7)
    v_add_u32_sdwa v116, v116, v82 dst_sel:DWORD dst_unused:UNUSED_PAD src0_sel:WORD_1 src1_sel:WORD_0
    v_lshlrev_b32 v116, 3, v116
    ds_write_b64 v116, v[56:57] offset:16400

    s_waitcnt lgkmcnt(7)
    v_add_u32_sdwa v117, v117, v83 dst_sel:DWORD dst_unused:UNUSED_PAD src0_sel:WORD_1 src1_sel:WORD_0
    v_lshlrev_b32 v117, 3, v117
    ds_write_b64 v117, v[58:59] offset:16400

L_skz_37:
    buffer_load_dwordx4 v[28:31], v1, s[12:15], s58 offen nt
    buffer_load_dwordx4 v[12:15], v1, s[8:11], s58 offen nt
    buffer_load_dwordx2 v[40:41], v2, s[16:19], s63 offen nt
    s_bitcmp0_b32 s28, 2
    s_cbranch_scc1 L_skz_38
    v_lshrrev_b32 v110, 16, v61
    ds_read_b32 v110, v110
    v_lshrrev_b32 v111, 16, v63
    ds_read_b32 v111, v111
    v_lshrrev_b32 v112, 16, v65
    ds_read_b32 v112, v112
    v_lshrrev_b32 v113, 16, v67
    ds_read_b32 v113, v113
    s_waitcnt lgkmcnt(3)
    v_add_u32_sdwa v110, v110, v84 dst_sel:DWORD dst_unused:UNUSED_PAD src0_sel:WORD_1 src1_sel:WORD_0
    v_lshlrev_b32 v110, 3, v110
    ds_write_b64 v110, v[60:61] offset:16400

    s_waitcnt lgkmcnt(3)
    v_add_u32_sdwa v111, v111, v85 dst_sel:DWORD dst_unused:UNUSED_PAD src0_sel:WORD_1 src1_sel:WORD_0
    v_lshlrev_b32 v111, 3, v111
    ds_write_b64 v111, v[62:63] offset:16400

    s_waitcnt lgkmcnt(3)
    v_add_u32_sdwa v112, v112, v86 dst_sel:DWORD dst_unused:UNUSED_PAD src0_sel:WORD_1 src1_sel:WORD_0
    v_lshlrev_b32 v112, 3, v112
    ds_write_b64 v112, v[64:65] offset:16400

    s_waitcnt lgkmcnt(3)
    v_add_u32_sdwa v113, v113, v87 dst_sel:DWORD dst_unused:UNUSED_PAD src0_sel:WORD_1 src1_sel:WORD_0
    v_lshlrev_b32 v113, 3, v113
    ds_write_b64 v113, v[66:67] offset:16400

L_skz_38:
    s_bitcmp0_b32 s28, 3
    s_cbranch_scc1 L_skz_39
    s_mov_b64 exec, s[66:67]
    v_lshrrev_b32 v110, 16, v69
    ds_read_b32 v110, v110
    v_lshrrev_b32 v111, 16, v71
    ds_read_b32 v111, v111
    v_lshrrev_b32 v112, 16, v73
    ds_read_b32 v112, v112
    v_lshrrev_b32 v113, 16, v75
    ds_read_b32 v113, v113
    s_waitcnt lgkmcnt(3)
    v_add_u32_sdwa v110, v110, v88 dst_sel:DWORD dst_unused:UNUSED_PAD src0_sel:WORD_1 src1_sel:WORD_0
    v_lshlrev_b32 v110, 3, v110
    ds_write_b64 v110, v[68:69] offset:16400

    s_waitcnt lgkmcnt(3)
    v_add_u32_sdwa v111, v111, v89 dst_sel:DWORD dst_unused:UNUSED_PAD src0_sel:WORD_1 src1_sel:WORD_0
    v_lshlrev_b32 v111, 3, v111
    ds_write_b64 v111, v[70:71] offset:16400

    s_waitcnt lgkmcnt(3)
    v_add_u32_sdwa v112, v112, v90 dst_sel:DWORD dst_unused:UNUSED_PAD src0_sel:WORD_1 src1_sel:WORD_0
    v_lshlrev_b32 v112, 3, v112
    ds_write_b64 v112, v[72:73] offset:16400

    s_waitcnt lgkmcnt(3)
    v_add_u32_sdwa v113, v113, v91 dst_sel:DWORD dst_unused:UNUSED_PAD src0_sel:WORD_1 src1_sel:WORD_0
    v_lshlrev_b32 v113, 3, v113
    ds_write_b64 v113, v[74:75] offset:16400

    s_mov_b64 exec, -1
L_skz_39:
    buffer_load_dwordx4 v[32:35], v1, s[12:15], s59 offen nt
    buffer_load_dwordx4 v[16:19], v1, s[8:11], s59 offen nt
    buffer_load_dwordx2 v[42:43], v2, s[16:19], s64 offen nt
    s_cmp_lg_u32 s49, 0
    s_cbranch_scc1 L_p1loop_5
L_p1epi_6:
    s_waitcnt vmcnt(0)
    s_waitcnt vmcnt(0)
    v_lshrrev_b32 v93, 16, v92
    v_and_b32 v92, 0xffff, v92
    v_add_u32 v110, v92, v94
    v_mad_u32_u24 v92, v92, 5, v96
    v_add_u32 v111, v93, v95
    v_mad_u32_u24 v93, v93, 5, v97
    v_max_u32 v110, v110, v111
    v_cmp_le_u32 vcc, s48, v110
    s_cbranch_vccnz L_full_40
L_fback_41:
    ds_write_b64 v2, v[92:93] offset:8192

    s_waitcnt lgkmcnt(0)
    s_barrier

    s_bitcmp0_b32 s28, 0
    s_cbranch_scc1 L_skw_42
    ds_read_b64 v[4:5], v2 offset:16400
    ds_read_b64 v[6:7], v2 offset:16408
    ds_read_b64 v[8:9], v2 offset:16392

    ds_read_b64 v[12:13], v2 offset:24592
    ds_read_b64 v[14:15], v2 offset:24600
    ds_read_b64 v[16:17], v2 offset:24584

    ds_read_b64 v[20:21], v2 offset:32784
    ds_read_b64 v[22:23], v2 offset:32792
    ds_read_b64 v[24:25], v2 offset:32776

    ds_read_b64 v[28:29], v2 offset:40976
    ds_read_b64 v[30:31], v2 offset:40984
    ds_read_b64 v[32:33], v2 offset:40968

    s_waitcnt lgkmcnt(9)
    v_lshrrev_b32 v10, 16, v5
    ds_read_b32 v10, v10 offset:8192

    s_waitcnt lgkmcnt(7)
    v_lshrrev_b32 v18, 16, v13
    ds_read_b32 v18, v18 offset:8192

    s_waitcnt lgkmcnt(5)
    v_lshrrev_b32 v26, 16, v21
    ds_read_b32 v26, v26 offset:8192

    s_waitcnt lgkmcnt(3)
    v_lshrrev_b32 v34, 16, v29
    ds_read_b32 v34, v34 offset:8192

    v_cmp_ne_u32_sdwa s[80:81], v5, v7 src0_sel:WORD_1 src1_sel:WORD_1
    v_cmp_ne_u32_sdwa vcc, v5, v9 src0_sel:WORD_1 src1_sel:WORD_1
    v_alignbyte_b32 v8, v9, v8, 2
    s_mov_b32 s54, -3
    v_alignbyte_b32 v5, v5, v4, 1
    v_perm_b32 v4, v4, v8, s47
    s_waitcnt lgkmcnt(3)
    v_add3_u32 v10, v10, v106, s54
    v_sub_u32 v11, 0, v10
    v_and_b32 v11, 3, v11
    s_mov_b64 exec, s[80:81]
    v_mov_b32 v11, 0
    v_mov_b32 v6, 0
    s_mov_b64 exec, vcc
    v_mov_b32 v11, 3

    s_mov_b64 exec, -1
    v_alignbyte_b32 v4, v5, v4, v11
    v_alignbyte_b32 v5, v6, v5, v11
    v_add_u32 v10, v10, v11

    buffer_store_dwordx2 v[4:5], v10, s[24:27], 0 offen
    v_cmp_ne_u32_sdwa s[80:81], v13, v15 src0_sel:WORD_1 src1_sel:WORD_1
    v_cmp_ne_u32_sdwa vcc, v13, v17 src0_sel:WORD_1 src1_sel:WORD_1
    v_alignbyte_b32 v16, v17, v16, 2
    s_mov_b32 s54, 5117
    v_alignbyte_b32 v13, v13, v12, 1
    v_perm_b32 v12, v12, v16, s47
    s_waitcnt lgkmcnt(2)
    v_add3_u32 v18, v18, v106, s54
    v_sub_u32 v19, 0, v18
    v_and_b32 v19, 3, v19
    s_mov_b64 exec, s[80:81]
    v_mov_b32 v19, 0
    v_mov_b32 v14, 0
    s_mov_b64 exec, vcc
    v_mov_b32 v19, 3

    s_mov_b64 exec, -1
    v_alignbyte_b32 v12, v13, v12, v19
    v_alignbyte_b32 v13, v14, v13, v19
    v_add_u32 v18, v18, v19

    buffer_store_dwordx2 v[12:13], v18, s[24:27], 0 offen
    v_cmp_ne_u32_sdwa s[80:81], v21, v23 src0_sel:WORD_1 src1_sel:WORD_1
    v_cmp_ne_u32_sdwa vcc, v21, v25 src0_sel:WORD_1 src1_sel:WORD_1
    v_alignbyte_b32 v24, v25, v24, 2
    s_mov_b32 s54, 10237
    v_alignbyte_b32 v21, v21, v20, 1
    v_perm_b32 v20, v20, v24, s47
    s_waitcnt lgkmcnt(1)
    v_add3_u32 v26, v26, v106, s54
    v_sub_u32 v27, 0, v26
    v_and_b32 v27, 3, v27
    s_mov_b64 exec, s[80:81]
    v_mov_b32 v27, 0
    v_mov_b32 v22, 0
    s_mov_b64 exec, vcc
    v_mov_b32 v27, 3

    s_mov_b64 exec, -1
    v_alignbyte_b32 v20, v21, v20, v27
    v_alignbyte_b32 v21, v22, v21, v27
    v_add_u32 v26, v26, v27

    buffer_store_dwordx2 v[20:21], v26, s[24:27], 0 offen
    v_cmp_ne_u32_sdwa s[80:81], v29, v31 src0_sel:WORD_1 src1_sel:WORD_1
    v_cmp_ne_u32_sdwa vcc, v29, v33 src0_sel:WORD_1 src1_sel:WORD_1
    v_alignbyte_b32 v32, v33, v32, 2
    s_mov_b32 s54, 15357
    v_alignbyte_b32 v29, v29, v28, 1
    v_perm_b32 v28, v28, v32, s47
    s_waitcnt lgkmcnt(0)
    v_add3_u32 v34, v34, v106, s54
    v_sub_u32 v35, 0, v34
    v_and_b32 v35, 3, v35
    s_mov_b64 exec, s[80:81]
    v_mov_b32 v35, 0
    v_mov_b32 v30, 0
    s_mov_b64 exec, vcc
    v_mov_b32 v35, 3

    s_mov_b64 exec, -1
    v_alignbyte_b32 v28, v29, v28, v35
    v_alignbyte_b32 v29, v30, v29, v35
    v_add_u32 v34, v34, v35

    buffer_store_dwordx2 v[28:29], v34, s[24:27], 0 offen
L_skw_42:
    s_bitcmp0_b32 s28, 1
    s_cbranch_scc1 L_skw_43
    v_add_u32 v107, 32768, v2
    ds_read_b64 v[4:5], v107 offset:16400
    ds_read_b64 v[6:7], v107 offset:16408
    ds_read_b64 v[8:9], v107 offset:16392

    ds_read_b64 v[12:13], v107 offset:24592
    ds_read_b64 v[14:15], v107 offset:24600
    ds_read_b64 v[16:17], v107 offset:24584

    ds_read_b64 v[20:21], v107 offset:32784
    ds_read_b64 v[22:23], v107 offset:32792
    ds_read_b64 v[24:25], v107 offset:32776

    ds_read_b64 v[28:29], v107 offset:40976
    ds_read_b64 v[30:31], v107 offset:40984
    ds_read_b64 v[32:33], v107 offset:40968

    s_waitcnt lgkmcnt(9)
    v_lshrrev_b32 v10, 16, v5
    ds_read_b32 v10, v10 offset:8192

    s_waitcnt lgkmcnt(7)
    v_lshrrev_b32 v18, 16, v13
    ds_read_b32 v18, v18 offset:8192

    s_waitcnt lgkmcnt(5)
    v_lshrrev_b32 v26, 16, v21
    ds_read_b32 v26, v26 offset:8192

    s_waitcnt lgkmcnt(3)
    v_lshrrev_b32 v34, 16, v29
    ds_read_b32 v34, v34 offset:8192

    v_cmp_ne_u32_sdwa s[80:81], v5, v7 src0_sel:WORD_1 src1_sel:WORD_1
    v_cmp_ne_u32_sdwa vcc, v5, v9 src0_sel:WORD_1 src1_sel:WORD_1
    v_alignbyte_b32 v8, v9, v8, 2
    s_mov_b32 s54, 20477
    v_alignbyte_b32 v5, v5, v4, 1
    v_perm_b32 v4, v4, v8, s47
    s_waitcnt lgkmcnt(3)
    v_add3_u32 v10, v10, v106, s54
    v_sub_u32 v11, 0, v10
    v_and_b32 v11, 3, v11
    s_mov_b64 exec, s[80:81]
    v_mov_b32 v11, 0
    v_mov_b32 v6, 0
    s_mov_b64 exec, vcc
    v_mov_b32 v11, 3

    s_mov_b64 exec, -1
    v_alignbyte_b32 v4, v5, v4, v11
    v_alignbyte_b32 v5, v6, v5, v11
    v_add_u32 v10, v10, v11

    buffer_store_dwordx2 v[4:5], v10, s[24:27], 0 offen
    v_cmp_ne_u32_sdwa s[80:81], v13, v15 src0_sel:WORD_1 src1_sel:WORD_1
    v_cmp_ne_u32_sdwa vcc, v13, v17 src0_sel:WORD_1 src1_sel:WORD_1
    v_alignbyte_b32 v16, v17, v16, 2
    s_mov_b32 s54, 25597
    v_alignbyte_b32 v13, v13, v12, 1
    v_perm_b32 v12, v12, v16, s47
    s_waitcnt lgkmcnt(2)
    v_add3_u32 v18, v18, v106, s54
    v_sub_u32 v19, 0, v18
    v_and_b32 v19, 3, v19
    s_mov_b64 exec, s[80:81]
    v_mov_b32 v19, 0
    v_mov_b32 v14, 0
    s_mov_b64 exec, vcc
    v_mov_b32 v19, 3

    s_mov_b64 exec, -1
    v_alignbyte_b32 v12, v13, v12, v19
    v_alignbyte_b32 v13, v14, v13, v19
    v_add_u32 v18, v18, v19

    buffer_store_dwordx2 v[12:13], v18, s[24:27], 0 offen
    v_cmp_ne_u32_sdwa s[80:81], v21, v23 src0_sel:WORD_1 src1_sel:WORD_1
    v_cmp_ne_u32_sdwa vcc, v21, v25 src0_sel:WORD_1 src1_sel:WORD_1
    v_alignbyte_b32 v24, v25, v24, 2
    s_mov_b32 s54, 30717
    v_alignbyte_b32 v21, v21, v20, 1
    v_perm_b32 v20, v20, v24, s47
    s_waitcnt lgkmcnt(1)
    v_add3_u32 v26, v26, v106, s54
    v_sub_u32 v27, 0, v26
    v_and_b32 v27, 3, v27
    s_mov_b64 exec, s[80:81]
    v_mov_b32 v27, 0
    v_mov_b32 v22, 0
    s_mov_b64 exec, vcc
    v_mov_b32 v27, 3

    s_mov_b64 exec, -1
    v_alignbyte_b32 v20, v21, v20, v27
    v_alignbyte_b32 v21, v22, v21, v27
    v_add_u32 v26, v26, v27

    buffer_store_dwordx2 v[20:21], v26, s[24:27], 0 offen
    v_cmp_ne_u32_sdwa s[80:81], v29, v31 src0_sel:WORD_1 src1_sel:WORD_1
    v_cmp_ne_u32_sdwa vcc, v29, v33 src0_sel:WORD_1 src1_sel:WORD_1
    v_alignbyte_b32 v32, v33, v32, 2
    s_mov_b32 s54, 35837
    v_alignbyte_b32 v29, v29, v28, 1
    v_perm_b32 v28, v28, v32, s47
    s_waitcnt lgkmcnt(0)
    v_add3_u32 v34, v34, v106, s54
    v_sub_u32 v35, 0, v34
    v_and_b32 v35, 3, v35
    s_mov_b64 exec, s[80:81]
    v_mov_b32 v35, 0
    v_mov_b32 v30, 0
    s_mov_b64 exec, vcc
    v_mov_b32 v35, 3

    s_mov_b64 exec, -1
    v_alignbyte_b32 v28, v29, v28, v35
    v_alignbyte_b32 v29, v30, v29, v35
    v_add_u32 v34, v34, v35

    buffer_store_dwordx2 v[28:29], v34, s[24:27], 0 offen
L_skw_43:
    s_bitcmp0_b32 s28, 2
    s_cbranch_scc1 L_skw_44
    v_add_u32 v107, 65536, v2
    ds_read_b64 v[4:5], v107 offset:16400
    ds_read_b64 v[6:7], v107 offset:16408
    ds_read_b64 v[8:9], v107 offset:16392

    ds_read_b64 v[12:13], v107 offset:24592
    ds_read_b64 v[14:15], v107 offset:24600
    ds_read_b64 v[16:17], v107 offset:24584

    ds_read_b64 v[20:21], v107 offset:32784
    ds_read_b64 v[22:23], v107 offset:32792
    ds_read_b64 v[24:25], v107 offset:32776

    ds_read_b64 v[28:29], v107 offset:40976
    ds_read_b64 v[30:31], v107 offset:40984
    ds_read_b64 v[32:33], v107 offset:40968

    s_waitcnt lgkmcnt(9)
    v_lshrrev_b32 v10, 16, v5
    ds_read_b32 v10, v10 offset:8192

    s_waitcnt lgkmcnt(7)
    v_lshrrev_b32 v18, 16, v13
    ds_read_b32 v18, v18 offset:8192

    s_waitcnt lgkmcnt(5)
    v_lshrrev_b32 v26, 16, v21
    ds_read_b32 v26, v26 offset:8192

    s_waitcnt lgkmcnt(3)
    v_lshrrev_b32 v34, 16, v29
    ds_read_b32 v34, v34 offset:8192

    v_cmp_ne_u32_sdwa s[80:81], v5, v7 src0_sel:WORD_1 src1_sel:WORD_1
    v_cmp_ne_u32_sdwa vcc, v5, v9 src0_sel:WORD_1 src1_sel:WORD_1
    v_alignbyte_b32 v8, v9, v8, 2
    s_mov_b32 s54, 40957
    v_alignbyte_b32 v5, v5, v4, 1
    v_perm_b32 v4, v4, v8, s47
    s_waitcnt lgkmcnt(3)
    v_add3_u32 v10, v10, v106, s54
    v_sub_u32 v11, 0, v10
    v_and_b32 v11, 3, v11
    s_mov_b64 exec, s[80:81]
    v_mov_b32 v11, 0
    v_mov_b32 v6, 0
    s_mov_b64 exec, vcc
    v_mov_b32 v11, 3

    s_mov_b64 exec, -1
    v_alignbyte_b32 v4, v5, v4, v11
    v_alignbyte_b32 v5, v6, v5, v11
    v_add_u32 v10, v10, v11

    buffer_store_dwordx2 v[4:5], v10, s[24:27], 0 offen
    v_cmp_ne_u32_sdwa s[80:81], v13, v15 src0_sel:WORD_1 src1_sel:WORD_1
    v_cmp_ne_u32_sdwa vcc, v13, v17 src0_sel:WORD_1 src1_sel:WORD_1
    v_alignbyte_b32 v16, v17, v16, 2
    s_mov_b32 s54, 46077
    v_alignbyte_b32 v13, v13, v12, 1
    v_perm_b32 v12, v12, v16, s47
    s_waitcnt lgkmcnt(2)
    v_add3_u32 v18, v18, v106, s54
    v_sub_u32 v19, 0, v18
    v_and_b32 v19, 3, v19
    s_mov_b64 exec, s[80:81]
    v_mov_b32 v19, 0
    v_mov_b32 v14, 0
    s_mov_b64 exec, vcc
    v_mov_b32 v19, 3

    s_mov_b64 exec, -1
    v_alignbyte_b32 v12, v13, v12, v19
    v_alignbyte_b32 v13, v14, v13, v19
    v_add_u32 v18, v18, v19

    buffer_store_dwordx2 v[12:13], v18, s[24:27], 0 offen
    v_cmp_ne_u32_sdwa s[80:81], v21, v23 src0_sel:WORD_1 src1_sel:WORD_1
    v_cmp_ne_u32_sdwa vcc, v21, v25 src0_sel:WORD_1 src1_sel:WORD_1
    v_alignbyte_b32 v24, v25, v24, 2
    s_mov_b32 s54, 51197
    v_alignbyte_b32 v21, v21, v20, 1
    v_perm_b32 v20, v20, v24, s47
    s_waitcnt lgkmcnt(1)
    v_add3_u32 v26, v26, v106, s54
    v_sub_u32 v27, 0, v26
    v_and_b32 v27, 3, v27
    s_mov_b64 exec, s[80:81]
    v_mov_b32 v27, 0
    v_mov_b32 v22, 0
    s_mov_b64 exec, vcc
    v_mov_b32 v27, 3

    s_mov_b64 exec, -1
    v_alignbyte_b32 v20, v21, v20, v27
    v_alignbyte_b32 v21, v22, v21, v27
    v_add_u32 v26, v26, v27

    buffer_store_dwordx2 v[20:21], v26, s[24:27], 0 offen
    v_cmp_ne_u32_sdwa s[80:81], v29, v31 src0_sel:WORD_1 src1_sel:WORD_1
    v_cmp_ne_u32_sdwa vcc, v29, v33 src0_sel:WORD_1 src1_sel:WORD_1
    v_alignbyte_b32 v32, v33, v32, 2
    s_mov_b32 s54, 56317
    v_alignbyte_b32 v29, v29, v28, 1
    v_perm_b32 v28, v28, v32, s47
    s_waitcnt lgkmcnt(0)
    v_add3_u32 v34, v34, v106, s54
    v_sub_u32 v35, 0, v34
    v_and_b32 v35, 3, v35
    s_mov_b64 exec, s[80:81]
    v_mov_b32 v35, 0
    v_mov_b32 v30, 0
    s_mov_b64 exec, vcc
    v_mov_b32 v35, 3

    s_mov_b64 exec, -1
    v_alignbyte_b32 v28, v29, v28, v35
    v_alignbyte_b32 v29, v30, v29, v35
    v_add_u32 v34, v34, v35

    buffer_store_dwordx2 v[28:29], v34, s[24:27], 0 offen
L_skw_44:
    s_bitcmp0_b32 s28, 3
    s_cbranch_scc1 L_skw_45
    v_add_u32 v107, 98304, v2
    ds_read_b64 v[4:5], v107 offset:16400
    ds_read_b64 v[6:7], v107 offset:16408
    ds_read_b64 v[8:9], v107 offset:16392

    ds_read_b64 v[12:13], v107 offset:24592
    ds_read_b64 v[14:15], v107 offset:24600
    ds_read_b64 v[16:17], v107 offset:24584

    ds_read_b64 v[20:21], v107 offset:32784
    ds_read_b64 v[22:23], v107 offset:32792
    ds_read_b64 v[24:25], v107 offset:32776

    ds_read_b64 v[28:29], v107 offset:40976
    ds_read_b64 v[30:31], v107 offset:40984
    ds_read_b64 v[32:33], v107 offset:40968

    s_waitcnt lgkmcnt(9)
    v_lshrrev_b32 v10, 16, v5
    ds_read_b32 v10, v10 offset:8192

    s_waitcnt lgkmcnt(7)
    v_lshrrev_b32 v18, 16, v13
    ds_read_b32 v18, v18 offset:8192

    s_waitcnt lgkmcnt(5)
    v_lshrrev_b32 v26, 16, v21
    ds_read_b32 v26, v26 offset:8192

    s_waitcnt lgkmcnt(3)
    v_lshrrev_b32 v34, 16, v29
    ds_read_b32 v34, v34 offset:8192

    v_cmp_ne_u32_sdwa s[80:81], v5, v7 src0_sel:WORD_1 src1_sel:WORD_1
    v_cmp_ne_u32_sdwa vcc, v5, v9 src0_sel:WORD_1 src1_sel:WORD_1
    v_alignbyte_b32 v8, v9, v8, 2
    s_mov_b32 s54, 61437
    v_alignbyte_b32 v5, v5, v4, 1
    v_perm_b32 v4, v4, v8, s47
    s_waitcnt lgkmcnt(3)
    v_add3_u32 v10, v10, v106, s54
    v_sub_u32 v11, 0, v10
    v_and_b32 v11, 3, v11
    s_mov_b64 exec, s[80:81]
    v_mov_b32 v11, 0
    v_mov_b32 v6, 0
    s_mov_b64 exec, vcc
    v_mov_b32 v11, 3

    s_mov_b64 exec, -1
    v_alignbyte_b32 v4, v5, v4, v11
    v_alignbyte_b32 v5, v6, v5, v11
    v_add_u32 v10, v10, v11

    buffer_store_dwordx2 v[4:5], v10, s[24:27], 0 offen
    v_cmp_ne_u32_sdwa s[80:81], v13, v15 src0_sel:WORD_1 src1_sel:WORD_1
    v_cmp_ne_u32_sdwa vcc, v13, v17 src0_sel:WORD_1 src1_sel:WORD_1
    v_alignbyte_b32 v16, v17, v16, 2
    s_mov_b32 s54, 66557
    v_alignbyte_b32 v13, v13, v12, 1
    v_perm_b32 v12, v12, v16, s47
    s_waitcnt lgkmcnt(2)
    v_add3_u32 v18, v18, v106, s54
    v_sub_u32 v19, 0, v18
    v_and_b32 v19, 3, v19
    s_mov_b64 exec, s[80:81]
    v_mov_b32 v19, 0
    v_mov_b32 v14, 0
    s_mov_b64 exec, vcc
    v_mov_b32 v19, 3

    s_mov_b64 exec, -1
    v_alignbyte_b32 v12, v13, v12, v19
    v_alignbyte_b32 v13, v14, v13, v19
    v_add_u32 v18, v18, v19

    buffer_store_dwordx2 v[12:13], v18, s[24:27], 0 offen
    v_cmp_ne_u32_sdwa s[80:81], v21, v23 src0_sel:WORD_1 src1_sel:WORD_1
    v_cmp_ne_u32_sdwa vcc, v21, v25 src0_sel:WORD_1 src1_sel:WORD_1
    v_alignbyte_b32 v24, v25, v24, 2
    s_mov_b32 s54, 71677
    v_alignbyte_b32 v21, v21, v20, 1
    v_perm_b32 v20, v20, v24, s47
    s_waitcnt lgkmcnt(1)
    v_add3_u32 v26, v26, v106, s54
    v_sub_u32 v27, 0, v26
    v_and_b32 v27, 3, v27
    s_mov_b64 exec, s[80:81]
    v_mov_b32 v27, 0
    v_mov_b32 v22, 0
    s_mov_b64 exec, vcc
    v_mov_b32 v27, 3

    s_mov_b64 exec, -1
    v_alignbyte_b32 v20, v21, v20, v27
    v_alignbyte_b32 v21, v22, v21, v27
    v_add_u32 v26, v26, v27

    buffer_store_dwordx2 v[20:21], v26, s[24:27], 0 offen
    v_cmp_ne_u32_sdwa s[80:81], v29, v31 src0_sel:WORD_1 src1_sel:WORD_1
    v_cmp_ne_u32_sdwa vcc, v29, v33 src0_sel:WORD_1 src1_sel:WORD_1
    v_alignbyte_b32 v32, v33, v32, 2
    s_mov_b32 s54, 76797
    v_alignbyte_b32 v29, v29, v28, 1
    v_perm_b32 v28, v28, v32, s47
    s_waitcnt lgkmcnt(0)
    v_add3_u32 v34, v34, v106, s54
    v_sub_u32 v35, 0, v34
    v_and_b32 v35, 3, v35
    s_mov_b64 exec, s[80:81]
    v_mov_b32 v35, 0
    v_mov_b32 v30, 0
    s_mov_b64 exec, vcc
    v_mov_b32 v35, 3

    s_andn2_b64 exec, -1, s[68:69]
    v_bfrev_b32 v34, 1
    s_mov_b64 exec, -1
    v_alignbyte_b32 v28, v29, v28, v35
    v_alignbyte_b32 v29, v30, v29, v35
    v_add_u32 v34, v34, v35

    buffer_store_dwordx2 v[28:29], v34, s[24:27], 0 offen
L_skw_45:
L_p1done_1:
    s_endpgm

L_ska_7:
    v_bfrev_b32 v126, 1
    buffer_load_dword v3, v126, s[96:99], 0 offen
    buffer_load_dword v3, v126, s[96:99], 0 offen
    buffer_load_dword v3, v126, s[96:99], 0 offen
    s_branch L_bka_8
L_ska_9:
    v_bfrev_b32 v126, 1
    buffer_load_dword v3, v126, s[96:99], 0 offen
    buffer_load_dword v3, v126, s[96:99], 0 offen
    buffer_load_dword v3, v126, s[96:99], 0 offen
    s_branch L_bka_10
L_ska_11:
    v_bfrev_b32 v126, 1
    buffer_load_dword v3, v126, s[96:99], 0 offen
    buffer_load_dword v3, v126, s[96:99], 0 offen
    buffer_load_dword v3, v126, s[96:99], 0 offen
    s_branch L_bka_12
L_ska_13:
    v_bfrev_b32 v126, 1
    buffer_load_dword v3, v126, s[96:99], 0 offen
    buffer_load_dword v3, v126, s[96:99], 0 offen
    buffer_load_dword v3, v126, s[96:99], 0 offen
    s_branch L_bka_14
L_full_25:
    v_mov_b32 v110, 0
    s_mov_b64 exec, vcc
    v_bfrev_b32 v92, 1
    v_bfrev_b32 v93, 1
    s_mov_b64 exec, 1
    buffer_atomic_or v104, v110, s[36:39], 0 offen
    s_mov_b64 exec, -1
    s_branch L_fback_26

L_full_40:
    v_mov_b32 v110, 0
    s_mov_b64 exec, vcc
    v_bfrev_b32 v92, 1
    v_bfrev_b32 v93, 1
    s_mov_b64 exec, 1
    buffer_atomic_or v104, v110, s[36:39], 0 offen
    s_mov_b64 exec, -1
    s_branch L_fback_41

.globl standalone__molecular_angular_gemnet__graph_kernel
.p2align 8
.type standalone__molecular_angular_gemnet__graph_kernel,@function
standalone__molecular_angular_gemnet__graph_kernel:
    s_cmp_ge_u32 s2, 256
    s_cbranch_scc1 L_p2done_46
    s_load_dwordx2 s[8:9], s[0:1], 0
    s_load_dwordx2 s[6:7], s[0:1], 104
    v_lshrrev_b32 v4, 6, v0
    s_lshr_b32 s37, s2, 1
    s_and_b32 s37, s37, 3
    s_lshr_b32 s36, s2, 3
    s_lshl_b32 s36, s36, 1
    s_and_b32 s3, s2, 1
    s_or_b32 s36, s36, s3
    v_readfirstlane_b32 s4, v4
    v_and_b32 v2, 63, v0
    v_lshrrev_b32 v3, 9, v0
    v_lshl_or_b32 v2, v3, 6, v2
    v_mul_u32_u24 v2, 20, v2
    v_lshlrev_b32 v3, 4, v0

    s_waitcnt lgkmcnt(0)
    s_lshl_b32 m0, s4, 10
    s_and_b32 s5, s4, 7
    s_lshr_b32 s39, s4, 3
    s_lshl_b32 s39, s39, 8
    s_mul_i32 s3, s5, 4096
    s_add_u32 s46, s6, s3
    s_addc_u32 s47, s7, 0
    s_mul_i32 s3, s5, 67117056
    s_add_u32 s3, s3, 83623936
    s_add_u32 s44, s6, s3
    s_addc_u32 s45, s7, 0
    s_mul_i32 s38, s37, 8
    s_add_u32 s4, s38, 8
    s_lshl_b32 s3, s38, 6
    s_add_u32 s3, s3, s36
    s_lshr_b32 s3, s3, 1
    s_lshl_b32 s3, s3, 2
    s_add_u32 s52, s46, s3
    s_addc_u32 s53, s47, 0

    s_load_dword s88, s[52:53], 0
    s_load_dword s89, s[52:53], 128
    s_load_dword s90, s[52:53], 256
    s_load_dword s91, s[52:53], 384
    s_load_dword s92, s[52:53], 512
    s_load_dword s93, s[52:53], 640
    s_load_dword s94, s[52:53], 768
    s_load_dword s95, s[52:53], 896
    s_mov_b32 s3, 32768
    s_load_dword s51, s[6:7], s3
    s_mov_b32 s10, 6400000
    s_mov_b32 s11, 0x20000

    s_add_u32 s12, s6, 393216
    s_addc_u32 s13, s7, 0
    s_mov_b32 s14, 0
    s_mov_b32 s15, 0x20000
    s_add_u32 s60, s6, 393216
    s_addc_u32 s61, s7, 0
    s_mov_b32 s62, 6406144
    s_mov_b32 s63, 0x20000
    s_mov_b32 s3, 135176
    s_load_dword s33, s[6:7], s3

    s_mul_i32 s43, s38, 200192
    s_mul_i32 s41, s4, 200192
    s_mul_i32 s50, s38, 200000
    s_add_u32 s14, s43, 50000

    buffer_load_dwordx4 v[76:79], v3, s[12:15], s43 offen
    s_add_u32 s52, s43, 16384
    buffer_load_dwordx4 v[80:83], v3, s[12:15], s52 offen
    s_add_u32 s52, s43, 32768
    buffer_load_dwordx4 v[84:87], v3, s[12:15], s52 offen
    s_add_u32 s52, s43, 49152
    v_lshlrev_b32 v119, 2, v0
    buffer_load_dword v88, v119, s[12:15], s52 offen
    s_add_u32 s20, s6, 135168
    s_addc_u32 s21, s7, 0
    s_mov_b32 s22, 4096
    s_mov_b32 s23, 0x20000
    v_and_b32 v44, 63, v0
    v_lshlrev_b32 v44, 4, v44
    buffer_load_dwordx2 v[120:121], v44, s[20:23], 0 offen offset:0
    buffer_load_dwordx2 v[122:123], v44, s[20:23], 0 offen offset:1024
    buffer_load_dwordx2 v[124:125], v44, s[20:23], 0 offen offset:2048
    buffer_load_dwordx2 v[126:127], v44, s[20:23], 0 offen offset:3072
    s_movk_i32 s40, 3072
    s_mov_b32 s19, 0x20000
    s_min_u32 s40, s40, 6552
    s_lshl_b32 s52, s38, 6
    s_add_u32 s52, s52, s36
    s_mul_i32 s52, s52, 32764
    s_add_u32 s16, s44, s52
    s_addc_u32 s17, s45, 0
    s_mul_i32 s52, s40, 5
    s_add_u32 s52, s52, 3
    s_and_b32 s18, s52, -4

    s_movk_i32 s53, 5120
    buffer_load_dwordx4 v[90:93], v2, s[16:19], s53 offen
    buffer_load_dword v110, v2, s[16:19], s53 offen offset:16
    s_movk_i32 s53, 7680
    buffer_load_dwordx4 v[94:97], v2, s[16:19], s53 offen
    buffer_load_dword v111, v2, s[16:19], s53 offen offset:16
    s_movk_i32 s53, 10240
    buffer_load_dwordx4 v[98:101], v2, s[16:19], s53 offen
    buffer_load_dword v112, v2, s[16:19], s53 offen offset:16
    s_lshr_b32 s3, s2, 3
    s_mul_i32 s3, s3, 49
    v_add_lshl_u32 v89, v0, s3, 7
    v_cmp_gt_u32 vcc, 49, v0
    v_bfrev_b32 v28, 1
    s_nop 0
    v_cndmask_b32 v89, v28, v89, vcc

    s_mov_b32 s19, 0x20000
    s_mov_b32 s28, 0x4b404000
    s_mov_b32 s29, 0x4b404000
    s_mov_b32 s30, 0xbfffc000
    s_mov_b32 s31, 0xbfffbfff
    s_mov_b32 s32, 0xffff0000
    s_mov_b32 s35, 0x05040100
    s_mov_b32 s97, 0x07060302
    s_mov_b32 s96, 0x40008000
    s_movk_i32 s3, 212
    v_cmp_gt_u32 s[48:49], s3, v0

    v_mov_b32 v1, 0
    s_mov_b32 s24, 0xc0c0004
    s_mov_b32 s25, 0xc0c0105
    s_mov_b32 s26, 0xc0c0206
    s_mov_b32 s27, 0xc0c0307
    v_mov_b32 v28, 0x40004000
    v_mov_b32 v29, 0x40004000
    v_mov_b32 v30, 0x40004000
    v_mov_b32 v31, 0x40004000
    v_add_u32 v32, 50000, v3
    v_add_u32 v33, 65536, v32

    ds_write_b128 v32, v[28:31] offset:0
    ds_write_b128 v32, v[28:31] offset:16384
    ds_write_b128 v32, v[28:31] offset:32768
    ds_write_b128 v32, v[28:31] offset:49152
    ds_write_b128 v33, v[28:31] offset:0
    ds_write_b128 v33, v[28:31] offset:16384
    v_cmp_gt_u32 vcc, 971, v0
    s_mov_b64 exec, vcc
    ds_write_b128 v33, v[28:31] offset:32768
    s_mov_b64 exec, -1
    s_waitcnt vmcnt(13)
    ds_write_addtid_b32 v76 offset:0
    ds_write_addtid_b32 v77 offset:256
    ds_write_addtid_b32 v78 offset:512
    ds_write_addtid_b32 v79 offset:768
    s_waitcnt vmcnt(12)
    ds_write_addtid_b32 v80 offset:16384
    ds_write_addtid_b32 v81 offset:16640
    ds_write_addtid_b32 v82 offset:16896
    ds_write_addtid_b32 v83 offset:17152
    s_waitcnt vmcnt(11)
    ds_write_addtid_b32 v84 offset:32768
    ds_write_addtid_b32 v85 offset:33024
    ds_write_addtid_b32 v86 offset:33280
    ds_write_addtid_b32 v87 offset:33536
    v_lshlrev_b32 v119, 2, v0
    s_waitcnt vmcnt(10)
    s_mov_b64 exec, s[48:49]
    ds_write_b32 v119, v88 offset:49152
    s_mov_b64 exec, -1
    s_add_u32 s43, s43, 50048
    s_add_u32 s14, s43, 50000
    s_min_u32 s14, s14, s41
    s_and_b32 s3, s36, 1
    s_lshl_b32 s3, s3, 4
    s_or_b32 s3, s3, 0x100000
    s_waitcnt lgkmcnt(0)

    s_bfe_u32 s88, s88, s3
    s_bfe_u32 s89, s89, s3
    s_bfe_u32 s90, s90, s3
    s_bfe_u32 s91, s91, s3
    s_bfe_u32 s92, s92, s3
    s_bfe_u32 s93, s93, s3
    s_bfe_u32 s94, s94, s3
    s_bfe_u32 s95, s95, s3
    s_waitcnt vmcnt(6)
    v_max3_u32 v120, v120, v122, v124
    v_add_f32 v121, v121, v123
    v_add_f32 v125, v125, v127
    v_max_u32 v120, v120, v126
    v_add_f32 v121, v121, v125

    s_nop 1
    v_max_u32_dpp v120, v120, v120 row_shr:1 row_mask:0xf bank_mask:0xf
    s_nop 1
    v_max_u32_dpp v120, v120, v120 row_shr:2 row_mask:0xf bank_mask:0xf
    s_nop 1
    v_max_u32_dpp v120, v120, v120 row_shr:4 row_mask:0xf bank_mask:0xf
    s_nop 1
    v_max_u32_dpp v120, v120, v120 row_shr:8 row_mask:0xf bank_mask:0xf
    s_nop 1
    v_max_u32_dpp v120, v120, v120 row_bcast:15 row_mask:0xa bank_mask:0xf
    s_nop 1
    v_max_u32_dpp v120, v120, v120 row_bcast:31 row_mask:0xc bank_mask:0xf
    s_nop 1
    v_add_f32_dpp v121, v121, v121 row_shr:1 row_mask:0xf bank_mask:0xf
    s_nop 1
    v_add_f32_dpp v121, v121, v121 row_shr:2 row_mask:0xf bank_mask:0xf
    s_nop 1
    v_add_f32_dpp v121, v121, v121 row_shr:4 row_mask:0xf bank_mask:0xf
    s_nop 1
    v_add_f32_dpp v121, v121, v121 row_shr:8 row_mask:0xf bank_mask:0xf
    s_nop 1
    v_add_f32_dpp v121, v121, v121 row_bcast:15 row_mask:0xa bank_mask:0xf
    s_nop 1
    v_add_f32_dpp v121, v121, v121 row_bcast:31 row_mask:0xc bank_mask:0xf
    v_lshlrev_b32 v120, 16, v120
    v_mul_f32 v121, 0x34a7c5ac, v121
    v_sqrt_f32 v121, v121
    v_mul_f32 v120, s33, v120
    v_mul_f32 v121, s33, v121
    v_cmp_gt_f32 vcc, 0x46fde800, v120
    s_mov_b64 s[64:65], vcc
    v_cmp_lt_f32 vcc, 0x44000000, v121
    v_mov_b32 v120, 0x37800000
    v_mul_f32 v120, s33, v120
    s_and_b64 vcc, vcc, s[64:65]
    v_mul_f32 v121, 0x46ff8000, v120
    v_rcp_f32 v121, v121
    v_readfirstlane_b32 s33, v120
    s_waitcnt lgkmcnt(0)
    s_barrier
    v_readfirstlane_b32 s34, v121
    v_mov_b32 v120, 150016
    v_mov_b32 v121, 0
    ds_write_b32 v120, v121 offset:8
    s_bitcmp0_b64 vcc, 63
    s_cbranch_scc1 L_p2slow_47
    s_cmp_lg_u32 s51, 0
    s_cbranch_scc1 L_p2slow_47

    s_min_u32 s88, s88, 6552
    s_lshl_b32 s52, s38, 6
    s_add_u32 s52, s52, s36
    s_mul_i32 s52, s52, 32764
    s_add_u32 s16, s44, s52
    s_addc_u32 s17, s45, 0
    s_mul_i32 s52, s88, 5
    s_add_u32 s52, s52, 3
    s_and_b32 s18, s52, -4

    s_movk_i32 s53, 12800
    buffer_load_dwordx4 v[102:105], v2, s[16:19], s53 offen
    buffer_load_dword v113, v2, s[16:19], s53 offen offset:16
    s_movk_i32 s53, 0
    buffer_load_dwordx4 v[4:7], v2, s[16:19], s53 offen
    buffer_load_dword v35, v2, s[16:19], s53 offen offset:16
    s_movk_i32 s53, 2560
    buffer_load_dwordx4 v[8:11], v2, s[16:19], s53 offen
    buffer_load_dword v43, v2, s[16:19], s53 offen offset:16
    s_movk_i32 s53, 15360
    buffer_load_dwordx4 v[106:109], v2, s[16:19], s53 offen
    buffer_load_dword v114, v2, s[16:19], s53 offen offset:16
    s_mov_b32 s40, s88
    s_sub_u32 s42, s40, s39

    s_add_u32 s55, s38, 1
    s_min_u32 s55, s55, 31
    s_mov_b32 s88, s89
    s_mov_b32 s89, s90
    s_mov_b32 s90, s91
    s_mov_b32 s91, s92
    s_mov_b32 s92, s93
    s_mov_b32 s93, s94
    s_mov_b32 s94, s95
    s_mov_b32 s95, 0
    s_min_u32 s88, s88, 6552
    s_lshl_b32 s52, s55, 6
    s_add_u32 s52, s52, s36
    s_mul_i32 s52, s52, 32764
    s_add_u32 s16, s44, s52
    s_addc_u32 s17, s45, 0
    s_mul_i32 s52, s88, 5
    s_add_u32 s52, s52, 3
    s_and_b32 s18, s52, -4

    s_waitcnt vmcnt(12)
    v_perm_b32 v44, v91, v90, s24
    v_perm_b32 v46, v92, v91, s25
    v_perm_b32 v48, v93, v92, s26
    v_perm_b32 v50, v110, v93, s27
    v_mov_b32 v12, v90
    v_alignbyte_b32 v13, v92, v91, 1
    v_alignbyte_b32 v14, v93, v92, 2
    v_alignbyte_b32 v15, v110, v93, 3
    v_lshlrev_b32_sdwa v44, 3, v44 dst_sel:WORD_0 dst_unused:UNUSED_PAD src0_sel:DWORD src1_sel:DWORD
    v_lshlrev_b32_sdwa v46, 3, v46 dst_sel:WORD_0 dst_unused:UNUSED_PAD src0_sel:DWORD src1_sel:DWORD
    v_lshlrev_b32_sdwa v48, 3, v48 dst_sel:WORD_0 dst_unused:UNUSED_PAD src0_sel:DWORD src1_sel:DWORD
    v_lshlrev_b32_sdwa v50, 3, v50 dst_sel:WORD_0 dst_unused:UNUSED_PAD src0_sel:DWORD src1_sel:DWORD
    s_cmp_lt_i32 s42, 1280
    s_cbranch_scc1 L_ufix_48
L_uback_49:

    v_subrev_co_u32 v12, s[80:81], 2.0, v12
    v_subrev_co_u32 v13, s[82:83], 2.0, v13
    v_subrev_co_u32 v14, s[84:85], 2.0, v14
    v_subrev_co_u32 v15, s[86:87], 2.0, v15
    s_mov_b64 exec, s[80:81]
    ds_read_b64 v[44:45], v44
    s_mov_b64 exec, s[82:83]
    ds_read_b64 v[46:47], v46
    s_mov_b64 exec, s[84:85]
    ds_read_b64 v[48:49], v48
    s_mov_b64 exec, s[86:87]
    ds_read_b64 v[50:51], v50
    s_mov_b64 exec, -1
    s_waitcnt vmcnt(10)
    v_perm_b32 v52, v95, v94, s24
    v_perm_b32 v54, v96, v95, s25
    v_perm_b32 v56, v97, v96, s26
    v_perm_b32 v58, v111, v97, s27
    v_mov_b32 v16, v94
    v_alignbyte_b32 v17, v96, v95, 1
    v_alignbyte_b32 v18, v97, v96, 2
    v_alignbyte_b32 v19, v111, v97, 3
    v_lshlrev_b32_sdwa v52, 3, v52 dst_sel:WORD_0 dst_unused:UNUSED_PAD src0_sel:DWORD src1_sel:DWORD
    v_lshlrev_b32_sdwa v54, 3, v54 dst_sel:WORD_0 dst_unused:UNUSED_PAD src0_sel:DWORD src1_sel:DWORD
    v_lshlrev_b32_sdwa v56, 3, v56 dst_sel:WORD_0 dst_unused:UNUSED_PAD src0_sel:DWORD src1_sel:DWORD
    v_lshlrev_b32_sdwa v58, 3, v58 dst_sel:WORD_0 dst_unused:UNUSED_PAD src0_sel:DWORD src1_sel:DWORD
    s_cmp_lt_i32 s42, 1792
    s_cbranch_scc1 L_ufix_50
L_uback_51:

    v_subrev_co_u32 v16, s[64:65], 2.0, v16
    v_subrev_co_u32 v17, s[66:67], 2.0, v17
    v_subrev_co_u32 v18, s[68:69], 2.0, v18
    v_subrev_co_u32 v19, s[70:71], 2.0, v19
    s_mov_b64 exec, s[64:65]
    ds_read_b64 v[52:53], v52
    s_mov_b64 exec, s[66:67]
    ds_read_b64 v[54:55], v54
    s_mov_b64 exec, s[68:69]
    ds_read_b64 v[56:57], v56
    s_mov_b64 exec, s[70:71]
    ds_read_b64 v[58:59], v58
    s_mov_b64 exec, -1
    s_waitcnt vmcnt(8)
    v_perm_b32 v60, v99, v98, s24
    v_perm_b32 v62, v100, v99, s25
    v_perm_b32 v64, v101, v100, s26
    v_perm_b32 v66, v112, v101, s27
    v_mov_b32 v20, v98
    v_alignbyte_b32 v21, v100, v99, 1
    v_alignbyte_b32 v22, v101, v100, 2
    v_alignbyte_b32 v23, v112, v101, 3
    v_lshlrev_b32_sdwa v60, 3, v60 dst_sel:WORD_0 dst_unused:UNUSED_PAD src0_sel:DWORD src1_sel:DWORD
    v_lshlrev_b32_sdwa v62, 3, v62 dst_sel:WORD_0 dst_unused:UNUSED_PAD src0_sel:DWORD src1_sel:DWORD
    v_lshlrev_b32_sdwa v64, 3, v64 dst_sel:WORD_0 dst_unused:UNUSED_PAD src0_sel:DWORD src1_sel:DWORD
    v_lshlrev_b32_sdwa v66, 3, v66 dst_sel:WORD_0 dst_unused:UNUSED_PAD src0_sel:DWORD src1_sel:DWORD
    s_cmp_lt_i32 s42, 2304
    s_cbranch_scc1 L_ufix_52
L_uback_53:

    v_subrev_co_u32 v20, s[72:73], 2.0, v20
    v_subrev_co_u32 v21, s[74:75], 2.0, v21
    v_subrev_co_u32 v22, s[76:77], 2.0, v22
    v_subrev_co_u32 v23, s[78:79], 2.0, v23
    s_mov_b64 exec, s[72:73]
    ds_read_b64 v[60:61], v60
    s_mov_b64 exec, s[74:75]
    ds_read_b64 v[62:63], v62
    s_mov_b64 exec, s[76:77]
    ds_read_b64 v[64:65], v64
    s_mov_b64 exec, s[78:79]
    ds_read_b64 v[66:67], v66
    s_mov_b64 exec, -1
    s_waitcnt vmcnt(6)
    v_perm_b32 v68, v103, v102, s24
    v_perm_b32 v70, v104, v103, s25
    v_perm_b32 v72, v105, v104, s26
    v_perm_b32 v74, v113, v105, s27
    v_mov_b32 v24, v102
    v_alignbyte_b32 v25, v104, v103, 1
    v_alignbyte_b32 v26, v105, v104, 2
    v_alignbyte_b32 v27, v113, v105, 3
    v_lshlrev_b32_sdwa v68, 3, v68 dst_sel:WORD_0 dst_unused:UNUSED_PAD src0_sel:DWORD src1_sel:DWORD
    v_lshlrev_b32_sdwa v70, 3, v70 dst_sel:WORD_0 dst_unused:UNUSED_PAD src0_sel:DWORD src1_sel:DWORD
    v_lshlrev_b32_sdwa v72, 3, v72 dst_sel:WORD_0 dst_unused:UNUSED_PAD src0_sel:DWORD src1_sel:DWORD
    v_lshlrev_b32_sdwa v74, 3, v74 dst_sel:WORD_0 dst_unused:UNUSED_PAD src0_sel:DWORD src1_sel:DWORD
    s_cmp_lt_i32 s42, 2816
    s_cbranch_scc1 L_ufix_54
L_uback_55:

    v_subrev_co_u32 v24, s[80:81], 2.0, v24
    v_subrev_co_u32 v25, s[82:83], 2.0, v25
    v_subrev_co_u32 v26, s[84:85], 2.0, v26
    v_subrev_co_u32 v27, s[86:87], 2.0, v27
    s_mov_b64 exec, s[80:81]
    ds_read_b64 v[68:69], v68
    s_mov_b64 exec, s[82:83]
    ds_read_b64 v[70:71], v70
    s_mov_b64 exec, s[84:85]
    ds_read_b64 v[72:73], v72
    s_mov_b64 exec, s[86:87]
    ds_read_b64 v[74:75], v74
    s_mov_b64 exec, -1
    s_waitcnt vmcnt(4)
    v_perm_b32 v28, v5, v4, s24
    v_perm_b32 v30, v6, v5, s25
    v_perm_b32 v32, v7, v6, s26
    v_perm_b32 v34, v35, v7, s27
    v_alignbyte_b32 v5, v6, v5, 1
    v_alignbyte_b32 v6, v7, v6, 2
    v_alignbyte_b32 v7, v35, v7, 3
    v_lshlrev_b32_sdwa v28, 3, v28 dst_sel:WORD_0 dst_unused:UNUSED_PAD src0_sel:DWORD src1_sel:DWORD
    v_lshlrev_b32_sdwa v30, 3, v30 dst_sel:WORD_0 dst_unused:UNUSED_PAD src0_sel:DWORD src1_sel:DWORD
    v_lshlrev_b32_sdwa v32, 3, v32 dst_sel:WORD_0 dst_unused:UNUSED_PAD src0_sel:DWORD src1_sel:DWORD
    v_lshlrev_b32_sdwa v34, 3, v34 dst_sel:WORD_0 dst_unused:UNUSED_PAD src0_sel:DWORD src1_sel:DWORD
    s_cmp_lt_i32 s42, 256
    s_cbranch_scc1 L_ufix_56
L_uback_57:

    v_subrev_co_u32 v4, s[64:65], 2.0, v4
    v_subrev_co_u32 v5, s[66:67], 2.0, v5
    v_subrev_co_u32 v6, s[68:69], 2.0, v6
    v_subrev_co_u32 v7, s[70:71], 2.0, v7
    s_mov_b64 exec, s[64:65]
    ds_read_b64 v[28:29], v28
    s_mov_b64 exec, s[66:67]
    ds_read_b64 v[30:31], v30
    s_mov_b64 exec, s[68:69]
    ds_read_b64 v[32:33], v32
    s_mov_b64 exec, s[70:71]
    ds_read_b64 v[34:35], v34
    s_mov_b64 exec, -1
    buffer_load_dwordx4 v[76:79], v3, s[12:15], s43 offen
    s_add_u32 s52, s43, 16384
    buffer_load_dwordx4 v[80:83], v3, s[12:15], s52 offen
    s_add_u32 s52, s43, 32768
    buffer_load_dwordx4 v[84:87], v3, s[12:15], s52 offen
    s_add_u32 s52, s43, 49152
    v_lshlrev_b32 v119, 2, v0
    buffer_load_dword v88, v119, s[12:15], s52 offen
    s_add_u32 s54, s43, 50048
    buffer_load_dword v115, v89, s[60:63], s54 offen
    s_add_u32 s54, s50, 0
    buffer_load_dword v115, v89, s[8:11], s54 offen
    s_waitcnt vmcnt(8)
    v_perm_b32 v36, v9, v8, s24
    v_perm_b32 v38, v10, v9, s25
    v_perm_b32 v40, v11, v10, s26
    v_perm_b32 v42, v43, v11, s27
    v_alignbyte_b32 v9, v10, v9, 1
    v_alignbyte_b32 v10, v11, v10, 2
    v_alignbyte_b32 v11, v43, v11, 3
    v_lshlrev_b32_sdwa v36, 3, v36 dst_sel:WORD_0 dst_unused:UNUSED_PAD src0_sel:DWORD src1_sel:DWORD
    v_lshlrev_b32_sdwa v38, 3, v38 dst_sel:WORD_0 dst_unused:UNUSED_PAD src0_sel:DWORD src1_sel:DWORD
    v_lshlrev_b32_sdwa v40, 3, v40 dst_sel:WORD_0 dst_unused:UNUSED_PAD src0_sel:DWORD src1_sel:DWORD
    v_lshlrev_b32_sdwa v42, 3, v42 dst_sel:WORD_0 dst_unused:UNUSED_PAD src0_sel:DWORD src1_sel:DWORD
    s_cmp_lt_i32 s42, 768
    s_cbranch_scc1 L_ufix_58
L_uback_59:

    v_subrev_co_u32 v8, s[72:73], 2.0, v8
    v_subrev_co_u32 v9, s[74:75], 2.0, v9
    v_subrev_co_u32 v10, s[76:77], 2.0, v10
    v_subrev_co_u32 v11, s[78:79], 2.0, v11
    s_mov_b64 exec, s[72:73]
    ds_read_b64 v[36:37], v36
    s_mov_b64 exec, s[74:75]
    ds_read_b64 v[38:39], v38
    s_mov_b64 exec, s[76:77]
    ds_read_b64 v[40:41], v40
    s_mov_b64 exec, s[78:79]
    ds_read_b64 v[42:43], v42
    s_mov_b64 exec, -1
    s_movk_i32 s53, 5120
    buffer_load_dwordx4 v[90:93], v2, s[16:19], s53 offen
    buffer_load_dword v110, v2, s[16:19], s53 offen offset:16
L_batch_60:
    s_add_u32 s5, s38, 1

    s_movk_i32 s53, 7680
    buffer_load_dwordx4 v[94:97], v2, s[16:19], s53 offen
    buffer_load_dword v111, v2, s[16:19], s53 offen offset:16
    v_subrev_co_u32 v4, s[64:65], 2.0, v4
    v_subrev_co_u32 v5, s[66:67], 2.0, v5
    v_subrev_co_u32 v6, s[68:69], 2.0, v6
    v_subrev_co_u32 v7, s[70:71], 2.0, v7
    v_subrev_co_u32 v8, s[72:73], 2.0, v8
    v_subrev_co_u32 v9, s[74:75], 2.0, v9
    v_subrev_co_u32 v10, s[76:77], 2.0, v10
    v_subrev_co_u32 v11, s[78:79], 2.0, v11
    v_subrev_co_u32 v12, s[80:81], 2.0, v12
    v_subrev_co_u32 v13, s[82:83], 2.0, v13
    v_subrev_co_u32 v14, s[84:85], 2.0, v14
    v_subrev_co_u32 v15, s[86:87], 2.0, v15
    s_waitcnt lgkmcnt(0)
    s_barrier
    s_waitcnt vmcnt(5)
    ds_write_addtid_b32 v76 offset:0
    ds_write_addtid_b32 v77 offset:256
    ds_write_addtid_b32 v78 offset:512
    ds_write_addtid_b32 v79 offset:768
    s_waitcnt vmcnt(4)
    ds_write_addtid_b32 v80 offset:16384
    ds_write_addtid_b32 v81 offset:16640
    ds_write_addtid_b32 v82 offset:16896
    ds_write_addtid_b32 v83 offset:17152
    s_waitcnt vmcnt(3)
    ds_write_addtid_b32 v84 offset:32768
    ds_write_addtid_b32 v85 offset:33024
    ds_write_addtid_b32 v86 offset:33280
    ds_write_addtid_b32 v87 offset:33536
    v_lshlrev_b32 v119, 2, v0
    s_waitcnt vmcnt(2)
    s_mov_b64 exec, s[48:49]
    ds_write_b32 v119, v88 offset:49152
    s_mov_b64 exec, -1
    s_add_u32 s43, s43, 50048
    s_add_u32 s14, s43, 50000
    s_min_u32 s14, s14, s41
    buffer_load_dwordx4 v[76:79], v3, s[12:15], s43 offen
    s_waitcnt lgkmcnt(0)
    s_barrier
    s_add_u32 s52, s43, 16384
    buffer_load_dwordx4 v[80:83], v3, s[12:15], s52 offen
    s_add_u32 s52, s43, 32768
    buffer_load_dwordx4 v[84:87], v3, s[12:15], s52 offen
    s_add_u32 s52, s43, 49152
    v_lshlrev_b32 v119, 2, v0
    buffer_load_dword v88, v119, s[12:15], s52 offen
    s_mov_b64 exec, s[64:65]
    ds_read_b64 v[28:29], v28
    s_mov_b64 exec, s[66:67]
    ds_read_b64 v[30:31], v30
    s_mov_b64 exec, s[68:69]
    ds_read_b64 v[32:33], v32
    s_mov_b64 exec, s[70:71]
    ds_read_b64 v[34:35], v34
    s_mov_b64 exec, s[72:73]
    ds_read_b64 v[36:37], v36
    s_mov_b64 exec, s[74:75]
    ds_read_b64 v[38:39], v38
    s_mov_b64 exec, s[76:77]
    ds_read_b64 v[40:41], v40
    s_mov_b64 exec, s[78:79]
    ds_read_b64 v[42:43], v42
    s_mov_b64 exec, s[80:81]
    ds_read_b64 v[44:45], v44
    s_mov_b64 exec, s[82:83]
    ds_read_b64 v[46:47], v46
    s_mov_b64 exec, s[84:85]
    ds_read_b64 v[48:49], v48
    s_mov_b64 exec, s[86:87]
    ds_read_b64 v[50:51], v50
    s_mov_b64 exec, -1
    v_subrev_co_u32 v16, s[64:65], 2.0, v16
    v_subrev_co_u32 v17, s[66:67], 2.0, v17
    v_subrev_co_u32 v18, s[68:69], 2.0, v18
    v_subrev_co_u32 v19, s[70:71], 2.0, v19
    v_subrev_co_u32 v20, s[72:73], 2.0, v20
    v_subrev_co_u32 v21, s[74:75], 2.0, v21
    v_subrev_co_u32 v22, s[76:77], 2.0, v22
    v_subrev_co_u32 v23, s[78:79], 2.0, v23
    v_subrev_co_u32 v24, s[80:81], 2.0, v24
    v_subrev_co_u32 v25, s[82:83], 2.0, v25
    v_subrev_co_u32 v26, s[84:85], 2.0, v26
    v_subrev_co_u32 v27, s[86:87], 2.0, v27
    s_mov_b64 exec, s[64:65]
    ds_read_b64 v[52:53], v52
    s_mov_b64 exec, s[66:67]
    ds_read_b64 v[54:55], v54
    s_mov_b64 exec, s[68:69]
    ds_read_b64 v[56:57], v56
    s_mov_b64 exec, s[70:71]
    ds_read_b64 v[58:59], v58
    s_mov_b64 exec, s[72:73]
    ds_read_b64 v[60:61], v60
    s_mov_b64 exec, s[74:75]
    ds_read_b64 v[62:63], v62
    s_mov_b64 exec, s[76:77]
    ds_read_b64 v[64:65], v64
    s_mov_b64 exec, s[78:79]
    ds_read_b64 v[66:67], v66
    s_mov_b64 exec, s[80:81]
    ds_read_b64 v[68:69], v68
    s_mov_b64 exec, s[82:83]
    ds_read_b64 v[70:71], v70
    s_mov_b64 exec, s[84:85]
    ds_read_b64 v[72:73], v72
    s_mov_b64 exec, s[86:87]
    ds_read_b64 v[74:75], v74
    s_mov_b64 exec, -1
    s_cmp_le_i32 s42, 3072
    s_cbranch_scc1 L_nt1_62
    s_waitcnt vmcnt(14)
    v_perm_b32 v120, v107, v106, s24
    v_perm_b32 v122, v108, v107, s25
    v_perm_b32 v124, v109, v108, s26
    v_perm_b32 v126, v114, v109, s27
    v_alignbyte_b32 v107, v108, v107, 1
    v_alignbyte_b32 v108, v109, v108, 2
    v_alignbyte_b32 v109, v114, v109, 3
    v_lshlrev_b32_sdwa v120, 3, v120 dst_sel:WORD_0 dst_unused:UNUSED_PAD src0_sel:DWORD src1_sel:DWORD
    v_lshlrev_b32_sdwa v122, 3, v122 dst_sel:WORD_0 dst_unused:UNUSED_PAD src0_sel:DWORD src1_sel:DWORD
    v_lshlrev_b32_sdwa v124, 3, v124 dst_sel:WORD_0 dst_unused:UNUSED_PAD src0_sel:DWORD src1_sel:DWORD
    v_lshlrev_b32_sdwa v126, 3, v126 dst_sel:WORD_0 dst_unused:UNUSED_PAD src0_sel:DWORD src1_sel:DWORD
    s_cmp_lt_i32 s42, 3328
    s_cbranch_scc1 L_ufix_65
L_uback_66:

    v_lshrrev_b32 v117, 30, v106
    v_and_b32 v106, 0x3fffffff, v106
    v_mul_u32_u24 v117, 50000, v117
    v_cmp_ne_u32 vcc, 0, v106
    v_add_u32 v120, v120, v117
    s_mov_b64 exec, vcc

    buffer_load_dwordx2 v[120:121], v120, s[8:11], s50 offen
    s_mov_b64 exec, -1
    v_lshrrev_b32 v117, 30, v107
    v_and_b32 v107, 0x3fffffff, v107
    v_mul_u32_u24 v117, 50000, v117
    v_cmp_ne_u32 vcc, 0, v107
    v_add_u32 v122, v122, v117
    s_mov_b64 exec, vcc

    buffer_load_dwordx2 v[122:123], v122, s[8:11], s50 offen
    s_mov_b64 exec, -1
    v_lshrrev_b32 v117, 30, v108
    v_and_b32 v108, 0x3fffffff, v108
    v_mul_u32_u24 v117, 50000, v117
    v_cmp_ne_u32 vcc, 0, v108
    v_add_u32 v124, v124, v117
    s_mov_b64 exec, vcc

    buffer_load_dwordx2 v[124:125], v124, s[8:11], s50 offen
    s_mov_b64 exec, -1
    v_lshrrev_b32 v117, 30, v109
    v_and_b32 v109, 0x3fffffff, v109
    v_mul_u32_u24 v117, 50000, v117
    v_cmp_ne_u32 vcc, 0, v109
    v_add_u32 v126, v126, v117
    s_mov_b64 exec, vcc

    buffer_load_dwordx2 v[126:127], v126, s[8:11], s50 offen
    s_mov_b64 exec, -1
L_nt1_62:
    v_subrev_co_u32 v4, s[64:65], 2.0, v4
    v_subrev_co_u32 v5, s[66:67], 2.0, v5
    v_subrev_co_u32 v6, s[68:69], 2.0, v6
    v_subrev_co_u32 v7, s[70:71], 2.0, v7
    v_subrev_co_u32 v8, s[72:73], 2.0, v8
    v_subrev_co_u32 v9, s[74:75], 2.0, v9
    v_subrev_co_u32 v10, s[76:77], 2.0, v10
    v_subrev_co_u32 v11, s[78:79], 2.0, v11
    v_subrev_co_u32 v12, s[80:81], 2.0, v12
    v_subrev_co_u32 v13, s[82:83], 2.0, v13
    v_subrev_co_u32 v14, s[84:85], 2.0, v14
    v_subrev_co_u32 v15, s[86:87], 2.0, v15
    s_waitcnt lgkmcnt(0)
    s_barrier
    s_waitcnt vmcnt(3)
    ds_write_addtid_b32 v76 offset:0
    ds_write_addtid_b32 v77 offset:256
    ds_write_addtid_b32 v78 offset:512
    ds_write_addtid_b32 v79 offset:768
    s_waitcnt vmcnt(2)
    ds_write_addtid_b32 v80 offset:16384
    ds_write_addtid_b32 v81 offset:16640
    ds_write_addtid_b32 v82 offset:16896
    ds_write_addtid_b32 v83 offset:17152
    s_waitcnt vmcnt(1)
    ds_write_addtid_b32 v84 offset:32768
    ds_write_addtid_b32 v85 offset:33024
    ds_write_addtid_b32 v86 offset:33280
    ds_write_addtid_b32 v87 offset:33536
    v_lshlrev_b32 v119, 2, v0
    s_waitcnt vmcnt(0)
    s_mov_b64 exec, s[48:49]
    ds_write_b32 v119, v88 offset:49152
    s_mov_b64 exec, -1
    s_add_u32 s43, s43, 50048
    s_add_u32 s14, s43, 50000
    s_min_u32 s14, s14, s41
    buffer_load_dwordx4 v[76:79], v3, s[12:15], s43 offen
    s_waitcnt lgkmcnt(0)
    s_barrier
    s_add_u32 s52, s43, 16384
    buffer_load_dwordx4 v[80:83], v3, s[12:15], s52 offen
    s_add_u32 s52, s43, 32768
    buffer_load_dwordx4 v[84:87], v3, s[12:15], s52 offen
    s_add_u32 s52, s43, 49152
    v_lshlrev_b32 v119, 2, v0
    buffer_load_dword v88, v119, s[12:15], s52 offen
    s_mov_b64 exec, s[64:65]
    ds_read_b64 v[28:29], v28
    s_mov_b64 exec, s[66:67]
    ds_read_b64 v[30:31], v30
    s_mov_b64 exec, s[68:69]
    ds_read_b64 v[32:33], v32
    s_mov_b64 exec, s[70:71]
    ds_read_b64 v[34:35], v34
    s_mov_b64 exec, s[72:73]
    ds_read_b64 v[36:37], v36
    s_mov_b64 exec, s[74:75]
    ds_read_b64 v[38:39], v38
    s_mov_b64 exec, s[76:77]
    ds_read_b64 v[40:41], v40
    s_mov_b64 exec, s[78:79]
    ds_read_b64 v[42:43], v42
    s_mov_b64 exec, s[80:81]
    ds_read_b64 v[44:45], v44
    s_mov_b64 exec, s[82:83]
    ds_read_b64 v[46:47], v46
    s_mov_b64 exec, s[84:85]
    ds_read_b64 v[48:49], v48
    s_mov_b64 exec, s[86:87]
    ds_read_b64 v[50:51], v50
    s_mov_b64 exec, -1
    v_subrev_co_u32 v16, s[64:65], 2.0, v16
    v_subrev_co_u32 v17, s[66:67], 2.0, v17
    v_subrev_co_u32 v18, s[68:69], 2.0, v18
    v_subrev_co_u32 v19, s[70:71], 2.0, v19
    v_subrev_co_u32 v20, s[72:73], 2.0, v20
    v_subrev_co_u32 v21, s[74:75], 2.0, v21
    v_subrev_co_u32 v22, s[76:77], 2.0, v22
    v_subrev_co_u32 v23, s[78:79], 2.0, v23
    v_subrev_co_u32 v24, s[80:81], 2.0, v24
    v_subrev_co_u32 v25, s[82:83], 2.0, v25
    v_subrev_co_u32 v26, s[84:85], 2.0, v26
    v_subrev_co_u32 v27, s[86:87], 2.0, v27
    s_mov_b64 exec, s[64:65]
    ds_read_b64 v[52:53], v52
    s_mov_b64 exec, s[66:67]
    ds_read_b64 v[54:55], v54
    s_mov_b64 exec, s[68:69]
    ds_read_b64 v[56:57], v56
    s_mov_b64 exec, s[70:71]
    ds_read_b64 v[58:59], v58
    s_mov_b64 exec, s[72:73]
    ds_read_b64 v[60:61], v60
    s_mov_b64 exec, s[74:75]
    ds_read_b64 v[62:63], v62
    s_mov_b64 exec, s[76:77]
    ds_read_b64 v[64:65], v64
    s_mov_b64 exec, s[78:79]
    ds_read_b64 v[66:67], v66
    s_mov_b64 exec, s[80:81]
    ds_read_b64 v[68:69], v68
    s_mov_b64 exec, s[82:83]
    ds_read_b64 v[70:71], v70
    s_mov_b64 exec, s[84:85]
    ds_read_b64 v[72:73], v72
    s_mov_b64 exec, s[86:87]
    ds_read_b64 v[74:75], v74
    s_mov_b64 exec, -1
    s_movk_i32 s53, 10240
    buffer_load_dwordx4 v[98:101], v2, s[16:19], s53 offen
    buffer_load_dword v112, v2, s[16:19], s53 offen offset:16
    s_cmp_le_i32 s42, 3072
    s_cbranch_scc1 L_nt2_63
    s_waitcnt vmcnt(6)
    v_cmp_ne_u32 s[56:57], 0, v106
    v_cmp_ne_u32 s[58:59], 0, v107
    v_cmp_ne_u32 s[98:99], 0, v108
    v_cmp_ne_u32 vcc, 0, v109
    s_mov_b64 exec, s[56:57]
    v_cvt_f32_i32_sdwa v118, sext(v106) dst_sel:DWORD dst_unused:UNUSED_PAD src0_sel:WORD_0
    v_lshlrev_b32 v116, 16, v120
    v_and_b32 v117, s32, v120
    v_mul_f32 v118, s33, v118
    v_lshlrev_b32 v120, 16, v121
    v_and_b32 v121, s32, v121
    v_lshlrev_b32_sdwa v106, 3, v106 dst_sel:DWORD dst_unused:UNUSED_PAD src0_sel:DWORD src1_sel:WORD_1
    v_pk_fma_f32 v[116:117], v[116:117], v[118:119], s[28:29] op_sel_hi:[1,0,1]
    v_pk_fma_f32 v[120:121], v[120:121], v[118:119], s[28:29] op_sel_hi:[1,0,1]
    v_perm_b32 v116, v117, v116, s35
    v_perm_b32 v117, v121, v120, s35
    v_lshl_add_u64 v[116:117], v[116:117], 0, s[30:31]
    ds_add_rtn_u64 v[120:121], v106, v[116:117] offset:50000

    s_mov_b64 exec, s[58:59]
    v_cvt_f32_i32_sdwa v118, sext(v107) dst_sel:DWORD dst_unused:UNUSED_PAD src0_sel:WORD_0
    v_lshlrev_b32 v116, 16, v122
    v_and_b32 v117, s32, v122
    v_mul_f32 v118, s33, v118
    v_lshlrev_b32 v122, 16, v123
    v_and_b32 v123, s32, v123
    v_lshlrev_b32_sdwa v107, 3, v107 dst_sel:DWORD dst_unused:UNUSED_PAD src0_sel:DWORD src1_sel:WORD_1
    v_pk_fma_f32 v[116:117], v[116:117], v[118:119], s[28:29] op_sel_hi:[1,0,1]
    v_pk_fma_f32 v[122:123], v[122:123], v[118:119], s[28:29] op_sel_hi:[1,0,1]
    v_perm_b32 v116, v117, v116, s35
    v_perm_b32 v117, v123, v122, s35
    v_lshl_add_u64 v[116:117], v[116:117], 0, s[30:31]
    ds_add_rtn_u64 v[122:123], v107, v[116:117] offset:50000

    s_mov_b64 exec, s[98:99]
    v_cvt_f32_i32_sdwa v118, sext(v108) dst_sel:DWORD dst_unused:UNUSED_PAD src0_sel:WORD_0
    v_lshlrev_b32 v116, 16, v124
    v_and_b32 v117, s32, v124
    v_mul_f32 v118, s33, v118
    v_lshlrev_b32 v124, 16, v125
    v_and_b32 v125, s32, v125
    v_lshlrev_b32_sdwa v108, 3, v108 dst_sel:DWORD dst_unused:UNUSED_PAD src0_sel:DWORD src1_sel:WORD_1
    v_pk_fma_f32 v[116:117], v[116:117], v[118:119], s[28:29] op_sel_hi:[1,0,1]
    v_pk_fma_f32 v[124:125], v[124:125], v[118:119], s[28:29] op_sel_hi:[1,0,1]
    v_perm_b32 v116, v117, v116, s35
    v_perm_b32 v117, v125, v124, s35
    v_lshl_add_u64 v[116:117], v[116:117], 0, s[30:31]
    ds_add_rtn_u64 v[124:125], v108, v[116:117] offset:50000

    s_mov_b64 exec, vcc
    v_cvt_f32_i32_sdwa v118, sext(v109) dst_sel:DWORD dst_unused:UNUSED_PAD src0_sel:WORD_0
    v_lshlrev_b32 v116, 16, v126
    v_and_b32 v117, s32, v126
    v_mul_f32 v118, s33, v118
    v_lshlrev_b32 v126, 16, v127
    v_and_b32 v127, s32, v127
    v_lshlrev_b32_sdwa v109, 3, v109 dst_sel:DWORD dst_unused:UNUSED_PAD src0_sel:DWORD src1_sel:WORD_1
    v_pk_fma_f32 v[116:117], v[116:117], v[118:119], s[28:29] op_sel_hi:[1,0,1]
    v_pk_fma_f32 v[126:127], v[126:127], v[118:119], s[28:29] op_sel_hi:[1,0,1]
    v_perm_b32 v116, v117, v116, s35
    v_perm_b32 v117, v127, v126, s35
    v_lshl_add_u64 v[116:117], v[116:117], 0, s[30:31]
    ds_add_rtn_u64 v[126:127], v109, v[116:117] offset:50000

    s_waitcnt lgkmcnt(0)
    s_mov_b64 exec, s[56:57]
    v_or3_b32 v1, v120, v121, v1
    s_mov_b64 exec, s[58:59]
    v_or3_b32 v1, v122, v123, v1
    s_mov_b64 exec, s[98:99]
    v_or3_b32 v1, v124, v125, v1
    s_mov_b64 exec, vcc
    v_or3_b32 v1, v126, v127, v1
    s_mov_b64 exec, -1
L_nt2_63:
    s_movk_i32 s53, 15360
    buffer_load_dwordx4 v[106:109], v2, s[16:19], s53 offen
    buffer_load_dword v114, v2, s[16:19], s53 offen offset:16
    s_cmp_le_u32 s40, 3584
    s_cbranch_scc1 L_noleft_64
    s_min_u32 s40, s40, 6552
    s_lshl_b32 s52, s38, 6
    s_add_u32 s52, s52, s36
    s_mul_i32 s52, s52, 32764
    s_add_u32 s20, s44, s52
    s_addc_u32 s21, s45, 0
    s_mul_i32 s52, s40, 5
    s_add_u32 s52, s52, 3
    s_and_b32 s22, s52, -4

    s_lshr_b32 s55, s39, 2
    s_add_u32 s55, s55, 3584
    v_and_b32 v120, 63, v0
    v_add_u32 v120, s55, v120
L_left_67:
    s_cmp_ge_u32 s55, s40
    s_cbranch_scc1 L_leftend_68
    v_mul_u32_u24 v121, 5, v120
    buffer_load_dword v122, v121, s[20:23], 0 offen
    buffer_load_ubyte v123, v121, s[20:23], 0 offen offset:4
    s_waitcnt vmcnt(0)

    v_perm_b32 v121, v123, v122, s24
    v_lshrrev_b32 v126, 30, v122
    v_and_b32 v121, 0x1fff, v121
    v_mul_u32_u24 v126, 6250, v126
    v_add_lshl_u32 v121, v121, v126, 3

    buffer_load_dwordx2 v[124:125], v121, s[8:11], s50 offen
    v_cmp_gt_u32 vcc, s40, v120
    s_waitcnt vmcnt(0)

    s_mov_b64 exec, vcc
    v_and_b32 v122, 0x3fffffff, v122
    v_cvt_f32_i32_sdwa v118, sext(v122) dst_sel:DWORD dst_unused:UNUSED_PAD src0_sel:WORD_0
    v_lshlrev_b32 v116, 16, v124
    v_and_b32 v117, s32, v124
    v_mul_f32 v118, s33, v118
    v_lshlrev_b32 v124, 16, v125
    v_and_b32 v125, s32, v125
    v_lshlrev_b32_sdwa v122, 3, v122 dst_sel:DWORD dst_unused:UNUSED_PAD src0_sel:DWORD src1_sel:WORD_1
    v_pk_fma_f32 v[116:117], v[116:117], v[118:119], s[28:29] op_sel_hi:[1,0,1]
    v_pk_fma_f32 v[124:125], v[124:125], v[118:119], s[28:29] op_sel_hi:[1,0,1]
    v_perm_b32 v116, v117, v116, s35
    v_perm_b32 v117, v125, v124, s35
    v_lshl_add_u64 v[116:117], v[116:117], 0, s[30:31]
    ds_add_rtn_u64 v[124:125], v122, v[116:117] offset:50000

    s_waitcnt lgkmcnt(0)
    v_or3_b32 v1, v124, v125, v1
    s_mov_b64 exec, -1
    v_add_u32 v120, 128, v120
    s_add_u32 s55, s55, 128
    s_branch L_left_67
L_leftend_68:

L_noleft_64:
    v_cmp_gt_u32 s[64:65], 2.0, v4
    v_and_b32 v4, 0x3fffffff, v4
    v_cmp_gt_u32 s[66:67], 2.0, v5
    v_and_b32 v5, 0x3fffffff, v5
    v_cmp_gt_u32 s[68:69], 2.0, v6
    v_and_b32 v6, 0x3fffffff, v6
    v_cmp_gt_u32 s[70:71], 2.0, v7
    v_and_b32 v7, 0x3fffffff, v7
    v_cmp_gt_u32 s[72:73], 2.0, v8
    v_and_b32 v8, 0x3fffffff, v8
    v_cmp_gt_u32 s[74:75], 2.0, v9
    v_and_b32 v9, 0x3fffffff, v9
    v_cmp_gt_u32 s[76:77], 2.0, v10
    v_and_b32 v10, 0x3fffffff, v10
    v_cmp_gt_u32 s[78:79], 2.0, v11
    v_and_b32 v11, 0x3fffffff, v11
    v_cmp_gt_u32 s[80:81], 2.0, v12
    v_and_b32 v12, 0x3fffffff, v12
    v_cmp_gt_u32 s[82:83], 2.0, v13
    v_and_b32 v13, 0x3fffffff, v13
    v_cmp_gt_u32 s[84:85], 2.0, v14
    v_and_b32 v14, 0x3fffffff, v14
    v_cmp_gt_u32 s[86:87], 2.0, v15
    v_and_b32 v15, 0x3fffffff, v15
    s_waitcnt lgkmcnt(0)
    s_barrier
    s_waitcnt vmcnt(7)
    ds_write_addtid_b32 v76 offset:0
    ds_write_addtid_b32 v77 offset:256
    ds_write_addtid_b32 v78 offset:512
    ds_write_addtid_b32 v79 offset:768
    s_waitcnt vmcnt(6)
    ds_write_addtid_b32 v80 offset:16384
    ds_write_addtid_b32 v81 offset:16640
    ds_write_addtid_b32 v82 offset:16896
    ds_write_addtid_b32 v83 offset:17152
    s_waitcnt vmcnt(5)
    ds_write_addtid_b32 v84 offset:32768
    ds_write_addtid_b32 v85 offset:33024
    ds_write_addtid_b32 v86 offset:33280
    ds_write_addtid_b32 v87 offset:33536
    v_lshlrev_b32 v119, 2, v0
    s_waitcnt vmcnt(4)
    s_mov_b64 exec, s[48:49]
    ds_write_b32 v119, v88 offset:49152
    s_mov_b64 exec, -1
    s_add_u32 s43, s43, 50048
    s_add_u32 s14, s43, 50000
    s_min_u32 s14, s14, s41
    buffer_load_dwordx4 v[76:79], v3, s[12:15], s43 offen
    s_waitcnt lgkmcnt(0)
    s_barrier
    s_add_u32 s52, s43, 16384
    buffer_load_dwordx4 v[80:83], v3, s[12:15], s52 offen
    s_add_u32 s52, s43, 32768
    buffer_load_dwordx4 v[84:87], v3, s[12:15], s52 offen
    s_add_u32 s52, s43, 49152
    v_lshlrev_b32 v119, 2, v0
    buffer_load_dword v88, v119, s[12:15], s52 offen
    s_mov_b64 exec, s[64:65]
    ds_read_b64 v[28:29], v28
    s_mov_b64 exec, s[66:67]
    ds_read_b64 v[30:31], v30
    s_mov_b64 exec, s[68:69]
    ds_read_b64 v[32:33], v32
    s_mov_b64 exec, s[70:71]
    ds_read_b64 v[34:35], v34
    s_mov_b64 exec, s[72:73]
    ds_read_b64 v[36:37], v36
    s_mov_b64 exec, s[74:75]
    ds_read_b64 v[38:39], v38
    s_mov_b64 exec, s[76:77]
    ds_read_b64 v[40:41], v40
    s_mov_b64 exec, s[78:79]
    ds_read_b64 v[42:43], v42
    s_mov_b64 exec, s[80:81]
    ds_read_b64 v[44:45], v44
    s_mov_b64 exec, s[82:83]
    ds_read_b64 v[46:47], v46
    s_mov_b64 exec, s[84:85]
    ds_read_b64 v[48:49], v48
    s_mov_b64 exec, s[86:87]
    ds_read_b64 v[50:51], v50
    s_mov_b64 exec, -1
    v_cmp_gt_u32 s[64:65], 2.0, v16
    v_and_b32 v16, 0x3fffffff, v16
    v_cmp_gt_u32 s[66:67], 2.0, v17
    v_and_b32 v17, 0x3fffffff, v17
    v_cmp_gt_u32 s[68:69], 2.0, v18
    v_and_b32 v18, 0x3fffffff, v18
    v_cmp_gt_u32 s[70:71], 2.0, v19
    v_and_b32 v19, 0x3fffffff, v19
    v_cmp_gt_u32 s[72:73], 2.0, v20
    v_and_b32 v20, 0x3fffffff, v20
    v_cmp_gt_u32 s[74:75], 2.0, v21
    v_and_b32 v21, 0x3fffffff, v21
    v_cmp_gt_u32 s[76:77], 2.0, v22
    v_and_b32 v22, 0x3fffffff, v22
    v_cmp_gt_u32 s[78:79], 2.0, v23
    v_and_b32 v23, 0x3fffffff, v23
    v_cmp_gt_u32 s[80:81], 2.0, v24
    v_and_b32 v24, 0x3fffffff, v24
    v_cmp_gt_u32 s[82:83], 2.0, v25
    v_and_b32 v25, 0x3fffffff, v25
    v_cmp_gt_u32 s[84:85], 2.0, v26
    v_and_b32 v26, 0x3fffffff, v26
    v_cmp_gt_u32 s[86:87], 2.0, v27
    v_and_b32 v27, 0x3fffffff, v27
    s_mov_b64 exec, s[64:65]
    ds_read_b64 v[52:53], v52
    s_mov_b64 exec, s[66:67]
    ds_read_b64 v[54:55], v54
    s_mov_b64 exec, s[68:69]
    ds_read_b64 v[56:57], v56
    s_mov_b64 exec, s[70:71]
    ds_read_b64 v[58:59], v58
    s_mov_b64 exec, s[72:73]
    ds_read_b64 v[60:61], v60
    s_mov_b64 exec, s[74:75]
    ds_read_b64 v[62:63], v62
    s_mov_b64 exec, s[76:77]
    ds_read_b64 v[64:65], v64
    s_mov_b64 exec, s[78:79]
    ds_read_b64 v[66:67], v66
    s_mov_b64 exec, s[80:81]
    ds_read_b64 v[68:69], v68
    s_mov_b64 exec, s[82:83]
    ds_read_b64 v[70:71], v70
    s_mov_b64 exec, s[84:85]
    ds_read_b64 v[72:73], v72
    s_mov_b64 exec, s[86:87]
    ds_read_b64 v[74:75], v74
    s_mov_b64 exec, -1
    s_movk_i32 s53, 12800
    buffer_load_dwordx4 v[102:105], v2, s[16:19], s53 offen
    buffer_load_dword v113, v2, s[16:19], s53 offen offset:16
    s_cmp_ge_u32 s5, s4
    s_cbranch_scc1 L_bend_61
    s_waitcnt lgkmcnt(15)
    v_mad_i32_i16 v120, v28, v4, s96
    v_mad_i32_i16 v28, v28, v4, s96 op_sel:[1,0,0,0]
    v_mad_i32_i16 v121, v29, v4, s96
    v_mad_i32_i16 v29, v29, v4, s96 op_sel:[1,0,0,0]
    v_lshlrev_b32_sdwa v4, 3, v4 dst_sel:DWORD dst_unused:UNUSED_PAD src0_sel:DWORD src1_sel:WORD_1
    v_perm_b32 v28, v28, v120, s97
    v_perm_b32 v29, v29, v121, s97
    v_lshl_add_u64 v[28:29], v[28:29], 0, s[30:31]

    ds_add_rtn_u64 v[28:29], v4, v[28:29] offset:50000
    v_mad_i32_i16 v122, v30, v5, s96
    v_mad_i32_i16 v30, v30, v5, s96 op_sel:[1,0,0,0]
    v_mad_i32_i16 v123, v31, v5, s96
    v_mad_i32_i16 v31, v31, v5, s96 op_sel:[1,0,0,0]
    v_lshlrev_b32_sdwa v5, 3, v5 dst_sel:DWORD dst_unused:UNUSED_PAD src0_sel:DWORD src1_sel:WORD_1
    v_perm_b32 v30, v30, v122, s97
    v_perm_b32 v31, v31, v123, s97
    v_lshl_add_u64 v[30:31], v[30:31], 0, s[30:31]

    ds_add_rtn_u64 v[30:31], v5, v[30:31] offset:50000
    v_mad_i32_i16 v124, v32, v6, s96
    v_mad_i32_i16 v32, v32, v6, s96 op_sel:[1,0,0,0]
    v_mad_i32_i16 v125, v33, v6, s96
    v_mad_i32_i16 v33, v33, v6, s96 op_sel:[1,0,0,0]
    v_lshlrev_b32_sdwa v6, 3, v6 dst_sel:DWORD dst_unused:UNUSED_PAD src0_sel:DWORD src1_sel:WORD_1
    v_perm_b32 v32, v32, v124, s97
    v_perm_b32 v33, v33, v125, s97
    v_lshl_add_u64 v[32:33], v[32:33], 0, s[30:31]

    ds_add_rtn_u64 v[32:33], v6, v[32:33] offset:50000
    v_mad_i32_i16 v126, v34, v7, s96
    v_mad_i32_i16 v34, v34, v7, s96 op_sel:[1,0,0,0]
    v_mad_i32_i16 v127, v35, v7, s96
    v_mad_i32_i16 v35, v35, v7, s96 op_sel:[1,0,0,0]
    v_lshlrev_b32_sdwa v7, 3, v7 dst_sel:DWORD dst_unused:UNUSED_PAD src0_sel:DWORD src1_sel:WORD_1
    v_perm_b32 v34, v34, v126, s97
    v_perm_b32 v35, v35, v127, s97
    v_lshl_add_u64 v[34:35], v[34:35], 0, s[30:31]

    ds_add_rtn_u64 v[34:35], v7, v[34:35] offset:50000
    v_mad_i32_i16 v120, v36, v8, s96
    v_mad_i32_i16 v36, v36, v8, s96 op_sel:[1,0,0,0]
    v_mad_i32_i16 v121, v37, v8, s96
    v_mad_i32_i16 v37, v37, v8, s96 op_sel:[1,0,0,0]
    v_lshlrev_b32_sdwa v8, 3, v8 dst_sel:DWORD dst_unused:UNUSED_PAD src0_sel:DWORD src1_sel:WORD_1
    v_perm_b32 v36, v36, v120, s97
    v_perm_b32 v37, v37, v121, s97
    v_lshl_add_u64 v[36:37], v[36:37], 0, s[30:31]

    ds_add_rtn_u64 v[36:37], v8, v[36:37] offset:50000
    v_mad_i32_i16 v122, v38, v9, s96
    v_mad_i32_i16 v38, v38, v9, s96 op_sel:[1,0,0,0]
    v_mad_i32_i16 v123, v39, v9, s96
    v_mad_i32_i16 v39, v39, v9, s96 op_sel:[1,0,0,0]
    v_lshlrev_b32_sdwa v9, 3, v9 dst_sel:DWORD dst_unused:UNUSED_PAD src0_sel:DWORD src1_sel:WORD_1
    v_perm_b32 v38, v38, v122, s97
    v_perm_b32 v39, v39, v123, s97
    v_lshl_add_u64 v[38:39], v[38:39], 0, s[30:31]

    ds_add_rtn_u64 v[38:39], v9, v[38:39] offset:50000
    v_mad_i32_i16 v124, v40, v10, s96
    v_mad_i32_i16 v40, v40, v10, s96 op_sel:[1,0,0,0]
    v_mad_i32_i16 v125, v41, v10, s96
    v_mad_i32_i16 v41, v41, v10, s96 op_sel:[1,0,0,0]
    v_lshlrev_b32_sdwa v10, 3, v10 dst_sel:DWORD dst_unused:UNUSED_PAD src0_sel:DWORD src1_sel:WORD_1
    v_perm_b32 v40, v40, v124, s97
    v_perm_b32 v41, v41, v125, s97
    v_lshl_add_u64 v[40:41], v[40:41], 0, s[30:31]

    ds_add_rtn_u64 v[40:41], v10, v[40:41] offset:50000
    v_mad_i32_i16 v126, v42, v11, s96
    v_mad_i32_i16 v42, v42, v11, s96 op_sel:[1,0,0,0]
    v_mad_i32_i16 v127, v43, v11, s96
    v_mad_i32_i16 v43, v43, v11, s96 op_sel:[1,0,0,0]
    v_lshlrev_b32_sdwa v11, 3, v11 dst_sel:DWORD dst_unused:UNUSED_PAD src0_sel:DWORD src1_sel:WORD_1
    v_perm_b32 v42, v42, v126, s97
    v_perm_b32 v43, v43, v127, s97
    v_lshl_add_u64 v[42:43], v[42:43], 0, s[30:31]

    ds_add_rtn_u64 v[42:43], v11, v[42:43] offset:50000
    s_waitcnt lgkmcnt(4)
    v_or3_b32 v1, v28, v29, v1
    v_or3_b32 v1, v30, v31, v1
    v_or3_b32 v1, v32, v33, v1
    v_or3_b32 v1, v34, v35, v1
    s_movk_i32 s53, 0
    buffer_load_dwordx4 v[4:7], v2, s[16:19], s53 offen
    buffer_load_dword v35, v2, s[16:19], s53 offen offset:16
    v_mad_i32_i16 v120, v44, v12, s96
    v_mad_i32_i16 v44, v44, v12, s96 op_sel:[1,0,0,0]
    v_mad_i32_i16 v121, v45, v12, s96
    v_mad_i32_i16 v45, v45, v12, s96 op_sel:[1,0,0,0]
    v_lshlrev_b32_sdwa v12, 3, v12 dst_sel:DWORD dst_unused:UNUSED_PAD src0_sel:DWORD src1_sel:WORD_1
    v_perm_b32 v44, v44, v120, s97
    v_perm_b32 v45, v45, v121, s97
    v_lshl_add_u64 v[44:45], v[44:45], 0, s[30:31]

    ds_add_rtn_u64 v[44:45], v12, v[44:45] offset:50000
    v_mad_i32_i16 v122, v46, v13, s96
    v_mad_i32_i16 v46, v46, v13, s96 op_sel:[1,0,0,0]
    v_mad_i32_i16 v123, v47, v13, s96
    v_mad_i32_i16 v47, v47, v13, s96 op_sel:[1,0,0,0]
    v_lshlrev_b32_sdwa v13, 3, v13 dst_sel:DWORD dst_unused:UNUSED_PAD src0_sel:DWORD src1_sel:WORD_1
    v_perm_b32 v46, v46, v122, s97
    v_perm_b32 v47, v47, v123, s97
    v_lshl_add_u64 v[46:47], v[46:47], 0, s[30:31]

    ds_add_rtn_u64 v[46:47], v13, v[46:47] offset:50000
    v_mad_i32_i16 v124, v48, v14, s96
    v_mad_i32_i16 v48, v48, v14, s96 op_sel:[1,0,0,0]
    v_mad_i32_i16 v125, v49, v14, s96
    v_mad_i32_i16 v49, v49, v14, s96 op_sel:[1,0,0,0]
    v_lshlrev_b32_sdwa v14, 3, v14 dst_sel:DWORD dst_unused:UNUSED_PAD src0_sel:DWORD src1_sel:WORD_1
    v_perm_b32 v48, v48, v124, s97
    v_perm_b32 v49, v49, v125, s97
    v_lshl_add_u64 v[48:49], v[48:49], 0, s[30:31]

    ds_add_rtn_u64 v[48:49], v14, v[48:49] offset:50000
    v_mad_i32_i16 v126, v50, v15, s96
    v_mad_i32_i16 v50, v50, v15, s96 op_sel:[1,0,0,0]
    v_mad_i32_i16 v127, v51, v15, s96
    v_mad_i32_i16 v51, v51, v15, s96 op_sel:[1,0,0,0]
    v_lshlrev_b32_sdwa v15, 3, v15 dst_sel:DWORD dst_unused:UNUSED_PAD src0_sel:DWORD src1_sel:WORD_1
    v_perm_b32 v50, v50, v126, s97
    v_perm_b32 v51, v51, v127, s97
    v_lshl_add_u64 v[50:51], v[50:51], 0, s[30:31]

    ds_add_rtn_u64 v[50:51], v15, v[50:51] offset:50000
    s_waitcnt lgkmcnt(4)
    v_or3_b32 v1, v36, v37, v1
    v_or3_b32 v1, v38, v39, v1
    v_or3_b32 v1, v40, v41, v1
    v_or3_b32 v1, v42, v43, v1
    s_movk_i32 s53, 2560
    buffer_load_dwordx4 v[8:11], v2, s[16:19], s53 offen
    buffer_load_dword v43, v2, s[16:19], s53 offen offset:16
    s_barrier
    s_waitcnt vmcnt(9)
    ds_write_addtid_b32 v76 offset:0
    ds_write_addtid_b32 v77 offset:256
    ds_write_addtid_b32 v78 offset:512
    ds_write_addtid_b32 v79 offset:768
    s_waitcnt vmcnt(8)
    ds_write_addtid_b32 v80 offset:16384
    ds_write_addtid_b32 v81 offset:16640
    ds_write_addtid_b32 v82 offset:16896
    ds_write_addtid_b32 v83 offset:17152
    s_waitcnt vmcnt(7)
    ds_write_addtid_b32 v84 offset:32768
    ds_write_addtid_b32 v85 offset:33024
    ds_write_addtid_b32 v86 offset:33280
    ds_write_addtid_b32 v87 offset:33536
    v_lshlrev_b32 v119, 2, v0
    s_waitcnt vmcnt(6)
    s_mov_b64 exec, s[48:49]
    ds_write_b32 v119, v88 offset:49152
    s_mov_b64 exec, -1
    s_add_u32 s43, s43, 50048
    s_add_u32 s14, s43, 50000
    s_min_u32 s14, s14, s41
    s_add_u32 s54, s43, 50048
    buffer_load_dword v115, v89, s[60:63], s54 offen
    s_add_u32 s54, s50, 200000
    buffer_load_dword v115, v89, s[8:11], s54 offen
    s_mov_b32 s40, s88
    s_sub_u32 s42, s40, s39

    s_add_u32 s55, s38, 2
    s_min_u32 s55, s55, 31
    s_mov_b32 s88, s89
    s_mov_b32 s89, s90
    s_mov_b32 s90, s91
    s_mov_b32 s91, s92
    s_mov_b32 s92, s93
    s_mov_b32 s93, s94
    s_mov_b32 s94, s95
    s_mov_b32 s95, 0
    s_min_u32 s88, s88, 6552
    s_lshl_b32 s52, s55, 6
    s_add_u32 s52, s52, s36
    s_mul_i32 s52, s52, 32764
    s_add_u32 s16, s44, s52
    s_addc_u32 s17, s45, 0
    s_mul_i32 s52, s88, 5
    s_add_u32 s52, s52, 3
    s_and_b32 s18, s52, -4

    v_mad_i32_i16 v120, v52, v16, s96
    v_mad_i32_i16 v52, v52, v16, s96 op_sel:[1,0,0,0]
    v_mad_i32_i16 v121, v53, v16, s96
    v_mad_i32_i16 v53, v53, v16, s96 op_sel:[1,0,0,0]
    v_lshlrev_b32_sdwa v16, 3, v16 dst_sel:DWORD dst_unused:UNUSED_PAD src0_sel:DWORD src1_sel:WORD_1
    v_perm_b32 v52, v52, v120, s97
    v_perm_b32 v53, v53, v121, s97
    v_lshl_add_u64 v[52:53], v[52:53], 0, s[30:31]

    ds_add_rtn_u64 v[52:53], v16, v[52:53] offset:50000
    v_mad_i32_i16 v122, v54, v17, s96
    v_mad_i32_i16 v54, v54, v17, s96 op_sel:[1,0,0,0]
    v_mad_i32_i16 v123, v55, v17, s96
    v_mad_i32_i16 v55, v55, v17, s96 op_sel:[1,0,0,0]
    v_lshlrev_b32_sdwa v17, 3, v17 dst_sel:DWORD dst_unused:UNUSED_PAD src0_sel:DWORD src1_sel:WORD_1
    v_perm_b32 v54, v54, v122, s97
    v_perm_b32 v55, v55, v123, s97
    v_lshl_add_u64 v[54:55], v[54:55], 0, s[30:31]

    ds_add_rtn_u64 v[54:55], v17, v[54:55] offset:50000
    v_mad_i32_i16 v124, v56, v18, s96
    v_mad_i32_i16 v56, v56, v18, s96 op_sel:[1,0,0,0]
    v_mad_i32_i16 v125, v57, v18, s96
    v_mad_i32_i16 v57, v57, v18, s96 op_sel:[1,0,0,0]
    v_lshlrev_b32_sdwa v18, 3, v18 dst_sel:DWORD dst_unused:UNUSED_PAD src0_sel:DWORD src1_sel:WORD_1
    v_perm_b32 v56, v56, v124, s97
    v_perm_b32 v57, v57, v125, s97
    v_lshl_add_u64 v[56:57], v[56:57], 0, s[30:31]

    ds_add_rtn_u64 v[56:57], v18, v[56:57] offset:50000
    v_mad_i32_i16 v126, v58, v19, s96
    v_mad_i32_i16 v58, v58, v19, s96 op_sel:[1,0,0,0]
    v_mad_i32_i16 v127, v59, v19, s96
    v_mad_i32_i16 v59, v59, v19, s96 op_sel:[1,0,0,0]
    v_lshlrev_b32_sdwa v19, 3, v19 dst_sel:DWORD dst_unused:UNUSED_PAD src0_sel:DWORD src1_sel:WORD_1
    v_perm_b32 v58, v58, v126, s97
    v_perm_b32 v59, v59, v127, s97
    v_lshl_add_u64 v[58:59], v[58:59], 0, s[30:31]

    ds_add_rtn_u64 v[58:59], v19, v[58:59] offset:50000
    s_waitcnt lgkmcnt(15)
    v_or3_b32 v1, v44, v45, v1
    v_or3_b32 v1, v46, v47, v1
    v_or3_b32 v1, v48, v49, v1
    v_or3_b32 v1, v50, v51, v1
    s_waitcnt vmcnt(26)
    v_perm_b32 v44, v91, v90, s24
    v_perm_b32 v46, v92, v91, s25
    v_perm_b32 v48, v93, v92, s26
    v_perm_b32 v50, v110, v93, s27
    v_mov_b32 v12, v90
    v_alignbyte_b32 v13, v92, v91, 1
    v_alignbyte_b32 v14, v93, v92, 2
    v_alignbyte_b32 v15, v110, v93, 3
    v_lshlrev_b32_sdwa v44, 3, v44 dst_sel:WORD_0 dst_unused:UNUSED_PAD src0_sel:DWORD src1_sel:DWORD
    v_lshlrev_b32_sdwa v46, 3, v46 dst_sel:WORD_0 dst_unused:UNUSED_PAD src0_sel:DWORD src1_sel:DWORD
    v_lshlrev_b32_sdwa v48, 3, v48 dst_sel:WORD_0 dst_unused:UNUSED_PAD src0_sel:DWORD src1_sel:DWORD
    v_lshlrev_b32_sdwa v50, 3, v50 dst_sel:WORD_0 dst_unused:UNUSED_PAD src0_sel:DWORD src1_sel:DWORD
    s_cmp_lt_i32 s42, 1280
    s_cbranch_scc1 L_ufix_69
L_uback_70:

    s_movk_i32 s53, 5120
    buffer_load_dwordx4 v[90:93], v2, s[16:19], s53 offen
    buffer_load_dword v110, v2, s[16:19], s53 offen offset:16
    s_waitcnt lgkmcnt(4)
    s_barrier
    v_subrev_co_u32 v12, s[80:81], 2.0, v12
    v_subrev_co_u32 v13, s[82:83], 2.0, v13
    v_subrev_co_u32 v14, s[84:85], 2.0, v14
    v_subrev_co_u32 v15, s[86:87], 2.0, v15
    s_mov_b64 exec, s[80:81]
    ds_read_b64 v[44:45], v44
    s_mov_b64 exec, s[82:83]
    ds_read_b64 v[46:47], v46
    s_mov_b64 exec, s[84:85]
    ds_read_b64 v[48:49], v48
    s_mov_b64 exec, s[86:87]
    ds_read_b64 v[50:51], v50
    s_mov_b64 exec, -1
    v_mad_i32_i16 v120, v60, v20, s96
    v_mad_i32_i16 v60, v60, v20, s96 op_sel:[1,0,0,0]
    v_mad_i32_i16 v121, v61, v20, s96
    v_mad_i32_i16 v61, v61, v20, s96 op_sel:[1,0,0,0]
    v_lshlrev_b32_sdwa v20, 3, v20 dst_sel:DWORD dst_unused:UNUSED_PAD src0_sel:DWORD src1_sel:WORD_1
    v_perm_b32 v60, v60, v120, s97
    v_perm_b32 v61, v61, v121, s97
    v_lshl_add_u64 v[60:61], v[60:61], 0, s[30:31]

    ds_add_rtn_u64 v[60:61], v20, v[60:61] offset:50000
    v_mad_i32_i16 v122, v62, v21, s96
    v_mad_i32_i16 v62, v62, v21, s96 op_sel:[1,0,0,0]
    v_mad_i32_i16 v123, v63, v21, s96
    v_mad_i32_i16 v63, v63, v21, s96 op_sel:[1,0,0,0]
    v_lshlrev_b32_sdwa v21, 3, v21 dst_sel:DWORD dst_unused:UNUSED_PAD src0_sel:DWORD src1_sel:WORD_1
    v_perm_b32 v62, v62, v122, s97
    v_perm_b32 v63, v63, v123, s97
    v_lshl_add_u64 v[62:63], v[62:63], 0, s[30:31]

    ds_add_rtn_u64 v[62:63], v21, v[62:63] offset:50000
    v_mad_i32_i16 v124, v64, v22, s96
    v_mad_i32_i16 v64, v64, v22, s96 op_sel:[1,0,0,0]
    v_mad_i32_i16 v125, v65, v22, s96
    v_mad_i32_i16 v65, v65, v22, s96 op_sel:[1,0,0,0]
    v_lshlrev_b32_sdwa v22, 3, v22 dst_sel:DWORD dst_unused:UNUSED_PAD src0_sel:DWORD src1_sel:WORD_1
    v_perm_b32 v64, v64, v124, s97
    v_perm_b32 v65, v65, v125, s97
    v_lshl_add_u64 v[64:65], v[64:65], 0, s[30:31]

    ds_add_rtn_u64 v[64:65], v22, v[64:65] offset:50000
    v_mad_i32_i16 v126, v66, v23, s96
    v_mad_i32_i16 v66, v66, v23, s96 op_sel:[1,0,0,0]
    v_mad_i32_i16 v127, v67, v23, s96
    v_mad_i32_i16 v67, v67, v23, s96 op_sel:[1,0,0,0]
    v_lshlrev_b32_sdwa v23, 3, v23 dst_sel:DWORD dst_unused:UNUSED_PAD src0_sel:DWORD src1_sel:WORD_1
    v_perm_b32 v66, v66, v126, s97
    v_perm_b32 v67, v67, v127, s97
    v_lshl_add_u64 v[66:67], v[66:67], 0, s[30:31]

    ds_add_rtn_u64 v[66:67], v23, v[66:67] offset:50000
    s_waitcnt lgkmcnt(8)
    v_or3_b32 v1, v52, v53, v1
    v_or3_b32 v1, v54, v55, v1
    v_or3_b32 v1, v56, v57, v1
    v_or3_b32 v1, v58, v59, v1
    s_waitcnt vmcnt(26)
    v_perm_b32 v52, v95, v94, s24
    v_perm_b32 v54, v96, v95, s25
    v_perm_b32 v56, v97, v96, s26
    v_perm_b32 v58, v111, v97, s27
    v_mov_b32 v16, v94
    v_alignbyte_b32 v17, v96, v95, 1
    v_alignbyte_b32 v18, v97, v96, 2
    v_alignbyte_b32 v19, v111, v97, 3
    v_lshlrev_b32_sdwa v52, 3, v52 dst_sel:WORD_0 dst_unused:UNUSED_PAD src0_sel:DWORD src1_sel:DWORD
    v_lshlrev_b32_sdwa v54, 3, v54 dst_sel:WORD_0 dst_unused:UNUSED_PAD src0_sel:DWORD src1_sel:DWORD
    v_lshlrev_b32_sdwa v56, 3, v56 dst_sel:WORD_0 dst_unused:UNUSED_PAD src0_sel:DWORD src1_sel:DWORD
    v_lshlrev_b32_sdwa v58, 3, v58 dst_sel:WORD_0 dst_unused:UNUSED_PAD src0_sel:DWORD src1_sel:DWORD
    s_cmp_lt_i32 s42, 1792
    s_cbranch_scc1 L_ufix_71
L_uback_72:

    v_subrev_co_u32 v16, s[64:65], 2.0, v16
    v_subrev_co_u32 v17, s[66:67], 2.0, v17
    v_subrev_co_u32 v18, s[68:69], 2.0, v18
    v_subrev_co_u32 v19, s[70:71], 2.0, v19
    s_mov_b64 exec, s[64:65]
    ds_read_b64 v[52:53], v52
    s_mov_b64 exec, s[66:67]
    ds_read_b64 v[54:55], v54
    s_mov_b64 exec, s[68:69]
    ds_read_b64 v[56:57], v56
    s_mov_b64 exec, s[70:71]
    ds_read_b64 v[58:59], v58
    s_mov_b64 exec, -1
    v_mad_i32_i16 v120, v68, v24, s96
    v_mad_i32_i16 v68, v68, v24, s96 op_sel:[1,0,0,0]
    v_mad_i32_i16 v121, v69, v24, s96
    v_mad_i32_i16 v69, v69, v24, s96 op_sel:[1,0,0,0]
    v_lshlrev_b32_sdwa v24, 3, v24 dst_sel:DWORD dst_unused:UNUSED_PAD src0_sel:DWORD src1_sel:WORD_1
    v_perm_b32 v68, v68, v120, s97
    v_perm_b32 v69, v69, v121, s97
    v_lshl_add_u64 v[68:69], v[68:69], 0, s[30:31]

    ds_add_rtn_u64 v[68:69], v24, v[68:69] offset:50000
    v_mad_i32_i16 v122, v70, v25, s96
    v_mad_i32_i16 v70, v70, v25, s96 op_sel:[1,0,0,0]
    v_mad_i32_i16 v123, v71, v25, s96
    v_mad_i32_i16 v71, v71, v25, s96 op_sel:[1,0,0,0]
    v_lshlrev_b32_sdwa v25, 3, v25 dst_sel:DWORD dst_unused:UNUSED_PAD src0_sel:DWORD src1_sel:WORD_1
    v_perm_b32 v70, v70, v122, s97
    v_perm_b32 v71, v71, v123, s97
    v_lshl_add_u64 v[70:71], v[70:71], 0, s[30:31]

    ds_add_rtn_u64 v[70:71], v25, v[70:71] offset:50000
    v_mad_i32_i16 v124, v72, v26, s96
    v_mad_i32_i16 v72, v72, v26, s96 op_sel:[1,0,0,0]
    v_mad_i32_i16 v125, v73, v26, s96
    v_mad_i32_i16 v73, v73, v26, s96 op_sel:[1,0,0,0]
    v_lshlrev_b32_sdwa v26, 3, v26 dst_sel:DWORD dst_unused:UNUSED_PAD src0_sel:DWORD src1_sel:WORD_1
    v_perm_b32 v72, v72, v124, s97
    v_perm_b32 v73, v73, v125, s97
    v_lshl_add_u64 v[72:73], v[72:73], 0, s[30:31]

    ds_add_rtn_u64 v[72:73], v26, v[72:73] offset:50000
    v_mad_i32_i16 v126, v74, v27, s96
    v_mad_i32_i16 v74, v74, v27, s96 op_sel:[1,0,0,0]
    v_mad_i32_i16 v127, v75, v27, s96
    v_mad_i32_i16 v75, v75, v27, s96 op_sel:[1,0,0,0]
    v_lshlrev_b32_sdwa v27, 3, v27 dst_sel:DWORD dst_unused:UNUSED_PAD src0_sel:DWORD src1_sel:WORD_1
    v_perm_b32 v74, v74, v126, s97
    v_perm_b32 v75, v75, v127, s97
    v_lshl_add_u64 v[74:75], v[74:75], 0, s[30:31]

    ds_add_rtn_u64 v[74:75], v27, v[74:75] offset:50000
    s_waitcnt lgkmcnt(8)
    v_or3_b32 v1, v60, v61, v1
    v_or3_b32 v1, v62, v63, v1
    v_or3_b32 v1, v64, v65, v1
    v_or3_b32 v1, v66, v67, v1
    s_waitcnt vmcnt(16)
    v_perm_b32 v60, v99, v98, s24
    v_perm_b32 v62, v100, v99, s25
    v_perm_b32 v64, v101, v100, s26
    v_perm_b32 v66, v112, v101, s27
    v_mov_b32 v20, v98
    v_alignbyte_b32 v21, v100, v99, 1
    v_alignbyte_b32 v22, v101, v100, 2
    v_alignbyte_b32 v23, v112, v101, 3
    v_lshlrev_b32_sdwa v60, 3, v60 dst_sel:WORD_0 dst_unused:UNUSED_PAD src0_sel:DWORD src1_sel:DWORD
    v_lshlrev_b32_sdwa v62, 3, v62 dst_sel:WORD_0 dst_unused:UNUSED_PAD src0_sel:DWORD src1_sel:DWORD
    v_lshlrev_b32_sdwa v64, 3, v64 dst_sel:WORD_0 dst_unused:UNUSED_PAD src0_sel:DWORD src1_sel:DWORD
    v_lshlrev_b32_sdwa v66, 3, v66 dst_sel:WORD_0 dst_unused:UNUSED_PAD src0_sel:DWORD src1_sel:DWORD
    s_cmp_lt_i32 s42, 2304
    s_cbranch_scc1 L_ufix_73
L_uback_74:

    v_subrev_co_u32 v20, s[72:73], 2.0, v20
    v_subrev_co_u32 v21, s[74:75], 2.0, v21
    v_subrev_co_u32 v22, s[76:77], 2.0, v22
    v_subrev_co_u32 v23, s[78:79], 2.0, v23
    s_mov_b64 exec, s[72:73]
    ds_read_b64 v[60:61], v60
    s_mov_b64 exec, s[74:75]
    ds_read_b64 v[62:63], v62
    s_mov_b64 exec, s[76:77]
    ds_read_b64 v[64:65], v64
    s_mov_b64 exec, s[78:79]
    ds_read_b64 v[66:67], v66
    s_mov_b64 exec, -1
    s_waitcnt lgkmcnt(4)
    v_or3_b32 v1, v68, v69, v1
    v_or3_b32 v1, v70, v71, v1
    v_or3_b32 v1, v72, v73, v1
    v_or3_b32 v1, v74, v75, v1
    s_waitcnt vmcnt(8)
    v_perm_b32 v68, v103, v102, s24
    v_perm_b32 v70, v104, v103, s25
    v_perm_b32 v72, v105, v104, s26
    v_perm_b32 v74, v113, v105, s27
    v_mov_b32 v24, v102
    v_alignbyte_b32 v25, v104, v103, 1
    v_alignbyte_b32 v26, v105, v104, 2
    v_alignbyte_b32 v27, v113, v105, 3
    v_lshlrev_b32_sdwa v68, 3, v68 dst_sel:WORD_0 dst_unused:UNUSED_PAD src0_sel:DWORD src1_sel:DWORD
    v_lshlrev_b32_sdwa v70, 3, v70 dst_sel:WORD_0 dst_unused:UNUSED_PAD src0_sel:DWORD src1_sel:DWORD
    v_lshlrev_b32_sdwa v72, 3, v72 dst_sel:WORD_0 dst_unused:UNUSED_PAD src0_sel:DWORD src1_sel:DWORD
    v_lshlrev_b32_sdwa v74, 3, v74 dst_sel:WORD_0 dst_unused:UNUSED_PAD src0_sel:DWORD src1_sel:DWORD
    s_cmp_lt_i32 s42, 2816
    s_cbranch_scc1 L_ufix_75
L_uback_76:

    v_subrev_co_u32 v24, s[80:81], 2.0, v24
    v_subrev_co_u32 v25, s[82:83], 2.0, v25
    v_subrev_co_u32 v26, s[84:85], 2.0, v26
    v_subrev_co_u32 v27, s[86:87], 2.0, v27
    s_mov_b64 exec, s[80:81]
    ds_read_b64 v[68:69], v68
    s_mov_b64 exec, s[82:83]
    ds_read_b64 v[70:71], v70
    s_mov_b64 exec, s[84:85]
    ds_read_b64 v[72:73], v72
    s_mov_b64 exec, s[86:87]
    ds_read_b64 v[74:75], v74
    s_mov_b64 exec, -1
    buffer_load_dwordx4 v[76:79], v3, s[12:15], s43 offen
    s_add_u32 s52, s43, 16384
    buffer_load_dwordx4 v[80:83], v3, s[12:15], s52 offen
    s_add_u32 s52, s43, 32768
    buffer_load_dwordx4 v[84:87], v3, s[12:15], s52 offen
    s_add_u32 s52, s43, 49152
    v_lshlrev_b32 v119, 2, v0
    buffer_load_dword v88, v119, s[12:15], s52 offen
    s_waitcnt vmcnt(10)
    v_perm_b32 v28, v5, v4, s24
    v_perm_b32 v30, v6, v5, s25
    v_perm_b32 v32, v7, v6, s26
    v_perm_b32 v34, v35, v7, s27
    v_alignbyte_b32 v5, v6, v5, 1
    v_alignbyte_b32 v6, v7, v6, 2
    v_alignbyte_b32 v7, v35, v7, 3
    v_lshlrev_b32_sdwa v28, 3, v28 dst_sel:WORD_0 dst_unused:UNUSED_PAD src0_sel:DWORD src1_sel:DWORD
    v_lshlrev_b32_sdwa v30, 3, v30 dst_sel:WORD_0 dst_unused:UNUSED_PAD src0_sel:DWORD src1_sel:DWORD
    v_lshlrev_b32_sdwa v32, 3, v32 dst_sel:WORD_0 dst_unused:UNUSED_PAD src0_sel:DWORD src1_sel:DWORD
    v_lshlrev_b32_sdwa v34, 3, v34 dst_sel:WORD_0 dst_unused:UNUSED_PAD src0_sel:DWORD src1_sel:DWORD
    s_cmp_lt_i32 s42, 256
    s_cbranch_scc1 L_ufix_77
L_uback_78:

    v_subrev_co_u32 v4, s[64:65], 2.0, v4
    v_subrev_co_u32 v5, s[66:67], 2.0, v5
    v_subrev_co_u32 v6, s[68:69], 2.0, v6
    v_subrev_co_u32 v7, s[70:71], 2.0, v7
    s_mov_b64 exec, s[64:65]
    ds_read_b64 v[28:29], v28
    s_mov_b64 exec, s[66:67]
    ds_read_b64 v[30:31], v30
    s_mov_b64 exec, s[68:69]
    ds_read_b64 v[32:33], v32
    s_mov_b64 exec, s[70:71]
    ds_read_b64 v[34:35], v34
    s_mov_b64 exec, -1
    s_waitcnt vmcnt(8)
    v_perm_b32 v36, v9, v8, s24
    v_perm_b32 v38, v10, v9, s25
    v_perm_b32 v40, v11, v10, s26
    v_perm_b32 v42, v43, v11, s27
    v_alignbyte_b32 v9, v10, v9, 1
    v_alignbyte_b32 v10, v11, v10, 2
    v_alignbyte_b32 v11, v43, v11, 3
    v_lshlrev_b32_sdwa v36, 3, v36 dst_sel:WORD_0 dst_unused:UNUSED_PAD src0_sel:DWORD src1_sel:DWORD
    v_lshlrev_b32_sdwa v38, 3, v38 dst_sel:WORD_0 dst_unused:UNUSED_PAD src0_sel:DWORD src1_sel:DWORD
    v_lshlrev_b32_sdwa v40, 3, v40 dst_sel:WORD_0 dst_unused:UNUSED_PAD src0_sel:DWORD src1_sel:DWORD
    v_lshlrev_b32_sdwa v42, 3, v42 dst_sel:WORD_0 dst_unused:UNUSED_PAD src0_sel:DWORD src1_sel:DWORD
    s_cmp_lt_i32 s42, 768
    s_cbranch_scc1 L_ufix_79
L_uback_80:

    v_subrev_co_u32 v8, s[72:73], 2.0, v8
    v_subrev_co_u32 v9, s[74:75], 2.0, v9
    v_subrev_co_u32 v10, s[76:77], 2.0, v10
    v_subrev_co_u32 v11, s[78:79], 2.0, v11
    s_mov_b64 exec, s[72:73]
    ds_read_b64 v[36:37], v36
    s_mov_b64 exec, s[74:75]
    ds_read_b64 v[38:39], v38
    s_mov_b64 exec, s[76:77]
    ds_read_b64 v[40:41], v40
    s_mov_b64 exec, s[78:79]
    ds_read_b64 v[42:43], v42
    s_mov_b64 exec, -1
    s_mov_b32 s38, s5
    s_add_u32 s50, s50, 200000
    s_branch L_batch_60
L_bend_61:

    s_load_dwordx2 s[64:65], s[0:1], 24
    s_load_dwordx2 s[86:87], s[0:1], 40
    s_load_dwordx8 s[88:95], s[0:1], 56
    s_mov_b32 s66, 1600000
    s_mov_b32 s67, 0x20000

    s_waitcnt lgkmcnt(15)
    v_mad_i32_i16 v120, v28, v4, s96
    v_mad_i32_i16 v28, v28, v4, s96 op_sel:[1,0,0,0]
    v_mad_i32_i16 v121, v29, v4, s96
    v_mad_i32_i16 v29, v29, v4, s96 op_sel:[1,0,0,0]
    v_lshlrev_b32_sdwa v4, 3, v4 dst_sel:DWORD dst_unused:UNUSED_PAD src0_sel:DWORD src1_sel:WORD_1
    v_perm_b32 v28, v28, v120, s97
    v_perm_b32 v29, v29, v121, s97
    v_lshl_add_u64 v[28:29], v[28:29], 0, s[30:31]

    ds_add_rtn_u64 v[28:29], v4, v[28:29] offset:50000
    v_mad_i32_i16 v122, v30, v5, s96
    v_mad_i32_i16 v30, v30, v5, s96 op_sel:[1,0,0,0]
    v_mad_i32_i16 v123, v31, v5, s96
    v_mad_i32_i16 v31, v31, v5, s96 op_sel:[1,0,0,0]
    v_lshlrev_b32_sdwa v5, 3, v5 dst_sel:DWORD dst_unused:UNUSED_PAD src0_sel:DWORD src1_sel:WORD_1
    v_perm_b32 v30, v30, v122, s97
    v_perm_b32 v31, v31, v123, s97
    v_lshl_add_u64 v[30:31], v[30:31], 0, s[30:31]

    ds_add_rtn_u64 v[30:31], v5, v[30:31] offset:50000
    v_mad_i32_i16 v124, v32, v6, s96
    v_mad_i32_i16 v32, v32, v6, s96 op_sel:[1,0,0,0]
    v_mad_i32_i16 v125, v33, v6, s96
    v_mad_i32_i16 v33, v33, v6, s96 op_sel:[1,0,0,0]
    v_lshlrev_b32_sdwa v6, 3, v6 dst_sel:DWORD dst_unused:UNUSED_PAD src0_sel:DWORD src1_sel:WORD_1
    v_perm_b32 v32, v32, v124, s97
    v_perm_b32 v33, v33, v125, s97
    v_lshl_add_u64 v[32:33], v[32:33], 0, s[30:31]

    ds_add_rtn_u64 v[32:33], v6, v[32:33] offset:50000
    v_mad_i32_i16 v126, v34, v7, s96
    v_mad_i32_i16 v34, v34, v7, s96 op_sel:[1,0,0,0]
    v_mad_i32_i16 v127, v35, v7, s96
    v_mad_i32_i16 v35, v35, v7, s96 op_sel:[1,0,0,0]
    v_lshlrev_b32_sdwa v7, 3, v7 dst_sel:DWORD dst_unused:UNUSED_PAD src0_sel:DWORD src1_sel:WORD_1
    v_perm_b32 v34, v34, v126, s97
    v_perm_b32 v35, v35, v127, s97
    v_lshl_add_u64 v[34:35], v[34:35], 0, s[30:31]

    ds_add_rtn_u64 v[34:35], v7, v[34:35] offset:50000
    v_mad_i32_i16 v120, v36, v8, s96
    v_mad_i32_i16 v36, v36, v8, s96 op_sel:[1,0,0,0]
    v_mad_i32_i16 v121, v37, v8, s96
    v_mad_i32_i16 v37, v37, v8, s96 op_sel:[1,0,0,0]
    v_lshlrev_b32_sdwa v8, 3, v8 dst_sel:DWORD dst_unused:UNUSED_PAD src0_sel:DWORD src1_sel:WORD_1
    v_perm_b32 v36, v36, v120, s97
    v_perm_b32 v37, v37, v121, s97
    v_lshl_add_u64 v[36:37], v[36:37], 0, s[30:31]

    ds_add_rtn_u64 v[36:37], v8, v[36:37] offset:50000
    v_mad_i32_i16 v122, v38, v9, s96
    v_mad_i32_i16 v38, v38, v9, s96 op_sel:[1,0,0,0]
    v_mad_i32_i16 v123, v39, v9, s96
    v_mad_i32_i16 v39, v39, v9, s96 op_sel:[1,0,0,0]
    v_lshlrev_b32_sdwa v9, 3, v9 dst_sel:DWORD dst_unused:UNUSED_PAD src0_sel:DWORD src1_sel:WORD_1
    v_perm_b32 v38, v38, v122, s97
    v_perm_b32 v39, v39, v123, s97
    v_lshl_add_u64 v[38:39], v[38:39], 0, s[30:31]

    ds_add_rtn_u64 v[38:39], v9, v[38:39] offset:50000
    v_mad_i32_i16 v124, v40, v10, s96
    v_mad_i32_i16 v40, v40, v10, s96 op_sel:[1,0,0,0]
    v_mad_i32_i16 v125, v41, v10, s96
    v_mad_i32_i16 v41, v41, v10, s96 op_sel:[1,0,0,0]
    v_lshlrev_b32_sdwa v10, 3, v10 dst_sel:DWORD dst_unused:UNUSED_PAD src0_sel:DWORD src1_sel:WORD_1
    v_perm_b32 v40, v40, v124, s97
    v_perm_b32 v41, v41, v125, s97
    v_lshl_add_u64 v[40:41], v[40:41], 0, s[30:31]

    ds_add_rtn_u64 v[40:41], v10, v[40:41] offset:50000
    v_mad_i32_i16 v126, v42, v11, s96
    v_mad_i32_i16 v42, v42, v11, s96 op_sel:[1,0,0,0]
    v_mad_i32_i16 v127, v43, v11, s96
    v_mad_i32_i16 v43, v43, v11, s96 op_sel:[1,0,0,0]
    v_lshlrev_b32_sdwa v11, 3, v11 dst_sel:DWORD dst_unused:UNUSED_PAD src0_sel:DWORD src1_sel:WORD_1
    v_perm_b32 v42, v42, v126, s97
    v_perm_b32 v43, v43, v127, s97
    v_lshl_add_u64 v[42:43], v[42:43], 0, s[30:31]

    ds_add_rtn_u64 v[42:43], v11, v[42:43] offset:50000
    s_waitcnt lgkmcnt(4)
    v_or3_b32 v1, v28, v29, v1
    v_or3_b32 v1, v30, v31, v1
    v_or3_b32 v1, v32, v33, v1
    v_or3_b32 v1, v34, v35, v1
    v_mad_i32_i16 v120, v44, v12, s96
    v_mad_i32_i16 v44, v44, v12, s96 op_sel:[1,0,0,0]
    v_mad_i32_i16 v121, v45, v12, s96
    v_mad_i32_i16 v45, v45, v12, s96 op_sel:[1,0,0,0]
    v_lshlrev_b32_sdwa v12, 3, v12 dst_sel:DWORD dst_unused:UNUSED_PAD src0_sel:DWORD src1_sel:WORD_1
    v_perm_b32 v44, v44, v120, s97
    v_perm_b32 v45, v45, v121, s97
    v_lshl_add_u64 v[44:45], v[44:45], 0, s[30:31]

    ds_add_rtn_u64 v[44:45], v12, v[44:45] offset:50000
    v_mad_i32_i16 v122, v46, v13, s96
    v_mad_i32_i16 v46, v46, v13, s96 op_sel:[1,0,0,0]
    v_mad_i32_i16 v123, v47, v13, s96
    v_mad_i32_i16 v47, v47, v13, s96 op_sel:[1,0,0,0]
    v_lshlrev_b32_sdwa v13, 3, v13 dst_sel:DWORD dst_unused:UNUSED_PAD src0_sel:DWORD src1_sel:WORD_1
    v_perm_b32 v46, v46, v122, s97
    v_perm_b32 v47, v47, v123, s97
    v_lshl_add_u64 v[46:47], v[46:47], 0, s[30:31]

    ds_add_rtn_u64 v[46:47], v13, v[46:47] offset:50000
    v_mad_i32_i16 v124, v48, v14, s96
    v_mad_i32_i16 v48, v48, v14, s96 op_sel:[1,0,0,0]
    v_mad_i32_i16 v125, v49, v14, s96
    v_mad_i32_i16 v49, v49, v14, s96 op_sel:[1,0,0,0]
    v_lshlrev_b32_sdwa v14, 3, v14 dst_sel:DWORD dst_unused:UNUSED_PAD src0_sel:DWORD src1_sel:WORD_1
    v_perm_b32 v48, v48, v124, s97
    v_perm_b32 v49, v49, v125, s97
    v_lshl_add_u64 v[48:49], v[48:49], 0, s[30:31]

    ds_add_rtn_u64 v[48:49], v14, v[48:49] offset:50000
    v_mad_i32_i16 v126, v50, v15, s96
    v_mad_i32_i16 v50, v50, v15, s96 op_sel:[1,0,0,0]
    v_mad_i32_i16 v127, v51, v15, s96
    v_mad_i32_i16 v51, v51, v15, s96 op_sel:[1,0,0,0]
    v_lshlrev_b32_sdwa v15, 3, v15 dst_sel:DWORD dst_unused:UNUSED_PAD src0_sel:DWORD src1_sel:WORD_1
    v_perm_b32 v50, v50, v126, s97
    v_perm_b32 v51, v51, v127, s97
    v_lshl_add_u64 v[50:51], v[50:51], 0, s[30:31]

    ds_add_rtn_u64 v[50:51], v15, v[50:51] offset:50000
    s_waitcnt lgkmcnt(4)
    v_or3_b32 v1, v36, v37, v1
    v_or3_b32 v1, v38, v39, v1
    v_or3_b32 v1, v40, v41, v1
    v_or3_b32 v1, v42, v43, v1
    v_mad_i32_i16 v120, v52, v16, s96
    v_mad_i32_i16 v52, v52, v16, s96 op_sel:[1,0,0,0]
    v_mad_i32_i16 v121, v53, v16, s96
    v_mad_i32_i16 v53, v53, v16, s96 op_sel:[1,0,0,0]
    v_lshlrev_b32_sdwa v16, 3, v16 dst_sel:DWORD dst_unused:UNUSED_PAD src0_sel:DWORD src1_sel:WORD_1
    v_perm_b32 v52, v52, v120, s97
    v_perm_b32 v53, v53, v121, s97
    v_lshl_add_u64 v[52:53], v[52:53], 0, s[30:31]

    ds_add_rtn_u64 v[52:53], v16, v[52:53] offset:50000
    v_mad_i32_i16 v122, v54, v17, s96
    v_mad_i32_i16 v54, v54, v17, s96 op_sel:[1,0,0,0]
    v_mad_i32_i16 v123, v55, v17, s96
    v_mad_i32_i16 v55, v55, v17, s96 op_sel:[1,0,0,0]
    v_lshlrev_b32_sdwa v17, 3, v17 dst_sel:DWORD dst_unused:UNUSED_PAD src0_sel:DWORD src1_sel:WORD_1
    v_perm_b32 v54, v54, v122, s97
    v_perm_b32 v55, v55, v123, s97
    v_lshl_add_u64 v[54:55], v[54:55], 0, s[30:31]

    ds_add_rtn_u64 v[54:55], v17, v[54:55] offset:50000
    v_mad_i32_i16 v124, v56, v18, s96
    v_mad_i32_i16 v56, v56, v18, s96 op_sel:[1,0,0,0]
    v_mad_i32_i16 v125, v57, v18, s96
    v_mad_i32_i16 v57, v57, v18, s96 op_sel:[1,0,0,0]
    v_lshlrev_b32_sdwa v18, 3, v18 dst_sel:DWORD dst_unused:UNUSED_PAD src0_sel:DWORD src1_sel:WORD_1
    v_perm_b32 v56, v56, v124, s97
    v_perm_b32 v57, v57, v125, s97
    v_lshl_add_u64 v[56:57], v[56:57], 0, s[30:31]

    ds_add_rtn_u64 v[56:57], v18, v[56:57] offset:50000
    v_mad_i32_i16 v126, v58, v19, s96
    v_mad_i32_i16 v58, v58, v19, s96 op_sel:[1,0,0,0]
    v_mad_i32_i16 v127, v59, v19, s96
    v_mad_i32_i16 v59, v59, v19, s96 op_sel:[1,0,0,0]
    v_lshlrev_b32_sdwa v19, 3, v19 dst_sel:DWORD dst_unused:UNUSED_PAD src0_sel:DWORD src1_sel:WORD_1
    v_perm_b32 v58, v58, v126, s97
    v_perm_b32 v59, v59, v127, s97
    v_lshl_add_u64 v[58:59], v[58:59], 0, s[30:31]

    ds_add_rtn_u64 v[58:59], v19, v[58:59] offset:50000
    s_waitcnt lgkmcnt(4)
    v_or3_b32 v1, v44, v45, v1
    v_or3_b32 v1, v46, v47, v1
    v_or3_b32 v1, v48, v49, v1
    v_or3_b32 v1, v50, v51, v1
    v_mad_i32_i16 v120, v60, v20, s96
    v_mad_i32_i16 v60, v60, v20, s96 op_sel:[1,0,0,0]
    v_mad_i32_i16 v121, v61, v20, s96
    v_mad_i32_i16 v61, v61, v20, s96 op_sel:[1,0,0,0]
    v_lshlrev_b32_sdwa v20, 3, v20 dst_sel:DWORD dst_unused:UNUSED_PAD src0_sel:DWORD src1_sel:WORD_1
    v_perm_b32 v60, v60, v120, s97
    v_perm_b32 v61, v61, v121, s97
    v_lshl_add_u64 v[60:61], v[60:61], 0, s[30:31]

    ds_add_rtn_u64 v[60:61], v20, v[60:61] offset:50000
    v_mad_i32_i16 v122, v62, v21, s96
    v_mad_i32_i16 v62, v62, v21, s96 op_sel:[1,0,0,0]
    v_mad_i32_i16 v123, v63, v21, s96
    v_mad_i32_i16 v63, v63, v21, s96 op_sel:[1,0,0,0]
    v_lshlrev_b32_sdwa v21, 3, v21 dst_sel:DWORD dst_unused:UNUSED_PAD src0_sel:DWORD src1_sel:WORD_1
    v_perm_b32 v62, v62, v122, s97
    v_perm_b32 v63, v63, v123, s97
    v_lshl_add_u64 v[62:63], v[62:63], 0, s[30:31]

    ds_add_rtn_u64 v[62:63], v21, v[62:63] offset:50000
    v_mad_i32_i16 v124, v64, v22, s96
    v_mad_i32_i16 v64, v64, v22, s96 op_sel:[1,0,0,0]
    v_mad_i32_i16 v125, v65, v22, s96
    v_mad_i32_i16 v65, v65, v22, s96 op_sel:[1,0,0,0]
    v_lshlrev_b32_sdwa v22, 3, v22 dst_sel:DWORD dst_unused:UNUSED_PAD src0_sel:DWORD src1_sel:WORD_1
    v_perm_b32 v64, v64, v124, s97
    v_perm_b32 v65, v65, v125, s97
    v_lshl_add_u64 v[64:65], v[64:65], 0, s[30:31]

    ds_add_rtn_u64 v[64:65], v22, v[64:65] offset:50000
    v_mad_i32_i16 v126, v66, v23, s96
    v_mad_i32_i16 v66, v66, v23, s96 op_sel:[1,0,0,0]
    v_mad_i32_i16 v127, v67, v23, s96
    v_mad_i32_i16 v67, v67, v23, s96 op_sel:[1,0,0,0]
    v_lshlrev_b32_sdwa v23, 3, v23 dst_sel:DWORD dst_unused:UNUSED_PAD src0_sel:DWORD src1_sel:WORD_1
    v_perm_b32 v66, v66, v126, s97
    v_perm_b32 v67, v67, v127, s97
    v_lshl_add_u64 v[66:67], v[66:67], 0, s[30:31]

    ds_add_rtn_u64 v[66:67], v23, v[66:67] offset:50000
    s_waitcnt lgkmcnt(4)
    v_or3_b32 v1, v52, v53, v1
    v_or3_b32 v1, v54, v55, v1
    v_or3_b32 v1, v56, v57, v1
    v_or3_b32 v1, v58, v59, v1
    v_mad_i32_i16 v120, v68, v24, s96
    v_mad_i32_i16 v68, v68, v24, s96 op_sel:[1,0,0,0]
    v_mad_i32_i16 v121, v69, v24, s96
    v_mad_i32_i16 v69, v69, v24, s96 op_sel:[1,0,0,0]
    v_lshlrev_b32_sdwa v24, 3, v24 dst_sel:DWORD dst_unused:UNUSED_PAD src0_sel:DWORD src1_sel:WORD_1
    v_perm_b32 v68, v68, v120, s97
    v_perm_b32 v69, v69, v121, s97
    v_lshl_add_u64 v[68:69], v[68:69], 0, s[30:31]

    ds_add_rtn_u64 v[68:69], v24, v[68:69] offset:50000
    v_mad_i32_i16 v122, v70, v25, s96
    v_mad_i32_i16 v70, v70, v25, s96 op_sel:[1,0,0,0]
    v_mad_i32_i16 v123, v71, v25, s96
    v_mad_i32_i16 v71, v71, v25, s96 op_sel:[1,0,0,0]
    v_lshlrev_b32_sdwa v25, 3, v25 dst_sel:DWORD dst_unused:UNUSED_PAD src0_sel:DWORD src1_sel:WORD_1
    v_perm_b32 v70, v70, v122, s97
    v_perm_b32 v71, v71, v123, s97
    v_lshl_add_u64 v[70:71], v[70:71], 0, s[30:31]

    ds_add_rtn_u64 v[70:71], v25, v[70:71] offset:50000
    v_mad_i32_i16 v124, v72, v26, s96
    v_mad_i32_i16 v72, v72, v26, s96 op_sel:[1,0,0,0]
    v_mad_i32_i16 v125, v73, v26, s96
    v_mad_i32_i16 v73, v73, v26, s96 op_sel:[1,0,0,0]
    v_lshlrev_b32_sdwa v26, 3, v26 dst_sel:DWORD dst_unused:UNUSED_PAD src0_sel:DWORD src1_sel:WORD_1
    v_perm_b32 v72, v72, v124, s97
    v_perm_b32 v73, v73, v125, s97
    v_lshl_add_u64 v[72:73], v[72:73], 0, s[30:31]

    ds_add_rtn_u64 v[72:73], v26, v[72:73] offset:50000
    v_mad_i32_i16 v126, v74, v27, s96
    v_mad_i32_i16 v74, v74, v27, s96 op_sel:[1,0,0,0]
    v_mad_i32_i16 v127, v75, v27, s96
    v_mad_i32_i16 v75, v75, v27, s96 op_sel:[1,0,0,0]
    v_lshlrev_b32_sdwa v27, 3, v27 dst_sel:DWORD dst_unused:UNUSED_PAD src0_sel:DWORD src1_sel:WORD_1
    v_perm_b32 v74, v74, v126, s97
    v_perm_b32 v75, v75, v127, s97
    v_lshl_add_u64 v[74:75], v[74:75], 0, s[30:31]

    ds_add_rtn_u64 v[74:75], v27, v[74:75] offset:50000
    s_waitcnt lgkmcnt(4)
    v_or3_b32 v1, v60, v61, v1
    v_or3_b32 v1, v62, v63, v1
    v_or3_b32 v1, v64, v65, v1
    v_or3_b32 v1, v66, v67, v1
    s_waitcnt lgkmcnt(0)
    v_or3_b32 v1, v68, v69, v1
    v_or3_b32 v1, v70, v71, v1
    v_or3_b32 v1, v72, v73, v1
    v_or3_b32 v1, v74, v75, v1
    s_waitcnt vmcnt(0)
    s_waitcnt lgkmcnt(0)
    s_load_dwordx4 s[28:31], s[86:87], 0
    s_load_dwordx16 s[68:83], s[88:89], 0
    s_load_dwordx8 s[12:19], s[92:93], 0
    s_load_dwordx8 s[56:63], s[94:95], 0
    s_mov_b64 s[48:49], s[90:91]
    s_load_dwordx16 s[84:99], s[48:49], 0

    s_mov_b32 s41, s37
    s_mul_i32 s3, s41, 3125
    s_add_u32 s5, s3, 3126
    s_add_u32 s3, s3, 1
    s_lshr_b32 s3, s3, 1
    s_lshr_b32 s5, s5, 1
    s_sub_u32 s5, s5, s3
    s_sub_u32 s5, s5, 782
    v_cmp_gt_u32 vcc, s5, v0
    s_mul_i32 s5, s36, 6250
    s_add_u32 s3, s3, s5
    v_add_u32 v6, s3, v0
    v_add_u32 v7, 782, v6
    v_mov_b32 v8, 0x2000000
    v_lshlrev_b32 v4, 4, v6
    v_cndmask_b32 v7, v8, v7, vcc
    v_lshlrev_b32 v6, 2, v6
    v_lshlrev_b32 v5, 4, v7
    v_lshlrev_b32 v7, 2, v7
    v_cmp_gt_u32 vcc, 782, v0
    s_mov_b64 exec, vcc
    s_cbranch_execz L_skld_84
    buffer_load_dword v6, v6, s[64:67], 0 offen
    buffer_load_dword v7, v7, s[64:67], 0 offen
    buffer_load_dwordx4 v[108:111], v4, s[8:11], 0 offen
    buffer_load_dwordx4 v[112:115], v5, s[8:11], 0 offen

L_skld_84:
    s_mov_b64 exec, -1
    s_barrier

    v_add_u32 v116, 50000, v3
    v_add_u32 v117, 115536, v3
    v_cmp_gt_u32 vcc, 106, v0

    v_mov_b32 v100, 0
    v_mov_b32 v101, 0
    v_mov_b32 v102, 0
    v_mov_b32 v103, 0
    ds_read_b128 v[76:79], v116 offset:0
    ds_read_b128 v[80:83], v116 offset:16384
    ds_read_b128 v[84:87], v116 offset:32768
    ds_read_b128 v[88:91], v116 offset:49152
    ds_read_b128 v[92:95], v117 offset:0
    ds_read_b128 v[96:99], v117 offset:16384
    s_mov_b64 exec, vcc
    ds_read_b128 v[100:103], v117 offset:32768
    s_mov_b64 exec, -1
    s_mul_i32 s3, s37, 6400000
    s_mul_i32 s5, s36, 100000
    s_add_u32 s3, s3, s5
    s_add_u32 s3, s3, 6799360

    s_add_u32 s20, s6, s3
    s_addc_u32 s21, s7, 0
    s_mov_b32 s22, 100000
    s_mov_b32 s23, 0x20000
    s_waitcnt lgkmcnt(6)
    s_mov_b32 s3, 0
    buffer_store_dwordx4 v[76:79], v3, s[20:23], s3 offen sc1
    s_waitcnt lgkmcnt(5)
    s_mov_b32 s3, 16384
    buffer_store_dwordx4 v[80:83], v3, s[20:23], s3 offen sc1
    s_waitcnt lgkmcnt(4)
    s_mov_b32 s3, 32768
    buffer_store_dwordx4 v[84:87], v3, s[20:23], s3 offen sc1
    s_waitcnt lgkmcnt(3)
    s_mov_b32 s3, 49152
    buffer_store_dwordx4 v[88:91], v3, s[20:23], s3 offen sc1
    s_waitcnt lgkmcnt(2)
    s_mov_b32 s3, 65536
    buffer_store_dwordx4 v[92:95], v3, s[20:23], s3 offen sc1
    s_waitcnt lgkmcnt(1)
    s_mov_b32 s3, 81920
    buffer_store_dwordx4 v[96:99], v3, s[20:23], s3 offen sc1
    s_waitcnt lgkmcnt(0)
    s_mov_b32 s3, 98304
    buffer_store_dwordx4 v[100:103], v3, s[20:23], s3 offen sc1
    v_or3_b32 v1, v76, v77, v1
    v_or3_b32 v1, v78, v79, v1
    v_or3_b32 v1, v80, v81, v1
    v_or3_b32 v1, v82, v83, v1
    v_or3_b32 v1, v84, v85, v1
    v_or3_b32 v1, v86, v87, v1
    v_or3_b32 v1, v88, v89, v1
    v_or3_b32 v1, v90, v91, v1
    v_or3_b32 v1, v92, v93, v1
    v_or3_b32 v1, v94, v95, v1
    v_or3_b32 v1, v96, v97, v1
    v_or3_b32 v1, v98, v99, v1
    v_or3_b32 v1, v100, v101, v1
    v_or3_b32 v1, v102, v103, v1
    v_and_b32 v1, 0x80008000, v1
    v_cmp_ne_u32 vcc, 0, v1
    v_mov_b32 v116, 150024
    v_mov_b32 v117, 1
    s_cbranch_vccz L_nf_81
    ds_write_b32 v116, v117
L_nf_81:
    s_mov_b32 s33, 1
    s_mov_b32 s42, 0
    v_cmp_gt_u32 vcc, 782, v0
    s_mov_b64 exec, vcc
    s_cbranch_execz L_p1end_86
    s_waitcnt vmcnt(9)
    s_branch L_lddone_83
L_fin_82:

    s_load_dwordx2 s[64:65], s[0:1], 24
    s_load_dwordx2 s[86:87], s[0:1], 40
    s_load_dwordx8 s[88:95], s[0:1], 56
    s_mov_b32 s66, 1600000
    s_mov_b32 s67, 0x20000

    s_waitcnt lgkmcnt(0)
    s_load_dwordx4 s[28:31], s[86:87], 0
    s_load_dwordx16 s[68:83], s[88:89], 0
    s_load_dwordx8 s[12:19], s[92:93], 0
    s_load_dwordx8 s[56:63], s[94:95], 0
    s_mov_b64 s[48:49], s[90:91]
    s_load_dwordx16 s[84:99], s[48:49], 0

    s_mov_b32 s42, 1
    s_mov_b32 s41, s37
L_qloop_85:
    s_mul_i32 s3, s41, 3125
    s_add_u32 s5, s3, 3126
    s_add_u32 s3, s3, 1
    s_lshr_b32 s3, s3, 1
    s_lshr_b32 s5, s5, 1
    s_sub_u32 s5, s5, s3
    s_sub_u32 s5, s5, 782
    v_cmp_gt_u32 vcc, s5, v0
    s_mul_i32 s5, s36, 6250
    s_add_u32 s3, s3, s5
    v_add_u32 v6, s3, v0
    v_add_u32 v7, 782, v6
    v_mov_b32 v8, 0x2000000
    v_lshlrev_b32 v4, 4, v6
    v_cndmask_b32 v7, v8, v7, vcc
    v_lshlrev_b32 v6, 2, v6
    v_lshlrev_b32 v5, 4, v7
    v_lshlrev_b32 v7, 2, v7
    v_cmp_gt_u32 vcc, 782, v0
    s_mov_b64 exec, vcc
    s_cbranch_execz L_p1end_86
    buffer_load_dword v6, v6, s[64:67], 0 offen
    buffer_load_dword v7, v7, s[64:67], 0 offen
    buffer_load_dwordx4 v[108:111], v4, s[8:11], 0 offen
    buffer_load_dwordx4 v[112:115], v5, s[8:11], 0 offen

    s_waitcnt vmcnt(2)
L_lddone_83:
    s_waitcnt lgkmcnt(0)
    v_lshlrev_b32 v8, 16, v6
    v_and_b32 v9, s32, v6
    v_lshlrev_b32 v10, 16, v7
    v_and_b32 v11, s32, v7

    s_lshl_b32 s52, s28, 16
    v_subrev_f32 v12, s52, v8
    v_subrev_f32 v20, s52, v9
    v_subrev_f32 v28, s52, v10
    v_subrev_f32 v36, s52, v11
    s_and_b32 s53, s28, s32
    v_subrev_f32 v13, s53, v8
    v_subrev_f32 v21, s53, v9
    v_subrev_f32 v29, s53, v10
    v_subrev_f32 v37, s53, v11
    s_lshl_b32 s52, s29, 16
    v_subrev_f32 v14, s52, v8
    v_subrev_f32 v22, s52, v9
    v_subrev_f32 v30, s52, v10
    v_subrev_f32 v38, s52, v11
    s_and_b32 s53, s29, s32
    v_subrev_f32 v15, s53, v8
    v_subrev_f32 v23, s53, v9
    v_subrev_f32 v31, s53, v10
    v_subrev_f32 v39, s53, v11
    s_lshl_b32 s52, s30, 16
    v_subrev_f32 v16, s52, v8
    v_subrev_f32 v24, s52, v9
    v_subrev_f32 v32, s52, v10
    v_subrev_f32 v40, s52, v11
    s_and_b32 s53, s30, s32
    v_subrev_f32 v17, s53, v8
    v_subrev_f32 v25, s53, v9
    v_subrev_f32 v33, s53, v10
    v_subrev_f32 v41, s53, v11
    s_lshl_b32 s52, s31, 16
    v_subrev_f32 v18, s52, v8
    v_subrev_f32 v26, s52, v9
    v_subrev_f32 v34, s52, v10
    v_subrev_f32 v42, s52, v11
    s_and_b32 s53, s31, s32
    v_subrev_f32 v19, s53, v8
    v_subrev_f32 v27, s53, v9
    v_subrev_f32 v35, s53, v10
    v_subrev_f32 v43, s53, v11
    v_cvt_pk_bf16_f32 v12, v12, v13
    v_cvt_pk_bf16_f32 v14, v14, v15
    v_cvt_pk_bf16_f32 v16, v16, v17
    v_cvt_pk_bf16_f32 v18, v18, v19
    v_cvt_pk_bf16_f32 v20, v20, v21
    v_cvt_pk_bf16_f32 v22, v22, v23
    v_cvt_pk_bf16_f32 v24, v24, v25
    v_cvt_pk_bf16_f32 v26, v26, v27
    v_cvt_pk_bf16_f32 v28, v28, v29
    v_cvt_pk_bf16_f32 v30, v30, v31
    v_cvt_pk_bf16_f32 v32, v32, v33
    v_cvt_pk_bf16_f32 v34, v34, v35
    v_cvt_pk_bf16_f32 v36, v36, v37
    v_cvt_pk_bf16_f32 v38, v38, v39
    v_cvt_pk_bf16_f32 v40, v40, v41
    v_cvt_pk_bf16_f32 v42, v42, v43
    v_and_b32 v13, s32, v12
    v_lshlrev_b32 v12, 16, v12
    v_and_b32 v15, s32, v14
    v_lshlrev_b32 v14, 16, v14
    v_and_b32 v17, s32, v16
    v_lshlrev_b32 v16, 16, v16
    v_and_b32 v19, s32, v18
    v_lshlrev_b32 v18, 16, v18
    v_and_b32 v21, s32, v20
    v_lshlrev_b32 v20, 16, v20
    v_and_b32 v23, s32, v22
    v_lshlrev_b32 v22, 16, v22
    v_and_b32 v25, s32, v24
    v_lshlrev_b32 v24, 16, v24
    v_and_b32 v27, s32, v26
    v_lshlrev_b32 v26, 16, v26
    v_and_b32 v29, s32, v28
    v_lshlrev_b32 v28, 16, v28
    v_and_b32 v31, s32, v30
    v_lshlrev_b32 v30, 16, v30
    v_and_b32 v33, s32, v32
    v_lshlrev_b32 v32, 16, v32
    v_and_b32 v35, s32, v34
    v_lshlrev_b32 v34, 16, v34
    v_and_b32 v37, s32, v36
    v_lshlrev_b32 v36, 16, v36
    v_and_b32 v39, s32, v38
    v_lshlrev_b32 v38, 16, v38
    v_and_b32 v41, s32, v40
    v_lshlrev_b32 v40, 16, v40
    v_and_b32 v43, s32, v42
    v_lshlrev_b32 v42, 16, v42
    v_mul_f32 v12, v12, v12
    v_mul_f32 v13, v13, v13
    v_mul_f32 v14, v14, v14
    v_mul_f32 v15, v15, v15
    v_mul_f32 v16, v16, v16
    v_mul_f32 v17, v17, v17
    v_mul_f32 v18, v18, v18
    v_mul_f32 v19, v19, v19
    v_mul_f32 v20, v20, v20
    v_mul_f32 v21, v21, v21
    v_mul_f32 v22, v22, v22
    v_mul_f32 v23, v23, v23
    v_mul_f32 v24, v24, v24
    v_mul_f32 v25, v25, v25
    v_mul_f32 v26, v26, v26
    v_mul_f32 v27, v27, v27
    v_mul_f32 v28, v28, v28
    v_mul_f32 v29, v29, v29
    v_mul_f32 v30, v30, v30
    v_mul_f32 v31, v31, v31
    v_mul_f32 v32, v32, v32
    v_mul_f32 v33, v33, v33
    v_mul_f32 v34, v34, v34
    v_mul_f32 v35, v35, v35
    v_mul_f32 v36, v36, v36
    v_mul_f32 v37, v37, v37
    v_mul_f32 v38, v38, v38
    v_mul_f32 v39, v39, v39
    v_mul_f32 v40, v40, v40
    v_mul_f32 v41, v41, v41
    v_mul_f32 v42, v42, v42
    v_mul_f32 v43, v43, v43
    v_cvt_pk_bf16_f32 v12, v12, v13
    v_cvt_pk_bf16_f32 v14, v14, v15
    v_cvt_pk_bf16_f32 v16, v16, v17
    v_cvt_pk_bf16_f32 v18, v18, v19
    v_cvt_pk_bf16_f32 v20, v20, v21
    v_cvt_pk_bf16_f32 v22, v22, v23
    v_cvt_pk_bf16_f32 v24, v24, v25
    v_cvt_pk_bf16_f32 v26, v26, v27
    v_cvt_pk_bf16_f32 v28, v28, v29
    v_cvt_pk_bf16_f32 v30, v30, v31
    v_cvt_pk_bf16_f32 v32, v32, v33
    v_cvt_pk_bf16_f32 v34, v34, v35
    v_cvt_pk_bf16_f32 v36, v36, v37
    v_cvt_pk_bf16_f32 v38, v38, v39
    v_cvt_pk_bf16_f32 v40, v40, v41
    v_cvt_pk_bf16_f32 v42, v42, v43
    v_and_b32 v13, s32, v12
    v_lshlrev_b32 v12, 16, v12
    v_and_b32 v15, s32, v14
    v_lshlrev_b32 v14, 16, v14
    v_and_b32 v17, s32, v16
    v_lshlrev_b32 v16, 16, v16
    v_and_b32 v19, s32, v18
    v_lshlrev_b32 v18, 16, v18
    v_and_b32 v21, s32, v20
    v_lshlrev_b32 v20, 16, v20
    v_and_b32 v23, s32, v22
    v_lshlrev_b32 v22, 16, v22
    v_and_b32 v25, s32, v24
    v_lshlrev_b32 v24, 16, v24
    v_and_b32 v27, s32, v26
    v_lshlrev_b32 v26, 16, v26
    v_and_b32 v29, s32, v28
    v_lshlrev_b32 v28, 16, v28
    v_and_b32 v31, s32, v30
    v_lshlrev_b32 v30, 16, v30
    v_and_b32 v33, s32, v32
    v_lshlrev_b32 v32, 16, v32
    v_and_b32 v35, s32, v34
    v_lshlrev_b32 v34, 16, v34
    v_and_b32 v37, s32, v36
    v_lshlrev_b32 v36, 16, v36
    v_and_b32 v39, s32, v38
    v_lshlrev_b32 v38, 16, v38
    v_and_b32 v41, s32, v40
    v_lshlrev_b32 v40, 16, v40
    v_and_b32 v43, s32, v42
    v_lshlrev_b32 v42, 16, v42
    v_mul_f32 v12, 0xc1200000, v12
    v_mul_f32 v13, 0xc1200000, v13
    v_mul_f32 v14, 0xc1200000, v14
    v_mul_f32 v15, 0xc1200000, v15
    v_mul_f32 v16, 0xc1200000, v16
    v_mul_f32 v17, 0xc1200000, v17
    v_mul_f32 v18, 0xc1200000, v18
    v_mul_f32 v19, 0xc1200000, v19
    v_mul_f32 v20, 0xc1200000, v20
    v_mul_f32 v21, 0xc1200000, v21
    v_mul_f32 v22, 0xc1200000, v22
    v_mul_f32 v23, 0xc1200000, v23
    v_mul_f32 v24, 0xc1200000, v24
    v_mul_f32 v25, 0xc1200000, v25
    v_mul_f32 v26, 0xc1200000, v26
    v_mul_f32 v27, 0xc1200000, v27
    v_mul_f32 v28, 0xc1200000, v28
    v_mul_f32 v29, 0xc1200000, v29
    v_mul_f32 v30, 0xc1200000, v30
    v_mul_f32 v31, 0xc1200000, v31
    v_mul_f32 v32, 0xc1200000, v32
    v_mul_f32 v33, 0xc1200000, v33
    v_mul_f32 v34, 0xc1200000, v34
    v_mul_f32 v35, 0xc1200000, v35
    v_mul_f32 v36, 0xc1200000, v36
    v_mul_f32 v37, 0xc1200000, v37
    v_mul_f32 v38, 0xc1200000, v38
    v_mul_f32 v39, 0xc1200000, v39
    v_mul_f32 v40, 0xc1200000, v40
    v_mul_f32 v41, 0xc1200000, v41
    v_mul_f32 v42, 0xc1200000, v42
    v_mul_f32 v43, 0xc1200000, v43
    v_cvt_pk_bf16_f32 v12, v12, v13
    v_cvt_pk_bf16_f32 v14, v14, v15
    v_cvt_pk_bf16_f32 v16, v16, v17
    v_cvt_pk_bf16_f32 v18, v18, v19
    v_cvt_pk_bf16_f32 v20, v20, v21
    v_cvt_pk_bf16_f32 v22, v22, v23
    v_cvt_pk_bf16_f32 v24, v24, v25
    v_cvt_pk_bf16_f32 v26, v26, v27
    v_cvt_pk_bf16_f32 v28, v28, v29
    v_cvt_pk_bf16_f32 v30, v30, v31
    v_cvt_pk_bf16_f32 v32, v32, v33
    v_cvt_pk_bf16_f32 v34, v34, v35
    v_cvt_pk_bf16_f32 v36, v36, v37
    v_cvt_pk_bf16_f32 v38, v38, v39
    v_cvt_pk_bf16_f32 v40, v40, v41
    v_cvt_pk_bf16_f32 v42, v42, v43
    v_and_b32 v13, s32, v12
    v_lshlrev_b32 v12, 16, v12
    v_and_b32 v15, s32, v14
    v_lshlrev_b32 v14, 16, v14
    v_and_b32 v17, s32, v16
    v_lshlrev_b32 v16, 16, v16
    v_and_b32 v19, s32, v18
    v_lshlrev_b32 v18, 16, v18
    v_and_b32 v21, s32, v20
    v_lshlrev_b32 v20, 16, v20
    v_and_b32 v23, s32, v22
    v_lshlrev_b32 v22, 16, v22
    v_and_b32 v25, s32, v24
    v_lshlrev_b32 v24, 16, v24
    v_and_b32 v27, s32, v26
    v_lshlrev_b32 v26, 16, v26
    v_and_b32 v29, s32, v28
    v_lshlrev_b32 v28, 16, v28
    v_and_b32 v31, s32, v30
    v_lshlrev_b32 v30, 16, v30
    v_and_b32 v33, s32, v32
    v_lshlrev_b32 v32, 16, v32
    v_and_b32 v35, s32, v34
    v_lshlrev_b32 v34, 16, v34
    v_and_b32 v37, s32, v36
    v_lshlrev_b32 v36, 16, v36
    v_and_b32 v39, s32, v38
    v_lshlrev_b32 v38, 16, v38
    v_and_b32 v41, s32, v40
    v_lshlrev_b32 v40, 16, v40
    v_and_b32 v43, s32, v42
    v_lshlrev_b32 v42, 16, v42
    v_mul_f32 v12, 0x3fb8aa3b, v12
    v_mul_f32 v13, 0x3fb8aa3b, v13
    v_mul_f32 v14, 0x3fb8aa3b, v14
    v_mul_f32 v15, 0x3fb8aa3b, v15
    v_mul_f32 v16, 0x3fb8aa3b, v16
    v_mul_f32 v17, 0x3fb8aa3b, v17
    v_mul_f32 v18, 0x3fb8aa3b, v18
    v_mul_f32 v19, 0x3fb8aa3b, v19
    v_mul_f32 v20, 0x3fb8aa3b, v20
    v_mul_f32 v21, 0x3fb8aa3b, v21
    v_mul_f32 v22, 0x3fb8aa3b, v22
    v_mul_f32 v23, 0x3fb8aa3b, v23
    v_mul_f32 v24, 0x3fb8aa3b, v24
    v_mul_f32 v25, 0x3fb8aa3b, v25
    v_mul_f32 v26, 0x3fb8aa3b, v26
    v_mul_f32 v27, 0x3fb8aa3b, v27
    v_mul_f32 v28, 0x3fb8aa3b, v28
    v_mul_f32 v29, 0x3fb8aa3b, v29
    v_mul_f32 v30, 0x3fb8aa3b, v30
    v_mul_f32 v31, 0x3fb8aa3b, v31
    v_mul_f32 v32, 0x3fb8aa3b, v32
    v_mul_f32 v33, 0x3fb8aa3b, v33
    v_mul_f32 v34, 0x3fb8aa3b, v34
    v_mul_f32 v35, 0x3fb8aa3b, v35
    v_mul_f32 v36, 0x3fb8aa3b, v36
    v_mul_f32 v37, 0x3fb8aa3b, v37
    v_mul_f32 v38, 0x3fb8aa3b, v38
    v_mul_f32 v39, 0x3fb8aa3b, v39
    v_mul_f32 v40, 0x3fb8aa3b, v40
    v_mul_f32 v41, 0x3fb8aa3b, v41
    v_mul_f32 v42, 0x3fb8aa3b, v42
    v_mul_f32 v43, 0x3fb8aa3b, v43
    v_exp_f32 v12, v12
    v_exp_f32 v13, v13
    v_exp_f32 v14, v14
    v_exp_f32 v15, v15
    v_exp_f32 v16, v16
    v_exp_f32 v17, v17
    v_exp_f32 v18, v18
    v_exp_f32 v19, v19
    v_exp_f32 v20, v20
    v_exp_f32 v21, v21
    v_exp_f32 v22, v22
    v_exp_f32 v23, v23
    v_exp_f32 v24, v24
    v_exp_f32 v25, v25
    v_exp_f32 v26, v26
    v_exp_f32 v27, v27
    v_exp_f32 v28, v28
    v_exp_f32 v29, v29
    v_exp_f32 v30, v30
    v_exp_f32 v31, v31
    v_exp_f32 v32, v32
    v_exp_f32 v33, v33
    v_exp_f32 v34, v34
    v_exp_f32 v35, v35
    v_exp_f32 v36, v36
    v_exp_f32 v37, v37
    v_exp_f32 v38, v38
    v_exp_f32 v39, v39
    v_exp_f32 v40, v40
    v_exp_f32 v41, v41
    v_exp_f32 v42, v42
    v_exp_f32 v43, v43
    s_nop 0
    v_cvt_pk_bf16_f32 v12, v12, v13
    v_cvt_pk_bf16_f32 v14, v14, v15
    v_cvt_pk_bf16_f32 v16, v16, v17
    v_cvt_pk_bf16_f32 v18, v18, v19
    v_cvt_pk_bf16_f32 v20, v20, v21
    v_cvt_pk_bf16_f32 v22, v22, v23
    v_cvt_pk_bf16_f32 v24, v24, v25
    v_cvt_pk_bf16_f32 v26, v26, v27
    v_cvt_pk_bf16_f32 v28, v28, v29
    v_cvt_pk_bf16_f32 v30, v30, v31
    v_cvt_pk_bf16_f32 v32, v32, v33
    v_cvt_pk_bf16_f32 v34, v34, v35
    v_cvt_pk_bf16_f32 v36, v36, v37
    v_cvt_pk_bf16_f32 v38, v38, v39
    v_cvt_pk_bf16_f32 v40, v40, v41
    v_cvt_pk_bf16_f32 v42, v42, v43
L_p1end_86:
    s_mov_b64 exec, -1
    s_cmp_eq_u32 s42, 2
    s_cbranch_scc1 L_part2_87
    s_waitcnt vmcnt(0) lgkmcnt(0)
    s_barrier
    s_cmp_lg_u32 s42, 0
    s_cbranch_scc1 L_nochk_93
    v_mov_b32 v116, 150024
    ds_read_b32 v117, v116
    s_waitcnt lgkmcnt(0)
    v_readfirstlane_b32 s3, v117
    s_nop 1
    s_cmp_lg_u32 s3, 0
    s_cbranch_scc1 L_p2slow_47
L_nochk_93:

    s_load_dwordx2 s[24:25], s[0:1], 88
    s_load_dwordx2 s[44:45], s[0:1], 96
    s_mov_b32 s26, 6400000
    s_mov_b32 s27, 0x20000
    s_movk_i32 s46, 256
    s_mov_b32 s47, 0x20000
    s_lshl_b32 s50, s36, 2
    v_and_b32 v116, 63, v0
    v_lshlrev_b32 v116, 20, v116

    s_add_u32 s20, s6, 6799360
    s_addc_u32 s21, s7, 0
    s_mov_b32 s22, 76800000
    s_mov_b32 s23, 0x20000
    v_readfirstlane_b32 s3, v0
    s_waitcnt lgkmcnt(0)
    s_cmp_eq_u32 s3, 960
    s_cbranch_scc1 L_sync_94
L_part2_87:
    v_cmp_gt_u32 vcc, 782, v0
    s_mov_b64 exec, vcc
    s_cbranch_execz L_p2end_88

    s_pack_ll_b32_b16 s52, s68, s70
    v_dot2_f32_bf16 v60, v12, s52, 0
    v_dot2_f32_bf16 v64, v20, s52, 0
    v_dot2_f32_bf16 v68, v28, s52, 0
    v_dot2_f32_bf16 v72, v36, s52, 0
    s_pack_hh_b32_b16 s53, s68, s70
    v_dot2_f32_bf16 v61, v12, s53, 0
    v_dot2_f32_bf16 v65, v20, s53, 0
    v_dot2_f32_bf16 v69, v28, s53, 0
    v_dot2_f32_bf16 v73, v36, s53, 0
    s_pack_ll_b32_b16 s52, s69, s71
    v_dot2_f32_bf16 v62, v12, s52, 0
    v_dot2_f32_bf16 v66, v20, s52, 0
    v_dot2_f32_bf16 v70, v28, s52, 0
    v_dot2_f32_bf16 v74, v36, s52, 0
    s_pack_hh_b32_b16 s53, s69, s71
    v_dot2_f32_bf16 v63, v12, s53, 0
    v_dot2_f32_bf16 v67, v20, s53, 0
    v_dot2_f32_bf16 v71, v28, s53, 0
    v_dot2_f32_bf16 v75, v36, s53, 0
    s_pack_ll_b32_b16 s52, s72, s74
    v_dot2_f32_bf16 v60, v14, s52, v60
    v_dot2_f32_bf16 v64, v22, s52, v64
    v_dot2_f32_bf16 v68, v30, s52, v68
    v_dot2_f32_bf16 v72, v38, s52, v72
    s_pack_hh_b32_b16 s53, s72, s74
    v_dot2_f32_bf16 v61, v14, s53, v61
    v_dot2_f32_bf16 v65, v22, s53, v65
    v_dot2_f32_bf16 v69, v30, s53, v69
    v_dot2_f32_bf16 v73, v38, s53, v73
    s_pack_ll_b32_b16 s52, s73, s75
    v_dot2_f32_bf16 v62, v14, s52, v62
    v_dot2_f32_bf16 v66, v22, s52, v66
    v_dot2_f32_bf16 v70, v30, s52, v70
    v_dot2_f32_bf16 v74, v38, s52, v74
    s_pack_hh_b32_b16 s53, s73, s75
    v_dot2_f32_bf16 v63, v14, s53, v63
    v_dot2_f32_bf16 v67, v22, s53, v67
    v_dot2_f32_bf16 v71, v30, s53, v71
    v_dot2_f32_bf16 v75, v38, s53, v75
    s_pack_ll_b32_b16 s52, s76, s78
    v_dot2_f32_bf16 v60, v16, s52, v60
    v_dot2_f32_bf16 v64, v24, s52, v64
    v_dot2_f32_bf16 v68, v32, s52, v68
    v_dot2_f32_bf16 v72, v40, s52, v72
    s_pack_hh_b32_b16 s53, s76, s78
    v_dot2_f32_bf16 v61, v16, s53, v61
    v_dot2_f32_bf16 v65, v24, s53, v65
    v_dot2_f32_bf16 v69, v32, s53, v69
    v_dot2_f32_bf16 v73, v40, s53, v73
    s_pack_ll_b32_b16 s52, s77, s79
    v_dot2_f32_bf16 v62, v16, s52, v62
    v_dot2_f32_bf16 v66, v24, s52, v66
    v_dot2_f32_bf16 v70, v32, s52, v70
    v_dot2_f32_bf16 v74, v40, s52, v74
    s_pack_hh_b32_b16 s53, s77, s79
    v_dot2_f32_bf16 v63, v16, s53, v63
    v_dot2_f32_bf16 v67, v24, s53, v67
    v_dot2_f32_bf16 v71, v32, s53, v71
    v_dot2_f32_bf16 v75, v40, s53, v75
    s_pack_ll_b32_b16 s52, s80, s82
    v_dot2_f32_bf16 v60, v18, s52, v60
    v_dot2_f32_bf16 v64, v26, s52, v64
    v_dot2_f32_bf16 v68, v34, s52, v68
    v_dot2_f32_bf16 v72, v42, s52, v72
    s_pack_hh_b32_b16 s53, s80, s82
    v_dot2_f32_bf16 v61, v18, s53, v61
    v_dot2_f32_bf16 v65, v26, s53, v65
    v_dot2_f32_bf16 v69, v34, s53, v69
    v_dot2_f32_bf16 v73, v42, s53, v73
    s_pack_ll_b32_b16 s52, s81, s83
    v_dot2_f32_bf16 v62, v18, s52, v62
    v_dot2_f32_bf16 v66, v26, s52, v66
    v_dot2_f32_bf16 v70, v34, s52, v70
    v_dot2_f32_bf16 v74, v42, s52, v74
    s_pack_hh_b32_b16 s53, s81, s83
    v_dot2_f32_bf16 v63, v18, s53, v63
    v_dot2_f32_bf16 v67, v26, s53, v67
    v_dot2_f32_bf16 v71, v34, s53, v71
    v_dot2_f32_bf16 v75, v42, s53, v75
    s_pack_ll_b32_b16 s52, s84, s86
    v_dot2_f32_bf16 v44, v12, s52, 0
    v_dot2_f32_bf16 v48, v20, s52, 0
    v_dot2_f32_bf16 v52, v28, s52, 0
    v_dot2_f32_bf16 v56, v36, s52, 0
    s_pack_hh_b32_b16 s53, s84, s86
    v_dot2_f32_bf16 v45, v12, s53, 0
    v_dot2_f32_bf16 v49, v20, s53, 0
    v_dot2_f32_bf16 v53, v28, s53, 0
    v_dot2_f32_bf16 v57, v36, s53, 0
    s_pack_ll_b32_b16 s52, s85, s87
    v_dot2_f32_bf16 v46, v12, s52, 0
    v_dot2_f32_bf16 v50, v20, s52, 0
    v_dot2_f32_bf16 v54, v28, s52, 0
    v_dot2_f32_bf16 v58, v36, s52, 0
    s_pack_hh_b32_b16 s53, s85, s87
    v_dot2_f32_bf16 v47, v12, s53, 0
    v_dot2_f32_bf16 v51, v20, s53, 0
    v_dot2_f32_bf16 v55, v28, s53, 0
    v_dot2_f32_bf16 v59, v36, s53, 0
    s_pack_ll_b32_b16 s52, s88, s90
    v_dot2_f32_bf16 v44, v14, s52, v44
    v_dot2_f32_bf16 v48, v22, s52, v48
    v_dot2_f32_bf16 v52, v30, s52, v52
    v_dot2_f32_bf16 v56, v38, s52, v56
    s_pack_hh_b32_b16 s53, s88, s90
    v_dot2_f32_bf16 v45, v14, s53, v45
    v_dot2_f32_bf16 v49, v22, s53, v49
    v_dot2_f32_bf16 v53, v30, s53, v53
    v_dot2_f32_bf16 v57, v38, s53, v57
    s_pack_ll_b32_b16 s52, s89, s91
    v_dot2_f32_bf16 v46, v14, s52, v46
    v_dot2_f32_bf16 v50, v22, s52, v50
    v_dot2_f32_bf16 v54, v30, s52, v54
    v_dot2_f32_bf16 v58, v38, s52, v58
    s_pack_hh_b32_b16 s53, s89, s91
    v_dot2_f32_bf16 v47, v14, s53, v47
    v_dot2_f32_bf16 v51, v22, s53, v51
    v_dot2_f32_bf16 v55, v30, s53, v55
    v_dot2_f32_bf16 v59, v38, s53, v59
    s_pack_ll_b32_b16 s52, s92, s94
    v_dot2_f32_bf16 v44, v16, s52, v44
    v_dot2_f32_bf16 v48, v24, s52, v48
    v_dot2_f32_bf16 v52, v32, s52, v52
    v_dot2_f32_bf16 v56, v40, s52, v56
    s_pack_hh_b32_b16 s53, s92, s94
    v_dot2_f32_bf16 v45, v16, s53, v45
    v_dot2_f32_bf16 v49, v24, s53, v49
    v_dot2_f32_bf16 v53, v32, s53, v53
    v_dot2_f32_bf16 v57, v40, s53, v57
    s_pack_ll_b32_b16 s52, s93, s95
    v_dot2_f32_bf16 v46, v16, s52, v46
    v_dot2_f32_bf16 v50, v24, s52, v50
    v_dot2_f32_bf16 v54, v32, s52, v54
    v_dot2_f32_bf16 v58, v40, s52, v58
    s_pack_hh_b32_b16 s53, s93, s95
    v_dot2_f32_bf16 v47, v16, s53, v47
    v_dot2_f32_bf16 v51, v24, s53, v51
    v_dot2_f32_bf16 v55, v32, s53, v55
    v_dot2_f32_bf16 v59, v40, s53, v59
    s_pack_ll_b32_b16 s52, s96, s98
    v_dot2_f32_bf16 v44, v18, s52, v44
    v_dot2_f32_bf16 v48, v26, s52, v48
    v_dot2_f32_bf16 v52, v34, s52, v52
    v_dot2_f32_bf16 v56, v42, s52, v56
    s_pack_hh_b32_b16 s53, s96, s98
    v_dot2_f32_bf16 v45, v18, s53, v45
    v_dot2_f32_bf16 v49, v26, s53, v49
    v_dot2_f32_bf16 v53, v34, s53, v53
    v_dot2_f32_bf16 v57, v42, s53, v57
    s_pack_ll_b32_b16 s52, s97, s99
    v_dot2_f32_bf16 v46, v18, s52, v46
    v_dot2_f32_bf16 v50, v26, s52, v50
    v_dot2_f32_bf16 v54, v34, s52, v54
    v_dot2_f32_bf16 v58, v42, s52, v58
    s_pack_hh_b32_b16 s53, s97, s99
    v_dot2_f32_bf16 v47, v18, s53, v47
    v_dot2_f32_bf16 v51, v26, s53, v51
    v_dot2_f32_bf16 v55, v34, s53, v55
    v_dot2_f32_bf16 v59, v42, s53, v59
    v_cvt_pk_bf16_f32 v60, v60, v61
    v_cvt_pk_bf16_f32 v62, v62, v63
    v_cvt_pk_bf16_f32 v64, v64, v65
    v_cvt_pk_bf16_f32 v66, v66, v67
    v_cvt_pk_bf16_f32 v68, v68, v69
    v_cvt_pk_bf16_f32 v70, v70, v71
    v_cvt_pk_bf16_f32 v72, v72, v73
    v_cvt_pk_bf16_f32 v74, v74, v75
    v_and_b32 v61, s32, v60
    v_lshlrev_b32 v60, 16, v60
    v_and_b32 v63, s32, v62
    v_lshlrev_b32 v62, 16, v62
    v_and_b32 v65, s32, v64
    v_lshlrev_b32 v64, 16, v64
    v_and_b32 v67, s32, v66
    v_lshlrev_b32 v66, 16, v66
    v_and_b32 v69, s32, v68
    v_lshlrev_b32 v68, 16, v68
    v_and_b32 v71, s32, v70
    v_lshlrev_b32 v70, 16, v70
    v_and_b32 v73, s32, v72
    v_lshlrev_b32 v72, 16, v72
    v_and_b32 v75, s32, v74
    v_lshlrev_b32 v74, 16, v74
L_p2end_88:
    s_mov_b64 exec, -1
    s_cmp_eq_u32 s42, 2
    s_cbranch_scc1 L_post_91
L_bcast_89:
    v_mov_b32 v118, 150016
    s_mov_b32 s42, 2
    s_waitcnt lgkmcnt(0)
    s_barrier
    ds_read_b32 v117, v118
    s_waitcnt lgkmcnt(0)
    v_readfirstlane_b32 s35, v117
    s_nop 1
    s_bitcmp1_b32 s35, 16
    s_cbranch_scc1 L_nextq_90
L_post_91:
    v_cmp_gt_u32 vcc, 782, v0
    s_mov_b64 exec, vcc
    s_cbranch_execz L_postend_92

    s_mov_b32 s3, 0
    buffer_load_dwordx4 v[76:79], v4, s[20:23], s3 offen sc1
    buffer_load_dwordx4 v[92:95], v5, s[20:23], s3 offen sc1
    s_mov_b32 s3, 6400000
    buffer_load_dwordx4 v[80:83], v4, s[20:23], s3 offen sc1
    buffer_load_dwordx4 v[96:99], v5, s[20:23], s3 offen sc1
    s_mov_b32 s3, 12800000
    buffer_load_dwordx4 v[84:87], v4, s[20:23], s3 offen sc1
    buffer_load_dwordx4 v[100:103], v5, s[20:23], s3 offen sc1
    s_mov_b32 s3, 19200000
    buffer_load_dwordx4 v[88:91], v4, s[20:23], s3 offen sc1
    buffer_load_dwordx4 v[104:107], v5, s[20:23], s3 offen sc1
    s_and_b32 s3, s35, 0xf0
    s_cbranch_scc1 L_fgen_98
    s_waitcnt vmcnt(0)

    v_add_u32 v76, v76, v80
    v_add_u32 v84, v84, v88
    v_add_u32 v77, v77, v81
    v_add_u32 v85, v85, v89
    v_add_u32 v78, v78, v82
    v_add_u32 v86, v86, v90
    v_add_u32 v79, v79, v83
    v_add_u32 v87, v87, v91
    v_add_u32_sdwa v12, v76, v84 dst_sel:DWORD dst_unused:UNUSED_PAD src0_sel:WORD_0 src1_sel:WORD_0
    v_add_u32_sdwa v13, v76, v84 dst_sel:DWORD dst_unused:UNUSED_PAD src0_sel:WORD_1 src1_sel:WORD_1
    v_add_u32_sdwa v14, v77, v85 dst_sel:DWORD dst_unused:UNUSED_PAD src0_sel:WORD_0 src1_sel:WORD_0
    v_add_u32_sdwa v15, v77, v85 dst_sel:DWORD dst_unused:UNUSED_PAD src0_sel:WORD_1 src1_sel:WORD_1
    v_add_u32_sdwa v16, v78, v86 dst_sel:DWORD dst_unused:UNUSED_PAD src0_sel:WORD_0 src1_sel:WORD_0
    v_add_u32_sdwa v17, v78, v86 dst_sel:DWORD dst_unused:UNUSED_PAD src0_sel:WORD_1 src1_sel:WORD_1
    v_add_u32_sdwa v18, v79, v87 dst_sel:DWORD dst_unused:UNUSED_PAD src0_sel:WORD_0 src1_sel:WORD_0
    v_add_u32_sdwa v19, v79, v87 dst_sel:DWORD dst_unused:UNUSED_PAD src0_sel:WORD_1 src1_sel:WORD_1
    v_add_u32 v92, v92, v96
    v_add_u32 v100, v100, v104
    v_add_u32 v93, v93, v97
    v_add_u32 v101, v101, v105
    v_add_u32 v94, v94, v98
    v_add_u32 v102, v102, v106
    v_add_u32 v95, v95, v99
    v_add_u32 v103, v103, v107
    v_add_u32_sdwa v20, v92, v100 dst_sel:DWORD dst_unused:UNUSED_PAD src0_sel:WORD_0 src1_sel:WORD_0
    v_add_u32_sdwa v21, v92, v100 dst_sel:DWORD dst_unused:UNUSED_PAD src0_sel:WORD_1 src1_sel:WORD_1
    v_add_u32_sdwa v22, v93, v101 dst_sel:DWORD dst_unused:UNUSED_PAD src0_sel:WORD_0 src1_sel:WORD_0
    v_add_u32_sdwa v23, v93, v101 dst_sel:DWORD dst_unused:UNUSED_PAD src0_sel:WORD_1 src1_sel:WORD_1
    v_add_u32_sdwa v24, v94, v102 dst_sel:DWORD dst_unused:UNUSED_PAD src0_sel:WORD_0 src1_sel:WORD_0
    v_add_u32_sdwa v25, v94, v102 dst_sel:DWORD dst_unused:UNUSED_PAD src0_sel:WORD_1 src1_sel:WORD_1
    v_add_u32_sdwa v26, v95, v103 dst_sel:DWORD dst_unused:UNUSED_PAD src0_sel:WORD_0 src1_sel:WORD_0
    v_add_u32_sdwa v27, v95, v103 dst_sel:DWORD dst_unused:UNUSED_PAD src0_sel:WORD_1 src1_sel:WORD_1
    v_add_u32 v12, 0xffff0000, v12
    v_add_u32 v13, 0xffff0000, v13
    v_add_u32 v14, 0xffff0000, v14
    v_add_u32 v15, 0xffff0000, v15
    v_add_u32 v16, 0xffff0000, v16
    v_add_u32 v17, 0xffff0000, v17
    v_add_u32 v18, 0xffff0000, v18
    v_add_u32 v19, 0xffff0000, v19
    v_add_u32 v20, 0xffff0000, v20
    v_add_u32 v21, 0xffff0000, v21
    v_add_u32 v22, 0xffff0000, v22
    v_add_u32 v23, 0xffff0000, v23
    v_add_u32 v24, 0xffff0000, v24
    v_add_u32 v25, 0xffff0000, v25
    v_add_u32 v26, 0xffff0000, v26
    v_add_u32 v27, 0xffff0000, v27
    v_cvt_f32_i32 v12, v12
    v_cvt_f32_i32 v13, v13
    v_cvt_f32_i32 v14, v14
    v_cvt_f32_i32 v15, v15
    v_cvt_f32_i32 v16, v16
    v_cvt_f32_i32 v17, v17
    v_cvt_f32_i32 v18, v18
    v_cvt_f32_i32 v19, v19
    v_cvt_f32_i32 v20, v20
    v_cvt_f32_i32 v21, v21
    v_cvt_f32_i32 v22, v22
    v_cvt_f32_i32 v23, v23
    v_cvt_f32_i32 v24, v24
    v_cvt_f32_i32 v25, v25
    v_cvt_f32_i32 v26, v26
    v_cvt_f32_i32 v27, v27
    v_mul_f32 v12, s34, v12
    v_mul_f32 v13, s34, v13
    v_mul_f32 v14, s34, v14
    v_mul_f32 v15, s34, v15
    v_mul_f32 v16, s34, v16
    v_mul_f32 v17, s34, v17
    v_mul_f32 v18, s34, v18
    v_mul_f32 v19, s34, v19
    v_mul_f32 v20, s34, v20
    v_mul_f32 v21, s34, v21
    v_mul_f32 v22, s34, v22
    v_mul_f32 v23, s34, v23
    v_mul_f32 v24, s34, v24
    v_mul_f32 v25, s34, v25
    v_mul_f32 v26, s34, v26
    v_mul_f32 v27, s34, v27
L_fbk_99:
    s_lshl_b32 s52, s12, 16
    v_mul_f32 v28, s52, v12
    v_mul_f32 v32, s52, v16
    v_mul_f32 v36, s52, v20
    v_mul_f32 v40, s52, v24
    s_and_b32 s53, s12, s32
    v_mul_f32 v29, s53, v12
    v_mul_f32 v33, s53, v16
    v_mul_f32 v37, s53, v20
    v_mul_f32 v41, s53, v24
    s_lshl_b32 s52, s13, 16
    v_mul_f32 v30, s52, v12
    v_mul_f32 v34, s52, v16
    v_mul_f32 v38, s52, v20
    v_mul_f32 v42, s52, v24
    s_and_b32 s53, s13, s32
    v_mul_f32 v31, s53, v12
    v_mul_f32 v35, s53, v16
    v_mul_f32 v39, s53, v20
    v_mul_f32 v43, s53, v24
    s_lshl_b32 s52, s14, 16
    v_fmac_f32 v28, s52, v13
    v_fmac_f32 v32, s52, v17
    v_fmac_f32 v36, s52, v21
    v_fmac_f32 v40, s52, v25
    s_and_b32 s53, s14, s32
    v_fmac_f32 v29, s53, v13
    v_fmac_f32 v33, s53, v17
    v_fmac_f32 v37, s53, v21
    v_fmac_f32 v41, s53, v25
    s_lshl_b32 s52, s15, 16
    v_fmac_f32 v30, s52, v13
    v_fmac_f32 v34, s52, v17
    v_fmac_f32 v38, s52, v21
    v_fmac_f32 v42, s52, v25
    s_and_b32 s53, s15, s32
    v_fmac_f32 v31, s53, v13
    v_fmac_f32 v35, s53, v17
    v_fmac_f32 v39, s53, v21
    v_fmac_f32 v43, s53, v25
    s_lshl_b32 s52, s16, 16
    v_fmac_f32 v28, s52, v14
    v_fmac_f32 v32, s52, v18
    v_fmac_f32 v36, s52, v22
    v_fmac_f32 v40, s52, v26
    s_and_b32 s53, s16, s32
    v_fmac_f32 v29, s53, v14
    v_fmac_f32 v33, s53, v18
    v_fmac_f32 v37, s53, v22
    v_fmac_f32 v41, s53, v26
    s_lshl_b32 s52, s17, 16
    v_fmac_f32 v30, s52, v14
    v_fmac_f32 v34, s52, v18
    v_fmac_f32 v38, s52, v22
    v_fmac_f32 v42, s52, v26
    s_and_b32 s53, s17, s32
    v_fmac_f32 v31, s53, v14
    v_fmac_f32 v35, s53, v18
    v_fmac_f32 v39, s53, v22
    v_fmac_f32 v43, s53, v26
    s_lshl_b32 s52, s18, 16
    v_fmac_f32 v28, s52, v15
    v_fmac_f32 v32, s52, v19
    v_fmac_f32 v36, s52, v23
    v_fmac_f32 v40, s52, v27
    s_and_b32 s53, s18, s32
    v_fmac_f32 v29, s53, v15
    v_fmac_f32 v33, s53, v19
    v_fmac_f32 v37, s53, v23
    v_fmac_f32 v41, s53, v27
    s_lshl_b32 s52, s19, 16
    v_fmac_f32 v30, s52, v15
    v_fmac_f32 v34, s52, v19
    v_fmac_f32 v38, s52, v23
    v_fmac_f32 v42, s52, v27
    s_and_b32 s53, s19, s32
    v_fmac_f32 v31, s53, v15
    v_fmac_f32 v35, s53, v19
    v_fmac_f32 v39, s53, v23
    v_fmac_f32 v43, s53, v27
    v_mul_f32 v28, v28, v44
    v_mul_f32 v29, v29, v45
    v_mul_f32 v30, v30, v46
    v_mul_f32 v31, v31, v47
    v_mul_f32 v32, v32, v48
    v_mul_f32 v33, v33, v49
    v_mul_f32 v34, v34, v50
    v_mul_f32 v35, v35, v51
    v_mul_f32 v36, v36, v52
    v_mul_f32 v37, v37, v53
    v_mul_f32 v38, v38, v54
    v_mul_f32 v39, v39, v55
    v_mul_f32 v40, v40, v56
    v_mul_f32 v41, v41, v57
    v_mul_f32 v42, v42, v58
    v_mul_f32 v43, v43, v59
    v_cvt_pk_bf16_f32 v28, v28, v29
    v_cvt_pk_bf16_f32 v30, v30, v31
    v_cvt_pk_bf16_f32 v32, v32, v33
    v_cvt_pk_bf16_f32 v34, v34, v35
    v_cvt_pk_bf16_f32 v36, v36, v37
    v_cvt_pk_bf16_f32 v38, v38, v39
    v_cvt_pk_bf16_f32 v40, v40, v41
    v_cvt_pk_bf16_f32 v42, v42, v43
    s_pack_ll_b32_b16 s52, s56, s58
    v_dot2_f32_bf16 v12, v28, s52, 0
    v_dot2_f32_bf16 v16, v32, s52, 0
    v_dot2_f32_bf16 v20, v36, s52, 0
    v_dot2_f32_bf16 v24, v40, s52, 0
    s_pack_hh_b32_b16 s53, s56, s58
    v_dot2_f32_bf16 v13, v28, s53, 0
    v_dot2_f32_bf16 v17, v32, s53, 0
    v_dot2_f32_bf16 v21, v36, s53, 0
    v_dot2_f32_bf16 v25, v40, s53, 0
    s_pack_ll_b32_b16 s52, s57, s59
    v_dot2_f32_bf16 v14, v28, s52, 0
    v_dot2_f32_bf16 v18, v32, s52, 0
    v_dot2_f32_bf16 v22, v36, s52, 0
    v_dot2_f32_bf16 v26, v40, s52, 0
    s_pack_hh_b32_b16 s53, s57, s59
    v_dot2_f32_bf16 v15, v28, s53, 0
    v_dot2_f32_bf16 v19, v32, s53, 0
    v_dot2_f32_bf16 v23, v36, s53, 0
    v_dot2_f32_bf16 v27, v40, s53, 0
    s_pack_ll_b32_b16 s52, s60, s62
    v_dot2_f32_bf16 v12, v30, s52, v12
    v_dot2_f32_bf16 v16, v34, s52, v16
    v_dot2_f32_bf16 v20, v38, s52, v20
    v_dot2_f32_bf16 v24, v42, s52, v24
    s_pack_hh_b32_b16 s53, s60, s62
    v_dot2_f32_bf16 v13, v30, s53, v13
    v_dot2_f32_bf16 v17, v34, s53, v17
    v_dot2_f32_bf16 v21, v38, s53, v21
    v_dot2_f32_bf16 v25, v42, s53, v25
    s_pack_ll_b32_b16 s52, s61, s63
    v_dot2_f32_bf16 v14, v30, s52, v14
    v_dot2_f32_bf16 v18, v34, s52, v18
    v_dot2_f32_bf16 v22, v38, s52, v22
    v_dot2_f32_bf16 v26, v42, s52, v26
    s_pack_hh_b32_b16 s53, s61, s63
    v_dot2_f32_bf16 v15, v30, s53, v15
    v_dot2_f32_bf16 v19, v34, s53, v19
    v_dot2_f32_bf16 v23, v38, s53, v23
    v_dot2_f32_bf16 v27, v42, s53, v27
    v_lshlrev_b32 v44, 16, v108
    v_and_b32 v45, s32, v108
    v_lshlrev_b32 v46, 16, v109
    v_and_b32 v47, s32, v109
    v_lshlrev_b32 v48, 16, v110
    v_and_b32 v49, s32, v110
    v_lshlrev_b32 v50, 16, v111
    v_and_b32 v51, s32, v111
    v_lshlrev_b32 v52, 16, v112
    v_and_b32 v53, s32, v112
    v_lshlrev_b32 v54, 16, v113
    v_and_b32 v55, s32, v113
    v_lshlrev_b32 v56, 16, v114
    v_and_b32 v57, s32, v114
    v_lshlrev_b32 v58, 16, v115
    v_and_b32 v59, s32, v115
    v_cvt_pk_bf16_f32 v12, v12, v13
    v_cvt_pk_bf16_f32 v14, v14, v15
    v_cvt_pk_bf16_f32 v16, v16, v17
    v_cvt_pk_bf16_f32 v18, v18, v19
    v_cvt_pk_bf16_f32 v20, v20, v21
    v_cvt_pk_bf16_f32 v22, v22, v23
    v_cvt_pk_bf16_f32 v24, v24, v25
    v_cvt_pk_bf16_f32 v26, v26, v27
    v_and_b32 v13, s32, v12
    v_lshlrev_b32 v12, 16, v12
    v_and_b32 v15, s32, v14
    v_lshlrev_b32 v14, 16, v14
    v_and_b32 v17, s32, v16
    v_lshlrev_b32 v16, 16, v16
    v_and_b32 v19, s32, v18
    v_lshlrev_b32 v18, 16, v18
    v_and_b32 v21, s32, v20
    v_lshlrev_b32 v20, 16, v20
    v_and_b32 v23, s32, v22
    v_lshlrev_b32 v22, 16, v22
    v_and_b32 v25, s32, v24
    v_lshlrev_b32 v24, 16, v24
    v_and_b32 v27, s32, v26
    v_lshlrev_b32 v26, 16, v26
    v_mul_f32 v12, v12, v60
    v_mul_f32 v13, v13, v61
    v_mul_f32 v14, v14, v62
    v_mul_f32 v15, v15, v63
    v_mul_f32 v16, v16, v64
    v_mul_f32 v17, v17, v65
    v_mul_f32 v18, v18, v66
    v_mul_f32 v19, v19, v67
    v_mul_f32 v20, v20, v68
    v_mul_f32 v21, v21, v69
    v_mul_f32 v22, v22, v70
    v_mul_f32 v23, v23, v71
    v_mul_f32 v24, v24, v72
    v_mul_f32 v25, v25, v73
    v_mul_f32 v26, v26, v74
    v_mul_f32 v27, v27, v75
    v_cvt_pk_bf16_f32 v12, v12, v13
    v_cvt_pk_bf16_f32 v14, v14, v15
    v_cvt_pk_bf16_f32 v16, v16, v17
    v_cvt_pk_bf16_f32 v18, v18, v19
    v_cvt_pk_bf16_f32 v20, v20, v21
    v_cvt_pk_bf16_f32 v22, v22, v23
    v_cvt_pk_bf16_f32 v24, v24, v25
    v_cvt_pk_bf16_f32 v26, v26, v27
    v_and_b32 v13, s32, v12
    v_lshlrev_b32 v12, 16, v12
    v_and_b32 v15, s32, v14
    v_lshlrev_b32 v14, 16, v14
    v_and_b32 v17, s32, v16
    v_lshlrev_b32 v16, 16, v16
    v_and_b32 v19, s32, v18
    v_lshlrev_b32 v18, 16, v18
    v_and_b32 v21, s32, v20
    v_lshlrev_b32 v20, 16, v20
    v_and_b32 v23, s32, v22
    v_lshlrev_b32 v22, 16, v22
    v_and_b32 v25, s32, v24
    v_lshlrev_b32 v24, 16, v24
    v_and_b32 v27, s32, v26
    v_lshlrev_b32 v26, 16, v26
    v_add_f32 v12, v12, v44
    v_add_f32 v13, v13, v45
    v_add_f32 v14, v14, v46
    v_add_f32 v15, v15, v47
    v_add_f32 v16, v16, v48
    v_add_f32 v17, v17, v49
    v_add_f32 v18, v18, v50
    v_add_f32 v19, v19, v51
    v_add_f32 v20, v20, v52
    v_add_f32 v21, v21, v53
    v_add_f32 v22, v22, v54
    v_add_f32 v23, v23, v55
    v_add_f32 v24, v24, v56
    v_add_f32 v25, v25, v57
    v_add_f32 v26, v26, v58
    v_add_f32 v27, v27, v59
    v_cvt_pk_bf16_f32 v28, v12, v13
    v_cvt_pk_bf16_f32 v29, v14, v15
    v_cvt_pk_bf16_f32 v30, v16, v17
    v_cvt_pk_bf16_f32 v31, v18, v19
    v_cvt_pk_bf16_f32 v32, v20, v21
    v_cvt_pk_bf16_f32 v33, v22, v23
    v_cvt_pk_bf16_f32 v34, v24, v25
    v_cvt_pk_bf16_f32 v35, v26, v27
    buffer_store_dwordx4 v[28:31], v4, s[24:27], 0 offen
    buffer_store_dwordx4 v[32:35], v5, s[24:27], 0 offen
L_postend_92:
    s_mov_b64 exec, -1
L_nextq_90:
    s_bfe_u32 s3, s35, 0x40008
    s_cbranch_scc0 L_fend_108
    s_ff1_i32_b32 s41, s3
    s_add_u32 s3, s41, 8
    s_bitset0_b32 s35, s3
    s_branch L_qloop_85
L_fend_108:

L_p2done_46:
    s_endpgm

L_ufix_48:
    v_and_b32 v117, 63, v0
    v_lshlrev_b32 v117, 2, v117
    s_sub_i32 s54, s42, 1024
    v_cmp_le_i32 vcc, s54, v117
    s_mov_b64 exec, vcc
    v_mov_b32 v12, 0
    v_mov_b32 v44, 0
    s_mov_b64 exec, -1
    s_sub_i32 s54, s42, 1025
    v_cmp_le_i32 vcc, s54, v117
    s_mov_b64 exec, vcc
    v_mov_b32 v13, 0
    v_mov_b32 v46, 0
    s_mov_b64 exec, -1
    s_sub_i32 s54, s42, 1026
    v_cmp_le_i32 vcc, s54, v117
    s_mov_b64 exec, vcc
    v_mov_b32 v14, 0
    v_mov_b32 v48, 0
    s_mov_b64 exec, -1
    s_sub_i32 s54, s42, 1027
    v_cmp_le_i32 vcc, s54, v117
    s_mov_b64 exec, vcc
    v_mov_b32 v15, 0
    v_mov_b32 v50, 0
    s_mov_b64 exec, -1
    s_branch L_uback_49
L_ufix_50:
    v_and_b32 v117, 63, v0
    v_lshlrev_b32 v117, 2, v117
    s_sub_i32 s54, s42, 1536
    v_cmp_le_i32 vcc, s54, v117
    s_mov_b64 exec, vcc
    v_mov_b32 v16, 0
    v_mov_b32 v52, 0
    s_mov_b64 exec, -1
    s_sub_i32 s54, s42, 1537
    v_cmp_le_i32 vcc, s54, v117
    s_mov_b64 exec, vcc
    v_mov_b32 v17, 0
    v_mov_b32 v54, 0
    s_mov_b64 exec, -1
    s_sub_i32 s54, s42, 1538
    v_cmp_le_i32 vcc, s54, v117
    s_mov_b64 exec, vcc
    v_mov_b32 v18, 0
    v_mov_b32 v56, 0
    s_mov_b64 exec, -1
    s_sub_i32 s54, s42, 1539
    v_cmp_le_i32 vcc, s54, v117
    s_mov_b64 exec, vcc
    v_mov_b32 v19, 0
    v_mov_b32 v58, 0
    s_mov_b64 exec, -1
    s_branch L_uback_51
L_ufix_52:
    v_and_b32 v117, 63, v0
    v_lshlrev_b32 v117, 2, v117
    s_sub_i32 s54, s42, 2048
    v_cmp_le_i32 vcc, s54, v117
    s_mov_b64 exec, vcc
    v_mov_b32 v20, 0
    v_mov_b32 v60, 0
    s_mov_b64 exec, -1
    s_sub_i32 s54, s42, 2049
    v_cmp_le_i32 vcc, s54, v117
    s_mov_b64 exec, vcc
    v_mov_b32 v21, 0
    v_mov_b32 v62, 0
    s_mov_b64 exec, -1
    s_sub_i32 s54, s42, 2050
    v_cmp_le_i32 vcc, s54, v117
    s_mov_b64 exec, vcc
    v_mov_b32 v22, 0
    v_mov_b32 v64, 0
    s_mov_b64 exec, -1
    s_sub_i32 s54, s42, 2051
    v_cmp_le_i32 vcc, s54, v117
    s_mov_b64 exec, vcc
    v_mov_b32 v23, 0
    v_mov_b32 v66, 0
    s_mov_b64 exec, -1
    s_branch L_uback_53
L_ufix_54:
    v_and_b32 v117, 63, v0
    v_lshlrev_b32 v117, 2, v117
    s_sub_i32 s54, s42, 2560
    v_cmp_le_i32 vcc, s54, v117
    s_mov_b64 exec, vcc
    v_mov_b32 v24, 0
    v_mov_b32 v68, 0
    s_mov_b64 exec, -1
    s_sub_i32 s54, s42, 2561
    v_cmp_le_i32 vcc, s54, v117
    s_mov_b64 exec, vcc
    v_mov_b32 v25, 0
    v_mov_b32 v70, 0
    s_mov_b64 exec, -1
    s_sub_i32 s54, s42, 2562
    v_cmp_le_i32 vcc, s54, v117
    s_mov_b64 exec, vcc
    v_mov_b32 v26, 0
    v_mov_b32 v72, 0
    s_mov_b64 exec, -1
    s_sub_i32 s54, s42, 2563
    v_cmp_le_i32 vcc, s54, v117
    s_mov_b64 exec, vcc
    v_mov_b32 v27, 0
    v_mov_b32 v74, 0
    s_mov_b64 exec, -1
    s_branch L_uback_55
L_ufix_56:
    v_and_b32 v117, 63, v0
    v_lshlrev_b32 v117, 2, v117
    s_sub_i32 s54, s42, 0
    v_cmp_le_i32 vcc, s54, v117
    s_mov_b64 exec, vcc
    v_mov_b32 v4, 0
    v_mov_b32 v28, 0
    s_mov_b64 exec, -1
    s_sub_i32 s54, s42, 1
    v_cmp_le_i32 vcc, s54, v117
    s_mov_b64 exec, vcc
    v_mov_b32 v5, 0
    v_mov_b32 v30, 0
    s_mov_b64 exec, -1
    s_sub_i32 s54, s42, 2
    v_cmp_le_i32 vcc, s54, v117
    s_mov_b64 exec, vcc
    v_mov_b32 v6, 0
    v_mov_b32 v32, 0
    s_mov_b64 exec, -1
    s_sub_i32 s54, s42, 3
    v_cmp_le_i32 vcc, s54, v117
    s_mov_b64 exec, vcc
    v_mov_b32 v7, 0
    v_mov_b32 v34, 0
    s_mov_b64 exec, -1
    s_branch L_uback_57
L_ufix_58:
    v_and_b32 v117, 63, v0
    v_lshlrev_b32 v117, 2, v117
    s_sub_i32 s54, s42, 512
    v_cmp_le_i32 vcc, s54, v117
    s_mov_b64 exec, vcc
    v_mov_b32 v8, 0
    v_mov_b32 v36, 0
    s_mov_b64 exec, -1
    s_sub_i32 s54, s42, 513
    v_cmp_le_i32 vcc, s54, v117
    s_mov_b64 exec, vcc
    v_mov_b32 v9, 0
    v_mov_b32 v38, 0
    s_mov_b64 exec, -1
    s_sub_i32 s54, s42, 514
    v_cmp_le_i32 vcc, s54, v117
    s_mov_b64 exec, vcc
    v_mov_b32 v10, 0
    v_mov_b32 v40, 0
    s_mov_b64 exec, -1
    s_sub_i32 s54, s42, 515
    v_cmp_le_i32 vcc, s54, v117
    s_mov_b64 exec, vcc
    v_mov_b32 v11, 0
    v_mov_b32 v42, 0
    s_mov_b64 exec, -1
    s_branch L_uback_59
L_ufix_65:
    v_and_b32 v117, 63, v0
    v_lshlrev_b32 v117, 2, v117
    s_sub_i32 s54, s42, 3072
    v_cmp_le_i32 vcc, s54, v117
    s_mov_b64 exec, vcc
    v_mov_b32 v106, 0
    v_mov_b32 v120, 0
    s_mov_b64 exec, -1
    s_sub_i32 s54, s42, 3073
    v_cmp_le_i32 vcc, s54, v117
    s_mov_b64 exec, vcc
    v_mov_b32 v107, 0
    v_mov_b32 v122, 0
    s_mov_b64 exec, -1
    s_sub_i32 s54, s42, 3074
    v_cmp_le_i32 vcc, s54, v117
    s_mov_b64 exec, vcc
    v_mov_b32 v108, 0
    v_mov_b32 v124, 0
    s_mov_b64 exec, -1
    s_sub_i32 s54, s42, 3075
    v_cmp_le_i32 vcc, s54, v117
    s_mov_b64 exec, vcc
    v_mov_b32 v109, 0
    v_mov_b32 v126, 0
    s_mov_b64 exec, -1
    s_branch L_uback_66
L_ufix_69:
    v_and_b32 v117, 63, v0
    v_lshlrev_b32 v117, 2, v117
    s_sub_i32 s54, s42, 1024
    v_cmp_le_i32 vcc, s54, v117
    s_mov_b64 exec, vcc
    v_mov_b32 v12, 0
    v_mov_b32 v44, 0
    s_mov_b64 exec, -1
    s_sub_i32 s54, s42, 1025
    v_cmp_le_i32 vcc, s54, v117
    s_mov_b64 exec, vcc
    v_mov_b32 v13, 0
    v_mov_b32 v46, 0
    s_mov_b64 exec, -1
    s_sub_i32 s54, s42, 1026
    v_cmp_le_i32 vcc, s54, v117
    s_mov_b64 exec, vcc
    v_mov_b32 v14, 0
    v_mov_b32 v48, 0
    s_mov_b64 exec, -1
    s_sub_i32 s54, s42, 1027
    v_cmp_le_i32 vcc, s54, v117
    s_mov_b64 exec, vcc
    v_mov_b32 v15, 0
    v_mov_b32 v50, 0
    s_mov_b64 exec, -1
    s_branch L_uback_70
L_ufix_71:
    v_and_b32 v117, 63, v0
    v_lshlrev_b32 v117, 2, v117
    s_sub_i32 s54, s42, 1536
    v_cmp_le_i32 vcc, s54, v117
    s_mov_b64 exec, vcc
    v_mov_b32 v16, 0
    v_mov_b32 v52, 0
    s_mov_b64 exec, -1
    s_sub_i32 s54, s42, 1537
    v_cmp_le_i32 vcc, s54, v117
    s_mov_b64 exec, vcc
    v_mov_b32 v17, 0
    v_mov_b32 v54, 0
    s_mov_b64 exec, -1
    s_sub_i32 s54, s42, 1538
    v_cmp_le_i32 vcc, s54, v117
    s_mov_b64 exec, vcc
    v_mov_b32 v18, 0
    v_mov_b32 v56, 0
    s_mov_b64 exec, -1
    s_sub_i32 s54, s42, 1539
    v_cmp_le_i32 vcc, s54, v117
    s_mov_b64 exec, vcc
    v_mov_b32 v19, 0
    v_mov_b32 v58, 0
    s_mov_b64 exec, -1
    s_branch L_uback_72
L_ufix_73:
    v_and_b32 v117, 63, v0
    v_lshlrev_b32 v117, 2, v117
    s_sub_i32 s54, s42, 2048
    v_cmp_le_i32 vcc, s54, v117
    s_mov_b64 exec, vcc
    v_mov_b32 v20, 0
    v_mov_b32 v60, 0
    s_mov_b64 exec, -1
    s_sub_i32 s54, s42, 2049
    v_cmp_le_i32 vcc, s54, v117
    s_mov_b64 exec, vcc
    v_mov_b32 v21, 0
    v_mov_b32 v62, 0
    s_mov_b64 exec, -1
    s_sub_i32 s54, s42, 2050
    v_cmp_le_i32 vcc, s54, v117
    s_mov_b64 exec, vcc
    v_mov_b32 v22, 0
    v_mov_b32 v64, 0
    s_mov_b64 exec, -1
    s_sub_i32 s54, s42, 2051
    v_cmp_le_i32 vcc, s54, v117
    s_mov_b64 exec, vcc
    v_mov_b32 v23, 0
    v_mov_b32 v66, 0
    s_mov_b64 exec, -1
    s_branch L_uback_74
L_ufix_75:
    v_and_b32 v117, 63, v0
    v_lshlrev_b32 v117, 2, v117
    s_sub_i32 s54, s42, 2560
    v_cmp_le_i32 vcc, s54, v117
    s_mov_b64 exec, vcc
    v_mov_b32 v24, 0
    v_mov_b32 v68, 0
    s_mov_b64 exec, -1
    s_sub_i32 s54, s42, 2561
    v_cmp_le_i32 vcc, s54, v117
    s_mov_b64 exec, vcc
    v_mov_b32 v25, 0
    v_mov_b32 v70, 0
    s_mov_b64 exec, -1
    s_sub_i32 s54, s42, 2562
    v_cmp_le_i32 vcc, s54, v117
    s_mov_b64 exec, vcc
    v_mov_b32 v26, 0
    v_mov_b32 v72, 0
    s_mov_b64 exec, -1
    s_sub_i32 s54, s42, 2563
    v_cmp_le_i32 vcc, s54, v117
    s_mov_b64 exec, vcc
    v_mov_b32 v27, 0
    v_mov_b32 v74, 0
    s_mov_b64 exec, -1
    s_branch L_uback_76
L_ufix_77:
    v_and_b32 v117, 63, v0
    v_lshlrev_b32 v117, 2, v117
    s_sub_i32 s54, s42, 0
    v_cmp_le_i32 vcc, s54, v117
    s_mov_b64 exec, vcc
    v_mov_b32 v4, 0
    v_mov_b32 v28, 0
    s_mov_b64 exec, -1
    s_sub_i32 s54, s42, 1
    v_cmp_le_i32 vcc, s54, v117
    s_mov_b64 exec, vcc
    v_mov_b32 v5, 0
    v_mov_b32 v30, 0
    s_mov_b64 exec, -1
    s_sub_i32 s54, s42, 2
    v_cmp_le_i32 vcc, s54, v117
    s_mov_b64 exec, vcc
    v_mov_b32 v6, 0
    v_mov_b32 v32, 0
    s_mov_b64 exec, -1
    s_sub_i32 s54, s42, 3
    v_cmp_le_i32 vcc, s54, v117
    s_mov_b64 exec, vcc
    v_mov_b32 v7, 0
    v_mov_b32 v34, 0
    s_mov_b64 exec, -1
    s_branch L_uback_78
L_ufix_79:
    v_and_b32 v117, 63, v0
    v_lshlrev_b32 v117, 2, v117
    s_sub_i32 s54, s42, 512
    v_cmp_le_i32 vcc, s54, v117
    s_mov_b64 exec, vcc
    v_mov_b32 v8, 0
    v_mov_b32 v36, 0
    s_mov_b64 exec, -1
    s_sub_i32 s54, s42, 513
    v_cmp_le_i32 vcc, s54, v117
    s_mov_b64 exec, vcc
    v_mov_b32 v9, 0
    v_mov_b32 v38, 0
    s_mov_b64 exec, -1
    s_sub_i32 s54, s42, 514
    v_cmp_le_i32 vcc, s54, v117
    s_mov_b64 exec, vcc
    v_mov_b32 v10, 0
    v_mov_b32 v40, 0
    s_mov_b64 exec, -1
    s_sub_i32 s54, s42, 515
    v_cmp_le_i32 vcc, s54, v117
    s_mov_b64 exec, vcc
    v_mov_b32 v11, 0
    v_mov_b32 v42, 0
    s_mov_b64 exec, -1
    s_branch L_uback_80
L_sync_94:
    v_mov_b32 v117, s33
    buffer_atomic_add v117, v116, s[44:47], s50 offen sc0
    s_waitcnt vmcnt(0)
    v_readfirstlane_b32 s4, v117
    s_movk_i32 s5, 400
    s_nop 0
    s_add_u32 s4, s4, s33
    s_bitcmp1_b32 s4, 2
    s_cbranch_scc1 L_tell_97
L_poll_95:
    s_sub_u32 s5, s5, 1
    s_cbranch_scc1 L_gave_96
    v_mov_b32 v117, 0
    buffer_atomic_add v117, v116, s[44:47], s50 offen sc0
    s_waitcnt vmcnt(0)
    v_readfirstlane_b32 s4, v117
    s_nop 1
    s_and_b32 s4, s4, 0xff
    s_bitcmp0_b32 s4, 2
    s_cbranch_scc1 L_poll_95
    s_branch L_tell_97
L_gave_96:
    s_lshl_b32 s4, 0x100, s37
    v_mov_b32 v117, s4
    buffer_atomic_or v117, v116, s[44:47], s50 offen sc0
    s_waitcnt vmcnt(0)
    v_readfirstlane_b32 s4, v117
    s_nop 1
    s_and_b32 s4, s4, 0xff
    s_bitcmp1_b32 s4, 2
    s_cselect_b32 s4, s4, 0x10000
L_tell_97:
    v_mov_b32 v117, s4
    v_mov_b32 v118, 150016
    ds_write_b32 v118, v117
    s_branch L_bcast_89

L_fgen_98:
    s_waitcnt vmcnt(0)
    v_lshlrev_b32 v6, 1, v4
    v_lshlrev_b32 v7, 1, v5
    v_mov_b32 v12, 0
    v_mov_b32 v13, 0
    v_mov_b32 v14, 0
    v_mov_b32 v15, 0
    v_mov_b32 v16, 0
    v_mov_b32 v17, 0
    v_mov_b32 v18, 0
    v_mov_b32 v19, 0
    v_mov_b32 v20, 0
    v_mov_b32 v21, 0
    v_mov_b32 v22, 0
    v_mov_b32 v23, 0
    v_mov_b32 v24, 0
    v_mov_b32 v25, 0
    v_mov_b32 v26, 0
    v_mov_b32 v27, 0
    s_bitcmp1_b32 s35, 4
    s_cbranch_scc1 L_ffl_100
    v_cvt_f32_u32_sdwa v28, v76 dst_sel:DWORD dst_unused:UNUSED_PAD src0_sel:WORD_0
    v_cvt_f32_u32_sdwa v29, v76 dst_sel:DWORD dst_unused:UNUSED_PAD src0_sel:WORD_1
    v_cvt_f32_u32_sdwa v30, v77 dst_sel:DWORD dst_unused:UNUSED_PAD src0_sel:WORD_0
    v_cvt_f32_u32_sdwa v31, v77 dst_sel:DWORD dst_unused:UNUSED_PAD src0_sel:WORD_1
    v_cvt_f32_u32_sdwa v32, v78 dst_sel:DWORD dst_unused:UNUSED_PAD src0_sel:WORD_0
    v_cvt_f32_u32_sdwa v33, v78 dst_sel:DWORD dst_unused:UNUSED_PAD src0_sel:WORD_1
    v_cvt_f32_u32_sdwa v34, v79 dst_sel:DWORD dst_unused:UNUSED_PAD src0_sel:WORD_0
    v_cvt_f32_u32_sdwa v35, v79 dst_sel:DWORD dst_unused:UNUSED_PAD src0_sel:WORD_1
    v_cvt_f32_u32_sdwa v36, v92 dst_sel:DWORD dst_unused:UNUSED_PAD src0_sel:WORD_0
    v_cvt_f32_u32_sdwa v37, v92 dst_sel:DWORD dst_unused:UNUSED_PAD src0_sel:WORD_1
    v_cvt_f32_u32_sdwa v38, v93 dst_sel:DWORD dst_unused:UNUSED_PAD src0_sel:WORD_0
    v_cvt_f32_u32_sdwa v39, v93 dst_sel:DWORD dst_unused:UNUSED_PAD src0_sel:WORD_1
    v_cvt_f32_u32_sdwa v40, v94 dst_sel:DWORD dst_unused:UNUSED_PAD src0_sel:WORD_0
    v_cvt_f32_u32_sdwa v41, v94 dst_sel:DWORD dst_unused:UNUSED_PAD src0_sel:WORD_1
    v_cvt_f32_u32_sdwa v42, v95 dst_sel:DWORD dst_unused:UNUSED_PAD src0_sel:WORD_0
    v_cvt_f32_u32_sdwa v43, v95 dst_sel:DWORD dst_unused:UNUSED_PAD src0_sel:WORD_1
    v_add_f32 v28, 0xc6800000, v28
    v_fmac_f32 v12, s34, v28
    v_add_f32 v29, 0xc6800000, v29
    v_fmac_f32 v13, s34, v29
    v_add_f32 v30, 0xc6800000, v30
    v_fmac_f32 v14, s34, v30
    v_add_f32 v31, 0xc6800000, v31
    v_fmac_f32 v15, s34, v31
    v_add_f32 v32, 0xc6800000, v32
    v_fmac_f32 v16, s34, v32
    v_add_f32 v33, 0xc6800000, v33
    v_fmac_f32 v17, s34, v33
    v_add_f32 v34, 0xc6800000, v34
    v_fmac_f32 v18, s34, v34
    v_add_f32 v35, 0xc6800000, v35
    v_fmac_f32 v19, s34, v35
    v_add_f32 v36, 0xc6800000, v36
    v_fmac_f32 v20, s34, v36
    v_add_f32 v37, 0xc6800000, v37
    v_fmac_f32 v21, s34, v37
    v_add_f32 v38, 0xc6800000, v38
    v_fmac_f32 v22, s34, v38
    v_add_f32 v39, 0xc6800000, v39
    v_fmac_f32 v23, s34, v39
    v_add_f32 v40, 0xc6800000, v40
    v_fmac_f32 v24, s34, v40
    v_add_f32 v41, 0xc6800000, v41
    v_fmac_f32 v25, s34, v41
    v_add_f32 v42, 0xc6800000, v42
    v_fmac_f32 v26, s34, v42
    v_add_f32 v43, 0xc6800000, v43
    v_fmac_f32 v27, s34, v43
    s_branch L_fnx_101
L_ffl_100:
    s_mov_b32 s3, 25600000
    buffer_load_dwordx4 v[28:31], v6, s[20:23], s3 offen offset:0 sc1
    buffer_load_dwordx4 v[32:35], v6, s[20:23], s3 offen offset:16 sc1
    buffer_load_dwordx4 v[36:39], v7, s[20:23], s3 offen offset:0 sc1
    buffer_load_dwordx4 v[40:43], v7, s[20:23], s3 offen offset:16 sc1
    s_waitcnt vmcnt(0)
    v_add_f32 v12, v12, v28
    v_add_f32 v13, v13, v29
    v_add_f32 v14, v14, v30
    v_add_f32 v15, v15, v31
    v_add_f32 v16, v16, v32
    v_add_f32 v17, v17, v33
    v_add_f32 v18, v18, v34
    v_add_f32 v19, v19, v35
    v_add_f32 v20, v20, v36
    v_add_f32 v21, v21, v37
    v_add_f32 v22, v22, v38
    v_add_f32 v23, v23, v39
    v_add_f32 v24, v24, v40
    v_add_f32 v25, v25, v41
    v_add_f32 v26, v26, v42
    v_add_f32 v27, v27, v43
L_fnx_101:
    s_bitcmp1_b32 s35, 5
    s_cbranch_scc1 L_ffl_102
    v_cvt_f32_u32_sdwa v28, v80 dst_sel:DWORD dst_unused:UNUSED_PAD src0_sel:WORD_0
    v_cvt_f32_u32_sdwa v29, v80 dst_sel:DWORD dst_unused:UNUSED_PAD src0_sel:WORD_1
    v_cvt_f32_u32_sdwa v30, v81 dst_sel:DWORD dst_unused:UNUSED_PAD src0_sel:WORD_0
    v_cvt_f32_u32_sdwa v31, v81 dst_sel:DWORD dst_unused:UNUSED_PAD src0_sel:WORD_1
    v_cvt_f32_u32_sdwa v32, v82 dst_sel:DWORD dst_unused:UNUSED_PAD src0_sel:WORD_0
    v_cvt_f32_u32_sdwa v33, v82 dst_sel:DWORD dst_unused:UNUSED_PAD src0_sel:WORD_1
    v_cvt_f32_u32_sdwa v34, v83 dst_sel:DWORD dst_unused:UNUSED_PAD src0_sel:WORD_0
    v_cvt_f32_u32_sdwa v35, v83 dst_sel:DWORD dst_unused:UNUSED_PAD src0_sel:WORD_1
    v_cvt_f32_u32_sdwa v36, v96 dst_sel:DWORD dst_unused:UNUSED_PAD src0_sel:WORD_0
    v_cvt_f32_u32_sdwa v37, v96 dst_sel:DWORD dst_unused:UNUSED_PAD src0_sel:WORD_1
    v_cvt_f32_u32_sdwa v38, v97 dst_sel:DWORD dst_unused:UNUSED_PAD src0_sel:WORD_0
    v_cvt_f32_u32_sdwa v39, v97 dst_sel:DWORD dst_unused:UNUSED_PAD src0_sel:WORD_1
    v_cvt_f32_u32_sdwa v40, v98 dst_sel:DWORD dst_unused:UNUSED_PAD src0_sel:WORD_0
    v_cvt_f32_u32_sdwa v41, v98 dst_sel:DWORD dst_unused:UNUSED_PAD src0_sel:WORD_1
    v_cvt_f32_u32_sdwa v42, v99 dst_sel:DWORD dst_unused:UNUSED_PAD src0_sel:WORD_0
    v_cvt_f32_u32_sdwa v43, v99 dst_sel:DWORD dst_unused:UNUSED_PAD src0_sel:WORD_1
    v_add_f32 v28, 0xc6800000, v28
    v_fmac_f32 v12, s34, v28
    v_add_f32 v29, 0xc6800000, v29
    v_fmac_f32 v13, s34, v29
    v_add_f32 v30, 0xc6800000, v30
    v_fmac_f32 v14, s34, v30
    v_add_f32 v31, 0xc6800000, v31
    v_fmac_f32 v15, s34, v31
    v_add_f32 v32, 0xc6800000, v32
    v_fmac_f32 v16, s34, v32
    v_add_f32 v33, 0xc6800000, v33
    v_fmac_f32 v17, s34, v33
    v_add_f32 v34, 0xc6800000, v34
    v_fmac_f32 v18, s34, v34
    v_add_f32 v35, 0xc6800000, v35
    v_fmac_f32 v19, s34, v35
    v_add_f32 v36, 0xc6800000, v36
    v_fmac_f32 v20, s34, v36
    v_add_f32 v37, 0xc6800000, v37
    v_fmac_f32 v21, s34, v37
    v_add_f32 v38, 0xc6800000, v38
    v_fmac_f32 v22, s34, v38
    v_add_f32 v39, 0xc6800000, v39
    v_fmac_f32 v23, s34, v39
    v_add_f32 v40, 0xc6800000, v40
    v_fmac_f32 v24, s34, v40
    v_add_f32 v41, 0xc6800000, v41
    v_fmac_f32 v25, s34, v41
    v_add_f32 v42, 0xc6800000, v42
    v_fmac_f32 v26, s34, v42
    v_add_f32 v43, 0xc6800000, v43
    v_fmac_f32 v27, s34, v43
    s_branch L_fnx_103
L_ffl_102:
    s_mov_b32 s3, 38400000
    buffer_load_dwordx4 v[28:31], v6, s[20:23], s3 offen offset:0 sc1
    buffer_load_dwordx4 v[32:35], v6, s[20:23], s3 offen offset:16 sc1
    buffer_load_dwordx4 v[36:39], v7, s[20:23], s3 offen offset:0 sc1
    buffer_load_dwordx4 v[40:43], v7, s[20:23], s3 offen offset:16 sc1
    s_waitcnt vmcnt(0)
    v_add_f32 v12, v12, v28
    v_add_f32 v13, v13, v29
    v_add_f32 v14, v14, v30
    v_add_f32 v15, v15, v31
    v_add_f32 v16, v16, v32
    v_add_f32 v17, v17, v33
    v_add_f32 v18, v18, v34
    v_add_f32 v19, v19, v35
    v_add_f32 v20, v20, v36
    v_add_f32 v21, v21, v37
    v_add_f32 v22, v22, v38
    v_add_f32 v23, v23, v39
    v_add_f32 v24, v24, v40
    v_add_f32 v25, v25, v41
    v_add_f32 v26, v26, v42
    v_add_f32 v27, v27, v43
L_fnx_103:
    s_bitcmp1_b32 s35, 6
    s_cbranch_scc1 L_ffl_104
    v_cvt_f32_u32_sdwa v28, v84 dst_sel:DWORD dst_unused:UNUSED_PAD src0_sel:WORD_0
    v_cvt_f32_u32_sdwa v29, v84 dst_sel:DWORD dst_unused:UNUSED_PAD src0_sel:WORD_1
    v_cvt_f32_u32_sdwa v30, v85 dst_sel:DWORD dst_unused:UNUSED_PAD src0_sel:WORD_0
    v_cvt_f32_u32_sdwa v31, v85 dst_sel:DWORD dst_unused:UNUSED_PAD src0_sel:WORD_1
    v_cvt_f32_u32_sdwa v32, v86 dst_sel:DWORD dst_unused:UNUSED_PAD src0_sel:WORD_0
    v_cvt_f32_u32_sdwa v33, v86 dst_sel:DWORD dst_unused:UNUSED_PAD src0_sel:WORD_1
    v_cvt_f32_u32_sdwa v34, v87 dst_sel:DWORD dst_unused:UNUSED_PAD src0_sel:WORD_0
    v_cvt_f32_u32_sdwa v35, v87 dst_sel:DWORD dst_unused:UNUSED_PAD src0_sel:WORD_1
    v_cvt_f32_u32_sdwa v36, v100 dst_sel:DWORD dst_unused:UNUSED_PAD src0_sel:WORD_0
    v_cvt_f32_u32_sdwa v37, v100 dst_sel:DWORD dst_unused:UNUSED_PAD src0_sel:WORD_1
    v_cvt_f32_u32_sdwa v38, v101 dst_sel:DWORD dst_unused:UNUSED_PAD src0_sel:WORD_0
    v_cvt_f32_u32_sdwa v39, v101 dst_sel:DWORD dst_unused:UNUSED_PAD src0_sel:WORD_1
    v_cvt_f32_u32_sdwa v40, v102 dst_sel:DWORD dst_unused:UNUSED_PAD src0_sel:WORD_0
    v_cvt_f32_u32_sdwa v41, v102 dst_sel:DWORD dst_unused:UNUSED_PAD src0_sel:WORD_1
    v_cvt_f32_u32_sdwa v42, v103 dst_sel:DWORD dst_unused:UNUSED_PAD src0_sel:WORD_0
    v_cvt_f32_u32_sdwa v43, v103 dst_sel:DWORD dst_unused:UNUSED_PAD src0_sel:WORD_1
    v_add_f32 v28, 0xc6800000, v28
    v_fmac_f32 v12, s34, v28
    v_add_f32 v29, 0xc6800000, v29
    v_fmac_f32 v13, s34, v29
    v_add_f32 v30, 0xc6800000, v30
    v_fmac_f32 v14, s34, v30
    v_add_f32 v31, 0xc6800000, v31
    v_fmac_f32 v15, s34, v31
    v_add_f32 v32, 0xc6800000, v32
    v_fmac_f32 v16, s34, v32
    v_add_f32 v33, 0xc6800000, v33
    v_fmac_f32 v17, s34, v33
    v_add_f32 v34, 0xc6800000, v34
    v_fmac_f32 v18, s34, v34
    v_add_f32 v35, 0xc6800000, v35
    v_fmac_f32 v19, s34, v35
    v_add_f32 v36, 0xc6800000, v36
    v_fmac_f32 v20, s34, v36
    v_add_f32 v37, 0xc6800000, v37
    v_fmac_f32 v21, s34, v37
    v_add_f32 v38, 0xc6800000, v38
    v_fmac_f32 v22, s34, v38
    v_add_f32 v39, 0xc6800000, v39
    v_fmac_f32 v23, s34, v39
    v_add_f32 v40, 0xc6800000, v40
    v_fmac_f32 v24, s34, v40
    v_add_f32 v41, 0xc6800000, v41
    v_fmac_f32 v25, s34, v41
    v_add_f32 v42, 0xc6800000, v42
    v_fmac_f32 v26, s34, v42
    v_add_f32 v43, 0xc6800000, v43
    v_fmac_f32 v27, s34, v43
    s_branch L_fnx_105
L_ffl_104:
    s_mov_b32 s3, 51200000
    buffer_load_dwordx4 v[28:31], v6, s[20:23], s3 offen offset:0 sc1
    buffer_load_dwordx4 v[32:35], v6, s[20:23], s3 offen offset:16 sc1
    buffer_load_dwordx4 v[36:39], v7, s[20:23], s3 offen offset:0 sc1
    buffer_load_dwordx4 v[40:43], v7, s[20:23], s3 offen offset:16 sc1
    s_waitcnt vmcnt(0)
    v_add_f32 v12, v12, v28
    v_add_f32 v13, v13, v29
    v_add_f32 v14, v14, v30
    v_add_f32 v15, v15, v31
    v_add_f32 v16, v16, v32
    v_add_f32 v17, v17, v33
    v_add_f32 v18, v18, v34
    v_add_f32 v19, v19, v35
    v_add_f32 v20, v20, v36
    v_add_f32 v21, v21, v37
    v_add_f32 v22, v22, v38
    v_add_f32 v23, v23, v39
    v_add_f32 v24, v24, v40
    v_add_f32 v25, v25, v41
    v_add_f32 v26, v26, v42
    v_add_f32 v27, v27, v43
L_fnx_105:
    s_bitcmp1_b32 s35, 7
    s_cbranch_scc1 L_ffl_106
    v_cvt_f32_u32_sdwa v28, v88 dst_sel:DWORD dst_unused:UNUSED_PAD src0_sel:WORD_0
    v_cvt_f32_u32_sdwa v29, v88 dst_sel:DWORD dst_unused:UNUSED_PAD src0_sel:WORD_1
    v_cvt_f32_u32_sdwa v30, v89 dst_sel:DWORD dst_unused:UNUSED_PAD src0_sel:WORD_0
    v_cvt_f32_u32_sdwa v31, v89 dst_sel:DWORD dst_unused:UNUSED_PAD src0_sel:WORD_1
    v_cvt_f32_u32_sdwa v32, v90 dst_sel:DWORD dst_unused:UNUSED_PAD src0_sel:WORD_0
    v_cvt_f32_u32_sdwa v33, v90 dst_sel:DWORD dst_unused:UNUSED_PAD src0_sel:WORD_1
    v_cvt_f32_u32_sdwa v34, v91 dst_sel:DWORD dst_unused:UNUSED_PAD src0_sel:WORD_0
    v_cvt_f32_u32_sdwa v35, v91 dst_sel:DWORD dst_unused:UNUSED_PAD src0_sel:WORD_1
    v_cvt_f32_u32_sdwa v36, v104 dst_sel:DWORD dst_unused:UNUSED_PAD src0_sel:WORD_0
    v_cvt_f32_u32_sdwa v37, v104 dst_sel:DWORD dst_unused:UNUSED_PAD src0_sel:WORD_1
    v_cvt_f32_u32_sdwa v38, v105 dst_sel:DWORD dst_unused:UNUSED_PAD src0_sel:WORD_0
    v_cvt_f32_u32_sdwa v39, v105 dst_sel:DWORD dst_unused:UNUSED_PAD src0_sel:WORD_1
    v_cvt_f32_u32_sdwa v40, v106 dst_sel:DWORD dst_unused:UNUSED_PAD src0_sel:WORD_0
    v_cvt_f32_u32_sdwa v41, v106 dst_sel:DWORD dst_unused:UNUSED_PAD src0_sel:WORD_1
    v_cvt_f32_u32_sdwa v42, v107 dst_sel:DWORD dst_unused:UNUSED_PAD src0_sel:WORD_0
    v_cvt_f32_u32_sdwa v43, v107 dst_sel:DWORD dst_unused:UNUSED_PAD src0_sel:WORD_1
    v_add_f32 v28, 0xc6800000, v28
    v_fmac_f32 v12, s34, v28
    v_add_f32 v29, 0xc6800000, v29
    v_fmac_f32 v13, s34, v29
    v_add_f32 v30, 0xc6800000, v30
    v_fmac_f32 v14, s34, v30
    v_add_f32 v31, 0xc6800000, v31
    v_fmac_f32 v15, s34, v31
    v_add_f32 v32, 0xc6800000, v32
    v_fmac_f32 v16, s34, v32
    v_add_f32 v33, 0xc6800000, v33
    v_fmac_f32 v17, s34, v33
    v_add_f32 v34, 0xc6800000, v34
    v_fmac_f32 v18, s34, v34
    v_add_f32 v35, 0xc6800000, v35
    v_fmac_f32 v19, s34, v35
    v_add_f32 v36, 0xc6800000, v36
    v_fmac_f32 v20, s34, v36
    v_add_f32 v37, 0xc6800000, v37
    v_fmac_f32 v21, s34, v37
    v_add_f32 v38, 0xc6800000, v38
    v_fmac_f32 v22, s34, v38
    v_add_f32 v39, 0xc6800000, v39
    v_fmac_f32 v23, s34, v39
    v_add_f32 v40, 0xc6800000, v40
    v_fmac_f32 v24, s34, v40
    v_add_f32 v41, 0xc6800000, v41
    v_fmac_f32 v25, s34, v41
    v_add_f32 v42, 0xc6800000, v42
    v_fmac_f32 v26, s34, v42
    v_add_f32 v43, 0xc6800000, v43
    v_fmac_f32 v27, s34, v43
    s_branch L_fnx_107
L_ffl_106:
    s_mov_b32 s3, 64000000
    buffer_load_dwordx4 v[28:31], v6, s[20:23], s3 offen offset:0 sc1
    buffer_load_dwordx4 v[32:35], v6, s[20:23], s3 offen offset:16 sc1
    buffer_load_dwordx4 v[36:39], v7, s[20:23], s3 offen offset:0 sc1
    buffer_load_dwordx4 v[40:43], v7, s[20:23], s3 offen offset:16 sc1
    s_waitcnt vmcnt(0)
    v_add_f32 v12, v12, v28
    v_add_f32 v13, v13, v29
    v_add_f32 v14, v14, v30
    v_add_f32 v15, v15, v31
    v_add_f32 v16, v16, v32
    v_add_f32 v17, v17, v33
    v_add_f32 v18, v18, v34
    v_add_f32 v19, v19, v35
    v_add_f32 v20, v20, v36
    v_add_f32 v21, v21, v37
    v_add_f32 v22, v22, v38
    v_add_f32 v23, v23, v39
    v_add_f32 v24, v24, v40
    v_add_f32 v25, v25, v41
    v_add_f32 v26, v26, v42
    v_add_f32 v27, v27, v43
L_fnx_107:
    s_branch L_fbk_99
L_p2slow_47:
    s_waitcnt vmcnt(0) lgkmcnt(0)
    s_mov_b32 s51, 0
    s_movk_i32 s43, 6250

L_sweep_109:
    s_barrier

    v_mov_b32 v28, 0x0
    v_mov_b32 v29, 0x0
    v_mov_b32 v30, 0x0
    v_mov_b32 v31, 0x0
    v_add_u32 v32, 50000, v3
    v_add_u32 v33, 65536, v32

    ds_write_b128 v32, v[28:31] offset:0
    ds_write_b128 v32, v[28:31] offset:16384
    ds_write_b128 v32, v[28:31] offset:32768
    ds_write_b128 v32, v[28:31] offset:49152
    ds_write_b128 v33, v[28:31] offset:0
    ds_write_b128 v33, v[28:31] offset:16384
    v_cmp_gt_u32 vcc, 971, v0
    s_mov_b64 exec, vcc
    ds_write_b128 v33, v[28:31] offset:32768
    s_mov_b64 exec, -1
    s_mov_b32 s3, 32768
    s_load_dword s40, s[6:7], s3
    s_waitcnt lgkmcnt(0)
    s_barrier
    s_cmp_lg_u32 s40, 0
    s_cbranch_scc1 L_raw_114
    s_sub_u32 s38, s4, 8
L_sbatch_110:
    s_lshl_b32 s52, s38, 6
    s_add_u32 s52, s52, s36
    s_lshr_b32 s52, s52, 1
    s_lshl_b32 s52, s52, 2
    s_load_dword s40, s[46:47], s52
    s_mul_i32 s50, s38, 200000
    s_and_b32 s3, s36, 1
    s_lshl_b32 s3, s3, 4
    s_or_b32 s3, s3, 0x100000
    s_waitcnt lgkmcnt(0)
    s_bfe_u32 s40, s40, s3

    s_min_u32 s40, s40, 6552
    s_lshl_b32 s52, s38, 6
    s_add_u32 s52, s52, s36
    s_mul_i32 s52, s52, 32764
    s_add_u32 s20, s44, s52
    s_addc_u32 s21, s45, 0
    s_mul_i32 s52, s40, 5
    s_add_u32 s52, s52, 3
    s_and_b32 s22, s52, -4

    s_lshr_b32 s55, s39, 2
    s_add_u32 s55, s55, 0
    v_and_b32 v36, 63, v0
    v_add_u32 v36, s55, v36
L_left_115:
    s_cmp_ge_u32 s55, s40
    s_cbranch_scc1 L_leftend_116
    v_mul_u32_u24 v37, 5, v36
    buffer_load_dword v38, v37, s[20:23], 0 offen
    buffer_load_ubyte v39, v37, s[20:23], 0 offen offset:4
    s_waitcnt vmcnt(0)

    v_perm_b32 v37, v39, v38, s24
    v_lshrrev_b32 v42, 30, v38
    v_and_b32 v37, 0x1fff, v37
    v_mul_u32_u24 v42, 6250, v42
    v_add_lshl_u32 v37, v37, v42, 3

    buffer_load_dwordx2 v[40:41], v37, s[8:11], s50 offen
    v_cmp_gt_u32 vcc, s40, v36
    s_waitcnt vmcnt(0)

    v_bfe_u32 v44, v38, 16, 14
    v_subrev_u32 v44, s51, v44
    v_cmp_gt_u32 s[64:65], s43, v44
    s_and_b64 exec, vcc, s[64:65]
    v_lshlrev_b32 v45, 8, v38
    v_cmpx_ne_u32 vcc, 0, v45
    v_lshlrev_b32 v44, 4, v44
    v_bfe_i32 v38, v38, 0, 16
    v_cvt_f32_i32 v38, v38
    v_mul_f32 v38, 0x38004020, v38
    v_lshlrev_b32 v45, 16, v40
    v_and_b32 v46, s32, v40
    v_lshlrev_b32 v47, 16, v41
    v_and_b32 v48, s32, v41

    v_mul_f32 v45, v45, v38
    ds_add_f32 v44, v45 offset:50000
    v_mul_f32 v46, v46, v38
    ds_add_f32 v44, v46 offset:50004
    v_mul_f32 v47, v47, v38
    ds_add_f32 v44, v47 offset:50008
    v_mul_f32 v48, v48, v38
    ds_add_f32 v44, v48 offset:50012
    s_mov_b64 exec, -1
    v_add_u32 v36, 128, v36
    s_add_u32 s55, s55, 128
    s_branch L_left_115
L_leftend_116:

    s_add_u32 s38, s38, 1
    s_cmp_lt_u32 s38, s4
    s_cbranch_scc1 L_sbatch_110
    s_branch L_swend_112

L_raw_114:
    s_load_dwordx2 s[68:69], s[0:1], 8
    s_load_dwordx2 s[72:73], s[0:1], 16
    s_load_dwordx2 s[76:77], s[0:1], 32
    s_load_dwordx2 s[80:81], s[0:1], 48
    s_mov_b32 s70, 204800000
    s_mov_b32 s71, 0x20000
    s_mov_b32 s74, 204800000
    s_mov_b32 s75, 0x20000
    s_mov_b32 s78, 102400000
    s_mov_b32 s79, 0x20000
    s_waitcnt lgkmcnt(0)
    s_load_dword s82, s[80:81], 0
    s_mul_i32 s83, s36, 12500
    s_add_u32 s83, s83, s51
    s_mul_i32 s84, s37, 200000
    s_mov_b32 s85, 200000
    s_mov_b32 s38, 0
    v_lshlrev_b32 v44, 5, v0
    v_mov_b32 v45, 0.15915494
    s_waitcnt lgkmcnt(0)
    s_lshl_b32 s82, s82, 16
    v_mul_f32 v45, s82, v45
L_rawl_111:
    s_lshr_b32 s3, s38, 1
    buffer_load_dwordx4 v[46:49], v44, s[72:75], s38 offen
    buffer_load_dwordx4 v[50:53], v44, s[72:75], s38 offen offset:16
    buffer_load_dwordx4 v[54:57], v44, s[68:71], s38 offen
    buffer_load_dwordx4 v[58:61], v44, s[68:71], s38 offen offset:16
    buffer_load_dwordx4 v[62:65], v3, s[76:79], s3 offen
    s_waitcnt vmcnt(1)

    v_subrev_u32 v46, s83, v46
    v_subrev_u32 v82, s84, v54
    v_cmp_gt_u32 vcc, s43, v46
    v_cmp_gt_u32 s[64:65], s85, v82
    v_lshlrev_b32 v54, 3, v54
    s_nand_b64 exec, vcc, s[64:65]
    v_bfrev_b32 v54, 1
    s_mov_b64 exec, -1
    buffer_load_dwordx2 v[66:67], v54, s[8:11], 0 offen

    v_subrev_u32 v47, s83, v47
    v_subrev_u32 v82, s84, v55
    v_cmp_gt_u32 vcc, s43, v47
    v_cmp_gt_u32 s[64:65], s85, v82
    v_lshlrev_b32 v55, 3, v55
    s_nand_b64 exec, vcc, s[64:65]
    v_bfrev_b32 v55, 1
    s_mov_b64 exec, -1
    buffer_load_dwordx2 v[68:69], v55, s[8:11], 0 offen

    v_subrev_u32 v48, s83, v48
    v_subrev_u32 v82, s84, v56
    v_cmp_gt_u32 vcc, s43, v48
    v_cmp_gt_u32 s[64:65], s85, v82
    v_lshlrev_b32 v56, 3, v56
    s_nand_b64 exec, vcc, s[64:65]
    v_bfrev_b32 v56, 1
    s_mov_b64 exec, -1
    buffer_load_dwordx2 v[70:71], v56, s[8:11], 0 offen

    v_subrev_u32 v49, s83, v49
    v_subrev_u32 v82, s84, v57
    v_cmp_gt_u32 vcc, s43, v49
    v_cmp_gt_u32 s[64:65], s85, v82
    v_lshlrev_b32 v57, 3, v57
    s_nand_b64 exec, vcc, s[64:65]
    v_bfrev_b32 v57, 1
    s_mov_b64 exec, -1
    buffer_load_dwordx2 v[72:73], v57, s[8:11], 0 offen

    v_subrev_u32 v50, s83, v50
    v_subrev_u32 v82, s84, v58
    v_cmp_gt_u32 vcc, s43, v50
    v_cmp_gt_u32 s[64:65], s85, v82
    v_lshlrev_b32 v58, 3, v58
    s_nand_b64 exec, vcc, s[64:65]
    v_bfrev_b32 v58, 1
    s_mov_b64 exec, -1
    buffer_load_dwordx2 v[74:75], v58, s[8:11], 0 offen

    v_subrev_u32 v51, s83, v51
    v_subrev_u32 v82, s84, v59
    v_cmp_gt_u32 vcc, s43, v51
    v_cmp_gt_u32 s[64:65], s85, v82
    v_lshlrev_b32 v59, 3, v59
    s_nand_b64 exec, vcc, s[64:65]
    v_bfrev_b32 v59, 1
    s_mov_b64 exec, -1
    buffer_load_dwordx2 v[76:77], v59, s[8:11], 0 offen

    v_subrev_u32 v52, s83, v52
    v_subrev_u32 v82, s84, v60
    v_cmp_gt_u32 vcc, s43, v52
    v_cmp_gt_u32 s[64:65], s85, v82
    v_lshlrev_b32 v60, 3, v60
    s_nand_b64 exec, vcc, s[64:65]
    v_bfrev_b32 v60, 1
    s_mov_b64 exec, -1
    buffer_load_dwordx2 v[78:79], v60, s[8:11], 0 offen

    v_subrev_u32 v53, s83, v53
    v_subrev_u32 v82, s84, v61
    v_cmp_gt_u32 vcc, s43, v53
    v_cmp_gt_u32 s[64:65], s85, v82
    v_lshlrev_b32 v61, 3, v61
    s_nand_b64 exec, vcc, s[64:65]
    v_bfrev_b32 v61, 1
    s_mov_b64 exec, -1
    buffer_load_dwordx2 v[80:81], v61, s[8:11], 0 offen

    s_waitcnt vmcnt(0)
    v_cmp_le_i32 vcc, 0, v54
    s_mov_b64 exec, vcc
    s_cbranch_execz L_rsk_117
    v_lshlrev_b32 v82, 16, v62
    v_mul_f32 v82, v82, v45
    v_fract_f32 v82, v82
    v_cos_f32 v82, v82
    v_lshlrev_b32 v46, 4, v46
    v_lshlrev_b32 v83, 16, v66
    v_and_b32 v84, s32, v66
    v_lshlrev_b32 v85, 16, v67
    v_and_b32 v86, s32, v67

    v_mul_f32 v83, v83, v82
    ds_add_f32 v46, v83 offset:50000
    v_mul_f32 v84, v84, v82
    ds_add_f32 v46, v84 offset:50004
    v_mul_f32 v85, v85, v82
    ds_add_f32 v46, v85 offset:50008
    v_mul_f32 v86, v86, v82
    ds_add_f32 v46, v86 offset:50012
L_rsk_117:
    s_mov_b64 exec, -1
    v_cmp_le_i32 vcc, 0, v55
    s_mov_b64 exec, vcc
    s_cbranch_execz L_rsk_118
    v_and_b32 v82, s32, v62
    v_mul_f32 v82, v82, v45
    v_fract_f32 v82, v82
    v_cos_f32 v82, v82
    v_lshlrev_b32 v47, 4, v47
    v_lshlrev_b32 v83, 16, v68
    v_and_b32 v84, s32, v68
    v_lshlrev_b32 v85, 16, v69
    v_and_b32 v86, s32, v69

    v_mul_f32 v83, v83, v82
    ds_add_f32 v47, v83 offset:50000
    v_mul_f32 v84, v84, v82
    ds_add_f32 v47, v84 offset:50004
    v_mul_f32 v85, v85, v82
    ds_add_f32 v47, v85 offset:50008
    v_mul_f32 v86, v86, v82
    ds_add_f32 v47, v86 offset:50012
L_rsk_118:
    s_mov_b64 exec, -1
    v_cmp_le_i32 vcc, 0, v56
    s_mov_b64 exec, vcc
    s_cbranch_execz L_rsk_119
    v_lshlrev_b32 v82, 16, v63
    v_mul_f32 v82, v82, v45
    v_fract_f32 v82, v82
    v_cos_f32 v82, v82
    v_lshlrev_b32 v48, 4, v48
    v_lshlrev_b32 v83, 16, v70
    v_and_b32 v84, s32, v70
    v_lshlrev_b32 v85, 16, v71
    v_and_b32 v86, s32, v71

    v_mul_f32 v83, v83, v82
    ds_add_f32 v48, v83 offset:50000
    v_mul_f32 v84, v84, v82
    ds_add_f32 v48, v84 offset:50004
    v_mul_f32 v85, v85, v82
    ds_add_f32 v48, v85 offset:50008
    v_mul_f32 v86, v86, v82
    ds_add_f32 v48, v86 offset:50012
L_rsk_119:
    s_mov_b64 exec, -1
    v_cmp_le_i32 vcc, 0, v57
    s_mov_b64 exec, vcc
    s_cbranch_execz L_rsk_120
    v_and_b32 v82, s32, v63
    v_mul_f32 v82, v82, v45
    v_fract_f32 v82, v82
    v_cos_f32 v82, v82
    v_lshlrev_b32 v49, 4, v49
    v_lshlrev_b32 v83, 16, v72
    v_and_b32 v84, s32, v72
    v_lshlrev_b32 v85, 16, v73
    v_and_b32 v86, s32, v73

    v_mul_f32 v83, v83, v82
    ds_add_f32 v49, v83 offset:50000
    v_mul_f32 v84, v84, v82
    ds_add_f32 v49, v84 offset:50004
    v_mul_f32 v85, v85, v82
    ds_add_f32 v49, v85 offset:50008
    v_mul_f32 v86, v86, v82
    ds_add_f32 v49, v86 offset:50012
L_rsk_120:
    s_mov_b64 exec, -1
    v_cmp_le_i32 vcc, 0, v58
    s_mov_b64 exec, vcc
    s_cbranch_execz L_rsk_121
    v_lshlrev_b32 v82, 16, v64
    v_mul_f32 v82, v82, v45
    v_fract_f32 v82, v82
    v_cos_f32 v82, v82
    v_lshlrev_b32 v50, 4, v50
    v_lshlrev_b32 v83, 16, v74
    v_and_b32 v84, s32, v74
    v_lshlrev_b32 v85, 16, v75
    v_and_b32 v86, s32, v75

    v_mul_f32 v83, v83, v82
    ds_add_f32 v50, v83 offset:50000
    v_mul_f32 v84, v84, v82
    ds_add_f32 v50, v84 offset:50004
    v_mul_f32 v85, v85, v82
    ds_add_f32 v50, v85 offset:50008
    v_mul_f32 v86, v86, v82
    ds_add_f32 v50, v86 offset:50012
L_rsk_121:
    s_mov_b64 exec, -1
    v_cmp_le_i32 vcc, 0, v59
    s_mov_b64 exec, vcc
    s_cbranch_execz L_rsk_122
    v_and_b32 v82, s32, v64
    v_mul_f32 v82, v82, v45
    v_fract_f32 v82, v82
    v_cos_f32 v82, v82
    v_lshlrev_b32 v51, 4, v51
    v_lshlrev_b32 v83, 16, v76
    v_and_b32 v84, s32, v76
    v_lshlrev_b32 v85, 16, v77
    v_and_b32 v86, s32, v77

    v_mul_f32 v83, v83, v82
    ds_add_f32 v51, v83 offset:50000
    v_mul_f32 v84, v84, v82
    ds_add_f32 v51, v84 offset:50004
    v_mul_f32 v85, v85, v82
    ds_add_f32 v51, v85 offset:50008
    v_mul_f32 v86, v86, v82
    ds_add_f32 v51, v86 offset:50012
L_rsk_122:
    s_mov_b64 exec, -1
    v_cmp_le_i32 vcc, 0, v60
    s_mov_b64 exec, vcc
    s_cbranch_execz L_rsk_123
    v_lshlrev_b32 v82, 16, v65
    v_mul_f32 v82, v82, v45
    v_fract_f32 v82, v82
    v_cos_f32 v82, v82
    v_lshlrev_b32 v52, 4, v52
    v_lshlrev_b32 v83, 16, v78
    v_and_b32 v84, s32, v78
    v_lshlrev_b32 v85, 16, v79
    v_and_b32 v86, s32, v79

    v_mul_f32 v83, v83, v82
    ds_add_f32 v52, v83 offset:50000
    v_mul_f32 v84, v84, v82
    ds_add_f32 v52, v84 offset:50004
    v_mul_f32 v85, v85, v82
    ds_add_f32 v52, v85 offset:50008
    v_mul_f32 v86, v86, v82
    ds_add_f32 v52, v86 offset:50012
L_rsk_123:
    s_mov_b64 exec, -1
    v_cmp_le_i32 vcc, 0, v61
    s_mov_b64 exec, vcc
    s_cbranch_execz L_rsk_124
    v_and_b32 v82, s32, v65
    v_mul_f32 v82, v82, v45
    v_fract_f32 v82, v82
    v_cos_f32 v82, v82
    v_lshlrev_b32 v53, 4, v53
    v_lshlrev_b32 v83, 16, v80
    v_and_b32 v84, s32, v80
    v_lshlrev_b32 v85, 16, v81
    v_and_b32 v86, s32, v81

    v_mul_f32 v83, v83, v82
    ds_add_f32 v53, v83 offset:50000
    v_mul_f32 v84, v84, v82
    ds_add_f32 v53, v84 offset:50004
    v_mul_f32 v85, v85, v82
    ds_add_f32 v53, v85 offset:50008
    v_mul_f32 v86, v86, v82
    ds_add_f32 v53, v86 offset:50012
L_rsk_124:
    s_mov_b64 exec, -1
    s_add_u32 s38, s38, 32768
    s_cmp_lt_u32 s38, 204800000
    s_cbranch_scc1 L_rawl_111
L_swend_112:
    s_waitcnt lgkmcnt(0)
    s_barrier
    s_mul_i32 s3, s37, 800000
    s_mul_i32 s5, s36, 12500
    s_add_u32 s3, s3, s5
    s_add_u32 s3, s3, s51
    s_lshl_b32 s3, s3, 4
    s_add_u32 s3, s3, 32399360

    s_add_u32 s20, s6, s3
    s_addc_u32 s21, s7, 0
    s_mov_b32 s22, 100000
    s_mov_b32 s23, 0x20000
    v_mov_b32 v36, v3
    s_mov_b32 s38, 0
L_wl_113:
    v_min_u32 v37, 100000, v36
    ds_read_b128 v[28:31], v37 offset:50000
    s_waitcnt lgkmcnt(0)
    buffer_store_dwordx4 v[28:31], v36, s[20:23], 0 offen sc1
    s_waitcnt vmcnt(0)
    v_add_u32 v36, 16384, v36
    s_add_u32 s38, s38, 1024
    s_cmp_lt_u32 s38, 6250
    s_cbranch_scc1 L_wl_113
    s_add_u32 s51, s51, 6250
    s_cmp_lt_u32 s51, 12500
    s_cbranch_scc1 L_sweep_109
    s_lshl_b32 s33, 16, s37
    s_add_u32 s33, s33, 1
    s_branch L_fin_82

.section .rodata,"a"
.p2align 6
.amdhsa_kernel g1_kernel
  .amdhsa_next_free_vgpr 128
  .amdhsa_next_free_sgpr 102
  .amdhsa_accum_offset 128
  .amdhsa_group_segment_fixed_size 0
  .amdhsa_kernarg_size 112
  .amdhsa_user_sgpr_count 2
  .amdhsa_user_sgpr_kernarg_segment_ptr 1
  .amdhsa_system_sgpr_workgroup_id_x 1
.end_amdhsa_kernel
.p2align 6
.amdhsa_kernel standalone__molecular_angular_gemnet__graph_kernel
  .amdhsa_next_free_vgpr 128
  .amdhsa_next_free_sgpr 102
  .amdhsa_accum_offset 128
  .amdhsa_group_segment_fixed_size 0
  .amdhsa_kernarg_size 112
  .amdhsa_user_sgpr_count 2
  .amdhsa_user_sgpr_kernarg_segment_ptr 1
  .amdhsa_system_sgpr_workgroup_id_x 1
  .amdhsa_float_denorm_mode_32 3
.end_amdhsa_kernel
```

```asm
; @launch kernel=g1_kernel grid=(256,1,1) block=(1024,1,1) lds=163840
; @launch kernel=standalone__molecular_angular_gemnet__graph_kernel grid=(256,1,1) block=(1024,1,1) lds=163840
.amdgcn_target "amdgcn-amd-amdhsa--gfx950"
.text
.globl g1_kernel
.p2align 8
.type g1_kernel,@function
g1_kernel:
    s_cmp_ge_u32 s2, 256
    s_cbranch_scc1 L_p1done_1
    s_load_dwordx4 s[80:83], s[0:1], 8
    s_load_dwordx2 s[84:85], s[0:1], 32
    s_load_dwordx2 s[86:87], s[0:1], 48
    s_load_dwordx4 s[4:7], s[0:1], 96
    s_load_dwordx2 s[78:79], s[0:1], 0
    v_lshlrev_b32 v1, 4, v0
    v_lshlrev_b32 v2, 3, v0
    v_lshlrev_b32 v98, 20, v0
    s_waitcnt lgkmcnt(0)
    s_load_dword s88, s[86:87], 0

    s_mov_b32 s96, s4
    s_mov_b32 s97, s5
    s_mov_b32 s98, 256
    s_mov_b32 s99, 0x20000
    v_readfirstlane_b32 s74, v0
    s_nop 1
    s_or_b32 s74, s74, s2
    s_cbranch_scc1 L_noinit_2

    v_mov_b32 v110, 1
    buffer_atomic_add v110, v98, s[96:99], 0 offen offset:64 sc0
    s_waitcnt vmcnt(0)
    v_readfirstlane_b32 s74, v110
    s_nop 1
    s_cmp_lg_u32 s74, 0
    s_cbranch_scc1 L_zno_4

    s_mov_b32 s92, s6
    s_mov_b32 s93, s7
    s_mov_b32 s94, 32784
    s_mov_b32 s95, 0x20000
    v_mov_b32 v110, 0
    v_mov_b32 v111, 0
    v_mov_b32 v112, 0
    v_mov_b32 v113, 0
L_zl_3:
    buffer_store_dwordx4 v[110:113], v1, s[92:95], s74 offen sc0 sc1
    s_add_u32 s74, s74, 1024
    s_cmp_le_u32 s74, 32768
    s_cbranch_scc1 L_zl_3
    v_mov_b32 v114, 1
    s_waitcnt vmcnt(0)
    buffer_atomic_add v114, v98, s[96:99], 0 offen offset:128
L_zno_4:

L_noinit_2:
    s_mov_b32 s20, s78
    s_mov_b32 s21, s79
    s_mov_b32 s22, 6400000
    s_mov_b32 s23, 0x20000
    v_mul_u32_u24 v110, 6240, v0
    v_and_b32 v111, 63, v0
    v_and_b32 v112, 0x3c0, v0
    v_lshlrev_b32 v111, 2, v111
    v_lshl_or_b32 v111, v112, 4, v111
    v_lshlrev_b32 v100, 2, v0
    s_lshr_b32 s50, s2, 1
    s_and_b32 s53, s2, 1
    s_mul_i32 s3, s50, 50000
    s_mul_i32 s54, s53, 24576
    s_add_u32 s3, s3, s54

    buffer_load_dwordx4 v[56:59], v110, s[20:23], 0 offen
    s_add_u32 s20, s78, s3
    s_addc_u32 s21, s79, 0
    s_mov_b32 s22, 24576
    s_mov_b32 s23, 0x20000
    s_movk_i32 s3, 16384
    buffer_load_dword v44, v111, s[20:23], 0 offen offset:0
    buffer_load_dword v45, v111, s[20:23], 0 offen offset:256
    buffer_load_dword v46, v111, s[20:23], 0 offen offset:512
    buffer_load_dword v47, v111, s[20:23], 0 offen offset:768
    buffer_load_dword v48, v111, s[20:23], s3 offen offset:0
    buffer_load_dword v49, v111, s[20:23], s3 offen offset:256
    buffer_load_dword v50, v111, s[20:23], s3 offen offset:512
    buffer_load_dword v51, v111, s[20:23], s3 offen offset:768
    s_mul_i32 s22, s53, 25424
    s_movk_i32 s3, 24576

    buffer_load_dword v52, v100, s[20:23], s3 offen
    s_mul_i32 s3, s50, 50048
    s_add_u32 s3, s3, s54
    s_add_u32 s54, s3, 393216

    s_mov_b32 s8, s80
    s_mov_b32 s9, s81
    s_mov_b32 s10, 0
    s_mov_b32 s11, 0x20000
    s_mov_b32 s12, s82
    s_mov_b32 s13, s83
    s_mov_b32 s14, 0
    s_mov_b32 s15, 0x20000
    s_mov_b32 s16, s84
    s_mov_b32 s17, s85
    s_mov_b32 s18, 0
    s_mov_b32 s19, 0x20000
    s_lshr_b32 s74, s2, 1
    s_and_b32 s74, s74, 28
    s_lshr_b32 s86, 0x00102010, s74
    s_lshr_b32 s87, 0x44414241, s74
    s_lshr_b32 s41, 0x43221100, s74
    s_and_b32 s86, s86, 15
    s_and_b32 s87, s87, 15
    s_and_b32 s41, s41, 15
    s_lshr_b32 s74, s2, 6
    s_lshl_b32 s74, s74, 3
    s_and_b32 s75, s2, 7
    s_add_u32 s74, s74, s75
    s_mul_i32 s74, s74, 5
    s_add_u32 s41, s41, s74

    s_mul_i32 s78, s41, 16384
    s_add_u32 s49, s78, 16384
    s_cmp_ge_u32 s41, 3125
    s_cmovk_i32 s49, 0
    s_cmovk_i32 s78, 0
    s_lshl_b32 s10, s49, 2
    s_lshl_b32 s14, s49, 2
    s_lshl_b32 s18, s49, 1
    s_sub_u32 s79, s87, s86
    s_bfm_b32 s85, s79, s86
    s_lshl_b32 s86, s86, 12
    s_lshl_b32 s87, s87, 12
    s_min_u32 s87, s87, 16384

    s_add_u32 s79, s78, 0
    s_bitcmp1_b32 s85, 0
    s_cselect_b32 s79, s79, 0x1ff00000
    s_lshl_b32 s56, s79, 2
    s_lshl_b32 s61, s79, 1

    s_add_u32 s79, s78, 4096
    s_bitcmp1_b32 s85, 1
    s_cselect_b32 s79, s79, 0x1ff00000
    s_lshl_b32 s57, s79, 2
    s_lshl_b32 s62, s79, 1

    s_add_u32 s79, s78, 8192
    s_bitcmp1_b32 s85, 2
    s_cselect_b32 s79, s79, 0x1ff00000
    s_lshl_b32 s58, s79, 2
    s_lshl_b32 s63, s79, 1

    s_add_u32 s79, s78, 12288
    s_bitcmp1_b32 s85, 3
    s_cselect_b32 s79, s79, 0x1ff00000
    s_lshl_b32 s59, s79, 2
    s_lshl_b32 s64, s79, 1

    s_mov_b32 s82, s85
    s_mov_b32 s83, s86
    s_mov_b32 s84, s87
    s_add_u32 s41, s2, 160
    s_mul_i32 s74, s41, 16384
    s_mov_b32 s10, 204800000
    s_mov_b32 s14, 204800000
    s_mov_b32 s18, 102400000

    s_add_u32 s75, s74, 0
    s_lshl_b32 s76, s75, 2
    s_lshl_b32 s75, s75, 1
    s_bitcmp1_b32 s82, 0
    s_cselect_b32 s56, s56, s76
    s_cselect_b32 s61, s61, s75

    s_add_u32 s75, s74, 4096
    s_lshl_b32 s76, s75, 2
    s_lshl_b32 s75, s75, 1
    s_bitcmp1_b32 s82, 1
    s_cselect_b32 s57, s57, s76
    s_cselect_b32 s62, s62, s75

    s_add_u32 s75, s74, 8192
    s_lshl_b32 s76, s75, 2
    s_lshl_b32 s75, s75, 1
    s_bitcmp1_b32 s82, 2
    s_cselect_b32 s58, s58, s76
    s_cselect_b32 s63, s63, s75

    s_add_u32 s75, s74, 12288
    s_lshl_b32 s76, s75, 2
    s_lshl_b32 s75, s75, 1
    s_bitcmp1_b32 s82, 3
    s_cselect_b32 s59, s59, s76
    s_cselect_b32 s64, s64, s75

    buffer_load_dwordx4 v[20:23], v1, s[12:15], s56 offen nt
    buffer_load_dwordx4 v[4:7], v1, s[8:11], s56 offen nt
    buffer_load_dwordx2 v[36:37], v2, s[16:19], s61 offen nt
    buffer_load_dwordx4 v[24:27], v1, s[12:15], s57 offen nt
    buffer_load_dwordx4 v[8:11], v1, s[8:11], s57 offen nt
    buffer_load_dwordx2 v[38:39], v2, s[16:19], s62 offen nt
    buffer_load_dwordx4 v[28:31], v1, s[12:15], s58 offen nt
    buffer_load_dwordx4 v[12:15], v1, s[8:11], s58 offen nt
    buffer_load_dwordx2 v[40:41], v2, s[16:19], s63 offen nt
    buffer_load_dwordx4 v[32:35], v1, s[12:15], s59 offen nt
    buffer_load_dwordx4 v[16:19], v1, s[8:11], s59 offen nt
    buffer_load_dwordx2 v[42:43], v2, s[16:19], s64 offen nt
    s_mov_b32 s86, 0
    s_mov_b32 s87, 4
    s_mul_i32 s78, s41, 16384
    s_add_u32 s49, s78, 16384
    s_cmp_ge_u32 s41, 3125
    s_cmovk_i32 s49, 0
    s_cmovk_i32 s78, 0
    s_lshl_b32 s10, s49, 2
    s_lshl_b32 s14, s49, 2
    s_lshl_b32 s18, s49, 1
    s_sub_u32 s79, s87, s86
    s_bfm_b32 s85, s79, s86
    s_lshl_b32 s86, s86, 12
    s_lshl_b32 s87, s87, 12
    s_min_u32 s87, s87, 16384

    s_add_u32 s79, s78, 0
    s_bitcmp1_b32 s85, 0
    s_cselect_b32 s79, s79, 0x1ff00000
    s_lshl_b32 s56, s79, 2
    s_lshl_b32 s61, s79, 1

    s_add_u32 s79, s78, 4096
    s_bitcmp1_b32 s85, 1
    s_cselect_b32 s79, s79, 0x1ff00000
    s_lshl_b32 s57, s79, 2
    s_lshl_b32 s62, s79, 1

    s_add_u32 s79, s78, 8192
    s_bitcmp1_b32 s85, 2
    s_cselect_b32 s79, s79, 0x1ff00000
    s_lshl_b32 s58, s79, 2
    s_lshl_b32 s63, s79, 1

    s_add_u32 s79, s78, 12288
    s_bitcmp1_b32 s85, 3
    s_cselect_b32 s79, s79, 0x1ff00000
    s_lshl_b32 s59, s79, 2
    s_lshl_b32 s64, s79, 1

    s_getreg_b32 s5, hwreg(HW_REG_XCC_ID)
    s_and_b32 s5, s5, 7
    s_mul_i32 s3, s5, 4096

    s_add_u32 s20, s6, s3
    s_addc_u32 s21, s7, 0
    s_mov_b32 s22, 4096
    s_mov_b32 s23, 0x20000
    s_mul_i32 s3, s5, 67117056
    s_add_u32 s3, s3, 83623936
    s_add_u32 s24, s6, s3
    s_addc_u32 s25, s7, 0
    s_mov_b32 s26, 67117056
    s_mov_b32 s27, 0x20000
    s_add_u32 s36, s6, 32768
    s_addc_u32 s37, s7, 0
    s_mov_b32 s38, 4
    s_mov_b32 s39, 0x20000
    s_mov_b32 s40, 687195
    s_mov_b32 s42, -6250
    s_mov_b32 s43, 1942
    s_mov_b32 s45, 0x06050400
    s_mov_b32 s46, 0x05040c00
    s_mov_b32 s47, 0x04020100
    s_mov_b32 s48, 6552
    s_mov_b32 s50, 0
    v_mov_b32 v104, 1
    v_mov_b32 v105, 0x46ff8000
    s_mov_b32 s55, 0x05040100
    v_mul_u32_u24 v106, 5, v0
    v_mov_b32 v108, 16384
    v_mov_b32 v114, 0
    v_mov_b32 v115, 0
    v_mov_b32 v116, 0
    v_mov_b32 v117, -1
    ds_write_b64 v2, v[114:115]
    s_movk_i32 s3, 1024
    v_cmp_gt_u32 s[66:67], s3, v0
    s_movk_i32 s3, 1024
    v_cmp_gt_u32 s[68:69], s3, v0
    s_mov_b64 exec, 1
    ds_write_b128 v108, v[114:117]
    s_mov_b64 exec, -1
    s_waitcnt lgkmcnt(0)
    s_lshl_b32 s88, s88, 16
    v_mov_b32 v110, 0.15915494
    v_mul_f32 v110, s88, v110
    s_mov_b32 s3, 0x7fff7fff
    v_readfirstlane_b32 s44, v110

    s_waitcnt vmcnt(12)
    v_mov_b32 v61, 0
    v_mov_b32 v62, 0
    v_mov_b32 v63, 0
    v_dot2_f32_bf16 v61, v44, v44, v61
    v_dot2_f32_bf16 v61, v45, v45, v61
    v_dot2_f32_bf16 v61, v46, v46, v61
    v_dot2_f32_bf16 v61, v47, v47, v61
    v_dot2_f32_bf16 v61, v48, v48, v61
    v_dot2_f32_bf16 v61, v49, v49, v61
    v_dot2_f32_bf16 v61, v50, v50, v61
    v_dot2_f32_bf16 v61, v51, v51, v61
    v_dot2_f32_bf16 v61, v52, v52, v61
    v_dot2_f32_bf16 v62, v56, v56, v62
    v_dot2_f32_bf16 v62, v57, v57, v62
    v_dot2_f32_bf16 v62, v58, v58, v62
    v_dot2_f32_bf16 v62, v59, v59, v62
    v_and_b32 v60, s3, v44
    v_and_b32 v64, s3, v45
    v_pk_max_u16 v60, v60, v64
    v_and_b32 v64, s3, v46
    v_pk_max_u16 v60, v60, v64
    v_and_b32 v64, s3, v47
    v_pk_max_u16 v60, v60, v64
    v_and_b32 v64, s3, v48
    v_pk_max_u16 v60, v60, v64
    v_and_b32 v64, s3, v49
    v_pk_max_u16 v60, v60, v64
    v_and_b32 v64, s3, v50
    v_pk_max_u16 v60, v60, v64
    v_and_b32 v64, s3, v51
    v_pk_max_u16 v60, v60, v64
    v_and_b32 v64, s3, v52
    v_pk_max_u16 v60, v60, v64
    v_lshrrev_b32 v64, 16, v60
    v_and_b32 v60, 0xffff, v60
    v_max_u32 v60, v60, v64

    s_nop 1
    v_max_u32_dpp v60, v60, v60 row_shr:1 row_mask:0xf bank_mask:0xf
    s_nop 1
    v_max_u32_dpp v60, v60, v60 row_shr:2 row_mask:0xf bank_mask:0xf
    s_nop 1
    v_max_u32_dpp v60, v60, v60 row_shr:4 row_mask:0xf bank_mask:0xf
    s_nop 1
    v_max_u32_dpp v60, v60, v60 row_shr:8 row_mask:0xf bank_mask:0xf
    s_nop 1
    v_max_u32_dpp v60, v60, v60 row_bcast:15 row_mask:0xa bank_mask:0xf
    s_nop 1
    v_max_u32_dpp v60, v60, v60 row_bcast:31 row_mask:0xc bank_mask:0xf
    s_nop 1
    v_add_f32_dpp v61, v61, v61 row_shr:1 row_mask:0xf bank_mask:0xf
    s_nop 1
    v_add_f32_dpp v61, v61, v61 row_shr:2 row_mask:0xf bank_mask:0xf
    s_nop 1
    v_add_f32_dpp v61, v61, v61 row_shr:4 row_mask:0xf bank_mask:0xf
    s_nop 1
    v_add_f32_dpp v61, v61, v61 row_shr:8 row_mask:0xf bank_mask:0xf
    s_nop 1
    v_add_f32_dpp v61, v61, v61 row_bcast:15 row_mask:0xa bank_mask:0xf
    s_nop 1
    v_add_f32_dpp v61, v61, v61 row_bcast:31 row_mask:0xc bank_mask:0xf
    s_nop 1
    v_add_f32_dpp v62, v62, v62 row_shr:1 row_mask:0xf bank_mask:0xf
    s_nop 1
    v_add_f32_dpp v62, v62, v62 row_shr:2 row_mask:0xf bank_mask:0xf
    s_nop 1
    v_add_f32_dpp v62, v62, v62 row_shr:4 row_mask:0xf bank_mask:0xf
    s_nop 1
    v_add_f32_dpp v62, v62, v62 row_shr:8 row_mask:0xf bank_mask:0xf
    s_nop 1
    v_add_f32_dpp v62, v62, v62 row_bcast:15 row_mask:0xa bank_mask:0xf
    s_nop 1
    v_add_f32_dpp v62, v62, v62 row_bcast:31 row_mask:0xc bank_mask:0xf
    v_lshrrev_b32 v64, 6, v0
    v_lshlrev_b32 v64, 4, v64
    s_mov_b32 exec_lo, 0
    s_brev_b32 exec_hi, 1
    ds_write_b128 v64, v[60:63] offset:8192
    s_mov_b64 exec, -1
    v_and_b32 v64, 15, v0
    v_lshlrev_b32 v64, 4, v64
    s_waitcnt lgkmcnt(0)
    s_barrier
    ds_read_b128 v[60:63], v64 offset:8192
    s_waitcnt lgkmcnt(0)

    s_nop 0
    v_max_u32_dpp v60, v60, v60 row_ror:1 row_mask:0xf bank_mask:0xf
    v_add_f32_dpp v61, v61, v61 row_ror:1 row_mask:0xf bank_mask:0xf
    v_add_f32_dpp v62, v62, v62 row_ror:1 row_mask:0xf bank_mask:0xf

    s_nop 0
    v_max_u32_dpp v60, v60, v60 row_ror:2 row_mask:0xf bank_mask:0xf
    v_add_f32_dpp v61, v61, v61 row_ror:2 row_mask:0xf bank_mask:0xf
    v_add_f32_dpp v62, v62, v62 row_ror:2 row_mask:0xf bank_mask:0xf

    s_nop 0
    v_max_u32_dpp v60, v60, v60 row_ror:4 row_mask:0xf bank_mask:0xf
    v_add_f32_dpp v61, v61, v61 row_ror:4 row_mask:0xf bank_mask:0xf
    v_add_f32_dpp v62, v62, v62 row_ror:4 row_mask:0xf bank_mask:0xf

    s_nop 0
    v_max_u32_dpp v60, v60, v60 row_ror:8 row_mask:0xf bank_mask:0xf
    v_add_f32_dpp v61, v61, v61 row_ror:8 row_mask:0xf bank_mask:0xf
    v_add_f32_dpp v62, v62, v62 row_ror:8 row_mask:0xf bank_mask:0xf

    v_rsq_f32 v62, v62
    v_mov_b32 v65, 0x4b400000
    v_mul_f32 v62, 0x47decb04, v62
    s_nop 0
    v_readfirstlane_b32 s74, v62

    s_add_u32 s92, s6, 135168
    s_addc_u32 s93, s7, 0
    s_mov_b32 s94, 4096
    s_mov_b32 s95, 0x20000
    s_lshl_b32 s3, s2, 4
    buffer_store_dwordx4 v[60:63], v98, s[92:95], s3 offen
    v_lshlrev_b32 v66, 16, v44
    v_and_b32 v44, 0xffff0000, v44
    v_fma_f32 v66, v66, s74, v65
    v_fma_f32 v44, v44, s74, v65
    v_perm_b32 v44, v44, v66, s55

    v_lshlrev_b32 v66, 16, v45
    v_and_b32 v45, 0xffff0000, v45
    v_fma_f32 v66, v66, s74, v65
    v_fma_f32 v45, v45, s74, v65
    v_perm_b32 v45, v45, v66, s55

    v_lshlrev_b32 v66, 16, v46
    v_and_b32 v46, 0xffff0000, v46
    v_fma_f32 v66, v66, s74, v65
    v_fma_f32 v46, v46, s74, v65
    v_perm_b32 v46, v46, v66, s55

    v_lshlrev_b32 v66, 16, v47
    v_and_b32 v47, 0xffff0000, v47
    v_fma_f32 v66, v66, s74, v65
    v_fma_f32 v47, v47, s74, v65
    v_perm_b32 v47, v47, v66, s55

    v_lshlrev_b32 v66, 16, v48
    v_and_b32 v48, 0xffff0000, v48
    v_fma_f32 v66, v66, s74, v65
    v_fma_f32 v48, v48, s74, v65
    v_perm_b32 v48, v48, v66, s55

    v_lshlrev_b32 v66, 16, v49
    v_and_b32 v49, 0xffff0000, v49
    v_fma_f32 v66, v66, s74, v65
    v_fma_f32 v49, v49, s74, v65
    v_perm_b32 v49, v49, v66, s55

    v_lshlrev_b32 v66, 16, v50
    v_and_b32 v50, 0xffff0000, v50
    v_fma_f32 v66, v66, s74, v65
    v_fma_f32 v50, v50, s74, v65
    v_perm_b32 v50, v50, v66, s55

    v_lshlrev_b32 v66, 16, v51
    v_and_b32 v51, 0xffff0000, v51
    v_fma_f32 v66, v66, s74, v65
    v_fma_f32 v51, v51, s74, v65
    v_perm_b32 v51, v51, v66, s55

    v_lshlrev_b32 v66, 16, v52
    v_and_b32 v52, 0xffff0000, v52
    v_fma_f32 v66, v66, s74, v65
    v_fma_f32 v52, v52, s74, v65
    v_perm_b32 v52, v52, v66, s55

    s_add_u32 s92, s6, s54
    s_addc_u32 s93, s7, 0
    s_mov_b32 s94, 24576
    s_mov_b32 s95, 0x20000
    s_movk_i32 s3, 16384
    buffer_store_dwordx4 v[44:47], v1, s[92:95], 0 offen
    buffer_store_dwordx4 v[48:51], v1, s[92:95], s3 offen
    s_mul_i32 s94, s53, 25424
    s_movk_i32 s3, 24576

    buffer_store_dword v52, v100, s[92:95], s3 offen
    s_nop 1
    v_mov_b32 v100, 0
    buffer_atomic_add v100, v98, s[96:99], 0 offen offset:128 sc0
    s_bitcmp0_b32 s82, 0
    s_cbranch_scc1 L_ska_7
    s_waitcnt vmcnt(14)
    v_mul_hi_u32_u24 v45, s40, v20
    v_mul_hi_u32_u24 v44, s40, v4
    v_mul_hi_u32_u24 v47, s40, v21
    v_mul_hi_u32_u24 v46, s40, v5
    v_mul_hi_u32_u24 v49, s40, v22
    v_mul_hi_u32_u24 v48, s40, v6
    v_mul_hi_u32_u24 v51, s40, v23
    v_mul_hi_u32_u24 v50, s40, v7
    v_and_b32 v45, -2, v45
    v_mad_u32_u24 v4, v44, s43, v4
    v_and_b32 v76, -4, v44
    v_and_b32 v47, -2, v47
    v_mad_u32_u24 v5, v46, s43, v5
    v_and_b32 v77, -4, v46
    v_and_b32 v49, -2, v49
    v_mad_u32_u24 v6, v48, s43, v6
    v_and_b32 v78, -4, v48
    v_and_b32 v51, -2, v51
    v_mad_u32_u24 v7, v50, s43, v7
    v_and_b32 v79, -4, v50
    v_mad_i32_i24 v20, v45, s42, v20
    v_lshl_add_u32 v45, v76, 5, v45
    v_mad_i32_i24 v21, v47, s42, v21
    v_lshl_add_u32 v47, v77, 5, v47
    v_mad_i32_i24 v22, v49, s42, v22
    v_lshl_add_u32 v49, v78, 5, v49
    v_mad_i32_i24 v23, v51, s42, v23
    v_lshl_add_u32 v51, v79, 5, v51
    v_add_u32 v45, v45, v45
    ds_add_rtn_u32 v76, v45, v104
    v_add_u32 v47, v47, v47
    ds_add_rtn_u32 v77, v47, v104
    v_add_u32 v49, v49, v49
    ds_add_rtn_u32 v78, v49, v104
    v_add_u32 v51, v51, v51
    ds_add_rtn_u32 v79, v51, v104
    v_lshlrev_b32 v110, 16, v36
    v_and_b32 v111, 0xffff0000, v36
    v_lshlrev_b32 v112, 16, v37
    v_and_b32 v113, 0xffff0000, v37
    v_mul_f32 v110, s44, v110
    v_mul_f32 v111, s44, v111
    v_mul_f32 v112, s44, v112
    v_mul_f32 v113, s44, v113
    v_fract_f32 v110, v110
    v_fract_f32 v111, v111
    v_fract_f32 v112, v112
    v_fract_f32 v113, v113
    v_cos_f32 v110, v110
    v_cos_f32 v111, v111
    v_cos_f32 v112, v112
    v_cos_f32 v113, v113
    v_lshl_or_b32 v44, v44, 14, v20
    v_perm_b32 v45, v45, v4, s46
    v_bfe_u32 v4, v4, 8, 5

    v_lshl_or_b32 v46, v46, 14, v21
    v_perm_b32 v47, v47, v5, s46
    v_bfe_u32 v5, v5, 8, 5

    v_lshl_or_b32 v48, v48, 14, v22
    v_perm_b32 v49, v49, v6, s46
    v_bfe_u32 v6, v6, 8, 5

    v_lshl_or_b32 v50, v50, 14, v23
    v_perm_b32 v51, v51, v7, s46
    v_bfe_u32 v7, v7, 8, 5

    v_fmaak_f32 v110, v110, v105, 0x4b400010
    v_fmaak_f32 v111, v111, v105, 0x4b400010
    v_fmaak_f32 v112, v112, v105, 0x4b400010
    v_fmaak_f32 v113, v113, v105, 0x4b400010
    v_sub_u32 v110, v110, v4
    v_sub_u32 v111, v111, v5
    v_sub_u32 v112, v112, v6
    v_sub_u32 v113, v113, v7
    v_bfi_b32 v110, 31, v4, v110
    v_bfi_b32 v111, 31, v5, v111
    v_bfi_b32 v112, 31, v6, v112
    v_bfi_b32 v113, 31, v7, v113
    v_perm_b32 v44, v44, v110, s55
    v_perm_b32 v46, v46, v111, s55
    v_perm_b32 v48, v48, v112, s55
    v_perm_b32 v50, v50, v113, s55
    buffer_load_dwordx4 v[20:23], v1, s[12:15], s56 offen nt
    buffer_load_dwordx4 v[4:7], v1, s[8:11], s56 offen nt
    buffer_load_dwordx2 v[36:37], v2, s[16:19], s61 offen nt
L_bka_8:
    s_bitcmp0_b32 s82, 1
    s_cbranch_scc1 L_ska_9
    s_waitcnt vmcnt(14)
    v_mul_hi_u32_u24 v53, s40, v24
    v_mul_hi_u32_u24 v52, s40, v8
    v_mul_hi_u32_u24 v55, s40, v25
    v_mul_hi_u32_u24 v54, s40, v9
    v_mul_hi_u32_u24 v57, s40, v26
    v_mul_hi_u32_u24 v56, s40, v10
    v_mul_hi_u32_u24 v59, s40, v27
    v_mul_hi_u32_u24 v58, s40, v11
    v_and_b32 v53, -2, v53
    v_mad_u32_u24 v8, v52, s43, v8
    v_and_b32 v80, -4, v52
    v_and_b32 v55, -2, v55
    v_mad_u32_u24 v9, v54, s43, v9
    v_and_b32 v81, -4, v54
    v_and_b32 v57, -2, v57
    v_mad_u32_u24 v10, v56, s43, v10
    v_and_b32 v82, -4, v56
    v_and_b32 v59, -2, v59
    v_mad_u32_u24 v11, v58, s43, v11
    v_and_b32 v83, -4, v58
    v_mad_i32_i24 v24, v53, s42, v24
    v_lshl_add_u32 v53, v80, 5, v53
    v_mad_i32_i24 v25, v55, s42, v25
    v_lshl_add_u32 v55, v81, 5, v55
    v_mad_i32_i24 v26, v57, s42, v26
    v_lshl_add_u32 v57, v82, 5, v57
    v_mad_i32_i24 v27, v59, s42, v27
    v_lshl_add_u32 v59, v83, 5, v59
    v_add_u32 v53, v53, v53
    ds_add_rtn_u32 v80, v53, v104
    v_add_u32 v55, v55, v55
    ds_add_rtn_u32 v81, v55, v104
    v_add_u32 v57, v57, v57
    ds_add_rtn_u32 v82, v57, v104
    v_add_u32 v59, v59, v59
    ds_add_rtn_u32 v83, v59, v104
    v_lshlrev_b32 v110, 16, v38
    v_and_b32 v111, 0xffff0000, v38
    v_lshlrev_b32 v112, 16, v39
    v_and_b32 v113, 0xffff0000, v39
    v_mul_f32 v110, s44, v110
    v_mul_f32 v111, s44, v111
    v_mul_f32 v112, s44, v112
    v_mul_f32 v113, s44, v113
    v_fract_f32 v110, v110
    v_fract_f32 v111, v111
    v_fract_f32 v112, v112
    v_fract_f32 v113, v113
    v_cos_f32 v110, v110
    v_cos_f32 v111, v111
    v_cos_f32 v112, v112
    v_cos_f32 v113, v113
    v_lshl_or_b32 v52, v52, 14, v24
    v_perm_b32 v53, v53, v8, s46
    v_bfe_u32 v8, v8, 8, 5

    v_lshl_or_b32 v54, v54, 14, v25
    v_perm_b32 v55, v55, v9, s46
    v_bfe_u32 v9, v9, 8, 5

    v_lshl_or_b32 v56, v56, 14, v26
    v_perm_b32 v57, v57, v10, s46
    v_bfe_u32 v10, v10, 8, 5

    v_lshl_or_b32 v58, v58, 14, v27
    v_perm_b32 v59, v59, v11, s46
    v_bfe_u32 v11, v11, 8, 5

    v_fmaak_f32 v110, v110, v105, 0x4b400010
    v_fmaak_f32 v111, v111, v105, 0x4b400010
    v_fmaak_f32 v112, v112, v105, 0x4b400010
    v_fmaak_f32 v113, v113, v105, 0x4b400010
    v_sub_u32 v110, v110, v8
    v_sub_u32 v111, v111, v9
    v_sub_u32 v112, v112, v10
    v_sub_u32 v113, v113, v11
    v_bfi_b32 v110, 31, v8, v110
    v_bfi_b32 v111, 31, v9, v111
    v_bfi_b32 v112, 31, v10, v112
    v_bfi_b32 v113, 31, v11, v113
    v_perm_b32 v52, v52, v110, s55
    v_perm_b32 v54, v54, v111, s55
    v_perm_b32 v56, v56, v112, s55
    v_perm_b32 v58, v58, v113, s55
    buffer_load_dwordx4 v[24:27], v1, s[12:15], s57 offen nt
    buffer_load_dwordx4 v[8:11], v1, s[8:11], s57 offen nt
    buffer_load_dwordx2 v[38:39], v2, s[16:19], s62 offen nt
L_bka_10:
    s_bitcmp0_b32 s82, 2
    s_cbranch_scc1 L_ska_11
    s_waitcnt vmcnt(14)
    v_mul_hi_u32_u24 v61, s40, v28
    v_mul_hi_u32_u24 v60, s40, v12
    v_mul_hi_u32_u24 v63, s40, v29
    v_mul_hi_u32_u24 v62, s40, v13
    v_mul_hi_u32_u24 v65, s40, v30
    v_mul_hi_u32_u24 v64, s40, v14
    v_mul_hi_u32_u24 v67, s40, v31
    v_mul_hi_u32_u24 v66, s40, v15
    v_and_b32 v61, -2, v61
    v_mad_u32_u24 v12, v60, s43, v12
    v_and_b32 v84, -4, v60
    v_and_b32 v63, -2, v63
    v_mad_u32_u24 v13, v62, s43, v13
    v_and_b32 v85, -4, v62
    v_and_b32 v65, -2, v65
    v_mad_u32_u24 v14, v64, s43, v14
    v_and_b32 v86, -4, v64
    v_and_b32 v67, -2, v67
    v_mad_u32_u24 v15, v66, s43, v15
    v_and_b32 v87, -4, v66
    v_mad_i32_i24 v28, v61, s42, v28
    v_lshl_add_u32 v61, v84, 5, v61
    v_mad_i32_i24 v29, v63, s42, v29
    v_lshl_add_u32 v63, v85, 5, v63
    v_mad_i32_i24 v30, v65, s42, v30
    v_lshl_add_u32 v65, v86, 5, v65
    v_mad_i32_i24 v31, v67, s42, v31
    v_lshl_add_u32 v67, v87, 5, v67
    v_add_u32 v61, v61, v61
    ds_add_rtn_u32 v84, v61, v104
    v_add_u32 v63, v63, v63
    ds_add_rtn_u32 v85, v63, v104
    v_add_u32 v65, v65, v65
    ds_add_rtn_u32 v86, v65, v104
    v_add_u32 v67, v67, v67
    ds_add_rtn_u32 v87, v67, v104
    v_lshlrev_b32 v110, 16, v40
    v_and_b32 v111, 0xffff0000, v40
    v_lshlrev_b32 v112, 16, v41
    v_and_b32 v113, 0xffff0000, v41
    v_mul_f32 v110, s44, v110
    v_mul_f32 v111, s44, v111
    v_mul_f32 v112, s44, v112
    v_mul_f32 v113, s44, v113
    v_fract_f32 v110, v110
    v_fract_f32 v111, v111
    v_fract_f32 v112, v112
    v_fract_f32 v113, v113
    v_cos_f32 v110, v110
    v_cos_f32 v111, v111
    v_cos_f32 v112, v112
    v_cos_f32 v113, v113
    v_lshl_or_b32 v60, v60, 14, v28
    v_perm_b32 v61, v61, v12, s46
    v_bfe_u32 v12, v12, 8, 5

    v_lshl_or_b32 v62, v62, 14, v29
    v_perm_b32 v63, v63, v13, s46
    v_bfe_u32 v13, v13, 8, 5

    v_lshl_or_b32 v64, v64, 14, v30
    v_perm_b32 v65, v65, v14, s46
    v_bfe_u32 v14, v14, 8, 5

    v_lshl_or_b32 v66, v66, 14, v31
    v_perm_b32 v67, v67, v15, s46
    v_bfe_u32 v15, v15, 8, 5

    v_fmaak_f32 v110, v110, v105, 0x4b400010
    v_fmaak_f32 v111, v111, v105, 0x4b400010
    v_fmaak_f32 v112, v112, v105, 0x4b400010
    v_fmaak_f32 v113, v113, v105, 0x4b400010
    v_sub_u32 v110, v110, v12
    v_sub_u32 v111, v111, v13
    v_sub_u32 v112, v112, v14
    v_sub_u32 v113, v113, v15
    v_bfi_b32 v110, 31, v12, v110
    v_bfi_b32 v111, 31, v13, v111
    v_bfi_b32 v112, 31, v14, v112
    v_bfi_b32 v113, 31, v15, v113
    v_perm_b32 v60, v60, v110, s55
    v_perm_b32 v62, v62, v111, s55
    v_perm_b32 v64, v64, v112, s55
    v_perm_b32 v66, v66, v113, s55
    buffer_load_dwordx4 v[28:31], v1, s[12:15], s58 offen nt
    buffer_load_dwordx4 v[12:15], v1, s[8:11], s58 offen nt
    buffer_load_dwordx2 v[40:41], v2, s[16:19], s63 offen nt
L_bka_12:
    s_bitcmp0_b32 s82, 3
    s_cbranch_scc1 L_ska_13
    s_waitcnt vmcnt(14)
    s_mov_b64 exec, s[66:67]
    v_mul_hi_u32_u24 v69, s40, v32
    v_mul_hi_u32_u24 v68, s40, v16
    v_mul_hi_u32_u24 v71, s40, v33
    v_mul_hi_u32_u24 v70, s40, v17
    v_mul_hi_u32_u24 v73, s40, v34
    v_mul_hi_u32_u24 v72, s40, v18
    v_mul_hi_u32_u24 v75, s40, v35
    v_mul_hi_u32_u24 v74, s40, v19
    v_and_b32 v69, -2, v69
    v_mad_u32_u24 v16, v68, s43, v16
    v_and_b32 v88, -4, v68
    v_and_b32 v71, -2, v71
    v_mad_u32_u24 v17, v70, s43, v17
    v_and_b32 v89, -4, v70
    v_and_b32 v73, -2, v73
    v_mad_u32_u24 v18, v72, s43, v18
    v_and_b32 v90, -4, v72
    v_and_b32 v75, -2, v75
    v_mad_u32_u24 v19, v74, s43, v19
    v_and_b32 v91, -4, v74
    v_mad_i32_i24 v32, v69, s42, v32
    v_lshl_add_u32 v69, v88, 5, v69
    v_mad_i32_i24 v33, v71, s42, v33
    v_lshl_add_u32 v71, v89, 5, v71
    v_mad_i32_i24 v34, v73, s42, v34
    v_lshl_add_u32 v73, v90, 5, v73
    v_mad_i32_i24 v35, v75, s42, v35
    v_lshl_add_u32 v75, v91, 5, v75
    v_add_u32 v69, v69, v69
    ds_add_rtn_u32 v88, v69, v104
    v_add_u32 v71, v71, v71
    ds_add_rtn_u32 v89, v71, v104
    v_add_u32 v73, v73, v73
    ds_add_rtn_u32 v90, v73, v104
    v_add_u32 v75, v75, v75
    ds_add_rtn_u32 v91, v75, v104
    v_lshlrev_b32 v110, 16, v42
    v_and_b32 v111, 0xffff0000, v42
    v_lshlrev_b32 v112, 16, v43
    v_and_b32 v113, 0xffff0000, v43
    v_mul_f32 v110, s44, v110
    v_mul_f32 v111, s44, v111
    v_mul_f32 v112, s44, v112
    v_mul_f32 v113, s44, v113
    v_fract_f32 v110, v110
    v_fract_f32 v111, v111
    v_fract_f32 v112, v112
    v_fract_f32 v113, v113
    v_cos_f32 v110, v110
    v_cos_f32 v111, v111
    v_cos_f32 v112, v112
    v_cos_f32 v113, v113
    v_lshl_or_b32 v68, v68, 14, v32
    v_perm_b32 v69, v69, v16, s46
    v_bfe_u32 v16, v16, 8, 5

    v_lshl_or_b32 v70, v70, 14, v33
    v_perm_b32 v71, v71, v17, s46
    v_bfe_u32 v17, v17, 8, 5

    v_lshl_or_b32 v72, v72, 14, v34
    v_perm_b32 v73, v73, v18, s46
    v_bfe_u32 v18, v18, 8, 5

    v_lshl_or_b32 v74, v74, 14, v35
    v_perm_b32 v75, v75, v19, s46
    v_bfe_u32 v19, v19, 8, 5

    v_fmaak_f32 v110, v110, v105, 0x4b400010
    v_fmaak_f32 v111, v111, v105, 0x4b400010
    v_fmaak_f32 v112, v112, v105, 0x4b400010
    v_fmaak_f32 v113, v113, v105, 0x4b400010
    v_sub_u32 v110, v110, v16
    v_sub_u32 v111, v111, v17
    v_sub_u32 v112, v112, v18
    v_sub_u32 v113, v113, v19
    v_bfi_b32 v110, 31, v16, v110
    v_bfi_b32 v111, 31, v17, v111
    v_bfi_b32 v112, 31, v18, v112
    v_bfi_b32 v113, 31, v19, v113
    v_perm_b32 v68, v68, v110, s55
    v_perm_b32 v70, v70, v111, s55
    v_perm_b32 v72, v72, v112, s55
    v_perm_b32 v74, v74, v113, s55
    s_mov_b64 exec, -1
    buffer_load_dwordx4 v[32:35], v1, s[12:15], s59 offen nt
    buffer_load_dwordx4 v[16:19], v1, s[8:11], s59 offen nt
    buffer_load_dwordx2 v[42:43], v2, s[16:19], s64 offen nt
L_bka_14:
    v_readfirstlane_b32 s74, v0
    s_nop 1
    s_cmp_lg_u32 s74, 0
    s_cbranch_scc1 L_ready_16

    s_waitcnt vmcnt(12)
    v_readfirstlane_b32 s74, v100
    s_nop 1
    s_cmp_lg_u32 s74, 0
    s_cbranch_scc1 L_ready_16

    v_mov_b32 v110, 1
    buffer_atomic_add v110, v98, s[96:99], 0 offen offset:64 sc0
    s_waitcnt vmcnt(0)
    v_readfirstlane_b32 s74, v110
    s_nop 1
    s_cmp_lg_u32 s74, 0
    s_cbranch_scc1 L_zno_18

    s_mov_b32 s92, s6
    s_mov_b32 s93, s7
    s_mov_b32 s94, 32784
    s_mov_b32 s95, 0x20000
    v_mov_b32 v110, 0
    v_mov_b32 v111, 0
    v_mov_b32 v112, 0
    v_mov_b32 v113, 0
L_zl_17:
    buffer_store_dwordx4 v[110:113], v1, s[92:95], s74 offen sc0 sc1
    s_add_u32 s74, s74, 1024
    s_cmp_le_u32 s74, 32768
    s_cbranch_scc1 L_zl_17
    v_mov_b32 v114, 1
    s_waitcnt vmcnt(0)
    buffer_atomic_add v114, v98, s[96:99], 0 offen offset:128
L_zno_18:

L_spin_15:
    v_mov_b32 v100, 0
    buffer_atomic_add v100, v98, s[96:99], 0 offen offset:128 sc0
    s_waitcnt vmcnt(0)
    v_readfirstlane_b32 s74, v100
    s_nop 1
    s_cmp_eq_u32 s74, 0
    s_cbranch_scc1 L_spin_15
L_ready_16:

    s_waitcnt lgkmcnt(0)
    s_barrier

    ds_read_b64 v[94:95], v2
    s_waitcnt lgkmcnt(0)
    v_and_b32 v94, 0xffff, v94
    v_and_b32 v95, 0xffff, v95
    v_add_u32 v97, v94, v95
    s_nop 1
    v_add_u32_dpp v97, v97, v97 row_shr:1 row_mask:0xf bank_mask:0xf
    s_nop 1
    v_add_u32_dpp v97, v97, v97 row_shr:2 row_mask:0xf bank_mask:0xf
    s_nop 1
    v_add_u32_dpp v97, v97, v97 row_shr:4 row_mask:0xf bank_mask:0xf
    s_nop 1
    v_add_u32_dpp v97, v97, v97 row_shr:8 row_mask:0xf bank_mask:0xf
    s_nop 1
    v_add_u32_dpp v97, v97, v97 row_bcast:15 row_mask:0xa bank_mask:0xf
    s_nop 1
    v_add_u32_dpp v97, v97, v97 row_bcast:31 row_mask:0xc bank_mask:0xf
    s_mov_b32 exec_lo, 0
    s_brev_b32 exec_hi, 1
    ds_add_rtn_u32 v96, v108, v97
    s_mov_b64 exec, -1

    v_add_u32 v92, v94, v94
    v_add_u32 v93, v95, v95
    v_med3_u32 v92, v94, 2, v92
    v_med3_u32 v93, v95, 2, v93
    v_lshl_or_b32 v92, v93, 16, v92
    v_lshlrev_b32 v93, 2, v0
    buffer_atomic_add v92, v93, s[20:23], 0 offen sc0
    s_waitcnt lgkmcnt(0)
    v_readlane_b32 s77, v96, 63
    v_mul_u32_u24 v114, 65528, v0
    v_sub_u32 v97, v97, v95
    s_sub_u32 s50, s50, s83
    s_sub_u32 s77, s77, s50
    v_add_u32 v97, s77, v97
    v_sub_u32 v96, v97, v94
    v_lshlrev_b32 v111, 16, v97
    v_lshlrev_b32 v110, 16, v96
    ds_write_b64 v2, v[110:111]
    v_mad_i32_i24 v96, v96, -5, v114
    v_mad_i32_i24 v97, v97, -5, v114
    v_add_u32 v97, 32764, v97
    s_add_u32 s50, s50, s84
    s_mov_b32 s28, s82
    s_mov_b32 s29, s83
    s_mov_b32 s30, s84
    s_lshl_b32 s74, s29, 3
    s_lshl_b32 s75, s30, 3
    v_mov_b32 v125, s74
    v_mov_b32 v126, s75
    v_mov_b32 v127, -1

    s_waitcnt lgkmcnt(0)
    s_barrier

    s_mov_b64 exec, 1
    ds_write_b32 v125, v127 offset:16396
    ds_write_b32 v126, v127 offset:16404
    s_mov_b64 exec, -1

    s_bitcmp0_b32 s28, 0
    s_cbranch_scc1 L_skz_19
    v_lshrrev_b32 v110, 16, v45
    ds_read_b32 v110, v110
    v_lshrrev_b32 v111, 16, v47
    ds_read_b32 v111, v111
    v_lshrrev_b32 v112, 16, v49
    ds_read_b32 v112, v112
    v_lshrrev_b32 v113, 16, v51
    ds_read_b32 v113, v113
    s_waitcnt lgkmcnt(3)
    v_add_u32_sdwa v110, v110, v76 dst_sel:DWORD dst_unused:UNUSED_PAD src0_sel:WORD_1 src1_sel:WORD_0
    v_lshlrev_b32 v110, 3, v110
    ds_write_b64 v110, v[44:45] offset:16400

    s_waitcnt lgkmcnt(3)
    v_add_u32_sdwa v111, v111, v77 dst_sel:DWORD dst_unused:UNUSED_PAD src0_sel:WORD_1 src1_sel:WORD_0
    v_lshlrev_b32 v111, 3, v111
    ds_write_b64 v111, v[46:47] offset:16400

    s_waitcnt lgkmcnt(3)
    v_add_u32_sdwa v112, v112, v78 dst_sel:DWORD dst_unused:UNUSED_PAD src0_sel:WORD_1 src1_sel:WORD_0
    v_lshlrev_b32 v112, 3, v112
    ds_write_b64 v112, v[48:49] offset:16400

    s_waitcnt lgkmcnt(3)
    v_add_u32_sdwa v113, v113, v79 dst_sel:DWORD dst_unused:UNUSED_PAD src0_sel:WORD_1 src1_sel:WORD_0
    v_lshlrev_b32 v113, 3, v113
    ds_write_b64 v113, v[50:51] offset:16400

L_skz_19:
    s_bitcmp0_b32 s28, 1
    s_cbranch_scc1 L_skz_20
    v_lshrrev_b32 v110, 16, v53
    ds_read_b32 v110, v110
    v_lshrrev_b32 v111, 16, v55
    ds_read_b32 v111, v111
    v_lshrrev_b32 v112, 16, v57
    ds_read_b32 v112, v112
    v_lshrrev_b32 v113, 16, v59
    ds_read_b32 v113, v113
    s_waitcnt lgkmcnt(3)
    v_add_u32_sdwa v110, v110, v80 dst_sel:DWORD dst_unused:UNUSED_PAD src0_sel:WORD_1 src1_sel:WORD_0
    v_lshlrev_b32 v110, 3, v110
    ds_write_b64 v110, v[52:53] offset:16400

    s_waitcnt lgkmcnt(3)
    v_add_u32_sdwa v111, v111, v81 dst_sel:DWORD dst_unused:UNUSED_PAD src0_sel:WORD_1 src1_sel:WORD_0
    v_lshlrev_b32 v111, 3, v111
    ds_write_b64 v111, v[54:55] offset:16400

    s_waitcnt lgkmcnt(3)
    v_add_u32_sdwa v112, v112, v82 dst_sel:DWORD dst_unused:UNUSED_PAD src0_sel:WORD_1 src1_sel:WORD_0
    v_lshlrev_b32 v112, 3, v112
    ds_write_b64 v112, v[56:57] offset:16400

    s_waitcnt lgkmcnt(3)
    v_add_u32_sdwa v113, v113, v83 dst_sel:DWORD dst_unused:UNUSED_PAD src0_sel:WORD_1 src1_sel:WORD_0
    v_lshlrev_b32 v113, 3, v113
    ds_write_b64 v113, v[58:59] offset:16400

L_skz_20:
    s_bitcmp0_b32 s28, 2
    s_cbranch_scc1 L_skz_21
    v_lshrrev_b32 v110, 16, v61
    ds_read_b32 v110, v110
    v_lshrrev_b32 v111, 16, v63
    ds_read_b32 v111, v111
    v_lshrrev_b32 v112, 16, v65
    ds_read_b32 v112, v112
    v_lshrrev_b32 v113, 16, v67
    ds_read_b32 v113, v113
    s_waitcnt lgkmcnt(3)
    v_add_u32_sdwa v110, v110, v84 dst_sel:DWORD dst_unused:UNUSED_PAD src0_sel:WORD_1 src1_sel:WORD_0
    v_lshlrev_b32 v110, 3, v110
    ds_write_b64 v110, v[60:61] offset:16400

    s_waitcnt lgkmcnt(3)
    v_add_u32_sdwa v111, v111, v85 dst_sel:DWORD dst_unused:UNUSED_PAD src0_sel:WORD_1 src1_sel:WORD_0
    v_lshlrev_b32 v111, 3, v111
    ds_write_b64 v111, v[62:63] offset:16400

    s_waitcnt lgkmcnt(3)
    v_add_u32_sdwa v112, v112, v86 dst_sel:DWORD dst_unused:UNUSED_PAD src0_sel:WORD_1 src1_sel:WORD_0
    v_lshlrev_b32 v112, 3, v112
    ds_write_b64 v112, v[64:65] offset:16400

    s_waitcnt lgkmcnt(3)
    v_add_u32_sdwa v113, v113, v87 dst_sel:DWORD dst_unused:UNUSED_PAD src0_sel:WORD_1 src1_sel:WORD_0
    v_lshlrev_b32 v113, 3, v113
    ds_write_b64 v113, v[66:67] offset:16400

L_skz_21:
    s_bitcmp0_b32 s28, 3
    s_cbranch_scc1 L_skz_22
    s_mov_b64 exec, s[66:67]
    v_lshrrev_b32 v110, 16, v69
    ds_read_b32 v110, v110
    v_lshrrev_b32 v111, 16, v71
    ds_read_b32 v111, v111
    v_lshrrev_b32 v112, 16, v73
    ds_read_b32 v112, v112
    v_lshrrev_b32 v113, 16, v75
    ds_read_b32 v113, v113
    s_waitcnt lgkmcnt(3)
    v_add_u32_sdwa v110, v110, v88 dst_sel:DWORD dst_unused:UNUSED_PAD src0_sel:WORD_1 src1_sel:WORD_0
    v_lshlrev_b32 v110, 3, v110
    ds_write_b64 v110, v[68:69] offset:16400

    s_waitcnt lgkmcnt(3)
    v_add_u32_sdwa v111, v111, v89 dst_sel:DWORD dst_unused:UNUSED_PAD src0_sel:WORD_1 src1_sel:WORD_0
    v_lshlrev_b32 v111, 3, v111
    ds_write_b64 v111, v[70:71] offset:16400

    s_waitcnt lgkmcnt(3)
    v_add_u32_sdwa v112, v112, v90 dst_sel:DWORD dst_unused:UNUSED_PAD src0_sel:WORD_1 src1_sel:WORD_0
    v_lshlrev_b32 v112, 3, v112
    ds_write_b64 v112, v[72:73] offset:16400

    s_waitcnt lgkmcnt(3)
    v_add_u32_sdwa v113, v113, v91 dst_sel:DWORD dst_unused:UNUSED_PAD src0_sel:WORD_1 src1_sel:WORD_0
    v_lshlrev_b32 v113, 3, v113
    ds_write_b64 v113, v[74:75] offset:16400

    s_mov_b64 exec, -1
L_skz_22:
    s_cmp_eq_u32 s49, 0
    s_cbranch_scc1 L_p1epi_6
L_p1loop_5:
    s_mov_b32 s82, s85
    s_mov_b32 s83, s86
    s_mov_b32 s84, s87
    v_mov_b32 v99, 1
    buffer_atomic_add v99, v98, s[96:99], 0 offen sc0
    s_bitcmp0_b32 s82, 0
    s_cbranch_scc1 L_ska_23
    s_waitcnt vmcnt(11)
    v_mul_hi_u32_u24 v45, s40, v20
    v_mul_hi_u32_u24 v44, s40, v4
    v_mul_hi_u32_u24 v47, s40, v21
    v_mul_hi_u32_u24 v46, s40, v5
    v_mul_hi_u32_u24 v49, s40, v22
    v_mul_hi_u32_u24 v48, s40, v6
    v_mul_hi_u32_u24 v51, s40, v23
    v_mul_hi_u32_u24 v50, s40, v7
    v_and_b32 v45, -2, v45
    v_mad_u32_u24 v4, v44, s43, v4
    v_and_b32 v76, -4, v44
    v_and_b32 v47, -2, v47
    v_mad_u32_u24 v5, v46, s43, v5
    v_and_b32 v77, -4, v46
    v_and_b32 v49, -2, v49
    v_mad_u32_u24 v6, v48, s43, v6
    v_and_b32 v78, -4, v48
    v_and_b32 v51, -2, v51
    v_mad_u32_u24 v7, v50, s43, v7
    v_and_b32 v79, -4, v50
    v_mad_i32_i24 v20, v45, s42, v20
    v_lshl_add_u32 v45, v76, 5, v45
    v_mad_i32_i24 v21, v47, s42, v21
    v_lshl_add_u32 v47, v77, 5, v47
    v_mad_i32_i24 v22, v49, s42, v22
    v_lshl_add_u32 v49, v78, 5, v49
    v_mad_i32_i24 v23, v51, s42, v23
    v_lshl_add_u32 v51, v79, 5, v51
    v_add_u32 v45, v45, v45
    ds_add_rtn_u32 v76, v45, v104
    v_add_u32 v47, v47, v47
    ds_add_rtn_u32 v77, v47, v104
    v_add_u32 v49, v49, v49
    ds_add_rtn_u32 v78, v49, v104
    v_add_u32 v51, v51, v51
    ds_add_rtn_u32 v79, v51, v104
    v_lshlrev_b32 v110, 16, v36
    v_and_b32 v111, 0xffff0000, v36
    v_lshlrev_b32 v112, 16, v37
    v_and_b32 v113, 0xffff0000, v37
    v_mul_f32 v110, s44, v110
    v_mul_f32 v111, s44, v111
    v_mul_f32 v112, s44, v112
    v_mul_f32 v113, s44, v113
    v_fract_f32 v110, v110
    v_fract_f32 v111, v111
    v_fract_f32 v112, v112
    v_fract_f32 v113, v113
    v_cos_f32 v110, v110
    v_cos_f32 v111, v111
    v_cos_f32 v112, v112
    v_cos_f32 v113, v113
    v_lshl_or_b32 v44, v44, 14, v20
    v_perm_b32 v45, v45, v4, s46
    v_bfe_u32 v4, v4, 8, 5

    v_lshl_or_b32 v46, v46, 14, v21
    v_perm_b32 v47, v47, v5, s46
    v_bfe_u32 v5, v5, 8, 5

    v_lshl_or_b32 v48, v48, 14, v22
    v_perm_b32 v49, v49, v6, s46
    v_bfe_u32 v6, v6, 8, 5

    v_lshl_or_b32 v50, v50, 14, v23
    v_perm_b32 v51, v51, v7, s46
    v_bfe_u32 v7, v7, 8, 5

    v_fmaak_f32 v110, v110, v105, 0x4b400010
    v_fmaak_f32 v111, v111, v105, 0x4b400010
    v_fmaak_f32 v112, v112, v105, 0x4b400010
    v_fmaak_f32 v113, v113, v105, 0x4b400010
    v_sub_u32 v110, v110, v4
    v_sub_u32 v111, v111, v5
    v_sub_u32 v112, v112, v6
    v_sub_u32 v113, v113, v7
    v_bfi_b32 v110, 31, v4, v110
    v_bfi_b32 v111, 31, v5, v111
    v_bfi_b32 v112, 31, v6, v112
    v_bfi_b32 v113, 31, v7, v113
    v_perm_b32 v44, v44, v110, s55
    v_perm_b32 v46, v46, v111, s55
    v_perm_b32 v48, v48, v112, s55
    v_perm_b32 v50, v50, v113, s55
L_ska_23:
    s_bitcmp0_b32 s82, 1
    s_cbranch_scc1 L_ska_24
    s_waitcnt vmcnt(8)
    v_mul_hi_u32_u24 v53, s40, v24
    v_mul_hi_u32_u24 v52, s40, v8
    v_mul_hi_u32_u24 v55, s40, v25
    v_mul_hi_u32_u24 v54, s40, v9
    v_mul_hi_u32_u24 v57, s40, v26
    v_mul_hi_u32_u24 v56, s40, v10
    v_mul_hi_u32_u24 v59, s40, v27
    v_mul_hi_u32_u24 v58, s40, v11
    v_and_b32 v53, -2, v53
    v_mad_u32_u24 v8, v52, s43, v8
    v_and_b32 v80, -4, v52
    v_and_b32 v55, -2, v55
    v_mad_u32_u24 v9, v54, s43, v9
    v_and_b32 v81, -4, v54
    v_and_b32 v57, -2, v57
    v_mad_u32_u24 v10, v56, s43, v10
    v_and_b32 v82, -4, v56
    v_and_b32 v59, -2, v59
    v_mad_u32_u24 v11, v58, s43, v11
    v_and_b32 v83, -4, v58
    v_mad_i32_i24 v24, v53, s42, v24
    v_lshl_add_u32 v53, v80, 5, v53
    v_mad_i32_i24 v25, v55, s42, v25
    v_lshl_add_u32 v55, v81, 5, v55
    v_mad_i32_i24 v26, v57, s42, v26
    v_lshl_add_u32 v57, v82, 5, v57
    v_mad_i32_i24 v27, v59, s42, v27
    v_lshl_add_u32 v59, v83, 5, v59
    v_add_u32 v53, v53, v53
    ds_add_rtn_u32 v80, v53, v104
    v_add_u32 v55, v55, v55
    ds_add_rtn_u32 v81, v55, v104
    v_add_u32 v57, v57, v57
    ds_add_rtn_u32 v82, v57, v104
    v_add_u32 v59, v59, v59
    ds_add_rtn_u32 v83, v59, v104
    v_lshlrev_b32 v110, 16, v38
    v_and_b32 v111, 0xffff0000, v38
    v_lshlrev_b32 v112, 16, v39
    v_and_b32 v113, 0xffff0000, v39
    v_mul_f32 v110, s44, v110
    v_mul_f32 v111, s44, v111
    v_mul_f32 v112, s44, v112
    v_mul_f32 v113, s44, v113
    v_fract_f32 v110, v110
    v_fract_f32 v111, v111
    v_fract_f32 v112, v112
    v_fract_f32 v113, v113
    v_cos_f32 v110, v110
    v_cos_f32 v111, v111
    v_cos_f32 v112, v112
    v_cos_f32 v113, v113
    v_lshl_or_b32 v52, v52, 14, v24
    v_perm_b32 v53, v53, v8, s46
    v_bfe_u32 v8, v8, 8, 5

    v_lshl_or_b32 v54, v54, 14, v25
    v_perm_b32 v55, v55, v9, s46
    v_bfe_u32 v9, v9, 8, 5

    v_lshl_or_b32 v56, v56, 14, v26
    v_perm_b32 v57, v57, v10, s46
    v_bfe_u32 v10, v10, 8, 5

    v_lshl_or_b32 v58, v58, 14, v27
    v_perm_b32 v59, v59, v11, s46
    v_bfe_u32 v11, v11, 8, 5

    v_fmaak_f32 v110, v110, v105, 0x4b400010
    v_fmaak_f32 v111, v111, v105, 0x4b400010
    v_fmaak_f32 v112, v112, v105, 0x4b400010
    v_fmaak_f32 v113, v113, v105, 0x4b400010
    v_sub_u32 v110, v110, v8
    v_sub_u32 v111, v111, v9
    v_sub_u32 v112, v112, v10
    v_sub_u32 v113, v113, v11
    v_bfi_b32 v110, 31, v8, v110
    v_bfi_b32 v111, 31, v9, v111
    v_bfi_b32 v112, 31, v10, v112
    v_bfi_b32 v113, 31, v11, v113
    v_perm_b32 v52, v52, v110, s55
    v_perm_b32 v54, v54, v111, s55
    v_perm_b32 v56, v56, v112, s55
    v_perm_b32 v58, v58, v113, s55
L_ska_24:
    s_waitcnt vmcnt(1)
    s_waitcnt vmcnt(0)
    v_cmp_eq_u32 vcc, 0, v0
    s_mov_b64 exec, vcc
    ds_write_b32 v108, v99 offset:8
    s_mov_b64 exec, -1
    s_waitcnt vmcnt(1)
    v_lshrrev_b32 v93, 16, v92
    v_and_b32 v92, 0xffff, v92
    v_add_u32 v110, v92, v94
    v_mad_u32_u24 v92, v92, 5, v96
    v_add_u32 v111, v93, v95
    v_mad_u32_u24 v93, v93, 5, v97
    v_max_u32 v110, v110, v111
    v_cmp_le_u32 vcc, s48, v110
    s_cbranch_vccnz L_full_25
L_fback_26:
    ds_write_b64 v2, v[92:93] offset:8192

    s_waitcnt lgkmcnt(0)
    s_barrier
    ds_read_b32 v111, v108 offset:8
    s_waitcnt lgkmcnt(0)
    v_readfirstlane_b32 s41, v111
    s_nop 1

    s_add_u32 s41, s41, 416
    s_sub_u32 s78, s41, 3061
    s_lshr_b32 s79, s78, 1
    s_add_u32 s79, s79, 3061
    s_and_b32 s86, s78, 1
    s_lshl_b32 s86, s86, 1
    s_add_u32 s87, s86, 2
    s_cmp_lt_u32 s41, 3061
    s_cselect_b32 s41, s41, s79
    s_cmovk_i32 s86, 0
    s_cmovk_i32 s87, 4

    s_mul_i32 s78, s41, 16384
    s_add_u32 s49, s78, 16384
    s_cmp_ge_u32 s41, 3125
    s_cmovk_i32 s49, 0
    s_cmovk_i32 s78, 0
    s_lshl_b32 s10, s49, 2
    s_lshl_b32 s14, s49, 2
    s_lshl_b32 s18, s49, 1
    s_sub_u32 s79, s87, s86
    s_bfm_b32 s85, s79, s86
    s_lshl_b32 s86, s86, 12
    s_lshl_b32 s87, s87, 12
    s_min_u32 s87, s87, 16384

    s_add_u32 s79, s78, 0
    s_bitcmp1_b32 s85, 0
    s_cselect_b32 s79, s79, 0x1ff00000
    s_lshl_b32 s56, s79, 2
    s_lshl_b32 s61, s79, 1

    s_add_u32 s79, s78, 4096
    s_bitcmp1_b32 s85, 1
    s_cselect_b32 s79, s79, 0x1ff00000
    s_lshl_b32 s57, s79, 2
    s_lshl_b32 s62, s79, 1

    s_add_u32 s79, s78, 8192
    s_bitcmp1_b32 s85, 2
    s_cselect_b32 s79, s79, 0x1ff00000
    s_lshl_b32 s58, s79, 2
    s_lshl_b32 s63, s79, 1

    s_add_u32 s79, s78, 12288
    s_bitcmp1_b32 s85, 3
    s_cselect_b32 s79, s79, 0x1ff00000
    s_lshl_b32 s59, s79, 2
    s_lshl_b32 s64, s79, 1

    s_bitcmp0_b32 s28, 0
    s_cbranch_scc1 L_skw_27
    ds_read_b64 v[110:111], v2 offset:16400
    ds_read_b64 v[112:113], v2 offset:16408
    ds_read_b64 v[114:115], v2 offset:16392

    ds_read_b64 v[118:119], v2 offset:24592
    ds_read_b64 v[120:121], v2 offset:24600
    ds_read_b64 v[122:123], v2 offset:24584

    s_waitcnt lgkmcnt(3)
    v_lshrrev_b32 v116, 16, v111
    ds_read_b32 v116, v116 offset:8192

    s_waitcnt lgkmcnt(1)
    v_lshrrev_b32 v124, 16, v119
    ds_read_b32 v124, v124 offset:8192

    v_cmp_ne_u32_sdwa s[80:81], v111, v113 src0_sel:WORD_1 src1_sel:WORD_1
    v_cmp_ne_u32_sdwa vcc, v111, v115 src0_sel:WORD_1 src1_sel:WORD_1
    v_alignbyte_b32 v114, v115, v114, 2
    s_mov_b32 s54, -3
    v_alignbyte_b32 v111, v111, v110, 1
    v_perm_b32 v110, v110, v114, s47
    s_waitcnt lgkmcnt(1)
    v_add3_u32 v116, v116, v106, s54
    v_sub_u32 v117, 0, v116
    v_and_b32 v117, 3, v117
    s_mov_b64 exec, s[80:81]
    v_mov_b32 v117, 0
    v_mov_b32 v112, 0
    s_mov_b64 exec, vcc
    v_mov_b32 v117, 3

    s_mov_b64 exec, -1
    v_alignbyte_b32 v110, v111, v110, v117
    v_alignbyte_b32 v111, v112, v111, v117
    v_add_u32 v116, v116, v117

    buffer_store_dwordx2 v[110:111], v116, s[24:27], 0 offen
    v_cmp_ne_u32_sdwa s[80:81], v119, v121 src0_sel:WORD_1 src1_sel:WORD_1
    v_cmp_ne_u32_sdwa vcc, v119, v123 src0_sel:WORD_1 src1_sel:WORD_1
    v_alignbyte_b32 v122, v123, v122, 2
    s_mov_b32 s54, 5117
    v_alignbyte_b32 v119, v119, v118, 1
    v_perm_b32 v118, v118, v122, s47
    s_waitcnt lgkmcnt(0)
    v_add3_u32 v124, v124, v106, s54
    v_sub_u32 v125, 0, v124
    v_and_b32 v125, 3, v125
    s_mov_b64 exec, s[80:81]
    v_mov_b32 v125, 0
    v_mov_b32 v120, 0
    s_mov_b64 exec, vcc
    v_mov_b32 v125, 3

    s_mov_b64 exec, -1
    v_alignbyte_b32 v118, v119, v118, v125
    v_alignbyte_b32 v119, v120, v119, v125
    v_add_u32 v124, v124, v125

    buffer_store_dwordx2 v[118:119], v124, s[24:27], 0 offen
L_skw_27:
    s_bitcmp0_b32 s28, 0
    s_cbranch_scc1 L_skw_28
    ds_read_b64 v[110:111], v2 offset:32784
    ds_read_b64 v[112:113], v2 offset:32792
    ds_read_b64 v[114:115], v2 offset:32776

    ds_read_b64 v[118:119], v2 offset:40976
    ds_read_b64 v[120:121], v2 offset:40984
    ds_read_b64 v[122:123], v2 offset:40968

    s_waitcnt lgkmcnt(3)
    v_lshrrev_b32 v116, 16, v111
    ds_read_b32 v116, v116 offset:8192

    s_waitcnt lgkmcnt(1)
    v_lshrrev_b32 v124, 16, v119
    ds_read_b32 v124, v124 offset:8192

    v_cmp_ne_u32_sdwa s[80:81], v111, v113 src0_sel:WORD_1 src1_sel:WORD_1
    v_cmp_ne_u32_sdwa vcc, v111, v115 src0_sel:WORD_1 src1_sel:WORD_1
    v_alignbyte_b32 v114, v115, v114, 2
    s_mov_b32 s54, 10237
    v_alignbyte_b32 v111, v111, v110, 1
    v_perm_b32 v110, v110, v114, s47
    s_waitcnt lgkmcnt(1)
    v_add3_u32 v116, v116, v106, s54
    v_sub_u32 v117, 0, v116
    v_and_b32 v117, 3, v117
    s_mov_b64 exec, s[80:81]
    v_mov_b32 v117, 0
    v_mov_b32 v112, 0
    s_mov_b64 exec, vcc
    v_mov_b32 v117, 3

    s_mov_b64 exec, -1
    v_alignbyte_b32 v110, v111, v110, v117
    v_alignbyte_b32 v111, v112, v111, v117
    v_add_u32 v116, v116, v117

    buffer_store_dwordx2 v[110:111], v116, s[24:27], 0 offen
    v_cmp_ne_u32_sdwa s[80:81], v119, v121 src0_sel:WORD_1 src1_sel:WORD_1
    v_cmp_ne_u32_sdwa vcc, v119, v123 src0_sel:WORD_1 src1_sel:WORD_1
    v_alignbyte_b32 v122, v123, v122, 2
    s_mov_b32 s54, 15357
    v_alignbyte_b32 v119, v119, v118, 1
    v_perm_b32 v118, v118, v122, s47
    s_waitcnt lgkmcnt(0)
    v_add3_u32 v124, v124, v106, s54
    v_sub_u32 v125, 0, v124
    v_and_b32 v125, 3, v125
    s_mov_b64 exec, s[80:81]
    v_mov_b32 v125, 0
    v_mov_b32 v120, 0
    s_mov_b64 exec, vcc
    v_mov_b32 v125, 3

    s_mov_b64 exec, -1
    v_alignbyte_b32 v118, v119, v118, v125
    v_alignbyte_b32 v119, v120, v119, v125
    v_add_u32 v124, v124, v125

    buffer_store_dwordx2 v[118:119], v124, s[24:27], 0 offen
L_skw_28:
    s_bitcmp0_b32 s82, 2
    s_cbranch_scc1 L_ska_29
    v_mul_hi_u32_u24 v61, s40, v28
    v_mul_hi_u32_u24 v60, s40, v12
    v_mul_hi_u32_u24 v63, s40, v29
    v_mul_hi_u32_u24 v62, s40, v13
    v_mul_hi_u32_u24 v65, s40, v30
    v_mul_hi_u32_u24 v64, s40, v14
    v_mul_hi_u32_u24 v67, s40, v31
    v_mul_hi_u32_u24 v66, s40, v15
    v_and_b32 v61, -2, v61
    v_mad_u32_u24 v12, v60, s43, v12
    v_and_b32 v84, -4, v60
    v_and_b32 v63, -2, v63
    v_mad_u32_u24 v13, v62, s43, v13
    v_and_b32 v85, -4, v62
    v_and_b32 v65, -2, v65
    v_mad_u32_u24 v14, v64, s43, v14
    v_and_b32 v86, -4, v64
    v_and_b32 v67, -2, v67
    v_mad_u32_u24 v15, v66, s43, v15
    v_and_b32 v87, -4, v66
    v_mad_i32_i24 v28, v61, s42, v28
    v_lshl_add_u32 v61, v84, 5, v61
    v_mad_i32_i24 v29, v63, s42, v29
    v_lshl_add_u32 v63, v85, 5, v63
    v_mad_i32_i24 v30, v65, s42, v30
    v_lshl_add_u32 v65, v86, 5, v65
    v_mad_i32_i24 v31, v67, s42, v31
    v_lshl_add_u32 v67, v87, 5, v67
    v_add_u32 v61, v61, v61
    ds_add_rtn_u32 v84, v61, v104
    v_add_u32 v63, v63, v63
    ds_add_rtn_u32 v85, v63, v104
    v_add_u32 v65, v65, v65
    ds_add_rtn_u32 v86, v65, v104
    v_add_u32 v67, v67, v67
    ds_add_rtn_u32 v87, v67, v104
    v_lshlrev_b32 v110, 16, v40
    v_and_b32 v111, 0xffff0000, v40
    v_lshlrev_b32 v112, 16, v41
    v_and_b32 v113, 0xffff0000, v41
    v_mul_f32 v110, s44, v110
    v_mul_f32 v111, s44, v111
    v_mul_f32 v112, s44, v112
    v_mul_f32 v113, s44, v113
    v_fract_f32 v110, v110
    v_fract_f32 v111, v111
    v_fract_f32 v112, v112
    v_fract_f32 v113, v113
    v_cos_f32 v110, v110
    v_cos_f32 v111, v111
    v_cos_f32 v112, v112
    v_cos_f32 v113, v113
    v_lshl_or_b32 v60, v60, 14, v28
    v_perm_b32 v61, v61, v12, s46
    v_bfe_u32 v12, v12, 8, 5

    v_lshl_or_b32 v62, v62, 14, v29
    v_perm_b32 v63, v63, v13, s46
    v_bfe_u32 v13, v13, 8, 5

    v_lshl_or_b32 v64, v64, 14, v30
    v_perm_b32 v65, v65, v14, s46
    v_bfe_u32 v14, v14, 8, 5

    v_lshl_or_b32 v66, v66, 14, v31
    v_perm_b32 v67, v67, v15, s46
    v_bfe_u32 v15, v15, 8, 5

    v_fmaak_f32 v110, v110, v105, 0x4b400010
    v_fmaak_f32 v111, v111, v105, 0x4b400010
    v_fmaak_f32 v112, v112, v105, 0x4b400010
    v_fmaak_f32 v113, v113, v105, 0x4b400010
    v_sub_u32 v110, v110, v12
    v_sub_u32 v111, v111, v13
    v_sub_u32 v112, v112, v14
    v_sub_u32 v113, v113, v15
    v_bfi_b32 v110, 31, v12, v110
    v_bfi_b32 v111, 31, v13, v111
    v_bfi_b32 v112, 31, v14, v112
    v_bfi_b32 v113, 31, v15, v113
    v_perm_b32 v60, v60, v110, s55
    v_perm_b32 v62, v62, v111, s55
    v_perm_b32 v64, v64, v112, s55
    v_perm_b32 v66, v66, v113, s55
L_ska_29:
    s_bitcmp0_b32 s28, 1
    s_cbranch_scc1 L_skw_30
    v_add_u32 v107, 32768, v2
    ds_read_b64 v[110:111], v107 offset:16400
    ds_read_b64 v[112:113], v107 offset:16408
    ds_read_b64 v[114:115], v107 offset:16392

    ds_read_b64 v[118:119], v107 offset:24592
    ds_read_b64 v[120:121], v107 offset:24600
    ds_read_b64 v[122:123], v107 offset:24584

    s_waitcnt lgkmcnt(3)
    v_lshrrev_b32 v116, 16, v111
    ds_read_b32 v116, v116 offset:8192

    s_waitcnt lgkmcnt(1)
    v_lshrrev_b32 v124, 16, v119
    ds_read_b32 v124, v124 offset:8192

    v_cmp_ne_u32_sdwa s[80:81], v111, v113 src0_sel:WORD_1 src1_sel:WORD_1
    v_cmp_ne_u32_sdwa vcc, v111, v115 src0_sel:WORD_1 src1_sel:WORD_1
    v_alignbyte_b32 v114, v115, v114, 2
    s_mov_b32 s54, 20477
    v_alignbyte_b32 v111, v111, v110, 1
    v_perm_b32 v110, v110, v114, s47
    s_waitcnt lgkmcnt(1)
    v_add3_u32 v116, v116, v106, s54
    v_sub_u32 v117, 0, v116
    v_and_b32 v117, 3, v117
    s_mov_b64 exec, s[80:81]
    v_mov_b32 v117, 0
    v_mov_b32 v112, 0
    s_mov_b64 exec, vcc
    v_mov_b32 v117, 3

    s_mov_b64 exec, -1
    v_alignbyte_b32 v110, v111, v110, v117
    v_alignbyte_b32 v111, v112, v111, v117
    v_add_u32 v116, v116, v117

    buffer_store_dwordx2 v[110:111], v116, s[24:27], 0 offen
    v_cmp_ne_u32_sdwa s[80:81], v119, v121 src0_sel:WORD_1 src1_sel:WORD_1
    v_cmp_ne_u32_sdwa vcc, v119, v123 src0_sel:WORD_1 src1_sel:WORD_1
    v_alignbyte_b32 v122, v123, v122, 2
    s_mov_b32 s54, 25597
    v_alignbyte_b32 v119, v119, v118, 1
    v_perm_b32 v118, v118, v122, s47
    s_waitcnt lgkmcnt(0)
    v_add3_u32 v124, v124, v106, s54
    v_sub_u32 v125, 0, v124
    v_and_b32 v125, 3, v125
    s_mov_b64 exec, s[80:81]
    v_mov_b32 v125, 0
    v_mov_b32 v120, 0
    s_mov_b64 exec, vcc
    v_mov_b32 v125, 3

    s_mov_b64 exec, -1
    v_alignbyte_b32 v118, v119, v118, v125
    v_alignbyte_b32 v119, v120, v119, v125
    v_add_u32 v124, v124, v125

    buffer_store_dwordx2 v[118:119], v124, s[24:27], 0 offen
L_skw_30:
    s_bitcmp0_b32 s28, 1
    s_cbranch_scc1 L_skw_31
    v_add_u32 v107, 32768, v2
    ds_read_b64 v[110:111], v107 offset:32784
    ds_read_b64 v[112:113], v107 offset:32792
    ds_read_b64 v[114:115], v107 offset:32776

    ds_read_b64 v[118:119], v107 offset:40976
    ds_read_b64 v[120:121], v107 offset:40984
    ds_read_b64 v[122:123], v107 offset:40968

    s_waitcnt lgkmcnt(3)
    v_lshrrev_b32 v116, 16, v111
    ds_read_b32 v116, v116 offset:8192

    s_waitcnt lgkmcnt(1)
    v_lshrrev_b32 v124, 16, v119
    ds_read_b32 v124, v124 offset:8192

    v_cmp_ne_u32_sdwa s[80:81], v111, v113 src0_sel:WORD_1 src1_sel:WORD_1
    v_cmp_ne_u32_sdwa vcc, v111, v115 src0_sel:WORD_1 src1_sel:WORD_1
    v_alignbyte_b32 v114, v115, v114, 2
    s_mov_b32 s54, 30717
    v_alignbyte_b32 v111, v111, v110, 1
    v_perm_b32 v110, v110, v114, s47
    s_waitcnt lgkmcnt(1)
    v_add3_u32 v116, v116, v106, s54
    v_sub_u32 v117, 0, v116
    v_and_b32 v117, 3, v117
    s_mov_b64 exec, s[80:81]
    v_mov_b32 v117, 0
    v_mov_b32 v112, 0
    s_mov_b64 exec, vcc
    v_mov_b32 v117, 3

    s_mov_b64 exec, -1
    v_alignbyte_b32 v110, v111, v110, v117
    v_alignbyte_b32 v111, v112, v111, v117
    v_add_u32 v116, v116, v117

    buffer_store_dwordx2 v[110:111], v116, s[24:27], 0 offen
    v_cmp_ne_u32_sdwa s[80:81], v119, v121 src0_sel:WORD_1 src1_sel:WORD_1
    v_cmp_ne_u32_sdwa vcc, v119, v123 src0_sel:WORD_1 src1_sel:WORD_1
    v_alignbyte_b32 v122, v123, v122, 2
    s_mov_b32 s54, 35837
    v_alignbyte_b32 v119, v119, v118, 1
    v_perm_b32 v118, v118, v122, s47
    s_waitcnt lgkmcnt(0)
    v_add3_u32 v124, v124, v106, s54
    v_sub_u32 v125, 0, v124
    v_and_b32 v125, 3, v125
    s_mov_b64 exec, s[80:81]
    v_mov_b32 v125, 0
    v_mov_b32 v120, 0
    s_mov_b64 exec, vcc
    v_mov_b32 v125, 3

    s_mov_b64 exec, -1
    v_alignbyte_b32 v118, v119, v118, v125
    v_alignbyte_b32 v119, v120, v119, v125
    v_add_u32 v124, v124, v125

    buffer_store_dwordx2 v[118:119], v124, s[24:27], 0 offen
L_skw_31:
    s_bitcmp0_b32 s28, 2
    s_cbranch_scc1 L_skw_32
    v_add_u32 v107, 65536, v2
    ds_read_b64 v[110:111], v107 offset:16400
    ds_read_b64 v[112:113], v107 offset:16408
    ds_read_b64 v[114:115], v107 offset:16392

    ds_read_b64 v[118:119], v107 offset:24592
    ds_read_b64 v[120:121], v107 offset:24600
    ds_read_b64 v[122:123], v107 offset:24584

    s_waitcnt lgkmcnt(3)
    v_lshrrev_b32 v116, 16, v111
    ds_read_b32 v116, v116 offset:8192

    s_waitcnt lgkmcnt(1)
    v_lshrrev_b32 v124, 16, v119
    ds_read_b32 v124, v124 offset:8192

    v_cmp_ne_u32_sdwa s[80:81], v111, v113 src0_sel:WORD_1 src1_sel:WORD_1
    v_cmp_ne_u32_sdwa vcc, v111, v115 src0_sel:WORD_1 src1_sel:WORD_1
    v_alignbyte_b32 v114, v115, v114, 2
    s_mov_b32 s54, 40957
    v_alignbyte_b32 v111, v111, v110, 1
    v_perm_b32 v110, v110, v114, s47
    s_waitcnt lgkmcnt(1)
    v_add3_u32 v116, v116, v106, s54
    v_sub_u32 v117, 0, v116
    v_and_b32 v117, 3, v117
    s_mov_b64 exec, s[80:81]
    v_mov_b32 v117, 0
    v_mov_b32 v112, 0
    s_mov_b64 exec, vcc
    v_mov_b32 v117, 3

    s_mov_b64 exec, -1
    v_alignbyte_b32 v110, v111, v110, v117
    v_alignbyte_b32 v111, v112, v111, v117
    v_add_u32 v116, v116, v117

    buffer_store_dwordx2 v[110:111], v116, s[24:27], 0 offen
    v_cmp_ne_u32_sdwa s[80:81], v119, v121 src0_sel:WORD_1 src1_sel:WORD_1
    v_cmp_ne_u32_sdwa vcc, v119, v123 src0_sel:WORD_1 src1_sel:WORD_1
    v_alignbyte_b32 v122, v123, v122, 2
    s_mov_b32 s54, 46077
    v_alignbyte_b32 v119, v119, v118, 1
    v_perm_b32 v118, v118, v122, s47
    s_waitcnt lgkmcnt(0)
    v_add3_u32 v124, v124, v106, s54
    v_sub_u32 v125, 0, v124
    v_and_b32 v125, 3, v125
    s_mov_b64 exec, s[80:81]
    v_mov_b32 v125, 0
    v_mov_b32 v120, 0
    s_mov_b64 exec, vcc
    v_mov_b32 v125, 3

    s_mov_b64 exec, -1
    v_alignbyte_b32 v118, v119, v118, v125
    v_alignbyte_b32 v119, v120, v119, v125
    v_add_u32 v124, v124, v125

    buffer_store_dwordx2 v[118:119], v124, s[24:27], 0 offen
L_skw_32:
    s_bitcmp0_b32 s82, 3
    s_cbranch_scc1 L_ska_33
    s_mov_b64 exec, s[66:67]
    v_mul_hi_u32_u24 v69, s40, v32
    v_mul_hi_u32_u24 v68, s40, v16
    v_mul_hi_u32_u24 v71, s40, v33
    v_mul_hi_u32_u24 v70, s40, v17
    v_mul_hi_u32_u24 v73, s40, v34
    v_mul_hi_u32_u24 v72, s40, v18
    v_mul_hi_u32_u24 v75, s40, v35
    v_mul_hi_u32_u24 v74, s40, v19
    v_and_b32 v69, -2, v69
    v_mad_u32_u24 v16, v68, s43, v16
    v_and_b32 v88, -4, v68
    v_and_b32 v71, -2, v71
    v_mad_u32_u24 v17, v70, s43, v17
    v_and_b32 v89, -4, v70
    v_and_b32 v73, -2, v73
    v_mad_u32_u24 v18, v72, s43, v18
    v_and_b32 v90, -4, v72
    v_and_b32 v75, -2, v75
    v_mad_u32_u24 v19, v74, s43, v19
    v_and_b32 v91, -4, v74
    v_mad_i32_i24 v32, v69, s42, v32
    v_lshl_add_u32 v69, v88, 5, v69
    v_mad_i32_i24 v33, v71, s42, v33
    v_lshl_add_u32 v71, v89, 5, v71
    v_mad_i32_i24 v34, v73, s42, v34
    v_lshl_add_u32 v73, v90, 5, v73
    v_mad_i32_i24 v35, v75, s42, v35
    v_lshl_add_u32 v75, v91, 5, v75
    v_add_u32 v69, v69, v69
    ds_add_rtn_u32 v88, v69, v104
    v_add_u32 v71, v71, v71
    ds_add_rtn_u32 v89, v71, v104
    v_add_u32 v73, v73, v73
    ds_add_rtn_u32 v90, v73, v104
    v_add_u32 v75, v75, v75
    ds_add_rtn_u32 v91, v75, v104
    v_lshlrev_b32 v110, 16, v42
    v_and_b32 v111, 0xffff0000, v42
    v_lshlrev_b32 v112, 16, v43
    v_and_b32 v113, 0xffff0000, v43
    v_mul_f32 v110, s44, v110
    v_mul_f32 v111, s44, v111
    v_mul_f32 v112, s44, v112
    v_mul_f32 v113, s44, v113
    v_fract_f32 v110, v110
    v_fract_f32 v111, v111
    v_fract_f32 v112, v112
    v_fract_f32 v113, v113
    v_cos_f32 v110, v110
    v_cos_f32 v111, v111
    v_cos_f32 v112, v112
    v_cos_f32 v113, v113
    v_lshl_or_b32 v68, v68, 14, v32
    v_perm_b32 v69, v69, v16, s46
    v_bfe_u32 v16, v16, 8, 5

    v_lshl_or_b32 v70, v70, 14, v33
    v_perm_b32 v71, v71, v17, s46
    v_bfe_u32 v17, v17, 8, 5

    v_lshl_or_b32 v72, v72, 14, v34
    v_perm_b32 v73, v73, v18, s46
    v_bfe_u32 v18, v18, 8, 5

    v_lshl_or_b32 v74, v74, 14, v35
    v_perm_b32 v75, v75, v19, s46
    v_bfe_u32 v19, v19, 8, 5

    v_fmaak_f32 v110, v110, v105, 0x4b400010
    v_fmaak_f32 v111, v111, v105, 0x4b400010
    v_fmaak_f32 v112, v112, v105, 0x4b400010
    v_fmaak_f32 v113, v113, v105, 0x4b400010
    v_sub_u32 v110, v110, v16
    v_sub_u32 v111, v111, v17
    v_sub_u32 v112, v112, v18
    v_sub_u32 v113, v113, v19
    v_bfi_b32 v110, 31, v16, v110
    v_bfi_b32 v111, 31, v17, v111
    v_bfi_b32 v112, 31, v18, v112
    v_bfi_b32 v113, 31, v19, v113
    v_perm_b32 v68, v68, v110, s55
    v_perm_b32 v70, v70, v111, s55
    v_perm_b32 v72, v72, v112, s55
    v_perm_b32 v74, v74, v113, s55
    s_mov_b64 exec, -1
L_ska_33:
    s_bitcmp0_b32 s28, 2
    s_cbranch_scc1 L_skw_34
    v_add_u32 v107, 65536, v2
    ds_read_b64 v[110:111], v107 offset:32784
    ds_read_b64 v[112:113], v107 offset:32792
    ds_read_b64 v[114:115], v107 offset:32776

    ds_read_b64 v[118:119], v107 offset:40976
    ds_read_b64 v[120:121], v107 offset:40984
    ds_read_b64 v[122:123], v107 offset:40968

    s_waitcnt lgkmcnt(3)
    v_lshrrev_b32 v116, 16, v111
    ds_read_b32 v116, v116 offset:8192

    s_waitcnt lgkmcnt(1)
    v_lshrrev_b32 v124, 16, v119
    ds_read_b32 v124, v124 offset:8192

    v_cmp_ne_u32_sdwa s[80:81], v111, v113 src0_sel:WORD_1 src1_sel:WORD_1
    v_cmp_ne_u32_sdwa vcc, v111, v115 src0_sel:WORD_1 src1_sel:WORD_1
    v_alignbyte_b32 v114, v115, v114, 2
    s_mov_b32 s54, 51197
    v_alignbyte_b32 v111, v111, v110, 1
    v_perm_b32 v110, v110, v114, s47
    s_waitcnt lgkmcnt(1)
    v_add3_u32 v116, v116, v106, s54
    v_sub_u32 v117, 0, v116
    v_and_b32 v117, 3, v117
    s_mov_b64 exec, s[80:81]
    v_mov_b32 v117, 0
    v_mov_b32 v112, 0
    s_mov_b64 exec, vcc
    v_mov_b32 v117, 3

    s_mov_b64 exec, -1
    v_alignbyte_b32 v110, v111, v110, v117
    v_alignbyte_b32 v111, v112, v111, v117
    v_add_u32 v116, v116, v117

    buffer_store_dwordx2 v[110:111], v116, s[24:27], 0 offen
    v_cmp_ne_u32_sdwa s[80:81], v119, v121 src0_sel:WORD_1 src1_sel:WORD_1
    v_cmp_ne_u32_sdwa vcc, v119, v123 src0_sel:WORD_1 src1_sel:WORD_1
    v_alignbyte_b32 v122, v123, v122, 2
    s_mov_b32 s54, 56317
    v_alignbyte_b32 v119, v119, v118, 1
    v_perm_b32 v118, v118, v122, s47
    s_waitcnt lgkmcnt(0)
    v_add3_u32 v124, v124, v106, s54
    v_sub_u32 v125, 0, v124
    v_and_b32 v125, 3, v125
    s_mov_b64 exec, s[80:81]
    v_mov_b32 v125, 0
    v_mov_b32 v120, 0
    s_mov_b64 exec, vcc
    v_mov_b32 v125, 3

    s_mov_b64 exec, -1
    v_alignbyte_b32 v118, v119, v118, v125
    v_alignbyte_b32 v119, v120, v119, v125
    v_add_u32 v124, v124, v125

    buffer_store_dwordx2 v[118:119], v124, s[24:27], 0 offen
L_skw_34:
    s_bitcmp0_b32 s28, 3
    s_cbranch_scc1 L_skw_35
    v_add_u32 v107, 98304, v2
    ds_read_b64 v[110:111], v107 offset:16400
    ds_read_b64 v[112:113], v107 offset:16408
    ds_read_b64 v[114:115], v107 offset:16392

    ds_read_b64 v[118:119], v107 offset:24592
    ds_read_b64 v[120:121], v107 offset:24600
    ds_read_b64 v[122:123], v107 offset:24584

    s_waitcnt lgkmcnt(3)
    v_lshrrev_b32 v116, 16, v111
    ds_read_b32 v116, v116 offset:8192

    s_waitcnt lgkmcnt(1)
    v_lshrrev_b32 v124, 16, v119
    ds_read_b32 v124, v124 offset:8192

    v_cmp_ne_u32_sdwa s[80:81], v111, v113 src0_sel:WORD_1 src1_sel:WORD_1
    v_cmp_ne_u32_sdwa vcc, v111, v115 src0_sel:WORD_1 src1_sel:WORD_1
    v_alignbyte_b32 v114, v115, v114, 2
    s_mov_b32 s54, 61437
    v_alignbyte_b32 v111, v111, v110, 1
    v_perm_b32 v110, v110, v114, s47
    s_waitcnt lgkmcnt(1)
    v_add3_u32 v116, v116, v106, s54
    v_sub_u32 v117, 0, v116
    v_and_b32 v117, 3, v117
    s_mov_b64 exec, s[80:81]
    v_mov_b32 v117, 0
    v_mov_b32 v112, 0
    s_mov_b64 exec, vcc
    v_mov_b32 v117, 3

    s_mov_b64 exec, -1
    v_alignbyte_b32 v110, v111, v110, v117
    v_alignbyte_b32 v111, v112, v111, v117
    v_add_u32 v116, v116, v117

    buffer_store_dwordx2 v[110:111], v116, s[24:27], 0 offen
    v_cmp_ne_u32_sdwa s[80:81], v119, v121 src0_sel:WORD_1 src1_sel:WORD_1
    v_cmp_ne_u32_sdwa vcc, v119, v123 src0_sel:WORD_1 src1_sel:WORD_1
    v_alignbyte_b32 v122, v123, v122, 2
    s_mov_b32 s54, 66557
    v_alignbyte_b32 v119, v119, v118, 1
    v_perm_b32 v118, v118, v122, s47
    s_waitcnt lgkmcnt(0)
    v_add3_u32 v124, v124, v106, s54
    v_sub_u32 v125, 0, v124
    v_and_b32 v125, 3, v125
    s_mov_b64 exec, s[80:81]
    v_mov_b32 v125, 0
    v_mov_b32 v120, 0
    s_mov_b64 exec, vcc
    v_mov_b32 v125, 3

    s_mov_b64 exec, -1
    v_alignbyte_b32 v118, v119, v118, v125
    v_alignbyte_b32 v119, v120, v119, v125
    v_add_u32 v124, v124, v125

    buffer_store_dwordx2 v[118:119], v124, s[24:27], 0 offen
L_skw_35:
    s_bitcmp0_b32 s28, 3
    s_cbranch_scc1 L_skw_36
    v_add_u32 v107, 98304, v2
    ds_read_b64 v[110:111], v107 offset:32784
    ds_read_b64 v[112:113], v107 offset:32792
    ds_read_b64 v[114:115], v107 offset:32776

    ds_read_b64 v[118:119], v107 offset:40976
    ds_read_b64 v[120:121], v107 offset:40984
    ds_read_b64 v[122:123], v107 offset:40968

    s_waitcnt lgkmcnt(3)
    v_lshrrev_b32 v116, 16, v111
    ds_read_b32 v116, v116 offset:8192

    s_waitcnt lgkmcnt(1)
    v_lshrrev_b32 v124, 16, v119
    ds_read_b32 v124, v124 offset:8192

    v_cmp_ne_u32_sdwa s[80:81], v111, v113 src0_sel:WORD_1 src1_sel:WORD_1
    v_cmp_ne_u32_sdwa vcc, v111, v115 src0_sel:WORD_1 src1_sel:WORD_1
    v_alignbyte_b32 v114, v115, v114, 2
    s_mov_b32 s54, 71677
    v_alignbyte_b32 v111, v111, v110, 1
    v_perm_b32 v110, v110, v114, s47
    s_waitcnt lgkmcnt(1)
    v_add3_u32 v116, v116, v106, s54
    v_sub_u32 v117, 0, v116
    v_and_b32 v117, 3, v117
    s_mov_b64 exec, s[80:81]
    v_mov_b32 v117, 0
    v_mov_b32 v112, 0
    s_mov_b64 exec, vcc
    v_mov_b32 v117, 3

    s_mov_b64 exec, -1
    v_alignbyte_b32 v110, v111, v110, v117
    v_alignbyte_b32 v111, v112, v111, v117
    v_add_u32 v116, v116, v117

    buffer_store_dwordx2 v[110:111], v116, s[24:27], 0 offen
    v_cmp_ne_u32_sdwa s[80:81], v119, v121 src0_sel:WORD_1 src1_sel:WORD_1
    v_cmp_ne_u32_sdwa vcc, v119, v123 src0_sel:WORD_1 src1_sel:WORD_1
    v_alignbyte_b32 v122, v123, v122, 2
    s_mov_b32 s54, 76797
    v_alignbyte_b32 v119, v119, v118, 1
    v_perm_b32 v118, v118, v122, s47
    s_waitcnt lgkmcnt(0)
    v_add3_u32 v124, v124, v106, s54
    v_sub_u32 v125, 0, v124
    v_and_b32 v125, 3, v125
    s_mov_b64 exec, s[80:81]
    v_mov_b32 v125, 0
    v_mov_b32 v120, 0
    s_mov_b64 exec, vcc
    v_mov_b32 v125, 3

    s_andn2_b64 exec, -1, s[68:69]
    v_bfrev_b32 v124, 1
    s_mov_b64 exec, -1
    v_alignbyte_b32 v118, v119, v118, v125
    v_alignbyte_b32 v119, v120, v119, v125
    v_add_u32 v124, v124, v125

    buffer_store_dwordx2 v[118:119], v124, s[24:27], 0 offen
L_skw_36:
    s_waitcnt lgkmcnt(0)
    s_barrier

    buffer_load_dwordx4 v[20:23], v1, s[12:15], s56 offen nt
    buffer_load_dwordx4 v[4:7], v1, s[8:11], s56 offen nt
    buffer_load_dwordx2 v[36:37], v2, s[16:19], s61 offen nt
    buffer_load_dwordx4 v[24:27], v1, s[12:15], s57 offen nt
    buffer_load_dwordx4 v[8:11], v1, s[8:11], s57 offen nt
    buffer_load_dwordx2 v[38:39], v2, s[16:19], s62 offen nt
    ds_read_b64 v[94:95], v2
    s_waitcnt lgkmcnt(0)
    v_and_b32 v94, 0xffff, v94
    v_and_b32 v95, 0xffff, v95
    v_add_u32 v97, v94, v95
    s_nop 1
    v_add_u32_dpp v97, v97, v97 row_shr:1 row_mask:0xf bank_mask:0xf
    s_nop 1
    v_add_u32_dpp v97, v97, v97 row_shr:2 row_mask:0xf bank_mask:0xf
    s_nop 1
    v_add_u32_dpp v97, v97, v97 row_shr:4 row_mask:0xf bank_mask:0xf
    s_nop 1
    v_add_u32_dpp v97, v97, v97 row_shr:8 row_mask:0xf bank_mask:0xf
    s_nop 1
    v_add_u32_dpp v97, v97, v97 row_bcast:15 row_mask:0xa bank_mask:0xf
    s_nop 1
    v_add_u32_dpp v97, v97, v97 row_bcast:31 row_mask:0xc bank_mask:0xf
    s_mov_b32 exec_lo, 0
    s_brev_b32 exec_hi, 1
    ds_add_rtn_u32 v96, v108, v97
    s_mov_b64 exec, -1

    v_add_u32 v92, v94, v94
    v_add_u32 v93, v95, v95
    v_med3_u32 v92, v94, 2, v92
    v_med3_u32 v93, v95, 2, v93
    v_lshl_or_b32 v92, v93, 16, v92
    v_lshlrev_b32 v93, 2, v0
    buffer_atomic_add v92, v93, s[20:23], 0 offen sc0
    s_waitcnt lgkmcnt(0)
    v_readlane_b32 s77, v96, 63
    v_mul_u32_u24 v114, 65528, v0
    v_sub_u32 v97, v97, v95
    s_sub_u32 s50, s50, s83
    s_sub_u32 s77, s77, s50
    v_add_u32 v97, s77, v97
    v_sub_u32 v96, v97, v94
    v_lshlrev_b32 v111, 16, v97
    v_lshlrev_b32 v110, 16, v96
    ds_write_b64 v2, v[110:111]
    v_mad_i32_i24 v96, v96, -5, v114
    v_mad_i32_i24 v97, v97, -5, v114
    v_add_u32 v97, 32764, v97
    s_add_u32 s50, s50, s84
    s_mov_b32 s28, s82
    s_mov_b32 s29, s83
    s_mov_b32 s30, s84
    s_lshl_b32 s74, s29, 3
    s_lshl_b32 s75, s30, 3
    v_mov_b32 v125, s74
    v_mov_b32 v126, s75
    v_mov_b32 v127, -1

    s_waitcnt lgkmcnt(0)
    s_barrier

    s_mov_b64 exec, 1
    ds_write_b32 v125, v127 offset:16396
    ds_write_b32 v126, v127 offset:16404
    s_mov_b64 exec, -1

    s_bitcmp0_b32 s28, 0
    s_cbranch_scc1 L_skz_37
    v_lshrrev_b32 v110, 16, v45
    ds_read_b32 v110, v110
    v_lshrrev_b32 v111, 16, v47
    ds_read_b32 v111, v111
    v_lshrrev_b32 v112, 16, v49
    ds_read_b32 v112, v112
    v_lshrrev_b32 v113, 16, v51
    ds_read_b32 v113, v113
    v_lshrrev_b32 v114, 16, v53
    ds_read_b32 v114, v114
    v_lshrrev_b32 v115, 16, v55
    ds_read_b32 v115, v115
    v_lshrrev_b32 v116, 16, v57
    ds_read_b32 v116, v116
    v_lshrrev_b32 v117, 16, v59
    ds_read_b32 v117, v117
    s_waitcnt lgkmcnt(7)
    v_add_u32_sdwa v110, v110, v76 dst_sel:DWORD dst_unused:UNUSED_PAD src0_sel:WORD_1 src1_sel:WORD_0
    v_lshlrev_b32 v110, 3, v110
    ds_write_b64 v110, v[44:45] offset:16400

    s_waitcnt lgkmcnt(7)
    v_add_u32_sdwa v111, v111, v77 dst_sel:DWORD dst_unused:UNUSED_PAD src0_sel:WORD_1 src1_sel:WORD_0
    v_lshlrev_b32 v111, 3, v111
    ds_write_b64 v111, v[46:47] offset:16400

    s_waitcnt lgkmcnt(7)
    v_add_u32_sdwa v112, v112, v78 dst_sel:DWORD dst_unused:UNUSED_PAD src0_sel:WORD_1 src1_sel:WORD_0
    v_lshlrev_b32 v112, 3, v112
    ds_write_b64 v112, v[48:49] offset:16400

    s_waitcnt lgkmcnt(7)
    v_add_u32_sdwa v113, v113, v79 dst_sel:DWORD dst_unused:UNUSED_PAD src0_sel:WORD_1 src1_sel:WORD_0
    v_lshlrev_b32 v113, 3, v113
    ds_write_b64 v113, v[50:51] offset:16400

    s_waitcnt lgkmcnt(7)
    v_add_u32_sdwa v114, v114, v80 dst_sel:DWORD dst_unused:UNUSED_PAD src0_sel:WORD_1 src1_sel:WORD_0
    v_lshlrev_b32 v114, 3, v114
    ds_write_b64 v114, v[52:53] offset:16400

    s_waitcnt lgkmcnt(7)
    v_add_u32_sdwa v115, v115, v81 dst_sel:DWORD dst_unused:UNUSED_PAD src0_sel:WORD_1 src1_sel:WORD_0
    v_lshlrev_b32 v115, 3, v115
    ds_write_b64 v115, v[54:55] offset:16400

    s_waitcnt lgkmcnt(7)
    v_add_u32_sdwa v116, v116, v82 dst_sel:DWORD dst_unused:UNUSED_PAD src0_sel:WORD_1 src1_sel:WORD_0
    v_lshlrev_b32 v116, 3, v116
    ds_write_b64 v116, v[56:57] offset:16400

    s_waitcnt lgkmcnt(7)
    v_add_u32_sdwa v117, v117, v83 dst_sel:DWORD dst_unused:UNUSED_PAD src0_sel:WORD_1 src1_sel:WORD_0
    v_lshlrev_b32 v117, 3, v117
    ds_write_b64 v117, v[58:59] offset:16400

L_skz_37:
    buffer_load_dwordx4 v[28:31], v1, s[12:15], s58 offen nt
    buffer_load_dwordx4 v[12:15], v1, s[8:11], s58 offen nt
    buffer_load_dwordx2 v[40:41], v2, s[16:19], s63 offen nt
    s_bitcmp0_b32 s28, 2
    s_cbranch_scc1 L_skz_38
    v_lshrrev_b32 v110, 16, v61
    ds_read_b32 v110, v110
    v_lshrrev_b32 v111, 16, v63
    ds_read_b32 v111, v111
    v_lshrrev_b32 v112, 16, v65
    ds_read_b32 v112, v112
    v_lshrrev_b32 v113, 16, v67
    ds_read_b32 v113, v113
    s_waitcnt lgkmcnt(3)
    v_add_u32_sdwa v110, v110, v84 dst_sel:DWORD dst_unused:UNUSED_PAD src0_sel:WORD_1 src1_sel:WORD_0
    v_lshlrev_b32 v110, 3, v110
    ds_write_b64 v110, v[60:61] offset:16400

    s_waitcnt lgkmcnt(3)
    v_add_u32_sdwa v111, v111, v85 dst_sel:DWORD dst_unused:UNUSED_PAD src0_sel:WORD_1 src1_sel:WORD_0
    v_lshlrev_b32 v111, 3, v111
    ds_write_b64 v111, v[62:63] offset:16400

    s_waitcnt lgkmcnt(3)
    v_add_u32_sdwa v112, v112, v86 dst_sel:DWORD dst_unused:UNUSED_PAD src0_sel:WORD_1 src1_sel:WORD_0
    v_lshlrev_b32 v112, 3, v112
    ds_write_b64 v112, v[64:65] offset:16400

    s_waitcnt lgkmcnt(3)
    v_add_u32_sdwa v113, v113, v87 dst_sel:DWORD dst_unused:UNUSED_PAD src0_sel:WORD_1 src1_sel:WORD_0
    v_lshlrev_b32 v113, 3, v113
    ds_write_b64 v113, v[66:67] offset:16400

L_skz_38:
    s_bitcmp0_b32 s28, 3
    s_cbranch_scc1 L_skz_39
    s_mov_b64 exec, s[66:67]
    v_lshrrev_b32 v110, 16, v69
    ds_read_b32 v110, v110
    v_lshrrev_b32 v111, 16, v71
    ds_read_b32 v111, v111
    v_lshrrev_b32 v112, 16, v73
    ds_read_b32 v112, v112
    v_lshrrev_b32 v113, 16, v75
    ds_read_b32 v113, v113
    s_waitcnt lgkmcnt(3)
    v_add_u32_sdwa v110, v110, v88 dst_sel:DWORD dst_unused:UNUSED_PAD src0_sel:WORD_1 src1_sel:WORD_0
    v_lshlrev_b32 v110, 3, v110
    ds_write_b64 v110, v[68:69] offset:16400

    s_waitcnt lgkmcnt(3)
    v_add_u32_sdwa v111, v111, v89 dst_sel:DWORD dst_unused:UNUSED_PAD src0_sel:WORD_1 src1_sel:WORD_0
    v_lshlrev_b32 v111, 3, v111
    ds_write_b64 v111, v[70:71] offset:16400

    s_waitcnt lgkmcnt(3)
    v_add_u32_sdwa v112, v112, v90 dst_sel:DWORD dst_unused:UNUSED_PAD src0_sel:WORD_1 src1_sel:WORD_0
    v_lshlrev_b32 v112, 3, v112
    ds_write_b64 v112, v[72:73] offset:16400

    s_waitcnt lgkmcnt(3)
    v_add_u32_sdwa v113, v113, v91 dst_sel:DWORD dst_unused:UNUSED_PAD src0_sel:WORD_1 src1_sel:WORD_0
    v_lshlrev_b32 v113, 3, v113
    ds_write_b64 v113, v[74:75] offset:16400

    s_mov_b64 exec, -1
L_skz_39:
    buffer_load_dwordx4 v[32:35], v1, s[12:15], s59 offen nt
    buffer_load_dwordx4 v[16:19], v1, s[8:11], s59 offen nt
    buffer_load_dwordx2 v[42:43], v2, s[16:19], s64 offen nt
    s_cmp_lg_u32 s49, 0
    s_cbranch_scc1 L_p1loop_5
L_p1epi_6:
    s_waitcnt vmcnt(0)
    s_waitcnt vmcnt(0)
    v_lshrrev_b32 v93, 16, v92
    v_and_b32 v92, 0xffff, v92
    v_add_u32 v110, v92, v94
    v_mad_u32_u24 v92, v92, 5, v96
    v_add_u32 v111, v93, v95
    v_mad_u32_u24 v93, v93, 5, v97
    v_max_u32 v110, v110, v111
    v_cmp_le_u32 vcc, s48, v110
    s_cbranch_vccnz L_full_40
L_fback_41:
    ds_write_b64 v2, v[92:93] offset:8192

    s_waitcnt lgkmcnt(0)
    s_barrier

    s_bitcmp0_b32 s28, 0
    s_cbranch_scc1 L_skw_42
    ds_read_b64 v[4:5], v2 offset:16400
    ds_read_b64 v[6:7], v2 offset:16408
    ds_read_b64 v[8:9], v2 offset:16392

    ds_read_b64 v[12:13], v2 offset:24592
    ds_read_b64 v[14:15], v2 offset:24600
    ds_read_b64 v[16:17], v2 offset:24584

    ds_read_b64 v[20:21], v2 offset:32784
    ds_read_b64 v[22:23], v2 offset:32792
    ds_read_b64 v[24:25], v2 offset:32776

    ds_read_b64 v[28:29], v2 offset:40976
    ds_read_b64 v[30:31], v2 offset:40984
    ds_read_b64 v[32:33], v2 offset:40968

    s_waitcnt lgkmcnt(9)
    v_lshrrev_b32 v10, 16, v5
    ds_read_b32 v10, v10 offset:8192

    s_waitcnt lgkmcnt(7)
    v_lshrrev_b32 v18, 16, v13
    ds_read_b32 v18, v18 offset:8192

    s_waitcnt lgkmcnt(5)
    v_lshrrev_b32 v26, 16, v21
    ds_read_b32 v26, v26 offset:8192

    s_waitcnt lgkmcnt(3)
    v_lshrrev_b32 v34, 16, v29
    ds_read_b32 v34, v34 offset:8192

    v_cmp_ne_u32_sdwa s[80:81], v5, v7 src0_sel:WORD_1 src1_sel:WORD_1
    v_cmp_ne_u32_sdwa vcc, v5, v9 src0_sel:WORD_1 src1_sel:WORD_1
    v_alignbyte_b32 v8, v9, v8, 2
    s_mov_b32 s54, -3
    v_alignbyte_b32 v5, v5, v4, 1
    v_perm_b32 v4, v4, v8, s47
    s_waitcnt lgkmcnt(3)
    v_add3_u32 v10, v10, v106, s54
    v_sub_u32 v11, 0, v10
    v_and_b32 v11, 3, v11
    s_mov_b64 exec, s[80:81]
    v_mov_b32 v11, 0
    v_mov_b32 v6, 0
    s_mov_b64 exec, vcc
    v_mov_b32 v11, 3

    s_mov_b64 exec, -1
    v_alignbyte_b32 v4, v5, v4, v11
    v_alignbyte_b32 v5, v6, v5, v11
    v_add_u32 v10, v10, v11

    buffer_store_dwordx2 v[4:5], v10, s[24:27], 0 offen
    v_cmp_ne_u32_sdwa s[80:81], v13, v15 src0_sel:WORD_1 src1_sel:WORD_1
    v_cmp_ne_u32_sdwa vcc, v13, v17 src0_sel:WORD_1 src1_sel:WORD_1
    v_alignbyte_b32 v16, v17, v16, 2
    s_mov_b32 s54, 5117
    v_alignbyte_b32 v13, v13, v12, 1
    v_perm_b32 v12, v12, v16, s47
    s_waitcnt lgkmcnt(2)
    v_add3_u32 v18, v18, v106, s54
    v_sub_u32 v19, 0, v18
    v_and_b32 v19, 3, v19
    s_mov_b64 exec, s[80:81]
    v_mov_b32 v19, 0
    v_mov_b32 v14, 0
    s_mov_b64 exec, vcc
    v_mov_b32 v19, 3

    s_mov_b64 exec, -1
    v_alignbyte_b32 v12, v13, v12, v19
    v_alignbyte_b32 v13, v14, v13, v19
    v_add_u32 v18, v18, v19

    buffer_store_dwordx2 v[12:13], v18, s[24:27], 0 offen
    v_cmp_ne_u32_sdwa s[80:81], v21, v23 src0_sel:WORD_1 src1_sel:WORD_1
    v_cmp_ne_u32_sdwa vcc, v21, v25 src0_sel:WORD_1 src1_sel:WORD_1
    v_alignbyte_b32 v24, v25, v24, 2
    s_mov_b32 s54, 10237
    v_alignbyte_b32 v21, v21, v20, 1
    v_perm_b32 v20, v20, v24, s47
    s_waitcnt lgkmcnt(1)
    v_add3_u32 v26, v26, v106, s54
    v_sub_u32 v27, 0, v26
    v_and_b32 v27, 3, v27
    s_mov_b64 exec, s[80:81]
    v_mov_b32 v27, 0
    v_mov_b32 v22, 0
    s_mov_b64 exec, vcc
    v_mov_b32 v27, 3

    s_mov_b64 exec, -1
    v_alignbyte_b32 v20, v21, v20, v27
    v_alignbyte_b32 v21, v22, v21, v27
    v_add_u32 v26, v26, v27

    buffer_store_dwordx2 v[20:21], v26, s[24:27], 0 offen
    v_cmp_ne_u32_sdwa s[80:81], v29, v31 src0_sel:WORD_1 src1_sel:WORD_1
    v_cmp_ne_u32_sdwa vcc, v29, v33 src0_sel:WORD_1 src1_sel:WORD_1
    v_alignbyte_b32 v32, v33, v32, 2
    s_mov_b32 s54, 15357
    v_alignbyte_b32 v29, v29, v28, 1
    v_perm_b32 v28, v28, v32, s47
    s_waitcnt lgkmcnt(0)
    v_add3_u32 v34, v34, v106, s54
    v_sub_u32 v35, 0, v34
    v_and_b32 v35, 3, v35
    s_mov_b64 exec, s[80:81]
    v_mov_b32 v35, 0
    v_mov_b32 v30, 0
    s_mov_b64 exec, vcc
    v_mov_b32 v35, 3

    s_mov_b64 exec, -1
    v_alignbyte_b32 v28, v29, v28, v35
    v_alignbyte_b32 v29, v30, v29, v35
    v_add_u32 v34, v34, v35

    buffer_store_dwordx2 v[28:29], v34, s[24:27], 0 offen
L_skw_42:
    s_bitcmp0_b32 s28, 1
    s_cbranch_scc1 L_skw_43
    v_add_u32 v107, 32768, v2
    ds_read_b64 v[4:5], v107 offset:16400
    ds_read_b64 v[6:7], v107 offset:16408
    ds_read_b64 v[8:9], v107 offset:16392

    ds_read_b64 v[12:13], v107 offset:24592
    ds_read_b64 v[14:15], v107 offset:24600
    ds_read_b64 v[16:17], v107 offset:24584

    ds_read_b64 v[20:21], v107 offset:32784
    ds_read_b64 v[22:23], v107 offset:32792
    ds_read_b64 v[24:25], v107 offset:32776

    ds_read_b64 v[28:29], v107 offset:40976
    ds_read_b64 v[30:31], v107 offset:40984
    ds_read_b64 v[32:33], v107 offset:40968

    s_waitcnt lgkmcnt(9)
    v_lshrrev_b32 v10, 16, v5
    ds_read_b32 v10, v10 offset:8192

    s_waitcnt lgkmcnt(7)
    v_lshrrev_b32 v18, 16, v13
    ds_read_b32 v18, v18 offset:8192

    s_waitcnt lgkmcnt(5)
    v_lshrrev_b32 v26, 16, v21
    ds_read_b32 v26, v26 offset:8192

    s_waitcnt lgkmcnt(3)
    v_lshrrev_b32 v34, 16, v29
    ds_read_b32 v34, v34 offset:8192

    v_cmp_ne_u32_sdwa s[80:81], v5, v7 src0_sel:WORD_1 src1_sel:WORD_1
    v_cmp_ne_u32_sdwa vcc, v5, v9 src0_sel:WORD_1 src1_sel:WORD_1
    v_alignbyte_b32 v8, v9, v8, 2
    s_mov_b32 s54, 20477
    v_alignbyte_b32 v5, v5, v4, 1
    v_perm_b32 v4, v4, v8, s47
    s_waitcnt lgkmcnt(3)
    v_add3_u32 v10, v10, v106, s54
    v_sub_u32 v11, 0, v10
    v_and_b32 v11, 3, v11
    s_mov_b64 exec, s[80:81]
    v_mov_b32 v11, 0
    v_mov_b32 v6, 0
    s_mov_b64 exec, vcc
    v_mov_b32 v11, 3

    s_mov_b64 exec, -1
    v_alignbyte_b32 v4, v5, v4, v11
    v_alignbyte_b32 v5, v6, v5, v11
    v_add_u32 v10, v10, v11

    buffer_store_dwordx2 v[4:5], v10, s[24:27], 0 offen
    v_cmp_ne_u32_sdwa s[80:81], v13, v15 src0_sel:WORD_1 src1_sel:WORD_1
    v_cmp_ne_u32_sdwa vcc, v13, v17 src0_sel:WORD_1 src1_sel:WORD_1
    v_alignbyte_b32 v16, v17, v16, 2
    s_mov_b32 s54, 25597
    v_alignbyte_b32 v13, v13, v12, 1
    v_perm_b32 v12, v12, v16, s47
    s_waitcnt lgkmcnt(2)
    v_add3_u32 v18, v18, v106, s54
    v_sub_u32 v19, 0, v18
    v_and_b32 v19, 3, v19
    s_mov_b64 exec, s[80:81]
    v_mov_b32 v19, 0
    v_mov_b32 v14, 0
    s_mov_b64 exec, vcc
    v_mov_b32 v19, 3

    s_mov_b64 exec, -1
    v_alignbyte_b32 v12, v13, v12, v19
    v_alignbyte_b32 v13, v14, v13, v19
    v_add_u32 v18, v18, v19

    buffer_store_dwordx2 v[12:13], v18, s[24:27], 0 offen
    v_cmp_ne_u32_sdwa s[80:81], v21, v23 src0_sel:WORD_1 src1_sel:WORD_1
    v_cmp_ne_u32_sdwa vcc, v21, v25 src0_sel:WORD_1 src1_sel:WORD_1
    v_alignbyte_b32 v24, v25, v24, 2
    s_mov_b32 s54, 30717
    v_alignbyte_b32 v21, v21, v20, 1
    v_perm_b32 v20, v20, v24, s47
    s_waitcnt lgkmcnt(1)
    v_add3_u32 v26, v26, v106, s54
    v_sub_u32 v27, 0, v26
    v_and_b32 v27, 3, v27
    s_mov_b64 exec, s[80:81]
    v_mov_b32 v27, 0
    v_mov_b32 v22, 0
    s_mov_b64 exec, vcc
    v_mov_b32 v27, 3

    s_mov_b64 exec, -1
    v_alignbyte_b32 v20, v21, v20, v27
    v_alignbyte_b32 v21, v22, v21, v27
    v_add_u32 v26, v26, v27

    buffer_store_dwordx2 v[20:21], v26, s[24:27], 0 offen
    v_cmp_ne_u32_sdwa s[80:81], v29, v31 src0_sel:WORD_1 src1_sel:WORD_1
    v_cmp_ne_u32_sdwa vcc, v29, v33 src0_sel:WORD_1 src1_sel:WORD_1
    v_alignbyte_b32 v32, v33, v32, 2
    s_mov_b32 s54, 35837
    v_alignbyte_b32 v29, v29, v28, 1
    v_perm_b32 v28, v28, v32, s47
    s_waitcnt lgkmcnt(0)
    v_add3_u32 v34, v34, v106, s54
    v_sub_u32 v35, 0, v34
    v_and_b32 v35, 3, v35
    s_mov_b64 exec, s[80:81]
    v_mov_b32 v35, 0
    v_mov_b32 v30, 0
    s_mov_b64 exec, vcc
    v_mov_b32 v35, 3

    s_mov_b64 exec, -1
    v_alignbyte_b32 v28, v29, v28, v35
    v_alignbyte_b32 v29, v30, v29, v35
    v_add_u32 v34, v34, v35

    buffer_store_dwordx2 v[28:29], v34, s[24:27], 0 offen
L_skw_43:
    s_bitcmp0_b32 s28, 2
    s_cbranch_scc1 L_skw_44
    v_add_u32 v107, 65536, v2
    ds_read_b64 v[4:5], v107 offset:16400
    ds_read_b64 v[6:7], v107 offset:16408
    ds_read_b64 v[8:9], v107 offset:16392

    ds_read_b64 v[12:13], v107 offset:24592
    ds_read_b64 v[14:15], v107 offset:24600
    ds_read_b64 v[16:17], v107 offset:24584

    ds_read_b64 v[20:21], v107 offset:32784
    ds_read_b64 v[22:23], v107 offset:32792
    ds_read_b64 v[24:25], v107 offset:32776

    ds_read_b64 v[28:29], v107 offset:40976
    ds_read_b64 v[30:31], v107 offset:40984
    ds_read_b64 v[32:33], v107 offset:40968

    s_waitcnt lgkmcnt(9)
    v_lshrrev_b32 v10, 16, v5
    ds_read_b32 v10, v10 offset:8192

    s_waitcnt lgkmcnt(7)
    v_lshrrev_b32 v18, 16, v13
    ds_read_b32 v18, v18 offset:8192

    s_waitcnt lgkmcnt(5)
    v_lshrrev_b32 v26, 16, v21
    ds_read_b32 v26, v26 offset:8192

    s_waitcnt lgkmcnt(3)
    v_lshrrev_b32 v34, 16, v29
    ds_read_b32 v34, v34 offset:8192

    v_cmp_ne_u32_sdwa s[80:81], v5, v7 src0_sel:WORD_1 src1_sel:WORD_1
    v_cmp_ne_u32_sdwa vcc, v5, v9 src0_sel:WORD_1 src1_sel:WORD_1
    v_alignbyte_b32 v8, v9, v8, 2
    s_mov_b32 s54, 40957
    v_alignbyte_b32 v5, v5, v4, 1
    v_perm_b32 v4, v4, v8, s47
    s_waitcnt lgkmcnt(3)
    v_add3_u32 v10, v10, v106, s54
    v_sub_u32 v11, 0, v10
    v_and_b32 v11, 3, v11
    s_mov_b64 exec, s[80:81]
    v_mov_b32 v11, 0
    v_mov_b32 v6, 0
    s_mov_b64 exec, vcc
    v_mov_b32 v11, 3

    s_mov_b64 exec, -1
    v_alignbyte_b32 v4, v5, v4, v11
    v_alignbyte_b32 v5, v6, v5, v11
    v_add_u32 v10, v10, v11

    buffer_store_dwordx2 v[4:5], v10, s[24:27], 0 offen
    v_cmp_ne_u32_sdwa s[80:81], v13, v15 src0_sel:WORD_1 src1_sel:WORD_1
    v_cmp_ne_u32_sdwa vcc, v13, v17 src0_sel:WORD_1 src1_sel:WORD_1
    v_alignbyte_b32 v16, v17, v16, 2
    s_mov_b32 s54, 46077
    v_alignbyte_b32 v13, v13, v12, 1
    v_perm_b32 v12, v12, v16, s47
    s_waitcnt lgkmcnt(2)
    v_add3_u32 v18, v18, v106, s54
    v_sub_u32 v19, 0, v18
    v_and_b32 v19, 3, v19
    s_mov_b64 exec, s[80:81]
    v_mov_b32 v19, 0
    v_mov_b32 v14, 0
    s_mov_b64 exec, vcc
    v_mov_b32 v19, 3

    s_mov_b64 exec, -1
    v_alignbyte_b32 v12, v13, v12, v19
    v_alignbyte_b32 v13, v14, v13, v19
    v_add_u32 v18, v18, v19

    buffer_store_dwordx2 v[12:13], v18, s[24:27], 0 offen
    v_cmp_ne_u32_sdwa s[80:81], v21, v23 src0_sel:WORD_1 src1_sel:WORD_1
    v_cmp_ne_u32_sdwa vcc, v21, v25 src0_sel:WORD_1 src1_sel:WORD_1
    v_alignbyte_b32 v24, v25, v24, 2
    s_mov_b32 s54, 51197
    v_alignbyte_b32 v21, v21, v20, 1
    v_perm_b32 v20, v20, v24, s47
    s_waitcnt lgkmcnt(1)
    v_add3_u32 v26, v26, v106, s54
    v_sub_u32 v27, 0, v26
    v_and_b32 v27, 3, v27
    s_mov_b64 exec, s[80:81]
    v_mov_b32 v27, 0
    v_mov_b32 v22, 0
    s_mov_b64 exec, vcc
    v_mov_b32 v27, 3

    s_mov_b64 exec, -1
    v_alignbyte_b32 v20, v21, v20, v27
    v_alignbyte_b32 v21, v22, v21, v27
    v_add_u32 v26, v26, v27

    buffer_store_dwordx2 v[20:21], v26, s[24:27], 0 offen
    v_cmp_ne_u32_sdwa s[80:81], v29, v31 src0_sel:WORD_1 src1_sel:WORD_1
    v_cmp_ne_u32_sdwa vcc, v29, v33 src0_sel:WORD_1 src1_sel:WORD_1
    v_alignbyte_b32 v32, v33, v32, 2
    s_mov_b32 s54, 56317
    v_alignbyte_b32 v29, v29, v28, 1
    v_perm_b32 v28, v28, v32, s47
    s_waitcnt lgkmcnt(0)
    v_add3_u32 v34, v34, v106, s54
    v_sub_u32 v35, 0, v34
    v_and_b32 v35, 3, v35
    s_mov_b64 exec, s[80:81]
    v_mov_b32 v35, 0
    v_mov_b32 v30, 0
    s_mov_b64 exec, vcc
    v_mov_b32 v35, 3

    s_mov_b64 exec, -1
    v_alignbyte_b32 v28, v29, v28, v35
    v_alignbyte_b32 v29, v30, v29, v35
    v_add_u32 v34, v34, v35

    buffer_store_dwordx2 v[28:29], v34, s[24:27], 0 offen
L_skw_44:
    s_bitcmp0_b32 s28, 3
    s_cbranch_scc1 L_skw_45
    v_add_u32 v107, 98304, v2
    ds_read_b64 v[4:5], v107 offset:16400
    ds_read_b64 v[6:7], v107 offset:16408
    ds_read_b64 v[8:9], v107 offset:16392

    ds_read_b64 v[12:13], v107 offset:24592
    ds_read_b64 v[14:15], v107 offset:24600
    ds_read_b64 v[16:17], v107 offset:24584

    ds_read_b64 v[20:21], v107 offset:32784
    ds_read_b64 v[22:23], v107 offset:32792
    ds_read_b64 v[24:25], v107 offset:32776

    ds_read_b64 v[28:29], v107 offset:40976
    ds_read_b64 v[30:31], v107 offset:40984
    ds_read_b64 v[32:33], v107 offset:40968

    s_waitcnt lgkmcnt(9)
    v_lshrrev_b32 v10, 16, v5
    ds_read_b32 v10, v10 offset:8192

    s_waitcnt lgkmcnt(7)
    v_lshrrev_b32 v18, 16, v13
    ds_read_b32 v18, v18 offset:8192

    s_waitcnt lgkmcnt(5)
    v_lshrrev_b32 v26, 16, v21
    ds_read_b32 v26, v26 offset:8192

    s_waitcnt lgkmcnt(3)
    v_lshrrev_b32 v34, 16, v29
    ds_read_b32 v34, v34 offset:8192

    v_cmp_ne_u32_sdwa s[80:81], v5, v7 src0_sel:WORD_1 src1_sel:WORD_1
    v_cmp_ne_u32_sdwa vcc, v5, v9 src0_sel:WORD_1 src1_sel:WORD_1
    v_alignbyte_b32 v8, v9, v8, 2
    s_mov_b32 s54, 61437
    v_alignbyte_b32 v5, v5, v4, 1
    v_perm_b32 v4, v4, v8, s47
    s_waitcnt lgkmcnt(3)
    v_add3_u32 v10, v10, v106, s54
    v_sub_u32 v11, 0, v10
    v_and_b32 v11, 3, v11
    s_mov_b64 exec, s[80:81]
    v_mov_b32 v11, 0
    v_mov_b32 v6, 0
    s_mov_b64 exec, vcc
    v_mov_b32 v11, 3

    s_mov_b64 exec, -1
    v_alignbyte_b32 v4, v5, v4, v11
    v_alignbyte_b32 v5, v6, v5, v11
    v_add_u32 v10, v10, v11

    buffer_store_dwordx2 v[4:5], v10, s[24:27], 0 offen
    v_cmp_ne_u32_sdwa s[80:81], v13, v15 src0_sel:WORD_1 src1_sel:WORD_1
    v_cmp_ne_u32_sdwa vcc, v13, v17 src0_sel:WORD_1 src1_sel:WORD_1
    v_alignbyte_b32 v16, v17, v16, 2
    s_mov_b32 s54, 66557
    v_alignbyte_b32 v13, v13, v12, 1
    v_perm_b32 v12, v12, v16, s47
    s_waitcnt lgkmcnt(2)
    v_add3_u32 v18, v18, v106, s54
    v_sub_u32 v19, 0, v18
    v_and_b32 v19, 3, v19
    s_mov_b64 exec, s[80:81]
    v_mov_b32 v19, 0
    v_mov_b32 v14, 0
    s_mov_b64 exec, vcc
    v_mov_b32 v19, 3

    s_mov_b64 exec, -1
    v_alignbyte_b32 v12, v13, v12, v19
    v_alignbyte_b32 v13, v14, v13, v19
    v_add_u32 v18, v18, v19

    buffer_store_dwordx2 v[12:13], v18, s[24:27], 0 offen
    v_cmp_ne_u32_sdwa s[80:81], v21, v23 src0_sel:WORD_1 src1_sel:WORD_1
    v_cmp_ne_u32_sdwa vcc, v21, v25 src0_sel:WORD_1 src1_sel:WORD_1
    v_alignbyte_b32 v24, v25, v24, 2
    s_mov_b32 s54, 71677
    v_alignbyte_b32 v21, v21, v20, 1
    v_perm_b32 v20, v20, v24, s47
    s_waitcnt lgkmcnt(1)
    v_add3_u32 v26, v26, v106, s54
    v_sub_u32 v27, 0, v26
    v_and_b32 v27, 3, v27
    s_mov_b64 exec, s[80:81]
    v_mov_b32 v27, 0
    v_mov_b32 v22, 0
    s_mov_b64 exec, vcc
    v_mov_b32 v27, 3

    s_mov_b64 exec, -1
    v_alignbyte_b32 v20, v21, v20, v27
    v_alignbyte_b32 v21, v22, v21, v27
    v_add_u32 v26, v26, v27

    buffer_store_dwordx2 v[20:21], v26, s[24:27], 0 offen
    v_cmp_ne_u32_sdwa s[80:81], v29, v31 src0_sel:WORD_1 src1_sel:WORD_1
    v_cmp_ne_u32_sdwa vcc, v29, v33 src0_sel:WORD_1 src1_sel:WORD_1
    v_alignbyte_b32 v32, v33, v32, 2
    s_mov_b32 s54, 76797
    v_alignbyte_b32 v29, v29, v28, 1
    v_perm_b32 v28, v28, v32, s47
    s_waitcnt lgkmcnt(0)
    v_add3_u32 v34, v34, v106, s54
    v_sub_u32 v35, 0, v34
    v_and_b32 v35, 3, v35
    s_mov_b64 exec, s[80:81]
    v_mov_b32 v35, 0
    v_mov_b32 v30, 0
    s_mov_b64 exec, vcc
    v_mov_b32 v35, 3

    s_andn2_b64 exec, -1, s[68:69]
    v_bfrev_b32 v34, 1
    s_mov_b64 exec, -1
    v_alignbyte_b32 v28, v29, v28, v35
    v_alignbyte_b32 v29, v30, v29, v35
    v_add_u32 v34, v34, v35

    buffer_store_dwordx2 v[28:29], v34, s[24:27], 0 offen
L_skw_45:
L_p1done_1:
    s_endpgm

L_ska_7:
    v_bfrev_b32 v126, 1
    buffer_load_dword v3, v126, s[96:99], 0 offen
    buffer_load_dword v3, v126, s[96:99], 0 offen
    buffer_load_dword v3, v126, s[96:99], 0 offen
    s_branch L_bka_8
L_ska_9:
    v_bfrev_b32 v126, 1
    buffer_load_dword v3, v126, s[96:99], 0 offen
    buffer_load_dword v3, v126, s[96:99], 0 offen
    buffer_load_dword v3, v126, s[96:99], 0 offen
    s_branch L_bka_10
L_ska_11:
    v_bfrev_b32 v126, 1
    buffer_load_dword v3, v126, s[96:99], 0 offen
    buffer_load_dword v3, v126, s[96:99], 0 offen
    buffer_load_dword v3, v126, s[96:99], 0 offen
    s_branch L_bka_12
L_ska_13:
    v_bfrev_b32 v126, 1
    buffer_load_dword v3, v126, s[96:99], 0 offen
    buffer_load_dword v3, v126, s[96:99], 0 offen
    buffer_load_dword v3, v126, s[96:99], 0 offen
    s_branch L_bka_14
L_full_25:
    v_mov_b32 v110, 0
    s_mov_b64 exec, vcc
    v_bfrev_b32 v92, 1
    v_bfrev_b32 v93, 1
    s_mov_b64 exec, 1
    buffer_atomic_or v104, v110, s[36:39], 0 offen
    s_mov_b64 exec, -1
    s_branch L_fback_26

L_full_40:
    v_mov_b32 v110, 0
    s_mov_b64 exec, vcc
    v_bfrev_b32 v92, 1
    v_bfrev_b32 v93, 1
    s_mov_b64 exec, 1
    buffer_atomic_or v104, v110, s[36:39], 0 offen
    s_mov_b64 exec, -1
    s_branch L_fback_41

.globl standalone__molecular_angular_gemnet__graph_kernel
.p2align 8
.type standalone__molecular_angular_gemnet__graph_kernel,@function
standalone__molecular_angular_gemnet__graph_kernel:
    s_cmp_ge_u32 s2, 256
    s_cbranch_scc1 L_p2done_46
    s_load_dwordx2 s[8:9], s[0:1], 0
    s_load_dwordx2 s[6:7], s[0:1], 104
    v_lshrrev_b32 v4, 6, v0
    s_lshr_b32 s37, s2, 1
    s_and_b32 s37, s37, 3
    s_lshr_b32 s36, s2, 3
    s_lshl_b32 s36, s36, 1
    s_and_b32 s3, s2, 1
    s_or_b32 s36, s36, s3
    v_readfirstlane_b32 s4, v4
    v_and_b32 v2, 63, v0
    v_lshrrev_b32 v3, 9, v0
    v_lshl_or_b32 v2, v3, 6, v2
    v_mul_u32_u24 v2, 20, v2
    v_lshlrev_b32 v3, 4, v0

    s_waitcnt lgkmcnt(0)
    s_lshl_b32 m0, s4, 10
    s_and_b32 s5, s4, 7
    s_lshr_b32 s39, s4, 3
    s_lshl_b32 s39, s39, 8
    s_mul_i32 s3, s5, 4096
    s_add_u32 s46, s6, s3
    s_addc_u32 s47, s7, 0
    s_mul_i32 s3, s5, 67117056
    s_add_u32 s3, s3, 83623936
    s_add_u32 s44, s6, s3
    s_addc_u32 s45, s7, 0
    s_mul_i32 s38, s37, 8
    s_add_u32 s4, s38, 8
    s_lshl_b32 s3, s38, 6
    s_add_u32 s3, s3, s36
    s_lshr_b32 s3, s3, 1
    s_lshl_b32 s3, s3, 2
    s_add_u32 s52, s46, s3
    s_addc_u32 s53, s47, 0

    s_load_dword s88, s[52:53], 0
    s_load_dword s89, s[52:53], 128
    s_load_dword s90, s[52:53], 256
    s_load_dword s91, s[52:53], 384
    s_load_dword s92, s[52:53], 512
    s_load_dword s93, s[52:53], 640
    s_load_dword s94, s[52:53], 768
    s_load_dword s95, s[52:53], 896
    s_mov_b32 s3, 32768
    s_load_dword s51, s[6:7], s3
    s_mov_b32 s10, 6400000
    s_mov_b32 s11, 0x20000

    s_add_u32 s12, s6, 393216
    s_addc_u32 s13, s7, 0
    s_mov_b32 s14, 0
    s_mov_b32 s15, 0x20000
    s_add_u32 s60, s6, 393216
    s_addc_u32 s61, s7, 0
    s_mov_b32 s62, 6406144
    s_mov_b32 s63, 0x20000
    s_mov_b32 s3, 135176
    s_load_dword s33, s[6:7], s3

    s_mul_i32 s43, s38, 200192
    s_mul_i32 s41, s4, 200192
    s_mul_i32 s50, s38, 200000
    s_add_u32 s14, s43, 50000

    buffer_load_dwordx4 v[76:79], v3, s[12:15], s43 offen
    s_add_u32 s52, s43, 16384
    buffer_load_dwordx4 v[80:83], v3, s[12:15], s52 offen
    s_add_u32 s52, s43, 32768
    buffer_load_dwordx4 v[84:87], v3, s[12:15], s52 offen
    s_add_u32 s52, s43, 49152
    v_lshlrev_b32 v119, 2, v0
    buffer_load_dword v88, v119, s[12:15], s52 offen
    s_add_u32 s20, s6, 135168
    s_addc_u32 s21, s7, 0
    s_mov_b32 s22, 4096
    s_mov_b32 s23, 0x20000
    v_and_b32 v44, 63, v0
    v_lshlrev_b32 v44, 4, v44
    buffer_load_dwordx2 v[120:121], v44, s[20:23], 0 offen offset:0
    buffer_load_dwordx2 v[122:123], v44, s[20:23], 0 offen offset:1024
    buffer_load_dwordx2 v[124:125], v44, s[20:23], 0 offen offset:2048
    buffer_load_dwordx2 v[126:127], v44, s[20:23], 0 offen offset:3072
    s_movk_i32 s40, 3072
    s_mov_b32 s19, 0x20000
    s_min_u32 s40, s40, 6552
    s_lshl_b32 s52, s38, 6
    s_add_u32 s52, s52, s36
    s_mul_i32 s52, s52, 32764
    s_add_u32 s16, s44, s52
    s_addc_u32 s17, s45, 0
    s_mul_i32 s52, s40, 5
    s_add_u32 s52, s52, 3
    s_and_b32 s18, s52, -4

    s_movk_i32 s53, 5120
    buffer_load_dwordx4 v[90:93], v2, s[16:19], s53 offen
    buffer_load_dword v110, v2, s[16:19], s53 offen offset:16
    s_movk_i32 s53, 7680
    buffer_load_dwordx4 v[94:97], v2, s[16:19], s53 offen
    buffer_load_dword v111, v2, s[16:19], s53 offen offset:16
    s_movk_i32 s53, 10240
    buffer_load_dwordx4 v[98:101], v2, s[16:19], s53 offen
    buffer_load_dword v112, v2, s[16:19], s53 offen offset:16
    s_lshr_b32 s3, s2, 3
    s_mul_i32 s3, s3, 49
    v_add_lshl_u32 v89, v0, s3, 7
    v_cmp_gt_u32 vcc, 49, v0
    v_bfrev_b32 v28, 1
    s_nop 0
    v_cndmask_b32 v89, v28, v89, vcc

    s_mov_b32 s19, 0x20000
    s_mov_b32 s28, 0x4b404000
    s_mov_b32 s29, 0x4b404000
    s_mov_b32 s30, 0xbfffc000
    s_mov_b32 s31, 0xbfffbfff
    s_mov_b32 s32, 0xffff0000
    s_mov_b32 s35, 0x05040100
    s_mov_b32 s97, 0x07060302
    s_mov_b32 s96, 0x40008000
    s_movk_i32 s3, 212
    v_cmp_gt_u32 s[48:49], s3, v0

    v_mov_b32 v1, 0
    s_mov_b32 s24, 0xc0c0004
    s_mov_b32 s25, 0xc0c0105
    s_mov_b32 s26, 0xc0c0206
    s_mov_b32 s27, 0xc0c0307
    v_mov_b32 v28, 0x40004000
    v_mov_b32 v29, 0x40004000
    v_mov_b32 v30, 0x40004000
    v_mov_b32 v31, 0x40004000
    v_add_u32 v32, 50000, v3
    v_add_u32 v33, 65536, v32

    ds_write_b128 v32, v[28:31] offset:0
    ds_write_b128 v32, v[28:31] offset:16384
    ds_write_b128 v32, v[28:31] offset:32768
    ds_write_b128 v32, v[28:31] offset:49152
    ds_write_b128 v33, v[28:31] offset:0
    ds_write_b128 v33, v[28:31] offset:16384
    v_cmp_gt_u32 vcc, 971, v0
    s_mov_b64 exec, vcc
    ds_write_b128 v33, v[28:31] offset:32768
    s_mov_b64 exec, -1
    s_waitcnt vmcnt(13)
    ds_write_addtid_b32 v76 offset:0
    ds_write_addtid_b32 v77 offset:256
    ds_write_addtid_b32 v78 offset:512
    ds_write_addtid_b32 v79 offset:768
    s_waitcnt vmcnt(12)
    ds_write_addtid_b32 v80 offset:16384
    ds_write_addtid_b32 v81 offset:16640
    ds_write_addtid_b32 v82 offset:16896
    ds_write_addtid_b32 v83 offset:17152
    s_waitcnt vmcnt(11)
    ds_write_addtid_b32 v84 offset:32768
    ds_write_addtid_b32 v85 offset:33024
    ds_write_addtid_b32 v86 offset:33280
    ds_write_addtid_b32 v87 offset:33536
    v_lshlrev_b32 v119, 2, v0
    s_waitcnt vmcnt(10)
    s_mov_b64 exec, s[48:49]
    ds_write_b32 v119, v88 offset:49152
    s_mov_b64 exec, -1
    s_add_u32 s43, s43, 50048
    s_add_u32 s14, s43, 50000
    s_min_u32 s14, s14, s41
    s_and_b32 s3, s36, 1
    s_lshl_b32 s3, s3, 4
    s_or_b32 s3, s3, 0x100000
    s_waitcnt lgkmcnt(0)

    s_bfe_u32 s88, s88, s3
    s_bfe_u32 s89, s89, s3
    s_bfe_u32 s90, s90, s3
    s_bfe_u32 s91, s91, s3
    s_bfe_u32 s92, s92, s3
    s_bfe_u32 s93, s93, s3
    s_bfe_u32 s94, s94, s3
    s_bfe_u32 s95, s95, s3
    s_waitcnt vmcnt(6)
    v_max3_u32 v120, v120, v122, v124
    v_add_f32 v121, v121, v123
    v_add_f32 v125, v125, v127
    v_max_u32 v120, v120, v126
    v_add_f32 v121, v121, v125

    s_nop 1
    v_max_u32_dpp v120, v120, v120 row_shr:1 row_mask:0xf bank_mask:0xf
    s_nop 1
    v_max_u32_dpp v120, v120, v120 row_shr:2 row_mask:0xf bank_mask:0xf
    s_nop 1
    v_max_u32_dpp v120, v120, v120 row_shr:4 row_mask:0xf bank_mask:0xf
    s_nop 1
    v_max_u32_dpp v120, v120, v120 row_shr:8 row_mask:0xf bank_mask:0xf
    s_nop 1
    v_max_u32_dpp v120, v120, v120 row_bcast:15 row_mask:0xa bank_mask:0xf
    s_nop 1
    v_max_u32_dpp v120, v120, v120 row_bcast:31 row_mask:0xc bank_mask:0xf
    s_nop 1
    v_add_f32_dpp v121, v121, v121 row_shr:1 row_mask:0xf bank_mask:0xf
    s_nop 1
    v_add_f32_dpp v121, v121, v121 row_shr:2 row_mask:0xf bank_mask:0xf
    s_nop 1
    v_add_f32_dpp v121, v121, v121 row_shr:4 row_mask:0xf bank_mask:0xf
    s_nop 1
    v_add_f32_dpp v121, v121, v121 row_shr:8 row_mask:0xf bank_mask:0xf
    s_nop 1
    v_add_f32_dpp v121, v121, v121 row_bcast:15 row_mask:0xa bank_mask:0xf
    s_nop 1
    v_add_f32_dpp v121, v121, v121 row_bcast:31 row_mask:0xc bank_mask:0xf
    v_lshlrev_b32 v120, 16, v120
    v_mul_f32 v121, 0x34a7c5ac, v121
    v_sqrt_f32 v121, v121
    v_mul_f32 v120, s33, v120
    v_mul_f32 v121, s33, v121
    v_cmp_gt_f32 vcc, 0x46fde800, v120
    s_mov_b64 s[64:65], vcc
    v_cmp_lt_f32 vcc, 0x44000000, v121
    v_mov_b32 v120, 0x37800000
    v_mul_f32 v120, s33, v120
    s_and_b64 vcc, vcc, s[64:65]
    v_mul_f32 v121, 0x46ff8000, v120
    v_rcp_f32 v121, v121
    v_readfirstlane_b32 s33, v120
    s_waitcnt lgkmcnt(0)
    s_barrier
    v_readfirstlane_b32 s34, v121
    v_mov_b32 v120, 150016
    v_mov_b32 v121, 0
    ds_write_b32 v120, v121 offset:8
    s_bitcmp0_b64 vcc, 63
    s_cbranch_scc1 L_p2slow_47
    s_cmp_lg_u32 s51, 0
    s_cbranch_scc1 L_p2slow_47

    s_min_u32 s88, s88, 6552
    s_lshl_b32 s52, s38, 6
    s_add_u32 s52, s52, s36
    s_mul_i32 s52, s52, 32764
    s_add_u32 s16, s44, s52
    s_addc_u32 s17, s45, 0
    s_mul_i32 s52, s88, 5
    s_add_u32 s52, s52, 3
    s_and_b32 s18, s52, -4

    s_movk_i32 s53, 12800
    buffer_load_dwordx4 v[102:105], v2, s[16:19], s53 offen
    buffer_load_dword v113, v2, s[16:19], s53 offen offset:16
    s_movk_i32 s53, 0
    buffer_load_dwordx4 v[4:7], v2, s[16:19], s53 offen
    buffer_load_dword v35, v2, s[16:19], s53 offen offset:16
    s_movk_i32 s53, 2560
    buffer_load_dwordx4 v[8:11], v2, s[16:19], s53 offen
    buffer_load_dword v43, v2, s[16:19], s53 offen offset:16
    s_movk_i32 s53, 15360
    buffer_load_dwordx4 v[106:109], v2, s[16:19], s53 offen
    buffer_load_dword v114, v2, s[16:19], s53 offen offset:16
    s_mov_b32 s40, s88
    s_sub_u32 s42, s40, s39

    s_add_u32 s55, s38, 1
    s_min_u32 s55, s55, 31
    s_mov_b32 s88, s89
    s_mov_b32 s89, s90
    s_mov_b32 s90, s91
    s_mov_b32 s91, s92
    s_mov_b32 s92, s93
    s_mov_b32 s93, s94
    s_mov_b32 s94, s95
    s_mov_b32 s95, 0
    s_min_u32 s88, s88, 6552
    s_lshl_b32 s52, s55, 6
    s_add_u32 s52, s52, s36
    s_mul_i32 s52, s52, 32764
    s_add_u32 s16, s44, s52
    s_addc_u32 s17, s45, 0
    s_mul_i32 s52, s88, 5
    s_add_u32 s52, s52, 3
    s_and_b32 s18, s52, -4

    s_waitcnt vmcnt(12)
    v_perm_b32 v44, v91, v90, s24
    v_perm_b32 v46, v92, v91, s25
    v_perm_b32 v48, v93, v92, s26
    v_perm_b32 v50, v110, v93, s27
    v_mov_b32 v12, v90
    v_alignbyte_b32 v13, v92, v91, 1
    v_alignbyte_b32 v14, v93, v92, 2
    v_alignbyte_b32 v15, v110, v93, 3
    v_lshlrev_b32_sdwa v44, 3, v44 dst_sel:WORD_0 dst_unused:UNUSED_PAD src0_sel:DWORD src1_sel:DWORD
    v_lshlrev_b32_sdwa v46, 3, v46 dst_sel:WORD_0 dst_unused:UNUSED_PAD src0_sel:DWORD src1_sel:DWORD
    v_lshlrev_b32_sdwa v48, 3, v48 dst_sel:WORD_0 dst_unused:UNUSED_PAD src0_sel:DWORD src1_sel:DWORD
    v_lshlrev_b32_sdwa v50, 3, v50 dst_sel:WORD_0 dst_unused:UNUSED_PAD src0_sel:DWORD src1_sel:DWORD
    s_cmp_lt_i32 s42, 1280
    s_cbranch_scc1 L_ufix_48
L_uback_49:

    v_subrev_co_u32 v12, s[80:81], 2.0, v12
    v_subrev_co_u32 v13, s[82:83], 2.0, v13
    v_subrev_co_u32 v14, s[84:85], 2.0, v14
    v_subrev_co_u32 v15, s[86:87], 2.0, v15
    s_mov_b64 exec, s[80:81]
    ds_read_b64 v[44:45], v44
    s_mov_b64 exec, s[82:83]
    ds_read_b64 v[46:47], v46
    s_mov_b64 exec, s[84:85]
    ds_read_b64 v[48:49], v48
    s_mov_b64 exec, s[86:87]
    ds_read_b64 v[50:51], v50
    s_mov_b64 exec, -1
    s_waitcnt vmcnt(10)
    v_perm_b32 v52, v95, v94, s24
    v_perm_b32 v54, v96, v95, s25
    v_perm_b32 v56, v97, v96, s26
    v_perm_b32 v58, v111, v97, s27
    v_mov_b32 v16, v94
    v_alignbyte_b32 v17, v96, v95, 1
    v_alignbyte_b32 v18, v97, v96, 2
    v_alignbyte_b32 v19, v111, v97, 3
    v_lshlrev_b32_sdwa v52, 3, v52 dst_sel:WORD_0 dst_unused:UNUSED_PAD src0_sel:DWORD src1_sel:DWORD
    v_lshlrev_b32_sdwa v54, 3, v54 dst_sel:WORD_0 dst_unused:UNUSED_PAD src0_sel:DWORD src1_sel:DWORD
    v_lshlrev_b32_sdwa v56, 3, v56 dst_sel:WORD_0 dst_unused:UNUSED_PAD src0_sel:DWORD src1_sel:DWORD
    v_lshlrev_b32_sdwa v58, 3, v58 dst_sel:WORD_0 dst_unused:UNUSED_PAD src0_sel:DWORD src1_sel:DWORD
    s_cmp_lt_i32 s42, 1792
    s_cbranch_scc1 L_ufix_50
L_uback_51:

    v_subrev_co_u32 v16, s[64:65], 2.0, v16
    v_subrev_co_u32 v17, s[66:67], 2.0, v17
    v_subrev_co_u32 v18, s[68:69], 2.0, v18
    v_subrev_co_u32 v19, s[70:71], 2.0, v19
    s_mov_b64 exec, s[64:65]
    ds_read_b64 v[52:53], v52
    s_mov_b64 exec, s[66:67]
    ds_read_b64 v[54:55], v54
    s_mov_b64 exec, s[68:69]
    ds_read_b64 v[56:57], v56
    s_mov_b64 exec, s[70:71]
    ds_read_b64 v[58:59], v58
    s_mov_b64 exec, -1
    s_waitcnt vmcnt(8)
    v_perm_b32 v60, v99, v98, s24
    v_perm_b32 v62, v100, v99, s25
    v_perm_b32 v64, v101, v100, s26
    v_perm_b32 v66, v112, v101, s27
    v_mov_b32 v20, v98
    v_alignbyte_b32 v21, v100, v99, 1
    v_alignbyte_b32 v22, v101, v100, 2
    v_alignbyte_b32 v23, v112, v101, 3
    v_lshlrev_b32_sdwa v60, 3, v60 dst_sel:WORD_0 dst_unused:UNUSED_PAD src0_sel:DWORD src1_sel:DWORD
    v_lshlrev_b32_sdwa v62, 3, v62 dst_sel:WORD_0 dst_unused:UNUSED_PAD src0_sel:DWORD src1_sel:DWORD
    v_lshlrev_b32_sdwa v64, 3, v64 dst_sel:WORD_0 dst_unused:UNUSED_PAD src0_sel:DWORD src1_sel:DWORD
    v_lshlrev_b32_sdwa v66, 3, v66 dst_sel:WORD_0 dst_unused:UNUSED_PAD src0_sel:DWORD src1_sel:DWORD
    s_cmp_lt_i32 s42, 2304
    s_cbranch_scc1 L_ufix_52
L_uback_53:

    v_subrev_co_u32 v20, s[72:73], 2.0, v20
    v_subrev_co_u32 v21, s[74:75], 2.0, v21
    v_subrev_co_u32 v22, s[76:77], 2.0, v22
    v_subrev_co_u32 v23, s[78:79], 2.0, v23
    s_mov_b64 exec, s[72:73]
    ds_read_b64 v[60:61], v60
    s_mov_b64 exec, s[74:75]
    ds_read_b64 v[62:63], v62
    s_mov_b64 exec, s[76:77]
    ds_read_b64 v[64:65], v64
    s_mov_b64 exec, s[78:79]
    ds_read_b64 v[66:67], v66
    s_mov_b64 exec, -1
    s_waitcnt vmcnt(6)
    v_perm_b32 v68, v103, v102, s24
    v_perm_b32 v70, v104, v103, s25
    v_perm_b32 v72, v105, v104, s26
    v_perm_b32 v74, v113, v105, s27
    v_mov_b32 v24, v102
    v_alignbyte_b32 v25, v104, v103, 1
    v_alignbyte_b32 v26, v105, v104, 2
    v_alignbyte_b32 v27, v113, v105, 3
    v_lshlrev_b32_sdwa v68, 3, v68 dst_sel:WORD_0 dst_unused:UNUSED_PAD src0_sel:DWORD src1_sel:DWORD
    v_lshlrev_b32_sdwa v70, 3, v70 dst_sel:WORD_0 dst_unused:UNUSED_PAD src0_sel:DWORD src1_sel:DWORD
    v_lshlrev_b32_sdwa v72, 3, v72 dst_sel:WORD_0 dst_unused:UNUSED_PAD src0_sel:DWORD src1_sel:DWORD
    v_lshlrev_b32_sdwa v74, 3, v74 dst_sel:WORD_0 dst_unused:UNUSED_PAD src0_sel:DWORD src1_sel:DWORD
    s_cmp_lt_i32 s42, 2816
    s_cbranch_scc1 L_ufix_54
L_uback_55:

    v_subrev_co_u32 v24, s[80:81], 2.0, v24
    v_subrev_co_u32 v25, s[82:83], 2.0, v25
    v_subrev_co_u32 v26, s[84:85], 2.0, v26
    v_subrev_co_u32 v27, s[86:87], 2.0, v27
    s_mov_b64 exec, s[80:81]
    ds_read_b64 v[68:69], v68
    s_mov_b64 exec, s[82:83]
    ds_read_b64 v[70:71], v70
    s_mov_b64 exec, s[84:85]
    ds_read_b64 v[72:73], v72
    s_mov_b64 exec, s[86:87]
    ds_read_b64 v[74:75], v74
    s_mov_b64 exec, -1
    s_waitcnt vmcnt(4)
    v_perm_b32 v28, v5, v4, s24
    v_perm_b32 v30, v6, v5, s25
    v_perm_b32 v32, v7, v6, s26
    v_perm_b32 v34, v35, v7, s27
    v_alignbyte_b32 v5, v6, v5, 1
    v_alignbyte_b32 v6, v7, v6, 2
    v_alignbyte_b32 v7, v35, v7, 3
    v_lshlrev_b32_sdwa v28, 3, v28 dst_sel:WORD_0 dst_unused:UNUSED_PAD src0_sel:DWORD src1_sel:DWORD
    v_lshlrev_b32_sdwa v30, 3, v30 dst_sel:WORD_0 dst_unused:UNUSED_PAD src0_sel:DWORD src1_sel:DWORD
    v_lshlrev_b32_sdwa v32, 3, v32 dst_sel:WORD_0 dst_unused:UNUSED_PAD src0_sel:DWORD src1_sel:DWORD
    v_lshlrev_b32_sdwa v34, 3, v34 dst_sel:WORD_0 dst_unused:UNUSED_PAD src0_sel:DWORD src1_sel:DWORD
    s_cmp_lt_i32 s42, 256
    s_cbranch_scc1 L_ufix_56
L_uback_57:

    v_subrev_co_u32 v4, s[64:65], 2.0, v4
    v_subrev_co_u32 v5, s[66:67], 2.0, v5
    v_subrev_co_u32 v6, s[68:69], 2.0, v6
    v_subrev_co_u32 v7, s[70:71], 2.0, v7
    s_mov_b64 exec, s[64:65]
    ds_read_b64 v[28:29], v28
    s_mov_b64 exec, s[66:67]
    ds_read_b64 v[30:31], v30
    s_mov_b64 exec, s[68:69]
    ds_read_b64 v[32:33], v32
    s_mov_b64 exec, s[70:71]
    ds_read_b64 v[34:35], v34
    s_mov_b64 exec, -1
    buffer_load_dwordx4 v[76:79], v3, s[12:15], s43 offen
    s_add_u32 s52, s43, 16384
    buffer_load_dwordx4 v[80:83], v3, s[12:15], s52 offen
    s_add_u32 s52, s43, 32768
    buffer_load_dwordx4 v[84:87], v3, s[12:15], s52 offen
    s_add_u32 s52, s43, 49152
    v_lshlrev_b32 v119, 2, v0
    buffer_load_dword v88, v119, s[12:15], s52 offen
    s_add_u32 s54, s43, 50048
    buffer_load_dword v115, v89, s[60:63], s54 offen
    s_add_u32 s54, s50, 0
    buffer_load_dword v115, v89, s[8:11], s54 offen
    s_waitcnt vmcnt(8)
    v_perm_b32 v36, v9, v8, s24
    v_perm_b32 v38, v10, v9, s25
    v_perm_b32 v40, v11, v10, s26
    v_perm_b32 v42, v43, v11, s27
    v_alignbyte_b32 v9, v10, v9, 1
    v_alignbyte_b32 v10, v11, v10, 2
    v_alignbyte_b32 v11, v43, v11, 3
    v_lshlrev_b32_sdwa v36, 3, v36 dst_sel:WORD_0 dst_unused:UNUSED_PAD src0_sel:DWORD src1_sel:DWORD
    v_lshlrev_b32_sdwa v38, 3, v38 dst_sel:WORD_0 dst_unused:UNUSED_PAD src0_sel:DWORD src1_sel:DWORD
    v_lshlrev_b32_sdwa v40, 3, v40 dst_sel:WORD_0 dst_unused:UNUSED_PAD src0_sel:DWORD src1_sel:DWORD
    v_lshlrev_b32_sdwa v42, 3, v42 dst_sel:WORD_0 dst_unused:UNUSED_PAD src0_sel:DWORD src1_sel:DWORD
    s_cmp_lt_i32 s42, 768
    s_cbranch_scc1 L_ufix_58
L_uback_59:

    v_subrev_co_u32 v8, s[72:73], 2.0, v8
    v_subrev_co_u32 v9, s[74:75], 2.0, v9
    v_subrev_co_u32 v10, s[76:77], 2.0, v10
    v_subrev_co_u32 v11, s[78:79], 2.0, v11
    s_mov_b64 exec, s[72:73]
    ds_read_b64 v[36:37], v36
    s_mov_b64 exec, s[74:75]
    ds_read_b64 v[38:39], v38
    s_mov_b64 exec, s[76:77]
    ds_read_b64 v[40:41], v40
    s_mov_b64 exec, s[78:79]
    ds_read_b64 v[42:43], v42
    s_mov_b64 exec, -1
    s_movk_i32 s53, 5120
    buffer_load_dwordx4 v[90:93], v2, s[16:19], s53 offen
    buffer_load_dword v110, v2, s[16:19], s53 offen offset:16
L_batch_60:
    s_add_u32 s5, s38, 1

    s_movk_i32 s53, 7680
    buffer_load_dwordx4 v[94:97], v2, s[16:19], s53 offen
    buffer_load_dword v111, v2, s[16:19], s53 offen offset:16
    v_subrev_co_u32 v4, s[64:65], 2.0, v4
    v_subrev_co_u32 v5, s[66:67], 2.0, v5
    v_subrev_co_u32 v6, s[68:69], 2.0, v6
    v_subrev_co_u32 v7, s[70:71], 2.0, v7
    v_subrev_co_u32 v8, s[72:73], 2.0, v8
    v_subrev_co_u32 v9, s[74:75], 2.0, v9
    v_subrev_co_u32 v10, s[76:77], 2.0, v10
    v_subrev_co_u32 v11, s[78:79], 2.0, v11
    v_subrev_co_u32 v12, s[80:81], 2.0, v12
    v_subrev_co_u32 v13, s[82:83], 2.0, v13
    v_subrev_co_u32 v14, s[84:85], 2.0, v14
    v_subrev_co_u32 v15, s[86:87], 2.0, v15
    s_waitcnt lgkmcnt(0)
    s_barrier
    s_waitcnt vmcnt(5)
    ds_write_addtid_b32 v76 offset:0
    ds_write_addtid_b32 v77 offset:256
    ds_write_addtid_b32 v78 offset:512
    ds_write_addtid_b32 v79 offset:768
    s_waitcnt vmcnt(4)
    ds_write_addtid_b32 v80 offset:16384
    ds_write_addtid_b32 v81 offset:16640
    ds_write_addtid_b32 v82 offset:16896
    ds_write_addtid_b32 v83 offset:17152
    s_waitcnt vmcnt(3)
    ds_write_addtid_b32 v84 offset:32768
    ds_write_addtid_b32 v85 offset:33024
    ds_write_addtid_b32 v86 offset:33280
    ds_write_addtid_b32 v87 offset:33536
    v_lshlrev_b32 v119, 2, v0
    s_waitcnt vmcnt(2)
    s_mov_b64 exec, s[48:49]
    ds_write_b32 v119, v88 offset:49152
    s_mov_b64 exec, -1
    s_add_u32 s43, s43, 50048
    s_add_u32 s14, s43, 50000
    s_min_u32 s14, s14, s41
    buffer_load_dwordx4 v[76:79], v3, s[12:15], s43 offen
    s_waitcnt lgkmcnt(0)
    s_barrier
    s_add_u32 s52, s43, 16384
    buffer_load_dwordx4 v[80:83], v3, s[12:15], s52 offen
    s_add_u32 s52, s43, 32768
    buffer_load_dwordx4 v[84:87], v3, s[12:15], s52 offen
    s_add_u32 s52, s43, 49152
    v_lshlrev_b32 v119, 2, v0
    buffer_load_dword v88, v119, s[12:15], s52 offen
    s_mov_b64 exec, s[64:65]
    ds_read_b64 v[28:29], v28
    s_mov_b64 exec, s[66:67]
    ds_read_b64 v[30:31], v30
    s_mov_b64 exec, s[68:69]
    ds_read_b64 v[32:33], v32
    s_mov_b64 exec, s[70:71]
    ds_read_b64 v[34:35], v34
    s_mov_b64 exec, s[72:73]
    ds_read_b64 v[36:37], v36
    s_mov_b64 exec, s[74:75]
    ds_read_b64 v[38:39], v38
    s_mov_b64 exec, s[76:77]
    ds_read_b64 v[40:41], v40
    s_mov_b64 exec, s[78:79]
    ds_read_b64 v[42:43], v42
    s_mov_b64 exec, s[80:81]
    ds_read_b64 v[44:45], v44
    s_mov_b64 exec, s[82:83]
    ds_read_b64 v[46:47], v46
    s_mov_b64 exec, s[84:85]
    ds_read_b64 v[48:49], v48
    s_mov_b64 exec, s[86:87]
    ds_read_b64 v[50:51], v50
    s_mov_b64 exec, -1
    v_subrev_co_u32 v16, s[64:65], 2.0, v16
    v_subrev_co_u32 v17, s[66:67], 2.0, v17
    v_subrev_co_u32 v18, s[68:69], 2.0, v18
    v_subrev_co_u32 v19, s[70:71], 2.0, v19
    v_subrev_co_u32 v20, s[72:73], 2.0, v20
    v_subrev_co_u32 v21, s[74:75], 2.0, v21
    v_subrev_co_u32 v22, s[76:77], 2.0, v22
    v_subrev_co_u32 v23, s[78:79], 2.0, v23
    v_subrev_co_u32 v24, s[80:81], 2.0, v24
    v_subrev_co_u32 v25, s[82:83], 2.0, v25
    v_subrev_co_u32 v26, s[84:85], 2.0, v26
    v_subrev_co_u32 v27, s[86:87], 2.0, v27
    s_mov_b64 exec, s[64:65]
    ds_read_b64 v[52:53], v52
    s_mov_b64 exec, s[66:67]
    ds_read_b64 v[54:55], v54
    s_mov_b64 exec, s[68:69]
    ds_read_b64 v[56:57], v56
    s_mov_b64 exec, s[70:71]
    ds_read_b64 v[58:59], v58
    s_mov_b64 exec, s[72:73]
    ds_read_b64 v[60:61], v60
    s_mov_b64 exec, s[74:75]
    ds_read_b64 v[62:63], v62
    s_mov_b64 exec, s[76:77]
    ds_read_b64 v[64:65], v64
    s_mov_b64 exec, s[78:79]
    ds_read_b64 v[66:67], v66
    s_mov_b64 exec, s[80:81]
    ds_read_b64 v[68:69], v68
    s_mov_b64 exec, s[82:83]
    ds_read_b64 v[70:71], v70
    s_mov_b64 exec, s[84:85]
    ds_read_b64 v[72:73], v72
    s_mov_b64 exec, s[86:87]
    ds_read_b64 v[74:75], v74
    s_mov_b64 exec, -1
    s_cmp_le_i32 s42, 3072
    s_cbranch_scc1 L_nt1_62
    s_waitcnt vmcnt(14)
    v_perm_b32 v120, v107, v106, s24
    v_perm_b32 v122, v108, v107, s25
    v_perm_b32 v124, v109, v108, s26
    v_perm_b32 v126, v114, v109, s27
    v_alignbyte_b32 v107, v108, v107, 1
    v_alignbyte_b32 v108, v109, v108, 2
    v_alignbyte_b32 v109, v114, v109, 3
    v_lshlrev_b32_sdwa v120, 3, v120 dst_sel:WORD_0 dst_unused:UNUSED_PAD src0_sel:DWORD src1_sel:DWORD
    v_lshlrev_b32_sdwa v122, 3, v122 dst_sel:WORD_0 dst_unused:UNUSED_PAD src0_sel:DWORD src1_sel:DWORD
    v_lshlrev_b32_sdwa v124, 3, v124 dst_sel:WORD_0 dst_unused:UNUSED_PAD src0_sel:DWORD src1_sel:DWORD
    v_lshlrev_b32_sdwa v126, 3, v126 dst_sel:WORD_0 dst_unused:UNUSED_PAD src0_sel:DWORD src1_sel:DWORD
    s_cmp_lt_i32 s42, 3328
    s_cbranch_scc1 L_ufix_65
L_uback_66:

    v_lshrrev_b32 v117, 30, v106
    v_and_b32 v106, 0x3fffffff, v106
    v_mul_u32_u24 v117, 50000, v117
    v_cmp_ne_u32 vcc, 0, v106
    v_add_u32 v120, v120, v117
    s_mov_b64 exec, vcc

    buffer_load_dwordx2 v[120:121], v120, s[8:11], s50 offen
    s_mov_b64 exec, -1
    v_lshrrev_b32 v117, 30, v107
    v_and_b32 v107, 0x3fffffff, v107
    v_mul_u32_u24 v117, 50000, v117
    v_cmp_ne_u32 vcc, 0, v107
    v_add_u32 v122, v122, v117
    s_mov_b64 exec, vcc

    buffer_load_dwordx2 v[122:123], v122, s[8:11], s50 offen
    s_mov_b64 exec, -1
    v_lshrrev_b32 v117, 30, v108
    v_and_b32 v108, 0x3fffffff, v108
    v_mul_u32_u24 v117, 50000, v117
    v_cmp_ne_u32 vcc, 0, v108
    v_add_u32 v124, v124, v117
    s_mov_b64 exec, vcc

    buffer_load_dwordx2 v[124:125], v124, s[8:11], s50 offen
    s_mov_b64 exec, -1
    v_lshrrev_b32 v117, 30, v109
    v_and_b32 v109, 0x3fffffff, v109
    v_mul_u32_u24 v117, 50000, v117
    v_cmp_ne_u32 vcc, 0, v109
    v_add_u32 v126, v126, v117
    s_mov_b64 exec, vcc

    buffer_load_dwordx2 v[126:127], v126, s[8:11], s50 offen
    s_mov_b64 exec, -1
L_nt1_62:
    v_subrev_co_u32 v4, s[64:65], 2.0, v4
    v_subrev_co_u32 v5, s[66:67], 2.0, v5
    v_subrev_co_u32 v6, s[68:69], 2.0, v6
    v_subrev_co_u32 v7, s[70:71], 2.0, v7
    v_subrev_co_u32 v8, s[72:73], 2.0, v8
    v_subrev_co_u32 v9, s[74:75], 2.0, v9
    v_subrev_co_u32 v10, s[76:77], 2.0, v10
    v_subrev_co_u32 v11, s[78:79], 2.0, v11
    v_subrev_co_u32 v12, s[80:81], 2.0, v12
    v_subrev_co_u32 v13, s[82:83], 2.0, v13
    v_subrev_co_u32 v14, s[84:85], 2.0, v14
    v_subrev_co_u32 v15, s[86:87], 2.0, v15
    s_waitcnt lgkmcnt(0)
    s_barrier
    s_waitcnt vmcnt(3)
    ds_write_addtid_b32 v76 offset:0
    ds_write_addtid_b32 v77 offset:256
    ds_write_addtid_b32 v78 offset:512
    ds_write_addtid_b32 v79 offset:768
    s_waitcnt vmcnt(2)
    ds_write_addtid_b32 v80 offset:16384
    ds_write_addtid_b32 v81 offset:16640
    ds_write_addtid_b32 v82 offset:16896
    ds_write_addtid_b32 v83 offset:17152
    s_waitcnt vmcnt(1)
    ds_write_addtid_b32 v84 offset:32768
    ds_write_addtid_b32 v85 offset:33024
    ds_write_addtid_b32 v86 offset:33280
    ds_write_addtid_b32 v87 offset:33536
    v_lshlrev_b32 v119, 2, v0
    s_waitcnt vmcnt(0)
    s_mov_b64 exec, s[48:49]
    ds_write_b32 v119, v88 offset:49152
    s_mov_b64 exec, -1
    s_add_u32 s43, s43, 50048
    s_add_u32 s14, s43, 50000
    s_min_u32 s14, s14, s41
    buffer_load_dwordx4 v[76:79], v3, s[12:15], s43 offen
    s_waitcnt lgkmcnt(0)
    s_barrier
    s_add_u32 s52, s43, 16384
    buffer_load_dwordx4 v[80:83], v3, s[12:15], s52 offen
    s_add_u32 s52, s43, 32768
    buffer_load_dwordx4 v[84:87], v3, s[12:15], s52 offen
    s_add_u32 s52, s43, 49152
    v_lshlrev_b32 v119, 2, v0
    buffer_load_dword v88, v119, s[12:15], s52 offen
    s_mov_b64 exec, s[64:65]
    ds_read_b64 v[28:29], v28
    s_mov_b64 exec, s[66:67]
    ds_read_b64 v[30:31], v30
    s_mov_b64 exec, s[68:69]
    ds_read_b64 v[32:33], v32
    s_mov_b64 exec, s[70:71]
    ds_read_b64 v[34:35], v34
    s_mov_b64 exec, s[72:73]
    ds_read_b64 v[36:37], v36
    s_mov_b64 exec, s[74:75]
    ds_read_b64 v[38:39], v38
    s_mov_b64 exec, s[76:77]
    ds_read_b64 v[40:41], v40
    s_mov_b64 exec, s[78:79]
    ds_read_b64 v[42:43], v42
    s_mov_b64 exec, s[80:81]
    ds_read_b64 v[44:45], v44
    s_mov_b64 exec, s[82:83]
    ds_read_b64 v[46:47], v46
    s_mov_b64 exec, s[84:85]
    ds_read_b64 v[48:49], v48
    s_mov_b64 exec, s[86:87]
    ds_read_b64 v[50:51], v50
    s_mov_b64 exec, -1
    v_subrev_co_u32 v16, s[64:65], 2.0, v16
    v_subrev_co_u32 v17, s[66:67], 2.0, v17
    v_subrev_co_u32 v18, s[68:69], 2.0, v18
    v_subrev_co_u32 v19, s[70:71], 2.0, v19
    v_subrev_co_u32 v20, s[72:73], 2.0, v20
    v_subrev_co_u32 v21, s[74:75], 2.0, v21
    v_subrev_co_u32 v22, s[76:77], 2.0, v22
    v_subrev_co_u32 v23, s[78:79], 2.0, v23
    v_subrev_co_u32 v24, s[80:81], 2.0, v24
    v_subrev_co_u32 v25, s[82:83], 2.0, v25
    v_subrev_co_u32 v26, s[84:85], 2.0, v26
    v_subrev_co_u32 v27, s[86:87], 2.0, v27
    s_mov_b64 exec, s[64:65]
    ds_read_b64 v[52:53], v52
    s_mov_b64 exec, s[66:67]
    ds_read_b64 v[54:55], v54
    s_mov_b64 exec, s[68:69]
    ds_read_b64 v[56:57], v56
    s_mov_b64 exec, s[70:71]
    ds_read_b64 v[58:59], v58
    s_mov_b64 exec, s[72:73]
    ds_read_b64 v[60:61], v60
    s_mov_b64 exec, s[74:75]
    ds_read_b64 v[62:63], v62
    s_mov_b64 exec, s[76:77]
    ds_read_b64 v[64:65], v64
    s_mov_b64 exec, s[78:79]
    ds_read_b64 v[66:67], v66
    s_mov_b64 exec, s[80:81]
    ds_read_b64 v[68:69], v68
    s_mov_b64 exec, s[82:83]
    ds_read_b64 v[70:71], v70
    s_mov_b64 exec, s[84:85]
    ds_read_b64 v[72:73], v72
    s_mov_b64 exec, s[86:87]
    ds_read_b64 v[74:75], v74
    s_mov_b64 exec, -1
    s_movk_i32 s53, 10240
    buffer_load_dwordx4 v[98:101], v2, s[16:19], s53 offen
    buffer_load_dword v112, v2, s[16:19], s53 offen offset:16
    s_cmp_le_i32 s42, 3072
    s_cbranch_scc1 L_nt2_63
    s_waitcnt vmcnt(6)
    v_cmp_ne_u32 s[56:57], 0, v106
    v_cmp_ne_u32 s[58:59], 0, v107
    v_cmp_ne_u32 s[98:99], 0, v108
    v_cmp_ne_u32 vcc, 0, v109
    s_mov_b64 exec, s[56:57]
    v_cvt_f32_i32_sdwa v118, sext(v106) dst_sel:DWORD dst_unused:UNUSED_PAD src0_sel:WORD_0
    v_lshlrev_b32 v116, 16, v120
    v_and_b32 v117, s32, v120
    v_mul_f32 v118, s33, v118
    v_lshlrev_b32 v120, 16, v121
    v_and_b32 v121, s32, v121
    v_lshlrev_b32_sdwa v106, 3, v106 dst_sel:DWORD dst_unused:UNUSED_PAD src0_sel:DWORD src1_sel:WORD_1
    v_pk_fma_f32 v[116:117], v[116:117], v[118:119], s[28:29] op_sel_hi:[1,0,1]
    v_pk_fma_f32 v[120:121], v[120:121], v[118:119], s[28:29] op_sel_hi:[1,0,1]
    v_perm_b32 v116, v117, v116, s35
    v_perm_b32 v117, v121, v120, s35
    v_lshl_add_u64 v[116:117], v[116:117], 0, s[30:31]
    ds_add_rtn_u64 v[120:121], v106, v[116:117] offset:50000

    s_mov_b64 exec, s[58:59]
    v_cvt_f32_i32_sdwa v118, sext(v107) dst_sel:DWORD dst_unused:UNUSED_PAD src0_sel:WORD_0
    v_lshlrev_b32 v116, 16, v122
    v_and_b32 v117, s32, v122
    v_mul_f32 v118, s33, v118
    v_lshlrev_b32 v122, 16, v123
    v_and_b32 v123, s32, v123
    v_lshlrev_b32_sdwa v107, 3, v107 dst_sel:DWORD dst_unused:UNUSED_PAD src0_sel:DWORD src1_sel:WORD_1
    v_pk_fma_f32 v[116:117], v[116:117], v[118:119], s[28:29] op_sel_hi:[1,0,1]
    v_pk_fma_f32 v[122:123], v[122:123], v[118:119], s[28:29] op_sel_hi:[1,0,1]
    v_perm_b32 v116, v117, v116, s35
    v_perm_b32 v117, v123, v122, s35
    v_lshl_add_u64 v[116:117], v[116:117], 0, s[30:31]
    ds_add_rtn_u64 v[122:123], v107, v[116:117] offset:50000

    s_mov_b64 exec, s[98:99]
    v_cvt_f32_i32_sdwa v118, sext(v108) dst_sel:DWORD dst_unused:UNUSED_PAD src0_sel:WORD_0
    v_lshlrev_b32 v116, 16, v124
    v_and_b32 v117, s32, v124
    v_mul_f32 v118, s33, v118
    v_lshlrev_b32 v124, 16, v125
    v_and_b32 v125, s32, v125
    v_lshlrev_b32_sdwa v108, 3, v108 dst_sel:DWORD dst_unused:UNUSED_PAD src0_sel:DWORD src1_sel:WORD_1
    v_pk_fma_f32 v[116:117], v[116:117], v[118:119], s[28:29] op_sel_hi:[1,0,1]
    v_pk_fma_f32 v[124:125], v[124:125], v[118:119], s[28:29] op_sel_hi:[1,0,1]
    v_perm_b32 v116, v117, v116, s35
    v_perm_b32 v117, v125, v124, s35
    v_lshl_add_u64 v[116:117], v[116:117], 0, s[30:31]
    ds_add_rtn_u64 v[124:125], v108, v[116:117] offset:50000

    s_mov_b64 exec, vcc
    v_cvt_f32_i32_sdwa v118, sext(v109) dst_sel:DWORD dst_unused:UNUSED_PAD src0_sel:WORD_0
    v_lshlrev_b32 v116, 16, v126
    v_and_b32 v117, s32, v126
    v_mul_f32 v118, s33, v118
    v_lshlrev_b32 v126, 16, v127
    v_and_b32 v127, s32, v127
    v_lshlrev_b32_sdwa v109, 3, v109 dst_sel:DWORD dst_unused:UNUSED_PAD src0_sel:DWORD src1_sel:WORD_1
    v_pk_fma_f32 v[116:117], v[116:117], v[118:119], s[28:29] op_sel_hi:[1,0,1]
    v_pk_fma_f32 v[126:127], v[126:127], v[118:119], s[28:29] op_sel_hi:[1,0,1]
    v_perm_b32 v116, v117, v116, s35
    v_perm_b32 v117, v127, v126, s35
    v_lshl_add_u64 v[116:117], v[116:117], 0, s[30:31]
    ds_add_rtn_u64 v[126:127], v109, v[116:117] offset:50000

    s_waitcnt lgkmcnt(0)
    s_mov_b64 exec, s[56:57]
    v_or3_b32 v1, v120, v121, v1
    s_mov_b64 exec, s[58:59]
    v_or3_b32 v1, v122, v123, v1
    s_mov_b64 exec, s[98:99]
    v_or3_b32 v1, v124, v125, v1
    s_mov_b64 exec, vcc
    v_or3_b32 v1, v126, v127, v1
    s_mov_b64 exec, -1
L_nt2_63:
    s_movk_i32 s53, 15360
    buffer_load_dwordx4 v[106:109], v2, s[16:19], s53 offen
    buffer_load_dword v114, v2, s[16:19], s53 offen offset:16
    s_cmp_le_u32 s40, 3584
    s_cbranch_scc1 L_noleft_64
    s_min_u32 s40, s40, 6552
    s_lshl_b32 s52, s38, 6
    s_add_u32 s52, s52, s36
    s_mul_i32 s52, s52, 32764
    s_add_u32 s20, s44, s52
    s_addc_u32 s21, s45, 0
    s_mul_i32 s52, s40, 5
    s_add_u32 s52, s52, 3
    s_and_b32 s22, s52, -4

    s_lshr_b32 s55, s39, 2
    s_add_u32 s55, s55, 3584
    v_and_b32 v120, 63, v0
    v_add_u32 v120, s55, v120
L_left_67:
    s_cmp_ge_u32 s55, s40
    s_cbranch_scc1 L_leftend_68
    v_mul_u32_u24 v121, 5, v120
    buffer_load_dword v122, v121, s[20:23], 0 offen
    buffer_load_ubyte v123, v121, s[20:23], 0 offen offset:4
    s_waitcnt vmcnt(0)

    v_perm_b32 v121, v123, v122, s24
    v_lshrrev_b32 v126, 30, v122
    v_and_b32 v121, 0x1fff, v121
    v_mul_u32_u24 v126, 6250, v126
    v_add_lshl_u32 v121, v121, v126, 3

    buffer_load_dwordx2 v[124:125], v121, s[8:11], s50 offen
    v_cmp_gt_u32 vcc, s40, v120
    s_waitcnt vmcnt(0)

    s_mov_b64 exec, vcc
    v_and_b32 v122, 0x3fffffff, v122
    v_cvt_f32_i32_sdwa v118, sext(v122) dst_sel:DWORD dst_unused:UNUSED_PAD src0_sel:WORD_0
    v_lshlrev_b32 v116, 16, v124
    v_and_b32 v117, s32, v124
    v_mul_f32 v118, s33, v118
    v_lshlrev_b32 v124, 16, v125
    v_and_b32 v125, s32, v125
    v_lshlrev_b32_sdwa v122, 3, v122 dst_sel:DWORD dst_unused:UNUSED_PAD src0_sel:DWORD src1_sel:WORD_1
    v_pk_fma_f32 v[116:117], v[116:117], v[118:119], s[28:29] op_sel_hi:[1,0,1]
    v_pk_fma_f32 v[124:125], v[124:125], v[118:119], s[28:29] op_sel_hi:[1,0,1]
    v_perm_b32 v116, v117, v116, s35
    v_perm_b32 v117, v125, v124, s35
    v_lshl_add_u64 v[116:117], v[116:117], 0, s[30:31]
    ds_add_rtn_u64 v[124:125], v122, v[116:117] offset:50000

    s_waitcnt lgkmcnt(0)
    v_or3_b32 v1, v124, v125, v1
    s_mov_b64 exec, -1
    v_add_u32 v120, 128, v120
    s_add_u32 s55, s55, 128
    s_branch L_left_67
L_leftend_68:

L_noleft_64:
    v_cmp_gt_u32 s[64:65], 2.0, v4
    v_and_b32 v4, 0x3fffffff, v4
    v_cmp_gt_u32 s[66:67], 2.0, v5
    v_and_b32 v5, 0x3fffffff, v5
    v_cmp_gt_u32 s[68:69], 2.0, v6
    v_and_b32 v6, 0x3fffffff, v6
    v_cmp_gt_u32 s[70:71], 2.0, v7
    v_and_b32 v7, 0x3fffffff, v7
    v_cmp_gt_u32 s[72:73], 2.0, v8
    v_and_b32 v8, 0x3fffffff, v8
    v_cmp_gt_u32 s[74:75], 2.0, v9
    v_and_b32 v9, 0x3fffffff, v9
    v_cmp_gt_u32 s[76:77], 2.0, v10
    v_and_b32 v10, 0x3fffffff, v10
    v_cmp_gt_u32 s[78:79], 2.0, v11
    v_and_b32 v11, 0x3fffffff, v11
    v_cmp_gt_u32 s[80:81], 2.0, v12
    v_and_b32 v12, 0x3fffffff, v12
    v_cmp_gt_u32 s[82:83], 2.0, v13
    v_and_b32 v13, 0x3fffffff, v13
    v_cmp_gt_u32 s[84:85], 2.0, v14
    v_and_b32 v14, 0x3fffffff, v14
    v_cmp_gt_u32 s[86:87], 2.0, v15
    v_and_b32 v15, 0x3fffffff, v15
    s_waitcnt lgkmcnt(0)
    s_barrier
    s_waitcnt vmcnt(7)
    ds_write_addtid_b32 v76 offset:0
    ds_write_addtid_b32 v77 offset:256
    ds_write_addtid_b32 v78 offset:512
    ds_write_addtid_b32 v79 offset:768
    s_waitcnt vmcnt(6)
    ds_write_addtid_b32 v80 offset:16384
    ds_write_addtid_b32 v81 offset:16640
    ds_write_addtid_b32 v82 offset:16896
    ds_write_addtid_b32 v83 offset:17152
    s_waitcnt vmcnt(5)
    ds_write_addtid_b32 v84 offset:32768
    ds_write_addtid_b32 v85 offset:33024
    ds_write_addtid_b32 v86 offset:33280
    ds_write_addtid_b32 v87 offset:33536
    v_lshlrev_b32 v119, 2, v0
    s_waitcnt vmcnt(4)
    s_mov_b64 exec, s[48:49]
    ds_write_b32 v119, v88 offset:49152
    s_mov_b64 exec, -1
    s_add_u32 s43, s43, 50048
    s_add_u32 s14, s43, 50000
    s_min_u32 s14, s14, s41
    buffer_load_dwordx4 v[76:79], v3, s[12:15], s43 offen
    s_waitcnt lgkmcnt(0)
    s_barrier
    s_add_u32 s52, s43, 16384
    buffer_load_dwordx4 v[80:83], v3, s[12:15], s52 offen
    s_add_u32 s52, s43, 32768
    buffer_load_dwordx4 v[84:87], v3, s[12:15], s52 offen
    s_add_u32 s52, s43, 49152
    v_lshlrev_b32 v119, 2, v0
    buffer_load_dword v88, v119, s[12:15], s52 offen
    s_mov_b64 exec, s[64:65]
    ds_read_b64 v[28:29], v28
    s_mov_b64 exec, s[66:67]
    ds_read_b64 v[30:31], v30
    s_mov_b64 exec, s[68:69]
    ds_read_b64 v[32:33], v32
    s_mov_b64 exec, s[70:71]
    ds_read_b64 v[34:35], v34
    s_mov_b64 exec, s[72:73]
    ds_read_b64 v[36:37], v36
    s_mov_b64 exec, s[74:75]
    ds_read_b64 v[38:39], v38
    s_mov_b64 exec, s[76:77]
    ds_read_b64 v[40:41], v40
    s_mov_b64 exec, s[78:79]
    ds_read_b64 v[42:43], v42
    s_mov_b64 exec, s[80:81]
    ds_read_b64 v[44:45], v44
    s_mov_b64 exec, s[82:83]
    ds_read_b64 v[46:47], v46
    s_mov_b64 exec, s[84:85]
    ds_read_b64 v[48:49], v48
    s_mov_b64 exec, s[86:87]
    ds_read_b64 v[50:51], v50
    s_mov_b64 exec, -1
    v_cmp_gt_u32 s[64:65], 2.0, v16
    v_and_b32 v16, 0x3fffffff, v16
    v_cmp_gt_u32 s[66:67], 2.0, v17
    v_and_b32 v17, 0x3fffffff, v17
    v_cmp_gt_u32 s[68:69], 2.0, v18
    v_and_b32 v18, 0x3fffffff, v18
    v_cmp_gt_u32 s[70:71], 2.0, v19
    v_and_b32 v19, 0x3fffffff, v19
    v_cmp_gt_u32 s[72:73], 2.0, v20
    v_and_b32 v20, 0x3fffffff, v20
    v_cmp_gt_u32 s[74:75], 2.0, v21
    v_and_b32 v21, 0x3fffffff, v21
    v_cmp_gt_u32 s[76:77], 2.0, v22
    v_and_b32 v22, 0x3fffffff, v22
    v_cmp_gt_u32 s[78:79], 2.0, v23
    v_and_b32 v23, 0x3fffffff, v23
    v_cmp_gt_u32 s[80:81], 2.0, v24
    v_and_b32 v24, 0x3fffffff, v24
    v_cmp_gt_u32 s[82:83], 2.0, v25
    v_and_b32 v25, 0x3fffffff, v25
    v_cmp_gt_u32 s[84:85], 2.0, v26
    v_and_b32 v26, 0x3fffffff, v26
    v_cmp_gt_u32 s[86:87], 2.0, v27
    v_and_b32 v27, 0x3fffffff, v27
    s_mov_b64 exec, s[64:65]
    ds_read_b64 v[52:53], v52
    s_mov_b64 exec, s[66:67]
    ds_read_b64 v[54:55], v54
    s_mov_b64 exec, s[68:69]
    ds_read_b64 v[56:57], v56
    s_mov_b64 exec, s[70:71]
    ds_read_b64 v[58:59], v58
    s_mov_b64 exec, s[72:73]
    ds_read_b64 v[60:61], v60
    s_mov_b64 exec, s[74:75]
    ds_read_b64 v[62:63], v62
    s_mov_b64 exec, s[76:77]
    ds_read_b64 v[64:65], v64
    s_mov_b64 exec, s[78:79]
    ds_read_b64 v[66:67], v66
    s_mov_b64 exec, s[80:81]
    ds_read_b64 v[68:69], v68
    s_mov_b64 exec, s[82:83]
    ds_read_b64 v[70:71], v70
    s_mov_b64 exec, s[84:85]
    ds_read_b64 v[72:73], v72
    s_mov_b64 exec, s[86:87]
    ds_read_b64 v[74:75], v74
    s_mov_b64 exec, -1
    s_movk_i32 s53, 12800
    buffer_load_dwordx4 v[102:105], v2, s[16:19], s53 offen
    buffer_load_dword v113, v2, s[16:19], s53 offen offset:16
    s_cmp_ge_u32 s5, s4
    s_cbranch_scc1 L_bend_61
    s_waitcnt lgkmcnt(15)
    v_mad_i32_i16 v120, v28, v4, s96
    v_mad_i32_i16 v28, v28, v4, s96 op_sel:[1,0,0,0]
    v_mad_i32_i16 v121, v29, v4, s96
    v_mad_i32_i16 v29, v29, v4, s96 op_sel:[1,0,0,0]
    v_lshlrev_b32_sdwa v4, 3, v4 dst_sel:DWORD dst_unused:UNUSED_PAD src0_sel:DWORD src1_sel:WORD_1
    v_perm_b32 v28, v28, v120, s97
    v_perm_b32 v29, v29, v121, s97
    v_lshl_add_u64 v[28:29], v[28:29], 0, s[30:31]

    ds_add_rtn_u64 v[28:29], v4, v[28:29] offset:50000
    v_mad_i32_i16 v122, v30, v5, s96
    v_mad_i32_i16 v30, v30, v5, s96 op_sel:[1,0,0,0]
    v_mad_i32_i16 v123, v31, v5, s96
    v_mad_i32_i16 v31, v31, v5, s96 op_sel:[1,0,0,0]
    v_lshlrev_b32_sdwa v5, 3, v5 dst_sel:DWORD dst_unused:UNUSED_PAD src0_sel:DWORD src1_sel:WORD_1
    v_perm_b32 v30, v30, v122, s97
    v_perm_b32 v31, v31, v123, s97
    v_lshl_add_u64 v[30:31], v[30:31], 0, s[30:31]

    ds_add_rtn_u64 v[30:31], v5, v[30:31] offset:50000
    v_mad_i32_i16 v124, v32, v6, s96
    v_mad_i32_i16 v32, v32, v6, s96 op_sel:[1,0,0,0]
    v_mad_i32_i16 v125, v33, v6, s96
    v_mad_i32_i16 v33, v33, v6, s96 op_sel:[1,0,0,0]
    v_lshlrev_b32_sdwa v6, 3, v6 dst_sel:DWORD dst_unused:UNUSED_PAD src0_sel:DWORD src1_sel:WORD_1
    v_perm_b32 v32, v32, v124, s97
    v_perm_b32 v33, v33, v125, s97
    v_lshl_add_u64 v[32:33], v[32:33], 0, s[30:31]

    ds_add_rtn_u64 v[32:33], v6, v[32:33] offset:50000
    v_mad_i32_i16 v126, v34, v7, s96
    v_mad_i32_i16 v34, v34, v7, s96 op_sel:[1,0,0,0]
    v_mad_i32_i16 v127, v35, v7, s96
    v_mad_i32_i16 v35, v35, v7, s96 op_sel:[1,0,0,0]
    v_lshlrev_b32_sdwa v7, 3, v7 dst_sel:DWORD dst_unused:UNUSED_PAD src0_sel:DWORD src1_sel:WORD_1
    v_perm_b32 v34, v34, v126, s97
    v_perm_b32 v35, v35, v127, s97
    v_lshl_add_u64 v[34:35], v[34:35], 0, s[30:31]

    ds_add_rtn_u64 v[34:35], v7, v[34:35] offset:50000
    v_mad_i32_i16 v120, v36, v8, s96
    v_mad_i32_i16 v36, v36, v8, s96 op_sel:[1,0,0,0]
    v_mad_i32_i16 v121, v37, v8, s96
    v_mad_i32_i16 v37, v37, v8, s96 op_sel:[1,0,0,0]
    v_lshlrev_b32_sdwa v8, 3, v8 dst_sel:DWORD dst_unused:UNUSED_PAD src0_sel:DWORD src1_sel:WORD_1
    v_perm_b32 v36, v36, v120, s97
    v_perm_b32 v37, v37, v121, s97
    v_lshl_add_u64 v[36:37], v[36:37], 0, s[30:31]

    ds_add_rtn_u64 v[36:37], v8, v[36:37] offset:50000
    v_mad_i32_i16 v122, v38, v9, s96
    v_mad_i32_i16 v38, v38, v9, s96 op_sel:[1,0,0,0]
    v_mad_i32_i16 v123, v39, v9, s96
    v_mad_i32_i16 v39, v39, v9, s96 op_sel:[1,0,0,0]
    v_lshlrev_b32_sdwa v9, 3, v9 dst_sel:DWORD dst_unused:UNUSED_PAD src0_sel:DWORD src1_sel:WORD_1
    v_perm_b32 v38, v38, v122, s97
    v_perm_b32 v39, v39, v123, s97
    v_lshl_add_u64 v[38:39], v[38:39], 0, s[30:31]

    ds_add_rtn_u64 v[38:39], v9, v[38:39] offset:50000
    v_mad_i32_i16 v124, v40, v10, s96
    v_mad_i32_i16 v40, v40, v10, s96 op_sel:[1,0,0,0]
    v_mad_i32_i16 v125, v41, v10, s96
    v_mad_i32_i16 v41, v41, v10, s96 op_sel:[1,0,0,0]
    v_lshlrev_b32_sdwa v10, 3, v10 dst_sel:DWORD dst_unused:UNUSED_PAD src0_sel:DWORD src1_sel:WORD_1
    v_perm_b32 v40, v40, v124, s97
    v_perm_b32 v41, v41, v125, s97
    v_lshl_add_u64 v[40:41], v[40:41], 0, s[30:31]

    ds_add_rtn_u64 v[40:41], v10, v[40:41] offset:50000
    v_mad_i32_i16 v126, v42, v11, s96
    v_mad_i32_i16 v42, v42, v11, s96 op_sel:[1,0,0,0]
    v_mad_i32_i16 v127, v43, v11, s96
    v_mad_i32_i16 v43, v43, v11, s96 op_sel:[1,0,0,0]
    v_lshlrev_b32_sdwa v11, 3, v11 dst_sel:DWORD dst_unused:UNUSED_PAD src0_sel:DWORD src1_sel:WORD_1
    v_perm_b32 v42, v42, v126, s97
    v_perm_b32 v43, v43, v127, s97
    v_lshl_add_u64 v[42:43], v[42:43], 0, s[30:31]

    ds_add_rtn_u64 v[42:43], v11, v[42:43] offset:50000
    s_waitcnt lgkmcnt(4)
    v_or3_b32 v1, v28, v29, v1
    v_or3_b32 v1, v30, v31, v1
    v_or3_b32 v1, v32, v33, v1
    v_or3_b32 v1, v34, v35, v1
    s_movk_i32 s53, 0
    buffer_load_dwordx4 v[4:7], v2, s[16:19], s53 offen
    buffer_load_dword v35, v2, s[16:19], s53 offen offset:16
    v_mad_i32_i16 v120, v44, v12, s96
    v_mad_i32_i16 v44, v44, v12, s96 op_sel:[1,0,0,0]
    v_mad_i32_i16 v121, v45, v12, s96
    v_mad_i32_i16 v45, v45, v12, s96 op_sel:[1,0,0,0]
    v_lshlrev_b32_sdwa v12, 3, v12 dst_sel:DWORD dst_unused:UNUSED_PAD src0_sel:DWORD src1_sel:WORD_1
    v_perm_b32 v44, v44, v120, s97
    v_perm_b32 v45, v45, v121, s97
    v_lshl_add_u64 v[44:45], v[44:45], 0, s[30:31]

    ds_add_rtn_u64 v[44:45], v12, v[44:45] offset:50000
    v_mad_i32_i16 v122, v46, v13, s96
    v_mad_i32_i16 v46, v46, v13, s96 op_sel:[1,0,0,0]
    v_mad_i32_i16 v123, v47, v13, s96
    v_mad_i32_i16 v47, v47, v13, s96 op_sel:[1,0,0,0]
    v_lshlrev_b32_sdwa v13, 3, v13 dst_sel:DWORD dst_unused:UNUSED_PAD src0_sel:DWORD src1_sel:WORD_1
    v_perm_b32 v46, v46, v122, s97
    v_perm_b32 v47, v47, v123, s97
    v_lshl_add_u64 v[46:47], v[46:47], 0, s[30:31]

    ds_add_rtn_u64 v[46:47], v13, v[46:47] offset:50000
    v_mad_i32_i16 v124, v48, v14, s96
    v_mad_i32_i16 v48, v48, v14, s96 op_sel:[1,0,0,0]
    v_mad_i32_i16 v125, v49, v14, s96
    v_mad_i32_i16 v49, v49, v14, s96 op_sel:[1,0,0,0]
    v_lshlrev_b32_sdwa v14, 3, v14 dst_sel:DWORD dst_unused:UNUSED_PAD src0_sel:DWORD src1_sel:WORD_1
    v_perm_b32 v48, v48, v124, s97
    v_perm_b32 v49, v49, v125, s97
    v_lshl_add_u64 v[48:49], v[48:49], 0, s[30:31]

    ds_add_rtn_u64 v[48:49], v14, v[48:49] offset:50000
    v_mad_i32_i16 v126, v50, v15, s96
    v_mad_i32_i16 v50, v50, v15, s96 op_sel:[1,0,0,0]
    v_mad_i32_i16 v127, v51, v15, s96
    v_mad_i32_i16 v51, v51, v15, s96 op_sel:[1,0,0,0]
    v_lshlrev_b32_sdwa v15, 3, v15 dst_sel:DWORD dst_unused:UNUSED_PAD src0_sel:DWORD src1_sel:WORD_1
    v_perm_b32 v50, v50, v126, s97
    v_perm_b32 v51, v51, v127, s97
    v_lshl_add_u64 v[50:51], v[50:51], 0, s[30:31]

    ds_add_rtn_u64 v[50:51], v15, v[50:51] offset:50000
    s_waitcnt lgkmcnt(4)
    v_or3_b32 v1, v36, v37, v1
    v_or3_b32 v1, v38, v39, v1
    v_or3_b32 v1, v40, v41, v1
    v_or3_b32 v1, v42, v43, v1
    s_movk_i32 s53, 2560
    buffer_load_dwordx4 v[8:11], v2, s[16:19], s53 offen
    buffer_load_dword v43, v2, s[16:19], s53 offen offset:16
    s_barrier
    s_waitcnt vmcnt(9)
    ds_write_addtid_b32 v76 offset:0
    ds_write_addtid_b32 v77 offset:256
    ds_write_addtid_b32 v78 offset:512
    ds_write_addtid_b32 v79 offset:768
    s_waitcnt vmcnt(8)
    ds_write_addtid_b32 v80 offset:16384
    ds_write_addtid_b32 v81 offset:16640
    ds_write_addtid_b32 v82 offset:16896
    ds_write_addtid_b32 v83 offset:17152
    s_waitcnt vmcnt(7)
    ds_write_addtid_b32 v84 offset:32768
    ds_write_addtid_b32 v85 offset:33024
    ds_write_addtid_b32 v86 offset:33280
    ds_write_addtid_b32 v87 offset:33536
    v_lshlrev_b32 v119, 2, v0
    s_waitcnt vmcnt(6)
    s_mov_b64 exec, s[48:49]
    ds_write_b32 v119, v88 offset:49152
    s_mov_b64 exec, -1
    s_add_u32 s43, s43, 50048
    s_add_u32 s14, s43, 50000
    s_min_u32 s14, s14, s41
    s_add_u32 s54, s43, 50048
    buffer_load_dword v115, v89, s[60:63], s54 offen
    s_add_u32 s54, s50, 200000
    buffer_load_dword v115, v89, s[8:11], s54 offen
    s_mov_b32 s40, s88
    s_sub_u32 s42, s40, s39

    s_add_u32 s55, s38, 2
    s_min_u32 s55, s55, 31
    s_mov_b32 s88, s89
    s_mov_b32 s89, s90
    s_mov_b32 s90, s91
    s_mov_b32 s91, s92
    s_mov_b32 s92, s93
    s_mov_b32 s93, s94
    s_mov_b32 s94, s95
    s_mov_b32 s95, 0
    s_min_u32 s88, s88, 6552
    s_lshl_b32 s52, s55, 6
    s_add_u32 s52, s52, s36
    s_mul_i32 s52, s52, 32764
    s_add_u32 s16, s44, s52
    s_addc_u32 s17, s45, 0
    s_mul_i32 s52, s88, 5
    s_add_u32 s52, s52, 3
    s_and_b32 s18, s52, -4

    v_mad_i32_i16 v120, v52, v16, s96
    v_mad_i32_i16 v52, v52, v16, s96 op_sel:[1,0,0,0]
    v_mad_i32_i16 v121, v53, v16, s96
    v_mad_i32_i16 v53, v53, v16, s96 op_sel:[1,0,0,0]
    v_lshlrev_b32_sdwa v16, 3, v16 dst_sel:DWORD dst_unused:UNUSED_PAD src0_sel:DWORD src1_sel:WORD_1
    v_perm_b32 v52, v52, v120, s97
    v_perm_b32 v53, v53, v121, s97
    v_lshl_add_u64 v[52:53], v[52:53], 0, s[30:31]

    ds_add_rtn_u64 v[52:53], v16, v[52:53] offset:50000
    v_mad_i32_i16 v122, v54, v17, s96
    v_mad_i32_i16 v54, v54, v17, s96 op_sel:[1,0,0,0]
    v_mad_i32_i16 v123, v55, v17, s96
    v_mad_i32_i16 v55, v55, v17, s96 op_sel:[1,0,0,0]
    v_lshlrev_b32_sdwa v17, 3, v17 dst_sel:DWORD dst_unused:UNUSED_PAD src0_sel:DWORD src1_sel:WORD_1
    v_perm_b32 v54, v54, v122, s97
    v_perm_b32 v55, v55, v123, s97
    v_lshl_add_u64 v[54:55], v[54:55], 0, s[30:31]

    ds_add_rtn_u64 v[54:55], v17, v[54:55] offset:50000
    v_mad_i32_i16 v124, v56, v18, s96
    v_mad_i32_i16 v56, v56, v18, s96 op_sel:[1,0,0,0]
    v_mad_i32_i16 v125, v57, v18, s96
    v_mad_i32_i16 v57, v57, v18, s96 op_sel:[1,0,0,0]
    v_lshlrev_b32_sdwa v18, 3, v18 dst_sel:DWORD dst_unused:UNUSED_PAD src0_sel:DWORD src1_sel:WORD_1
    v_perm_b32 v56, v56, v124, s97
    v_perm_b32 v57, v57, v125, s97
    v_lshl_add_u64 v[56:57], v[56:57], 0, s[30:31]

    ds_add_rtn_u64 v[56:57], v18, v[56:57] offset:50000
    v_mad_i32_i16 v126, v58, v19, s96
    v_mad_i32_i16 v58, v58, v19, s96 op_sel:[1,0,0,0]
    v_mad_i32_i16 v127, v59, v19, s96
    v_mad_i32_i16 v59, v59, v19, s96 op_sel:[1,0,0,0]
    v_lshlrev_b32_sdwa v19, 3, v19 dst_sel:DWORD dst_unused:UNUSED_PAD src0_sel:DWORD src1_sel:WORD_1
    v_perm_b32 v58, v58, v126, s97
    v_perm_b32 v59, v59, v127, s97
    v_lshl_add_u64 v[58:59], v[58:59], 0, s[30:31]

    ds_add_rtn_u64 v[58:59], v19, v[58:59] offset:50000
    s_waitcnt lgkmcnt(15)
    v_or3_b32 v1, v44, v45, v1
    v_or3_b32 v1, v46, v47, v1
    v_or3_b32 v1, v48, v49, v1
    v_or3_b32 v1, v50, v51, v1
    s_waitcnt vmcnt(26)
    v_perm_b32 v44, v91, v90, s24
    v_perm_b32 v46, v92, v91, s25
    v_perm_b32 v48, v93, v92, s26
    v_perm_b32 v50, v110, v93, s27
    v_mov_b32 v12, v90
    v_alignbyte_b32 v13, v92, v91, 1
    v_alignbyte_b32 v14, v93, v92, 2
    v_alignbyte_b32 v15, v110, v93, 3
    v_lshlrev_b32_sdwa v44, 3, v44 dst_sel:WORD_0 dst_unused:UNUSED_PAD src0_sel:DWORD src1_sel:DWORD
    v_lshlrev_b32_sdwa v46, 3, v46 dst_sel:WORD_0 dst_unused:UNUSED_PAD src0_sel:DWORD src1_sel:DWORD
    v_lshlrev_b32_sdwa v48, 3, v48 dst_sel:WORD_0 dst_unused:UNUSED_PAD src0_sel:DWORD src1_sel:DWORD
    v_lshlrev_b32_sdwa v50, 3, v50 dst_sel:WORD_0 dst_unused:UNUSED_PAD src0_sel:DWORD src1_sel:DWORD
    s_cmp_lt_i32 s42, 1280
    s_cbranch_scc1 L_ufix_69
L_uback_70:

    s_movk_i32 s53, 5120
    buffer_load_dwordx4 v[90:93], v2, s[16:19], s53 offen
    buffer_load_dword v110, v2, s[16:19], s53 offen offset:16
    s_waitcnt lgkmcnt(4)
    s_barrier
    v_subrev_co_u32 v12, s[80:81], 2.0, v12
    v_subrev_co_u32 v13, s[82:83], 2.0, v13
    v_subrev_co_u32 v14, s[84:85], 2.0, v14
    v_subrev_co_u32 v15, s[86:87], 2.0, v15
    s_mov_b64 exec, s[80:81]
    ds_read_b64 v[44:45], v44
    s_mov_b64 exec, s[82:83]
    ds_read_b64 v[46:47], v46
    s_mov_b64 exec, s[84:85]
    ds_read_b64 v[48:49], v48
    s_mov_b64 exec, s[86:87]
    ds_read_b64 v[50:51], v50
    s_mov_b64 exec, -1
    v_mad_i32_i16 v120, v60, v20, s96
    v_mad_i32_i16 v60, v60, v20, s96 op_sel:[1,0,0,0]
    v_mad_i32_i16 v121, v61, v20, s96
    v_mad_i32_i16 v61, v61, v20, s96 op_sel:[1,0,0,0]
    v_lshlrev_b32_sdwa v20, 3, v20 dst_sel:DWORD dst_unused:UNUSED_PAD src0_sel:DWORD src1_sel:WORD_1
    v_perm_b32 v60, v60, v120, s97
    v_perm_b32 v61, v61, v121, s97
    v_lshl_add_u64 v[60:61], v[60:61], 0, s[30:31]

    ds_add_rtn_u64 v[60:61], v20, v[60:61] offset:50000
    v_mad_i32_i16 v122, v62, v21, s96
    v_mad_i32_i16 v62, v62, v21, s96 op_sel:[1,0,0,0]
    v_mad_i32_i16 v123, v63, v21, s96
    v_mad_i32_i16 v63, v63, v21, s96 op_sel:[1,0,0,0]
    v_lshlrev_b32_sdwa v21, 3, v21 dst_sel:DWORD dst_unused:UNUSED_PAD src0_sel:DWORD src1_sel:WORD_1
    v_perm_b32 v62, v62, v122, s97
    v_perm_b32 v63, v63, v123, s97
    v_lshl_add_u64 v[62:63], v[62:63], 0, s[30:31]

    ds_add_rtn_u64 v[62:63], v21, v[62:63] offset:50000
    v_mad_i32_i16 v124, v64, v22, s96
    v_mad_i32_i16 v64, v64, v22, s96 op_sel:[1,0,0,0]
    v_mad_i32_i16 v125, v65, v22, s96
    v_mad_i32_i16 v65, v65, v22, s96 op_sel:[1,0,0,0]
    v_lshlrev_b32_sdwa v22, 3, v22 dst_sel:DWORD dst_unused:UNUSED_PAD src0_sel:DWORD src1_sel:WORD_1
    v_perm_b32 v64, v64, v124, s97
    v_perm_b32 v65, v65, v125, s97
    v_lshl_add_u64 v[64:65], v[64:65], 0, s[30:31]

    ds_add_rtn_u64 v[64:65], v22, v[64:65] offset:50000
    v_mad_i32_i16 v126, v66, v23, s96
    v_mad_i32_i16 v66, v66, v23, s96 op_sel:[1,0,0,0]
    v_mad_i32_i16 v127, v67, v23, s96
    v_mad_i32_i16 v67, v67, v23, s96 op_sel:[1,0,0,0]
    v_lshlrev_b32_sdwa v23, 3, v23 dst_sel:DWORD dst_unused:UNUSED_PAD src0_sel:DWORD src1_sel:WORD_1
    v_perm_b32 v66, v66, v126, s97
    v_perm_b32 v67, v67, v127, s97
    v_lshl_add_u64 v[66:67], v[66:67], 0, s[30:31]

    ds_add_rtn_u64 v[66:67], v23, v[66:67] offset:50000
    s_waitcnt lgkmcnt(8)
    v_or3_b32 v1, v52, v53, v1
    v_or3_b32 v1, v54, v55, v1
    v_or3_b32 v1, v56, v57, v1
    v_or3_b32 v1, v58, v59, v1
    s_waitcnt vmcnt(26)
    v_perm_b32 v52, v95, v94, s24
    v_perm_b32 v54, v96, v95, s25
    v_perm_b32 v56, v97, v96, s26
    v_perm_b32 v58, v111, v97, s27
    v_mov_b32 v16, v94
    v_alignbyte_b32 v17, v96, v95, 1
    v_alignbyte_b32 v18, v97, v96, 2
    v_alignbyte_b32 v19, v111, v97, 3
    v_lshlrev_b32_sdwa v52, 3, v52 dst_sel:WORD_0 dst_unused:UNUSED_PAD src0_sel:DWORD src1_sel:DWORD
    v_lshlrev_b32_sdwa v54, 3, v54 dst_sel:WORD_0 dst_unused:UNUSED_PAD src0_sel:DWORD src1_sel:DWORD
    v_lshlrev_b32_sdwa v56, 3, v56 dst_sel:WORD_0 dst_unused:UNUSED_PAD src0_sel:DWORD src1_sel:DWORD
    v_lshlrev_b32_sdwa v58, 3, v58 dst_sel:WORD_0 dst_unused:UNUSED_PAD src0_sel:DWORD src1_sel:DWORD
    s_cmp_lt_i32 s42, 1792
    s_cbranch_scc1 L_ufix_71
L_uback_72:

    v_subrev_co_u32 v16, s[64:65], 2.0, v16
    v_subrev_co_u32 v17, s[66:67], 2.0, v17
    v_subrev_co_u32 v18, s[68:69], 2.0, v18
    v_subrev_co_u32 v19, s[70:71], 2.0, v19
    s_mov_b64 exec, s[64:65]
    ds_read_b64 v[52:53], v52
    s_mov_b64 exec, s[66:67]
    ds_read_b64 v[54:55], v54
    s_mov_b64 exec, s[68:69]
    ds_read_b64 v[56:57], v56
    s_mov_b64 exec, s[70:71]
    ds_read_b64 v[58:59], v58
    s_mov_b64 exec, -1
    v_mad_i32_i16 v120, v68, v24, s96
    v_mad_i32_i16 v68, v68, v24, s96 op_sel:[1,0,0,0]
    v_mad_i32_i16 v121, v69, v24, s96
    v_mad_i32_i16 v69, v69, v24, s96 op_sel:[1,0,0,0]
    v_lshlrev_b32_sdwa v24, 3, v24 dst_sel:DWORD dst_unused:UNUSED_PAD src0_sel:DWORD src1_sel:WORD_1
    v_perm_b32 v68, v68, v120, s97
    v_perm_b32 v69, v69, v121, s97
    v_lshl_add_u64 v[68:69], v[68:69], 0, s[30:31]

    ds_add_rtn_u64 v[68:69], v24, v[68:69] offset:50000
    v_mad_i32_i16 v122, v70, v25, s96
    v_mad_i32_i16 v70, v70, v25, s96 op_sel:[1,0,0,0]
    v_mad_i32_i16 v123, v71, v25, s96
    v_mad_i32_i16 v71, v71, v25, s96 op_sel:[1,0,0,0]
    v_lshlrev_b32_sdwa v25, 3, v25 dst_sel:DWORD dst_unused:UNUSED_PAD src0_sel:DWORD src1_sel:WORD_1
    v_perm_b32 v70, v70, v122, s97
    v_perm_b32 v71, v71, v123, s97
    v_lshl_add_u64 v[70:71], v[70:71], 0, s[30:31]

    ds_add_rtn_u64 v[70:71], v25, v[70:71] offset:50000
    v_mad_i32_i16 v124, v72, v26, s96
    v_mad_i32_i16 v72, v72, v26, s96 op_sel:[1,0,0,0]
    v_mad_i32_i16 v125, v73, v26, s96
    v_mad_i32_i16 v73, v73, v26, s96 op_sel:[1,0,0,0]
    v_lshlrev_b32_sdwa v26, 3, v26 dst_sel:DWORD dst_unused:UNUSED_PAD src0_sel:DWORD src1_sel:WORD_1
    v_perm_b32 v72, v72, v124, s97
    v_perm_b32 v73, v73, v125, s97
    v_lshl_add_u64 v[72:73], v[72:73], 0, s[30:31]

    ds_add_rtn_u64 v[72:73], v26, v[72:73] offset:50000
    v_mad_i32_i16 v126, v74, v27, s96
    v_mad_i32_i16 v74, v74, v27, s96 op_sel:[1,0,0,0]
    v_mad_i32_i16 v127, v75, v27, s96
    v_mad_i32_i16 v75, v75, v27, s96 op_sel:[1,0,0,0]
    v_lshlrev_b32_sdwa v27, 3, v27 dst_sel:DWORD dst_unused:UNUSED_PAD src0_sel:DWORD src1_sel:WORD_1
    v_perm_b32 v74, v74, v126, s97
    v_perm_b32 v75, v75, v127, s97
    v_lshl_add_u64 v[74:75], v[74:75], 0, s[30:31]

    ds_add_rtn_u64 v[74:75], v27, v[74:75] offset:50000
    s_waitcnt lgkmcnt(8)
    v_or3_b32 v1, v60, v61, v1
    v_or3_b32 v1, v62, v63, v1
    v_or3_b32 v1, v64, v65, v1
    v_or3_b32 v1, v66, v67, v1
    s_waitcnt vmcnt(16)
    v_perm_b32 v60, v99, v98, s24
    v_perm_b32 v62, v100, v99, s25
    v_perm_b32 v64, v101, v100, s26
    v_perm_b32 v66, v112, v101, s27
    v_mov_b32 v20, v98
    v_alignbyte_b32 v21, v100, v99, 1
    v_alignbyte_b32 v22, v101, v100, 2
    v_alignbyte_b32 v23, v112, v101, 3
    v_lshlrev_b32_sdwa v60, 3, v60 dst_sel:WORD_0 dst_unused:UNUSED_PAD src0_sel:DWORD src1_sel:DWORD
    v_lshlrev_b32_sdwa v62, 3, v62 dst_sel:WORD_0 dst_unused:UNUSED_PAD src0_sel:DWORD src1_sel:DWORD
    v_lshlrev_b32_sdwa v64, 3, v64 dst_sel:WORD_0 dst_unused:UNUSED_PAD src0_sel:DWORD src1_sel:DWORD
    v_lshlrev_b32_sdwa v66, 3, v66 dst_sel:WORD_0 dst_unused:UNUSED_PAD src0_sel:DWORD src1_sel:DWORD
    s_cmp_lt_i32 s42, 2304
    s_cbranch_scc1 L_ufix_73
L_uback_74:

    v_subrev_co_u32 v20, s[72:73], 2.0, v20
    v_subrev_co_u32 v21, s[74:75], 2.0, v21
    v_subrev_co_u32 v22, s[76:77], 2.0, v22
    v_subrev_co_u32 v23, s[78:79], 2.0, v23
    s_mov_b64 exec, s[72:73]
    ds_read_b64 v[60:61], v60
    s_mov_b64 exec, s[74:75]
    ds_read_b64 v[62:63], v62
    s_mov_b64 exec, s[76:77]
    ds_read_b64 v[64:65], v64
    s_mov_b64 exec, s[78:79]
    ds_read_b64 v[66:67], v66
    s_mov_b64 exec, -1
    s_waitcnt lgkmcnt(4)
    v_or3_b32 v1, v68, v69, v1
    v_or3_b32 v1, v70, v71, v1
    v_or3_b32 v1, v72, v73, v1
    v_or3_b32 v1, v74, v75, v1
    s_waitcnt vmcnt(8)
    v_perm_b32 v68, v103, v102, s24
    v_perm_b32 v70, v104, v103, s25
    v_perm_b32 v72, v105, v104, s26
    v_perm_b32 v74, v113, v105, s27
    v_mov_b32 v24, v102
    v_alignbyte_b32 v25, v104, v103, 1
    v_alignbyte_b32 v26, v105, v104, 2
    v_alignbyte_b32 v27, v113, v105, 3
    v_lshlrev_b32_sdwa v68, 3, v68 dst_sel:WORD_0 dst_unused:UNUSED_PAD src0_sel:DWORD src1_sel:DWORD
    v_lshlrev_b32_sdwa v70, 3, v70 dst_sel:WORD_0 dst_unused:UNUSED_PAD src0_sel:DWORD src1_sel:DWORD
    v_lshlrev_b32_sdwa v72, 3, v72 dst_sel:WORD_0 dst_unused:UNUSED_PAD src0_sel:DWORD src1_sel:DWORD
    v_lshlrev_b32_sdwa v74, 3, v74 dst_sel:WORD_0 dst_unused:UNUSED_PAD src0_sel:DWORD src1_sel:DWORD
    s_cmp_lt_i32 s42, 2816
    s_cbranch_scc1 L_ufix_75
L_uback_76:

    v_subrev_co_u32 v24, s[80:81], 2.0, v24
    v_subrev_co_u32 v25, s[82:83], 2.0, v25
    v_subrev_co_u32 v26, s[84:85], 2.0, v26
    v_subrev_co_u32 v27, s[86:87], 2.0, v27
    s_mov_b64 exec, s[80:81]
    ds_read_b64 v[68:69], v68
    s_mov_b64 exec, s[82:83]
    ds_read_b64 v[70:71], v70
    s_mov_b64 exec, s[84:85]
    ds_read_b64 v[72:73], v72
    s_mov_b64 exec, s[86:87]
    ds_read_b64 v[74:75], v74
    s_mov_b64 exec, -1
    buffer_load_dwordx4 v[76:79], v3, s[12:15], s43 offen
    s_add_u32 s52, s43, 16384
    buffer_load_dwordx4 v[80:83], v3, s[12:15], s52 offen
    s_add_u32 s52, s43, 32768
    buffer_load_dwordx4 v[84:87], v3, s[12:15], s52 offen
    s_add_u32 s52, s43, 49152
    v_lshlrev_b32 v119, 2, v0
    buffer_load_dword v88, v119, s[12:15], s52 offen
    s_waitcnt vmcnt(10)
    v_perm_b32 v28, v5, v4, s24
    v_perm_b32 v30, v6, v5, s25
    v_perm_b32 v32, v7, v6, s26
    v_perm_b32 v34, v35, v7, s27
    v_alignbyte_b32 v5, v6, v5, 1
    v_alignbyte_b32 v6, v7, v6, 2
    v_alignbyte_b32 v7, v35, v7, 3
    v_lshlrev_b32_sdwa v28, 3, v28 dst_sel:WORD_0 dst_unused:UNUSED_PAD src0_sel:DWORD src1_sel:DWORD
    v_lshlrev_b32_sdwa v30, 3, v30 dst_sel:WORD_0 dst_unused:UNUSED_PAD src0_sel:DWORD src1_sel:DWORD
    v_lshlrev_b32_sdwa v32, 3, v32 dst_sel:WORD_0 dst_unused:UNUSED_PAD src0_sel:DWORD src1_sel:DWORD
    v_lshlrev_b32_sdwa v34, 3, v34 dst_sel:WORD_0 dst_unused:UNUSED_PAD src0_sel:DWORD src1_sel:DWORD
    s_cmp_lt_i32 s42, 256
    s_cbranch_scc1 L_ufix_77
L_uback_78:

    v_subrev_co_u32 v4, s[64:65], 2.0, v4
    v_subrev_co_u32 v5, s[66:67], 2.0, v5
    v_subrev_co_u32 v6, s[68:69], 2.0, v6
    v_subrev_co_u32 v7, s[70:71], 2.0, v7
    s_mov_b64 exec, s[64:65]
    ds_read_b64 v[28:29], v28
    s_mov_b64 exec, s[66:67]
    ds_read_b64 v[30:31], v30
    s_mov_b64 exec, s[68:69]
    ds_read_b64 v[32:33], v32
    s_mov_b64 exec, s[70:71]
    ds_read_b64 v[34:35], v34
    s_mov_b64 exec, -1
    s_waitcnt vmcnt(8)
    v_perm_b32 v36, v9, v8, s24
    v_perm_b32 v38, v10, v9, s25
    v_perm_b32 v40, v11, v10, s26
    v_perm_b32 v42, v43, v11, s27
    v_alignbyte_b32 v9, v10, v9, 1
    v_alignbyte_b32 v10, v11, v10, 2
    v_alignbyte_b32 v11, v43, v11, 3
    v_lshlrev_b32_sdwa v36, 3, v36 dst_sel:WORD_0 dst_unused:UNUSED_PAD src0_sel:DWORD src1_sel:DWORD
    v_lshlrev_b32_sdwa v38, 3, v38 dst_sel:WORD_0 dst_unused:UNUSED_PAD src0_sel:DWORD src1_sel:DWORD
    v_lshlrev_b32_sdwa v40, 3, v40 dst_sel:WORD_0 dst_unused:UNUSED_PAD src0_sel:DWORD src1_sel:DWORD
    v_lshlrev_b32_sdwa v42, 3, v42 dst_sel:WORD_0 dst_unused:UNUSED_PAD src0_sel:DWORD src1_sel:DWORD
    s_cmp_lt_i32 s42, 768
    s_cbranch_scc1 L_ufix_79
L_uback_80:

    v_subrev_co_u32 v8, s[72:73], 2.0, v8
    v_subrev_co_u32 v9, s[74:75], 2.0, v9
    v_subrev_co_u32 v10, s[76:77], 2.0, v10
    v_subrev_co_u32 v11, s[78:79], 2.0, v11
    s_mov_b64 exec, s[72:73]
    ds_read_b64 v[36:37], v36
    s_mov_b64 exec, s[74:75]
    ds_read_b64 v[38:39], v38
    s_mov_b64 exec, s[76:77]
    ds_read_b64 v[40:41], v40
    s_mov_b64 exec, s[78:79]
    ds_read_b64 v[42:43], v42
    s_mov_b64 exec, -1
    s_mov_b32 s38, s5
    s_add_u32 s50, s50, 200000
    s_branch L_batch_60
L_bend_61:

    s_load_dwordx2 s[64:65], s[0:1], 24
    s_load_dwordx2 s[86:87], s[0:1], 40
    s_load_dwordx8 s[88:95], s[0:1], 56
    s_mov_b32 s66, 1600000
    s_mov_b32 s67, 0x20000

    s_waitcnt lgkmcnt(15)
    v_mad_i32_i16 v120, v28, v4, s96
    v_mad_i32_i16 v28, v28, v4, s96 op_sel:[1,0,0,0]
    v_mad_i32_i16 v121, v29, v4, s96
    v_mad_i32_i16 v29, v29, v4, s96 op_sel:[1,0,0,0]
    v_lshlrev_b32_sdwa v4, 3, v4 dst_sel:DWORD dst_unused:UNUSED_PAD src0_sel:DWORD src1_sel:WORD_1
    v_perm_b32 v28, v28, v120, s97
    v_perm_b32 v29, v29, v121, s97
    v_lshl_add_u64 v[28:29], v[28:29], 0, s[30:31]

    ds_add_rtn_u64 v[28:29], v4, v[28:29] offset:50000
    v_mad_i32_i16 v122, v30, v5, s96
    v_mad_i32_i16 v30, v30, v5, s96 op_sel:[1,0,0,0]
    v_mad_i32_i16 v123, v31, v5, s96
    v_mad_i32_i16 v31, v31, v5, s96 op_sel:[1,0,0,0]
    v_lshlrev_b32_sdwa v5, 3, v5 dst_sel:DWORD dst_unused:UNUSED_PAD src0_sel:DWORD src1_sel:WORD_1
    v_perm_b32 v30, v30, v122, s97
    v_perm_b32 v31, v31, v123, s97
    v_lshl_add_u64 v[30:31], v[30:31], 0, s[30:31]

    ds_add_rtn_u64 v[30:31], v5, v[30:31] offset:50000
    v_mad_i32_i16 v124, v32, v6, s96
    v_mad_i32_i16 v32, v32, v6, s96 op_sel:[1,0,0,0]
    v_mad_i32_i16 v125, v33, v6, s96
    v_mad_i32_i16 v33, v33, v6, s96 op_sel:[1,0,0,0]
    v_lshlrev_b32_sdwa v6, 3, v6 dst_sel:DWORD dst_unused:UNUSED_PAD src0_sel:DWORD src1_sel:WORD_1
    v_perm_b32 v32, v32, v124, s97
    v_perm_b32 v33, v33, v125, s97
    v_lshl_add_u64 v[32:33], v[32:33], 0, s[30:31]

    ds_add_rtn_u64 v[32:33], v6, v[32:33] offset:50000
    v_mad_i32_i16 v126, v34, v7, s96
    v_mad_i32_i16 v34, v34, v7, s96 op_sel:[1,0,0,0]
    v_mad_i32_i16 v127, v35, v7, s96
    v_mad_i32_i16 v35, v35, v7, s96 op_sel:[1,0,0,0]
    v_lshlrev_b32_sdwa v7, 3, v7 dst_sel:DWORD dst_unused:UNUSED_PAD src0_sel:DWORD src1_sel:WORD_1
    v_perm_b32 v34, v34, v126, s97
    v_perm_b32 v35, v35, v127, s97
    v_lshl_add_u64 v[34:35], v[34:35], 0, s[30:31]

    ds_add_rtn_u64 v[34:35], v7, v[34:35] offset:50000
    v_mad_i32_i16 v120, v36, v8, s96
    v_mad_i32_i16 v36, v36, v8, s96 op_sel:[1,0,0,0]
    v_mad_i32_i16 v121, v37, v8, s96
    v_mad_i32_i16 v37, v37, v8, s96 op_sel:[1,0,0,0]
    v_lshlrev_b32_sdwa v8, 3, v8 dst_sel:DWORD dst_unused:UNUSED_PAD src0_sel:DWORD src1_sel:WORD_1
    v_perm_b32 v36, v36, v120, s97
    v_perm_b32 v37, v37, v121, s97
    v_lshl_add_u64 v[36:37], v[36:37], 0, s[30:31]

    ds_add_rtn_u64 v[36:37], v8, v[36:37] offset:50000
    v_mad_i32_i16 v122, v38, v9, s96
    v_mad_i32_i16 v38, v38, v9, s96 op_sel:[1,0,0,0]
    v_mad_i32_i16 v123, v39, v9, s96
    v_mad_i32_i16 v39, v39, v9, s96 op_sel:[1,0,0,0]
    v_lshlrev_b32_sdwa v9, 3, v9 dst_sel:DWORD dst_unused:UNUSED_PAD src0_sel:DWORD src1_sel:WORD_1
    v_perm_b32 v38, v38, v122, s97
    v_perm_b32 v39, v39, v123, s97
    v_lshl_add_u64 v[38:39], v[38:39], 0, s[30:31]

    ds_add_rtn_u64 v[38:39], v9, v[38:39] offset:50000
    v_mad_i32_i16 v124, v40, v10, s96
    v_mad_i32_i16 v40, v40, v10, s96 op_sel:[1,0,0,0]
    v_mad_i32_i16 v125, v41, v10, s96
    v_mad_i32_i16 v41, v41, v10, s96 op_sel:[1,0,0,0]
    v_lshlrev_b32_sdwa v10, 3, v10 dst_sel:DWORD dst_unused:UNUSED_PAD src0_sel:DWORD src1_sel:WORD_1
    v_perm_b32 v40, v40, v124, s97
    v_perm_b32 v41, v41, v125, s97
    v_lshl_add_u64 v[40:41], v[40:41], 0, s[30:31]

    ds_add_rtn_u64 v[40:41], v10, v[40:41] offset:50000
    v_mad_i32_i16 v126, v42, v11, s96
    v_mad_i32_i16 v42, v42, v11, s96 op_sel:[1,0,0,0]
    v_mad_i32_i16 v127, v43, v11, s96
    v_mad_i32_i16 v43, v43, v11, s96 op_sel:[1,0,0,0]
    v_lshlrev_b32_sdwa v11, 3, v11 dst_sel:DWORD dst_unused:UNUSED_PAD src0_sel:DWORD src1_sel:WORD_1
    v_perm_b32 v42, v42, v126, s97
    v_perm_b32 v43, v43, v127, s97
    v_lshl_add_u64 v[42:43], v[42:43], 0, s[30:31]

    ds_add_rtn_u64 v[42:43], v11, v[42:43] offset:50000
    s_waitcnt lgkmcnt(4)
    v_or3_b32 v1, v28, v29, v1
    v_or3_b32 v1, v30, v31, v1
    v_or3_b32 v1, v32, v33, v1
    v_or3_b32 v1, v34, v35, v1
    v_mad_i32_i16 v120, v44, v12, s96
    v_mad_i32_i16 v44, v44, v12, s96 op_sel:[1,0,0,0]
    v_mad_i32_i16 v121, v45, v12, s96
    v_mad_i32_i16 v45, v45, v12, s96 op_sel:[1,0,0,0]
    v_lshlrev_b32_sdwa v12, 3, v12 dst_sel:DWORD dst_unused:UNUSED_PAD src0_sel:DWORD src1_sel:WORD_1
    v_perm_b32 v44, v44, v120, s97
    v_perm_b32 v45, v45, v121, s97
    v_lshl_add_u64 v[44:45], v[44:45], 0, s[30:31]

    ds_add_rtn_u64 v[44:45], v12, v[44:45] offset:50000
    v_mad_i32_i16 v122, v46, v13, s96
    v_mad_i32_i16 v46, v46, v13, s96 op_sel:[1,0,0,0]
    v_mad_i32_i16 v123, v47, v13, s96
    v_mad_i32_i16 v47, v47, v13, s96 op_sel:[1,0,0,0]
    v_lshlrev_b32_sdwa v13, 3, v13 dst_sel:DWORD dst_unused:UNUSED_PAD src0_sel:DWORD src1_sel:WORD_1
    v_perm_b32 v46, v46, v122, s97
    v_perm_b32 v47, v47, v123, s97
    v_lshl_add_u64 v[46:47], v[46:47], 0, s[30:31]

    ds_add_rtn_u64 v[46:47], v13, v[46:47] offset:50000
    v_mad_i32_i16 v124, v48, v14, s96
    v_mad_i32_i16 v48, v48, v14, s96 op_sel:[1,0,0,0]
    v_mad_i32_i16 v125, v49, v14, s96
    v_mad_i32_i16 v49, v49, v14, s96 op_sel:[1,0,0,0]
    v_lshlrev_b32_sdwa v14, 3, v14 dst_sel:DWORD dst_unused:UNUSED_PAD src0_sel:DWORD src1_sel:WORD_1
    v_perm_b32 v48, v48, v124, s97
    v_perm_b32 v49, v49, v125, s97
    v_lshl_add_u64 v[48:49], v[48:49], 0, s[30:31]

    ds_add_rtn_u64 v[48:49], v14, v[48:49] offset:50000
    v_mad_i32_i16 v126, v50, v15, s96
    v_mad_i32_i16 v50, v50, v15, s96 op_sel:[1,0,0,0]
    v_mad_i32_i16 v127, v51, v15, s96
    v_mad_i32_i16 v51, v51, v15, s96 op_sel:[1,0,0,0]
    v_lshlrev_b32_sdwa v15, 3, v15 dst_sel:DWORD dst_unused:UNUSED_PAD src0_sel:DWORD src1_sel:WORD_1
    v_perm_b32 v50, v50, v126, s97
    v_perm_b32 v51, v51, v127, s97
    v_lshl_add_u64 v[50:51], v[50:51], 0, s[30:31]

    ds_add_rtn_u64 v[50:51], v15, v[50:51] offset:50000
    s_waitcnt lgkmcnt(4)
    v_or3_b32 v1, v36, v37, v1
    v_or3_b32 v1, v38, v39, v1
    v_or3_b32 v1, v40, v41, v1
    v_or3_b32 v1, v42, v43, v1
    v_mad_i32_i16 v120, v52, v16, s96
    v_mad_i32_i16 v52, v52, v16, s96 op_sel:[1,0,0,0]
    v_mad_i32_i16 v121, v53, v16, s96
    v_mad_i32_i16 v53, v53, v16, s96 op_sel:[1,0,0,0]
    v_lshlrev_b32_sdwa v16, 3, v16 dst_sel:DWORD dst_unused:UNUSED_PAD src0_sel:DWORD src1_sel:WORD_1
    v_perm_b32 v52, v52, v120, s97
    v_perm_b32 v53, v53, v121, s97
    v_lshl_add_u64 v[52:53], v[52:53], 0, s[30:31]

    ds_add_rtn_u64 v[52:53], v16, v[52:53] offset:50000
    v_mad_i32_i16 v122, v54, v17, s96
    v_mad_i32_i16 v54, v54, v17, s96 op_sel:[1,0,0,0]
    v_mad_i32_i16 v123, v55, v17, s96
    v_mad_i32_i16 v55, v55, v17, s96 op_sel:[1,0,0,0]
    v_lshlrev_b32_sdwa v17, 3, v17 dst_sel:DWORD dst_unused:UNUSED_PAD src0_sel:DWORD src1_sel:WORD_1
    v_perm_b32 v54, v54, v122, s97
    v_perm_b32 v55, v55, v123, s97
    v_lshl_add_u64 v[54:55], v[54:55], 0, s[30:31]

    ds_add_rtn_u64 v[54:55], v17, v[54:55] offset:50000
    v_mad_i32_i16 v124, v56, v18, s96
    v_mad_i32_i16 v56, v56, v18, s96 op_sel:[1,0,0,0]
    v_mad_i32_i16 v125, v57, v18, s96
    v_mad_i32_i16 v57, v57, v18, s96 op_sel:[1,0,0,0]
    v_lshlrev_b32_sdwa v18, 3, v18 dst_sel:DWORD dst_unused:UNUSED_PAD src0_sel:DWORD src1_sel:WORD_1
    v_perm_b32 v56, v56, v124, s97
    v_perm_b32 v57, v57, v125, s97
    v_lshl_add_u64 v[56:57], v[56:57], 0, s[30:31]

    ds_add_rtn_u64 v[56:57], v18, v[56:57] offset:50000
    v_mad_i32_i16 v126, v58, v19, s96
    v_mad_i32_i16 v58, v58, v19, s96 op_sel:[1,0,0,0]
    v_mad_i32_i16 v127, v59, v19, s96
    v_mad_i32_i16 v59, v59, v19, s96 op_sel:[1,0,0,0]
    v_lshlrev_b32_sdwa v19, 3, v19 dst_sel:DWORD dst_unused:UNUSED_PAD src0_sel:DWORD src1_sel:WORD_1
    v_perm_b32 v58, v58, v126, s97
    v_perm_b32 v59, v59, v127, s97
    v_lshl_add_u64 v[58:59], v[58:59], 0, s[30:31]

    ds_add_rtn_u64 v[58:59], v19, v[58:59] offset:50000
    s_waitcnt lgkmcnt(4)
    v_or3_b32 v1, v44, v45, v1
    v_or3_b32 v1, v46, v47, v1
    v_or3_b32 v1, v48, v49, v1
    v_or3_b32 v1, v50, v51, v1
    v_mad_i32_i16 v120, v60, v20, s96
    v_mad_i32_i16 v60, v60, v20, s96 op_sel:[1,0,0,0]
    v_mad_i32_i16 v121, v61, v20, s96
    v_mad_i32_i16 v61, v61, v20, s96 op_sel:[1,0,0,0]
    v_lshlrev_b32_sdwa v20, 3, v20 dst_sel:DWORD dst_unused:UNUSED_PAD src0_sel:DWORD src1_sel:WORD_1
    v_perm_b32 v60, v60, v120, s97
    v_perm_b32 v61, v61, v121, s97
    v_lshl_add_u64 v[60:61], v[60:61], 0, s[30:31]

    ds_add_rtn_u64 v[60:61], v20, v[60:61] offset:50000
    v_mad_i32_i16 v122, v62, v21, s96
    v_mad_i32_i16 v62, v62, v21, s96 op_sel:[1,0,0,0]
    v_mad_i32_i16 v123, v63, v21, s96
    v_mad_i32_i16 v63, v63, v21, s96 op_sel:[1,0,0,0]
    v_lshlrev_b32_sdwa v21, 3, v21 dst_sel:DWORD dst_unused:UNUSED_PAD src0_sel:DWORD src1_sel:WORD_1
    v_perm_b32 v62, v62, v122, s97
    v_perm_b32 v63, v63, v123, s97
    v_lshl_add_u64 v[62:63], v[62:63], 0, s[30:31]

    ds_add_rtn_u64 v[62:63], v21, v[62:63] offset:50000
    v_mad_i32_i16 v124, v64, v22, s96
    v_mad_i32_i16 v64, v64, v22, s96 op_sel:[1,0,0,0]
    v_mad_i32_i16 v125, v65, v22, s96
    v_mad_i32_i16 v65, v65, v22, s96 op_sel:[1,0,0,0]
    v_lshlrev_b32_sdwa v22, 3, v22 dst_sel:DWORD dst_unused:UNUSED_PAD src0_sel:DWORD src1_sel:WORD_1
    v_perm_b32 v64, v64, v124, s97
    v_perm_b32 v65, v65, v125, s97
    v_lshl_add_u64 v[64:65], v[64:65], 0, s[30:31]

    ds_add_rtn_u64 v[64:65], v22, v[64:65] offset:50000
    v_mad_i32_i16 v126, v66, v23, s96
    v_mad_i32_i16 v66, v66, v23, s96 op_sel:[1,0,0,0]
    v_mad_i32_i16 v127, v67, v23, s96
    v_mad_i32_i16 v67, v67, v23, s96 op_sel:[1,0,0,0]
    v_lshlrev_b32_sdwa v23, 3, v23 dst_sel:DWORD dst_unused:UNUSED_PAD src0_sel:DWORD src1_sel:WORD_1
    v_perm_b32 v66, v66, v126, s97
    v_perm_b32 v67, v67, v127, s97
    v_lshl_add_u64 v[66:67], v[66:67], 0, s[30:31]

    ds_add_rtn_u64 v[66:67], v23, v[66:67] offset:50000
    s_waitcnt lgkmcnt(4)
    v_or3_b32 v1, v52, v53, v1
    v_or3_b32 v1, v54, v55, v1
    v_or3_b32 v1, v56, v57, v1
    v_or3_b32 v1, v58, v59, v1
    v_mad_i32_i16 v120, v68, v24, s96
    v_mad_i32_i16 v68, v68, v24, s96 op_sel:[1,0,0,0]
    v_mad_i32_i16 v121, v69, v24, s96
    v_mad_i32_i16 v69, v69, v24, s96 op_sel:[1,0,0,0]
    v_lshlrev_b32_sdwa v24, 3, v24 dst_sel:DWORD dst_unused:UNUSED_PAD src0_sel:DWORD src1_sel:WORD_1
    v_perm_b32 v68, v68, v120, s97
    v_perm_b32 v69, v69, v121, s97
    v_lshl_add_u64 v[68:69], v[68:69], 0, s[30:31]

    ds_add_rtn_u64 v[68:69], v24, v[68:69] offset:50000
    v_mad_i32_i16 v122, v70, v25, s96
    v_mad_i32_i16 v70, v70, v25, s96 op_sel:[1,0,0,0]
    v_mad_i32_i16 v123, v71, v25, s96
    v_mad_i32_i16 v71, v71, v25, s96 op_sel:[1,0,0,0]
    v_lshlrev_b32_sdwa v25, 3, v25 dst_sel:DWORD dst_unused:UNUSED_PAD src0_sel:DWORD src1_sel:WORD_1
    v_perm_b32 v70, v70, v122, s97
    v_perm_b32 v71, v71, v123, s97
    v_lshl_add_u64 v[70:71], v[70:71], 0, s[30:31]

    ds_add_rtn_u64 v[70:71], v25, v[70:71] offset:50000
    v_mad_i32_i16 v124, v72, v26, s96
    v_mad_i32_i16 v72, v72, v26, s96 op_sel:[1,0,0,0]
    v_mad_i32_i16 v125, v73, v26, s96
    v_mad_i32_i16 v73, v73, v26, s96 op_sel:[1,0,0,0]
    v_lshlrev_b32_sdwa v26, 3, v26 dst_sel:DWORD dst_unused:UNUSED_PAD src0_sel:DWORD src1_sel:WORD_1
    v_perm_b32 v72, v72, v124, s97
    v_perm_b32 v73, v73, v125, s97
    v_lshl_add_u64 v[72:73], v[72:73], 0, s[30:31]

    ds_add_rtn_u64 v[72:73], v26, v[72:73] offset:50000
    v_mad_i32_i16 v126, v74, v27, s96
    v_mad_i32_i16 v74, v74, v27, s96 op_sel:[1,0,0,0]
    v_mad_i32_i16 v127, v75, v27, s96
    v_mad_i32_i16 v75, v75, v27, s96 op_sel:[1,0,0,0]
    v_lshlrev_b32_sdwa v27, 3, v27 dst_sel:DWORD dst_unused:UNUSED_PAD src0_sel:DWORD src1_sel:WORD_1
    v_perm_b32 v74, v74, v126, s97
    v_perm_b32 v75, v75, v127, s97
    v_lshl_add_u64 v[74:75], v[74:75], 0, s[30:31]

    ds_add_rtn_u64 v[74:75], v27, v[74:75] offset:50000
    s_waitcnt lgkmcnt(4)
    v_or3_b32 v1, v60, v61, v1
    v_or3_b32 v1, v62, v63, v1
    v_or3_b32 v1, v64, v65, v1
    v_or3_b32 v1, v66, v67, v1
    s_waitcnt lgkmcnt(0)
    v_or3_b32 v1, v68, v69, v1
    v_or3_b32 v1, v70, v71, v1
    v_or3_b32 v1, v72, v73, v1
    v_or3_b32 v1, v74, v75, v1
    s_waitcnt vmcnt(0)
    s_waitcnt lgkmcnt(0)
    s_load_dwordx4 s[28:31], s[86:87], 0
    s_load_dwordx16 s[68:83], s[88:89], 0
    s_load_dwordx8 s[12:19], s[92:93], 0
    s_load_dwordx8 s[56:63], s[94:95], 0
    s_mov_b64 s[48:49], s[90:91]
    s_load_dwordx16 s[84:99], s[48:49], 0

    s_mov_b32 s41, s37
    s_mul_i32 s3, s41, 3125
    s_add_u32 s5, s3, 3126
    s_add_u32 s3, s3, 1
    s_lshr_b32 s3, s3, 1
    s_lshr_b32 s5, s5, 1
    s_sub_u32 s5, s5, s3
    s_sub_u32 s5, s5, 782
    v_cmp_gt_u32 vcc, s5, v0
    s_mul_i32 s5, s36, 6250
    s_add_u32 s3, s3, s5
    v_add_u32 v6, s3, v0
    v_add_u32 v7, 782, v6
    v_mov_b32 v8, 0x2000000
    v_lshlrev_b32 v4, 4, v6
    v_cndmask_b32 v7, v8, v7, vcc
    v_lshlrev_b32 v6, 2, v6
    v_lshlrev_b32 v5, 4, v7
    v_lshlrev_b32 v7, 2, v7
    v_cmp_gt_u32 vcc, 782, v0
    s_mov_b64 exec, vcc
    s_cbranch_execz L_skld_84
    buffer_load_dword v6, v6, s[64:67], 0 offen
    buffer_load_dword v7, v7, s[64:67], 0 offen
    buffer_load_dwordx4 v[108:111], v4, s[8:11], 0 offen
    buffer_load_dwordx4 v[112:115], v5, s[8:11], 0 offen

L_skld_84:
    s_mov_b64 exec, -1
    s_barrier

    v_add_u32 v116, 50000, v3
    v_add_u32 v117, 115536, v3
    v_cmp_gt_u32 vcc, 106, v0

    v_mov_b32 v100, 0
    v_mov_b32 v101, 0
    v_mov_b32 v102, 0
    v_mov_b32 v103, 0
    ds_read_b128 v[76:79], v116 offset:0
    ds_read_b128 v[80:83], v116 offset:16384
    ds_read_b128 v[84:87], v116 offset:32768
    ds_read_b128 v[88:91], v116 offset:49152
    ds_read_b128 v[92:95], v117 offset:0
    ds_read_b128 v[96:99], v117 offset:16384
    s_mov_b64 exec, vcc
    ds_read_b128 v[100:103], v117 offset:32768
    s_mov_b64 exec, -1
    s_mul_i32 s3, s37, 6400000
    s_mul_i32 s5, s36, 100000
    s_add_u32 s3, s3, s5
    s_add_u32 s3, s3, 6799360

    s_add_u32 s20, s6, s3
    s_addc_u32 s21, s7, 0
    s_mov_b32 s22, 100000
    s_mov_b32 s23, 0x20000
    s_waitcnt lgkmcnt(6)
    s_mov_b32 s3, 0
    buffer_store_dwordx4 v[76:79], v3, s[20:23], s3 offen sc1
    s_waitcnt lgkmcnt(5)
    s_mov_b32 s3, 16384
    buffer_store_dwordx4 v[80:83], v3, s[20:23], s3 offen sc1
    s_waitcnt lgkmcnt(4)
    s_mov_b32 s3, 32768
    buffer_store_dwordx4 v[84:87], v3, s[20:23], s3 offen sc1
    s_waitcnt lgkmcnt(3)
    s_mov_b32 s3, 49152
    buffer_store_dwordx4 v[88:91], v3, s[20:23], s3 offen sc1
    s_waitcnt lgkmcnt(2)
    s_mov_b32 s3, 65536
    buffer_store_dwordx4 v[92:95], v3, s[20:23], s3 offen sc1
    s_waitcnt lgkmcnt(1)
    s_mov_b32 s3, 81920
    buffer_store_dwordx4 v[96:99], v3, s[20:23], s3 offen sc1
    s_waitcnt lgkmcnt(0)
    s_mov_b32 s3, 98304
    buffer_store_dwordx4 v[100:103], v3, s[20:23], s3 offen sc1
    v_or3_b32 v1, v76, v77, v1
    v_or3_b32 v1, v78, v79, v1
    v_or3_b32 v1, v80, v81, v1
    v_or3_b32 v1, v82, v83, v1
    v_or3_b32 v1, v84, v85, v1
    v_or3_b32 v1, v86, v87, v1
    v_or3_b32 v1, v88, v89, v1
    v_or3_b32 v1, v90, v91, v1
    v_or3_b32 v1, v92, v93, v1
    v_or3_b32 v1, v94, v95, v1
    v_or3_b32 v1, v96, v97, v1
    v_or3_b32 v1, v98, v99, v1
    v_or3_b32 v1, v100, v101, v1
    v_or3_b32 v1, v102, v103, v1
    v_and_b32 v1, 0x80008000, v1
    v_cmp_ne_u32 vcc, 0, v1
    v_mov_b32 v116, 150024
    v_mov_b32 v117, 1
    s_cbranch_vccz L_nf_81
    ds_write_b32 v116, v117
L_nf_81:
    s_mov_b32 s33, 1
    s_mov_b32 s42, 0
    v_cmp_gt_u32 vcc, 782, v0
    s_mov_b64 exec, vcc
    s_cbranch_execz L_p1end_86
    s_waitcnt vmcnt(9)
    s_branch L_lddone_83
L_fin_82:

    s_load_dwordx2 s[64:65], s[0:1], 24
    s_load_dwordx2 s[86:87], s[0:1], 40
    s_load_dwordx8 s[88:95], s[0:1], 56
    s_mov_b32 s66, 1600000
    s_mov_b32 s67, 0x20000

    s_waitcnt lgkmcnt(0)
    s_load_dwordx4 s[28:31], s[86:87], 0
    s_load_dwordx16 s[68:83], s[88:89], 0
    s_load_dwordx8 s[12:19], s[92:93], 0
    s_load_dwordx8 s[56:63], s[94:95], 0
    s_mov_b64 s[48:49], s[90:91]
    s_load_dwordx16 s[84:99], s[48:49], 0

    s_mov_b32 s42, 1
    s_mov_b32 s41, s37
L_qloop_85:
    s_mul_i32 s3, s41, 3125
    s_add_u32 s5, s3, 3126
    s_add_u32 s3, s3, 1
    s_lshr_b32 s3, s3, 1
    s_lshr_b32 s5, s5, 1
    s_sub_u32 s5, s5, s3
    s_sub_u32 s5, s5, 782
    v_cmp_gt_u32 vcc, s5, v0
    s_mul_i32 s5, s36, 6250
    s_add_u32 s3, s3, s5
    v_add_u32 v6, s3, v0
    v_add_u32 v7, 782, v6
    v_mov_b32 v8, 0x2000000
    v_lshlrev_b32 v4, 4, v6
    v_cndmask_b32 v7, v8, v7, vcc
    v_lshlrev_b32 v6, 2, v6
    v_lshlrev_b32 v5, 4, v7
    v_lshlrev_b32 v7, 2, v7
    v_cmp_gt_u32 vcc, 782, v0
    s_mov_b64 exec, vcc
    s_cbranch_execz L_p1end_86
    buffer_load_dword v6, v6, s[64:67], 0 offen
    buffer_load_dword v7, v7, s[64:67], 0 offen
    buffer_load_dwordx4 v[108:111], v4, s[8:11], 0 offen
    buffer_load_dwordx4 v[112:115], v5, s[8:11], 0 offen

    s_waitcnt vmcnt(2)
L_lddone_83:
    s_waitcnt lgkmcnt(0)
    v_lshlrev_b32 v8, 16, v6
    v_and_b32 v9, s32, v6
    v_lshlrev_b32 v10, 16, v7
    v_and_b32 v11, s32, v7

    s_lshl_b32 s52, s28, 16
    v_subrev_f32 v12, s52, v8
    v_subrev_f32 v20, s52, v9
    v_subrev_f32 v28, s52, v10
    v_subrev_f32 v36, s52, v11
    s_and_b32 s53, s28, s32
    v_subrev_f32 v13, s53, v8
    v_subrev_f32 v21, s53, v9
    v_subrev_f32 v29, s53, v10
    v_subrev_f32 v37, s53, v11
    s_lshl_b32 s52, s29, 16
    v_subrev_f32 v14, s52, v8
    v_subrev_f32 v22, s52, v9
    v_subrev_f32 v30, s52, v10
    v_subrev_f32 v38, s52, v11
    s_and_b32 s53, s29, s32
    v_subrev_f32 v15, s53, v8
    v_subrev_f32 v23, s53, v9
    v_subrev_f32 v31, s53, v10
    v_subrev_f32 v39, s53, v11
    s_lshl_b32 s52, s30, 16
    v_subrev_f32 v16, s52, v8
    v_subrev_f32 v24, s52, v9
    v_subrev_f32 v32, s52, v10
    v_subrev_f32 v40, s52, v11
    s_and_b32 s53, s30, s32
    v_subrev_f32 v17, s53, v8
    v_subrev_f32 v25, s53, v9
    v_subrev_f32 v33, s53, v10
    v_subrev_f32 v41, s53, v11
    s_lshl_b32 s52, s31, 16
    v_subrev_f32 v18, s52, v8
    v_subrev_f32 v26, s52, v9
    v_subrev_f32 v34, s52, v10
    v_subrev_f32 v42, s52, v11
    s_and_b32 s53, s31, s32
    v_subrev_f32 v19, s53, v8
    v_subrev_f32 v27, s53, v9
    v_subrev_f32 v35, s53, v10
    v_subrev_f32 v43, s53, v11
    v_cvt_pk_bf16_f32 v12, v12, v13
    v_cvt_pk_bf16_f32 v14, v14, v15
    v_cvt_pk_bf16_f32 v16, v16, v17
    v_cvt_pk_bf16_f32 v18, v18, v19
    v_cvt_pk_bf16_f32 v20, v20, v21
    v_cvt_pk_bf16_f32 v22, v22, v23
    v_cvt_pk_bf16_f32 v24, v24, v25
    v_cvt_pk_bf16_f32 v26, v26, v27
    v_cvt_pk_bf16_f32 v28, v28, v29
    v_cvt_pk_bf16_f32 v30, v30, v31
    v_cvt_pk_bf16_f32 v32, v32, v33
    v_cvt_pk_bf16_f32 v34, v34, v35
    v_cvt_pk_bf16_f32 v36, v36, v37
    v_cvt_pk_bf16_f32 v38, v38, v39
    v_cvt_pk_bf16_f32 v40, v40, v41
    v_cvt_pk_bf16_f32 v42, v42, v43
    v_and_b32 v13, s32, v12
    v_lshlrev_b32 v12, 16, v12
    v_and_b32 v15, s32, v14
    v_lshlrev_b32 v14, 16, v14
    v_and_b32 v17, s32, v16
    v_lshlrev_b32 v16, 16, v16
    v_and_b32 v19, s32, v18
    v_lshlrev_b32 v18, 16, v18
    v_and_b32 v21, s32, v20
    v_lshlrev_b32 v20, 16, v20
    v_and_b32 v23, s32, v22
    v_lshlrev_b32 v22, 16, v22
    v_and_b32 v25, s32, v24
    v_lshlrev_b32 v24, 16, v24
    v_and_b32 v27, s32, v26
    v_lshlrev_b32 v26, 16, v26
    v_and_b32 v29, s32, v28
    v_lshlrev_b32 v28, 16, v28
    v_and_b32 v31, s32, v30
    v_lshlrev_b32 v30, 16, v30
    v_and_b32 v33, s32, v32
    v_lshlrev_b32 v32, 16, v32
    v_and_b32 v35, s32, v34
    v_lshlrev_b32 v34, 16, v34
    v_and_b32 v37, s32, v36
    v_lshlrev_b32 v36, 16, v36
    v_and_b32 v39, s32, v38
    v_lshlrev_b32 v38, 16, v38
    v_and_b32 v41, s32, v40
    v_lshlrev_b32 v40, 16, v40
    v_and_b32 v43, s32, v42
    v_lshlrev_b32 v42, 16, v42
    v_mul_f32 v12, v12, v12
    v_mul_f32 v13, v13, v13
    v_mul_f32 v14, v14, v14
    v_mul_f32 v15, v15, v15
    v_mul_f32 v16, v16, v16
    v_mul_f32 v17, v17, v17
    v_mul_f32 v18, v18, v18
    v_mul_f32 v19, v19, v19
    v_mul_f32 v20, v20, v20
    v_mul_f32 v21, v21, v21
    v_mul_f32 v22, v22, v22
    v_mul_f32 v23, v23, v23
    v_mul_f32 v24, v24, v24
    v_mul_f32 v25, v25, v25
    v_mul_f32 v26, v26, v26
    v_mul_f32 v27, v27, v27
    v_mul_f32 v28, v28, v28
    v_mul_f32 v29, v29, v29
    v_mul_f32 v30, v30, v30
    v_mul_f32 v31, v31, v31
    v_mul_f32 v32, v32, v32
    v_mul_f32 v33, v33, v33
    v_mul_f32 v34, v34, v34
    v_mul_f32 v35, v35, v35
    v_mul_f32 v36, v36, v36
    v_mul_f32 v37, v37, v37
    v_mul_f32 v38, v38, v38
    v_mul_f32 v39, v39, v39
    v_mul_f32 v40, v40, v40
    v_mul_f32 v41, v41, v41
    v_mul_f32 v42, v42, v42
    v_mul_f32 v43, v43, v43
    v_cvt_pk_bf16_f32 v12, v12, v13
    v_cvt_pk_bf16_f32 v14, v14, v15
    v_cvt_pk_bf16_f32 v16, v16, v17
    v_cvt_pk_bf16_f32 v18, v18, v19
    v_cvt_pk_bf16_f32 v20, v20, v21
    v_cvt_pk_bf16_f32 v22, v22, v23
    v_cvt_pk_bf16_f32 v24, v24, v25
    v_cvt_pk_bf16_f32 v26, v26, v27
    v_cvt_pk_bf16_f32 v28, v28, v29
    v_cvt_pk_bf16_f32 v30, v30, v31
    v_cvt_pk_bf16_f32 v32, v32, v33
    v_cvt_pk_bf16_f32 v34, v34, v35
    v_cvt_pk_bf16_f32 v36, v36, v37
    v_cvt_pk_bf16_f32 v38, v38, v39
    v_cvt_pk_bf16_f32 v40, v40, v41
    v_cvt_pk_bf16_f32 v42, v42, v43
    v_and_b32 v13, s32, v12
    v_lshlrev_b32 v12, 16, v12
    v_and_b32 v15, s32, v14
    v_lshlrev_b32 v14, 16, v14
    v_and_b32 v17, s32, v16
    v_lshlrev_b32 v16, 16, v16
    v_and_b32 v19, s32, v18
    v_lshlrev_b32 v18, 16, v18
    v_and_b32 v21, s32, v20
    v_lshlrev_b32 v20, 16, v20
    v_and_b32 v23, s32, v22
    v_lshlrev_b32 v22, 16, v22
    v_and_b32 v25, s32, v24
    v_lshlrev_b32 v24, 16, v24
    v_and_b32 v27, s32, v26
    v_lshlrev_b32 v26, 16, v26
    v_and_b32 v29, s32, v28
    v_lshlrev_b32 v28, 16, v28
    v_and_b32 v31, s32, v30
    v_lshlrev_b32 v30, 16, v30
    v_and_b32 v33, s32, v32
    v_lshlrev_b32 v32, 16, v32
    v_and_b32 v35, s32, v34
    v_lshlrev_b32 v34, 16, v34
    v_and_b32 v37, s32, v36
    v_lshlrev_b32 v36, 16, v36
    v_and_b32 v39, s32, v38
    v_lshlrev_b32 v38, 16, v38
    v_and_b32 v41, s32, v40
    v_lshlrev_b32 v40, 16, v40
    v_and_b32 v43, s32, v42
    v_lshlrev_b32 v42, 16, v42
    v_mul_f32 v12, 0xc1200000, v12
    v_mul_f32 v13, 0xc1200000, v13
    v_mul_f32 v14, 0xc1200000, v14
    v_mul_f32 v15, 0xc1200000, v15
    v_mul_f32 v16, 0xc1200000, v16
    v_mul_f32 v17, 0xc1200000, v17
    v_mul_f32 v18, 0xc1200000, v18
    v_mul_f32 v19, 0xc1200000, v19
    v_mul_f32 v20, 0xc1200000, v20
    v_mul_f32 v21, 0xc1200000, v21
    v_mul_f32 v22, 0xc1200000, v22
    v_mul_f32 v23, 0xc1200000, v23
    v_mul_f32 v24, 0xc1200000, v24
    v_mul_f32 v25, 0xc1200000, v25
    v_mul_f32 v26, 0xc1200000, v26
    v_mul_f32 v27, 0xc1200000, v27
    v_mul_f32 v28, 0xc1200000, v28
    v_mul_f32 v29, 0xc1200000, v29
    v_mul_f32 v30, 0xc1200000, v30
    v_mul_f32 v31, 0xc1200000, v31
    v_mul_f32 v32, 0xc1200000, v32
    v_mul_f32 v33, 0xc1200000, v33
    v_mul_f32 v34, 0xc1200000, v34
    v_mul_f32 v35, 0xc1200000, v35
    v_mul_f32 v36, 0xc1200000, v36
    v_mul_f32 v37, 0xc1200000, v37
    v_mul_f32 v38, 0xc1200000, v38
    v_mul_f32 v39, 0xc1200000, v39
    v_mul_f32 v40, 0xc1200000, v40
    v_mul_f32 v41, 0xc1200000, v41
    v_mul_f32 v42, 0xc1200000, v42
    v_mul_f32 v43, 0xc1200000, v43
    v_cvt_pk_bf16_f32 v12, v12, v13
    v_cvt_pk_bf16_f32 v14, v14, v15
    v_cvt_pk_bf16_f32 v16, v16, v17
    v_cvt_pk_bf16_f32 v18, v18, v19
    v_cvt_pk_bf16_f32 v20, v20, v21
    v_cvt_pk_bf16_f32 v22, v22, v23
    v_cvt_pk_bf16_f32 v24, v24, v25
    v_cvt_pk_bf16_f32 v26, v26, v27
    v_cvt_pk_bf16_f32 v28, v28, v29
    v_cvt_pk_bf16_f32 v30, v30, v31
    v_cvt_pk_bf16_f32 v32, v32, v33
    v_cvt_pk_bf16_f32 v34, v34, v35
    v_cvt_pk_bf16_f32 v36, v36, v37
    v_cvt_pk_bf16_f32 v38, v38, v39
    v_cvt_pk_bf16_f32 v40, v40, v41
    v_cvt_pk_bf16_f32 v42, v42, v43
    v_and_b32 v13, s32, v12
    v_lshlrev_b32 v12, 16, v12
    v_and_b32 v15, s32, v14
    v_lshlrev_b32 v14, 16, v14
    v_and_b32 v17, s32, v16
    v_lshlrev_b32 v16, 16, v16
    v_and_b32 v19, s32, v18
    v_lshlrev_b32 v18, 16, v18
    v_and_b32 v21, s32, v20
    v_lshlrev_b32 v20, 16, v20
    v_and_b32 v23, s32, v22
    v_lshlrev_b32 v22, 16, v22
    v_and_b32 v25, s32, v24
    v_lshlrev_b32 v24, 16, v24
    v_and_b32 v27, s32, v26
    v_lshlrev_b32 v26, 16, v26
    v_and_b32 v29, s32, v28
    v_lshlrev_b32 v28, 16, v28
    v_and_b32 v31, s32, v30
    v_lshlrev_b32 v30, 16, v30
    v_and_b32 v33, s32, v32
    v_lshlrev_b32 v32, 16, v32
    v_and_b32 v35, s32, v34
    v_lshlrev_b32 v34, 16, v34
    v_and_b32 v37, s32, v36
    v_lshlrev_b32 v36, 16, v36
    v_and_b32 v39, s32, v38
    v_lshlrev_b32 v38, 16, v38
    v_and_b32 v41, s32, v40
    v_lshlrev_b32 v40, 16, v40
    v_and_b32 v43, s32, v42
    v_lshlrev_b32 v42, 16, v42
    v_mul_f32 v12, 0x3fb8aa3b, v12
    v_mul_f32 v13, 0x3fb8aa3b, v13
    v_mul_f32 v14, 0x3fb8aa3b, v14
    v_mul_f32 v15, 0x3fb8aa3b, v15
    v_mul_f32 v16, 0x3fb8aa3b, v16
    v_mul_f32 v17, 0x3fb8aa3b, v17
    v_mul_f32 v18, 0x3fb8aa3b, v18
    v_mul_f32 v19, 0x3fb8aa3b, v19
    v_mul_f32 v20, 0x3fb8aa3b, v20
    v_mul_f32 v21, 0x3fb8aa3b, v21
    v_mul_f32 v22, 0x3fb8aa3b, v22
    v_mul_f32 v23, 0x3fb8aa3b, v23
    v_mul_f32 v24, 0x3fb8aa3b, v24
    v_mul_f32 v25, 0x3fb8aa3b, v25
    v_mul_f32 v26, 0x3fb8aa3b, v26
    v_mul_f32 v27, 0x3fb8aa3b, v27
    v_mul_f32 v28, 0x3fb8aa3b, v28
    v_mul_f32 v29, 0x3fb8aa3b, v29
    v_mul_f32 v30, 0x3fb8aa3b, v30
    v_mul_f32 v31, 0x3fb8aa3b, v31
    v_mul_f32 v32, 0x3fb8aa3b, v32
    v_mul_f32 v33, 0x3fb8aa3b, v33
    v_mul_f32 v34, 0x3fb8aa3b, v34
    v_mul_f32 v35, 0x3fb8aa3b, v35
    v_mul_f32 v36, 0x3fb8aa3b, v36
    v_mul_f32 v37, 0x3fb8aa3b, v37
    v_mul_f32 v38, 0x3fb8aa3b, v38
    v_mul_f32 v39, 0x3fb8aa3b, v39
    v_mul_f32 v40, 0x3fb8aa3b, v40
    v_mul_f32 v41, 0x3fb8aa3b, v41
    v_mul_f32 v42, 0x3fb8aa3b, v42
    v_mul_f32 v43, 0x3fb8aa3b, v43
    v_exp_f32 v12, v12
    v_exp_f32 v13, v13
    v_exp_f32 v14, v14
    v_exp_f32 v15, v15
    v_exp_f32 v16, v16
    v_exp_f32 v17, v17
    v_exp_f32 v18, v18
    v_exp_f32 v19, v19
    v_exp_f32 v20, v20
    v_exp_f32 v21, v21
    v_exp_f32 v22, v22
    v_exp_f32 v23, v23
    v_exp_f32 v24, v24
    v_exp_f32 v25, v25
    v_exp_f32 v26, v26
    v_exp_f32 v27, v27
    v_exp_f32 v28, v28
    v_exp_f32 v29, v29
    v_exp_f32 v30, v30
    v_exp_f32 v31, v31
    v_exp_f32 v32, v32
    v_exp_f32 v33, v33
    v_exp_f32 v34, v34
    v_exp_f32 v35, v35
    v_exp_f32 v36, v36
    v_exp_f32 v37, v37
    v_exp_f32 v38, v38
    v_exp_f32 v39, v39
    v_exp_f32 v40, v40
    v_exp_f32 v41, v41
    v_exp_f32 v42, v42
    v_exp_f32 v43, v43
    s_nop 0
    v_cvt_pk_bf16_f32 v12, v12, v13
    v_cvt_pk_bf16_f32 v14, v14, v15
    v_cvt_pk_bf16_f32 v16, v16, v17
    v_cvt_pk_bf16_f32 v18, v18, v19
    v_cvt_pk_bf16_f32 v20, v20, v21
    v_cvt_pk_bf16_f32 v22, v22, v23
    v_cvt_pk_bf16_f32 v24, v24, v25
    v_cvt_pk_bf16_f32 v26, v26, v27
    v_cvt_pk_bf16_f32 v28, v28, v29
    v_cvt_pk_bf16_f32 v30, v30, v31
    v_cvt_pk_bf16_f32 v32, v32, v33
    v_cvt_pk_bf16_f32 v34, v34, v35
    v_cvt_pk_bf16_f32 v36, v36, v37
    v_cvt_pk_bf16_f32 v38, v38, v39
    v_cvt_pk_bf16_f32 v40, v40, v41
    v_cvt_pk_bf16_f32 v42, v42, v43
L_p1end_86:
    s_mov_b64 exec, -1
    s_cmp_eq_u32 s42, 2
    s_cbranch_scc1 L_part2_87
    s_waitcnt vmcnt(0) lgkmcnt(0)
    s_barrier
    s_cmp_lg_u32 s42, 0
    s_cbranch_scc1 L_nochk_93
    v_mov_b32 v116, 150024
    ds_read_b32 v117, v116
    s_waitcnt lgkmcnt(0)
    v_readfirstlane_b32 s3, v117
    s_nop 1
    s_cmp_lg_u32 s3, 0
    s_cbranch_scc1 L_p2slow_47
L_nochk_93:

    s_load_dwordx2 s[24:25], s[0:1], 88
    s_load_dwordx2 s[44:45], s[0:1], 96
    s_mov_b32 s26, 6400000
    s_mov_b32 s27, 0x20000
    s_movk_i32 s46, 256
    s_mov_b32 s47, 0x20000
    s_lshl_b32 s50, s36, 2
    v_and_b32 v116, 63, v0
    v_lshlrev_b32 v116, 20, v116

    s_add_u32 s20, s6, 6799360
    s_addc_u32 s21, s7, 0
    s_mov_b32 s22, 76800000
    s_mov_b32 s23, 0x20000
    v_readfirstlane_b32 s3, v0
    s_waitcnt lgkmcnt(0)
    s_cmp_eq_u32 s3, 960
    s_cbranch_scc1 L_sync_94
L_part2_87:
    v_cmp_gt_u32 vcc, 782, v0
    s_mov_b64 exec, vcc
    s_cbranch_execz L_p2end_88

    s_pack_ll_b32_b16 s52, s68, s70
    v_dot2_f32_bf16 v60, v12, s52, 0
    v_dot2_f32_bf16 v64, v20, s52, 0
    v_dot2_f32_bf16 v68, v28, s52, 0
    v_dot2_f32_bf16 v72, v36, s52, 0
    s_pack_hh_b32_b16 s53, s68, s70
    v_dot2_f32_bf16 v61, v12, s53, 0
    v_dot2_f32_bf16 v65, v20, s53, 0
    v_dot2_f32_bf16 v69, v28, s53, 0
    v_dot2_f32_bf16 v73, v36, s53, 0
    s_pack_ll_b32_b16 s52, s69, s71
    v_dot2_f32_bf16 v62, v12, s52, 0
    v_dot2_f32_bf16 v66, v20, s52, 0
    v_dot2_f32_bf16 v70, v28, s52, 0
    v_dot2_f32_bf16 v74, v36, s52, 0
    s_pack_hh_b32_b16 s53, s69, s71
    v_dot2_f32_bf16 v63, v12, s53, 0
    v_dot2_f32_bf16 v67, v20, s53, 0
    v_dot2_f32_bf16 v71, v28, s53, 0
    v_dot2_f32_bf16 v75, v36, s53, 0
    s_pack_ll_b32_b16 s52, s72, s74
    v_dot2_f32_bf16 v60, v14, s52, v60
    v_dot2_f32_bf16 v64, v22, s52, v64
    v_dot2_f32_bf16 v68, v30, s52, v68
    v_dot2_f32_bf16 v72, v38, s52, v72
    s_pack_hh_b32_b16 s53, s72, s74
    v_dot2_f32_bf16 v61, v14, s53, v61
    v_dot2_f32_bf16 v65, v22, s53, v65
    v_dot2_f32_bf16 v69, v30, s53, v69
    v_dot2_f32_bf16 v73, v38, s53, v73
    s_pack_ll_b32_b16 s52, s73, s75
    v_dot2_f32_bf16 v62, v14, s52, v62
    v_dot2_f32_bf16 v66, v22, s52, v66
    v_dot2_f32_bf16 v70, v30, s52, v70
    v_dot2_f32_bf16 v74, v38, s52, v74
    s_pack_hh_b32_b16 s53, s73, s75
    v_dot2_f32_bf16 v63, v14, s53, v63
    v_dot2_f32_bf16 v67, v22, s53, v67
    v_dot2_f32_bf16 v71, v30, s53, v71
    v_dot2_f32_bf16 v75, v38, s53, v75
    s_pack_ll_b32_b16 s52, s76, s78
    v_dot2_f32_bf16 v60, v16, s52, v60
    v_dot2_f32_bf16 v64, v24, s52, v64
    v_dot2_f32_bf16 v68, v32, s52, v68
    v_dot2_f32_bf16 v72, v40, s52, v72
    s_pack_hh_b32_b16 s53, s76, s78
    v_dot2_f32_bf16 v61, v16, s53, v61
    v_dot2_f32_bf16 v65, v24, s53, v65
    v_dot2_f32_bf16 v69, v32, s53, v69
    v_dot2_f32_bf16 v73, v40, s53, v73
    s_pack_ll_b32_b16 s52, s77, s79
    v_dot2_f32_bf16 v62, v16, s52, v62
    v_dot2_f32_bf16 v66, v24, s52, v66
    v_dot2_f32_bf16 v70, v32, s52, v70
    v_dot2_f32_bf16 v74, v40, s52, v74
    s_pack_hh_b32_b16 s53, s77, s79
    v_dot2_f32_bf16 v63, v16, s53, v63
    v_dot2_f32_bf16 v67, v24, s53, v67
    v_dot2_f32_bf16 v71, v32, s53, v71
    v_dot2_f32_bf16 v75, v40, s53, v75
    s_pack_ll_b32_b16 s52, s80, s82
    v_dot2_f32_bf16 v60, v18, s52, v60
    v_dot2_f32_bf16 v64, v26, s52, v64
    v_dot2_f32_bf16 v68, v34, s52, v68
    v_dot2_f32_bf16 v72, v42, s52, v72
    s_pack_hh_b32_b16 s53, s80, s82
    v_dot2_f32_bf16 v61, v18, s53, v61
    v_dot2_f32_bf16 v65, v26, s53, v65
    v_dot2_f32_bf16 v69, v34, s53, v69
    v_dot2_f32_bf16 v73, v42, s53, v73
    s_pack_ll_b32_b16 s52, s81, s83
    v_dot2_f32_bf16 v62, v18, s52, v62
    v_dot2_f32_bf16 v66, v26, s52, v66
    v_dot2_f32_bf16 v70, v34, s52, v70
    v_dot2_f32_bf16 v74, v42, s52, v74
    s_pack_hh_b32_b16 s53, s81, s83
    v_dot2_f32_bf16 v63, v18, s53, v63
    v_dot2_f32_bf16 v67, v26, s53, v67
    v_dot2_f32_bf16 v71, v34, s53, v71
    v_dot2_f32_bf16 v75, v42, s53, v75
    s_pack_ll_b32_b16 s52, s84, s86
    v_dot2_f32_bf16 v44, v12, s52, 0
    v_dot2_f32_bf16 v48, v20, s52, 0
    v_dot2_f32_bf16 v52, v28, s52, 0
    v_dot2_f32_bf16 v56, v36, s52, 0
    s_pack_hh_b32_b16 s53, s84, s86
    v_dot2_f32_bf16 v45, v12, s53, 0
    v_dot2_f32_bf16 v49, v20, s53, 0
    v_dot2_f32_bf16 v53, v28, s53, 0
    v_dot2_f32_bf16 v57, v36, s53, 0
    s_pack_ll_b32_b16 s52, s85, s87
    v_dot2_f32_bf16 v46, v12, s52, 0
    v_dot2_f32_bf16 v50, v20, s52, 0
    v_dot2_f32_bf16 v54, v28, s52, 0
    v_dot2_f32_bf16 v58, v36, s52, 0
    s_pack_hh_b32_b16 s53, s85, s87
    v_dot2_f32_bf16 v47, v12, s53, 0
    v_dot2_f32_bf16 v51, v20, s53, 0
    v_dot2_f32_bf16 v55, v28, s53, 0
    v_dot2_f32_bf16 v59, v36, s53, 0
    s_pack_ll_b32_b16 s52, s88, s90
    v_dot2_f32_bf16 v44, v14, s52, v44
    v_dot2_f32_bf16 v48, v22, s52, v48
    v_dot2_f32_bf16 v52, v30, s52, v52
    v_dot2_f32_bf16 v56, v38, s52, v56
    s_pack_hh_b32_b16 s53, s88, s90
    v_dot2_f32_bf16 v45, v14, s53, v45
    v_dot2_f32_bf16 v49, v22, s53, v49
    v_dot2_f32_bf16 v53, v30, s53, v53
    v_dot2_f32_bf16 v57, v38, s53, v57
    s_pack_ll_b32_b16 s52, s89, s91
    v_dot2_f32_bf16 v46, v14, s52, v46
    v_dot2_f32_bf16 v50, v22, s52, v50
    v_dot2_f32_bf16 v54, v30, s52, v54
    v_dot2_f32_bf16 v58, v38, s52, v58
    s_pack_hh_b32_b16 s53, s89, s91
    v_dot2_f32_bf16 v47, v14, s53, v47
    v_dot2_f32_bf16 v51, v22, s53, v51
    v_dot2_f32_bf16 v55, v30, s53, v55
    v_dot2_f32_bf16 v59, v38, s53, v59
    s_pack_ll_b32_b16 s52, s92, s94
    v_dot2_f32_bf16 v44, v16, s52, v44
    v_dot2_f32_bf16 v48, v24, s52, v48
    v_dot2_f32_bf16 v52, v32, s52, v52
    v_dot2_f32_bf16 v56, v40, s52, v56
    s_pack_hh_b32_b16 s53, s92, s94
    v_dot2_f32_bf16 v45, v16, s53, v45
    v_dot2_f32_bf16 v49, v24, s53, v49
    v_dot2_f32_bf16 v53, v32, s53, v53
    v_dot2_f32_bf16 v57, v40, s53, v57
    s_pack_ll_b32_b16 s52, s93, s95
    v_dot2_f32_bf16 v46, v16, s52, v46
    v_dot2_f32_bf16 v50, v24, s52, v50
    v_dot2_f32_bf16 v54, v32, s52, v54
    v_dot2_f32_bf16 v58, v40, s52, v58
    s_pack_hh_b32_b16 s53, s93, s95
    v_dot2_f32_bf16 v47, v16, s53, v47
    v_dot2_f32_bf16 v51, v24, s53, v51
    v_dot2_f32_bf16 v55, v32, s53, v55
    v_dot2_f32_bf16 v59, v40, s53, v59
    s_pack_ll_b32_b16 s52, s96, s98
    v_dot2_f32_bf16 v44, v18, s52, v44
    v_dot2_f32_bf16 v48, v26, s52, v48
    v_dot2_f32_bf16 v52, v34, s52, v52
    v_dot2_f32_bf16 v56, v42, s52, v56
    s_pack_hh_b32_b16 s53, s96, s98
    v_dot2_f32_bf16 v45, v18, s53, v45
    v_dot2_f32_bf16 v49, v26, s53, v49
    v_dot2_f32_bf16 v53, v34, s53, v53
    v_dot2_f32_bf16 v57, v42, s53, v57
    s_pack_ll_b32_b16 s52, s97, s99
    v_dot2_f32_bf16 v46, v18, s52, v46
    v_dot2_f32_bf16 v50, v26, s52, v50
    v_dot2_f32_bf16 v54, v34, s52, v54
    v_dot2_f32_bf16 v58, v42, s52, v58
    s_pack_hh_b32_b16 s53, s97, s99
    v_dot2_f32_bf16 v47, v18, s53, v47
    v_dot2_f32_bf16 v51, v26, s53, v51
    v_dot2_f32_bf16 v55, v34, s53, v55
    v_dot2_f32_bf16 v59, v42, s53, v59
    v_cvt_pk_bf16_f32 v60, v60, v61
    v_cvt_pk_bf16_f32 v62, v62, v63
    v_cvt_pk_bf16_f32 v64, v64, v65
    v_cvt_pk_bf16_f32 v66, v66, v67
    v_cvt_pk_bf16_f32 v68, v68, v69
    v_cvt_pk_bf16_f32 v70, v70, v71
    v_cvt_pk_bf16_f32 v72, v72, v73
    v_cvt_pk_bf16_f32 v74, v74, v75
    v_and_b32 v61, s32, v60
    v_lshlrev_b32 v60, 16, v60
    v_and_b32 v63, s32, v62
    v_lshlrev_b32 v62, 16, v62
    v_and_b32 v65, s32, v64
    v_lshlrev_b32 v64, 16, v64
    v_and_b32 v67, s32, v66
    v_lshlrev_b32 v66, 16, v66
    v_and_b32 v69, s32, v68
    v_lshlrev_b32 v68, 16, v68
    v_and_b32 v71, s32, v70
    v_lshlrev_b32 v70, 16, v70
    v_and_b32 v73, s32, v72
    v_lshlrev_b32 v72, 16, v72
    v_and_b32 v75, s32, v74
    v_lshlrev_b32 v74, 16, v74
L_p2end_88:
    s_mov_b64 exec, -1
    s_cmp_eq_u32 s42, 2
    s_cbranch_scc1 L_post_91
L_bcast_89:
    v_mov_b32 v118, 150016
    s_mov_b32 s42, 2
    s_waitcnt lgkmcnt(0)
    s_barrier
    ds_read_b32 v117, v118
    s_waitcnt lgkmcnt(0)
    v_readfirstlane_b32 s35, v117
    s_nop 1
    s_bitcmp1_b32 s35, 16
    s_cbranch_scc1 L_nextq_90
L_post_91:
    v_cmp_gt_u32 vcc, 782, v0
    s_mov_b64 exec, vcc
    s_cbranch_execz L_postend_92

    s_mov_b32 s3, 0
    buffer_load_dwordx4 v[76:79], v4, s[20:23], s3 offen sc1
    buffer_load_dwordx4 v[92:95], v5, s[20:23], s3 offen sc1
    s_mov_b32 s3, 6400000
    buffer_load_dwordx4 v[80:83], v4, s[20:23], s3 offen sc1
    buffer_load_dwordx4 v[96:99], v5, s[20:23], s3 offen sc1
    s_mov_b32 s3, 12800000
    buffer_load_dwordx4 v[84:87], v4, s[20:23], s3 offen sc1
    buffer_load_dwordx4 v[100:103], v5, s[20:23], s3 offen sc1
    s_mov_b32 s3, 19200000
    buffer_load_dwordx4 v[88:91], v4, s[20:23], s3 offen sc1
    buffer_load_dwordx4 v[104:107], v5, s[20:23], s3 offen sc1
    s_and_b32 s3, s35, 0xf0
    s_cbranch_scc1 L_fgen_98
    s_waitcnt vmcnt(0)

    v_add_u32 v76, v76, v80
    v_add_u32 v84, v84, v88
    v_add_u32 v77, v77, v81
    v_add_u32 v85, v85, v89
    v_add_u32 v78, v78, v82
    v_add_u32 v86, v86, v90
    v_add_u32 v79, v79, v83
    v_add_u32 v87, v87, v91
    v_add_u32_sdwa v12, v76, v84 dst_sel:DWORD dst_unused:UNUSED_PAD src0_sel:WORD_0 src1_sel:WORD_0
    v_add_u32_sdwa v13, v76, v84 dst_sel:DWORD dst_unused:UNUSED_PAD src0_sel:WORD_1 src1_sel:WORD_1
    v_add_u32_sdwa v14, v77, v85 dst_sel:DWORD dst_unused:UNUSED_PAD src0_sel:WORD_0 src1_sel:WORD_0
    v_add_u32_sdwa v15, v77, v85 dst_sel:DWORD dst_unused:UNUSED_PAD src0_sel:WORD_1 src1_sel:WORD_1
    v_add_u32_sdwa v16, v78, v86 dst_sel:DWORD dst_unused:UNUSED_PAD src0_sel:WORD_0 src1_sel:WORD_0
    v_add_u32_sdwa v17, v78, v86 dst_sel:DWORD dst_unused:UNUSED_PAD src0_sel:WORD_1 src1_sel:WORD_1
    v_add_u32_sdwa v18, v79, v87 dst_sel:DWORD dst_unused:UNUSED_PAD src0_sel:WORD_0 src1_sel:WORD_0
    v_add_u32_sdwa v19, v79, v87 dst_sel:DWORD dst_unused:UNUSED_PAD src0_sel:WORD_1 src1_sel:WORD_1
    v_add_u32 v92, v92, v96
    v_add_u32 v100, v100, v104
    v_add_u32 v93, v93, v97
    v_add_u32 v101, v101, v105
    v_add_u32 v94, v94, v98
    v_add_u32 v102, v102, v106
    v_add_u32 v95, v95, v99
    v_add_u32 v103, v103, v107
    v_add_u32_sdwa v20, v92, v100 dst_sel:DWORD dst_unused:UNUSED_PAD src0_sel:WORD_0 src1_sel:WORD_0
    v_add_u32_sdwa v21, v92, v100 dst_sel:DWORD dst_unused:UNUSED_PAD src0_sel:WORD_1 src1_sel:WORD_1
    v_add_u32_sdwa v22, v93, v101 dst_sel:DWORD dst_unused:UNUSED_PAD src0_sel:WORD_0 src1_sel:WORD_0
    v_add_u32_sdwa v23, v93, v101 dst_sel:DWORD dst_unused:UNUSED_PAD src0_sel:WORD_1 src1_sel:WORD_1
    v_add_u32_sdwa v24, v94, v102 dst_sel:DWORD dst_unused:UNUSED_PAD src0_sel:WORD_0 src1_sel:WORD_0
    v_add_u32_sdwa v25, v94, v102 dst_sel:DWORD dst_unused:UNUSED_PAD src0_sel:WORD_1 src1_sel:WORD_1
    v_add_u32_sdwa v26, v95, v103 dst_sel:DWORD dst_unused:UNUSED_PAD src0_sel:WORD_0 src1_sel:WORD_0
    v_add_u32_sdwa v27, v95, v103 dst_sel:DWORD dst_unused:UNUSED_PAD src0_sel:WORD_1 src1_sel:WORD_1
    v_add_u32 v12, 0xffff0000, v12
    v_add_u32 v13, 0xffff0000, v13
    v_add_u32 v14, 0xffff0000, v14
    v_add_u32 v15, 0xffff0000, v15
    v_add_u32 v16, 0xffff0000, v16
    v_add_u32 v17, 0xffff0000, v17
    v_add_u32 v18, 0xffff0000, v18
    v_add_u32 v19, 0xffff0000, v19
    v_add_u32 v20, 0xffff0000, v20
    v_add_u32 v21, 0xffff0000, v21
    v_add_u32 v22, 0xffff0000, v22
    v_add_u32 v23, 0xffff0000, v23
    v_add_u32 v24, 0xffff0000, v24
    v_add_u32 v25, 0xffff0000, v25
    v_add_u32 v26, 0xffff0000, v26
    v_add_u32 v27, 0xffff0000, v27
    v_cvt_f32_i32 v12, v12
    v_cvt_f32_i32 v13, v13
    v_cvt_f32_i32 v14, v14
    v_cvt_f32_i32 v15, v15
    v_cvt_f32_i32 v16, v16
    v_cvt_f32_i32 v17, v17
    v_cvt_f32_i32 v18, v18
    v_cvt_f32_i32 v19, v19
    v_cvt_f32_i32 v20, v20
    v_cvt_f32_i32 v21, v21
    v_cvt_f32_i32 v22, v22
    v_cvt_f32_i32 v23, v23
    v_cvt_f32_i32 v24, v24
    v_cvt_f32_i32 v25, v25
    v_cvt_f32_i32 v26, v26
    v_cvt_f32_i32 v27, v27
    v_mul_f32 v12, s34, v12
    v_mul_f32 v13, s34, v13
    v_mul_f32 v14, s34, v14
    v_mul_f32 v15, s34, v15
    v_mul_f32 v16, s34, v16
    v_mul_f32 v17, s34, v17
    v_mul_f32 v18, s34, v18
    v_mul_f32 v19, s34, v19
    v_mul_f32 v20, s34, v20
    v_mul_f32 v21, s34, v21
    v_mul_f32 v22, s34, v22
    v_mul_f32 v23, s34, v23
    v_mul_f32 v24, s34, v24
    v_mul_f32 v25, s34, v25
    v_mul_f32 v26, s34, v26
    v_mul_f32 v27, s34, v27
L_fbk_99:
    s_lshl_b32 s52, s12, 16
    v_mul_f32 v28, s52, v12
    v_mul_f32 v32, s52, v16
    v_mul_f32 v36, s52, v20
    v_mul_f32 v40, s52, v24
    s_and_b32 s53, s12, s32
    v_mul_f32 v29, s53, v12
    v_mul_f32 v33, s53, v16
    v_mul_f32 v37, s53, v20
    v_mul_f32 v41, s53, v24
    s_lshl_b32 s52, s13, 16
    v_mul_f32 v30, s52, v12
    v_mul_f32 v34, s52, v16
    v_mul_f32 v38, s52, v20
    v_mul_f32 v42, s52, v24
    s_and_b32 s53, s13, s32
    v_mul_f32 v31, s53, v12
    v_mul_f32 v35, s53, v16
    v_mul_f32 v39, s53, v20
    v_mul_f32 v43, s53, v24
    s_lshl_b32 s52, s14, 16
    v_fmac_f32 v28, s52, v13
    v_fmac_f32 v32, s52, v17
    v_fmac_f32 v36, s52, v21
    v_fmac_f32 v40, s52, v25
    s_and_b32 s53, s14, s32
    v_fmac_f32 v29, s53, v13
    v_fmac_f32 v33, s53, v17
    v_fmac_f32 v37, s53, v21
    v_fmac_f32 v41, s53, v25
    s_lshl_b32 s52, s15, 16
    v_fmac_f32 v30, s52, v13
    v_fmac_f32 v34, s52, v17
    v_fmac_f32 v38, s52, v21
    v_fmac_f32 v42, s52, v25
    s_and_b32 s53, s15, s32
    v_fmac_f32 v31, s53, v13
    v_fmac_f32 v35, s53, v17
    v_fmac_f32 v39, s53, v21
    v_fmac_f32 v43, s53, v25
    s_lshl_b32 s52, s16, 16
    v_fmac_f32 v28, s52, v14
    v_fmac_f32 v32, s52, v18
    v_fmac_f32 v36, s52, v22
    v_fmac_f32 v40, s52, v26
    s_and_b32 s53, s16, s32
    v_fmac_f32 v29, s53, v14
    v_fmac_f32 v33, s53, v18
    v_fmac_f32 v37, s53, v22
    v_fmac_f32 v41, s53, v26
    s_lshl_b32 s52, s17, 16
    v_fmac_f32 v30, s52, v14
    v_fmac_f32 v34, s52, v18
    v_fmac_f32 v38, s52, v22
    v_fmac_f32 v42, s52, v26
    s_and_b32 s53, s17, s32
    v_fmac_f32 v31, s53, v14
    v_fmac_f32 v35, s53, v18
    v_fmac_f32 v39, s53, v22
    v_fmac_f32 v43, s53, v26
    s_lshl_b32 s52, s18, 16
    v_fmac_f32 v28, s52, v15
    v_fmac_f32 v32, s52, v19
    v_fmac_f32 v36, s52, v23
    v_fmac_f32 v40, s52, v27
    s_and_b32 s53, s18, s32
    v_fmac_f32 v29, s53, v15
    v_fmac_f32 v33, s53, v19
    v_fmac_f32 v37, s53, v23
    v_fmac_f32 v41, s53, v27
    s_lshl_b32 s52, s19, 16
    v_fmac_f32 v30, s52, v15
    v_fmac_f32 v34, s52, v19
    v_fmac_f32 v38, s52, v23
    v_fmac_f32 v42, s52, v27
    s_and_b32 s53, s19, s32
    v_fmac_f32 v31, s53, v15
    v_fmac_f32 v35, s53, v19
    v_fmac_f32 v39, s53, v23
    v_fmac_f32 v43, s53, v27
    v_mul_f32 v28, v28, v44
    v_mul_f32 v29, v29, v45
    v_mul_f32 v30, v30, v46
    v_mul_f32 v31, v31, v47
    v_mul_f32 v32, v32, v48
    v_mul_f32 v33, v33, v49
    v_mul_f32 v34, v34, v50
    v_mul_f32 v35, v35, v51
    v_mul_f32 v36, v36, v52
    v_mul_f32 v37, v37, v53
    v_mul_f32 v38, v38, v54
    v_mul_f32 v39, v39, v55
    v_mul_f32 v40, v40, v56
    v_mul_f32 v41, v41, v57
    v_mul_f32 v42, v42, v58
    v_mul_f32 v43, v43, v59
    v_cvt_pk_bf16_f32 v28, v28, v29
    v_cvt_pk_bf16_f32 v30, v30, v31
    v_cvt_pk_bf16_f32 v32, v32, v33
    v_cvt_pk_bf16_f32 v34, v34, v35
    v_cvt_pk_bf16_f32 v36, v36, v37
    v_cvt_pk_bf16_f32 v38, v38, v39
    v_cvt_pk_bf16_f32 v40, v40, v41
    v_cvt_pk_bf16_f32 v42, v42, v43
    s_pack_ll_b32_b16 s52, s56, s58
    v_dot2_f32_bf16 v12, v28, s52, 0
    v_dot2_f32_bf16 v16, v32, s52, 0
    v_dot2_f32_bf16 v20, v36, s52, 0
    v_dot2_f32_bf16 v24, v40, s52, 0
    s_pack_hh_b32_b16 s53, s56, s58
    v_dot2_f32_bf16 v13, v28, s53, 0
    v_dot2_f32_bf16 v17, v32, s53, 0
    v_dot2_f32_bf16 v21, v36, s53, 0
    v_dot2_f32_bf16 v25, v40, s53, 0
    s_pack_ll_b32_b16 s52, s57, s59
    v_dot2_f32_bf16 v14, v28, s52, 0
    v_dot2_f32_bf16 v18, v32, s52, 0
    v_dot2_f32_bf16 v22, v36, s52, 0
    v_dot2_f32_bf16 v26, v40, s52, 0
    s_pack_hh_b32_b16 s53, s57, s59
    v_dot2_f32_bf16 v15, v28, s53, 0
    v_dot2_f32_bf16 v19, v32, s53, 0
    v_dot2_f32_bf16 v23, v36, s53, 0
    v_dot2_f32_bf16 v27, v40, s53, 0
    s_pack_ll_b32_b16 s52, s60, s62
    v_dot2_f32_bf16 v12, v30, s52, v12
    v_dot2_f32_bf16 v16, v34, s52, v16
    v_dot2_f32_bf16 v20, v38, s52, v20
    v_dot2_f32_bf16 v24, v42, s52, v24
    s_pack_hh_b32_b16 s53, s60, s62
    v_dot2_f32_bf16 v13, v30, s53, v13
    v_dot2_f32_bf16 v17, v34, s53, v17
    v_dot2_f32_bf16 v21, v38, s53, v21
    v_dot2_f32_bf16 v25, v42, s53, v25
    s_pack_ll_b32_b16 s52, s61, s63
    v_dot2_f32_bf16 v14, v30, s52, v14
    v_dot2_f32_bf16 v18, v34, s52, v18
    v_dot2_f32_bf16 v22, v38, s52, v22
    v_dot2_f32_bf16 v26, v42, s52, v26
    s_pack_hh_b32_b16 s53, s61, s63
    v_dot2_f32_bf16 v15, v30, s53, v15
    v_dot2_f32_bf16 v19, v34, s53, v19
    v_dot2_f32_bf16 v23, v38, s53, v23
    v_dot2_f32_bf16 v27, v42, s53, v27
    v_lshlrev_b32 v44, 16, v108
    v_and_b32 v45, s32, v108
    v_lshlrev_b32 v46, 16, v109
    v_and_b32 v47, s32, v109
    v_lshlrev_b32 v48, 16, v110
    v_and_b32 v49, s32, v110
    v_lshlrev_b32 v50, 16, v111
    v_and_b32 v51, s32, v111
    v_lshlrev_b32 v52, 16, v112
    v_and_b32 v53, s32, v112
    v_lshlrev_b32 v54, 16, v113
    v_and_b32 v55, s32, v113
    v_lshlrev_b32 v56, 16, v114
    v_and_b32 v57, s32, v114
    v_lshlrev_b32 v58, 16, v115
    v_and_b32 v59, s32, v115
    v_cvt_pk_bf16_f32 v12, v12, v13
    v_cvt_pk_bf16_f32 v14, v14, v15
    v_cvt_pk_bf16_f32 v16, v16, v17
    v_cvt_pk_bf16_f32 v18, v18, v19
    v_cvt_pk_bf16_f32 v20, v20, v21
    v_cvt_pk_bf16_f32 v22, v22, v23
    v_cvt_pk_bf16_f32 v24, v24, v25
    v_cvt_pk_bf16_f32 v26, v26, v27
    v_and_b32 v13, s32, v12
    v_lshlrev_b32 v12, 16, v12
    v_and_b32 v15, s32, v14
    v_lshlrev_b32 v14, 16, v14
    v_and_b32 v17, s32, v16
    v_lshlrev_b32 v16, 16, v16
    v_and_b32 v19, s32, v18
    v_lshlrev_b32 v18, 16, v18
    v_and_b32 v21, s32, v20
    v_lshlrev_b32 v20, 16, v20
    v_and_b32 v23, s32, v22
    v_lshlrev_b32 v22, 16, v22
    v_and_b32 v25, s32, v24
    v_lshlrev_b32 v24, 16, v24
    v_and_b32 v27, s32, v26
    v_lshlrev_b32 v26, 16, v26
    v_mul_f32 v12, v12, v60
    v_mul_f32 v13, v13, v61
    v_mul_f32 v14, v14, v62
    v_mul_f32 v15, v15, v63
    v_mul_f32 v16, v16, v64
    v_mul_f32 v17, v17, v65
    v_mul_f32 v18, v18, v66
    v_mul_f32 v19, v19, v67
    v_mul_f32 v20, v20, v68
    v_mul_f32 v21, v21, v69
    v_mul_f32 v22, v22, v70
    v_mul_f32 v23, v23, v71
    v_mul_f32 v24, v24, v72
    v_mul_f32 v25, v25, v73
    v_mul_f32 v26, v26, v74
    v_mul_f32 v27, v27, v75
    v_cvt_pk_bf16_f32 v12, v12, v13
    v_cvt_pk_bf16_f32 v14, v14, v15
    v_cvt_pk_bf16_f32 v16, v16, v17
    v_cvt_pk_bf16_f32 v18, v18, v19
    v_cvt_pk_bf16_f32 v20, v20, v21
    v_cvt_pk_bf16_f32 v22, v22, v23
    v_cvt_pk_bf16_f32 v24, v24, v25
    v_cvt_pk_bf16_f32 v26, v26, v27
    v_and_b32 v13, s32, v12
    v_lshlrev_b32 v12, 16, v12
    v_and_b32 v15, s32, v14
    v_lshlrev_b32 v14, 16, v14
    v_and_b32 v17, s32, v16
    v_lshlrev_b32 v16, 16, v16
    v_and_b32 v19, s32, v18
    v_lshlrev_b32 v18, 16, v18
    v_and_b32 v21, s32, v20
    v_lshlrev_b32 v20, 16, v20
    v_and_b32 v23, s32, v22
    v_lshlrev_b32 v22, 16, v22
    v_and_b32 v25, s32, v24
    v_lshlrev_b32 v24, 16, v24
    v_and_b32 v27, s32, v26
    v_lshlrev_b32 v26, 16, v26
    v_add_f32 v12, v12, v44
    v_add_f32 v13, v13, v45
    v_add_f32 v14, v14, v46
    v_add_f32 v15, v15, v47
    v_add_f32 v16, v16, v48
    v_add_f32 v17, v17, v49
    v_add_f32 v18, v18, v50
    v_add_f32 v19, v19, v51
    v_add_f32 v20, v20, v52
    v_add_f32 v21, v21, v53
    v_add_f32 v22, v22, v54
    v_add_f32 v23, v23, v55
    v_add_f32 v24, v24, v56
    v_add_f32 v25, v25, v57
    v_add_f32 v26, v26, v58
    v_add_f32 v27, v27, v59
    v_cvt_pk_bf16_f32 v28, v12, v13
    v_cvt_pk_bf16_f32 v29, v14, v15
    v_cvt_pk_bf16_f32 v30, v16, v17
    v_cvt_pk_bf16_f32 v31, v18, v19
    v_cvt_pk_bf16_f32 v32, v20, v21
    v_cvt_pk_bf16_f32 v33, v22, v23
    v_cvt_pk_bf16_f32 v34, v24, v25
    v_cvt_pk_bf16_f32 v35, v26, v27
    buffer_store_dwordx4 v[28:31], v4, s[24:27], 0 offen
    buffer_store_dwordx4 v[32:35], v5, s[24:27], 0 offen
L_postend_92:
    s_mov_b64 exec, -1
L_nextq_90:
    s_bfe_u32 s3, s35, 0x40008
    s_cbranch_scc0 L_fend_108
    s_ff1_i32_b32 s41, s3
    s_add_u32 s3, s41, 8
    s_bitset0_b32 s35, s3
    s_branch L_qloop_85
L_fend_108:

L_p2done_46:
    s_endpgm

L_ufix_48:
    v_and_b32 v117, 63, v0
    v_lshlrev_b32 v117, 2, v117
    s_sub_i32 s54, s42, 1024
    v_cmp_le_i32 vcc, s54, v117
    s_mov_b64 exec, vcc
    v_mov_b32 v12, 0
    v_mov_b32 v44, 0
    s_mov_b64 exec, -1
    s_sub_i32 s54, s42, 1025
    v_cmp_le_i32 vcc, s54, v117
    s_mov_b64 exec, vcc
    v_mov_b32 v13, 0
    v_mov_b32 v46, 0
    s_mov_b64 exec, -1
    s_sub_i32 s54, s42, 1026
    v_cmp_le_i32 vcc, s54, v117
    s_mov_b64 exec, vcc
    v_mov_b32 v14, 0
    v_mov_b32 v48, 0
    s_mov_b64 exec, -1
    s_sub_i32 s54, s42, 1027
    v_cmp_le_i32 vcc, s54, v117
    s_mov_b64 exec, vcc
    v_mov_b32 v15, 0
    v_mov_b32 v50, 0
    s_mov_b64 exec, -1
    s_branch L_uback_49
L_ufix_50:
    v_and_b32 v117, 63, v0
    v_lshlrev_b32 v117, 2, v117
    s_sub_i32 s54, s42, 1536
    v_cmp_le_i32 vcc, s54, v117
    s_mov_b64 exec, vcc
    v_mov_b32 v16, 0
    v_mov_b32 v52, 0
    s_mov_b64 exec, -1
    s_sub_i32 s54, s42, 1537
    v_cmp_le_i32 vcc, s54, v117
    s_mov_b64 exec, vcc
    v_mov_b32 v17, 0
    v_mov_b32 v54, 0
    s_mov_b64 exec, -1
    s_sub_i32 s54, s42, 1538
    v_cmp_le_i32 vcc, s54, v117
    s_mov_b64 exec, vcc
    v_mov_b32 v18, 0
    v_mov_b32 v56, 0
    s_mov_b64 exec, -1
    s_sub_i32 s54, s42, 1539
    v_cmp_le_i32 vcc, s54, v117
    s_mov_b64 exec, vcc
    v_mov_b32 v19, 0
    v_mov_b32 v58, 0
    s_mov_b64 exec, -1
    s_branch L_uback_51
L_ufix_52:
    v_and_b32 v117, 63, v0
    v_lshlrev_b32 v117, 2, v117
    s_sub_i32 s54, s42, 2048
    v_cmp_le_i32 vcc, s54, v117
    s_mov_b64 exec, vcc
    v_mov_b32 v20, 0
    v_mov_b32 v60, 0
    s_mov_b64 exec, -1
    s_sub_i32 s54, s42, 2049
    v_cmp_le_i32 vcc, s54, v117
    s_mov_b64 exec, vcc
    v_mov_b32 v21, 0
    v_mov_b32 v62, 0
    s_mov_b64 exec, -1
    s_sub_i32 s54, s42, 2050
    v_cmp_le_i32 vcc, s54, v117
    s_mov_b64 exec, vcc
    v_mov_b32 v22, 0
    v_mov_b32 v64, 0
    s_mov_b64 exec, -1
    s_sub_i32 s54, s42, 2051
    v_cmp_le_i32 vcc, s54, v117
    s_mov_b64 exec, vcc
    v_mov_b32 v23, 0
    v_mov_b32 v66, 0
    s_mov_b64 exec, -1
    s_branch L_uback_53
L_ufix_54:
    v_and_b32 v117, 63, v0
    v_lshlrev_b32 v117, 2, v117
    s_sub_i32 s54, s42, 2560
    v_cmp_le_i32 vcc, s54, v117
    s_mov_b64 exec, vcc
    v_mov_b32 v24, 0
    v_mov_b32 v68, 0
    s_mov_b64 exec, -1
    s_sub_i32 s54, s42, 2561
    v_cmp_le_i32 vcc, s54, v117
    s_mov_b64 exec, vcc
    v_mov_b32 v25, 0
    v_mov_b32 v70, 0
    s_mov_b64 exec, -1
    s_sub_i32 s54, s42, 2562
    v_cmp_le_i32 vcc, s54, v117
    s_mov_b64 exec, vcc
    v_mov_b32 v26, 0
    v_mov_b32 v72, 0
    s_mov_b64 exec, -1
    s_sub_i32 s54, s42, 2563
    v_cmp_le_i32 vcc, s54, v117
    s_mov_b64 exec, vcc
    v_mov_b32 v27, 0
    v_mov_b32 v74, 0
    s_mov_b64 exec, -1
    s_branch L_uback_55
L_ufix_56:
    v_and_b32 v117, 63, v0
    v_lshlrev_b32 v117, 2, v117
    s_sub_i32 s54, s42, 0
    v_cmp_le_i32 vcc, s54, v117
    s_mov_b64 exec, vcc
    v_mov_b32 v4, 0
    v_mov_b32 v28, 0
    s_mov_b64 exec, -1
    s_sub_i32 s54, s42, 1
    v_cmp_le_i32 vcc, s54, v117
    s_mov_b64 exec, vcc
    v_mov_b32 v5, 0
    v_mov_b32 v30, 0
    s_mov_b64 exec, -1
    s_sub_i32 s54, s42, 2
    v_cmp_le_i32 vcc, s54, v117
    s_mov_b64 exec, vcc
    v_mov_b32 v6, 0
    v_mov_b32 v32, 0
    s_mov_b64 exec, -1
    s_sub_i32 s54, s42, 3
    v_cmp_le_i32 vcc, s54, v117
    s_mov_b64 exec, vcc
    v_mov_b32 v7, 0
    v_mov_b32 v34, 0
    s_mov_b64 exec, -1
    s_branch L_uback_57
L_ufix_58:
    v_and_b32 v117, 63, v0
    v_lshlrev_b32 v117, 2, v117
    s_sub_i32 s54, s42, 512
    v_cmp_le_i32 vcc, s54, v117
    s_mov_b64 exec, vcc
    v_mov_b32 v8, 0
    v_mov_b32 v36, 0
    s_mov_b64 exec, -1
    s_sub_i32 s54, s42, 513
    v_cmp_le_i32 vcc, s54, v117
    s_mov_b64 exec, vcc
    v_mov_b32 v9, 0
    v_mov_b32 v38, 0
    s_mov_b64 exec, -1
    s_sub_i32 s54, s42, 514
    v_cmp_le_i32 vcc, s54, v117
    s_mov_b64 exec, vcc
    v_mov_b32 v10, 0
    v_mov_b32 v40, 0
    s_mov_b64 exec, -1
    s_sub_i32 s54, s42, 515
    v_cmp_le_i32 vcc, s54, v117
    s_mov_b64 exec, vcc
    v_mov_b32 v11, 0
    v_mov_b32 v42, 0
    s_mov_b64 exec, -1
    s_branch L_uback_59
L_ufix_65:
    v_and_b32 v117, 63, v0
    v_lshlrev_b32 v117, 2, v117
    s_sub_i32 s54, s42, 3072
    v_cmp_le_i32 vcc, s54, v117
    s_mov_b64 exec, vcc
    v_mov_b32 v106, 0
    v_mov_b32 v120, 0
    s_mov_b64 exec, -1
    s_sub_i32 s54, s42, 3073
    v_cmp_le_i32 vcc, s54, v117
    s_mov_b64 exec, vcc
    v_mov_b32 v107, 0
    v_mov_b32 v122, 0
    s_mov_b64 exec, -1
    s_sub_i32 s54, s42, 3074
    v_cmp_le_i32 vcc, s54, v117
    s_mov_b64 exec, vcc
    v_mov_b32 v108, 0
    v_mov_b32 v124, 0
    s_mov_b64 exec, -1
    s_sub_i32 s54, s42, 3075
    v_cmp_le_i32 vcc, s54, v117
    s_mov_b64 exec, vcc
    v_mov_b32 v109, 0
    v_mov_b32 v126, 0
    s_mov_b64 exec, -1
    s_branch L_uback_66
L_ufix_69:
    v_and_b32 v117, 63, v0
    v_lshlrev_b32 v117, 2, v117
    s_sub_i32 s54, s42, 1024
    v_cmp_le_i32 vcc, s54, v117
    s_mov_b64 exec, vcc
    v_mov_b32 v12, 0
    v_mov_b32 v44, 0
    s_mov_b64 exec, -1
    s_sub_i32 s54, s42, 1025
    v_cmp_le_i32 vcc, s54, v117
    s_mov_b64 exec, vcc
    v_mov_b32 v13, 0
    v_mov_b32 v46, 0
    s_mov_b64 exec, -1
    s_sub_i32 s54, s42, 1026
    v_cmp_le_i32 vcc, s54, v117
    s_mov_b64 exec, vcc
    v_mov_b32 v14, 0
    v_mov_b32 v48, 0
    s_mov_b64 exec, -1
    s_sub_i32 s54, s42, 1027
    v_cmp_le_i32 vcc, s54, v117
    s_mov_b64 exec, vcc
    v_mov_b32 v15, 0
    v_mov_b32 v50, 0
    s_mov_b64 exec, -1
    s_branch L_uback_70
L_ufix_71:
    v_and_b32 v117, 63, v0
    v_lshlrev_b32 v117, 2, v117
    s_sub_i32 s54, s42, 1536
    v_cmp_le_i32 vcc, s54, v117
    s_mov_b64 exec, vcc
    v_mov_b32 v16, 0
    v_mov_b32 v52, 0
    s_mov_b64 exec, -1
    s_sub_i32 s54, s42, 1537
    v_cmp_le_i32 vcc, s54, v117
    s_mov_b64 exec, vcc
    v_mov_b32 v17, 0
    v_mov_b32 v54, 0
    s_mov_b64 exec, -1
    s_sub_i32 s54, s42, 1538
    v_cmp_le_i32 vcc, s54, v117
    s_mov_b64 exec, vcc
    v_mov_b32 v18, 0
    v_mov_b32 v56, 0
    s_mov_b64 exec, -1
    s_sub_i32 s54, s42, 1539
    v_cmp_le_i32 vcc, s54, v117
    s_mov_b64 exec, vcc
    v_mov_b32 v19, 0
    v_mov_b32 v58, 0
    s_mov_b64 exec, -1
    s_branch L_uback_72
L_ufix_73:
    v_and_b32 v117, 63, v0
    v_lshlrev_b32 v117, 2, v117
    s_sub_i32 s54, s42, 2048
    v_cmp_le_i32 vcc, s54, v117
    s_mov_b64 exec, vcc
    v_mov_b32 v20, 0
    v_mov_b32 v60, 0
    s_mov_b64 exec, -1
    s_sub_i32 s54, s42, 2049
    v_cmp_le_i32 vcc, s54, v117
    s_mov_b64 exec, vcc
    v_mov_b32 v21, 0
    v_mov_b32 v62, 0
    s_mov_b64 exec, -1
    s_sub_i32 s54, s42, 2050
    v_cmp_le_i32 vcc, s54, v117
    s_mov_b64 exec, vcc
    v_mov_b32 v22, 0
    v_mov_b32 v64, 0
    s_mov_b64 exec, -1
    s_sub_i32 s54, s42, 2051
    v_cmp_le_i32 vcc, s54, v117
    s_mov_b64 exec, vcc
    v_mov_b32 v23, 0
    v_mov_b32 v66, 0
    s_mov_b64 exec, -1
    s_branch L_uback_74
L_ufix_75:
    v_and_b32 v117, 63, v0
    v_lshlrev_b32 v117, 2, v117
    s_sub_i32 s54, s42, 2560
    v_cmp_le_i32 vcc, s54, v117
    s_mov_b64 exec, vcc
    v_mov_b32 v24, 0
    v_mov_b32 v68, 0
    s_mov_b64 exec, -1
    s_sub_i32 s54, s42, 2561
    v_cmp_le_i32 vcc, s54, v117
    s_mov_b64 exec, vcc
    v_mov_b32 v25, 0
    v_mov_b32 v70, 0
    s_mov_b64 exec, -1
    s_sub_i32 s54, s42, 2562
    v_cmp_le_i32 vcc, s54, v117
    s_mov_b64 exec, vcc
    v_mov_b32 v26, 0
    v_mov_b32 v72, 0
    s_mov_b64 exec, -1
    s_sub_i32 s54, s42, 2563
    v_cmp_le_i32 vcc, s54, v117
    s_mov_b64 exec, vcc
    v_mov_b32 v27, 0
    v_mov_b32 v74, 0
    s_mov_b64 exec, -1
    s_branch L_uback_76
L_ufix_77:
    v_and_b32 v117, 63, v0
    v_lshlrev_b32 v117, 2, v117
    s_sub_i32 s54, s42, 0
    v_cmp_le_i32 vcc, s54, v117
    s_mov_b64 exec, vcc
    v_mov_b32 v4, 0
    v_mov_b32 v28, 0
    s_mov_b64 exec, -1
    s_sub_i32 s54, s42, 1
    v_cmp_le_i32 vcc, s54, v117
    s_mov_b64 exec, vcc
    v_mov_b32 v5, 0
    v_mov_b32 v30, 0
    s_mov_b64 exec, -1
    s_sub_i32 s54, s42, 2
    v_cmp_le_i32 vcc, s54, v117
    s_mov_b64 exec, vcc
    v_mov_b32 v6, 0
    v_mov_b32 v32, 0
    s_mov_b64 exec, -1
    s_sub_i32 s54, s42, 3
    v_cmp_le_i32 vcc, s54, v117
    s_mov_b64 exec, vcc
    v_mov_b32 v7, 0
    v_mov_b32 v34, 0
    s_mov_b64 exec, -1
    s_branch L_uback_78
L_ufix_79:
    v_and_b32 v117, 63, v0
    v_lshlrev_b32 v117, 2, v117
    s_sub_i32 s54, s42, 512
    v_cmp_le_i32 vcc, s54, v117
    s_mov_b64 exec, vcc
    v_mov_b32 v8, 0
    v_mov_b32 v36, 0
    s_mov_b64 exec, -1
    s_sub_i32 s54, s42, 513
    v_cmp_le_i32 vcc, s54, v117
    s_mov_b64 exec, vcc
    v_mov_b32 v9, 0
    v_mov_b32 v38, 0
    s_mov_b64 exec, -1
    s_sub_i32 s54, s42, 514
    v_cmp_le_i32 vcc, s54, v117
    s_mov_b64 exec, vcc
    v_mov_b32 v10, 0
    v_mov_b32 v40, 0
    s_mov_b64 exec, -1
    s_sub_i32 s54, s42, 515
    v_cmp_le_i32 vcc, s54, v117
    s_mov_b64 exec, vcc
    v_mov_b32 v11, 0
    v_mov_b32 v42, 0
    s_mov_b64 exec, -1
    s_branch L_uback_80
L_sync_94:
    v_mov_b32 v117, s33
    buffer_atomic_add v117, v116, s[44:47], s50 offen sc0
    s_waitcnt vmcnt(0)
    v_readfirstlane_b32 s4, v117
    s_movk_i32 s5, 400
    s_nop 0
    s_add_u32 s4, s4, s33
    s_bitcmp1_b32 s4, 2
    s_cbranch_scc1 L_tell_97
L_poll_95:
    s_sub_u32 s5, s5, 1
    s_cbranch_scc1 L_gave_96
    v_mov_b32 v117, 0
    buffer_atomic_add v117, v116, s[44:47], s50 offen sc0
    s_waitcnt vmcnt(0)
    v_readfirstlane_b32 s4, v117
    s_nop 1
    s_and_b32 s4, s4, 0xff
    s_bitcmp0_b32 s4, 2
    s_cbranch_scc1 L_poll_95
    s_branch L_tell_97
L_gave_96:
    s_lshl_b32 s4, 0x100, s37
    v_mov_b32 v117, s4
    buffer_atomic_or v117, v116, s[44:47], s50 offen sc0
    s_waitcnt vmcnt(0)
    v_readfirstlane_b32 s4, v117
    s_nop 1
    s_and_b32 s4, s4, 0xff
    s_bitcmp1_b32 s4, 2
    s_cselect_b32 s4, s4, 0x10000
L_tell_97:
    v_mov_b32 v117, s4
    v_mov_b32 v118, 150016
    ds_write_b32 v118, v117
    s_branch L_bcast_89

L_fgen_98:
    s_waitcnt vmcnt(0)
    v_lshlrev_b32 v6, 1, v4
    v_lshlrev_b32 v7, 1, v5
    v_mov_b32 v12, 0
    v_mov_b32 v13, 0
    v_mov_b32 v14, 0
    v_mov_b32 v15, 0
    v_mov_b32 v16, 0
    v_mov_b32 v17, 0
    v_mov_b32 v18, 0
    v_mov_b32 v19, 0
    v_mov_b32 v20, 0
    v_mov_b32 v21, 0
    v_mov_b32 v22, 0
    v_mov_b32 v23, 0
    v_mov_b32 v24, 0
    v_mov_b32 v25, 0
    v_mov_b32 v26, 0
    v_mov_b32 v27, 0
    s_bitcmp1_b32 s35, 4
    s_cbranch_scc1 L_ffl_100
    v_cvt_f32_u32_sdwa v28, v76 dst_sel:DWORD dst_unused:UNUSED_PAD src0_sel:WORD_0
    v_cvt_f32_u32_sdwa v29, v76 dst_sel:DWORD dst_unused:UNUSED_PAD src0_sel:WORD_1
    v_cvt_f32_u32_sdwa v30, v77 dst_sel:DWORD dst_unused:UNUSED_PAD src0_sel:WORD_0
    v_cvt_f32_u32_sdwa v31, v77 dst_sel:DWORD dst_unused:UNUSED_PAD src0_sel:WORD_1
    v_cvt_f32_u32_sdwa v32, v78 dst_sel:DWORD dst_unused:UNUSED_PAD src0_sel:WORD_0
    v_cvt_f32_u32_sdwa v33, v78 dst_sel:DWORD dst_unused:UNUSED_PAD src0_sel:WORD_1
    v_cvt_f32_u32_sdwa v34, v79 dst_sel:DWORD dst_unused:UNUSED_PAD src0_sel:WORD_0
    v_cvt_f32_u32_sdwa v35, v79 dst_sel:DWORD dst_unused:UNUSED_PAD src0_sel:WORD_1
    v_cvt_f32_u32_sdwa v36, v92 dst_sel:DWORD dst_unused:UNUSED_PAD src0_sel:WORD_0
    v_cvt_f32_u32_sdwa v37, v92 dst_sel:DWORD dst_unused:UNUSED_PAD src0_sel:WORD_1
    v_cvt_f32_u32_sdwa v38, v93 dst_sel:DWORD dst_unused:UNUSED_PAD src0_sel:WORD_0
    v_cvt_f32_u32_sdwa v39, v93 dst_sel:DWORD dst_unused:UNUSED_PAD src0_sel:WORD_1
    v_cvt_f32_u32_sdwa v40, v94 dst_sel:DWORD dst_unused:UNUSED_PAD src0_sel:WORD_0
    v_cvt_f32_u32_sdwa v41, v94 dst_sel:DWORD dst_unused:UNUSED_PAD src0_sel:WORD_1
    v_cvt_f32_u32_sdwa v42, v95 dst_sel:DWORD dst_unused:UNUSED_PAD src0_sel:WORD_0
    v_cvt_f32_u32_sdwa v43, v95 dst_sel:DWORD dst_unused:UNUSED_PAD src0_sel:WORD_1
    v_add_f32 v28, 0xc6800000, v28
    v_fmac_f32 v12, s34, v28
    v_add_f32 v29, 0xc6800000, v29
    v_fmac_f32 v13, s34, v29
    v_add_f32 v30, 0xc6800000, v30
    v_fmac_f32 v14, s34, v30
    v_add_f32 v31, 0xc6800000, v31
    v_fmac_f32 v15, s34, v31
    v_add_f32 v32, 0xc6800000, v32
    v_fmac_f32 v16, s34, v32
    v_add_f32 v33, 0xc6800000, v33
    v_fmac_f32 v17, s34, v33
    v_add_f32 v34, 0xc6800000, v34
    v_fmac_f32 v18, s34, v34
    v_add_f32 v35, 0xc6800000, v35
    v_fmac_f32 v19, s34, v35
    v_add_f32 v36, 0xc6800000, v36
    v_fmac_f32 v20, s34, v36
    v_add_f32 v37, 0xc6800000, v37
    v_fmac_f32 v21, s34, v37
    v_add_f32 v38, 0xc6800000, v38
    v_fmac_f32 v22, s34, v38
    v_add_f32 v39, 0xc6800000, v39
    v_fmac_f32 v23, s34, v39
    v_add_f32 v40, 0xc6800000, v40
    v_fmac_f32 v24, s34, v40
    v_add_f32 v41, 0xc6800000, v41
    v_fmac_f32 v25, s34, v41
    v_add_f32 v42, 0xc6800000, v42
    v_fmac_f32 v26, s34, v42
    v_add_f32 v43, 0xc6800000, v43
    v_fmac_f32 v27, s34, v43
    s_branch L_fnx_101
L_ffl_100:
    s_mov_b32 s3, 25600000
    buffer_load_dwordx4 v[28:31], v6, s[20:23], s3 offen offset:0 sc1
    buffer_load_dwordx4 v[32:35], v6, s[20:23], s3 offen offset:16 sc1
    buffer_load_dwordx4 v[36:39], v7, s[20:23], s3 offen offset:0 sc1
    buffer_load_dwordx4 v[40:43], v7, s[20:23], s3 offen offset:16 sc1
    s_waitcnt vmcnt(0)
    v_add_f32 v12, v12, v28
    v_add_f32 v13, v13, v29
    v_add_f32 v14, v14, v30
    v_add_f32 v15, v15, v31
    v_add_f32 v16, v16, v32
    v_add_f32 v17, v17, v33
    v_add_f32 v18, v18, v34
    v_add_f32 v19, v19, v35
    v_add_f32 v20, v20, v36
    v_add_f32 v21, v21, v37
    v_add_f32 v22, v22, v38
    v_add_f32 v23, v23, v39
    v_add_f32 v24, v24, v40
    v_add_f32 v25, v25, v41
    v_add_f32 v26, v26, v42
    v_add_f32 v27, v27, v43
L_fnx_101:
    s_bitcmp1_b32 s35, 5
    s_cbranch_scc1 L_ffl_102
    v_cvt_f32_u32_sdwa v28, v80 dst_sel:DWORD dst_unused:UNUSED_PAD src0_sel:WORD_0
    v_cvt_f32_u32_sdwa v29, v80 dst_sel:DWORD dst_unused:UNUSED_PAD src0_sel:WORD_1
    v_cvt_f32_u32_sdwa v30, v81 dst_sel:DWORD dst_unused:UNUSED_PAD src0_sel:WORD_0
    v_cvt_f32_u32_sdwa v31, v81 dst_sel:DWORD dst_unused:UNUSED_PAD src0_sel:WORD_1
    v_cvt_f32_u32_sdwa v32, v82 dst_sel:DWORD dst_unused:UNUSED_PAD src0_sel:WORD_0
    v_cvt_f32_u32_sdwa v33, v82 dst_sel:DWORD dst_unused:UNUSED_PAD src0_sel:WORD_1
    v_cvt_f32_u32_sdwa v34, v83 dst_sel:DWORD dst_unused:UNUSED_PAD src0_sel:WORD_0
    v_cvt_f32_u32_sdwa v35, v83 dst_sel:DWORD dst_unused:UNUSED_PAD src0_sel:WORD_1
    v_cvt_f32_u32_sdwa v36, v96 dst_sel:DWORD dst_unused:UNUSED_PAD src0_sel:WORD_0
    v_cvt_f32_u32_sdwa v37, v96 dst_sel:DWORD dst_unused:UNUSED_PAD src0_sel:WORD_1
    v_cvt_f32_u32_sdwa v38, v97 dst_sel:DWORD dst_unused:UNUSED_PAD src0_sel:WORD_0
    v_cvt_f32_u32_sdwa v39, v97 dst_sel:DWORD dst_unused:UNUSED_PAD src0_sel:WORD_1
    v_cvt_f32_u32_sdwa v40, v98 dst_sel:DWORD dst_unused:UNUSED_PAD src0_sel:WORD_0
    v_cvt_f32_u32_sdwa v41, v98 dst_sel:DWORD dst_unused:UNUSED_PAD src0_sel:WORD_1
    v_cvt_f32_u32_sdwa v42, v99 dst_sel:DWORD dst_unused:UNUSED_PAD src0_sel:WORD_0
    v_cvt_f32_u32_sdwa v43, v99 dst_sel:DWORD dst_unused:UNUSED_PAD src0_sel:WORD_1
    v_add_f32 v28, 0xc6800000, v28
    v_fmac_f32 v12, s34, v28
    v_add_f32 v29, 0xc6800000, v29
    v_fmac_f32 v13, s34, v29
    v_add_f32 v30, 0xc6800000, v30
    v_fmac_f32 v14, s34, v30
    v_add_f32 v31, 0xc6800000, v31
    v_fmac_f32 v15, s34, v31
    v_add_f32 v32, 0xc6800000, v32
    v_fmac_f32 v16, s34, v32
    v_add_f32 v33, 0xc6800000, v33
    v_fmac_f32 v17, s34, v33
    v_add_f32 v34, 0xc6800000, v34
    v_fmac_f32 v18, s34, v34
    v_add_f32 v35, 0xc6800000, v35
    v_fmac_f32 v19, s34, v35
    v_add_f32 v36, 0xc6800000, v36
    v_fmac_f32 v20, s34, v36
    v_add_f32 v37, 0xc6800000, v37
    v_fmac_f32 v21, s34, v37
    v_add_f32 v38, 0xc6800000, v38
    v_fmac_f32 v22, s34, v38
    v_add_f32 v39, 0xc6800000, v39
    v_fmac_f32 v23, s34, v39
    v_add_f32 v40, 0xc6800000, v40
    v_fmac_f32 v24, s34, v40
    v_add_f32 v41, 0xc6800000, v41
    v_fmac_f32 v25, s34, v41
    v_add_f32 v42, 0xc6800000, v42
    v_fmac_f32 v26, s34, v42
    v_add_f32 v43, 0xc6800000, v43
    v_fmac_f32 v27, s34, v43
    s_branch L_fnx_103
L_ffl_102:
    s_mov_b32 s3, 38400000
    buffer_load_dwordx4 v[28:31], v6, s[20:23], s3 offen offset:0 sc1
    buffer_load_dwordx4 v[32:35], v6, s[20:23], s3 offen offset:16 sc1
    buffer_load_dwordx4 v[36:39], v7, s[20:23], s3 offen offset:0 sc1
    buffer_load_dwordx4 v[40:43], v7, s[20:23], s3 offen offset:16 sc1
    s_waitcnt vmcnt(0)
    v_add_f32 v12, v12, v28
    v_add_f32 v13, v13, v29
    v_add_f32 v14, v14, v30
    v_add_f32 v15, v15, v31
    v_add_f32 v16, v16, v32
    v_add_f32 v17, v17, v33
    v_add_f32 v18, v18, v34
    v_add_f32 v19, v19, v35
    v_add_f32 v20, v20, v36
    v_add_f32 v21, v21, v37
    v_add_f32 v22, v22, v38
    v_add_f32 v23, v23, v39
    v_add_f32 v24, v24, v40
    v_add_f32 v25, v25, v41
    v_add_f32 v26, v26, v42
    v_add_f32 v27, v27, v43
L_fnx_103:
    s_bitcmp1_b32 s35, 6
    s_cbranch_scc1 L_ffl_104
    v_cvt_f32_u32_sdwa v28, v84 dst_sel:DWORD dst_unused:UNUSED_PAD src0_sel:WORD_0
    v_cvt_f32_u32_sdwa v29, v84 dst_sel:DWORD dst_unused:UNUSED_PAD src0_sel:WORD_1
    v_cvt_f32_u32_sdwa v30, v85 dst_sel:DWORD dst_unused:UNUSED_PAD src0_sel:WORD_0
    v_cvt_f32_u32_sdwa v31, v85 dst_sel:DWORD dst_unused:UNUSED_PAD src0_sel:WORD_1
    v_cvt_f32_u32_sdwa v32, v86 dst_sel:DWORD dst_unused:UNUSED_PAD src0_sel:WORD_0
    v_cvt_f32_u32_sdwa v33, v86 dst_sel:DWORD dst_unused:UNUSED_PAD src0_sel:WORD_1
    v_cvt_f32_u32_sdwa v34, v87 dst_sel:DWORD dst_unused:UNUSED_PAD src0_sel:WORD_0
    v_cvt_f32_u32_sdwa v35, v87 dst_sel:DWORD dst_unused:UNUSED_PAD src0_sel:WORD_1
    v_cvt_f32_u32_sdwa v36, v100 dst_sel:DWORD dst_unused:UNUSED_PAD src0_sel:WORD_0
    v_cvt_f32_u32_sdwa v37, v100 dst_sel:DWORD dst_unused:UNUSED_PAD src0_sel:WORD_1
    v_cvt_f32_u32_sdwa v38, v101 dst_sel:DWORD dst_unused:UNUSED_PAD src0_sel:WORD_0
    v_cvt_f32_u32_sdwa v39, v101 dst_sel:DWORD dst_unused:UNUSED_PAD src0_sel:WORD_1
    v_cvt_f32_u32_sdwa v40, v102 dst_sel:DWORD dst_unused:UNUSED_PAD src0_sel:WORD_0
    v_cvt_f32_u32_sdwa v41, v102 dst_sel:DWORD dst_unused:UNUSED_PAD src0_sel:WORD_1
    v_cvt_f32_u32_sdwa v42, v103 dst_sel:DWORD dst_unused:UNUSED_PAD src0_sel:WORD_0
    v_cvt_f32_u32_sdwa v43, v103 dst_sel:DWORD dst_unused:UNUSED_PAD src0_sel:WORD_1
    v_add_f32 v28, 0xc6800000, v28
    v_fmac_f32 v12, s34, v28
    v_add_f32 v29, 0xc6800000, v29
    v_fmac_f32 v13, s34, v29
    v_add_f32 v30, 0xc6800000, v30
    v_fmac_f32 v14, s34, v30
    v_add_f32 v31, 0xc6800000, v31
    v_fmac_f32 v15, s34, v31
    v_add_f32 v32, 0xc6800000, v32
    v_fmac_f32 v16, s34, v32
    v_add_f32 v33, 0xc6800000, v33
    v_fmac_f32 v17, s34, v33
    v_add_f32 v34, 0xc6800000, v34
    v_fmac_f32 v18, s34, v34
    v_add_f32 v35, 0xc6800000, v35
    v_fmac_f32 v19, s34, v35
    v_add_f32 v36, 0xc6800000, v36
    v_fmac_f32 v20, s34, v36
    v_add_f32 v37, 0xc6800000, v37
    v_fmac_f32 v21, s34, v37
    v_add_f32 v38, 0xc6800000, v38
    v_fmac_f32 v22, s34, v38
    v_add_f32 v39, 0xc6800000, v39
    v_fmac_f32 v23, s34, v39
    v_add_f32 v40, 0xc6800000, v40
    v_fmac_f32 v24, s34, v40
    v_add_f32 v41, 0xc6800000, v41
    v_fmac_f32 v25, s34, v41
    v_add_f32 v42, 0xc6800000, v42
    v_fmac_f32 v26, s34, v42
    v_add_f32 v43, 0xc6800000, v43
    v_fmac_f32 v27, s34, v43
    s_branch L_fnx_105
L_ffl_104:
    s_mov_b32 s3, 51200000
    buffer_load_dwordx4 v[28:31], v6, s[20:23], s3 offen offset:0 sc1
    buffer_load_dwordx4 v[32:35], v6, s[20:23], s3 offen offset:16 sc1
    buffer_load_dwordx4 v[36:39], v7, s[20:23], s3 offen offset:0 sc1
    buffer_load_dwordx4 v[40:43], v7, s[20:23], s3 offen offset:16 sc1
    s_waitcnt vmcnt(0)
    v_add_f32 v12, v12, v28
    v_add_f32 v13, v13, v29
    v_add_f32 v14, v14, v30
    v_add_f32 v15, v15, v31
    v_add_f32 v16, v16, v32
    v_add_f32 v17, v17, v33
    v_add_f32 v18, v18, v34
    v_add_f32 v19, v19, v35
    v_add_f32 v20, v20, v36
    v_add_f32 v21, v21, v37
    v_add_f32 v22, v22, v38
    v_add_f32 v23, v23, v39
    v_add_f32 v24, v24, v40
    v_add_f32 v25, v25, v41
    v_add_f32 v26, v26, v42
    v_add_f32 v27, v27, v43
L_fnx_105:
    s_bitcmp1_b32 s35, 7
    s_cbranch_scc1 L_ffl_106
    v_cvt_f32_u32_sdwa v28, v88 dst_sel:DWORD dst_unused:UNUSED_PAD src0_sel:WORD_0
    v_cvt_f32_u32_sdwa v29, v88 dst_sel:DWORD dst_unused:UNUSED_PAD src0_sel:WORD_1
    v_cvt_f32_u32_sdwa v30, v89 dst_sel:DWORD dst_unused:UNUSED_PAD src0_sel:WORD_0
    v_cvt_f32_u32_sdwa v31, v89 dst_sel:DWORD dst_unused:UNUSED_PAD src0_sel:WORD_1
    v_cvt_f32_u32_sdwa v32, v90 dst_sel:DWORD dst_unused:UNUSED_PAD src0_sel:WORD_0
    v_cvt_f32_u32_sdwa v33, v90 dst_sel:DWORD dst_unused:UNUSED_PAD src0_sel:WORD_1
    v_cvt_f32_u32_sdwa v34, v91 dst_sel:DWORD dst_unused:UNUSED_PAD src0_sel:WORD_0
    v_cvt_f32_u32_sdwa v35, v91 dst_sel:DWORD dst_unused:UNUSED_PAD src0_sel:WORD_1
    v_cvt_f32_u32_sdwa v36, v104 dst_sel:DWORD dst_unused:UNUSED_PAD src0_sel:WORD_0
    v_cvt_f32_u32_sdwa v37, v104 dst_sel:DWORD dst_unused:UNUSED_PAD src0_sel:WORD_1
    v_cvt_f32_u32_sdwa v38, v105 dst_sel:DWORD dst_unused:UNUSED_PAD src0_sel:WORD_0
    v_cvt_f32_u32_sdwa v39, v105 dst_sel:DWORD dst_unused:UNUSED_PAD src0_sel:WORD_1
    v_cvt_f32_u32_sdwa v40, v106 dst_sel:DWORD dst_unused:UNUSED_PAD src0_sel:WORD_0
    v_cvt_f32_u32_sdwa v41, v106 dst_sel:DWORD dst_unused:UNUSED_PAD src0_sel:WORD_1
    v_cvt_f32_u32_sdwa v42, v107 dst_sel:DWORD dst_unused:UNUSED_PAD src0_sel:WORD_0
    v_cvt_f32_u32_sdwa v43, v107 dst_sel:DWORD dst_unused:UNUSED_PAD src0_sel:WORD_1
    v_add_f32 v28, 0xc6800000, v28
    v_fmac_f32 v12, s34, v28
    v_add_f32 v29, 0xc6800000, v29
    v_fmac_f32 v13, s34, v29
    v_add_f32 v30, 0xc6800000, v30
    v_fmac_f32 v14, s34, v30
    v_add_f32 v31, 0xc6800000, v31
    v_fmac_f32 v15, s34, v31
    v_add_f32 v32, 0xc6800000, v32
    v_fmac_f32 v16, s34, v32
    v_add_f32 v33, 0xc6800000, v33
    v_fmac_f32 v17, s34, v33
    v_add_f32 v34, 0xc6800000, v34
    v_fmac_f32 v18, s34, v34
    v_add_f32 v35, 0xc6800000, v35
    v_fmac_f32 v19, s34, v35
    v_add_f32 v36, 0xc6800000, v36
    v_fmac_f32 v20, s34, v36
    v_add_f32 v37, 0xc6800000, v37
    v_fmac_f32 v21, s34, v37
    v_add_f32 v38, 0xc6800000, v38
    v_fmac_f32 v22, s34, v38
    v_add_f32 v39, 0xc6800000, v39
    v_fmac_f32 v23, s34, v39
    v_add_f32 v40, 0xc6800000, v40
    v_fmac_f32 v24, s34, v40
    v_add_f32 v41, 0xc6800000, v41
    v_fmac_f32 v25, s34, v41
    v_add_f32 v42, 0xc6800000, v42
    v_fmac_f32 v26, s34, v42
    v_add_f32 v43, 0xc6800000, v43
    v_fmac_f32 v27, s34, v43
    s_branch L_fnx_107
L_ffl_106:
    s_mov_b32 s3, 64000000
    buffer_load_dwordx4 v[28:31], v6, s[20:23], s3 offen offset:0 sc1
    buffer_load_dwordx4 v[32:35], v6, s[20:23], s3 offen offset:16 sc1
    buffer_load_dwordx4 v[36:39], v7, s[20:23], s3 offen offset:0 sc1
    buffer_load_dwordx4 v[40:43], v7, s[20:23], s3 offen offset:16 sc1
    s_waitcnt vmcnt(0)
    v_add_f32 v12, v12, v28
    v_add_f32 v13, v13, v29
    v_add_f32 v14, v14, v30
    v_add_f32 v15, v15, v31
    v_add_f32 v16, v16, v32
    v_add_f32 v17, v17, v33
    v_add_f32 v18, v18, v34
    v_add_f32 v19, v19, v35
    v_add_f32 v20, v20, v36
    v_add_f32 v21, v21, v37
    v_add_f32 v22, v22, v38
    v_add_f32 v23, v23, v39
    v_add_f32 v24, v24, v40
    v_add_f32 v25, v25, v41
    v_add_f32 v26, v26, v42
    v_add_f32 v27, v27, v43
L_fnx_107:
    s_branch L_fbk_99
L_p2slow_47:
    s_waitcnt vmcnt(0) lgkmcnt(0)
    s_mov_b32 s51, 0
    s_movk_i32 s43, 6250

L_sweep_109:
    s_barrier

    v_mov_b32 v28, 0x0
    v_mov_b32 v29, 0x0
    v_mov_b32 v30, 0x0
    v_mov_b32 v31, 0x0
    v_add_u32 v32, 50000, v3
    v_add_u32 v33, 65536, v32

    ds_write_b128 v32, v[28:31] offset:0
    ds_write_b128 v32, v[28:31] offset:16384
    ds_write_b128 v32, v[28:31] offset:32768
    ds_write_b128 v32, v[28:31] offset:49152
    ds_write_b128 v33, v[28:31] offset:0
    ds_write_b128 v33, v[28:31] offset:16384
    v_cmp_gt_u32 vcc, 971, v0
    s_mov_b64 exec, vcc
    ds_write_b128 v33, v[28:31] offset:32768
    s_mov_b64 exec, -1
    s_mov_b32 s3, 32768
    s_load_dword s40, s[6:7], s3
    s_waitcnt lgkmcnt(0)
    s_barrier
    s_cmp_lg_u32 s40, 0
    s_cbranch_scc1 L_raw_114
    s_sub_u32 s38, s4, 8
L_sbatch_110:
    s_lshl_b32 s52, s38, 6
    s_add_u32 s52, s52, s36
    s_lshr_b32 s52, s52, 1
    s_lshl_b32 s52, s52, 2
    s_load_dword s40, s[46:47], s52
    s_mul_i32 s50, s38, 200000
    s_and_b32 s3, s36, 1
    s_lshl_b32 s3, s3, 4
    s_or_b32 s3, s3, 0x100000
    s_waitcnt lgkmcnt(0)
    s_bfe_u32 s40, s40, s3

    s_min_u32 s40, s40, 6552
    s_lshl_b32 s52, s38, 6
    s_add_u32 s52, s52, s36
    s_mul_i32 s52, s52, 32764
    s_add_u32 s20, s44, s52
    s_addc_u32 s21, s45, 0
    s_mul_i32 s52, s40, 5
    s_add_u32 s52, s52, 3
    s_and_b32 s22, s52, -4

    s_lshr_b32 s55, s39, 2
    s_add_u32 s55, s55, 0
    v_and_b32 v36, 63, v0
    v_add_u32 v36, s55, v36
L_left_115:
    s_cmp_ge_u32 s55, s40
    s_cbranch_scc1 L_leftend_116
    v_mul_u32_u24 v37, 5, v36
    buffer_load_dword v38, v37, s[20:23], 0 offen
    buffer_load_ubyte v39, v37, s[20:23], 0 offen offset:4
    s_waitcnt vmcnt(0)

    v_perm_b32 v37, v39, v38, s24
    v_lshrrev_b32 v42, 30, v38
    v_and_b32 v37, 0x1fff, v37
    v_mul_u32_u24 v42, 6250, v42
    v_add_lshl_u32 v37, v37, v42, 3

    buffer_load_dwordx2 v[40:41], v37, s[8:11], s50 offen
    v_cmp_gt_u32 vcc, s40, v36
    s_waitcnt vmcnt(0)

    v_bfe_u32 v44, v38, 16, 14
    v_subrev_u32 v44, s51, v44
    v_cmp_gt_u32 s[64:65], s43, v44
    s_and_b64 exec, vcc, s[64:65]
    v_lshlrev_b32 v45, 8, v38
    v_cmpx_ne_u32 vcc, 0, v45
    v_lshlrev_b32 v44, 4, v44
    v_bfe_i32 v38, v38, 0, 16
    v_cvt_f32_i32 v38, v38
    v_mul_f32 v38, 0x38004020, v38
    v_lshlrev_b32 v45, 16, v40
    v_and_b32 v46, s32, v40
    v_lshlrev_b32 v47, 16, v41
    v_and_b32 v48, s32, v41

    v_mul_f32 v45, v45, v38
    ds_add_f32 v44, v45 offset:50000
    v_mul_f32 v46, v46, v38
    ds_add_f32 v44, v46 offset:50004
    v_mul_f32 v47, v47, v38
    ds_add_f32 v44, v47 offset:50008
    v_mul_f32 v48, v48, v38
    ds_add_f32 v44, v48 offset:50012
    s_mov_b64 exec, -1
    v_add_u32 v36, 128, v36
    s_add_u32 s55, s55, 128
    s_branch L_left_115
L_leftend_116:

    s_add_u32 s38, s38, 1
    s_cmp_lt_u32 s38, s4
    s_cbranch_scc1 L_sbatch_110
    s_branch L_swend_112

L_raw_114:
    s_load_dwordx2 s[68:69], s[0:1], 8
    s_load_dwordx2 s[72:73], s[0:1], 16
    s_load_dwordx2 s[76:77], s[0:1], 32
    s_load_dwordx2 s[80:81], s[0:1], 48
    s_mov_b32 s70, 204800000
    s_mov_b32 s71, 0x20000
    s_mov_b32 s74, 204800000
    s_mov_b32 s75, 0x20000
    s_mov_b32 s78, 102400000
    s_mov_b32 s79, 0x20000
    s_waitcnt lgkmcnt(0)
    s_load_dword s82, s[80:81], 0
    s_mul_i32 s83, s36, 12500
    s_add_u32 s83, s83, s51
    s_mul_i32 s84, s37, 200000
    s_mov_b32 s85, 200000
    s_mov_b32 s38, 0
    v_lshlrev_b32 v44, 5, v0
    v_mov_b32 v45, 0.15915494
    s_waitcnt lgkmcnt(0)
    s_lshl_b32 s82, s82, 16
    v_mul_f32 v45, s82, v45
L_rawl_111:
    s_lshr_b32 s3, s38, 1
    buffer_load_dwordx4 v[46:49], v44, s[72:75], s38 offen
    buffer_load_dwordx4 v[50:53], v44, s[72:75], s38 offen offset:16
    buffer_load_dwordx4 v[54:57], v44, s[68:71], s38 offen
    buffer_load_dwordx4 v[58:61], v44, s[68:71], s38 offen offset:16
    buffer_load_dwordx4 v[62:65], v3, s[76:79], s3 offen
    s_waitcnt vmcnt(1)

    v_subrev_u32 v46, s83, v46
    v_subrev_u32 v82, s84, v54
    v_cmp_gt_u32 vcc, s43, v46
    v_cmp_gt_u32 s[64:65], s85, v82
    v_lshlrev_b32 v54, 3, v54
    s_nand_b64 exec, vcc, s[64:65]
    v_bfrev_b32 v54, 1
    s_mov_b64 exec, -1
    buffer_load_dwordx2 v[66:67], v54, s[8:11], 0 offen

    v_subrev_u32 v47, s83, v47
    v_subrev_u32 v82, s84, v55
    v_cmp_gt_u32 vcc, s43, v47
    v_cmp_gt_u32 s[64:65], s85, v82
    v_lshlrev_b32 v55, 3, v55
    s_nand_b64 exec, vcc, s[64:65]
    v_bfrev_b32 v55, 1
    s_mov_b64 exec, -1
    buffer_load_dwordx2 v[68:69], v55, s[8:11], 0 offen

    v_subrev_u32 v48, s83, v48
    v_subrev_u32 v82, s84, v56
    v_cmp_gt_u32 vcc, s43, v48
    v_cmp_gt_u32 s[64:65], s85, v82
    v_lshlrev_b32 v56, 3, v56
    s_nand_b64 exec, vcc, s[64:65]
    v_bfrev_b32 v56, 1
    s_mov_b64 exec, -1
    buffer_load_dwordx2 v[70:71], v56, s[8:11], 0 offen

    v_subrev_u32 v49, s83, v49
    v_subrev_u32 v82, s84, v57
    v_cmp_gt_u32 vcc, s43, v49
    v_cmp_gt_u32 s[64:65], s85, v82
    v_lshlrev_b32 v57, 3, v57
    s_nand_b64 exec, vcc, s[64:65]
    v_bfrev_b32 v57, 1
    s_mov_b64 exec, -1
    buffer_load_dwordx2 v[72:73], v57, s[8:11], 0 offen

    v_subrev_u32 v50, s83, v50
    v_subrev_u32 v82, s84, v58
    v_cmp_gt_u32 vcc, s43, v50
    v_cmp_gt_u32 s[64:65], s85, v82
    v_lshlrev_b32 v58, 3, v58
    s_nand_b64 exec, vcc, s[64:65]
    v_bfrev_b32 v58, 1
    s_mov_b64 exec, -1
    buffer_load_dwordx2 v[74:75], v58, s[8:11], 0 offen

    v_subrev_u32 v51, s83, v51
    v_subrev_u32 v82, s84, v59
    v_cmp_gt_u32 vcc, s43, v51
    v_cmp_gt_u32 s[64:65], s85, v82
    v_lshlrev_b32 v59, 3, v59
    s_nand_b64 exec, vcc, s[64:65]
    v_bfrev_b32 v59, 1
    s_mov_b64 exec, -1
    buffer_load_dwordx2 v[76:77], v59, s[8:11], 0 offen

    v_subrev_u32 v52, s83, v52
    v_subrev_u32 v82, s84, v60
    v_cmp_gt_u32 vcc, s43, v52
    v_cmp_gt_u32 s[64:65], s85, v82
    v_lshlrev_b32 v60, 3, v60
    s_nand_b64 exec, vcc, s[64:65]
    v_bfrev_b32 v60, 1
    s_mov_b64 exec, -1
    buffer_load_dwordx2 v[78:79], v60, s[8:11], 0 offen

    v_subrev_u32 v53, s83, v53
    v_subrev_u32 v82, s84, v61
    v_cmp_gt_u32 vcc, s43, v53
    v_cmp_gt_u32 s[64:65], s85, v82
    v_lshlrev_b32 v61, 3, v61
    s_nand_b64 exec, vcc, s[64:65]
    v_bfrev_b32 v61, 1
    s_mov_b64 exec, -1
    buffer_load_dwordx2 v[80:81], v61, s[8:11], 0 offen

    s_waitcnt vmcnt(0)
    v_cmp_le_i32 vcc, 0, v54
    s_mov_b64 exec, vcc
    s_cbranch_execz L_rsk_117
    v_lshlrev_b32 v82, 16, v62
    v_mul_f32 v82, v82, v45
    v_fract_f32 v82, v82
    v_cos_f32 v82, v82
    v_lshlrev_b32 v46, 4, v46
    v_lshlrev_b32 v83, 16, v66
    v_and_b32 v84, s32, v66
    v_lshlrev_b32 v85, 16, v67
    v_and_b32 v86, s32, v67

    v_mul_f32 v83, v83, v82
    ds_add_f32 v46, v83 offset:50000
    v_mul_f32 v84, v84, v82
    ds_add_f32 v46, v84 offset:50004
    v_mul_f32 v85, v85, v82
    ds_add_f32 v46, v85 offset:50008
    v_mul_f32 v86, v86, v82
    ds_add_f32 v46, v86 offset:50012
L_rsk_117:
    s_mov_b64 exec, -1
    v_cmp_le_i32 vcc, 0, v55
    s_mov_b64 exec, vcc
    s_cbranch_execz L_rsk_118
    v_and_b32 v82, s32, v62
    v_mul_f32 v82, v82, v45
    v_fract_f32 v82, v82
    v_cos_f32 v82, v82
    v_lshlrev_b32 v47, 4, v47
    v_lshlrev_b32 v83, 16, v68
    v_and_b32 v84, s32, v68
    v_lshlrev_b32 v85, 16, v69
    v_and_b32 v86, s32, v69

    v_mul_f32 v83, v83, v82
    ds_add_f32 v47, v83 offset:50000
    v_mul_f32 v84, v84, v82
    ds_add_f32 v47, v84 offset:50004
    v_mul_f32 v85, v85, v82
    ds_add_f32 v47, v85 offset:50008
    v_mul_f32 v86, v86, v82
    ds_add_f32 v47, v86 offset:50012
L_rsk_118:
    s_mov_b64 exec, -1
    v_cmp_le_i32 vcc, 0, v56
    s_mov_b64 exec, vcc
    s_cbranch_execz L_rsk_119
    v_lshlrev_b32 v82, 16, v63
    v_mul_f32 v82, v82, v45
    v_fract_f32 v82, v82
    v_cos_f32 v82, v82
    v_lshlrev_b32 v48, 4, v48
    v_lshlrev_b32 v83, 16, v70
    v_and_b32 v84, s32, v70
    v_lshlrev_b32 v85, 16, v71
    v_and_b32 v86, s32, v71

    v_mul_f32 v83, v83, v82
    ds_add_f32 v48, v83 offset:50000
    v_mul_f32 v84, v84, v82
    ds_add_f32 v48, v84 offset:50004
    v_mul_f32 v85, v85, v82
    ds_add_f32 v48, v85 offset:50008
    v_mul_f32 v86, v86, v82
    ds_add_f32 v48, v86 offset:50012
L_rsk_119:
    s_mov_b64 exec, -1
    v_cmp_le_i32 vcc, 0, v57
    s_mov_b64 exec, vcc
    s_cbranch_execz L_rsk_120
    v_and_b32 v82, s32, v63
    v_mul_f32 v82, v82, v45
    v_fract_f32 v82, v82
    v_cos_f32 v82, v82
    v_lshlrev_b32 v49, 4, v49
    v_lshlrev_b32 v83, 16, v72
    v_and_b32 v84, s32, v72
    v_lshlrev_b32 v85, 16, v73
    v_and_b32 v86, s32, v73

    v_mul_f32 v83, v83, v82
    ds_add_f32 v49, v83 offset:50000
    v_mul_f32 v84, v84, v82
    ds_add_f32 v49, v84 offset:50004
    v_mul_f32 v85, v85, v82
    ds_add_f32 v49, v85 offset:50008
    v_mul_f32 v86, v86, v82
    ds_add_f32 v49, v86 offset:50012
L_rsk_120:
    s_mov_b64 exec, -1
    v_cmp_le_i32 vcc, 0, v58
    s_mov_b64 exec, vcc
    s_cbranch_execz L_rsk_121
    v_lshlrev_b32 v82, 16, v64
    v_mul_f32 v82, v82, v45
    v_fract_f32 v82, v82
    v_cos_f32 v82, v82
    v_lshlrev_b32 v50, 4, v50
    v_lshlrev_b32 v83, 16, v74
    v_and_b32 v84, s32, v74
    v_lshlrev_b32 v85, 16, v75
    v_and_b32 v86, s32, v75

    v_mul_f32 v83, v83, v82
    ds_add_f32 v50, v83 offset:50000
    v_mul_f32 v84, v84, v82
    ds_add_f32 v50, v84 offset:50004
    v_mul_f32 v85, v85, v82
    ds_add_f32 v50, v85 offset:50008
    v_mul_f32 v86, v86, v82
    ds_add_f32 v50, v86 offset:50012
L_rsk_121:
    s_mov_b64 exec, -1
    v_cmp_le_i32 vcc, 0, v59
    s_mov_b64 exec, vcc
    s_cbranch_execz L_rsk_122
    v_and_b32 v82, s32, v64
    v_mul_f32 v82, v82, v45
    v_fract_f32 v82, v82
    v_cos_f32 v82, v82
    v_lshlrev_b32 v51, 4, v51
    v_lshlrev_b32 v83, 16, v76
    v_and_b32 v84, s32, v76
    v_lshlrev_b32 v85, 16, v77
    v_and_b32 v86, s32, v77

    v_mul_f32 v83, v83, v82
    ds_add_f32 v51, v83 offset:50000
    v_mul_f32 v84, v84, v82
    ds_add_f32 v51, v84 offset:50004
    v_mul_f32 v85, v85, v82
    ds_add_f32 v51, v85 offset:50008
    v_mul_f32 v86, v86, v82
    ds_add_f32 v51, v86 offset:50012
L_rsk_122:
    s_mov_b64 exec, -1
    v_cmp_le_i32 vcc, 0, v60
    s_mov_b64 exec, vcc
    s_cbranch_execz L_rsk_123
    v_lshlrev_b32 v82, 16, v65
    v_mul_f32 v82, v82, v45
    v_fract_f32 v82, v82
    v_cos_f32 v82, v82
    v_lshlrev_b32 v52, 4, v52
    v_lshlrev_b32 v83, 16, v78
    v_and_b32 v84, s32, v78
    v_lshlrev_b32 v85, 16, v79
    v_and_b32 v86, s32, v79

    v_mul_f32 v83, v83, v82
    ds_add_f32 v52, v83 offset:50000
    v_mul_f32 v84, v84, v82
    ds_add_f32 v52, v84 offset:50004
    v_mul_f32 v85, v85, v82
    ds_add_f32 v52, v85 offset:50008
    v_mul_f32 v86, v86, v82
    ds_add_f32 v52, v86 offset:50012
L_rsk_123:
    s_mov_b64 exec, -1
    v_cmp_le_i32 vcc, 0, v61
    s_mov_b64 exec, vcc
    s_cbranch_execz L_rsk_124
    v_and_b32 v82, s32, v65
    v_mul_f32 v82, v82, v45
    v_fract_f32 v82, v82
    v_cos_f32 v82, v82
    v_lshlrev_b32 v53, 4, v53
    v_lshlrev_b32 v83, 16, v80
    v_and_b32 v84, s32, v80
    v_lshlrev_b32 v85, 16, v81
    v_and_b32 v86, s32, v81

    v_mul_f32 v83, v83, v82
    ds_add_f32 v53, v83 offset:50000
    v_mul_f32 v84, v84, v82
    ds_add_f32 v53, v84 offset:50004
    v_mul_f32 v85, v85, v82
    ds_add_f32 v53, v85 offset:50008
    v_mul_f32 v86, v86, v82
    ds_add_f32 v53, v86 offset:50012
L_rsk_124:
    s_mov_b64 exec, -1
    s_add_u32 s38, s38, 32768
    s_cmp_lt_u32 s38, 204800000
    s_cbranch_scc1 L_rawl_111
L_swend_112:
    s_waitcnt lgkmcnt(0)
    s_barrier
    s_mul_i32 s3, s37, 800000
    s_mul_i32 s5, s36, 12500
    s_add_u32 s3, s3, s5
    s_add_u32 s3, s3, s51
    s_lshl_b32 s3, s3, 4
    s_add_u32 s3, s3, 32399360

    s_add_u32 s20, s6, s3
    s_addc_u32 s21, s7, 0
    s_mov_b32 s22, 100000
    s_mov_b32 s23, 0x20000
    v_mov_b32 v36, v3
    s_mov_b32 s38, 0
L_wl_113:
    v_min_u32 v37, 100000, v36
    ds_read_b128 v[28:31], v37 offset:50000
    s_waitcnt lgkmcnt(0)
    buffer_store_dwordx4 v[28:31], v36, s[20:23], 0 offen sc1
    s_waitcnt vmcnt(0)
    v_add_u32 v36, 16384, v36
    s_add_u32 s38, s38, 1024
    s_cmp_lt_u32 s38, 6250
    s_cbranch_scc1 L_wl_113
    s_add_u32 s51, s51, 6250
    s_cmp_lt_u32 s51, 12500
    s_cbranch_scc1 L_sweep_109
    s_lshl_b32 s33, 16, s37
    s_add_u32 s33, s33, 1
    s_branch L_fin_82

.section .rodata,"a"
.p2align 6
.amdhsa_kernel g1_kernel
  .amdhsa_next_free_vgpr 128
  .amdhsa_next_free_sgpr 102
  .amdhsa_accum_offset 128
  .amdhsa_group_segment_fixed_size 0
  .amdhsa_kernarg_size 112
  .amdhsa_user_sgpr_count 2
  .amdhsa_user_sgpr_kernarg_segment_ptr 1
  .amdhsa_system_sgpr_workgroup_id_x 1
.end_amdhsa_kernel
.p2align 6
.amdhsa_kernel standalone__molecular_angular_gemnet__graph_kernel
  .amdhsa_next_free_vgpr 128
  .amdhsa_next_free_sgpr 102
  .amdhsa_accum_offset 128
  .amdhsa_group_segment_fixed_size 0
  .amdhsa_kernarg_size 112
  .amdhsa_user_sgpr_count 2
  .amdhsa_user_sgpr_kernarg_segment_ptr 1
  .amdhsa_system_sgpr_workgroup_id_x 1
  .amdhsa_float_denorm_mode_32 3
.end_amdhsa_kernel
```

```asm
; @launch kernel=g1_kernel grid=(256,1,1) block=(1024,1,1) lds=163840
; @launch kernel=standalone__molecular_angular_gemnet__graph_kernel grid=(256,1,1) block=(1024,1,1) lds=163840
.amdgcn_target "amdgcn-amd-amdhsa--gfx950"
.text
.globl g1_kernel
.p2align 8
.type g1_kernel,@function
g1_kernel:
    s_cmp_ge_u32 s2, 256
    s_cbranch_scc1 L_p1done_1
    s_load_dwordx4 s[80:83], s[0:1], 8
    s_load_dwordx2 s[84:85], s[0:1], 32
    s_load_dwordx2 s[86:87], s[0:1], 48
    s_load_dwordx4 s[4:7], s[0:1], 96
    s_load_dwordx2 s[78:79], s[0:1], 0
    v_lshlrev_b32 v1, 4, v0
    v_lshlrev_b32 v2, 3, v0
    v_lshlrev_b32 v98, 20, v0
    s_waitcnt lgkmcnt(0)
    s_load_dword s88, s[86:87], 0

    s_mov_b32 s96, s4
    s_mov_b32 s97, s5
    s_mov_b32 s98, 256
    s_mov_b32 s99, 0x20000
    v_readfirstlane_b32 s74, v0
    s_nop 1
    s_or_b32 s74, s74, s2
    s_cbranch_scc1 L_noinit_2

    v_mov_b32 v110, 1
    buffer_atomic_add v110, v98, s[96:99], 0 offen offset:64 sc0
    s_waitcnt vmcnt(0)
    v_readfirstlane_b32 s74, v110
    s_nop 1
    s_cmp_lg_u32 s74, 0
    s_cbranch_scc1 L_zno_4

    s_mov_b32 s92, s6
    s_mov_b32 s93, s7
    s_mov_b32 s94, 32784
    s_mov_b32 s95, 0x20000
    v_mov_b32 v110, 0
    v_mov_b32 v111, 0
    v_mov_b32 v112, 0
    v_mov_b32 v113, 0
L_zl_3:
    buffer_store_dwordx4 v[110:113], v1, s[92:95], s74 offen sc0 sc1
    s_add_u32 s74, s74, 1024
    s_cmp_le_u32 s74, 32768
    s_cbranch_scc1 L_zl_3
    v_mov_b32 v114, 1
    s_waitcnt vmcnt(0)
    buffer_atomic_add v114, v98, s[96:99], 0 offen offset:128
L_zno_4:

L_noinit_2:
    s_mov_b32 s20, s78
    s_mov_b32 s21, s79
    s_mov_b32 s22, 6400000
    s_mov_b32 s23, 0x20000
    v_mul_u32_u24 v110, 6240, v0
    v_and_b32 v111, 63, v0
    v_and_b32 v112, 0x3c0, v0
    v_lshlrev_b32 v111, 2, v111
    v_lshl_or_b32 v111, v112, 4, v111
    v_lshlrev_b32 v100, 2, v0
    s_lshr_b32 s50, s2, 1
    s_and_b32 s53, s2, 1
    s_mul_i32 s3, s50, 50000
    s_mul_i32 s54, s53, 24576
    s_add_u32 s3, s3, s54

    buffer_load_dwordx4 v[56:59], v110, s[20:23], 0 offen
    s_add_u32 s20, s78, s3
    s_addc_u32 s21, s79, 0
    s_mov_b32 s22, 24576
    s_mov_b32 s23, 0x20000
    s_movk_i32 s3, 16384
    buffer_load_dword v44, v111, s[20:23], 0 offen offset:0
    buffer_load_dword v45, v111, s[20:23], 0 offen offset:256
    buffer_load_dword v46, v111, s[20:23], 0 offen offset:512
    buffer_load_dword v47, v111, s[20:23], 0 offen offset:768
    buffer_load_dword v48, v111, s[20:23], s3 offen offset:0
    buffer_load_dword v49, v111, s[20:23], s3 offen offset:256
    buffer_load_dword v50, v111, s[20:23], s3 offen offset:512
    buffer_load_dword v51, v111, s[20:23], s3 offen offset:768
    s_mul_i32 s22, s53, 25424
    s_movk_i32 s3, 24576

    buffer_load_dword v52, v100, s[20:23], s3 offen
    s_mul_i32 s3, s50, 50048
    s_add_u32 s3, s3, s54
    s_add_u32 s54, s3, 2490368

    v_readfirstlane_b32 s74, v0
    s_mov_b32 s55, 0x05040100
    s_nop 0
    s_cmp_lt_u32 s74, 768
    s_cbranch_scc1 L_nogate_5
    s_load_dwordx2 s[92:93], s[0:1], 40
    s_load_dwordx4 s[32:35], s[0:1], 56
    v_mov_b32 v110, 0
    s_waitcnt lgkmcnt(0)
    global_load_dwordx4 v[60:63], v110, s[92:93]

    global_load_dwordx4 v[64:67], v110, s[32:33] offset:0
    global_load_dwordx4 v[80:83], v110, s[34:35] offset:0
    global_load_dwordx4 v[68:71], v110, s[32:33] offset:16
    global_load_dwordx4 v[84:87], v110, s[34:35] offset:16
    global_load_dwordx4 v[72:75], v110, s[32:33] offset:32
    global_load_dwordx4 v[88:91], v110, s[34:35] offset:32
    global_load_dwordx4 v[76:79], v110, s[32:33] offset:48
    global_load_dwordx4 v[92:95], v110, s[34:35] offset:48
    s_lshl_b32 s74, s2, 8
    v_and_b32 v111, 255, v0
    v_add_u32 v111, s74, v111
    v_lshlrev_b32 v112, 16, v111
    v_lshlrev_b32 v111, 5, v111
    s_mov_b32 s75, 0x07060302
    s_waitcnt vmcnt(0)

    v_lshlrev_b32 v118, 16, v60
    v_and_b32 v119, 0xffff0000, v60
    v_lshlrev_b32 v120, 16, v61
    v_and_b32 v121, 0xffff0000, v61
    v_lshlrev_b32 v122, 16, v62
    v_and_b32 v123, 0xffff0000, v62
    v_lshlrev_b32 v124, 16, v63
    v_and_b32 v125, 0xffff0000, v63
    v_sub_f32 v118, v112, v118
    v_sub_f32 v119, v112, v119
    v_sub_f32 v120, v112, v120
    v_sub_f32 v121, v112, v121
    v_sub_f32 v122, v112, v122
    v_sub_f32 v123, v112, v123
    v_sub_f32 v124, v112, v124
    v_sub_f32 v125, v112, v125
    v_cvt_pk_bf16_f32 v118, v118, v119
    v_cvt_pk_bf16_f32 v120, v120, v121
    v_cvt_pk_bf16_f32 v122, v122, v123
    v_cvt_pk_bf16_f32 v124, v124, v125
    v_and_b32 v119, 0xffff0000, v118
    v_lshlrev_b32 v118, 16, v118
    v_and_b32 v121, 0xffff0000, v120
    v_lshlrev_b32 v120, 16, v120
    v_and_b32 v123, 0xffff0000, v122
    v_lshlrev_b32 v122, 16, v122
    v_and_b32 v125, 0xffff0000, v124
    v_lshlrev_b32 v124, 16, v124
    v_mul_f32 v118, v118, v118
    v_mul_f32 v119, v119, v119
    v_mul_f32 v120, v120, v120
    v_mul_f32 v121, v121, v121
    v_mul_f32 v122, v122, v122
    v_mul_f32 v123, v123, v123
    v_mul_f32 v124, v124, v124
    v_mul_f32 v125, v125, v125
    v_cvt_pk_bf16_f32 v118, v118, v119
    v_cvt_pk_bf16_f32 v120, v120, v121
    v_cvt_pk_bf16_f32 v122, v122, v123
    v_cvt_pk_bf16_f32 v124, v124, v125
    v_and_b32 v119, 0xffff0000, v118
    v_lshlrev_b32 v118, 16, v118
    v_and_b32 v121, 0xffff0000, v120
    v_lshlrev_b32 v120, 16, v120
    v_and_b32 v123, 0xffff0000, v122
    v_lshlrev_b32 v122, 16, v122
    v_and_b32 v125, 0xffff0000, v124
    v_lshlrev_b32 v124, 16, v124
    v_mul_f32 v118, 0xc1200000, v118
    v_mul_f32 v119, 0xc1200000, v119
    v_mul_f32 v120, 0xc1200000, v120
    v_mul_f32 v121, 0xc1200000, v121
    v_mul_f32 v122, 0xc1200000, v122
    v_mul_f32 v123, 0xc1200000, v123
    v_mul_f32 v124, 0xc1200000, v124
    v_mul_f32 v125, 0xc1200000, v125
    v_cvt_pk_bf16_f32 v118, v118, v119
    v_cvt_pk_bf16_f32 v120, v120, v121
    v_cvt_pk_bf16_f32 v122, v122, v123
    v_cvt_pk_bf16_f32 v124, v124, v125
    v_and_b32 v119, 0xffff0000, v118
    v_lshlrev_b32 v118, 16, v118
    v_and_b32 v121, 0xffff0000, v120
    v_lshlrev_b32 v120, 16, v120
    v_and_b32 v123, 0xffff0000, v122
    v_lshlrev_b32 v122, 16, v122
    v_and_b32 v125, 0xffff0000, v124
    v_lshlrev_b32 v124, 16, v124
    v_mul_f32 v118, 0x3fb8aa3b, v118
    v_mul_f32 v119, 0x3fb8aa3b, v119
    v_mul_f32 v120, 0x3fb8aa3b, v120
    v_mul_f32 v121, 0x3fb8aa3b, v121
    v_mul_f32 v122, 0x3fb8aa3b, v122
    v_mul_f32 v123, 0x3fb8aa3b, v123
    v_mul_f32 v124, 0x3fb8aa3b, v124
    v_mul_f32 v125, 0x3fb8aa3b, v125
    v_exp_f32 v118, v118
    v_exp_f32 v119, v119
    v_exp_f32 v120, v120
    v_exp_f32 v121, v121
    v_exp_f32 v122, v122
    v_exp_f32 v123, v123
    v_exp_f32 v124, v124
    v_exp_f32 v125, v125
    s_nop 0
    v_cvt_pk_bf16_f32 v118, v118, v119
    v_cvt_pk_bf16_f32 v120, v120, v121
    v_cvt_pk_bf16_f32 v122, v122, v123
    v_cvt_pk_bf16_f32 v124, v124, v125
    v_perm_b32 v113, v66, v64, s55
    v_dot2_f32_bf16 v114, v118, v113, 0

    v_perm_b32 v113, v66, v64, s75
    v_dot2_f32_bf16 v115, v118, v113, 0

    v_perm_b32 v113, v67, v65, s55
    v_dot2_f32_bf16 v116, v118, v113, 0

    v_perm_b32 v113, v67, v65, s75
    v_dot2_f32_bf16 v117, v118, v113, 0

    v_perm_b32 v113, v70, v68, s55
    v_dot2_f32_bf16 v114, v120, v113, v114

    v_perm_b32 v113, v70, v68, s75
    v_dot2_f32_bf16 v115, v120, v113, v115

    v_perm_b32 v113, v71, v69, s55
    v_dot2_f32_bf16 v116, v120, v113, v116

    v_perm_b32 v113, v71, v69, s75
    v_dot2_f32_bf16 v117, v120, v113, v117

    v_perm_b32 v113, v74, v72, s55
    v_dot2_f32_bf16 v114, v122, v113, v114

    v_perm_b32 v113, v74, v72, s75
    v_dot2_f32_bf16 v115, v122, v113, v115

    v_perm_b32 v113, v75, v73, s55
    v_dot2_f32_bf16 v116, v122, v113, v116

    v_perm_b32 v113, v75, v73, s75
    v_dot2_f32_bf16 v117, v122, v113, v117

    v_perm_b32 v113, v78, v76, s55
    v_dot2_f32_bf16 v114, v124, v113, v114

    v_perm_b32 v113, v78, v76, s75
    v_dot2_f32_bf16 v115, v124, v113, v115

    v_perm_b32 v113, v79, v77, s55
    v_dot2_f32_bf16 v116, v124, v113, v116

    v_perm_b32 v113, v79, v77, s75
    v_dot2_f32_bf16 v117, v124, v113, v117

    v_perm_b32 v113, v82, v80, s55
    v_dot2_f32_bf16 v60, v118, v113, 0

    v_perm_b32 v113, v82, v80, s75
    v_dot2_f32_bf16 v61, v118, v113, 0

    v_perm_b32 v113, v83, v81, s55
    v_dot2_f32_bf16 v62, v118, v113, 0

    v_perm_b32 v113, v83, v81, s75
    v_dot2_f32_bf16 v63, v118, v113, 0

    v_perm_b32 v113, v86, v84, s55
    v_dot2_f32_bf16 v60, v120, v113, v60

    v_perm_b32 v113, v86, v84, s75
    v_dot2_f32_bf16 v61, v120, v113, v61

    v_perm_b32 v113, v87, v85, s55
    v_dot2_f32_bf16 v62, v120, v113, v62

    v_perm_b32 v113, v87, v85, s75
    v_dot2_f32_bf16 v63, v120, v113, v63

    v_perm_b32 v113, v90, v88, s55
    v_dot2_f32_bf16 v60, v122, v113, v60

    v_perm_b32 v113, v90, v88, s75
    v_dot2_f32_bf16 v61, v122, v113, v61

    v_perm_b32 v113, v91, v89, s55
    v_dot2_f32_bf16 v62, v122, v113, v62

    v_perm_b32 v113, v91, v89, s75
    v_dot2_f32_bf16 v63, v122, v113, v63

    v_perm_b32 v113, v94, v92, s55
    v_dot2_f32_bf16 v60, v124, v113, v60

    v_perm_b32 v113, v94, v92, s75
    v_dot2_f32_bf16 v61, v124, v113, v61

    v_perm_b32 v113, v95, v93, s55
    v_dot2_f32_bf16 v62, v124, v113, v62

    v_perm_b32 v113, v95, v93, s75
    v_dot2_f32_bf16 v63, v124, v113, v63

    s_add_u32 s92, s6, 393216
    s_addc_u32 s93, s7, 0
    s_mov_b32 s94, 2097152
    s_mov_b32 s95, 0x20000
    v_cvt_pk_bf16_f32 v114, v114, v115
    v_cvt_pk_bf16_f32 v115, v116, v117
    buffer_store_dwordx4 v[60:63], v111, s[92:95], 0 offen
    buffer_store_dwordx2 v[114:115], v111, s[92:95], 0 offen offset:16
    s_nop 1
L_nogate_5:

    s_mov_b32 s8, s80
    s_mov_b32 s9, s81
    s_mov_b32 s10, 0
    s_mov_b32 s11, 0x20000
    s_mov_b32 s12, s82
    s_mov_b32 s13, s83
    s_mov_b32 s14, 0
    s_mov_b32 s15, 0x20000
    s_mov_b32 s16, s84
    s_mov_b32 s17, s85
    s_mov_b32 s18, 0
    s_mov_b32 s19, 0x20000
    s_lshr_b32 s74, s2, 1
    s_and_b32 s74, s74, 28
    s_lshr_b32 s86, 0x00102010, s74
    s_lshr_b32 s87, 0x44414241, s74
    s_lshr_b32 s41, 0x43221100, s74
    s_and_b32 s86, s86, 15
    s_and_b32 s87, s87, 15
    s_and_b32 s41, s41, 15
    s_lshr_b32 s74, s2, 6
    s_lshl_b32 s74, s74, 3
    s_and_b32 s75, s2, 7
    s_add_u32 s74, s74, s75
    s_mul_i32 s74, s74, 5
    s_add_u32 s41, s41, s74

    s_mul_i32 s78, s41, 16384
    s_add_u32 s49, s78, 16384
    s_cmp_ge_u32 s41, 3125
    s_cmovk_i32 s49, 0
    s_cmovk_i32 s78, 0
    s_lshl_b32 s10, s49, 2
    s_lshl_b32 s14, s49, 2
    s_lshl_b32 s18, s49, 1
    s_sub_u32 s79, s87, s86
    s_bfm_b32 s85, s79, s86
    s_lshl_b32 s86, s86, 12
    s_lshl_b32 s87, s87, 12
    s_min_u32 s87, s87, 16384

    s_add_u32 s79, s78, 0
    s_bitcmp1_b32 s85, 0
    s_cselect_b32 s79, s79, 0x1ff00000
    s_lshl_b32 s56, s79, 2
    s_lshl_b32 s61, s79, 1

    s_add_u32 s79, s78, 4096
    s_bitcmp1_b32 s85, 1
    s_cselect_b32 s79, s79, 0x1ff00000
    s_lshl_b32 s57, s79, 2
    s_lshl_b32 s62, s79, 1

    s_add_u32 s79, s78, 8192
    s_bitcmp1_b32 s85, 2
    s_cselect_b32 s79, s79, 0x1ff00000
    s_lshl_b32 s58, s79, 2
    s_lshl_b32 s63, s79, 1

    s_add_u32 s79, s78, 12288
    s_bitcmp1_b32 s85, 3
    s_cselect_b32 s79, s79, 0x1ff00000
    s_lshl_b32 s59, s79, 2
    s_lshl_b32 s64, s79, 1

    s_mov_b32 s82, s85
    s_mov_b32 s83, s86
    s_mov_b32 s84, s87
    s_add_u32 s41, s2, 160
    s_mul_i32 s74, s41, 16384
    s_mov_b32 s10, 204800000
    s_mov_b32 s14, 204800000
    s_mov_b32 s18, 102400000

    s_add_u32 s75, s74, 0
    s_lshl_b32 s76, s75, 2
    s_lshl_b32 s75, s75, 1
    s_bitcmp1_b32 s82, 0
    s_cselect_b32 s56, s56, s76
    s_cselect_b32 s61, s61, s75

    s_add_u32 s75, s74, 4096
    s_lshl_b32 s76, s75, 2
    s_lshl_b32 s75, s75, 1
    s_bitcmp1_b32 s82, 1
    s_cselect_b32 s57, s57, s76
    s_cselect_b32 s62, s62, s75

    s_add_u32 s75, s74, 8192
    s_lshl_b32 s76, s75, 2
    s_lshl_b32 s75, s75, 1
    s_bitcmp1_b32 s82, 2
    s_cselect_b32 s58, s58, s76
    s_cselect_b32 s63, s63, s75

    s_add_u32 s75, s74, 12288
    s_lshl_b32 s76, s75, 2
    s_lshl_b32 s75, s75, 1
    s_bitcmp1_b32 s82, 3
    s_cselect_b32 s59, s59, s76
    s_cselect_b32 s64, s64, s75

    buffer_load_dwordx4 v[20:23], v1, s[12:15], s56 offen nt
    buffer_load_dwordx4 v[4:7], v1, s[8:11], s56 offen nt
    buffer_load_dwordx2 v[36:37], v2, s[16:19], s61 offen nt
    buffer_load_dwordx4 v[24:27], v1, s[12:15], s57 offen nt
    buffer_load_dwordx4 v[8:11], v1, s[8:11], s57 offen nt
    buffer_load_dwordx2 v[38:39], v2, s[16:19], s62 offen nt
    buffer_load_dwordx4 v[28:31], v1, s[12:15], s58 offen nt
    buffer_load_dwordx4 v[12:15], v1, s[8:11], s58 offen nt
    buffer_load_dwordx2 v[40:41], v2, s[16:19], s63 offen nt
    buffer_load_dwordx4 v[32:35], v1, s[12:15], s59 offen nt
    buffer_load_dwordx4 v[16:19], v1, s[8:11], s59 offen nt
    buffer_load_dwordx2 v[42:43], v2, s[16:19], s64 offen nt
    s_mov_b32 s86, 0
    s_mov_b32 s87, 4
    s_mul_i32 s78, s41, 16384
    s_add_u32 s49, s78, 16384
    s_cmp_ge_u32 s41, 3125
    s_cmovk_i32 s49, 0
    s_cmovk_i32 s78, 0
    s_lshl_b32 s10, s49, 2
    s_lshl_b32 s14, s49, 2
    s_lshl_b32 s18, s49, 1
    s_sub_u32 s79, s87, s86
    s_bfm_b32 s85, s79, s86
    s_lshl_b32 s86, s86, 12
    s_lshl_b32 s87, s87, 12
    s_min_u32 s87, s87, 16384

    s_add_u32 s79, s78, 0
    s_bitcmp1_b32 s85, 0
    s_cselect_b32 s79, s79, 0x1ff00000
    s_lshl_b32 s56, s79, 2
    s_lshl_b32 s61, s79, 1

    s_add_u32 s79, s78, 4096
    s_bitcmp1_b32 s85, 1
    s_cselect_b32 s79, s79, 0x1ff00000
    s_lshl_b32 s57, s79, 2
    s_lshl_b32 s62, s79, 1

    s_add_u32 s79, s78, 8192
    s_bitcmp1_b32 s85, 2
    s_cselect_b32 s79, s79, 0x1ff00000
    s_lshl_b32 s58, s79, 2
    s_lshl_b32 s63, s79, 1

    s_add_u32 s79, s78, 12288
    s_bitcmp1_b32 s85, 3
    s_cselect_b32 s79, s79, 0x1ff00000
    s_lshl_b32 s59, s79, 2
    s_lshl_b32 s64, s79, 1

    s_getreg_b32 s5, hwreg(HW_REG_XCC_ID)
    s_and_b32 s5, s5, 7
    s_mul_i32 s3, s5, 4096

    s_add_u32 s20, s6, s3
    s_addc_u32 s21, s7, 0
    s_mov_b32 s22, 4096
    s_mov_b32 s23, 0x20000
    s_mul_i32 s3, s5, 67117056
    s_add_u32 s3, s3, 85721088
    s_add_u32 s24, s6, s3
    s_addc_u32 s25, s7, 0
    s_mov_b32 s26, 67117056
    s_mov_b32 s27, 0x20000
    s_add_u32 s36, s6, 32768
    s_addc_u32 s37, s7, 0
    s_mov_b32 s38, 4
    s_mov_b32 s39, 0x20000
    s_mov_b32 s40, 687195
    s_mov_b32 s42, -6250
    s_mov_b32 s43, 1942
    s_mov_b32 s45, 0x06050400
    s_mov_b32 s46, 0x05040c00
    s_mov_b32 s47, 0x04020100
    s_mov_b32 s48, 6552
    s_mov_b32 s50, 0
    v_mov_b32 v104, 1
    v_mov_b32 v105, 0x46ff8000
    s_mov_b32 s55, 0x05040100
    v_mul_u32_u24 v106, 5, v0
    v_mov_b32 v108, 16384
    v_mov_b32 v114, 0
    v_mov_b32 v115, 0
    v_mov_b32 v116, 0
    v_mov_b32 v117, -1
    ds_write_b64 v2, v[114:115]
    s_movk_i32 s3, 1024
    v_cmp_gt_u32 s[66:67], s3, v0
    s_movk_i32 s3, 1024
    v_cmp_gt_u32 s[68:69], s3, v0
    s_mov_b64 exec, 1
    ds_write_b128 v108, v[114:117]
    s_mov_b64 exec, -1
    s_waitcnt lgkmcnt(0)
    s_lshl_b32 s88, s88, 16
    v_mov_b32 v110, 0.15915494
    v_mul_f32 v110, s88, v110
    s_mov_b32 s3, 0x7fff7fff
    v_readfirstlane_b32 s44, v110

    s_waitcnt vmcnt(12)
    v_mov_b32 v61, 0
    v_mov_b32 v62, 0
    v_mov_b32 v63, 0
    v_dot2_f32_bf16 v61, v44, v44, v61
    v_dot2_f32_bf16 v61, v45, v45, v61
    v_dot2_f32_bf16 v61, v46, v46, v61
    v_dot2_f32_bf16 v61, v47, v47, v61
    v_dot2_f32_bf16 v61, v48, v48, v61
    v_dot2_f32_bf16 v61, v49, v49, v61
    v_dot2_f32_bf16 v61, v50, v50, v61
    v_dot2_f32_bf16 v61, v51, v51, v61
    v_dot2_f32_bf16 v61, v52, v52, v61
    v_dot2_f32_bf16 v62, v56, v56, v62
    v_dot2_f32_bf16 v62, v57, v57, v62
    v_dot2_f32_bf16 v62, v58, v58, v62
    v_dot2_f32_bf16 v62, v59, v59, v62
    v_and_b32 v60, s3, v44
    v_and_b32 v64, s3, v45
    v_pk_max_u16 v60, v60, v64
    v_and_b32 v64, s3, v46
    v_pk_max_u16 v60, v60, v64
    v_and_b32 v64, s3, v47
    v_pk_max_u16 v60, v60, v64
    v_and_b32 v64, s3, v48
    v_pk_max_u16 v60, v60, v64
    v_and_b32 v64, s3, v49
    v_pk_max_u16 v60, v60, v64
    v_and_b32 v64, s3, v50
    v_pk_max_u16 v60, v60, v64
    v_and_b32 v64, s3, v51
    v_pk_max_u16 v60, v60, v64
    v_and_b32 v64, s3, v52
    v_pk_max_u16 v60, v60, v64
    v_lshrrev_b32 v64, 16, v60
    v_and_b32 v60, 0xffff, v60
    v_max_u32 v60, v60, v64

    s_nop 1
    v_max_u32_dpp v60, v60, v60 row_shr:1 row_mask:0xf bank_mask:0xf
    s_nop 1
    v_max_u32_dpp v60, v60, v60 row_shr:2 row_mask:0xf bank_mask:0xf
    s_nop 1
    v_max_u32_dpp v60, v60, v60 row_shr:4 row_mask:0xf bank_mask:0xf
    s_nop 1
    v_max_u32_dpp v60, v60, v60 row_shr:8 row_mask:0xf bank_mask:0xf
    s_nop 1
    v_max_u32_dpp v60, v60, v60 row_bcast:15 row_mask:0xa bank_mask:0xf
    s_nop 1
    v_max_u32_dpp v60, v60, v60 row_bcast:31 row_mask:0xc bank_mask:0xf
    s_nop 1
    v_add_f32_dpp v61, v61, v61 row_shr:1 row_mask:0xf bank_mask:0xf
    s_nop 1
    v_add_f32_dpp v61, v61, v61 row_shr:2 row_mask:0xf bank_mask:0xf
    s_nop 1
    v_add_f32_dpp v61, v61, v61 row_shr:4 row_mask:0xf bank_mask:0xf
    s_nop 1
    v_add_f32_dpp v61, v61, v61 row_shr:8 row_mask:0xf bank_mask:0xf
    s_nop 1
    v_add_f32_dpp v61, v61, v61 row_bcast:15 row_mask:0xa bank_mask:0xf
    s_nop 1
    v_add_f32_dpp v61, v61, v61 row_bcast:31 row_mask:0xc bank_mask:0xf
    s_nop 1
    v_add_f32_dpp v62, v62, v62 row_shr:1 row_mask:0xf bank_mask:0xf
    s_nop 1
    v_add_f32_dpp v62, v62, v62 row_shr:2 row_mask:0xf bank_mask:0xf
    s_nop 1
    v_add_f32_dpp v62, v62, v62 row_shr:4 row_mask:0xf bank_mask:0xf
    s_nop 1
    v_add_f32_dpp v62, v62, v62 row_shr:8 row_mask:0xf bank_mask:0xf
    s_nop 1
    v_add_f32_dpp v62, v62, v62 row_bcast:15 row_mask:0xa bank_mask:0xf
    s_nop 1
    v_add_f32_dpp v62, v62, v62 row_bcast:31 row_mask:0xc bank_mask:0xf
    v_lshrrev_b32 v64, 6, v0
    v_lshlrev_b32 v64, 4, v64
    s_mov_b32 exec_lo, 0
    s_brev_b32 exec_hi, 1
    ds_write_b128 v64, v[60:63] offset:8192
    s_mov_b64 exec, -1
    v_and_b32 v64, 15, v0
    v_lshlrev_b32 v64, 4, v64
    s_waitcnt lgkmcnt(0)
    s_barrier
    ds_read_b128 v[60:63], v64 offset:8192
    s_waitcnt lgkmcnt(0)

    s_nop 0
    v_max_u32_dpp v60, v60, v60 row_ror:1 row_mask:0xf bank_mask:0xf
    v_add_f32_dpp v61, v61, v61 row_ror:1 row_mask:0xf bank_mask:0xf
    v_add_f32_dpp v62, v62, v62 row_ror:1 row_mask:0xf bank_mask:0xf

    s_nop 0
    v_max_u32_dpp v60, v60, v60 row_ror:2 row_mask:0xf bank_mask:0xf
    v_add_f32_dpp v61, v61, v61 row_ror:2 row_mask:0xf bank_mask:0xf
    v_add_f32_dpp v62, v62, v62 row_ror:2 row_mask:0xf bank_mask:0xf

    s_nop 0
    v_max_u32_dpp v60, v60, v60 row_ror:4 row_mask:0xf bank_mask:0xf
    v_add_f32_dpp v61, v61, v61 row_ror:4 row_mask:0xf bank_mask:0xf
    v_add_f32_dpp v62, v62, v62 row_ror:4 row_mask:0xf bank_mask:0xf

    s_nop 0
    v_max_u32_dpp v60, v60, v60 row_ror:8 row_mask:0xf bank_mask:0xf
    v_add_f32_dpp v61, v61, v61 row_ror:8 row_mask:0xf bank_mask:0xf
    v_add_f32_dpp v62, v62, v62 row_ror:8 row_mask:0xf bank_mask:0xf

    v_rsq_f32 v62, v62
    v_mov_b32 v65, 0x4b400000
    v_mul_f32 v62, 0x47decb04, v62
    s_nop 0
    v_readfirstlane_b32 s74, v62

    s_add_u32 s92, s6, 135168
    s_addc_u32 s93, s7, 0
    s_mov_b32 s94, 4096
    s_mov_b32 s95, 0x20000
    s_lshl_b32 s3, s2, 4
    buffer_store_dwordx4 v[60:63], v98, s[92:95], s3 offen
    v_lshlrev_b32 v66, 16, v44
    v_and_b32 v44, 0xffff0000, v44
    v_fma_f32 v66, v66, s74, v65
    v_fma_f32 v44, v44, s74, v65
    v_perm_b32 v44, v44, v66, s55

    v_lshlrev_b32 v66, 16, v45
    v_and_b32 v45, 0xffff0000, v45
    v_fma_f32 v66, v66, s74, v65
    v_fma_f32 v45, v45, s74, v65
    v_perm_b32 v45, v45, v66, s55

    v_lshlrev_b32 v66, 16, v46
    v_and_b32 v46, 0xffff0000, v46
    v_fma_f32 v66, v66, s74, v65
    v_fma_f32 v46, v46, s74, v65
    v_perm_b32 v46, v46, v66, s55

    v_lshlrev_b32 v66, 16, v47
    v_and_b32 v47, 0xffff0000, v47
    v_fma_f32 v66, v66, s74, v65
    v_fma_f32 v47, v47, s74, v65
    v_perm_b32 v47, v47, v66, s55

    v_lshlrev_b32 v66, 16, v48
    v_and_b32 v48, 0xffff0000, v48
    v_fma_f32 v66, v66, s74, v65
    v_fma_f32 v48, v48, s74, v65
    v_perm_b32 v48, v48, v66, s55

    v_lshlrev_b32 v66, 16, v49
    v_and_b32 v49, 0xffff0000, v49
    v_fma_f32 v66, v66, s74, v65
    v_fma_f32 v49, v49, s74, v65
    v_perm_b32 v49, v49, v66, s55

    v_lshlrev_b32 v66, 16, v50
    v_and_b32 v50, 0xffff0000, v50
    v_fma_f32 v66, v66, s74, v65
    v_fma_f32 v50, v50, s74, v65
    v_perm_b32 v50, v50, v66, s55

    v_lshlrev_b32 v66, 16, v51
    v_and_b32 v51, 0xffff0000, v51
    v_fma_f32 v66, v66, s74, v65
    v_fma_f32 v51, v51, s74, v65
    v_perm_b32 v51, v51, v66, s55

    v_lshlrev_b32 v66, 16, v52
    v_and_b32 v52, 0xffff0000, v52
    v_fma_f32 v66, v66, s74, v65
    v_fma_f32 v52, v52, s74, v65
    v_perm_b32 v52, v52, v66, s55

    s_add_u32 s92, s6, s54
    s_addc_u32 s93, s7, 0
    s_mov_b32 s94, 24576
    s_mov_b32 s95, 0x20000
    s_movk_i32 s3, 16384
    buffer_store_dwordx4 v[44:47], v1, s[92:95], 0 offen
    buffer_store_dwordx4 v[48:51], v1, s[92:95], s3 offen
    s_mul_i32 s94, s53, 25424
    s_movk_i32 s3, 24576

    buffer_store_dword v52, v100, s[92:95], s3 offen
    s_nop 1
    v_mov_b32 v100, 0
    buffer_atomic_add v100, v98, s[96:99], 0 offen offset:128 sc0
    s_bitcmp0_b32 s82, 0
    s_cbranch_scc1 L_ska_8
    s_waitcnt vmcnt(14)
    v_mul_hi_u32_u24 v45, s40, v20
    v_mul_hi_u32_u24 v44, s40, v4
    v_mul_hi_u32_u24 v47, s40, v21
    v_mul_hi_u32_u24 v46, s40, v5
    v_mul_hi_u32_u24 v49, s40, v22
    v_mul_hi_u32_u24 v48, s40, v6
    v_mul_hi_u32_u24 v51, s40, v23
    v_mul_hi_u32_u24 v50, s40, v7
    v_and_b32 v45, -2, v45
    v_mad_u32_u24 v4, v44, s43, v4
    v_and_b32 v76, -4, v44
    v_and_b32 v47, -2, v47
    v_mad_u32_u24 v5, v46, s43, v5
    v_and_b32 v77, -4, v46
    v_and_b32 v49, -2, v49
    v_mad_u32_u24 v6, v48, s43, v6
    v_and_b32 v78, -4, v48
    v_and_b32 v51, -2, v51
    v_mad_u32_u24 v7, v50, s43, v7
    v_and_b32 v79, -4, v50
    v_mad_i32_i24 v20, v45, s42, v20
    v_lshl_add_u32 v45, v76, 5, v45
    v_mad_i32_i24 v21, v47, s42, v21
    v_lshl_add_u32 v47, v77, 5, v47
    v_mad_i32_i24 v22, v49, s42, v22
    v_lshl_add_u32 v49, v78, 5, v49
    v_mad_i32_i24 v23, v51, s42, v23
    v_lshl_add_u32 v51, v79, 5, v51
    v_add_u32 v45, v45, v45
    ds_add_rtn_u32 v76, v45, v104
    v_add_u32 v47, v47, v47
    ds_add_rtn_u32 v77, v47, v104
    v_add_u32 v49, v49, v49
    ds_add_rtn_u32 v78, v49, v104
    v_add_u32 v51, v51, v51
    ds_add_rtn_u32 v79, v51, v104
    v_lshlrev_b32 v110, 16, v36
    v_and_b32 v111, 0xffff0000, v36
    v_lshlrev_b32 v112, 16, v37
    v_and_b32 v113, 0xffff0000, v37
    v_mul_f32 v110, s44, v110
    v_mul_f32 v111, s44, v111
    v_mul_f32 v112, s44, v112
    v_mul_f32 v113, s44, v113
    v_fract_f32 v110, v110
    v_fract_f32 v111, v111
    v_fract_f32 v112, v112
    v_fract_f32 v113, v113
    v_cos_f32 v110, v110
    v_cos_f32 v111, v111
    v_cos_f32 v112, v112
    v_cos_f32 v113, v113
    v_lshl_or_b32 v44, v44, 14, v20
    v_perm_b32 v45, v45, v4, s46
    v_bfe_u32 v4, v4, 8, 5

    v_lshl_or_b32 v46, v46, 14, v21
    v_perm_b32 v47, v47, v5, s46
    v_bfe_u32 v5, v5, 8, 5

    v_lshl_or_b32 v48, v48, 14, v22
    v_perm_b32 v49, v49, v6, s46
    v_bfe_u32 v6, v6, 8, 5

    v_lshl_or_b32 v50, v50, 14, v23
    v_perm_b32 v51, v51, v7, s46
    v_bfe_u32 v7, v7, 8, 5

    v_fmaak_f32 v110, v110, v105, 0x4b400010
    v_fmaak_f32 v111, v111, v105, 0x4b400010
    v_fmaak_f32 v112, v112, v105, 0x4b400010
    v_fmaak_f32 v113, v113, v105, 0x4b400010
    v_sub_u32 v110, v110, v4
    v_sub_u32 v111, v111, v5
    v_sub_u32 v112, v112, v6
    v_sub_u32 v113, v113, v7
    v_bfi_b32 v110, 31, v4, v110
    v_bfi_b32 v111, 31, v5, v111
    v_bfi_b32 v112, 31, v6, v112
    v_bfi_b32 v113, 31, v7, v113
    v_perm_b32 v44, v44, v110, s55
    v_perm_b32 v46, v46, v111, s55
    v_perm_b32 v48, v48, v112, s55
    v_perm_b32 v50, v50, v113, s55
    buffer_load_dwordx4 v[20:23], v1, s[12:15], s56 offen nt
    buffer_load_dwordx4 v[4:7], v1, s[8:11], s56 offen nt
    buffer_load_dwordx2 v[36:37], v2, s[16:19], s61 offen nt
L_bka_9:
    s_bitcmp0_b32 s82, 1
    s_cbranch_scc1 L_ska_10
    s_waitcnt vmcnt(14)
    v_mul_hi_u32_u24 v53, s40, v24
    v_mul_hi_u32_u24 v52, s40, v8
    v_mul_hi_u32_u24 v55, s40, v25
    v_mul_hi_u32_u24 v54, s40, v9
    v_mul_hi_u32_u24 v57, s40, v26
    v_mul_hi_u32_u24 v56, s40, v10
    v_mul_hi_u32_u24 v59, s40, v27
    v_mul_hi_u32_u24 v58, s40, v11
    v_and_b32 v53, -2, v53
    v_mad_u32_u24 v8, v52, s43, v8
    v_and_b32 v80, -4, v52
    v_and_b32 v55, -2, v55
    v_mad_u32_u24 v9, v54, s43, v9
    v_and_b32 v81, -4, v54
    v_and_b32 v57, -2, v57
    v_mad_u32_u24 v10, v56, s43, v10
    v_and_b32 v82, -4, v56
    v_and_b32 v59, -2, v59
    v_mad_u32_u24 v11, v58, s43, v11
    v_and_b32 v83, -4, v58
    v_mad_i32_i24 v24, v53, s42, v24
    v_lshl_add_u32 v53, v80, 5, v53
    v_mad_i32_i24 v25, v55, s42, v25
    v_lshl_add_u32 v55, v81, 5, v55
    v_mad_i32_i24 v26, v57, s42, v26
    v_lshl_add_u32 v57, v82, 5, v57
    v_mad_i32_i24 v27, v59, s42, v27
    v_lshl_add_u32 v59, v83, 5, v59
    v_add_u32 v53, v53, v53
    ds_add_rtn_u32 v80, v53, v104
    v_add_u32 v55, v55, v55
    ds_add_rtn_u32 v81, v55, v104
    v_add_u32 v57, v57, v57
    ds_add_rtn_u32 v82, v57, v104
    v_add_u32 v59, v59, v59
    ds_add_rtn_u32 v83, v59, v104
    v_lshlrev_b32 v110, 16, v38
    v_and_b32 v111, 0xffff0000, v38
    v_lshlrev_b32 v112, 16, v39
    v_and_b32 v113, 0xffff0000, v39
    v_mul_f32 v110, s44, v110
    v_mul_f32 v111, s44, v111
    v_mul_f32 v112, s44, v112
    v_mul_f32 v113, s44, v113
    v_fract_f32 v110, v110
    v_fract_f32 v111, v111
    v_fract_f32 v112, v112
    v_fract_f32 v113, v113
    v_cos_f32 v110, v110
    v_cos_f32 v111, v111
    v_cos_f32 v112, v112
    v_cos_f32 v113, v113
    v_lshl_or_b32 v52, v52, 14, v24
    v_perm_b32 v53, v53, v8, s46
    v_bfe_u32 v8, v8, 8, 5

    v_lshl_or_b32 v54, v54, 14, v25
    v_perm_b32 v55, v55, v9, s46
    v_bfe_u32 v9, v9, 8, 5

    v_lshl_or_b32 v56, v56, 14, v26
    v_perm_b32 v57, v57, v10, s46
    v_bfe_u32 v10, v10, 8, 5

    v_lshl_or_b32 v58, v58, 14, v27
    v_perm_b32 v59, v59, v11, s46
    v_bfe_u32 v11, v11, 8, 5

    v_fmaak_f32 v110, v110, v105, 0x4b400010
    v_fmaak_f32 v111, v111, v105, 0x4b400010
    v_fmaak_f32 v112, v112, v105, 0x4b400010
    v_fmaak_f32 v113, v113, v105, 0x4b400010
    v_sub_u32 v110, v110, v8
    v_sub_u32 v111, v111, v9
    v_sub_u32 v112, v112, v10
    v_sub_u32 v113, v113, v11
    v_bfi_b32 v110, 31, v8, v110
    v_bfi_b32 v111, 31, v9, v111
    v_bfi_b32 v112, 31, v10, v112
    v_bfi_b32 v113, 31, v11, v113
    v_perm_b32 v52, v52, v110, s55
    v_perm_b32 v54, v54, v111, s55
    v_perm_b32 v56, v56, v112, s55
    v_perm_b32 v58, v58, v113, s55
    buffer_load_dwordx4 v[24:27], v1, s[12:15], s57 offen nt
    buffer_load_dwordx4 v[8:11], v1, s[8:11], s57 offen nt
    buffer_load_dwordx2 v[38:39], v2, s[16:19], s62 offen nt
L_bka_11:
    s_bitcmp0_b32 s82, 2
    s_cbranch_scc1 L_ska_12
    s_waitcnt vmcnt(14)
    v_mul_hi_u32_u24 v61, s40, v28
    v_mul_hi_u32_u24 v60, s40, v12
    v_mul_hi_u32_u24 v63, s40, v29
    v_mul_hi_u32_u24 v62, s40, v13
    v_mul_hi_u32_u24 v65, s40, v30
    v_mul_hi_u32_u24 v64, s40, v14
    v_mul_hi_u32_u24 v67, s40, v31
    v_mul_hi_u32_u24 v66, s40, v15
    v_and_b32 v61, -2, v61
    v_mad_u32_u24 v12, v60, s43, v12
    v_and_b32 v84, -4, v60
    v_and_b32 v63, -2, v63
    v_mad_u32_u24 v13, v62, s43, v13
    v_and_b32 v85, -4, v62
    v_and_b32 v65, -2, v65
    v_mad_u32_u24 v14, v64, s43, v14
    v_and_b32 v86, -4, v64
    v_and_b32 v67, -2, v67
    v_mad_u32_u24 v15, v66, s43, v15
    v_and_b32 v87, -4, v66
    v_mad_i32_i24 v28, v61, s42, v28
    v_lshl_add_u32 v61, v84, 5, v61
    v_mad_i32_i24 v29, v63, s42, v29
    v_lshl_add_u32 v63, v85, 5, v63
    v_mad_i32_i24 v30, v65, s42, v30
    v_lshl_add_u32 v65, v86, 5, v65
    v_mad_i32_i24 v31, v67, s42, v31
    v_lshl_add_u32 v67, v87, 5, v67
    v_add_u32 v61, v61, v61
    ds_add_rtn_u32 v84, v61, v104
    v_add_u32 v63, v63, v63
    ds_add_rtn_u32 v85, v63, v104
    v_add_u32 v65, v65, v65
    ds_add_rtn_u32 v86, v65, v104
    v_add_u32 v67, v67, v67
    ds_add_rtn_u32 v87, v67, v104
    v_lshlrev_b32 v110, 16, v40
    v_and_b32 v111, 0xffff0000, v40
    v_lshlrev_b32 v112, 16, v41
    v_and_b32 v113, 0xffff0000, v41
    v_mul_f32 v110, s44, v110
    v_mul_f32 v111, s44, v111
    v_mul_f32 v112, s44, v112
    v_mul_f32 v113, s44, v113
    v_fract_f32 v110, v110
    v_fract_f32 v111, v111
    v_fract_f32 v112, v112
    v_fract_f32 v113, v113
    v_cos_f32 v110, v110
    v_cos_f32 v111, v111
    v_cos_f32 v112, v112
    v_cos_f32 v113, v113
    v_lshl_or_b32 v60, v60, 14, v28
    v_perm_b32 v61, v61, v12, s46
    v_bfe_u32 v12, v12, 8, 5

    v_lshl_or_b32 v62, v62, 14, v29
    v_perm_b32 v63, v63, v13, s46
    v_bfe_u32 v13, v13, 8, 5

    v_lshl_or_b32 v64, v64, 14, v30
    v_perm_b32 v65, v65, v14, s46
    v_bfe_u32 v14, v14, 8, 5

    v_lshl_or_b32 v66, v66, 14, v31
    v_perm_b32 v67, v67, v15, s46
    v_bfe_u32 v15, v15, 8, 5

    v_fmaak_f32 v110, v110, v105, 0x4b400010
    v_fmaak_f32 v111, v111, v105, 0x4b400010
    v_fmaak_f32 v112, v112, v105, 0x4b400010
    v_fmaak_f32 v113, v113, v105, 0x4b400010
    v_sub_u32 v110, v110, v12
    v_sub_u32 v111, v111, v13
    v_sub_u32 v112, v112, v14
    v_sub_u32 v113, v113, v15
    v_bfi_b32 v110, 31, v12, v110
    v_bfi_b32 v111, 31, v13, v111
    v_bfi_b32 v112, 31, v14, v112
    v_bfi_b32 v113, 31, v15, v113
    v_perm_b32 v60, v60, v110, s55
    v_perm_b32 v62, v62, v111, s55
    v_perm_b32 v64, v64, v112, s55
    v_perm_b32 v66, v66, v113, s55
    buffer_load_dwordx4 v[28:31], v1, s[12:15], s58 offen nt
    buffer_load_dwordx4 v[12:15], v1, s[8:11], s58 offen nt
    buffer_load_dwordx2 v[40:41], v2, s[16:19], s63 offen nt
L_bka_13:
    s_bitcmp0_b32 s82, 3
    s_cbranch_scc1 L_ska_14
    s_waitcnt vmcnt(14)
    s_mov_b64 exec, s[66:67]
    v_mul_hi_u32_u24 v69, s40, v32
    v_mul_hi_u32_u24 v68, s40, v16
    v_mul_hi_u32_u24 v71, s40, v33
    v_mul_hi_u32_u24 v70, s40, v17
    v_mul_hi_u32_u24 v73, s40, v34
    v_mul_hi_u32_u24 v72, s40, v18
    v_mul_hi_u32_u24 v75, s40, v35
    v_mul_hi_u32_u24 v74, s40, v19
    v_and_b32 v69, -2, v69
    v_mad_u32_u24 v16, v68, s43, v16
    v_and_b32 v88, -4, v68
    v_and_b32 v71, -2, v71
    v_mad_u32_u24 v17, v70, s43, v17
    v_and_b32 v89, -4, v70
    v_and_b32 v73, -2, v73
    v_mad_u32_u24 v18, v72, s43, v18
    v_and_b32 v90, -4, v72
    v_and_b32 v75, -2, v75
    v_mad_u32_u24 v19, v74, s43, v19
    v_and_b32 v91, -4, v74
    v_mad_i32_i24 v32, v69, s42, v32
    v_lshl_add_u32 v69, v88, 5, v69
    v_mad_i32_i24 v33, v71, s42, v33
    v_lshl_add_u32 v71, v89, 5, v71
    v_mad_i32_i24 v34, v73, s42, v34
    v_lshl_add_u32 v73, v90, 5, v73
    v_mad_i32_i24 v35, v75, s42, v35
    v_lshl_add_u32 v75, v91, 5, v75
    v_add_u32 v69, v69, v69
    ds_add_rtn_u32 v88, v69, v104
    v_add_u32 v71, v71, v71
    ds_add_rtn_u32 v89, v71, v104
    v_add_u32 v73, v73, v73
    ds_add_rtn_u32 v90, v73, v104
    v_add_u32 v75, v75, v75
    ds_add_rtn_u32 v91, v75, v104
    v_lshlrev_b32 v110, 16, v42
    v_and_b32 v111, 0xffff0000, v42
    v_lshlrev_b32 v112, 16, v43
    v_and_b32 v113, 0xffff0000, v43
    v_mul_f32 v110, s44, v110
    v_mul_f32 v111, s44, v111
    v_mul_f32 v112, s44, v112
    v_mul_f32 v113, s44, v113
    v_fract_f32 v110, v110
    v_fract_f32 v111, v111
    v_fract_f32 v112, v112
    v_fract_f32 v113, v113
    v_cos_f32 v110, v110
    v_cos_f32 v111, v111
    v_cos_f32 v112, v112
    v_cos_f32 v113, v113
    v_lshl_or_b32 v68, v68, 14, v32
    v_perm_b32 v69, v69, v16, s46
    v_bfe_u32 v16, v16, 8, 5

    v_lshl_or_b32 v70, v70, 14, v33
    v_perm_b32 v71, v71, v17, s46
    v_bfe_u32 v17, v17, 8, 5

    v_lshl_or_b32 v72, v72, 14, v34
    v_perm_b32 v73, v73, v18, s46
    v_bfe_u32 v18, v18, 8, 5

    v_lshl_or_b32 v74, v74, 14, v35
    v_perm_b32 v75, v75, v19, s46
    v_bfe_u32 v19, v19, 8, 5

    v_fmaak_f32 v110, v110, v105, 0x4b400010
    v_fmaak_f32 v111, v111, v105, 0x4b400010
    v_fmaak_f32 v112, v112, v105, 0x4b400010
    v_fmaak_f32 v113, v113, v105, 0x4b400010
    v_sub_u32 v110, v110, v16
    v_sub_u32 v111, v111, v17
    v_sub_u32 v112, v112, v18
    v_sub_u32 v113, v113, v19
    v_bfi_b32 v110, 31, v16, v110
    v_bfi_b32 v111, 31, v17, v111
    v_bfi_b32 v112, 31, v18, v112
    v_bfi_b32 v113, 31, v19, v113
    v_perm_b32 v68, v68, v110, s55
    v_perm_b32 v70, v70, v111, s55
    v_perm_b32 v72, v72, v112, s55
    v_perm_b32 v74, v74, v113, s55
    s_mov_b64 exec, -1
    buffer_load_dwordx4 v[32:35], v1, s[12:15], s59 offen nt
    buffer_load_dwordx4 v[16:19], v1, s[8:11], s59 offen nt
    buffer_load_dwordx2 v[42:43], v2, s[16:19], s64 offen nt
L_bka_15:
    v_readfirstlane_b32 s74, v0
    s_nop 1
    s_cmp_lg_u32 s74, 0
    s_cbranch_scc1 L_ready_17

    s_waitcnt vmcnt(12)
    v_readfirstlane_b32 s74, v100
    s_nop 1
    s_cmp_lg_u32 s74, 0
    s_cbranch_scc1 L_ready_17

    v_mov_b32 v110, 1
    buffer_atomic_add v110, v98, s[96:99], 0 offen offset:64 sc0
    s_waitcnt vmcnt(0)
    v_readfirstlane_b32 s74, v110
    s_nop 1
    s_cmp_lg_u32 s74, 0
    s_cbranch_scc1 L_zno_19

    s_mov_b32 s92, s6
    s_mov_b32 s93, s7
    s_mov_b32 s94, 32784
    s_mov_b32 s95, 0x20000
    v_mov_b32 v110, 0
    v_mov_b32 v111, 0
    v_mov_b32 v112, 0
    v_mov_b32 v113, 0
L_zl_18:
    buffer_store_dwordx4 v[110:113], v1, s[92:95], s74 offen sc0 sc1
    s_add_u32 s74, s74, 1024
    s_cmp_le_u32 s74, 32768
    s_cbranch_scc1 L_zl_18
    v_mov_b32 v114, 1
    s_waitcnt vmcnt(0)
    buffer_atomic_add v114, v98, s[96:99], 0 offen offset:128
L_zno_19:

L_spin_16:
    v_mov_b32 v100, 0
    buffer_atomic_add v100, v98, s[96:99], 0 offen offset:128 sc0
    s_waitcnt vmcnt(0)
    v_readfirstlane_b32 s74, v100
    s_nop 1
    s_cmp_eq_u32 s74, 0
    s_cbranch_scc1 L_spin_16
L_ready_17:

    s_waitcnt lgkmcnt(0)
    s_barrier

    ds_read_b64 v[94:95], v2
    s_waitcnt lgkmcnt(0)
    v_and_b32 v94, 0xffff, v94
    v_and_b32 v95, 0xffff, v95
    v_add_u32 v97, v94, v95
    s_nop 1
    v_add_u32_dpp v97, v97, v97 row_shr:1 row_mask:0xf bank_mask:0xf
    s_nop 1
    v_add_u32_dpp v97, v97, v97 row_shr:2 row_mask:0xf bank_mask:0xf
    s_nop 1
    v_add_u32_dpp v97, v97, v97 row_shr:4 row_mask:0xf bank_mask:0xf
    s_nop 1
    v_add_u32_dpp v97, v97, v97 row_shr:8 row_mask:0xf bank_mask:0xf
    s_nop 1
    v_add_u32_dpp v97, v97, v97 row_bcast:15 row_mask:0xa bank_mask:0xf
    s_nop 1
    v_add_u32_dpp v97, v97, v97 row_bcast:31 row_mask:0xc bank_mask:0xf
    s_mov_b32 exec_lo, 0
    s_brev_b32 exec_hi, 1
    ds_add_rtn_u32 v96, v108, v97
    s_mov_b64 exec, -1

    v_add_u32 v92, v94, v94
    v_add_u32 v93, v95, v95
    v_med3_u32 v92, v94, 2, v92
    v_med3_u32 v93, v95, 2, v93
    v_lshl_or_b32 v92, v93, 16, v92
    v_lshlrev_b32 v93, 2, v0
    buffer_atomic_add v92, v93, s[20:23], 0 offen sc0
    s_waitcnt lgkmcnt(0)
    v_readlane_b32 s77, v96, 63
    v_mul_u32_u24 v114, 65528, v0
    v_sub_u32 v97, v97, v95
    s_sub_u32 s50, s50, s83
    s_sub_u32 s77, s77, s50
    v_add_u32 v97, s77, v97
    v_sub_u32 v96, v97, v94
    v_lshlrev_b32 v111, 16, v97
    v_lshlrev_b32 v110, 16, v96
    ds_write_b64 v2, v[110:111]
    v_mad_i32_i24 v96, v96, -5, v114
    v_mad_i32_i24 v97, v97, -5, v114
    v_add_u32 v97, 32764, v97
    s_add_u32 s50, s50, s84
    s_mov_b32 s28, s82
    s_mov_b32 s29, s83
    s_mov_b32 s30, s84
    s_lshl_b32 s74, s29, 3
    s_lshl_b32 s75, s30, 3
    v_mov_b32 v125, s74
    v_mov_b32 v126, s75
    v_mov_b32 v127, -1

    s_waitcnt lgkmcnt(0)
    s_barrier

    s_mov_b64 exec, 1
    ds_write_b32 v125, v127 offset:16396
    ds_write_b32 v126, v127 offset:16404
    s_mov_b64 exec, -1

    s_bitcmp0_b32 s28, 0
    s_cbranch_scc1 L_skz_20
    v_lshrrev_b32 v110, 16, v45
    ds_read_b32 v110, v110
    v_lshrrev_b32 v111, 16, v47
    ds_read_b32 v111, v111
    v_lshrrev_b32 v112, 16, v49
    ds_read_b32 v112, v112
    v_lshrrev_b32 v113, 16, v51
    ds_read_b32 v113, v113
    s_waitcnt lgkmcnt(3)
    v_add_u32_sdwa v110, v110, v76 dst_sel:DWORD dst_unused:UNUSED_PAD src0_sel:WORD_1 src1_sel:WORD_0
    v_lshlrev_b32 v110, 3, v110
    ds_write_b64 v110, v[44:45] offset:16400

    s_waitcnt lgkmcnt(3)
    v_add_u32_sdwa v111, v111, v77 dst_sel:DWORD dst_unused:UNUSED_PAD src0_sel:WORD_1 src1_sel:WORD_0
    v_lshlrev_b32 v111, 3, v111
    ds_write_b64 v111, v[46:47] offset:16400

    s_waitcnt lgkmcnt(3)
    v_add_u32_sdwa v112, v112, v78 dst_sel:DWORD dst_unused:UNUSED_PAD src0_sel:WORD_1 src1_sel:WORD_0
    v_lshlrev_b32 v112, 3, v112
    ds_write_b64 v112, v[48:49] offset:16400

    s_waitcnt lgkmcnt(3)
    v_add_u32_sdwa v113, v113, v79 dst_sel:DWORD dst_unused:UNUSED_PAD src0_sel:WORD_1 src1_sel:WORD_0
    v_lshlrev_b32 v113, 3, v113
    ds_write_b64 v113, v[50:51] offset:16400

L_skz_20:
    s_bitcmp0_b32 s28, 1
    s_cbranch_scc1 L_skz_21
    v_lshrrev_b32 v110, 16, v53
    ds_read_b32 v110, v110
    v_lshrrev_b32 v111, 16, v55
    ds_read_b32 v111, v111
    v_lshrrev_b32 v112, 16, v57
    ds_read_b32 v112, v112
    v_lshrrev_b32 v113, 16, v59
    ds_read_b32 v113, v113
    s_waitcnt lgkmcnt(3)
    v_add_u32_sdwa v110, v110, v80 dst_sel:DWORD dst_unused:UNUSED_PAD src0_sel:WORD_1 src1_sel:WORD_0
    v_lshlrev_b32 v110, 3, v110
    ds_write_b64 v110, v[52:53] offset:16400

    s_waitcnt lgkmcnt(3)
    v_add_u32_sdwa v111, v111, v81 dst_sel:DWORD dst_unused:UNUSED_PAD src0_sel:WORD_1 src1_sel:WORD_0
    v_lshlrev_b32 v111, 3, v111
    ds_write_b64 v111, v[54:55] offset:16400

    s_waitcnt lgkmcnt(3)
    v_add_u32_sdwa v112, v112, v82 dst_sel:DWORD dst_unused:UNUSED_PAD src0_sel:WORD_1 src1_sel:WORD_0
    v_lshlrev_b32 v112, 3, v112
    ds_write_b64 v112, v[56:57] offset:16400

    s_waitcnt lgkmcnt(3)
    v_add_u32_sdwa v113, v113, v83 dst_sel:DWORD dst_unused:UNUSED_PAD src0_sel:WORD_1 src1_sel:WORD_0
    v_lshlrev_b32 v113, 3, v113
    ds_write_b64 v113, v[58:59] offset:16400

L_skz_21:
    s_bitcmp0_b32 s28, 2
    s_cbranch_scc1 L_skz_22
    v_lshrrev_b32 v110, 16, v61
    ds_read_b32 v110, v110
    v_lshrrev_b32 v111, 16, v63
    ds_read_b32 v111, v111
    v_lshrrev_b32 v112, 16, v65
    ds_read_b32 v112, v112
    v_lshrrev_b32 v113, 16, v67
    ds_read_b32 v113, v113
    s_waitcnt lgkmcnt(3)
    v_add_u32_sdwa v110, v110, v84 dst_sel:DWORD dst_unused:UNUSED_PAD src0_sel:WORD_1 src1_sel:WORD_0
    v_lshlrev_b32 v110, 3, v110
    ds_write_b64 v110, v[60:61] offset:16400

    s_waitcnt lgkmcnt(3)
    v_add_u32_sdwa v111, v111, v85 dst_sel:DWORD dst_unused:UNUSED_PAD src0_sel:WORD_1 src1_sel:WORD_0
    v_lshlrev_b32 v111, 3, v111
    ds_write_b64 v111, v[62:63] offset:16400

    s_waitcnt lgkmcnt(3)
    v_add_u32_sdwa v112, v112, v86 dst_sel:DWORD dst_unused:UNUSED_PAD src0_sel:WORD_1 src1_sel:WORD_0
    v_lshlrev_b32 v112, 3, v112
    ds_write_b64 v112, v[64:65] offset:16400

    s_waitcnt lgkmcnt(3)
    v_add_u32_sdwa v113, v113, v87 dst_sel:DWORD dst_unused:UNUSED_PAD src0_sel:WORD_1 src1_sel:WORD_0
    v_lshlrev_b32 v113, 3, v113
    ds_write_b64 v113, v[66:67] offset:16400

L_skz_22:
    s_bitcmp0_b32 s28, 3
    s_cbranch_scc1 L_skz_23
    s_mov_b64 exec, s[66:67]
    v_lshrrev_b32 v110, 16, v69
    ds_read_b32 v110, v110
    v_lshrrev_b32 v111, 16, v71
    ds_read_b32 v111, v111
    v_lshrrev_b32 v112, 16, v73
    ds_read_b32 v112, v112
    v_lshrrev_b32 v113, 16, v75
    ds_read_b32 v113, v113
    s_waitcnt lgkmcnt(3)
    v_add_u32_sdwa v110, v110, v88 dst_sel:DWORD dst_unused:UNUSED_PAD src0_sel:WORD_1 src1_sel:WORD_0
    v_lshlrev_b32 v110, 3, v110
    ds_write_b64 v110, v[68:69] offset:16400

    s_waitcnt lgkmcnt(3)
    v_add_u32_sdwa v111, v111, v89 dst_sel:DWORD dst_unused:UNUSED_PAD src0_sel:WORD_1 src1_sel:WORD_0
    v_lshlrev_b32 v111, 3, v111
    ds_write_b64 v111, v[70:71] offset:16400

    s_waitcnt lgkmcnt(3)
    v_add_u32_sdwa v112, v112, v90 dst_sel:DWORD dst_unused:UNUSED_PAD src0_sel:WORD_1 src1_sel:WORD_0
    v_lshlrev_b32 v112, 3, v112
    ds_write_b64 v112, v[72:73] offset:16400

    s_waitcnt lgkmcnt(3)
    v_add_u32_sdwa v113, v113, v91 dst_sel:DWORD dst_unused:UNUSED_PAD src0_sel:WORD_1 src1_sel:WORD_0
    v_lshlrev_b32 v113, 3, v113
    ds_write_b64 v113, v[74:75] offset:16400

    s_mov_b64 exec, -1
L_skz_23:
    s_cmp_eq_u32 s49, 0
    s_cbranch_scc1 L_p1epi_7
L_p1loop_6:
    s_mov_b32 s82, s85
    s_mov_b32 s83, s86
    s_mov_b32 s84, s87
    v_mov_b32 v99, 1
    buffer_atomic_add v99, v98, s[96:99], 0 offen sc0
    s_bitcmp0_b32 s82, 0
    s_cbranch_scc1 L_ska_24
    s_waitcnt vmcnt(11)
    v_mul_hi_u32_u24 v45, s40, v20
    v_mul_hi_u32_u24 v44, s40, v4
    v_mul_hi_u32_u24 v47, s40, v21
    v_mul_hi_u32_u24 v46, s40, v5
    v_mul_hi_u32_u24 v49, s40, v22
    v_mul_hi_u32_u24 v48, s40, v6
    v_mul_hi_u32_u24 v51, s40, v23
    v_mul_hi_u32_u24 v50, s40, v7
    v_and_b32 v45, -2, v45
    v_mad_u32_u24 v4, v44, s43, v4
    v_and_b32 v76, -4, v44
    v_and_b32 v47, -2, v47
    v_mad_u32_u24 v5, v46, s43, v5
    v_and_b32 v77, -4, v46
    v_and_b32 v49, -2, v49
    v_mad_u32_u24 v6, v48, s43, v6
    v_and_b32 v78, -4, v48
    v_and_b32 v51, -2, v51
    v_mad_u32_u24 v7, v50, s43, v7
    v_and_b32 v79, -4, v50
    v_mad_i32_i24 v20, v45, s42, v20
    v_lshl_add_u32 v45, v76, 5, v45
    v_mad_i32_i24 v21, v47, s42, v21
    v_lshl_add_u32 v47, v77, 5, v47
    v_mad_i32_i24 v22, v49, s42, v22
    v_lshl_add_u32 v49, v78, 5, v49
    v_mad_i32_i24 v23, v51, s42, v23
    v_lshl_add_u32 v51, v79, 5, v51
    v_add_u32 v45, v45, v45
    ds_add_rtn_u32 v76, v45, v104
    v_add_u32 v47, v47, v47
    ds_add_rtn_u32 v77, v47, v104
    v_add_u32 v49, v49, v49
    ds_add_rtn_u32 v78, v49, v104
    v_add_u32 v51, v51, v51
    ds_add_rtn_u32 v79, v51, v104
    v_lshlrev_b32 v110, 16, v36
    v_and_b32 v111, 0xffff0000, v36
    v_lshlrev_b32 v112, 16, v37
    v_and_b32 v113, 0xffff0000, v37
    v_mul_f32 v110, s44, v110
    v_mul_f32 v111, s44, v111
    v_mul_f32 v112, s44, v112
    v_mul_f32 v113, s44, v113
    v_fract_f32 v110, v110
    v_fract_f32 v111, v111
    v_fract_f32 v112, v112
    v_fract_f32 v113, v113
    v_cos_f32 v110, v110
    v_cos_f32 v111, v111
    v_cos_f32 v112, v112
    v_cos_f32 v113, v113
    v_lshl_or_b32 v44, v44, 14, v20
    v_perm_b32 v45, v45, v4, s46
    v_bfe_u32 v4, v4, 8, 5

    v_lshl_or_b32 v46, v46, 14, v21
    v_perm_b32 v47, v47, v5, s46
    v_bfe_u32 v5, v5, 8, 5

    v_lshl_or_b32 v48, v48, 14, v22
    v_perm_b32 v49, v49, v6, s46
    v_bfe_u32 v6, v6, 8, 5

    v_lshl_or_b32 v50, v50, 14, v23
    v_perm_b32 v51, v51, v7, s46
    v_bfe_u32 v7, v7, 8, 5

    v_fmaak_f32 v110, v110, v105, 0x4b400010
    v_fmaak_f32 v111, v111, v105, 0x4b400010
    v_fmaak_f32 v112, v112, v105, 0x4b400010
    v_fmaak_f32 v113, v113, v105, 0x4b400010
    v_sub_u32 v110, v110, v4
    v_sub_u32 v111, v111, v5
    v_sub_u32 v112, v112, v6
    v_sub_u32 v113, v113, v7
    v_bfi_b32 v110, 31, v4, v110
    v_bfi_b32 v111, 31, v5, v111
    v_bfi_b32 v112, 31, v6, v112
    v_bfi_b32 v113, 31, v7, v113
    v_perm_b32 v44, v44, v110, s55
    v_perm_b32 v46, v46, v111, s55
    v_perm_b32 v48, v48, v112, s55
    v_perm_b32 v50, v50, v113, s55
L_ska_24:
    s_bitcmp0_b32 s82, 1
    s_cbranch_scc1 L_ska_25
    s_waitcnt vmcnt(8)
    v_mul_hi_u32_u24 v53, s40, v24
    v_mul_hi_u32_u24 v52, s40, v8
    v_mul_hi_u32_u24 v55, s40, v25
    v_mul_hi_u32_u24 v54, s40, v9
    v_mul_hi_u32_u24 v57, s40, v26
    v_mul_hi_u32_u24 v56, s40, v10
    v_mul_hi_u32_u24 v59, s40, v27
    v_mul_hi_u32_u24 v58, s40, v11
    v_and_b32 v53, -2, v53
    v_mad_u32_u24 v8, v52, s43, v8
    v_and_b32 v80, -4, v52
    v_and_b32 v55, -2, v55
    v_mad_u32_u24 v9, v54, s43, v9
    v_and_b32 v81, -4, v54
    v_and_b32 v57, -2, v57
    v_mad_u32_u24 v10, v56, s43, v10
    v_and_b32 v82, -4, v56
    v_and_b32 v59, -2, v59
    v_mad_u32_u24 v11, v58, s43, v11
    v_and_b32 v83, -4, v58
    v_mad_i32_i24 v24, v53, s42, v24
    v_lshl_add_u32 v53, v80, 5, v53
    v_mad_i32_i24 v25, v55, s42, v25
    v_lshl_add_u32 v55, v81, 5, v55
    v_mad_i32_i24 v26, v57, s42, v26
    v_lshl_add_u32 v57, v82, 5, v57
    v_mad_i32_i24 v27, v59, s42, v27
    v_lshl_add_u32 v59, v83, 5, v59
    v_add_u32 v53, v53, v53
    ds_add_rtn_u32 v80, v53, v104
    v_add_u32 v55, v55, v55
    ds_add_rtn_u32 v81, v55, v104
    v_add_u32 v57, v57, v57
    ds_add_rtn_u32 v82, v57, v104
    v_add_u32 v59, v59, v59
    ds_add_rtn_u32 v83, v59, v104
    v_lshlrev_b32 v110, 16, v38
    v_and_b32 v111, 0xffff0000, v38
    v_lshlrev_b32 v112, 16, v39
    v_and_b32 v113, 0xffff0000, v39
    v_mul_f32 v110, s44, v110
    v_mul_f32 v111, s44, v111
    v_mul_f32 v112, s44, v112
    v_mul_f32 v113, s44, v113
    v_fract_f32 v110, v110
    v_fract_f32 v111, v111
    v_fract_f32 v112, v112
    v_fract_f32 v113, v113
    v_cos_f32 v110, v110
    v_cos_f32 v111, v111
    v_cos_f32 v112, v112
    v_cos_f32 v113, v113
    v_lshl_or_b32 v52, v52, 14, v24
    v_perm_b32 v53, v53, v8, s46
    v_bfe_u32 v8, v8, 8, 5

    v_lshl_or_b32 v54, v54, 14, v25
    v_perm_b32 v55, v55, v9, s46
    v_bfe_u32 v9, v9, 8, 5

    v_lshl_or_b32 v56, v56, 14, v26
    v_perm_b32 v57, v57, v10, s46
    v_bfe_u32 v10, v10, 8, 5

    v_lshl_or_b32 v58, v58, 14, v27
    v_perm_b32 v59, v59, v11, s46
    v_bfe_u32 v11, v11, 8, 5

    v_fmaak_f32 v110, v110, v105, 0x4b400010
    v_fmaak_f32 v111, v111, v105, 0x4b400010
    v_fmaak_f32 v112, v112, v105, 0x4b400010
    v_fmaak_f32 v113, v113, v105, 0x4b400010
    v_sub_u32 v110, v110, v8
    v_sub_u32 v111, v111, v9
    v_sub_u32 v112, v112, v10
    v_sub_u32 v113, v113, v11
    v_bfi_b32 v110, 31, v8, v110
    v_bfi_b32 v111, 31, v9, v111
    v_bfi_b32 v112, 31, v10, v112
    v_bfi_b32 v113, 31, v11, v113
    v_perm_b32 v52, v52, v110, s55
    v_perm_b32 v54, v54, v111, s55
    v_perm_b32 v56, v56, v112, s55
    v_perm_b32 v58, v58, v113, s55
L_ska_25:
    s_waitcnt vmcnt(1)
    s_waitcnt vmcnt(0)
    v_cmp_eq_u32 vcc, 0, v0
    s_mov_b64 exec, vcc
    ds_write_b32 v108, v99 offset:8
    s_mov_b64 exec, -1
    s_waitcnt vmcnt(1)
    v_lshrrev_b32 v93, 16, v92
    v_and_b32 v92, 0xffff, v92
    v_add_u32 v110, v92, v94
    v_mad_u32_u24 v92, v92, 5, v96
    v_add_u32 v111, v93, v95
    v_mad_u32_u24 v93, v93, 5, v97
    v_max_u32 v110, v110, v111
    v_cmp_le_u32 vcc, s48, v110
    s_cbranch_vccnz L_full_26
L_fback_27:
    ds_write_b64 v2, v[92:93] offset:8192

    s_waitcnt lgkmcnt(0)
    s_barrier
    ds_read_b32 v111, v108 offset:8
    s_waitcnt lgkmcnt(0)
    v_readfirstlane_b32 s41, v111
    s_nop 1

    s_add_u32 s41, s41, 416
    s_sub_u32 s78, s41, 3061
    s_lshr_b32 s79, s78, 1
    s_add_u32 s79, s79, 3061
    s_and_b32 s86, s78, 1
    s_lshl_b32 s86, s86, 1
    s_add_u32 s87, s86, 2
    s_cmp_lt_u32 s41, 3061
    s_cselect_b32 s41, s41, s79
    s_cmovk_i32 s86, 0
    s_cmovk_i32 s87, 4

    s_mul_i32 s78, s41, 16384
    s_add_u32 s49, s78, 16384
    s_cmp_ge_u32 s41, 3125
    s_cmovk_i32 s49, 0
    s_cmovk_i32 s78, 0
    s_lshl_b32 s10, s49, 2
    s_lshl_b32 s14, s49, 2
    s_lshl_b32 s18, s49, 1
    s_sub_u32 s79, s87, s86
    s_bfm_b32 s85, s79, s86
    s_lshl_b32 s86, s86, 12
    s_lshl_b32 s87, s87, 12
    s_min_u32 s87, s87, 16384

    s_add_u32 s79, s78, 0
    s_bitcmp1_b32 s85, 0
    s_cselect_b32 s79, s79, 0x1ff00000
    s_lshl_b32 s56, s79, 2
    s_lshl_b32 s61, s79, 1

    s_add_u32 s79, s78, 4096
    s_bitcmp1_b32 s85, 1
    s_cselect_b32 s79, s79, 0x1ff00000
    s_lshl_b32 s57, s79, 2
    s_lshl_b32 s62, s79, 1

    s_add_u32 s79, s78, 8192
    s_bitcmp1_b32 s85, 2
    s_cselect_b32 s79, s79, 0x1ff00000
    s_lshl_b32 s58, s79, 2
    s_lshl_b32 s63, s79, 1

    s_add_u32 s79, s78, 12288
    s_bitcmp1_b32 s85, 3
    s_cselect_b32 s79, s79, 0x1ff00000
    s_lshl_b32 s59, s79, 2
    s_lshl_b32 s64, s79, 1

    s_bitcmp0_b32 s28, 0
    s_cbranch_scc1 L_skw_28
    ds_read_b64 v[110:111], v2 offset:16400
    ds_read_b64 v[112:113], v2 offset:16408
    ds_read_b64 v[114:115], v2 offset:16392

    ds_read_b64 v[118:119], v2 offset:24592
    ds_read_b64 v[120:121], v2 offset:24600
    ds_read_b64 v[122:123], v2 offset:24584

    s_waitcnt lgkmcnt(3)
    v_lshrrev_b32 v116, 16, v111
    ds_read_b32 v116, v116 offset:8192

    s_waitcnt lgkmcnt(1)
    v_lshrrev_b32 v124, 16, v119
    ds_read_b32 v124, v124 offset:8192

    v_cmp_ne_u32_sdwa s[80:81], v111, v113 src0_sel:WORD_1 src1_sel:WORD_1
    v_cmp_ne_u32_sdwa vcc, v111, v115 src0_sel:WORD_1 src1_sel:WORD_1
    v_alignbyte_b32 v114, v115, v114, 2
    s_mov_b32 s54, -3
    v_alignbyte_b32 v111, v111, v110, 1
    v_perm_b32 v110, v110, v114, s47
    s_waitcnt lgkmcnt(1)
    v_add3_u32 v116, v116, v106, s54
    v_sub_u32 v117, 0, v116
    v_and_b32 v117, 3, v117
    s_mov_b64 exec, s[80:81]
    v_mov_b32 v117, 0
    v_mov_b32 v112, 0
    s_mov_b64 exec, vcc
    v_mov_b32 v117, 3

    s_mov_b64 exec, -1
    v_alignbyte_b32 v110, v111, v110, v117
    v_alignbyte_b32 v111, v112, v111, v117
    v_add_u32 v116, v116, v117

    buffer_store_dwordx2 v[110:111], v116, s[24:27], 0 offen
    v_cmp_ne_u32_sdwa s[80:81], v119, v121 src0_sel:WORD_1 src1_sel:WORD_1
    v_cmp_ne_u32_sdwa vcc, v119, v123 src0_sel:WORD_1 src1_sel:WORD_1
    v_alignbyte_b32 v122, v123, v122, 2
    s_mov_b32 s54, 5117
    v_alignbyte_b32 v119, v119, v118, 1
    v_perm_b32 v118, v118, v122, s47
    s_waitcnt lgkmcnt(0)
    v_add3_u32 v124, v124, v106, s54
    v_sub_u32 v125, 0, v124
    v_and_b32 v125, 3, v125
    s_mov_b64 exec, s[80:81]
    v_mov_b32 v125, 0
    v_mov_b32 v120, 0
    s_mov_b64 exec, vcc
    v_mov_b32 v125, 3

    s_mov_b64 exec, -1
    v_alignbyte_b32 v118, v119, v118, v125
    v_alignbyte_b32 v119, v120, v119, v125
    v_add_u32 v124, v124, v125

    buffer_store_dwordx2 v[118:119], v124, s[24:27], 0 offen
L_skw_28:
    s_bitcmp0_b32 s28, 0
    s_cbranch_scc1 L_skw_29
    ds_read_b64 v[110:111], v2 offset:32784
    ds_read_b64 v[112:113], v2 offset:32792
    ds_read_b64 v[114:115], v2 offset:32776

    ds_read_b64 v[118:119], v2 offset:40976
    ds_read_b64 v[120:121], v2 offset:40984
    ds_read_b64 v[122:123], v2 offset:40968

    s_waitcnt lgkmcnt(3)
    v_lshrrev_b32 v116, 16, v111
    ds_read_b32 v116, v116 offset:8192

    s_waitcnt lgkmcnt(1)
    v_lshrrev_b32 v124, 16, v119
    ds_read_b32 v124, v124 offset:8192

    v_cmp_ne_u32_sdwa s[80:81], v111, v113 src0_sel:WORD_1 src1_sel:WORD_1
    v_cmp_ne_u32_sdwa vcc, v111, v115 src0_sel:WORD_1 src1_sel:WORD_1
    v_alignbyte_b32 v114, v115, v114, 2
    s_mov_b32 s54, 10237
    v_alignbyte_b32 v111, v111, v110, 1
    v_perm_b32 v110, v110, v114, s47
    s_waitcnt lgkmcnt(1)
    v_add3_u32 v116, v116, v106, s54
    v_sub_u32 v117, 0, v116
    v_and_b32 v117, 3, v117
    s_mov_b64 exec, s[80:81]
    v_mov_b32 v117, 0
    v_mov_b32 v112, 0
    s_mov_b64 exec, vcc
    v_mov_b32 v117, 3

    s_mov_b64 exec, -1
    v_alignbyte_b32 v110, v111, v110, v117
    v_alignbyte_b32 v111, v112, v111, v117
    v_add_u32 v116, v116, v117

    buffer_store_dwordx2 v[110:111], v116, s[24:27], 0 offen
    v_cmp_ne_u32_sdwa s[80:81], v119, v121 src0_sel:WORD_1 src1_sel:WORD_1
    v_cmp_ne_u32_sdwa vcc, v119, v123 src0_sel:WORD_1 src1_sel:WORD_1
    v_alignbyte_b32 v122, v123, v122, 2
    s_mov_b32 s54, 15357
    v_alignbyte_b32 v119, v119, v118, 1
    v_perm_b32 v118, v118, v122, s47
    s_waitcnt lgkmcnt(0)
    v_add3_u32 v124, v124, v106, s54
    v_sub_u32 v125, 0, v124
    v_and_b32 v125, 3, v125
    s_mov_b64 exec, s[80:81]
    v_mov_b32 v125, 0
    v_mov_b32 v120, 0
    s_mov_b64 exec, vcc
    v_mov_b32 v125, 3

    s_mov_b64 exec, -1
    v_alignbyte_b32 v118, v119, v118, v125
    v_alignbyte_b32 v119, v120, v119, v125
    v_add_u32 v124, v124, v125

    buffer_store_dwordx2 v[118:119], v124, s[24:27], 0 offen
L_skw_29:
    s_bitcmp0_b32 s82, 2
    s_cbranch_scc1 L_ska_30
    v_mul_hi_u32_u24 v61, s40, v28
    v_mul_hi_u32_u24 v60, s40, v12
    v_mul_hi_u32_u24 v63, s40, v29
    v_mul_hi_u32_u24 v62, s40, v13
    v_mul_hi_u32_u24 v65, s40, v30
    v_mul_hi_u32_u24 v64, s40, v14
    v_mul_hi_u32_u24 v67, s40, v31
    v_mul_hi_u32_u24 v66, s40, v15
    v_and_b32 v61, -2, v61
    v_mad_u32_u24 v12, v60, s43, v12
    v_and_b32 v84, -4, v60
    v_and_b32 v63, -2, v63
    v_mad_u32_u24 v13, v62, s43, v13
    v_and_b32 v85, -4, v62
    v_and_b32 v65, -2, v65
    v_mad_u32_u24 v14, v64, s43, v14
    v_and_b32 v86, -4, v64
    v_and_b32 v67, -2, v67
    v_mad_u32_u24 v15, v66, s43, v15
    v_and_b32 v87, -4, v66
    v_mad_i32_i24 v28, v61, s42, v28
    v_lshl_add_u32 v61, v84, 5, v61
    v_mad_i32_i24 v29, v63, s42, v29
    v_lshl_add_u32 v63, v85, 5, v63
    v_mad_i32_i24 v30, v65, s42, v30
    v_lshl_add_u32 v65, v86, 5, v65
    v_mad_i32_i24 v31, v67, s42, v31
    v_lshl_add_u32 v67, v87, 5, v67
    v_add_u32 v61, v61, v61
    ds_add_rtn_u32 v84, v61, v104
    v_add_u32 v63, v63, v63
    ds_add_rtn_u32 v85, v63, v104
    v_add_u32 v65, v65, v65
    ds_add_rtn_u32 v86, v65, v104
    v_add_u32 v67, v67, v67
    ds_add_rtn_u32 v87, v67, v104
    v_lshlrev_b32 v110, 16, v40
    v_and_b32 v111, 0xffff0000, v40
    v_lshlrev_b32 v112, 16, v41
    v_and_b32 v113, 0xffff0000, v41
    v_mul_f32 v110, s44, v110
    v_mul_f32 v111, s44, v111
    v_mul_f32 v112, s44, v112
    v_mul_f32 v113, s44, v113
    v_fract_f32 v110, v110
    v_fract_f32 v111, v111
    v_fract_f32 v112, v112
    v_fract_f32 v113, v113
    v_cos_f32 v110, v110
    v_cos_f32 v111, v111
    v_cos_f32 v112, v112
    v_cos_f32 v113, v113
    v_lshl_or_b32 v60, v60, 14, v28
    v_perm_b32 v61, v61, v12, s46
    v_bfe_u32 v12, v12, 8, 5

    v_lshl_or_b32 v62, v62, 14, v29
    v_perm_b32 v63, v63, v13, s46
    v_bfe_u32 v13, v13, 8, 5

    v_lshl_or_b32 v64, v64, 14, v30
    v_perm_b32 v65, v65, v14, s46
    v_bfe_u32 v14, v14, 8, 5

    v_lshl_or_b32 v66, v66, 14, v31
    v_perm_b32 v67, v67, v15, s46
    v_bfe_u32 v15, v15, 8, 5

    v_fmaak_f32 v110, v110, v105, 0x4b400010
    v_fmaak_f32 v111, v111, v105, 0x4b400010
    v_fmaak_f32 v112, v112, v105, 0x4b400010
    v_fmaak_f32 v113, v113, v105, 0x4b400010
    v_sub_u32 v110, v110, v12
    v_sub_u32 v111, v111, v13
    v_sub_u32 v112, v112, v14
    v_sub_u32 v113, v113, v15
    v_bfi_b32 v110, 31, v12, v110
    v_bfi_b32 v111, 31, v13, v111
    v_bfi_b32 v112, 31, v14, v112
    v_bfi_b32 v113, 31, v15, v113
    v_perm_b32 v60, v60, v110, s55
    v_perm_b32 v62, v62, v111, s55
    v_perm_b32 v64, v64, v112, s55
    v_perm_b32 v66, v66, v113, s55
L_ska_30:
    s_bitcmp0_b32 s28, 1
    s_cbranch_scc1 L_skw_31
    v_add_u32 v107, 32768, v2
    ds_read_b64 v[110:111], v107 offset:16400
    ds_read_b64 v[112:113], v107 offset:16408
    ds_read_b64 v[114:115], v107 offset:16392

    ds_read_b64 v[118:119], v107 offset:24592
    ds_read_b64 v[120:121], v107 offset:24600
    ds_read_b64 v[122:123], v107 offset:24584

    s_waitcnt lgkmcnt(3)
    v_lshrrev_b32 v116, 16, v111
    ds_read_b32 v116, v116 offset:8192

    s_waitcnt lgkmcnt(1)
    v_lshrrev_b32 v124, 16, v119
    ds_read_b32 v124, v124 offset:8192

    v_cmp_ne_u32_sdwa s[80:81], v111, v113 src0_sel:WORD_1 src1_sel:WORD_1
    v_cmp_ne_u32_sdwa vcc, v111, v115 src0_sel:WORD_1 src1_sel:WORD_1
    v_alignbyte_b32 v114, v115, v114, 2
    s_mov_b32 s54, 20477
    v_alignbyte_b32 v111, v111, v110, 1
    v_perm_b32 v110, v110, v114, s47
    s_waitcnt lgkmcnt(1)
    v_add3_u32 v116, v116, v106, s54
    v_sub_u32 v117, 0, v116
    v_and_b32 v117, 3, v117
    s_mov_b64 exec, s[80:81]
    v_mov_b32 v117, 0
    v_mov_b32 v112, 0
    s_mov_b64 exec, vcc
    v_mov_b32 v117, 3

    s_mov_b64 exec, -1
    v_alignbyte_b32 v110, v111, v110, v117
    v_alignbyte_b32 v111, v112, v111, v117
    v_add_u32 v116, v116, v117

    buffer_store_dwordx2 v[110:111], v116, s[24:27], 0 offen
    v_cmp_ne_u32_sdwa s[80:81], v119, v121 src0_sel:WORD_1 src1_sel:WORD_1
    v_cmp_ne_u32_sdwa vcc, v119, v123 src0_sel:WORD_1 src1_sel:WORD_1
    v_alignbyte_b32 v122, v123, v122, 2
    s_mov_b32 s54, 25597
    v_alignbyte_b32 v119, v119, v118, 1
    v_perm_b32 v118, v118, v122, s47
    s_waitcnt lgkmcnt(0)
    v_add3_u32 v124, v124, v106, s54
    v_sub_u32 v125, 0, v124
    v_and_b32 v125, 3, v125
    s_mov_b64 exec, s[80:81]
    v_mov_b32 v125, 0
    v_mov_b32 v120, 0
    s_mov_b64 exec, vcc
    v_mov_b32 v125, 3

    s_mov_b64 exec, -1
    v_alignbyte_b32 v118, v119, v118, v125
    v_alignbyte_b32 v119, v120, v119, v125
    v_add_u32 v124, v124, v125

    buffer_store_dwordx2 v[118:119], v124, s[24:27], 0 offen
L_skw_31:
    s_bitcmp0_b32 s28, 1
    s_cbranch_scc1 L_skw_32
    v_add_u32 v107, 32768, v2
    ds_read_b64 v[110:111], v107 offset:32784
    ds_read_b64 v[112:113], v107 offset:32792
    ds_read_b64 v[114:115], v107 offset:32776

    ds_read_b64 v[118:119], v107 offset:40976
    ds_read_b64 v[120:121], v107 offset:40984
    ds_read_b64 v[122:123], v107 offset:40968

    s_waitcnt lgkmcnt(3)
    v_lshrrev_b32 v116, 16, v111
    ds_read_b32 v116, v116 offset:8192

    s_waitcnt lgkmcnt(1)
    v_lshrrev_b32 v124, 16, v119
    ds_read_b32 v124, v124 offset:8192

    v_cmp_ne_u32_sdwa s[80:81], v111, v113 src0_sel:WORD_1 src1_sel:WORD_1
    v_cmp_ne_u32_sdwa vcc, v111, v115 src0_sel:WORD_1 src1_sel:WORD_1
    v_alignbyte_b32 v114, v115, v114, 2
    s_mov_b32 s54, 30717
    v_alignbyte_b32 v111, v111, v110, 1
    v_perm_b32 v110, v110, v114, s47
    s_waitcnt lgkmcnt(1)
    v_add3_u32 v116, v116, v106, s54
    v_sub_u32 v117, 0, v116
    v_and_b32 v117, 3, v117
    s_mov_b64 exec, s[80:81]
    v_mov_b32 v117, 0
    v_mov_b32 v112, 0
    s_mov_b64 exec, vcc
    v_mov_b32 v117, 3

    s_mov_b64 exec, -1
    v_alignbyte_b32 v110, v111, v110, v117
    v_alignbyte_b32 v111, v112, v111, v117
    v_add_u32 v116, v116, v117

    buffer_store_dwordx2 v[110:111], v116, s[24:27], 0 offen
    v_cmp_ne_u32_sdwa s[80:81], v119, v121 src0_sel:WORD_1 src1_sel:WORD_1
    v_cmp_ne_u32_sdwa vcc, v119, v123 src0_sel:WORD_1 src1_sel:WORD_1
    v_alignbyte_b32 v122, v123, v122, 2
    s_mov_b32 s54, 35837
    v_alignbyte_b32 v119, v119, v118, 1
    v_perm_b32 v118, v118, v122, s47
    s_waitcnt lgkmcnt(0)
    v_add3_u32 v124, v124, v106, s54
    v_sub_u32 v125, 0, v124
    v_and_b32 v125, 3, v125
    s_mov_b64 exec, s[80:81]
    v_mov_b32 v125, 0
    v_mov_b32 v120, 0
    s_mov_b64 exec, vcc
    v_mov_b32 v125, 3

    s_mov_b64 exec, -1
    v_alignbyte_b32 v118, v119, v118, v125
    v_alignbyte_b32 v119, v120, v119, v125
    v_add_u32 v124, v124, v125

    buffer_store_dwordx2 v[118:119], v124, s[24:27], 0 offen
L_skw_32:
    s_bitcmp0_b32 s28, 2
    s_cbranch_scc1 L_skw_33
    v_add_u32 v107, 65536, v2
    ds_read_b64 v[110:111], v107 offset:16400
    ds_read_b64 v[112:113], v107 offset:16408
    ds_read_b64 v[114:115], v107 offset:16392

    ds_read_b64 v[118:119], v107 offset:24592
    ds_read_b64 v[120:121], v107 offset:24600
    ds_read_b64 v[122:123], v107 offset:24584

    s_waitcnt lgkmcnt(3)
    v_lshrrev_b32 v116, 16, v111
    ds_read_b32 v116, v116 offset:8192

    s_waitcnt lgkmcnt(1)
    v_lshrrev_b32 v124, 16, v119
    ds_read_b32 v124, v124 offset:8192

    v_cmp_ne_u32_sdwa s[80:81], v111, v113 src0_sel:WORD_1 src1_sel:WORD_1
    v_cmp_ne_u32_sdwa vcc, v111, v115 src0_sel:WORD_1 src1_sel:WORD_1
    v_alignbyte_b32 v114, v115, v114, 2
    s_mov_b32 s54, 40957
    v_alignbyte_b32 v111, v111, v110, 1
    v_perm_b32 v110, v110, v114, s47
    s_waitcnt lgkmcnt(1)
    v_add3_u32 v116, v116, v106, s54
    v_sub_u32 v117, 0, v116
    v_and_b32 v117, 3, v117
    s_mov_b64 exec, s[80:81]
    v_mov_b32 v117, 0
    v_mov_b32 v112, 0
    s_mov_b64 exec, vcc
    v_mov_b32 v117, 3

    s_mov_b64 exec, -1
    v_alignbyte_b32 v110, v111, v110, v117
    v_alignbyte_b32 v111, v112, v111, v117
    v_add_u32 v116, v116, v117

    buffer_store_dwordx2 v[110:111], v116, s[24:27], 0 offen
    v_cmp_ne_u32_sdwa s[80:81], v119, v121 src0_sel:WORD_1 src1_sel:WORD_1
    v_cmp_ne_u32_sdwa vcc, v119, v123 src0_sel:WORD_1 src1_sel:WORD_1
    v_alignbyte_b32 v122, v123, v122, 2
    s_mov_b32 s54, 46077
    v_alignbyte_b32 v119, v119, v118, 1
    v_perm_b32 v118, v118, v122, s47
    s_waitcnt lgkmcnt(0)
    v_add3_u32 v124, v124, v106, s54
    v_sub_u32 v125, 0, v124
    v_and_b32 v125, 3, v125
    s_mov_b64 exec, s[80:81]
    v_mov_b32 v125, 0
    v_mov_b32 v120, 0
    s_mov_b64 exec, vcc
    v_mov_b32 v125, 3

    s_mov_b64 exec, -1
    v_alignbyte_b32 v118, v119, v118, v125
    v_alignbyte_b32 v119, v120, v119, v125
    v_add_u32 v124, v124, v125

    buffer_store_dwordx2 v[118:119], v124, s[24:27], 0 offen
L_skw_33:
    s_bitcmp0_b32 s82, 3
    s_cbranch_scc1 L_ska_34
    s_mov_b64 exec, s[66:67]
    v_mul_hi_u32_u24 v69, s40, v32
    v_mul_hi_u32_u24 v68, s40, v16
    v_mul_hi_u32_u24 v71, s40, v33
    v_mul_hi_u32_u24 v70, s40, v17
    v_mul_hi_u32_u24 v73, s40, v34
    v_mul_hi_u32_u24 v72, s40, v18
    v_mul_hi_u32_u24 v75, s40, v35
    v_mul_hi_u32_u24 v74, s40, v19
    v_and_b32 v69, -2, v69
    v_mad_u32_u24 v16, v68, s43, v16
    v_and_b32 v88, -4, v68
    v_and_b32 v71, -2, v71
    v_mad_u32_u24 v17, v70, s43, v17
    v_and_b32 v89, -4, v70
    v_and_b32 v73, -2, v73
    v_mad_u32_u24 v18, v72, s43, v18
    v_and_b32 v90, -4, v72
    v_and_b32 v75, -2, v75
    v_mad_u32_u24 v19, v74, s43, v19
    v_and_b32 v91, -4, v74
    v_mad_i32_i24 v32, v69, s42, v32
    v_lshl_add_u32 v69, v88, 5, v69
    v_mad_i32_i24 v33, v71, s42, v33
    v_lshl_add_u32 v71, v89, 5, v71
    v_mad_i32_i24 v34, v73, s42, v34
    v_lshl_add_u32 v73, v90, 5, v73
    v_mad_i32_i24 v35, v75, s42, v35
    v_lshl_add_u32 v75, v91, 5, v75
    v_add_u32 v69, v69, v69
    ds_add_rtn_u32 v88, v69, v104
    v_add_u32 v71, v71, v71
    ds_add_rtn_u32 v89, v71, v104
    v_add_u32 v73, v73, v73
    ds_add_rtn_u32 v90, v73, v104
    v_add_u32 v75, v75, v75
    ds_add_rtn_u32 v91, v75, v104
    v_lshlrev_b32 v110, 16, v42
    v_and_b32 v111, 0xffff0000, v42
    v_lshlrev_b32 v112, 16, v43
    v_and_b32 v113, 0xffff0000, v43
    v_mul_f32 v110, s44, v110
    v_mul_f32 v111, s44, v111
    v_mul_f32 v112, s44, v112
    v_mul_f32 v113, s44, v113
    v_fract_f32 v110, v110
    v_fract_f32 v111, v111
    v_fract_f32 v112, v112
    v_fract_f32 v113, v113
    v_cos_f32 v110, v110
    v_cos_f32 v111, v111
    v_cos_f32 v112, v112
    v_cos_f32 v113, v113
    v_lshl_or_b32 v68, v68, 14, v32
    v_perm_b32 v69, v69, v16, s46
    v_bfe_u32 v16, v16, 8, 5

    v_lshl_or_b32 v70, v70, 14, v33
    v_perm_b32 v71, v71, v17, s46
    v_bfe_u32 v17, v17, 8, 5

    v_lshl_or_b32 v72, v72, 14, v34
    v_perm_b32 v73, v73, v18, s46
    v_bfe_u32 v18, v18, 8, 5

    v_lshl_or_b32 v74, v74, 14, v35
    v_perm_b32 v75, v75, v19, s46
    v_bfe_u32 v19, v19, 8, 5

    v_fmaak_f32 v110, v110, v105, 0x4b400010
    v_fmaak_f32 v111, v111, v105, 0x4b400010
    v_fmaak_f32 v112, v112, v105, 0x4b400010
    v_fmaak_f32 v113, v113, v105, 0x4b400010
    v_sub_u32 v110, v110, v16
    v_sub_u32 v111, v111, v17
    v_sub_u32 v112, v112, v18
    v_sub_u32 v113, v113, v19
    v_bfi_b32 v110, 31, v16, v110
    v_bfi_b32 v111, 31, v17, v111
    v_bfi_b32 v112, 31, v18, v112
    v_bfi_b32 v113, 31, v19, v113
    v_perm_b32 v68, v68, v110, s55
    v_perm_b32 v70, v70, v111, s55
    v_perm_b32 v72, v72, v112, s55
    v_perm_b32 v74, v74, v113, s55
    s_mov_b64 exec, -1
L_ska_34:
    s_bitcmp0_b32 s28, 2
    s_cbranch_scc1 L_skw_35
    v_add_u32 v107, 65536, v2
    ds_read_b64 v[110:111], v107 offset:32784
    ds_read_b64 v[112:113], v107 offset:32792
    ds_read_b64 v[114:115], v107 offset:32776

    ds_read_b64 v[118:119], v107 offset:40976
    ds_read_b64 v[120:121], v107 offset:40984
    ds_read_b64 v[122:123], v107 offset:40968

    s_waitcnt lgkmcnt(3)
    v_lshrrev_b32 v116, 16, v111
    ds_read_b32 v116, v116 offset:8192

    s_waitcnt lgkmcnt(1)
    v_lshrrev_b32 v124, 16, v119
    ds_read_b32 v124, v124 offset:8192

    v_cmp_ne_u32_sdwa s[80:81], v111, v113 src0_sel:WORD_1 src1_sel:WORD_1
    v_cmp_ne_u32_sdwa vcc, v111, v115 src0_sel:WORD_1 src1_sel:WORD_1
    v_alignbyte_b32 v114, v115, v114, 2
    s_mov_b32 s54, 51197
    v_alignbyte_b32 v111, v111, v110, 1
    v_perm_b32 v110, v110, v114, s47
    s_waitcnt lgkmcnt(1)
    v_add3_u32 v116, v116, v106, s54
    v_sub_u32 v117, 0, v116
    v_and_b32 v117, 3, v117
    s_mov_b64 exec, s[80:81]
    v_mov_b32 v117, 0
    v_mov_b32 v112, 0
    s_mov_b64 exec, vcc
    v_mov_b32 v117, 3

    s_mov_b64 exec, -1
    v_alignbyte_b32 v110, v111, v110, v117
    v_alignbyte_b32 v111, v112, v111, v117
    v_add_u32 v116, v116, v117

    buffer_store_dwordx2 v[110:111], v116, s[24:27], 0 offen
    v_cmp_ne_u32_sdwa s[80:81], v119, v121 src0_sel:WORD_1 src1_sel:WORD_1
    v_cmp_ne_u32_sdwa vcc, v119, v123 src0_sel:WORD_1 src1_sel:WORD_1
    v_alignbyte_b32 v122, v123, v122, 2
    s_mov_b32 s54, 56317
    v_alignbyte_b32 v119, v119, v118, 1
    v_perm_b32 v118, v118, v122, s47
    s_waitcnt lgkmcnt(0)
    v_add3_u32 v124, v124, v106, s54
    v_sub_u32 v125, 0, v124
    v_and_b32 v125, 3, v125
    s_mov_b64 exec, s[80:81]
    v_mov_b32 v125, 0
    v_mov_b32 v120, 0
    s_mov_b64 exec, vcc
    v_mov_b32 v125, 3

    s_mov_b64 exec, -1
    v_alignbyte_b32 v118, v119, v118, v125
    v_alignbyte_b32 v119, v120, v119, v125
    v_add_u32 v124, v124, v125

    buffer_store_dwordx2 v[118:119], v124, s[24:27], 0 offen
L_skw_35:
    s_bitcmp0_b32 s28, 3
    s_cbranch_scc1 L_skw_36
    v_add_u32 v107, 98304, v2
    ds_read_b64 v[110:111], v107 offset:16400
    ds_read_b64 v[112:113], v107 offset:16408
    ds_read_b64 v[114:115], v107 offset:16392

    ds_read_b64 v[118:119], v107 offset:24592
    ds_read_b64 v[120:121], v107 offset:24600
    ds_read_b64 v[122:123], v107 offset:24584

    s_waitcnt lgkmcnt(3)
    v_lshrrev_b32 v116, 16, v111
    ds_read_b32 v116, v116 offset:8192

    s_waitcnt lgkmcnt(1)
    v_lshrrev_b32 v124, 16, v119
    ds_read_b32 v124, v124 offset:8192

    v_cmp_ne_u32_sdwa s[80:81], v111, v113 src0_sel:WORD_1 src1_sel:WORD_1
    v_cmp_ne_u32_sdwa vcc, v111, v115 src0_sel:WORD_1 src1_sel:WORD_1
    v_alignbyte_b32 v114, v115, v114, 2
    s_mov_b32 s54, 61437
    v_alignbyte_b32 v111, v111, v110, 1
    v_perm_b32 v110, v110, v114, s47
    s_waitcnt lgkmcnt(1)
    v_add3_u32 v116, v116, v106, s54
    v_sub_u32 v117, 0, v116
    v_and_b32 v117, 3, v117
    s_mov_b64 exec, s[80:81]
    v_mov_b32 v117, 0
    v_mov_b32 v112, 0
    s_mov_b64 exec, vcc
    v_mov_b32 v117, 3

    s_mov_b64 exec, -1
    v_alignbyte_b32 v110, v111, v110, v117
    v_alignbyte_b32 v111, v112, v111, v117
    v_add_u32 v116, v116, v117

    buffer_store_dwordx2 v[110:111], v116, s[24:27], 0 offen
    v_cmp_ne_u32_sdwa s[80:81], v119, v121 src0_sel:WORD_1 src1_sel:WORD_1
    v_cmp_ne_u32_sdwa vcc, v119, v123 src0_sel:WORD_1 src1_sel:WORD_1
    v_alignbyte_b32 v122, v123, v122, 2
    s_mov_b32 s54, 66557
    v_alignbyte_b32 v119, v119, v118, 1
    v_perm_b32 v118, v118, v122, s47
    s_waitcnt lgkmcnt(0)
    v_add3_u32 v124, v124, v106, s54
    v_sub_u32 v125, 0, v124
    v_and_b32 v125, 3, v125
    s_mov_b64 exec, s[80:81]
    v_mov_b32 v125, 0
    v_mov_b32 v120, 0
    s_mov_b64 exec, vcc
    v_mov_b32 v125, 3

    s_mov_b64 exec, -1
    v_alignbyte_b32 v118, v119, v118, v125
    v_alignbyte_b32 v119, v120, v119, v125
    v_add_u32 v124, v124, v125

    buffer_store_dwordx2 v[118:119], v124, s[24:27], 0 offen
L_skw_36:
    s_bitcmp0_b32 s28, 3
    s_cbranch_scc1 L_skw_37
    v_add_u32 v107, 98304, v2
    ds_read_b64 v[110:111], v107 offset:32784
    ds_read_b64 v[112:113], v107 offset:32792
    ds_read_b64 v[114:115], v107 offset:32776

    ds_read_b64 v[118:119], v107 offset:40976
    ds_read_b64 v[120:121], v107 offset:40984
    ds_read_b64 v[122:123], v107 offset:40968

    s_waitcnt lgkmcnt(3)
    v_lshrrev_b32 v116, 16, v111
    ds_read_b32 v116, v116 offset:8192

    s_waitcnt lgkmcnt(1)
    v_lshrrev_b32 v124, 16, v119
    ds_read_b32 v124, v124 offset:8192

    v_cmp_ne_u32_sdwa s[80:81], v111, v113 src0_sel:WORD_1 src1_sel:WORD_1
    v_cmp_ne_u32_sdwa vcc, v111, v115 src0_sel:WORD_1 src1_sel:WORD_1
    v_alignbyte_b32 v114, v115, v114, 2
    s_mov_b32 s54, 71677
    v_alignbyte_b32 v111, v111, v110, 1
    v_perm_b32 v110, v110, v114, s47
    s_waitcnt lgkmcnt(1)
    v_add3_u32 v116, v116, v106, s54
    v_sub_u32 v117, 0, v116
    v_and_b32 v117, 3, v117
    s_mov_b64 exec, s[80:81]
    v_mov_b32 v117, 0
    v_mov_b32 v112, 0
    s_mov_b64 exec, vcc
    v_mov_b32 v117, 3

    s_mov_b64 exec, -1
    v_alignbyte_b32 v110, v111, v110, v117
    v_alignbyte_b32 v111, v112, v111, v117
    v_add_u32 v116, v116, v117

    buffer_store_dwordx2 v[110:111], v116, s[24:27], 0 offen
    v_cmp_ne_u32_sdwa s[80:81], v119, v121 src0_sel:WORD_1 src1_sel:WORD_1
    v_cmp_ne_u32_sdwa vcc, v119, v123 src0_sel:WORD_1 src1_sel:WORD_1
    v_alignbyte_b32 v122, v123, v122, 2
    s_mov_b32 s54, 76797
    v_alignbyte_b32 v119, v119, v118, 1
    v_perm_b32 v118, v118, v122, s47
    s_waitcnt lgkmcnt(0)
    v_add3_u32 v124, v124, v106, s54
    v_sub_u32 v125, 0, v124
    v_and_b32 v125, 3, v125
    s_mov_b64 exec, s[80:81]
    v_mov_b32 v125, 0
    v_mov_b32 v120, 0
    s_mov_b64 exec, vcc
    v_mov_b32 v125, 3

    s_andn2_b64 exec, -1, s[68:69]
    v_bfrev_b32 v124, 1
    s_mov_b64 exec, -1
    v_alignbyte_b32 v118, v119, v118, v125
    v_alignbyte_b32 v119, v120, v119, v125
    v_add_u32 v124, v124, v125

    buffer_store_dwordx2 v[118:119], v124, s[24:27], 0 offen
L_skw_37:
    s_waitcnt lgkmcnt(0)
    s_barrier

    buffer_load_dwordx4 v[20:23], v1, s[12:15], s56 offen nt
    buffer_load_dwordx4 v[4:7], v1, s[8:11], s56 offen nt
    buffer_load_dwordx2 v[36:37], v2, s[16:19], s61 offen nt
    buffer_load_dwordx4 v[24:27], v1, s[12:15], s57 offen nt
    buffer_load_dwordx4 v[8:11], v1, s[8:11], s57 offen nt
    buffer_load_dwordx2 v[38:39], v2, s[16:19], s62 offen nt
    ds_read_b64 v[94:95], v2
    s_waitcnt lgkmcnt(0)
    v_and_b32 v94, 0xffff, v94
    v_and_b32 v95, 0xffff, v95
    v_add_u32 v97, v94, v95
    s_nop 1
    v_add_u32_dpp v97, v97, v97 row_shr:1 row_mask:0xf bank_mask:0xf
    s_nop 1
    v_add_u32_dpp v97, v97, v97 row_shr:2 row_mask:0xf bank_mask:0xf
    s_nop 1
    v_add_u32_dpp v97, v97, v97 row_shr:4 row_mask:0xf bank_mask:0xf
    s_nop 1
    v_add_u32_dpp v97, v97, v97 row_shr:8 row_mask:0xf bank_mask:0xf
    s_nop 1
    v_add_u32_dpp v97, v97, v97 row_bcast:15 row_mask:0xa bank_mask:0xf
    s_nop 1
    v_add_u32_dpp v97, v97, v97 row_bcast:31 row_mask:0xc bank_mask:0xf
    s_mov_b32 exec_lo, 0
    s_brev_b32 exec_hi, 1
    ds_add_rtn_u32 v96, v108, v97
    s_mov_b64 exec, -1

    v_add_u32 v92, v94, v94
    v_add_u32 v93, v95, v95
    v_med3_u32 v92, v94, 2, v92
    v_med3_u32 v93, v95, 2, v93
    v_lshl_or_b32 v92, v93, 16, v92
    v_lshlrev_b32 v93, 2, v0
    buffer_atomic_add v92, v93, s[20:23], 0 offen sc0
    s_waitcnt lgkmcnt(0)
    v_readlane_b32 s77, v96, 63
    v_mul_u32_u24 v114, 65528, v0
    v_sub_u32 v97, v97, v95
    s_sub_u32 s50, s50, s83
    s_sub_u32 s77, s77, s50
    v_add_u32 v97, s77, v97
    v_sub_u32 v96, v97, v94
    v_lshlrev_b32 v111, 16, v97
    v_lshlrev_b32 v110, 16, v96
    ds_write_b64 v2, v[110:111]
    v_mad_i32_i24 v96, v96, -5, v114
    v_mad_i32_i24 v97, v97, -5, v114
    v_add_u32 v97, 32764, v97
    s_add_u32 s50, s50, s84
    s_mov_b32 s28, s82
    s_mov_b32 s29, s83
    s_mov_b32 s30, s84
    s_lshl_b32 s74, s29, 3
    s_lshl_b32 s75, s30, 3
    v_mov_b32 v125, s74
    v_mov_b32 v126, s75
    v_mov_b32 v127, -1

    s_waitcnt lgkmcnt(0)
    s_barrier

    s_mov_b64 exec, 1
    ds_write_b32 v125, v127 offset:16396
    ds_write_b32 v126, v127 offset:16404
    s_mov_b64 exec, -1

    s_bitcmp0_b32 s28, 0
    s_cbranch_scc1 L_skz_38
    v_lshrrev_b32 v110, 16, v45
    ds_read_b32 v110, v110
    v_lshrrev_b32 v111, 16, v47
    ds_read_b32 v111, v111
    v_lshrrev_b32 v112, 16, v49
    ds_read_b32 v112, v112
    v_lshrrev_b32 v113, 16, v51
    ds_read_b32 v113, v113
    v_lshrrev_b32 v114, 16, v53
    ds_read_b32 v114, v114
    v_lshrrev_b32 v115, 16, v55
    ds_read_b32 v115, v115
    v_lshrrev_b32 v116, 16, v57
    ds_read_b32 v116, v116
    v_lshrrev_b32 v117, 16, v59
    ds_read_b32 v117, v117
    s_waitcnt lgkmcnt(7)
    v_add_u32_sdwa v110, v110, v76 dst_sel:DWORD dst_unused:UNUSED_PAD src0_sel:WORD_1 src1_sel:WORD_0
    v_lshlrev_b32 v110, 3, v110
    ds_write_b64 v110, v[44:45] offset:16400

    s_waitcnt lgkmcnt(7)
    v_add_u32_sdwa v111, v111, v77 dst_sel:DWORD dst_unused:UNUSED_PAD src0_sel:WORD_1 src1_sel:WORD_0
    v_lshlrev_b32 v111, 3, v111
    ds_write_b64 v111, v[46:47] offset:16400

    s_waitcnt lgkmcnt(7)
    v_add_u32_sdwa v112, v112, v78 dst_sel:DWORD dst_unused:UNUSED_PAD src0_sel:WORD_1 src1_sel:WORD_0
    v_lshlrev_b32 v112, 3, v112
    ds_write_b64 v112, v[48:49] offset:16400

    s_waitcnt lgkmcnt(7)
    v_add_u32_sdwa v113, v113, v79 dst_sel:DWORD dst_unused:UNUSED_PAD src0_sel:WORD_1 src1_sel:WORD_0
    v_lshlrev_b32 v113, 3, v113
    ds_write_b64 v113, v[50:51] offset:16400

    s_waitcnt lgkmcnt(7)
    v_add_u32_sdwa v114, v114, v80 dst_sel:DWORD dst_unused:UNUSED_PAD src0_sel:WORD_1 src1_sel:WORD_0
    v_lshlrev_b32 v114, 3, v114
    ds_write_b64 v114, v[52:53] offset:16400

    s_waitcnt lgkmcnt(7)
    v_add_u32_sdwa v115, v115, v81 dst_sel:DWORD dst_unused:UNUSED_PAD src0_sel:WORD_1 src1_sel:WORD_0
    v_lshlrev_b32 v115, 3, v115
    ds_write_b64 v115, v[54:55] offset:16400

    s_waitcnt lgkmcnt(7)
    v_add_u32_sdwa v116, v116, v82 dst_sel:DWORD dst_unused:UNUSED_PAD src0_sel:WORD_1 src1_sel:WORD_0
    v_lshlrev_b32 v116, 3, v116
    ds_write_b64 v116, v[56:57] offset:16400

    s_waitcnt lgkmcnt(7)
    v_add_u32_sdwa v117, v117, v83 dst_sel:DWORD dst_unused:UNUSED_PAD src0_sel:WORD_1 src1_sel:WORD_0
    v_lshlrev_b32 v117, 3, v117
    ds_write_b64 v117, v[58:59] offset:16400

L_skz_38:
    buffer_load_dwordx4 v[28:31], v1, s[12:15], s58 offen nt
    buffer_load_dwordx4 v[12:15], v1, s[8:11], s58 offen nt
    buffer_load_dwordx2 v[40:41], v2, s[16:19], s63 offen nt
    s_bitcmp0_b32 s28, 2
    s_cbranch_scc1 L_skz_39
    v_lshrrev_b32 v110, 16, v61
    ds_read_b32 v110, v110
    v_lshrrev_b32 v111, 16, v63
    ds_read_b32 v111, v111
    v_lshrrev_b32 v112, 16, v65
    ds_read_b32 v112, v112
    v_lshrrev_b32 v113, 16, v67
    ds_read_b32 v113, v113
    s_waitcnt lgkmcnt(3)
    v_add_u32_sdwa v110, v110, v84 dst_sel:DWORD dst_unused:UNUSED_PAD src0_sel:WORD_1 src1_sel:WORD_0
    v_lshlrev_b32 v110, 3, v110
    ds_write_b64 v110, v[60:61] offset:16400

    s_waitcnt lgkmcnt(3)
    v_add_u32_sdwa v111, v111, v85 dst_sel:DWORD dst_unused:UNUSED_PAD src0_sel:WORD_1 src1_sel:WORD_0
    v_lshlrev_b32 v111, 3, v111
    ds_write_b64 v111, v[62:63] offset:16400

    s_waitcnt lgkmcnt(3)
    v_add_u32_sdwa v112, v112, v86 dst_sel:DWORD dst_unused:UNUSED_PAD src0_sel:WORD_1 src1_sel:WORD_0
    v_lshlrev_b32 v112, 3, v112
    ds_write_b64 v112, v[64:65] offset:16400

    s_waitcnt lgkmcnt(3)
    v_add_u32_sdwa v113, v113, v87 dst_sel:DWORD dst_unused:UNUSED_PAD src0_sel:WORD_1 src1_sel:WORD_0
    v_lshlrev_b32 v113, 3, v113
    ds_write_b64 v113, v[66:67] offset:16400

L_skz_39:
    s_bitcmp0_b32 s28, 3
    s_cbranch_scc1 L_skz_40
    s_mov_b64 exec, s[66:67]
    v_lshrrev_b32 v110, 16, v69
    ds_read_b32 v110, v110
    v_lshrrev_b32 v111, 16, v71
    ds_read_b32 v111, v111
    v_lshrrev_b32 v112, 16, v73
    ds_read_b32 v112, v112
    v_lshrrev_b32 v113, 16, v75
    ds_read_b32 v113, v113
    s_waitcnt lgkmcnt(3)
    v_add_u32_sdwa v110, v110, v88 dst_sel:DWORD dst_unused:UNUSED_PAD src0_sel:WORD_1 src1_sel:WORD_0
    v_lshlrev_b32 v110, 3, v110
    ds_write_b64 v110, v[68:69] offset:16400

    s_waitcnt lgkmcnt(3)
    v_add_u32_sdwa v111, v111, v89 dst_sel:DWORD dst_unused:UNUSED_PAD src0_sel:WORD_1 src1_sel:WORD_0
    v_lshlrev_b32 v111, 3, v111
    ds_write_b64 v111, v[70:71] offset:16400

    s_waitcnt lgkmcnt(3)
    v_add_u32_sdwa v112, v112, v90 dst_sel:DWORD dst_unused:UNUSED_PAD src0_sel:WORD_1 src1_sel:WORD_0
    v_lshlrev_b32 v112, 3, v112
    ds_write_b64 v112, v[72:73] offset:16400

    s_waitcnt lgkmcnt(3)
    v_add_u32_sdwa v113, v113, v91 dst_sel:DWORD dst_unused:UNUSED_PAD src0_sel:WORD_1 src1_sel:WORD_0
    v_lshlrev_b32 v113, 3, v113
    ds_write_b64 v113, v[74:75] offset:16400

    s_mov_b64 exec, -1
L_skz_40:
    buffer_load_dwordx4 v[32:35], v1, s[12:15], s59 offen nt
    buffer_load_dwordx4 v[16:19], v1, s[8:11], s59 offen nt
    buffer_load_dwordx2 v[42:43], v2, s[16:19], s64 offen nt
    s_cmp_lg_u32 s49, 0
    s_cbranch_scc1 L_p1loop_6
L_p1epi_7:
    s_waitcnt vmcnt(0)
    s_waitcnt vmcnt(0)
    v_lshrrev_b32 v93, 16, v92
    v_and_b32 v92, 0xffff, v92
    v_add_u32 v110, v92, v94
    v_mad_u32_u24 v92, v92, 5, v96
    v_add_u32 v111, v93, v95
    v_mad_u32_u24 v93, v93, 5, v97
    v_max_u32 v110, v110, v111
    v_cmp_le_u32 vcc, s48, v110
    s_cbranch_vccnz L_full_41
L_fback_42:
    ds_write_b64 v2, v[92:93] offset:8192

    s_waitcnt lgkmcnt(0)
    s_barrier

    s_bitcmp0_b32 s28, 0
    s_cbranch_scc1 L_skw_43
    ds_read_b64 v[4:5], v2 offset:16400
    ds_read_b64 v[6:7], v2 offset:16408
    ds_read_b64 v[8:9], v2 offset:16392

    ds_read_b64 v[12:13], v2 offset:24592
    ds_read_b64 v[14:15], v2 offset:24600
    ds_read_b64 v[16:17], v2 offset:24584

    ds_read_b64 v[20:21], v2 offset:32784
    ds_read_b64 v[22:23], v2 offset:32792
    ds_read_b64 v[24:25], v2 offset:32776

    ds_read_b64 v[28:29], v2 offset:40976
    ds_read_b64 v[30:31], v2 offset:40984
    ds_read_b64 v[32:33], v2 offset:40968

    s_waitcnt lgkmcnt(9)
    v_lshrrev_b32 v10, 16, v5
    ds_read_b32 v10, v10 offset:8192

    s_waitcnt lgkmcnt(7)
    v_lshrrev_b32 v18, 16, v13
    ds_read_b32 v18, v18 offset:8192

    s_waitcnt lgkmcnt(5)
    v_lshrrev_b32 v26, 16, v21
    ds_read_b32 v26, v26 offset:8192

    s_waitcnt lgkmcnt(3)
    v_lshrrev_b32 v34, 16, v29
    ds_read_b32 v34, v34 offset:8192

    v_cmp_ne_u32_sdwa s[80:81], v5, v7 src0_sel:WORD_1 src1_sel:WORD_1
    v_cmp_ne_u32_sdwa vcc, v5, v9 src0_sel:WORD_1 src1_sel:WORD_1
    v_alignbyte_b32 v8, v9, v8, 2
    s_mov_b32 s54, -3
    v_alignbyte_b32 v5, v5, v4, 1
    v_perm_b32 v4, v4, v8, s47
    s_waitcnt lgkmcnt(3)
    v_add3_u32 v10, v10, v106, s54
    v_sub_u32 v11, 0, v10
    v_and_b32 v11, 3, v11
    s_mov_b64 exec, s[80:81]
    v_mov_b32 v11, 0
    v_mov_b32 v6, 0
    s_mov_b64 exec, vcc
    v_mov_b32 v11, 3

    s_mov_b64 exec, -1
    v_alignbyte_b32 v4, v5, v4, v11
    v_alignbyte_b32 v5, v6, v5, v11
    v_add_u32 v10, v10, v11

    buffer_store_dwordx2 v[4:5], v10, s[24:27], 0 offen
    v_cmp_ne_u32_sdwa s[80:81], v13, v15 src0_sel:WORD_1 src1_sel:WORD_1
    v_cmp_ne_u32_sdwa vcc, v13, v17 src0_sel:WORD_1 src1_sel:WORD_1
    v_alignbyte_b32 v16, v17, v16, 2
    s_mov_b32 s54, 5117
    v_alignbyte_b32 v13, v13, v12, 1
    v_perm_b32 v12, v12, v16, s47
    s_waitcnt lgkmcnt(2)
    v_add3_u32 v18, v18, v106, s54
    v_sub_u32 v19, 0, v18
    v_and_b32 v19, 3, v19
    s_mov_b64 exec, s[80:81]
    v_mov_b32 v19, 0
    v_mov_b32 v14, 0
    s_mov_b64 exec, vcc
    v_mov_b32 v19, 3

    s_mov_b64 exec, -1
    v_alignbyte_b32 v12, v13, v12, v19
    v_alignbyte_b32 v13, v14, v13, v19
    v_add_u32 v18, v18, v19

    buffer_store_dwordx2 v[12:13], v18, s[24:27], 0 offen
    v_cmp_ne_u32_sdwa s[80:81], v21, v23 src0_sel:WORD_1 src1_sel:WORD_1
    v_cmp_ne_u32_sdwa vcc, v21, v25 src0_sel:WORD_1 src1_sel:WORD_1
    v_alignbyte_b32 v24, v25, v24, 2
    s_mov_b32 s54, 10237
    v_alignbyte_b32 v21, v21, v20, 1
    v_perm_b32 v20, v20, v24, s47
    s_waitcnt lgkmcnt(1)
    v_add3_u32 v26, v26, v106, s54
    v_sub_u32 v27, 0, v26
    v_and_b32 v27, 3, v27
    s_mov_b64 exec, s[80:81]
    v_mov_b32 v27, 0
    v_mov_b32 v22, 0
    s_mov_b64 exec, vcc
    v_mov_b32 v27, 3

    s_mov_b64 exec, -1
    v_alignbyte_b32 v20, v21, v20, v27
    v_alignbyte_b32 v21, v22, v21, v27
    v_add_u32 v26, v26, v27

    buffer_store_dwordx2 v[20:21], v26, s[24:27], 0 offen
    v_cmp_ne_u32_sdwa s[80:81], v29, v31 src0_sel:WORD_1 src1_sel:WORD_1
    v_cmp_ne_u32_sdwa vcc, v29, v33 src0_sel:WORD_1 src1_sel:WORD_1
    v_alignbyte_b32 v32, v33, v32, 2
    s_mov_b32 s54, 15357
    v_alignbyte_b32 v29, v29, v28, 1
    v_perm_b32 v28, v28, v32, s47
    s_waitcnt lgkmcnt(0)
    v_add3_u32 v34, v34, v106, s54
    v_sub_u32 v35, 0, v34
    v_and_b32 v35, 3, v35
    s_mov_b64 exec, s[80:81]
    v_mov_b32 v35, 0
    v_mov_b32 v30, 0
    s_mov_b64 exec, vcc
    v_mov_b32 v35, 3

    s_mov_b64 exec, -1
    v_alignbyte_b32 v28, v29, v28, v35
    v_alignbyte_b32 v29, v30, v29, v35
    v_add_u32 v34, v34, v35

    buffer_store_dwordx2 v[28:29], v34, s[24:27], 0 offen
L_skw_43:
    s_bitcmp0_b32 s28, 1
    s_cbranch_scc1 L_skw_44
    v_add_u32 v107, 32768, v2
    ds_read_b64 v[4:5], v107 offset:16400
    ds_read_b64 v[6:7], v107 offset:16408
    ds_read_b64 v[8:9], v107 offset:16392

    ds_read_b64 v[12:13], v107 offset:24592
    ds_read_b64 v[14:15], v107 offset:24600
    ds_read_b64 v[16:17], v107 offset:24584

    ds_read_b64 v[20:21], v107 offset:32784
    ds_read_b64 v[22:23], v107 offset:32792
    ds_read_b64 v[24:25], v107 offset:32776

    ds_read_b64 v[28:29], v107 offset:40976
    ds_read_b64 v[30:31], v107 offset:40984
    ds_read_b64 v[32:33], v107 offset:40968

    s_waitcnt lgkmcnt(9)
    v_lshrrev_b32 v10, 16, v5
    ds_read_b32 v10, v10 offset:8192

    s_waitcnt lgkmcnt(7)
    v_lshrrev_b32 v18, 16, v13
    ds_read_b32 v18, v18 offset:8192

    s_waitcnt lgkmcnt(5)
    v_lshrrev_b32 v26, 16, v21
    ds_read_b32 v26, v26 offset:8192

    s_waitcnt lgkmcnt(3)
    v_lshrrev_b32 v34, 16, v29
    ds_read_b32 v34, v34 offset:8192

    v_cmp_ne_u32_sdwa s[80:81], v5, v7 src0_sel:WORD_1 src1_sel:WORD_1
    v_cmp_ne_u32_sdwa vcc, v5, v9 src0_sel:WORD_1 src1_sel:WORD_1
    v_alignbyte_b32 v8, v9, v8, 2
    s_mov_b32 s54, 20477
    v_alignbyte_b32 v5, v5, v4, 1
    v_perm_b32 v4, v4, v8, s47
    s_waitcnt lgkmcnt(3)
    v_add3_u32 v10, v10, v106, s54
    v_sub_u32 v11, 0, v10
    v_and_b32 v11, 3, v11
    s_mov_b64 exec, s[80:81]
    v_mov_b32 v11, 0
    v_mov_b32 v6, 0
    s_mov_b64 exec, vcc
    v_mov_b32 v11, 3

    s_mov_b64 exec, -1
    v_alignbyte_b32 v4, v5, v4, v11
    v_alignbyte_b32 v5, v6, v5, v11
    v_add_u32 v10, v10, v11

    buffer_store_dwordx2 v[4:5], v10, s[24:27], 0 offen
    v_cmp_ne_u32_sdwa s[80:81], v13, v15 src0_sel:WORD_1 src1_sel:WORD_1
    v_cmp_ne_u32_sdwa vcc, v13, v17 src0_sel:WORD_1 src1_sel:WORD_1
    v_alignbyte_b32 v16, v17, v16, 2
    s_mov_b32 s54, 25597
    v_alignbyte_b32 v13, v13, v12, 1
    v_perm_b32 v12, v12, v16, s47
    s_waitcnt lgkmcnt(2)
    v_add3_u32 v18, v18, v106, s54
    v_sub_u32 v19, 0, v18
    v_and_b32 v19, 3, v19
    s_mov_b64 exec, s[80:81]
    v_mov_b32 v19, 0
    v_mov_b32 v14, 0
    s_mov_b64 exec, vcc
    v_mov_b32 v19, 3

    s_mov_b64 exec, -1
    v_alignbyte_b32 v12, v13, v12, v19
    v_alignbyte_b32 v13, v14, v13, v19
    v_add_u32 v18, v18, v19

    buffer_store_dwordx2 v[12:13], v18, s[24:27], 0 offen
    v_cmp_ne_u32_sdwa s[80:81], v21, v23 src0_sel:WORD_1 src1_sel:WORD_1
    v_cmp_ne_u32_sdwa vcc, v21, v25 src0_sel:WORD_1 src1_sel:WORD_1
    v_alignbyte_b32 v24, v25, v24, 2
    s_mov_b32 s54, 30717
    v_alignbyte_b32 v21, v21, v20, 1
    v_perm_b32 v20, v20, v24, s47
    s_waitcnt lgkmcnt(1)
    v_add3_u32 v26, v26, v106, s54
    v_sub_u32 v27, 0, v26
    v_and_b32 v27, 3, v27
    s_mov_b64 exec, s[80:81]
    v_mov_b32 v27, 0
    v_mov_b32 v22, 0
    s_mov_b64 exec, vcc
    v_mov_b32 v27, 3

    s_mov_b64 exec, -1
    v_alignbyte_b32 v20, v21, v20, v27
    v_alignbyte_b32 v21, v22, v21, v27
    v_add_u32 v26, v26, v27

    buffer_store_dwordx2 v[20:21], v26, s[24:27], 0 offen
    v_cmp_ne_u32_sdwa s[80:81], v29, v31 src0_sel:WORD_1 src1_sel:WORD_1
    v_cmp_ne_u32_sdwa vcc, v29, v33 src0_sel:WORD_1 src1_sel:WORD_1
    v_alignbyte_b32 v32, v33, v32, 2
    s_mov_b32 s54, 35837
    v_alignbyte_b32 v29, v29, v28, 1
    v_perm_b32 v28, v28, v32, s47
    s_waitcnt lgkmcnt(0)
    v_add3_u32 v34, v34, v106, s54
    v_sub_u32 v35, 0, v34
    v_and_b32 v35, 3, v35
    s_mov_b64 exec, s[80:81]
    v_mov_b32 v35, 0
    v_mov_b32 v30, 0
    s_mov_b64 exec, vcc
    v_mov_b32 v35, 3

    s_mov_b64 exec, -1
    v_alignbyte_b32 v28, v29, v28, v35
    v_alignbyte_b32 v29, v30, v29, v35
    v_add_u32 v34, v34, v35

    buffer_store_dwordx2 v[28:29], v34, s[24:27], 0 offen
L_skw_44:
    s_bitcmp0_b32 s28, 2
    s_cbranch_scc1 L_skw_45
    v_add_u32 v107, 65536, v2
    ds_read_b64 v[4:5], v107 offset:16400
    ds_read_b64 v[6:7], v107 offset:16408
    ds_read_b64 v[8:9], v107 offset:16392

    ds_read_b64 v[12:13], v107 offset:24592
    ds_read_b64 v[14:15], v107 offset:24600
    ds_read_b64 v[16:17], v107 offset:24584

    ds_read_b64 v[20:21], v107 offset:32784
    ds_read_b64 v[22:23], v107 offset:32792
    ds_read_b64 v[24:25], v107 offset:32776

    ds_read_b64 v[28:29], v107 offset:40976
    ds_read_b64 v[30:31], v107 offset:40984
    ds_read_b64 v[32:33], v107 offset:40968

    s_waitcnt lgkmcnt(9)
    v_lshrrev_b32 v10, 16, v5
    ds_read_b32 v10, v10 offset:8192

    s_waitcnt lgkmcnt(7)
    v_lshrrev_b32 v18, 16, v13
    ds_read_b32 v18, v18 offset:8192

    s_waitcnt lgkmcnt(5)
    v_lshrrev_b32 v26, 16, v21
    ds_read_b32 v26, v26 offset:8192

    s_waitcnt lgkmcnt(3)
    v_lshrrev_b32 v34, 16, v29
    ds_read_b32 v34, v34 offset:8192

    v_cmp_ne_u32_sdwa s[80:81], v5, v7 src0_sel:WORD_1 src1_sel:WORD_1
    v_cmp_ne_u32_sdwa vcc, v5, v9 src0_sel:WORD_1 src1_sel:WORD_1
    v_alignbyte_b32 v8, v9, v8, 2
    s_mov_b32 s54, 40957
    v_alignbyte_b32 v5, v5, v4, 1
    v_perm_b32 v4, v4, v8, s47
    s_waitcnt lgkmcnt(3)
    v_add3_u32 v10, v10, v106, s54
    v_sub_u32 v11, 0, v10
    v_and_b32 v11, 3, v11
    s_mov_b64 exec, s[80:81]
    v_mov_b32 v11, 0
    v_mov_b32 v6, 0
    s_mov_b64 exec, vcc
    v_mov_b32 v11, 3

    s_mov_b64 exec, -1
    v_alignbyte_b32 v4, v5, v4, v11
    v_alignbyte_b32 v5, v6, v5, v11
    v_add_u32 v10, v10, v11

    buffer_store_dwordx2 v[4:5], v10, s[24:27], 0 offen
    v_cmp_ne_u32_sdwa s[80:81], v13, v15 src0_sel:WORD_1 src1_sel:WORD_1
    v_cmp_ne_u32_sdwa vcc, v13, v17 src0_sel:WORD_1 src1_sel:WORD_1
    v_alignbyte_b32 v16, v17, v16, 2
    s_mov_b32 s54, 46077
    v_alignbyte_b32 v13, v13, v12, 1
    v_perm_b32 v12, v12, v16, s47
    s_waitcnt lgkmcnt(2)
    v_add3_u32 v18, v18, v106, s54
    v_sub_u32 v19, 0, v18
    v_and_b32 v19, 3, v19
    s_mov_b64 exec, s[80:81]
    v_mov_b32 v19, 0
    v_mov_b32 v14, 0
    s_mov_b64 exec, vcc
    v_mov_b32 v19, 3

    s_mov_b64 exec, -1
    v_alignbyte_b32 v12, v13, v12, v19
    v_alignbyte_b32 v13, v14, v13, v19
    v_add_u32 v18, v18, v19

    buffer_store_dwordx2 v[12:13], v18, s[24:27], 0 offen
    v_cmp_ne_u32_sdwa s[80:81], v21, v23 src0_sel:WORD_1 src1_sel:WORD_1
    v_cmp_ne_u32_sdwa vcc, v21, v25 src0_sel:WORD_1 src1_sel:WORD_1
    v_alignbyte_b32 v24, v25, v24, 2
    s_mov_b32 s54, 51197
    v_alignbyte_b32 v21, v21, v20, 1
    v_perm_b32 v20, v20, v24, s47
    s_waitcnt lgkmcnt(1)
    v_add3_u32 v26, v26, v106, s54
    v_sub_u32 v27, 0, v26
    v_and_b32 v27, 3, v27
    s_mov_b64 exec, s[80:81]
    v_mov_b32 v27, 0
    v_mov_b32 v22, 0
    s_mov_b64 exec, vcc
    v_mov_b32 v27, 3

    s_mov_b64 exec, -1
    v_alignbyte_b32 v20, v21, v20, v27
    v_alignbyte_b32 v21, v22, v21, v27
    v_add_u32 v26, v26, v27

    buffer_store_dwordx2 v[20:21], v26, s[24:27], 0 offen
    v_cmp_ne_u32_sdwa s[80:81], v29, v31 src0_sel:WORD_1 src1_sel:WORD_1
    v_cmp_ne_u32_sdwa vcc, v29, v33 src0_sel:WORD_1 src1_sel:WORD_1
    v_alignbyte_b32 v32, v33, v32, 2
    s_mov_b32 s54, 56317
    v_alignbyte_b32 v29, v29, v28, 1
    v_perm_b32 v28, v28, v32, s47
    s_waitcnt lgkmcnt(0)
    v_add3_u32 v34, v34, v106, s54
    v_sub_u32 v35, 0, v34
    v_and_b32 v35, 3, v35
    s_mov_b64 exec, s[80:81]
    v_mov_b32 v35, 0
    v_mov_b32 v30, 0
    s_mov_b64 exec, vcc
    v_mov_b32 v35, 3

    s_mov_b64 exec, -1
    v_alignbyte_b32 v28, v29, v28, v35
    v_alignbyte_b32 v29, v30, v29, v35
    v_add_u32 v34, v34, v35

    buffer_store_dwordx2 v[28:29], v34, s[24:27], 0 offen
L_skw_45:
    s_bitcmp0_b32 s28, 3
    s_cbranch_scc1 L_skw_46
    v_add_u32 v107, 98304, v2
    ds_read_b64 v[4:5], v107 offset:16400
    ds_read_b64 v[6:7], v107 offset:16408
    ds_read_b64 v[8:9], v107 offset:16392

    ds_read_b64 v[12:13], v107 offset:24592
    ds_read_b64 v[14:15], v107 offset:24600
    ds_read_b64 v[16:17], v107 offset:24584

    ds_read_b64 v[20:21], v107 offset:32784
    ds_read_b64 v[22:23], v107 offset:32792
    ds_read_b64 v[24:25], v107 offset:32776

    ds_read_b64 v[28:29], v107 offset:40976
    ds_read_b64 v[30:31], v107 offset:40984
    ds_read_b64 v[32:33], v107 offset:40968

    s_waitcnt lgkmcnt(9)
    v_lshrrev_b32 v10, 16, v5
    ds_read_b32 v10, v10 offset:8192

    s_waitcnt lgkmcnt(7)
    v_lshrrev_b32 v18, 16, v13
    ds_read_b32 v18, v18 offset:8192

    s_waitcnt lgkmcnt(5)
    v_lshrrev_b32 v26, 16, v21
    ds_read_b32 v26, v26 offset:8192

    s_waitcnt lgkmcnt(3)
    v_lshrrev_b32 v34, 16, v29
    ds_read_b32 v34, v34 offset:8192

    v_cmp_ne_u32_sdwa s[80:81], v5, v7 src0_sel:WORD_1 src1_sel:WORD_1
    v_cmp_ne_u32_sdwa vcc, v5, v9 src0_sel:WORD_1 src1_sel:WORD_1
    v_alignbyte_b32 v8, v9, v8, 2
    s_mov_b32 s54, 61437
    v_alignbyte_b32 v5, v5, v4, 1
    v_perm_b32 v4, v4, v8, s47
    s_waitcnt lgkmcnt(3)
    v_add3_u32 v10, v10, v106, s54
    v_sub_u32 v11, 0, v10
    v_and_b32 v11, 3, v11
    s_mov_b64 exec, s[80:81]
    v_mov_b32 v11, 0
    v_mov_b32 v6, 0
    s_mov_b64 exec, vcc
    v_mov_b32 v11, 3

    s_mov_b64 exec, -1
    v_alignbyte_b32 v4, v5, v4, v11
    v_alignbyte_b32 v5, v6, v5, v11
    v_add_u32 v10, v10, v11

    buffer_store_dwordx2 v[4:5], v10, s[24:27], 0 offen
    v_cmp_ne_u32_sdwa s[80:81], v13, v15 src0_sel:WORD_1 src1_sel:WORD_1
    v_cmp_ne_u32_sdwa vcc, v13, v17 src0_sel:WORD_1 src1_sel:WORD_1
    v_alignbyte_b32 v16, v17, v16, 2
    s_mov_b32 s54, 66557
    v_alignbyte_b32 v13, v13, v12, 1
    v_perm_b32 v12, v12, v16, s47
    s_waitcnt lgkmcnt(2)
    v_add3_u32 v18, v18, v106, s54
    v_sub_u32 v19, 0, v18
    v_and_b32 v19, 3, v19
    s_mov_b64 exec, s[80:81]
    v_mov_b32 v19, 0
    v_mov_b32 v14, 0
    s_mov_b64 exec, vcc
    v_mov_b32 v19, 3

    s_mov_b64 exec, -1
    v_alignbyte_b32 v12, v13, v12, v19
    v_alignbyte_b32 v13, v14, v13, v19
    v_add_u32 v18, v18, v19

    buffer_store_dwordx2 v[12:13], v18, s[24:27], 0 offen
    v_cmp_ne_u32_sdwa s[80:81], v21, v23 src0_sel:WORD_1 src1_sel:WORD_1
    v_cmp_ne_u32_sdwa vcc, v21, v25 src0_sel:WORD_1 src1_sel:WORD_1
    v_alignbyte_b32 v24, v25, v24, 2
    s_mov_b32 s54, 71677
    v_alignbyte_b32 v21, v21, v20, 1
    v_perm_b32 v20, v20, v24, s47
    s_waitcnt lgkmcnt(1)
    v_add3_u32 v26, v26, v106, s54
    v_sub_u32 v27, 0, v26
    v_and_b32 v27, 3, v27
    s_mov_b64 exec, s[80:81]
    v_mov_b32 v27, 0
    v_mov_b32 v22, 0
    s_mov_b64 exec, vcc
    v_mov_b32 v27, 3

    s_mov_b64 exec, -1
    v_alignbyte_b32 v20, v21, v20, v27
    v_alignbyte_b32 v21, v22, v21, v27
    v_add_u32 v26, v26, v27

    buffer_store_dwordx2 v[20:21], v26, s[24:27], 0 offen
    v_cmp_ne_u32_sdwa s[80:81], v29, v31 src0_sel:WORD_1 src1_sel:WORD_1
    v_cmp_ne_u32_sdwa vcc, v29, v33 src0_sel:WORD_1 src1_sel:WORD_1
    v_alignbyte_b32 v32, v33, v32, 2
    s_mov_b32 s54, 76797
    v_alignbyte_b32 v29, v29, v28, 1
    v_perm_b32 v28, v28, v32, s47
    s_waitcnt lgkmcnt(0)
    v_add3_u32 v34, v34, v106, s54
    v_sub_u32 v35, 0, v34
    v_and_b32 v35, 3, v35
    s_mov_b64 exec, s[80:81]
    v_mov_b32 v35, 0
    v_mov_b32 v30, 0
    s_mov_b64 exec, vcc
    v_mov_b32 v35, 3

    s_andn2_b64 exec, -1, s[68:69]
    v_bfrev_b32 v34, 1
    s_mov_b64 exec, -1
    v_alignbyte_b32 v28, v29, v28, v35
    v_alignbyte_b32 v29, v30, v29, v35
    v_add_u32 v34, v34, v35

    buffer_store_dwordx2 v[28:29], v34, s[24:27], 0 offen
L_skw_46:
L_p1done_1:
    s_endpgm

L_ska_8:
    v_bfrev_b32 v126, 1
    buffer_load_dword v3, v126, s[96:99], 0 offen
    buffer_load_dword v3, v126, s[96:99], 0 offen
    buffer_load_dword v3, v126, s[96:99], 0 offen
    s_branch L_bka_9
L_ska_10:
    v_bfrev_b32 v126, 1
    buffer_load_dword v3, v126, s[96:99], 0 offen
    buffer_load_dword v3, v126, s[96:99], 0 offen
    buffer_load_dword v3, v126, s[96:99], 0 offen
    s_branch L_bka_11
L_ska_12:
    v_bfrev_b32 v126, 1
    buffer_load_dword v3, v126, s[96:99], 0 offen
    buffer_load_dword v3, v126, s[96:99], 0 offen
    buffer_load_dword v3, v126, s[96:99], 0 offen
    s_branch L_bka_13
L_ska_14:
    v_bfrev_b32 v126, 1
    buffer_load_dword v3, v126, s[96:99], 0 offen
    buffer_load_dword v3, v126, s[96:99], 0 offen
    buffer_load_dword v3, v126, s[96:99], 0 offen
    s_branch L_bka_15
L_full_26:
    v_mov_b32 v110, 0
    s_mov_b64 exec, vcc
    v_bfrev_b32 v92, 1
    v_bfrev_b32 v93, 1
    s_mov_b64 exec, 1
    buffer_atomic_or v104, v110, s[36:39], 0 offen
    s_mov_b64 exec, -1
    s_branch L_fback_27

L_full_41:
    v_mov_b32 v110, 0
    s_mov_b64 exec, vcc
    v_bfrev_b32 v92, 1
    v_bfrev_b32 v93, 1
    s_mov_b64 exec, 1
    buffer_atomic_or v104, v110, s[36:39], 0 offen
    s_mov_b64 exec, -1
    s_branch L_fback_42

.globl standalone__molecular_angular_gemnet__graph_kernel
.p2align 8
.type standalone__molecular_angular_gemnet__graph_kernel,@function
standalone__molecular_angular_gemnet__graph_kernel:
    s_cmp_ge_u32 s2, 256
    s_cbranch_scc1 L_p2done_47
    s_load_dwordx2 s[8:9], s[0:1], 0
    s_load_dwordx2 s[6:7], s[0:1], 104
    v_lshrrev_b32 v4, 6, v0
    s_lshr_b32 s37, s2, 1
    s_and_b32 s37, s37, 3
    s_lshr_b32 s36, s2, 3
    s_lshl_b32 s36, s36, 1
    s_and_b32 s3, s2, 1
    s_or_b32 s36, s36, s3
    v_readfirstlane_b32 s4, v4
    v_and_b32 v2, 63, v0
    v_lshrrev_b32 v3, 9, v0
    v_lshl_or_b32 v2, v3, 6, v2
    v_mul_u32_u24 v2, 20, v2
    v_lshlrev_b32 v3, 4, v0

    s_waitcnt lgkmcnt(0)
    s_lshl_b32 m0, s4, 10
    s_and_b32 s5, s4, 7
    s_lshr_b32 s39, s4, 3
    s_lshl_b32 s39, s39, 8
    s_mul_i32 s3, s5, 4096
    s_add_u32 s46, s6, s3
    s_addc_u32 s47, s7, 0
    s_mul_i32 s3, s5, 67117056
    s_add_u32 s3, s3, 85721088
    s_add_u32 s44, s6, s3
    s_addc_u32 s45, s7, 0
    s_mul_i32 s38, s37, 8
    s_add_u32 s4, s38, 8
    s_lshl_b32 s3, s38, 6
    s_add_u32 s3, s3, s36
    s_lshr_b32 s3, s3, 1
    s_lshl_b32 s3, s3, 2
    s_add_u32 s52, s46, s3
    s_addc_u32 s53, s47, 0

    s_load_dword s88, s[52:53], 0
    s_load_dword s89, s[52:53], 128
    s_load_dword s90, s[52:53], 256
    s_load_dword s91, s[52:53], 384
    s_load_dword s92, s[52:53], 512
    s_load_dword s93, s[52:53], 640
    s_load_dword s94, s[52:53], 768
    s_load_dword s95, s[52:53], 896
    s_mov_b32 s3, 32768
    s_load_dword s51, s[6:7], s3
    s_mov_b32 s10, 6400000
    s_mov_b32 s11, 0x20000

    s_add_u32 s12, s6, 2490368
    s_addc_u32 s13, s7, 0
    s_mov_b32 s14, 0
    s_mov_b32 s15, 0x20000
    s_add_u32 s60, s6, 2490368
    s_addc_u32 s61, s7, 0
    s_mov_b32 s62, 6406144
    s_mov_b32 s63, 0x20000
    s_mov_b32 s3, 135176
    s_load_dword s33, s[6:7], s3

    s_mul_i32 s43, s38, 200192
    s_mul_i32 s41, s4, 200192
    s_mul_i32 s50, s38, 200000
    s_add_u32 s14, s43, 50000

    buffer_load_dwordx4 v[76:79], v3, s[12:15], s43 offen
    s_add_u32 s52, s43, 16384
    buffer_load_dwordx4 v[80:83], v3, s[12:15], s52 offen
    s_add_u32 s52, s43, 32768
    buffer_load_dwordx4 v[84:87], v3, s[12:15], s52 offen
    s_add_u32 s52, s43, 49152
    v_lshlrev_b32 v119, 2, v0
    buffer_load_dword v88, v119, s[12:15], s52 offen
    s_add_u32 s20, s6, 135168
    s_addc_u32 s21, s7, 0
    s_mov_b32 s22, 4096
    s_mov_b32 s23, 0x20000
    v_and_b32 v44, 63, v0
    v_lshlrev_b32 v44, 4, v44
    buffer_load_dwordx2 v[120:121], v44, s[20:23], 0 offen offset:0
    buffer_load_dwordx2 v[122:123], v44, s[20:23], 0 offen offset:1024
    buffer_load_dwordx2 v[124:125], v44, s[20:23], 0 offen offset:2048
    buffer_load_dwordx2 v[126:127], v44, s[20:23], 0 offen offset:3072
    s_movk_i32 s40, 3072
    s_mov_b32 s19, 0x20000
    s_min_u32 s40, s40, 6552
    s_lshl_b32 s52, s38, 6
    s_add_u32 s52, s52, s36
    s_mul_i32 s52, s52, 32764
    s_add_u32 s16, s44, s52
    s_addc_u32 s17, s45, 0
    s_mul_i32 s52, s40, 5
    s_add_u32 s52, s52, 3
    s_and_b32 s18, s52, -4

    s_movk_i32 s53, 5120
    buffer_load_dwordx4 v[90:93], v2, s[16:19], s53 offen
    buffer_load_dword v110, v2, s[16:19], s53 offen offset:16
    s_movk_i32 s53, 7680
    buffer_load_dwordx4 v[94:97], v2, s[16:19], s53 offen
    buffer_load_dword v111, v2, s[16:19], s53 offen offset:16
    s_movk_i32 s53, 10240
    buffer_load_dwordx4 v[98:101], v2, s[16:19], s53 offen
    buffer_load_dword v112, v2, s[16:19], s53 offen offset:16
    s_lshr_b32 s3, s2, 3
    s_mul_i32 s3, s3, 49
    v_add_lshl_u32 v89, v0, s3, 7
    v_cmp_gt_u32 vcc, 49, v0
    v_bfrev_b32 v28, 1
    s_nop 0
    v_cndmask_b32 v89, v28, v89, vcc

    s_mov_b32 s19, 0x20000
    s_mov_b32 s28, 0x4b404000
    s_mov_b32 s29, 0x4b404000
    s_mov_b32 s30, 0xbfffc000
    s_mov_b32 s31, 0xbfffbfff
    s_mov_b32 s32, 0xffff0000
    s_mov_b32 s35, 0x05040100
    s_mov_b32 s97, 0x07060302
    s_mov_b32 s96, 0x40008000
    s_movk_i32 s3, 212
    v_cmp_gt_u32 s[48:49], s3, v0

    v_mov_b32 v1, 0
    s_mov_b32 s24, 0xc0c0004
    s_mov_b32 s25, 0xc0c0105
    s_mov_b32 s26, 0xc0c0206
    s_mov_b32 s27, 0xc0c0307
    v_mov_b32 v28, 0x40004000
    v_mov_b32 v29, 0x40004000
    v_mov_b32 v30, 0x40004000
    v_mov_b32 v31, 0x40004000
    v_add_u32 v32, 50000, v3
    v_add_u32 v33, 65536, v32

    ds_write_b128 v32, v[28:31] offset:0
    ds_write_b128 v32, v[28:31] offset:16384
    ds_write_b128 v32, v[28:31] offset:32768
    ds_write_b128 v32, v[28:31] offset:49152
    ds_write_b128 v33, v[28:31] offset:0
    ds_write_b128 v33, v[28:31] offset:16384
    v_cmp_gt_u32 vcc, 971, v0
    s_mov_b64 exec, vcc
    ds_write_b128 v33, v[28:31] offset:32768
    s_mov_b64 exec, -1
    s_waitcnt vmcnt(13)
    ds_write_addtid_b32 v76 offset:0
    ds_write_addtid_b32 v77 offset:256
    ds_write_addtid_b32 v78 offset:512
    ds_write_addtid_b32 v79 offset:768
    s_waitcnt vmcnt(12)
    ds_write_addtid_b32 v80 offset:16384
    ds_write_addtid_b32 v81 offset:16640
    ds_write_addtid_b32 v82 offset:16896
    ds_write_addtid_b32 v83 offset:17152
    s_waitcnt vmcnt(11)
    ds_write_addtid_b32 v84 offset:32768
    ds_write_addtid_b32 v85 offset:33024
    ds_write_addtid_b32 v86 offset:33280
    ds_write_addtid_b32 v87 offset:33536
    v_lshlrev_b32 v119, 2, v0
    s_waitcnt vmcnt(10)
    s_mov_b64 exec, s[48:49]
    ds_write_b32 v119, v88 offset:49152
    s_mov_b64 exec, -1
    s_add_u32 s43, s43, 50048
    s_add_u32 s14, s43, 50000
    s_min_u32 s14, s14, s41
    s_and_b32 s3, s36, 1
    s_lshl_b32 s3, s3, 4
    s_or_b32 s3, s3, 0x100000
    s_waitcnt lgkmcnt(0)

    s_bfe_u32 s88, s88, s3
    s_bfe_u32 s89, s89, s3
    s_bfe_u32 s90, s90, s3
    s_bfe_u32 s91, s91, s3
    s_bfe_u32 s92, s92, s3
    s_bfe_u32 s93, s93, s3
    s_bfe_u32 s94, s94, s3
    s_bfe_u32 s95, s95, s3
    s_waitcnt vmcnt(6)
    v_max3_u32 v120, v120, v122, v124
    v_add_f32 v121, v121, v123
    v_add_f32 v125, v125, v127
    v_max_u32 v120, v120, v126
    v_add_f32 v121, v121, v125

    s_nop 1
    v_max_u32_dpp v120, v120, v120 row_shr:1 row_mask:0xf bank_mask:0xf
    s_nop 1
    v_max_u32_dpp v120, v120, v120 row_shr:2 row_mask:0xf bank_mask:0xf
    s_nop 1
    v_max_u32_dpp v120, v120, v120 row_shr:4 row_mask:0xf bank_mask:0xf
    s_nop 1
    v_max_u32_dpp v120, v120, v120 row_shr:8 row_mask:0xf bank_mask:0xf
    s_nop 1
    v_max_u32_dpp v120, v120, v120 row_bcast:15 row_mask:0xa bank_mask:0xf
    s_nop 1
    v_max_u32_dpp v120, v120, v120 row_bcast:31 row_mask:0xc bank_mask:0xf
    s_nop 1
    v_add_f32_dpp v121, v121, v121 row_shr:1 row_mask:0xf bank_mask:0xf
    s_nop 1
    v_add_f32_dpp v121, v121, v121 row_shr:2 row_mask:0xf bank_mask:0xf
    s_nop 1
    v_add_f32_dpp v121, v121, v121 row_shr:4 row_mask:0xf bank_mask:0xf
    s_nop 1
    v_add_f32_dpp v121, v121, v121 row_shr:8 row_mask:0xf bank_mask:0xf
    s_nop 1
    v_add_f32_dpp v121, v121, v121 row_bcast:15 row_mask:0xa bank_mask:0xf
    s_nop 1
    v_add_f32_dpp v121, v121, v121 row_bcast:31 row_mask:0xc bank_mask:0xf
    v_lshlrev_b32 v120, 16, v120
    v_mul_f32 v121, 0x34a7c5ac, v121
    v_sqrt_f32 v121, v121
    v_mul_f32 v120, s33, v120
    v_mul_f32 v121, s33, v121
    v_cmp_gt_f32 vcc, 0x46fde800, v120
    s_mov_b64 s[64:65], vcc
    v_cmp_lt_f32 vcc, 0x44000000, v121
    v_mov_b32 v120, 0x37800000
    v_mul_f32 v120, s33, v120
    s_and_b64 vcc, vcc, s[64:65]
    v_mul_f32 v121, 0x46ff8000, v120
    v_rcp_f32 v121, v121
    v_readfirstlane_b32 s33, v120
    s_waitcnt lgkmcnt(0)
    s_barrier
    v_readfirstlane_b32 s34, v121
    v_mov_b32 v120, 150016
    v_mov_b32 v121, 0
    ds_write_b32 v120, v121 offset:8
    s_bitcmp0_b64 vcc, 63
    s_cbranch_scc1 L_p2slow_48
    s_cmp_lg_u32 s51, 0
    s_cbranch_scc1 L_p2slow_48

    s_min_u32 s88, s88, 6552
    s_lshl_b32 s52, s38, 6
    s_add_u32 s52, s52, s36
    s_mul_i32 s52, s52, 32764
    s_add_u32 s16, s44, s52
    s_addc_u32 s17, s45, 0
    s_mul_i32 s52, s88, 5
    s_add_u32 s52, s52, 3
    s_and_b32 s18, s52, -4

    s_movk_i32 s53, 12800
    buffer_load_dwordx4 v[102:105], v2, s[16:19], s53 offen
    buffer_load_dword v113, v2, s[16:19], s53 offen offset:16
    s_movk_i32 s53, 0
    buffer_load_dwordx4 v[4:7], v2, s[16:19], s53 offen nt
    buffer_load_dword v35, v2, s[16:19], s53 offen offset:16 nt
    s_movk_i32 s53, 2560
    buffer_load_dwordx4 v[8:11], v2, s[16:19], s53 offen
    buffer_load_dword v43, v2, s[16:19], s53 offen offset:16
    s_movk_i32 s53, 15360
    buffer_load_dwordx4 v[106:109], v2, s[16:19], s53 offen
    buffer_load_dword v114, v2, s[16:19], s53 offen offset:16
    s_mov_b32 s40, s88
    s_sub_u32 s42, s40, s39

    s_add_u32 s55, s38, 1
    s_min_u32 s55, s55, 31
    s_mov_b32 s88, s89
    s_mov_b32 s89, s90
    s_mov_b32 s90, s91
    s_mov_b32 s91, s92
    s_mov_b32 s92, s93
    s_mov_b32 s93, s94
    s_mov_b32 s94, s95
    s_mov_b32 s95, 0
    s_min_u32 s88, s88, 6552
    s_lshl_b32 s52, s55, 6
    s_add_u32 s52, s52, s36
    s_mul_i32 s52, s52, 32764
    s_add_u32 s16, s44, s52
    s_addc_u32 s17, s45, 0
    s_mul_i32 s52, s88, 5
    s_add_u32 s52, s52, 3
    s_and_b32 s18, s52, -4

    s_waitcnt vmcnt(12)
    v_perm_b32 v44, v91, v90, s24
    v_perm_b32 v46, v92, v91, s25
    v_perm_b32 v48, v93, v92, s26
    v_perm_b32 v50, v110, v93, s27
    v_mov_b32 v12, v90
    v_alignbyte_b32 v13, v92, v91, 1
    v_alignbyte_b32 v14, v93, v92, 2
    v_alignbyte_b32 v15, v110, v93, 3
    v_lshlrev_b32_sdwa v44, 3, v44 dst_sel:WORD_0 dst_unused:UNUSED_PAD src0_sel:DWORD src1_sel:DWORD
    v_lshlrev_b32_sdwa v46, 3, v46 dst_sel:WORD_0 dst_unused:UNUSED_PAD src0_sel:DWORD src1_sel:DWORD
    v_lshlrev_b32_sdwa v48, 3, v48 dst_sel:WORD_0 dst_unused:UNUSED_PAD src0_sel:DWORD src1_sel:DWORD
    v_lshlrev_b32_sdwa v50, 3, v50 dst_sel:WORD_0 dst_unused:UNUSED_PAD src0_sel:DWORD src1_sel:DWORD
    s_cmp_lt_i32 s42, 1280
    s_cbranch_scc1 L_ufix_49
L_uback_50:

    v_subrev_co_u32 v12, s[80:81], 2.0, v12
    v_subrev_co_u32 v13, s[82:83], 2.0, v13
    v_subrev_co_u32 v14, s[84:85], 2.0, v14
    v_subrev_co_u32 v15, s[86:87], 2.0, v15
    s_mov_b64 exec, s[80:81]
    ds_read_b64 v[44:45], v44
    s_mov_b64 exec, s[82:83]
    ds_read_b64 v[46:47], v46
    s_mov_b64 exec, s[84:85]
    ds_read_b64 v[48:49], v48
    s_mov_b64 exec, s[86:87]
    ds_read_b64 v[50:51], v50
    s_mov_b64 exec, -1
    s_waitcnt vmcnt(10)
    v_perm_b32 v52, v95, v94, s24
    v_perm_b32 v54, v96, v95, s25
    v_perm_b32 v56, v97, v96, s26
    v_perm_b32 v58, v111, v97, s27
    v_mov_b32 v16, v94
    v_alignbyte_b32 v17, v96, v95, 1
    v_alignbyte_b32 v18, v97, v96, 2
    v_alignbyte_b32 v19, v111, v97, 3
    v_lshlrev_b32_sdwa v52, 3, v52 dst_sel:WORD_0 dst_unused:UNUSED_PAD src0_sel:DWORD src1_sel:DWORD
    v_lshlrev_b32_sdwa v54, 3, v54 dst_sel:WORD_0 dst_unused:UNUSED_PAD src0_sel:DWORD src1_sel:DWORD
    v_lshlrev_b32_sdwa v56, 3, v56 dst_sel:WORD_0 dst_unused:UNUSED_PAD src0_sel:DWORD src1_sel:DWORD
    v_lshlrev_b32_sdwa v58, 3, v58 dst_sel:WORD_0 dst_unused:UNUSED_PAD src0_sel:DWORD src1_sel:DWORD
    s_cmp_lt_i32 s42, 1792
    s_cbranch_scc1 L_ufix_51
L_uback_52:

    v_subrev_co_u32 v16, s[64:65], 2.0, v16
    v_subrev_co_u32 v17, s[66:67], 2.0, v17
    v_subrev_co_u32 v18, s[68:69], 2.0, v18
    v_subrev_co_u32 v19, s[70:71], 2.0, v19
    s_mov_b64 exec, s[64:65]
    ds_read_b64 v[52:53], v52
    s_mov_b64 exec, s[66:67]
    ds_read_b64 v[54:55], v54
    s_mov_b64 exec, s[68:69]
    ds_read_b64 v[56:57], v56
    s_mov_b64 exec, s[70:71]
    ds_read_b64 v[58:59], v58
    s_mov_b64 exec, -1
    s_waitcnt vmcnt(8)
    v_perm_b32 v60, v99, v98, s24
    v_perm_b32 v62, v100, v99, s25
    v_perm_b32 v64, v101, v100, s26
    v_perm_b32 v66, v112, v101, s27
    v_mov_b32 v20, v98
    v_alignbyte_b32 v21, v100, v99, 1
    v_alignbyte_b32 v22, v101, v100, 2
    v_alignbyte_b32 v23, v112, v101, 3
    v_lshlrev_b32_sdwa v60, 3, v60 dst_sel:WORD_0 dst_unused:UNUSED_PAD src0_sel:DWORD src1_sel:DWORD
    v_lshlrev_b32_sdwa v62, 3, v62 dst_sel:WORD_0 dst_unused:UNUSED_PAD src0_sel:DWORD src1_sel:DWORD
    v_lshlrev_b32_sdwa v64, 3, v64 dst_sel:WORD_0 dst_unused:UNUSED_PAD src0_sel:DWORD src1_sel:DWORD
    v_lshlrev_b32_sdwa v66, 3, v66 dst_sel:WORD_0 dst_unused:UNUSED_PAD src0_sel:DWORD src1_sel:DWORD
    s_cmp_lt_i32 s42, 2304
    s_cbranch_scc1 L_ufix_53
L_uback_54:

    v_subrev_co_u32 v20, s[72:73], 2.0, v20
    v_subrev_co_u32 v21, s[74:75], 2.0, v21
    v_subrev_co_u32 v22, s[76:77], 2.0, v22
    v_subrev_co_u32 v23, s[78:79], 2.0, v23
    s_mov_b64 exec, s[72:73]
    ds_read_b64 v[60:61], v60
    s_mov_b64 exec, s[74:75]
    ds_read_b64 v[62:63], v62
    s_mov_b64 exec, s[76:77]
    ds_read_b64 v[64:65], v64
    s_mov_b64 exec, s[78:79]
    ds_read_b64 v[66:67], v66
    s_mov_b64 exec, -1
    s_waitcnt vmcnt(6)
    v_perm_b32 v68, v103, v102, s24
    v_perm_b32 v70, v104, v103, s25
    v_perm_b32 v72, v105, v104, s26
    v_perm_b32 v74, v113, v105, s27
    v_mov_b32 v24, v102
    v_alignbyte_b32 v25, v104, v103, 1
    v_alignbyte_b32 v26, v105, v104, 2
    v_alignbyte_b32 v27, v113, v105, 3
    v_lshlrev_b32_sdwa v68, 3, v68 dst_sel:WORD_0 dst_unused:UNUSED_PAD src0_sel:DWORD src1_sel:DWORD
    v_lshlrev_b32_sdwa v70, 3, v70 dst_sel:WORD_0 dst_unused:UNUSED_PAD src0_sel:DWORD src1_sel:DWORD
    v_lshlrev_b32_sdwa v72, 3, v72 dst_sel:WORD_0 dst_unused:UNUSED_PAD src0_sel:DWORD src1_sel:DWORD
    v_lshlrev_b32_sdwa v74, 3, v74 dst_sel:WORD_0 dst_unused:UNUSED_PAD src0_sel:DWORD src1_sel:DWORD
    s_cmp_lt_i32 s42, 2816
    s_cbranch_scc1 L_ufix_55
L_uback_56:

    v_subrev_co_u32 v24, s[80:81], 2.0, v24
    v_subrev_co_u32 v25, s[82:83], 2.0, v25
    v_subrev_co_u32 v26, s[84:85], 2.0, v26
    v_subrev_co_u32 v27, s[86:87], 2.0, v27
    s_mov_b64 exec, s[80:81]
    ds_read_b64 v[68:69], v68
    s_mov_b64 exec, s[82:83]
    ds_read_b64 v[70:71], v70
    s_mov_b64 exec, s[84:85]
    ds_read_b64 v[72:73], v72
    s_mov_b64 exec, s[86:87]
    ds_read_b64 v[74:75], v74
    s_mov_b64 exec, -1
    s_waitcnt vmcnt(4)
    v_perm_b32 v28, v5, v4, s24
    v_perm_b32 v30, v6, v5, s25
    v_perm_b32 v32, v7, v6, s26
    v_perm_b32 v34, v35, v7, s27
    v_alignbyte_b32 v5, v6, v5, 1
    v_alignbyte_b32 v6, v7, v6, 2
    v_alignbyte_b32 v7, v35, v7, 3
    v_lshlrev_b32_sdwa v28, 3, v28 dst_sel:WORD_0 dst_unused:UNUSED_PAD src0_sel:DWORD src1_sel:DWORD
    v_lshlrev_b32_sdwa v30, 3, v30 dst_sel:WORD_0 dst_unused:UNUSED_PAD src0_sel:DWORD src1_sel:DWORD
    v_lshlrev_b32_sdwa v32, 3, v32 dst_sel:WORD_0 dst_unused:UNUSED_PAD src0_sel:DWORD src1_sel:DWORD
    v_lshlrev_b32_sdwa v34, 3, v34 dst_sel:WORD_0 dst_unused:UNUSED_PAD src0_sel:DWORD src1_sel:DWORD
    s_cmp_lt_i32 s42, 256
    s_cbranch_scc1 L_ufix_57
L_uback_58:

    v_subrev_co_u32 v4, s[64:65], 2.0, v4
    v_subrev_co_u32 v5, s[66:67], 2.0, v5
    v_subrev_co_u32 v6, s[68:69], 2.0, v6
    v_subrev_co_u32 v7, s[70:71], 2.0, v7
    s_mov_b64 exec, s[64:65]
    ds_read_b64 v[28:29], v28
    s_mov_b64 exec, s[66:67]
    ds_read_b64 v[30:31], v30
    s_mov_b64 exec, s[68:69]
    ds_read_b64 v[32:33], v32
    s_mov_b64 exec, s[70:71]
    ds_read_b64 v[34:35], v34
    s_mov_b64 exec, -1
    buffer_load_dwordx4 v[76:79], v3, s[12:15], s43 offen
    s_add_u32 s52, s43, 16384
    buffer_load_dwordx4 v[80:83], v3, s[12:15], s52 offen
    s_add_u32 s52, s43, 32768
    buffer_load_dwordx4 v[84:87], v3, s[12:15], s52 offen
    s_add_u32 s52, s43, 49152
    v_lshlrev_b32 v119, 2, v0
    buffer_load_dword v88, v119, s[12:15], s52 offen
    s_add_u32 s54, s43, 50048
    buffer_load_dword v115, v89, s[60:63], s54 offen
    s_add_u32 s54, s50, 0
    buffer_load_dword v115, v89, s[8:11], s54 offen
    s_waitcnt vmcnt(8)
    v_perm_b32 v36, v9, v8, s24
    v_perm_b32 v38, v10, v9, s25
    v_perm_b32 v40, v11, v10, s26
    v_perm_b32 v42, v43, v11, s27
    v_alignbyte_b32 v9, v10, v9, 1
    v_alignbyte_b32 v10, v11, v10, 2
    v_alignbyte_b32 v11, v43, v11, 3
    v_lshlrev_b32_sdwa v36, 3, v36 dst_sel:WORD_0 dst_unused:UNUSED_PAD src0_sel:DWORD src1_sel:DWORD
    v_lshlrev_b32_sdwa v38, 3, v38 dst_sel:WORD_0 dst_unused:UNUSED_PAD src0_sel:DWORD src1_sel:DWORD
    v_lshlrev_b32_sdwa v40, 3, v40 dst_sel:WORD_0 dst_unused:UNUSED_PAD src0_sel:DWORD src1_sel:DWORD
    v_lshlrev_b32_sdwa v42, 3, v42 dst_sel:WORD_0 dst_unused:UNUSED_PAD src0_sel:DWORD src1_sel:DWORD
    s_cmp_lt_i32 s42, 768
    s_cbranch_scc1 L_ufix_59
L_uback_60:

    v_subrev_co_u32 v8, s[72:73], 2.0, v8
    v_subrev_co_u32 v9, s[74:75], 2.0, v9
    v_subrev_co_u32 v10, s[76:77], 2.0, v10
    v_subrev_co_u32 v11, s[78:79], 2.0, v11
    s_mov_b64 exec, s[72:73]
    ds_read_b64 v[36:37], v36
    s_mov_b64 exec, s[74:75]
    ds_read_b64 v[38:39], v38
    s_mov_b64 exec, s[76:77]
    ds_read_b64 v[40:41], v40
    s_mov_b64 exec, s[78:79]
    ds_read_b64 v[42:43], v42
    s_mov_b64 exec, -1
    s_movk_i32 s53, 5120
    buffer_load_dwordx4 v[90:93], v2, s[16:19], s53 offen
    buffer_load_dword v110, v2, s[16:19], s53 offen offset:16
L_batch_61:
    s_add_u32 s5, s38, 1

    s_movk_i32 s53, 7680
    buffer_load_dwordx4 v[94:97], v2, s[16:19], s53 offen
    buffer_load_dword v111, v2, s[16:19], s53 offen offset:16
    v_subrev_co_u32 v4, s[64:65], 2.0, v4
    v_subrev_co_u32 v5, s[66:67], 2.0, v5
    v_subrev_co_u32 v6, s[68:69], 2.0, v6
    v_subrev_co_u32 v7, s[70:71], 2.0, v7
    v_subrev_co_u32 v8, s[72:73], 2.0, v8
    v_subrev_co_u32 v9, s[74:75], 2.0, v9
    v_subrev_co_u32 v10, s[76:77], 2.0, v10
    v_subrev_co_u32 v11, s[78:79], 2.0, v11
    v_subrev_co_u32 v12, s[80:81], 2.0, v12
    v_subrev_co_u32 v13, s[82:83], 2.0, v13
    v_subrev_co_u32 v14, s[84:85], 2.0, v14
    v_subrev_co_u32 v15, s[86:87], 2.0, v15
    s_waitcnt lgkmcnt(0)
    s_barrier
    s_waitcnt vmcnt(5)
    ds_write_addtid_b32 v76 offset:0
    ds_write_addtid_b32 v77 offset:256
    ds_write_addtid_b32 v78 offset:512
    ds_write_addtid_b32 v79 offset:768
    s_waitcnt vmcnt(4)
    ds_write_addtid_b32 v80 offset:16384
    ds_write_addtid_b32 v81 offset:16640
    ds_write_addtid_b32 v82 offset:16896
    ds_write_addtid_b32 v83 offset:17152
    s_waitcnt vmcnt(3)
    ds_write_addtid_b32 v84 offset:32768
    ds_write_addtid_b32 v85 offset:33024
    ds_write_addtid_b32 v86 offset:33280
    ds_write_addtid_b32 v87 offset:33536
    v_lshlrev_b32 v119, 2, v0
    s_waitcnt vmcnt(2)
    s_mov_b64 exec, s[48:49]
    ds_write_b32 v119, v88 offset:49152
    s_mov_b64 exec, -1
    s_add_u32 s43, s43, 50048
    s_add_u32 s14, s43, 50000
    s_min_u32 s14, s14, s41
    buffer_load_dwordx4 v[76:79], v3, s[12:15], s43 offen
    s_waitcnt lgkmcnt(0)
    s_barrier
    s_add_u32 s52, s43, 16384
    buffer_load_dwordx4 v[80:83], v3, s[12:15], s52 offen
    s_add_u32 s52, s43, 32768
    buffer_load_dwordx4 v[84:87], v3, s[12:15], s52 offen
    s_add_u32 s52, s43, 49152
    v_lshlrev_b32 v119, 2, v0
    buffer_load_dword v88, v119, s[12:15], s52 offen
    s_mov_b64 exec, s[64:65]
    ds_read_b64 v[28:29], v28
    s_mov_b64 exec, s[66:67]
    ds_read_b64 v[30:31], v30
    s_mov_b64 exec, s[68:69]
    ds_read_b64 v[32:33], v32
    s_mov_b64 exec, s[70:71]
    ds_read_b64 v[34:35], v34
    s_mov_b64 exec, s[72:73]
    ds_read_b64 v[36:37], v36
    s_mov_b64 exec, s[74:75]
    ds_read_b64 v[38:39], v38
    s_mov_b64 exec, s[76:77]
    ds_read_b64 v[40:41], v40
    s_mov_b64 exec, s[78:79]
    ds_read_b64 v[42:43], v42
    s_mov_b64 exec, s[80:81]
    ds_read_b64 v[44:45], v44
    s_mov_b64 exec, s[82:83]
    ds_read_b64 v[46:47], v46
    s_mov_b64 exec, s[84:85]
    ds_read_b64 v[48:49], v48
    s_mov_b64 exec, s[86:87]
    ds_read_b64 v[50:51], v50
    s_mov_b64 exec, -1
    v_subrev_co_u32 v16, s[64:65], 2.0, v16
    v_subrev_co_u32 v17, s[66:67], 2.0, v17
    v_subrev_co_u32 v18, s[68:69], 2.0, v18
    v_subrev_co_u32 v19, s[70:71], 2.0, v19
    v_subrev_co_u32 v20, s[72:73], 2.0, v20
    v_subrev_co_u32 v21, s[74:75], 2.0, v21
    v_subrev_co_u32 v22, s[76:77], 2.0, v22
    v_subrev_co_u32 v23, s[78:79], 2.0, v23
    v_subrev_co_u32 v24, s[80:81], 2.0, v24
    v_subrev_co_u32 v25, s[82:83], 2.0, v25
    v_subrev_co_u32 v26, s[84:85], 2.0, v26
    v_subrev_co_u32 v27, s[86:87], 2.0, v27
    s_mov_b64 exec, s[64:65]
    ds_read_b64 v[52:53], v52
    s_mov_b64 exec, s[66:67]
    ds_read_b64 v[54:55], v54
    s_mov_b64 exec, s[68:69]
    ds_read_b64 v[56:57], v56
    s_mov_b64 exec, s[70:71]
    ds_read_b64 v[58:59], v58
    s_mov_b64 exec, s[72:73]
    ds_read_b64 v[60:61], v60
    s_mov_b64 exec, s[74:75]
    ds_read_b64 v[62:63], v62
    s_mov_b64 exec, s[76:77]
    ds_read_b64 v[64:65], v64
    s_mov_b64 exec, s[78:79]
    ds_read_b64 v[66:67], v66
    s_mov_b64 exec, s[80:81]
    ds_read_b64 v[68:69], v68
    s_mov_b64 exec, s[82:83]
    ds_read_b64 v[70:71], v70
    s_mov_b64 exec, s[84:85]
    ds_read_b64 v[72:73], v72
    s_mov_b64 exec, s[86:87]
    ds_read_b64 v[74:75], v74
    s_mov_b64 exec, -1
    s_cmp_le_i32 s42, 3072
    s_cbranch_scc1 L_nt1_63
    s_waitcnt vmcnt(14)
    v_perm_b32 v120, v107, v106, s24
    v_perm_b32 v122, v108, v107, s25
    v_perm_b32 v124, v109, v108, s26
    v_perm_b32 v126, v114, v109, s27
    v_alignbyte_b32 v107, v108, v107, 1
    v_alignbyte_b32 v108, v109, v108, 2
    v_alignbyte_b32 v109, v114, v109, 3
    v_lshlrev_b32_sdwa v120, 3, v120 dst_sel:WORD_0 dst_unused:UNUSED_PAD src0_sel:DWORD src1_sel:DWORD
    v_lshlrev_b32_sdwa v122, 3, v122 dst_sel:WORD_0 dst_unused:UNUSED_PAD src0_sel:DWORD src1_sel:DWORD
    v_lshlrev_b32_sdwa v124, 3, v124 dst_sel:WORD_0 dst_unused:UNUSED_PAD src0_sel:DWORD src1_sel:DWORD
    v_lshlrev_b32_sdwa v126, 3, v126 dst_sel:WORD_0 dst_unused:UNUSED_PAD src0_sel:DWORD src1_sel:DWORD
    s_cmp_lt_i32 s42, 3328
    s_cbranch_scc1 L_ufix_66
L_uback_67:

    v_lshrrev_b32 v117, 30, v106
    v_and_b32 v106, 0x3fffffff, v106
    v_mul_u32_u24 v117, 50000, v117
    v_cmp_ne_u32 vcc, 0, v106
    v_add_u32 v120, v120, v117
    s_mov_b64 exec, vcc

    buffer_load_dwordx2 v[120:121], v120, s[8:11], s50 offen
    s_mov_b64 exec, -1
    v_lshrrev_b32 v117, 30, v107
    v_and_b32 v107, 0x3fffffff, v107
    v_mul_u32_u24 v117, 50000, v117
    v_cmp_ne_u32 vcc, 0, v107
    v_add_u32 v122, v122, v117
    s_mov_b64 exec, vcc

    buffer_load_dwordx2 v[122:123], v122, s[8:11], s50 offen
    s_mov_b64 exec, -1
    v_lshrrev_b32 v117, 30, v108
    v_and_b32 v108, 0x3fffffff, v108
    v_mul_u32_u24 v117, 50000, v117
    v_cmp_ne_u32 vcc, 0, v108
    v_add_u32 v124, v124, v117
    s_mov_b64 exec, vcc

    buffer_load_dwordx2 v[124:125], v124, s[8:11], s50 offen
    s_mov_b64 exec, -1
    v_lshrrev_b32 v117, 30, v109
    v_and_b32 v109, 0x3fffffff, v109
    v_mul_u32_u24 v117, 50000, v117
    v_cmp_ne_u32 vcc, 0, v109
    v_add_u32 v126, v126, v117
    s_mov_b64 exec, vcc

    buffer_load_dwordx2 v[126:127], v126, s[8:11], s50 offen
    s_mov_b64 exec, -1
L_nt1_63:
    v_subrev_co_u32 v4, s[64:65], 2.0, v4
    v_subrev_co_u32 v5, s[66:67], 2.0, v5
    v_subrev_co_u32 v6, s[68:69], 2.0, v6
    v_subrev_co_u32 v7, s[70:71], 2.0, v7
    v_subrev_co_u32 v8, s[72:73], 2.0, v8
    v_subrev_co_u32 v9, s[74:75], 2.0, v9
    v_subrev_co_u32 v10, s[76:77], 2.0, v10
    v_subrev_co_u32 v11, s[78:79], 2.0, v11
    v_subrev_co_u32 v12, s[80:81], 2.0, v12
    v_subrev_co_u32 v13, s[82:83], 2.0, v13
    v_subrev_co_u32 v14, s[84:85], 2.0, v14
    v_subrev_co_u32 v15, s[86:87], 2.0, v15
    s_waitcnt lgkmcnt(0)
    s_barrier
    s_waitcnt vmcnt(3)
    ds_write_addtid_b32 v76 offset:0
    ds_write_addtid_b32 v77 offset:256
    ds_write_addtid_b32 v78 offset:512
    ds_write_addtid_b32 v79 offset:768
    s_waitcnt vmcnt(2)
    ds_write_addtid_b32 v80 offset:16384
    ds_write_addtid_b32 v81 offset:16640
    ds_write_addtid_b32 v82 offset:16896
    ds_write_addtid_b32 v83 offset:17152
    s_waitcnt vmcnt(1)
    ds_write_addtid_b32 v84 offset:32768
    ds_write_addtid_b32 v85 offset:33024
    ds_write_addtid_b32 v86 offset:33280
    ds_write_addtid_b32 v87 offset:33536
    v_lshlrev_b32 v119, 2, v0
    s_waitcnt vmcnt(0)
    s_mov_b64 exec, s[48:49]
    ds_write_b32 v119, v88 offset:49152
    s_mov_b64 exec, -1
    s_add_u32 s43, s43, 50048
    s_add_u32 s14, s43, 50000
    s_min_u32 s14, s14, s41
    buffer_load_dwordx4 v[76:79], v3, s[12:15], s43 offen
    s_waitcnt lgkmcnt(0)
    s_barrier
    s_add_u32 s52, s43, 16384
    buffer_load_dwordx4 v[80:83], v3, s[12:15], s52 offen
    s_add_u32 s52, s43, 32768
    buffer_load_dwordx4 v[84:87], v3, s[12:15], s52 offen
    s_add_u32 s52, s43, 49152
    v_lshlrev_b32 v119, 2, v0
    buffer_load_dword v88, v119, s[12:15], s52 offen
    s_mov_b64 exec, s[64:65]
    ds_read_b64 v[28:29], v28
    s_mov_b64 exec, s[66:67]
    ds_read_b64 v[30:31], v30
    s_mov_b64 exec, s[68:69]
    ds_read_b64 v[32:33], v32
    s_mov_b64 exec, s[70:71]
    ds_read_b64 v[34:35], v34
    s_mov_b64 exec, s[72:73]
    ds_read_b64 v[36:37], v36
    s_mov_b64 exec, s[74:75]
    ds_read_b64 v[38:39], v38
    s_mov_b64 exec, s[76:77]
    ds_read_b64 v[40:41], v40
    s_mov_b64 exec, s[78:79]
    ds_read_b64 v[42:43], v42
    s_mov_b64 exec, s[80:81]
    ds_read_b64 v[44:45], v44
    s_mov_b64 exec, s[82:83]
    ds_read_b64 v[46:47], v46
    s_mov_b64 exec, s[84:85]
    ds_read_b64 v[48:49], v48
    s_mov_b64 exec, s[86:87]
    ds_read_b64 v[50:51], v50
    s_mov_b64 exec, -1
    v_subrev_co_u32 v16, s[64:65], 2.0, v16
    v_subrev_co_u32 v17, s[66:67], 2.0, v17
    v_subrev_co_u32 v18, s[68:69], 2.0, v18
    v_subrev_co_u32 v19, s[70:71], 2.0, v19
    v_subrev_co_u32 v20, s[72:73], 2.0, v20
    v_subrev_co_u32 v21, s[74:75], 2.0, v21
    v_subrev_co_u32 v22, s[76:77], 2.0, v22
    v_subrev_co_u32 v23, s[78:79], 2.0, v23
    v_subrev_co_u32 v24, s[80:81], 2.0, v24
    v_subrev_co_u32 v25, s[82:83], 2.0, v25
    v_subrev_co_u32 v26, s[84:85], 2.0, v26
    v_subrev_co_u32 v27, s[86:87], 2.0, v27
    s_mov_b64 exec, s[64:65]
    ds_read_b64 v[52:53], v52
    s_mov_b64 exec, s[66:67]
    ds_read_b64 v[54:55], v54
    s_mov_b64 exec, s[68:69]
    ds_read_b64 v[56:57], v56
    s_mov_b64 exec, s[70:71]
    ds_read_b64 v[58:59], v58
    s_mov_b64 exec, s[72:73]
    ds_read_b64 v[60:61], v60
    s_mov_b64 exec, s[74:75]
    ds_read_b64 v[62:63], v62
    s_mov_b64 exec, s[76:77]
    ds_read_b64 v[64:65], v64
    s_mov_b64 exec, s[78:79]
    ds_read_b64 v[66:67], v66
    s_mov_b64 exec, s[80:81]
    ds_read_b64 v[68:69], v68
    s_mov_b64 exec, s[82:83]
    ds_read_b64 v[70:71], v70
    s_mov_b64 exec, s[84:85]
    ds_read_b64 v[72:73], v72
    s_mov_b64 exec, s[86:87]
    ds_read_b64 v[74:75], v74
    s_mov_b64 exec, -1
    s_movk_i32 s53, 10240
    buffer_load_dwordx4 v[98:101], v2, s[16:19], s53 offen
    buffer_load_dword v112, v2, s[16:19], s53 offen offset:16
    s_cmp_le_i32 s42, 3072
    s_cbranch_scc1 L_nt2_64
    s_waitcnt vmcnt(6)
    v_cmp_ne_u32 s[56:57], 0, v106
    v_cmp_ne_u32 s[58:59], 0, v107
    v_cmp_ne_u32 s[98:99], 0, v108
    v_cmp_ne_u32 vcc, 0, v109
    s_mov_b64 exec, s[56:57]
    v_cvt_f32_i32_sdwa v118, sext(v106) dst_sel:DWORD dst_unused:UNUSED_PAD src0_sel:WORD_0
    v_lshlrev_b32 v116, 16, v120
    v_and_b32 v117, s32, v120
    v_mul_f32 v118, s33, v118
    v_lshlrev_b32 v120, 16, v121
    v_and_b32 v121, s32, v121
    v_lshlrev_b32_sdwa v106, 3, v106 dst_sel:DWORD dst_unused:UNUSED_PAD src0_sel:DWORD src1_sel:WORD_1
    v_pk_fma_f32 v[116:117], v[116:117], v[118:119], s[28:29] op_sel_hi:[1,0,1]
    v_pk_fma_f32 v[120:121], v[120:121], v[118:119], s[28:29] op_sel_hi:[1,0,1]
    v_perm_b32 v116, v117, v116, s35
    v_perm_b32 v117, v121, v120, s35
    v_lshl_add_u64 v[116:117], v[116:117], 0, s[30:31]
    ds_add_rtn_u64 v[120:121], v106, v[116:117] offset:50000

    s_mov_b64 exec, s[58:59]
    v_cvt_f32_i32_sdwa v118, sext(v107) dst_sel:DWORD dst_unused:UNUSED_PAD src0_sel:WORD_0
    v_lshlrev_b32 v116, 16, v122
    v_and_b32 v117, s32, v122
    v_mul_f32 v118, s33, v118
    v_lshlrev_b32 v122, 16, v123
    v_and_b32 v123, s32, v123
    v_lshlrev_b32_sdwa v107, 3, v107 dst_sel:DWORD dst_unused:UNUSED_PAD src0_sel:DWORD src1_sel:WORD_1
    v_pk_fma_f32 v[116:117], v[116:117], v[118:119], s[28:29] op_sel_hi:[1,0,1]
    v_pk_fma_f32 v[122:123], v[122:123], v[118:119], s[28:29] op_sel_hi:[1,0,1]
    v_perm_b32 v116, v117, v116, s35
    v_perm_b32 v117, v123, v122, s35
    v_lshl_add_u64 v[116:117], v[116:117], 0, s[30:31]
    ds_add_rtn_u64 v[122:123], v107, v[116:117] offset:50000

    s_mov_b64 exec, s[98:99]
    v_cvt_f32_i32_sdwa v118, sext(v108) dst_sel:DWORD dst_unused:UNUSED_PAD src0_sel:WORD_0
    v_lshlrev_b32 v116, 16, v124
    v_and_b32 v117, s32, v124
    v_mul_f32 v118, s33, v118
    v_lshlrev_b32 v124, 16, v125
    v_and_b32 v125, s32, v125
    v_lshlrev_b32_sdwa v108, 3, v108 dst_sel:DWORD dst_unused:UNUSED_PAD src0_sel:DWORD src1_sel:WORD_1
    v_pk_fma_f32 v[116:117], v[116:117], v[118:119], s[28:29] op_sel_hi:[1,0,1]
    v_pk_fma_f32 v[124:125], v[124:125], v[118:119], s[28:29] op_sel_hi:[1,0,1]
    v_perm_b32 v116, v117, v116, s35
    v_perm_b32 v117, v125, v124, s35
    v_lshl_add_u64 v[116:117], v[116:117], 0, s[30:31]
    ds_add_rtn_u64 v[124:125], v108, v[116:117] offset:50000

    s_mov_b64 exec, vcc
    v_cvt_f32_i32_sdwa v118, sext(v109) dst_sel:DWORD dst_unused:UNUSED_PAD src0_sel:WORD_0
    v_lshlrev_b32 v116, 16, v126
    v_and_b32 v117, s32, v126
    v_mul_f32 v118, s33, v118
    v_lshlrev_b32 v126, 16, v127
    v_and_b32 v127, s32, v127
    v_lshlrev_b32_sdwa v109, 3, v109 dst_sel:DWORD dst_unused:UNUSED_PAD src0_sel:DWORD src1_sel:WORD_1
    v_pk_fma_f32 v[116:117], v[116:117], v[118:119], s[28:29] op_sel_hi:[1,0,1]
    v_pk_fma_f32 v[126:127], v[126:127], v[118:119], s[28:29] op_sel_hi:[1,0,1]
    v_perm_b32 v116, v117, v116, s35
    v_perm_b32 v117, v127, v126, s35
    v_lshl_add_u64 v[116:117], v[116:117], 0, s[30:31]
    ds_add_rtn_u64 v[126:127], v109, v[116:117] offset:50000

    s_waitcnt lgkmcnt(0)
    s_mov_b64 exec, s[56:57]
    v_or3_b32 v1, v120, v121, v1
    s_mov_b64 exec, s[58:59]
    v_or3_b32 v1, v122, v123, v1
    s_mov_b64 exec, s[98:99]
    v_or3_b32 v1, v124, v125, v1
    s_mov_b64 exec, vcc
    v_or3_b32 v1, v126, v127, v1
    s_mov_b64 exec, -1
L_nt2_64:
    s_movk_i32 s53, 15360
    buffer_load_dwordx4 v[106:109], v2, s[16:19], s53 offen
    buffer_load_dword v114, v2, s[16:19], s53 offen offset:16
    s_cmp_le_u32 s40, 3584
    s_cbranch_scc1 L_noleft_65
    s_min_u32 s40, s40, 6552
    s_lshl_b32 s52, s38, 6
    s_add_u32 s52, s52, s36
    s_mul_i32 s52, s52, 32764
    s_add_u32 s20, s44, s52
    s_addc_u32 s21, s45, 0
    s_mul_i32 s52, s40, 5
    s_add_u32 s52, s52, 3
    s_and_b32 s22, s52, -4

    s_lshr_b32 s55, s39, 2
    s_add_u32 s55, s55, 3584
    v_and_b32 v120, 63, v0
    v_add_u32 v120, s55, v120
L_left_68:
    s_cmp_ge_u32 s55, s40
    s_cbranch_scc1 L_leftend_69
    v_mul_u32_u24 v121, 5, v120
    buffer_load_dword v122, v121, s[20:23], 0 offen
    buffer_load_ubyte v123, v121, s[20:23], 0 offen offset:4
    s_waitcnt vmcnt(0)

    v_perm_b32 v121, v123, v122, s24
    v_lshrrev_b32 v126, 30, v122
    v_and_b32 v121, 0x1fff, v121
    v_mul_u32_u24 v126, 6250, v126
    v_add_lshl_u32 v121, v121, v126, 3

    buffer_load_dwordx2 v[124:125], v121, s[8:11], s50 offen
    v_cmp_gt_u32 vcc, s40, v120
    s_waitcnt vmcnt(0)

    s_mov_b64 exec, vcc
    v_and_b32 v122, 0x3fffffff, v122
    v_cvt_f32_i32_sdwa v118, sext(v122) dst_sel:DWORD dst_unused:UNUSED_PAD src0_sel:WORD_0
    v_lshlrev_b32 v116, 16, v124
    v_and_b32 v117, s32, v124
    v_mul_f32 v118, s33, v118
    v_lshlrev_b32 v124, 16, v125
    v_and_b32 v125, s32, v125
    v_lshlrev_b32_sdwa v122, 3, v122 dst_sel:DWORD dst_unused:UNUSED_PAD src0_sel:DWORD src1_sel:WORD_1
    v_pk_fma_f32 v[116:117], v[116:117], v[118:119], s[28:29] op_sel_hi:[1,0,1]
    v_pk_fma_f32 v[124:125], v[124:125], v[118:119], s[28:29] op_sel_hi:[1,0,1]
    v_perm_b32 v116, v117, v116, s35
    v_perm_b32 v117, v125, v124, s35
    v_lshl_add_u64 v[116:117], v[116:117], 0, s[30:31]
    ds_add_rtn_u64 v[124:125], v122, v[116:117] offset:50000

    s_waitcnt lgkmcnt(0)
    v_or3_b32 v1, v124, v125, v1
    s_mov_b64 exec, -1
    v_add_u32 v120, 128, v120
    s_add_u32 s55, s55, 128
    s_branch L_left_68
L_leftend_69:

L_noleft_65:
    v_cmp_gt_u32 s[64:65], 2.0, v4
    v_and_b32 v4, 0x3fffffff, v4
    v_cmp_gt_u32 s[66:67], 2.0, v5
    v_and_b32 v5, 0x3fffffff, v5
    v_cmp_gt_u32 s[68:69], 2.0, v6
    v_and_b32 v6, 0x3fffffff, v6
    v_cmp_gt_u32 s[70:71], 2.0, v7
    v_and_b32 v7, 0x3fffffff, v7
    v_cmp_gt_u32 s[72:73], 2.0, v8
    v_and_b32 v8, 0x3fffffff, v8
    v_cmp_gt_u32 s[74:75], 2.0, v9
    v_and_b32 v9, 0x3fffffff, v9
    v_cmp_gt_u32 s[76:77], 2.0, v10
    v_and_b32 v10, 0x3fffffff, v10
    v_cmp_gt_u32 s[78:79], 2.0, v11
    v_and_b32 v11, 0x3fffffff, v11
    v_cmp_gt_u32 s[80:81], 2.0, v12
    v_and_b32 v12, 0x3fffffff, v12
    v_cmp_gt_u32 s[82:83], 2.0, v13
    v_and_b32 v13, 0x3fffffff, v13
    v_cmp_gt_u32 s[84:85], 2.0, v14
    v_and_b32 v14, 0x3fffffff, v14
    v_cmp_gt_u32 s[86:87], 2.0, v15
    v_and_b32 v15, 0x3fffffff, v15
    s_waitcnt lgkmcnt(0)
    s_barrier
    s_waitcnt vmcnt(7)
    ds_write_addtid_b32 v76 offset:0
    ds_write_addtid_b32 v77 offset:256
    ds_write_addtid_b32 v78 offset:512
    ds_write_addtid_b32 v79 offset:768
    s_waitcnt vmcnt(6)
    ds_write_addtid_b32 v80 offset:16384
    ds_write_addtid_b32 v81 offset:16640
    ds_write_addtid_b32 v82 offset:16896
    ds_write_addtid_b32 v83 offset:17152
    s_waitcnt vmcnt(5)
    ds_write_addtid_b32 v84 offset:32768
    ds_write_addtid_b32 v85 offset:33024
    ds_write_addtid_b32 v86 offset:33280
    ds_write_addtid_b32 v87 offset:33536
    v_lshlrev_b32 v119, 2, v0
    s_waitcnt vmcnt(4)
    s_mov_b64 exec, s[48:49]
    ds_write_b32 v119, v88 offset:49152
    s_mov_b64 exec, -1
    s_add_u32 s43, s43, 50048
    s_add_u32 s14, s43, 50000
    s_min_u32 s14, s14, s41
    buffer_load_dwordx4 v[76:79], v3, s[12:15], s43 offen
    s_waitcnt lgkmcnt(0)
    s_barrier
    s_add_u32 s52, s43, 16384
    buffer_load_dwordx4 v[80:83], v3, s[12:15], s52 offen
    s_add_u32 s52, s43, 32768
    buffer_load_dwordx4 v[84:87], v3, s[12:15], s52 offen
    s_add_u32 s52, s43, 49152
    v_lshlrev_b32 v119, 2, v0
    buffer_load_dword v88, v119, s[12:15], s52 offen
    s_mov_b64 exec, s[64:65]
    ds_read_b64 v[28:29], v28
    s_mov_b64 exec, s[66:67]
    ds_read_b64 v[30:31], v30
    s_mov_b64 exec, s[68:69]
    ds_read_b64 v[32:33], v32
    s_mov_b64 exec, s[70:71]
    ds_read_b64 v[34:35], v34
    s_mov_b64 exec, s[72:73]
    ds_read_b64 v[36:37], v36
    s_mov_b64 exec, s[74:75]
    ds_read_b64 v[38:39], v38
    s_mov_b64 exec, s[76:77]
    ds_read_b64 v[40:41], v40
    s_mov_b64 exec, s[78:79]
    ds_read_b64 v[42:43], v42
    s_mov_b64 exec, s[80:81]
    ds_read_b64 v[44:45], v44
    s_mov_b64 exec, s[82:83]
    ds_read_b64 v[46:47], v46
    s_mov_b64 exec, s[84:85]
    ds_read_b64 v[48:49], v48
    s_mov_b64 exec, s[86:87]
    ds_read_b64 v[50:51], v50
    s_mov_b64 exec, -1
    v_cmp_gt_u32 s[64:65], 2.0, v16
    v_and_b32 v16, 0x3fffffff, v16
    v_cmp_gt_u32 s[66:67], 2.0, v17
    v_and_b32 v17, 0x3fffffff, v17
    v_cmp_gt_u32 s[68:69], 2.0, v18
    v_and_b32 v18, 0x3fffffff, v18
    v_cmp_gt_u32 s[70:71], 2.0, v19
    v_and_b32 v19, 0x3fffffff, v19
    v_cmp_gt_u32 s[72:73], 2.0, v20
    v_and_b32 v20, 0x3fffffff, v20
    v_cmp_gt_u32 s[74:75], 2.0, v21
    v_and_b32 v21, 0x3fffffff, v21
    v_cmp_gt_u32 s[76:77], 2.0, v22
    v_and_b32 v22, 0x3fffffff, v22
    v_cmp_gt_u32 s[78:79], 2.0, v23
    v_and_b32 v23, 0x3fffffff, v23
    v_cmp_gt_u32 s[80:81], 2.0, v24
    v_and_b32 v24, 0x3fffffff, v24
    v_cmp_gt_u32 s[82:83], 2.0, v25
    v_and_b32 v25, 0x3fffffff, v25
    v_cmp_gt_u32 s[84:85], 2.0, v26
    v_and_b32 v26, 0x3fffffff, v26
    v_cmp_gt_u32 s[86:87], 2.0, v27
    v_and_b32 v27, 0x3fffffff, v27
    s_mov_b64 exec, s[64:65]
    ds_read_b64 v[52:53], v52
    s_mov_b64 exec, s[66:67]
    ds_read_b64 v[54:55], v54
    s_mov_b64 exec, s[68:69]
    ds_read_b64 v[56:57], v56
    s_mov_b64 exec, s[70:71]
    ds_read_b64 v[58:59], v58
    s_mov_b64 exec, s[72:73]
    ds_read_b64 v[60:61], v60
    s_mov_b64 exec, s[74:75]
    ds_read_b64 v[62:63], v62
    s_mov_b64 exec, s[76:77]
    ds_read_b64 v[64:65], v64
    s_mov_b64 exec, s[78:79]
    ds_read_b64 v[66:67], v66
    s_mov_b64 exec, s[80:81]
    ds_read_b64 v[68:69], v68
    s_mov_b64 exec, s[82:83]
    ds_read_b64 v[70:71], v70
    s_mov_b64 exec, s[84:85]
    ds_read_b64 v[72:73], v72
    s_mov_b64 exec, s[86:87]
    ds_read_b64 v[74:75], v74
    s_mov_b64 exec, -1
    s_movk_i32 s53, 12800
    buffer_load_dwordx4 v[102:105], v2, s[16:19], s53 offen
    buffer_load_dword v113, v2, s[16:19], s53 offen offset:16
    s_cmp_ge_u32 s5, s4
    s_cbranch_scc1 L_bend_62
    s_waitcnt lgkmcnt(15)
    v_mad_i32_i16 v120, v28, v4, s96
    v_mad_i32_i16 v28, v28, v4, s96 op_sel:[1,0,0,0]
    v_mad_i32_i16 v121, v29, v4, s96
    v_mad_i32_i16 v29, v29, v4, s96 op_sel:[1,0,0,0]
    v_lshlrev_b32_sdwa v4, 3, v4 dst_sel:DWORD dst_unused:UNUSED_PAD src0_sel:DWORD src1_sel:WORD_1
    v_perm_b32 v28, v28, v120, s97
    v_perm_b32 v29, v29, v121, s97
    v_lshl_add_u64 v[28:29], v[28:29], 0, s[30:31]

    ds_add_rtn_u64 v[28:29], v4, v[28:29] offset:50000
    v_mad_i32_i16 v122, v30, v5, s96
    v_mad_i32_i16 v30, v30, v5, s96 op_sel:[1,0,0,0]
    v_mad_i32_i16 v123, v31, v5, s96
    v_mad_i32_i16 v31, v31, v5, s96 op_sel:[1,0,0,0]
    v_lshlrev_b32_sdwa v5, 3, v5 dst_sel:DWORD dst_unused:UNUSED_PAD src0_sel:DWORD src1_sel:WORD_1
    v_perm_b32 v30, v30, v122, s97
    v_perm_b32 v31, v31, v123, s97
    v_lshl_add_u64 v[30:31], v[30:31], 0, s[30:31]

    ds_add_rtn_u64 v[30:31], v5, v[30:31] offset:50000
    v_mad_i32_i16 v124, v32, v6, s96
    v_mad_i32_i16 v32, v32, v6, s96 op_sel:[1,0,0,0]
    v_mad_i32_i16 v125, v33, v6, s96
    v_mad_i32_i16 v33, v33, v6, s96 op_sel:[1,0,0,0]
    v_lshlrev_b32_sdwa v6, 3, v6 dst_sel:DWORD dst_unused:UNUSED_PAD src0_sel:DWORD src1_sel:WORD_1
    v_perm_b32 v32, v32, v124, s97
    v_perm_b32 v33, v33, v125, s97
    v_lshl_add_u64 v[32:33], v[32:33], 0, s[30:31]

    ds_add_rtn_u64 v[32:33], v6, v[32:33] offset:50000
    v_mad_i32_i16 v126, v34, v7, s96
    v_mad_i32_i16 v34, v34, v7, s96 op_sel:[1,0,0,0]
    v_mad_i32_i16 v127, v35, v7, s96
    v_mad_i32_i16 v35, v35, v7, s96 op_sel:[1,0,0,0]
    v_lshlrev_b32_sdwa v7, 3, v7 dst_sel:DWORD dst_unused:UNUSED_PAD src0_sel:DWORD src1_sel:WORD_1
    v_perm_b32 v34, v34, v126, s97
    v_perm_b32 v35, v35, v127, s97
    v_lshl_add_u64 v[34:35], v[34:35], 0, s[30:31]

    ds_add_rtn_u64 v[34:35], v7, v[34:35] offset:50000
    v_mad_i32_i16 v120, v36, v8, s96
    v_mad_i32_i16 v36, v36, v8, s96 op_sel:[1,0,0,0]
    v_mad_i32_i16 v121, v37, v8, s96
    v_mad_i32_i16 v37, v37, v8, s96 op_sel:[1,0,0,0]
    v_lshlrev_b32_sdwa v8, 3, v8 dst_sel:DWORD dst_unused:UNUSED_PAD src0_sel:DWORD src1_sel:WORD_1
    v_perm_b32 v36, v36, v120, s97
    v_perm_b32 v37, v37, v121, s97
    v_lshl_add_u64 v[36:37], v[36:37], 0, s[30:31]

    ds_add_rtn_u64 v[36:37], v8, v[36:37] offset:50000
    v_mad_i32_i16 v122, v38, v9, s96
    v_mad_i32_i16 v38, v38, v9, s96 op_sel:[1,0,0,0]
    v_mad_i32_i16 v123, v39, v9, s96
    v_mad_i32_i16 v39, v39, v9, s96 op_sel:[1,0,0,0]
    v_lshlrev_b32_sdwa v9, 3, v9 dst_sel:DWORD dst_unused:UNUSED_PAD src0_sel:DWORD src1_sel:WORD_1
    v_perm_b32 v38, v38, v122, s97
    v_perm_b32 v39, v39, v123, s97
    v_lshl_add_u64 v[38:39], v[38:39], 0, s[30:31]

    ds_add_rtn_u64 v[38:39], v9, v[38:39] offset:50000
    v_mad_i32_i16 v124, v40, v10, s96
    v_mad_i32_i16 v40, v40, v10, s96 op_sel:[1,0,0,0]
    v_mad_i32_i16 v125, v41, v10, s96
    v_mad_i32_i16 v41, v41, v10, s96 op_sel:[1,0,0,0]
    v_lshlrev_b32_sdwa v10, 3, v10 dst_sel:DWORD dst_unused:UNUSED_PAD src0_sel:DWORD src1_sel:WORD_1
    v_perm_b32 v40, v40, v124, s97
    v_perm_b32 v41, v41, v125, s97
    v_lshl_add_u64 v[40:41], v[40:41], 0, s[30:31]

    ds_add_rtn_u64 v[40:41], v10, v[40:41] offset:50000
    v_mad_i32_i16 v126, v42, v11, s96
    v_mad_i32_i16 v42, v42, v11, s96 op_sel:[1,0,0,0]
    v_mad_i32_i16 v127, v43, v11, s96
    v_mad_i32_i16 v43, v43, v11, s96 op_sel:[1,0,0,0]
    v_lshlrev_b32_sdwa v11, 3, v11 dst_sel:DWORD dst_unused:UNUSED_PAD src0_sel:DWORD src1_sel:WORD_1
    v_perm_b32 v42, v42, v126, s97
    v_perm_b32 v43, v43, v127, s97
    v_lshl_add_u64 v[42:43], v[42:43], 0, s[30:31]

    ds_add_rtn_u64 v[42:43], v11, v[42:43] offset:50000
    s_waitcnt lgkmcnt(4)
    v_or3_b32 v1, v28, v29, v1
    v_or3_b32 v1, v30, v31, v1
    v_or3_b32 v1, v32, v33, v1
    v_or3_b32 v1, v34, v35, v1
    s_movk_i32 s53, 0
    buffer_load_dwordx4 v[4:7], v2, s[16:19], s53 offen nt
    buffer_load_dword v35, v2, s[16:19], s53 offen offset:16 nt
    v_mad_i32_i16 v120, v44, v12, s96
    v_mad_i32_i16 v44, v44, v12, s96 op_sel:[1,0,0,0]
    v_mad_i32_i16 v121, v45, v12, s96
    v_mad_i32_i16 v45, v45, v12, s96 op_sel:[1,0,0,0]
    v_lshlrev_b32_sdwa v12, 3, v12 dst_sel:DWORD dst_unused:UNUSED_PAD src0_sel:DWORD src1_sel:WORD_1
    v_perm_b32 v44, v44, v120, s97
    v_perm_b32 v45, v45, v121, s97
    v_lshl_add_u64 v[44:45], v[44:45], 0, s[30:31]

    ds_add_rtn_u64 v[44:45], v12, v[44:45] offset:50000
    v_mad_i32_i16 v122, v46, v13, s96
    v_mad_i32_i16 v46, v46, v13, s96 op_sel:[1,0,0,0]
    v_mad_i32_i16 v123, v47, v13, s96
    v_mad_i32_i16 v47, v47, v13, s96 op_sel:[1,0,0,0]
    v_lshlrev_b32_sdwa v13, 3, v13 dst_sel:DWORD dst_unused:UNUSED_PAD src0_sel:DWORD src1_sel:WORD_1
    v_perm_b32 v46, v46, v122, s97
    v_perm_b32 v47, v47, v123, s97
    v_lshl_add_u64 v[46:47], v[46:47], 0, s[30:31]

    ds_add_rtn_u64 v[46:47], v13, v[46:47] offset:50000
    v_mad_i32_i16 v124, v48, v14, s96
    v_mad_i32_i16 v48, v48, v14, s96 op_sel:[1,0,0,0]
    v_mad_i32_i16 v125, v49, v14, s96
    v_mad_i32_i16 v49, v49, v14, s96 op_sel:[1,0,0,0]
    v_lshlrev_b32_sdwa v14, 3, v14 dst_sel:DWORD dst_unused:UNUSED_PAD src0_sel:DWORD src1_sel:WORD_1
    v_perm_b32 v48, v48, v124, s97
    v_perm_b32 v49, v49, v125, s97
    v_lshl_add_u64 v[48:49], v[48:49], 0, s[30:31]

    ds_add_rtn_u64 v[48:49], v14, v[48:49] offset:50000
    v_mad_i32_i16 v126, v50, v15, s96
    v_mad_i32_i16 v50, v50, v15, s96 op_sel:[1,0,0,0]
    v_mad_i32_i16 v127, v51, v15, s96
    v_mad_i32_i16 v51, v51, v15, s96 op_sel:[1,0,0,0]
    v_lshlrev_b32_sdwa v15, 3, v15 dst_sel:DWORD dst_unused:UNUSED_PAD src0_sel:DWORD src1_sel:WORD_1
    v_perm_b32 v50, v50, v126, s97
    v_perm_b32 v51, v51, v127, s97
    v_lshl_add_u64 v[50:51], v[50:51], 0, s[30:31]

    ds_add_rtn_u64 v[50:51], v15, v[50:51] offset:50000
    s_waitcnt lgkmcnt(4)
    v_or3_b32 v1, v36, v37, v1
    v_or3_b32 v1, v38, v39, v1
    v_or3_b32 v1, v40, v41, v1
    v_or3_b32 v1, v42, v43, v1
    s_movk_i32 s53, 2560
    buffer_load_dwordx4 v[8:11], v2, s[16:19], s53 offen
    buffer_load_dword v43, v2, s[16:19], s53 offen offset:16
    s_barrier
    s_waitcnt vmcnt(9)
    ds_write_addtid_b32 v76 offset:0
    ds_write_addtid_b32 v77 offset:256
    ds_write_addtid_b32 v78 offset:512
    ds_write_addtid_b32 v79 offset:768
    s_waitcnt vmcnt(8)
    ds_write_addtid_b32 v80 offset:16384
    ds_write_addtid_b32 v81 offset:16640
    ds_write_addtid_b32 v82 offset:16896
    ds_write_addtid_b32 v83 offset:17152
    s_waitcnt vmcnt(7)
    ds_write_addtid_b32 v84 offset:32768
    ds_write_addtid_b32 v85 offset:33024
    ds_write_addtid_b32 v86 offset:33280
    ds_write_addtid_b32 v87 offset:33536
    v_lshlrev_b32 v119, 2, v0
    s_waitcnt vmcnt(6)
    s_mov_b64 exec, s[48:49]
    ds_write_b32 v119, v88 offset:49152
    s_mov_b64 exec, -1
    s_add_u32 s43, s43, 50048
    s_add_u32 s14, s43, 50000
    s_min_u32 s14, s14, s41
    s_add_u32 s54, s43, 50048
    buffer_load_dword v115, v89, s[60:63], s54 offen
    s_add_u32 s54, s50, 200000
    buffer_load_dword v115, v89, s[8:11], s54 offen
    s_mov_b32 s40, s88
    s_sub_u32 s42, s40, s39

    s_add_u32 s55, s38, 2
    s_min_u32 s55, s55, 31
    s_mov_b32 s88, s89
    s_mov_b32 s89, s90
    s_mov_b32 s90, s91
    s_mov_b32 s91, s92
    s_mov_b32 s92, s93
    s_mov_b32 s93, s94
    s_mov_b32 s94, s95
    s_mov_b32 s95, 0
    s_min_u32 s88, s88, 6552
    s_lshl_b32 s52, s55, 6
    s_add_u32 s52, s52, s36
    s_mul_i32 s52, s52, 32764
    s_add_u32 s16, s44, s52
    s_addc_u32 s17, s45, 0
    s_mul_i32 s52, s88, 5
    s_add_u32 s52, s52, 3
    s_and_b32 s18, s52, -4

    v_mad_i32_i16 v120, v52, v16, s96
    v_mad_i32_i16 v52, v52, v16, s96 op_sel:[1,0,0,0]
    v_mad_i32_i16 v121, v53, v16, s96
    v_mad_i32_i16 v53, v53, v16, s96 op_sel:[1,0,0,0]
    v_lshlrev_b32_sdwa v16, 3, v16 dst_sel:DWORD dst_unused:UNUSED_PAD src0_sel:DWORD src1_sel:WORD_1
    v_perm_b32 v52, v52, v120, s97
    v_perm_b32 v53, v53, v121, s97
    v_lshl_add_u64 v[52:53], v[52:53], 0, s[30:31]

    ds_add_rtn_u64 v[52:53], v16, v[52:53] offset:50000
    v_mad_i32_i16 v122, v54, v17, s96
    v_mad_i32_i16 v54, v54, v17, s96 op_sel:[1,0,0,0]
    v_mad_i32_i16 v123, v55, v17, s96
    v_mad_i32_i16 v55, v55, v17, s96 op_sel:[1,0,0,0]
    v_lshlrev_b32_sdwa v17, 3, v17 dst_sel:DWORD dst_unused:UNUSED_PAD src0_sel:DWORD src1_sel:WORD_1
    v_perm_b32 v54, v54, v122, s97
    v_perm_b32 v55, v55, v123, s97
    v_lshl_add_u64 v[54:55], v[54:55], 0, s[30:31]

    ds_add_rtn_u64 v[54:55], v17, v[54:55] offset:50000
    v_mad_i32_i16 v124, v56, v18, s96
    v_mad_i32_i16 v56, v56, v18, s96 op_sel:[1,0,0,0]
    v_mad_i32_i16 v125, v57, v18, s96
    v_mad_i32_i16 v57, v57, v18, s96 op_sel:[1,0,0,0]
    v_lshlrev_b32_sdwa v18, 3, v18 dst_sel:DWORD dst_unused:UNUSED_PAD src0_sel:DWORD src1_sel:WORD_1
    v_perm_b32 v56, v56, v124, s97
    v_perm_b32 v57, v57, v125, s97
    v_lshl_add_u64 v[56:57], v[56:57], 0, s[30:31]

    ds_add_rtn_u64 v[56:57], v18, v[56:57] offset:50000
    v_mad_i32_i16 v126, v58, v19, s96
    v_mad_i32_i16 v58, v58, v19, s96 op_sel:[1,0,0,0]
    v_mad_i32_i16 v127, v59, v19, s96
    v_mad_i32_i16 v59, v59, v19, s96 op_sel:[1,0,0,0]
    v_lshlrev_b32_sdwa v19, 3, v19 dst_sel:DWORD dst_unused:UNUSED_PAD src0_sel:DWORD src1_sel:WORD_1
    v_perm_b32 v58, v58, v126, s97
    v_perm_b32 v59, v59, v127, s97
    v_lshl_add_u64 v[58:59], v[58:59], 0, s[30:31]

    ds_add_rtn_u64 v[58:59], v19, v[58:59] offset:50000
    s_waitcnt lgkmcnt(15)
    v_or3_b32 v1, v44, v45, v1
    v_or3_b32 v1, v46, v47, v1
    v_or3_b32 v1, v48, v49, v1
    v_or3_b32 v1, v50, v51, v1
    s_waitcnt vmcnt(26)
    v_perm_b32 v44, v91, v90, s24
    v_perm_b32 v46, v92, v91, s25
    v_perm_b32 v48, v93, v92, s26
    v_perm_b32 v50, v110, v93, s27
    v_mov_b32 v12, v90
    v_alignbyte_b32 v13, v92, v91, 1
    v_alignbyte_b32 v14, v93, v92, 2
    v_alignbyte_b32 v15, v110, v93, 3
    v_lshlrev_b32_sdwa v44, 3, v44 dst_sel:WORD_0 dst_unused:UNUSED_PAD src0_sel:DWORD src1_sel:DWORD
    v_lshlrev_b32_sdwa v46, 3, v46 dst_sel:WORD_0 dst_unused:UNUSED_PAD src0_sel:DWORD src1_sel:DWORD
    v_lshlrev_b32_sdwa v48, 3, v48 dst_sel:WORD_0 dst_unused:UNUSED_PAD src0_sel:DWORD src1_sel:DWORD
    v_lshlrev_b32_sdwa v50, 3, v50 dst_sel:WORD_0 dst_unused:UNUSED_PAD src0_sel:DWORD src1_sel:DWORD
    s_cmp_lt_i32 s42, 1280
    s_cbranch_scc1 L_ufix_70
L_uback_71:

    s_movk_i32 s53, 5120
    buffer_load_dwordx4 v[90:93], v2, s[16:19], s53 offen
    buffer_load_dword v110, v2, s[16:19], s53 offen offset:16
    s_waitcnt lgkmcnt(4)
    s_barrier
    v_subrev_co_u32 v12, s[80:81], 2.0, v12
    v_subrev_co_u32 v13, s[82:83], 2.0, v13
    v_subrev_co_u32 v14, s[84:85], 2.0, v14
    v_subrev_co_u32 v15, s[86:87], 2.0, v15
    s_mov_b64 exec, s[80:81]
    ds_read_b64 v[44:45], v44
    s_mov_b64 exec, s[82:83]
    ds_read_b64 v[46:47], v46
    s_mov_b64 exec, s[84:85]
    ds_read_b64 v[48:49], v48
    s_mov_b64 exec, s[86:87]
    ds_read_b64 v[50:51], v50
    s_mov_b64 exec, -1
    v_mad_i32_i16 v120, v60, v20, s96
    v_mad_i32_i16 v60, v60, v20, s96 op_sel:[1,0,0,0]
    v_mad_i32_i16 v121, v61, v20, s96
    v_mad_i32_i16 v61, v61, v20, s96 op_sel:[1,0,0,0]
    v_lshlrev_b32_sdwa v20, 3, v20 dst_sel:DWORD dst_unused:UNUSED_PAD src0_sel:DWORD src1_sel:WORD_1
    v_perm_b32 v60, v60, v120, s97
    v_perm_b32 v61, v61, v121, s97
    v_lshl_add_u64 v[60:61], v[60:61], 0, s[30:31]

    ds_add_rtn_u64 v[60:61], v20, v[60:61] offset:50000
    v_mad_i32_i16 v122, v62, v21, s96
    v_mad_i32_i16 v62, v62, v21, s96 op_sel:[1,0,0,0]
    v_mad_i32_i16 v123, v63, v21, s96
    v_mad_i32_i16 v63, v63, v21, s96 op_sel:[1,0,0,0]
    v_lshlrev_b32_sdwa v21, 3, v21 dst_sel:DWORD dst_unused:UNUSED_PAD src0_sel:DWORD src1_sel:WORD_1
    v_perm_b32 v62, v62, v122, s97
    v_perm_b32 v63, v63, v123, s97
    v_lshl_add_u64 v[62:63], v[62:63], 0, s[30:31]

    ds_add_rtn_u64 v[62:63], v21, v[62:63] offset:50000
    v_mad_i32_i16 v124, v64, v22, s96
    v_mad_i32_i16 v64, v64, v22, s96 op_sel:[1,0,0,0]
    v_mad_i32_i16 v125, v65, v22, s96
    v_mad_i32_i16 v65, v65, v22, s96 op_sel:[1,0,0,0]
    v_lshlrev_b32_sdwa v22, 3, v22 dst_sel:DWORD dst_unused:UNUSED_PAD src0_sel:DWORD src1_sel:WORD_1
    v_perm_b32 v64, v64, v124, s97
    v_perm_b32 v65, v65, v125, s97
    v_lshl_add_u64 v[64:65], v[64:65], 0, s[30:31]

    ds_add_rtn_u64 v[64:65], v22, v[64:65] offset:50000
    v_mad_i32_i16 v126, v66, v23, s96
    v_mad_i32_i16 v66, v66, v23, s96 op_sel:[1,0,0,0]
    v_mad_i32_i16 v127, v67, v23, s96
    v_mad_i32_i16 v67, v67, v23, s96 op_sel:[1,0,0,0]
    v_lshlrev_b32_sdwa v23, 3, v23 dst_sel:DWORD dst_unused:UNUSED_PAD src0_sel:DWORD src1_sel:WORD_1
    v_perm_b32 v66, v66, v126, s97
    v_perm_b32 v67, v67, v127, s97
    v_lshl_add_u64 v[66:67], v[66:67], 0, s[30:31]

    ds_add_rtn_u64 v[66:67], v23, v[66:67] offset:50000
    s_waitcnt lgkmcnt(8)
    v_or3_b32 v1, v52, v53, v1
    v_or3_b32 v1, v54, v55, v1
    v_or3_b32 v1, v56, v57, v1
    v_or3_b32 v1, v58, v59, v1
    s_waitcnt vmcnt(26)
    v_perm_b32 v52, v95, v94, s24
    v_perm_b32 v54, v96, v95, s25
    v_perm_b32 v56, v97, v96, s26
    v_perm_b32 v58, v111, v97, s27
    v_mov_b32 v16, v94
    v_alignbyte_b32 v17, v96, v95, 1
    v_alignbyte_b32 v18, v97, v96, 2
    v_alignbyte_b32 v19, v111, v97, 3
    v_lshlrev_b32_sdwa v52, 3, v52 dst_sel:WORD_0 dst_unused:UNUSED_PAD src0_sel:DWORD src1_sel:DWORD
    v_lshlrev_b32_sdwa v54, 3, v54 dst_sel:WORD_0 dst_unused:UNUSED_PAD src0_sel:DWORD src1_sel:DWORD
    v_lshlrev_b32_sdwa v56, 3, v56 dst_sel:WORD_0 dst_unused:UNUSED_PAD src0_sel:DWORD src1_sel:DWORD
    v_lshlrev_b32_sdwa v58, 3, v58 dst_sel:WORD_0 dst_unused:UNUSED_PAD src0_sel:DWORD src1_sel:DWORD
    s_cmp_lt_i32 s42, 1792
    s_cbranch_scc1 L_ufix_72
L_uback_73:

    v_subrev_co_u32 v16, s[64:65], 2.0, v16
    v_subrev_co_u32 v17, s[66:67], 2.0, v17
    v_subrev_co_u32 v18, s[68:69], 2.0, v18
    v_subrev_co_u32 v19, s[70:71], 2.0, v19
    s_mov_b64 exec, s[64:65]
    ds_read_b64 v[52:53], v52
    s_mov_b64 exec, s[66:67]
    ds_read_b64 v[54:55], v54
    s_mov_b64 exec, s[68:69]
    ds_read_b64 v[56:57], v56
    s_mov_b64 exec, s[70:71]
    ds_read_b64 v[58:59], v58
    s_mov_b64 exec, -1
    v_mad_i32_i16 v120, v68, v24, s96
    v_mad_i32_i16 v68, v68, v24, s96 op_sel:[1,0,0,0]
    v_mad_i32_i16 v121, v69, v24, s96
    v_mad_i32_i16 v69, v69, v24, s96 op_sel:[1,0,0,0]
    v_lshlrev_b32_sdwa v24, 3, v24 dst_sel:DWORD dst_unused:UNUSED_PAD src0_sel:DWORD src1_sel:WORD_1
    v_perm_b32 v68, v68, v120, s97
    v_perm_b32 v69, v69, v121, s97
    v_lshl_add_u64 v[68:69], v[68:69], 0, s[30:31]

    ds_add_rtn_u64 v[68:69], v24, v[68:69] offset:50000
    v_mad_i32_i16 v122, v70, v25, s96
    v_mad_i32_i16 v70, v70, v25, s96 op_sel:[1,0,0,0]
    v_mad_i32_i16 v123, v71, v25, s96
    v_mad_i32_i16 v71, v71, v25, s96 op_sel:[1,0,0,0]
    v_lshlrev_b32_sdwa v25, 3, v25 dst_sel:DWORD dst_unused:UNUSED_PAD src0_sel:DWORD src1_sel:WORD_1
    v_perm_b32 v70, v70, v122, s97
    v_perm_b32 v71, v71, v123, s97
    v_lshl_add_u64 v[70:71], v[70:71], 0, s[30:31]

    ds_add_rtn_u64 v[70:71], v25, v[70:71] offset:50000
    v_mad_i32_i16 v124, v72, v26, s96
    v_mad_i32_i16 v72, v72, v26, s96 op_sel:[1,0,0,0]
    v_mad_i32_i16 v125, v73, v26, s96
    v_mad_i32_i16 v73, v73, v26, s96 op_sel:[1,0,0,0]
    v_lshlrev_b32_sdwa v26, 3, v26 dst_sel:DWORD dst_unused:UNUSED_PAD src0_sel:DWORD src1_sel:WORD_1
    v_perm_b32 v72, v72, v124, s97
    v_perm_b32 v73, v73, v125, s97
    v_lshl_add_u64 v[72:73], v[72:73], 0, s[30:31]

    ds_add_rtn_u64 v[72:73], v26, v[72:73] offset:50000
    v_mad_i32_i16 v126, v74, v27, s96
    v_mad_i32_i16 v74, v74, v27, s96 op_sel:[1,0,0,0]
    v_mad_i32_i16 v127, v75, v27, s96
    v_mad_i32_i16 v75, v75, v27, s96 op_sel:[1,0,0,0]
    v_lshlrev_b32_sdwa v27, 3, v27 dst_sel:DWORD dst_unused:UNUSED_PAD src0_sel:DWORD src1_sel:WORD_1
    v_perm_b32 v74, v74, v126, s97
    v_perm_b32 v75, v75, v127, s97
    v_lshl_add_u64 v[74:75], v[74:75], 0, s[30:31]

    ds_add_rtn_u64 v[74:75], v27, v[74:75] offset:50000
    s_waitcnt lgkmcnt(8)
    v_or3_b32 v1, v60, v61, v1
    v_or3_b32 v1, v62, v63, v1
    v_or3_b32 v1, v64, v65, v1
    v_or3_b32 v1, v66, v67, v1
    s_waitcnt vmcnt(16)
    v_perm_b32 v60, v99, v98, s24
    v_perm_b32 v62, v100, v99, s25
    v_perm_b32 v64, v101, v100, s26
    v_perm_b32 v66, v112, v101, s27
    v_mov_b32 v20, v98
    v_alignbyte_b32 v21, v100, v99, 1
    v_alignbyte_b32 v22, v101, v100, 2
    v_alignbyte_b32 v23, v112, v101, 3
    v_lshlrev_b32_sdwa v60, 3, v60 dst_sel:WORD_0 dst_unused:UNUSED_PAD src0_sel:DWORD src1_sel:DWORD
    v_lshlrev_b32_sdwa v62, 3, v62 dst_sel:WORD_0 dst_unused:UNUSED_PAD src0_sel:DWORD src1_sel:DWORD
    v_lshlrev_b32_sdwa v64, 3, v64 dst_sel:WORD_0 dst_unused:UNUSED_PAD src0_sel:DWORD src1_sel:DWORD
    v_lshlrev_b32_sdwa v66, 3, v66 dst_sel:WORD_0 dst_unused:UNUSED_PAD src0_sel:DWORD src1_sel:DWORD
    s_cmp_lt_i32 s42, 2304
    s_cbranch_scc1 L_ufix_74
L_uback_75:

    v_subrev_co_u32 v20, s[72:73], 2.0, v20
    v_subrev_co_u32 v21, s[74:75], 2.0, v21
    v_subrev_co_u32 v22, s[76:77], 2.0, v22
    v_subrev_co_u32 v23, s[78:79], 2.0, v23
    s_mov_b64 exec, s[72:73]
    ds_read_b64 v[60:61], v60
    s_mov_b64 exec, s[74:75]
    ds_read_b64 v[62:63], v62
    s_mov_b64 exec, s[76:77]
    ds_read_b64 v[64:65], v64
    s_mov_b64 exec, s[78:79]
    ds_read_b64 v[66:67], v66
    s_mov_b64 exec, -1
    s_waitcnt lgkmcnt(4)
    v_or3_b32 v1, v68, v69, v1
    v_or3_b32 v1, v70, v71, v1
    v_or3_b32 v1, v72, v73, v1
    v_or3_b32 v1, v74, v75, v1
    s_waitcnt vmcnt(8)
    v_perm_b32 v68, v103, v102, s24
    v_perm_b32 v70, v104, v103, s25
    v_perm_b32 v72, v105, v104, s26
    v_perm_b32 v74, v113, v105, s27
    v_mov_b32 v24, v102
    v_alignbyte_b32 v25, v104, v103, 1
    v_alignbyte_b32 v26, v105, v104, 2
    v_alignbyte_b32 v27, v113, v105, 3
    v_lshlrev_b32_sdwa v68, 3, v68 dst_sel:WORD_0 dst_unused:UNUSED_PAD src0_sel:DWORD src1_sel:DWORD
    v_lshlrev_b32_sdwa v70, 3, v70 dst_sel:WORD_0 dst_unused:UNUSED_PAD src0_sel:DWORD src1_sel:DWORD
    v_lshlrev_b32_sdwa v72, 3, v72 dst_sel:WORD_0 dst_unused:UNUSED_PAD src0_sel:DWORD src1_sel:DWORD
    v_lshlrev_b32_sdwa v74, 3, v74 dst_sel:WORD_0 dst_unused:UNUSED_PAD src0_sel:DWORD src1_sel:DWORD
    s_cmp_lt_i32 s42, 2816
    s_cbranch_scc1 L_ufix_76
L_uback_77:

    v_subrev_co_u32 v24, s[80:81], 2.0, v24
    v_subrev_co_u32 v25, s[82:83], 2.0, v25
    v_subrev_co_u32 v26, s[84:85], 2.0, v26
    v_subrev_co_u32 v27, s[86:87], 2.0, v27
    s_mov_b64 exec, s[80:81]
    ds_read_b64 v[68:69], v68
    s_mov_b64 exec, s[82:83]
    ds_read_b64 v[70:71], v70
    s_mov_b64 exec, s[84:85]
    ds_read_b64 v[72:73], v72
    s_mov_b64 exec, s[86:87]
    ds_read_b64 v[74:75], v74
    s_mov_b64 exec, -1
    buffer_load_dwordx4 v[76:79], v3, s[12:15], s43 offen
    s_add_u32 s52, s43, 16384
    buffer_load_dwordx4 v[80:83], v3, s[12:15], s52 offen
    s_add_u32 s52, s43, 32768
    buffer_load_dwordx4 v[84:87], v3, s[12:15], s52 offen
    s_add_u32 s52, s43, 49152
    v_lshlrev_b32 v119, 2, v0
    buffer_load_dword v88, v119, s[12:15], s52 offen
    s_waitcnt vmcnt(10)
    v_perm_b32 v28, v5, v4, s24
    v_perm_b32 v30, v6, v5, s25
    v_perm_b32 v32, v7, v6, s26
    v_perm_b32 v34, v35, v7, s27
    v_alignbyte_b32 v5, v6, v5, 1
    v_alignbyte_b32 v6, v7, v6, 2
    v_alignbyte_b32 v7, v35, v7, 3
    v_lshlrev_b32_sdwa v28, 3, v28 dst_sel:WORD_0 dst_unused:UNUSED_PAD src0_sel:DWORD src1_sel:DWORD
    v_lshlrev_b32_sdwa v30, 3, v30 dst_sel:WORD_0 dst_unused:UNUSED_PAD src0_sel:DWORD src1_sel:DWORD
    v_lshlrev_b32_sdwa v32, 3, v32 dst_sel:WORD_0 dst_unused:UNUSED_PAD src0_sel:DWORD src1_sel:DWORD
    v_lshlrev_b32_sdwa v34, 3, v34 dst_sel:WORD_0 dst_unused:UNUSED_PAD src0_sel:DWORD src1_sel:DWORD
    s_cmp_lt_i32 s42, 256
    s_cbranch_scc1 L_ufix_78
L_uback_79:

    v_subrev_co_u32 v4, s[64:65], 2.0, v4
    v_subrev_co_u32 v5, s[66:67], 2.0, v5
    v_subrev_co_u32 v6, s[68:69], 2.0, v6
    v_subrev_co_u32 v7, s[70:71], 2.0, v7
    s_mov_b64 exec, s[64:65]
    ds_read_b64 v[28:29], v28
    s_mov_b64 exec, s[66:67]
    ds_read_b64 v[30:31], v30
    s_mov_b64 exec, s[68:69]
    ds_read_b64 v[32:33], v32
    s_mov_b64 exec, s[70:71]
    ds_read_b64 v[34:35], v34
    s_mov_b64 exec, -1
    s_waitcnt vmcnt(8)
    v_perm_b32 v36, v9, v8, s24
    v_perm_b32 v38, v10, v9, s25
    v_perm_b32 v40, v11, v10, s26
    v_perm_b32 v42, v43, v11, s27
    v_alignbyte_b32 v9, v10, v9, 1
    v_alignbyte_b32 v10, v11, v10, 2
    v_alignbyte_b32 v11, v43, v11, 3
    v_lshlrev_b32_sdwa v36, 3, v36 dst_sel:WORD_0 dst_unused:UNUSED_PAD src0_sel:DWORD src1_sel:DWORD
    v_lshlrev_b32_sdwa v38, 3, v38 dst_sel:WORD_0 dst_unused:UNUSED_PAD src0_sel:DWORD src1_sel:DWORD
    v_lshlrev_b32_sdwa v40, 3, v40 dst_sel:WORD_0 dst_unused:UNUSED_PAD src0_sel:DWORD src1_sel:DWORD
    v_lshlrev_b32_sdwa v42, 3, v42 dst_sel:WORD_0 dst_unused:UNUSED_PAD src0_sel:DWORD src1_sel:DWORD
    s_cmp_lt_i32 s42, 768
    s_cbranch_scc1 L_ufix_80
L_uback_81:

    v_subrev_co_u32 v8, s[72:73], 2.0, v8
    v_subrev_co_u32 v9, s[74:75], 2.0, v9
    v_subrev_co_u32 v10, s[76:77], 2.0, v10
    v_subrev_co_u32 v11, s[78:79], 2.0, v11
    s_mov_b64 exec, s[72:73]
    ds_read_b64 v[36:37], v36
    s_mov_b64 exec, s[74:75]
    ds_read_b64 v[38:39], v38
    s_mov_b64 exec, s[76:77]
    ds_read_b64 v[40:41], v40
    s_mov_b64 exec, s[78:79]
    ds_read_b64 v[42:43], v42
    s_mov_b64 exec, -1
    s_mov_b32 s38, s5
    s_add_u32 s50, s50, 200000
    s_branch L_batch_61
L_bend_62:

    s_waitcnt vmcnt(0)
    s_load_dwordx2 s[68:69], s[0:1], 24
    s_load_dwordx4 s[88:91], s[0:1], 72
    s_load_dwordx2 s[76:77], s[0:1], 88
    s_load_dwordx2 s[80:81], s[0:1], 96
    s_mov_b32 s70, 1600000
    s_mov_b32 s71, 0x20000
    s_mov_b32 s78, 6400000
    s_mov_b32 s79, 0x20000
    s_movk_i32 s82, 256
    s_mov_b32 s83, 0x20000
    s_lshl_b32 s48, s36, 2
    s_mov_b32 s41, s37

    s_add_u32 s84, s6, 8896512
    s_addc_u32 s85, s7, 0
    s_mov_b32 s86, 76800000
    s_mov_b32 s87, 0x20000
    s_add_u32 s72, s6, 393216
    s_addc_u32 s73, s7, 0
    s_mov_b32 s74, 2097152
    s_mov_b32 s75, 0x20000
    s_waitcnt lgkmcnt(15)
    v_mad_i32_i16 v120, v28, v4, s96
    v_mad_i32_i16 v28, v28, v4, s96 op_sel:[1,0,0,0]
    v_mad_i32_i16 v121, v29, v4, s96
    v_mad_i32_i16 v29, v29, v4, s96 op_sel:[1,0,0,0]
    v_lshlrev_b32_sdwa v4, 3, v4 dst_sel:DWORD dst_unused:UNUSED_PAD src0_sel:DWORD src1_sel:WORD_1
    v_perm_b32 v28, v28, v120, s97
    v_perm_b32 v29, v29, v121, s97
    v_lshl_add_u64 v[28:29], v[28:29], 0, s[30:31]

    ds_add_rtn_u64 v[28:29], v4, v[28:29] offset:50000
    v_mad_i32_i16 v122, v30, v5, s96
    v_mad_i32_i16 v30, v30, v5, s96 op_sel:[1,0,0,0]
    v_mad_i32_i16 v123, v31, v5, s96
    v_mad_i32_i16 v31, v31, v5, s96 op_sel:[1,0,0,0]
    v_lshlrev_b32_sdwa v5, 3, v5 dst_sel:DWORD dst_unused:UNUSED_PAD src0_sel:DWORD src1_sel:WORD_1
    v_perm_b32 v30, v30, v122, s97
    v_perm_b32 v31, v31, v123, s97
    v_lshl_add_u64 v[30:31], v[30:31], 0, s[30:31]

    ds_add_rtn_u64 v[30:31], v5, v[30:31] offset:50000
    v_mad_i32_i16 v124, v32, v6, s96
    v_mad_i32_i16 v32, v32, v6, s96 op_sel:[1,0,0,0]
    v_mad_i32_i16 v125, v33, v6, s96
    v_mad_i32_i16 v33, v33, v6, s96 op_sel:[1,0,0,0]
    v_lshlrev_b32_sdwa v6, 3, v6 dst_sel:DWORD dst_unused:UNUSED_PAD src0_sel:DWORD src1_sel:WORD_1
    v_perm_b32 v32, v32, v124, s97
    v_perm_b32 v33, v33, v125, s97
    v_lshl_add_u64 v[32:33], v[32:33], 0, s[30:31]

    ds_add_rtn_u64 v[32:33], v6, v[32:33] offset:50000
    v_mad_i32_i16 v126, v34, v7, s96
    v_mad_i32_i16 v34, v34, v7, s96 op_sel:[1,0,0,0]
    v_mad_i32_i16 v127, v35, v7, s96
    v_mad_i32_i16 v35, v35, v7, s96 op_sel:[1,0,0,0]
    v_lshlrev_b32_sdwa v7, 3, v7 dst_sel:DWORD dst_unused:UNUSED_PAD src0_sel:DWORD src1_sel:WORD_1
    v_perm_b32 v34, v34, v126, s97
    v_perm_b32 v35, v35, v127, s97
    v_lshl_add_u64 v[34:35], v[34:35], 0, s[30:31]

    ds_add_rtn_u64 v[34:35], v7, v[34:35] offset:50000
    s_waitcnt lgkmcnt(0)
    s_load_dwordx8 s[12:19], s[88:89], 0
    s_load_dwordx8 s[56:63], s[90:91], 0

    s_mul_i32 s28, s41, 3125
    s_add_u32 s29, s28, 3126
    s_add_u32 s28, s28, 1
    s_lshr_b32 s28, s28, 1
    s_lshr_b32 s29, s29, 1
    s_sub_u32 s29, s29, s28
    s_sub_u32 s5, s29, 782
    s_mul_i32 s3, s36, 6250
    v_add_u32 v78, s28, v0
    v_mov_b32 v82, 0x2000000
    v_add_u32 v79, 782, v78
    v_cmp_gt_u32 vcc, 782, v0
    v_add_u32 v76, s3, v78
    v_add_u32 v77, s3, v79
    v_cndmask_b32 v76, v82, v76, vcc
    v_cmp_gt_u32 vcc, s5, v0
    v_lshlrev_b32 v78, 4, v78
    v_lshlrev_b32 v79, 4, v79
    v_cndmask_b32 v77, v82, v77, vcc
    v_lshlrev_b32 v80, 2, v76
    v_lshlrev_b32 v76, 4, v76
    v_lshlrev_b32 v81, 2, v77
    v_lshlrev_b32 v77, 4, v77
    buffer_load_dword v80, v80, s[68:71], 0 offen
    buffer_load_dword v81, v81, s[68:71], 0 offen
    buffer_load_dwordx4 v[86:89], v76, s[8:11], 0 offen
    buffer_load_dwordx4 v[90:93], v77, s[8:11], 0 offen

    v_mad_i32_i16 v120, v36, v8, s96
    v_mad_i32_i16 v36, v36, v8, s96 op_sel:[1,0,0,0]
    v_mad_i32_i16 v121, v37, v8, s96
    v_mad_i32_i16 v37, v37, v8, s96 op_sel:[1,0,0,0]
    v_lshlrev_b32_sdwa v8, 3, v8 dst_sel:DWORD dst_unused:UNUSED_PAD src0_sel:DWORD src1_sel:WORD_1
    v_perm_b32 v36, v36, v120, s97
    v_perm_b32 v37, v37, v121, s97
    v_lshl_add_u64 v[36:37], v[36:37], 0, s[30:31]

    ds_add_rtn_u64 v[36:37], v8, v[36:37] offset:50000
    v_mad_i32_i16 v122, v38, v9, s96
    v_mad_i32_i16 v38, v38, v9, s96 op_sel:[1,0,0,0]
    v_mad_i32_i16 v123, v39, v9, s96
    v_mad_i32_i16 v39, v39, v9, s96 op_sel:[1,0,0,0]
    v_lshlrev_b32_sdwa v9, 3, v9 dst_sel:DWORD dst_unused:UNUSED_PAD src0_sel:DWORD src1_sel:WORD_1
    v_perm_b32 v38, v38, v122, s97
    v_perm_b32 v39, v39, v123, s97
    v_lshl_add_u64 v[38:39], v[38:39], 0, s[30:31]

    ds_add_rtn_u64 v[38:39], v9, v[38:39] offset:50000
    v_mad_i32_i16 v124, v40, v10, s96
    v_mad_i32_i16 v40, v40, v10, s96 op_sel:[1,0,0,0]
    v_mad_i32_i16 v125, v41, v10, s96
    v_mad_i32_i16 v41, v41, v10, s96 op_sel:[1,0,0,0]
    v_lshlrev_b32_sdwa v10, 3, v10 dst_sel:DWORD dst_unused:UNUSED_PAD src0_sel:DWORD src1_sel:WORD_1
    v_perm_b32 v40, v40, v124, s97
    v_perm_b32 v41, v41, v125, s97
    v_lshl_add_u64 v[40:41], v[40:41], 0, s[30:31]

    ds_add_rtn_u64 v[40:41], v10, v[40:41] offset:50000
    v_mad_i32_i16 v126, v42, v11, s96
    v_mad_i32_i16 v42, v42, v11, s96 op_sel:[1,0,0,0]
    v_mad_i32_i16 v127, v43, v11, s96
    v_mad_i32_i16 v43, v43, v11, s96 op_sel:[1,0,0,0]
    v_lshlrev_b32_sdwa v11, 3, v11 dst_sel:DWORD dst_unused:UNUSED_PAD src0_sel:DWORD src1_sel:WORD_1
    v_perm_b32 v42, v42, v126, s97
    v_perm_b32 v43, v43, v127, s97
    v_lshl_add_u64 v[42:43], v[42:43], 0, s[30:31]

    ds_add_rtn_u64 v[42:43], v11, v[42:43] offset:50000
    v_or3_b32 v1, v28, v29, v1
    v_or3_b32 v1, v30, v31, v1
    v_or3_b32 v1, v32, v33, v1
    v_or3_b32 v1, v34, v35, v1
    v_mad_i32_i16 v120, v44, v12, s96
    v_mad_i32_i16 v44, v44, v12, s96 op_sel:[1,0,0,0]
    v_mad_i32_i16 v121, v45, v12, s96
    v_mad_i32_i16 v45, v45, v12, s96 op_sel:[1,0,0,0]
    v_lshlrev_b32_sdwa v12, 3, v12 dst_sel:DWORD dst_unused:UNUSED_PAD src0_sel:DWORD src1_sel:WORD_1
    v_perm_b32 v44, v44, v120, s97
    v_perm_b32 v45, v45, v121, s97
    v_lshl_add_u64 v[44:45], v[44:45], 0, s[30:31]

    ds_add_rtn_u64 v[44:45], v12, v[44:45] offset:50000
    v_mad_i32_i16 v122, v46, v13, s96
    v_mad_i32_i16 v46, v46, v13, s96 op_sel:[1,0,0,0]
    v_mad_i32_i16 v123, v47, v13, s96
    v_mad_i32_i16 v47, v47, v13, s96 op_sel:[1,0,0,0]
    v_lshlrev_b32_sdwa v13, 3, v13 dst_sel:DWORD dst_unused:UNUSED_PAD src0_sel:DWORD src1_sel:WORD_1
    v_perm_b32 v46, v46, v122, s97
    v_perm_b32 v47, v47, v123, s97
    v_lshl_add_u64 v[46:47], v[46:47], 0, s[30:31]

    ds_add_rtn_u64 v[46:47], v13, v[46:47] offset:50000
    v_mad_i32_i16 v124, v48, v14, s96
    v_mad_i32_i16 v48, v48, v14, s96 op_sel:[1,0,0,0]
    v_mad_i32_i16 v125, v49, v14, s96
    v_mad_i32_i16 v49, v49, v14, s96 op_sel:[1,0,0,0]
    v_lshlrev_b32_sdwa v14, 3, v14 dst_sel:DWORD dst_unused:UNUSED_PAD src0_sel:DWORD src1_sel:WORD_1
    v_perm_b32 v48, v48, v124, s97
    v_perm_b32 v49, v49, v125, s97
    v_lshl_add_u64 v[48:49], v[48:49], 0, s[30:31]

    ds_add_rtn_u64 v[48:49], v14, v[48:49] offset:50000
    v_mad_i32_i16 v126, v50, v15, s96
    v_mad_i32_i16 v50, v50, v15, s96 op_sel:[1,0,0,0]
    v_mad_i32_i16 v127, v51, v15, s96
    v_mad_i32_i16 v51, v51, v15, s96 op_sel:[1,0,0,0]
    v_lshlrev_b32_sdwa v15, 3, v15 dst_sel:DWORD dst_unused:UNUSED_PAD src0_sel:DWORD src1_sel:WORD_1
    v_perm_b32 v50, v50, v126, s97
    v_perm_b32 v51, v51, v127, s97
    v_lshl_add_u64 v[50:51], v[50:51], 0, s[30:31]

    ds_add_rtn_u64 v[50:51], v15, v[50:51] offset:50000
    s_waitcnt lgkmcnt(4)
    v_or3_b32 v1, v36, v37, v1
    v_or3_b32 v1, v38, v39, v1
    v_or3_b32 v1, v40, v41, v1
    v_or3_b32 v1, v42, v43, v1
    v_mad_i32_i16 v120, v52, v16, s96
    v_mad_i32_i16 v52, v52, v16, s96 op_sel:[1,0,0,0]
    v_mad_i32_i16 v121, v53, v16, s96
    v_mad_i32_i16 v53, v53, v16, s96 op_sel:[1,0,0,0]
    v_lshlrev_b32_sdwa v16, 3, v16 dst_sel:DWORD dst_unused:UNUSED_PAD src0_sel:DWORD src1_sel:WORD_1
    v_perm_b32 v52, v52, v120, s97
    v_perm_b32 v53, v53, v121, s97
    v_lshl_add_u64 v[52:53], v[52:53], 0, s[30:31]

    ds_add_rtn_u64 v[52:53], v16, v[52:53] offset:50000
    v_mad_i32_i16 v122, v54, v17, s96
    v_mad_i32_i16 v54, v54, v17, s96 op_sel:[1,0,0,0]
    v_mad_i32_i16 v123, v55, v17, s96
    v_mad_i32_i16 v55, v55, v17, s96 op_sel:[1,0,0,0]
    v_lshlrev_b32_sdwa v17, 3, v17 dst_sel:DWORD dst_unused:UNUSED_PAD src0_sel:DWORD src1_sel:WORD_1
    v_perm_b32 v54, v54, v122, s97
    v_perm_b32 v55, v55, v123, s97
    v_lshl_add_u64 v[54:55], v[54:55], 0, s[30:31]

    ds_add_rtn_u64 v[54:55], v17, v[54:55] offset:50000
    v_mad_i32_i16 v124, v56, v18, s96
    v_mad_i32_i16 v56, v56, v18, s96 op_sel:[1,0,0,0]
    v_mad_i32_i16 v125, v57, v18, s96
    v_mad_i32_i16 v57, v57, v18, s96 op_sel:[1,0,0,0]
    v_lshlrev_b32_sdwa v18, 3, v18 dst_sel:DWORD dst_unused:UNUSED_PAD src0_sel:DWORD src1_sel:WORD_1
    v_perm_b32 v56, v56, v124, s97
    v_perm_b32 v57, v57, v125, s97
    v_lshl_add_u64 v[56:57], v[56:57], 0, s[30:31]

    ds_add_rtn_u64 v[56:57], v18, v[56:57] offset:50000
    v_mad_i32_i16 v126, v58, v19, s96
    v_mad_i32_i16 v58, v58, v19, s96 op_sel:[1,0,0,0]
    v_mad_i32_i16 v127, v59, v19, s96
    v_mad_i32_i16 v59, v59, v19, s96 op_sel:[1,0,0,0]
    v_lshlrev_b32_sdwa v19, 3, v19 dst_sel:DWORD dst_unused:UNUSED_PAD src0_sel:DWORD src1_sel:WORD_1
    v_perm_b32 v58, v58, v126, s97
    v_perm_b32 v59, v59, v127, s97
    v_lshl_add_u64 v[58:59], v[58:59], 0, s[30:31]

    ds_add_rtn_u64 v[58:59], v19, v[58:59] offset:50000
    s_waitcnt lgkmcnt(4)
    v_or3_b32 v1, v44, v45, v1
    v_or3_b32 v1, v46, v47, v1
    v_or3_b32 v1, v48, v49, v1
    v_or3_b32 v1, v50, v51, v1
    s_waitcnt vmcnt(2)
    v_lshlrev_b32_sdwa v82, 5, v80 dst_sel:DWORD dst_unused:UNUSED_PAD src0_sel:DWORD src1_sel:WORD_0
    v_lshlrev_b32_sdwa v83, 5, v80 dst_sel:DWORD dst_unused:UNUSED_PAD src0_sel:DWORD src1_sel:WORD_1
    v_lshlrev_b32_sdwa v84, 5, v81 dst_sel:DWORD dst_unused:UNUSED_PAD src0_sel:DWORD src1_sel:WORD_0
    v_lshlrev_b32_sdwa v85, 5, v81 dst_sel:DWORD dst_unused:UNUSED_PAD src0_sel:DWORD src1_sel:WORD_1
    buffer_load_dwordx4 v[94:97], v82, s[72:75], 0 offen
    buffer_load_dwordx2 v[110:111], v82, s[72:75], 0 offen offset:16

    buffer_load_dwordx4 v[98:101], v83, s[72:75], 0 offen
    buffer_load_dwordx2 v[112:113], v83, s[72:75], 0 offen offset:16

    buffer_load_dwordx4 v[102:105], v84, s[72:75], 0 offen
    buffer_load_dwordx2 v[114:115], v84, s[72:75], 0 offen offset:16

    buffer_load_dwordx4 v[106:109], v85, s[72:75], 0 offen
    buffer_load_dwordx2 v[116:117], v85, s[72:75], 0 offen offset:16

    v_mad_i32_i16 v120, v60, v20, s96
    v_mad_i32_i16 v60, v60, v20, s96 op_sel:[1,0,0,0]
    v_mad_i32_i16 v121, v61, v20, s96
    v_mad_i32_i16 v61, v61, v20, s96 op_sel:[1,0,0,0]
    v_lshlrev_b32_sdwa v20, 3, v20 dst_sel:DWORD dst_unused:UNUSED_PAD src0_sel:DWORD src1_sel:WORD_1
    v_perm_b32 v60, v60, v120, s97
    v_perm_b32 v61, v61, v121, s97
    v_lshl_add_u64 v[60:61], v[60:61], 0, s[30:31]

    ds_add_rtn_u64 v[60:61], v20, v[60:61] offset:50000
    v_mad_i32_i16 v122, v62, v21, s96
    v_mad_i32_i16 v62, v62, v21, s96 op_sel:[1,0,0,0]
    v_mad_i32_i16 v123, v63, v21, s96
    v_mad_i32_i16 v63, v63, v21, s96 op_sel:[1,0,0,0]
    v_lshlrev_b32_sdwa v21, 3, v21 dst_sel:DWORD dst_unused:UNUSED_PAD src0_sel:DWORD src1_sel:WORD_1
    v_perm_b32 v62, v62, v122, s97
    v_perm_b32 v63, v63, v123, s97
    v_lshl_add_u64 v[62:63], v[62:63], 0, s[30:31]

    ds_add_rtn_u64 v[62:63], v21, v[62:63] offset:50000
    v_mad_i32_i16 v124, v64, v22, s96
    v_mad_i32_i16 v64, v64, v22, s96 op_sel:[1,0,0,0]
    v_mad_i32_i16 v125, v65, v22, s96
    v_mad_i32_i16 v65, v65, v22, s96 op_sel:[1,0,0,0]
    v_lshlrev_b32_sdwa v22, 3, v22 dst_sel:DWORD dst_unused:UNUSED_PAD src0_sel:DWORD src1_sel:WORD_1
    v_perm_b32 v64, v64, v124, s97
    v_perm_b32 v65, v65, v125, s97
    v_lshl_add_u64 v[64:65], v[64:65], 0, s[30:31]

    ds_add_rtn_u64 v[64:65], v22, v[64:65] offset:50000
    v_mad_i32_i16 v126, v66, v23, s96
    v_mad_i32_i16 v66, v66, v23, s96 op_sel:[1,0,0,0]
    v_mad_i32_i16 v127, v67, v23, s96
    v_mad_i32_i16 v67, v67, v23, s96 op_sel:[1,0,0,0]
    v_lshlrev_b32_sdwa v23, 3, v23 dst_sel:DWORD dst_unused:UNUSED_PAD src0_sel:DWORD src1_sel:WORD_1
    v_perm_b32 v66, v66, v126, s97
    v_perm_b32 v67, v67, v127, s97
    v_lshl_add_u64 v[66:67], v[66:67], 0, s[30:31]

    ds_add_rtn_u64 v[66:67], v23, v[66:67] offset:50000
    s_waitcnt lgkmcnt(4)
    v_or3_b32 v1, v52, v53, v1
    v_or3_b32 v1, v54, v55, v1
    v_or3_b32 v1, v56, v57, v1
    v_or3_b32 v1, v58, v59, v1
    v_mad_i32_i16 v120, v68, v24, s96
    v_mad_i32_i16 v68, v68, v24, s96 op_sel:[1,0,0,0]
    v_mad_i32_i16 v121, v69, v24, s96
    v_mad_i32_i16 v69, v69, v24, s96 op_sel:[1,0,0,0]
    v_lshlrev_b32_sdwa v24, 3, v24 dst_sel:DWORD dst_unused:UNUSED_PAD src0_sel:DWORD src1_sel:WORD_1
    v_perm_b32 v68, v68, v120, s97
    v_perm_b32 v69, v69, v121, s97
    v_lshl_add_u64 v[68:69], v[68:69], 0, s[30:31]

    ds_add_rtn_u64 v[68:69], v24, v[68:69] offset:50000
    v_mad_i32_i16 v122, v70, v25, s96
    v_mad_i32_i16 v70, v70, v25, s96 op_sel:[1,0,0,0]
    v_mad_i32_i16 v123, v71, v25, s96
    v_mad_i32_i16 v71, v71, v25, s96 op_sel:[1,0,0,0]
    v_lshlrev_b32_sdwa v25, 3, v25 dst_sel:DWORD dst_unused:UNUSED_PAD src0_sel:DWORD src1_sel:WORD_1
    v_perm_b32 v70, v70, v122, s97
    v_perm_b32 v71, v71, v123, s97
    v_lshl_add_u64 v[70:71], v[70:71], 0, s[30:31]

    ds_add_rtn_u64 v[70:71], v25, v[70:71] offset:50000
    v_mad_i32_i16 v124, v72, v26, s96
    v_mad_i32_i16 v72, v72, v26, s96 op_sel:[1,0,0,0]
    v_mad_i32_i16 v125, v73, v26, s96
    v_mad_i32_i16 v73, v73, v26, s96 op_sel:[1,0,0,0]
    v_lshlrev_b32_sdwa v26, 3, v26 dst_sel:DWORD dst_unused:UNUSED_PAD src0_sel:DWORD src1_sel:WORD_1
    v_perm_b32 v72, v72, v124, s97
    v_perm_b32 v73, v73, v125, s97
    v_lshl_add_u64 v[72:73], v[72:73], 0, s[30:31]

    ds_add_rtn_u64 v[72:73], v26, v[72:73] offset:50000
    v_mad_i32_i16 v126, v74, v27, s96
    v_mad_i32_i16 v74, v74, v27, s96 op_sel:[1,0,0,0]
    v_mad_i32_i16 v127, v75, v27, s96
    v_mad_i32_i16 v75, v75, v27, s96 op_sel:[1,0,0,0]
    v_lshlrev_b32_sdwa v27, 3, v27 dst_sel:DWORD dst_unused:UNUSED_PAD src0_sel:DWORD src1_sel:WORD_1
    v_perm_b32 v74, v74, v126, s97
    v_perm_b32 v75, v75, v127, s97
    v_lshl_add_u64 v[74:75], v[74:75], 0, s[30:31]

    ds_add_rtn_u64 v[74:75], v27, v[74:75] offset:50000
    s_waitcnt lgkmcnt(4)
    v_or3_b32 v1, v60, v61, v1
    v_or3_b32 v1, v62, v63, v1
    v_or3_b32 v1, v64, v65, v1
    v_or3_b32 v1, v66, v67, v1
    s_waitcnt lgkmcnt(0)
    v_or3_b32 v1, v68, v69, v1
    v_or3_b32 v1, v70, v71, v1
    v_or3_b32 v1, v72, v73, v1
    v_or3_b32 v1, v74, v75, v1
    s_barrier

    v_add_u32 v40, 50000, v3
    v_add_u32 v41, 115536, v3
    v_cmp_gt_u32 vcc, 106, v0

    v_mov_b32 v28, 0
    v_mov_b32 v29, 0
    v_mov_b32 v30, 0
    v_mov_b32 v31, 0
    ds_read_b128 v[4:7], v40 offset:0
    ds_read_b128 v[8:11], v40 offset:16384
    ds_read_b128 v[12:15], v40 offset:32768
    ds_read_b128 v[16:19], v40 offset:49152
    ds_read_b128 v[20:23], v41 offset:0
    ds_read_b128 v[24:27], v41 offset:16384
    s_mov_b64 exec, vcc
    ds_read_b128 v[28:31], v41 offset:32768
    s_mov_b64 exec, -1
    s_mul_i32 s3, s37, 6400000
    s_mul_i32 s5, s36, 100000
    s_add_u32 s3, s3, s5
    s_add_u32 s3, s3, 8896512
    v_bfrev_b32 v42, 1

    s_add_u32 s20, s6, s3
    s_addc_u32 s21, s7, 0
    s_mov_b32 s22, 100000
    s_mov_b32 s23, 0x20000
    s_sub_u32 s3, 0, s28
    v_add_u32 v43, s3, v0
    v_cmp_gt_u32 vcc, s29, v43
    s_mov_b32 s3, 0
    s_waitcnt lgkmcnt(6)
    v_cndmask_b32 v43, v3, v42, vcc
    buffer_store_dwordx4 v[4:7], v43, s[20:23], s3 offen sc1

    s_sub_u32 s3, 1024, s28
    v_add_u32 v43, s3, v0
    v_cmp_gt_u32 vcc, s29, v43
    s_mov_b32 s3, 16384
    s_waitcnt lgkmcnt(5)
    v_cndmask_b32 v43, v3, v42, vcc
    buffer_store_dwordx4 v[8:11], v43, s[20:23], s3 offen sc1

    s_sub_u32 s3, 2048, s28
    v_add_u32 v43, s3, v0
    v_cmp_gt_u32 vcc, s29, v43
    s_mov_b32 s3, 32768
    s_waitcnt lgkmcnt(4)
    v_cndmask_b32 v43, v3, v42, vcc
    buffer_store_dwordx4 v[12:15], v43, s[20:23], s3 offen sc1

    s_sub_u32 s3, 3072, s28
    v_add_u32 v43, s3, v0
    v_cmp_gt_u32 vcc, s29, v43
    s_mov_b32 s3, 49152
    s_waitcnt lgkmcnt(3)
    v_cndmask_b32 v43, v3, v42, vcc
    buffer_store_dwordx4 v[16:19], v43, s[20:23], s3 offen sc1

    s_sub_u32 s3, 4096, s28
    v_add_u32 v43, s3, v0
    v_cmp_gt_u32 vcc, s29, v43
    s_mov_b32 s3, 65536
    s_waitcnt lgkmcnt(2)
    v_cndmask_b32 v43, v3, v42, vcc
    buffer_store_dwordx4 v[20:23], v43, s[20:23], s3 offen sc1

    s_sub_u32 s3, 5120, s28
    v_add_u32 v43, s3, v0
    v_cmp_gt_u32 vcc, s29, v43
    s_mov_b32 s3, 81920
    s_waitcnt lgkmcnt(1)
    v_cndmask_b32 v43, v3, v42, vcc
    buffer_store_dwordx4 v[24:27], v43, s[20:23], s3 offen sc1

    s_sub_u32 s3, 6144, s28
    v_add_u32 v43, s3, v0
    v_cmp_gt_u32 vcc, s29, v43
    s_mov_b32 s3, 98304
    s_waitcnt lgkmcnt(0)
    v_cndmask_b32 v43, v3, v42, vcc
    buffer_store_dwordx4 v[28:31], v43, s[20:23], s3 offen sc1

    v_or3_b32 v1, v4, v5, v1
    v_or3_b32 v1, v6, v7, v1
    v_or3_b32 v1, v8, v9, v1
    v_or3_b32 v1, v10, v11, v1
    v_or3_b32 v1, v12, v13, v1
    v_or3_b32 v1, v14, v15, v1
    v_or3_b32 v1, v16, v17, v1
    v_or3_b32 v1, v18, v19, v1
    v_or3_b32 v1, v20, v21, v1
    v_or3_b32 v1, v22, v23, v1
    v_or3_b32 v1, v24, v25, v1
    v_or3_b32 v1, v26, v27, v1
    v_or3_b32 v1, v28, v29, v1
    v_or3_b32 v1, v30, v31, v1
    v_and_b32 v1, 0x80008000, v1
    v_cmp_ne_u32 vcc, 0, v1
    v_mov_b32 v40, 150024
    v_mov_b32 v41, 1
    s_cbranch_vccz L_nf_82
    ds_write_b32 v40, v41
L_nf_82:
    s_mov_b32 s33, 1
    s_mov_b32 s49, s37
    s_waitcnt vmcnt(0) lgkmcnt(0)

    s_barrier
    ds_read_b32 v41, v40
    s_waitcnt lgkmcnt(0)
    v_readfirstlane_b32 s3, v41
    s_nop 1
    s_cmp_lg_u32 s3, 0
    s_cbranch_scc1 L_p2slow_48

L_meet_84:
    v_readfirstlane_b32 s3, v0
    v_mov_b32 v118, 150016
    s_nop 0
    s_cmp_eq_u32 s3, 960
    s_cbranch_scc1 L_sync_91
L_bcast_86:
    s_barrier

    ds_read_b32 v119, v118
    s_waitcnt lgkmcnt(0)
    v_readfirstlane_b32 s35, v119
    s_nop 1
    s_bitcmp1_b32 s35, 16
    s_cbranch_scc1 L_fend_92
L_post_88:
    v_cmp_gt_u32 vcc, 782, v0
    s_mov_b64 exec, vcc
    s_cbranch_execz L_postend_89

    s_cmp_eq_u32 s49, 0
    s_cbranch_scc1 L_own_98
    s_mov_b32 s3, 0
    buffer_load_dwordx4 v[36:39], v76, s[84:87], s3 offen sc1
    buffer_load_dwordx4 v[52:55], v77, s[84:87], s3 offen sc1
L_obk_99:
    s_cmp_eq_u32 s49, 1
    s_cbranch_scc1 L_own_100
    s_mov_b32 s3, 6400000
    buffer_load_dwordx4 v[40:43], v76, s[84:87], s3 offen sc1
    buffer_load_dwordx4 v[56:59], v77, s[84:87], s3 offen sc1
L_obk_101:
    s_cmp_eq_u32 s49, 2
    s_cbranch_scc1 L_own_102
    s_mov_b32 s3, 12800000
    buffer_load_dwordx4 v[44:47], v76, s[84:87], s3 offen sc1
    buffer_load_dwordx4 v[60:63], v77, s[84:87], s3 offen sc1
L_obk_103:
    s_cmp_eq_u32 s49, 3
    s_cbranch_scc1 L_own_104
    s_mov_b32 s3, 19200000
    buffer_load_dwordx4 v[48:51], v76, s[84:87], s3 offen sc1
    buffer_load_dwordx4 v[64:67], v77, s[84:87], s3 offen sc1
L_obk_105:
    s_and_b32 s3, s35, 0xf0
    s_waitcnt vmcnt(0) lgkmcnt(0)
    s_cbranch_scc1 L_fgen_106

    v_add_u32 v36, v36, v40
    v_add_u32 v44, v44, v48
    v_add_u32 v37, v37, v41
    v_add_u32 v45, v45, v49
    v_add_u32 v38, v38, v42
    v_add_u32 v46, v46, v50
    v_add_u32 v39, v39, v43
    v_add_u32 v47, v47, v51
    v_add_u32_sdwa v4, v36, v44 dst_sel:DWORD dst_unused:UNUSED_PAD src0_sel:WORD_0 src1_sel:WORD_0
    v_add_u32_sdwa v5, v36, v44 dst_sel:DWORD dst_unused:UNUSED_PAD src0_sel:WORD_1 src1_sel:WORD_1
    v_add_u32_sdwa v6, v37, v45 dst_sel:DWORD dst_unused:UNUSED_PAD src0_sel:WORD_0 src1_sel:WORD_0
    v_add_u32_sdwa v7, v37, v45 dst_sel:DWORD dst_unused:UNUSED_PAD src0_sel:WORD_1 src1_sel:WORD_1
    v_add_u32_sdwa v8, v38, v46 dst_sel:DWORD dst_unused:UNUSED_PAD src0_sel:WORD_0 src1_sel:WORD_0
    v_add_u32_sdwa v9, v38, v46 dst_sel:DWORD dst_unused:UNUSED_PAD src0_sel:WORD_1 src1_sel:WORD_1
    v_add_u32_sdwa v10, v39, v47 dst_sel:DWORD dst_unused:UNUSED_PAD src0_sel:WORD_0 src1_sel:WORD_0
    v_add_u32_sdwa v11, v39, v47 dst_sel:DWORD dst_unused:UNUSED_PAD src0_sel:WORD_1 src1_sel:WORD_1
    v_add_u32 v52, v52, v56
    v_add_u32 v60, v60, v64
    v_add_u32 v53, v53, v57
    v_add_u32 v61, v61, v65
    v_add_u32 v54, v54, v58
    v_add_u32 v62, v62, v66
    v_add_u32 v55, v55, v59
    v_add_u32 v63, v63, v67
    v_add_u32_sdwa v12, v52, v60 dst_sel:DWORD dst_unused:UNUSED_PAD src0_sel:WORD_0 src1_sel:WORD_0
    v_add_u32_sdwa v13, v52, v60 dst_sel:DWORD dst_unused:UNUSED_PAD src0_sel:WORD_1 src1_sel:WORD_1
    v_add_u32_sdwa v14, v53, v61 dst_sel:DWORD dst_unused:UNUSED_PAD src0_sel:WORD_0 src1_sel:WORD_0
    v_add_u32_sdwa v15, v53, v61 dst_sel:DWORD dst_unused:UNUSED_PAD src0_sel:WORD_1 src1_sel:WORD_1
    v_add_u32_sdwa v16, v54, v62 dst_sel:DWORD dst_unused:UNUSED_PAD src0_sel:WORD_0 src1_sel:WORD_0
    v_add_u32_sdwa v17, v54, v62 dst_sel:DWORD dst_unused:UNUSED_PAD src0_sel:WORD_1 src1_sel:WORD_1
    v_add_u32_sdwa v18, v55, v63 dst_sel:DWORD dst_unused:UNUSED_PAD src0_sel:WORD_0 src1_sel:WORD_0
    v_add_u32_sdwa v19, v55, v63 dst_sel:DWORD dst_unused:UNUSED_PAD src0_sel:WORD_1 src1_sel:WORD_1
    v_add_u32 v4, 0xffff0000, v4
    v_add_u32 v5, 0xffff0000, v5
    v_add_u32 v6, 0xffff0000, v6
    v_add_u32 v7, 0xffff0000, v7
    v_add_u32 v8, 0xffff0000, v8
    v_add_u32 v9, 0xffff0000, v9
    v_add_u32 v10, 0xffff0000, v10
    v_add_u32 v11, 0xffff0000, v11
    v_add_u32 v12, 0xffff0000, v12
    v_add_u32 v13, 0xffff0000, v13
    v_add_u32 v14, 0xffff0000, v14
    v_add_u32 v15, 0xffff0000, v15
    v_add_u32 v16, 0xffff0000, v16
    v_add_u32 v17, 0xffff0000, v17
    v_add_u32 v18, 0xffff0000, v18
    v_add_u32 v19, 0xffff0000, v19
    v_cvt_f32_i32 v4, v4
    v_cvt_f32_i32 v5, v5
    v_cvt_f32_i32 v6, v6
    v_cvt_f32_i32 v7, v7
    v_cvt_f32_i32 v8, v8
    v_cvt_f32_i32 v9, v9
    v_cvt_f32_i32 v10, v10
    v_cvt_f32_i32 v11, v11
    v_cvt_f32_i32 v12, v12
    v_cvt_f32_i32 v13, v13
    v_cvt_f32_i32 v14, v14
    v_cvt_f32_i32 v15, v15
    v_cvt_f32_i32 v16, v16
    v_cvt_f32_i32 v17, v17
    v_cvt_f32_i32 v18, v18
    v_cvt_f32_i32 v19, v19
    v_mul_f32 v4, s34, v4
    v_mul_f32 v5, s34, v5
    v_mul_f32 v6, s34, v6
    v_mul_f32 v7, s34, v7
    v_mul_f32 v8, s34, v8
    v_mul_f32 v9, s34, v9
    v_mul_f32 v10, s34, v10
    v_mul_f32 v11, s34, v11
    v_mul_f32 v12, s34, v12
    v_mul_f32 v13, s34, v13
    v_mul_f32 v14, s34, v14
    v_mul_f32 v15, s34, v15
    v_mul_f32 v16, s34, v16
    v_mul_f32 v17, s34, v17
    v_mul_f32 v18, s34, v18
    v_mul_f32 v19, s34, v19
L_fbk_107:
    s_lshl_b32 s52, s12, 16
    v_mul_f32 v20, s52, v4
    v_mul_f32 v24, s52, v8
    v_mul_f32 v28, s52, v12
    v_mul_f32 v32, s52, v16
    s_and_b32 s53, s12, s32
    v_mul_f32 v21, s53, v4
    v_mul_f32 v25, s53, v8
    v_mul_f32 v29, s53, v12
    v_mul_f32 v33, s53, v16
    s_lshl_b32 s52, s13, 16
    v_mul_f32 v22, s52, v4
    v_mul_f32 v26, s52, v8
    v_mul_f32 v30, s52, v12
    v_mul_f32 v34, s52, v16
    s_and_b32 s53, s13, s32
    v_mul_f32 v23, s53, v4
    v_mul_f32 v27, s53, v8
    v_mul_f32 v31, s53, v12
    v_mul_f32 v35, s53, v16
    s_lshl_b32 s52, s14, 16
    v_fmac_f32 v20, s52, v5
    v_fmac_f32 v24, s52, v9
    v_fmac_f32 v28, s52, v13
    v_fmac_f32 v32, s52, v17
    s_and_b32 s53, s14, s32
    v_fmac_f32 v21, s53, v5
    v_fmac_f32 v25, s53, v9
    v_fmac_f32 v29, s53, v13
    v_fmac_f32 v33, s53, v17
    s_lshl_b32 s52, s15, 16
    v_fmac_f32 v22, s52, v5
    v_fmac_f32 v26, s52, v9
    v_fmac_f32 v30, s52, v13
    v_fmac_f32 v34, s52, v17
    s_and_b32 s53, s15, s32
    v_fmac_f32 v23, s53, v5
    v_fmac_f32 v27, s53, v9
    v_fmac_f32 v31, s53, v13
    v_fmac_f32 v35, s53, v17
    s_lshl_b32 s52, s16, 16
    v_fmac_f32 v20, s52, v6
    v_fmac_f32 v24, s52, v10
    v_fmac_f32 v28, s52, v14
    v_fmac_f32 v32, s52, v18
    s_and_b32 s53, s16, s32
    v_fmac_f32 v21, s53, v6
    v_fmac_f32 v25, s53, v10
    v_fmac_f32 v29, s53, v14
    v_fmac_f32 v33, s53, v18
    s_lshl_b32 s52, s17, 16
    v_fmac_f32 v22, s52, v6
    v_fmac_f32 v26, s52, v10
    v_fmac_f32 v30, s52, v14
    v_fmac_f32 v34, s52, v18
    s_and_b32 s53, s17, s32
    v_fmac_f32 v23, s53, v6
    v_fmac_f32 v27, s53, v10
    v_fmac_f32 v31, s53, v14
    v_fmac_f32 v35, s53, v18
    s_lshl_b32 s52, s18, 16
    v_fmac_f32 v20, s52, v7
    v_fmac_f32 v24, s52, v11
    v_fmac_f32 v28, s52, v15
    v_fmac_f32 v32, s52, v19
    s_and_b32 s53, s18, s32
    v_fmac_f32 v21, s53, v7
    v_fmac_f32 v25, s53, v11
    v_fmac_f32 v29, s53, v15
    v_fmac_f32 v33, s53, v19
    s_lshl_b32 s52, s19, 16
    v_fmac_f32 v22, s52, v7
    v_fmac_f32 v26, s52, v11
    v_fmac_f32 v30, s52, v15
    v_fmac_f32 v34, s52, v19
    s_and_b32 s53, s19, s32
    v_fmac_f32 v23, s53, v7
    v_fmac_f32 v27, s53, v11
    v_fmac_f32 v31, s53, v15
    v_fmac_f32 v35, s53, v19
    v_mul_f32 v20, v20, v94
    v_mul_f32 v21, v21, v95
    v_mul_f32 v22, v22, v96
    v_mul_f32 v23, v23, v97
    v_mul_f32 v24, v24, v98
    v_mul_f32 v25, v25, v99
    v_mul_f32 v26, v26, v100
    v_mul_f32 v27, v27, v101
    v_mul_f32 v28, v28, v102
    v_mul_f32 v29, v29, v103
    v_mul_f32 v30, v30, v104
    v_mul_f32 v31, v31, v105
    v_mul_f32 v32, v32, v106
    v_mul_f32 v33, v33, v107
    v_mul_f32 v34, v34, v108
    v_mul_f32 v35, v35, v109
    v_cvt_pk_bf16_f32 v20, v20, v21
    v_cvt_pk_bf16_f32 v22, v22, v23
    v_cvt_pk_bf16_f32 v24, v24, v25
    v_cvt_pk_bf16_f32 v26, v26, v27
    v_cvt_pk_bf16_f32 v28, v28, v29
    v_cvt_pk_bf16_f32 v30, v30, v31
    v_cvt_pk_bf16_f32 v32, v32, v33
    v_cvt_pk_bf16_f32 v34, v34, v35
    s_pack_ll_b32_b16 s52, s56, s58
    v_dot2_f32_bf16 v4, v20, s52, 0
    v_dot2_f32_bf16 v8, v24, s52, 0
    v_dot2_f32_bf16 v12, v28, s52, 0
    v_dot2_f32_bf16 v16, v32, s52, 0
    s_pack_hh_b32_b16 s53, s56, s58
    v_dot2_f32_bf16 v5, v20, s53, 0
    v_dot2_f32_bf16 v9, v24, s53, 0
    v_dot2_f32_bf16 v13, v28, s53, 0
    v_dot2_f32_bf16 v17, v32, s53, 0
    s_pack_ll_b32_b16 s52, s57, s59
    v_dot2_f32_bf16 v6, v20, s52, 0
    v_dot2_f32_bf16 v10, v24, s52, 0
    v_dot2_f32_bf16 v14, v28, s52, 0
    v_dot2_f32_bf16 v18, v32, s52, 0
    s_pack_hh_b32_b16 s53, s57, s59
    v_dot2_f32_bf16 v7, v20, s53, 0
    v_dot2_f32_bf16 v11, v24, s53, 0
    v_dot2_f32_bf16 v15, v28, s53, 0
    v_dot2_f32_bf16 v19, v32, s53, 0
    s_pack_ll_b32_b16 s52, s60, s62
    v_dot2_f32_bf16 v4, v22, s52, v4
    v_dot2_f32_bf16 v8, v26, s52, v8
    v_dot2_f32_bf16 v12, v30, s52, v12
    v_dot2_f32_bf16 v16, v34, s52, v16
    s_pack_hh_b32_b16 s53, s60, s62
    v_dot2_f32_bf16 v5, v22, s53, v5
    v_dot2_f32_bf16 v9, v26, s53, v9
    v_dot2_f32_bf16 v13, v30, s53, v13
    v_dot2_f32_bf16 v17, v34, s53, v17
    s_pack_ll_b32_b16 s52, s61, s63
    v_dot2_f32_bf16 v6, v22, s52, v6
    v_dot2_f32_bf16 v10, v26, s52, v10
    v_dot2_f32_bf16 v14, v30, s52, v14
    v_dot2_f32_bf16 v18, v34, s52, v18
    s_pack_hh_b32_b16 s53, s61, s63
    v_dot2_f32_bf16 v7, v22, s53, v7
    v_dot2_f32_bf16 v11, v26, s53, v11
    v_dot2_f32_bf16 v15, v30, s53, v15
    v_dot2_f32_bf16 v19, v34, s53, v19
    v_lshlrev_b32 v36, 16, v86
    v_and_b32 v37, s32, v86
    v_lshlrev_b32 v52, 16, v110
    v_and_b32 v53, s32, v110
    v_lshlrev_b32 v38, 16, v87
    v_and_b32 v39, s32, v87
    v_lshlrev_b32 v54, 16, v111
    v_and_b32 v55, s32, v111
    v_lshlrev_b32 v40, 16, v88
    v_and_b32 v41, s32, v88
    v_lshlrev_b32 v56, 16, v112
    v_and_b32 v57, s32, v112
    v_lshlrev_b32 v42, 16, v89
    v_and_b32 v43, s32, v89
    v_lshlrev_b32 v58, 16, v113
    v_and_b32 v59, s32, v113
    v_lshlrev_b32 v44, 16, v90
    v_and_b32 v45, s32, v90
    v_lshlrev_b32 v60, 16, v114
    v_and_b32 v61, s32, v114
    v_lshlrev_b32 v46, 16, v91
    v_and_b32 v47, s32, v91
    v_lshlrev_b32 v62, 16, v115
    v_and_b32 v63, s32, v115
    v_lshlrev_b32 v48, 16, v92
    v_and_b32 v49, s32, v92
    v_lshlrev_b32 v64, 16, v116
    v_and_b32 v65, s32, v116
    v_lshlrev_b32 v50, 16, v93
    v_and_b32 v51, s32, v93
    v_lshlrev_b32 v66, 16, v117
    v_and_b32 v67, s32, v117
    v_cvt_pk_bf16_f32 v4, v4, v5
    v_cvt_pk_bf16_f32 v6, v6, v7
    v_cvt_pk_bf16_f32 v8, v8, v9
    v_cvt_pk_bf16_f32 v10, v10, v11
    v_cvt_pk_bf16_f32 v12, v12, v13
    v_cvt_pk_bf16_f32 v14, v14, v15
    v_cvt_pk_bf16_f32 v16, v16, v17
    v_cvt_pk_bf16_f32 v18, v18, v19
    v_and_b32 v5, s32, v4
    v_lshlrev_b32 v4, 16, v4
    v_and_b32 v7, s32, v6
    v_lshlrev_b32 v6, 16, v6
    v_and_b32 v9, s32, v8
    v_lshlrev_b32 v8, 16, v8
    v_and_b32 v11, s32, v10
    v_lshlrev_b32 v10, 16, v10
    v_and_b32 v13, s32, v12
    v_lshlrev_b32 v12, 16, v12
    v_and_b32 v15, s32, v14
    v_lshlrev_b32 v14, 16, v14
    v_and_b32 v17, s32, v16
    v_lshlrev_b32 v16, 16, v16
    v_and_b32 v19, s32, v18
    v_lshlrev_b32 v18, 16, v18
    v_mul_f32 v4, v4, v52
    v_mul_f32 v5, v5, v53
    v_mul_f32 v6, v6, v54
    v_mul_f32 v7, v7, v55
    v_mul_f32 v8, v8, v56
    v_mul_f32 v9, v9, v57
    v_mul_f32 v10, v10, v58
    v_mul_f32 v11, v11, v59
    v_mul_f32 v12, v12, v60
    v_mul_f32 v13, v13, v61
    v_mul_f32 v14, v14, v62
    v_mul_f32 v15, v15, v63
    v_mul_f32 v16, v16, v64
    v_mul_f32 v17, v17, v65
    v_mul_f32 v18, v18, v66
    v_mul_f32 v19, v19, v67
    v_cvt_pk_bf16_f32 v4, v4, v5
    v_cvt_pk_bf16_f32 v6, v6, v7
    v_cvt_pk_bf16_f32 v8, v8, v9
    v_cvt_pk_bf16_f32 v10, v10, v11
    v_cvt_pk_bf16_f32 v12, v12, v13
    v_cvt_pk_bf16_f32 v14, v14, v15
    v_cvt_pk_bf16_f32 v16, v16, v17
    v_cvt_pk_bf16_f32 v18, v18, v19
    v_and_b32 v5, s32, v4
    v_lshlrev_b32 v4, 16, v4
    v_and_b32 v7, s32, v6
    v_lshlrev_b32 v6, 16, v6
    v_and_b32 v9, s32, v8
    v_lshlrev_b32 v8, 16, v8
    v_and_b32 v11, s32, v10
    v_lshlrev_b32 v10, 16, v10
    v_and_b32 v13, s32, v12
    v_lshlrev_b32 v12, 16, v12
    v_and_b32 v15, s32, v14
    v_lshlrev_b32 v14, 16, v14
    v_and_b32 v17, s32, v16
    v_lshlrev_b32 v16, 16, v16
    v_and_b32 v19, s32, v18
    v_lshlrev_b32 v18, 16, v18
    v_add_f32 v4, v4, v36
    v_add_f32 v5, v5, v37
    v_add_f32 v6, v6, v38
    v_add_f32 v7, v7, v39
    v_add_f32 v8, v8, v40
    v_add_f32 v9, v9, v41
    v_add_f32 v10, v10, v42
    v_add_f32 v11, v11, v43
    v_add_f32 v12, v12, v44
    v_add_f32 v13, v13, v45
    v_add_f32 v14, v14, v46
    v_add_f32 v15, v15, v47
    v_add_f32 v16, v16, v48
    v_add_f32 v17, v17, v49
    v_add_f32 v18, v18, v50
    v_add_f32 v19, v19, v51
    v_cvt_pk_bf16_f32 v20, v4, v5
    v_cvt_pk_bf16_f32 v21, v6, v7
    v_cvt_pk_bf16_f32 v22, v8, v9
    v_cvt_pk_bf16_f32 v23, v10, v11
    v_cvt_pk_bf16_f32 v24, v12, v13
    v_cvt_pk_bf16_f32 v25, v14, v15
    v_cvt_pk_bf16_f32 v26, v16, v17
    v_cvt_pk_bf16_f32 v27, v18, v19
    buffer_store_dwordx4 v[20:23], v76, s[76:79], 0 offen
    buffer_store_dwordx4 v[24:27], v77, s[76:79], 0 offen
L_postend_89:
    s_mov_b64 exec, -1

    s_bfe_u32 s3, s35, 0x40008
    s_cbranch_scc0 L_fend_92
    s_ff1_i32_b32 s41, s3
    s_add_u32 s3, s41, 8
    s_bitset0_b32 s35, s3
    s_mov_b32 s49, -1

    s_mul_i32 s28, s41, 3125
    s_add_u32 s29, s28, 3126
    s_add_u32 s28, s28, 1
    s_lshr_b32 s28, s28, 1
    s_lshr_b32 s29, s29, 1
    s_sub_u32 s29, s29, s28
    s_sub_u32 s5, s29, 782
    s_mul_i32 s3, s36, 6250
    v_add_u32 v78, s28, v0
    v_mov_b32 v82, 0x2000000
    v_add_u32 v79, 782, v78
    v_cmp_gt_u32 vcc, 782, v0
    v_add_u32 v76, s3, v78
    v_add_u32 v77, s3, v79
    v_cndmask_b32 v76, v82, v76, vcc
    v_cmp_gt_u32 vcc, s5, v0
    v_lshlrev_b32 v78, 4, v78
    v_lshlrev_b32 v79, 4, v79
    v_cndmask_b32 v77, v82, v77, vcc
    v_lshlrev_b32 v80, 2, v76
    v_lshlrev_b32 v76, 4, v76
    v_lshlrev_b32 v81, 2, v77
    v_lshlrev_b32 v77, 4, v77
    buffer_load_dword v80, v80, s[68:71], 0 offen
    buffer_load_dword v81, v81, s[68:71], 0 offen
    buffer_load_dwordx4 v[86:89], v76, s[8:11], 0 offen
    buffer_load_dwordx4 v[90:93], v77, s[8:11], 0 offen

    s_waitcnt vmcnt(2)
    v_lshlrev_b32_sdwa v82, 5, v80 dst_sel:DWORD dst_unused:UNUSED_PAD src0_sel:DWORD src1_sel:WORD_0
    v_lshlrev_b32_sdwa v83, 5, v80 dst_sel:DWORD dst_unused:UNUSED_PAD src0_sel:DWORD src1_sel:WORD_1
    v_lshlrev_b32_sdwa v84, 5, v81 dst_sel:DWORD dst_unused:UNUSED_PAD src0_sel:DWORD src1_sel:WORD_0
    v_lshlrev_b32_sdwa v85, 5, v81 dst_sel:DWORD dst_unused:UNUSED_PAD src0_sel:DWORD src1_sel:WORD_1
    buffer_load_dwordx4 v[94:97], v82, s[72:75], 0 offen
    buffer_load_dwordx2 v[110:111], v82, s[72:75], 0 offen offset:16

    buffer_load_dwordx4 v[98:101], v83, s[72:75], 0 offen
    buffer_load_dwordx2 v[112:113], v83, s[72:75], 0 offen offset:16

    buffer_load_dwordx4 v[102:105], v84, s[72:75], 0 offen
    buffer_load_dwordx2 v[114:115], v84, s[72:75], 0 offen offset:16

    buffer_load_dwordx4 v[106:109], v85, s[72:75], 0 offen
    buffer_load_dwordx2 v[116:117], v85, s[72:75], 0 offen offset:16

    s_branch L_post_88
L_fin_83:

    s_load_dwordx2 s[68:69], s[0:1], 24
    s_load_dwordx4 s[88:91], s[0:1], 72
    s_load_dwordx2 s[76:77], s[0:1], 88
    s_load_dwordx2 s[80:81], s[0:1], 96
    s_mov_b32 s70, 1600000
    s_mov_b32 s71, 0x20000
    s_mov_b32 s78, 6400000
    s_mov_b32 s79, 0x20000
    s_movk_i32 s82, 256
    s_mov_b32 s83, 0x20000
    s_lshl_b32 s48, s36, 2
    s_mov_b32 s41, s37

    s_add_u32 s84, s6, 8896512
    s_addc_u32 s85, s7, 0
    s_mov_b32 s86, 76800000
    s_mov_b32 s87, 0x20000
    s_add_u32 s72, s6, 393216
    s_addc_u32 s73, s7, 0
    s_mov_b32 s74, 2097152
    s_mov_b32 s75, 0x20000
    s_mov_b32 s49, -1
    s_waitcnt lgkmcnt(0)
    s_load_dwordx8 s[12:19], s[88:89], 0
    s_load_dwordx8 s[56:63], s[90:91], 0

    s_mul_i32 s28, s41, 3125
    s_add_u32 s29, s28, 3126
    s_add_u32 s28, s28, 1
    s_lshr_b32 s28, s28, 1
    s_lshr_b32 s29, s29, 1
    s_sub_u32 s29, s29, s28
    s_sub_u32 s5, s29, 782
    s_mul_i32 s3, s36, 6250
    v_add_u32 v78, s28, v0
    v_mov_b32 v82, 0x2000000
    v_add_u32 v79, 782, v78
    v_cmp_gt_u32 vcc, 782, v0
    v_add_u32 v76, s3, v78
    v_add_u32 v77, s3, v79
    v_cndmask_b32 v76, v82, v76, vcc
    v_cmp_gt_u32 vcc, s5, v0
    v_lshlrev_b32 v78, 4, v78
    v_lshlrev_b32 v79, 4, v79
    v_cndmask_b32 v77, v82, v77, vcc
    v_lshlrev_b32 v80, 2, v76
    v_lshlrev_b32 v76, 4, v76
    v_lshlrev_b32 v81, 2, v77
    v_lshlrev_b32 v77, 4, v77
    buffer_load_dword v80, v80, s[68:71], 0 offen
    buffer_load_dword v81, v81, s[68:71], 0 offen
    buffer_load_dwordx4 v[86:89], v76, s[8:11], 0 offen
    buffer_load_dwordx4 v[90:93], v77, s[8:11], 0 offen

    s_waitcnt vmcnt(2)
    v_lshlrev_b32_sdwa v82, 5, v80 dst_sel:DWORD dst_unused:UNUSED_PAD src0_sel:DWORD src1_sel:WORD_0
    v_lshlrev_b32_sdwa v83, 5, v80 dst_sel:DWORD dst_unused:UNUSED_PAD src0_sel:DWORD src1_sel:WORD_1
    v_lshlrev_b32_sdwa v84, 5, v81 dst_sel:DWORD dst_unused:UNUSED_PAD src0_sel:DWORD src1_sel:WORD_0
    v_lshlrev_b32_sdwa v85, 5, v81 dst_sel:DWORD dst_unused:UNUSED_PAD src0_sel:DWORD src1_sel:WORD_1
    buffer_load_dwordx4 v[94:97], v82, s[72:75], 0 offen
    buffer_load_dwordx2 v[110:111], v82, s[72:75], 0 offen offset:16

    buffer_load_dwordx4 v[98:101], v83, s[72:75], 0 offen
    buffer_load_dwordx2 v[112:113], v83, s[72:75], 0 offen offset:16

    buffer_load_dwordx4 v[102:105], v84, s[72:75], 0 offen
    buffer_load_dwordx2 v[114:115], v84, s[72:75], 0 offen offset:16

    buffer_load_dwordx4 v[106:109], v85, s[72:75], 0 offen
    buffer_load_dwordx2 v[116:117], v85, s[72:75], 0 offen offset:16

    s_waitcnt vmcnt(0) lgkmcnt(0)
    s_barrier
    s_branch L_meet_84
L_fend_92:

L_p2done_47:
    s_endpgm

L_ufix_49:
    v_and_b32 v117, 63, v0
    v_lshlrev_b32 v117, 2, v117
    s_sub_i32 s54, s42, 1024
    v_cmp_le_i32 vcc, s54, v117
    s_mov_b64 exec, vcc
    v_mov_b32 v12, 0
    v_mov_b32 v44, 0
    s_mov_b64 exec, -1
    s_sub_i32 s54, s42, 1025
    v_cmp_le_i32 vcc, s54, v117
    s_mov_b64 exec, vcc
    v_mov_b32 v13, 0
    v_mov_b32 v46, 0
    s_mov_b64 exec, -1
    s_sub_i32 s54, s42, 1026
    v_cmp_le_i32 vcc, s54, v117
    s_mov_b64 exec, vcc
    v_mov_b32 v14, 0
    v_mov_b32 v48, 0
    s_mov_b64 exec, -1
    s_sub_i32 s54, s42, 1027
    v_cmp_le_i32 vcc, s54, v117
    s_mov_b64 exec, vcc
    v_mov_b32 v15, 0
    v_mov_b32 v50, 0
    s_mov_b64 exec, -1
    s_branch L_uback_50
L_ufix_51:
    v_and_b32 v117, 63, v0
    v_lshlrev_b32 v117, 2, v117
    s_sub_i32 s54, s42, 1536
    v_cmp_le_i32 vcc, s54, v117
    s_mov_b64 exec, vcc
    v_mov_b32 v16, 0
    v_mov_b32 v52, 0
    s_mov_b64 exec, -1
    s_sub_i32 s54, s42, 1537
    v_cmp_le_i32 vcc, s54, v117
    s_mov_b64 exec, vcc
    v_mov_b32 v17, 0
    v_mov_b32 v54, 0
    s_mov_b64 exec, -1
    s_sub_i32 s54, s42, 1538
    v_cmp_le_i32 vcc, s54, v117
    s_mov_b64 exec, vcc
    v_mov_b32 v18, 0
    v_mov_b32 v56, 0
    s_mov_b64 exec, -1
    s_sub_i32 s54, s42, 1539
    v_cmp_le_i32 vcc, s54, v117
    s_mov_b64 exec, vcc
    v_mov_b32 v19, 0
    v_mov_b32 v58, 0
    s_mov_b64 exec, -1
    s_branch L_uback_52
L_ufix_53:
    v_and_b32 v117, 63, v0
    v_lshlrev_b32 v117, 2, v117
    s_sub_i32 s54, s42, 2048
    v_cmp_le_i32 vcc, s54, v117
    s_mov_b64 exec, vcc
    v_mov_b32 v20, 0
    v_mov_b32 v60, 0
    s_mov_b64 exec, -1
    s_sub_i32 s54, s42, 2049
    v_cmp_le_i32 vcc, s54, v117
    s_mov_b64 exec, vcc
    v_mov_b32 v21, 0
    v_mov_b32 v62, 0
    s_mov_b64 exec, -1
    s_sub_i32 s54, s42, 2050
    v_cmp_le_i32 vcc, s54, v117
    s_mov_b64 exec, vcc
    v_mov_b32 v22, 0
    v_mov_b32 v64, 0
    s_mov_b64 exec, -1
    s_sub_i32 s54, s42, 2051
    v_cmp_le_i32 vcc, s54, v117
    s_mov_b64 exec, vcc
    v_mov_b32 v23, 0
    v_mov_b32 v66, 0
    s_mov_b64 exec, -1
    s_branch L_uback_54
L_ufix_55:
    v_and_b32 v117, 63, v0
    v_lshlrev_b32 v117, 2, v117
    s_sub_i32 s54, s42, 2560
    v_cmp_le_i32 vcc, s54, v117
    s_mov_b64 exec, vcc
    v_mov_b32 v24, 0
    v_mov_b32 v68, 0
    s_mov_b64 exec, -1
    s_sub_i32 s54, s42, 2561
    v_cmp_le_i32 vcc, s54, v117
    s_mov_b64 exec, vcc
    v_mov_b32 v25, 0
    v_mov_b32 v70, 0
    s_mov_b64 exec, -1
    s_sub_i32 s54, s42, 2562
    v_cmp_le_i32 vcc, s54, v117
    s_mov_b64 exec, vcc
    v_mov_b32 v26, 0
    v_mov_b32 v72, 0
    s_mov_b64 exec, -1
    s_sub_i32 s54, s42, 2563
    v_cmp_le_i32 vcc, s54, v117
    s_mov_b64 exec, vcc
    v_mov_b32 v27, 0
    v_mov_b32 v74, 0
    s_mov_b64 exec, -1
    s_branch L_uback_56
L_ufix_57:
    v_and_b32 v117, 63, v0
    v_lshlrev_b32 v117, 2, v117
    s_sub_i32 s54, s42, 0
    v_cmp_le_i32 vcc, s54, v117
    s_mov_b64 exec, vcc
    v_mov_b32 v4, 0
    v_mov_b32 v28, 0
    s_mov_b64 exec, -1
    s_sub_i32 s54, s42, 1
    v_cmp_le_i32 vcc, s54, v117
    s_mov_b64 exec, vcc
    v_mov_b32 v5, 0
    v_mov_b32 v30, 0
    s_mov_b64 exec, -1
    s_sub_i32 s54, s42, 2
    v_cmp_le_i32 vcc, s54, v117
    s_mov_b64 exec, vcc
    v_mov_b32 v6, 0
    v_mov_b32 v32, 0
    s_mov_b64 exec, -1
    s_sub_i32 s54, s42, 3
    v_cmp_le_i32 vcc, s54, v117
    s_mov_b64 exec, vcc
    v_mov_b32 v7, 0
    v_mov_b32 v34, 0
    s_mov_b64 exec, -1
    s_branch L_uback_58
L_ufix_59:
    v_and_b32 v117, 63, v0
    v_lshlrev_b32 v117, 2, v117
    s_sub_i32 s54, s42, 512
    v_cmp_le_i32 vcc, s54, v117
    s_mov_b64 exec, vcc
    v_mov_b32 v8, 0
    v_mov_b32 v36, 0
    s_mov_b64 exec, -1
    s_sub_i32 s54, s42, 513
    v_cmp_le_i32 vcc, s54, v117
    s_mov_b64 exec, vcc
    v_mov_b32 v9, 0
    v_mov_b32 v38, 0
    s_mov_b64 exec, -1
    s_sub_i32 s54, s42, 514
    v_cmp_le_i32 vcc, s54, v117
    s_mov_b64 exec, vcc
    v_mov_b32 v10, 0
    v_mov_b32 v40, 0
    s_mov_b64 exec, -1
    s_sub_i32 s54, s42, 515
    v_cmp_le_i32 vcc, s54, v117
    s_mov_b64 exec, vcc
    v_mov_b32 v11, 0
    v_mov_b32 v42, 0
    s_mov_b64 exec, -1
    s_branch L_uback_60
L_ufix_66:
    v_and_b32 v117, 63, v0
    v_lshlrev_b32 v117, 2, v117
    s_sub_i32 s54, s42, 3072
    v_cmp_le_i32 vcc, s54, v117
    s_mov_b64 exec, vcc
    v_mov_b32 v106, 0
    v_mov_b32 v120, 0
    s_mov_b64 exec, -1
    s_sub_i32 s54, s42, 3073
    v_cmp_le_i32 vcc, s54, v117
    s_mov_b64 exec, vcc
    v_mov_b32 v107, 0
    v_mov_b32 v122, 0
    s_mov_b64 exec, -1
    s_sub_i32 s54, s42, 3074
    v_cmp_le_i32 vcc, s54, v117
    s_mov_b64 exec, vcc
    v_mov_b32 v108, 0
    v_mov_b32 v124, 0
    s_mov_b64 exec, -1
    s_sub_i32 s54, s42, 3075
    v_cmp_le_i32 vcc, s54, v117
    s_mov_b64 exec, vcc
    v_mov_b32 v109, 0
    v_mov_b32 v126, 0
    s_mov_b64 exec, -1
    s_branch L_uback_67
L_ufix_70:
    v_and_b32 v117, 63, v0
    v_lshlrev_b32 v117, 2, v117
    s_sub_i32 s54, s42, 1024
    v_cmp_le_i32 vcc, s54, v117
    s_mov_b64 exec, vcc
    v_mov_b32 v12, 0
    v_mov_b32 v44, 0
    s_mov_b64 exec, -1
    s_sub_i32 s54, s42, 1025
    v_cmp_le_i32 vcc, s54, v117
    s_mov_b64 exec, vcc
    v_mov_b32 v13, 0
    v_mov_b32 v46, 0
    s_mov_b64 exec, -1
    s_sub_i32 s54, s42, 1026
    v_cmp_le_i32 vcc, s54, v117
    s_mov_b64 exec, vcc
    v_mov_b32 v14, 0
    v_mov_b32 v48, 0
    s_mov_b64 exec, -1
    s_sub_i32 s54, s42, 1027
    v_cmp_le_i32 vcc, s54, v117
    s_mov_b64 exec, vcc
    v_mov_b32 v15, 0
    v_mov_b32 v50, 0
    s_mov_b64 exec, -1
    s_branch L_uback_71
L_ufix_72:
    v_and_b32 v117, 63, v0
    v_lshlrev_b32 v117, 2, v117
    s_sub_i32 s54, s42, 1536
    v_cmp_le_i32 vcc, s54, v117
    s_mov_b64 exec, vcc
    v_mov_b32 v16, 0
    v_mov_b32 v52, 0
    s_mov_b64 exec, -1
    s_sub_i32 s54, s42, 1537
    v_cmp_le_i32 vcc, s54, v117
    s_mov_b64 exec, vcc
    v_mov_b32 v17, 0
    v_mov_b32 v54, 0
    s_mov_b64 exec, -1
    s_sub_i32 s54, s42, 1538
    v_cmp_le_i32 vcc, s54, v117
    s_mov_b64 exec, vcc
    v_mov_b32 v18, 0
    v_mov_b32 v56, 0
    s_mov_b64 exec, -1
    s_sub_i32 s54, s42, 1539
    v_cmp_le_i32 vcc, s54, v117
    s_mov_b64 exec, vcc
    v_mov_b32 v19, 0
    v_mov_b32 v58, 0
    s_mov_b64 exec, -1
    s_branch L_uback_73
L_ufix_74:
    v_and_b32 v117, 63, v0
    v_lshlrev_b32 v117, 2, v117
    s_sub_i32 s54, s42, 2048
    v_cmp_le_i32 vcc, s54, v117
    s_mov_b64 exec, vcc
    v_mov_b32 v20, 0
    v_mov_b32 v60, 0
    s_mov_b64 exec, -1
    s_sub_i32 s54, s42, 2049
    v_cmp_le_i32 vcc, s54, v117
    s_mov_b64 exec, vcc
    v_mov_b32 v21, 0
    v_mov_b32 v62, 0
    s_mov_b64 exec, -1
    s_sub_i32 s54, s42, 2050
    v_cmp_le_i32 vcc, s54, v117
    s_mov_b64 exec, vcc
    v_mov_b32 v22, 0
    v_mov_b32 v64, 0
    s_mov_b64 exec, -1
    s_sub_i32 s54, s42, 2051
    v_cmp_le_i32 vcc, s54, v117
    s_mov_b64 exec, vcc
    v_mov_b32 v23, 0
    v_mov_b32 v66, 0
    s_mov_b64 exec, -1
    s_branch L_uback_75
L_ufix_76:
    v_and_b32 v117, 63, v0
    v_lshlrev_b32 v117, 2, v117
    s_sub_i32 s54, s42, 2560
    v_cmp_le_i32 vcc, s54, v117
    s_mov_b64 exec, vcc
    v_mov_b32 v24, 0
    v_mov_b32 v68, 0
    s_mov_b64 exec, -1
    s_sub_i32 s54, s42, 2561
    v_cmp_le_i32 vcc, s54, v117
    s_mov_b64 exec, vcc
    v_mov_b32 v25, 0
    v_mov_b32 v70, 0
    s_mov_b64 exec, -1
    s_sub_i32 s54, s42, 2562
    v_cmp_le_i32 vcc, s54, v117
    s_mov_b64 exec, vcc
    v_mov_b32 v26, 0
    v_mov_b32 v72, 0
    s_mov_b64 exec, -1
    s_sub_i32 s54, s42, 2563
    v_cmp_le_i32 vcc, s54, v117
    s_mov_b64 exec, vcc
    v_mov_b32 v27, 0
    v_mov_b32 v74, 0
    s_mov_b64 exec, -1
    s_branch L_uback_77
L_ufix_78:
    v_and_b32 v117, 63, v0
    v_lshlrev_b32 v117, 2, v117
    s_sub_i32 s54, s42, 0
    v_cmp_le_i32 vcc, s54, v117
    s_mov_b64 exec, vcc
    v_mov_b32 v4, 0
    v_mov_b32 v28, 0
    s_mov_b64 exec, -1
    s_sub_i32 s54, s42, 1
    v_cmp_le_i32 vcc, s54, v117
    s_mov_b64 exec, vcc
    v_mov_b32 v5, 0
    v_mov_b32 v30, 0
    s_mov_b64 exec, -1
    s_sub_i32 s54, s42, 2
    v_cmp_le_i32 vcc, s54, v117
    s_mov_b64 exec, vcc
    v_mov_b32 v6, 0
    v_mov_b32 v32, 0
    s_mov_b64 exec, -1
    s_sub_i32 s54, s42, 3
    v_cmp_le_i32 vcc, s54, v117
    s_mov_b64 exec, vcc
    v_mov_b32 v7, 0
    v_mov_b32 v34, 0
    s_mov_b64 exec, -1
    s_branch L_uback_79
L_ufix_80:
    v_and_b32 v117, 63, v0
    v_lshlrev_b32 v117, 2, v117
    s_sub_i32 s54, s42, 512
    v_cmp_le_i32 vcc, s54, v117
    s_mov_b64 exec, vcc
    v_mov_b32 v8, 0
    v_mov_b32 v36, 0
    s_mov_b64 exec, -1
    s_sub_i32 s54, s42, 513
    v_cmp_le_i32 vcc, s54, v117
    s_mov_b64 exec, vcc
    v_mov_b32 v9, 0
    v_mov_b32 v38, 0
    s_mov_b64 exec, -1
    s_sub_i32 s54, s42, 514
    v_cmp_le_i32 vcc, s54, v117
    s_mov_b64 exec, vcc
    v_mov_b32 v10, 0
    v_mov_b32 v40, 0
    s_mov_b64 exec, -1
    s_sub_i32 s54, s42, 515
    v_cmp_le_i32 vcc, s54, v117
    s_mov_b64 exec, vcc
    v_mov_b32 v11, 0
    v_mov_b32 v42, 0
    s_mov_b64 exec, -1
    s_branch L_uback_81
L_sync_91:
    v_and_b32 v40, 63, v0
    v_lshlrev_b32 v41, 20, v40
    v_mov_b32 v42, s33
    buffer_atomic_add v42, v41, s[80:83], s48 offen sc0
    s_waitcnt vmcnt(0)
    v_readfirstlane_b32 s4, v42
    s_movk_i32 s5, 400
    s_nop 0
    s_add_u32 s4, s4, s33
    s_bitcmp1_b32 s4, 2
    s_cbranch_scc1 L_tell_95
L_poll_93:
    s_sub_u32 s5, s5, 1
    s_cbranch_scc1 L_gave_94
    v_mov_b32 v42, 0
    buffer_atomic_add v42, v41, s[80:83], s48 offen sc0
    s_waitcnt vmcnt(0)
    v_readfirstlane_b32 s4, v42
    s_nop 1
    s_and_b32 s4, s4, 0xff
    s_bitcmp0_b32 s4, 2
    s_cbranch_scc1 L_poll_93
    s_branch L_tell_95
L_gave_94:
    s_cmp_lg_u32 s49, s37
    s_cbranch_scc1 L_gno_97
    v_add_lshl_u32 v40, v40, s28, 4
    s_mov_b32 s5, 0
L_gl_96:
    v_min_u32 v43, 100000, v40
    ds_read_b128 v[44:47], v43 offset:50000
    s_waitcnt lgkmcnt(0)
    buffer_store_dwordx4 v[44:47], v40, s[20:23], 0 offen sc1
    s_waitcnt vmcnt(0)
    v_add_u32 v40, 1024, v40
    s_add_u32 s5, s5, 64
    s_cmp_lt_u32 s5, s29
    s_cbranch_scc1 L_gl_96
L_gno_97:
    s_lshl_b32 s4, 0x100, s37
    v_mov_b32 v42, s4
    buffer_atomic_or v42, v41, s[80:83], s48 offen sc0
    s_waitcnt vmcnt(0)
    v_readfirstlane_b32 s4, v42
    s_nop 1
    s_and_b32 s4, s4, 0xff
    s_bitcmp1_b32 s4, 2
    s_cselect_b32 s4, s4, 0x10000
L_tell_95:
    v_mov_b32 v42, s4
    ds_write_b32 v118, v42
    s_waitcnt lgkmcnt(0)
    s_branch L_bcast_86

L_own_98:
    ds_read_b128 v[36:39], v78 offset:50000
    ds_read_b128 v[52:55], v79 offset:50000
    s_branch L_obk_99

L_own_100:
    ds_read_b128 v[40:43], v78 offset:50000
    ds_read_b128 v[56:59], v79 offset:50000
    s_branch L_obk_101

L_own_102:
    ds_read_b128 v[44:47], v78 offset:50000
    ds_read_b128 v[60:63], v79 offset:50000
    s_branch L_obk_103

L_own_104:
    ds_read_b128 v[48:51], v78 offset:50000
    ds_read_b128 v[64:67], v79 offset:50000
    s_branch L_obk_105

L_fgen_106:
    v_lshlrev_b32 v82, 1, v76
    v_lshlrev_b32 v83, 1, v77
    v_mov_b32 v4, 0
    v_mov_b32 v5, 0
    v_mov_b32 v6, 0
    v_mov_b32 v7, 0
    v_mov_b32 v8, 0
    v_mov_b32 v9, 0
    v_mov_b32 v10, 0
    v_mov_b32 v11, 0
    v_mov_b32 v12, 0
    v_mov_b32 v13, 0
    v_mov_b32 v14, 0
    v_mov_b32 v15, 0
    v_mov_b32 v16, 0
    v_mov_b32 v17, 0
    v_mov_b32 v18, 0
    v_mov_b32 v19, 0
    s_bitcmp1_b32 s35, 4
    s_cbranch_scc1 L_ffl_108
    v_cvt_f32_u32_sdwa v20, v36 dst_sel:DWORD dst_unused:UNUSED_PAD src0_sel:WORD_0
    v_cvt_f32_u32_sdwa v21, v36 dst_sel:DWORD dst_unused:UNUSED_PAD src0_sel:WORD_1
    v_cvt_f32_u32_sdwa v22, v37 dst_sel:DWORD dst_unused:UNUSED_PAD src0_sel:WORD_0
    v_cvt_f32_u32_sdwa v23, v37 dst_sel:DWORD dst_unused:UNUSED_PAD src0_sel:WORD_1
    v_cvt_f32_u32_sdwa v24, v38 dst_sel:DWORD dst_unused:UNUSED_PAD src0_sel:WORD_0
    v_cvt_f32_u32_sdwa v25, v38 dst_sel:DWORD dst_unused:UNUSED_PAD src0_sel:WORD_1
    v_cvt_f32_u32_sdwa v26, v39 dst_sel:DWORD dst_unused:UNUSED_PAD src0_sel:WORD_0
    v_cvt_f32_u32_sdwa v27, v39 dst_sel:DWORD dst_unused:UNUSED_PAD src0_sel:WORD_1
    v_cvt_f32_u32_sdwa v28, v52 dst_sel:DWORD dst_unused:UNUSED_PAD src0_sel:WORD_0
    v_cvt_f32_u32_sdwa v29, v52 dst_sel:DWORD dst_unused:UNUSED_PAD src0_sel:WORD_1
    v_cvt_f32_u32_sdwa v30, v53 dst_sel:DWORD dst_unused:UNUSED_PAD src0_sel:WORD_0
    v_cvt_f32_u32_sdwa v31, v53 dst_sel:DWORD dst_unused:UNUSED_PAD src0_sel:WORD_1
    v_cvt_f32_u32_sdwa v32, v54 dst_sel:DWORD dst_unused:UNUSED_PAD src0_sel:WORD_0
    v_cvt_f32_u32_sdwa v33, v54 dst_sel:DWORD dst_unused:UNUSED_PAD src0_sel:WORD_1
    v_cvt_f32_u32_sdwa v34, v55 dst_sel:DWORD dst_unused:UNUSED_PAD src0_sel:WORD_0
    v_cvt_f32_u32_sdwa v35, v55 dst_sel:DWORD dst_unused:UNUSED_PAD src0_sel:WORD_1
    v_add_f32 v20, 0xc6800000, v20
    v_fmac_f32 v4, s34, v20
    v_add_f32 v21, 0xc6800000, v21
    v_fmac_f32 v5, s34, v21
    v_add_f32 v22, 0xc6800000, v22
    v_fmac_f32 v6, s34, v22
    v_add_f32 v23, 0xc6800000, v23
    v_fmac_f32 v7, s34, v23
    v_add_f32 v24, 0xc6800000, v24
    v_fmac_f32 v8, s34, v24
    v_add_f32 v25, 0xc6800000, v25
    v_fmac_f32 v9, s34, v25
    v_add_f32 v26, 0xc6800000, v26
    v_fmac_f32 v10, s34, v26
    v_add_f32 v27, 0xc6800000, v27
    v_fmac_f32 v11, s34, v27
    v_add_f32 v28, 0xc6800000, v28
    v_fmac_f32 v12, s34, v28
    v_add_f32 v29, 0xc6800000, v29
    v_fmac_f32 v13, s34, v29
    v_add_f32 v30, 0xc6800000, v30
    v_fmac_f32 v14, s34, v30
    v_add_f32 v31, 0xc6800000, v31
    v_fmac_f32 v15, s34, v31
    v_add_f32 v32, 0xc6800000, v32
    v_fmac_f32 v16, s34, v32
    v_add_f32 v33, 0xc6800000, v33
    v_fmac_f32 v17, s34, v33
    v_add_f32 v34, 0xc6800000, v34
    v_fmac_f32 v18, s34, v34
    v_add_f32 v35, 0xc6800000, v35
    v_fmac_f32 v19, s34, v35
    s_branch L_fnx_109
L_ffl_108:
    s_mov_b32 s3, 25600000
    buffer_load_dwordx4 v[20:23], v82, s[84:87], s3 offen offset:0 sc1
    buffer_load_dwordx4 v[24:27], v82, s[84:87], s3 offen offset:16 sc1
    buffer_load_dwordx4 v[28:31], v83, s[84:87], s3 offen offset:0 sc1
    buffer_load_dwordx4 v[32:35], v83, s[84:87], s3 offen offset:16 sc1
    s_waitcnt vmcnt(0)
    v_add_f32 v4, v4, v20
    v_add_f32 v5, v5, v21
    v_add_f32 v6, v6, v22
    v_add_f32 v7, v7, v23
    v_add_f32 v8, v8, v24
    v_add_f32 v9, v9, v25
    v_add_f32 v10, v10, v26
    v_add_f32 v11, v11, v27
    v_add_f32 v12, v12, v28
    v_add_f32 v13, v13, v29
    v_add_f32 v14, v14, v30
    v_add_f32 v15, v15, v31
    v_add_f32 v16, v16, v32
    v_add_f32 v17, v17, v33
    v_add_f32 v18, v18, v34
    v_add_f32 v19, v19, v35
L_fnx_109:
    s_bitcmp1_b32 s35, 5
    s_cbranch_scc1 L_ffl_110
    v_cvt_f32_u32_sdwa v20, v40 dst_sel:DWORD dst_unused:UNUSED_PAD src0_sel:WORD_0
    v_cvt_f32_u32_sdwa v21, v40 dst_sel:DWORD dst_unused:UNUSED_PAD src0_sel:WORD_1
    v_cvt_f32_u32_sdwa v22, v41 dst_sel:DWORD dst_unused:UNUSED_PAD src0_sel:WORD_0
    v_cvt_f32_u32_sdwa v23, v41 dst_sel:DWORD dst_unused:UNUSED_PAD src0_sel:WORD_1
    v_cvt_f32_u32_sdwa v24, v42 dst_sel:DWORD dst_unused:UNUSED_PAD src0_sel:WORD_0
    v_cvt_f32_u32_sdwa v25, v42 dst_sel:DWORD dst_unused:UNUSED_PAD src0_sel:WORD_1
    v_cvt_f32_u32_sdwa v26, v43 dst_sel:DWORD dst_unused:UNUSED_PAD src0_sel:WORD_0
    v_cvt_f32_u32_sdwa v27, v43 dst_sel:DWORD dst_unused:UNUSED_PAD src0_sel:WORD_1
    v_cvt_f32_u32_sdwa v28, v56 dst_sel:DWORD dst_unused:UNUSED_PAD src0_sel:WORD_0
    v_cvt_f32_u32_sdwa v29, v56 dst_sel:DWORD dst_unused:UNUSED_PAD src0_sel:WORD_1
    v_cvt_f32_u32_sdwa v30, v57 dst_sel:DWORD dst_unused:UNUSED_PAD src0_sel:WORD_0
    v_cvt_f32_u32_sdwa v31, v57 dst_sel:DWORD dst_unused:UNUSED_PAD src0_sel:WORD_1
    v_cvt_f32_u32_sdwa v32, v58 dst_sel:DWORD dst_unused:UNUSED_PAD src0_sel:WORD_0
    v_cvt_f32_u32_sdwa v33, v58 dst_sel:DWORD dst_unused:UNUSED_PAD src0_sel:WORD_1
    v_cvt_f32_u32_sdwa v34, v59 dst_sel:DWORD dst_unused:UNUSED_PAD src0_sel:WORD_0
    v_cvt_f32_u32_sdwa v35, v59 dst_sel:DWORD dst_unused:UNUSED_PAD src0_sel:WORD_1
    v_add_f32 v20, 0xc6800000, v20
    v_fmac_f32 v4, s34, v20
    v_add_f32 v21, 0xc6800000, v21
    v_fmac_f32 v5, s34, v21
    v_add_f32 v22, 0xc6800000, v22
    v_fmac_f32 v6, s34, v22
    v_add_f32 v23, 0xc6800000, v23
    v_fmac_f32 v7, s34, v23
    v_add_f32 v24, 0xc6800000, v24
    v_fmac_f32 v8, s34, v24
    v_add_f32 v25, 0xc6800000, v25
    v_fmac_f32 v9, s34, v25
    v_add_f32 v26, 0xc6800000, v26
    v_fmac_f32 v10, s34, v26
    v_add_f32 v27, 0xc6800000, v27
    v_fmac_f32 v11, s34, v27
    v_add_f32 v28, 0xc6800000, v28
    v_fmac_f32 v12, s34, v28
    v_add_f32 v29, 0xc6800000, v29
    v_fmac_f32 v13, s34, v29
    v_add_f32 v30, 0xc6800000, v30
    v_fmac_f32 v14, s34, v30
    v_add_f32 v31, 0xc6800000, v31
    v_fmac_f32 v15, s34, v31
    v_add_f32 v32, 0xc6800000, v32
    v_fmac_f32 v16, s34, v32
    v_add_f32 v33, 0xc6800000, v33
    v_fmac_f32 v17, s34, v33
    v_add_f32 v34, 0xc6800000, v34
    v_fmac_f32 v18, s34, v34
    v_add_f32 v35, 0xc6800000, v35
    v_fmac_f32 v19, s34, v35
    s_branch L_fnx_111
L_ffl_110:
    s_mov_b32 s3, 38400000
    buffer_load_dwordx4 v[20:23], v82, s[84:87], s3 offen offset:0 sc1
    buffer_load_dwordx4 v[24:27], v82, s[84:87], s3 offen offset:16 sc1
    buffer_load_dwordx4 v[28:31], v83, s[84:87], s3 offen offset:0 sc1
    buffer_load_dwordx4 v[32:35], v83, s[84:87], s3 offen offset:16 sc1
    s_waitcnt vmcnt(0)
    v_add_f32 v4, v4, v20
    v_add_f32 v5, v5, v21
    v_add_f32 v6, v6, v22
    v_add_f32 v7, v7, v23
    v_add_f32 v8, v8, v24
    v_add_f32 v9, v9, v25
    v_add_f32 v10, v10, v26
    v_add_f32 v11, v11, v27
    v_add_f32 v12, v12, v28
    v_add_f32 v13, v13, v29
    v_add_f32 v14, v14, v30
    v_add_f32 v15, v15, v31
    v_add_f32 v16, v16, v32
    v_add_f32 v17, v17, v33
    v_add_f32 v18, v18, v34
    v_add_f32 v19, v19, v35
L_fnx_111:
    s_bitcmp1_b32 s35, 6
    s_cbranch_scc1 L_ffl_112
    v_cvt_f32_u32_sdwa v20, v44 dst_sel:DWORD dst_unused:UNUSED_PAD src0_sel:WORD_0
    v_cvt_f32_u32_sdwa v21, v44 dst_sel:DWORD dst_unused:UNUSED_PAD src0_sel:WORD_1
    v_cvt_f32_u32_sdwa v22, v45 dst_sel:DWORD dst_unused:UNUSED_PAD src0_sel:WORD_0
    v_cvt_f32_u32_sdwa v23, v45 dst_sel:DWORD dst_unused:UNUSED_PAD src0_sel:WORD_1
    v_cvt_f32_u32_sdwa v24, v46 dst_sel:DWORD dst_unused:UNUSED_PAD src0_sel:WORD_0
    v_cvt_f32_u32_sdwa v25, v46 dst_sel:DWORD dst_unused:UNUSED_PAD src0_sel:WORD_1
    v_cvt_f32_u32_sdwa v26, v47 dst_sel:DWORD dst_unused:UNUSED_PAD src0_sel:WORD_0
    v_cvt_f32_u32_sdwa v27, v47 dst_sel:DWORD dst_unused:UNUSED_PAD src0_sel:WORD_1
    v_cvt_f32_u32_sdwa v28, v60 dst_sel:DWORD dst_unused:UNUSED_PAD src0_sel:WORD_0
    v_cvt_f32_u32_sdwa v29, v60 dst_sel:DWORD dst_unused:UNUSED_PAD src0_sel:WORD_1
    v_cvt_f32_u32_sdwa v30, v61 dst_sel:DWORD dst_unused:UNUSED_PAD src0_sel:WORD_0
    v_cvt_f32_u32_sdwa v31, v61 dst_sel:DWORD dst_unused:UNUSED_PAD src0_sel:WORD_1
    v_cvt_f32_u32_sdwa v32, v62 dst_sel:DWORD dst_unused:UNUSED_PAD src0_sel:WORD_0
    v_cvt_f32_u32_sdwa v33, v62 dst_sel:DWORD dst_unused:UNUSED_PAD src0_sel:WORD_1
    v_cvt_f32_u32_sdwa v34, v63 dst_sel:DWORD dst_unused:UNUSED_PAD src0_sel:WORD_0
    v_cvt_f32_u32_sdwa v35, v63 dst_sel:DWORD dst_unused:UNUSED_PAD src0_sel:WORD_1
    v_add_f32 v20, 0xc6800000, v20
    v_fmac_f32 v4, s34, v20
    v_add_f32 v21, 0xc6800000, v21
    v_fmac_f32 v5, s34, v21
    v_add_f32 v22, 0xc6800000, v22
    v_fmac_f32 v6, s34, v22
    v_add_f32 v23, 0xc6800000, v23
    v_fmac_f32 v7, s34, v23
    v_add_f32 v24, 0xc6800000, v24
    v_fmac_f32 v8, s34, v24
    v_add_f32 v25, 0xc6800000, v25
    v_fmac_f32 v9, s34, v25
    v_add_f32 v26, 0xc6800000, v26
    v_fmac_f32 v10, s34, v26
    v_add_f32 v27, 0xc6800000, v27
    v_fmac_f32 v11, s34, v27
    v_add_f32 v28, 0xc6800000, v28
    v_fmac_f32 v12, s34, v28
    v_add_f32 v29, 0xc6800000, v29
    v_fmac_f32 v13, s34, v29
    v_add_f32 v30, 0xc6800000, v30
    v_fmac_f32 v14, s34, v30
    v_add_f32 v31, 0xc6800000, v31
    v_fmac_f32 v15, s34, v31
    v_add_f32 v32, 0xc6800000, v32
    v_fmac_f32 v16, s34, v32
    v_add_f32 v33, 0xc6800000, v33
    v_fmac_f32 v17, s34, v33
    v_add_f32 v34, 0xc6800000, v34
    v_fmac_f32 v18, s34, v34
    v_add_f32 v35, 0xc6800000, v35
    v_fmac_f32 v19, s34, v35
    s_branch L_fnx_113
L_ffl_112:
    s_mov_b32 s3, 51200000
    buffer_load_dwordx4 v[20:23], v82, s[84:87], s3 offen offset:0 sc1
    buffer_load_dwordx4 v[24:27], v82, s[84:87], s3 offen offset:16 sc1
    buffer_load_dwordx4 v[28:31], v83, s[84:87], s3 offen offset:0 sc1
    buffer_load_dwordx4 v[32:35], v83, s[84:87], s3 offen offset:16 sc1
    s_waitcnt vmcnt(0)
    v_add_f32 v4, v4, v20
    v_add_f32 v5, v5, v21
    v_add_f32 v6, v6, v22
    v_add_f32 v7, v7, v23
    v_add_f32 v8, v8, v24
    v_add_f32 v9, v9, v25
    v_add_f32 v10, v10, v26
    v_add_f32 v11, v11, v27
    v_add_f32 v12, v12, v28
    v_add_f32 v13, v13, v29
    v_add_f32 v14, v14, v30
    v_add_f32 v15, v15, v31
    v_add_f32 v16, v16, v32
    v_add_f32 v17, v17, v33
    v_add_f32 v18, v18, v34
    v_add_f32 v19, v19, v35
L_fnx_113:
    s_bitcmp1_b32 s35, 7
    s_cbranch_scc1 L_ffl_114
    v_cvt_f32_u32_sdwa v20, v48 dst_sel:DWORD dst_unused:UNUSED_PAD src0_sel:WORD_0
    v_cvt_f32_u32_sdwa v21, v48 dst_sel:DWORD dst_unused:UNUSED_PAD src0_sel:WORD_1
    v_cvt_f32_u32_sdwa v22, v49 dst_sel:DWORD dst_unused:UNUSED_PAD src0_sel:WORD_0
    v_cvt_f32_u32_sdwa v23, v49 dst_sel:DWORD dst_unused:UNUSED_PAD src0_sel:WORD_1
    v_cvt_f32_u32_sdwa v24, v50 dst_sel:DWORD dst_unused:UNUSED_PAD src0_sel:WORD_0
    v_cvt_f32_u32_sdwa v25, v50 dst_sel:DWORD dst_unused:UNUSED_PAD src0_sel:WORD_1
    v_cvt_f32_u32_sdwa v26, v51 dst_sel:DWORD dst_unused:UNUSED_PAD src0_sel:WORD_0
    v_cvt_f32_u32_sdwa v27, v51 dst_sel:DWORD dst_unused:UNUSED_PAD src0_sel:WORD_1
    v_cvt_f32_u32_sdwa v28, v64 dst_sel:DWORD dst_unused:UNUSED_PAD src0_sel:WORD_0
    v_cvt_f32_u32_sdwa v29, v64 dst_sel:DWORD dst_unused:UNUSED_PAD src0_sel:WORD_1
    v_cvt_f32_u32_sdwa v30, v65 dst_sel:DWORD dst_unused:UNUSED_PAD src0_sel:WORD_0
    v_cvt_f32_u32_sdwa v31, v65 dst_sel:DWORD dst_unused:UNUSED_PAD src0_sel:WORD_1
    v_cvt_f32_u32_sdwa v32, v66 dst_sel:DWORD dst_unused:UNUSED_PAD src0_sel:WORD_0
    v_cvt_f32_u32_sdwa v33, v66 dst_sel:DWORD dst_unused:UNUSED_PAD src0_sel:WORD_1
    v_cvt_f32_u32_sdwa v34, v67 dst_sel:DWORD dst_unused:UNUSED_PAD src0_sel:WORD_0
    v_cvt_f32_u32_sdwa v35, v67 dst_sel:DWORD dst_unused:UNUSED_PAD src0_sel:WORD_1
    v_add_f32 v20, 0xc6800000, v20
    v_fmac_f32 v4, s34, v20
    v_add_f32 v21, 0xc6800000, v21
    v_fmac_f32 v5, s34, v21
    v_add_f32 v22, 0xc6800000, v22
    v_fmac_f32 v6, s34, v22
    v_add_f32 v23, 0xc6800000, v23
    v_fmac_f32 v7, s34, v23
    v_add_f32 v24, 0xc6800000, v24
    v_fmac_f32 v8, s34, v24
    v_add_f32 v25, 0xc6800000, v25
    v_fmac_f32 v9, s34, v25
    v_add_f32 v26, 0xc6800000, v26
    v_fmac_f32 v10, s34, v26
    v_add_f32 v27, 0xc6800000, v27
    v_fmac_f32 v11, s34, v27
    v_add_f32 v28, 0xc6800000, v28
    v_fmac_f32 v12, s34, v28
    v_add_f32 v29, 0xc6800000, v29
    v_fmac_f32 v13, s34, v29
    v_add_f32 v30, 0xc6800000, v30
    v_fmac_f32 v14, s34, v30
    v_add_f32 v31, 0xc6800000, v31
    v_fmac_f32 v15, s34, v31
    v_add_f32 v32, 0xc6800000, v32
    v_fmac_f32 v16, s34, v32
    v_add_f32 v33, 0xc6800000, v33
    v_fmac_f32 v17, s34, v33
    v_add_f32 v34, 0xc6800000, v34
    v_fmac_f32 v18, s34, v34
    v_add_f32 v35, 0xc6800000, v35
    v_fmac_f32 v19, s34, v35
    s_branch L_fnx_115
L_ffl_114:
    s_mov_b32 s3, 64000000
    buffer_load_dwordx4 v[20:23], v82, s[84:87], s3 offen offset:0 sc1
    buffer_load_dwordx4 v[24:27], v82, s[84:87], s3 offen offset:16 sc1
    buffer_load_dwordx4 v[28:31], v83, s[84:87], s3 offen offset:0 sc1
    buffer_load_dwordx4 v[32:35], v83, s[84:87], s3 offen offset:16 sc1
    s_waitcnt vmcnt(0)
    v_add_f32 v4, v4, v20
    v_add_f32 v5, v5, v21
    v_add_f32 v6, v6, v22
    v_add_f32 v7, v7, v23
    v_add_f32 v8, v8, v24
    v_add_f32 v9, v9, v25
    v_add_f32 v10, v10, v26
    v_add_f32 v11, v11, v27
    v_add_f32 v12, v12, v28
    v_add_f32 v13, v13, v29
    v_add_f32 v14, v14, v30
    v_add_f32 v15, v15, v31
    v_add_f32 v16, v16, v32
    v_add_f32 v17, v17, v33
    v_add_f32 v18, v18, v34
    v_add_f32 v19, v19, v35
L_fnx_115:
    s_branch L_fbk_107
L_p2slow_48:
    s_waitcnt vmcnt(0) lgkmcnt(0)
    s_mov_b32 s51, 0
    s_movk_i32 s43, 6250
L_sweep_116:
    s_barrier

    v_mov_b32 v28, 0x0
    v_mov_b32 v29, 0x0
    v_mov_b32 v30, 0x0
    v_mov_b32 v31, 0x0
    v_add_u32 v32, 50000, v3
    v_add_u32 v33, 65536, v32

    ds_write_b128 v32, v[28:31] offset:0
    ds_write_b128 v32, v[28:31] offset:16384
    ds_write_b128 v32, v[28:31] offset:32768
    ds_write_b128 v32, v[28:31] offset:49152
    ds_write_b128 v33, v[28:31] offset:0
    ds_write_b128 v33, v[28:31] offset:16384
    v_cmp_gt_u32 vcc, 971, v0
    s_mov_b64 exec, vcc
    ds_write_b128 v33, v[28:31] offset:32768
    s_mov_b64 exec, -1
    s_mov_b32 s3, 32768
    s_load_dword s40, s[6:7], s3
    s_waitcnt lgkmcnt(0)
    s_barrier
    s_cmp_lg_u32 s40, 0
    s_cbranch_scc1 L_raw_121
    s_sub_u32 s38, s4, 8
L_sbatch_117:
    s_lshl_b32 s52, s38, 6
    s_add_u32 s52, s52, s36
    s_lshr_b32 s52, s52, 1
    s_lshl_b32 s52, s52, 2
    s_load_dword s40, s[46:47], s52
    s_mul_i32 s50, s38, 200000
    s_and_b32 s3, s36, 1
    s_lshl_b32 s3, s3, 4
    s_or_b32 s3, s3, 0x100000
    s_waitcnt lgkmcnt(0)
    s_bfe_u32 s40, s40, s3

    s_min_u32 s40, s40, 6552
    s_lshl_b32 s52, s38, 6
    s_add_u32 s52, s52, s36
    s_mul_i32 s52, s52, 32764
    s_add_u32 s20, s44, s52
    s_addc_u32 s21, s45, 0
    s_mul_i32 s52, s40, 5
    s_add_u32 s52, s52, 3
    s_and_b32 s22, s52, -4

    s_lshr_b32 s55, s39, 2
    s_add_u32 s55, s55, 0
    v_and_b32 v36, 63, v0
    v_add_u32 v36, s55, v36
L_left_122:
    s_cmp_ge_u32 s55, s40
    s_cbranch_scc1 L_leftend_123
    v_mul_u32_u24 v37, 5, v36
    buffer_load_dword v38, v37, s[20:23], 0 offen
    buffer_load_ubyte v39, v37, s[20:23], 0 offen offset:4
    s_waitcnt vmcnt(0)

    v_perm_b32 v37, v39, v38, s24
    v_lshrrev_b32 v42, 30, v38
    v_and_b32 v37, 0x1fff, v37
    v_mul_u32_u24 v42, 6250, v42
    v_add_lshl_u32 v37, v37, v42, 3

    buffer_load_dwordx2 v[40:41], v37, s[8:11], s50 offen
    v_cmp_gt_u32 vcc, s40, v36
    s_waitcnt vmcnt(0)

    v_bfe_u32 v44, v38, 16, 14
    v_subrev_u32 v44, s51, v44
    v_cmp_gt_u32 s[64:65], s43, v44
    s_and_b64 exec, vcc, s[64:65]
    v_lshlrev_b32 v45, 8, v38
    v_cmpx_ne_u32 vcc, 0, v45
    v_lshlrev_b32 v44, 4, v44
    v_bfe_i32 v38, v38, 0, 16
    v_cvt_f32_i32 v38, v38
    v_mul_f32 v38, 0x38004020, v38
    v_lshlrev_b32 v45, 16, v40
    v_and_b32 v46, s32, v40
    v_lshlrev_b32 v47, 16, v41
    v_and_b32 v48, s32, v41

    v_mul_f32 v45, v45, v38
    ds_add_f32 v44, v45 offset:50000
    v_mul_f32 v46, v46, v38
    ds_add_f32 v44, v46 offset:50004
    v_mul_f32 v47, v47, v38
    ds_add_f32 v44, v47 offset:50008
    v_mul_f32 v48, v48, v38
    ds_add_f32 v44, v48 offset:50012
    s_mov_b64 exec, -1
    v_add_u32 v36, 128, v36
    s_add_u32 s55, s55, 128
    s_branch L_left_122
L_leftend_123:

    s_add_u32 s38, s38, 1
    s_cmp_lt_u32 s38, s4
    s_cbranch_scc1 L_sbatch_117
    s_branch L_swend_119

L_raw_121:
    s_load_dwordx2 s[68:69], s[0:1], 8
    s_load_dwordx2 s[72:73], s[0:1], 16
    s_load_dwordx2 s[76:77], s[0:1], 32
    s_load_dwordx2 s[80:81], s[0:1], 48
    s_mov_b32 s70, 204800000
    s_mov_b32 s71, 0x20000
    s_mov_b32 s74, 204800000
    s_mov_b32 s75, 0x20000
    s_mov_b32 s78, 102400000
    s_mov_b32 s79, 0x20000
    s_waitcnt lgkmcnt(0)
    s_load_dword s82, s[80:81], 0
    s_mul_i32 s83, s36, 12500
    s_add_u32 s83, s83, s51
    s_mul_i32 s84, s37, 200000
    s_mov_b32 s85, 200000
    s_mov_b32 s38, 0
    v_lshlrev_b32 v44, 5, v0
    v_mov_b32 v45, 0.15915494
    s_waitcnt lgkmcnt(0)
    s_lshl_b32 s82, s82, 16
    v_mul_f32 v45, s82, v45
L_rawl_118:
    s_lshr_b32 s3, s38, 1
    buffer_load_dwordx4 v[46:49], v44, s[72:75], s38 offen
    buffer_load_dwordx4 v[50:53], v44, s[72:75], s38 offen offset:16
    buffer_load_dwordx4 v[54:57], v44, s[68:71], s38 offen
    buffer_load_dwordx4 v[58:61], v44, s[68:71], s38 offen offset:16
    buffer_load_dwordx4 v[62:65], v3, s[76:79], s3 offen
    s_waitcnt vmcnt(1)

    v_subrev_u32 v46, s83, v46
    v_subrev_u32 v82, s84, v54
    v_cmp_gt_u32 vcc, s43, v46
    v_cmp_gt_u32 s[64:65], s85, v82
    v_lshlrev_b32 v54, 3, v54
    s_nand_b64 exec, vcc, s[64:65]
    v_bfrev_b32 v54, 1
    s_mov_b64 exec, -1
    buffer_load_dwordx2 v[66:67], v54, s[8:11], 0 offen

    v_subrev_u32 v47, s83, v47
    v_subrev_u32 v82, s84, v55
    v_cmp_gt_u32 vcc, s43, v47
    v_cmp_gt_u32 s[64:65], s85, v82
    v_lshlrev_b32 v55, 3, v55
    s_nand_b64 exec, vcc, s[64:65]
    v_bfrev_b32 v55, 1
    s_mov_b64 exec, -1
    buffer_load_dwordx2 v[68:69], v55, s[8:11], 0 offen

    v_subrev_u32 v48, s83, v48
    v_subrev_u32 v82, s84, v56
    v_cmp_gt_u32 vcc, s43, v48
    v_cmp_gt_u32 s[64:65], s85, v82
    v_lshlrev_b32 v56, 3, v56
    s_nand_b64 exec, vcc, s[64:65]
    v_bfrev_b32 v56, 1
    s_mov_b64 exec, -1
    buffer_load_dwordx2 v[70:71], v56, s[8:11], 0 offen

    v_subrev_u32 v49, s83, v49
    v_subrev_u32 v82, s84, v57
    v_cmp_gt_u32 vcc, s43, v49
    v_cmp_gt_u32 s[64:65], s85, v82
    v_lshlrev_b32 v57, 3, v57
    s_nand_b64 exec, vcc, s[64:65]
    v_bfrev_b32 v57, 1
    s_mov_b64 exec, -1
    buffer_load_dwordx2 v[72:73], v57, s[8:11], 0 offen

    v_subrev_u32 v50, s83, v50
    v_subrev_u32 v82, s84, v58
    v_cmp_gt_u32 vcc, s43, v50
    v_cmp_gt_u32 s[64:65], s85, v82
    v_lshlrev_b32 v58, 3, v58
    s_nand_b64 exec, vcc, s[64:65]
    v_bfrev_b32 v58, 1
    s_mov_b64 exec, -1
    buffer_load_dwordx2 v[74:75], v58, s[8:11], 0 offen

    v_subrev_u32 v51, s83, v51
    v_subrev_u32 v82, s84, v59
    v_cmp_gt_u32 vcc, s43, v51
    v_cmp_gt_u32 s[64:65], s85, v82
    v_lshlrev_b32 v59, 3, v59
    s_nand_b64 exec, vcc, s[64:65]
    v_bfrev_b32 v59, 1
    s_mov_b64 exec, -1
    buffer_load_dwordx2 v[76:77], v59, s[8:11], 0 offen

    v_subrev_u32 v52, s83, v52
    v_subrev_u32 v82, s84, v60
    v_cmp_gt_u32 vcc, s43, v52
    v_cmp_gt_u32 s[64:65], s85, v82
    v_lshlrev_b32 v60, 3, v60
    s_nand_b64 exec, vcc, s[64:65]
    v_bfrev_b32 v60, 1
    s_mov_b64 exec, -1
    buffer_load_dwordx2 v[78:79], v60, s[8:11], 0 offen

    v_subrev_u32 v53, s83, v53
    v_subrev_u32 v82, s84, v61
    v_cmp_gt_u32 vcc, s43, v53
    v_cmp_gt_u32 s[64:65], s85, v82
    v_lshlrev_b32 v61, 3, v61
    s_nand_b64 exec, vcc, s[64:65]
    v_bfrev_b32 v61, 1
    s_mov_b64 exec, -1
    buffer_load_dwordx2 v[80:81], v61, s[8:11], 0 offen

    s_waitcnt vmcnt(0)
    v_cmp_le_i32 vcc, 0, v54
    s_mov_b64 exec, vcc
    s_cbranch_execz L_rsk_124
    v_lshlrev_b32 v82, 16, v62
    v_mul_f32 v82, v82, v45
    v_fract_f32 v82, v82
    v_cos_f32 v82, v82
    v_lshlrev_b32 v46, 4, v46
    v_lshlrev_b32 v83, 16, v66
    v_and_b32 v84, s32, v66
    v_lshlrev_b32 v85, 16, v67
    v_and_b32 v86, s32, v67

    v_mul_f32 v83, v83, v82
    ds_add_f32 v46, v83 offset:50000
    v_mul_f32 v84, v84, v82
    ds_add_f32 v46, v84 offset:50004
    v_mul_f32 v85, v85, v82
    ds_add_f32 v46, v85 offset:50008
    v_mul_f32 v86, v86, v82
    ds_add_f32 v46, v86 offset:50012
L_rsk_124:
    s_mov_b64 exec, -1
    v_cmp_le_i32 vcc, 0, v55
    s_mov_b64 exec, vcc
    s_cbranch_execz L_rsk_125
    v_and_b32 v82, s32, v62
    v_mul_f32 v82, v82, v45
    v_fract_f32 v82, v82
    v_cos_f32 v82, v82
    v_lshlrev_b32 v47, 4, v47
    v_lshlrev_b32 v83, 16, v68
    v_and_b32 v84, s32, v68
    v_lshlrev_b32 v85, 16, v69
    v_and_b32 v86, s32, v69

    v_mul_f32 v83, v83, v82
    ds_add_f32 v47, v83 offset:50000
    v_mul_f32 v84, v84, v82
    ds_add_f32 v47, v84 offset:50004
    v_mul_f32 v85, v85, v82
    ds_add_f32 v47, v85 offset:50008
    v_mul_f32 v86, v86, v82
    ds_add_f32 v47, v86 offset:50012
L_rsk_125:
    s_mov_b64 exec, -1
    v_cmp_le_i32 vcc, 0, v56
    s_mov_b64 exec, vcc
    s_cbranch_execz L_rsk_126
    v_lshlrev_b32 v82, 16, v63
    v_mul_f32 v82, v82, v45
    v_fract_f32 v82, v82
    v_cos_f32 v82, v82
    v_lshlrev_b32 v48, 4, v48
    v_lshlrev_b32 v83, 16, v70
    v_and_b32 v84, s32, v70
    v_lshlrev_b32 v85, 16, v71
    v_and_b32 v86, s32, v71

    v_mul_f32 v83, v83, v82
    ds_add_f32 v48, v83 offset:50000
    v_mul_f32 v84, v84, v82
    ds_add_f32 v48, v84 offset:50004
    v_mul_f32 v85, v85, v82
    ds_add_f32 v48, v85 offset:50008
    v_mul_f32 v86, v86, v82
    ds_add_f32 v48, v86 offset:50012
L_rsk_126:
    s_mov_b64 exec, -1
    v_cmp_le_i32 vcc, 0, v57
    s_mov_b64 exec, vcc
    s_cbranch_execz L_rsk_127
    v_and_b32 v82, s32, v63
    v_mul_f32 v82, v82, v45
    v_fract_f32 v82, v82
    v_cos_f32 v82, v82
    v_lshlrev_b32 v49, 4, v49
    v_lshlrev_b32 v83, 16, v72
    v_and_b32 v84, s32, v72
    v_lshlrev_b32 v85, 16, v73
    v_and_b32 v86, s32, v73

    v_mul_f32 v83, v83, v82
    ds_add_f32 v49, v83 offset:50000
    v_mul_f32 v84, v84, v82
    ds_add_f32 v49, v84 offset:50004
    v_mul_f32 v85, v85, v82
    ds_add_f32 v49, v85 offset:50008
    v_mul_f32 v86, v86, v82
    ds_add_f32 v49, v86 offset:50012
L_rsk_127:
    s_mov_b64 exec, -1
    v_cmp_le_i32 vcc, 0, v58
    s_mov_b64 exec, vcc
    s_cbranch_execz L_rsk_128
    v_lshlrev_b32 v82, 16, v64
    v_mul_f32 v82, v82, v45
    v_fract_f32 v82, v82
    v_cos_f32 v82, v82
    v_lshlrev_b32 v50, 4, v50
    v_lshlrev_b32 v83, 16, v74
    v_and_b32 v84, s32, v74
    v_lshlrev_b32 v85, 16, v75
    v_and_b32 v86, s32, v75

    v_mul_f32 v83, v83, v82
    ds_add_f32 v50, v83 offset:50000
    v_mul_f32 v84, v84, v82
    ds_add_f32 v50, v84 offset:50004
    v_mul_f32 v85, v85, v82
    ds_add_f32 v50, v85 offset:50008
    v_mul_f32 v86, v86, v82
    ds_add_f32 v50, v86 offset:50012
L_rsk_128:
    s_mov_b64 exec, -1
    v_cmp_le_i32 vcc, 0, v59
    s_mov_b64 exec, vcc
    s_cbranch_execz L_rsk_129
    v_and_b32 v82, s32, v64
    v_mul_f32 v82, v82, v45
    v_fract_f32 v82, v82
    v_cos_f32 v82, v82
    v_lshlrev_b32 v51, 4, v51
    v_lshlrev_b32 v83, 16, v76
    v_and_b32 v84, s32, v76
    v_lshlrev_b32 v85, 16, v77
    v_and_b32 v86, s32, v77

    v_mul_f32 v83, v83, v82
    ds_add_f32 v51, v83 offset:50000
    v_mul_f32 v84, v84, v82
    ds_add_f32 v51, v84 offset:50004
    v_mul_f32 v85, v85, v82
    ds_add_f32 v51, v85 offset:50008
    v_mul_f32 v86, v86, v82
    ds_add_f32 v51, v86 offset:50012
L_rsk_129:
    s_mov_b64 exec, -1
    v_cmp_le_i32 vcc, 0, v60
    s_mov_b64 exec, vcc
    s_cbranch_execz L_rsk_130
    v_lshlrev_b32 v82, 16, v65
    v_mul_f32 v82, v82, v45
    v_fract_f32 v82, v82
    v_cos_f32 v82, v82
    v_lshlrev_b32 v52, 4, v52
    v_lshlrev_b32 v83, 16, v78
    v_and_b32 v84, s32, v78
    v_lshlrev_b32 v85, 16, v79
    v_and_b32 v86, s32, v79

    v_mul_f32 v83, v83, v82
    ds_add_f32 v52, v83 offset:50000
    v_mul_f32 v84, v84, v82
    ds_add_f32 v52, v84 offset:50004
    v_mul_f32 v85, v85, v82
    ds_add_f32 v52, v85 offset:50008
    v_mul_f32 v86, v86, v82
    ds_add_f32 v52, v86 offset:50012
L_rsk_130:
    s_mov_b64 exec, -1
    v_cmp_le_i32 vcc, 0, v61
    s_mov_b64 exec, vcc
    s_cbranch_execz L_rsk_131
    v_and_b32 v82, s32, v65
    v_mul_f32 v82, v82, v45
    v_fract_f32 v82, v82
    v_cos_f32 v82, v82
    v_lshlrev_b32 v53, 4, v53
    v_lshlrev_b32 v83, 16, v80
    v_and_b32 v84, s32, v80
    v_lshlrev_b32 v85, 16, v81
    v_and_b32 v86, s32, v81

    v_mul_f32 v83, v83, v82
    ds_add_f32 v53, v83 offset:50000
    v_mul_f32 v84, v84, v82
    ds_add_f32 v53, v84 offset:50004
    v_mul_f32 v85, v85, v82
    ds_add_f32 v53, v85 offset:50008
    v_mul_f32 v86, v86, v82
    ds_add_f32 v53, v86 offset:50012
L_rsk_131:
    s_mov_b64 exec, -1
    s_add_u32 s38, s38, 32768
    s_cmp_lt_u32 s38, 204800000
    s_cbranch_scc1 L_rawl_118
L_swend_119:
    s_waitcnt lgkmcnt(0)
    s_barrier
    s_mul_i32 s3, s37, 800000
    s_mul_i32 s5, s36, 12500
    s_add_u32 s3, s3, s5
    s_add_u32 s3, s3, s51
    s_lshl_b32 s3, s3, 4
    s_add_u32 s3, s3, 34496512

    s_add_u32 s20, s6, s3
    s_addc_u32 s21, s7, 0
    s_mov_b32 s22, 100000
    s_mov_b32 s23, 0x20000
    v_mov_b32 v36, v3
    s_mov_b32 s38, 0
L_wl_120:
    v_min_u32 v37, 100000, v36
    ds_read_b128 v[28:31], v37 offset:50000
    s_waitcnt lgkmcnt(0)
    buffer_store_dwordx4 v[28:31], v36, s[20:23], 0 offen sc1
    s_waitcnt vmcnt(0)
    v_add_u32 v36, 16384, v36
    s_add_u32 s38, s38, 1024
    s_cmp_lt_u32 s38, 6250
    s_cbranch_scc1 L_wl_120
    s_add_u32 s51, s51, 6250
    s_cmp_lt_u32 s51, 12500
    s_cbranch_scc1 L_sweep_116
    s_lshl_b32 s33, 16, s37
    s_add_u32 s33, s33, 1
    s_branch L_fin_83

.section .rodata,"a"
.p2align 6
.amdhsa_kernel g1_kernel
  .amdhsa_next_free_vgpr 128
  .amdhsa_next_free_sgpr 102
  .amdhsa_accum_offset 128
  .amdhsa_group_segment_fixed_size 0
  .amdhsa_kernarg_size 112
  .amdhsa_user_sgpr_count 2
  .amdhsa_user_sgpr_kernarg_segment_ptr 1
  .amdhsa_system_sgpr_workgroup_id_x 1
  .amdhsa_float_denorm_mode_32 3
.end_amdhsa_kernel
.p2align 6
.amdhsa_kernel standalone__molecular_angular_gemnet__graph_kernel
  .amdhsa_next_free_vgpr 128
  .amdhsa_next_free_sgpr 102
  .amdhsa_accum_offset 128
  .amdhsa_group_segment_fixed_size 0
  .amdhsa_kernarg_size 112
  .amdhsa_user_sgpr_count 2
  .amdhsa_user_sgpr_kernarg_segment_ptr 1
  .amdhsa_system_sgpr_workgroup_id_x 1
  .amdhsa_float_denorm_mode_32 3
.end_amdhsa_kernel
```

```asm
; @launch kernel=g1_kernel grid=(256,1,1) block=(1024,1,1) lds=163840
; @launch kernel=standalone__molecular_angular_gemnet__graph_kernel grid=(256,1,1) block=(1024,1,1) lds=163840
.amdgcn_target "amdgcn-amd-amdhsa--gfx950"
.text
.globl g1_kernel
.p2align 8
.type g1_kernel,@function
g1_kernel:
    s_cmp_ge_u32 s2, 256
    s_cbranch_scc1 L_p1done_1
    s_load_dwordx4 s[80:83], s[0:1], 8
    s_load_dwordx2 s[84:85], s[0:1], 32
    s_load_dwordx2 s[86:87], s[0:1], 48
    s_load_dwordx4 s[4:7], s[0:1], 96
    s_load_dwordx2 s[78:79], s[0:1], 0
    v_lshlrev_b32 v1, 4, v0
    v_lshlrev_b32 v2, 3, v0
    v_lshlrev_b32 v98, 20, v0
    s_waitcnt lgkmcnt(0)
    s_load_dword s88, s[86:87], 0

    s_mov_b32 s96, s4
    s_mov_b32 s97, s5
    s_mov_b32 s98, 256
    s_mov_b32 s99, 0x20000
    v_readfirstlane_b32 s74, v0
    s_nop 1
    s_or_b32 s74, s74, s2
    s_cbranch_scc1 L_noinit_2

    v_mov_b32 v110, 1
    buffer_atomic_add v110, v98, s[96:99], 0 offen offset:64 sc0
    s_waitcnt vmcnt(0)
    v_readfirstlane_b32 s74, v110
    s_nop 1
    s_cmp_lg_u32 s74, 0
    s_cbranch_scc1 L_zno_4

    s_mov_b32 s92, s6
    s_mov_b32 s93, s7
    s_mov_b32 s94, 32784
    s_mov_b32 s95, 0x20000
    v_mov_b32 v110, 0
    v_mov_b32 v111, 0
    v_mov_b32 v112, 0
    v_mov_b32 v113, 0
L_zl_3:
    buffer_store_dwordx4 v[110:113], v1, s[92:95], s74 offen sc0 sc1
    s_add_u32 s74, s74, 1024
    s_cmp_le_u32 s74, 32768
    s_cbranch_scc1 L_zl_3
    v_mov_b32 v114, 1
    s_waitcnt vmcnt(0)
    buffer_atomic_add v114, v98, s[96:99], 0 offen offset:128
L_zno_4:

L_noinit_2:
    s_mov_b32 s20, s78
    s_mov_b32 s21, s79
    s_mov_b32 s22, 6400000
    s_mov_b32 s23, 0x20000
    v_mul_u32_u24 v110, 6240, v0
    v_and_b32 v111, 63, v0
    v_and_b32 v112, 0x3c0, v0
    v_lshlrev_b32 v111, 2, v111
    v_lshl_or_b32 v111, v112, 4, v111
    v_lshlrev_b32 v100, 2, v0
    s_lshr_b32 s50, s2, 1
    s_and_b32 s53, s2, 1
    s_mul_i32 s3, s50, 50000
    s_mul_i32 s54, s53, 24576
    s_add_u32 s3, s3, s54

    buffer_load_dwordx4 v[56:59], v110, s[20:23], 0 offen
    s_add_u32 s20, s78, s3
    s_addc_u32 s21, s79, 0
    s_mov_b32 s22, 24576
    s_mov_b32 s23, 0x20000
    s_movk_i32 s3, 16384
    buffer_load_dword v44, v111, s[20:23], 0 offen offset:0
    buffer_load_dword v45, v111, s[20:23], 0 offen offset:256
    buffer_load_dword v46, v111, s[20:23], 0 offen offset:512
    buffer_load_dword v47, v111, s[20:23], 0 offen offset:768
    buffer_load_dword v48, v111, s[20:23], s3 offen offset:0
    buffer_load_dword v49, v111, s[20:23], s3 offen offset:256
    buffer_load_dword v50, v111, s[20:23], s3 offen offset:512
    buffer_load_dword v51, v111, s[20:23], s3 offen offset:768
    s_mul_i32 s22, s53, 25424
    s_movk_i32 s3, 24576

    buffer_load_dword v52, v100, s[20:23], s3 offen
    s_mul_i32 s3, s50, 50048
    s_add_u32 s3, s3, s54
    s_add_u32 s54, s3, 2490368

    v_readfirstlane_b32 s74, v0
    s_mov_b32 s55, 0x05040100
    s_nop 0
    s_cmp_lt_u32 s74, 768
    s_cbranch_scc1 L_nogate_5
    s_load_dwordx2 s[92:93], s[0:1], 40
    s_load_dwordx4 s[32:35], s[0:1], 56
    v_mov_b32 v110, 0
    s_waitcnt lgkmcnt(0)
    global_load_dwordx4 v[60:63], v110, s[92:93]

    global_load_dwordx4 v[64:67], v110, s[32:33] offset:0
    global_load_dwordx4 v[80:83], v110, s[34:35] offset:0
    global_load_dwordx4 v[68:71], v110, s[32:33] offset:16
    global_load_dwordx4 v[84:87], v110, s[34:35] offset:16
    global_load_dwordx4 v[72:75], v110, s[32:33] offset:32
    global_load_dwordx4 v[88:91], v110, s[34:35] offset:32
    global_load_dwordx4 v[76:79], v110, s[32:33] offset:48
    global_load_dwordx4 v[92:95], v110, s[34:35] offset:48
    s_lshl_b32 s74, s2, 8
    v_and_b32 v111, 255, v0
    v_add_u32 v111, s74, v111
    v_lshlrev_b32 v112, 16, v111
    v_lshlrev_b32 v111, 5, v111
    s_mov_b32 s75, 0x07060302
    s_waitcnt vmcnt(0)

    v_lshlrev_b32 v118, 16, v60
    v_and_b32 v119, 0xffff0000, v60
    v_lshlrev_b32 v120, 16, v61
    v_and_b32 v121, 0xffff0000, v61
    v_lshlrev_b32 v122, 16, v62
    v_and_b32 v123, 0xffff0000, v62
    v_lshlrev_b32 v124, 16, v63
    v_and_b32 v125, 0xffff0000, v63
    v_sub_f32 v118, v112, v118
    v_sub_f32 v119, v112, v119
    v_sub_f32 v120, v112, v120
    v_sub_f32 v121, v112, v121
    v_sub_f32 v122, v112, v122
    v_sub_f32 v123, v112, v123
    v_sub_f32 v124, v112, v124
    v_sub_f32 v125, v112, v125
    v_cvt_pk_bf16_f32 v118, v118, v119
    v_cvt_pk_bf16_f32 v120, v120, v121
    v_cvt_pk_bf16_f32 v122, v122, v123
    v_cvt_pk_bf16_f32 v124, v124, v125
    v_and_b32 v119, 0xffff0000, v118
    v_lshlrev_b32 v118, 16, v118
    v_and_b32 v121, 0xffff0000, v120
    v_lshlrev_b32 v120, 16, v120
    v_and_b32 v123, 0xffff0000, v122
    v_lshlrev_b32 v122, 16, v122
    v_and_b32 v125, 0xffff0000, v124
    v_lshlrev_b32 v124, 16, v124
    v_mul_f32 v118, v118, v118
    v_mul_f32 v119, v119, v119
    v_mul_f32 v120, v120, v120
    v_mul_f32 v121, v121, v121
    v_mul_f32 v122, v122, v122
    v_mul_f32 v123, v123, v123
    v_mul_f32 v124, v124, v124
    v_mul_f32 v125, v125, v125
    v_cvt_pk_bf16_f32 v118, v118, v119
    v_cvt_pk_bf16_f32 v120, v120, v121
    v_cvt_pk_bf16_f32 v122, v122, v123
    v_cvt_pk_bf16_f32 v124, v124, v125
    v_and_b32 v119, 0xffff0000, v118
    v_lshlrev_b32 v118, 16, v118
    v_and_b32 v121, 0xffff0000, v120
    v_lshlrev_b32 v120, 16, v120
    v_and_b32 v123, 0xffff0000, v122
    v_lshlrev_b32 v122, 16, v122
    v_and_b32 v125, 0xffff0000, v124
    v_lshlrev_b32 v124, 16, v124
    v_mul_f32 v118, 0xc1200000, v118
    v_mul_f32 v119, 0xc1200000, v119
    v_mul_f32 v120, 0xc1200000, v120
    v_mul_f32 v121, 0xc1200000, v121
    v_mul_f32 v122, 0xc1200000, v122
    v_mul_f32 v123, 0xc1200000, v123
    v_mul_f32 v124, 0xc1200000, v124
    v_mul_f32 v125, 0xc1200000, v125
    v_cvt_pk_bf16_f32 v118, v118, v119
    v_cvt_pk_bf16_f32 v120, v120, v121
    v_cvt_pk_bf16_f32 v122, v122, v123
    v_cvt_pk_bf16_f32 v124, v124, v125
    v_and_b32 v119, 0xffff0000, v118
    v_lshlrev_b32 v118, 16, v118
    v_and_b32 v121, 0xffff0000, v120
    v_lshlrev_b32 v120, 16, v120
    v_and_b32 v123, 0xffff0000, v122
    v_lshlrev_b32 v122, 16, v122
    v_and_b32 v125, 0xffff0000, v124
    v_lshlrev_b32 v124, 16, v124
    v_mul_f32 v118, 0x3fb8aa3b, v118
    v_mul_f32 v119, 0x3fb8aa3b, v119
    v_mul_f32 v120, 0x3fb8aa3b, v120
    v_mul_f32 v121, 0x3fb8aa3b, v121
    v_mul_f32 v122, 0x3fb8aa3b, v122
    v_mul_f32 v123, 0x3fb8aa3b, v123
    v_mul_f32 v124, 0x3fb8aa3b, v124
    v_mul_f32 v125, 0x3fb8aa3b, v125
    v_exp_f32 v118, v118
    v_exp_f32 v119, v119
    v_exp_f32 v120, v120
    v_exp_f32 v121, v121
    v_exp_f32 v122, v122
    v_exp_f32 v123, v123
    v_exp_f32 v124, v124
    v_exp_f32 v125, v125
    s_nop 0
    v_cvt_pk_bf16_f32 v118, v118, v119
    v_cvt_pk_bf16_f32 v120, v120, v121
    v_cvt_pk_bf16_f32 v122, v122, v123
    v_cvt_pk_bf16_f32 v124, v124, v125
    v_perm_b32 v113, v66, v64, s55
    v_dot2_f32_bf16 v114, v118, v113, 0

    v_perm_b32 v113, v66, v64, s75
    v_dot2_f32_bf16 v115, v118, v113, 0

    v_perm_b32 v113, v67, v65, s55
    v_dot2_f32_bf16 v116, v118, v113, 0

    v_perm_b32 v113, v67, v65, s75
    v_dot2_f32_bf16 v117, v118, v113, 0

    v_perm_b32 v113, v70, v68, s55
    v_dot2_f32_bf16 v114, v120, v113, v114

    v_perm_b32 v113, v70, v68, s75
    v_dot2_f32_bf16 v115, v120, v113, v115

    v_perm_b32 v113, v71, v69, s55
    v_dot2_f32_bf16 v116, v120, v113, v116

    v_perm_b32 v113, v71, v69, s75
    v_dot2_f32_bf16 v117, v120, v113, v117

    v_perm_b32 v113, v74, v72, s55
    v_dot2_f32_bf16 v114, v122, v113, v114

    v_perm_b32 v113, v74, v72, s75
    v_dot2_f32_bf16 v115, v122, v113, v115

    v_perm_b32 v113, v75, v73, s55
    v_dot2_f32_bf16 v116, v122, v113, v116

    v_perm_b32 v113, v75, v73, s75
    v_dot2_f32_bf16 v117, v122, v113, v117

    v_perm_b32 v113, v78, v76, s55
    v_dot2_f32_bf16 v114, v124, v113, v114

    v_perm_b32 v113, v78, v76, s75
    v_dot2_f32_bf16 v115, v124, v113, v115

    v_perm_b32 v113, v79, v77, s55
    v_dot2_f32_bf16 v116, v124, v113, v116

    v_perm_b32 v113, v79, v77, s75
    v_dot2_f32_bf16 v117, v124, v113, v117

    v_perm_b32 v113, v82, v80, s55
    v_dot2_f32_bf16 v60, v118, v113, 0

    v_perm_b32 v113, v82, v80, s75
    v_dot2_f32_bf16 v61, v118, v113, 0

    v_perm_b32 v113, v83, v81, s55
    v_dot2_f32_bf16 v62, v118, v113, 0

    v_perm_b32 v113, v83, v81, s75
    v_dot2_f32_bf16 v63, v118, v113, 0

    v_perm_b32 v113, v86, v84, s55
    v_dot2_f32_bf16 v60, v120, v113, v60

    v_perm_b32 v113, v86, v84, s75
    v_dot2_f32_bf16 v61, v120, v113, v61

    v_perm_b32 v113, v87, v85, s55
    v_dot2_f32_bf16 v62, v120, v113, v62

    v_perm_b32 v113, v87, v85, s75
    v_dot2_f32_bf16 v63, v120, v113, v63

    v_perm_b32 v113, v90, v88, s55
    v_dot2_f32_bf16 v60, v122, v113, v60

    v_perm_b32 v113, v90, v88, s75
    v_dot2_f32_bf16 v61, v122, v113, v61

    v_perm_b32 v113, v91, v89, s55
    v_dot2_f32_bf16 v62, v122, v113, v62

    v_perm_b32 v113, v91, v89, s75
    v_dot2_f32_bf16 v63, v122, v113, v63

    v_perm_b32 v113, v94, v92, s55
    v_dot2_f32_bf16 v60, v124, v113, v60

    v_perm_b32 v113, v94, v92, s75
    v_dot2_f32_bf16 v61, v124, v113, v61

    v_perm_b32 v113, v95, v93, s55
    v_dot2_f32_bf16 v62, v124, v113, v62

    v_perm_b32 v113, v95, v93, s75
    v_dot2_f32_bf16 v63, v124, v113, v63

    s_add_u32 s92, s6, 393216
    s_addc_u32 s93, s7, 0
    s_mov_b32 s94, 2097152
    s_mov_b32 s95, 0x20000
    v_cvt_pk_bf16_f32 v114, v114, v115
    v_cvt_pk_bf16_f32 v115, v116, v117
    buffer_store_dwordx4 v[60:63], v111, s[92:95], 0 offen
    buffer_store_dwordx2 v[114:115], v111, s[92:95], 0 offen offset:16
    s_nop 1
L_nogate_5:

    s_mov_b32 s8, s80
    s_mov_b32 s9, s81
    s_mov_b32 s10, 0
    s_mov_b32 s11, 0x20000
    s_mov_b32 s12, s82
    s_mov_b32 s13, s83
    s_mov_b32 s14, 0
    s_mov_b32 s15, 0x20000
    s_mov_b32 s16, s84
    s_mov_b32 s17, s85
    s_mov_b32 s18, 0
    s_mov_b32 s19, 0x20000
    s_lshr_b32 s74, s2, 1
    s_and_b32 s74, s74, 28
    s_lshr_b32 s86, 0x00102010, s74
    s_lshr_b32 s87, 0x44414241, s74
    s_lshr_b32 s41, 0x43221100, s74
    s_and_b32 s86, s86, 15
    s_and_b32 s87, s87, 15
    s_and_b32 s41, s41, 15
    s_lshr_b32 s74, s2, 6
    s_lshl_b32 s74, s74, 3
    s_and_b32 s75, s2, 7
    s_add_u32 s74, s74, s75
    s_mul_i32 s74, s74, 5
    s_add_u32 s41, s41, s74

    s_mul_i32 s78, s41, 16384
    s_add_u32 s49, s78, 16384
    s_cmp_ge_u32 s41, 3125
    s_cmovk_i32 s49, 0
    s_cmovk_i32 s78, 0
    s_lshl_b32 s10, s49, 2
    s_lshl_b32 s14, s49, 2
    s_lshl_b32 s18, s49, 1
    s_sub_u32 s79, s87, s86
    s_bfm_b32 s85, s79, s86
    s_lshl_b32 s86, s86, 12
    s_lshl_b32 s87, s87, 12
    s_min_u32 s87, s87, 16384

    s_add_u32 s79, s78, 0
    s_bitcmp1_b32 s85, 0
    s_cselect_b32 s79, s79, 0x1ff00000
    s_lshl_b32 s56, s79, 2
    s_lshl_b32 s61, s79, 1

    s_add_u32 s79, s78, 4096
    s_bitcmp1_b32 s85, 1
    s_cselect_b32 s79, s79, 0x1ff00000
    s_lshl_b32 s57, s79, 2
    s_lshl_b32 s62, s79, 1

    s_add_u32 s79, s78, 8192
    s_bitcmp1_b32 s85, 2
    s_cselect_b32 s79, s79, 0x1ff00000
    s_lshl_b32 s58, s79, 2
    s_lshl_b32 s63, s79, 1

    s_add_u32 s79, s78, 12288
    s_bitcmp1_b32 s85, 3
    s_cselect_b32 s79, s79, 0x1ff00000
    s_lshl_b32 s59, s79, 2
    s_lshl_b32 s64, s79, 1

    s_mov_b32 s82, s85
    s_mov_b32 s83, s86
    s_mov_b32 s84, s87
    s_add_u32 s41, s2, 160
    s_mul_i32 s74, s41, 16384
    s_mov_b32 s10, 204800000
    s_mov_b32 s14, 204800000
    s_mov_b32 s18, 102400000

    s_add_u32 s75, s74, 0
    s_lshl_b32 s76, s75, 2
    s_lshl_b32 s75, s75, 1
    s_bitcmp1_b32 s82, 0
    s_cselect_b32 s56, s56, s76
    s_cselect_b32 s61, s61, s75

    s_add_u32 s75, s74, 4096
    s_lshl_b32 s76, s75, 2
    s_lshl_b32 s75, s75, 1
    s_bitcmp1_b32 s82, 1
    s_cselect_b32 s57, s57, s76
    s_cselect_b32 s62, s62, s75

    s_add_u32 s75, s74, 8192
    s_lshl_b32 s76, s75, 2
    s_lshl_b32 s75, s75, 1
    s_bitcmp1_b32 s82, 2
    s_cselect_b32 s58, s58, s76
    s_cselect_b32 s63, s63, s75

    s_add_u32 s75, s74, 12288
    s_lshl_b32 s76, s75, 2
    s_lshl_b32 s75, s75, 1
    s_bitcmp1_b32 s82, 3
    s_cselect_b32 s59, s59, s76
    s_cselect_b32 s64, s64, s75

    buffer_load_dwordx4 v[20:23], v1, s[12:15], s56 offen nt
    buffer_load_dwordx4 v[4:7], v1, s[8:11], s56 offen nt
    buffer_load_dwordx2 v[36:37], v2, s[16:19], s61 offen nt
    buffer_load_dwordx4 v[24:27], v1, s[12:15], s57 offen nt
    buffer_load_dwordx4 v[8:11], v1, s[8:11], s57 offen nt
    buffer_load_dwordx2 v[38:39], v2, s[16:19], s62 offen nt
    buffer_load_dwordx4 v[28:31], v1, s[12:15], s58 offen nt
    buffer_load_dwordx4 v[12:15], v1, s[8:11], s58 offen nt
    buffer_load_dwordx2 v[40:41], v2, s[16:19], s63 offen nt
    buffer_load_dwordx4 v[32:35], v1, s[12:15], s59 offen nt
    buffer_load_dwordx4 v[16:19], v1, s[8:11], s59 offen nt
    buffer_load_dwordx2 v[42:43], v2, s[16:19], s64 offen nt
    s_mov_b32 s86, 0
    s_mov_b32 s87, 4
    s_mul_i32 s78, s41, 16384
    s_add_u32 s49, s78, 16384
    s_cmp_ge_u32 s41, 3125
    s_cmovk_i32 s49, 0
    s_cmovk_i32 s78, 0
    s_lshl_b32 s10, s49, 2
    s_lshl_b32 s14, s49, 2
    s_lshl_b32 s18, s49, 1
    s_sub_u32 s79, s87, s86
    s_bfm_b32 s85, s79, s86
    s_lshl_b32 s86, s86, 12
    s_lshl_b32 s87, s87, 12
    s_min_u32 s87, s87, 16384

    s_add_u32 s79, s78, 0
    s_bitcmp1_b32 s85, 0
    s_cselect_b32 s79, s79, 0x1ff00000
    s_lshl_b32 s56, s79, 2
    s_lshl_b32 s61, s79, 1

    s_add_u32 s79, s78, 4096
    s_bitcmp1_b32 s85, 1
    s_cselect_b32 s79, s79, 0x1ff00000
    s_lshl_b32 s57, s79, 2
    s_lshl_b32 s62, s79, 1

    s_add_u32 s79, s78, 8192
    s_bitcmp1_b32 s85, 2
    s_cselect_b32 s79, s79, 0x1ff00000
    s_lshl_b32 s58, s79, 2
    s_lshl_b32 s63, s79, 1

    s_add_u32 s79, s78, 12288
    s_bitcmp1_b32 s85, 3
    s_cselect_b32 s79, s79, 0x1ff00000
    s_lshl_b32 s59, s79, 2
    s_lshl_b32 s64, s79, 1

    s_getreg_b32 s5, hwreg(HW_REG_XCC_ID)
    s_and_b32 s5, s5, 7
    s_mul_i32 s3, s5, 4096

    s_add_u32 s20, s6, s3
    s_addc_u32 s21, s7, 0
    s_mov_b32 s22, 4096
    s_mov_b32 s23, 0x20000
    s_mul_i32 s3, s5, 67117056
    s_add_u32 s3, s3, 85721088
    s_add_u32 s24, s6, s3
    s_addc_u32 s25, s7, 0
    s_mov_b32 s26, 67117056
    s_mov_b32 s27, 0x20000
    s_add_u32 s36, s6, 32768
    s_addc_u32 s37, s7, 0
    s_mov_b32 s38, 4
    s_mov_b32 s39, 0x20000
    s_mov_b32 s40, 687195
    s_mov_b32 s42, -6250
    s_mov_b32 s43, 1942
    s_mov_b32 s45, 0x06050400
    s_mov_b32 s46, 0x05040c00
    s_mov_b32 s47, 0x04020100
    s_mov_b32 s48, 6552
    s_mov_b32 s50, 0
    v_mov_b32 v104, 1
    v_mov_b32 v105, 0x46ff8000
    s_mov_b32 s55, 0x05040100
    v_mul_u32_u24 v106, 5, v0
    v_mov_b32 v108, 16384
    v_mov_b32 v114, 0
    v_mov_b32 v115, 0
    v_mov_b32 v116, 0
    v_mov_b32 v117, -1
    ds_write_b64 v2, v[114:115]
    s_movk_i32 s3, 1024
    v_cmp_gt_u32 s[66:67], s3, v0
    s_movk_i32 s3, 1024
    v_cmp_gt_u32 s[68:69], s3, v0
    s_mov_b64 exec, 1
    ds_write_b128 v108, v[114:117]
    s_mov_b64 exec, -1
    s_waitcnt lgkmcnt(0)
    s_lshl_b32 s88, s88, 16
    v_mov_b32 v110, 0.15915494
    v_mul_f32 v110, s88, v110
    s_mov_b32 s3, 0x7fff7fff
    v_readfirstlane_b32 s44, v110

    s_waitcnt vmcnt(12)
    v_mov_b32 v61, 0
    v_mov_b32 v62, 0
    v_mov_b32 v63, 0
    v_dot2_f32_bf16 v61, v44, v44, v61
    v_dot2_f32_bf16 v61, v45, v45, v61
    v_dot2_f32_bf16 v61, v46, v46, v61
    v_dot2_f32_bf16 v61, v47, v47, v61
    v_dot2_f32_bf16 v61, v48, v48, v61
    v_dot2_f32_bf16 v61, v49, v49, v61
    v_dot2_f32_bf16 v61, v50, v50, v61
    v_dot2_f32_bf16 v61, v51, v51, v61
    v_dot2_f32_bf16 v61, v52, v52, v61
    v_dot2_f32_bf16 v62, v56, v56, v62
    v_dot2_f32_bf16 v62, v57, v57, v62
    v_dot2_f32_bf16 v62, v58, v58, v62
    v_dot2_f32_bf16 v62, v59, v59, v62
    v_and_b32 v60, s3, v44
    v_and_b32 v64, s3, v45
    v_pk_max_u16 v60, v60, v64
    v_and_b32 v64, s3, v46
    v_pk_max_u16 v60, v60, v64
    v_and_b32 v64, s3, v47
    v_pk_max_u16 v60, v60, v64
    v_and_b32 v64, s3, v48
    v_pk_max_u16 v60, v60, v64
    v_and_b32 v64, s3, v49
    v_pk_max_u16 v60, v60, v64
    v_and_b32 v64, s3, v50
    v_pk_max_u16 v60, v60, v64
    v_and_b32 v64, s3, v51
    v_pk_max_u16 v60, v60, v64
    v_and_b32 v64, s3, v52
    v_pk_max_u16 v60, v60, v64
    v_lshrrev_b32 v64, 16, v60
    v_and_b32 v60, 0xffff, v60
    v_max_u32 v60, v60, v64

    s_nop 1
    v_max_u32_dpp v60, v60, v60 row_shr:1 row_mask:0xf bank_mask:0xf
    s_nop 1
    v_max_u32_dpp v60, v60, v60 row_shr:2 row_mask:0xf bank_mask:0xf
    s_nop 1
    v_max_u32_dpp v60, v60, v60 row_shr:4 row_mask:0xf bank_mask:0xf
    s_nop 1
    v_max_u32_dpp v60, v60, v60 row_shr:8 row_mask:0xf bank_mask:0xf
    s_nop 1
    v_max_u32_dpp v60, v60, v60 row_bcast:15 row_mask:0xa bank_mask:0xf
    s_nop 1
    v_max_u32_dpp v60, v60, v60 row_bcast:31 row_mask:0xc bank_mask:0xf
    s_nop 1
    v_add_f32_dpp v61, v61, v61 row_shr:1 row_mask:0xf bank_mask:0xf
    s_nop 1
    v_add_f32_dpp v61, v61, v61 row_shr:2 row_mask:0xf bank_mask:0xf
    s_nop 1
    v_add_f32_dpp v61, v61, v61 row_shr:4 row_mask:0xf bank_mask:0xf
    s_nop 1
    v_add_f32_dpp v61, v61, v61 row_shr:8 row_mask:0xf bank_mask:0xf
    s_nop 1
    v_add_f32_dpp v61, v61, v61 row_bcast:15 row_mask:0xa bank_mask:0xf
    s_nop 1
    v_add_f32_dpp v61, v61, v61 row_bcast:31 row_mask:0xc bank_mask:0xf
    s_nop 1
    v_add_f32_dpp v62, v62, v62 row_shr:1 row_mask:0xf bank_mask:0xf
    s_nop 1
    v_add_f32_dpp v62, v62, v62 row_shr:2 row_mask:0xf bank_mask:0xf
    s_nop 1
    v_add_f32_dpp v62, v62, v62 row_shr:4 row_mask:0xf bank_mask:0xf
    s_nop 1
    v_add_f32_dpp v62, v62, v62 row_shr:8 row_mask:0xf bank_mask:0xf
    s_nop 1
    v_add_f32_dpp v62, v62, v62 row_bcast:15 row_mask:0xa bank_mask:0xf
    s_nop 1
    v_add_f32_dpp v62, v62, v62 row_bcast:31 row_mask:0xc bank_mask:0xf
    v_lshrrev_b32 v64, 6, v0
    v_lshlrev_b32 v64, 4, v64
    s_mov_b32 exec_lo, 0
    s_brev_b32 exec_hi, 1
    ds_write_b128 v64, v[60:63] offset:8192
    s_mov_b64 exec, -1
    v_and_b32 v64, 15, v0
    v_lshlrev_b32 v64, 4, v64
    s_waitcnt lgkmcnt(0)
    s_barrier
    ds_read_b128 v[60:63], v64 offset:8192
    s_waitcnt lgkmcnt(0)

    s_nop 0
    v_max_u32_dpp v60, v60, v60 row_ror:1 row_mask:0xf bank_mask:0xf
    v_add_f32_dpp v61, v61, v61 row_ror:1 row_mask:0xf bank_mask:0xf
    v_add_f32_dpp v62, v62, v62 row_ror:1 row_mask:0xf bank_mask:0xf

    s_nop 0
    v_max_u32_dpp v60, v60, v60 row_ror:2 row_mask:0xf bank_mask:0xf
    v_add_f32_dpp v61, v61, v61 row_ror:2 row_mask:0xf bank_mask:0xf
    v_add_f32_dpp v62, v62, v62 row_ror:2 row_mask:0xf bank_mask:0xf

    s_nop 0
    v_max_u32_dpp v60, v60, v60 row_ror:4 row_mask:0xf bank_mask:0xf
    v_add_f32_dpp v61, v61, v61 row_ror:4 row_mask:0xf bank_mask:0xf
    v_add_f32_dpp v62, v62, v62 row_ror:4 row_mask:0xf bank_mask:0xf

    s_nop 0
    v_max_u32_dpp v60, v60, v60 row_ror:8 row_mask:0xf bank_mask:0xf
    v_add_f32_dpp v61, v61, v61 row_ror:8 row_mask:0xf bank_mask:0xf
    v_add_f32_dpp v62, v62, v62 row_ror:8 row_mask:0xf bank_mask:0xf

    v_rsq_f32 v62, v62
    v_mov_b32 v65, 0x4b400000
    v_mul_f32 v62, 0x47decb04, v62
    s_nop 0
    v_readfirstlane_b32 s74, v62

    s_add_u32 s92, s6, 135168
    s_addc_u32 s93, s7, 0
    s_mov_b32 s94, 4096
    s_mov_b32 s95, 0x20000
    s_lshl_b32 s3, s2, 4
    buffer_store_dwordx4 v[60:63], v98, s[92:95], s3 offen
    v_lshlrev_b32 v66, 16, v44
    v_and_b32 v44, 0xffff0000, v44
    v_fma_f32 v66, v66, s74, v65
    v_fma_f32 v44, v44, s74, v65
    v_perm_b32 v44, v44, v66, s55

    v_lshlrev_b32 v66, 16, v45
    v_and_b32 v45, 0xffff0000, v45
    v_fma_f32 v66, v66, s74, v65
    v_fma_f32 v45, v45, s74, v65
    v_perm_b32 v45, v45, v66, s55

    v_lshlrev_b32 v66, 16, v46
    v_and_b32 v46, 0xffff0000, v46
    v_fma_f32 v66, v66, s74, v65
    v_fma_f32 v46, v46, s74, v65
    v_perm_b32 v46, v46, v66, s55

    v_lshlrev_b32 v66, 16, v47
    v_and_b32 v47, 0xffff0000, v47
    v_fma_f32 v66, v66, s74, v65
    v_fma_f32 v47, v47, s74, v65
    v_perm_b32 v47, v47, v66, s55

    v_lshlrev_b32 v66, 16, v48
    v_and_b32 v48, 0xffff0000, v48
    v_fma_f32 v66, v66, s74, v65
    v_fma_f32 v48, v48, s74, v65
    v_perm_b32 v48, v48, v66, s55

    v_lshlrev_b32 v66, 16, v49
    v_and_b32 v49, 0xffff0000, v49
    v_fma_f32 v66, v66, s74, v65
    v_fma_f32 v49, v49, s74, v65
    v_perm_b32 v49, v49, v66, s55

    v_lshlrev_b32 v66, 16, v50
    v_and_b32 v50, 0xffff0000, v50
    v_fma_f32 v66, v66, s74, v65
    v_fma_f32 v50, v50, s74, v65
    v_perm_b32 v50, v50, v66, s55

    v_lshlrev_b32 v66, 16, v51
    v_and_b32 v51, 0xffff0000, v51
    v_fma_f32 v66, v66, s74, v65
    v_fma_f32 v51, v51, s74, v65
    v_perm_b32 v51, v51, v66, s55

    v_lshlrev_b32 v66, 16, v52
    v_and_b32 v52, 0xffff0000, v52
    v_fma_f32 v66, v66, s74, v65
    v_fma_f32 v52, v52, s74, v65
    v_perm_b32 v52, v52, v66, s55

    s_add_u32 s92, s6, s54
    s_addc_u32 s93, s7, 0
    s_mov_b32 s94, 24576
    s_mov_b32 s95, 0x20000
    s_movk_i32 s3, 16384
    buffer_store_dwordx4 v[44:47], v1, s[92:95], 0 offen
    buffer_store_dwordx4 v[48:51], v1, s[92:95], s3 offen
    s_mul_i32 s94, s53, 25424
    s_movk_i32 s3, 24576

    buffer_store_dword v52, v100, s[92:95], s3 offen
    s_nop 1
    v_mov_b32 v100, 0
    buffer_atomic_add v100, v98, s[96:99], 0 offen offset:128 sc0
    s_bitcmp0_b32 s82, 0
    s_cbranch_scc1 L_ska_8
    s_waitcnt vmcnt(14)
    v_mul_hi_u32_u24 v45, s40, v20
    v_mul_hi_u32_u24 v44, s40, v4
    v_mul_hi_u32_u24 v47, s40, v21
    v_mul_hi_u32_u24 v46, s40, v5
    v_mul_hi_u32_u24 v49, s40, v22
    v_mul_hi_u32_u24 v48, s40, v6
    v_mul_hi_u32_u24 v51, s40, v23
    v_mul_hi_u32_u24 v50, s40, v7
    v_and_b32 v45, -2, v45
    v_mad_u32_u24 v4, v44, s43, v4
    v_and_b32 v76, -4, v44
    v_and_b32 v47, -2, v47
    v_mad_u32_u24 v5, v46, s43, v5
    v_and_b32 v77, -4, v46
    v_and_b32 v49, -2, v49
    v_mad_u32_u24 v6, v48, s43, v6
    v_and_b32 v78, -4, v48
    v_and_b32 v51, -2, v51
    v_mad_u32_u24 v7, v50, s43, v7
    v_and_b32 v79, -4, v50
    v_mad_i32_i24 v20, v45, s42, v20
    v_lshl_add_u32 v45, v76, 5, v45
    v_mad_i32_i24 v21, v47, s42, v21
    v_lshl_add_u32 v47, v77, 5, v47
    v_mad_i32_i24 v22, v49, s42, v22
    v_lshl_add_u32 v49, v78, 5, v49
    v_mad_i32_i24 v23, v51, s42, v23
    v_lshl_add_u32 v51, v79, 5, v51
    v_add_u32 v45, v45, v45
    ds_add_rtn_u32 v76, v45, v104
    v_add_u32 v47, v47, v47
    ds_add_rtn_u32 v77, v47, v104
    v_add_u32 v49, v49, v49
    ds_add_rtn_u32 v78, v49, v104
    v_add_u32 v51, v51, v51
    ds_add_rtn_u32 v79, v51, v104
    v_lshlrev_b32 v110, 16, v36
    v_and_b32 v111, 0xffff0000, v36
    v_lshlrev_b32 v112, 16, v37
    v_and_b32 v113, 0xffff0000, v37
    v_mul_f32 v110, s44, v110
    v_mul_f32 v111, s44, v111
    v_mul_f32 v112, s44, v112
    v_mul_f32 v113, s44, v113
    v_fract_f32 v110, v110
    v_fract_f32 v111, v111
    v_fract_f32 v112, v112
    v_fract_f32 v113, v113
    v_cos_f32 v110, v110
    v_cos_f32 v111, v111
    v_cos_f32 v112, v112
    v_cos_f32 v113, v113
    v_lshl_or_b32 v44, v44, 14, v20
    v_perm_b32 v45, v45, v4, s46
    v_bfe_u32 v4, v4, 8, 5

    v_lshl_or_b32 v46, v46, 14, v21
    v_perm_b32 v47, v47, v5, s46
    v_bfe_u32 v5, v5, 8, 5

    v_lshl_or_b32 v48, v48, 14, v22
    v_perm_b32 v49, v49, v6, s46
    v_bfe_u32 v6, v6, 8, 5

    v_lshl_or_b32 v50, v50, 14, v23
    v_perm_b32 v51, v51, v7, s46
    v_bfe_u32 v7, v7, 8, 5

    v_fmaak_f32 v110, v110, v105, 0x4b400010
    v_fmaak_f32 v111, v111, v105, 0x4b400010
    v_fmaak_f32 v112, v112, v105, 0x4b400010
    v_fmaak_f32 v113, v113, v105, 0x4b400010
    v_sub_u32 v110, v110, v4
    v_sub_u32 v111, v111, v5
    v_sub_u32 v112, v112, v6
    v_sub_u32 v113, v113, v7
    v_bfi_b32 v110, 31, v4, v110
    v_bfi_b32 v111, 31, v5, v111
    v_bfi_b32 v112, 31, v6, v112
    v_bfi_b32 v113, 31, v7, v113
    v_perm_b32 v44, v44, v110, s55
    v_perm_b32 v46, v46, v111, s55
    v_perm_b32 v48, v48, v112, s55
    v_perm_b32 v50, v50, v113, s55
    buffer_load_dwordx4 v[20:23], v1, s[12:15], s56 offen nt
    buffer_load_dwordx4 v[4:7], v1, s[8:11], s56 offen nt
    buffer_load_dwordx2 v[36:37], v2, s[16:19], s61 offen nt
L_bka_9:
    s_bitcmp0_b32 s82, 1
    s_cbranch_scc1 L_ska_10
    s_waitcnt vmcnt(14)
    v_mul_hi_u32_u24 v53, s40, v24
    v_mul_hi_u32_u24 v52, s40, v8
    v_mul_hi_u32_u24 v55, s40, v25
    v_mul_hi_u32_u24 v54, s40, v9
    v_mul_hi_u32_u24 v57, s40, v26
    v_mul_hi_u32_u24 v56, s40, v10
    v_mul_hi_u32_u24 v59, s40, v27
    v_mul_hi_u32_u24 v58, s40, v11
    v_and_b32 v53, -2, v53
    v_mad_u32_u24 v8, v52, s43, v8
    v_and_b32 v80, -4, v52
    v_and_b32 v55, -2, v55
    v_mad_u32_u24 v9, v54, s43, v9
    v_and_b32 v81, -4, v54
    v_and_b32 v57, -2, v57
    v_mad_u32_u24 v10, v56, s43, v10
    v_and_b32 v82, -4, v56
    v_and_b32 v59, -2, v59
    v_mad_u32_u24 v11, v58, s43, v11
    v_and_b32 v83, -4, v58
    v_mad_i32_i24 v24, v53, s42, v24
    v_lshl_add_u32 v53, v80, 5, v53
    v_mad_i32_i24 v25, v55, s42, v25
    v_lshl_add_u32 v55, v81, 5, v55
    v_mad_i32_i24 v26, v57, s42, v26
    v_lshl_add_u32 v57, v82, 5, v57
    v_mad_i32_i24 v27, v59, s42, v27
    v_lshl_add_u32 v59, v83, 5, v59
    v_add_u32 v53, v53, v53
    ds_add_rtn_u32 v80, v53, v104
    v_add_u32 v55, v55, v55
    ds_add_rtn_u32 v81, v55, v104
    v_add_u32 v57, v57, v57
    ds_add_rtn_u32 v82, v57, v104
    v_add_u32 v59, v59, v59
    ds_add_rtn_u32 v83, v59, v104
    v_lshlrev_b32 v110, 16, v38
    v_and_b32 v111, 0xffff0000, v38
    v_lshlrev_b32 v112, 16, v39
    v_and_b32 v113, 0xffff0000, v39
    v_mul_f32 v110, s44, v110
    v_mul_f32 v111, s44, v111
    v_mul_f32 v112, s44, v112
    v_mul_f32 v113, s44, v113
    v_fract_f32 v110, v110
    v_fract_f32 v111, v111
    v_fract_f32 v112, v112
    v_fract_f32 v113, v113
    v_cos_f32 v110, v110
    v_cos_f32 v111, v111
    v_cos_f32 v112, v112
    v_cos_f32 v113, v113
    v_lshl_or_b32 v52, v52, 14, v24
    v_perm_b32 v53, v53, v8, s46
    v_bfe_u32 v8, v8, 8, 5

    v_lshl_or_b32 v54, v54, 14, v25
    v_perm_b32 v55, v55, v9, s46
    v_bfe_u32 v9, v9, 8, 5

    v_lshl_or_b32 v56, v56, 14, v26
    v_perm_b32 v57, v57, v10, s46
    v_bfe_u32 v10, v10, 8, 5

    v_lshl_or_b32 v58, v58, 14, v27
    v_perm_b32 v59, v59, v11, s46
    v_bfe_u32 v11, v11, 8, 5

    v_fmaak_f32 v110, v110, v105, 0x4b400010
    v_fmaak_f32 v111, v111, v105, 0x4b400010
    v_fmaak_f32 v112, v112, v105, 0x4b400010
    v_fmaak_f32 v113, v113, v105, 0x4b400010
    v_sub_u32 v110, v110, v8
    v_sub_u32 v111, v111, v9
    v_sub_u32 v112, v112, v10
    v_sub_u32 v113, v113, v11
    v_bfi_b32 v110, 31, v8, v110
    v_bfi_b32 v111, 31, v9, v111
    v_bfi_b32 v112, 31, v10, v112
    v_bfi_b32 v113, 31, v11, v113
    v_perm_b32 v52, v52, v110, s55
    v_perm_b32 v54, v54, v111, s55
    v_perm_b32 v56, v56, v112, s55
    v_perm_b32 v58, v58, v113, s55
    buffer_load_dwordx4 v[24:27], v1, s[12:15], s57 offen nt
    buffer_load_dwordx4 v[8:11], v1, s[8:11], s57 offen nt
    buffer_load_dwordx2 v[38:39], v2, s[16:19], s62 offen nt
L_bka_11:
    s_bitcmp0_b32 s82, 2
    s_cbranch_scc1 L_ska_12
    s_waitcnt vmcnt(14)
    v_mul_hi_u32_u24 v61, s40, v28
    v_mul_hi_u32_u24 v60, s40, v12
    v_mul_hi_u32_u24 v63, s40, v29
    v_mul_hi_u32_u24 v62, s40, v13
    v_mul_hi_u32_u24 v65, s40, v30
    v_mul_hi_u32_u24 v64, s40, v14
    v_mul_hi_u32_u24 v67, s40, v31
    v_mul_hi_u32_u24 v66, s40, v15
    v_and_b32 v61, -2, v61
    v_mad_u32_u24 v12, v60, s43, v12
    v_and_b32 v84, -4, v60
    v_and_b32 v63, -2, v63
    v_mad_u32_u24 v13, v62, s43, v13
    v_and_b32 v85, -4, v62
    v_and_b32 v65, -2, v65
    v_mad_u32_u24 v14, v64, s43, v14
    v_and_b32 v86, -4, v64
    v_and_b32 v67, -2, v67
    v_mad_u32_u24 v15, v66, s43, v15
    v_and_b32 v87, -4, v66
    v_mad_i32_i24 v28, v61, s42, v28
    v_lshl_add_u32 v61, v84, 5, v61
    v_mad_i32_i24 v29, v63, s42, v29
    v_lshl_add_u32 v63, v85, 5, v63
    v_mad_i32_i24 v30, v65, s42, v30
    v_lshl_add_u32 v65, v86, 5, v65
    v_mad_i32_i24 v31, v67, s42, v31
    v_lshl_add_u32 v67, v87, 5, v67
    v_add_u32 v61, v61, v61
    ds_add_rtn_u32 v84, v61, v104
    v_add_u32 v63, v63, v63
    ds_add_rtn_u32 v85, v63, v104
    v_add_u32 v65, v65, v65
    ds_add_rtn_u32 v86, v65, v104
    v_add_u32 v67, v67, v67
    ds_add_rtn_u32 v87, v67, v104
    v_lshlrev_b32 v110, 16, v40
    v_and_b32 v111, 0xffff0000, v40
    v_lshlrev_b32 v112, 16, v41
    v_and_b32 v113, 0xffff0000, v41
    v_mul_f32 v110, s44, v110
    v_mul_f32 v111, s44, v111
    v_mul_f32 v112, s44, v112
    v_mul_f32 v113, s44, v113
    v_fract_f32 v110, v110
    v_fract_f32 v111, v111
    v_fract_f32 v112, v112
    v_fract_f32 v113, v113
    v_cos_f32 v110, v110
    v_cos_f32 v111, v111
    v_cos_f32 v112, v112
    v_cos_f32 v113, v113
    v_lshl_or_b32 v60, v60, 14, v28
    v_perm_b32 v61, v61, v12, s46
    v_bfe_u32 v12, v12, 8, 5

    v_lshl_or_b32 v62, v62, 14, v29
    v_perm_b32 v63, v63, v13, s46
    v_bfe_u32 v13, v13, 8, 5

    v_lshl_or_b32 v64, v64, 14, v30
    v_perm_b32 v65, v65, v14, s46
    v_bfe_u32 v14, v14, 8, 5

    v_lshl_or_b32 v66, v66, 14, v31
    v_perm_b32 v67, v67, v15, s46
    v_bfe_u32 v15, v15, 8, 5

    v_fmaak_f32 v110, v110, v105, 0x4b400010
    v_fmaak_f32 v111, v111, v105, 0x4b400010
    v_fmaak_f32 v112, v112, v105, 0x4b400010
    v_fmaak_f32 v113, v113, v105, 0x4b400010
    v_sub_u32 v110, v110, v12
    v_sub_u32 v111, v111, v13
    v_sub_u32 v112, v112, v14
    v_sub_u32 v113, v113, v15
    v_bfi_b32 v110, 31, v12, v110
    v_bfi_b32 v111, 31, v13, v111
    v_bfi_b32 v112, 31, v14, v112
    v_bfi_b32 v113, 31, v15, v113
    v_perm_b32 v60, v60, v110, s55
    v_perm_b32 v62, v62, v111, s55
    v_perm_b32 v64, v64, v112, s55
    v_perm_b32 v66, v66, v113, s55
    buffer_load_dwordx4 v[28:31], v1, s[12:15], s58 offen nt
    buffer_load_dwordx4 v[12:15], v1, s[8:11], s58 offen nt
    buffer_load_dwordx2 v[40:41], v2, s[16:19], s63 offen nt
L_bka_13:
    s_bitcmp0_b32 s82, 3
    s_cbranch_scc1 L_ska_14
    s_waitcnt vmcnt(14)
    s_mov_b64 exec, s[66:67]
    v_mul_hi_u32_u24 v69, s40, v32
    v_mul_hi_u32_u24 v68, s40, v16
    v_mul_hi_u32_u24 v71, s40, v33
    v_mul_hi_u32_u24 v70, s40, v17
    v_mul_hi_u32_u24 v73, s40, v34
    v_mul_hi_u32_u24 v72, s40, v18
    v_mul_hi_u32_u24 v75, s40, v35
    v_mul_hi_u32_u24 v74, s40, v19
    v_and_b32 v69, -2, v69
    v_mad_u32_u24 v16, v68, s43, v16
    v_and_b32 v88, -4, v68
    v_and_b32 v71, -2, v71
    v_mad_u32_u24 v17, v70, s43, v17
    v_and_b32 v89, -4, v70
    v_and_b32 v73, -2, v73
    v_mad_u32_u24 v18, v72, s43, v18
    v_and_b32 v90, -4, v72
    v_and_b32 v75, -2, v75
    v_mad_u32_u24 v19, v74, s43, v19
    v_and_b32 v91, -4, v74
    v_mad_i32_i24 v32, v69, s42, v32
    v_lshl_add_u32 v69, v88, 5, v69
    v_mad_i32_i24 v33, v71, s42, v33
    v_lshl_add_u32 v71, v89, 5, v71
    v_mad_i32_i24 v34, v73, s42, v34
    v_lshl_add_u32 v73, v90, 5, v73
    v_mad_i32_i24 v35, v75, s42, v35
    v_lshl_add_u32 v75, v91, 5, v75
    v_add_u32 v69, v69, v69
    ds_add_rtn_u32 v88, v69, v104
    v_add_u32 v71, v71, v71
    ds_add_rtn_u32 v89, v71, v104
    v_add_u32 v73, v73, v73
    ds_add_rtn_u32 v90, v73, v104
    v_add_u32 v75, v75, v75
    ds_add_rtn_u32 v91, v75, v104
    v_lshlrev_b32 v110, 16, v42
    v_and_b32 v111, 0xffff0000, v42
    v_lshlrev_b32 v112, 16, v43
    v_and_b32 v113, 0xffff0000, v43
    v_mul_f32 v110, s44, v110
    v_mul_f32 v111, s44, v111
    v_mul_f32 v112, s44, v112
    v_mul_f32 v113, s44, v113
    v_fract_f32 v110, v110
    v_fract_f32 v111, v111
    v_fract_f32 v112, v112
    v_fract_f32 v113, v113
    v_cos_f32 v110, v110
    v_cos_f32 v111, v111
    v_cos_f32 v112, v112
    v_cos_f32 v113, v113
    v_lshl_or_b32 v68, v68, 14, v32
    v_perm_b32 v69, v69, v16, s46
    v_bfe_u32 v16, v16, 8, 5

    v_lshl_or_b32 v70, v70, 14, v33
    v_perm_b32 v71, v71, v17, s46
    v_bfe_u32 v17, v17, 8, 5

    v_lshl_or_b32 v72, v72, 14, v34
    v_perm_b32 v73, v73, v18, s46
    v_bfe_u32 v18, v18, 8, 5

    v_lshl_or_b32 v74, v74, 14, v35
    v_perm_b32 v75, v75, v19, s46
    v_bfe_u32 v19, v19, 8, 5

    v_fmaak_f32 v110, v110, v105, 0x4b400010
    v_fmaak_f32 v111, v111, v105, 0x4b400010
    v_fmaak_f32 v112, v112, v105, 0x4b400010
    v_fmaak_f32 v113, v113, v105, 0x4b400010
    v_sub_u32 v110, v110, v16
    v_sub_u32 v111, v111, v17
    v_sub_u32 v112, v112, v18
    v_sub_u32 v113, v113, v19
    v_bfi_b32 v110, 31, v16, v110
    v_bfi_b32 v111, 31, v17, v111
    v_bfi_b32 v112, 31, v18, v112
    v_bfi_b32 v113, 31, v19, v113
    v_perm_b32 v68, v68, v110, s55
    v_perm_b32 v70, v70, v111, s55
    v_perm_b32 v72, v72, v112, s55
    v_perm_b32 v74, v74, v113, s55
    s_mov_b64 exec, -1
    buffer_load_dwordx4 v[32:35], v1, s[12:15], s59 offen nt
    buffer_load_dwordx4 v[16:19], v1, s[8:11], s59 offen nt
    buffer_load_dwordx2 v[42:43], v2, s[16:19], s64 offen nt
L_bka_15:
    v_readfirstlane_b32 s74, v0
    s_nop 1
    s_cmp_lg_u32 s74, 0
    s_cbranch_scc1 L_ready_17

    s_waitcnt vmcnt(12)
    v_readfirstlane_b32 s74, v100
    s_nop 1
    s_cmp_lg_u32 s74, 0
    s_cbranch_scc1 L_ready_17

    v_mov_b32 v110, 1
    buffer_atomic_add v110, v98, s[96:99], 0 offen offset:64 sc0
    s_waitcnt vmcnt(0)
    v_readfirstlane_b32 s74, v110
    s_nop 1
    s_cmp_lg_u32 s74, 0
    s_cbranch_scc1 L_zno_19

    s_mov_b32 s92, s6
    s_mov_b32 s93, s7
    s_mov_b32 s94, 32784
    s_mov_b32 s95, 0x20000
    v_mov_b32 v110, 0
    v_mov_b32 v111, 0
    v_mov_b32 v112, 0
    v_mov_b32 v113, 0
L_zl_18:
    buffer_store_dwordx4 v[110:113], v1, s[92:95], s74 offen sc0 sc1
    s_add_u32 s74, s74, 1024
    s_cmp_le_u32 s74, 32768
    s_cbranch_scc1 L_zl_18
    v_mov_b32 v114, 1
    s_waitcnt vmcnt(0)
    buffer_atomic_add v114, v98, s[96:99], 0 offen offset:128
L_zno_19:

L_spin_16:
    v_mov_b32 v100, 0
    buffer_atomic_add v100, v98, s[96:99], 0 offen offset:128 sc0
    s_waitcnt vmcnt(0)
    v_readfirstlane_b32 s74, v100
    s_nop 1
    s_cmp_eq_u32 s74, 0
    s_cbranch_scc1 L_spin_16
L_ready_17:

    s_waitcnt lgkmcnt(0)
    s_barrier

    ds_read_b64 v[94:95], v2
    s_waitcnt lgkmcnt(0)
    v_and_b32 v94, 0xffff, v94
    v_and_b32 v95, 0xffff, v95
    v_add_u32 v97, v94, v95
    s_nop 1
    v_add_u32_dpp v97, v97, v97 row_shr:1 row_mask:0xf bank_mask:0xf
    s_nop 1
    v_add_u32_dpp v97, v97, v97 row_shr:2 row_mask:0xf bank_mask:0xf
    s_nop 1
    v_add_u32_dpp v97, v97, v97 row_shr:4 row_mask:0xf bank_mask:0xf
    s_nop 1
    v_add_u32_dpp v97, v97, v97 row_shr:8 row_mask:0xf bank_mask:0xf
    s_nop 1
    v_add_u32_dpp v97, v97, v97 row_bcast:15 row_mask:0xa bank_mask:0xf
    s_nop 1
    v_add_u32_dpp v97, v97, v97 row_bcast:31 row_mask:0xc bank_mask:0xf
    s_mov_b32 exec_lo, 0
    s_brev_b32 exec_hi, 1
    ds_add_rtn_u32 v96, v108, v97
    s_mov_b64 exec, -1

    v_add_u32 v92, v94, v94
    v_add_u32 v93, v95, v95
    v_med3_u32 v92, v94, 2, v92
    v_med3_u32 v93, v95, 2, v93
    v_lshl_or_b32 v92, v93, 16, v92
    v_lshlrev_b32 v93, 2, v0
    buffer_atomic_add v92, v93, s[20:23], 0 offen sc0
    s_waitcnt lgkmcnt(0)
    v_readlane_b32 s77, v96, 63
    v_mul_u32_u24 v114, 65528, v0
    v_sub_u32 v97, v97, v95
    s_sub_u32 s50, s50, s83
    s_sub_u32 s77, s77, s50
    v_add_u32 v97, s77, v97
    v_sub_u32 v96, v97, v94
    v_lshlrev_b32 v111, 16, v97
    v_lshlrev_b32 v110, 16, v96
    ds_write_b64 v2, v[110:111]
    v_mad_i32_i24 v96, v96, -5, v114
    v_mad_i32_i24 v97, v97, -5, v114
    v_add_u32 v97, 32764, v97
    s_add_u32 s50, s50, s84
    s_mov_b32 s28, s82
    s_mov_b32 s29, s83
    s_mov_b32 s30, s84
    s_lshl_b32 s74, s29, 3
    s_lshl_b32 s75, s30, 3
    v_mov_b32 v125, s74
    v_mov_b32 v126, s75
    v_mov_b32 v127, -1

    s_waitcnt lgkmcnt(0)
    s_barrier

    s_mov_b64 exec, 1
    ds_write_b32 v125, v127 offset:16396
    ds_write_b32 v126, v127 offset:16404
    s_mov_b64 exec, -1

    s_bitcmp0_b32 s28, 0
    s_cbranch_scc1 L_skz_20
    v_lshrrev_b32 v110, 16, v45
    ds_read_b32 v110, v110
    v_lshrrev_b32 v111, 16, v47
    ds_read_b32 v111, v111
    v_lshrrev_b32 v112, 16, v49
    ds_read_b32 v112, v112
    v_lshrrev_b32 v113, 16, v51
    ds_read_b32 v113, v113
    s_waitcnt lgkmcnt(3)
    v_add_u32_sdwa v110, v110, v76 dst_sel:DWORD dst_unused:UNUSED_PAD src0_sel:WORD_1 src1_sel:WORD_0
    v_lshlrev_b32 v110, 3, v110
    ds_write_b64 v110, v[44:45] offset:16400

    s_waitcnt lgkmcnt(3)
    v_add_u32_sdwa v111, v111, v77 dst_sel:DWORD dst_unused:UNUSED_PAD src0_sel:WORD_1 src1_sel:WORD_0
    v_lshlrev_b32 v111, 3, v111
    ds_write_b64 v111, v[46:47] offset:16400

    s_waitcnt lgkmcnt(3)
    v_add_u32_sdwa v112, v112, v78 dst_sel:DWORD dst_unused:UNUSED_PAD src0_sel:WORD_1 src1_sel:WORD_0
    v_lshlrev_b32 v112, 3, v112
    ds_write_b64 v112, v[48:49] offset:16400

    s_waitcnt lgkmcnt(3)
    v_add_u32_sdwa v113, v113, v79 dst_sel:DWORD dst_unused:UNUSED_PAD src0_sel:WORD_1 src1_sel:WORD_0
    v_lshlrev_b32 v113, 3, v113
    ds_write_b64 v113, v[50:51] offset:16400

L_skz_20:
    s_bitcmp0_b32 s28, 1
    s_cbranch_scc1 L_skz_21
    v_lshrrev_b32 v110, 16, v53
    ds_read_b32 v110, v110
    v_lshrrev_b32 v111, 16, v55
    ds_read_b32 v111, v111
    v_lshrrev_b32 v112, 16, v57
    ds_read_b32 v112, v112
    v_lshrrev_b32 v113, 16, v59
    ds_read_b32 v113, v113
    s_waitcnt lgkmcnt(3)
    v_add_u32_sdwa v110, v110, v80 dst_sel:DWORD dst_unused:UNUSED_PAD src0_sel:WORD_1 src1_sel:WORD_0
    v_lshlrev_b32 v110, 3, v110
    ds_write_b64 v110, v[52:53] offset:16400

    s_waitcnt lgkmcnt(3)
    v_add_u32_sdwa v111, v111, v81 dst_sel:DWORD dst_unused:UNUSED_PAD src0_sel:WORD_1 src1_sel:WORD_0
    v_lshlrev_b32 v111, 3, v111
    ds_write_b64 v111, v[54:55] offset:16400

    s_waitcnt lgkmcnt(3)
    v_add_u32_sdwa v112, v112, v82 dst_sel:DWORD dst_unused:UNUSED_PAD src0_sel:WORD_1 src1_sel:WORD_0
    v_lshlrev_b32 v112, 3, v112
    ds_write_b64 v112, v[56:57] offset:16400

    s_waitcnt lgkmcnt(3)
    v_add_u32_sdwa v113, v113, v83 dst_sel:DWORD dst_unused:UNUSED_PAD src0_sel:WORD_1 src1_sel:WORD_0
    v_lshlrev_b32 v113, 3, v113
    ds_write_b64 v113, v[58:59] offset:16400

L_skz_21:
    s_bitcmp0_b32 s28, 2
    s_cbranch_scc1 L_skz_22
    v_lshrrev_b32 v110, 16, v61
    ds_read_b32 v110, v110
    v_lshrrev_b32 v111, 16, v63
    ds_read_b32 v111, v111
    v_lshrrev_b32 v112, 16, v65
    ds_read_b32 v112, v112
    v_lshrrev_b32 v113, 16, v67
    ds_read_b32 v113, v113
    s_waitcnt lgkmcnt(3)
    v_add_u32_sdwa v110, v110, v84 dst_sel:DWORD dst_unused:UNUSED_PAD src0_sel:WORD_1 src1_sel:WORD_0
    v_lshlrev_b32 v110, 3, v110
    ds_write_b64 v110, v[60:61] offset:16400

    s_waitcnt lgkmcnt(3)
    v_add_u32_sdwa v111, v111, v85 dst_sel:DWORD dst_unused:UNUSED_PAD src0_sel:WORD_1 src1_sel:WORD_0
    v_lshlrev_b32 v111, 3, v111
    ds_write_b64 v111, v[62:63] offset:16400

    s_waitcnt lgkmcnt(3)
    v_add_u32_sdwa v112, v112, v86 dst_sel:DWORD dst_unused:UNUSED_PAD src0_sel:WORD_1 src1_sel:WORD_0
    v_lshlrev_b32 v112, 3, v112
    ds_write_b64 v112, v[64:65] offset:16400

    s_waitcnt lgkmcnt(3)
    v_add_u32_sdwa v113, v113, v87 dst_sel:DWORD dst_unused:UNUSED_PAD src0_sel:WORD_1 src1_sel:WORD_0
    v_lshlrev_b32 v113, 3, v113
    ds_write_b64 v113, v[66:67] offset:16400

L_skz_22:
    s_bitcmp0_b32 s28, 3
    s_cbranch_scc1 L_skz_23
    s_mov_b64 exec, s[66:67]
    v_lshrrev_b32 v110, 16, v69
    ds_read_b32 v110, v110
    v_lshrrev_b32 v111, 16, v71
    ds_read_b32 v111, v111
    v_lshrrev_b32 v112, 16, v73
    ds_read_b32 v112, v112
    v_lshrrev_b32 v113, 16, v75
    ds_read_b32 v113, v113
    s_waitcnt lgkmcnt(3)
    v_add_u32_sdwa v110, v110, v88 dst_sel:DWORD dst_unused:UNUSED_PAD src0_sel:WORD_1 src1_sel:WORD_0
    v_lshlrev_b32 v110, 3, v110
    ds_write_b64 v110, v[68:69] offset:16400

    s_waitcnt lgkmcnt(3)
    v_add_u32_sdwa v111, v111, v89 dst_sel:DWORD dst_unused:UNUSED_PAD src0_sel:WORD_1 src1_sel:WORD_0
    v_lshlrev_b32 v111, 3, v111
    ds_write_b64 v111, v[70:71] offset:16400

    s_waitcnt lgkmcnt(3)
    v_add_u32_sdwa v112, v112, v90 dst_sel:DWORD dst_unused:UNUSED_PAD src0_sel:WORD_1 src1_sel:WORD_0
    v_lshlrev_b32 v112, 3, v112
    ds_write_b64 v112, v[72:73] offset:16400

    s_waitcnt lgkmcnt(3)
    v_add_u32_sdwa v113, v113, v91 dst_sel:DWORD dst_unused:UNUSED_PAD src0_sel:WORD_1 src1_sel:WORD_0
    v_lshlrev_b32 v113, 3, v113
    ds_write_b64 v113, v[74:75] offset:16400

    s_mov_b64 exec, -1
L_skz_23:
    s_cmp_eq_u32 s49, 0
    s_cbranch_scc1 L_p1epi_7
L_p1loop_6:
    s_mov_b32 s82, s85
    s_mov_b32 s83, s86
    s_mov_b32 s84, s87
    v_mov_b32 v99, 1
    buffer_atomic_add v99, v98, s[96:99], 0 offen sc0
    s_bitcmp0_b32 s82, 0
    s_cbranch_scc1 L_ska_24
    s_waitcnt vmcnt(11)
    v_mul_hi_u32_u24 v45, s40, v20
    v_mul_hi_u32_u24 v44, s40, v4
    v_mul_hi_u32_u24 v47, s40, v21
    v_mul_hi_u32_u24 v46, s40, v5
    v_mul_hi_u32_u24 v49, s40, v22
    v_mul_hi_u32_u24 v48, s40, v6
    v_mul_hi_u32_u24 v51, s40, v23
    v_mul_hi_u32_u24 v50, s40, v7
    v_and_b32 v45, -2, v45
    v_mad_u32_u24 v4, v44, s43, v4
    v_and_b32 v76, -4, v44
    v_and_b32 v47, -2, v47
    v_mad_u32_u24 v5, v46, s43, v5
    v_and_b32 v77, -4, v46
    v_and_b32 v49, -2, v49
    v_mad_u32_u24 v6, v48, s43, v6
    v_and_b32 v78, -4, v48
    v_and_b32 v51, -2, v51
    v_mad_u32_u24 v7, v50, s43, v7
    v_and_b32 v79, -4, v50
    v_mad_i32_i24 v20, v45, s42, v20
    v_lshl_add_u32 v45, v76, 5, v45
    v_mad_i32_i24 v21, v47, s42, v21
    v_lshl_add_u32 v47, v77, 5, v47
    v_mad_i32_i24 v22, v49, s42, v22
    v_lshl_add_u32 v49, v78, 5, v49
    v_mad_i32_i24 v23, v51, s42, v23
    v_lshl_add_u32 v51, v79, 5, v51
    v_add_u32 v45, v45, v45
    ds_add_rtn_u32 v76, v45, v104
    v_add_u32 v47, v47, v47
    ds_add_rtn_u32 v77, v47, v104
    v_add_u32 v49, v49, v49
    ds_add_rtn_u32 v78, v49, v104
    v_add_u32 v51, v51, v51
    ds_add_rtn_u32 v79, v51, v104
    v_lshlrev_b32 v110, 16, v36
    v_and_b32 v111, 0xffff0000, v36
    v_lshlrev_b32 v112, 16, v37
    v_and_b32 v113, 0xffff0000, v37
    v_mul_f32 v110, s44, v110
    v_mul_f32 v111, s44, v111
    v_mul_f32 v112, s44, v112
    v_mul_f32 v113, s44, v113
    v_fract_f32 v110, v110
    v_fract_f32 v111, v111
    v_fract_f32 v112, v112
    v_fract_f32 v113, v113
    v_cos_f32 v110, v110
    v_cos_f32 v111, v111
    v_cos_f32 v112, v112
    v_cos_f32 v113, v113
    v_lshl_or_b32 v44, v44, 14, v20
    v_perm_b32 v45, v45, v4, s46
    v_bfe_u32 v4, v4, 8, 5

    v_lshl_or_b32 v46, v46, 14, v21
    v_perm_b32 v47, v47, v5, s46
    v_bfe_u32 v5, v5, 8, 5

    v_lshl_or_b32 v48, v48, 14, v22
    v_perm_b32 v49, v49, v6, s46
    v_bfe_u32 v6, v6, 8, 5

    v_lshl_or_b32 v50, v50, 14, v23
    v_perm_b32 v51, v51, v7, s46
    v_bfe_u32 v7, v7, 8, 5

    v_fmaak_f32 v110, v110, v105, 0x4b400010
    v_fmaak_f32 v111, v111, v105, 0x4b400010
    v_fmaak_f32 v112, v112, v105, 0x4b400010
    v_fmaak_f32 v113, v113, v105, 0x4b400010
    v_sub_u32 v110, v110, v4
    v_sub_u32 v111, v111, v5
    v_sub_u32 v112, v112, v6
    v_sub_u32 v113, v113, v7
    v_bfi_b32 v110, 31, v4, v110
    v_bfi_b32 v111, 31, v5, v111
    v_bfi_b32 v112, 31, v6, v112
    v_bfi_b32 v113, 31, v7, v113
    v_perm_b32 v44, v44, v110, s55
    v_perm_b32 v46, v46, v111, s55
    v_perm_b32 v48, v48, v112, s55
    v_perm_b32 v50, v50, v113, s55
L_ska_24:
    s_bitcmp0_b32 s82, 1
    s_cbranch_scc1 L_ska_25
    s_waitcnt vmcnt(8)
    v_mul_hi_u32_u24 v53, s40, v24
    v_mul_hi_u32_u24 v52, s40, v8
    v_mul_hi_u32_u24 v55, s40, v25
    v_mul_hi_u32_u24 v54, s40, v9
    v_mul_hi_u32_u24 v57, s40, v26
    v_mul_hi_u32_u24 v56, s40, v10
    v_mul_hi_u32_u24 v59, s40, v27
    v_mul_hi_u32_u24 v58, s40, v11
    v_and_b32 v53, -2, v53
    v_mad_u32_u24 v8, v52, s43, v8
    v_and_b32 v80, -4, v52
    v_and_b32 v55, -2, v55
    v_mad_u32_u24 v9, v54, s43, v9
    v_and_b32 v81, -4, v54
    v_and_b32 v57, -2, v57
    v_mad_u32_u24 v10, v56, s43, v10
    v_and_b32 v82, -4, v56
    v_and_b32 v59, -2, v59
    v_mad_u32_u24 v11, v58, s43, v11
    v_and_b32 v83, -4, v58
    v_mad_i32_i24 v24, v53, s42, v24
    v_lshl_add_u32 v53, v80, 5, v53
    v_mad_i32_i24 v25, v55, s42, v25
    v_lshl_add_u32 v55, v81, 5, v55
    v_mad_i32_i24 v26, v57, s42, v26
    v_lshl_add_u32 v57, v82, 5, v57
    v_mad_i32_i24 v27, v59, s42, v27
    v_lshl_add_u32 v59, v83, 5, v59
    v_add_u32 v53, v53, v53
    ds_add_rtn_u32 v80, v53, v104
    v_add_u32 v55, v55, v55
    ds_add_rtn_u32 v81, v55, v104
    v_add_u32 v57, v57, v57
    ds_add_rtn_u32 v82, v57, v104
    v_add_u32 v59, v59, v59
    ds_add_rtn_u32 v83, v59, v104
    v_lshlrev_b32 v110, 16, v38
    v_and_b32 v111, 0xffff0000, v38
    v_lshlrev_b32 v112, 16, v39
    v_and_b32 v113, 0xffff0000, v39
    v_mul_f32 v110, s44, v110
    v_mul_f32 v111, s44, v111
    v_mul_f32 v112, s44, v112
    v_mul_f32 v113, s44, v113
    v_fract_f32 v110, v110
    v_fract_f32 v111, v111
    v_fract_f32 v112, v112
    v_fract_f32 v113, v113
    v_cos_f32 v110, v110
    v_cos_f32 v111, v111
    v_cos_f32 v112, v112
    v_cos_f32 v113, v113
    v_lshl_or_b32 v52, v52, 14, v24
    v_perm_b32 v53, v53, v8, s46
    v_bfe_u32 v8, v8, 8, 5

    v_lshl_or_b32 v54, v54, 14, v25
    v_perm_b32 v55, v55, v9, s46
    v_bfe_u32 v9, v9, 8, 5

    v_lshl_or_b32 v56, v56, 14, v26
    v_perm_b32 v57, v57, v10, s46
    v_bfe_u32 v10, v10, 8, 5

    v_lshl_or_b32 v58, v58, 14, v27
    v_perm_b32 v59, v59, v11, s46
    v_bfe_u32 v11, v11, 8, 5

    v_fmaak_f32 v110, v110, v105, 0x4b400010
    v_fmaak_f32 v111, v111, v105, 0x4b400010
    v_fmaak_f32 v112, v112, v105, 0x4b400010
    v_fmaak_f32 v113, v113, v105, 0x4b400010
    v_sub_u32 v110, v110, v8
    v_sub_u32 v111, v111, v9
    v_sub_u32 v112, v112, v10
    v_sub_u32 v113, v113, v11
    v_bfi_b32 v110, 31, v8, v110
    v_bfi_b32 v111, 31, v9, v111
    v_bfi_b32 v112, 31, v10, v112
    v_bfi_b32 v113, 31, v11, v113
    v_perm_b32 v52, v52, v110, s55
    v_perm_b32 v54, v54, v111, s55
    v_perm_b32 v56, v56, v112, s55
    v_perm_b32 v58, v58, v113, s55
L_ska_25:
    s_waitcnt vmcnt(1)
    s_waitcnt vmcnt(0)
    v_cmp_eq_u32 vcc, 0, v0
    s_mov_b64 exec, vcc
    ds_write_b32 v108, v99 offset:8
    s_mov_b64 exec, -1
    s_waitcnt vmcnt(1)
    v_lshrrev_b32 v93, 16, v92
    v_and_b32 v92, 0xffff, v92
    v_add_u32 v110, v92, v94
    v_mad_u32_u24 v92, v92, 5, v96
    v_add_u32 v111, v93, v95
    v_mad_u32_u24 v93, v93, 5, v97
    v_max_u32 v110, v110, v111
    v_cmp_le_u32 vcc, s48, v110
    s_cbranch_vccnz L_full_26
L_fback_27:
    ds_write_b64 v2, v[92:93] offset:8192

    s_waitcnt lgkmcnt(0)
    s_barrier
    ds_read_b32 v111, v108 offset:8
    s_waitcnt lgkmcnt(0)
    v_readfirstlane_b32 s41, v111
    s_nop 1

    s_add_u32 s41, s41, 416
    s_sub_u32 s78, s41, 3061
    s_lshr_b32 s79, s78, 1
    s_add_u32 s79, s79, 3061
    s_and_b32 s86, s78, 1
    s_lshl_b32 s86, s86, 1
    s_add_u32 s87, s86, 2
    s_cmp_lt_u32 s41, 3061
    s_cselect_b32 s41, s41, s79
    s_cmovk_i32 s86, 0
    s_cmovk_i32 s87, 4

    s_mul_i32 s78, s41, 16384
    s_add_u32 s49, s78, 16384
    s_cmp_ge_u32 s41, 3125
    s_cmovk_i32 s49, 0
    s_cmovk_i32 s78, 0
    s_lshl_b32 s10, s49, 2
    s_lshl_b32 s14, s49, 2
    s_lshl_b32 s18, s49, 1
    s_sub_u32 s79, s87, s86
    s_bfm_b32 s85, s79, s86
    s_lshl_b32 s86, s86, 12
    s_lshl_b32 s87, s87, 12
    s_min_u32 s87, s87, 16384

    s_add_u32 s79, s78, 0
    s_bitcmp1_b32 s85, 0
    s_cselect_b32 s79, s79, 0x1ff00000
    s_lshl_b32 s56, s79, 2
    s_lshl_b32 s61, s79, 1

    s_add_u32 s79, s78, 4096
    s_bitcmp1_b32 s85, 1
    s_cselect_b32 s79, s79, 0x1ff00000
    s_lshl_b32 s57, s79, 2
    s_lshl_b32 s62, s79, 1

    s_add_u32 s79, s78, 8192
    s_bitcmp1_b32 s85, 2
    s_cselect_b32 s79, s79, 0x1ff00000
    s_lshl_b32 s58, s79, 2
    s_lshl_b32 s63, s79, 1

    s_add_u32 s79, s78, 12288
    s_bitcmp1_b32 s85, 3
    s_cselect_b32 s79, s79, 0x1ff00000
    s_lshl_b32 s59, s79, 2
    s_lshl_b32 s64, s79, 1

    s_bitcmp0_b32 s28, 0
    s_cbranch_scc1 L_skw_28
    ds_read_b64 v[110:111], v2 offset:16400
    ds_read_b64 v[112:113], v2 offset:16408
    ds_read_b64 v[114:115], v2 offset:16392

    ds_read_b64 v[118:119], v2 offset:24592
    ds_read_b64 v[120:121], v2 offset:24600
    ds_read_b64 v[122:123], v2 offset:24584

    s_waitcnt lgkmcnt(3)
    v_lshrrev_b32 v116, 16, v111
    ds_read_b32 v116, v116 offset:8192

    s_waitcnt lgkmcnt(1)
    v_lshrrev_b32 v124, 16, v119
    ds_read_b32 v124, v124 offset:8192

    v_cmp_ne_u32_sdwa s[80:81], v111, v113 src0_sel:WORD_1 src1_sel:WORD_1
    v_cmp_ne_u32_sdwa vcc, v111, v115 src0_sel:WORD_1 src1_sel:WORD_1
    v_alignbyte_b32 v114, v115, v114, 2
    s_mov_b32 s54, -3
    v_alignbyte_b32 v111, v111, v110, 1
    v_perm_b32 v110, v110, v114, s47
    s_waitcnt lgkmcnt(1)
    v_add3_u32 v116, v116, v106, s54
    v_sub_u32 v117, 0, v116
    v_and_b32 v117, 3, v117
    s_mov_b64 exec, s[80:81]
    v_mov_b32 v117, 0
    v_mov_b32 v112, 0
    s_mov_b64 exec, vcc
    v_mov_b32 v117, 3

    s_mov_b64 exec, -1
    v_alignbyte_b32 v110, v111, v110, v117
    v_alignbyte_b32 v111, v112, v111, v117
    v_add_u32 v116, v116, v117

    buffer_store_dwordx2 v[110:111], v116, s[24:27], 0 offen
    v_cmp_ne_u32_sdwa s[80:81], v119, v121 src0_sel:WORD_1 src1_sel:WORD_1
    v_cmp_ne_u32_sdwa vcc, v119, v123 src0_sel:WORD_1 src1_sel:WORD_1
    v_alignbyte_b32 v122, v123, v122, 2
    s_mov_b32 s54, 5117
    v_alignbyte_b32 v119, v119, v118, 1
    v_perm_b32 v118, v118, v122, s47
    s_waitcnt lgkmcnt(0)
    v_add3_u32 v124, v124, v106, s54
    v_sub_u32 v125, 0, v124
    v_and_b32 v125, 3, v125
    s_mov_b64 exec, s[80:81]
    v_mov_b32 v125, 0
    v_mov_b32 v120, 0
    s_mov_b64 exec, vcc
    v_mov_b32 v125, 3

    s_mov_b64 exec, -1
    v_alignbyte_b32 v118, v119, v118, v125
    v_alignbyte_b32 v119, v120, v119, v125
    v_add_u32 v124, v124, v125

    buffer_store_dwordx2 v[118:119], v124, s[24:27], 0 offen
L_skw_28:
    s_bitcmp0_b32 s28, 0
    s_cbranch_scc1 L_skw_29
    ds_read_b64 v[110:111], v2 offset:32784
    ds_read_b64 v[112:113], v2 offset:32792
    ds_read_b64 v[114:115], v2 offset:32776

    ds_read_b64 v[118:119], v2 offset:40976
    ds_read_b64 v[120:121], v2 offset:40984
    ds_read_b64 v[122:123], v2 offset:40968

    s_waitcnt lgkmcnt(3)
    v_lshrrev_b32 v116, 16, v111
    ds_read_b32 v116, v116 offset:8192

    s_waitcnt lgkmcnt(1)
    v_lshrrev_b32 v124, 16, v119
    ds_read_b32 v124, v124 offset:8192

    v_cmp_ne_u32_sdwa s[80:81], v111, v113 src0_sel:WORD_1 src1_sel:WORD_1
    v_cmp_ne_u32_sdwa vcc, v111, v115 src0_sel:WORD_1 src1_sel:WORD_1
    v_alignbyte_b32 v114, v115, v114, 2
    s_mov_b32 s54, 10237
    v_alignbyte_b32 v111, v111, v110, 1
    v_perm_b32 v110, v110, v114, s47
    s_waitcnt lgkmcnt(1)
    v_add3_u32 v116, v116, v106, s54
    v_sub_u32 v117, 0, v116
    v_and_b32 v117, 3, v117
    s_mov_b64 exec, s[80:81]
    v_mov_b32 v117, 0
    v_mov_b32 v112, 0
    s_mov_b64 exec, vcc
    v_mov_b32 v117, 3

    s_mov_b64 exec, -1
    v_alignbyte_b32 v110, v111, v110, v117
    v_alignbyte_b32 v111, v112, v111, v117
    v_add_u32 v116, v116, v117

    buffer_store_dwordx2 v[110:111], v116, s[24:27], 0 offen
    v_cmp_ne_u32_sdwa s[80:81], v119, v121 src0_sel:WORD_1 src1_sel:WORD_1
    v_cmp_ne_u32_sdwa vcc, v119, v123 src0_sel:WORD_1 src1_sel:WORD_1
    v_alignbyte_b32 v122, v123, v122, 2
    s_mov_b32 s54, 15357
    v_alignbyte_b32 v119, v119, v118, 1
    v_perm_b32 v118, v118, v122, s47
    s_waitcnt lgkmcnt(0)
    v_add3_u32 v124, v124, v106, s54
    v_sub_u32 v125, 0, v124
    v_and_b32 v125, 3, v125
    s_mov_b64 exec, s[80:81]
    v_mov_b32 v125, 0
    v_mov_b32 v120, 0
    s_mov_b64 exec, vcc
    v_mov_b32 v125, 3

    s_mov_b64 exec, -1
    v_alignbyte_b32 v118, v119, v118, v125
    v_alignbyte_b32 v119, v120, v119, v125
    v_add_u32 v124, v124, v125

    buffer_store_dwordx2 v[118:119], v124, s[24:27], 0 offen
L_skw_29:
    s_bitcmp0_b32 s82, 2
    s_cbranch_scc1 L_ska_30
    v_mul_hi_u32_u24 v61, s40, v28
    v_mul_hi_u32_u24 v60, s40, v12
    v_mul_hi_u32_u24 v63, s40, v29
    v_mul_hi_u32_u24 v62, s40, v13
    v_mul_hi_u32_u24 v65, s40, v30
    v_mul_hi_u32_u24 v64, s40, v14
    v_mul_hi_u32_u24 v67, s40, v31
    v_mul_hi_u32_u24 v66, s40, v15
    v_and_b32 v61, -2, v61
    v_mad_u32_u24 v12, v60, s43, v12
    v_and_b32 v84, -4, v60
    v_and_b32 v63, -2, v63
    v_mad_u32_u24 v13, v62, s43, v13
    v_and_b32 v85, -4, v62
    v_and_b32 v65, -2, v65
    v_mad_u32_u24 v14, v64, s43, v14
    v_and_b32 v86, -4, v64
    v_and_b32 v67, -2, v67
    v_mad_u32_u24 v15, v66, s43, v15
    v_and_b32 v87, -4, v66
    v_mad_i32_i24 v28, v61, s42, v28
    v_lshl_add_u32 v61, v84, 5, v61
    v_mad_i32_i24 v29, v63, s42, v29
    v_lshl_add_u32 v63, v85, 5, v63
    v_mad_i32_i24 v30, v65, s42, v30
    v_lshl_add_u32 v65, v86, 5, v65
    v_mad_i32_i24 v31, v67, s42, v31
    v_lshl_add_u32 v67, v87, 5, v67
    v_add_u32 v61, v61, v61
    ds_add_rtn_u32 v84, v61, v104
    v_add_u32 v63, v63, v63
    ds_add_rtn_u32 v85, v63, v104
    v_add_u32 v65, v65, v65
    ds_add_rtn_u32 v86, v65, v104
    v_add_u32 v67, v67, v67
    ds_add_rtn_u32 v87, v67, v104
    v_lshlrev_b32 v110, 16, v40
    v_and_b32 v111, 0xffff0000, v40
    v_lshlrev_b32 v112, 16, v41
    v_and_b32 v113, 0xffff0000, v41
    v_mul_f32 v110, s44, v110
    v_mul_f32 v111, s44, v111
    v_mul_f32 v112, s44, v112
    v_mul_f32 v113, s44, v113
    v_fract_f32 v110, v110
    v_fract_f32 v111, v111
    v_fract_f32 v112, v112
    v_fract_f32 v113, v113
    v_cos_f32 v110, v110
    v_cos_f32 v111, v111
    v_cos_f32 v112, v112
    v_cos_f32 v113, v113
    v_lshl_or_b32 v60, v60, 14, v28
    v_perm_b32 v61, v61, v12, s46
    v_bfe_u32 v12, v12, 8, 5

    v_lshl_or_b32 v62, v62, 14, v29
    v_perm_b32 v63, v63, v13, s46
    v_bfe_u32 v13, v13, 8, 5

    v_lshl_or_b32 v64, v64, 14, v30
    v_perm_b32 v65, v65, v14, s46
    v_bfe_u32 v14, v14, 8, 5

    v_lshl_or_b32 v66, v66, 14, v31
    v_perm_b32 v67, v67, v15, s46
    v_bfe_u32 v15, v15, 8, 5

    v_fmaak_f32 v110, v110, v105, 0x4b400010
    v_fmaak_f32 v111, v111, v105, 0x4b400010
    v_fmaak_f32 v112, v112, v105, 0x4b400010
    v_fmaak_f32 v113, v113, v105, 0x4b400010
    v_sub_u32 v110, v110, v12
    v_sub_u32 v111, v111, v13
    v_sub_u32 v112, v112, v14
    v_sub_u32 v113, v113, v15
    v_bfi_b32 v110, 31, v12, v110
    v_bfi_b32 v111, 31, v13, v111
    v_bfi_b32 v112, 31, v14, v112
    v_bfi_b32 v113, 31, v15, v113
    v_perm_b32 v60, v60, v110, s55
    v_perm_b32 v62, v62, v111, s55
    v_perm_b32 v64, v64, v112, s55
    v_perm_b32 v66, v66, v113, s55
L_ska_30:
    s_bitcmp0_b32 s28, 1
    s_cbranch_scc1 L_skw_31
    v_add_u32 v107, 32768, v2
    ds_read_b64 v[110:111], v107 offset:16400
    ds_read_b64 v[112:113], v107 offset:16408
    ds_read_b64 v[114:115], v107 offset:16392

    ds_read_b64 v[118:119], v107 offset:24592
    ds_read_b64 v[120:121], v107 offset:24600
    ds_read_b64 v[122:123], v107 offset:24584

    s_waitcnt lgkmcnt(3)
    v_lshrrev_b32 v116, 16, v111
    ds_read_b32 v116, v116 offset:8192

    s_waitcnt lgkmcnt(1)
    v_lshrrev_b32 v124, 16, v119
    ds_read_b32 v124, v124 offset:8192

    v_cmp_ne_u32_sdwa s[80:81], v111, v113 src0_sel:WORD_1 src1_sel:WORD_1
    v_cmp_ne_u32_sdwa vcc, v111, v115 src0_sel:WORD_1 src1_sel:WORD_1
    v_alignbyte_b32 v114, v115, v114, 2
    s_mov_b32 s54, 20477
    v_alignbyte_b32 v111, v111, v110, 1
    v_perm_b32 v110, v110, v114, s47
    s_waitcnt lgkmcnt(1)
    v_add3_u32 v116, v116, v106, s54
    v_sub_u32 v117, 0, v116
    v_and_b32 v117, 3, v117
    s_mov_b64 exec, s[80:81]
    v_mov_b32 v117, 0
    v_mov_b32 v112, 0
    s_mov_b64 exec, vcc
    v_mov_b32 v117, 3

    s_mov_b64 exec, -1
    v_alignbyte_b32 v110, v111, v110, v117
    v_alignbyte_b32 v111, v112, v111, v117
    v_add_u32 v116, v116, v117

    buffer_store_dwordx2 v[110:111], v116, s[24:27], 0 offen
    v_cmp_ne_u32_sdwa s[80:81], v119, v121 src0_sel:WORD_1 src1_sel:WORD_1
    v_cmp_ne_u32_sdwa vcc, v119, v123 src0_sel:WORD_1 src1_sel:WORD_1
    v_alignbyte_b32 v122, v123, v122, 2
    s_mov_b32 s54, 25597
    v_alignbyte_b32 v119, v119, v118, 1
    v_perm_b32 v118, v118, v122, s47
    s_waitcnt lgkmcnt(0)
    v_add3_u32 v124, v124, v106, s54
    v_sub_u32 v125, 0, v124
    v_and_b32 v125, 3, v125
    s_mov_b64 exec, s[80:81]
    v_mov_b32 v125, 0
    v_mov_b32 v120, 0
    s_mov_b64 exec, vcc
    v_mov_b32 v125, 3

    s_mov_b64 exec, -1
    v_alignbyte_b32 v118, v119, v118, v125
    v_alignbyte_b32 v119, v120, v119, v125
    v_add_u32 v124, v124, v125

    buffer_store_dwordx2 v[118:119], v124, s[24:27], 0 offen
L_skw_31:
    s_bitcmp0_b32 s28, 1
    s_cbranch_scc1 L_skw_32
    v_add_u32 v107, 32768, v2
    ds_read_b64 v[110:111], v107 offset:32784
    ds_read_b64 v[112:113], v107 offset:32792
    ds_read_b64 v[114:115], v107 offset:32776

    ds_read_b64 v[118:119], v107 offset:40976
    ds_read_b64 v[120:121], v107 offset:40984
    ds_read_b64 v[122:123], v107 offset:40968

    s_waitcnt lgkmcnt(3)
    v_lshrrev_b32 v116, 16, v111
    ds_read_b32 v116, v116 offset:8192

    s_waitcnt lgkmcnt(1)
    v_lshrrev_b32 v124, 16, v119
    ds_read_b32 v124, v124 offset:8192

    v_cmp_ne_u32_sdwa s[80:81], v111, v113 src0_sel:WORD_1 src1_sel:WORD_1
    v_cmp_ne_u32_sdwa vcc, v111, v115 src0_sel:WORD_1 src1_sel:WORD_1
    v_alignbyte_b32 v114, v115, v114, 2
    s_mov_b32 s54, 30717
    v_alignbyte_b32 v111, v111, v110, 1
    v_perm_b32 v110, v110, v114, s47
    s_waitcnt lgkmcnt(1)
    v_add3_u32 v116, v116, v106, s54
    v_sub_u32 v117, 0, v116
    v_and_b32 v117, 3, v117
    s_mov_b64 exec, s[80:81]
    v_mov_b32 v117, 0
    v_mov_b32 v112, 0
    s_mov_b64 exec, vcc
    v_mov_b32 v117, 3

    s_mov_b64 exec, -1
    v_alignbyte_b32 v110, v111, v110, v117
    v_alignbyte_b32 v111, v112, v111, v117
    v_add_u32 v116, v116, v117

    buffer_store_dwordx2 v[110:111], v116, s[24:27], 0 offen
    v_cmp_ne_u32_sdwa s[80:81], v119, v121 src0_sel:WORD_1 src1_sel:WORD_1
    v_cmp_ne_u32_sdwa vcc, v119, v123 src0_sel:WORD_1 src1_sel:WORD_1
    v_alignbyte_b32 v122, v123, v122, 2
    s_mov_b32 s54, 35837
    v_alignbyte_b32 v119, v119, v118, 1
    v_perm_b32 v118, v118, v122, s47
    s_waitcnt lgkmcnt(0)
    v_add3_u32 v124, v124, v106, s54
    v_sub_u32 v125, 0, v124
    v_and_b32 v125, 3, v125
    s_mov_b64 exec, s[80:81]
    v_mov_b32 v125, 0
    v_mov_b32 v120, 0
    s_mov_b64 exec, vcc
    v_mov_b32 v125, 3

    s_mov_b64 exec, -1
    v_alignbyte_b32 v118, v119, v118, v125
    v_alignbyte_b32 v119, v120, v119, v125
    v_add_u32 v124, v124, v125

    buffer_store_dwordx2 v[118:119], v124, s[24:27], 0 offen
L_skw_32:
    s_bitcmp0_b32 s28, 2
    s_cbranch_scc1 L_skw_33
    v_add_u32 v107, 65536, v2
    ds_read_b64 v[110:111], v107 offset:16400
    ds_read_b64 v[112:113], v107 offset:16408
    ds_read_b64 v[114:115], v107 offset:16392

    ds_read_b64 v[118:119], v107 offset:24592
    ds_read_b64 v[120:121], v107 offset:24600
    ds_read_b64 v[122:123], v107 offset:24584

    s_waitcnt lgkmcnt(3)
    v_lshrrev_b32 v116, 16, v111
    ds_read_b32 v116, v116 offset:8192

    s_waitcnt lgkmcnt(1)
    v_lshrrev_b32 v124, 16, v119
    ds_read_b32 v124, v124 offset:8192

    v_cmp_ne_u32_sdwa s[80:81], v111, v113 src0_sel:WORD_1 src1_sel:WORD_1
    v_cmp_ne_u32_sdwa vcc, v111, v115 src0_sel:WORD_1 src1_sel:WORD_1
    v_alignbyte_b32 v114, v115, v114, 2
    s_mov_b32 s54, 40957
    v_alignbyte_b32 v111, v111, v110, 1
    v_perm_b32 v110, v110, v114, s47
    s_waitcnt lgkmcnt(1)
    v_add3_u32 v116, v116, v106, s54
    v_sub_u32 v117, 0, v116
    v_and_b32 v117, 3, v117
    s_mov_b64 exec, s[80:81]
    v_mov_b32 v117, 0
    v_mov_b32 v112, 0
    s_mov_b64 exec, vcc
    v_mov_b32 v117, 3

    s_mov_b64 exec, -1
    v_alignbyte_b32 v110, v111, v110, v117
    v_alignbyte_b32 v111, v112, v111, v117
    v_add_u32 v116, v116, v117

    buffer_store_dwordx2 v[110:111], v116, s[24:27], 0 offen
    v_cmp_ne_u32_sdwa s[80:81], v119, v121 src0_sel:WORD_1 src1_sel:WORD_1
    v_cmp_ne_u32_sdwa vcc, v119, v123 src0_sel:WORD_1 src1_sel:WORD_1
    v_alignbyte_b32 v122, v123, v122, 2
    s_mov_b32 s54, 46077
    v_alignbyte_b32 v119, v119, v118, 1
    v_perm_b32 v118, v118, v122, s47
    s_waitcnt lgkmcnt(0)
    v_add3_u32 v124, v124, v106, s54
    v_sub_u32 v125, 0, v124
    v_and_b32 v125, 3, v125
    s_mov_b64 exec, s[80:81]
    v_mov_b32 v125, 0
    v_mov_b32 v120, 0
    s_mov_b64 exec, vcc
    v_mov_b32 v125, 3

    s_mov_b64 exec, -1
    v_alignbyte_b32 v118, v119, v118, v125
    v_alignbyte_b32 v119, v120, v119, v125
    v_add_u32 v124, v124, v125

    buffer_store_dwordx2 v[118:119], v124, s[24:27], 0 offen
L_skw_33:
    s_bitcmp0_b32 s82, 3
    s_cbranch_scc1 L_ska_34
    s_mov_b64 exec, s[66:67]
    v_mul_hi_u32_u24 v69, s40, v32
    v_mul_hi_u32_u24 v68, s40, v16
    v_mul_hi_u32_u24 v71, s40, v33
    v_mul_hi_u32_u24 v70, s40, v17
    v_mul_hi_u32_u24 v73, s40, v34
    v_mul_hi_u32_u24 v72, s40, v18
    v_mul_hi_u32_u24 v75, s40, v35
    v_mul_hi_u32_u24 v74, s40, v19
    v_and_b32 v69, -2, v69
    v_mad_u32_u24 v16, v68, s43, v16
    v_and_b32 v88, -4, v68
    v_and_b32 v71, -2, v71
    v_mad_u32_u24 v17, v70, s43, v17
    v_and_b32 v89, -4, v70
    v_and_b32 v73, -2, v73
    v_mad_u32_u24 v18, v72, s43, v18
    v_and_b32 v90, -4, v72
    v_and_b32 v75, -2, v75
    v_mad_u32_u24 v19, v74, s43, v19
    v_and_b32 v91, -4, v74
    v_mad_i32_i24 v32, v69, s42, v32
    v_lshl_add_u32 v69, v88, 5, v69
    v_mad_i32_i24 v33, v71, s42, v33
    v_lshl_add_u32 v71, v89, 5, v71
    v_mad_i32_i24 v34, v73, s42, v34
    v_lshl_add_u32 v73, v90, 5, v73
    v_mad_i32_i24 v35, v75, s42, v35
    v_lshl_add_u32 v75, v91, 5, v75
    v_add_u32 v69, v69, v69
    ds_add_rtn_u32 v88, v69, v104
    v_add_u32 v71, v71, v71
    ds_add_rtn_u32 v89, v71, v104
    v_add_u32 v73, v73, v73
    ds_add_rtn_u32 v90, v73, v104
    v_add_u32 v75, v75, v75
    ds_add_rtn_u32 v91, v75, v104
    v_lshlrev_b32 v110, 16, v42
    v_and_b32 v111, 0xffff0000, v42
    v_lshlrev_b32 v112, 16, v43
    v_and_b32 v113, 0xffff0000, v43
    v_mul_f32 v110, s44, v110
    v_mul_f32 v111, s44, v111
    v_mul_f32 v112, s44, v112
    v_mul_f32 v113, s44, v113
    v_fract_f32 v110, v110
    v_fract_f32 v111, v111
    v_fract_f32 v112, v112
    v_fract_f32 v113, v113
    v_cos_f32 v110, v110
    v_cos_f32 v111, v111
    v_cos_f32 v112, v112
    v_cos_f32 v113, v113
    v_lshl_or_b32 v68, v68, 14, v32
    v_perm_b32 v69, v69, v16, s46
    v_bfe_u32 v16, v16, 8, 5

    v_lshl_or_b32 v70, v70, 14, v33
    v_perm_b32 v71, v71, v17, s46
    v_bfe_u32 v17, v17, 8, 5

    v_lshl_or_b32 v72, v72, 14, v34
    v_perm_b32 v73, v73, v18, s46
    v_bfe_u32 v18, v18, 8, 5

    v_lshl_or_b32 v74, v74, 14, v35
    v_perm_b32 v75, v75, v19, s46
    v_bfe_u32 v19, v19, 8, 5

    v_fmaak_f32 v110, v110, v105, 0x4b400010
    v_fmaak_f32 v111, v111, v105, 0x4b400010
    v_fmaak_f32 v112, v112, v105, 0x4b400010
    v_fmaak_f32 v113, v113, v105, 0x4b400010
    v_sub_u32 v110, v110, v16
    v_sub_u32 v111, v111, v17
    v_sub_u32 v112, v112, v18
    v_sub_u32 v113, v113, v19
    v_bfi_b32 v110, 31, v16, v110
    v_bfi_b32 v111, 31, v17, v111
    v_bfi_b32 v112, 31, v18, v112
    v_bfi_b32 v113, 31, v19, v113
    v_perm_b32 v68, v68, v110, s55
    v_perm_b32 v70, v70, v111, s55
    v_perm_b32 v72, v72, v112, s55
    v_perm_b32 v74, v74, v113, s55
    s_mov_b64 exec, -1
L_ska_34:
    s_bitcmp0_b32 s28, 2
    s_cbranch_scc1 L_skw_35
    v_add_u32 v107, 65536, v2
    ds_read_b64 v[110:111], v107 offset:32784
    ds_read_b64 v[112:113], v107 offset:32792
    ds_read_b64 v[114:115], v107 offset:32776

    ds_read_b64 v[118:119], v107 offset:40976
    ds_read_b64 v[120:121], v107 offset:40984
    ds_read_b64 v[122:123], v107 offset:40968

    s_waitcnt lgkmcnt(3)
    v_lshrrev_b32 v116, 16, v111
    ds_read_b32 v116, v116 offset:8192

    s_waitcnt lgkmcnt(1)
    v_lshrrev_b32 v124, 16, v119
    ds_read_b32 v124, v124 offset:8192

    v_cmp_ne_u32_sdwa s[80:81], v111, v113 src0_sel:WORD_1 src1_sel:WORD_1
    v_cmp_ne_u32_sdwa vcc, v111, v115 src0_sel:WORD_1 src1_sel:WORD_1
    v_alignbyte_b32 v114, v115, v114, 2
    s_mov_b32 s54, 51197
    v_alignbyte_b32 v111, v111, v110, 1
    v_perm_b32 v110, v110, v114, s47
    s_waitcnt lgkmcnt(1)
    v_add3_u32 v116, v116, v106, s54
    v_sub_u32 v117, 0, v116
    v_and_b32 v117, 3, v117
    s_mov_b64 exec, s[80:81]
    v_mov_b32 v117, 0
    v_mov_b32 v112, 0
    s_mov_b64 exec, vcc
    v_mov_b32 v117, 3

    s_mov_b64 exec, -1
    v_alignbyte_b32 v110, v111, v110, v117
    v_alignbyte_b32 v111, v112, v111, v117
    v_add_u32 v116, v116, v117

    buffer_store_dwordx2 v[110:111], v116, s[24:27], 0 offen
    v_cmp_ne_u32_sdwa s[80:81], v119, v121 src0_sel:WORD_1 src1_sel:WORD_1
    v_cmp_ne_u32_sdwa vcc, v119, v123 src0_sel:WORD_1 src1_sel:WORD_1
    v_alignbyte_b32 v122, v123, v122, 2
    s_mov_b32 s54, 56317
    v_alignbyte_b32 v119, v119, v118, 1
    v_perm_b32 v118, v118, v122, s47
    s_waitcnt lgkmcnt(0)
    v_add3_u32 v124, v124, v106, s54
    v_sub_u32 v125, 0, v124
    v_and_b32 v125, 3, v125
    s_mov_b64 exec, s[80:81]
    v_mov_b32 v125, 0
    v_mov_b32 v120, 0
    s_mov_b64 exec, vcc
    v_mov_b32 v125, 3

    s_mov_b64 exec, -1
    v_alignbyte_b32 v118, v119, v118, v125
    v_alignbyte_b32 v119, v120, v119, v125
    v_add_u32 v124, v124, v125

    buffer_store_dwordx2 v[118:119], v124, s[24:27], 0 offen
L_skw_35:
    s_bitcmp0_b32 s28, 3
    s_cbranch_scc1 L_skw_36
    v_add_u32 v107, 98304, v2
    ds_read_b64 v[110:111], v107 offset:16400
    ds_read_b64 v[112:113], v107 offset:16408
    ds_read_b64 v[114:115], v107 offset:16392

    ds_read_b64 v[118:119], v107 offset:24592
    ds_read_b64 v[120:121], v107 offset:24600
    ds_read_b64 v[122:123], v107 offset:24584

    s_waitcnt lgkmcnt(3)
    v_lshrrev_b32 v116, 16, v111
    ds_read_b32 v116, v116 offset:8192

    s_waitcnt lgkmcnt(1)
    v_lshrrev_b32 v124, 16, v119
    ds_read_b32 v124, v124 offset:8192

    v_cmp_ne_u32_sdwa s[80:81], v111, v113 src0_sel:WORD_1 src1_sel:WORD_1
    v_cmp_ne_u32_sdwa vcc, v111, v115 src0_sel:WORD_1 src1_sel:WORD_1
    v_alignbyte_b32 v114, v115, v114, 2
    s_mov_b32 s54, 61437
    v_alignbyte_b32 v111, v111, v110, 1
    v_perm_b32 v110, v110, v114, s47
    s_waitcnt lgkmcnt(1)
    v_add3_u32 v116, v116, v106, s54
    v_sub_u32 v117, 0, v116
    v_and_b32 v117, 3, v117
    s_mov_b64 exec, s[80:81]
    v_mov_b32 v117, 0
    v_mov_b32 v112, 0
    s_mov_b64 exec, vcc
    v_mov_b32 v117, 3

    s_mov_b64 exec, -1
    v_alignbyte_b32 v110, v111, v110, v117
    v_alignbyte_b32 v111, v112, v111, v117
    v_add_u32 v116, v116, v117

    buffer_store_dwordx2 v[110:111], v116, s[24:27], 0 offen
    v_cmp_ne_u32_sdwa s[80:81], v119, v121 src0_sel:WORD_1 src1_sel:WORD_1
    v_cmp_ne_u32_sdwa vcc, v119, v123 src0_sel:WORD_1 src1_sel:WORD_1
    v_alignbyte_b32 v122, v123, v122, 2
    s_mov_b32 s54, 66557
    v_alignbyte_b32 v119, v119, v118, 1
    v_perm_b32 v118, v118, v122, s47
    s_waitcnt lgkmcnt(0)
    v_add3_u32 v124, v124, v106, s54
    v_sub_u32 v125, 0, v124
    v_and_b32 v125, 3, v125
    s_mov_b64 exec, s[80:81]
    v_mov_b32 v125, 0
    v_mov_b32 v120, 0
    s_mov_b64 exec, vcc
    v_mov_b32 v125, 3

    s_mov_b64 exec, -1
    v_alignbyte_b32 v118, v119, v118, v125
    v_alignbyte_b32 v119, v120, v119, v125
    v_add_u32 v124, v124, v125

    buffer_store_dwordx2 v[118:119], v124, s[24:27], 0 offen
L_skw_36:
    s_bitcmp0_b32 s28, 3
    s_cbranch_scc1 L_skw_37
    v_add_u32 v107, 98304, v2
    ds_read_b64 v[110:111], v107 offset:32784
    ds_read_b64 v[112:113], v107 offset:32792
    ds_read_b64 v[114:115], v107 offset:32776

    ds_read_b64 v[118:119], v107 offset:40976
    ds_read_b64 v[120:121], v107 offset:40984
    ds_read_b64 v[122:123], v107 offset:40968

    s_waitcnt lgkmcnt(3)
    v_lshrrev_b32 v116, 16, v111
    ds_read_b32 v116, v116 offset:8192

    s_waitcnt lgkmcnt(1)
    v_lshrrev_b32 v124, 16, v119
    ds_read_b32 v124, v124 offset:8192

    v_cmp_ne_u32_sdwa s[80:81], v111, v113 src0_sel:WORD_1 src1_sel:WORD_1
    v_cmp_ne_u32_sdwa vcc, v111, v115 src0_sel:WORD_1 src1_sel:WORD_1
    v_alignbyte_b32 v114, v115, v114, 2
    s_mov_b32 s54, 71677
    v_alignbyte_b32 v111, v111, v110, 1
    v_perm_b32 v110, v110, v114, s47
    s_waitcnt lgkmcnt(1)
    v_add3_u32 v116, v116, v106, s54
    v_sub_u32 v117, 0, v116
    v_and_b32 v117, 3, v117
    s_mov_b64 exec, s[80:81]
    v_mov_b32 v117, 0
    v_mov_b32 v112, 0
    s_mov_b64 exec, vcc
    v_mov_b32 v117, 3

    s_mov_b64 exec, -1
    v_alignbyte_b32 v110, v111, v110, v117
    v_alignbyte_b32 v111, v112, v111, v117
    v_add_u32 v116, v116, v117

    buffer_store_dwordx2 v[110:111], v116, s[24:27], 0 offen
    v_cmp_ne_u32_sdwa s[80:81], v119, v121 src0_sel:WORD_1 src1_sel:WORD_1
    v_cmp_ne_u32_sdwa vcc, v119, v123 src0_sel:WORD_1 src1_sel:WORD_1
    v_alignbyte_b32 v122, v123, v122, 2
    s_mov_b32 s54, 76797
    v_alignbyte_b32 v119, v119, v118, 1
    v_perm_b32 v118, v118, v122, s47
    s_waitcnt lgkmcnt(0)
    v_add3_u32 v124, v124, v106, s54
    v_sub_u32 v125, 0, v124
    v_and_b32 v125, 3, v125
    s_mov_b64 exec, s[80:81]
    v_mov_b32 v125, 0
    v_mov_b32 v120, 0
    s_mov_b64 exec, vcc
    v_mov_b32 v125, 3

    s_andn2_b64 exec, -1, s[68:69]
    v_bfrev_b32 v124, 1
    s_mov_b64 exec, -1
    v_alignbyte_b32 v118, v119, v118, v125
    v_alignbyte_b32 v119, v120, v119, v125
    v_add_u32 v124, v124, v125

    buffer_store_dwordx2 v[118:119], v124, s[24:27], 0 offen
L_skw_37:
    s_waitcnt lgkmcnt(0)
    s_barrier

    buffer_load_dwordx4 v[20:23], v1, s[12:15], s56 offen nt
    buffer_load_dwordx4 v[4:7], v1, s[8:11], s56 offen nt
    buffer_load_dwordx2 v[36:37], v2, s[16:19], s61 offen nt
    buffer_load_dwordx4 v[24:27], v1, s[12:15], s57 offen nt
    buffer_load_dwordx4 v[8:11], v1, s[8:11], s57 offen nt
    buffer_load_dwordx2 v[38:39], v2, s[16:19], s62 offen nt
    ds_read_b64 v[94:95], v2
    s_waitcnt lgkmcnt(0)
    v_and_b32 v94, 0xffff, v94
    v_and_b32 v95, 0xffff, v95
    v_add_u32 v97, v94, v95
    s_nop 1
    v_add_u32_dpp v97, v97, v97 row_shr:1 row_mask:0xf bank_mask:0xf
    s_nop 1
    v_add_u32_dpp v97, v97, v97 row_shr:2 row_mask:0xf bank_mask:0xf
    s_nop 1
    v_add_u32_dpp v97, v97, v97 row_shr:4 row_mask:0xf bank_mask:0xf
    s_nop 1
    v_add_u32_dpp v97, v97, v97 row_shr:8 row_mask:0xf bank_mask:0xf
    s_nop 1
    v_add_u32_dpp v97, v97, v97 row_bcast:15 row_mask:0xa bank_mask:0xf
    s_nop 1
    v_add_u32_dpp v97, v97, v97 row_bcast:31 row_mask:0xc bank_mask:0xf
    s_mov_b32 exec_lo, 0
    s_brev_b32 exec_hi, 1
    ds_add_rtn_u32 v96, v108, v97
    s_mov_b64 exec, -1

    v_add_u32 v92, v94, v94
    v_add_u32 v93, v95, v95
    v_med3_u32 v92, v94, 2, v92
    v_med3_u32 v93, v95, 2, v93
    v_lshl_or_b32 v92, v93, 16, v92
    v_lshlrev_b32 v93, 2, v0
    buffer_atomic_add v92, v93, s[20:23], 0 offen sc0
    s_waitcnt lgkmcnt(0)
    v_readlane_b32 s77, v96, 63
    v_mul_u32_u24 v114, 65528, v0
    v_sub_u32 v97, v97, v95
    s_sub_u32 s50, s50, s83
    s_sub_u32 s77, s77, s50
    v_add_u32 v97, s77, v97
    v_sub_u32 v96, v97, v94
    v_lshlrev_b32 v111, 16, v97
    v_lshlrev_b32 v110, 16, v96
    ds_write_b64 v2, v[110:111]
    v_mad_i32_i24 v96, v96, -5, v114
    v_mad_i32_i24 v97, v97, -5, v114
    v_add_u32 v97, 32764, v97
    s_add_u32 s50, s50, s84
    s_mov_b32 s28, s82
    s_mov_b32 s29, s83
    s_mov_b32 s30, s84
    s_lshl_b32 s74, s29, 3
    s_lshl_b32 s75, s30, 3
    v_mov_b32 v125, s74
    v_mov_b32 v126, s75
    v_mov_b32 v127, -1

    s_waitcnt lgkmcnt(0)
    s_barrier

    s_mov_b64 exec, 1
    ds_write_b32 v125, v127 offset:16396
    ds_write_b32 v126, v127 offset:16404
    s_mov_b64 exec, -1

    s_bitcmp0_b32 s28, 0
    s_cbranch_scc1 L_skz_38
    v_lshrrev_b32 v110, 16, v45
    ds_read_b32 v110, v110
    v_lshrrev_b32 v111, 16, v47
    ds_read_b32 v111, v111
    v_lshrrev_b32 v112, 16, v49
    ds_read_b32 v112, v112
    v_lshrrev_b32 v113, 16, v51
    ds_read_b32 v113, v113
    v_lshrrev_b32 v114, 16, v53
    ds_read_b32 v114, v114
    v_lshrrev_b32 v115, 16, v55
    ds_read_b32 v115, v115
    v_lshrrev_b32 v116, 16, v57
    ds_read_b32 v116, v116
    v_lshrrev_b32 v117, 16, v59
    ds_read_b32 v117, v117
    s_waitcnt lgkmcnt(7)
    v_add_u32_sdwa v110, v110, v76 dst_sel:DWORD dst_unused:UNUSED_PAD src0_sel:WORD_1 src1_sel:WORD_0
    v_lshlrev_b32 v110, 3, v110
    ds_write_b64 v110, v[44:45] offset:16400

    s_waitcnt lgkmcnt(7)
    v_add_u32_sdwa v111, v111, v77 dst_sel:DWORD dst_unused:UNUSED_PAD src0_sel:WORD_1 src1_sel:WORD_0
    v_lshlrev_b32 v111, 3, v111
    ds_write_b64 v111, v[46:47] offset:16400

    s_waitcnt lgkmcnt(7)
    v_add_u32_sdwa v112, v112, v78 dst_sel:DWORD dst_unused:UNUSED_PAD src0_sel:WORD_1 src1_sel:WORD_0
    v_lshlrev_b32 v112, 3, v112
    ds_write_b64 v112, v[48:49] offset:16400

    s_waitcnt lgkmcnt(7)
    v_add_u32_sdwa v113, v113, v79 dst_sel:DWORD dst_unused:UNUSED_PAD src0_sel:WORD_1 src1_sel:WORD_0
    v_lshlrev_b32 v113, 3, v113
    ds_write_b64 v113, v[50:51] offset:16400

    s_waitcnt lgkmcnt(7)
    v_add_u32_sdwa v114, v114, v80 dst_sel:DWORD dst_unused:UNUSED_PAD src0_sel:WORD_1 src1_sel:WORD_0
    v_lshlrev_b32 v114, 3, v114
    ds_write_b64 v114, v[52:53] offset:16400

    s_waitcnt lgkmcnt(7)
    v_add_u32_sdwa v115, v115, v81 dst_sel:DWORD dst_unused:UNUSED_PAD src0_sel:WORD_1 src1_sel:WORD_0
    v_lshlrev_b32 v115, 3, v115
    ds_write_b64 v115, v[54:55] offset:16400

    s_waitcnt lgkmcnt(7)
    v_add_u32_sdwa v116, v116, v82 dst_sel:DWORD dst_unused:UNUSED_PAD src0_sel:WORD_1 src1_sel:WORD_0
    v_lshlrev_b32 v116, 3, v116
    ds_write_b64 v116, v[56:57] offset:16400

    s_waitcnt lgkmcnt(7)
    v_add_u32_sdwa v117, v117, v83 dst_sel:DWORD dst_unused:UNUSED_PAD src0_sel:WORD_1 src1_sel:WORD_0
    v_lshlrev_b32 v117, 3, v117
    ds_write_b64 v117, v[58:59] offset:16400

L_skz_38:
    buffer_load_dwordx4 v[28:31], v1, s[12:15], s58 offen nt
    buffer_load_dwordx4 v[12:15], v1, s[8:11], s58 offen nt
    buffer_load_dwordx2 v[40:41], v2, s[16:19], s63 offen nt
    s_bitcmp0_b32 s28, 2
    s_cbranch_scc1 L_skz_39
    v_lshrrev_b32 v110, 16, v61
    ds_read_b32 v110, v110
    v_lshrrev_b32 v111, 16, v63
    ds_read_b32 v111, v111
    v_lshrrev_b32 v112, 16, v65
    ds_read_b32 v112, v112
    v_lshrrev_b32 v113, 16, v67
    ds_read_b32 v113, v113
    s_waitcnt lgkmcnt(3)
    v_add_u32_sdwa v110, v110, v84 dst_sel:DWORD dst_unused:UNUSED_PAD src0_sel:WORD_1 src1_sel:WORD_0
    v_lshlrev_b32 v110, 3, v110
    ds_write_b64 v110, v[60:61] offset:16400

    s_waitcnt lgkmcnt(3)
    v_add_u32_sdwa v111, v111, v85 dst_sel:DWORD dst_unused:UNUSED_PAD src0_sel:WORD_1 src1_sel:WORD_0
    v_lshlrev_b32 v111, 3, v111
    ds_write_b64 v111, v[62:63] offset:16400

    s_waitcnt lgkmcnt(3)
    v_add_u32_sdwa v112, v112, v86 dst_sel:DWORD dst_unused:UNUSED_PAD src0_sel:WORD_1 src1_sel:WORD_0
    v_lshlrev_b32 v112, 3, v112
    ds_write_b64 v112, v[64:65] offset:16400

    s_waitcnt lgkmcnt(3)
    v_add_u32_sdwa v113, v113, v87 dst_sel:DWORD dst_unused:UNUSED_PAD src0_sel:WORD_1 src1_sel:WORD_0
    v_lshlrev_b32 v113, 3, v113
    ds_write_b64 v113, v[66:67] offset:16400

L_skz_39:
    s_bitcmp0_b32 s28, 3
    s_cbranch_scc1 L_skz_40
    s_mov_b64 exec, s[66:67]
    v_lshrrev_b32 v110, 16, v69
    ds_read_b32 v110, v110
    v_lshrrev_b32 v111, 16, v71
    ds_read_b32 v111, v111
    v_lshrrev_b32 v112, 16, v73
    ds_read_b32 v112, v112
    v_lshrrev_b32 v113, 16, v75
    ds_read_b32 v113, v113
    s_waitcnt lgkmcnt(3)
    v_add_u32_sdwa v110, v110, v88 dst_sel:DWORD dst_unused:UNUSED_PAD src0_sel:WORD_1 src1_sel:WORD_0
    v_lshlrev_b32 v110, 3, v110
    ds_write_b64 v110, v[68:69] offset:16400

    s_waitcnt lgkmcnt(3)
    v_add_u32_sdwa v111, v111, v89 dst_sel:DWORD dst_unused:UNUSED_PAD src0_sel:WORD_1 src1_sel:WORD_0
    v_lshlrev_b32 v111, 3, v111
    ds_write_b64 v111, v[70:71] offset:16400

    s_waitcnt lgkmcnt(3)
    v_add_u32_sdwa v112, v112, v90 dst_sel:DWORD dst_unused:UNUSED_PAD src0_sel:WORD_1 src1_sel:WORD_0
    v_lshlrev_b32 v112, 3, v112
    ds_write_b64 v112, v[72:73] offset:16400

    s_waitcnt lgkmcnt(3)
    v_add_u32_sdwa v113, v113, v91 dst_sel:DWORD dst_unused:UNUSED_PAD src0_sel:WORD_1 src1_sel:WORD_0
    v_lshlrev_b32 v113, 3, v113
    ds_write_b64 v113, v[74:75] offset:16400

    s_mov_b64 exec, -1
L_skz_40:
    buffer_load_dwordx4 v[32:35], v1, s[12:15], s59 offen nt
    buffer_load_dwordx4 v[16:19], v1, s[8:11], s59 offen nt
    buffer_load_dwordx2 v[42:43], v2, s[16:19], s64 offen nt
    s_cmp_lg_u32 s49, 0
    s_cbranch_scc1 L_p1loop_6
L_p1epi_7:
    s_waitcnt vmcnt(0)
    s_waitcnt vmcnt(0)
    v_lshrrev_b32 v93, 16, v92
    v_and_b32 v92, 0xffff, v92
    v_add_u32 v110, v92, v94
    v_mad_u32_u24 v92, v92, 5, v96
    v_add_u32 v111, v93, v95
    v_mad_u32_u24 v93, v93, 5, v97
    v_max_u32 v110, v110, v111
    v_cmp_le_u32 vcc, s48, v110
    s_cbranch_vccnz L_full_41
L_fback_42:
    ds_write_b64 v2, v[92:93] offset:8192

    s_waitcnt lgkmcnt(0)
    s_barrier

    s_bitcmp0_b32 s28, 0
    s_cbranch_scc1 L_skw_43
    ds_read_b64 v[4:5], v2 offset:16400
    ds_read_b64 v[6:7], v2 offset:16408
    ds_read_b64 v[8:9], v2 offset:16392

    ds_read_b64 v[12:13], v2 offset:24592
    ds_read_b64 v[14:15], v2 offset:24600
    ds_read_b64 v[16:17], v2 offset:24584

    ds_read_b64 v[20:21], v2 offset:32784
    ds_read_b64 v[22:23], v2 offset:32792
    ds_read_b64 v[24:25], v2 offset:32776

    ds_read_b64 v[28:29], v2 offset:40976
    ds_read_b64 v[30:31], v2 offset:40984
    ds_read_b64 v[32:33], v2 offset:40968

    s_waitcnt lgkmcnt(9)
    v_lshrrev_b32 v10, 16, v5
    ds_read_b32 v10, v10 offset:8192

    s_waitcnt lgkmcnt(7)
    v_lshrrev_b32 v18, 16, v13
    ds_read_b32 v18, v18 offset:8192

    s_waitcnt lgkmcnt(5)
    v_lshrrev_b32 v26, 16, v21
    ds_read_b32 v26, v26 offset:8192

    s_waitcnt lgkmcnt(3)
    v_lshrrev_b32 v34, 16, v29
    ds_read_b32 v34, v34 offset:8192

    v_cmp_ne_u32_sdwa s[80:81], v5, v7 src0_sel:WORD_1 src1_sel:WORD_1
    v_cmp_ne_u32_sdwa vcc, v5, v9 src0_sel:WORD_1 src1_sel:WORD_1
    v_alignbyte_b32 v8, v9, v8, 2
    s_mov_b32 s54, -3
    v_alignbyte_b32 v5, v5, v4, 1
    v_perm_b32 v4, v4, v8, s47
    s_waitcnt lgkmcnt(3)
    v_add3_u32 v10, v10, v106, s54
    v_sub_u32 v11, 0, v10
    v_and_b32 v11, 3, v11
    s_mov_b64 exec, s[80:81]
    v_mov_b32 v11, 0
    v_mov_b32 v6, 0
    s_mov_b64 exec, vcc
    v_mov_b32 v11, 3

    s_mov_b64 exec, -1
    v_alignbyte_b32 v4, v5, v4, v11
    v_alignbyte_b32 v5, v6, v5, v11
    v_add_u32 v10, v10, v11

    buffer_store_dwordx2 v[4:5], v10, s[24:27], 0 offen
    v_cmp_ne_u32_sdwa s[80:81], v13, v15 src0_sel:WORD_1 src1_sel:WORD_1
    v_cmp_ne_u32_sdwa vcc, v13, v17 src0_sel:WORD_1 src1_sel:WORD_1
    v_alignbyte_b32 v16, v17, v16, 2
    s_mov_b32 s54, 5117
    v_alignbyte_b32 v13, v13, v12, 1
    v_perm_b32 v12, v12, v16, s47
    s_waitcnt lgkmcnt(2)
    v_add3_u32 v18, v18, v106, s54
    v_sub_u32 v19, 0, v18
    v_and_b32 v19, 3, v19
    s_mov_b64 exec, s[80:81]
    v_mov_b32 v19, 0
    v_mov_b32 v14, 0
    s_mov_b64 exec, vcc
    v_mov_b32 v19, 3

    s_mov_b64 exec, -1
    v_alignbyte_b32 v12, v13, v12, v19
    v_alignbyte_b32 v13, v14, v13, v19
    v_add_u32 v18, v18, v19

    buffer_store_dwordx2 v[12:13], v18, s[24:27], 0 offen
    v_cmp_ne_u32_sdwa s[80:81], v21, v23 src0_sel:WORD_1 src1_sel:WORD_1
    v_cmp_ne_u32_sdwa vcc, v21, v25 src0_sel:WORD_1 src1_sel:WORD_1
    v_alignbyte_b32 v24, v25, v24, 2
    s_mov_b32 s54, 10237
    v_alignbyte_b32 v21, v21, v20, 1
    v_perm_b32 v20, v20, v24, s47
    s_waitcnt lgkmcnt(1)
    v_add3_u32 v26, v26, v106, s54
    v_sub_u32 v27, 0, v26
    v_and_b32 v27, 3, v27
    s_mov_b64 exec, s[80:81]
    v_mov_b32 v27, 0
    v_mov_b32 v22, 0
    s_mov_b64 exec, vcc
    v_mov_b32 v27, 3

    s_mov_b64 exec, -1
    v_alignbyte_b32 v20, v21, v20, v27
    v_alignbyte_b32 v21, v22, v21, v27
    v_add_u32 v26, v26, v27

    buffer_store_dwordx2 v[20:21], v26, s[24:27], 0 offen
    v_cmp_ne_u32_sdwa s[80:81], v29, v31 src0_sel:WORD_1 src1_sel:WORD_1
    v_cmp_ne_u32_sdwa vcc, v29, v33 src0_sel:WORD_1 src1_sel:WORD_1
    v_alignbyte_b32 v32, v33, v32, 2
    s_mov_b32 s54, 15357
    v_alignbyte_b32 v29, v29, v28, 1
    v_perm_b32 v28, v28, v32, s47
    s_waitcnt lgkmcnt(0)
    v_add3_u32 v34, v34, v106, s54
    v_sub_u32 v35, 0, v34
    v_and_b32 v35, 3, v35
    s_mov_b64 exec, s[80:81]
    v_mov_b32 v35, 0
    v_mov_b32 v30, 0
    s_mov_b64 exec, vcc
    v_mov_b32 v35, 3

    s_mov_b64 exec, -1
    v_alignbyte_b32 v28, v29, v28, v35
    v_alignbyte_b32 v29, v30, v29, v35
    v_add_u32 v34, v34, v35

    buffer_store_dwordx2 v[28:29], v34, s[24:27], 0 offen
L_skw_43:
    s_bitcmp0_b32 s28, 1
    s_cbranch_scc1 L_skw_44
    v_add_u32 v107, 32768, v2
    ds_read_b64 v[4:5], v107 offset:16400
    ds_read_b64 v[6:7], v107 offset:16408
    ds_read_b64 v[8:9], v107 offset:16392

    ds_read_b64 v[12:13], v107 offset:24592
    ds_read_b64 v[14:15], v107 offset:24600
    ds_read_b64 v[16:17], v107 offset:24584

    ds_read_b64 v[20:21], v107 offset:32784
    ds_read_b64 v[22:23], v107 offset:32792
    ds_read_b64 v[24:25], v107 offset:32776

    ds_read_b64 v[28:29], v107 offset:40976
    ds_read_b64 v[30:31], v107 offset:40984
    ds_read_b64 v[32:33], v107 offset:40968

    s_waitcnt lgkmcnt(9)
    v_lshrrev_b32 v10, 16, v5
    ds_read_b32 v10, v10 offset:8192

    s_waitcnt lgkmcnt(7)
    v_lshrrev_b32 v18, 16, v13
    ds_read_b32 v18, v18 offset:8192

    s_waitcnt lgkmcnt(5)
    v_lshrrev_b32 v26, 16, v21
    ds_read_b32 v26, v26 offset:8192

    s_waitcnt lgkmcnt(3)
    v_lshrrev_b32 v34, 16, v29
    ds_read_b32 v34, v34 offset:8192

    v_cmp_ne_u32_sdwa s[80:81], v5, v7 src0_sel:WORD_1 src1_sel:WORD_1
    v_cmp_ne_u32_sdwa vcc, v5, v9 src0_sel:WORD_1 src1_sel:WORD_1
    v_alignbyte_b32 v8, v9, v8, 2
    s_mov_b32 s54, 20477
    v_alignbyte_b32 v5, v5, v4, 1
    v_perm_b32 v4, v4, v8, s47
    s_waitcnt lgkmcnt(3)
    v_add3_u32 v10, v10, v106, s54
    v_sub_u32 v11, 0, v10
    v_and_b32 v11, 3, v11
    s_mov_b64 exec, s[80:81]
    v_mov_b32 v11, 0
    v_mov_b32 v6, 0
    s_mov_b64 exec, vcc
    v_mov_b32 v11, 3

    s_mov_b64 exec, -1
    v_alignbyte_b32 v4, v5, v4, v11
    v_alignbyte_b32 v5, v6, v5, v11
    v_add_u32 v10, v10, v11

    buffer_store_dwordx2 v[4:5], v10, s[24:27], 0 offen
    v_cmp_ne_u32_sdwa s[80:81], v13, v15 src0_sel:WORD_1 src1_sel:WORD_1
    v_cmp_ne_u32_sdwa vcc, v13, v17 src0_sel:WORD_1 src1_sel:WORD_1
    v_alignbyte_b32 v16, v17, v16, 2
    s_mov_b32 s54, 25597
    v_alignbyte_b32 v13, v13, v12, 1
    v_perm_b32 v12, v12, v16, s47
    s_waitcnt lgkmcnt(2)
    v_add3_u32 v18, v18, v106, s54
    v_sub_u32 v19, 0, v18
    v_and_b32 v19, 3, v19
    s_mov_b64 exec, s[80:81]
    v_mov_b32 v19, 0
    v_mov_b32 v14, 0
    s_mov_b64 exec, vcc
    v_mov_b32 v19, 3

    s_mov_b64 exec, -1
    v_alignbyte_b32 v12, v13, v12, v19
    v_alignbyte_b32 v13, v14, v13, v19
    v_add_u32 v18, v18, v19

    buffer_store_dwordx2 v[12:13], v18, s[24:27], 0 offen
    v_cmp_ne_u32_sdwa s[80:81], v21, v23 src0_sel:WORD_1 src1_sel:WORD_1
    v_cmp_ne_u32_sdwa vcc, v21, v25 src0_sel:WORD_1 src1_sel:WORD_1
    v_alignbyte_b32 v24, v25, v24, 2
    s_mov_b32 s54, 30717
    v_alignbyte_b32 v21, v21, v20, 1
    v_perm_b32 v20, v20, v24, s47
    s_waitcnt lgkmcnt(1)
    v_add3_u32 v26, v26, v106, s54
    v_sub_u32 v27, 0, v26
    v_and_b32 v27, 3, v27
    s_mov_b64 exec, s[80:81]
    v_mov_b32 v27, 0
    v_mov_b32 v22, 0
    s_mov_b64 exec, vcc
    v_mov_b32 v27, 3

    s_mov_b64 exec, -1
    v_alignbyte_b32 v20, v21, v20, v27
    v_alignbyte_b32 v21, v22, v21, v27
    v_add_u32 v26, v26, v27

    buffer_store_dwordx2 v[20:21], v26, s[24:27], 0 offen
    v_cmp_ne_u32_sdwa s[80:81], v29, v31 src0_sel:WORD_1 src1_sel:WORD_1
    v_cmp_ne_u32_sdwa vcc, v29, v33 src0_sel:WORD_1 src1_sel:WORD_1
    v_alignbyte_b32 v32, v33, v32, 2
    s_mov_b32 s54, 35837
    v_alignbyte_b32 v29, v29, v28, 1
    v_perm_b32 v28, v28, v32, s47
    s_waitcnt lgkmcnt(0)
    v_add3_u32 v34, v34, v106, s54
    v_sub_u32 v35, 0, v34
    v_and_b32 v35, 3, v35
    s_mov_b64 exec, s[80:81]
    v_mov_b32 v35, 0
    v_mov_b32 v30, 0
    s_mov_b64 exec, vcc
    v_mov_b32 v35, 3

    s_mov_b64 exec, -1
    v_alignbyte_b32 v28, v29, v28, v35
    v_alignbyte_b32 v29, v30, v29, v35
    v_add_u32 v34, v34, v35

    buffer_store_dwordx2 v[28:29], v34, s[24:27], 0 offen
L_skw_44:
    s_bitcmp0_b32 s28, 2
    s_cbranch_scc1 L_skw_45
    v_add_u32 v107, 65536, v2
    ds_read_b64 v[4:5], v107 offset:16400
    ds_read_b64 v[6:7], v107 offset:16408
    ds_read_b64 v[8:9], v107 offset:16392

    ds_read_b64 v[12:13], v107 offset:24592
    ds_read_b64 v[14:15], v107 offset:24600
    ds_read_b64 v[16:17], v107 offset:24584

    ds_read_b64 v[20:21], v107 offset:32784
    ds_read_b64 v[22:23], v107 offset:32792
    ds_read_b64 v[24:25], v107 offset:32776

    ds_read_b64 v[28:29], v107 offset:40976
    ds_read_b64 v[30:31], v107 offset:40984
    ds_read_b64 v[32:33], v107 offset:40968

    s_waitcnt lgkmcnt(9)
    v_lshrrev_b32 v10, 16, v5
    ds_read_b32 v10, v10 offset:8192

    s_waitcnt lgkmcnt(7)
    v_lshrrev_b32 v18, 16, v13
    ds_read_b32 v18, v18 offset:8192

    s_waitcnt lgkmcnt(5)
    v_lshrrev_b32 v26, 16, v21
    ds_read_b32 v26, v26 offset:8192

    s_waitcnt lgkmcnt(3)
    v_lshrrev_b32 v34, 16, v29
    ds_read_b32 v34, v34 offset:8192

    v_cmp_ne_u32_sdwa s[80:81], v5, v7 src0_sel:WORD_1 src1_sel:WORD_1
    v_cmp_ne_u32_sdwa vcc, v5, v9 src0_sel:WORD_1 src1_sel:WORD_1
    v_alignbyte_b32 v8, v9, v8, 2
    s_mov_b32 s54, 40957
    v_alignbyte_b32 v5, v5, v4, 1
    v_perm_b32 v4, v4, v8, s47
    s_waitcnt lgkmcnt(3)
    v_add3_u32 v10, v10, v106, s54
    v_sub_u32 v11, 0, v10
    v_and_b32 v11, 3, v11
    s_mov_b64 exec, s[80:81]
    v_mov_b32 v11, 0
    v_mov_b32 v6, 0
    s_mov_b64 exec, vcc
    v_mov_b32 v11, 3

    s_mov_b64 exec, -1
    v_alignbyte_b32 v4, v5, v4, v11
    v_alignbyte_b32 v5, v6, v5, v11
    v_add_u32 v10, v10, v11

    buffer_store_dwordx2 v[4:5], v10, s[24:27], 0 offen
    v_cmp_ne_u32_sdwa s[80:81], v13, v15 src0_sel:WORD_1 src1_sel:WORD_1
    v_cmp_ne_u32_sdwa vcc, v13, v17 src0_sel:WORD_1 src1_sel:WORD_1
    v_alignbyte_b32 v16, v17, v16, 2
    s_mov_b32 s54, 46077
    v_alignbyte_b32 v13, v13, v12, 1
    v_perm_b32 v12, v12, v16, s47
    s_waitcnt lgkmcnt(2)
    v_add3_u32 v18, v18, v106, s54
    v_sub_u32 v19, 0, v18
    v_and_b32 v19, 3, v19
    s_mov_b64 exec, s[80:81]
    v_mov_b32 v19, 0
    v_mov_b32 v14, 0
    s_mov_b64 exec, vcc
    v_mov_b32 v19, 3

    s_mov_b64 exec, -1
    v_alignbyte_b32 v12, v13, v12, v19
    v_alignbyte_b32 v13, v14, v13, v19
    v_add_u32 v18, v18, v19

    buffer_store_dwordx2 v[12:13], v18, s[24:27], 0 offen
    v_cmp_ne_u32_sdwa s[80:81], v21, v23 src0_sel:WORD_1 src1_sel:WORD_1
    v_cmp_ne_u32_sdwa vcc, v21, v25 src0_sel:WORD_1 src1_sel:WORD_1
    v_alignbyte_b32 v24, v25, v24, 2
    s_mov_b32 s54, 51197
    v_alignbyte_b32 v21, v21, v20, 1
    v_perm_b32 v20, v20, v24, s47
    s_waitcnt lgkmcnt(1)
    v_add3_u32 v26, v26, v106, s54
    v_sub_u32 v27, 0, v26
    v_and_b32 v27, 3, v27
    s_mov_b64 exec, s[80:81]
    v_mov_b32 v27, 0
    v_mov_b32 v22, 0
    s_mov_b64 exec, vcc
    v_mov_b32 v27, 3

    s_mov_b64 exec, -1
    v_alignbyte_b32 v20, v21, v20, v27
    v_alignbyte_b32 v21, v22, v21, v27
    v_add_u32 v26, v26, v27

    buffer_store_dwordx2 v[20:21], v26, s[24:27], 0 offen
    v_cmp_ne_u32_sdwa s[80:81], v29, v31 src0_sel:WORD_1 src1_sel:WORD_1
    v_cmp_ne_u32_sdwa vcc, v29, v33 src0_sel:WORD_1 src1_sel:WORD_1
    v_alignbyte_b32 v32, v33, v32, 2
    s_mov_b32 s54, 56317
    v_alignbyte_b32 v29, v29, v28, 1
    v_perm_b32 v28, v28, v32, s47
    s_waitcnt lgkmcnt(0)
    v_add3_u32 v34, v34, v106, s54
    v_sub_u32 v35, 0, v34
    v_and_b32 v35, 3, v35
    s_mov_b64 exec, s[80:81]
    v_mov_b32 v35, 0
    v_mov_b32 v30, 0
    s_mov_b64 exec, vcc
    v_mov_b32 v35, 3

    s_mov_b64 exec, -1
    v_alignbyte_b32 v28, v29, v28, v35
    v_alignbyte_b32 v29, v30, v29, v35
    v_add_u32 v34, v34, v35

    buffer_store_dwordx2 v[28:29], v34, s[24:27], 0 offen
L_skw_45:
    s_bitcmp0_b32 s28, 3
    s_cbranch_scc1 L_skw_46
    v_add_u32 v107, 98304, v2
    ds_read_b64 v[4:5], v107 offset:16400
    ds_read_b64 v[6:7], v107 offset:16408
    ds_read_b64 v[8:9], v107 offset:16392

    ds_read_b64 v[12:13], v107 offset:24592
    ds_read_b64 v[14:15], v107 offset:24600
    ds_read_b64 v[16:17], v107 offset:24584

    ds_read_b64 v[20:21], v107 offset:32784
    ds_read_b64 v[22:23], v107 offset:32792
    ds_read_b64 v[24:25], v107 offset:32776

    ds_read_b64 v[28:29], v107 offset:40976
    ds_read_b64 v[30:31], v107 offset:40984
    ds_read_b64 v[32:33], v107 offset:40968

    s_waitcnt lgkmcnt(9)
    v_lshrrev_b32 v10, 16, v5
    ds_read_b32 v10, v10 offset:8192

    s_waitcnt lgkmcnt(7)
    v_lshrrev_b32 v18, 16, v13
    ds_read_b32 v18, v18 offset:8192

    s_waitcnt lgkmcnt(5)
    v_lshrrev_b32 v26, 16, v21
    ds_read_b32 v26, v26 offset:8192

    s_waitcnt lgkmcnt(3)
    v_lshrrev_b32 v34, 16, v29
    ds_read_b32 v34, v34 offset:8192

    v_cmp_ne_u32_sdwa s[80:81], v5, v7 src0_sel:WORD_1 src1_sel:WORD_1
    v_cmp_ne_u32_sdwa vcc, v5, v9 src0_sel:WORD_1 src1_sel:WORD_1
    v_alignbyte_b32 v8, v9, v8, 2
    s_mov_b32 s54, 61437
    v_alignbyte_b32 v5, v5, v4, 1
    v_perm_b32 v4, v4, v8, s47
    s_waitcnt lgkmcnt(3)
    v_add3_u32 v10, v10, v106, s54
    v_sub_u32 v11, 0, v10
    v_and_b32 v11, 3, v11
    s_mov_b64 exec, s[80:81]
    v_mov_b32 v11, 0
    v_mov_b32 v6, 0
    s_mov_b64 exec, vcc
    v_mov_b32 v11, 3

    s_mov_b64 exec, -1
    v_alignbyte_b32 v4, v5, v4, v11
    v_alignbyte_b32 v5, v6, v5, v11
    v_add_u32 v10, v10, v11

    buffer_store_dwordx2 v[4:5], v10, s[24:27], 0 offen
    v_cmp_ne_u32_sdwa s[80:81], v13, v15 src0_sel:WORD_1 src1_sel:WORD_1
    v_cmp_ne_u32_sdwa vcc, v13, v17 src0_sel:WORD_1 src1_sel:WORD_1
    v_alignbyte_b32 v16, v17, v16, 2
    s_mov_b32 s54, 66557
    v_alignbyte_b32 v13, v13, v12, 1
    v_perm_b32 v12, v12, v16, s47
    s_waitcnt lgkmcnt(2)
    v_add3_u32 v18, v18, v106, s54
    v_sub_u32 v19, 0, v18
    v_and_b32 v19, 3, v19
    s_mov_b64 exec, s[80:81]
    v_mov_b32 v19, 0
    v_mov_b32 v14, 0
    s_mov_b64 exec, vcc
    v_mov_b32 v19, 3

    s_mov_b64 exec, -1
    v_alignbyte_b32 v12, v13, v12, v19
    v_alignbyte_b32 v13, v14, v13, v19
    v_add_u32 v18, v18, v19

    buffer_store_dwordx2 v[12:13], v18, s[24:27], 0 offen
    v_cmp_ne_u32_sdwa s[80:81], v21, v23 src0_sel:WORD_1 src1_sel:WORD_1
    v_cmp_ne_u32_sdwa vcc, v21, v25 src0_sel:WORD_1 src1_sel:WORD_1
    v_alignbyte_b32 v24, v25, v24, 2
    s_mov_b32 s54, 71677
    v_alignbyte_b32 v21, v21, v20, 1
    v_perm_b32 v20, v20, v24, s47
    s_waitcnt lgkmcnt(1)
    v_add3_u32 v26, v26, v106, s54
    v_sub_u32 v27, 0, v26
    v_and_b32 v27, 3, v27
    s_mov_b64 exec, s[80:81]
    v_mov_b32 v27, 0
    v_mov_b32 v22, 0
    s_mov_b64 exec, vcc
    v_mov_b32 v27, 3

    s_mov_b64 exec, -1
    v_alignbyte_b32 v20, v21, v20, v27
    v_alignbyte_b32 v21, v22, v21, v27
    v_add_u32 v26, v26, v27

    buffer_store_dwordx2 v[20:21], v26, s[24:27], 0 offen
    v_cmp_ne_u32_sdwa s[80:81], v29, v31 src0_sel:WORD_1 src1_sel:WORD_1
    v_cmp_ne_u32_sdwa vcc, v29, v33 src0_sel:WORD_1 src1_sel:WORD_1
    v_alignbyte_b32 v32, v33, v32, 2
    s_mov_b32 s54, 76797
    v_alignbyte_b32 v29, v29, v28, 1
    v_perm_b32 v28, v28, v32, s47
    s_waitcnt lgkmcnt(0)
    v_add3_u32 v34, v34, v106, s54
    v_sub_u32 v35, 0, v34
    v_and_b32 v35, 3, v35
    s_mov_b64 exec, s[80:81]
    v_mov_b32 v35, 0
    v_mov_b32 v30, 0
    s_mov_b64 exec, vcc
    v_mov_b32 v35, 3

    s_andn2_b64 exec, -1, s[68:69]
    v_bfrev_b32 v34, 1
    s_mov_b64 exec, -1
    v_alignbyte_b32 v28, v29, v28, v35
    v_alignbyte_b32 v29, v30, v29, v35
    v_add_u32 v34, v34, v35

    buffer_store_dwordx2 v[28:29], v34, s[24:27], 0 offen
L_skw_46:
L_p1done_1:
    s_endpgm

L_ska_8:
    v_bfrev_b32 v126, 1
    buffer_load_dword v3, v126, s[96:99], 0 offen
    buffer_load_dword v3, v126, s[96:99], 0 offen
    buffer_load_dword v3, v126, s[96:99], 0 offen
    s_branch L_bka_9
L_ska_10:
    v_bfrev_b32 v126, 1
    buffer_load_dword v3, v126, s[96:99], 0 offen
    buffer_load_dword v3, v126, s[96:99], 0 offen
    buffer_load_dword v3, v126, s[96:99], 0 offen
    s_branch L_bka_11
L_ska_12:
    v_bfrev_b32 v126, 1
    buffer_load_dword v3, v126, s[96:99], 0 offen
    buffer_load_dword v3, v126, s[96:99], 0 offen
    buffer_load_dword v3, v126, s[96:99], 0 offen
    s_branch L_bka_13
L_ska_14:
    v_bfrev_b32 v126, 1
    buffer_load_dword v3, v126, s[96:99], 0 offen
    buffer_load_dword v3, v126, s[96:99], 0 offen
    buffer_load_dword v3, v126, s[96:99], 0 offen
    s_branch L_bka_15
L_full_26:
    v_mov_b32 v110, 0
    s_mov_b64 exec, vcc
    v_bfrev_b32 v92, 1
    v_bfrev_b32 v93, 1
    s_mov_b64 exec, 1
    buffer_atomic_or v104, v110, s[36:39], 0 offen
    s_mov_b64 exec, -1
    s_branch L_fback_27

L_full_41:
    v_mov_b32 v110, 0
    s_mov_b64 exec, vcc
    v_bfrev_b32 v92, 1
    v_bfrev_b32 v93, 1
    s_mov_b64 exec, 1
    buffer_atomic_or v104, v110, s[36:39], 0 offen
    s_mov_b64 exec, -1
    s_branch L_fback_42

.globl standalone__molecular_angular_gemnet__graph_kernel
.p2align 8
.type standalone__molecular_angular_gemnet__graph_kernel,@function
standalone__molecular_angular_gemnet__graph_kernel:
    s_cmp_ge_u32 s2, 256
    s_cbranch_scc1 L_p2done_47
    s_load_dwordx2 s[8:9], s[0:1], 0
    s_load_dwordx2 s[6:7], s[0:1], 104
    v_lshrrev_b32 v4, 6, v0

    s_lshr_b32 s37, s2, 1
    s_and_b32 s37, s37, 3
    s_lshr_b32 s36, s2, 3
    s_lshl_b32 s36, s36, 1
    s_and_b32 s3, s2, 1
    s_or_b32 s36, s36, s3

    v_readfirstlane_b32 s4, v4
    v_and_b32 v2, 63, v0
    v_lshrrev_b32 v3, 9, v0
    v_lshl_or_b32 v2, v3, 6, v2
    v_mul_u32_u24 v2, 20, v2
    v_lshlrev_b32 v3, 4, v0

    s_waitcnt lgkmcnt(0)
    s_lshl_b32 m0, s4, 10
    s_and_b32 s5, s4, 7
    s_lshr_b32 s39, s4, 3
    s_lshl_b32 s39, s39, 8
    s_mul_i32 s3, s5, 4096
    s_add_u32 s46, s6, s3
    s_addc_u32 s47, s7, 0
    s_mul_i32 s3, s5, 67117056
    s_add_u32 s3, s3, 85721088
    s_add_u32 s44, s6, s3
    s_addc_u32 s45, s7, 0
    s_mul_i32 s38, s37, 8
    s_add_u32 s4, s38, 8
    s_lshl_b32 s3, s38, 6
    s_add_u32 s3, s3, s36
    s_lshr_b32 s3, s3, 1
    s_lshl_b32 s3, s3, 2
    s_add_u32 s52, s46, s3
    s_addc_u32 s53, s47, 0

    s_load_dword s88, s[52:53], 0
    s_load_dword s89, s[52:53], 128
    s_load_dword s90, s[52:53], 256
    s_load_dword s91, s[52:53], 384
    s_load_dword s92, s[52:53], 512
    s_load_dword s93, s[52:53], 640
    s_load_dword s94, s[52:53], 768
    s_load_dword s95, s[52:53], 896
    s_mov_b32 s3, 32768
    s_load_dword s51, s[6:7], s3
    s_mov_b32 s10, 6400000
    s_mov_b32 s11, 0x20000

    s_add_u32 s12, s6, 2490368
    s_addc_u32 s13, s7, 0
    s_mov_b32 s14, 0
    s_mov_b32 s15, 0x20000
    s_add_u32 s60, s6, 2490368
    s_addc_u32 s61, s7, 0
    s_mov_b32 s62, 6406144
    s_mov_b32 s63, 0x20000
    s_mov_b32 s3, 135176
    s_load_dword s33, s[6:7], s3

    s_mul_i32 s43, s38, 200192
    s_mul_i32 s41, s4, 200192
    s_mul_i32 s50, s38, 200000
    s_add_u32 s14, s43, 50000

    buffer_load_dwordx4 v[76:79], v3, s[12:15], s43 offen
    s_add_u32 s52, s43, 16384
    buffer_load_dwordx4 v[80:83], v3, s[12:15], s52 offen
    s_add_u32 s52, s43, 32768
    buffer_load_dwordx4 v[84:87], v3, s[12:15], s52 offen
    s_add_u32 s52, s43, 49152
    v_lshlrev_b32 v119, 2, v0
    buffer_load_dword v88, v119, s[12:15], s52 offen
    s_add_u32 s20, s6, 135168
    s_addc_u32 s21, s7, 0
    s_mov_b32 s22, 4096
    s_mov_b32 s23, 0x20000
    v_and_b32 v44, 63, v0
    v_lshlrev_b32 v44, 4, v44
    buffer_load_dwordx2 v[120:121], v44, s[20:23], 0 offen offset:0
    buffer_load_dwordx2 v[122:123], v44, s[20:23], 0 offen offset:1024
    buffer_load_dwordx2 v[124:125], v44, s[20:23], 0 offen offset:2048
    buffer_load_dwordx2 v[126:127], v44, s[20:23], 0 offen offset:3072
    s_movk_i32 s40, 3072
    s_mov_b32 s19, 0x20000
    s_min_u32 s40, s40, 6552
    s_lshl_b32 s52, s38, 6
    s_add_u32 s52, s52, s36
    s_mul_i32 s52, s52, 32764
    s_add_u32 s16, s44, s52
    s_addc_u32 s17, s45, 0
    s_mul_i32 s52, s40, 5
    s_add_u32 s52, s52, 3
    s_and_b32 s18, s52, -4

    s_movk_i32 s53, 5120
    buffer_load_dwordx4 v[90:93], v2, s[16:19], s53 offen
    buffer_load_dword v110, v2, s[16:19], s53 offen offset:16
    s_movk_i32 s53, 7680
    buffer_load_dwordx4 v[94:97], v2, s[16:19], s53 offen
    buffer_load_dword v111, v2, s[16:19], s53 offen offset:16
    s_movk_i32 s53, 10240
    buffer_load_dwordx4 v[98:101], v2, s[16:19], s53 offen
    buffer_load_dword v112, v2, s[16:19], s53 offen offset:16
    s_lshr_b32 s3, s2, 3
    s_mul_i32 s3, s3, 49
    v_add_lshl_u32 v89, v0, s3, 7
    v_cmp_gt_u32 vcc, 49, v0
    v_bfrev_b32 v28, 1
    s_nop 0
    v_cndmask_b32 v89, v28, v89, vcc

    s_mov_b32 s19, 0x20000
    s_mov_b32 s28, 0x4b404000
    s_mov_b32 s29, 0x4b404000
    s_mov_b32 s30, 0xbfffc000
    s_mov_b32 s31, 0xbfffbfff
    s_mov_b32 s32, 0xffff0000
    s_mov_b32 s35, 0x05040100
    s_mov_b32 s97, 0x07060302
    s_mov_b32 s96, 0x40008000
    s_movk_i32 s3, 212
    v_cmp_gt_u32 s[48:49], s3, v0

    v_mov_b32 v1, 0
    s_mov_b32 s24, 0xc0c0004
    s_mov_b32 s25, 0xc0c0105
    s_mov_b32 s26, 0xc0c0206
    s_mov_b32 s27, 0xc0c0307
    v_mov_b32 v28, 0x40004000
    v_mov_b32 v29, 0x40004000
    v_mov_b32 v30, 0x40004000
    v_mov_b32 v31, 0x40004000
    v_add_u32 v32, 50000, v3
    v_add_u32 v33, 65536, v32

    ds_write_b128 v32, v[28:31] offset:0
    ds_write_b128 v32, v[28:31] offset:16384
    ds_write_b128 v32, v[28:31] offset:32768
    ds_write_b128 v32, v[28:31] offset:49152
    ds_write_b128 v33, v[28:31] offset:0
    ds_write_b128 v33, v[28:31] offset:16384
    v_cmp_gt_u32 vcc, 971, v0
    s_mov_b64 exec, vcc
    ds_write_b128 v33, v[28:31] offset:32768
    s_mov_b64 exec, -1
    s_waitcnt vmcnt(13)
    ds_write_addtid_b32 v76 offset:0
    ds_write_addtid_b32 v77 offset:256
    ds_write_addtid_b32 v78 offset:512
    ds_write_addtid_b32 v79 offset:768
    s_waitcnt vmcnt(12)
    ds_write_addtid_b32 v80 offset:16384
    ds_write_addtid_b32 v81 offset:16640
    ds_write_addtid_b32 v82 offset:16896
    ds_write_addtid_b32 v83 offset:17152
    s_waitcnt vmcnt(11)
    ds_write_addtid_b32 v84 offset:32768
    ds_write_addtid_b32 v85 offset:33024
    ds_write_addtid_b32 v86 offset:33280
    ds_write_addtid_b32 v87 offset:33536
    v_lshlrev_b32 v119, 2, v0
    s_waitcnt vmcnt(10)
    s_mov_b64 exec, s[48:49]
    ds_write_b32 v119, v88 offset:49152
    s_mov_b64 exec, -1
    s_add_u32 s43, s43, 50048
    s_add_u32 s14, s43, 50000
    s_min_u32 s14, s14, s41
    s_and_b32 s3, s36, 1
    s_lshl_b32 s3, s3, 4
    s_or_b32 s3, s3, 0x100000
    s_waitcnt lgkmcnt(0)

    s_bfe_u32 s88, s88, s3
    s_bfe_u32 s89, s89, s3
    s_bfe_u32 s90, s90, s3
    s_bfe_u32 s91, s91, s3
    s_bfe_u32 s92, s92, s3
    s_bfe_u32 s93, s93, s3
    s_bfe_u32 s94, s94, s3
    s_bfe_u32 s95, s95, s3
    s_waitcnt vmcnt(6)
    v_max3_u32 v120, v120, v122, v124
    v_add_f32 v121, v121, v123
    v_add_f32 v125, v125, v127
    v_max_u32 v120, v120, v126
    v_add_f32 v121, v121, v125

    s_nop 1
    v_max_u32_dpp v120, v120, v120 row_shr:1 row_mask:0xf bank_mask:0xf
    s_nop 1
    v_max_u32_dpp v120, v120, v120 row_shr:2 row_mask:0xf bank_mask:0xf
    s_nop 1
    v_max_u32_dpp v120, v120, v120 row_shr:4 row_mask:0xf bank_mask:0xf
    s_nop 1
    v_max_u32_dpp v120, v120, v120 row_shr:8 row_mask:0xf bank_mask:0xf
    s_nop 1
    v_max_u32_dpp v120, v120, v120 row_bcast:15 row_mask:0xa bank_mask:0xf
    s_nop 1
    v_max_u32_dpp v120, v120, v120 row_bcast:31 row_mask:0xc bank_mask:0xf
    s_nop 1
    v_add_f32_dpp v121, v121, v121 row_shr:1 row_mask:0xf bank_mask:0xf
    s_nop 1
    v_add_f32_dpp v121, v121, v121 row_shr:2 row_mask:0xf bank_mask:0xf
    s_nop 1
    v_add_f32_dpp v121, v121, v121 row_shr:4 row_mask:0xf bank_mask:0xf
    s_nop 1
    v_add_f32_dpp v121, v121, v121 row_shr:8 row_mask:0xf bank_mask:0xf
    s_nop 1
    v_add_f32_dpp v121, v121, v121 row_bcast:15 row_mask:0xa bank_mask:0xf
    s_nop 1
    v_add_f32_dpp v121, v121, v121 row_bcast:31 row_mask:0xc bank_mask:0xf
    v_lshlrev_b32 v120, 16, v120
    v_mul_f32 v121, 0x34a7c5ac, v121
    v_sqrt_f32 v121, v121
    v_mul_f32 v120, s33, v120
    v_mul_f32 v121, s33, v121
    v_cmp_gt_f32 vcc, 0x46fde800, v120
    s_mov_b64 s[64:65], vcc
    v_cmp_lt_f32 vcc, 0x44000000, v121
    v_mov_b32 v120, 0x37800000
    v_mul_f32 v120, s33, v120
    s_and_b64 vcc, vcc, s[64:65]
    v_mul_f32 v121, 0x46ff8000, v120
    v_rcp_f32 v121, v121
    v_readfirstlane_b32 s33, v120
    s_waitcnt lgkmcnt(0)
    s_barrier
    v_readfirstlane_b32 s34, v121
    v_mov_b32 v120, 150016
    v_mov_b32 v121, 0
    ds_write_b32 v120, v121 offset:8
    s_bitcmp0_b64 vcc, 63
    s_cbranch_scc1 L_p2slow_48
    s_cmp_lg_u32 s51, 0
    s_cbranch_scc1 L_p2slow_48

    s_min_u32 s88, s88, 6552
    s_lshl_b32 s52, s38, 6
    s_add_u32 s52, s52, s36
    s_mul_i32 s52, s52, 32764
    s_add_u32 s16, s44, s52
    s_addc_u32 s17, s45, 0
    s_mul_i32 s52, s88, 5
    s_add_u32 s52, s52, 3
    s_and_b32 s18, s52, -4

    s_movk_i32 s53, 12800
    buffer_load_dwordx4 v[102:105], v2, s[16:19], s53 offen
    buffer_load_dword v113, v2, s[16:19], s53 offen offset:16
    s_movk_i32 s53, 0
    buffer_load_dwordx4 v[4:7], v2, s[16:19], s53 offen nt
    buffer_load_dword v35, v2, s[16:19], s53 offen offset:16 nt
    s_movk_i32 s53, 2560
    buffer_load_dwordx4 v[8:11], v2, s[16:19], s53 offen
    buffer_load_dword v43, v2, s[16:19], s53 offen offset:16
    s_movk_i32 s53, 15360
    buffer_load_dwordx4 v[106:109], v2, s[16:19], s53 offen
    buffer_load_dword v114, v2, s[16:19], s53 offen offset:16
    s_mov_b32 s40, s88
    s_sub_u32 s42, s40, s39

    s_add_u32 s55, s38, 1
    s_min_u32 s55, s55, 31
    s_mov_b32 s88, s89
    s_mov_b32 s89, s90
    s_mov_b32 s90, s91
    s_mov_b32 s91, s92
    s_mov_b32 s92, s93
    s_mov_b32 s93, s94
    s_mov_b32 s94, s95
    s_mov_b32 s95, 0
    s_min_u32 s88, s88, 6552
    s_lshl_b32 s52, s55, 6
    s_add_u32 s52, s52, s36
    s_mul_i32 s52, s52, 32764
    s_add_u32 s16, s44, s52
    s_addc_u32 s17, s45, 0
    s_mul_i32 s52, s88, 5
    s_add_u32 s52, s52, 3
    s_and_b32 s18, s52, -4

    s_waitcnt vmcnt(12)
    v_perm_b32 v44, v91, v90, s24
    v_perm_b32 v46, v92, v91, s25
    v_perm_b32 v48, v93, v92, s26
    v_perm_b32 v50, v110, v93, s27
    v_mov_b32 v12, v90
    v_alignbyte_b32 v13, v92, v91, 1
    v_alignbyte_b32 v14, v93, v92, 2
    v_alignbyte_b32 v15, v110, v93, 3
    v_lshlrev_b32_sdwa v44, 3, v44 dst_sel:WORD_0 dst_unused:UNUSED_PAD src0_sel:DWORD src1_sel:DWORD
    v_lshlrev_b32_sdwa v46, 3, v46 dst_sel:WORD_0 dst_unused:UNUSED_PAD src0_sel:DWORD src1_sel:DWORD
    v_lshlrev_b32_sdwa v48, 3, v48 dst_sel:WORD_0 dst_unused:UNUSED_PAD src0_sel:DWORD src1_sel:DWORD
    v_lshlrev_b32_sdwa v50, 3, v50 dst_sel:WORD_0 dst_unused:UNUSED_PAD src0_sel:DWORD src1_sel:DWORD
    s_cmp_lt_i32 s42, 1280
    s_cbranch_scc1 L_ufix_49
L_uback_50:

    v_subrev_co_u32 v12, s[80:81], 2.0, v12
    v_subrev_co_u32 v13, s[82:83], 2.0, v13
    v_subrev_co_u32 v14, s[84:85], 2.0, v14
    v_subrev_co_u32 v15, s[86:87], 2.0, v15
    s_mov_b64 exec, s[80:81]
    ds_read_b64 v[44:45], v44
    s_mov_b64 exec, s[82:83]
    ds_read_b64 v[46:47], v46
    s_mov_b64 exec, s[84:85]
    ds_read_b64 v[48:49], v48
    s_mov_b64 exec, s[86:87]
    ds_read_b64 v[50:51], v50
    s_mov_b64 exec, -1
    s_waitcnt vmcnt(10)
    v_perm_b32 v52, v95, v94, s24
    v_perm_b32 v54, v96, v95, s25
    v_perm_b32 v56, v97, v96, s26
    v_perm_b32 v58, v111, v97, s27
    v_mov_b32 v16, v94
    v_alignbyte_b32 v17, v96, v95, 1
    v_alignbyte_b32 v18, v97, v96, 2
    v_alignbyte_b32 v19, v111, v97, 3
    v_lshlrev_b32_sdwa v52, 3, v52 dst_sel:WORD_0 dst_unused:UNUSED_PAD src0_sel:DWORD src1_sel:DWORD
    v_lshlrev_b32_sdwa v54, 3, v54 dst_sel:WORD_0 dst_unused:UNUSED_PAD src0_sel:DWORD src1_sel:DWORD
    v_lshlrev_b32_sdwa v56, 3, v56 dst_sel:WORD_0 dst_unused:UNUSED_PAD src0_sel:DWORD src1_sel:DWORD
    v_lshlrev_b32_sdwa v58, 3, v58 dst_sel:WORD_0 dst_unused:UNUSED_PAD src0_sel:DWORD src1_sel:DWORD
    s_cmp_lt_i32 s42, 1792
    s_cbranch_scc1 L_ufix_51
L_uback_52:

    v_subrev_co_u32 v16, s[64:65], 2.0, v16
    v_subrev_co_u32 v17, s[66:67], 2.0, v17
    v_subrev_co_u32 v18, s[68:69], 2.0, v18
    v_subrev_co_u32 v19, s[70:71], 2.0, v19
    s_mov_b64 exec, s[64:65]
    ds_read_b64 v[52:53], v52
    s_mov_b64 exec, s[66:67]
    ds_read_b64 v[54:55], v54
    s_mov_b64 exec, s[68:69]
    ds_read_b64 v[56:57], v56
    s_mov_b64 exec, s[70:71]
    ds_read_b64 v[58:59], v58
    s_mov_b64 exec, -1
    s_waitcnt vmcnt(8)
    v_perm_b32 v60, v99, v98, s24
    v_perm_b32 v62, v100, v99, s25
    v_perm_b32 v64, v101, v100, s26
    v_perm_b32 v66, v112, v101, s27
    v_mov_b32 v20, v98
    v_alignbyte_b32 v21, v100, v99, 1
    v_alignbyte_b32 v22, v101, v100, 2
    v_alignbyte_b32 v23, v112, v101, 3
    v_lshlrev_b32_sdwa v60, 3, v60 dst_sel:WORD_0 dst_unused:UNUSED_PAD src0_sel:DWORD src1_sel:DWORD
    v_lshlrev_b32_sdwa v62, 3, v62 dst_sel:WORD_0 dst_unused:UNUSED_PAD src0_sel:DWORD src1_sel:DWORD
    v_lshlrev_b32_sdwa v64, 3, v64 dst_sel:WORD_0 dst_unused:UNUSED_PAD src0_sel:DWORD src1_sel:DWORD
    v_lshlrev_b32_sdwa v66, 3, v66 dst_sel:WORD_0 dst_unused:UNUSED_PAD src0_sel:DWORD src1_sel:DWORD
    s_cmp_lt_i32 s42, 2304
    s_cbranch_scc1 L_ufix_53
L_uback_54:

    v_subrev_co_u32 v20, s[72:73], 2.0, v20
    v_subrev_co_u32 v21, s[74:75], 2.0, v21
    v_subrev_co_u32 v22, s[76:77], 2.0, v22
    v_subrev_co_u32 v23, s[78:79], 2.0, v23
    s_mov_b64 exec, s[72:73]
    ds_read_b64 v[60:61], v60
    s_mov_b64 exec, s[74:75]
    ds_read_b64 v[62:63], v62
    s_mov_b64 exec, s[76:77]
    ds_read_b64 v[64:65], v64
    s_mov_b64 exec, s[78:79]
    ds_read_b64 v[66:67], v66
    s_mov_b64 exec, -1
    s_waitcnt vmcnt(6)
    v_perm_b32 v68, v103, v102, s24
    v_perm_b32 v70, v104, v103, s25
    v_perm_b32 v72, v105, v104, s26
    v_perm_b32 v74, v113, v105, s27
    v_mov_b32 v24, v102
    v_alignbyte_b32 v25, v104, v103, 1
    v_alignbyte_b32 v26, v105, v104, 2
    v_alignbyte_b32 v27, v113, v105, 3
    v_lshlrev_b32_sdwa v68, 3, v68 dst_sel:WORD_0 dst_unused:UNUSED_PAD src0_sel:DWORD src1_sel:DWORD
    v_lshlrev_b32_sdwa v70, 3, v70 dst_sel:WORD_0 dst_unused:UNUSED_PAD src0_sel:DWORD src1_sel:DWORD
    v_lshlrev_b32_sdwa v72, 3, v72 dst_sel:WORD_0 dst_unused:UNUSED_PAD src0_sel:DWORD src1_sel:DWORD
    v_lshlrev_b32_sdwa v74, 3, v74 dst_sel:WORD_0 dst_unused:UNUSED_PAD src0_sel:DWORD src1_sel:DWORD
    s_cmp_lt_i32 s42, 2816
    s_cbranch_scc1 L_ufix_55
L_uback_56:

    v_subrev_co_u32 v24, s[80:81], 2.0, v24
    v_subrev_co_u32 v25, s[82:83], 2.0, v25
    v_subrev_co_u32 v26, s[84:85], 2.0, v26
    v_subrev_co_u32 v27, s[86:87], 2.0, v27
    s_mov_b64 exec, s[80:81]
    ds_read_b64 v[68:69], v68
    s_mov_b64 exec, s[82:83]
    ds_read_b64 v[70:71], v70
    s_mov_b64 exec, s[84:85]
    ds_read_b64 v[72:73], v72
    s_mov_b64 exec, s[86:87]
    ds_read_b64 v[74:75], v74
    s_mov_b64 exec, -1
    s_waitcnt vmcnt(4)
    v_perm_b32 v28, v5, v4, s24
    v_perm_b32 v30, v6, v5, s25
    v_perm_b32 v32, v7, v6, s26
    v_perm_b32 v34, v35, v7, s27
    v_alignbyte_b32 v5, v6, v5, 1
    v_alignbyte_b32 v6, v7, v6, 2
    v_alignbyte_b32 v7, v35, v7, 3
    v_lshlrev_b32_sdwa v28, 3, v28 dst_sel:WORD_0 dst_unused:UNUSED_PAD src0_sel:DWORD src1_sel:DWORD
    v_lshlrev_b32_sdwa v30, 3, v30 dst_sel:WORD_0 dst_unused:UNUSED_PAD src0_sel:DWORD src1_sel:DWORD
    v_lshlrev_b32_sdwa v32, 3, v32 dst_sel:WORD_0 dst_unused:UNUSED_PAD src0_sel:DWORD src1_sel:DWORD
    v_lshlrev_b32_sdwa v34, 3, v34 dst_sel:WORD_0 dst_unused:UNUSED_PAD src0_sel:DWORD src1_sel:DWORD
    s_cmp_lt_i32 s42, 256
    s_cbranch_scc1 L_ufix_57
L_uback_58:

    v_subrev_co_u32 v4, s[64:65], 2.0, v4
    v_subrev_co_u32 v5, s[66:67], 2.0, v5
    v_subrev_co_u32 v6, s[68:69], 2.0, v6
    v_subrev_co_u32 v7, s[70:71], 2.0, v7
    s_mov_b64 exec, s[64:65]
    ds_read_b64 v[28:29], v28
    s_mov_b64 exec, s[66:67]
    ds_read_b64 v[30:31], v30
    s_mov_b64 exec, s[68:69]
    ds_read_b64 v[32:33], v32
    s_mov_b64 exec, s[70:71]
    ds_read_b64 v[34:35], v34
    s_mov_b64 exec, -1
    buffer_load_dwordx4 v[76:79], v3, s[12:15], s43 offen
    s_add_u32 s52, s43, 16384
    buffer_load_dwordx4 v[80:83], v3, s[12:15], s52 offen
    s_add_u32 s52, s43, 32768
    buffer_load_dwordx4 v[84:87], v3, s[12:15], s52 offen
    s_add_u32 s52, s43, 49152
    v_lshlrev_b32 v119, 2, v0
    buffer_load_dword v88, v119, s[12:15], s52 offen
    s_add_u32 s54, s43, 50048
    buffer_load_dword v115, v89, s[60:63], s54 offen
    s_add_u32 s54, s50, 0
    buffer_load_dword v115, v89, s[8:11], s54 offen
    s_waitcnt vmcnt(8)
    v_perm_b32 v36, v9, v8, s24
    v_perm_b32 v38, v10, v9, s25
    v_perm_b32 v40, v11, v10, s26
    v_perm_b32 v42, v43, v11, s27
    v_alignbyte_b32 v9, v10, v9, 1
    v_alignbyte_b32 v10, v11, v10, 2
    v_alignbyte_b32 v11, v43, v11, 3
    v_lshlrev_b32_sdwa v36, 3, v36 dst_sel:WORD_0 dst_unused:UNUSED_PAD src0_sel:DWORD src1_sel:DWORD
    v_lshlrev_b32_sdwa v38, 3, v38 dst_sel:WORD_0 dst_unused:UNUSED_PAD src0_sel:DWORD src1_sel:DWORD
    v_lshlrev_b32_sdwa v40, 3, v40 dst_sel:WORD_0 dst_unused:UNUSED_PAD src0_sel:DWORD src1_sel:DWORD
    v_lshlrev_b32_sdwa v42, 3, v42 dst_sel:WORD_0 dst_unused:UNUSED_PAD src0_sel:DWORD src1_sel:DWORD
    s_cmp_lt_i32 s42, 768
    s_cbranch_scc1 L_ufix_59
L_uback_60:

    v_subrev_co_u32 v8, s[72:73], 2.0, v8
    v_subrev_co_u32 v9, s[74:75], 2.0, v9
    v_subrev_co_u32 v10, s[76:77], 2.0, v10
    v_subrev_co_u32 v11, s[78:79], 2.0, v11
    s_mov_b64 exec, s[72:73]
    ds_read_b64 v[36:37], v36
    s_mov_b64 exec, s[74:75]
    ds_read_b64 v[38:39], v38
    s_mov_b64 exec, s[76:77]
    ds_read_b64 v[40:41], v40
    s_mov_b64 exec, s[78:79]
    ds_read_b64 v[42:43], v42
    s_mov_b64 exec, -1
    s_movk_i32 s53, 5120
    buffer_load_dwordx4 v[90:93], v2, s[16:19], s53 offen
    buffer_load_dword v110, v2, s[16:19], s53 offen offset:16
L_batch_61:
    s_add_u32 s5, s38, 1

    s_movk_i32 s53, 7680
    buffer_load_dwordx4 v[94:97], v2, s[16:19], s53 offen
    buffer_load_dword v111, v2, s[16:19], s53 offen offset:16
    v_subrev_co_u32 v4, s[64:65], 2.0, v4
    v_subrev_co_u32 v5, s[66:67], 2.0, v5
    v_subrev_co_u32 v6, s[68:69], 2.0, v6
    v_subrev_co_u32 v7, s[70:71], 2.0, v7
    v_subrev_co_u32 v8, s[72:73], 2.0, v8
    v_subrev_co_u32 v9, s[74:75], 2.0, v9
    v_subrev_co_u32 v10, s[76:77], 2.0, v10
    v_subrev_co_u32 v11, s[78:79], 2.0, v11
    v_subrev_co_u32 v12, s[80:81], 2.0, v12
    v_subrev_co_u32 v13, s[82:83], 2.0, v13
    v_subrev_co_u32 v14, s[84:85], 2.0, v14
    v_subrev_co_u32 v15, s[86:87], 2.0, v15
    s_waitcnt lgkmcnt(0)
    s_barrier
    s_waitcnt vmcnt(7)
    ds_write_addtid_b32 v76 offset:0
    ds_write_addtid_b32 v77 offset:256
    ds_write_addtid_b32 v78 offset:512
    ds_write_addtid_b32 v79 offset:768
    s_waitcnt vmcnt(6)
    ds_write_addtid_b32 v80 offset:16384
    ds_write_addtid_b32 v81 offset:16640
    ds_write_addtid_b32 v82 offset:16896
    ds_write_addtid_b32 v83 offset:17152
    s_waitcnt vmcnt(5)
    ds_write_addtid_b32 v84 offset:32768
    ds_write_addtid_b32 v85 offset:33024
    ds_write_addtid_b32 v86 offset:33280
    ds_write_addtid_b32 v87 offset:33536
    v_lshlrev_b32 v119, 2, v0
    s_waitcnt vmcnt(4)
    s_mov_b64 exec, s[48:49]
    ds_write_b32 v119, v88 offset:49152
    s_mov_b64 exec, -1
    s_add_u32 s43, s43, 50048
    s_add_u32 s14, s43, 50000
    s_min_u32 s14, s14, s41
    buffer_load_dwordx4 v[76:79], v3, s[12:15], s43 offen
    s_waitcnt lgkmcnt(0)
    s_barrier
    s_add_u32 s52, s43, 16384
    buffer_load_dwordx4 v[80:83], v3, s[12:15], s52 offen
    s_add_u32 s52, s43, 32768
    buffer_load_dwordx4 v[84:87], v3, s[12:15], s52 offen
    s_add_u32 s52, s43, 49152
    v_lshlrev_b32 v119, 2, v0
    buffer_load_dword v88, v119, s[12:15], s52 offen
    s_mov_b64 exec, s[64:65]
    ds_read_b64 v[28:29], v28
    s_mov_b64 exec, s[66:67]
    ds_read_b64 v[30:31], v30
    s_mov_b64 exec, s[68:69]
    ds_read_b64 v[32:33], v32
    s_mov_b64 exec, s[70:71]
    ds_read_b64 v[34:35], v34
    s_mov_b64 exec, s[72:73]
    ds_read_b64 v[36:37], v36
    s_mov_b64 exec, s[74:75]
    ds_read_b64 v[38:39], v38
    s_mov_b64 exec, s[76:77]
    ds_read_b64 v[40:41], v40
    s_mov_b64 exec, s[78:79]
    ds_read_b64 v[42:43], v42
    s_mov_b64 exec, s[80:81]
    ds_read_b64 v[44:45], v44
    s_mov_b64 exec, s[82:83]
    ds_read_b64 v[46:47], v46
    s_mov_b64 exec, s[84:85]
    ds_read_b64 v[48:49], v48
    s_mov_b64 exec, s[86:87]
    ds_read_b64 v[50:51], v50
    s_mov_b64 exec, -1
    v_subrev_co_u32 v16, s[64:65], 2.0, v16
    v_subrev_co_u32 v17, s[66:67], 2.0, v17
    v_subrev_co_u32 v18, s[68:69], 2.0, v18
    v_subrev_co_u32 v19, s[70:71], 2.0, v19
    v_subrev_co_u32 v20, s[72:73], 2.0, v20
    v_subrev_co_u32 v21, s[74:75], 2.0, v21
    v_subrev_co_u32 v22, s[76:77], 2.0, v22
    v_subrev_co_u32 v23, s[78:79], 2.0, v23
    v_subrev_co_u32 v24, s[80:81], 2.0, v24
    v_subrev_co_u32 v25, s[82:83], 2.0, v25
    v_subrev_co_u32 v26, s[84:85], 2.0, v26
    v_subrev_co_u32 v27, s[86:87], 2.0, v27
    s_mov_b64 exec, s[64:65]
    ds_read_b64 v[52:53], v52
    s_mov_b64 exec, s[66:67]
    ds_read_b64 v[54:55], v54
    s_mov_b64 exec, s[68:69]
    ds_read_b64 v[56:57], v56
    s_mov_b64 exec, s[70:71]
    ds_read_b64 v[58:59], v58
    s_mov_b64 exec, s[72:73]
    ds_read_b64 v[60:61], v60
    s_mov_b64 exec, s[74:75]
    ds_read_b64 v[62:63], v62
    s_mov_b64 exec, s[76:77]
    ds_read_b64 v[64:65], v64
    s_mov_b64 exec, s[78:79]
    ds_read_b64 v[66:67], v66
    s_mov_b64 exec, s[80:81]
    ds_read_b64 v[68:69], v68
    s_mov_b64 exec, s[82:83]
    ds_read_b64 v[70:71], v70
    s_mov_b64 exec, s[84:85]
    ds_read_b64 v[72:73], v72
    s_mov_b64 exec, s[86:87]
    ds_read_b64 v[74:75], v74
    s_mov_b64 exec, -1
    s_cmp_le_i32 s42, 3072
    s_cbranch_scc1 L_nt1_63
    s_waitcnt vmcnt(14)
    v_perm_b32 v120, v107, v106, s24
    v_perm_b32 v122, v108, v107, s25
    v_perm_b32 v124, v109, v108, s26
    v_perm_b32 v126, v114, v109, s27
    v_alignbyte_b32 v107, v108, v107, 1
    v_alignbyte_b32 v108, v109, v108, 2
    v_alignbyte_b32 v109, v114, v109, 3
    v_lshlrev_b32_sdwa v120, 3, v120 dst_sel:WORD_0 dst_unused:UNUSED_PAD src0_sel:DWORD src1_sel:DWORD
    v_lshlrev_b32_sdwa v122, 3, v122 dst_sel:WORD_0 dst_unused:UNUSED_PAD src0_sel:DWORD src1_sel:DWORD
    v_lshlrev_b32_sdwa v124, 3, v124 dst_sel:WORD_0 dst_unused:UNUSED_PAD src0_sel:DWORD src1_sel:DWORD
    v_lshlrev_b32_sdwa v126, 3, v126 dst_sel:WORD_0 dst_unused:UNUSED_PAD src0_sel:DWORD src1_sel:DWORD
    s_cmp_lt_i32 s42, 3328
    s_cbranch_scc1 L_ufix_66
L_uback_67:

    v_lshrrev_b32 v117, 30, v106
    v_and_b32 v106, 0x3fffffff, v106
    v_mul_u32_u24 v117, 50000, v117
    v_cmp_ne_u32 vcc, 0, v106
    v_add_u32 v120, v120, v117
    s_mov_b64 exec, vcc

    buffer_load_dwordx2 v[120:121], v120, s[8:11], s50 offen
    s_mov_b64 exec, -1
    v_lshrrev_b32 v117, 30, v107
    v_and_b32 v107, 0x3fffffff, v107
    v_mul_u32_u24 v117, 50000, v117
    v_cmp_ne_u32 vcc, 0, v107
    v_add_u32 v122, v122, v117
    s_mov_b64 exec, vcc

    buffer_load_dwordx2 v[122:123], v122, s[8:11], s50 offen
    s_mov_b64 exec, -1
    v_lshrrev_b32 v117, 30, v108
    v_and_b32 v108, 0x3fffffff, v108
    v_mul_u32_u24 v117, 50000, v117
    v_cmp_ne_u32 vcc, 0, v108
    v_add_u32 v124, v124, v117
    s_mov_b64 exec, vcc

    buffer_load_dwordx2 v[124:125], v124, s[8:11], s50 offen
    s_mov_b64 exec, -1
    v_lshrrev_b32 v117, 30, v109
    v_and_b32 v109, 0x3fffffff, v109
    v_mul_u32_u24 v117, 50000, v117
    v_cmp_ne_u32 vcc, 0, v109
    v_add_u32 v126, v126, v117
    s_mov_b64 exec, vcc

    buffer_load_dwordx2 v[126:127], v126, s[8:11], s50 offen
    s_mov_b64 exec, -1
L_nt1_63:
    v_subrev_co_u32 v4, s[64:65], 2.0, v4
    v_subrev_co_u32 v5, s[66:67], 2.0, v5
    v_subrev_co_u32 v6, s[68:69], 2.0, v6
    v_subrev_co_u32 v7, s[70:71], 2.0, v7
    v_subrev_co_u32 v8, s[72:73], 2.0, v8
    v_subrev_co_u32 v9, s[74:75], 2.0, v9
    v_subrev_co_u32 v10, s[76:77], 2.0, v10
    v_subrev_co_u32 v11, s[78:79], 2.0, v11
    v_subrev_co_u32 v12, s[80:81], 2.0, v12
    v_subrev_co_u32 v13, s[82:83], 2.0, v13
    v_subrev_co_u32 v14, s[84:85], 2.0, v14
    v_subrev_co_u32 v15, s[86:87], 2.0, v15
    s_waitcnt lgkmcnt(0)
    s_barrier
    s_waitcnt vmcnt(3)
    ds_write_addtid_b32 v76 offset:0
    ds_write_addtid_b32 v77 offset:256
    ds_write_addtid_b32 v78 offset:512
    ds_write_addtid_b32 v79 offset:768
    s_waitcnt vmcnt(2)
    ds_write_addtid_b32 v80 offset:16384
    ds_write_addtid_b32 v81 offset:16640
    ds_write_addtid_b32 v82 offset:16896
    ds_write_addtid_b32 v83 offset:17152
    s_waitcnt vmcnt(1)
    ds_write_addtid_b32 v84 offset:32768
    ds_write_addtid_b32 v85 offset:33024
    ds_write_addtid_b32 v86 offset:33280
    ds_write_addtid_b32 v87 offset:33536
    v_lshlrev_b32 v119, 2, v0
    s_waitcnt vmcnt(0)
    s_mov_b64 exec, s[48:49]
    ds_write_b32 v119, v88 offset:49152
    s_mov_b64 exec, -1
    s_add_u32 s43, s43, 50048
    s_add_u32 s14, s43, 50000
    s_min_u32 s14, s14, s41
    buffer_load_dwordx4 v[76:79], v3, s[12:15], s43 offen
    s_waitcnt lgkmcnt(0)
    s_barrier
    s_add_u32 s52, s43, 16384
    buffer_load_dwordx4 v[80:83], v3, s[12:15], s52 offen
    s_add_u32 s52, s43, 32768
    buffer_load_dwordx4 v[84:87], v3, s[12:15], s52 offen
    s_add_u32 s52, s43, 49152
    v_lshlrev_b32 v119, 2, v0
    buffer_load_dword v88, v119, s[12:15], s52 offen
    s_mov_b64 exec, s[64:65]
    ds_read_b64 v[28:29], v28
    s_mov_b64 exec, s[66:67]
    ds_read_b64 v[30:31], v30
    s_mov_b64 exec, s[68:69]
    ds_read_b64 v[32:33], v32
    s_mov_b64 exec, s[70:71]
    ds_read_b64 v[34:35], v34
    s_mov_b64 exec, s[72:73]
    ds_read_b64 v[36:37], v36
    s_mov_b64 exec, s[74:75]
    ds_read_b64 v[38:39], v38
    s_mov_b64 exec, s[76:77]
    ds_read_b64 v[40:41], v40
    s_mov_b64 exec, s[78:79]
    ds_read_b64 v[42:43], v42
    s_mov_b64 exec, s[80:81]
    ds_read_b64 v[44:45], v44
    s_mov_b64 exec, s[82:83]
    ds_read_b64 v[46:47], v46
    s_mov_b64 exec, s[84:85]
    ds_read_b64 v[48:49], v48
    s_mov_b64 exec, s[86:87]
    ds_read_b64 v[50:51], v50
    s_mov_b64 exec, -1
    v_subrev_co_u32 v16, s[64:65], 2.0, v16
    v_subrev_co_u32 v17, s[66:67], 2.0, v17
    v_subrev_co_u32 v18, s[68:69], 2.0, v18
    v_subrev_co_u32 v19, s[70:71], 2.0, v19
    v_subrev_co_u32 v20, s[72:73], 2.0, v20
    v_subrev_co_u32 v21, s[74:75], 2.0, v21
    v_subrev_co_u32 v22, s[76:77], 2.0, v22
    v_subrev_co_u32 v23, s[78:79], 2.0, v23
    v_subrev_co_u32 v24, s[80:81], 2.0, v24
    v_subrev_co_u32 v25, s[82:83], 2.0, v25
    v_subrev_co_u32 v26, s[84:85], 2.0, v26
    v_subrev_co_u32 v27, s[86:87], 2.0, v27
    s_mov_b64 exec, s[64:65]
    ds_read_b64 v[52:53], v52
    s_mov_b64 exec, s[66:67]
    ds_read_b64 v[54:55], v54
    s_mov_b64 exec, s[68:69]
    ds_read_b64 v[56:57], v56
    s_mov_b64 exec, s[70:71]
    ds_read_b64 v[58:59], v58
    s_mov_b64 exec, s[72:73]
    ds_read_b64 v[60:61], v60
    s_mov_b64 exec, s[74:75]
    ds_read_b64 v[62:63], v62
    s_mov_b64 exec, s[76:77]
    ds_read_b64 v[64:65], v64
    s_mov_b64 exec, s[78:79]
    ds_read_b64 v[66:67], v66
    s_mov_b64 exec, s[80:81]
    ds_read_b64 v[68:69], v68
    s_mov_b64 exec, s[82:83]
    ds_read_b64 v[70:71], v70
    s_mov_b64 exec, s[84:85]
    ds_read_b64 v[72:73], v72
    s_mov_b64 exec, s[86:87]
    ds_read_b64 v[74:75], v74
    s_mov_b64 exec, -1
    s_movk_i32 s53, 10240
    buffer_load_dwordx4 v[98:101], v2, s[16:19], s53 offen
    buffer_load_dword v112, v2, s[16:19], s53 offen offset:16
    s_movk_i32 s53, 12800
    buffer_load_dwordx4 v[102:105], v2, s[16:19], s53 offen
    buffer_load_dword v113, v2, s[16:19], s53 offen offset:16
    s_cmp_le_i32 s42, 3072
    s_cbranch_scc1 L_nt2_64
    s_waitcnt vmcnt(8)
    v_cmp_ne_u32 s[56:57], 0, v106
    v_cmp_ne_u32 s[58:59], 0, v107
    v_cmp_ne_u32 s[98:99], 0, v108
    v_cmp_ne_u32 vcc, 0, v109
    s_mov_b64 exec, s[56:57]
    v_cvt_f32_i32_sdwa v118, sext(v106) dst_sel:DWORD dst_unused:UNUSED_PAD src0_sel:WORD_0
    v_lshlrev_b32 v116, 16, v120
    v_and_b32 v117, s32, v120
    v_mul_f32 v118, s33, v118
    v_lshlrev_b32 v120, 16, v121
    v_and_b32 v121, s32, v121
    v_lshlrev_b32_sdwa v106, 3, v106 dst_sel:DWORD dst_unused:UNUSED_PAD src0_sel:DWORD src1_sel:WORD_1
    v_pk_fma_f32 v[116:117], v[116:117], v[118:119], s[28:29] op_sel_hi:[1,0,1]
    v_pk_fma_f32 v[120:121], v[120:121], v[118:119], s[28:29] op_sel_hi:[1,0,1]
    v_perm_b32 v116, v117, v116, s35
    v_perm_b32 v117, v121, v120, s35
    v_lshl_add_u64 v[116:117], v[116:117], 0, s[30:31]
    ds_add_rtn_u64 v[120:121], v106, v[116:117] offset:50000

    s_mov_b64 exec, s[58:59]
    v_cvt_f32_i32_sdwa v118, sext(v107) dst_sel:DWORD dst_unused:UNUSED_PAD src0_sel:WORD_0
    v_lshlrev_b32 v116, 16, v122
    v_and_b32 v117, s32, v122
    v_mul_f32 v118, s33, v118
    v_lshlrev_b32 v122, 16, v123
    v_and_b32 v123, s32, v123
    v_lshlrev_b32_sdwa v107, 3, v107 dst_sel:DWORD dst_unused:UNUSED_PAD src0_sel:DWORD src1_sel:WORD_1
    v_pk_fma_f32 v[116:117], v[116:117], v[118:119], s[28:29] op_sel_hi:[1,0,1]
    v_pk_fma_f32 v[122:123], v[122:123], v[118:119], s[28:29] op_sel_hi:[1,0,1]
    v_perm_b32 v116, v117, v116, s35
    v_perm_b32 v117, v123, v122, s35
    v_lshl_add_u64 v[116:117], v[116:117], 0, s[30:31]
    ds_add_rtn_u64 v[122:123], v107, v[116:117] offset:50000

    s_mov_b64 exec, s[98:99]
    v_cvt_f32_i32_sdwa v118, sext(v108) dst_sel:DWORD dst_unused:UNUSED_PAD src0_sel:WORD_0
    v_lshlrev_b32 v116, 16, v124
    v_and_b32 v117, s32, v124
    v_mul_f32 v118, s33, v118
    v_lshlrev_b32 v124, 16, v125
    v_and_b32 v125, s32, v125
    v_lshlrev_b32_sdwa v108, 3, v108 dst_sel:DWORD dst_unused:UNUSED_PAD src0_sel:DWORD src1_sel:WORD_1
    v_pk_fma_f32 v[116:117], v[116:117], v[118:119], s[28:29] op_sel_hi:[1,0,1]
    v_pk_fma_f32 v[124:125], v[124:125], v[118:119], s[28:29] op_sel_hi:[1,0,1]
    v_perm_b32 v116, v117, v116, s35
    v_perm_b32 v117, v125, v124, s35
    v_lshl_add_u64 v[116:117], v[116:117], 0, s[30:31]
    ds_add_rtn_u64 v[124:125], v108, v[116:117] offset:50000

    s_mov_b64 exec, vcc
    v_cvt_f32_i32_sdwa v118, sext(v109) dst_sel:DWORD dst_unused:UNUSED_PAD src0_sel:WORD_0
    v_lshlrev_b32 v116, 16, v126
    v_and_b32 v117, s32, v126
    v_mul_f32 v118, s33, v118
    v_lshlrev_b32 v126, 16, v127
    v_and_b32 v127, s32, v127
    v_lshlrev_b32_sdwa v109, 3, v109 dst_sel:DWORD dst_unused:UNUSED_PAD src0_sel:DWORD src1_sel:WORD_1
    v_pk_fma_f32 v[116:117], v[116:117], v[118:119], s[28:29] op_sel_hi:[1,0,1]
    v_pk_fma_f32 v[126:127], v[126:127], v[118:119], s[28:29] op_sel_hi:[1,0,1]
    v_perm_b32 v116, v117, v116, s35
    v_perm_b32 v117, v127, v126, s35
    v_lshl_add_u64 v[116:117], v[116:117], 0, s[30:31]
    ds_add_rtn_u64 v[126:127], v109, v[116:117] offset:50000

    s_waitcnt lgkmcnt(0)
    s_mov_b64 exec, s[56:57]
    v_or3_b32 v1, v120, v121, v1
    s_mov_b64 exec, s[58:59]
    v_or3_b32 v1, v122, v123, v1
    s_mov_b64 exec, s[98:99]
    v_or3_b32 v1, v124, v125, v1
    s_mov_b64 exec, vcc
    v_or3_b32 v1, v126, v127, v1
    s_mov_b64 exec, -1
L_nt2_64:
    s_movk_i32 s53, 15360
    buffer_load_dwordx4 v[106:109], v2, s[16:19], s53 offen
    buffer_load_dword v114, v2, s[16:19], s53 offen offset:16
    s_cmp_le_u32 s40, 3584
    s_cbranch_scc1 L_noleft_65
    s_min_u32 s40, s40, 6552
    s_lshl_b32 s52, s38, 6
    s_add_u32 s52, s52, s36
    s_mul_i32 s52, s52, 32764
    s_add_u32 s20, s44, s52
    s_addc_u32 s21, s45, 0
    s_mul_i32 s52, s40, 5
    s_add_u32 s52, s52, 3
    s_and_b32 s22, s52, -4

    s_lshr_b32 s55, s39, 2
    s_add_u32 s55, s55, 3584
    v_and_b32 v120, 63, v0
    v_add_u32 v120, s55, v120
L_left_68:
    s_cmp_ge_u32 s55, s40
    s_cbranch_scc1 L_leftend_69
    v_mul_u32_u24 v121, 5, v120
    buffer_load_dword v122, v121, s[20:23], 0 offen
    buffer_load_ubyte v123, v121, s[20:23], 0 offen offset:4
    s_waitcnt vmcnt(0)

    v_perm_b32 v121, v123, v122, s24
    v_lshrrev_b32 v126, 30, v122
    v_and_b32 v121, 0x1fff, v121
    v_mul_u32_u24 v126, 6250, v126
    v_add_lshl_u32 v121, v121, v126, 3

    buffer_load_dwordx2 v[124:125], v121, s[8:11], s50 offen
    v_cmp_gt_u32 vcc, s40, v120
    s_waitcnt vmcnt(0)

    s_mov_b64 exec, vcc
    v_and_b32 v122, 0x3fffffff, v122
    v_cvt_f32_i32_sdwa v118, sext(v122) dst_sel:DWORD dst_unused:UNUSED_PAD src0_sel:WORD_0
    v_lshlrev_b32 v116, 16, v124
    v_and_b32 v117, s32, v124
    v_mul_f32 v118, s33, v118
    v_lshlrev_b32 v124, 16, v125
    v_and_b32 v125, s32, v125
    v_lshlrev_b32_sdwa v122, 3, v122 dst_sel:DWORD dst_unused:UNUSED_PAD src0_sel:DWORD src1_sel:WORD_1
    v_pk_fma_f32 v[116:117], v[116:117], v[118:119], s[28:29] op_sel_hi:[1,0,1]
    v_pk_fma_f32 v[124:125], v[124:125], v[118:119], s[28:29] op_sel_hi:[1,0,1]
    v_perm_b32 v116, v117, v116, s35
    v_perm_b32 v117, v125, v124, s35
    v_lshl_add_u64 v[116:117], v[116:117], 0, s[30:31]
    ds_add_rtn_u64 v[124:125], v122, v[116:117] offset:50000

    s_waitcnt lgkmcnt(0)
    v_or3_b32 v1, v124, v125, v1
    s_mov_b64 exec, -1
    v_add_u32 v120, 128, v120
    s_add_u32 s55, s55, 128
    s_branch L_left_68
L_leftend_69:

L_noleft_65:
    v_cmp_gt_u32 s[64:65], 2.0, v4
    v_and_b32 v4, 0x3fffffff, v4
    v_cmp_gt_u32 s[66:67], 2.0, v5
    v_and_b32 v5, 0x3fffffff, v5
    v_cmp_gt_u32 s[68:69], 2.0, v6
    v_and_b32 v6, 0x3fffffff, v6
    v_cmp_gt_u32 s[70:71], 2.0, v7
    v_and_b32 v7, 0x3fffffff, v7
    v_cmp_gt_u32 s[72:73], 2.0, v8
    v_and_b32 v8, 0x3fffffff, v8
    v_cmp_gt_u32 s[74:75], 2.0, v9
    v_and_b32 v9, 0x3fffffff, v9
    v_cmp_gt_u32 s[76:77], 2.0, v10
    v_and_b32 v10, 0x3fffffff, v10
    v_cmp_gt_u32 s[78:79], 2.0, v11
    v_and_b32 v11, 0x3fffffff, v11
    v_cmp_gt_u32 s[80:81], 2.0, v12
    v_and_b32 v12, 0x3fffffff, v12
    v_cmp_gt_u32 s[82:83], 2.0, v13
    v_and_b32 v13, 0x3fffffff, v13
    v_cmp_gt_u32 s[84:85], 2.0, v14
    v_and_b32 v14, 0x3fffffff, v14
    v_cmp_gt_u32 s[86:87], 2.0, v15
    v_and_b32 v15, 0x3fffffff, v15
    s_waitcnt lgkmcnt(0)
    s_barrier
    s_waitcnt vmcnt(9)
    ds_write_addtid_b32 v76 offset:0
    ds_write_addtid_b32 v77 offset:256
    ds_write_addtid_b32 v78 offset:512
    ds_write_addtid_b32 v79 offset:768
    s_waitcnt vmcnt(8)
    ds_write_addtid_b32 v80 offset:16384
    ds_write_addtid_b32 v81 offset:16640
    ds_write_addtid_b32 v82 offset:16896
    ds_write_addtid_b32 v83 offset:17152
    s_waitcnt vmcnt(7)
    ds_write_addtid_b32 v84 offset:32768
    ds_write_addtid_b32 v85 offset:33024
    ds_write_addtid_b32 v86 offset:33280
    ds_write_addtid_b32 v87 offset:33536
    v_lshlrev_b32 v119, 2, v0
    s_waitcnt vmcnt(6)
    s_mov_b64 exec, s[48:49]
    ds_write_b32 v119, v88 offset:49152
    s_mov_b64 exec, -1
    s_add_u32 s43, s43, 50048
    s_add_u32 s14, s43, 50000
    s_min_u32 s14, s14, s41
    buffer_load_dwordx4 v[76:79], v3, s[12:15], s43 offen
    s_waitcnt lgkmcnt(0)
    s_barrier
    s_add_u32 s52, s43, 16384
    buffer_load_dwordx4 v[80:83], v3, s[12:15], s52 offen
    s_add_u32 s52, s43, 32768
    buffer_load_dwordx4 v[84:87], v3, s[12:15], s52 offen
    s_add_u32 s52, s43, 49152
    v_lshlrev_b32 v119, 2, v0
    buffer_load_dword v88, v119, s[12:15], s52 offen
    s_mov_b64 exec, s[64:65]
    ds_read_b64 v[28:29], v28
    s_mov_b64 exec, s[66:67]
    ds_read_b64 v[30:31], v30
    s_mov_b64 exec, s[68:69]
    ds_read_b64 v[32:33], v32
    s_mov_b64 exec, s[70:71]
    ds_read_b64 v[34:35], v34
    s_mov_b64 exec, s[72:73]
    ds_read_b64 v[36:37], v36
    s_mov_b64 exec, s[74:75]
    ds_read_b64 v[38:39], v38
    s_mov_b64 exec, s[76:77]
    ds_read_b64 v[40:41], v40
    s_mov_b64 exec, s[78:79]
    ds_read_b64 v[42:43], v42
    s_mov_b64 exec, s[80:81]
    ds_read_b64 v[44:45], v44
    s_mov_b64 exec, s[82:83]
    ds_read_b64 v[46:47], v46
    s_mov_b64 exec, s[84:85]
    ds_read_b64 v[48:49], v48
    s_mov_b64 exec, s[86:87]
    ds_read_b64 v[50:51], v50
    s_mov_b64 exec, -1
    v_cmp_gt_u32 s[64:65], 2.0, v16
    v_and_b32 v16, 0x3fffffff, v16
    v_cmp_gt_u32 s[66:67], 2.0, v17
    v_and_b32 v17, 0x3fffffff, v17
    v_cmp_gt_u32 s[68:69], 2.0, v18
    v_and_b32 v18, 0x3fffffff, v18
    v_cmp_gt_u32 s[70:71], 2.0, v19
    v_and_b32 v19, 0x3fffffff, v19
    v_cmp_gt_u32 s[72:73], 2.0, v20
    v_and_b32 v20, 0x3fffffff, v20
    v_cmp_gt_u32 s[74:75], 2.0, v21
    v_and_b32 v21, 0x3fffffff, v21
    v_cmp_gt_u32 s[76:77], 2.0, v22
    v_and_b32 v22, 0x3fffffff, v22
    v_cmp_gt_u32 s[78:79], 2.0, v23
    v_and_b32 v23, 0x3fffffff, v23
    v_cmp_gt_u32 s[80:81], 2.0, v24
    v_and_b32 v24, 0x3fffffff, v24
    v_cmp_gt_u32 s[82:83], 2.0, v25
    v_and_b32 v25, 0x3fffffff, v25
    v_cmp_gt_u32 s[84:85], 2.0, v26
    v_and_b32 v26, 0x3fffffff, v26
    v_cmp_gt_u32 s[86:87], 2.0, v27
    v_and_b32 v27, 0x3fffffff, v27
    s_mov_b64 exec, s[64:65]
    ds_read_b64 v[52:53], v52
    s_mov_b64 exec, s[66:67]
    ds_read_b64 v[54:55], v54
    s_mov_b64 exec, s[68:69]
    ds_read_b64 v[56:57], v56
    s_mov_b64 exec, s[70:71]
    ds_read_b64 v[58:59], v58
    s_mov_b64 exec, s[72:73]
    ds_read_b64 v[60:61], v60
    s_mov_b64 exec, s[74:75]
    ds_read_b64 v[62:63], v62
    s_mov_b64 exec, s[76:77]
    ds_read_b64 v[64:65], v64
    s_mov_b64 exec, s[78:79]
    ds_read_b64 v[66:67], v66
    s_mov_b64 exec, s[80:81]
    ds_read_b64 v[68:69], v68
    s_mov_b64 exec, s[82:83]
    ds_read_b64 v[70:71], v70
    s_mov_b64 exec, s[84:85]
    ds_read_b64 v[72:73], v72
    s_mov_b64 exec, s[86:87]
    ds_read_b64 v[74:75], v74
    s_mov_b64 exec, -1
    s_cmp_ge_u32 s5, s4
    s_cbranch_scc1 L_bend_62
    s_waitcnt lgkmcnt(15)
    v_mad_i32_i16 v120, v28, v4, s96
    v_mad_i32_i16 v28, v28, v4, s96 op_sel:[1,0,0,0]
    v_mad_i32_i16 v121, v29, v4, s96
    v_mad_i32_i16 v29, v29, v4, s96 op_sel:[1,0,0,0]
    v_lshlrev_b32_sdwa v4, 3, v4 dst_sel:DWORD dst_unused:UNUSED_PAD src0_sel:DWORD src1_sel:WORD_1
    v_perm_b32 v28, v28, v120, s97
    v_perm_b32 v29, v29, v121, s97
    v_lshl_add_u64 v[28:29], v[28:29], 0, s[30:31]

    ds_add_rtn_u64 v[28:29], v4, v[28:29] offset:50000
    v_mad_i32_i16 v122, v30, v5, s96
    v_mad_i32_i16 v30, v30, v5, s96 op_sel:[1,0,0,0]
    v_mad_i32_i16 v123, v31, v5, s96
    v_mad_i32_i16 v31, v31, v5, s96 op_sel:[1,0,0,0]
    v_lshlrev_b32_sdwa v5, 3, v5 dst_sel:DWORD dst_unused:UNUSED_PAD src0_sel:DWORD src1_sel:WORD_1
    v_perm_b32 v30, v30, v122, s97
    v_perm_b32 v31, v31, v123, s97
    v_lshl_add_u64 v[30:31], v[30:31], 0, s[30:31]

    ds_add_rtn_u64 v[30:31], v5, v[30:31] offset:50000
    v_mad_i32_i16 v124, v32, v6, s96
    v_mad_i32_i16 v32, v32, v6, s96 op_sel:[1,0,0,0]
    v_mad_i32_i16 v125, v33, v6, s96
    v_mad_i32_i16 v33, v33, v6, s96 op_sel:[1,0,0,0]
    v_lshlrev_b32_sdwa v6, 3, v6 dst_sel:DWORD dst_unused:UNUSED_PAD src0_sel:DWORD src1_sel:WORD_1
    v_perm_b32 v32, v32, v124, s97
    v_perm_b32 v33, v33, v125, s97
    v_lshl_add_u64 v[32:33], v[32:33], 0, s[30:31]

    ds_add_rtn_u64 v[32:33], v6, v[32:33] offset:50000
    v_mad_i32_i16 v126, v34, v7, s96
    v_mad_i32_i16 v34, v34, v7, s96 op_sel:[1,0,0,0]
    v_mad_i32_i16 v127, v35, v7, s96
    v_mad_i32_i16 v35, v35, v7, s96 op_sel:[1,0,0,0]
    v_lshlrev_b32_sdwa v7, 3, v7 dst_sel:DWORD dst_unused:UNUSED_PAD src0_sel:DWORD src1_sel:WORD_1
    v_perm_b32 v34, v34, v126, s97
    v_perm_b32 v35, v35, v127, s97
    v_lshl_add_u64 v[34:35], v[34:35], 0, s[30:31]

    ds_add_rtn_u64 v[34:35], v7, v[34:35] offset:50000
    v_mad_i32_i16 v120, v36, v8, s96
    v_mad_i32_i16 v36, v36, v8, s96 op_sel:[1,0,0,0]
    v_mad_i32_i16 v121, v37, v8, s96
    v_mad_i32_i16 v37, v37, v8, s96 op_sel:[1,0,0,0]
    v_lshlrev_b32_sdwa v8, 3, v8 dst_sel:DWORD dst_unused:UNUSED_PAD src0_sel:DWORD src1_sel:WORD_1
    v_perm_b32 v36, v36, v120, s97
    v_perm_b32 v37, v37, v121, s97
    v_lshl_add_u64 v[36:37], v[36:37], 0, s[30:31]

    ds_add_rtn_u64 v[36:37], v8, v[36:37] offset:50000
    v_mad_i32_i16 v122, v38, v9, s96
    v_mad_i32_i16 v38, v38, v9, s96 op_sel:[1,0,0,0]
    v_mad_i32_i16 v123, v39, v9, s96
    v_mad_i32_i16 v39, v39, v9, s96 op_sel:[1,0,0,0]
    v_lshlrev_b32_sdwa v9, 3, v9 dst_sel:DWORD dst_unused:UNUSED_PAD src0_sel:DWORD src1_sel:WORD_1
    v_perm_b32 v38, v38, v122, s97
    v_perm_b32 v39, v39, v123, s97
    v_lshl_add_u64 v[38:39], v[38:39], 0, s[30:31]

    ds_add_rtn_u64 v[38:39], v9, v[38:39] offset:50000
    v_mad_i32_i16 v124, v40, v10, s96
    v_mad_i32_i16 v40, v40, v10, s96 op_sel:[1,0,0,0]
    v_mad_i32_i16 v125, v41, v10, s96
    v_mad_i32_i16 v41, v41, v10, s96 op_sel:[1,0,0,0]
    v_lshlrev_b32_sdwa v10, 3, v10 dst_sel:DWORD dst_unused:UNUSED_PAD src0_sel:DWORD src1_sel:WORD_1
    v_perm_b32 v40, v40, v124, s97
    v_perm_b32 v41, v41, v125, s97
    v_lshl_add_u64 v[40:41], v[40:41], 0, s[30:31]

    ds_add_rtn_u64 v[40:41], v10, v[40:41] offset:50000
    v_mad_i32_i16 v126, v42, v11, s96
    v_mad_i32_i16 v42, v42, v11, s96 op_sel:[1,0,0,0]
    v_mad_i32_i16 v127, v43, v11, s96
    v_mad_i32_i16 v43, v43, v11, s96 op_sel:[1,0,0,0]
    v_lshlrev_b32_sdwa v11, 3, v11 dst_sel:DWORD dst_unused:UNUSED_PAD src0_sel:DWORD src1_sel:WORD_1
    v_perm_b32 v42, v42, v126, s97
    v_perm_b32 v43, v43, v127, s97
    v_lshl_add_u64 v[42:43], v[42:43], 0, s[30:31]

    ds_add_rtn_u64 v[42:43], v11, v[42:43] offset:50000
    s_waitcnt lgkmcnt(4)
    v_or3_b32 v1, v28, v29, v1
    v_or3_b32 v1, v30, v31, v1
    v_or3_b32 v1, v32, v33, v1
    v_or3_b32 v1, v34, v35, v1
    s_movk_i32 s53, 0
    buffer_load_dwordx4 v[4:7], v2, s[16:19], s53 offen nt
    buffer_load_dword v35, v2, s[16:19], s53 offen offset:16 nt
    v_mad_i32_i16 v120, v44, v12, s96
    v_mad_i32_i16 v44, v44, v12, s96 op_sel:[1,0,0,0]
    v_mad_i32_i16 v121, v45, v12, s96
    v_mad_i32_i16 v45, v45, v12, s96 op_sel:[1,0,0,0]
    v_lshlrev_b32_sdwa v12, 3, v12 dst_sel:DWORD dst_unused:UNUSED_PAD src0_sel:DWORD src1_sel:WORD_1
    v_perm_b32 v44, v44, v120, s97
    v_perm_b32 v45, v45, v121, s97
    v_lshl_add_u64 v[44:45], v[44:45], 0, s[30:31]

    ds_add_rtn_u64 v[44:45], v12, v[44:45] offset:50000
    v_mad_i32_i16 v122, v46, v13, s96
    v_mad_i32_i16 v46, v46, v13, s96 op_sel:[1,0,0,0]
    v_mad_i32_i16 v123, v47, v13, s96
    v_mad_i32_i16 v47, v47, v13, s96 op_sel:[1,0,0,0]
    v_lshlrev_b32_sdwa v13, 3, v13 dst_sel:DWORD dst_unused:UNUSED_PAD src0_sel:DWORD src1_sel:WORD_1
    v_perm_b32 v46, v46, v122, s97
    v_perm_b32 v47, v47, v123, s97
    v_lshl_add_u64 v[46:47], v[46:47], 0, s[30:31]

    ds_add_rtn_u64 v[46:47], v13, v[46:47] offset:50000
    v_mad_i32_i16 v124, v48, v14, s96
    v_mad_i32_i16 v48, v48, v14, s96 op_sel:[1,0,0,0]
    v_mad_i32_i16 v125, v49, v14, s96
    v_mad_i32_i16 v49, v49, v14, s96 op_sel:[1,0,0,0]
    v_lshlrev_b32_sdwa v14, 3, v14 dst_sel:DWORD dst_unused:UNUSED_PAD src0_sel:DWORD src1_sel:WORD_1
    v_perm_b32 v48, v48, v124, s97
    v_perm_b32 v49, v49, v125, s97
    v_lshl_add_u64 v[48:49], v[48:49], 0, s[30:31]

    ds_add_rtn_u64 v[48:49], v14, v[48:49] offset:50000
    v_mad_i32_i16 v126, v50, v15, s96
    v_mad_i32_i16 v50, v50, v15, s96 op_sel:[1,0,0,0]
    v_mad_i32_i16 v127, v51, v15, s96
    v_mad_i32_i16 v51, v51, v15, s96 op_sel:[1,0,0,0]
    v_lshlrev_b32_sdwa v15, 3, v15 dst_sel:DWORD dst_unused:UNUSED_PAD src0_sel:DWORD src1_sel:WORD_1
    v_perm_b32 v50, v50, v126, s97
    v_perm_b32 v51, v51, v127, s97
    v_lshl_add_u64 v[50:51], v[50:51], 0, s[30:31]

    ds_add_rtn_u64 v[50:51], v15, v[50:51] offset:50000
    s_waitcnt lgkmcnt(4)
    v_or3_b32 v1, v36, v37, v1
    v_or3_b32 v1, v38, v39, v1
    v_or3_b32 v1, v40, v41, v1
    v_or3_b32 v1, v42, v43, v1
    s_movk_i32 s53, 2560
    buffer_load_dwordx4 v[8:11], v2, s[16:19], s53 offen
    buffer_load_dword v43, v2, s[16:19], s53 offen offset:16
    s_barrier
    s_waitcnt vmcnt(7)
    ds_write_addtid_b32 v76 offset:0
    ds_write_addtid_b32 v77 offset:256
    ds_write_addtid_b32 v78 offset:512
    ds_write_addtid_b32 v79 offset:768
    s_waitcnt vmcnt(6)
    ds_write_addtid_b32 v80 offset:16384
    ds_write_addtid_b32 v81 offset:16640
    ds_write_addtid_b32 v82 offset:16896
    ds_write_addtid_b32 v83 offset:17152
    s_waitcnt vmcnt(5)
    ds_write_addtid_b32 v84 offset:32768
    ds_write_addtid_b32 v85 offset:33024
    ds_write_addtid_b32 v86 offset:33280
    ds_write_addtid_b32 v87 offset:33536
    v_lshlrev_b32 v119, 2, v0
    s_waitcnt vmcnt(4)
    s_mov_b64 exec, s[48:49]
    ds_write_b32 v119, v88 offset:49152
    s_mov_b64 exec, -1
    s_add_u32 s43, s43, 50048
    s_add_u32 s14, s43, 50000
    s_min_u32 s14, s14, s41
    s_mov_b32 s40, s88
    s_sub_u32 s42, s40, s39

    s_add_u32 s55, s38, 2
    s_min_u32 s55, s55, 31
    s_mov_b32 s88, s89
    s_mov_b32 s89, s90
    s_mov_b32 s90, s91
    s_mov_b32 s91, s92
    s_mov_b32 s92, s93
    s_mov_b32 s93, s94
    s_mov_b32 s94, s95
    s_mov_b32 s95, 0
    s_min_u32 s88, s88, 6552
    s_lshl_b32 s52, s55, 6
    s_add_u32 s52, s52, s36
    s_mul_i32 s52, s52, 32764
    s_add_u32 s16, s44, s52
    s_addc_u32 s17, s45, 0
    s_mul_i32 s52, s88, 5
    s_add_u32 s52, s52, 3
    s_and_b32 s18, s52, -4

    v_mad_i32_i16 v120, v52, v16, s96
    v_mad_i32_i16 v52, v52, v16, s96 op_sel:[1,0,0,0]
    v_mad_i32_i16 v121, v53, v16, s96
    v_mad_i32_i16 v53, v53, v16, s96 op_sel:[1,0,0,0]
    v_lshlrev_b32_sdwa v16, 3, v16 dst_sel:DWORD dst_unused:UNUSED_PAD src0_sel:DWORD src1_sel:WORD_1
    v_perm_b32 v52, v52, v120, s97
    v_perm_b32 v53, v53, v121, s97
    v_lshl_add_u64 v[52:53], v[52:53], 0, s[30:31]

    ds_add_rtn_u64 v[52:53], v16, v[52:53] offset:50000
    v_mad_i32_i16 v122, v54, v17, s96
    v_mad_i32_i16 v54, v54, v17, s96 op_sel:[1,0,0,0]
    v_mad_i32_i16 v123, v55, v17, s96
    v_mad_i32_i16 v55, v55, v17, s96 op_sel:[1,0,0,0]
    v_lshlrev_b32_sdwa v17, 3, v17 dst_sel:DWORD dst_unused:UNUSED_PAD src0_sel:DWORD src1_sel:WORD_1
    v_perm_b32 v54, v54, v122, s97
    v_perm_b32 v55, v55, v123, s97
    v_lshl_add_u64 v[54:55], v[54:55], 0, s[30:31]

    ds_add_rtn_u64 v[54:55], v17, v[54:55] offset:50000
    v_mad_i32_i16 v124, v56, v18, s96
    v_mad_i32_i16 v56, v56, v18, s96 op_sel:[1,0,0,0]
    v_mad_i32_i16 v125, v57, v18, s96
    v_mad_i32_i16 v57, v57, v18, s96 op_sel:[1,0,0,0]
    v_lshlrev_b32_sdwa v18, 3, v18 dst_sel:DWORD dst_unused:UNUSED_PAD src0_sel:DWORD src1_sel:WORD_1
    v_perm_b32 v56, v56, v124, s97
    v_perm_b32 v57, v57, v125, s97
    v_lshl_add_u64 v[56:57], v[56:57], 0, s[30:31]

    ds_add_rtn_u64 v[56:57], v18, v[56:57] offset:50000
    v_mad_i32_i16 v126, v58, v19, s96
    v_mad_i32_i16 v58, v58, v19, s96 op_sel:[1,0,0,0]
    v_mad_i32_i16 v127, v59, v19, s96
    v_mad_i32_i16 v59, v59, v19, s96 op_sel:[1,0,0,0]
    v_lshlrev_b32_sdwa v19, 3, v19 dst_sel:DWORD dst_unused:UNUSED_PAD src0_sel:DWORD src1_sel:WORD_1
    v_perm_b32 v58, v58, v126, s97
    v_perm_b32 v59, v59, v127, s97
    v_lshl_add_u64 v[58:59], v[58:59], 0, s[30:31]

    ds_add_rtn_u64 v[58:59], v19, v[58:59] offset:50000
    s_waitcnt lgkmcnt(15)
    v_or3_b32 v1, v44, v45, v1
    v_or3_b32 v1, v46, v47, v1
    v_or3_b32 v1, v48, v49, v1
    v_or3_b32 v1, v50, v51, v1
    s_waitcnt vmcnt(24)
    v_perm_b32 v44, v91, v90, s24
    v_perm_b32 v46, v92, v91, s25
    v_perm_b32 v48, v93, v92, s26
    v_perm_b32 v50, v110, v93, s27
    v_mov_b32 v12, v90
    v_alignbyte_b32 v13, v92, v91, 1
    v_alignbyte_b32 v14, v93, v92, 2
    v_alignbyte_b32 v15, v110, v93, 3
    v_lshlrev_b32_sdwa v44, 3, v44 dst_sel:WORD_0 dst_unused:UNUSED_PAD src0_sel:DWORD src1_sel:DWORD
    v_lshlrev_b32_sdwa v46, 3, v46 dst_sel:WORD_0 dst_unused:UNUSED_PAD src0_sel:DWORD src1_sel:DWORD
    v_lshlrev_b32_sdwa v48, 3, v48 dst_sel:WORD_0 dst_unused:UNUSED_PAD src0_sel:DWORD src1_sel:DWORD
    v_lshlrev_b32_sdwa v50, 3, v50 dst_sel:WORD_0 dst_unused:UNUSED_PAD src0_sel:DWORD src1_sel:DWORD
    s_cmp_lt_i32 s42, 1280
    s_cbranch_scc1 L_ufix_70
L_uback_71:

    s_movk_i32 s53, 5120
    buffer_load_dwordx4 v[90:93], v2, s[16:19], s53 offen
    buffer_load_dword v110, v2, s[16:19], s53 offen offset:16
    s_waitcnt lgkmcnt(4)
    s_barrier
    v_subrev_co_u32 v12, s[80:81], 2.0, v12
    v_subrev_co_u32 v13, s[82:83], 2.0, v13
    v_subrev_co_u32 v14, s[84:85], 2.0, v14
    v_subrev_co_u32 v15, s[86:87], 2.0, v15
    s_mov_b64 exec, s[80:81]
    ds_read_b64 v[44:45], v44
    s_mov_b64 exec, s[82:83]
    ds_read_b64 v[46:47], v46
    s_mov_b64 exec, s[84:85]
    ds_read_b64 v[48:49], v48
    s_mov_b64 exec, s[86:87]
    ds_read_b64 v[50:51], v50
    s_mov_b64 exec, -1
    v_mad_i32_i16 v120, v60, v20, s96
    v_mad_i32_i16 v60, v60, v20, s96 op_sel:[1,0,0,0]
    v_mad_i32_i16 v121, v61, v20, s96
    v_mad_i32_i16 v61, v61, v20, s96 op_sel:[1,0,0,0]
    v_lshlrev_b32_sdwa v20, 3, v20 dst_sel:DWORD dst_unused:UNUSED_PAD src0_sel:DWORD src1_sel:WORD_1
    v_perm_b32 v60, v60, v120, s97
    v_perm_b32 v61, v61, v121, s97
    v_lshl_add_u64 v[60:61], v[60:61], 0, s[30:31]

    ds_add_rtn_u64 v[60:61], v20, v[60:61] offset:50000
    v_mad_i32_i16 v122, v62, v21, s96
    v_mad_i32_i16 v62, v62, v21, s96 op_sel:[1,0,0,0]
    v_mad_i32_i16 v123, v63, v21, s96
    v_mad_i32_i16 v63, v63, v21, s96 op_sel:[1,0,0,0]
    v_lshlrev_b32_sdwa v21, 3, v21 dst_sel:DWORD dst_unused:UNUSED_PAD src0_sel:DWORD src1_sel:WORD_1
    v_perm_b32 v62, v62, v122, s97
    v_perm_b32 v63, v63, v123, s97
    v_lshl_add_u64 v[62:63], v[62:63], 0, s[30:31]

    ds_add_rtn_u64 v[62:63], v21, v[62:63] offset:50000
    v_mad_i32_i16 v124, v64, v22, s96
    v_mad_i32_i16 v64, v64, v22, s96 op_sel:[1,0,0,0]
    v_mad_i32_i16 v125, v65, v22, s96
    v_mad_i32_i16 v65, v65, v22, s96 op_sel:[1,0,0,0]
    v_lshlrev_b32_sdwa v22, 3, v22 dst_sel:DWORD dst_unused:UNUSED_PAD src0_sel:DWORD src1_sel:WORD_1
    v_perm_b32 v64, v64, v124, s97
    v_perm_b32 v65, v65, v125, s97
    v_lshl_add_u64 v[64:65], v[64:65], 0, s[30:31]

    ds_add_rtn_u64 v[64:65], v22, v[64:65] offset:50000
    v_mad_i32_i16 v126, v66, v23, s96
    v_mad_i32_i16 v66, v66, v23, s96 op_sel:[1,0,0,0]
    v_mad_i32_i16 v127, v67, v23, s96
    v_mad_i32_i16 v67, v67, v23, s96 op_sel:[1,0,0,0]
    v_lshlrev_b32_sdwa v23, 3, v23 dst_sel:DWORD dst_unused:UNUSED_PAD src0_sel:DWORD src1_sel:WORD_1
    v_perm_b32 v66, v66, v126, s97
    v_perm_b32 v67, v67, v127, s97
    v_lshl_add_u64 v[66:67], v[66:67], 0, s[30:31]

    ds_add_rtn_u64 v[66:67], v23, v[66:67] offset:50000
    s_waitcnt lgkmcnt(8)
    v_or3_b32 v1, v52, v53, v1
    v_or3_b32 v1, v54, v55, v1
    v_or3_b32 v1, v56, v57, v1
    v_or3_b32 v1, v58, v59, v1
    s_waitcnt vmcnt(24)
    v_perm_b32 v52, v95, v94, s24
    v_perm_b32 v54, v96, v95, s25
    v_perm_b32 v56, v97, v96, s26
    v_perm_b32 v58, v111, v97, s27
    v_mov_b32 v16, v94
    v_alignbyte_b32 v17, v96, v95, 1
    v_alignbyte_b32 v18, v97, v96, 2
    v_alignbyte_b32 v19, v111, v97, 3
    v_lshlrev_b32_sdwa v52, 3, v52 dst_sel:WORD_0 dst_unused:UNUSED_PAD src0_sel:DWORD src1_sel:DWORD
    v_lshlrev_b32_sdwa v54, 3, v54 dst_sel:WORD_0 dst_unused:UNUSED_PAD src0_sel:DWORD src1_sel:DWORD
    v_lshlrev_b32_sdwa v56, 3, v56 dst_sel:WORD_0 dst_unused:UNUSED_PAD src0_sel:DWORD src1_sel:DWORD
    v_lshlrev_b32_sdwa v58, 3, v58 dst_sel:WORD_0 dst_unused:UNUSED_PAD src0_sel:DWORD src1_sel:DWORD
    s_cmp_lt_i32 s42, 1792
    s_cbranch_scc1 L_ufix_72
L_uback_73:

    v_subrev_co_u32 v16, s[64:65], 2.0, v16
    v_subrev_co_u32 v17, s[66:67], 2.0, v17
    v_subrev_co_u32 v18, s[68:69], 2.0, v18
    v_subrev_co_u32 v19, s[70:71], 2.0, v19
    s_mov_b64 exec, s[64:65]
    ds_read_b64 v[52:53], v52
    s_mov_b64 exec, s[66:67]
    ds_read_b64 v[54:55], v54
    s_mov_b64 exec, s[68:69]
    ds_read_b64 v[56:57], v56
    s_mov_b64 exec, s[70:71]
    ds_read_b64 v[58:59], v58
    s_mov_b64 exec, -1
    v_mad_i32_i16 v120, v68, v24, s96
    v_mad_i32_i16 v68, v68, v24, s96 op_sel:[1,0,0,0]
    v_mad_i32_i16 v121, v69, v24, s96
    v_mad_i32_i16 v69, v69, v24, s96 op_sel:[1,0,0,0]
    v_lshlrev_b32_sdwa v24, 3, v24 dst_sel:DWORD dst_unused:UNUSED_PAD src0_sel:DWORD src1_sel:WORD_1
    v_perm_b32 v68, v68, v120, s97
    v_perm_b32 v69, v69, v121, s97
    v_lshl_add_u64 v[68:69], v[68:69], 0, s[30:31]

    ds_add_rtn_u64 v[68:69], v24, v[68:69] offset:50000
    v_mad_i32_i16 v122, v70, v25, s96
    v_mad_i32_i16 v70, v70, v25, s96 op_sel:[1,0,0,0]
    v_mad_i32_i16 v123, v71, v25, s96
    v_mad_i32_i16 v71, v71, v25, s96 op_sel:[1,0,0,0]
    v_lshlrev_b32_sdwa v25, 3, v25 dst_sel:DWORD dst_unused:UNUSED_PAD src0_sel:DWORD src1_sel:WORD_1
    v_perm_b32 v70, v70, v122, s97
    v_perm_b32 v71, v71, v123, s97
    v_lshl_add_u64 v[70:71], v[70:71], 0, s[30:31]

    ds_add_rtn_u64 v[70:71], v25, v[70:71] offset:50000
    v_mad_i32_i16 v124, v72, v26, s96
    v_mad_i32_i16 v72, v72, v26, s96 op_sel:[1,0,0,0]
    v_mad_i32_i16 v125, v73, v26, s96
    v_mad_i32_i16 v73, v73, v26, s96 op_sel:[1,0,0,0]
    v_lshlrev_b32_sdwa v26, 3, v26 dst_sel:DWORD dst_unused:UNUSED_PAD src0_sel:DWORD src1_sel:WORD_1
    v_perm_b32 v72, v72, v124, s97
    v_perm_b32 v73, v73, v125, s97
    v_lshl_add_u64 v[72:73], v[72:73], 0, s[30:31]

    ds_add_rtn_u64 v[72:73], v26, v[72:73] offset:50000
    v_mad_i32_i16 v126, v74, v27, s96
    v_mad_i32_i16 v74, v74, v27, s96 op_sel:[1,0,0,0]
    v_mad_i32_i16 v127, v75, v27, s96
    v_mad_i32_i16 v75, v75, v27, s96 op_sel:[1,0,0,0]
    v_lshlrev_b32_sdwa v27, 3, v27 dst_sel:DWORD dst_unused:UNUSED_PAD src0_sel:DWORD src1_sel:WORD_1
    v_perm_b32 v74, v74, v126, s97
    v_perm_b32 v75, v75, v127, s97
    v_lshl_add_u64 v[74:75], v[74:75], 0, s[30:31]

    ds_add_rtn_u64 v[74:75], v27, v[74:75] offset:50000
    s_waitcnt lgkmcnt(8)
    v_or3_b32 v1, v60, v61, v1
    v_or3_b32 v1, v62, v63, v1
    v_or3_b32 v1, v64, v65, v1
    v_or3_b32 v1, v66, v67, v1
    s_waitcnt vmcnt(14)
    v_perm_b32 v60, v99, v98, s24
    v_perm_b32 v62, v100, v99, s25
    v_perm_b32 v64, v101, v100, s26
    v_perm_b32 v66, v112, v101, s27
    v_mov_b32 v20, v98
    v_alignbyte_b32 v21, v100, v99, 1
    v_alignbyte_b32 v22, v101, v100, 2
    v_alignbyte_b32 v23, v112, v101, 3
    v_lshlrev_b32_sdwa v60, 3, v60 dst_sel:WORD_0 dst_unused:UNUSED_PAD src0_sel:DWORD src1_sel:DWORD
    v_lshlrev_b32_sdwa v62, 3, v62 dst_sel:WORD_0 dst_unused:UNUSED_PAD src0_sel:DWORD src1_sel:DWORD
    v_lshlrev_b32_sdwa v64, 3, v64 dst_sel:WORD_0 dst_unused:UNUSED_PAD src0_sel:DWORD src1_sel:DWORD
    v_lshlrev_b32_sdwa v66, 3, v66 dst_sel:WORD_0 dst_unused:UNUSED_PAD src0_sel:DWORD src1_sel:DWORD
    s_cmp_lt_i32 s42, 2304
    s_cbranch_scc1 L_ufix_74
L_uback_75:

    v_subrev_co_u32 v20, s[72:73], 2.0, v20
    v_subrev_co_u32 v21, s[74:75], 2.0, v21
    v_subrev_co_u32 v22, s[76:77], 2.0, v22
    v_subrev_co_u32 v23, s[78:79], 2.0, v23
    s_mov_b64 exec, s[72:73]
    ds_read_b64 v[60:61], v60
    s_mov_b64 exec, s[74:75]
    ds_read_b64 v[62:63], v62
    s_mov_b64 exec, s[76:77]
    ds_read_b64 v[64:65], v64
    s_mov_b64 exec, s[78:79]
    ds_read_b64 v[66:67], v66
    s_mov_b64 exec, -1
    s_waitcnt lgkmcnt(4)
    v_or3_b32 v1, v68, v69, v1
    v_or3_b32 v1, v70, v71, v1
    v_or3_b32 v1, v72, v73, v1
    v_or3_b32 v1, v74, v75, v1
    s_waitcnt vmcnt(12)
    v_perm_b32 v68, v103, v102, s24
    v_perm_b32 v70, v104, v103, s25
    v_perm_b32 v72, v105, v104, s26
    v_perm_b32 v74, v113, v105, s27
    v_mov_b32 v24, v102
    v_alignbyte_b32 v25, v104, v103, 1
    v_alignbyte_b32 v26, v105, v104, 2
    v_alignbyte_b32 v27, v113, v105, 3
    v_lshlrev_b32_sdwa v68, 3, v68 dst_sel:WORD_0 dst_unused:UNUSED_PAD src0_sel:DWORD src1_sel:DWORD
    v_lshlrev_b32_sdwa v70, 3, v70 dst_sel:WORD_0 dst_unused:UNUSED_PAD src0_sel:DWORD src1_sel:DWORD
    v_lshlrev_b32_sdwa v72, 3, v72 dst_sel:WORD_0 dst_unused:UNUSED_PAD src0_sel:DWORD src1_sel:DWORD
    v_lshlrev_b32_sdwa v74, 3, v74 dst_sel:WORD_0 dst_unused:UNUSED_PAD src0_sel:DWORD src1_sel:DWORD
    s_cmp_lt_i32 s42, 2816
    s_cbranch_scc1 L_ufix_76
L_uback_77:

    v_subrev_co_u32 v24, s[80:81], 2.0, v24
    v_subrev_co_u32 v25, s[82:83], 2.0, v25
    v_subrev_co_u32 v26, s[84:85], 2.0, v26
    v_subrev_co_u32 v27, s[86:87], 2.0, v27
    s_mov_b64 exec, s[80:81]
    ds_read_b64 v[68:69], v68
    s_mov_b64 exec, s[82:83]
    ds_read_b64 v[70:71], v70
    s_mov_b64 exec, s[84:85]
    ds_read_b64 v[72:73], v72
    s_mov_b64 exec, s[86:87]
    ds_read_b64 v[74:75], v74
    s_mov_b64 exec, -1
    buffer_load_dwordx4 v[76:79], v3, s[12:15], s43 offen
    s_add_u32 s52, s43, 16384
    buffer_load_dwordx4 v[80:83], v3, s[12:15], s52 offen
    s_add_u32 s52, s43, 32768
    buffer_load_dwordx4 v[84:87], v3, s[12:15], s52 offen
    s_add_u32 s52, s43, 49152
    v_lshlrev_b32 v119, 2, v0
    buffer_load_dword v88, v119, s[12:15], s52 offen
    s_add_u32 s54, s43, 50048
    buffer_load_dword v115, v89, s[60:63], s54 offen
    s_add_u32 s54, s50, 200000
    buffer_load_dword v115, v89, s[8:11], s54 offen
    s_waitcnt vmcnt(10)
    v_perm_b32 v28, v5, v4, s24
    v_perm_b32 v30, v6, v5, s25
    v_perm_b32 v32, v7, v6, s26
    v_perm_b32 v34, v35, v7, s27
    v_alignbyte_b32 v5, v6, v5, 1
    v_alignbyte_b32 v6, v7, v6, 2
    v_alignbyte_b32 v7, v35, v7, 3
    v_lshlrev_b32_sdwa v28, 3, v28 dst_sel:WORD_0 dst_unused:UNUSED_PAD src0_sel:DWORD src1_sel:DWORD
    v_lshlrev_b32_sdwa v30, 3, v30 dst_sel:WORD_0 dst_unused:UNUSED_PAD src0_sel:DWORD src1_sel:DWORD
    v_lshlrev_b32_sdwa v32, 3, v32 dst_sel:WORD_0 dst_unused:UNUSED_PAD src0_sel:DWORD src1_sel:DWORD
    v_lshlrev_b32_sdwa v34, 3, v34 dst_sel:WORD_0 dst_unused:UNUSED_PAD src0_sel:DWORD src1_sel:DWORD
    s_cmp_lt_i32 s42, 256
    s_cbranch_scc1 L_ufix_78
L_uback_79:

    v_subrev_co_u32 v4, s[64:65], 2.0, v4
    v_subrev_co_u32 v5, s[66:67], 2.0, v5
    v_subrev_co_u32 v6, s[68:69], 2.0, v6
    v_subrev_co_u32 v7, s[70:71], 2.0, v7
    s_mov_b64 exec, s[64:65]
    ds_read_b64 v[28:29], v28
    s_mov_b64 exec, s[66:67]
    ds_read_b64 v[30:31], v30
    s_mov_b64 exec, s[68:69]
    ds_read_b64 v[32:33], v32
    s_mov_b64 exec, s[70:71]
    ds_read_b64 v[34:35], v34
    s_mov_b64 exec, -1
    s_waitcnt vmcnt(8)
    v_perm_b32 v36, v9, v8, s24
    v_perm_b32 v38, v10, v9, s25
    v_perm_b32 v40, v11, v10, s26
    v_perm_b32 v42, v43, v11, s27
    v_alignbyte_b32 v9, v10, v9, 1
    v_alignbyte_b32 v10, v11, v10, 2
    v_alignbyte_b32 v11, v43, v11, 3
    v_lshlrev_b32_sdwa v36, 3, v36 dst_sel:WORD_0 dst_unused:UNUSED_PAD src0_sel:DWORD src1_sel:DWORD
    v_lshlrev_b32_sdwa v38, 3, v38 dst_sel:WORD_0 dst_unused:UNUSED_PAD src0_sel:DWORD src1_sel:DWORD
    v_lshlrev_b32_sdwa v40, 3, v40 dst_sel:WORD_0 dst_unused:UNUSED_PAD src0_sel:DWORD src1_sel:DWORD
    v_lshlrev_b32_sdwa v42, 3, v42 dst_sel:WORD_0 dst_unused:UNUSED_PAD src0_sel:DWORD src1_sel:DWORD
    s_cmp_lt_i32 s42, 768
    s_cbranch_scc1 L_ufix_80
L_uback_81:

    v_subrev_co_u32 v8, s[72:73], 2.0, v8
    v_subrev_co_u32 v9, s[74:75], 2.0, v9
    v_subrev_co_u32 v10, s[76:77], 2.0, v10
    v_subrev_co_u32 v11, s[78:79], 2.0, v11
    s_mov_b64 exec, s[72:73]
    ds_read_b64 v[36:37], v36
    s_mov_b64 exec, s[74:75]
    ds_read_b64 v[38:39], v38
    s_mov_b64 exec, s[76:77]
    ds_read_b64 v[40:41], v40
    s_mov_b64 exec, s[78:79]
    ds_read_b64 v[42:43], v42
    s_mov_b64 exec, -1
    s_mov_b32 s38, s5
    s_add_u32 s50, s50, 200000
    s_branch L_batch_61
L_bend_62:

    s_waitcnt vmcnt(0)
    s_load_dwordx2 s[68:69], s[0:1], 24
    s_load_dwordx4 s[88:91], s[0:1], 72
    s_load_dwordx2 s[76:77], s[0:1], 88
    s_load_dwordx2 s[80:81], s[0:1], 96
    s_mov_b32 s70, 1600000
    s_mov_b32 s71, 0x20000
    s_mov_b32 s78, 6400000
    s_mov_b32 s79, 0x20000
    s_movk_i32 s82, 256
    s_mov_b32 s83, 0x20000
    s_lshl_b32 s48, s36, 2
    s_mov_b32 s41, s37

    s_add_u32 s84, s6, 8896512
    s_addc_u32 s85, s7, 0
    s_mov_b32 s86, 76800000
    s_mov_b32 s87, 0x20000
    s_add_u32 s72, s6, 393216
    s_addc_u32 s73, s7, 0
    s_mov_b32 s74, 2097152
    s_mov_b32 s75, 0x20000
    s_waitcnt lgkmcnt(15)
    v_mad_i32_i16 v120, v28, v4, s96
    v_mad_i32_i16 v28, v28, v4, s96 op_sel:[1,0,0,0]
    v_mad_i32_i16 v121, v29, v4, s96
    v_mad_i32_i16 v29, v29, v4, s96 op_sel:[1,0,0,0]
    v_lshlrev_b32_sdwa v4, 3, v4 dst_sel:DWORD dst_unused:UNUSED_PAD src0_sel:DWORD src1_sel:WORD_1
    v_perm_b32 v28, v28, v120, s97
    v_perm_b32 v29, v29, v121, s97
    v_lshl_add_u64 v[28:29], v[28:29], 0, s[30:31]

    ds_add_rtn_u64 v[28:29], v4, v[28:29] offset:50000
    v_mad_i32_i16 v122, v30, v5, s96
    v_mad_i32_i16 v30, v30, v5, s96 op_sel:[1,0,0,0]
    v_mad_i32_i16 v123, v31, v5, s96
    v_mad_i32_i16 v31, v31, v5, s96 op_sel:[1,0,0,0]
    v_lshlrev_b32_sdwa v5, 3, v5 dst_sel:DWORD dst_unused:UNUSED_PAD src0_sel:DWORD src1_sel:WORD_1
    v_perm_b32 v30, v30, v122, s97
    v_perm_b32 v31, v31, v123, s97
    v_lshl_add_u64 v[30:31], v[30:31], 0, s[30:31]

    ds_add_rtn_u64 v[30:31], v5, v[30:31] offset:50000
    v_mad_i32_i16 v124, v32, v6, s96
    v_mad_i32_i16 v32, v32, v6, s96 op_sel:[1,0,0,0]
    v_mad_i32_i16 v125, v33, v6, s96
    v_mad_i32_i16 v33, v33, v6, s96 op_sel:[1,0,0,0]
    v_lshlrev_b32_sdwa v6, 3, v6 dst_sel:DWORD dst_unused:UNUSED_PAD src0_sel:DWORD src1_sel:WORD_1
    v_perm_b32 v32, v32, v124, s97
    v_perm_b32 v33, v33, v125, s97
    v_lshl_add_u64 v[32:33], v[32:33], 0, s[30:31]

    ds_add_rtn_u64 v[32:33], v6, v[32:33] offset:50000
    v_mad_i32_i16 v126, v34, v7, s96
    v_mad_i32_i16 v34, v34, v7, s96 op_sel:[1,0,0,0]
    v_mad_i32_i16 v127, v35, v7, s96
    v_mad_i32_i16 v35, v35, v7, s96 op_sel:[1,0,0,0]
    v_lshlrev_b32_sdwa v7, 3, v7 dst_sel:DWORD dst_unused:UNUSED_PAD src0_sel:DWORD src1_sel:WORD_1
    v_perm_b32 v34, v34, v126, s97
    v_perm_b32 v35, v35, v127, s97
    v_lshl_add_u64 v[34:35], v[34:35], 0, s[30:31]

    ds_add_rtn_u64 v[34:35], v7, v[34:35] offset:50000
    s_waitcnt lgkmcnt(0)
    s_load_dwordx8 s[12:19], s[88:89], 0
    s_load_dwordx8 s[56:63], s[90:91], 0

    s_mul_i32 s28, s41, 3125
    s_add_u32 s29, s28, 3126
    s_add_u32 s28, s28, 1
    s_lshr_b32 s28, s28, 1
    s_lshr_b32 s29, s29, 1
    s_sub_u32 s29, s29, s28
    s_sub_u32 s5, s29, 782
    s_mul_i32 s3, s36, 6250
    v_add_u32 v78, s28, v0
    v_mov_b32 v82, 0x2000000
    v_add_u32 v79, 782, v78
    v_cmp_gt_u32 vcc, 782, v0
    v_add_u32 v76, s3, v78
    v_add_u32 v77, s3, v79
    v_cndmask_b32 v76, v82, v76, vcc
    v_cmp_gt_u32 vcc, s5, v0
    v_lshlrev_b32 v78, 4, v78
    v_lshlrev_b32 v79, 4, v79
    v_cndmask_b32 v77, v82, v77, vcc
    v_lshlrev_b32 v80, 2, v76
    v_lshlrev_b32 v76, 4, v76
    v_lshlrev_b32 v81, 2, v77
    v_lshlrev_b32 v77, 4, v77
    buffer_load_dword v80, v80, s[68:71], 0 offen
    buffer_load_dword v81, v81, s[68:71], 0 offen
    buffer_load_dwordx4 v[86:89], v76, s[8:11], 0 offen
    buffer_load_dwordx4 v[90:93], v77, s[8:11], 0 offen

    v_mad_i32_i16 v120, v36, v8, s96
    v_mad_i32_i16 v36, v36, v8, s96 op_sel:[1,0,0,0]
    v_mad_i32_i16 v121, v37, v8, s96
    v_mad_i32_i16 v37, v37, v8, s96 op_sel:[1,0,0,0]
    v_lshlrev_b32_sdwa v8, 3, v8 dst_sel:DWORD dst_unused:UNUSED_PAD src0_sel:DWORD src1_sel:WORD_1
    v_perm_b32 v36, v36, v120, s97
    v_perm_b32 v37, v37, v121, s97
    v_lshl_add_u64 v[36:37], v[36:37], 0, s[30:31]

    ds_add_rtn_u64 v[36:37], v8, v[36:37] offset:50000
    v_mad_i32_i16 v122, v38, v9, s96
    v_mad_i32_i16 v38, v38, v9, s96 op_sel:[1,0,0,0]
    v_mad_i32_i16 v123, v39, v9, s96
    v_mad_i32_i16 v39, v39, v9, s96 op_sel:[1,0,0,0]
    v_lshlrev_b32_sdwa v9, 3, v9 dst_sel:DWORD dst_unused:UNUSED_PAD src0_sel:DWORD src1_sel:WORD_1
    v_perm_b32 v38, v38, v122, s97
    v_perm_b32 v39, v39, v123, s97
    v_lshl_add_u64 v[38:39], v[38:39], 0, s[30:31]

    ds_add_rtn_u64 v[38:39], v9, v[38:39] offset:50000
    v_mad_i32_i16 v124, v40, v10, s96
    v_mad_i32_i16 v40, v40, v10, s96 op_sel:[1,0,0,0]
    v_mad_i32_i16 v125, v41, v10, s96
    v_mad_i32_i16 v41, v41, v10, s96 op_sel:[1,0,0,0]
    v_lshlrev_b32_sdwa v10, 3, v10 dst_sel:DWORD dst_unused:UNUSED_PAD src0_sel:DWORD src1_sel:WORD_1
    v_perm_b32 v40, v40, v124, s97
    v_perm_b32 v41, v41, v125, s97
    v_lshl_add_u64 v[40:41], v[40:41], 0, s[30:31]

    ds_add_rtn_u64 v[40:41], v10, v[40:41] offset:50000
    v_mad_i32_i16 v126, v42, v11, s96
    v_mad_i32_i16 v42, v42, v11, s96 op_sel:[1,0,0,0]
    v_mad_i32_i16 v127, v43, v11, s96
    v_mad_i32_i16 v43, v43, v11, s96 op_sel:[1,0,0,0]
    v_lshlrev_b32_sdwa v11, 3, v11 dst_sel:DWORD dst_unused:UNUSED_PAD src0_sel:DWORD src1_sel:WORD_1
    v_perm_b32 v42, v42, v126, s97
    v_perm_b32 v43, v43, v127, s97
    v_lshl_add_u64 v[42:43], v[42:43], 0, s[30:31]

    ds_add_rtn_u64 v[42:43], v11, v[42:43] offset:50000
    v_or3_b32 v1, v28, v29, v1
    v_or3_b32 v1, v30, v31, v1
    v_or3_b32 v1, v32, v33, v1
    v_or3_b32 v1, v34, v35, v1
    v_mad_i32_i16 v120, v44, v12, s96
    v_mad_i32_i16 v44, v44, v12, s96 op_sel:[1,0,0,0]
    v_mad_i32_i16 v121, v45, v12, s96
    v_mad_i32_i16 v45, v45, v12, s96 op_sel:[1,0,0,0]
    v_lshlrev_b32_sdwa v12, 3, v12 dst_sel:DWORD dst_unused:UNUSED_PAD src0_sel:DWORD src1_sel:WORD_1
    v_perm_b32 v44, v44, v120, s97
    v_perm_b32 v45, v45, v121, s97
    v_lshl_add_u64 v[44:45], v[44:45], 0, s[30:31]

    ds_add_rtn_u64 v[44:45], v12, v[44:45] offset:50000
    v_mad_i32_i16 v122, v46, v13, s96
    v_mad_i32_i16 v46, v46, v13, s96 op_sel:[1,0,0,0]
    v_mad_i32_i16 v123, v47, v13, s96
    v_mad_i32_i16 v47, v47, v13, s96 op_sel:[1,0,0,0]
    v_lshlrev_b32_sdwa v13, 3, v13 dst_sel:DWORD dst_unused:UNUSED_PAD src0_sel:DWORD src1_sel:WORD_1
    v_perm_b32 v46, v46, v122, s97
    v_perm_b32 v47, v47, v123, s97
    v_lshl_add_u64 v[46:47], v[46:47], 0, s[30:31]

    ds_add_rtn_u64 v[46:47], v13, v[46:47] offset:50000
    v_mad_i32_i16 v124, v48, v14, s96
    v_mad_i32_i16 v48, v48, v14, s96 op_sel:[1,0,0,0]
    v_mad_i32_i16 v125, v49, v14, s96
    v_mad_i32_i16 v49, v49, v14, s96 op_sel:[1,0,0,0]
    v_lshlrev_b32_sdwa v14, 3, v14 dst_sel:DWORD dst_unused:UNUSED_PAD src0_sel:DWORD src1_sel:WORD_1
    v_perm_b32 v48, v48, v124, s97
    v_perm_b32 v49, v49, v125, s97
    v_lshl_add_u64 v[48:49], v[48:49], 0, s[30:31]

    ds_add_rtn_u64 v[48:49], v14, v[48:49] offset:50000
    v_mad_i32_i16 v126, v50, v15, s96
    v_mad_i32_i16 v50, v50, v15, s96 op_sel:[1,0,0,0]
    v_mad_i32_i16 v127, v51, v15, s96
    v_mad_i32_i16 v51, v51, v15, s96 op_sel:[1,0,0,0]
    v_lshlrev_b32_sdwa v15, 3, v15 dst_sel:DWORD dst_unused:UNUSED_PAD src0_sel:DWORD src1_sel:WORD_1
    v_perm_b32 v50, v50, v126, s97
    v_perm_b32 v51, v51, v127, s97
    v_lshl_add_u64 v[50:51], v[50:51], 0, s[30:31]

    ds_add_rtn_u64 v[50:51], v15, v[50:51] offset:50000
    s_waitcnt lgkmcnt(4)
    v_or3_b32 v1, v36, v37, v1
    v_or3_b32 v1, v38, v39, v1
    v_or3_b32 v1, v40, v41, v1
    v_or3_b32 v1, v42, v43, v1
    v_mad_i32_i16 v120, v52, v16, s96
    v_mad_i32_i16 v52, v52, v16, s96 op_sel:[1,0,0,0]
    v_mad_i32_i16 v121, v53, v16, s96
    v_mad_i32_i16 v53, v53, v16, s96 op_sel:[1,0,0,0]
    v_lshlrev_b32_sdwa v16, 3, v16 dst_sel:DWORD dst_unused:UNUSED_PAD src0_sel:DWORD src1_sel:WORD_1
    v_perm_b32 v52, v52, v120, s97
    v_perm_b32 v53, v53, v121, s97
    v_lshl_add_u64 v[52:53], v[52:53], 0, s[30:31]

    ds_add_rtn_u64 v[52:53], v16, v[52:53] offset:50000
    v_mad_i32_i16 v122, v54, v17, s96
    v_mad_i32_i16 v54, v54, v17, s96 op_sel:[1,0,0,0]
    v_mad_i32_i16 v123, v55, v17, s96
    v_mad_i32_i16 v55, v55, v17, s96 op_sel:[1,0,0,0]
    v_lshlrev_b32_sdwa v17, 3, v17 dst_sel:DWORD dst_unused:UNUSED_PAD src0_sel:DWORD src1_sel:WORD_1
    v_perm_b32 v54, v54, v122, s97
    v_perm_b32 v55, v55, v123, s97
    v_lshl_add_u64 v[54:55], v[54:55], 0, s[30:31]

    ds_add_rtn_u64 v[54:55], v17, v[54:55] offset:50000
    v_mad_i32_i16 v124, v56, v18, s96
    v_mad_i32_i16 v56, v56, v18, s96 op_sel:[1,0,0,0]
    v_mad_i32_i16 v125, v57, v18, s96
    v_mad_i32_i16 v57, v57, v18, s96 op_sel:[1,0,0,0]
    v_lshlrev_b32_sdwa v18, 3, v18 dst_sel:DWORD dst_unused:UNUSED_PAD src0_sel:DWORD src1_sel:WORD_1
    v_perm_b32 v56, v56, v124, s97
    v_perm_b32 v57, v57, v125, s97
    v_lshl_add_u64 v[56:57], v[56:57], 0, s[30:31]

    ds_add_rtn_u64 v[56:57], v18, v[56:57] offset:50000
    v_mad_i32_i16 v126, v58, v19, s96
    v_mad_i32_i16 v58, v58, v19, s96 op_sel:[1,0,0,0]
    v_mad_i32_i16 v127, v59, v19, s96
    v_mad_i32_i16 v59, v59, v19, s96 op_sel:[1,0,0,0]
    v_lshlrev_b32_sdwa v19, 3, v19 dst_sel:DWORD dst_unused:UNUSED_PAD src0_sel:DWORD src1_sel:WORD_1
    v_perm_b32 v58, v58, v126, s97
    v_perm_b32 v59, v59, v127, s97
    v_lshl_add_u64 v[58:59], v[58:59], 0, s[30:31]

    ds_add_rtn_u64 v[58:59], v19, v[58:59] offset:50000
    s_waitcnt lgkmcnt(4)
    v_or3_b32 v1, v44, v45, v1
    v_or3_b32 v1, v46, v47, v1
    v_or3_b32 v1, v48, v49, v1
    v_or3_b32 v1, v50, v51, v1
    s_waitcnt vmcnt(2)
    v_lshlrev_b32_sdwa v82, 5, v80 dst_sel:DWORD dst_unused:UNUSED_PAD src0_sel:DWORD src1_sel:WORD_0
    v_lshlrev_b32_sdwa v83, 5, v80 dst_sel:DWORD dst_unused:UNUSED_PAD src0_sel:DWORD src1_sel:WORD_1
    v_lshlrev_b32_sdwa v84, 5, v81 dst_sel:DWORD dst_unused:UNUSED_PAD src0_sel:DWORD src1_sel:WORD_0
    v_lshlrev_b32_sdwa v85, 5, v81 dst_sel:DWORD dst_unused:UNUSED_PAD src0_sel:DWORD src1_sel:WORD_1
    buffer_load_dwordx4 v[94:97], v82, s[72:75], 0 offen
    buffer_load_dwordx2 v[110:111], v82, s[72:75], 0 offen offset:16

    buffer_load_dwordx4 v[98:101], v83, s[72:75], 0 offen
    buffer_load_dwordx2 v[112:113], v83, s[72:75], 0 offen offset:16

    buffer_load_dwordx4 v[102:105], v84, s[72:75], 0 offen
    buffer_load_dwordx2 v[114:115], v84, s[72:75], 0 offen offset:16

    buffer_load_dwordx4 v[106:109], v85, s[72:75], 0 offen
    buffer_load_dwordx2 v[116:117], v85, s[72:75], 0 offen offset:16

    v_mad_i32_i16 v120, v60, v20, s96
    v_mad_i32_i16 v60, v60, v20, s96 op_sel:[1,0,0,0]
    v_mad_i32_i16 v121, v61, v20, s96
    v_mad_i32_i16 v61, v61, v20, s96 op_sel:[1,0,0,0]
    v_lshlrev_b32_sdwa v20, 3, v20 dst_sel:DWORD dst_unused:UNUSED_PAD src0_sel:DWORD src1_sel:WORD_1
    v_perm_b32 v60, v60, v120, s97
    v_perm_b32 v61, v61, v121, s97
    v_lshl_add_u64 v[60:61], v[60:61], 0, s[30:31]

    ds_add_rtn_u64 v[60:61], v20, v[60:61] offset:50000
    v_mad_i32_i16 v122, v62, v21, s96
    v_mad_i32_i16 v62, v62, v21, s96 op_sel:[1,0,0,0]
    v_mad_i32_i16 v123, v63, v21, s96
    v_mad_i32_i16 v63, v63, v21, s96 op_sel:[1,0,0,0]
    v_lshlrev_b32_sdwa v21, 3, v21 dst_sel:DWORD dst_unused:UNUSED_PAD src0_sel:DWORD src1_sel:WORD_1
    v_perm_b32 v62, v62, v122, s97
    v_perm_b32 v63, v63, v123, s97
    v_lshl_add_u64 v[62:63], v[62:63], 0, s[30:31]

    ds_add_rtn_u64 v[62:63], v21, v[62:63] offset:50000
    v_mad_i32_i16 v124, v64, v22, s96
    v_mad_i32_i16 v64, v64, v22, s96 op_sel:[1,0,0,0]
    v_mad_i32_i16 v125, v65, v22, s96
    v_mad_i32_i16 v65, v65, v22, s96 op_sel:[1,0,0,0]
    v_lshlrev_b32_sdwa v22, 3, v22 dst_sel:DWORD dst_unused:UNUSED_PAD src0_sel:DWORD src1_sel:WORD_1
    v_perm_b32 v64, v64, v124, s97
    v_perm_b32 v65, v65, v125, s97
    v_lshl_add_u64 v[64:65], v[64:65], 0, s[30:31]

    ds_add_rtn_u64 v[64:65], v22, v[64:65] offset:50000
    v_mad_i32_i16 v126, v66, v23, s96
    v_mad_i32_i16 v66, v66, v23, s96 op_sel:[1,0,0,0]
    v_mad_i32_i16 v127, v67, v23, s96
    v_mad_i32_i16 v67, v67, v23, s96 op_sel:[1,0,0,0]
    v_lshlrev_b32_sdwa v23, 3, v23 dst_sel:DWORD dst_unused:UNUSED_PAD src0_sel:DWORD src1_sel:WORD_1
    v_perm_b32 v66, v66, v126, s97
    v_perm_b32 v67, v67, v127, s97
    v_lshl_add_u64 v[66:67], v[66:67], 0, s[30:31]

    ds_add_rtn_u64 v[66:67], v23, v[66:67] offset:50000
    s_waitcnt lgkmcnt(4)
    v_or3_b32 v1, v52, v53, v1
    v_or3_b32 v1, v54, v55, v1
    v_or3_b32 v1, v56, v57, v1
    v_or3_b32 v1, v58, v59, v1
    v_mad_i32_i16 v120, v68, v24, s96
    v_mad_i32_i16 v68, v68, v24, s96 op_sel:[1,0,0,0]
    v_mad_i32_i16 v121, v69, v24, s96
    v_mad_i32_i16 v69, v69, v24, s96 op_sel:[1,0,0,0]
    v_lshlrev_b32_sdwa v24, 3, v24 dst_sel:DWORD dst_unused:UNUSED_PAD src0_sel:DWORD src1_sel:WORD_1
    v_perm_b32 v68, v68, v120, s97
    v_perm_b32 v69, v69, v121, s97
    v_lshl_add_u64 v[68:69], v[68:69], 0, s[30:31]

    ds_add_rtn_u64 v[68:69], v24, v[68:69] offset:50000
    v_mad_i32_i16 v122, v70, v25, s96
    v_mad_i32_i16 v70, v70, v25, s96 op_sel:[1,0,0,0]
    v_mad_i32_i16 v123, v71, v25, s96
    v_mad_i32_i16 v71, v71, v25, s96 op_sel:[1,0,0,0]
    v_lshlrev_b32_sdwa v25, 3, v25 dst_sel:DWORD dst_unused:UNUSED_PAD src0_sel:DWORD src1_sel:WORD_1
    v_perm_b32 v70, v70, v122, s97
    v_perm_b32 v71, v71, v123, s97
    v_lshl_add_u64 v[70:71], v[70:71], 0, s[30:31]

    ds_add_rtn_u64 v[70:71], v25, v[70:71] offset:50000
    v_mad_i32_i16 v124, v72, v26, s96
    v_mad_i32_i16 v72, v72, v26, s96 op_sel:[1,0,0,0]
    v_mad_i32_i16 v125, v73, v26, s96
    v_mad_i32_i16 v73, v73, v26, s96 op_sel:[1,0,0,0]
    v_lshlrev_b32_sdwa v26, 3, v26 dst_sel:DWORD dst_unused:UNUSED_PAD src0_sel:DWORD src1_sel:WORD_1
    v_perm_b32 v72, v72, v124, s97
    v_perm_b32 v73, v73, v125, s97
    v_lshl_add_u64 v[72:73], v[72:73], 0, s[30:31]

    ds_add_rtn_u64 v[72:73], v26, v[72:73] offset:50000
    v_mad_i32_i16 v126, v74, v27, s96
    v_mad_i32_i16 v74, v74, v27, s96 op_sel:[1,0,0,0]
    v_mad_i32_i16 v127, v75, v27, s96
    v_mad_i32_i16 v75, v75, v27, s96 op_sel:[1,0,0,0]
    v_lshlrev_b32_sdwa v27, 3, v27 dst_sel:DWORD dst_unused:UNUSED_PAD src0_sel:DWORD src1_sel:WORD_1
    v_perm_b32 v74, v74, v126, s97
    v_perm_b32 v75, v75, v127, s97
    v_lshl_add_u64 v[74:75], v[74:75], 0, s[30:31]

    ds_add_rtn_u64 v[74:75], v27, v[74:75] offset:50000
    s_waitcnt lgkmcnt(4)
    v_or3_b32 v1, v60, v61, v1
    v_or3_b32 v1, v62, v63, v1
    v_or3_b32 v1, v64, v65, v1
    v_or3_b32 v1, v66, v67, v1
    s_waitcnt lgkmcnt(0)
    v_or3_b32 v1, v68, v69, v1
    v_or3_b32 v1, v70, v71, v1
    v_or3_b32 v1, v72, v73, v1
    v_or3_b32 v1, v74, v75, v1
    s_barrier

    v_add_u32 v40, 50000, v3
    v_add_u32 v41, 115536, v3
    v_cmp_gt_u32 vcc, 106, v0

    v_mov_b32 v28, 0
    v_mov_b32 v29, 0
    v_mov_b32 v30, 0
    v_mov_b32 v31, 0
    ds_read_b128 v[4:7], v40 offset:0
    ds_read_b128 v[8:11], v40 offset:16384
    ds_read_b128 v[12:15], v40 offset:32768
    ds_read_b128 v[16:19], v40 offset:49152
    ds_read_b128 v[20:23], v41 offset:0
    ds_read_b128 v[24:27], v41 offset:16384
    s_mov_b64 exec, vcc
    ds_read_b128 v[28:31], v41 offset:32768
    s_mov_b64 exec, -1
    s_mul_i32 s3, s37, 6400000
    s_mul_i32 s5, s36, 100000
    s_add_u32 s3, s3, s5
    s_add_u32 s3, s3, 8896512
    v_bfrev_b32 v42, 1

    s_add_u32 s20, s6, s3
    s_addc_u32 s21, s7, 0
    s_mov_b32 s22, 100000
    s_mov_b32 s23, 0x20000
    s_sub_u32 s3, 0, s28
    v_add_u32 v43, s3, v0
    v_cmp_gt_u32 vcc, s29, v43
    s_mov_b32 s3, 0
    s_waitcnt lgkmcnt(6)
    v_cndmask_b32 v43, v3, v42, vcc
    buffer_store_dwordx4 v[4:7], v43, s[20:23], s3 offen sc1

    s_sub_u32 s3, 1024, s28
    v_add_u32 v43, s3, v0
    v_cmp_gt_u32 vcc, s29, v43
    s_mov_b32 s3, 16384
    s_waitcnt lgkmcnt(5)
    v_cndmask_b32 v43, v3, v42, vcc
    buffer_store_dwordx4 v[8:11], v43, s[20:23], s3 offen sc1

    s_sub_u32 s3, 2048, s28
    v_add_u32 v43, s3, v0
    v_cmp_gt_u32 vcc, s29, v43
    s_mov_b32 s3, 32768
    s_waitcnt lgkmcnt(4)
    v_cndmask_b32 v43, v3, v42, vcc
    buffer_store_dwordx4 v[12:15], v43, s[20:23], s3 offen sc1

    s_sub_u32 s3, 3072, s28
    v_add_u32 v43, s3, v0
    v_cmp_gt_u32 vcc, s29, v43
    s_mov_b32 s3, 49152
    s_waitcnt lgkmcnt(3)
    v_cndmask_b32 v43, v3, v42, vcc
    buffer_store_dwordx4 v[16:19], v43, s[20:23], s3 offen sc1

    s_sub_u32 s3, 4096, s28
    v_add_u32 v43, s3, v0
    v_cmp_gt_u32 vcc, s29, v43
    s_mov_b32 s3, 65536
    s_waitcnt lgkmcnt(2)
    v_cndmask_b32 v43, v3, v42, vcc
    buffer_store_dwordx4 v[20:23], v43, s[20:23], s3 offen sc1

    s_sub_u32 s3, 5120, s28
    v_add_u32 v43, s3, v0
    v_cmp_gt_u32 vcc, s29, v43
    s_mov_b32 s3, 81920
    s_waitcnt lgkmcnt(1)
    v_cndmask_b32 v43, v3, v42, vcc
    buffer_store_dwordx4 v[24:27], v43, s[20:23], s3 offen sc1

    s_sub_u32 s3, 6144, s28
    v_add_u32 v43, s3, v0
    v_cmp_gt_u32 vcc, s29, v43
    s_mov_b32 s3, 98304
    s_waitcnt lgkmcnt(0)
    v_cndmask_b32 v43, v3, v42, vcc
    buffer_store_dwordx4 v[28:31], v43, s[20:23], s3 offen sc1

    v_or3_b32 v1, v4, v5, v1
    v_or3_b32 v1, v6, v7, v1
    v_or3_b32 v1, v8, v9, v1
    v_or3_b32 v1, v10, v11, v1
    v_or3_b32 v1, v12, v13, v1
    v_or3_b32 v1, v14, v15, v1
    v_or3_b32 v1, v16, v17, v1
    v_or3_b32 v1, v18, v19, v1
    v_or3_b32 v1, v20, v21, v1
    v_or3_b32 v1, v22, v23, v1
    v_or3_b32 v1, v24, v25, v1
    v_or3_b32 v1, v26, v27, v1
    v_or3_b32 v1, v28, v29, v1
    v_or3_b32 v1, v30, v31, v1
    v_and_b32 v1, 0x80008000, v1
    v_cmp_ne_u32 vcc, 0, v1
    v_mov_b32 v40, 150024
    v_mov_b32 v41, 1
    s_cbranch_vccz L_nf_82
    ds_write_b32 v40, v41
L_nf_82:
    s_mov_b32 s33, 1
    s_mov_b32 s49, s37
    s_waitcnt vmcnt(0) lgkmcnt(0)

    s_barrier
    ds_read_b32 v41, v40
    s_waitcnt lgkmcnt(0)
    v_readfirstlane_b32 s3, v41
    s_nop 1
    s_cmp_lg_u32 s3, 0
    s_cbranch_scc1 L_p2slow_48

L_meet_84:
    v_readfirstlane_b32 s3, v0
    v_mov_b32 v118, 150016
    s_nop 0
    s_cmp_eq_u32 s3, 960
    s_cbranch_scc1 L_sync_91
L_bcast_86:
    s_barrier

    ds_read_b32 v119, v118
    s_waitcnt lgkmcnt(0)
    v_readfirstlane_b32 s35, v119
    s_nop 1
    s_bitcmp1_b32 s35, 16
    s_cbranch_scc1 L_fend_92
L_post_88:
    v_cmp_gt_u32 vcc, 782, v0
    s_mov_b64 exec, vcc
    s_cbranch_execz L_postend_89

    s_cmp_eq_u32 s49, 0
    s_cbranch_scc1 L_own_98
    s_mov_b32 s3, 0
    buffer_load_dwordx4 v[36:39], v76, s[84:87], s3 offen sc1
    buffer_load_dwordx4 v[52:55], v77, s[84:87], s3 offen sc1
L_obk_99:
    s_cmp_eq_u32 s49, 1
    s_cbranch_scc1 L_own_100
    s_mov_b32 s3, 6400000
    buffer_load_dwordx4 v[40:43], v76, s[84:87], s3 offen sc1
    buffer_load_dwordx4 v[56:59], v77, s[84:87], s3 offen sc1
L_obk_101:
    s_cmp_eq_u32 s49, 2
    s_cbranch_scc1 L_own_102
    s_mov_b32 s3, 12800000
    buffer_load_dwordx4 v[44:47], v76, s[84:87], s3 offen sc1
    buffer_load_dwordx4 v[60:63], v77, s[84:87], s3 offen sc1
L_obk_103:
    s_cmp_eq_u32 s49, 3
    s_cbranch_scc1 L_own_104
    s_mov_b32 s3, 19200000
    buffer_load_dwordx4 v[48:51], v76, s[84:87], s3 offen sc1
    buffer_load_dwordx4 v[64:67], v77, s[84:87], s3 offen sc1
L_obk_105:
    s_and_b32 s3, s35, 0xf0
    s_waitcnt vmcnt(0) lgkmcnt(0)
    s_cbranch_scc1 L_fgen_106

    v_add_u32 v36, v36, v40
    v_add_u32 v44, v44, v48
    v_add_u32 v37, v37, v41
    v_add_u32 v45, v45, v49
    v_add_u32 v38, v38, v42
    v_add_u32 v46, v46, v50
    v_add_u32 v39, v39, v43
    v_add_u32 v47, v47, v51
    v_add_u32_sdwa v4, v36, v44 dst_sel:DWORD dst_unused:UNUSED_PAD src0_sel:WORD_0 src1_sel:WORD_0
    v_add_u32_sdwa v5, v36, v44 dst_sel:DWORD dst_unused:UNUSED_PAD src0_sel:WORD_1 src1_sel:WORD_1
    v_add_u32_sdwa v6, v37, v45 dst_sel:DWORD dst_unused:UNUSED_PAD src0_sel:WORD_0 src1_sel:WORD_0
    v_add_u32_sdwa v7, v37, v45 dst_sel:DWORD dst_unused:UNUSED_PAD src0_sel:WORD_1 src1_sel:WORD_1
    v_add_u32_sdwa v8, v38, v46 dst_sel:DWORD dst_unused:UNUSED_PAD src0_sel:WORD_0 src1_sel:WORD_0
    v_add_u32_sdwa v9, v38, v46 dst_sel:DWORD dst_unused:UNUSED_PAD src0_sel:WORD_1 src1_sel:WORD_1
    v_add_u32_sdwa v10, v39, v47 dst_sel:DWORD dst_unused:UNUSED_PAD src0_sel:WORD_0 src1_sel:WORD_0
    v_add_u32_sdwa v11, v39, v47 dst_sel:DWORD dst_unused:UNUSED_PAD src0_sel:WORD_1 src1_sel:WORD_1
    v_add_u32 v52, v52, v56
    v_add_u32 v60, v60, v64
    v_add_u32 v53, v53, v57
    v_add_u32 v61, v61, v65
    v_add_u32 v54, v54, v58
    v_add_u32 v62, v62, v66
    v_add_u32 v55, v55, v59
    v_add_u32 v63, v63, v67
    v_add_u32_sdwa v12, v52, v60 dst_sel:DWORD dst_unused:UNUSED_PAD src0_sel:WORD_0 src1_sel:WORD_0
    v_add_u32_sdwa v13, v52, v60 dst_sel:DWORD dst_unused:UNUSED_PAD src0_sel:WORD_1 src1_sel:WORD_1
    v_add_u32_sdwa v14, v53, v61 dst_sel:DWORD dst_unused:UNUSED_PAD src0_sel:WORD_0 src1_sel:WORD_0
    v_add_u32_sdwa v15, v53, v61 dst_sel:DWORD dst_unused:UNUSED_PAD src0_sel:WORD_1 src1_sel:WORD_1
    v_add_u32_sdwa v16, v54, v62 dst_sel:DWORD dst_unused:UNUSED_PAD src0_sel:WORD_0 src1_sel:WORD_0
    v_add_u32_sdwa v17, v54, v62 dst_sel:DWORD dst_unused:UNUSED_PAD src0_sel:WORD_1 src1_sel:WORD_1
    v_add_u32_sdwa v18, v55, v63 dst_sel:DWORD dst_unused:UNUSED_PAD src0_sel:WORD_0 src1_sel:WORD_0
    v_add_u32_sdwa v19, v55, v63 dst_sel:DWORD dst_unused:UNUSED_PAD src0_sel:WORD_1 src1_sel:WORD_1
    v_add_u32 v4, 0xffff0000, v4
    v_add_u32 v5, 0xffff0000, v5
    v_add_u32 v6, 0xffff0000, v6
    v_add_u32 v7, 0xffff0000, v7
    v_add_u32 v8, 0xffff0000, v8
    v_add_u32 v9, 0xffff0000, v9
    v_add_u32 v10, 0xffff0000, v10
    v_add_u32 v11, 0xffff0000, v11
    v_add_u32 v12, 0xffff0000, v12
    v_add_u32 v13, 0xffff0000, v13
    v_add_u32 v14, 0xffff0000, v14
    v_add_u32 v15, 0xffff0000, v15
    v_add_u32 v16, 0xffff0000, v16
    v_add_u32 v17, 0xffff0000, v17
    v_add_u32 v18, 0xffff0000, v18
    v_add_u32 v19, 0xffff0000, v19
    v_cvt_f32_i32 v4, v4
    v_cvt_f32_i32 v5, v5
    v_cvt_f32_i32 v6, v6
    v_cvt_f32_i32 v7, v7
    v_cvt_f32_i32 v8, v8
    v_cvt_f32_i32 v9, v9
    v_cvt_f32_i32 v10, v10
    v_cvt_f32_i32 v11, v11
    v_cvt_f32_i32 v12, v12
    v_cvt_f32_i32 v13, v13
    v_cvt_f32_i32 v14, v14
    v_cvt_f32_i32 v15, v15
    v_cvt_f32_i32 v16, v16
    v_cvt_f32_i32 v17, v17
    v_cvt_f32_i32 v18, v18
    v_cvt_f32_i32 v19, v19
    v_mul_f32 v4, s34, v4
    v_mul_f32 v5, s34, v5
    v_mul_f32 v6, s34, v6
    v_mul_f32 v7, s34, v7
    v_mul_f32 v8, s34, v8
    v_mul_f32 v9, s34, v9
    v_mul_f32 v10, s34, v10
    v_mul_f32 v11, s34, v11
    v_mul_f32 v12, s34, v12
    v_mul_f32 v13, s34, v13
    v_mul_f32 v14, s34, v14
    v_mul_f32 v15, s34, v15
    v_mul_f32 v16, s34, v16
    v_mul_f32 v17, s34, v17
    v_mul_f32 v18, s34, v18
    v_mul_f32 v19, s34, v19
L_fbk_107:
    s_lshl_b32 s52, s12, 16
    v_mul_f32 v20, s52, v4
    v_mul_f32 v24, s52, v8
    v_mul_f32 v28, s52, v12
    v_mul_f32 v32, s52, v16
    s_and_b32 s53, s12, s32
    v_mul_f32 v21, s53, v4
    v_mul_f32 v25, s53, v8
    v_mul_f32 v29, s53, v12
    v_mul_f32 v33, s53, v16
    s_lshl_b32 s52, s13, 16
    v_mul_f32 v22, s52, v4
    v_mul_f32 v26, s52, v8
    v_mul_f32 v30, s52, v12
    v_mul_f32 v34, s52, v16
    s_and_b32 s53, s13, s32
    v_mul_f32 v23, s53, v4
    v_mul_f32 v27, s53, v8
    v_mul_f32 v31, s53, v12
    v_mul_f32 v35, s53, v16
    s_lshl_b32 s52, s14, 16
    v_fmac_f32 v20, s52, v5
    v_fmac_f32 v24, s52, v9
    v_fmac_f32 v28, s52, v13
    v_fmac_f32 v32, s52, v17
    s_and_b32 s53, s14, s32
    v_fmac_f32 v21, s53, v5
    v_fmac_f32 v25, s53, v9
    v_fmac_f32 v29, s53, v13
    v_fmac_f32 v33, s53, v17
    s_lshl_b32 s52, s15, 16
    v_fmac_f32 v22, s52, v5
    v_fmac_f32 v26, s52, v9
    v_fmac_f32 v30, s52, v13
    v_fmac_f32 v34, s52, v17
    s_and_b32 s53, s15, s32
    v_fmac_f32 v23, s53, v5
    v_fmac_f32 v27, s53, v9
    v_fmac_f32 v31, s53, v13
    v_fmac_f32 v35, s53, v17
    s_lshl_b32 s52, s16, 16
    v_fmac_f32 v20, s52, v6
    v_fmac_f32 v24, s52, v10
    v_fmac_f32 v28, s52, v14
    v_fmac_f32 v32, s52, v18
    s_and_b32 s53, s16, s32
    v_fmac_f32 v21, s53, v6
    v_fmac_f32 v25, s53, v10
    v_fmac_f32 v29, s53, v14
    v_fmac_f32 v33, s53, v18
    s_lshl_b32 s52, s17, 16
    v_fmac_f32 v22, s52, v6
    v_fmac_f32 v26, s52, v10
    v_fmac_f32 v30, s52, v14
    v_fmac_f32 v34, s52, v18
    s_and_b32 s53, s17, s32
    v_fmac_f32 v23, s53, v6
    v_fmac_f32 v27, s53, v10
    v_fmac_f32 v31, s53, v14
    v_fmac_f32 v35, s53, v18
    s_lshl_b32 s52, s18, 16
    v_fmac_f32 v20, s52, v7
    v_fmac_f32 v24, s52, v11
    v_fmac_f32 v28, s52, v15
    v_fmac_f32 v32, s52, v19
    s_and_b32 s53, s18, s32
    v_fmac_f32 v21, s53, v7
    v_fmac_f32 v25, s53, v11
    v_fmac_f32 v29, s53, v15
    v_fmac_f32 v33, s53, v19
    s_lshl_b32 s52, s19, 16
    v_fmac_f32 v22, s52, v7
    v_fmac_f32 v26, s52, v11
    v_fmac_f32 v30, s52, v15
    v_fmac_f32 v34, s52, v19
    s_and_b32 s53, s19, s32
    v_fmac_f32 v23, s53, v7
    v_fmac_f32 v27, s53, v11
    v_fmac_f32 v31, s53, v15
    v_fmac_f32 v35, s53, v19
    v_mul_f32 v20, v20, v94
    v_mul_f32 v21, v21, v95
    v_mul_f32 v22, v22, v96
    v_mul_f32 v23, v23, v97
    v_mul_f32 v24, v24, v98
    v_mul_f32 v25, v25, v99
    v_mul_f32 v26, v26, v100
    v_mul_f32 v27, v27, v101
    v_mul_f32 v28, v28, v102
    v_mul_f32 v29, v29, v103
    v_mul_f32 v30, v30, v104
    v_mul_f32 v31, v31, v105
    v_mul_f32 v32, v32, v106
    v_mul_f32 v33, v33, v107
    v_mul_f32 v34, v34, v108
    v_mul_f32 v35, v35, v109
    v_cvt_pk_bf16_f32 v20, v20, v21
    v_cvt_pk_bf16_f32 v22, v22, v23
    v_cvt_pk_bf16_f32 v24, v24, v25
    v_cvt_pk_bf16_f32 v26, v26, v27
    v_cvt_pk_bf16_f32 v28, v28, v29
    v_cvt_pk_bf16_f32 v30, v30, v31
    v_cvt_pk_bf16_f32 v32, v32, v33
    v_cvt_pk_bf16_f32 v34, v34, v35
    s_pack_ll_b32_b16 s52, s56, s58
    v_dot2_f32_bf16 v4, v20, s52, 0
    v_dot2_f32_bf16 v8, v24, s52, 0
    v_dot2_f32_bf16 v12, v28, s52, 0
    v_dot2_f32_bf16 v16, v32, s52, 0
    s_pack_hh_b32_b16 s53, s56, s58
    v_dot2_f32_bf16 v5, v20, s53, 0
    v_dot2_f32_bf16 v9, v24, s53, 0
    v_dot2_f32_bf16 v13, v28, s53, 0
    v_dot2_f32_bf16 v17, v32, s53, 0
    s_pack_ll_b32_b16 s52, s57, s59
    v_dot2_f32_bf16 v6, v20, s52, 0
    v_dot2_f32_bf16 v10, v24, s52, 0
    v_dot2_f32_bf16 v14, v28, s52, 0
    v_dot2_f32_bf16 v18, v32, s52, 0
    s_pack_hh_b32_b16 s53, s57, s59
    v_dot2_f32_bf16 v7, v20, s53, 0
    v_dot2_f32_bf16 v11, v24, s53, 0
    v_dot2_f32_bf16 v15, v28, s53, 0
    v_dot2_f32_bf16 v19, v32, s53, 0
    s_pack_ll_b32_b16 s52, s60, s62
    v_dot2_f32_bf16 v4, v22, s52, v4
    v_dot2_f32_bf16 v8, v26, s52, v8
    v_dot2_f32_bf16 v12, v30, s52, v12
    v_dot2_f32_bf16 v16, v34, s52, v16
    s_pack_hh_b32_b16 s53, s60, s62
    v_dot2_f32_bf16 v5, v22, s53, v5
    v_dot2_f32_bf16 v9, v26, s53, v9
    v_dot2_f32_bf16 v13, v30, s53, v13
    v_dot2_f32_bf16 v17, v34, s53, v17
    s_pack_ll_b32_b16 s52, s61, s63
    v_dot2_f32_bf16 v6, v22, s52, v6
    v_dot2_f32_bf16 v10, v26, s52, v10
    v_dot2_f32_bf16 v14, v30, s52, v14
    v_dot2_f32_bf16 v18, v34, s52, v18
    s_pack_hh_b32_b16 s53, s61, s63
    v_dot2_f32_bf16 v7, v22, s53, v7
    v_dot2_f32_bf16 v11, v26, s53, v11
    v_dot2_f32_bf16 v15, v30, s53, v15
    v_dot2_f32_bf16 v19, v34, s53, v19
    v_lshlrev_b32 v36, 16, v86
    v_and_b32 v37, s32, v86
    v_lshlrev_b32 v52, 16, v110
    v_and_b32 v53, s32, v110
    v_lshlrev_b32 v38, 16, v87
    v_and_b32 v39, s32, v87
    v_lshlrev_b32 v54, 16, v111
    v_and_b32 v55, s32, v111
    v_lshlrev_b32 v40, 16, v88
    v_and_b32 v41, s32, v88
    v_lshlrev_b32 v56, 16, v112
    v_and_b32 v57, s32, v112
    v_lshlrev_b32 v42, 16, v89
    v_and_b32 v43, s32, v89
    v_lshlrev_b32 v58, 16, v113
    v_and_b32 v59, s32, v113
    v_lshlrev_b32 v44, 16, v90
    v_and_b32 v45, s32, v90
    v_lshlrev_b32 v60, 16, v114
    v_and_b32 v61, s32, v114
    v_lshlrev_b32 v46, 16, v91
    v_and_b32 v47, s32, v91
    v_lshlrev_b32 v62, 16, v115
    v_and_b32 v63, s32, v115
    v_lshlrev_b32 v48, 16, v92
    v_and_b32 v49, s32, v92
    v_lshlrev_b32 v64, 16, v116
    v_and_b32 v65, s32, v116
    v_lshlrev_b32 v50, 16, v93
    v_and_b32 v51, s32, v93
    v_lshlrev_b32 v66, 16, v117
    v_and_b32 v67, s32, v117
    v_cvt_pk_bf16_f32 v4, v4, v5
    v_cvt_pk_bf16_f32 v6, v6, v7
    v_cvt_pk_bf16_f32 v8, v8, v9
    v_cvt_pk_bf16_f32 v10, v10, v11
    v_cvt_pk_bf16_f32 v12, v12, v13
    v_cvt_pk_bf16_f32 v14, v14, v15
    v_cvt_pk_bf16_f32 v16, v16, v17
    v_cvt_pk_bf16_f32 v18, v18, v19
    v_and_b32 v5, s32, v4
    v_lshlrev_b32 v4, 16, v4
    v_and_b32 v7, s32, v6
    v_lshlrev_b32 v6, 16, v6
    v_and_b32 v9, s32, v8
    v_lshlrev_b32 v8, 16, v8
    v_and_b32 v11, s32, v10
    v_lshlrev_b32 v10, 16, v10
    v_and_b32 v13, s32, v12
    v_lshlrev_b32 v12, 16, v12
    v_and_b32 v15, s32, v14
    v_lshlrev_b32 v14, 16, v14
    v_and_b32 v17, s32, v16
    v_lshlrev_b32 v16, 16, v16
    v_and_b32 v19, s32, v18
    v_lshlrev_b32 v18, 16, v18
    v_mul_f32 v4, v4, v52
    v_mul_f32 v5, v5, v53
    v_mul_f32 v6, v6, v54
    v_mul_f32 v7, v7, v55
    v_mul_f32 v8, v8, v56
    v_mul_f32 v9, v9, v57
    v_mul_f32 v10, v10, v58
    v_mul_f32 v11, v11, v59
    v_mul_f32 v12, v12, v60
    v_mul_f32 v13, v13, v61
    v_mul_f32 v14, v14, v62
    v_mul_f32 v15, v15, v63
    v_mul_f32 v16, v16, v64
    v_mul_f32 v17, v17, v65
    v_mul_f32 v18, v18, v66
    v_mul_f32 v19, v19, v67
    v_cvt_pk_bf16_f32 v4, v4, v5
    v_cvt_pk_bf16_f32 v6, v6, v7
    v_cvt_pk_bf16_f32 v8, v8, v9
    v_cvt_pk_bf16_f32 v10, v10, v11
    v_cvt_pk_bf16_f32 v12, v12, v13
    v_cvt_pk_bf16_f32 v14, v14, v15
    v_cvt_pk_bf16_f32 v16, v16, v17
    v_cvt_pk_bf16_f32 v18, v18, v19
    v_and_b32 v5, s32, v4
    v_lshlrev_b32 v4, 16, v4
    v_and_b32 v7, s32, v6
    v_lshlrev_b32 v6, 16, v6
    v_and_b32 v9, s32, v8
    v_lshlrev_b32 v8, 16, v8
    v_and_b32 v11, s32, v10
    v_lshlrev_b32 v10, 16, v10
    v_and_b32 v13, s32, v12
    v_lshlrev_b32 v12, 16, v12
    v_and_b32 v15, s32, v14
    v_lshlrev_b32 v14, 16, v14
    v_and_b32 v17, s32, v16
    v_lshlrev_b32 v16, 16, v16
    v_and_b32 v19, s32, v18
    v_lshlrev_b32 v18, 16, v18
    v_add_f32 v4, v4, v36
    v_add_f32 v5, v5, v37
    v_add_f32 v6, v6, v38
    v_add_f32 v7, v7, v39
    v_add_f32 v8, v8, v40
    v_add_f32 v9, v9, v41
    v_add_f32 v10, v10, v42
    v_add_f32 v11, v11, v43
    v_add_f32 v12, v12, v44
    v_add_f32 v13, v13, v45
    v_add_f32 v14, v14, v46
    v_add_f32 v15, v15, v47
    v_add_f32 v16, v16, v48
    v_add_f32 v17, v17, v49
    v_add_f32 v18, v18, v50
    v_add_f32 v19, v19, v51
    v_cvt_pk_bf16_f32 v20, v4, v5
    v_cvt_pk_bf16_f32 v21, v6, v7
    v_cvt_pk_bf16_f32 v22, v8, v9
    v_cvt_pk_bf16_f32 v23, v10, v11
    v_cvt_pk_bf16_f32 v24, v12, v13
    v_cvt_pk_bf16_f32 v25, v14, v15
    v_cvt_pk_bf16_f32 v26, v16, v17
    v_cvt_pk_bf16_f32 v27, v18, v19
    buffer_store_dwordx4 v[20:23], v76, s[76:79], 0 offen
    buffer_store_dwordx4 v[24:27], v77, s[76:79], 0 offen
L_postend_89:
    s_mov_b64 exec, -1

    s_bfe_u32 s3, s35, 0x40008
    s_cbranch_scc0 L_fend_92
    s_ff1_i32_b32 s41, s3
    s_add_u32 s3, s41, 8
    s_bitset0_b32 s35, s3
    s_mov_b32 s49, -1

    s_mul_i32 s28, s41, 3125
    s_add_u32 s29, s28, 3126
    s_add_u32 s28, s28, 1
    s_lshr_b32 s28, s28, 1
    s_lshr_b32 s29, s29, 1
    s_sub_u32 s29, s29, s28
    s_sub_u32 s5, s29, 782
    s_mul_i32 s3, s36, 6250
    v_add_u32 v78, s28, v0
    v_mov_b32 v82, 0x2000000
    v_add_u32 v79, 782, v78
    v_cmp_gt_u32 vcc, 782, v0
    v_add_u32 v76, s3, v78
    v_add_u32 v77, s3, v79
    v_cndmask_b32 v76, v82, v76, vcc
    v_cmp_gt_u32 vcc, s5, v0
    v_lshlrev_b32 v78, 4, v78
    v_lshlrev_b32 v79, 4, v79
    v_cndmask_b32 v77, v82, v77, vcc
    v_lshlrev_b32 v80, 2, v76
    v_lshlrev_b32 v76, 4, v76
    v_lshlrev_b32 v81, 2, v77
    v_lshlrev_b32 v77, 4, v77
    buffer_load_dword v80, v80, s[68:71], 0 offen
    buffer_load_dword v81, v81, s[68:71], 0 offen
    buffer_load_dwordx4 v[86:89], v76, s[8:11], 0 offen
    buffer_load_dwordx4 v[90:93], v77, s[8:11], 0 offen

    s_waitcnt vmcnt(2)
    v_lshlrev_b32_sdwa v82, 5, v80 dst_sel:DWORD dst_unused:UNUSED_PAD src0_sel:DWORD src1_sel:WORD_0
    v_lshlrev_b32_sdwa v83, 5, v80 dst_sel:DWORD dst_unused:UNUSED_PAD src0_sel:DWORD src1_sel:WORD_1
    v_lshlrev_b32_sdwa v84, 5, v81 dst_sel:DWORD dst_unused:UNUSED_PAD src0_sel:DWORD src1_sel:WORD_0
    v_lshlrev_b32_sdwa v85, 5, v81 dst_sel:DWORD dst_unused:UNUSED_PAD src0_sel:DWORD src1_sel:WORD_1
    buffer_load_dwordx4 v[94:97], v82, s[72:75], 0 offen
    buffer_load_dwordx2 v[110:111], v82, s[72:75], 0 offen offset:16

    buffer_load_dwordx4 v[98:101], v83, s[72:75], 0 offen
    buffer_load_dwordx2 v[112:113], v83, s[72:75], 0 offen offset:16

    buffer_load_dwordx4 v[102:105], v84, s[72:75], 0 offen
    buffer_load_dwordx2 v[114:115], v84, s[72:75], 0 offen offset:16

    buffer_load_dwordx4 v[106:109], v85, s[72:75], 0 offen
    buffer_load_dwordx2 v[116:117], v85, s[72:75], 0 offen offset:16

    s_branch L_post_88
L_fin_83:

    s_load_dwordx2 s[68:69], s[0:1], 24
    s_load_dwordx4 s[88:91], s[0:1], 72
    s_load_dwordx2 s[76:77], s[0:1], 88
    s_load_dwordx2 s[80:81], s[0:1], 96
    s_mov_b32 s70, 1600000
    s_mov_b32 s71, 0x20000
    s_mov_b32 s78, 6400000
    s_mov_b32 s79, 0x20000
    s_movk_i32 s82, 256
    s_mov_b32 s83, 0x20000
    s_lshl_b32 s48, s36, 2
    s_mov_b32 s41, s37

    s_add_u32 s84, s6, 8896512
    s_addc_u32 s85, s7, 0
    s_mov_b32 s86, 76800000
    s_mov_b32 s87, 0x20000
    s_add_u32 s72, s6, 393216
    s_addc_u32 s73, s7, 0
    s_mov_b32 s74, 2097152
    s_mov_b32 s75, 0x20000
    s_mov_b32 s49, -1
    s_waitcnt lgkmcnt(0)
    s_load_dwordx8 s[12:19], s[88:89], 0
    s_load_dwordx8 s[56:63], s[90:91], 0

    s_mul_i32 s28, s41, 3125
    s_add_u32 s29, s28, 3126
    s_add_u32 s28, s28, 1
    s_lshr_b32 s28, s28, 1
    s_lshr_b32 s29, s29, 1
    s_sub_u32 s29, s29, s28
    s_sub_u32 s5, s29, 782
    s_mul_i32 s3, s36, 6250
    v_add_u32 v78, s28, v0
    v_mov_b32 v82, 0x2000000
    v_add_u32 v79, 782, v78
    v_cmp_gt_u32 vcc, 782, v0
    v_add_u32 v76, s3, v78
    v_add_u32 v77, s3, v79
    v_cndmask_b32 v76, v82, v76, vcc
    v_cmp_gt_u32 vcc, s5, v0
    v_lshlrev_b32 v78, 4, v78
    v_lshlrev_b32 v79, 4, v79
    v_cndmask_b32 v77, v82, v77, vcc
    v_lshlrev_b32 v80, 2, v76
    v_lshlrev_b32 v76, 4, v76
    v_lshlrev_b32 v81, 2, v77
    v_lshlrev_b32 v77, 4, v77
    buffer_load_dword v80, v80, s[68:71], 0 offen
    buffer_load_dword v81, v81, s[68:71], 0 offen
    buffer_load_dwordx4 v[86:89], v76, s[8:11], 0 offen
    buffer_load_dwordx4 v[90:93], v77, s[8:11], 0 offen

    s_waitcnt vmcnt(2)
    v_lshlrev_b32_sdwa v82, 5, v80 dst_sel:DWORD dst_unused:UNUSED_PAD src0_sel:DWORD src1_sel:WORD_0
    v_lshlrev_b32_sdwa v83, 5, v80 dst_sel:DWORD dst_unused:UNUSED_PAD src0_sel:DWORD src1_sel:WORD_1
    v_lshlrev_b32_sdwa v84, 5, v81 dst_sel:DWORD dst_unused:UNUSED_PAD src0_sel:DWORD src1_sel:WORD_0
    v_lshlrev_b32_sdwa v85, 5, v81 dst_sel:DWORD dst_unused:UNUSED_PAD src0_sel:DWORD src1_sel:WORD_1
    buffer_load_dwordx4 v[94:97], v82, s[72:75], 0 offen
    buffer_load_dwordx2 v[110:111], v82, s[72:75], 0 offen offset:16

    buffer_load_dwordx4 v[98:101], v83, s[72:75], 0 offen
    buffer_load_dwordx2 v[112:113], v83, s[72:75], 0 offen offset:16

    buffer_load_dwordx4 v[102:105], v84, s[72:75], 0 offen
    buffer_load_dwordx2 v[114:115], v84, s[72:75], 0 offen offset:16

    buffer_load_dwordx4 v[106:109], v85, s[72:75], 0 offen
    buffer_load_dwordx2 v[116:117], v85, s[72:75], 0 offen offset:16

    s_waitcnt vmcnt(0) lgkmcnt(0)
    s_barrier
    s_branch L_meet_84
L_fend_92:

L_p2done_47:
    s_endpgm

L_ufix_49:
    v_and_b32 v117, 63, v0
    v_lshlrev_b32 v117, 2, v117
    s_sub_i32 s54, s42, 1024
    v_cmp_le_i32 vcc, s54, v117
    s_mov_b64 exec, vcc
    v_mov_b32 v12, 0
    v_mov_b32 v44, 0
    s_mov_b64 exec, -1
    s_sub_i32 s54, s42, 1025
    v_cmp_le_i32 vcc, s54, v117
    s_mov_b64 exec, vcc
    v_mov_b32 v13, 0
    v_mov_b32 v46, 0
    s_mov_b64 exec, -1
    s_sub_i32 s54, s42, 1026
    v_cmp_le_i32 vcc, s54, v117
    s_mov_b64 exec, vcc
    v_mov_b32 v14, 0
    v_mov_b32 v48, 0
    s_mov_b64 exec, -1
    s_sub_i32 s54, s42, 1027
    v_cmp_le_i32 vcc, s54, v117
    s_mov_b64 exec, vcc
    v_mov_b32 v15, 0
    v_mov_b32 v50, 0
    s_mov_b64 exec, -1
    s_branch L_uback_50
L_ufix_51:
    v_and_b32 v117, 63, v0
    v_lshlrev_b32 v117, 2, v117
    s_sub_i32 s54, s42, 1536
    v_cmp_le_i32 vcc, s54, v117
    s_mov_b64 exec, vcc
    v_mov_b32 v16, 0
    v_mov_b32 v52, 0
    s_mov_b64 exec, -1
    s_sub_i32 s54, s42, 1537
    v_cmp_le_i32 vcc, s54, v117
    s_mov_b64 exec, vcc
    v_mov_b32 v17, 0
    v_mov_b32 v54, 0
    s_mov_b64 exec, -1
    s_sub_i32 s54, s42, 1538
    v_cmp_le_i32 vcc, s54, v117
    s_mov_b64 exec, vcc
    v_mov_b32 v18, 0
    v_mov_b32 v56, 0
    s_mov_b64 exec, -1
    s_sub_i32 s54, s42, 1539
    v_cmp_le_i32 vcc, s54, v117
    s_mov_b64 exec, vcc
    v_mov_b32 v19, 0
    v_mov_b32 v58, 0
    s_mov_b64 exec, -1
    s_branch L_uback_52
L_ufix_53:
    v_and_b32 v117, 63, v0
    v_lshlrev_b32 v117, 2, v117
    s_sub_i32 s54, s42, 2048
    v_cmp_le_i32 vcc, s54, v117
    s_mov_b64 exec, vcc
    v_mov_b32 v20, 0
    v_mov_b32 v60, 0
    s_mov_b64 exec, -1
    s_sub_i32 s54, s42, 2049
    v_cmp_le_i32 vcc, s54, v117
    s_mov_b64 exec, vcc
    v_mov_b32 v21, 0
    v_mov_b32 v62, 0
    s_mov_b64 exec, -1
    s_sub_i32 s54, s42, 2050
    v_cmp_le_i32 vcc, s54, v117
    s_mov_b64 exec, vcc
    v_mov_b32 v22, 0
    v_mov_b32 v64, 0
    s_mov_b64 exec, -1
    s_sub_i32 s54, s42, 2051
    v_cmp_le_i32 vcc, s54, v117
    s_mov_b64 exec, vcc
    v_mov_b32 v23, 0
    v_mov_b32 v66, 0
    s_mov_b64 exec, -1
    s_branch L_uback_54
L_ufix_55:
    v_and_b32 v117, 63, v0
    v_lshlrev_b32 v117, 2, v117
    s_sub_i32 s54, s42, 2560
    v_cmp_le_i32 vcc, s54, v117
    s_mov_b64 exec, vcc
    v_mov_b32 v24, 0
    v_mov_b32 v68, 0
    s_mov_b64 exec, -1
    s_sub_i32 s54, s42, 2561
    v_cmp_le_i32 vcc, s54, v117
    s_mov_b64 exec, vcc
    v_mov_b32 v25, 0
    v_mov_b32 v70, 0
    s_mov_b64 exec, -1
    s_sub_i32 s54, s42, 2562
    v_cmp_le_i32 vcc, s54, v117
    s_mov_b64 exec, vcc
    v_mov_b32 v26, 0
    v_mov_b32 v72, 0
    s_mov_b64 exec, -1
    s_sub_i32 s54, s42, 2563
    v_cmp_le_i32 vcc, s54, v117
    s_mov_b64 exec, vcc
    v_mov_b32 v27, 0
    v_mov_b32 v74, 0
    s_mov_b64 exec, -1
    s_branch L_uback_56
L_ufix_57:
    v_and_b32 v117, 63, v0
    v_lshlrev_b32 v117, 2, v117
    s_sub_i32 s54, s42, 0
    v_cmp_le_i32 vcc, s54, v117
    s_mov_b64 exec, vcc
    v_mov_b32 v4, 0
    v_mov_b32 v28, 0
    s_mov_b64 exec, -1
    s_sub_i32 s54, s42, 1
    v_cmp_le_i32 vcc, s54, v117
    s_mov_b64 exec, vcc
    v_mov_b32 v5, 0
    v_mov_b32 v30, 0
    s_mov_b64 exec, -1
    s_sub_i32 s54, s42, 2
    v_cmp_le_i32 vcc, s54, v117
    s_mov_b64 exec, vcc
    v_mov_b32 v6, 0
    v_mov_b32 v32, 0
    s_mov_b64 exec, -1
    s_sub_i32 s54, s42, 3
    v_cmp_le_i32 vcc, s54, v117
    s_mov_b64 exec, vcc
    v_mov_b32 v7, 0
    v_mov_b32 v34, 0
    s_mov_b64 exec, -1
    s_branch L_uback_58
L_ufix_59:
    v_and_b32 v117, 63, v0
    v_lshlrev_b32 v117, 2, v117
    s_sub_i32 s54, s42, 512
    v_cmp_le_i32 vcc, s54, v117
    s_mov_b64 exec, vcc
    v_mov_b32 v8, 0
    v_mov_b32 v36, 0
    s_mov_b64 exec, -1
    s_sub_i32 s54, s42, 513
    v_cmp_le_i32 vcc, s54, v117
    s_mov_b64 exec, vcc
    v_mov_b32 v9, 0
    v_mov_b32 v38, 0
    s_mov_b64 exec, -1
    s_sub_i32 s54, s42, 514
    v_cmp_le_i32 vcc, s54, v117
    s_mov_b64 exec, vcc
    v_mov_b32 v10, 0
    v_mov_b32 v40, 0
    s_mov_b64 exec, -1
    s_sub_i32 s54, s42, 515
    v_cmp_le_i32 vcc, s54, v117
    s_mov_b64 exec, vcc
    v_mov_b32 v11, 0
    v_mov_b32 v42, 0
    s_mov_b64 exec, -1
    s_branch L_uback_60
L_ufix_66:
    v_and_b32 v117, 63, v0
    v_lshlrev_b32 v117, 2, v117
    s_sub_i32 s54, s42, 3072
    v_cmp_le_i32 vcc, s54, v117
    s_mov_b64 exec, vcc
    v_mov_b32 v106, 0
    v_mov_b32 v120, 0
    s_mov_b64 exec, -1
    s_sub_i32 s54, s42, 3073
    v_cmp_le_i32 vcc, s54, v117
    s_mov_b64 exec, vcc
    v_mov_b32 v107, 0
    v_mov_b32 v122, 0
    s_mov_b64 exec, -1
    s_sub_i32 s54, s42, 3074
    v_cmp_le_i32 vcc, s54, v117
    s_mov_b64 exec, vcc
    v_mov_b32 v108, 0
    v_mov_b32 v124, 0
    s_mov_b64 exec, -1
    s_sub_i32 s54, s42, 3075
    v_cmp_le_i32 vcc, s54, v117
    s_mov_b64 exec, vcc
    v_mov_b32 v109, 0
    v_mov_b32 v126, 0
    s_mov_b64 exec, -1
    s_branch L_uback_67
L_ufix_70:
    v_and_b32 v117, 63, v0
    v_lshlrev_b32 v117, 2, v117
    s_sub_i32 s54, s42, 1024
    v_cmp_le_i32 vcc, s54, v117
    s_mov_b64 exec, vcc
    v_mov_b32 v12, 0
    v_mov_b32 v44, 0
    s_mov_b64 exec, -1
    s_sub_i32 s54, s42, 1025
    v_cmp_le_i32 vcc, s54, v117
    s_mov_b64 exec, vcc
    v_mov_b32 v13, 0
    v_mov_b32 v46, 0
    s_mov_b64 exec, -1
    s_sub_i32 s54, s42, 1026
    v_cmp_le_i32 vcc, s54, v117
    s_mov_b64 exec, vcc
    v_mov_b32 v14, 0
    v_mov_b32 v48, 0
    s_mov_b64 exec, -1
    s_sub_i32 s54, s42, 1027
    v_cmp_le_i32 vcc, s54, v117
    s_mov_b64 exec, vcc
    v_mov_b32 v15, 0
    v_mov_b32 v50, 0
    s_mov_b64 exec, -1
    s_branch L_uback_71
L_ufix_72:
    v_and_b32 v117, 63, v0
    v_lshlrev_b32 v117, 2, v117
    s_sub_i32 s54, s42, 1536
    v_cmp_le_i32 vcc, s54, v117
    s_mov_b64 exec, vcc
    v_mov_b32 v16, 0
    v_mov_b32 v52, 0
    s_mov_b64 exec, -1
    s_sub_i32 s54, s42, 1537
    v_cmp_le_i32 vcc, s54, v117
    s_mov_b64 exec, vcc
    v_mov_b32 v17, 0
    v_mov_b32 v54, 0
    s_mov_b64 exec, -1
    s_sub_i32 s54, s42, 1538
    v_cmp_le_i32 vcc, s54, v117
    s_mov_b64 exec, vcc
    v_mov_b32 v18, 0
    v_mov_b32 v56, 0
    s_mov_b64 exec, -1
    s_sub_i32 s54, s42, 1539
    v_cmp_le_i32 vcc, s54, v117
    s_mov_b64 exec, vcc
    v_mov_b32 v19, 0
    v_mov_b32 v58, 0
    s_mov_b64 exec, -1
    s_branch L_uback_73
L_ufix_74:
    v_and_b32 v117, 63, v0
    v_lshlrev_b32 v117, 2, v117
    s_sub_i32 s54, s42, 2048
    v_cmp_le_i32 vcc, s54, v117
    s_mov_b64 exec, vcc
    v_mov_b32 v20, 0
    v_mov_b32 v60, 0
    s_mov_b64 exec, -1
    s_sub_i32 s54, s42, 2049
    v_cmp_le_i32 vcc, s54, v117
    s_mov_b64 exec, vcc
    v_mov_b32 v21, 0
    v_mov_b32 v62, 0
    s_mov_b64 exec, -1
    s_sub_i32 s54, s42, 2050
    v_cmp_le_i32 vcc, s54, v117
    s_mov_b64 exec, vcc
    v_mov_b32 v22, 0
    v_mov_b32 v64, 0
    s_mov_b64 exec, -1
    s_sub_i32 s54, s42, 2051
    v_cmp_le_i32 vcc, s54, v117
    s_mov_b64 exec, vcc
    v_mov_b32 v23, 0
    v_mov_b32 v66, 0
    s_mov_b64 exec, -1
    s_branch L_uback_75
L_ufix_76:
    v_and_b32 v117, 63, v0
    v_lshlrev_b32 v117, 2, v117
    s_sub_i32 s54, s42, 2560
    v_cmp_le_i32 vcc, s54, v117
    s_mov_b64 exec, vcc
    v_mov_b32 v24, 0
    v_mov_b32 v68, 0
    s_mov_b64 exec, -1
    s_sub_i32 s54, s42, 2561
    v_cmp_le_i32 vcc, s54, v117
    s_mov_b64 exec, vcc
    v_mov_b32 v25, 0
    v_mov_b32 v70, 0
    s_mov_b64 exec, -1
    s_sub_i32 s54, s42, 2562
    v_cmp_le_i32 vcc, s54, v117
    s_mov_b64 exec, vcc
    v_mov_b32 v26, 0
    v_mov_b32 v72, 0
    s_mov_b64 exec, -1
    s_sub_i32 s54, s42, 2563
    v_cmp_le_i32 vcc, s54, v117
    s_mov_b64 exec, vcc
    v_mov_b32 v27, 0
    v_mov_b32 v74, 0
    s_mov_b64 exec, -1
    s_branch L_uback_77
L_ufix_78:
    v_and_b32 v117, 63, v0
    v_lshlrev_b32 v117, 2, v117
    s_sub_i32 s54, s42, 0
    v_cmp_le_i32 vcc, s54, v117
    s_mov_b64 exec, vcc
    v_mov_b32 v4, 0
    v_mov_b32 v28, 0
    s_mov_b64 exec, -1
    s_sub_i32 s54, s42, 1
    v_cmp_le_i32 vcc, s54, v117
    s_mov_b64 exec, vcc
    v_mov_b32 v5, 0
    v_mov_b32 v30, 0
    s_mov_b64 exec, -1
    s_sub_i32 s54, s42, 2
    v_cmp_le_i32 vcc, s54, v117
    s_mov_b64 exec, vcc
    v_mov_b32 v6, 0
    v_mov_b32 v32, 0
    s_mov_b64 exec, -1
    s_sub_i32 s54, s42, 3
    v_cmp_le_i32 vcc, s54, v117
    s_mov_b64 exec, vcc
    v_mov_b32 v7, 0
    v_mov_b32 v34, 0
    s_mov_b64 exec, -1
    s_branch L_uback_79
L_ufix_80:
    v_and_b32 v117, 63, v0
    v_lshlrev_b32 v117, 2, v117
    s_sub_i32 s54, s42, 512
    v_cmp_le_i32 vcc, s54, v117
    s_mov_b64 exec, vcc
    v_mov_b32 v8, 0
    v_mov_b32 v36, 0
    s_mov_b64 exec, -1
    s_sub_i32 s54, s42, 513
    v_cmp_le_i32 vcc, s54, v117
    s_mov_b64 exec, vcc
    v_mov_b32 v9, 0
    v_mov_b32 v38, 0
    s_mov_b64 exec, -1
    s_sub_i32 s54, s42, 514
    v_cmp_le_i32 vcc, s54, v117
    s_mov_b64 exec, vcc
    v_mov_b32 v10, 0
    v_mov_b32 v40, 0
    s_mov_b64 exec, -1
    s_sub_i32 s54, s42, 515
    v_cmp_le_i32 vcc, s54, v117
    s_mov_b64 exec, vcc
    v_mov_b32 v11, 0
    v_mov_b32 v42, 0
    s_mov_b64 exec, -1
    s_branch L_uback_81
L_sync_91:
    v_and_b32 v40, 63, v0
    v_lshlrev_b32 v41, 20, v40
    v_mov_b32 v42, s33
    buffer_atomic_add v42, v41, s[80:83], s48 offen sc0
    s_waitcnt vmcnt(0)
    v_readfirstlane_b32 s4, v42
    s_movk_i32 s5, 400
    s_nop 0
    s_add_u32 s4, s4, s33
    s_bitcmp1_b32 s4, 2
    s_cbranch_scc1 L_tell_95
L_poll_93:
    s_sub_u32 s5, s5, 1
    s_cbranch_scc1 L_gave_94
    v_mov_b32 v42, 0
    buffer_atomic_add v42, v41, s[80:83], s48 offen sc0
    s_waitcnt vmcnt(0)
    v_readfirstlane_b32 s4, v42
    s_nop 1
    s_and_b32 s4, s4, 0xff
    s_bitcmp0_b32 s4, 2
    s_cbranch_scc1 L_poll_93
    s_branch L_tell_95
L_gave_94:
    s_cmp_lg_u32 s49, s37
    s_cbranch_scc1 L_gno_97
    v_add_lshl_u32 v40, v40, s28, 4
    s_mov_b32 s5, 0
L_gl_96:
    v_min_u32 v43, 100000, v40
    ds_read_b128 v[44:47], v43 offset:50000
    s_waitcnt lgkmcnt(0)
    buffer_store_dwordx4 v[44:47], v40, s[20:23], 0 offen sc1
    s_waitcnt vmcnt(0)
    v_add_u32 v40, 1024, v40
    s_add_u32 s5, s5, 64
    s_cmp_lt_u32 s5, s29
    s_cbranch_scc1 L_gl_96
L_gno_97:
    s_lshl_b32 s4, 0x100, s37
    v_mov_b32 v42, s4
    buffer_atomic_or v42, v41, s[80:83], s48 offen sc0
    s_waitcnt vmcnt(0)
    v_readfirstlane_b32 s4, v42
    s_nop 1
    s_and_b32 s4, s4, 0xff
    s_bitcmp1_b32 s4, 2
    s_cselect_b32 s4, s4, 0x10000
L_tell_95:
    v_mov_b32 v42, s4
    ds_write_b32 v118, v42
    s_waitcnt lgkmcnt(0)
    s_branch L_bcast_86

L_own_98:
    ds_read_b128 v[36:39], v78 offset:50000
    ds_read_b128 v[52:55], v79 offset:50000
    s_branch L_obk_99

L_own_100:
    ds_read_b128 v[40:43], v78 offset:50000
    ds_read_b128 v[56:59], v79 offset:50000
    s_branch L_obk_101

L_own_102:
    ds_read_b128 v[44:47], v78 offset:50000
    ds_read_b128 v[60:63], v79 offset:50000
    s_branch L_obk_103

L_own_104:
    ds_read_b128 v[48:51], v78 offset:50000
    ds_read_b128 v[64:67], v79 offset:50000
    s_branch L_obk_105

L_fgen_106:
    v_lshlrev_b32 v82, 1, v76
    v_lshlrev_b32 v83, 1, v77
    v_mov_b32 v4, 0
    v_mov_b32 v5, 0
    v_mov_b32 v6, 0
    v_mov_b32 v7, 0
    v_mov_b32 v8, 0
    v_mov_b32 v9, 0
    v_mov_b32 v10, 0
    v_mov_b32 v11, 0
    v_mov_b32 v12, 0
    v_mov_b32 v13, 0
    v_mov_b32 v14, 0
    v_mov_b32 v15, 0
    v_mov_b32 v16, 0
    v_mov_b32 v17, 0
    v_mov_b32 v18, 0
    v_mov_b32 v19, 0
    s_bitcmp1_b32 s35, 4
    s_cbranch_scc1 L_ffl_108
    v_cvt_f32_u32_sdwa v20, v36 dst_sel:DWORD dst_unused:UNUSED_PAD src0_sel:WORD_0
    v_cvt_f32_u32_sdwa v21, v36 dst_sel:DWORD dst_unused:UNUSED_PAD src0_sel:WORD_1
    v_cvt_f32_u32_sdwa v22, v37 dst_sel:DWORD dst_unused:UNUSED_PAD src0_sel:WORD_0
    v_cvt_f32_u32_sdwa v23, v37 dst_sel:DWORD dst_unused:UNUSED_PAD src0_sel:WORD_1
    v_cvt_f32_u32_sdwa v24, v38 dst_sel:DWORD dst_unused:UNUSED_PAD src0_sel:WORD_0
    v_cvt_f32_u32_sdwa v25, v38 dst_sel:DWORD dst_unused:UNUSED_PAD src0_sel:WORD_1
    v_cvt_f32_u32_sdwa v26, v39 dst_sel:DWORD dst_unused:UNUSED_PAD src0_sel:WORD_0
    v_cvt_f32_u32_sdwa v27, v39 dst_sel:DWORD dst_unused:UNUSED_PAD src0_sel:WORD_1
    v_cvt_f32_u32_sdwa v28, v52 dst_sel:DWORD dst_unused:UNUSED_PAD src0_sel:WORD_0
    v_cvt_f32_u32_sdwa v29, v52 dst_sel:DWORD dst_unused:UNUSED_PAD src0_sel:WORD_1
    v_cvt_f32_u32_sdwa v30, v53 dst_sel:DWORD dst_unused:UNUSED_PAD src0_sel:WORD_0
    v_cvt_f32_u32_sdwa v31, v53 dst_sel:DWORD dst_unused:UNUSED_PAD src0_sel:WORD_1
    v_cvt_f32_u32_sdwa v32, v54 dst_sel:DWORD dst_unused:UNUSED_PAD src0_sel:WORD_0
    v_cvt_f32_u32_sdwa v33, v54 dst_sel:DWORD dst_unused:UNUSED_PAD src0_sel:WORD_1
    v_cvt_f32_u32_sdwa v34, v55 dst_sel:DWORD dst_unused:UNUSED_PAD src0_sel:WORD_0
    v_cvt_f32_u32_sdwa v35, v55 dst_sel:DWORD dst_unused:UNUSED_PAD src0_sel:WORD_1
    v_add_f32 v20, 0xc6800000, v20
    v_fmac_f32 v4, s34, v20
    v_add_f32 v21, 0xc6800000, v21
    v_fmac_f32 v5, s34, v21
    v_add_f32 v22, 0xc6800000, v22
    v_fmac_f32 v6, s34, v22
    v_add_f32 v23, 0xc6800000, v23
    v_fmac_f32 v7, s34, v23
    v_add_f32 v24, 0xc6800000, v24
    v_fmac_f32 v8, s34, v24
    v_add_f32 v25, 0xc6800000, v25
    v_fmac_f32 v9, s34, v25
    v_add_f32 v26, 0xc6800000, v26
    v_fmac_f32 v10, s34, v26
    v_add_f32 v27, 0xc6800000, v27
    v_fmac_f32 v11, s34, v27
    v_add_f32 v28, 0xc6800000, v28
    v_fmac_f32 v12, s34, v28
    v_add_f32 v29, 0xc6800000, v29
    v_fmac_f32 v13, s34, v29
    v_add_f32 v30, 0xc6800000, v30
    v_fmac_f32 v14, s34, v30
    v_add_f32 v31, 0xc6800000, v31
    v_fmac_f32 v15, s34, v31
    v_add_f32 v32, 0xc6800000, v32
    v_fmac_f32 v16, s34, v32
    v_add_f32 v33, 0xc6800000, v33
    v_fmac_f32 v17, s34, v33
    v_add_f32 v34, 0xc6800000, v34
    v_fmac_f32 v18, s34, v34
    v_add_f32 v35, 0xc6800000, v35
    v_fmac_f32 v19, s34, v35
    s_branch L_fnx_109
L_ffl_108:
    s_mov_b32 s3, 25600000
    buffer_load_dwordx4 v[20:23], v82, s[84:87], s3 offen offset:0 sc1
    buffer_load_dwordx4 v[24:27], v82, s[84:87], s3 offen offset:16 sc1
    buffer_load_dwordx4 v[28:31], v83, s[84:87], s3 offen offset:0 sc1
    buffer_load_dwordx4 v[32:35], v83, s[84:87], s3 offen offset:16 sc1
    s_waitcnt vmcnt(0)
    v_add_f32 v4, v4, v20
    v_add_f32 v5, v5, v21
    v_add_f32 v6, v6, v22
    v_add_f32 v7, v7, v23
    v_add_f32 v8, v8, v24
    v_add_f32 v9, v9, v25
    v_add_f32 v10, v10, v26
    v_add_f32 v11, v11, v27
    v_add_f32 v12, v12, v28
    v_add_f32 v13, v13, v29
    v_add_f32 v14, v14, v30
    v_add_f32 v15, v15, v31
    v_add_f32 v16, v16, v32
    v_add_f32 v17, v17, v33
    v_add_f32 v18, v18, v34
    v_add_f32 v19, v19, v35
L_fnx_109:
    s_bitcmp1_b32 s35, 5
    s_cbranch_scc1 L_ffl_110
    v_cvt_f32_u32_sdwa v20, v40 dst_sel:DWORD dst_unused:UNUSED_PAD src0_sel:WORD_0
    v_cvt_f32_u32_sdwa v21, v40 dst_sel:DWORD dst_unused:UNUSED_PAD src0_sel:WORD_1
    v_cvt_f32_u32_sdwa v22, v41 dst_sel:DWORD dst_unused:UNUSED_PAD src0_sel:WORD_0
    v_cvt_f32_u32_sdwa v23, v41 dst_sel:DWORD dst_unused:UNUSED_PAD src0_sel:WORD_1
    v_cvt_f32_u32_sdwa v24, v42 dst_sel:DWORD dst_unused:UNUSED_PAD src0_sel:WORD_0
    v_cvt_f32_u32_sdwa v25, v42 dst_sel:DWORD dst_unused:UNUSED_PAD src0_sel:WORD_1
    v_cvt_f32_u32_sdwa v26, v43 dst_sel:DWORD dst_unused:UNUSED_PAD src0_sel:WORD_0
    v_cvt_f32_u32_sdwa v27, v43 dst_sel:DWORD dst_unused:UNUSED_PAD src0_sel:WORD_1
    v_cvt_f32_u32_sdwa v28, v56 dst_sel:DWORD dst_unused:UNUSED_PAD src0_sel:WORD_0
    v_cvt_f32_u32_sdwa v29, v56 dst_sel:DWORD dst_unused:UNUSED_PAD src0_sel:WORD_1
    v_cvt_f32_u32_sdwa v30, v57 dst_sel:DWORD dst_unused:UNUSED_PAD src0_sel:WORD_0
    v_cvt_f32_u32_sdwa v31, v57 dst_sel:DWORD dst_unused:UNUSED_PAD src0_sel:WORD_1
    v_cvt_f32_u32_sdwa v32, v58 dst_sel:DWORD dst_unused:UNUSED_PAD src0_sel:WORD_0
    v_cvt_f32_u32_sdwa v33, v58 dst_sel:DWORD dst_unused:UNUSED_PAD src0_sel:WORD_1
    v_cvt_f32_u32_sdwa v34, v59 dst_sel:DWORD dst_unused:UNUSED_PAD src0_sel:WORD_0
    v_cvt_f32_u32_sdwa v35, v59 dst_sel:DWORD dst_unused:UNUSED_PAD src0_sel:WORD_1
    v_add_f32 v20, 0xc6800000, v20
    v_fmac_f32 v4, s34, v20
    v_add_f32 v21, 0xc6800000, v21
    v_fmac_f32 v5, s34, v21
    v_add_f32 v22, 0xc6800000, v22
    v_fmac_f32 v6, s34, v22
    v_add_f32 v23, 0xc6800000, v23
    v_fmac_f32 v7, s34, v23
    v_add_f32 v24, 0xc6800000, v24
    v_fmac_f32 v8, s34, v24
    v_add_f32 v25, 0xc6800000, v25
    v_fmac_f32 v9, s34, v25
    v_add_f32 v26, 0xc6800000, v26
    v_fmac_f32 v10, s34, v26
    v_add_f32 v27, 0xc6800000, v27
    v_fmac_f32 v11, s34, v27
    v_add_f32 v28, 0xc6800000, v28
    v_fmac_f32 v12, s34, v28
    v_add_f32 v29, 0xc6800000, v29
    v_fmac_f32 v13, s34, v29
    v_add_f32 v30, 0xc6800000, v30
    v_fmac_f32 v14, s34, v30
    v_add_f32 v31, 0xc6800000, v31
    v_fmac_f32 v15, s34, v31
    v_add_f32 v32, 0xc6800000, v32
    v_fmac_f32 v16, s34, v32
    v_add_f32 v33, 0xc6800000, v33
    v_fmac_f32 v17, s34, v33
    v_add_f32 v34, 0xc6800000, v34
    v_fmac_f32 v18, s34, v34
    v_add_f32 v35, 0xc6800000, v35
    v_fmac_f32 v19, s34, v35
    s_branch L_fnx_111
L_ffl_110:
    s_mov_b32 s3, 38400000
    buffer_load_dwordx4 v[20:23], v82, s[84:87], s3 offen offset:0 sc1
    buffer_load_dwordx4 v[24:27], v82, s[84:87], s3 offen offset:16 sc1
    buffer_load_dwordx4 v[28:31], v83, s[84:87], s3 offen offset:0 sc1
    buffer_load_dwordx4 v[32:35], v83, s[84:87], s3 offen offset:16 sc1
    s_waitcnt vmcnt(0)
    v_add_f32 v4, v4, v20
    v_add_f32 v5, v5, v21
    v_add_f32 v6, v6, v22
    v_add_f32 v7, v7, v23
    v_add_f32 v8, v8, v24
    v_add_f32 v9, v9, v25
    v_add_f32 v10, v10, v26
    v_add_f32 v11, v11, v27
    v_add_f32 v12, v12, v28
    v_add_f32 v13, v13, v29
    v_add_f32 v14, v14, v30
    v_add_f32 v15, v15, v31
    v_add_f32 v16, v16, v32
    v_add_f32 v17, v17, v33
    v_add_f32 v18, v18, v34
    v_add_f32 v19, v19, v35
L_fnx_111:
    s_bitcmp1_b32 s35, 6
    s_cbranch_scc1 L_ffl_112
    v_cvt_f32_u32_sdwa v20, v44 dst_sel:DWORD dst_unused:UNUSED_PAD src0_sel:WORD_0
    v_cvt_f32_u32_sdwa v21, v44 dst_sel:DWORD dst_unused:UNUSED_PAD src0_sel:WORD_1
    v_cvt_f32_u32_sdwa v22, v45 dst_sel:DWORD dst_unused:UNUSED_PAD src0_sel:WORD_0
    v_cvt_f32_u32_sdwa v23, v45 dst_sel:DWORD dst_unused:UNUSED_PAD src0_sel:WORD_1
    v_cvt_f32_u32_sdwa v24, v46 dst_sel:DWORD dst_unused:UNUSED_PAD src0_sel:WORD_0
    v_cvt_f32_u32_sdwa v25, v46 dst_sel:DWORD dst_unused:UNUSED_PAD src0_sel:WORD_1
    v_cvt_f32_u32_sdwa v26, v47 dst_sel:DWORD dst_unused:UNUSED_PAD src0_sel:WORD_0
    v_cvt_f32_u32_sdwa v27, v47 dst_sel:DWORD dst_unused:UNUSED_PAD src0_sel:WORD_1
    v_cvt_f32_u32_sdwa v28, v60 dst_sel:DWORD dst_unused:UNUSED_PAD src0_sel:WORD_0
    v_cvt_f32_u32_sdwa v29, v60 dst_sel:DWORD dst_unused:UNUSED_PAD src0_sel:WORD_1
    v_cvt_f32_u32_sdwa v30, v61 dst_sel:DWORD dst_unused:UNUSED_PAD src0_sel:WORD_0
    v_cvt_f32_u32_sdwa v31, v61 dst_sel:DWORD dst_unused:UNUSED_PAD src0_sel:WORD_1
    v_cvt_f32_u32_sdwa v32, v62 dst_sel:DWORD dst_unused:UNUSED_PAD src0_sel:WORD_0
    v_cvt_f32_u32_sdwa v33, v62 dst_sel:DWORD dst_unused:UNUSED_PAD src0_sel:WORD_1
    v_cvt_f32_u32_sdwa v34, v63 dst_sel:DWORD dst_unused:UNUSED_PAD src0_sel:WORD_0
    v_cvt_f32_u32_sdwa v35, v63 dst_sel:DWORD dst_unused:UNUSED_PAD src0_sel:WORD_1
    v_add_f32 v20, 0xc6800000, v20
    v_fmac_f32 v4, s34, v20
    v_add_f32 v21, 0xc6800000, v21
    v_fmac_f32 v5, s34, v21
    v_add_f32 v22, 0xc6800000, v22
    v_fmac_f32 v6, s34, v22
    v_add_f32 v23, 0xc6800000, v23
    v_fmac_f32 v7, s34, v23
    v_add_f32 v24, 0xc6800000, v24
    v_fmac_f32 v8, s34, v24
    v_add_f32 v25, 0xc6800000, v25
    v_fmac_f32 v9, s34, v25
    v_add_f32 v26, 0xc6800000, v26
    v_fmac_f32 v10, s34, v26
    v_add_f32 v27, 0xc6800000, v27
    v_fmac_f32 v11, s34, v27
    v_add_f32 v28, 0xc6800000, v28
    v_fmac_f32 v12, s34, v28
    v_add_f32 v29, 0xc6800000, v29
    v_fmac_f32 v13, s34, v29
    v_add_f32 v30, 0xc6800000, v30
    v_fmac_f32 v14, s34, v30
    v_add_f32 v31, 0xc6800000, v31
    v_fmac_f32 v15, s34, v31
    v_add_f32 v32, 0xc6800000, v32
    v_fmac_f32 v16, s34, v32
    v_add_f32 v33, 0xc6800000, v33
    v_fmac_f32 v17, s34, v33
    v_add_f32 v34, 0xc6800000, v34
    v_fmac_f32 v18, s34, v34
    v_add_f32 v35, 0xc6800000, v35
    v_fmac_f32 v19, s34, v35
    s_branch L_fnx_113
L_ffl_112:
    s_mov_b32 s3, 51200000
    buffer_load_dwordx4 v[20:23], v82, s[84:87], s3 offen offset:0 sc1
    buffer_load_dwordx4 v[24:27], v82, s[84:87], s3 offen offset:16 sc1
    buffer_load_dwordx4 v[28:31], v83, s[84:87], s3 offen offset:0 sc1
    buffer_load_dwordx4 v[32:35], v83, s[84:87], s3 offen offset:16 sc1
    s_waitcnt vmcnt(0)
    v_add_f32 v4, v4, v20
    v_add_f32 v5, v5, v21
    v_add_f32 v6, v6, v22
    v_add_f32 v7, v7, v23
    v_add_f32 v8, v8, v24
    v_add_f32 v9, v9, v25
    v_add_f32 v10, v10, v26
    v_add_f32 v11, v11, v27
    v_add_f32 v12, v12, v28
    v_add_f32 v13, v13, v29
    v_add_f32 v14, v14, v30
    v_add_f32 v15, v15, v31
    v_add_f32 v16, v16, v32
    v_add_f32 v17, v17, v33
    v_add_f32 v18, v18, v34
    v_add_f32 v19, v19, v35
L_fnx_113:
    s_bitcmp1_b32 s35, 7
    s_cbranch_scc1 L_ffl_114
    v_cvt_f32_u32_sdwa v20, v48 dst_sel:DWORD dst_unused:UNUSED_PAD src0_sel:WORD_0
    v_cvt_f32_u32_sdwa v21, v48 dst_sel:DWORD dst_unused:UNUSED_PAD src0_sel:WORD_1
    v_cvt_f32_u32_sdwa v22, v49 dst_sel:DWORD dst_unused:UNUSED_PAD src0_sel:WORD_0
    v_cvt_f32_u32_sdwa v23, v49 dst_sel:DWORD dst_unused:UNUSED_PAD src0_sel:WORD_1
    v_cvt_f32_u32_sdwa v24, v50 dst_sel:DWORD dst_unused:UNUSED_PAD src0_sel:WORD_0
    v_cvt_f32_u32_sdwa v25, v50 dst_sel:DWORD dst_unused:UNUSED_PAD src0_sel:WORD_1
    v_cvt_f32_u32_sdwa v26, v51 dst_sel:DWORD dst_unused:UNUSED_PAD src0_sel:WORD_0
    v_cvt_f32_u32_sdwa v27, v51 dst_sel:DWORD dst_unused:UNUSED_PAD src0_sel:WORD_1
    v_cvt_f32_u32_sdwa v28, v64 dst_sel:DWORD dst_unused:UNUSED_PAD src0_sel:WORD_0
    v_cvt_f32_u32_sdwa v29, v64 dst_sel:DWORD dst_unused:UNUSED_PAD src0_sel:WORD_1
    v_cvt_f32_u32_sdwa v30, v65 dst_sel:DWORD dst_unused:UNUSED_PAD src0_sel:WORD_0
    v_cvt_f32_u32_sdwa v31, v65 dst_sel:DWORD dst_unused:UNUSED_PAD src0_sel:WORD_1
    v_cvt_f32_u32_sdwa v32, v66 dst_sel:DWORD dst_unused:UNUSED_PAD src0_sel:WORD_0
    v_cvt_f32_u32_sdwa v33, v66 dst_sel:DWORD dst_unused:UNUSED_PAD src0_sel:WORD_1
    v_cvt_f32_u32_sdwa v34, v67 dst_sel:DWORD dst_unused:UNUSED_PAD src0_sel:WORD_0
    v_cvt_f32_u32_sdwa v35, v67 dst_sel:DWORD dst_unused:UNUSED_PAD src0_sel:WORD_1
    v_add_f32 v20, 0xc6800000, v20
    v_fmac_f32 v4, s34, v20
    v_add_f32 v21, 0xc6800000, v21
    v_fmac_f32 v5, s34, v21
    v_add_f32 v22, 0xc6800000, v22
    v_fmac_f32 v6, s34, v22
    v_add_f32 v23, 0xc6800000, v23
    v_fmac_f32 v7, s34, v23
    v_add_f32 v24, 0xc6800000, v24
    v_fmac_f32 v8, s34, v24
    v_add_f32 v25, 0xc6800000, v25
    v_fmac_f32 v9, s34, v25
    v_add_f32 v26, 0xc6800000, v26
    v_fmac_f32 v10, s34, v26
    v_add_f32 v27, 0xc6800000, v27
    v_fmac_f32 v11, s34, v27
    v_add_f32 v28, 0xc6800000, v28
    v_fmac_f32 v12, s34, v28
    v_add_f32 v29, 0xc6800000, v29
    v_fmac_f32 v13, s34, v29
    v_add_f32 v30, 0xc6800000, v30
    v_fmac_f32 v14, s34, v30
    v_add_f32 v31, 0xc6800000, v31
    v_fmac_f32 v15, s34, v31
    v_add_f32 v32, 0xc6800000, v32
    v_fmac_f32 v16, s34, v32
    v_add_f32 v33, 0xc6800000, v33
    v_fmac_f32 v17, s34, v33
    v_add_f32 v34, 0xc6800000, v34
    v_fmac_f32 v18, s34, v34
    v_add_f32 v35, 0xc6800000, v35
    v_fmac_f32 v19, s34, v35
    s_branch L_fnx_115
L_ffl_114:
    s_mov_b32 s3, 64000000
    buffer_load_dwordx4 v[20:23], v82, s[84:87], s3 offen offset:0 sc1
    buffer_load_dwordx4 v[24:27], v82, s[84:87], s3 offen offset:16 sc1
    buffer_load_dwordx4 v[28:31], v83, s[84:87], s3 offen offset:0 sc1
    buffer_load_dwordx4 v[32:35], v83, s[84:87], s3 offen offset:16 sc1
    s_waitcnt vmcnt(0)
    v_add_f32 v4, v4, v20
    v_add_f32 v5, v5, v21
    v_add_f32 v6, v6, v22
    v_add_f32 v7, v7, v23
    v_add_f32 v8, v8, v24
    v_add_f32 v9, v9, v25
    v_add_f32 v10, v10, v26
    v_add_f32 v11, v11, v27
    v_add_f32 v12, v12, v28
    v_add_f32 v13, v13, v29
    v_add_f32 v14, v14, v30
    v_add_f32 v15, v15, v31
    v_add_f32 v16, v16, v32
    v_add_f32 v17, v17, v33
    v_add_f32 v18, v18, v34
    v_add_f32 v19, v19, v35
L_fnx_115:
    s_branch L_fbk_107
L_p2slow_48:
    s_waitcnt vmcnt(0) lgkmcnt(0)
    s_mov_b32 s51, 0
    s_movk_i32 s43, 6250
L_sweep_116:
    s_barrier

    v_mov_b32 v28, 0x0
    v_mov_b32 v29, 0x0
    v_mov_b32 v30, 0x0
    v_mov_b32 v31, 0x0
    v_add_u32 v32, 50000, v3
    v_add_u32 v33, 65536, v32

    ds_write_b128 v32, v[28:31] offset:0
    ds_write_b128 v32, v[28:31] offset:16384
    ds_write_b128 v32, v[28:31] offset:32768
    ds_write_b128 v32, v[28:31] offset:49152
    ds_write_b128 v33, v[28:31] offset:0
    ds_write_b128 v33, v[28:31] offset:16384
    v_cmp_gt_u32 vcc, 971, v0
    s_mov_b64 exec, vcc
    ds_write_b128 v33, v[28:31] offset:32768
    s_mov_b64 exec, -1
    s_mov_b32 s3, 32768
    s_load_dword s40, s[6:7], s3
    s_waitcnt lgkmcnt(0)
    s_barrier
    s_cmp_lg_u32 s40, 0
    s_cbranch_scc1 L_raw_121
    s_sub_u32 s38, s4, 8
L_sbatch_117:
    s_lshl_b32 s52, s38, 6
    s_add_u32 s52, s52, s36
    s_lshr_b32 s52, s52, 1
    s_lshl_b32 s52, s52, 2
    s_load_dword s40, s[46:47], s52
    s_mul_i32 s50, s38, 200000
    s_and_b32 s3, s36, 1
    s_lshl_b32 s3, s3, 4
    s_or_b32 s3, s3, 0x100000
    s_waitcnt lgkmcnt(0)
    s_bfe_u32 s40, s40, s3

    s_min_u32 s40, s40, 6552
    s_lshl_b32 s52, s38, 6
    s_add_u32 s52, s52, s36
    s_mul_i32 s52, s52, 32764
    s_add_u32 s20, s44, s52
    s_addc_u32 s21, s45, 0
    s_mul_i32 s52, s40, 5
    s_add_u32 s52, s52, 3
    s_and_b32 s22, s52, -4

    s_lshr_b32 s55, s39, 2
    s_add_u32 s55, s55, 0
    v_and_b32 v36, 63, v0
    v_add_u32 v36, s55, v36
L_left_122:
    s_cmp_ge_u32 s55, s40
    s_cbranch_scc1 L_leftend_123
    v_mul_u32_u24 v37, 5, v36
    buffer_load_dword v38, v37, s[20:23], 0 offen
    buffer_load_ubyte v39, v37, s[20:23], 0 offen offset:4
    s_waitcnt vmcnt(0)

    v_perm_b32 v37, v39, v38, s24
    v_lshrrev_b32 v42, 30, v38
    v_and_b32 v37, 0x1fff, v37
    v_mul_u32_u24 v42, 6250, v42
    v_add_lshl_u32 v37, v37, v42, 3

    buffer_load_dwordx2 v[40:41], v37, s[8:11], s50 offen
    v_cmp_gt_u32 vcc, s40, v36
    s_waitcnt vmcnt(0)

    v_bfe_u32 v44, v38, 16, 14
    v_subrev_u32 v44, s51, v44
    v_cmp_gt_u32 s[64:65], s43, v44
    s_and_b64 exec, vcc, s[64:65]
    v_lshlrev_b32 v45, 8, v38
    v_cmpx_ne_u32 vcc, 0, v45
    v_lshlrev_b32 v44, 4, v44
    v_bfe_i32 v38, v38, 0, 16
    v_cvt_f32_i32 v38, v38
    v_mul_f32 v38, 0x38004020, v38
    v_lshlrev_b32 v45, 16, v40
    v_and_b32 v46, s32, v40
    v_lshlrev_b32 v47, 16, v41
    v_and_b32 v48, s32, v41

    v_mul_f32 v45, v45, v38
    ds_add_f32 v44, v45 offset:50000
    v_mul_f32 v46, v46, v38
    ds_add_f32 v44, v46 offset:50004
    v_mul_f32 v47, v47, v38
    ds_add_f32 v44, v47 offset:50008
    v_mul_f32 v48, v48, v38
    ds_add_f32 v44, v48 offset:50012
    s_mov_b64 exec, -1
    v_add_u32 v36, 128, v36
    s_add_u32 s55, s55, 128
    s_branch L_left_122
L_leftend_123:

    s_add_u32 s38, s38, 1
    s_cmp_lt_u32 s38, s4
    s_cbranch_scc1 L_sbatch_117
    s_branch L_swend_119

L_raw_121:
    s_load_dwordx2 s[68:69], s[0:1], 8
    s_load_dwordx2 s[72:73], s[0:1], 16
    s_load_dwordx2 s[76:77], s[0:1], 32
    s_load_dwordx2 s[80:81], s[0:1], 48
    s_mov_b32 s70, 204800000
    s_mov_b32 s71, 0x20000
    s_mov_b32 s74, 204800000
    s_mov_b32 s75, 0x20000
    s_mov_b32 s78, 102400000
    s_mov_b32 s79, 0x20000
    s_waitcnt lgkmcnt(0)
    s_load_dword s82, s[80:81], 0
    s_mul_i32 s83, s36, 12500
    s_add_u32 s83, s83, s51
    s_mul_i32 s84, s37, 200000
    s_mov_b32 s85, 200000
    s_mov_b32 s38, 0
    v_lshlrev_b32 v44, 5, v0
    v_mov_b32 v45, 0.15915494
    s_waitcnt lgkmcnt(0)
    s_lshl_b32 s82, s82, 16
    v_mul_f32 v45, s82, v45
L_rawl_118:
    s_lshr_b32 s3, s38, 1
    buffer_load_dwordx4 v[46:49], v44, s[72:75], s38 offen
    buffer_load_dwordx4 v[50:53], v44, s[72:75], s38 offen offset:16
    buffer_load_dwordx4 v[54:57], v44, s[68:71], s38 offen
    buffer_load_dwordx4 v[58:61], v44, s[68:71], s38 offen offset:16
    buffer_load_dwordx4 v[62:65], v3, s[76:79], s3 offen
    s_waitcnt vmcnt(1)

    v_subrev_u32 v46, s83, v46
    v_subrev_u32 v82, s84, v54
    v_cmp_gt_u32 vcc, s43, v46
    v_cmp_gt_u32 s[64:65], s85, v82
    v_lshlrev_b32 v54, 3, v54
    s_nand_b64 exec, vcc, s[64:65]
    v_bfrev_b32 v54, 1
    s_mov_b64 exec, -1
    buffer_load_dwordx2 v[66:67], v54, s[8:11], 0 offen

    v_subrev_u32 v47, s83, v47
    v_subrev_u32 v82, s84, v55
    v_cmp_gt_u32 vcc, s43, v47
    v_cmp_gt_u32 s[64:65], s85, v82
    v_lshlrev_b32 v55, 3, v55
    s_nand_b64 exec, vcc, s[64:65]
    v_bfrev_b32 v55, 1
    s_mov_b64 exec, -1
    buffer_load_dwordx2 v[68:69], v55, s[8:11], 0 offen

    v_subrev_u32 v48, s83, v48
    v_subrev_u32 v82, s84, v56
    v_cmp_gt_u32 vcc, s43, v48
    v_cmp_gt_u32 s[64:65], s85, v82
    v_lshlrev_b32 v56, 3, v56
    s_nand_b64 exec, vcc, s[64:65]
    v_bfrev_b32 v56, 1
    s_mov_b64 exec, -1
    buffer_load_dwordx2 v[70:71], v56, s[8:11], 0 offen

    v_subrev_u32 v49, s83, v49
    v_subrev_u32 v82, s84, v57
    v_cmp_gt_u32 vcc, s43, v49
    v_cmp_gt_u32 s[64:65], s85, v82
    v_lshlrev_b32 v57, 3, v57
    s_nand_b64 exec, vcc, s[64:65]
    v_bfrev_b32 v57, 1
    s_mov_b64 exec, -1
    buffer_load_dwordx2 v[72:73], v57, s[8:11], 0 offen

    v_subrev_u32 v50, s83, v50
    v_subrev_u32 v82, s84, v58
    v_cmp_gt_u32 vcc, s43, v50
    v_cmp_gt_u32 s[64:65], s85, v82
    v_lshlrev_b32 v58, 3, v58
    s_nand_b64 exec, vcc, s[64:65]
    v_bfrev_b32 v58, 1
    s_mov_b64 exec, -1
    buffer_load_dwordx2 v[74:75], v58, s[8:11], 0 offen

    v_subrev_u32 v51, s83, v51
    v_subrev_u32 v82, s84, v59
    v_cmp_gt_u32 vcc, s43, v51
    v_cmp_gt_u32 s[64:65], s85, v82
    v_lshlrev_b32 v59, 3, v59
    s_nand_b64 exec, vcc, s[64:65]
    v_bfrev_b32 v59, 1
    s_mov_b64 exec, -1
    buffer_load_dwordx2 v[76:77], v59, s[8:11], 0 offen

    v_subrev_u32 v52, s83, v52
    v_subrev_u32 v82, s84, v60
    v_cmp_gt_u32 vcc, s43, v52
    v_cmp_gt_u32 s[64:65], s85, v82
    v_lshlrev_b32 v60, 3, v60
    s_nand_b64 exec, vcc, s[64:65]
    v_bfrev_b32 v60, 1
    s_mov_b64 exec, -1
    buffer_load_dwordx2 v[78:79], v60, s[8:11], 0 offen

    v_subrev_u32 v53, s83, v53
    v_subrev_u32 v82, s84, v61
    v_cmp_gt_u32 vcc, s43, v53
    v_cmp_gt_u32 s[64:65], s85, v82
    v_lshlrev_b32 v61, 3, v61
    s_nand_b64 exec, vcc, s[64:65]
    v_bfrev_b32 v61, 1
    s_mov_b64 exec, -1
    buffer_load_dwordx2 v[80:81], v61, s[8:11], 0 offen

    s_waitcnt vmcnt(0)
    v_cmp_le_i32 vcc, 0, v54
    s_mov_b64 exec, vcc
    s_cbranch_execz L_rsk_124
    v_lshlrev_b32 v82, 16, v62
    v_mul_f32 v82, v82, v45
    v_fract_f32 v82, v82
    v_cos_f32 v82, v82
    v_lshlrev_b32 v46, 4, v46
    v_lshlrev_b32 v83, 16, v66
    v_and_b32 v84, s32, v66
    v_lshlrev_b32 v85, 16, v67
    v_and_b32 v86, s32, v67

    v_mul_f32 v83, v83, v82
    ds_add_f32 v46, v83 offset:50000
    v_mul_f32 v84, v84, v82
    ds_add_f32 v46, v84 offset:50004
    v_mul_f32 v85, v85, v82
    ds_add_f32 v46, v85 offset:50008
    v_mul_f32 v86, v86, v82
    ds_add_f32 v46, v86 offset:50012
L_rsk_124:
    s_mov_b64 exec, -1
    v_cmp_le_i32 vcc, 0, v55
    s_mov_b64 exec, vcc
    s_cbranch_execz L_rsk_125
    v_and_b32 v82, s32, v62
    v_mul_f32 v82, v82, v45
    v_fract_f32 v82, v82
    v_cos_f32 v82, v82
    v_lshlrev_b32 v47, 4, v47
    v_lshlrev_b32 v83, 16, v68
    v_and_b32 v84, s32, v68
    v_lshlrev_b32 v85, 16, v69
    v_and_b32 v86, s32, v69

    v_mul_f32 v83, v83, v82
    ds_add_f32 v47, v83 offset:50000
    v_mul_f32 v84, v84, v82
    ds_add_f32 v47, v84 offset:50004
    v_mul_f32 v85, v85, v82
    ds_add_f32 v47, v85 offset:50008
    v_mul_f32 v86, v86, v82
    ds_add_f32 v47, v86 offset:50012
L_rsk_125:
    s_mov_b64 exec, -1
    v_cmp_le_i32 vcc, 0, v56
    s_mov_b64 exec, vcc
    s_cbranch_execz L_rsk_126
    v_lshlrev_b32 v82, 16, v63
    v_mul_f32 v82, v82, v45
    v_fract_f32 v82, v82
    v_cos_f32 v82, v82
    v_lshlrev_b32 v48, 4, v48
    v_lshlrev_b32 v83, 16, v70
    v_and_b32 v84, s32, v70
    v_lshlrev_b32 v85, 16, v71
    v_and_b32 v86, s32, v71

    v_mul_f32 v83, v83, v82
    ds_add_f32 v48, v83 offset:50000
    v_mul_f32 v84, v84, v82
    ds_add_f32 v48, v84 offset:50004
    v_mul_f32 v85, v85, v82
    ds_add_f32 v48, v85 offset:50008
    v_mul_f32 v86, v86, v82
    ds_add_f32 v48, v86 offset:50012
L_rsk_126:
    s_mov_b64 exec, -1
    v_cmp_le_i32 vcc, 0, v57
    s_mov_b64 exec, vcc
    s_cbranch_execz L_rsk_127
    v_and_b32 v82, s32, v63
    v_mul_f32 v82, v82, v45
    v_fract_f32 v82, v82
    v_cos_f32 v82, v82
    v_lshlrev_b32 v49, 4, v49
    v_lshlrev_b32 v83, 16, v72
    v_and_b32 v84, s32, v72
    v_lshlrev_b32 v85, 16, v73
    v_and_b32 v86, s32, v73

    v_mul_f32 v83, v83, v82
    ds_add_f32 v49, v83 offset:50000
    v_mul_f32 v84, v84, v82
    ds_add_f32 v49, v84 offset:50004
    v_mul_f32 v85, v85, v82
    ds_add_f32 v49, v85 offset:50008
    v_mul_f32 v86, v86, v82
    ds_add_f32 v49, v86 offset:50012
L_rsk_127:
    s_mov_b64 exec, -1
    v_cmp_le_i32 vcc, 0, v58
    s_mov_b64 exec, vcc
    s_cbranch_execz L_rsk_128
    v_lshlrev_b32 v82, 16, v64
    v_mul_f32 v82, v82, v45
    v_fract_f32 v82, v82
    v_cos_f32 v82, v82
    v_lshlrev_b32 v50, 4, v50
    v_lshlrev_b32 v83, 16, v74
    v_and_b32 v84, s32, v74
    v_lshlrev_b32 v85, 16, v75
    v_and_b32 v86, s32, v75

    v_mul_f32 v83, v83, v82
    ds_add_f32 v50, v83 offset:50000
    v_mul_f32 v84, v84, v82
    ds_add_f32 v50, v84 offset:50004
    v_mul_f32 v85, v85, v82
    ds_add_f32 v50, v85 offset:50008
    v_mul_f32 v86, v86, v82
    ds_add_f32 v50, v86 offset:50012
L_rsk_128:
    s_mov_b64 exec, -1
    v_cmp_le_i32 vcc, 0, v59
    s_mov_b64 exec, vcc
    s_cbranch_execz L_rsk_129
    v_and_b32 v82, s32, v64
    v_mul_f32 v82, v82, v45
    v_fract_f32 v82, v82
    v_cos_f32 v82, v82
    v_lshlrev_b32 v51, 4, v51
    v_lshlrev_b32 v83, 16, v76
    v_and_b32 v84, s32, v76
    v_lshlrev_b32 v85, 16, v77
    v_and_b32 v86, s32, v77

    v_mul_f32 v83, v83, v82
    ds_add_f32 v51, v83 offset:50000
    v_mul_f32 v84, v84, v82
    ds_add_f32 v51, v84 offset:50004
    v_mul_f32 v85, v85, v82
    ds_add_f32 v51, v85 offset:50008
    v_mul_f32 v86, v86, v82
    ds_add_f32 v51, v86 offset:50012
L_rsk_129:
    s_mov_b64 exec, -1
    v_cmp_le_i32 vcc, 0, v60
    s_mov_b64 exec, vcc
    s_cbranch_execz L_rsk_130
    v_lshlrev_b32 v82, 16, v65
    v_mul_f32 v82, v82, v45
    v_fract_f32 v82, v82
    v_cos_f32 v82, v82
    v_lshlrev_b32 v52, 4, v52
    v_lshlrev_b32 v83, 16, v78
    v_and_b32 v84, s32, v78
    v_lshlrev_b32 v85, 16, v79
    v_and_b32 v86, s32, v79

    v_mul_f32 v83, v83, v82
    ds_add_f32 v52, v83 offset:50000
    v_mul_f32 v84, v84, v82
    ds_add_f32 v52, v84 offset:50004
    v_mul_f32 v85, v85, v82
    ds_add_f32 v52, v85 offset:50008
    v_mul_f32 v86, v86, v82
    ds_add_f32 v52, v86 offset:50012
L_rsk_130:
    s_mov_b64 exec, -1
    v_cmp_le_i32 vcc, 0, v61
    s_mov_b64 exec, vcc
    s_cbranch_execz L_rsk_131
    v_and_b32 v82, s32, v65
    v_mul_f32 v82, v82, v45
    v_fract_f32 v82, v82
    v_cos_f32 v82, v82
    v_lshlrev_b32 v53, 4, v53
    v_lshlrev_b32 v83, 16, v80
    v_and_b32 v84, s32, v80
    v_lshlrev_b32 v85, 16, v81
    v_and_b32 v86, s32, v81

    v_mul_f32 v83, v83, v82
    ds_add_f32 v53, v83 offset:50000
    v_mul_f32 v84, v84, v82
    ds_add_f32 v53, v84 offset:50004
    v_mul_f32 v85, v85, v82
    ds_add_f32 v53, v85 offset:50008
    v_mul_f32 v86, v86, v82
    ds_add_f32 v53, v86 offset:50012
L_rsk_131:
    s_mov_b64 exec, -1
    s_add_u32 s38, s38, 32768
    s_cmp_lt_u32 s38, 204800000
    s_cbranch_scc1 L_rawl_118
L_swend_119:
    s_waitcnt lgkmcnt(0)
    s_barrier
    s_mul_i32 s3, s37, 800000
    s_mul_i32 s5, s36, 12500
    s_add_u32 s3, s3, s5
    s_add_u32 s3, s3, s51
    s_lshl_b32 s3, s3, 4
    s_add_u32 s3, s3, 34496512

    s_add_u32 s20, s6, s3
    s_addc_u32 s21, s7, 0
    s_mov_b32 s22, 100000
    s_mov_b32 s23, 0x20000
    v_mov_b32 v36, v3
    s_mov_b32 s38, 0
L_wl_120:
    v_min_u32 v37, 100000, v36
    ds_read_b128 v[28:31], v37 offset:50000
    s_waitcnt lgkmcnt(0)
    buffer_store_dwordx4 v[28:31], v36, s[20:23], 0 offen sc1
    s_waitcnt vmcnt(0)
    v_add_u32 v36, 16384, v36
    s_add_u32 s38, s38, 1024
    s_cmp_lt_u32 s38, 6250
    s_cbranch_scc1 L_wl_120
    s_add_u32 s51, s51, 6250
    s_cmp_lt_u32 s51, 12500
    s_cbranch_scc1 L_sweep_116
    s_lshl_b32 s33, 16, s37
    s_add_u32 s33, s33, 1
    s_branch L_fin_83

.section .rodata,"a"
.p2align 6
.amdhsa_kernel g1_kernel
  .amdhsa_next_free_vgpr 128
  .amdhsa_next_free_sgpr 102
  .amdhsa_accum_offset 128
  .amdhsa_group_segment_fixed_size 0
  .amdhsa_kernarg_size 112
  .amdhsa_user_sgpr_count 2
  .amdhsa_user_sgpr_kernarg_segment_ptr 1
  .amdhsa_system_sgpr_workgroup_id_x 1
  .amdhsa_float_denorm_mode_32 3
.end_amdhsa_kernel
.p2align 6
.amdhsa_kernel standalone__molecular_angular_gemnet__graph_kernel
  .amdhsa_next_free_vgpr 128
  .amdhsa_next_free_sgpr 102
  .amdhsa_accum_offset 128
  .amdhsa_group_segment_fixed_size 0
  .amdhsa_kernarg_size 112
  .amdhsa_user_sgpr_count 2
  .amdhsa_user_sgpr_kernarg_segment_ptr 1
  .amdhsa_system_sgpr_workgroup_id_x 1
  .amdhsa_float_denorm_mode_32 3
.end_amdhsa_kernel
```

```asm
; @launch kernel=g1_kernel grid=(256,1,1) block=(1024,1,1) lds=163840
; @launch kernel=standalone__molecular_angular_gemnet__graph_kernel grid=(256,1,1) block=(1024,1,1) lds=163840
.amdgcn_target "amdgcn-amd-amdhsa--gfx950"
.text
.globl g1_kernel
.p2align 8
.type g1_kernel,@function
g1_kernel:
    s_cmp_ge_u32 s2, 256
    s_cbranch_scc1 L_p1done_1
    s_load_dwordx4 s[80:83], s[0:1], 8
    s_load_dwordx2 s[84:85], s[0:1], 32
    s_load_dwordx2 s[86:87], s[0:1], 48
    s_load_dwordx4 s[4:7], s[0:1], 96
    s_load_dwordx2 s[78:79], s[0:1], 0
    v_lshlrev_b32 v1, 4, v0
    v_lshlrev_b32 v2, 3, v0
    v_lshlrev_b32 v98, 20, v0
    s_waitcnt lgkmcnt(0)
    s_load_dword s88, s[86:87], 0

    s_mov_b32 s96, s4
    s_mov_b32 s97, s5
    s_mov_b32 s98, 256
    s_mov_b32 s99, 0x20000
    v_readfirstlane_b32 s74, v0
    s_nop 1
    s_or_b32 s74, s74, s2
    s_cbranch_scc1 L_noinit_2

    v_mov_b32 v110, 1
    buffer_atomic_add v110, v98, s[96:99], 0 offen offset:64 sc0
    s_waitcnt vmcnt(0)
    v_readfirstlane_b32 s74, v110
    s_nop 1
    s_cmp_lg_u32 s74, 0
    s_cbranch_scc1 L_zno_4

    s_mov_b32 s92, s6
    s_mov_b32 s93, s7
    s_mov_b32 s94, 32784
    s_mov_b32 s95, 0x20000
    v_mov_b32 v110, 0
    v_mov_b32 v111, 0
    v_mov_b32 v112, 0
    v_mov_b32 v113, 0
L_zl_3:
    buffer_store_dwordx4 v[110:113], v1, s[92:95], s74 offen sc0 sc1
    s_add_u32 s74, s74, 1024
    s_cmp_le_u32 s74, 32768
    s_cbranch_scc1 L_zl_3
    v_mov_b32 v114, 1
    s_waitcnt vmcnt(0)
    buffer_atomic_add v114, v98, s[96:99], 0 offen offset:128
L_zno_4:

L_noinit_2:
    s_mov_b32 s20, s78
    s_mov_b32 s21, s79
    s_mov_b32 s22, 6400000
    s_mov_b32 s23, 0x20000
    v_mul_u32_u24 v110, 6240, v0
    v_and_b32 v111, 63, v0
    v_and_b32 v112, 0x3c0, v0
    v_lshlrev_b32 v111, 2, v111
    v_lshl_or_b32 v111, v112, 4, v111
    v_lshlrev_b32 v100, 2, v0
    s_lshr_b32 s50, s2, 1
    s_and_b32 s53, s2, 1
    s_mul_i32 s3, s50, 50000
    s_mul_i32 s54, s53, 24576
    s_add_u32 s3, s3, s54

    buffer_load_dwordx4 v[56:59], v110, s[20:23], 0 offen
    s_add_u32 s20, s78, s3
    s_addc_u32 s21, s79, 0
    s_mov_b32 s22, 24576
    s_mov_b32 s23, 0x20000
    s_movk_i32 s3, 16384
    buffer_load_dword v44, v111, s[20:23], 0 offen offset:0
    buffer_load_dword v45, v111, s[20:23], 0 offen offset:256
    buffer_load_dword v46, v111, s[20:23], 0 offen offset:512
    buffer_load_dword v47, v111, s[20:23], 0 offen offset:768
    buffer_load_dword v48, v111, s[20:23], s3 offen offset:0
    buffer_load_dword v49, v111, s[20:23], s3 offen offset:256
    buffer_load_dword v50, v111, s[20:23], s3 offen offset:512
    buffer_load_dword v51, v111, s[20:23], s3 offen offset:768
    s_mul_i32 s22, s53, 25424
    s_movk_i32 s3, 24576

    buffer_load_dword v52, v100, s[20:23], s3 offen
    s_mul_i32 s3, s50, 50048
    s_add_u32 s3, s3, s54
    s_add_u32 s54, s3, 2490368

    v_readfirstlane_b32 s74, v0
    s_mov_b32 s55, 0x05040100
    s_nop 0
    s_cmp_lt_u32 s74, 768
    s_cbranch_scc1 L_nogate_5
    s_load_dwordx2 s[92:93], s[0:1], 40
    s_load_dwordx4 s[32:35], s[0:1], 56
    v_mov_b32 v110, 0
    s_waitcnt lgkmcnt(0)
    global_load_dwordx4 v[60:63], v110, s[92:93]

    global_load_dwordx4 v[64:67], v110, s[32:33] offset:0
    global_load_dwordx4 v[80:83], v110, s[34:35] offset:0
    global_load_dwordx4 v[68:71], v110, s[32:33] offset:16
    global_load_dwordx4 v[84:87], v110, s[34:35] offset:16
    global_load_dwordx4 v[72:75], v110, s[32:33] offset:32
    global_load_dwordx4 v[88:91], v110, s[34:35] offset:32
    global_load_dwordx4 v[76:79], v110, s[32:33] offset:48
    global_load_dwordx4 v[92:95], v110, s[34:35] offset:48
    s_lshl_b32 s74, s2, 8
    v_and_b32 v111, 255, v0
    v_add_u32 v111, s74, v111
    v_lshlrev_b32 v112, 16, v111
    v_lshlrev_b32 v111, 5, v111
    s_mov_b32 s75, 0x07060302
    s_waitcnt vmcnt(0)

    v_lshlrev_b32 v118, 16, v60
    v_and_b32 v119, 0xffff0000, v60
    v_lshlrev_b32 v120, 16, v61
    v_and_b32 v121, 0xffff0000, v61
    v_lshlrev_b32 v122, 16, v62
    v_and_b32 v123, 0xffff0000, v62
    v_lshlrev_b32 v124, 16, v63
    v_and_b32 v125, 0xffff0000, v63
    v_sub_f32 v118, v112, v118
    v_sub_f32 v119, v112, v119
    v_sub_f32 v120, v112, v120
    v_sub_f32 v121, v112, v121
    v_sub_f32 v122, v112, v122
    v_sub_f32 v123, v112, v123
    v_sub_f32 v124, v112, v124
    v_sub_f32 v125, v112, v125
    v_cvt_pk_bf16_f32 v118, v118, v119
    v_cvt_pk_bf16_f32 v120, v120, v121
    v_cvt_pk_bf16_f32 v122, v122, v123
    v_cvt_pk_bf16_f32 v124, v124, v125
    v_and_b32 v119, 0xffff0000, v118
    v_lshlrev_b32 v118, 16, v118
    v_and_b32 v121, 0xffff0000, v120
    v_lshlrev_b32 v120, 16, v120
    v_and_b32 v123, 0xffff0000, v122
    v_lshlrev_b32 v122, 16, v122
    v_and_b32 v125, 0xffff0000, v124
    v_lshlrev_b32 v124, 16, v124
    v_mul_f32 v118, v118, v118
    v_mul_f32 v119, v119, v119
    v_mul_f32 v120, v120, v120
    v_mul_f32 v121, v121, v121
    v_mul_f32 v122, v122, v122
    v_mul_f32 v123, v123, v123
    v_mul_f32 v124, v124, v124
    v_mul_f32 v125, v125, v125
    v_cvt_pk_bf16_f32 v118, v118, v119
    v_cvt_pk_bf16_f32 v120, v120, v121
    v_cvt_pk_bf16_f32 v122, v122, v123
    v_cvt_pk_bf16_f32 v124, v124, v125
    v_and_b32 v119, 0xffff0000, v118
    v_lshlrev_b32 v118, 16, v118
    v_and_b32 v121, 0xffff0000, v120
    v_lshlrev_b32 v120, 16, v120
    v_and_b32 v123, 0xffff0000, v122
    v_lshlrev_b32 v122, 16, v122
    v_and_b32 v125, 0xffff0000, v124
    v_lshlrev_b32 v124, 16, v124
    v_mul_f32 v118, 0xc1200000, v118
    v_mul_f32 v119, 0xc1200000, v119
    v_mul_f32 v120, 0xc1200000, v120
    v_mul_f32 v121, 0xc1200000, v121
    v_mul_f32 v122, 0xc1200000, v122
    v_mul_f32 v123, 0xc1200000, v123
    v_mul_f32 v124, 0xc1200000, v124
    v_mul_f32 v125, 0xc1200000, v125
    v_cvt_pk_bf16_f32 v118, v118, v119
    v_cvt_pk_bf16_f32 v120, v120, v121
    v_cvt_pk_bf16_f32 v122, v122, v123
    v_cvt_pk_bf16_f32 v124, v124, v125
    v_and_b32 v119, 0xffff0000, v118
    v_lshlrev_b32 v118, 16, v118
    v_and_b32 v121, 0xffff0000, v120
    v_lshlrev_b32 v120, 16, v120
    v_and_b32 v123, 0xffff0000, v122
    v_lshlrev_b32 v122, 16, v122
    v_and_b32 v125, 0xffff0000, v124
    v_lshlrev_b32 v124, 16, v124
    v_mul_f32 v118, 0x3fb8aa3b, v118
    v_mul_f32 v119, 0x3fb8aa3b, v119
    v_mul_f32 v120, 0x3fb8aa3b, v120
    v_mul_f32 v121, 0x3fb8aa3b, v121
    v_mul_f32 v122, 0x3fb8aa3b, v122
    v_mul_f32 v123, 0x3fb8aa3b, v123
    v_mul_f32 v124, 0x3fb8aa3b, v124
    v_mul_f32 v125, 0x3fb8aa3b, v125
    v_exp_f32 v118, v118
    v_exp_f32 v119, v119
    v_exp_f32 v120, v120
    v_exp_f32 v121, v121
    v_exp_f32 v122, v122
    v_exp_f32 v123, v123
    v_exp_f32 v124, v124
    v_exp_f32 v125, v125
    s_nop 0
    v_cvt_pk_bf16_f32 v118, v118, v119
    v_cvt_pk_bf16_f32 v120, v120, v121
    v_cvt_pk_bf16_f32 v122, v122, v123
    v_cvt_pk_bf16_f32 v124, v124, v125
    v_perm_b32 v113, v66, v64, s55
    v_dot2_f32_bf16 v114, v118, v113, 0

    v_perm_b32 v113, v66, v64, s75
    v_dot2_f32_bf16 v115, v118, v113, 0

    v_perm_b32 v113, v67, v65, s55
    v_dot2_f32_bf16 v116, v118, v113, 0

    v_perm_b32 v113, v67, v65, s75
    v_dot2_f32_bf16 v117, v118, v113, 0

    v_perm_b32 v113, v70, v68, s55
    v_dot2_f32_bf16 v114, v120, v113, v114

    v_perm_b32 v113, v70, v68, s75
    v_dot2_f32_bf16 v115, v120, v113, v115

    v_perm_b32 v113, v71, v69, s55
    v_dot2_f32_bf16 v116, v120, v113, v116

    v_perm_b32 v113, v71, v69, s75
    v_dot2_f32_bf16 v117, v120, v113, v117

    v_perm_b32 v113, v74, v72, s55
    v_dot2_f32_bf16 v114, v122, v113, v114

    v_perm_b32 v113, v74, v72, s75
    v_dot2_f32_bf16 v115, v122, v113, v115

    v_perm_b32 v113, v75, v73, s55
    v_dot2_f32_bf16 v116, v122, v113, v116

    v_perm_b32 v113, v75, v73, s75
    v_dot2_f32_bf16 v117, v122, v113, v117

    v_perm_b32 v113, v78, v76, s55
    v_dot2_f32_bf16 v114, v124, v113, v114

    v_perm_b32 v113, v78, v76, s75
    v_dot2_f32_bf16 v115, v124, v113, v115

    v_perm_b32 v113, v79, v77, s55
    v_dot2_f32_bf16 v116, v124, v113, v116

    v_perm_b32 v113, v79, v77, s75
    v_dot2_f32_bf16 v117, v124, v113, v117

    v_perm_b32 v113, v82, v80, s55
    v_dot2_f32_bf16 v60, v118, v113, 0

    v_perm_b32 v113, v82, v80, s75
    v_dot2_f32_bf16 v61, v118, v113, 0

    v_perm_b32 v113, v83, v81, s55
    v_dot2_f32_bf16 v62, v118, v113, 0

    v_perm_b32 v113, v83, v81, s75
    v_dot2_f32_bf16 v63, v118, v113, 0

    v_perm_b32 v113, v86, v84, s55
    v_dot2_f32_bf16 v60, v120, v113, v60

    v_perm_b32 v113, v86, v84, s75
    v_dot2_f32_bf16 v61, v120, v113, v61

    v_perm_b32 v113, v87, v85, s55
    v_dot2_f32_bf16 v62, v120, v113, v62

    v_perm_b32 v113, v87, v85, s75
    v_dot2_f32_bf16 v63, v120, v113, v63

    v_perm_b32 v113, v90, v88, s55
    v_dot2_f32_bf16 v60, v122, v113, v60

    v_perm_b32 v113, v90, v88, s75
    v_dot2_f32_bf16 v61, v122, v113, v61

    v_perm_b32 v113, v91, v89, s55
    v_dot2_f32_bf16 v62, v122, v113, v62

    v_perm_b32 v113, v91, v89, s75
    v_dot2_f32_bf16 v63, v122, v113, v63

    v_perm_b32 v113, v94, v92, s55
    v_dot2_f32_bf16 v60, v124, v113, v60

    v_perm_b32 v113, v94, v92, s75
    v_dot2_f32_bf16 v61, v124, v113, v61

    v_perm_b32 v113, v95, v93, s55
    v_dot2_f32_bf16 v62, v124, v113, v62

    v_perm_b32 v113, v95, v93, s75
    v_dot2_f32_bf16 v63, v124, v113, v63

    s_add_u32 s92, s6, 393216
    s_addc_u32 s93, s7, 0
    s_mov_b32 s94, 2097152
    s_mov_b32 s95, 0x20000
    v_cvt_pk_bf16_f32 v114, v114, v115
    v_cvt_pk_bf16_f32 v115, v116, v117
    buffer_store_dwordx4 v[60:63], v111, s[92:95], 0 offen
    buffer_store_dwordx2 v[114:115], v111, s[92:95], 0 offen offset:16
    s_nop 1
L_nogate_5:

    s_mov_b32 s8, s80
    s_mov_b32 s9, s81
    s_mov_b32 s10, 0
    s_mov_b32 s11, 0x20000
    s_mov_b32 s12, s82
    s_mov_b32 s13, s83
    s_mov_b32 s14, 0
    s_mov_b32 s15, 0x20000
    s_mov_b32 s16, s84
    s_mov_b32 s17, s85
    s_mov_b32 s18, 0
    s_mov_b32 s19, 0x20000
    s_lshr_b32 s74, s2, 1
    s_and_b32 s74, s74, 28
    s_lshr_b32 s86, 0x00102010, s74
    s_lshr_b32 s87, 0x44414241, s74
    s_lshr_b32 s41, 0x43221100, s74
    s_and_b32 s86, s86, 15
    s_and_b32 s87, s87, 15
    s_and_b32 s41, s41, 15
    s_lshr_b32 s74, s2, 6
    s_lshl_b32 s74, s74, 3
    s_and_b32 s75, s2, 7
    s_add_u32 s74, s74, s75
    s_mul_i32 s74, s74, 5
    s_add_u32 s41, s41, s74

    s_mul_i32 s78, s41, 16384
    s_add_u32 s49, s78, 16384
    s_cmp_ge_u32 s41, 3125
    s_cmovk_i32 s49, 0
    s_cmovk_i32 s78, 0
    s_lshl_b32 s10, s49, 2
    s_lshl_b32 s14, s49, 2
    s_lshl_b32 s18, s49, 1
    s_sub_u32 s79, s87, s86
    s_bfm_b32 s85, s79, s86
    s_lshl_b32 s86, s86, 12
    s_lshl_b32 s87, s87, 12
    s_min_u32 s87, s87, 16384

    s_add_u32 s79, s78, 0
    s_bitcmp1_b32 s85, 0
    s_cselect_b32 s79, s79, 0x1ff00000
    s_lshl_b32 s56, s79, 2
    s_lshl_b32 s61, s79, 1

    s_add_u32 s79, s78, 4096
    s_bitcmp1_b32 s85, 1
    s_cselect_b32 s79, s79, 0x1ff00000
    s_lshl_b32 s57, s79, 2
    s_lshl_b32 s62, s79, 1

    s_add_u32 s79, s78, 8192
    s_bitcmp1_b32 s85, 2
    s_cselect_b32 s79, s79, 0x1ff00000
    s_lshl_b32 s58, s79, 2
    s_lshl_b32 s63, s79, 1

    s_add_u32 s79, s78, 12288
    s_bitcmp1_b32 s85, 3
    s_cselect_b32 s79, s79, 0x1ff00000
    s_lshl_b32 s59, s79, 2
    s_lshl_b32 s64, s79, 1

    s_mov_b32 s82, s85
    s_mov_b32 s83, s86
    s_mov_b32 s84, s87
    s_add_u32 s41, s2, 160
    s_mul_i32 s74, s41, 16384
    s_mov_b32 s10, 204800000
    s_mov_b32 s14, 204800000
    s_mov_b32 s18, 102400000

    s_add_u32 s75, s74, 0
    s_lshl_b32 s76, s75, 2
    s_lshl_b32 s75, s75, 1
    s_bitcmp1_b32 s82, 0
    s_cselect_b32 s56, s56, s76
    s_cselect_b32 s61, s61, s75

    s_add_u32 s75, s74, 4096
    s_lshl_b32 s76, s75, 2
    s_lshl_b32 s75, s75, 1
    s_bitcmp1_b32 s82, 1
    s_cselect_b32 s57, s57, s76
    s_cselect_b32 s62, s62, s75

    s_add_u32 s75, s74, 8192
    s_lshl_b32 s76, s75, 2
    s_lshl_b32 s75, s75, 1
    s_bitcmp1_b32 s82, 2
    s_cselect_b32 s58, s58, s76
    s_cselect_b32 s63, s63, s75

    s_add_u32 s75, s74, 12288
    s_lshl_b32 s76, s75, 2
    s_lshl_b32 s75, s75, 1
    s_bitcmp1_b32 s82, 3
    s_cselect_b32 s59, s59, s76
    s_cselect_b32 s64, s64, s75

    buffer_load_dwordx4 v[20:23], v1, s[12:15], s56 offen nt
    buffer_load_dwordx4 v[4:7], v1, s[8:11], s56 offen nt
    buffer_load_dwordx2 v[36:37], v2, s[16:19], s61 offen nt
    buffer_load_dwordx4 v[24:27], v1, s[12:15], s57 offen nt
    buffer_load_dwordx4 v[8:11], v1, s[8:11], s57 offen nt
    buffer_load_dwordx2 v[38:39], v2, s[16:19], s62 offen nt
    buffer_load_dwordx4 v[28:31], v1, s[12:15], s58 offen nt
    buffer_load_dwordx4 v[12:15], v1, s[8:11], s58 offen nt
    buffer_load_dwordx2 v[40:41], v2, s[16:19], s63 offen nt
    buffer_load_dwordx4 v[32:35], v1, s[12:15], s59 offen nt
    buffer_load_dwordx4 v[16:19], v1, s[8:11], s59 offen nt
    buffer_load_dwordx2 v[42:43], v2, s[16:19], s64 offen nt
    s_mov_b32 s86, 0
    s_mov_b32 s87, 4
    s_mul_i32 s78, s41, 16384
    s_add_u32 s49, s78, 16384
    s_cmp_ge_u32 s41, 3125
    s_cmovk_i32 s49, 0
    s_cmovk_i32 s78, 0
    s_lshl_b32 s10, s49, 2
    s_lshl_b32 s14, s49, 2
    s_lshl_b32 s18, s49, 1
    s_sub_u32 s79, s87, s86
    s_bfm_b32 s85, s79, s86
    s_lshl_b32 s86, s86, 12
    s_lshl_b32 s87, s87, 12
    s_min_u32 s87, s87, 16384

    s_add_u32 s79, s78, 0
    s_bitcmp1_b32 s85, 0
    s_cselect_b32 s79, s79, 0x1ff00000
    s_lshl_b32 s56, s79, 2
    s_lshl_b32 s61, s79, 1

    s_add_u32 s79, s78, 4096
    s_bitcmp1_b32 s85, 1
    s_cselect_b32 s79, s79, 0x1ff00000
    s_lshl_b32 s57, s79, 2
    s_lshl_b32 s62, s79, 1

    s_add_u32 s79, s78, 8192
    s_bitcmp1_b32 s85, 2
    s_cselect_b32 s79, s79, 0x1ff00000
    s_lshl_b32 s58, s79, 2
    s_lshl_b32 s63, s79, 1

    s_add_u32 s79, s78, 12288
    s_bitcmp1_b32 s85, 3
    s_cselect_b32 s79, s79, 0x1ff00000
    s_lshl_b32 s59, s79, 2
    s_lshl_b32 s64, s79, 1

    s_getreg_b32 s5, hwreg(HW_REG_XCC_ID)
    s_and_b32 s5, s5, 7
    s_mul_i32 s3, s5, 4096

    s_add_u32 s20, s6, s3
    s_addc_u32 s21, s7, 0
    s_mov_b32 s22, 4096
    s_mov_b32 s23, 0x20000
    s_mul_i32 s3, s5, 67117056
    s_add_u32 s3, s3, 85721088
    s_add_u32 s24, s6, s3
    s_addc_u32 s25, s7, 0
    s_mov_b32 s26, 67117056
    s_mov_b32 s27, 0x20000
    s_add_u32 s36, s6, 32768
    s_addc_u32 s37, s7, 0
    s_mov_b32 s38, 4
    s_mov_b32 s39, 0x20000
    s_mov_b32 s40, 687195
    s_mov_b32 s42, -6250
    s_mov_b32 s43, 1942
    s_mov_b32 s45, 0x06050400
    s_mov_b32 s46, 0x05040c00
    s_mov_b32 s47, 0x04020100
    s_mov_b32 s48, 6524
    s_mov_b32 s50, 0
    v_mov_b32 v104, 1
    v_mov_b32 v105, 0x46ff8000
    s_mov_b32 s55, 0x05040100
    v_mul_u32_u24 v106, 5, v0
    v_mov_b32 v108, 16384
    v_mov_b32 v114, 0
    v_mov_b32 v115, 0
    v_mov_b32 v116, 0
    v_mov_b32 v117, -1
    ds_write_b64 v2, v[114:115]
    s_movk_i32 s3, 1024
    v_cmp_gt_u32 s[66:67], s3, v0
    s_movk_i32 s3, 1024
    v_cmp_gt_u32 s[68:69], s3, v0
    s_mov_b64 exec, 1
    ds_write_b128 v108, v[114:117]
    s_mov_b64 exec, -1
    s_waitcnt lgkmcnt(0)
    s_lshl_b32 s88, s88, 16
    v_mov_b32 v110, 0.15915494
    v_mul_f32 v110, s88, v110
    s_mov_b32 s3, 0x7fff7fff
    v_readfirstlane_b32 s44, v110

    s_waitcnt vmcnt(12)
    v_mov_b32 v61, 0
    v_mov_b32 v62, 0
    v_mov_b32 v63, 0
    v_dot2_f32_bf16 v61, v44, v44, v61
    v_dot2_f32_bf16 v61, v45, v45, v61
    v_dot2_f32_bf16 v61, v46, v46, v61
    v_dot2_f32_bf16 v61, v47, v47, v61
    v_dot2_f32_bf16 v61, v48, v48, v61
    v_dot2_f32_bf16 v61, v49, v49, v61
    v_dot2_f32_bf16 v61, v50, v50, v61
    v_dot2_f32_bf16 v61, v51, v51, v61
    v_dot2_f32_bf16 v61, v52, v52, v61
    v_dot2_f32_bf16 v62, v56, v56, v62
    v_dot2_f32_bf16 v62, v57, v57, v62
    v_dot2_f32_bf16 v62, v58, v58, v62
    v_dot2_f32_bf16 v62, v59, v59, v62
    v_and_b32 v60, s3, v44
    v_and_b32 v64, s3, v45
    v_pk_max_u16 v60, v60, v64
    v_and_b32 v64, s3, v46
    v_pk_max_u16 v60, v60, v64
    v_and_b32 v64, s3, v47
    v_pk_max_u16 v60, v60, v64
    v_and_b32 v64, s3, v48
    v_pk_max_u16 v60, v60, v64
    v_and_b32 v64, s3, v49
    v_pk_max_u16 v60, v60, v64
    v_and_b32 v64, s3, v50
    v_pk_max_u16 v60, v60, v64
    v_and_b32 v64, s3, v51
    v_pk_max_u16 v60, v60, v64
    v_and_b32 v64, s3, v52
    v_pk_max_u16 v60, v60, v64
    v_lshrrev_b32 v64, 16, v60
    v_and_b32 v60, 0xffff, v60
    v_max_u32 v60, v60, v64

    s_nop 1
    v_max_u32_dpp v60, v60, v60 row_shr:1 row_mask:0xf bank_mask:0xf
    s_nop 1
    v_max_u32_dpp v60, v60, v60 row_shr:2 row_mask:0xf bank_mask:0xf
    s_nop 1
    v_max_u32_dpp v60, v60, v60 row_shr:4 row_mask:0xf bank_mask:0xf
    s_nop 1
    v_max_u32_dpp v60, v60, v60 row_shr:8 row_mask:0xf bank_mask:0xf
    s_nop 1
    v_max_u32_dpp v60, v60, v60 row_bcast:15 row_mask:0xa bank_mask:0xf
    s_nop 1
    v_max_u32_dpp v60, v60, v60 row_bcast:31 row_mask:0xc bank_mask:0xf
    s_nop 1
    v_add_f32_dpp v61, v61, v61 row_shr:1 row_mask:0xf bank_mask:0xf
    s_nop 1
    v_add_f32_dpp v61, v61, v61 row_shr:2 row_mask:0xf bank_mask:0xf
    s_nop 1
    v_add_f32_dpp v61, v61, v61 row_shr:4 row_mask:0xf bank_mask:0xf
    s_nop 1
    v_add_f32_dpp v61, v61, v61 row_shr:8 row_mask:0xf bank_mask:0xf
    s_nop 1
    v_add_f32_dpp v61, v61, v61 row_bcast:15 row_mask:0xa bank_mask:0xf
    s_nop 1
    v_add_f32_dpp v61, v61, v61 row_bcast:31 row_mask:0xc bank_mask:0xf
    s_nop 1
    v_add_f32_dpp v62, v62, v62 row_shr:1 row_mask:0xf bank_mask:0xf
    s_nop 1
    v_add_f32_dpp v62, v62, v62 row_shr:2 row_mask:0xf bank_mask:0xf
    s_nop 1
    v_add_f32_dpp v62, v62, v62 row_shr:4 row_mask:0xf bank_mask:0xf
    s_nop 1
    v_add_f32_dpp v62, v62, v62 row_shr:8 row_mask:0xf bank_mask:0xf
    s_nop 1
    v_add_f32_dpp v62, v62, v62 row_bcast:15 row_mask:0xa bank_mask:0xf
    s_nop 1
    v_add_f32_dpp v62, v62, v62 row_bcast:31 row_mask:0xc bank_mask:0xf
    v_lshrrev_b32 v64, 6, v0
    v_lshlrev_b32 v64, 4, v64
    s_mov_b32 exec_lo, 0
    s_brev_b32 exec_hi, 1
    ds_write_b128 v64, v[60:63] offset:8192
    s_mov_b64 exec, -1
    v_and_b32 v64, 15, v0
    v_lshlrev_b32 v64, 4, v64
    s_waitcnt lgkmcnt(0)
    s_barrier
    ds_read_b128 v[60:63], v64 offset:8192
    s_waitcnt lgkmcnt(0)

    s_nop 0
    v_max_u32_dpp v60, v60, v60 row_ror:1 row_mask:0xf bank_mask:0xf
    v_add_f32_dpp v61, v61, v61 row_ror:1 row_mask:0xf bank_mask:0xf
    v_add_f32_dpp v62, v62, v62 row_ror:1 row_mask:0xf bank_mask:0xf

    s_nop 0
    v_max_u32_dpp v60, v60, v60 row_ror:2 row_mask:0xf bank_mask:0xf
    v_add_f32_dpp v61, v61, v61 row_ror:2 row_mask:0xf bank_mask:0xf
    v_add_f32_dpp v62, v62, v62 row_ror:2 row_mask:0xf bank_mask:0xf

    s_nop 0
    v_max_u32_dpp v60, v60, v60 row_ror:4 row_mask:0xf bank_mask:0xf
    v_add_f32_dpp v61, v61, v61 row_ror:4 row_mask:0xf bank_mask:0xf
    v_add_f32_dpp v62, v62, v62 row_ror:4 row_mask:0xf bank_mask:0xf

    s_nop 0
    v_max_u32_dpp v60, v60, v60 row_ror:8 row_mask:0xf bank_mask:0xf
    v_add_f32_dpp v61, v61, v61 row_ror:8 row_mask:0xf bank_mask:0xf
    v_add_f32_dpp v62, v62, v62 row_ror:8 row_mask:0xf bank_mask:0xf

    v_rsq_f32 v62, v62
    v_mov_b32 v65, 0x4b400000
    v_mul_f32 v62, 0x47decb04, v62
    s_nop 0
    v_readfirstlane_b32 s74, v62

    s_add_u32 s92, s6, 135168
    s_addc_u32 s93, s7, 0
    s_mov_b32 s94, 4096
    s_mov_b32 s95, 0x20000
    s_lshl_b32 s3, s2, 4
    buffer_store_dwordx4 v[60:63], v98, s[92:95], s3 offen
    v_lshlrev_b32 v66, 16, v44
    v_and_b32 v44, 0xffff0000, v44
    v_fma_f32 v66, v66, s74, v65
    v_fma_f32 v44, v44, s74, v65
    v_perm_b32 v44, v44, v66, s55

    v_lshlrev_b32 v66, 16, v45
    v_and_b32 v45, 0xffff0000, v45
    v_fma_f32 v66, v66, s74, v65
    v_fma_f32 v45, v45, s74, v65
    v_perm_b32 v45, v45, v66, s55

    v_lshlrev_b32 v66, 16, v46
    v_and_b32 v46, 0xffff0000, v46
    v_fma_f32 v66, v66, s74, v65
    v_fma_f32 v46, v46, s74, v65
    v_perm_b32 v46, v46, v66, s55

    v_lshlrev_b32 v66, 16, v47
    v_and_b32 v47, 0xffff0000, v47
    v_fma_f32 v66, v66, s74, v65
    v_fma_f32 v47, v47, s74, v65
    v_perm_b32 v47, v47, v66, s55

    v_lshlrev_b32 v66, 16, v48
    v_and_b32 v48, 0xffff0000, v48
    v_fma_f32 v66, v66, s74, v65
    v_fma_f32 v48, v48, s74, v65
    v_perm_b32 v48, v48, v66, s55

    v_lshlrev_b32 v66, 16, v49
    v_and_b32 v49, 0xffff0000, v49
    v_fma_f32 v66, v66, s74, v65
    v_fma_f32 v49, v49, s74, v65
    v_perm_b32 v49, v49, v66, s55

    v_lshlrev_b32 v66, 16, v50
    v_and_b32 v50, 0xffff0000, v50
    v_fma_f32 v66, v66, s74, v65
    v_fma_f32 v50, v50, s74, v65
    v_perm_b32 v50, v50, v66, s55

    v_lshlrev_b32 v66, 16, v51
    v_and_b32 v51, 0xffff0000, v51
    v_fma_f32 v66, v66, s74, v65
    v_fma_f32 v51, v51, s74, v65
    v_perm_b32 v51, v51, v66, s55

    v_lshlrev_b32 v66, 16, v52
    v_and_b32 v52, 0xffff0000, v52
    v_fma_f32 v66, v66, s74, v65
    v_fma_f32 v52, v52, s74, v65
    v_perm_b32 v52, v52, v66, s55

    s_add_u32 s92, s6, s54
    s_addc_u32 s93, s7, 0
    s_mov_b32 s94, 24576
    s_mov_b32 s95, 0x20000
    s_movk_i32 s3, 16384
    buffer_store_dwordx4 v[44:47], v1, s[92:95], 0 offen
    buffer_store_dwordx4 v[48:51], v1, s[92:95], s3 offen
    s_mul_i32 s94, s53, 25424
    s_movk_i32 s3, 24576

    buffer_store_dword v52, v100, s[92:95], s3 offen
    s_nop 1
    v_mov_b32 v100, 0
    buffer_atomic_add v100, v98, s[96:99], 0 offen offset:128 sc0
    s_bitcmp0_b32 s82, 0
    s_cbranch_scc1 L_ska_8
    s_waitcnt vmcnt(14)
    v_mul_hi_u32_u24 v45, s40, v20
    v_mul_hi_u32_u24 v44, s40, v4
    v_mul_hi_u32_u24 v47, s40, v21
    v_mul_hi_u32_u24 v46, s40, v5
    v_mul_hi_u32_u24 v49, s40, v22
    v_mul_hi_u32_u24 v48, s40, v6
    v_mul_hi_u32_u24 v51, s40, v23
    v_mul_hi_u32_u24 v50, s40, v7
    v_and_b32 v45, -2, v45
    v_mad_u32_u24 v4, v44, s43, v4
    v_and_b32 v76, -4, v44
    v_and_b32 v47, -2, v47
    v_mad_u32_u24 v5, v46, s43, v5
    v_and_b32 v77, -4, v46
    v_and_b32 v49, -2, v49
    v_mad_u32_u24 v6, v48, s43, v6
    v_and_b32 v78, -4, v48
    v_and_b32 v51, -2, v51
    v_mad_u32_u24 v7, v50, s43, v7
    v_and_b32 v79, -4, v50
    v_mad_i32_i24 v20, v45, s42, v20
    v_lshl_add_u32 v45, v76, 5, v45
    v_mad_i32_i24 v21, v47, s42, v21
    v_lshl_add_u32 v47, v77, 5, v47
    v_mad_i32_i24 v22, v49, s42, v22
    v_lshl_add_u32 v49, v78, 5, v49
    v_mad_i32_i24 v23, v51, s42, v23
    v_lshl_add_u32 v51, v79, 5, v51
    v_add_u32 v45, v45, v45
    ds_add_rtn_u32 v76, v45, v104
    v_add_u32 v47, v47, v47
    ds_add_rtn_u32 v77, v47, v104
    v_add_u32 v49, v49, v49
    ds_add_rtn_u32 v78, v49, v104
    v_add_u32 v51, v51, v51
    ds_add_rtn_u32 v79, v51, v104
    v_lshlrev_b32 v110, 16, v36
    v_and_b32 v111, 0xffff0000, v36
    v_lshlrev_b32 v112, 16, v37
    v_and_b32 v113, 0xffff0000, v37
    v_mul_f32 v110, s44, v110
    v_mul_f32 v111, s44, v111
    v_mul_f32 v112, s44, v112
    v_mul_f32 v113, s44, v113
    v_fract_f32 v110, v110
    v_fract_f32 v111, v111
    v_fract_f32 v112, v112
    v_fract_f32 v113, v113
    v_cos_f32 v110, v110
    v_cos_f32 v111, v111
    v_cos_f32 v112, v112
    v_cos_f32 v113, v113
    v_lshl_or_b32 v44, v44, 14, v20
    v_perm_b32 v45, v45, v4, s46
    v_bfe_u32 v4, v4, 8, 5

    v_lshl_or_b32 v46, v46, 14, v21
    v_perm_b32 v47, v47, v5, s46
    v_bfe_u32 v5, v5, 8, 5

    v_lshl_or_b32 v48, v48, 14, v22
    v_perm_b32 v49, v49, v6, s46
    v_bfe_u32 v6, v6, 8, 5

    v_lshl_or_b32 v50, v50, 14, v23
    v_perm_b32 v51, v51, v7, s46
    v_bfe_u32 v7, v7, 8, 5

    v_fmaak_f32 v110, v110, v105, 0x4b400010
    v_fmaak_f32 v111, v111, v105, 0x4b400010
    v_fmaak_f32 v112, v112, v105, 0x4b400010
    v_fmaak_f32 v113, v113, v105, 0x4b400010
    v_sub_u32 v110, v110, v4
    v_sub_u32 v111, v111, v5
    v_sub_u32 v112, v112, v6
    v_sub_u32 v113, v113, v7
    v_bfi_b32 v110, 31, v4, v110
    v_bfi_b32 v111, 31, v5, v111
    v_bfi_b32 v112, 31, v6, v112
    v_bfi_b32 v113, 31, v7, v113
    v_perm_b32 v44, v44, v110, s55
    v_perm_b32 v46, v46, v111, s55
    v_perm_b32 v48, v48, v112, s55
    v_perm_b32 v50, v50, v113, s55
    buffer_load_dwordx4 v[20:23], v1, s[12:15], s56 offen nt
    buffer_load_dwordx4 v[4:7], v1, s[8:11], s56 offen nt
    buffer_load_dwordx2 v[36:37], v2, s[16:19], s61 offen nt
L_bka_9:
    s_bitcmp0_b32 s82, 1
    s_cbranch_scc1 L_ska_10
    s_waitcnt vmcnt(14)
    v_mul_hi_u32_u24 v53, s40, v24
    v_mul_hi_u32_u24 v52, s40, v8
    v_mul_hi_u32_u24 v55, s40, v25
    v_mul_hi_u32_u24 v54, s40, v9
    v_mul_hi_u32_u24 v57, s40, v26
    v_mul_hi_u32_u24 v56, s40, v10
    v_mul_hi_u32_u24 v59, s40, v27
    v_mul_hi_u32_u24 v58, s40, v11
    v_and_b32 v53, -2, v53
    v_mad_u32_u24 v8, v52, s43, v8
    v_and_b32 v80, -4, v52
    v_and_b32 v55, -2, v55
    v_mad_u32_u24 v9, v54, s43, v9
    v_and_b32 v81, -4, v54
    v_and_b32 v57, -2, v57
    v_mad_u32_u24 v10, v56, s43, v10
    v_and_b32 v82, -4, v56
    v_and_b32 v59, -2, v59
    v_mad_u32_u24 v11, v58, s43, v11
    v_and_b32 v83, -4, v58
    v_mad_i32_i24 v24, v53, s42, v24
    v_lshl_add_u32 v53, v80, 5, v53
    v_mad_i32_i24 v25, v55, s42, v25
    v_lshl_add_u32 v55, v81, 5, v55
    v_mad_i32_i24 v26, v57, s42, v26
    v_lshl_add_u32 v57, v82, 5, v57
    v_mad_i32_i24 v27, v59, s42, v27
    v_lshl_add_u32 v59, v83, 5, v59
    v_add_u32 v53, v53, v53
    ds_add_rtn_u32 v80, v53, v104
    v_add_u32 v55, v55, v55
    ds_add_rtn_u32 v81, v55, v104
    v_add_u32 v57, v57, v57
    ds_add_rtn_u32 v82, v57, v104
    v_add_u32 v59, v59, v59
    ds_add_rtn_u32 v83, v59, v104
    v_lshlrev_b32 v110, 16, v38
    v_and_b32 v111, 0xffff0000, v38
    v_lshlrev_b32 v112, 16, v39
    v_and_b32 v113, 0xffff0000, v39
    v_mul_f32 v110, s44, v110
    v_mul_f32 v111, s44, v111
    v_mul_f32 v112, s44, v112
    v_mul_f32 v113, s44, v113
    v_fract_f32 v110, v110
    v_fract_f32 v111, v111
    v_fract_f32 v112, v112
    v_fract_f32 v113, v113
    v_cos_f32 v110, v110
    v_cos_f32 v111, v111
    v_cos_f32 v112, v112
    v_cos_f32 v113, v113
    v_lshl_or_b32 v52, v52, 14, v24
    v_perm_b32 v53, v53, v8, s46
    v_bfe_u32 v8, v8, 8, 5

    v_lshl_or_b32 v54, v54, 14, v25
    v_perm_b32 v55, v55, v9, s46
    v_bfe_u32 v9, v9, 8, 5

    v_lshl_or_b32 v56, v56, 14, v26
    v_perm_b32 v57, v57, v10, s46
    v_bfe_u32 v10, v10, 8, 5

    v_lshl_or_b32 v58, v58, 14, v27
    v_perm_b32 v59, v59, v11, s46
    v_bfe_u32 v11, v11, 8, 5

    v_fmaak_f32 v110, v110, v105, 0x4b400010
    v_fmaak_f32 v111, v111, v105, 0x4b400010
    v_fmaak_f32 v112, v112, v105, 0x4b400010
    v_fmaak_f32 v113, v113, v105, 0x4b400010
    v_sub_u32 v110, v110, v8
    v_sub_u32 v111, v111, v9
    v_sub_u32 v112, v112, v10
    v_sub_u32 v113, v113, v11
    v_bfi_b32 v110, 31, v8, v110
    v_bfi_b32 v111, 31, v9, v111
    v_bfi_b32 v112, 31, v10, v112
    v_bfi_b32 v113, 31, v11, v113
    v_perm_b32 v52, v52, v110, s55
    v_perm_b32 v54, v54, v111, s55
    v_perm_b32 v56, v56, v112, s55
    v_perm_b32 v58, v58, v113, s55
    buffer_load_dwordx4 v[24:27], v1, s[12:15], s57 offen nt
    buffer_load_dwordx4 v[8:11], v1, s[8:11], s57 offen nt
    buffer_load_dwordx2 v[38:39], v2, s[16:19], s62 offen nt
L_bka_11:
    s_bitcmp0_b32 s82, 2
    s_cbranch_scc1 L_ska_12
    s_waitcnt vmcnt(14)
    v_mul_hi_u32_u24 v61, s40, v28
    v_mul_hi_u32_u24 v60, s40, v12
    v_mul_hi_u32_u24 v63, s40, v29
    v_mul_hi_u32_u24 v62, s40, v13
    v_mul_hi_u32_u24 v65, s40, v30
    v_mul_hi_u32_u24 v64, s40, v14
    v_mul_hi_u32_u24 v67, s40, v31
    v_mul_hi_u32_u24 v66, s40, v15
    v_and_b32 v61, -2, v61
    v_mad_u32_u24 v12, v60, s43, v12
    v_and_b32 v84, -4, v60
    v_and_b32 v63, -2, v63
    v_mad_u32_u24 v13, v62, s43, v13
    v_and_b32 v85, -4, v62
    v_and_b32 v65, -2, v65
    v_mad_u32_u24 v14, v64, s43, v14
    v_and_b32 v86, -4, v64
    v_and_b32 v67, -2, v67
    v_mad_u32_u24 v15, v66, s43, v15
    v_and_b32 v87, -4, v66
    v_mad_i32_i24 v28, v61, s42, v28
    v_lshl_add_u32 v61, v84, 5, v61
    v_mad_i32_i24 v29, v63, s42, v29
    v_lshl_add_u32 v63, v85, 5, v63
    v_mad_i32_i24 v30, v65, s42, v30
    v_lshl_add_u32 v65, v86, 5, v65
    v_mad_i32_i24 v31, v67, s42, v31
    v_lshl_add_u32 v67, v87, 5, v67
    v_add_u32 v61, v61, v61
    ds_add_rtn_u32 v84, v61, v104
    v_add_u32 v63, v63, v63
    ds_add_rtn_u32 v85, v63, v104
    v_add_u32 v65, v65, v65
    ds_add_rtn_u32 v86, v65, v104
    v_add_u32 v67, v67, v67
    ds_add_rtn_u32 v87, v67, v104
    v_lshlrev_b32 v110, 16, v40
    v_and_b32 v111, 0xffff0000, v40
    v_lshlrev_b32 v112, 16, v41
    v_and_b32 v113, 0xffff0000, v41
    v_mul_f32 v110, s44, v110
    v_mul_f32 v111, s44, v111
    v_mul_f32 v112, s44, v112
    v_mul_f32 v113, s44, v113
    v_fract_f32 v110, v110
    v_fract_f32 v111, v111
    v_fract_f32 v112, v112
    v_fract_f32 v113, v113
    v_cos_f32 v110, v110
    v_cos_f32 v111, v111
    v_cos_f32 v112, v112
    v_cos_f32 v113, v113
    v_lshl_or_b32 v60, v60, 14, v28
    v_perm_b32 v61, v61, v12, s46
    v_bfe_u32 v12, v12, 8, 5

    v_lshl_or_b32 v62, v62, 14, v29
    v_perm_b32 v63, v63, v13, s46
    v_bfe_u32 v13, v13, 8, 5

    v_lshl_or_b32 v64, v64, 14, v30
    v_perm_b32 v65, v65, v14, s46
    v_bfe_u32 v14, v14, 8, 5

    v_lshl_or_b32 v66, v66, 14, v31
    v_perm_b32 v67, v67, v15, s46
    v_bfe_u32 v15, v15, 8, 5

    v_fmaak_f32 v110, v110, v105, 0x4b400010
    v_fmaak_f32 v111, v111, v105, 0x4b400010
    v_fmaak_f32 v112, v112, v105, 0x4b400010
    v_fmaak_f32 v113, v113, v105, 0x4b400010
    v_sub_u32 v110, v110, v12
    v_sub_u32 v111, v111, v13
    v_sub_u32 v112, v112, v14
    v_sub_u32 v113, v113, v15
    v_bfi_b32 v110, 31, v12, v110
    v_bfi_b32 v111, 31, v13, v111
    v_bfi_b32 v112, 31, v14, v112
    v_bfi_b32 v113, 31, v15, v113
    v_perm_b32 v60, v60, v110, s55
    v_perm_b32 v62, v62, v111, s55
    v_perm_b32 v64, v64, v112, s55
    v_perm_b32 v66, v66, v113, s55
    buffer_load_dwordx4 v[28:31], v1, s[12:15], s58 offen nt
    buffer_load_dwordx4 v[12:15], v1, s[8:11], s58 offen nt
    buffer_load_dwordx2 v[40:41], v2, s[16:19], s63 offen nt
L_bka_13:
    s_bitcmp0_b32 s82, 3
    s_cbranch_scc1 L_ska_14
    s_waitcnt vmcnt(14)
    s_mov_b64 exec, s[66:67]
    v_mul_hi_u32_u24 v69, s40, v32
    v_mul_hi_u32_u24 v68, s40, v16
    v_mul_hi_u32_u24 v71, s40, v33
    v_mul_hi_u32_u24 v70, s40, v17
    v_mul_hi_u32_u24 v73, s40, v34
    v_mul_hi_u32_u24 v72, s40, v18
    v_mul_hi_u32_u24 v75, s40, v35
    v_mul_hi_u32_u24 v74, s40, v19
    v_and_b32 v69, -2, v69
    v_mad_u32_u24 v16, v68, s43, v16
    v_and_b32 v88, -4, v68
    v_and_b32 v71, -2, v71
    v_mad_u32_u24 v17, v70, s43, v17
    v_and_b32 v89, -4, v70
    v_and_b32 v73, -2, v73
    v_mad_u32_u24 v18, v72, s43, v18
    v_and_b32 v90, -4, v72
    v_and_b32 v75, -2, v75
    v_mad_u32_u24 v19, v74, s43, v19
    v_and_b32 v91, -4, v74
    v_mad_i32_i24 v32, v69, s42, v32
    v_lshl_add_u32 v69, v88, 5, v69
    v_mad_i32_i24 v33, v71, s42, v33
    v_lshl_add_u32 v71, v89, 5, v71
    v_mad_i32_i24 v34, v73, s42, v34
    v_lshl_add_u32 v73, v90, 5, v73
    v_mad_i32_i24 v35, v75, s42, v35
    v_lshl_add_u32 v75, v91, 5, v75
    v_add_u32 v69, v69, v69
    ds_add_rtn_u32 v88, v69, v104
    v_add_u32 v71, v71, v71
    ds_add_rtn_u32 v89, v71, v104
    v_add_u32 v73, v73, v73
    ds_add_rtn_u32 v90, v73, v104
    v_add_u32 v75, v75, v75
    ds_add_rtn_u32 v91, v75, v104
    v_lshlrev_b32 v110, 16, v42
    v_and_b32 v111, 0xffff0000, v42
    v_lshlrev_b32 v112, 16, v43
    v_and_b32 v113, 0xffff0000, v43
    v_mul_f32 v110, s44, v110
    v_mul_f32 v111, s44, v111
    v_mul_f32 v112, s44, v112
    v_mul_f32 v113, s44, v113
    v_fract_f32 v110, v110
    v_fract_f32 v111, v111
    v_fract_f32 v112, v112
    v_fract_f32 v113, v113
    v_cos_f32 v110, v110
    v_cos_f32 v111, v111
    v_cos_f32 v112, v112
    v_cos_f32 v113, v113
    v_lshl_or_b32 v68, v68, 14, v32
    v_perm_b32 v69, v69, v16, s46
    v_bfe_u32 v16, v16, 8, 5

    v_lshl_or_b32 v70, v70, 14, v33
    v_perm_b32 v71, v71, v17, s46
    v_bfe_u32 v17, v17, 8, 5

    v_lshl_or_b32 v72, v72, 14, v34
    v_perm_b32 v73, v73, v18, s46
    v_bfe_u32 v18, v18, 8, 5

    v_lshl_or_b32 v74, v74, 14, v35
    v_perm_b32 v75, v75, v19, s46
    v_bfe_u32 v19, v19, 8, 5

    v_fmaak_f32 v110, v110, v105, 0x4b400010
    v_fmaak_f32 v111, v111, v105, 0x4b400010
    v_fmaak_f32 v112, v112, v105, 0x4b400010
    v_fmaak_f32 v113, v113, v105, 0x4b400010
    v_sub_u32 v110, v110, v16
    v_sub_u32 v111, v111, v17
    v_sub_u32 v112, v112, v18
    v_sub_u32 v113, v113, v19
    v_bfi_b32 v110, 31, v16, v110
    v_bfi_b32 v111, 31, v17, v111
    v_bfi_b32 v112, 31, v18, v112
    v_bfi_b32 v113, 31, v19, v113
    v_perm_b32 v68, v68, v110, s55
    v_perm_b32 v70, v70, v111, s55
    v_perm_b32 v72, v72, v112, s55
    v_perm_b32 v74, v74, v113, s55
    s_mov_b64 exec, -1
    buffer_load_dwordx4 v[32:35], v1, s[12:15], s59 offen nt
    buffer_load_dwordx4 v[16:19], v1, s[8:11], s59 offen nt
    buffer_load_dwordx2 v[42:43], v2, s[16:19], s64 offen nt
L_bka_15:
    v_readfirstlane_b32 s74, v0
    s_nop 1
    s_cmp_lg_u32 s74, 0
    s_cbranch_scc1 L_ready_17

    s_waitcnt vmcnt(12)
    v_readfirstlane_b32 s74, v100
    s_nop 1
    s_cmp_lg_u32 s74, 0
    s_cbranch_scc1 L_ready_17

    v_mov_b32 v110, 1
    buffer_atomic_add v110, v98, s[96:99], 0 offen offset:64 sc0
    s_waitcnt vmcnt(0)
    v_readfirstlane_b32 s74, v110
    s_nop 1
    s_cmp_lg_u32 s74, 0
    s_cbranch_scc1 L_zno_19

    s_mov_b32 s92, s6
    s_mov_b32 s93, s7
    s_mov_b32 s94, 32784
    s_mov_b32 s95, 0x20000
    v_mov_b32 v110, 0
    v_mov_b32 v111, 0
    v_mov_b32 v112, 0
    v_mov_b32 v113, 0
L_zl_18:
    buffer_store_dwordx4 v[110:113], v1, s[92:95], s74 offen sc0 sc1
    s_add_u32 s74, s74, 1024
    s_cmp_le_u32 s74, 32768
    s_cbranch_scc1 L_zl_18
    v_mov_b32 v114, 1
    s_waitcnt vmcnt(0)
    buffer_atomic_add v114, v98, s[96:99], 0 offen offset:128
L_zno_19:

L_spin_16:
    v_mov_b32 v100, 0
    buffer_atomic_add v100, v98, s[96:99], 0 offen offset:128 sc0
    s_waitcnt vmcnt(0)
    v_readfirstlane_b32 s74, v100
    s_nop 1
    s_cmp_eq_u32 s74, 0
    s_cbranch_scc1 L_spin_16
L_ready_17:

    s_waitcnt lgkmcnt(0)
    s_barrier

    ds_read_b64 v[94:95], v2
    s_waitcnt lgkmcnt(0)
    v_and_b32 v94, 0xffff, v94
    v_and_b32 v95, 0xffff, v95
    v_add_u32 v97, v94, v95
    s_nop 1
    v_add_u32_dpp v97, v97, v97 row_shr:1 row_mask:0xf bank_mask:0xf
    s_nop 1
    v_add_u32_dpp v97, v97, v97 row_shr:2 row_mask:0xf bank_mask:0xf
    s_nop 1
    v_add_u32_dpp v97, v97, v97 row_shr:4 row_mask:0xf bank_mask:0xf
    s_nop 1
    v_add_u32_dpp v97, v97, v97 row_shr:8 row_mask:0xf bank_mask:0xf
    s_nop 1
    v_add_u32_dpp v97, v97, v97 row_bcast:15 row_mask:0xa bank_mask:0xf
    s_nop 1
    v_add_u32_dpp v97, v97, v97 row_bcast:31 row_mask:0xc bank_mask:0xf
    s_mov_b32 exec_lo, 0
    s_brev_b32 exec_hi, 1
    ds_add_rtn_u32 v96, v108, v97
    s_mov_b64 exec, -1

    v_add_u32 v92, v94, v94
    v_add_u32 v93, v95, v95
    v_med3_u32 v92, v94, 2, v92
    v_med3_u32 v93, v95, 2, v93
    v_lshl_or_b32 v92, v93, 16, v92
    v_lshlrev_b32 v93, 2, v0
    buffer_atomic_add v92, v93, s[20:23], 0 offen sc0
    s_waitcnt lgkmcnt(0)
    v_readlane_b32 s77, v96, 63
    v_mul_u32_u24 v114, 65528, v0
    v_sub_u32 v97, v97, v95
    s_sub_u32 s50, s50, s83
    s_sub_u32 s77, s77, s50
    v_add_u32 v97, s77, v97
    v_sub_u32 v96, v97, v94
    v_lshlrev_b32 v111, 16, v97
    v_lshlrev_b32 v110, 16, v96
    ds_write_b64 v2, v[110:111]
    v_add_u32 v115, 32764, v114
    v_and_b32 v114, 0xffffff80, v114
    v_and_b32 v115, 0xffffff80, v115
    v_mad_i32_i24 v96, v96, -5, v114
    v_mad_i32_i24 v97, v97, -5, v115
    s_add_u32 s50, s50, s84
    s_mov_b32 s28, s82
    s_mov_b32 s29, s83
    s_mov_b32 s30, s84
    s_lshl_b32 s74, s29, 3
    s_lshl_b32 s75, s30, 3
    v_mov_b32 v125, s74
    v_mov_b32 v126, s75
    v_mov_b32 v127, -1

    s_waitcnt lgkmcnt(0)
    s_barrier

    s_mov_b64 exec, 1
    ds_write_b32 v125, v127 offset:16396
    ds_write_b32 v126, v127 offset:16404
    s_mov_b64 exec, -1

    s_bitcmp0_b32 s28, 0
    s_cbranch_scc1 L_skz_20
    v_lshrrev_b32 v110, 16, v45
    ds_read_b32 v110, v110
    v_lshrrev_b32 v111, 16, v47
    ds_read_b32 v111, v111
    v_lshrrev_b32 v112, 16, v49
    ds_read_b32 v112, v112
    v_lshrrev_b32 v113, 16, v51
    ds_read_b32 v113, v113
    s_waitcnt lgkmcnt(3)
    v_add_u32_sdwa v110, v110, v76 dst_sel:DWORD dst_unused:UNUSED_PAD src0_sel:WORD_1 src1_sel:WORD_0
    v_lshlrev_b32 v110, 3, v110
    ds_write_b64 v110, v[44:45] offset:16400

    s_waitcnt lgkmcnt(3)
    v_add_u32_sdwa v111, v111, v77 dst_sel:DWORD dst_unused:UNUSED_PAD src0_sel:WORD_1 src1_sel:WORD_0
    v_lshlrev_b32 v111, 3, v111
    ds_write_b64 v111, v[46:47] offset:16400

    s_waitcnt lgkmcnt(3)
    v_add_u32_sdwa v112, v112, v78 dst_sel:DWORD dst_unused:UNUSED_PAD src0_sel:WORD_1 src1_sel:WORD_0
    v_lshlrev_b32 v112, 3, v112
    ds_write_b64 v112, v[48:49] offset:16400

    s_waitcnt lgkmcnt(3)
    v_add_u32_sdwa v113, v113, v79 dst_sel:DWORD dst_unused:UNUSED_PAD src0_sel:WORD_1 src1_sel:WORD_0
    v_lshlrev_b32 v113, 3, v113
    ds_write_b64 v113, v[50:51] offset:16400

L_skz_20:
    s_bitcmp0_b32 s28, 1
    s_cbranch_scc1 L_skz_21
    v_lshrrev_b32 v110, 16, v53
    ds_read_b32 v110, v110
    v_lshrrev_b32 v111, 16, v55
    ds_read_b32 v111, v111
    v_lshrrev_b32 v112, 16, v57
    ds_read_b32 v112, v112
    v_lshrrev_b32 v113, 16, v59
    ds_read_b32 v113, v113
    s_waitcnt lgkmcnt(3)
    v_add_u32_sdwa v110, v110, v80 dst_sel:DWORD dst_unused:UNUSED_PAD src0_sel:WORD_1 src1_sel:WORD_0
    v_lshlrev_b32 v110, 3, v110
    ds_write_b64 v110, v[52:53] offset:16400

    s_waitcnt lgkmcnt(3)
    v_add_u32_sdwa v111, v111, v81 dst_sel:DWORD dst_unused:UNUSED_PAD src0_sel:WORD_1 src1_sel:WORD_0
    v_lshlrev_b32 v111, 3, v111
    ds_write_b64 v111, v[54:55] offset:16400

    s_waitcnt lgkmcnt(3)
    v_add_u32_sdwa v112, v112, v82 dst_sel:DWORD dst_unused:UNUSED_PAD src0_sel:WORD_1 src1_sel:WORD_0
    v_lshlrev_b32 v112, 3, v112
    ds_write_b64 v112, v[56:57] offset:16400

    s_waitcnt lgkmcnt(3)
    v_add_u32_sdwa v113, v113, v83 dst_sel:DWORD dst_unused:UNUSED_PAD src0_sel:WORD_1 src1_sel:WORD_0
    v_lshlrev_b32 v113, 3, v113
    ds_write_b64 v113, v[58:59] offset:16400

L_skz_21:
    s_bitcmp0_b32 s28, 2
    s_cbranch_scc1 L_skz_22
    v_lshrrev_b32 v110, 16, v61
    ds_read_b32 v110, v110
    v_lshrrev_b32 v111, 16, v63
    ds_read_b32 v111, v111
    v_lshrrev_b32 v112, 16, v65
    ds_read_b32 v112, v112
    v_lshrrev_b32 v113, 16, v67
    ds_read_b32 v113, v113
    s_waitcnt lgkmcnt(3)
    v_add_u32_sdwa v110, v110, v84 dst_sel:DWORD dst_unused:UNUSED_PAD src0_sel:WORD_1 src1_sel:WORD_0
    v_lshlrev_b32 v110, 3, v110
    ds_write_b64 v110, v[60:61] offset:16400

    s_waitcnt lgkmcnt(3)
    v_add_u32_sdwa v111, v111, v85 dst_sel:DWORD dst_unused:UNUSED_PAD src0_sel:WORD_1 src1_sel:WORD_0
    v_lshlrev_b32 v111, 3, v111
    ds_write_b64 v111, v[62:63] offset:16400

    s_waitcnt lgkmcnt(3)
    v_add_u32_sdwa v112, v112, v86 dst_sel:DWORD dst_unused:UNUSED_PAD src0_sel:WORD_1 src1_sel:WORD_0
    v_lshlrev_b32 v112, 3, v112
    ds_write_b64 v112, v[64:65] offset:16400

    s_waitcnt lgkmcnt(3)
    v_add_u32_sdwa v113, v113, v87 dst_sel:DWORD dst_unused:UNUSED_PAD src0_sel:WORD_1 src1_sel:WORD_0
    v_lshlrev_b32 v113, 3, v113
    ds_write_b64 v113, v[66:67] offset:16400

L_skz_22:
    s_bitcmp0_b32 s28, 3
    s_cbranch_scc1 L_skz_23
    s_mov_b64 exec, s[66:67]
    v_lshrrev_b32 v110, 16, v69
    ds_read_b32 v110, v110
    v_lshrrev_b32 v111, 16, v71
    ds_read_b32 v111, v111
    v_lshrrev_b32 v112, 16, v73
    ds_read_b32 v112, v112
    v_lshrrev_b32 v113, 16, v75
    ds_read_b32 v113, v113
    s_waitcnt lgkmcnt(3)
    v_add_u32_sdwa v110, v110, v88 dst_sel:DWORD dst_unused:UNUSED_PAD src0_sel:WORD_1 src1_sel:WORD_0
    v_lshlrev_b32 v110, 3, v110
    ds_write_b64 v110, v[68:69] offset:16400

    s_waitcnt lgkmcnt(3)
    v_add_u32_sdwa v111, v111, v89 dst_sel:DWORD dst_unused:UNUSED_PAD src0_sel:WORD_1 src1_sel:WORD_0
    v_lshlrev_b32 v111, 3, v111
    ds_write_b64 v111, v[70:71] offset:16400

    s_waitcnt lgkmcnt(3)
    v_add_u32_sdwa v112, v112, v90 dst_sel:DWORD dst_unused:UNUSED_PAD src0_sel:WORD_1 src1_sel:WORD_0
    v_lshlrev_b32 v112, 3, v112
    ds_write_b64 v112, v[72:73] offset:16400

    s_waitcnt lgkmcnt(3)
    v_add_u32_sdwa v113, v113, v91 dst_sel:DWORD dst_unused:UNUSED_PAD src0_sel:WORD_1 src1_sel:WORD_0
    v_lshlrev_b32 v113, 3, v113
    ds_write_b64 v113, v[74:75] offset:16400

    s_mov_b64 exec, -1
L_skz_23:
    s_cmp_eq_u32 s49, 0
    s_cbranch_scc1 L_p1epi_7
L_p1loop_6:
    s_mov_b32 s82, s85
    s_mov_b32 s83, s86
    s_mov_b32 s84, s87
    v_mov_b32 v99, 1
    buffer_atomic_add v99, v98, s[96:99], 0 offen sc0
    s_bitcmp0_b32 s82, 0
    s_cbranch_scc1 L_ska_24
    s_waitcnt vmcnt(11)
    v_mul_hi_u32_u24 v45, s40, v20
    v_mul_hi_u32_u24 v44, s40, v4
    v_mul_hi_u32_u24 v47, s40, v21
    v_mul_hi_u32_u24 v46, s40, v5
    v_mul_hi_u32_u24 v49, s40, v22
    v_mul_hi_u32_u24 v48, s40, v6
    v_mul_hi_u32_u24 v51, s40, v23
    v_mul_hi_u32_u24 v50, s40, v7
    v_and_b32 v45, -2, v45
    v_mad_u32_u24 v4, v44, s43, v4
    v_and_b32 v76, -4, v44
    v_and_b32 v47, -2, v47
    v_mad_u32_u24 v5, v46, s43, v5
    v_and_b32 v77, -4, v46
    v_and_b32 v49, -2, v49
    v_mad_u32_u24 v6, v48, s43, v6
    v_and_b32 v78, -4, v48
    v_and_b32 v51, -2, v51
    v_mad_u32_u24 v7, v50, s43, v7
    v_and_b32 v79, -4, v50
    v_mad_i32_i24 v20, v45, s42, v20
    v_lshl_add_u32 v45, v76, 5, v45
    v_mad_i32_i24 v21, v47, s42, v21
    v_lshl_add_u32 v47, v77, 5, v47
    v_mad_i32_i24 v22, v49, s42, v22
    v_lshl_add_u32 v49, v78, 5, v49
    v_mad_i32_i24 v23, v51, s42, v23
    v_lshl_add_u32 v51, v79, 5, v51
    v_add_u32 v45, v45, v45
    ds_add_rtn_u32 v76, v45, v104
    v_add_u32 v47, v47, v47
    ds_add_rtn_u32 v77, v47, v104
    v_add_u32 v49, v49, v49
    ds_add_rtn_u32 v78, v49, v104
    v_add_u32 v51, v51, v51
    ds_add_rtn_u32 v79, v51, v104
    v_lshlrev_b32 v110, 16, v36
    v_and_b32 v111, 0xffff0000, v36
    v_lshlrev_b32 v112, 16, v37
    v_and_b32 v113, 0xffff0000, v37
    v_mul_f32 v110, s44, v110
    v_mul_f32 v111, s44, v111
    v_mul_f32 v112, s44, v112
    v_mul_f32 v113, s44, v113
    v_fract_f32 v110, v110
    v_fract_f32 v111, v111
    v_fract_f32 v112, v112
    v_fract_f32 v113, v113
    v_cos_f32 v110, v110
    v_cos_f32 v111, v111
    v_cos_f32 v112, v112
    v_cos_f32 v113, v113
    v_lshl_or_b32 v44, v44, 14, v20
    v_perm_b32 v45, v45, v4, s46
    v_bfe_u32 v4, v4, 8, 5

    v_lshl_or_b32 v46, v46, 14, v21
    v_perm_b32 v47, v47, v5, s46
    v_bfe_u32 v5, v5, 8, 5

    v_lshl_or_b32 v48, v48, 14, v22
    v_perm_b32 v49, v49, v6, s46
    v_bfe_u32 v6, v6, 8, 5

    v_lshl_or_b32 v50, v50, 14, v23
    v_perm_b32 v51, v51, v7, s46
    v_bfe_u32 v7, v7, 8, 5

    v_fmaak_f32 v110, v110, v105, 0x4b400010
    v_fmaak_f32 v111, v111, v105, 0x4b400010
    v_fmaak_f32 v112, v112, v105, 0x4b400010
    v_fmaak_f32 v113, v113, v105, 0x4b400010
    v_sub_u32 v110, v110, v4
    v_sub_u32 v111, v111, v5
    v_sub_u32 v112, v112, v6
    v_sub_u32 v113, v113, v7
    v_bfi_b32 v110, 31, v4, v110
    v_bfi_b32 v111, 31, v5, v111
    v_bfi_b32 v112, 31, v6, v112
    v_bfi_b32 v113, 31, v7, v113
    v_perm_b32 v44, v44, v110, s55
    v_perm_b32 v46, v46, v111, s55
    v_perm_b32 v48, v48, v112, s55
    v_perm_b32 v50, v50, v113, s55
L_ska_24:
    s_bitcmp0_b32 s82, 1
    s_cbranch_scc1 L_ska_25
    s_waitcnt vmcnt(8)
    v_mul_hi_u32_u24 v53, s40, v24
    v_mul_hi_u32_u24 v52, s40, v8
    v_mul_hi_u32_u24 v55, s40, v25
    v_mul_hi_u32_u24 v54, s40, v9
    v_mul_hi_u32_u24 v57, s40, v26
    v_mul_hi_u32_u24 v56, s40, v10
    v_mul_hi_u32_u24 v59, s40, v27
    v_mul_hi_u32_u24 v58, s40, v11
    v_and_b32 v53, -2, v53
    v_mad_u32_u24 v8, v52, s43, v8
    v_and_b32 v80, -4, v52
    v_and_b32 v55, -2, v55
    v_mad_u32_u24 v9, v54, s43, v9
    v_and_b32 v81, -4, v54
    v_and_b32 v57, -2, v57
    v_mad_u32_u24 v10, v56, s43, v10
    v_and_b32 v82, -4, v56
    v_and_b32 v59, -2, v59
    v_mad_u32_u24 v11, v58, s43, v11
    v_and_b32 v83, -4, v58
    v_mad_i32_i24 v24, v53, s42, v24
    v_lshl_add_u32 v53, v80, 5, v53
    v_mad_i32_i24 v25, v55, s42, v25
    v_lshl_add_u32 v55, v81, 5, v55
    v_mad_i32_i24 v26, v57, s42, v26
    v_lshl_add_u32 v57, v82, 5, v57
    v_mad_i32_i24 v27, v59, s42, v27
    v_lshl_add_u32 v59, v83, 5, v59
    v_add_u32 v53, v53, v53
    ds_add_rtn_u32 v80, v53, v104
    v_add_u32 v55, v55, v55
    ds_add_rtn_u32 v81, v55, v104
    v_add_u32 v57, v57, v57
    ds_add_rtn_u32 v82, v57, v104
    v_add_u32 v59, v59, v59
    ds_add_rtn_u32 v83, v59, v104
    v_lshlrev_b32 v110, 16, v38
    v_and_b32 v111, 0xffff0000, v38
    v_lshlrev_b32 v112, 16, v39
    v_and_b32 v113, 0xffff0000, v39
    v_mul_f32 v110, s44, v110
    v_mul_f32 v111, s44, v111
    v_mul_f32 v112, s44, v112
    v_mul_f32 v113, s44, v113
    v_fract_f32 v110, v110
    v_fract_f32 v111, v111
    v_fract_f32 v112, v112
    v_fract_f32 v113, v113
    v_cos_f32 v110, v110
    v_cos_f32 v111, v111
    v_cos_f32 v112, v112
    v_cos_f32 v113, v113
    v_lshl_or_b32 v52, v52, 14, v24
    v_perm_b32 v53, v53, v8, s46
    v_bfe_u32 v8, v8, 8, 5

    v_lshl_or_b32 v54, v54, 14, v25
    v_perm_b32 v55, v55, v9, s46
    v_bfe_u32 v9, v9, 8, 5

    v_lshl_or_b32 v56, v56, 14, v26
    v_perm_b32 v57, v57, v10, s46
    v_bfe_u32 v10, v10, 8, 5

    v_lshl_or_b32 v58, v58, 14, v27
    v_perm_b32 v59, v59, v11, s46
    v_bfe_u32 v11, v11, 8, 5

    v_fmaak_f32 v110, v110, v105, 0x4b400010
    v_fmaak_f32 v111, v111, v105, 0x4b400010
    v_fmaak_f32 v112, v112, v105, 0x4b400010
    v_fmaak_f32 v113, v113, v105, 0x4b400010
    v_sub_u32 v110, v110, v8
    v_sub_u32 v111, v111, v9
    v_sub_u32 v112, v112, v10
    v_sub_u32 v113, v113, v11
    v_bfi_b32 v110, 31, v8, v110
    v_bfi_b32 v111, 31, v9, v111
    v_bfi_b32 v112, 31, v10, v112
    v_bfi_b32 v113, 31, v11, v113
    v_perm_b32 v52, v52, v110, s55
    v_perm_b32 v54, v54, v111, s55
    v_perm_b32 v56, v56, v112, s55
    v_perm_b32 v58, v58, v113, s55
L_ska_25:
    s_waitcnt vmcnt(1)
    s_waitcnt vmcnt(0)
    v_cmp_eq_u32 vcc, 0, v0
    s_mov_b64 exec, vcc
    ds_write_b32 v108, v99 offset:8
    s_mov_b64 exec, -1
    s_waitcnt vmcnt(1)
    v_lshrrev_b32 v93, 16, v92
    v_and_b32 v92, 0xffff, v92
    v_add_u32 v110, v92, v94
    v_mad_u32_u24 v92, v92, 5, v96
    v_add_u32 v111, v93, v95
    v_mad_u32_u24 v93, v93, 5, v97
    v_max_u32 v110, v110, v111
    v_cmp_le_u32 vcc, s48, v110
    s_cbranch_vccnz L_full_26
L_fback_27:
    ds_write_b64 v2, v[92:93] offset:8192

    s_waitcnt lgkmcnt(0)
    s_barrier
    ds_read_b32 v111, v108 offset:8
    s_waitcnt lgkmcnt(0)
    v_readfirstlane_b32 s41, v111
    s_nop 1

    s_add_u32 s41, s41, 416
    s_sub_u32 s78, s41, 3061
    s_lshr_b32 s79, s78, 1
    s_add_u32 s79, s79, 3061
    s_and_b32 s86, s78, 1
    s_lshl_b32 s86, s86, 1
    s_add_u32 s87, s86, 2
    s_cmp_lt_u32 s41, 3061
    s_cselect_b32 s41, s41, s79
    s_cmovk_i32 s86, 0
    s_cmovk_i32 s87, 4

    s_mul_i32 s78, s41, 16384
    s_add_u32 s49, s78, 16384
    s_cmp_ge_u32 s41, 3125
    s_cmovk_i32 s49, 0
    s_cmovk_i32 s78, 0
    s_lshl_b32 s10, s49, 2
    s_lshl_b32 s14, s49, 2
    s_lshl_b32 s18, s49, 1
    s_sub_u32 s79, s87, s86
    s_bfm_b32 s85, s79, s86
    s_lshl_b32 s86, s86, 12
    s_lshl_b32 s87, s87, 12
    s_min_u32 s87, s87, 16384

    s_add_u32 s79, s78, 0
    s_bitcmp1_b32 s85, 0
    s_cselect_b32 s79, s79, 0x1ff00000
    s_lshl_b32 s56, s79, 2
    s_lshl_b32 s61, s79, 1

    s_add_u32 s79, s78, 4096
    s_bitcmp1_b32 s85, 1
    s_cselect_b32 s79, s79, 0x1ff00000
    s_lshl_b32 s57, s79, 2
    s_lshl_b32 s62, s79, 1

    s_add_u32 s79, s78, 8192
    s_bitcmp1_b32 s85, 2
    s_cselect_b32 s79, s79, 0x1ff00000
    s_lshl_b32 s58, s79, 2
    s_lshl_b32 s63, s79, 1

    s_add_u32 s79, s78, 12288
    s_bitcmp1_b32 s85, 3
    s_cselect_b32 s79, s79, 0x1ff00000
    s_lshl_b32 s59, s79, 2
    s_lshl_b32 s64, s79, 1

    s_bitcmp0_b32 s28, 0
    s_cbranch_scc1 L_skw_28
    ds_read_b64 v[110:111], v2 offset:16400
    ds_read_b64 v[112:113], v2 offset:16408
    ds_read_b64 v[114:115], v2 offset:16392

    ds_read_b64 v[118:119], v2 offset:24592
    ds_read_b64 v[120:121], v2 offset:24600
    ds_read_b64 v[122:123], v2 offset:24584

    s_waitcnt lgkmcnt(3)
    v_lshrrev_b32 v116, 16, v111
    ds_read_b32 v116, v116 offset:8192

    s_waitcnt lgkmcnt(1)
    v_lshrrev_b32 v124, 16, v119
    ds_read_b32 v124, v124 offset:8192

    v_cmp_ne_u32_sdwa s[80:81], v111, v113 src0_sel:WORD_1 src1_sel:WORD_1
    v_cmp_ne_u32_sdwa vcc, v111, v115 src0_sel:WORD_1 src1_sel:WORD_1
    v_alignbyte_b32 v114, v115, v114, 2
    s_mov_b32 s54, -3
    v_alignbyte_b32 v111, v111, v110, 1
    v_perm_b32 v110, v110, v114, s47
    s_waitcnt lgkmcnt(1)
    v_add3_u32 v116, v116, v106, s54
    v_sub_u32 v117, 0, v116
    v_and_b32 v117, 3, v117
    s_mov_b64 exec, s[80:81]
    v_mov_b32 v117, 0
    v_mov_b32 v112, 0
    s_mov_b64 exec, vcc
    v_mov_b32 v117, 3

    s_mov_b64 exec, -1
    v_alignbyte_b32 v110, v111, v110, v117
    v_alignbyte_b32 v111, v112, v111, v117
    v_add_u32 v116, v116, v117

    buffer_store_dwordx2 v[110:111], v116, s[24:27], 0 offen
    v_cmp_ne_u32_sdwa s[80:81], v119, v121 src0_sel:WORD_1 src1_sel:WORD_1
    v_cmp_ne_u32_sdwa vcc, v119, v123 src0_sel:WORD_1 src1_sel:WORD_1
    v_alignbyte_b32 v122, v123, v122, 2
    s_mov_b32 s54, 5117
    v_alignbyte_b32 v119, v119, v118, 1
    v_perm_b32 v118, v118, v122, s47
    s_waitcnt lgkmcnt(0)
    v_add3_u32 v124, v124, v106, s54
    v_sub_u32 v125, 0, v124
    v_and_b32 v125, 3, v125
    s_mov_b64 exec, s[80:81]
    v_mov_b32 v125, 0
    v_mov_b32 v120, 0
    s_mov_b64 exec, vcc
    v_mov_b32 v125, 3

    s_mov_b64 exec, -1
    v_alignbyte_b32 v118, v119, v118, v125
    v_alignbyte_b32 v119, v120, v119, v125
    v_add_u32 v124, v124, v125

    buffer_store_dwordx2 v[118:119], v124, s[24:27], 0 offen
L_skw_28:
    s_bitcmp0_b32 s28, 0
    s_cbranch_scc1 L_skw_29
    ds_read_b64 v[110:111], v2 offset:32784
    ds_read_b64 v[112:113], v2 offset:32792
    ds_read_b64 v[114:115], v2 offset:32776

    ds_read_b64 v[118:119], v2 offset:40976
    ds_read_b64 v[120:121], v2 offset:40984
    ds_read_b64 v[122:123], v2 offset:40968

    s_waitcnt lgkmcnt(3)
    v_lshrrev_b32 v116, 16, v111
    ds_read_b32 v116, v116 offset:8192

    s_waitcnt lgkmcnt(1)
    v_lshrrev_b32 v124, 16, v119
    ds_read_b32 v124, v124 offset:8192

    v_cmp_ne_u32_sdwa s[80:81], v111, v113 src0_sel:WORD_1 src1_sel:WORD_1
    v_cmp_ne_u32_sdwa vcc, v111, v115 src0_sel:WORD_1 src1_sel:WORD_1
    v_alignbyte_b32 v114, v115, v114, 2
    s_mov_b32 s54, 10237
    v_alignbyte_b32 v111, v111, v110, 1
    v_perm_b32 v110, v110, v114, s47
    s_waitcnt lgkmcnt(1)
    v_add3_u32 v116, v116, v106, s54
    v_sub_u32 v117, 0, v116
    v_and_b32 v117, 3, v117
    s_mov_b64 exec, s[80:81]
    v_mov_b32 v117, 0
    v_mov_b32 v112, 0
    s_mov_b64 exec, vcc
    v_mov_b32 v117, 3

    s_mov_b64 exec, -1
    v_alignbyte_b32 v110, v111, v110, v117
    v_alignbyte_b32 v111, v112, v111, v117
    v_add_u32 v116, v116, v117

    buffer_store_dwordx2 v[110:111], v116, s[24:27], 0 offen
    v_cmp_ne_u32_sdwa s[80:81], v119, v121 src0_sel:WORD_1 src1_sel:WORD_1
    v_cmp_ne_u32_sdwa vcc, v119, v123 src0_sel:WORD_1 src1_sel:WORD_1
    v_alignbyte_b32 v122, v123, v122, 2
    s_mov_b32 s54, 15357
    v_alignbyte_b32 v119, v119, v118, 1
    v_perm_b32 v118, v118, v122, s47
    s_waitcnt lgkmcnt(0)
    v_add3_u32 v124, v124, v106, s54
    v_sub_u32 v125, 0, v124
    v_and_b32 v125, 3, v125
    s_mov_b64 exec, s[80:81]
    v_mov_b32 v125, 0
    v_mov_b32 v120, 0
    s_mov_b64 exec, vcc
    v_mov_b32 v125, 3

    s_mov_b64 exec, -1
    v_alignbyte_b32 v118, v119, v118, v125
    v_alignbyte_b32 v119, v120, v119, v125
    v_add_u32 v124, v124, v125

    buffer_store_dwordx2 v[118:119], v124, s[24:27], 0 offen
L_skw_29:
    s_bitcmp0_b32 s82, 2
    s_cbranch_scc1 L_ska_30
    v_mul_hi_u32_u24 v61, s40, v28
    v_mul_hi_u32_u24 v60, s40, v12
    v_mul_hi_u32_u24 v63, s40, v29
    v_mul_hi_u32_u24 v62, s40, v13
    v_mul_hi_u32_u24 v65, s40, v30
    v_mul_hi_u32_u24 v64, s40, v14
    v_mul_hi_u32_u24 v67, s40, v31
    v_mul_hi_u32_u24 v66, s40, v15
    v_and_b32 v61, -2, v61
    v_mad_u32_u24 v12, v60, s43, v12
    v_and_b32 v84, -4, v60
    v_and_b32 v63, -2, v63
    v_mad_u32_u24 v13, v62, s43, v13
    v_and_b32 v85, -4, v62
    v_and_b32 v65, -2, v65
    v_mad_u32_u24 v14, v64, s43, v14
    v_and_b32 v86, -4, v64
    v_and_b32 v67, -2, v67
    v_mad_u32_u24 v15, v66, s43, v15
    v_and_b32 v87, -4, v66
    v_mad_i32_i24 v28, v61, s42, v28
    v_lshl_add_u32 v61, v84, 5, v61
    v_mad_i32_i24 v29, v63, s42, v29
    v_lshl_add_u32 v63, v85, 5, v63
    v_mad_i32_i24 v30, v65, s42, v30
    v_lshl_add_u32 v65, v86, 5, v65
    v_mad_i32_i24 v31, v67, s42, v31
    v_lshl_add_u32 v67, v87, 5, v67
    v_add_u32 v61, v61, v61
    ds_add_rtn_u32 v84, v61, v104
    v_add_u32 v63, v63, v63
    ds_add_rtn_u32 v85, v63, v104
    v_add_u32 v65, v65, v65
    ds_add_rtn_u32 v86, v65, v104
    v_add_u32 v67, v67, v67
    ds_add_rtn_u32 v87, v67, v104
    v_lshlrev_b32 v110, 16, v40
    v_and_b32 v111, 0xffff0000, v40
    v_lshlrev_b32 v112, 16, v41
    v_and_b32 v113, 0xffff0000, v41
    v_mul_f32 v110, s44, v110
    v_mul_f32 v111, s44, v111
    v_mul_f32 v112, s44, v112
    v_mul_f32 v113, s44, v113
    v_fract_f32 v110, v110
    v_fract_f32 v111, v111
    v_fract_f32 v112, v112
    v_fract_f32 v113, v113
    v_cos_f32 v110, v110
    v_cos_f32 v111, v111
    v_cos_f32 v112, v112
    v_cos_f32 v113, v113
    v_lshl_or_b32 v60, v60, 14, v28
    v_perm_b32 v61, v61, v12, s46
    v_bfe_u32 v12, v12, 8, 5

    v_lshl_or_b32 v62, v62, 14, v29
    v_perm_b32 v63, v63, v13, s46
    v_bfe_u32 v13, v13, 8, 5

    v_lshl_or_b32 v64, v64, 14, v30
    v_perm_b32 v65, v65, v14, s46
    v_bfe_u32 v14, v14, 8, 5

    v_lshl_or_b32 v66, v66, 14, v31
    v_perm_b32 v67, v67, v15, s46
    v_bfe_u32 v15, v15, 8, 5

    v_fmaak_f32 v110, v110, v105, 0x4b400010
    v_fmaak_f32 v111, v111, v105, 0x4b400010
    v_fmaak_f32 v112, v112, v105, 0x4b400010
    v_fmaak_f32 v113, v113, v105, 0x4b400010
    v_sub_u32 v110, v110, v12
    v_sub_u32 v111, v111, v13
    v_sub_u32 v112, v112, v14
    v_sub_u32 v113, v113, v15
    v_bfi_b32 v110, 31, v12, v110
    v_bfi_b32 v111, 31, v13, v111
    v_bfi_b32 v112, 31, v14, v112
    v_bfi_b32 v113, 31, v15, v113
    v_perm_b32 v60, v60, v110, s55
    v_perm_b32 v62, v62, v111, s55
    v_perm_b32 v64, v64, v112, s55
    v_perm_b32 v66, v66, v113, s55
L_ska_30:
    s_bitcmp0_b32 s28, 1
    s_cbranch_scc1 L_skw_31
    v_add_u32 v107, 32768, v2
    ds_read_b64 v[110:111], v107 offset:16400
    ds_read_b64 v[112:113], v107 offset:16408
    ds_read_b64 v[114:115], v107 offset:16392

    ds_read_b64 v[118:119], v107 offset:24592
    ds_read_b64 v[120:121], v107 offset:24600
    ds_read_b64 v[122:123], v107 offset:24584

    s_waitcnt lgkmcnt(3)
    v_lshrrev_b32 v116, 16, v111
    ds_read_b32 v116, v116 offset:8192

    s_waitcnt lgkmcnt(1)
    v_lshrrev_b32 v124, 16, v119
    ds_read_b32 v124, v124 offset:8192

    v_cmp_ne_u32_sdwa s[80:81], v111, v113 src0_sel:WORD_1 src1_sel:WORD_1
    v_cmp_ne_u32_sdwa vcc, v111, v115 src0_sel:WORD_1 src1_sel:WORD_1
    v_alignbyte_b32 v114, v115, v114, 2
    s_mov_b32 s54, 20477
    v_alignbyte_b32 v111, v111, v110, 1
    v_perm_b32 v110, v110, v114, s47
    s_waitcnt lgkmcnt(1)
    v_add3_u32 v116, v116, v106, s54
    v_sub_u32 v117, 0, v116
    v_and_b32 v117, 3, v117
    s_mov_b64 exec, s[80:81]
    v_mov_b32 v117, 0
    v_mov_b32 v112, 0
    s_mov_b64 exec, vcc
    v_mov_b32 v117, 3

    s_mov_b64 exec, -1
    v_alignbyte_b32 v110, v111, v110, v117
    v_alignbyte_b32 v111, v112, v111, v117
    v_add_u32 v116, v116, v117

    buffer_store_dwordx2 v[110:111], v116, s[24:27], 0 offen
    v_cmp_ne_u32_sdwa s[80:81], v119, v121 src0_sel:WORD_1 src1_sel:WORD_1
    v_cmp_ne_u32_sdwa vcc, v119, v123 src0_sel:WORD_1 src1_sel:WORD_1
    v_alignbyte_b32 v122, v123, v122, 2
    s_mov_b32 s54, 25597
    v_alignbyte_b32 v119, v119, v118, 1
    v_perm_b32 v118, v118, v122, s47
    s_waitcnt lgkmcnt(0)
    v_add3_u32 v124, v124, v106, s54
    v_sub_u32 v125, 0, v124
    v_and_b32 v125, 3, v125
    s_mov_b64 exec, s[80:81]
    v_mov_b32 v125, 0
    v_mov_b32 v120, 0
    s_mov_b64 exec, vcc
    v_mov_b32 v125, 3

    s_mov_b64 exec, -1
    v_alignbyte_b32 v118, v119, v118, v125
    v_alignbyte_b32 v119, v120, v119, v125
    v_add_u32 v124, v124, v125

    buffer_store_dwordx2 v[118:119], v124, s[24:27], 0 offen
L_skw_31:
    s_bitcmp0_b32 s28, 1
    s_cbranch_scc1 L_skw_32
    v_add_u32 v107, 32768, v2
    ds_read_b64 v[110:111], v107 offset:32784
    ds_read_b64 v[112:113], v107 offset:32792
    ds_read_b64 v[114:115], v107 offset:32776

    ds_read_b64 v[118:119], v107 offset:40976
    ds_read_b64 v[120:121], v107 offset:40984
    ds_read_b64 v[122:123], v107 offset:40968

    s_waitcnt lgkmcnt(3)
    v_lshrrev_b32 v116, 16, v111
    ds_read_b32 v116, v116 offset:8192

    s_waitcnt lgkmcnt(1)
    v_lshrrev_b32 v124, 16, v119
    ds_read_b32 v124, v124 offset:8192

    v_cmp_ne_u32_sdwa s[80:81], v111, v113 src0_sel:WORD_1 src1_sel:WORD_1
    v_cmp_ne_u32_sdwa vcc, v111, v115 src0_sel:WORD_1 src1_sel:WORD_1
    v_alignbyte_b32 v114, v115, v114, 2
    s_mov_b32 s54, 30717
    v_alignbyte_b32 v111, v111, v110, 1
    v_perm_b32 v110, v110, v114, s47
    s_waitcnt lgkmcnt(1)
    v_add3_u32 v116, v116, v106, s54
    v_sub_u32 v117, 0, v116
    v_and_b32 v117, 3, v117
    s_mov_b64 exec, s[80:81]
    v_mov_b32 v117, 0
    v_mov_b32 v112, 0
    s_mov_b64 exec, vcc
    v_mov_b32 v117, 3

    s_mov_b64 exec, -1
    v_alignbyte_b32 v110, v111, v110, v117
    v_alignbyte_b32 v111, v112, v111, v117
    v_add_u32 v116, v116, v117

    buffer_store_dwordx2 v[110:111], v116, s[24:27], 0 offen
    v_cmp_ne_u32_sdwa s[80:81], v119, v121 src0_sel:WORD_1 src1_sel:WORD_1
    v_cmp_ne_u32_sdwa vcc, v119, v123 src0_sel:WORD_1 src1_sel:WORD_1
    v_alignbyte_b32 v122, v123, v122, 2
    s_mov_b32 s54, 35837
    v_alignbyte_b32 v119, v119, v118, 1
    v_perm_b32 v118, v118, v122, s47
    s_waitcnt lgkmcnt(0)
    v_add3_u32 v124, v124, v106, s54
    v_sub_u32 v125, 0, v124
    v_and_b32 v125, 3, v125
    s_mov_b64 exec, s[80:81]
    v_mov_b32 v125, 0
    v_mov_b32 v120, 0
    s_mov_b64 exec, vcc
    v_mov_b32 v125, 3

    s_mov_b64 exec, -1
    v_alignbyte_b32 v118, v119, v118, v125
    v_alignbyte_b32 v119, v120, v119, v125
    v_add_u32 v124, v124, v125

    buffer_store_dwordx2 v[118:119], v124, s[24:27], 0 offen
L_skw_32:
    s_bitcmp0_b32 s28, 2
    s_cbranch_scc1 L_skw_33
    v_add_u32 v107, 65536, v2
    ds_read_b64 v[110:111], v107 offset:16400
    ds_read_b64 v[112:113], v107 offset:16408
    ds_read_b64 v[114:115], v107 offset:16392

    ds_read_b64 v[118:119], v107 offset:24592
    ds_read_b64 v[120:121], v107 offset:24600
    ds_read_b64 v[122:123], v107 offset:24584

    s_waitcnt lgkmcnt(3)
    v_lshrrev_b32 v116, 16, v111
    ds_read_b32 v116, v116 offset:8192

    s_waitcnt lgkmcnt(1)
    v_lshrrev_b32 v124, 16, v119
    ds_read_b32 v124, v124 offset:8192

    v_cmp_ne_u32_sdwa s[80:81], v111, v113 src0_sel:WORD_1 src1_sel:WORD_1
    v_cmp_ne_u32_sdwa vcc, v111, v115 src0_sel:WORD_1 src1_sel:WORD_1
    v_alignbyte_b32 v114, v115, v114, 2
    s_mov_b32 s54, 40957
    v_alignbyte_b32 v111, v111, v110, 1
    v_perm_b32 v110, v110, v114, s47
    s_waitcnt lgkmcnt(1)
    v_add3_u32 v116, v116, v106, s54
    v_sub_u32 v117, 0, v116
    v_and_b32 v117, 3, v117
    s_mov_b64 exec, s[80:81]
    v_mov_b32 v117, 0
    v_mov_b32 v112, 0
    s_mov_b64 exec, vcc
    v_mov_b32 v117, 3

    s_mov_b64 exec, -1
    v_alignbyte_b32 v110, v111, v110, v117
    v_alignbyte_b32 v111, v112, v111, v117
    v_add_u32 v116, v116, v117

    buffer_store_dwordx2 v[110:111], v116, s[24:27], 0 offen
    v_cmp_ne_u32_sdwa s[80:81], v119, v121 src0_sel:WORD_1 src1_sel:WORD_1
    v_cmp_ne_u32_sdwa vcc, v119, v123 src0_sel:WORD_1 src1_sel:WORD_1
    v_alignbyte_b32 v122, v123, v122, 2
    s_mov_b32 s54, 46077
    v_alignbyte_b32 v119, v119, v118, 1
    v_perm_b32 v118, v118, v122, s47
    s_waitcnt lgkmcnt(0)
    v_add3_u32 v124, v124, v106, s54
    v_sub_u32 v125, 0, v124
    v_and_b32 v125, 3, v125
    s_mov_b64 exec, s[80:81]
    v_mov_b32 v125, 0
    v_mov_b32 v120, 0
    s_mov_b64 exec, vcc
    v_mov_b32 v125, 3

    s_mov_b64 exec, -1
    v_alignbyte_b32 v118, v119, v118, v125
    v_alignbyte_b32 v119, v120, v119, v125
    v_add_u32 v124, v124, v125

    buffer_store_dwordx2 v[118:119], v124, s[24:27], 0 offen
L_skw_33:
    s_bitcmp0_b32 s82, 3
    s_cbranch_scc1 L_ska_34
    s_mov_b64 exec, s[66:67]
    v_mul_hi_u32_u24 v69, s40, v32
    v_mul_hi_u32_u24 v68, s40, v16
    v_mul_hi_u32_u24 v71, s40, v33
    v_mul_hi_u32_u24 v70, s40, v17
    v_mul_hi_u32_u24 v73, s40, v34
    v_mul_hi_u32_u24 v72, s40, v18
    v_mul_hi_u32_u24 v75, s40, v35
    v_mul_hi_u32_u24 v74, s40, v19
    v_and_b32 v69, -2, v69
    v_mad_u32_u24 v16, v68, s43, v16
    v_and_b32 v88, -4, v68
    v_and_b32 v71, -2, v71
    v_mad_u32_u24 v17, v70, s43, v17
    v_and_b32 v89, -4, v70
    v_and_b32 v73, -2, v73
    v_mad_u32_u24 v18, v72, s43, v18
    v_and_b32 v90, -4, v72
    v_and_b32 v75, -2, v75
    v_mad_u32_u24 v19, v74, s43, v19
    v_and_b32 v91, -4, v74
    v_mad_i32_i24 v32, v69, s42, v32
    v_lshl_add_u32 v69, v88, 5, v69
    v_mad_i32_i24 v33, v71, s42, v33
    v_lshl_add_u32 v71, v89, 5, v71
    v_mad_i32_i24 v34, v73, s42, v34
    v_lshl_add_u32 v73, v90, 5, v73
    v_mad_i32_i24 v35, v75, s42, v35
    v_lshl_add_u32 v75, v91, 5, v75
    v_add_u32 v69, v69, v69
    ds_add_rtn_u32 v88, v69, v104
    v_add_u32 v71, v71, v71
    ds_add_rtn_u32 v89, v71, v104
    v_add_u32 v73, v73, v73
    ds_add_rtn_u32 v90, v73, v104
    v_add_u32 v75, v75, v75
    ds_add_rtn_u32 v91, v75, v104
    v_lshlrev_b32 v110, 16, v42
    v_and_b32 v111, 0xffff0000, v42
    v_lshlrev_b32 v112, 16, v43
    v_and_b32 v113, 0xffff0000, v43
    v_mul_f32 v110, s44, v110
    v_mul_f32 v111, s44, v111
    v_mul_f32 v112, s44, v112
    v_mul_f32 v113, s44, v113
    v_fract_f32 v110, v110
    v_fract_f32 v111, v111
    v_fract_f32 v112, v112
    v_fract_f32 v113, v113
    v_cos_f32 v110, v110
    v_cos_f32 v111, v111
    v_cos_f32 v112, v112
    v_cos_f32 v113, v113
    v_lshl_or_b32 v68, v68, 14, v32
    v_perm_b32 v69, v69, v16, s46
    v_bfe_u32 v16, v16, 8, 5

    v_lshl_or_b32 v70, v70, 14, v33
    v_perm_b32 v71, v71, v17, s46
    v_bfe_u32 v17, v17, 8, 5

    v_lshl_or_b32 v72, v72, 14, v34
    v_perm_b32 v73, v73, v18, s46
    v_bfe_u32 v18, v18, 8, 5

    v_lshl_or_b32 v74, v74, 14, v35
    v_perm_b32 v75, v75, v19, s46
    v_bfe_u32 v19, v19, 8, 5

    v_fmaak_f32 v110, v110, v105, 0x4b400010
    v_fmaak_f32 v111, v111, v105, 0x4b400010
    v_fmaak_f32 v112, v112, v105, 0x4b400010
    v_fmaak_f32 v113, v113, v105, 0x4b400010
    v_sub_u32 v110, v110, v16
    v_sub_u32 v111, v111, v17
    v_sub_u32 v112, v112, v18
    v_sub_u32 v113, v113, v19
    v_bfi_b32 v110, 31, v16, v110
    v_bfi_b32 v111, 31, v17, v111
    v_bfi_b32 v112, 31, v18, v112
    v_bfi_b32 v113, 31, v19, v113
    v_perm_b32 v68, v68, v110, s55
    v_perm_b32 v70, v70, v111, s55
    v_perm_b32 v72, v72, v112, s55
    v_perm_b32 v74, v74, v113, s55
    s_mov_b64 exec, -1
L_ska_34:
    s_bitcmp0_b32 s28, 2
    s_cbranch_scc1 L_skw_35
    v_add_u32 v107, 65536, v2
    ds_read_b64 v[110:111], v107 offset:32784
    ds_read_b64 v[112:113], v107 offset:32792
    ds_read_b64 v[114:115], v107 offset:32776

    ds_read_b64 v[118:119], v107 offset:40976
    ds_read_b64 v[120:121], v107 offset:40984
    ds_read_b64 v[122:123], v107 offset:40968

    s_waitcnt lgkmcnt(3)
    v_lshrrev_b32 v116, 16, v111
    ds_read_b32 v116, v116 offset:8192

    s_waitcnt lgkmcnt(1)
    v_lshrrev_b32 v124, 16, v119
    ds_read_b32 v124, v124 offset:8192

    v_cmp_ne_u32_sdwa s[80:81], v111, v113 src0_sel:WORD_1 src1_sel:WORD_1
    v_cmp_ne_u32_sdwa vcc, v111, v115 src0_sel:WORD_1 src1_sel:WORD_1
    v_alignbyte_b32 v114, v115, v114, 2
    s_mov_b32 s54, 51197
    v_alignbyte_b32 v111, v111, v110, 1
    v_perm_b32 v110, v110, v114, s47
    s_waitcnt lgkmcnt(1)
    v_add3_u32 v116, v116, v106, s54
    v_sub_u32 v117, 0, v116
    v_and_b32 v117, 3, v117
    s_mov_b64 exec, s[80:81]
    v_mov_b32 v117, 0
    v_mov_b32 v112, 0
    s_mov_b64 exec, vcc
    v_mov_b32 v117, 3

    s_mov_b64 exec, -1
    v_alignbyte_b32 v110, v111, v110, v117
    v_alignbyte_b32 v111, v112, v111, v117
    v_add_u32 v116, v116, v117

    buffer_store_dwordx2 v[110:111], v116, s[24:27], 0 offen
    v_cmp_ne_u32_sdwa s[80:81], v119, v121 src0_sel:WORD_1 src1_sel:WORD_1
    v_cmp_ne_u32_sdwa vcc, v119, v123 src0_sel:WORD_1 src1_sel:WORD_1
    v_alignbyte_b32 v122, v123, v122, 2
    s_mov_b32 s54, 56317
    v_alignbyte_b32 v119, v119, v118, 1
    v_perm_b32 v118, v118, v122, s47
    s_waitcnt lgkmcnt(0)
    v_add3_u32 v124, v124, v106, s54
    v_sub_u32 v125, 0, v124
    v_and_b32 v125, 3, v125
    s_mov_b64 exec, s[80:81]
    v_mov_b32 v125, 0
    v_mov_b32 v120, 0
    s_mov_b64 exec, vcc
    v_mov_b32 v125, 3

    s_mov_b64 exec, -1
    v_alignbyte_b32 v118, v119, v118, v125
    v_alignbyte_b32 v119, v120, v119, v125
    v_add_u32 v124, v124, v125

    buffer_store_dwordx2 v[118:119], v124, s[24:27], 0 offen
L_skw_35:
    s_bitcmp0_b32 s28, 3
    s_cbranch_scc1 L_skw_36
    v_add_u32 v107, 98304, v2
    ds_read_b64 v[110:111], v107 offset:16400
    ds_read_b64 v[112:113], v107 offset:16408
    ds_read_b64 v[114:115], v107 offset:16392

    ds_read_b64 v[118:119], v107 offset:24592
    ds_read_b64 v[120:121], v107 offset:24600
    ds_read_b64 v[122:123], v107 offset:24584

    s_waitcnt lgkmcnt(3)
    v_lshrrev_b32 v116, 16, v111
    ds_read_b32 v116, v116 offset:8192

    s_waitcnt lgkmcnt(1)
    v_lshrrev_b32 v124, 16, v119
    ds_read_b32 v124, v124 offset:8192

    v_cmp_ne_u32_sdwa s[80:81], v111, v113 src0_sel:WORD_1 src1_sel:WORD_1
    v_cmp_ne_u32_sdwa vcc, v111, v115 src0_sel:WORD_1 src1_sel:WORD_1
    v_alignbyte_b32 v114, v115, v114, 2
    s_mov_b32 s54, 61437
    v_alignbyte_b32 v111, v111, v110, 1
    v_perm_b32 v110, v110, v114, s47
    s_waitcnt lgkmcnt(1)
    v_add3_u32 v116, v116, v106, s54
    v_sub_u32 v117, 0, v116
    v_and_b32 v117, 3, v117
    s_mov_b64 exec, s[80:81]
    v_mov_b32 v117, 0
    v_mov_b32 v112, 0
    s_mov_b64 exec, vcc
    v_mov_b32 v117, 3

    s_mov_b64 exec, -1
    v_alignbyte_b32 v110, v111, v110, v117
    v_alignbyte_b32 v111, v112, v111, v117
    v_add_u32 v116, v116, v117

    buffer_store_dwordx2 v[110:111], v116, s[24:27], 0 offen
    v_cmp_ne_u32_sdwa s[80:81], v119, v121 src0_sel:WORD_1 src1_sel:WORD_1
    v_cmp_ne_u32_sdwa vcc, v119, v123 src0_sel:WORD_1 src1_sel:WORD_1
    v_alignbyte_b32 v122, v123, v122, 2
    s_mov_b32 s54, 66557
    v_alignbyte_b32 v119, v119, v118, 1
    v_perm_b32 v118, v118, v122, s47
    s_waitcnt lgkmcnt(0)
    v_add3_u32 v124, v124, v106, s54
    v_sub_u32 v125, 0, v124
    v_and_b32 v125, 3, v125
    s_mov_b64 exec, s[80:81]
    v_mov_b32 v125, 0
    v_mov_b32 v120, 0
    s_mov_b64 exec, vcc
    v_mov_b32 v125, 3

    s_mov_b64 exec, -1
    v_alignbyte_b32 v118, v119, v118, v125
    v_alignbyte_b32 v119, v120, v119, v125
    v_add_u32 v124, v124, v125

    buffer_store_dwordx2 v[118:119], v124, s[24:27], 0 offen
L_skw_36:
    s_bitcmp0_b32 s28, 3
    s_cbranch_scc1 L_skw_37
    v_add_u32 v107, 98304, v2
    ds_read_b64 v[110:111], v107 offset:32784
    ds_read_b64 v[112:113], v107 offset:32792
    ds_read_b64 v[114:115], v107 offset:32776

    ds_read_b64 v[118:119], v107 offset:40976
    ds_read_b64 v[120:121], v107 offset:40984
    ds_read_b64 v[122:123], v107 offset:40968

    s_waitcnt lgkmcnt(3)
    v_lshrrev_b32 v116, 16, v111
    ds_read_b32 v116, v116 offset:8192

    s_waitcnt lgkmcnt(1)
    v_lshrrev_b32 v124, 16, v119
    ds_read_b32 v124, v124 offset:8192

    v_cmp_ne_u32_sdwa s[80:81], v111, v113 src0_sel:WORD_1 src1_sel:WORD_1
    v_cmp_ne_u32_sdwa vcc, v111, v115 src0_sel:WORD_1 src1_sel:WORD_1
    v_alignbyte_b32 v114, v115, v114, 2
    s_mov_b32 s54, 71677
    v_alignbyte_b32 v111, v111, v110, 1
    v_perm_b32 v110, v110, v114, s47
    s_waitcnt lgkmcnt(1)
    v_add3_u32 v116, v116, v106, s54
    v_sub_u32 v117, 0, v116
    v_and_b32 v117, 3, v117
    s_mov_b64 exec, s[80:81]
    v_mov_b32 v117, 0
    v_mov_b32 v112, 0
    s_mov_b64 exec, vcc
    v_mov_b32 v117, 3

    s_mov_b64 exec, -1
    v_alignbyte_b32 v110, v111, v110, v117
    v_alignbyte_b32 v111, v112, v111, v117
    v_add_u32 v116, v116, v117

    buffer_store_dwordx2 v[110:111], v116, s[24:27], 0 offen
    v_cmp_ne_u32_sdwa s[80:81], v119, v121 src0_sel:WORD_1 src1_sel:WORD_1
    v_cmp_ne_u32_sdwa vcc, v119, v123 src0_sel:WORD_1 src1_sel:WORD_1
    v_alignbyte_b32 v122, v123, v122, 2
    s_mov_b32 s54, 76797
    v_alignbyte_b32 v119, v119, v118, 1
    v_perm_b32 v118, v118, v122, s47
    s_waitcnt lgkmcnt(0)
    v_add3_u32 v124, v124, v106, s54
    v_sub_u32 v125, 0, v124
    v_and_b32 v125, 3, v125
    s_mov_b64 exec, s[80:81]
    v_mov_b32 v125, 0
    v_mov_b32 v120, 0
    s_mov_b64 exec, vcc
    v_mov_b32 v125, 3

    s_andn2_b64 exec, -1, s[68:69]
    v_bfrev_b32 v124, 1
    s_mov_b64 exec, -1
    v_alignbyte_b32 v118, v119, v118, v125
    v_alignbyte_b32 v119, v120, v119, v125
    v_add_u32 v124, v124, v125

    buffer_store_dwordx2 v[118:119], v124, s[24:27], 0 offen
L_skw_37:
    s_waitcnt lgkmcnt(0)
    s_barrier

    buffer_load_dwordx4 v[20:23], v1, s[12:15], s56 offen nt
    buffer_load_dwordx4 v[4:7], v1, s[8:11], s56 offen nt
    buffer_load_dwordx2 v[36:37], v2, s[16:19], s61 offen nt
    buffer_load_dwordx4 v[24:27], v1, s[12:15], s57 offen nt
    buffer_load_dwordx4 v[8:11], v1, s[8:11], s57 offen nt
    buffer_load_dwordx2 v[38:39], v2, s[16:19], s62 offen nt
    ds_read_b64 v[94:95], v2
    s_waitcnt lgkmcnt(0)
    v_and_b32 v94, 0xffff, v94
    v_and_b32 v95, 0xffff, v95
    v_add_u32 v97, v94, v95
    s_nop 1
    v_add_u32_dpp v97, v97, v97 row_shr:1 row_mask:0xf bank_mask:0xf
    s_nop 1
    v_add_u32_dpp v97, v97, v97 row_shr:2 row_mask:0xf bank_mask:0xf
    s_nop 1
    v_add_u32_dpp v97, v97, v97 row_shr:4 row_mask:0xf bank_mask:0xf
    s_nop 1
    v_add_u32_dpp v97, v97, v97 row_shr:8 row_mask:0xf bank_mask:0xf
    s_nop 1
    v_add_u32_dpp v97, v97, v97 row_bcast:15 row_mask:0xa bank_mask:0xf
    s_nop 1
    v_add_u32_dpp v97, v97, v97 row_bcast:31 row_mask:0xc bank_mask:0xf
    s_mov_b32 exec_lo, 0
    s_brev_b32 exec_hi, 1
    ds_add_rtn_u32 v96, v108, v97
    s_mov_b64 exec, -1

    v_add_u32 v92, v94, v94
    v_add_u32 v93, v95, v95
    v_med3_u32 v92, v94, 2, v92
    v_med3_u32 v93, v95, 2, v93
    v_lshl_or_b32 v92, v93, 16, v92
    v_lshlrev_b32 v93, 2, v0
    buffer_atomic_add v92, v93, s[20:23], 0 offen sc0
    s_waitcnt lgkmcnt(0)
    v_readlane_b32 s77, v96, 63
    v_mul_u32_u24 v114, 65528, v0
    v_sub_u32 v97, v97, v95
    s_sub_u32 s50, s50, s83
    s_sub_u32 s77, s77, s50
    v_add_u32 v97, s77, v97
    v_sub_u32 v96, v97, v94
    v_lshlrev_b32 v111, 16, v97
    v_lshlrev_b32 v110, 16, v96
    ds_write_b64 v2, v[110:111]
    v_add_u32 v115, 32764, v114
    v_and_b32 v114, 0xffffff80, v114
    v_and_b32 v115, 0xffffff80, v115
    v_mad_i32_i24 v96, v96, -5, v114
    v_mad_i32_i24 v97, v97, -5, v115
    s_add_u32 s50, s50, s84
    s_mov_b32 s28, s82
    s_mov_b32 s29, s83
    s_mov_b32 s30, s84
    s_lshl_b32 s74, s29, 3
    s_lshl_b32 s75, s30, 3
    v_mov_b32 v125, s74
    v_mov_b32 v126, s75
    v_mov_b32 v127, -1

    s_waitcnt lgkmcnt(0)
    s_barrier

    s_mov_b64 exec, 1
    ds_write_b32 v125, v127 offset:16396
    ds_write_b32 v126, v127 offset:16404
    s_mov_b64 exec, -1

    s_bitcmp0_b32 s28, 0
    s_cbranch_scc1 L_skz_38
    v_lshrrev_b32 v110, 16, v45
    ds_read_b32 v110, v110
    v_lshrrev_b32 v111, 16, v47
    ds_read_b32 v111, v111
    v_lshrrev_b32 v112, 16, v49
    ds_read_b32 v112, v112
    v_lshrrev_b32 v113, 16, v51
    ds_read_b32 v113, v113
    v_lshrrev_b32 v114, 16, v53
    ds_read_b32 v114, v114
    v_lshrrev_b32 v115, 16, v55
    ds_read_b32 v115, v115
    v_lshrrev_b32 v116, 16, v57
    ds_read_b32 v116, v116
    v_lshrrev_b32 v117, 16, v59
    ds_read_b32 v117, v117
    s_waitcnt lgkmcnt(7)
    v_add_u32_sdwa v110, v110, v76 dst_sel:DWORD dst_unused:UNUSED_PAD src0_sel:WORD_1 src1_sel:WORD_0
    v_lshlrev_b32 v110, 3, v110
    ds_write_b64 v110, v[44:45] offset:16400

    s_waitcnt lgkmcnt(7)
    v_add_u32_sdwa v111, v111, v77 dst_sel:DWORD dst_unused:UNUSED_PAD src0_sel:WORD_1 src1_sel:WORD_0
    v_lshlrev_b32 v111, 3, v111
    ds_write_b64 v111, v[46:47] offset:16400

    s_waitcnt lgkmcnt(7)
    v_add_u32_sdwa v112, v112, v78 dst_sel:DWORD dst_unused:UNUSED_PAD src0_sel:WORD_1 src1_sel:WORD_0
    v_lshlrev_b32 v112, 3, v112
    ds_write_b64 v112, v[48:49] offset:16400

    s_waitcnt lgkmcnt(7)
    v_add_u32_sdwa v113, v113, v79 dst_sel:DWORD dst_unused:UNUSED_PAD src0_sel:WORD_1 src1_sel:WORD_0
    v_lshlrev_b32 v113, 3, v113
    ds_write_b64 v113, v[50:51] offset:16400

    s_waitcnt lgkmcnt(7)
    v_add_u32_sdwa v114, v114, v80 dst_sel:DWORD dst_unused:UNUSED_PAD src0_sel:WORD_1 src1_sel:WORD_0
    v_lshlrev_b32 v114, 3, v114
    ds_write_b64 v114, v[52:53] offset:16400

    s_waitcnt lgkmcnt(7)
    v_add_u32_sdwa v115, v115, v81 dst_sel:DWORD dst_unused:UNUSED_PAD src0_sel:WORD_1 src1_sel:WORD_0
    v_lshlrev_b32 v115, 3, v115
    ds_write_b64 v115, v[54:55] offset:16400

    s_waitcnt lgkmcnt(7)
    v_add_u32_sdwa v116, v116, v82 dst_sel:DWORD dst_unused:UNUSED_PAD src0_sel:WORD_1 src1_sel:WORD_0
    v_lshlrev_b32 v116, 3, v116
    ds_write_b64 v116, v[56:57] offset:16400

    s_waitcnt lgkmcnt(7)
    v_add_u32_sdwa v117, v117, v83 dst_sel:DWORD dst_unused:UNUSED_PAD src0_sel:WORD_1 src1_sel:WORD_0
    v_lshlrev_b32 v117, 3, v117
    ds_write_b64 v117, v[58:59] offset:16400

L_skz_38:
    buffer_load_dwordx4 v[28:31], v1, s[12:15], s58 offen nt
    buffer_load_dwordx4 v[12:15], v1, s[8:11], s58 offen nt
    buffer_load_dwordx2 v[40:41], v2, s[16:19], s63 offen nt
    s_bitcmp0_b32 s28, 2
    s_cbranch_scc1 L_skz_39
    v_lshrrev_b32 v110, 16, v61
    ds_read_b32 v110, v110
    v_lshrrev_b32 v111, 16, v63
    ds_read_b32 v111, v111
    v_lshrrev_b32 v112, 16, v65
    ds_read_b32 v112, v112
    v_lshrrev_b32 v113, 16, v67
    ds_read_b32 v113, v113
    s_waitcnt lgkmcnt(3)
    v_add_u32_sdwa v110, v110, v84 dst_sel:DWORD dst_unused:UNUSED_PAD src0_sel:WORD_1 src1_sel:WORD_0
    v_lshlrev_b32 v110, 3, v110
    ds_write_b64 v110, v[60:61] offset:16400

    s_waitcnt lgkmcnt(3)
    v_add_u32_sdwa v111, v111, v85 dst_sel:DWORD dst_unused:UNUSED_PAD src0_sel:WORD_1 src1_sel:WORD_0
    v_lshlrev_b32 v111, 3, v111
    ds_write_b64 v111, v[62:63] offset:16400

    s_waitcnt lgkmcnt(3)
    v_add_u32_sdwa v112, v112, v86 dst_sel:DWORD dst_unused:UNUSED_PAD src0_sel:WORD_1 src1_sel:WORD_0
    v_lshlrev_b32 v112, 3, v112
    ds_write_b64 v112, v[64:65] offset:16400

    s_waitcnt lgkmcnt(3)
    v_add_u32_sdwa v113, v113, v87 dst_sel:DWORD dst_unused:UNUSED_PAD src0_sel:WORD_1 src1_sel:WORD_0
    v_lshlrev_b32 v113, 3, v113
    ds_write_b64 v113, v[66:67] offset:16400

L_skz_39:
    s_bitcmp0_b32 s28, 3
    s_cbranch_scc1 L_skz_40
    s_mov_b64 exec, s[66:67]
    v_lshrrev_b32 v110, 16, v69
    ds_read_b32 v110, v110
    v_lshrrev_b32 v111, 16, v71
    ds_read_b32 v111, v111
    v_lshrrev_b32 v112, 16, v73
    ds_read_b32 v112, v112
    v_lshrrev_b32 v113, 16, v75
    ds_read_b32 v113, v113
    s_waitcnt lgkmcnt(3)
    v_add_u32_sdwa v110, v110, v88 dst_sel:DWORD dst_unused:UNUSED_PAD src0_sel:WORD_1 src1_sel:WORD_0
    v_lshlrev_b32 v110, 3, v110
    ds_write_b64 v110, v[68:69] offset:16400

    s_waitcnt lgkmcnt(3)
    v_add_u32_sdwa v111, v111, v89 dst_sel:DWORD dst_unused:UNUSED_PAD src0_sel:WORD_1 src1_sel:WORD_0
    v_lshlrev_b32 v111, 3, v111
    ds_write_b64 v111, v[70:71] offset:16400

    s_waitcnt lgkmcnt(3)
    v_add_u32_sdwa v112, v112, v90 dst_sel:DWORD dst_unused:UNUSED_PAD src0_sel:WORD_1 src1_sel:WORD_0
    v_lshlrev_b32 v112, 3, v112
    ds_write_b64 v112, v[72:73] offset:16400

    s_waitcnt lgkmcnt(3)
    v_add_u32_sdwa v113, v113, v91 dst_sel:DWORD dst_unused:UNUSED_PAD src0_sel:WORD_1 src1_sel:WORD_0
    v_lshlrev_b32 v113, 3, v113
    ds_write_b64 v113, v[74:75] offset:16400

    s_mov_b64 exec, -1
L_skz_40:
    buffer_load_dwordx4 v[32:35], v1, s[12:15], s59 offen nt
    buffer_load_dwordx4 v[16:19], v1, s[8:11], s59 offen nt
    buffer_load_dwordx2 v[42:43], v2, s[16:19], s64 offen nt
    s_cmp_lg_u32 s49, 0
    s_cbranch_scc1 L_p1loop_6
L_p1epi_7:
    s_waitcnt vmcnt(0)
    s_waitcnt vmcnt(0)
    v_lshrrev_b32 v93, 16, v92
    v_and_b32 v92, 0xffff, v92
    v_add_u32 v110, v92, v94
    v_mad_u32_u24 v92, v92, 5, v96
    v_add_u32 v111, v93, v95
    v_mad_u32_u24 v93, v93, 5, v97
    v_max_u32 v110, v110, v111
    v_cmp_le_u32 vcc, s48, v110
    s_cbranch_vccnz L_full_41
L_fback_42:
    ds_write_b64 v2, v[92:93] offset:8192

    s_waitcnt lgkmcnt(0)
    s_barrier

    s_bitcmp0_b32 s28, 0
    s_cbranch_scc1 L_skw_43
    ds_read_b64 v[4:5], v2 offset:16400
    ds_read_b64 v[6:7], v2 offset:16408
    ds_read_b64 v[8:9], v2 offset:16392

    ds_read_b64 v[12:13], v2 offset:24592
    ds_read_b64 v[14:15], v2 offset:24600
    ds_read_b64 v[16:17], v2 offset:24584

    ds_read_b64 v[20:21], v2 offset:32784
    ds_read_b64 v[22:23], v2 offset:32792
    ds_read_b64 v[24:25], v2 offset:32776

    ds_read_b64 v[28:29], v2 offset:40976
    ds_read_b64 v[30:31], v2 offset:40984
    ds_read_b64 v[32:33], v2 offset:40968

    s_waitcnt lgkmcnt(9)
    v_lshrrev_b32 v10, 16, v5
    ds_read_b32 v10, v10 offset:8192

    s_waitcnt lgkmcnt(7)
    v_lshrrev_b32 v18, 16, v13
    ds_read_b32 v18, v18 offset:8192

    s_waitcnt lgkmcnt(5)
    v_lshrrev_b32 v26, 16, v21
    ds_read_b32 v26, v26 offset:8192

    s_waitcnt lgkmcnt(3)
    v_lshrrev_b32 v34, 16, v29
    ds_read_b32 v34, v34 offset:8192

    v_cmp_ne_u32_sdwa s[80:81], v5, v7 src0_sel:WORD_1 src1_sel:WORD_1
    v_cmp_ne_u32_sdwa vcc, v5, v9 src0_sel:WORD_1 src1_sel:WORD_1
    v_alignbyte_b32 v8, v9, v8, 2
    s_mov_b32 s54, -3
    v_alignbyte_b32 v5, v5, v4, 1
    v_perm_b32 v4, v4, v8, s47
    s_waitcnt lgkmcnt(3)
    v_add3_u32 v10, v10, v106, s54
    v_sub_u32 v11, 0, v10
    v_and_b32 v11, 3, v11
    s_mov_b64 exec, s[80:81]
    v_mov_b32 v11, 0
    v_mov_b32 v6, 0
    s_mov_b64 exec, vcc
    v_mov_b32 v11, 3

    s_mov_b64 exec, -1
    v_alignbyte_b32 v4, v5, v4, v11
    v_alignbyte_b32 v5, v6, v5, v11
    v_add_u32 v10, v10, v11

    buffer_store_dwordx2 v[4:5], v10, s[24:27], 0 offen
    v_cmp_ne_u32_sdwa s[80:81], v13, v15 src0_sel:WORD_1 src1_sel:WORD_1
    v_cmp_ne_u32_sdwa vcc, v13, v17 src0_sel:WORD_1 src1_sel:WORD_1
    v_alignbyte_b32 v16, v17, v16, 2
    s_mov_b32 s54, 5117
    v_alignbyte_b32 v13, v13, v12, 1
    v_perm_b32 v12, v12, v16, s47
    s_waitcnt lgkmcnt(2)
    v_add3_u32 v18, v18, v106, s54
    v_sub_u32 v19, 0, v18
    v_and_b32 v19, 3, v19
    s_mov_b64 exec, s[80:81]
    v_mov_b32 v19, 0
    v_mov_b32 v14, 0
    s_mov_b64 exec, vcc
    v_mov_b32 v19, 3

    s_mov_b64 exec, -1
    v_alignbyte_b32 v12, v13, v12, v19
    v_alignbyte_b32 v13, v14, v13, v19
    v_add_u32 v18, v18, v19

    buffer_store_dwordx2 v[12:13], v18, s[24:27], 0 offen
    v_cmp_ne_u32_sdwa s[80:81], v21, v23 src0_sel:WORD_1 src1_sel:WORD_1
    v_cmp_ne_u32_sdwa vcc, v21, v25 src0_sel:WORD_1 src1_sel:WORD_1
    v_alignbyte_b32 v24, v25, v24, 2
    s_mov_b32 s54, 10237
    v_alignbyte_b32 v21, v21, v20, 1
    v_perm_b32 v20, v20, v24, s47
    s_waitcnt lgkmcnt(1)
    v_add3_u32 v26, v26, v106, s54
    v_sub_u32 v27, 0, v26
    v_and_b32 v27, 3, v27
    s_mov_b64 exec, s[80:81]
    v_mov_b32 v27, 0
    v_mov_b32 v22, 0
    s_mov_b64 exec, vcc
    v_mov_b32 v27, 3

    s_mov_b64 exec, -1
    v_alignbyte_b32 v20, v21, v20, v27
    v_alignbyte_b32 v21, v22, v21, v27
    v_add_u32 v26, v26, v27

    buffer_store_dwordx2 v[20:21], v26, s[24:27], 0 offen
    v_cmp_ne_u32_sdwa s[80:81], v29, v31 src0_sel:WORD_1 src1_sel:WORD_1
    v_cmp_ne_u32_sdwa vcc, v29, v33 src0_sel:WORD_1 src1_sel:WORD_1
    v_alignbyte_b32 v32, v33, v32, 2
    s_mov_b32 s54, 15357
    v_alignbyte_b32 v29, v29, v28, 1
    v_perm_b32 v28, v28, v32, s47
    s_waitcnt lgkmcnt(0)
    v_add3_u32 v34, v34, v106, s54
    v_sub_u32 v35, 0, v34
    v_and_b32 v35, 3, v35
    s_mov_b64 exec, s[80:81]
    v_mov_b32 v35, 0
    v_mov_b32 v30, 0
    s_mov_b64 exec, vcc
    v_mov_b32 v35, 3

    s_mov_b64 exec, -1
    v_alignbyte_b32 v28, v29, v28, v35
    v_alignbyte_b32 v29, v30, v29, v35
    v_add_u32 v34, v34, v35

    buffer_store_dwordx2 v[28:29], v34, s[24:27], 0 offen
L_skw_43:
    s_bitcmp0_b32 s28, 1
    s_cbranch_scc1 L_skw_44
    v_add_u32 v107, 32768, v2
    ds_read_b64 v[4:5], v107 offset:16400
    ds_read_b64 v[6:7], v107 offset:16408
    ds_read_b64 v[8:9], v107 offset:16392

    ds_read_b64 v[12:13], v107 offset:24592
    ds_read_b64 v[14:15], v107 offset:24600
    ds_read_b64 v[16:17], v107 offset:24584

    ds_read_b64 v[20:21], v107 offset:32784
    ds_read_b64 v[22:23], v107 offset:32792
    ds_read_b64 v[24:25], v107 offset:32776

    ds_read_b64 v[28:29], v107 offset:40976
    ds_read_b64 v[30:31], v107 offset:40984
    ds_read_b64 v[32:33], v107 offset:40968

    s_waitcnt lgkmcnt(9)
    v_lshrrev_b32 v10, 16, v5
    ds_read_b32 v10, v10 offset:8192

    s_waitcnt lgkmcnt(7)
    v_lshrrev_b32 v18, 16, v13
    ds_read_b32 v18, v18 offset:8192

    s_waitcnt lgkmcnt(5)
    v_lshrrev_b32 v26, 16, v21
    ds_read_b32 v26, v26 offset:8192

    s_waitcnt lgkmcnt(3)
    v_lshrrev_b32 v34, 16, v29
    ds_read_b32 v34, v34 offset:8192

    v_cmp_ne_u32_sdwa s[80:81], v5, v7 src0_sel:WORD_1 src1_sel:WORD_1
    v_cmp_ne_u32_sdwa vcc, v5, v9 src0_sel:WORD_1 src1_sel:WORD_1
    v_alignbyte_b32 v8, v9, v8, 2
    s_mov_b32 s54, 20477
    v_alignbyte_b32 v5, v5, v4, 1
    v_perm_b32 v4, v4, v8, s47
    s_waitcnt lgkmcnt(3)
    v_add3_u32 v10, v10, v106, s54
    v_sub_u32 v11, 0, v10
    v_and_b32 v11, 3, v11
    s_mov_b64 exec, s[80:81]
    v_mov_b32 v11, 0
    v_mov_b32 v6, 0
    s_mov_b64 exec, vcc
    v_mov_b32 v11, 3

    s_mov_b64 exec, -1
    v_alignbyte_b32 v4, v5, v4, v11
    v_alignbyte_b32 v5, v6, v5, v11
    v_add_u32 v10, v10, v11

    buffer_store_dwordx2 v[4:5], v10, s[24:27], 0 offen
    v_cmp_ne_u32_sdwa s[80:81], v13, v15 src0_sel:WORD_1 src1_sel:WORD_1
    v_cmp_ne_u32_sdwa vcc, v13, v17 src0_sel:WORD_1 src1_sel:WORD_1
    v_alignbyte_b32 v16, v17, v16, 2
    s_mov_b32 s54, 25597
    v_alignbyte_b32 v13, v13, v12, 1
    v_perm_b32 v12, v12, v16, s47
    s_waitcnt lgkmcnt(2)
    v_add3_u32 v18, v18, v106, s54
    v_sub_u32 v19, 0, v18
    v_and_b32 v19, 3, v19
    s_mov_b64 exec, s[80:81]
    v_mov_b32 v19, 0
    v_mov_b32 v14, 0
    s_mov_b64 exec, vcc
    v_mov_b32 v19, 3

    s_mov_b64 exec, -1
    v_alignbyte_b32 v12, v13, v12, v19
    v_alignbyte_b32 v13, v14, v13, v19
    v_add_u32 v18, v18, v19

    buffer_store_dwordx2 v[12:13], v18, s[24:27], 0 offen
    v_cmp_ne_u32_sdwa s[80:81], v21, v23 src0_sel:WORD_1 src1_sel:WORD_1
    v_cmp_ne_u32_sdwa vcc, v21, v25 src0_sel:WORD_1 src1_sel:WORD_1
    v_alignbyte_b32 v24, v25, v24, 2
    s_mov_b32 s54, 30717
    v_alignbyte_b32 v21, v21, v20, 1
    v_perm_b32 v20, v20, v24, s47
    s_waitcnt lgkmcnt(1)
    v_add3_u32 v26, v26, v106, s54
    v_sub_u32 v27, 0, v26
    v_and_b32 v27, 3, v27
    s_mov_b64 exec, s[80:81]
    v_mov_b32 v27, 0
    v_mov_b32 v22, 0
    s_mov_b64 exec, vcc
    v_mov_b32 v27, 3

    s_mov_b64 exec, -1
    v_alignbyte_b32 v20, v21, v20, v27
    v_alignbyte_b32 v21, v22, v21, v27
    v_add_u32 v26, v26, v27

    buffer_store_dwordx2 v[20:21], v26, s[24:27], 0 offen
    v_cmp_ne_u32_sdwa s[80:81], v29, v31 src0_sel:WORD_1 src1_sel:WORD_1
    v_cmp_ne_u32_sdwa vcc, v29, v33 src0_sel:WORD_1 src1_sel:WORD_1
    v_alignbyte_b32 v32, v33, v32, 2
    s_mov_b32 s54, 35837
    v_alignbyte_b32 v29, v29, v28, 1
    v_perm_b32 v28, v28, v32, s47
    s_waitcnt lgkmcnt(0)
    v_add3_u32 v34, v34, v106, s54
    v_sub_u32 v35, 0, v34
    v_and_b32 v35, 3, v35
    s_mov_b64 exec, s[80:81]
    v_mov_b32 v35, 0
    v_mov_b32 v30, 0
    s_mov_b64 exec, vcc
    v_mov_b32 v35, 3

    s_mov_b64 exec, -1
    v_alignbyte_b32 v28, v29, v28, v35
    v_alignbyte_b32 v29, v30, v29, v35
    v_add_u32 v34, v34, v35

    buffer_store_dwordx2 v[28:29], v34, s[24:27], 0 offen
L_skw_44:
    s_bitcmp0_b32 s28, 2
    s_cbranch_scc1 L_skw_45
    v_add_u32 v107, 65536, v2
    ds_read_b64 v[4:5], v107 offset:16400
    ds_read_b64 v[6:7], v107 offset:16408
    ds_read_b64 v[8:9], v107 offset:16392

    ds_read_b64 v[12:13], v107 offset:24592
    ds_read_b64 v[14:15], v107 offset:24600
    ds_read_b64 v[16:17], v107 offset:24584

    ds_read_b64 v[20:21], v107 offset:32784
    ds_read_b64 v[22:23], v107 offset:32792
    ds_read_b64 v[24:25], v107 offset:32776

    ds_read_b64 v[28:29], v107 offset:40976
    ds_read_b64 v[30:31], v107 offset:40984
    ds_read_b64 v[32:33], v107 offset:40968

    s_waitcnt lgkmcnt(9)
    v_lshrrev_b32 v10, 16, v5
    ds_read_b32 v10, v10 offset:8192

    s_waitcnt lgkmcnt(7)
    v_lshrrev_b32 v18, 16, v13
    ds_read_b32 v18, v18 offset:8192

    s_waitcnt lgkmcnt(5)
    v_lshrrev_b32 v26, 16, v21
    ds_read_b32 v26, v26 offset:8192

    s_waitcnt lgkmcnt(3)
    v_lshrrev_b32 v34, 16, v29
    ds_read_b32 v34, v34 offset:8192

    v_cmp_ne_u32_sdwa s[80:81], v5, v7 src0_sel:WORD_1 src1_sel:WORD_1
    v_cmp_ne_u32_sdwa vcc, v5, v9 src0_sel:WORD_1 src1_sel:WORD_1
    v_alignbyte_b32 v8, v9, v8, 2
    s_mov_b32 s54, 40957
    v_alignbyte_b32 v5, v5, v4, 1
    v_perm_b32 v4, v4, v8, s47
    s_waitcnt lgkmcnt(3)
    v_add3_u32 v10, v10, v106, s54
    v_sub_u32 v11, 0, v10
    v_and_b32 v11, 3, v11
    s_mov_b64 exec, s[80:81]
    v_mov_b32 v11, 0
    v_mov_b32 v6, 0
    s_mov_b64 exec, vcc
    v_mov_b32 v11, 3

    s_mov_b64 exec, -1
    v_alignbyte_b32 v4, v5, v4, v11
    v_alignbyte_b32 v5, v6, v5, v11
    v_add_u32 v10, v10, v11

    buffer_store_dwordx2 v[4:5], v10, s[24:27], 0 offen
    v_cmp_ne_u32_sdwa s[80:81], v13, v15 src0_sel:WORD_1 src1_sel:WORD_1
    v_cmp_ne_u32_sdwa vcc, v13, v17 src0_sel:WORD_1 src1_sel:WORD_1
    v_alignbyte_b32 v16, v17, v16, 2
    s_mov_b32 s54, 46077
    v_alignbyte_b32 v13, v13, v12, 1
    v_perm_b32 v12, v12, v16, s47
    s_waitcnt lgkmcnt(2)
    v_add3_u32 v18, v18, v106, s54
    v_sub_u32 v19, 0, v18
    v_and_b32 v19, 3, v19
    s_mov_b64 exec, s[80:81]
    v_mov_b32 v19, 0
    v_mov_b32 v14, 0
    s_mov_b64 exec, vcc
    v_mov_b32 v19, 3

    s_mov_b64 exec, -1
    v_alignbyte_b32 v12, v13, v12, v19
    v_alignbyte_b32 v13, v14, v13, v19
    v_add_u32 v18, v18, v19

    buffer_store_dwordx2 v[12:13], v18, s[24:27], 0 offen
    v_cmp_ne_u32_sdwa s[80:81], v21, v23 src0_sel:WORD_1 src1_sel:WORD_1
    v_cmp_ne_u32_sdwa vcc, v21, v25 src0_sel:WORD_1 src1_sel:WORD_1
    v_alignbyte_b32 v24, v25, v24, 2
    s_mov_b32 s54, 51197
    v_alignbyte_b32 v21, v21, v20, 1
    v_perm_b32 v20, v20, v24, s47
    s_waitcnt lgkmcnt(1)
    v_add3_u32 v26, v26, v106, s54
    v_sub_u32 v27, 0, v26
    v_and_b32 v27, 3, v27
    s_mov_b64 exec, s[80:81]
    v_mov_b32 v27, 0
    v_mov_b32 v22, 0
    s_mov_b64 exec, vcc
    v_mov_b32 v27, 3

    s_mov_b64 exec, -1
    v_alignbyte_b32 v20, v21, v20, v27
    v_alignbyte_b32 v21, v22, v21, v27
    v_add_u32 v26, v26, v27

    buffer_store_dwordx2 v[20:21], v26, s[24:27], 0 offen
    v_cmp_ne_u32_sdwa s[80:81], v29, v31 src0_sel:WORD_1 src1_sel:WORD_1
    v_cmp_ne_u32_sdwa vcc, v29, v33 src0_sel:WORD_1 src1_sel:WORD_1
    v_alignbyte_b32 v32, v33, v32, 2
    s_mov_b32 s54, 56317
    v_alignbyte_b32 v29, v29, v28, 1
    v_perm_b32 v28, v28, v32, s47
    s_waitcnt lgkmcnt(0)
    v_add3_u32 v34, v34, v106, s54
    v_sub_u32 v35, 0, v34
    v_and_b32 v35, 3, v35
    s_mov_b64 exec, s[80:81]
    v_mov_b32 v35, 0
    v_mov_b32 v30, 0
    s_mov_b64 exec, vcc
    v_mov_b32 v35, 3

    s_mov_b64 exec, -1
    v_alignbyte_b32 v28, v29, v28, v35
    v_alignbyte_b32 v29, v30, v29, v35
    v_add_u32 v34, v34, v35

    buffer_store_dwordx2 v[28:29], v34, s[24:27], 0 offen
L_skw_45:
    s_bitcmp0_b32 s28, 3
    s_cbranch_scc1 L_skw_46
    v_add_u32 v107, 98304, v2
    ds_read_b64 v[4:5], v107 offset:16400
    ds_read_b64 v[6:7], v107 offset:16408
    ds_read_b64 v[8:9], v107 offset:16392

    ds_read_b64 v[12:13], v107 offset:24592
    ds_read_b64 v[14:15], v107 offset:24600
    ds_read_b64 v[16:17], v107 offset:24584

    ds_read_b64 v[20:21], v107 offset:32784
    ds_read_b64 v[22:23], v107 offset:32792
    ds_read_b64 v[24:25], v107 offset:32776

    ds_read_b64 v[28:29], v107 offset:40976
    ds_read_b64 v[30:31], v107 offset:40984
    ds_read_b64 v[32:33], v107 offset:40968

    s_waitcnt lgkmcnt(9)
    v_lshrrev_b32 v10, 16, v5
    ds_read_b32 v10, v10 offset:8192

    s_waitcnt lgkmcnt(7)
    v_lshrrev_b32 v18, 16, v13
    ds_read_b32 v18, v18 offset:8192

    s_waitcnt lgkmcnt(5)
    v_lshrrev_b32 v26, 16, v21
    ds_read_b32 v26, v26 offset:8192

    s_waitcnt lgkmcnt(3)
    v_lshrrev_b32 v34, 16, v29
    ds_read_b32 v34, v34 offset:8192

    v_cmp_ne_u32_sdwa s[80:81], v5, v7 src0_sel:WORD_1 src1_sel:WORD_1
    v_cmp_ne_u32_sdwa vcc, v5, v9 src0_sel:WORD_1 src1_sel:WORD_1
    v_alignbyte_b32 v8, v9, v8, 2
    s_mov_b32 s54, 61437
    v_alignbyte_b32 v5, v5, v4, 1
    v_perm_b32 v4, v4, v8, s47
    s_waitcnt lgkmcnt(3)
    v_add3_u32 v10, v10, v106, s54
    v_sub_u32 v11, 0, v10
    v_and_b32 v11, 3, v11
    s_mov_b64 exec, s[80:81]
    v_mov_b32 v11, 0
    v_mov_b32 v6, 0
    s_mov_b64 exec, vcc
    v_mov_b32 v11, 3

    s_mov_b64 exec, -1
    v_alignbyte_b32 v4, v5, v4, v11
    v_alignbyte_b32 v5, v6, v5, v11
    v_add_u32 v10, v10, v11

    buffer_store_dwordx2 v[4:5], v10, s[24:27], 0 offen
    v_cmp_ne_u32_sdwa s[80:81], v13, v15 src0_sel:WORD_1 src1_sel:WORD_1
    v_cmp_ne_u32_sdwa vcc, v13, v17 src0_sel:WORD_1 src1_sel:WORD_1
    v_alignbyte_b32 v16, v17, v16, 2
    s_mov_b32 s54, 66557
    v_alignbyte_b32 v13, v13, v12, 1
    v_perm_b32 v12, v12, v16, s47
    s_waitcnt lgkmcnt(2)
    v_add3_u32 v18, v18, v106, s54
    v_sub_u32 v19, 0, v18
    v_and_b32 v19, 3, v19
    s_mov_b64 exec, s[80:81]
    v_mov_b32 v19, 0
    v_mov_b32 v14, 0
    s_mov_b64 exec, vcc
    v_mov_b32 v19, 3

    s_mov_b64 exec, -1
    v_alignbyte_b32 v12, v13, v12, v19
    v_alignbyte_b32 v13, v14, v13, v19
    v_add_u32 v18, v18, v19

    buffer_store_dwordx2 v[12:13], v18, s[24:27], 0 offen
    v_cmp_ne_u32_sdwa s[80:81], v21, v23 src0_sel:WORD_1 src1_sel:WORD_1
    v_cmp_ne_u32_sdwa vcc, v21, v25 src0_sel:WORD_1 src1_sel:WORD_1
    v_alignbyte_b32 v24, v25, v24, 2
    s_mov_b32 s54, 71677
    v_alignbyte_b32 v21, v21, v20, 1
    v_perm_b32 v20, v20, v24, s47
    s_waitcnt lgkmcnt(1)
    v_add3_u32 v26, v26, v106, s54
    v_sub_u32 v27, 0, v26
    v_and_b32 v27, 3, v27
    s_mov_b64 exec, s[80:81]
    v_mov_b32 v27, 0
    v_mov_b32 v22, 0
    s_mov_b64 exec, vcc
    v_mov_b32 v27, 3

    s_mov_b64 exec, -1
    v_alignbyte_b32 v20, v21, v20, v27
    v_alignbyte_b32 v21, v22, v21, v27
    v_add_u32 v26, v26, v27

    buffer_store_dwordx2 v[20:21], v26, s[24:27], 0 offen
    v_cmp_ne_u32_sdwa s[80:81], v29, v31 src0_sel:WORD_1 src1_sel:WORD_1
    v_cmp_ne_u32_sdwa vcc, v29, v33 src0_sel:WORD_1 src1_sel:WORD_1
    v_alignbyte_b32 v32, v33, v32, 2
    s_mov_b32 s54, 76797
    v_alignbyte_b32 v29, v29, v28, 1
    v_perm_b32 v28, v28, v32, s47
    s_waitcnt lgkmcnt(0)
    v_add3_u32 v34, v34, v106, s54
    v_sub_u32 v35, 0, v34
    v_and_b32 v35, 3, v35
    s_mov_b64 exec, s[80:81]
    v_mov_b32 v35, 0
    v_mov_b32 v30, 0
    s_mov_b64 exec, vcc
    v_mov_b32 v35, 3

    s_andn2_b64 exec, -1, s[68:69]
    v_bfrev_b32 v34, 1
    s_mov_b64 exec, -1
    v_alignbyte_b32 v28, v29, v28, v35
    v_alignbyte_b32 v29, v30, v29, v35
    v_add_u32 v34, v34, v35

    buffer_store_dwordx2 v[28:29], v34, s[24:27], 0 offen
L_skw_46:
L_p1done_1:
    s_endpgm

L_ska_8:
    v_bfrev_b32 v126, 1
    buffer_load_dword v3, v126, s[96:99], 0 offen
    buffer_load_dword v3, v126, s[96:99], 0 offen
    buffer_load_dword v3, v126, s[96:99], 0 offen
    s_branch L_bka_9
L_ska_10:
    v_bfrev_b32 v126, 1
    buffer_load_dword v3, v126, s[96:99], 0 offen
    buffer_load_dword v3, v126, s[96:99], 0 offen
    buffer_load_dword v3, v126, s[96:99], 0 offen
    s_branch L_bka_11
L_ska_12:
    v_bfrev_b32 v126, 1
    buffer_load_dword v3, v126, s[96:99], 0 offen
    buffer_load_dword v3, v126, s[96:99], 0 offen
    buffer_load_dword v3, v126, s[96:99], 0 offen
    s_branch L_bka_13
L_ska_14:
    v_bfrev_b32 v126, 1
    buffer_load_dword v3, v126, s[96:99], 0 offen
    buffer_load_dword v3, v126, s[96:99], 0 offen
    buffer_load_dword v3, v126, s[96:99], 0 offen
    s_branch L_bka_15
L_full_26:
    v_mov_b32 v110, 0
    s_mov_b64 exec, vcc
    v_bfrev_b32 v92, 1
    v_bfrev_b32 v93, 1
    s_mov_b64 exec, 1
    buffer_atomic_or v104, v110, s[36:39], 0 offen
    s_mov_b64 exec, -1
    s_branch L_fback_27

L_full_41:
    v_mov_b32 v110, 0
    s_mov_b64 exec, vcc
    v_bfrev_b32 v92, 1
    v_bfrev_b32 v93, 1
    s_mov_b64 exec, 1
    buffer_atomic_or v104, v110, s[36:39], 0 offen
    s_mov_b64 exec, -1
    s_branch L_fback_42

.globl standalone__molecular_angular_gemnet__graph_kernel
.p2align 8
.type standalone__molecular_angular_gemnet__graph_kernel,@function
standalone__molecular_angular_gemnet__graph_kernel:
    s_cmp_ge_u32 s2, 256
    s_cbranch_scc1 L_p2done_47
    s_load_dwordx2 s[8:9], s[0:1], 0
    s_load_dwordx2 s[6:7], s[0:1], 104
    v_lshrrev_b32 v4, 6, v0

    s_lshr_b32 s37, s2, 1
    s_and_b32 s37, s37, 3
    s_lshr_b32 s36, s2, 3
    s_lshl_b32 s36, s36, 1
    s_and_b32 s3, s2, 1
    s_or_b32 s36, s36, s3

    v_readfirstlane_b32 s4, v4
    v_and_b32 v2, 63, v0
    v_lshrrev_b32 v3, 9, v0
    v_lshl_or_b32 v2, v3, 6, v2
    v_mul_u32_u24 v2, 20, v2
    v_lshlrev_b32 v3, 4, v0

    s_waitcnt lgkmcnt(0)
    s_lshl_b32 m0, s4, 10
    s_and_b32 s5, s4, 7
    s_lshr_b32 s39, s4, 3
    s_lshl_b32 s39, s39, 8
    s_mul_i32 s3, s5, 4096
    s_add_u32 s46, s6, s3
    s_addc_u32 s47, s7, 0
    s_mul_i32 s3, s5, 67117056
    s_add_u32 s3, s3, 85721088
    s_add_u32 s44, s6, s3
    s_addc_u32 s45, s7, 0
    s_mul_i32 s38, s37, 8
    s_add_u32 s4, s38, 8
    s_lshl_b32 s3, s38, 6
    s_add_u32 s3, s3, s36
    s_lshr_b32 s3, s3, 1
    s_lshl_b32 s3, s3, 2
    s_add_u32 s52, s46, s3
    s_addc_u32 s53, s47, 0

    s_load_dword s88, s[52:53], 0
    s_load_dword s89, s[52:53], 128
    s_load_dword s90, s[52:53], 256
    s_load_dword s91, s[52:53], 384
    s_load_dword s92, s[52:53], 512
    s_load_dword s93, s[52:53], 640
    s_load_dword s94, s[52:53], 768
    s_load_dword s95, s[52:53], 896
    s_mov_b32 s3, 32768
    s_load_dword s51, s[6:7], s3
    s_mov_b32 s10, 6400000
    s_mov_b32 s11, 0x20000

    s_add_u32 s12, s6, 2490368
    s_addc_u32 s13, s7, 0
    s_mov_b32 s14, 0
    s_mov_b32 s15, 0x20000
    s_add_u32 s60, s6, 2490368
    s_addc_u32 s61, s7, 0
    s_mov_b32 s62, 6406144
    s_mov_b32 s63, 0x20000
    s_mov_b32 s3, 135176
    s_load_dword s33, s[6:7], s3

    s_mul_i32 s43, s38, 200192
    s_mul_i32 s41, s4, 200192
    s_mul_i32 s50, s38, 200000
    s_add_u32 s14, s43, 50000

    buffer_load_dwordx4 v[76:79], v3, s[12:15], s43 offen
    s_add_u32 s52, s43, 16384
    buffer_load_dwordx4 v[80:83], v3, s[12:15], s52 offen
    s_add_u32 s52, s43, 32768
    buffer_load_dwordx4 v[84:87], v3, s[12:15], s52 offen
    s_add_u32 s52, s43, 49152
    v_lshlrev_b32 v119, 2, v0
    buffer_load_dword v88, v119, s[12:15], s52 offen
    s_add_u32 s20, s6, 135168
    s_addc_u32 s21, s7, 0
    s_mov_b32 s22, 4096
    s_mov_b32 s23, 0x20000
    v_and_b32 v44, 63, v0
    v_lshlrev_b32 v44, 4, v44
    buffer_load_dwordx2 v[120:121], v44, s[20:23], 0 offen offset:0
    buffer_load_dwordx2 v[122:123], v44, s[20:23], 0 offen offset:1024
    buffer_load_dwordx2 v[124:125], v44, s[20:23], 0 offen offset:2048
    buffer_load_dwordx2 v[126:127], v44, s[20:23], 0 offen offset:3072
    s_movk_i32 s40, 3072
    s_mov_b32 s19, 0x20000
    s_min_u32 s40, s40, 6524
    s_lshl_b32 s52, s38, 6
    s_add_u32 s52, s52, s36
    s_mul_i32 s52, s52, 32764
    s_and_b32 s52, s52, 0xffffff80
    s_add_u32 s16, s44, s52
    s_addc_u32 s17, s45, 0
    s_mul_i32 s52, s40, 5
    s_add_u32 s52, s52, 3
    s_and_b32 s18, s52, -4

    s_movk_i32 s53, 5120
    buffer_load_dwordx4 v[90:93], v2, s[16:19], s53 offen
    buffer_load_dword v110, v2, s[16:19], s53 offen offset:16
    s_movk_i32 s53, 7680
    buffer_load_dwordx4 v[94:97], v2, s[16:19], s53 offen
    buffer_load_dword v111, v2, s[16:19], s53 offen offset:16
    s_movk_i32 s53, 10240
    buffer_load_dwordx4 v[98:101], v2, s[16:19], s53 offen
    buffer_load_dword v112, v2, s[16:19], s53 offen offset:16
    s_lshr_b32 s3, s2, 3
    s_mul_i32 s3, s3, 49
    v_add_lshl_u32 v89, v0, s3, 7
    v_cmp_gt_u32 vcc, 49, v0
    v_bfrev_b32 v28, 1
    s_nop 0
    v_cndmask_b32 v89, v28, v89, vcc

    s_mov_b32 s19, 0x20000
    s_mov_b32 s28, 0x4b404000
    s_mov_b32 s29, 0x4b404000
    s_mov_b32 s30, 0xbfffc000
    s_mov_b32 s31, 0xbfffbfff
    s_mov_b32 s32, 0xffff0000
    s_mov_b32 s35, 0x05040100
    s_mov_b32 s97, 0x07060302
    s_mov_b32 s96, 0x40008000
    s_movk_i32 s3, 212
    v_cmp_gt_u32 s[48:49], s3, v0

    v_mov_b32 v1, 0
    s_mov_b32 s24, 0xc0c0004
    s_mov_b32 s25, 0xc0c0105
    s_mov_b32 s26, 0xc0c0206
    s_mov_b32 s27, 0xc0c0307
    v_mov_b32 v28, 0x40004000
    v_mov_b32 v29, 0x40004000
    v_mov_b32 v30, 0x40004000
    v_mov_b32 v31, 0x40004000
    v_add_u32 v32, 50000, v3
    v_add_u32 v33, 65536, v32

    ds_write_b128 v32, v[28:31] offset:0
    ds_write_b128 v32, v[28:31] offset:16384
    ds_write_b128 v32, v[28:31] offset:32768
    ds_write_b128 v32, v[28:31] offset:49152
    ds_write_b128 v33, v[28:31] offset:0
    ds_write_b128 v33, v[28:31] offset:16384
    v_cmp_gt_u32 vcc, 971, v0
    s_mov_b64 exec, vcc
    ds_write_b128 v33, v[28:31] offset:32768
    s_mov_b64 exec, -1
    s_waitcnt vmcnt(13)
    ds_write_addtid_b32 v76 offset:0
    ds_write_addtid_b32 v77 offset:256
    ds_write_addtid_b32 v78 offset:512
    ds_write_addtid_b32 v79 offset:768
    s_waitcnt vmcnt(12)
    ds_write_addtid_b32 v80 offset:16384
    ds_write_addtid_b32 v81 offset:16640
    ds_write_addtid_b32 v82 offset:16896
    ds_write_addtid_b32 v83 offset:17152
    s_waitcnt vmcnt(11)
    ds_write_addtid_b32 v84 offset:32768
    ds_write_addtid_b32 v85 offset:33024
    ds_write_addtid_b32 v86 offset:33280
    ds_write_addtid_b32 v87 offset:33536
    v_lshlrev_b32 v119, 2, v0
    s_waitcnt vmcnt(10)
    s_mov_b64 exec, s[48:49]
    ds_write_b32 v119, v88 offset:49152
    s_mov_b64 exec, -1
    s_add_u32 s43, s43, 50048
    s_add_u32 s14, s43, 50000
    s_min_u32 s14, s14, s41
    s_and_b32 s3, s36, 1
    s_lshl_b32 s3, s3, 4
    s_or_b32 s3, s3, 0x100000
    s_waitcnt lgkmcnt(0)

    s_bfe_u32 s88, s88, s3
    s_bfe_u32 s89, s89, s3
    s_bfe_u32 s90, s90, s3
    s_bfe_u32 s91, s91, s3
    s_bfe_u32 s92, s92, s3
    s_bfe_u32 s93, s93, s3
    s_bfe_u32 s94, s94, s3
    s_bfe_u32 s95, s95, s3
    s_waitcnt vmcnt(6)
    v_max3_u32 v120, v120, v122, v124
    v_add_f32 v121, v121, v123
    v_add_f32 v125, v125, v127
    v_max_u32 v120, v120, v126
    v_add_f32 v121, v121, v125

    s_nop 1
    v_max_u32_dpp v120, v120, v120 row_shr:1 row_mask:0xf bank_mask:0xf
    s_nop 1
    v_max_u32_dpp v120, v120, v120 row_shr:2 row_mask:0xf bank_mask:0xf
    s_nop 1
    v_max_u32_dpp v120, v120, v120 row_shr:4 row_mask:0xf bank_mask:0xf
    s_nop 1
    v_max_u32_dpp v120, v120, v120 row_shr:8 row_mask:0xf bank_mask:0xf
    s_nop 1
    v_max_u32_dpp v120, v120, v120 row_bcast:15 row_mask:0xa bank_mask:0xf
    s_nop 1
    v_max_u32_dpp v120, v120, v120 row_bcast:31 row_mask:0xc bank_mask:0xf
    s_nop 1
    v_add_f32_dpp v121, v121, v121 row_shr:1 row_mask:0xf bank_mask:0xf
    s_nop 1
    v_add_f32_dpp v121, v121, v121 row_shr:2 row_mask:0xf bank_mask:0xf
    s_nop 1
    v_add_f32_dpp v121, v121, v121 row_shr:4 row_mask:0xf bank_mask:0xf
    s_nop 1
    v_add_f32_dpp v121, v121, v121 row_shr:8 row_mask:0xf bank_mask:0xf
    s_nop 1
    v_add_f32_dpp v121, v121, v121 row_bcast:15 row_mask:0xa bank_mask:0xf
    s_nop 1
    v_add_f32_dpp v121, v121, v121 row_bcast:31 row_mask:0xc bank_mask:0xf
    v_lshlrev_b32 v120, 16, v120
    v_mul_f32 v121, 0x34a7c5ac, v121
    v_sqrt_f32 v121, v121
    v_mul_f32 v120, s33, v120
    v_mul_f32 v121, s33, v121
    v_cmp_gt_f32 vcc, 0x46fde800, v120
    s_mov_b64 s[64:65], vcc
    v_cmp_lt_f32 vcc, 0x44000000, v121
    v_mov_b32 v120, 0x37800000
    v_mul_f32 v120, s33, v120
    s_and_b64 vcc, vcc, s[64:65]
    v_mul_f32 v121, 0x46ff8000, v120
    v_rcp_f32 v121, v121
    v_readfirstlane_b32 s33, v120
    s_waitcnt lgkmcnt(0)
    s_barrier
    v_readfirstlane_b32 s34, v121
    v_mov_b32 v120, 150016
    v_mov_b32 v121, 0
    ds_write_b32 v120, v121 offset:8
    s_bitcmp0_b64 vcc, 63
    s_cbranch_scc1 L_p2slow_48
    s_cmp_lg_u32 s51, 0
    s_cbranch_scc1 L_p2slow_48

    s_min_u32 s88, s88, 6524
    s_lshl_b32 s52, s38, 6
    s_add_u32 s52, s52, s36
    s_mul_i32 s52, s52, 32764
    s_and_b32 s52, s52, 0xffffff80
    s_add_u32 s16, s44, s52
    s_addc_u32 s17, s45, 0
    s_mul_i32 s52, s88, 5
    s_add_u32 s52, s52, 3
    s_and_b32 s18, s52, -4

    s_movk_i32 s53, 12800
    buffer_load_dwordx4 v[102:105], v2, s[16:19], s53 offen
    buffer_load_dword v113, v2, s[16:19], s53 offen offset:16
    s_movk_i32 s53, 0
    buffer_load_dwordx4 v[4:7], v2, s[16:19], s53 offen nt
    buffer_load_dword v35, v2, s[16:19], s53 offen offset:16 nt
    s_movk_i32 s53, 2560
    buffer_load_dwordx4 v[8:11], v2, s[16:19], s53 offen
    buffer_load_dword v43, v2, s[16:19], s53 offen offset:16
    s_movk_i32 s53, 15360
    buffer_load_dwordx4 v[106:109], v2, s[16:19], s53 offen
    buffer_load_dword v114, v2, s[16:19], s53 offen offset:16
    s_mov_b32 s40, s88
    s_sub_u32 s42, s40, s39

    s_add_u32 s55, s38, 1
    s_min_u32 s55, s55, 31
    s_mov_b32 s88, s89
    s_mov_b32 s89, s90
    s_mov_b32 s90, s91
    s_mov_b32 s91, s92
    s_mov_b32 s92, s93
    s_mov_b32 s93, s94
    s_mov_b32 s94, s95
    s_mov_b32 s95, 0
    s_min_u32 s88, s88, 6524
    s_lshl_b32 s52, s55, 6
    s_add_u32 s52, s52, s36
    s_mul_i32 s52, s52, 32764
    s_and_b32 s52, s52, 0xffffff80
    s_add_u32 s16, s44, s52
    s_addc_u32 s17, s45, 0
    s_mul_i32 s52, s88, 5
    s_add_u32 s52, s52, 3
    s_and_b32 s18, s52, -4

    s_waitcnt vmcnt(12)
    v_perm_b32 v44, v91, v90, s24
    v_perm_b32 v46, v92, v91, s25
    v_perm_b32 v48, v93, v92, s26
    v_perm_b32 v50, v110, v93, s27
    v_mov_b32 v12, v90
    v_alignbyte_b32 v13, v92, v91, 1
    v_alignbyte_b32 v14, v93, v92, 2
    v_alignbyte_b32 v15, v110, v93, 3
    v_lshlrev_b32_sdwa v44, 3, v44 dst_sel:WORD_0 dst_unused:UNUSED_PAD src0_sel:DWORD src1_sel:DWORD
    v_lshlrev_b32_sdwa v46, 3, v46 dst_sel:WORD_0 dst_unused:UNUSED_PAD src0_sel:DWORD src1_sel:DWORD
    v_lshlrev_b32_sdwa v48, 3, v48 dst_sel:WORD_0 dst_unused:UNUSED_PAD src0_sel:DWORD src1_sel:DWORD
    v_lshlrev_b32_sdwa v50, 3, v50 dst_sel:WORD_0 dst_unused:UNUSED_PAD src0_sel:DWORD src1_sel:DWORD
    s_cmp_lt_i32 s42, 1280
    s_cbranch_scc1 L_ufix_49
L_uback_50:

    v_subrev_co_u32 v12, s[80:81], 2.0, v12
    v_subrev_co_u32 v13, s[82:83], 2.0, v13
    v_subrev_co_u32 v14, s[84:85], 2.0, v14
    v_subrev_co_u32 v15, s[86:87], 2.0, v15
    s_mov_b64 exec, s[80:81]
    ds_read_b64 v[44:45], v44
    s_mov_b64 exec, s[82:83]
    ds_read_b64 v[46:47], v46
    s_mov_b64 exec, s[84:85]
    ds_read_b64 v[48:49], v48
    s_mov_b64 exec, s[86:87]
    ds_read_b64 v[50:51], v50
    s_mov_b64 exec, -1
    s_waitcnt vmcnt(10)
    v_perm_b32 v52, v95, v94, s24
    v_perm_b32 v54, v96, v95, s25
    v_perm_b32 v56, v97, v96, s26
    v_perm_b32 v58, v111, v97, s27
    v_mov_b32 v16, v94
    v_alignbyte_b32 v17, v96, v95, 1
    v_alignbyte_b32 v18, v97, v96, 2
    v_alignbyte_b32 v19, v111, v97, 3
    v_lshlrev_b32_sdwa v52, 3, v52 dst_sel:WORD_0 dst_unused:UNUSED_PAD src0_sel:DWORD src1_sel:DWORD
    v_lshlrev_b32_sdwa v54, 3, v54 dst_sel:WORD_0 dst_unused:UNUSED_PAD src0_sel:DWORD src1_sel:DWORD
    v_lshlrev_b32_sdwa v56, 3, v56 dst_sel:WORD_0 dst_unused:UNUSED_PAD src0_sel:DWORD src1_sel:DWORD
    v_lshlrev_b32_sdwa v58, 3, v58 dst_sel:WORD_0 dst_unused:UNUSED_PAD src0_sel:DWORD src1_sel:DWORD
    s_cmp_lt_i32 s42, 1792
    s_cbranch_scc1 L_ufix_51
L_uback_52:

    v_subrev_co_u32 v16, s[64:65], 2.0, v16
    v_subrev_co_u32 v17, s[66:67], 2.0, v17
    v_subrev_co_u32 v18, s[68:69], 2.0, v18
    v_subrev_co_u32 v19, s[70:71], 2.0, v19
    s_mov_b64 exec, s[64:65]
    ds_read_b64 v[52:53], v52
    s_mov_b64 exec, s[66:67]
    ds_read_b64 v[54:55], v54
    s_mov_b64 exec, s[68:69]
    ds_read_b64 v[56:57], v56
    s_mov_b64 exec, s[70:71]
    ds_read_b64 v[58:59], v58
    s_mov_b64 exec, -1
    s_waitcnt vmcnt(8)
    v_perm_b32 v60, v99, v98, s24
    v_perm_b32 v62, v100, v99, s25
    v_perm_b32 v64, v101, v100, s26
    v_perm_b32 v66, v112, v101, s27
    v_mov_b32 v20, v98
    v_alignbyte_b32 v21, v100, v99, 1
    v_alignbyte_b32 v22, v101, v100, 2
    v_alignbyte_b32 v23, v112, v101, 3
    v_lshlrev_b32_sdwa v60, 3, v60 dst_sel:WORD_0 dst_unused:UNUSED_PAD src0_sel:DWORD src1_sel:DWORD
    v_lshlrev_b32_sdwa v62, 3, v62 dst_sel:WORD_0 dst_unused:UNUSED_PAD src0_sel:DWORD src1_sel:DWORD
    v_lshlrev_b32_sdwa v64, 3, v64 dst_sel:WORD_0 dst_unused:UNUSED_PAD src0_sel:DWORD src1_sel:DWORD
    v_lshlrev_b32_sdwa v66, 3, v66 dst_sel:WORD_0 dst_unused:UNUSED_PAD src0_sel:DWORD src1_sel:DWORD
    s_cmp_lt_i32 s42, 2304
    s_cbranch_scc1 L_ufix_53
L_uback_54:

    v_subrev_co_u32 v20, s[72:73], 2.0, v20
    v_subrev_co_u32 v21, s[74:75], 2.0, v21
    v_subrev_co_u32 v22, s[76:77], 2.0, v22
    v_subrev_co_u32 v23, s[78:79], 2.0, v23
    s_mov_b64 exec, s[72:73]
    ds_read_b64 v[60:61], v60
    s_mov_b64 exec, s[74:75]
    ds_read_b64 v[62:63], v62
    s_mov_b64 exec, s[76:77]
    ds_read_b64 v[64:65], v64
    s_mov_b64 exec, s[78:79]
    ds_read_b64 v[66:67], v66
    s_mov_b64 exec, -1
    s_waitcnt vmcnt(6)
    v_perm_b32 v68, v103, v102, s24
    v_perm_b32 v70, v104, v103, s25
    v_perm_b32 v72, v105, v104, s26
    v_perm_b32 v74, v113, v105, s27
    v_mov_b32 v24, v102
    v_alignbyte_b32 v25, v104, v103, 1
    v_alignbyte_b32 v26, v105, v104, 2
    v_alignbyte_b32 v27, v113, v105, 3
    v_lshlrev_b32_sdwa v68, 3, v68 dst_sel:WORD_0 dst_unused:UNUSED_PAD src0_sel:DWORD src1_sel:DWORD
    v_lshlrev_b32_sdwa v70, 3, v70 dst_sel:WORD_0 dst_unused:UNUSED_PAD src0_sel:DWORD src1_sel:DWORD
    v_lshlrev_b32_sdwa v72, 3, v72 dst_sel:WORD_0 dst_unused:UNUSED_PAD src0_sel:DWORD src1_sel:DWORD
    v_lshlrev_b32_sdwa v74, 3, v74 dst_sel:WORD_0 dst_unused:UNUSED_PAD src0_sel:DWORD src1_sel:DWORD
    s_cmp_lt_i32 s42, 2816
    s_cbranch_scc1 L_ufix_55
L_uback_56:

    v_subrev_co_u32 v24, s[80:81], 2.0, v24
    v_subrev_co_u32 v25, s[82:83], 2.0, v25
    v_subrev_co_u32 v26, s[84:85], 2.0, v26
    v_subrev_co_u32 v27, s[86:87], 2.0, v27
    s_mov_b64 exec, s[80:81]
    ds_read_b64 v[68:69], v68
    s_mov_b64 exec, s[82:83]
    ds_read_b64 v[70:71], v70
    s_mov_b64 exec, s[84:85]
    ds_read_b64 v[72:73], v72
    s_mov_b64 exec, s[86:87]
    ds_read_b64 v[74:75], v74
    s_mov_b64 exec, -1
    s_waitcnt vmcnt(4)
    v_perm_b32 v28, v5, v4, s24
    v_perm_b32 v30, v6, v5, s25
    v_perm_b32 v32, v7, v6, s26
    v_perm_b32 v34, v35, v7, s27
    v_alignbyte_b32 v5, v6, v5, 1
    v_alignbyte_b32 v6, v7, v6, 2
    v_alignbyte_b32 v7, v35, v7, 3
    v_lshlrev_b32_sdwa v28, 3, v28 dst_sel:WORD_0 dst_unused:UNUSED_PAD src0_sel:DWORD src1_sel:DWORD
    v_lshlrev_b32_sdwa v30, 3, v30 dst_sel:WORD_0 dst_unused:UNUSED_PAD src0_sel:DWORD src1_sel:DWORD
    v_lshlrev_b32_sdwa v32, 3, v32 dst_sel:WORD_0 dst_unused:UNUSED_PAD src0_sel:DWORD src1_sel:DWORD
    v_lshlrev_b32_sdwa v34, 3, v34 dst_sel:WORD_0 dst_unused:UNUSED_PAD src0_sel:DWORD src1_sel:DWORD
    s_cmp_lt_i32 s42, 256
    s_cbranch_scc1 L_ufix_57
L_uback_58:

    v_subrev_co_u32 v4, s[64:65], 2.0, v4
    v_subrev_co_u32 v5, s[66:67], 2.0, v5
    v_subrev_co_u32 v6, s[68:69], 2.0, v6
    v_subrev_co_u32 v7, s[70:71], 2.0, v7
    s_mov_b64 exec, s[64:65]
    ds_read_b64 v[28:29], v28
    s_mov_b64 exec, s[66:67]
    ds_read_b64 v[30:31], v30
    s_mov_b64 exec, s[68:69]
    ds_read_b64 v[32:33], v32
    s_mov_b64 exec, s[70:71]
    ds_read_b64 v[34:35], v34
    s_mov_b64 exec, -1
    buffer_load_dwordx4 v[76:79], v3, s[12:15], s43 offen
    s_add_u32 s52, s43, 16384
    buffer_load_dwordx4 v[80:83], v3, s[12:15], s52 offen
    s_add_u32 s52, s43, 32768
    buffer_load_dwordx4 v[84:87], v3, s[12:15], s52 offen
    s_add_u32 s52, s43, 49152
    v_lshlrev_b32 v119, 2, v0
    buffer_load_dword v88, v119, s[12:15], s52 offen
    s_add_u32 s54, s43, 50048
    buffer_load_dword v115, v89, s[60:63], s54 offen
    s_add_u32 s54, s50, 0
    buffer_load_dword v115, v89, s[8:11], s54 offen
    s_waitcnt vmcnt(8)
    v_perm_b32 v36, v9, v8, s24
    v_perm_b32 v38, v10, v9, s25
    v_perm_b32 v40, v11, v10, s26
    v_perm_b32 v42, v43, v11, s27
    v_alignbyte_b32 v9, v10, v9, 1
    v_alignbyte_b32 v10, v11, v10, 2
    v_alignbyte_b32 v11, v43, v11, 3
    v_lshlrev_b32_sdwa v36, 3, v36 dst_sel:WORD_0 dst_unused:UNUSED_PAD src0_sel:DWORD src1_sel:DWORD
    v_lshlrev_b32_sdwa v38, 3, v38 dst_sel:WORD_0 dst_unused:UNUSED_PAD src0_sel:DWORD src1_sel:DWORD
    v_lshlrev_b32_sdwa v40, 3, v40 dst_sel:WORD_0 dst_unused:UNUSED_PAD src0_sel:DWORD src1_sel:DWORD
    v_lshlrev_b32_sdwa v42, 3, v42 dst_sel:WORD_0 dst_unused:UNUSED_PAD src0_sel:DWORD src1_sel:DWORD
    s_cmp_lt_i32 s42, 768
    s_cbranch_scc1 L_ufix_59
L_uback_60:

    v_subrev_co_u32 v8, s[72:73], 2.0, v8
    v_subrev_co_u32 v9, s[74:75], 2.0, v9
    v_subrev_co_u32 v10, s[76:77], 2.0, v10
    v_subrev_co_u32 v11, s[78:79], 2.0, v11
    s_mov_b64 exec, s[72:73]
    ds_read_b64 v[36:37], v36
    s_mov_b64 exec, s[74:75]
    ds_read_b64 v[38:39], v38
    s_mov_b64 exec, s[76:77]
    ds_read_b64 v[40:41], v40
    s_mov_b64 exec, s[78:79]
    ds_read_b64 v[42:43], v42
    s_mov_b64 exec, -1
    s_movk_i32 s53, 5120
    buffer_load_dwordx4 v[90:93], v2, s[16:19], s53 offen
    buffer_load_dword v110, v2, s[16:19], s53 offen offset:16
L_batch_61:
    s_add_u32 s5, s38, 1

    s_movk_i32 s53, 7680
    buffer_load_dwordx4 v[94:97], v2, s[16:19], s53 offen
    buffer_load_dword v111, v2, s[16:19], s53 offen offset:16
    v_subrev_co_u32 v4, s[64:65], 2.0, v4
    v_subrev_co_u32 v5, s[66:67], 2.0, v5
    v_subrev_co_u32 v6, s[68:69], 2.0, v6
    v_subrev_co_u32 v7, s[70:71], 2.0, v7
    v_subrev_co_u32 v8, s[72:73], 2.0, v8
    v_subrev_co_u32 v9, s[74:75], 2.0, v9
    v_subrev_co_u32 v10, s[76:77], 2.0, v10
    v_subrev_co_u32 v11, s[78:79], 2.0, v11
    v_subrev_co_u32 v12, s[80:81], 2.0, v12
    v_subrev_co_u32 v13, s[82:83], 2.0, v13
    v_subrev_co_u32 v14, s[84:85], 2.0, v14
    v_subrev_co_u32 v15, s[86:87], 2.0, v15
    s_waitcnt lgkmcnt(0)
    s_barrier
    s_waitcnt vmcnt(7)
    ds_write_addtid_b32 v76 offset:0
    ds_write_addtid_b32 v77 offset:256
    ds_write_addtid_b32 v78 offset:512
    ds_write_addtid_b32 v79 offset:768
    s_waitcnt vmcnt(6)
    ds_write_addtid_b32 v80 offset:16384
    ds_write_addtid_b32 v81 offset:16640
    ds_write_addtid_b32 v82 offset:16896
    ds_write_addtid_b32 v83 offset:17152
    s_waitcnt vmcnt(5)
    ds_write_addtid_b32 v84 offset:32768
    ds_write_addtid_b32 v85 offset:33024
    ds_write_addtid_b32 v86 offset:33280
    ds_write_addtid_b32 v87 offset:33536
    v_lshlrev_b32 v119, 2, v0
    s_waitcnt vmcnt(4)
    s_mov_b64 exec, s[48:49]
    ds_write_b32 v119, v88 offset:49152
    s_mov_b64 exec, -1
    s_add_u32 s43, s43, 50048
    s_add_u32 s14, s43, 50000
    s_min_u32 s14, s14, s41
    buffer_load_dwordx4 v[76:79], v3, s[12:15], s43 offen
    s_waitcnt lgkmcnt(0)
    s_barrier
    s_add_u32 s52, s43, 16384
    buffer_load_dwordx4 v[80:83], v3, s[12:15], s52 offen
    s_add_u32 s52, s43, 32768
    buffer_load_dwordx4 v[84:87], v3, s[12:15], s52 offen
    s_add_u32 s52, s43, 49152
    v_lshlrev_b32 v119, 2, v0
    buffer_load_dword v88, v119, s[12:15], s52 offen
    s_mov_b64 exec, s[64:65]
    ds_read_b64 v[28:29], v28
    s_mov_b64 exec, s[66:67]
    ds_read_b64 v[30:31], v30
    s_mov_b64 exec, s[68:69]
    ds_read_b64 v[32:33], v32
    s_mov_b64 exec, s[70:71]
    ds_read_b64 v[34:35], v34
    s_mov_b64 exec, s[72:73]
    ds_read_b64 v[36:37], v36
    s_mov_b64 exec, s[74:75]
    ds_read_b64 v[38:39], v38
    s_mov_b64 exec, s[76:77]
    ds_read_b64 v[40:41], v40
    s_mov_b64 exec, s[78:79]
    ds_read_b64 v[42:43], v42
    s_mov_b64 exec, s[80:81]
    ds_read_b64 v[44:45], v44
    s_mov_b64 exec, s[82:83]
    ds_read_b64 v[46:47], v46
    s_mov_b64 exec, s[84:85]
    ds_read_b64 v[48:49], v48
    s_mov_b64 exec, s[86:87]
    ds_read_b64 v[50:51], v50
    s_mov_b64 exec, -1
    v_subrev_co_u32 v16, s[64:65], 2.0, v16
    v_subrev_co_u32 v17, s[66:67], 2.0, v17
    v_subrev_co_u32 v18, s[68:69], 2.0, v18
    v_subrev_co_u32 v19, s[70:71], 2.0, v19
    v_subrev_co_u32 v20, s[72:73], 2.0, v20
    v_subrev_co_u32 v21, s[74:75], 2.0, v21
    v_subrev_co_u32 v22, s[76:77], 2.0, v22
    v_subrev_co_u32 v23, s[78:79], 2.0, v23
    v_subrev_co_u32 v24, s[80:81], 2.0, v24
    v_subrev_co_u32 v25, s[82:83], 2.0, v25
    v_subrev_co_u32 v26, s[84:85], 2.0, v26
    v_subrev_co_u32 v27, s[86:87], 2.0, v27
    s_mov_b64 exec, s[64:65]
    ds_read_b64 v[52:53], v52
    s_mov_b64 exec, s[66:67]
    ds_read_b64 v[54:55], v54
    s_mov_b64 exec, s[68:69]
    ds_read_b64 v[56:57], v56
    s_mov_b64 exec, s[70:71]
    ds_read_b64 v[58:59], v58
    s_mov_b64 exec, s[72:73]
    ds_read_b64 v[60:61], v60
    s_mov_b64 exec, s[74:75]
    ds_read_b64 v[62:63], v62
    s_mov_b64 exec, s[76:77]
    ds_read_b64 v[64:65], v64
    s_mov_b64 exec, s[78:79]
    ds_read_b64 v[66:67], v66
    s_mov_b64 exec, s[80:81]
    ds_read_b64 v[68:69], v68
    s_mov_b64 exec, s[82:83]
    ds_read_b64 v[70:71], v70
    s_mov_b64 exec, s[84:85]
    ds_read_b64 v[72:73], v72
    s_mov_b64 exec, s[86:87]
    ds_read_b64 v[74:75], v74
    s_mov_b64 exec, -1
    s_cmp_le_i32 s42, 3072
    s_cbranch_scc1 L_nt1_63
    s_waitcnt vmcnt(14)
    v_perm_b32 v120, v107, v106, s24
    v_perm_b32 v122, v108, v107, s25
    v_perm_b32 v124, v109, v108, s26
    v_perm_b32 v126, v114, v109, s27
    v_alignbyte_b32 v107, v108, v107, 1
    v_alignbyte_b32 v108, v109, v108, 2
    v_alignbyte_b32 v109, v114, v109, 3
    v_lshlrev_b32_sdwa v120, 3, v120 dst_sel:WORD_0 dst_unused:UNUSED_PAD src0_sel:DWORD src1_sel:DWORD
    v_lshlrev_b32_sdwa v122, 3, v122 dst_sel:WORD_0 dst_unused:UNUSED_PAD src0_sel:DWORD src1_sel:DWORD
    v_lshlrev_b32_sdwa v124, 3, v124 dst_sel:WORD_0 dst_unused:UNUSED_PAD src0_sel:DWORD src1_sel:DWORD
    v_lshlrev_b32_sdwa v126, 3, v126 dst_sel:WORD_0 dst_unused:UNUSED_PAD src0_sel:DWORD src1_sel:DWORD
    s_cmp_lt_i32 s42, 3328
    s_cbranch_scc1 L_ufix_66
L_uback_67:

    v_lshrrev_b32 v117, 30, v106
    v_and_b32 v106, 0x3fffffff, v106
    v_mul_u32_u24 v117, 50000, v117
    v_cmp_ne_u32 vcc, 0, v106
    v_add_u32 v120, v120, v117
    s_mov_b64 exec, vcc

    buffer_load_dwordx2 v[120:121], v120, s[8:11], s50 offen
    s_mov_b64 exec, -1
    v_lshrrev_b32 v117, 30, v107
    v_and_b32 v107, 0x3fffffff, v107
    v_mul_u32_u24 v117, 50000, v117
    v_cmp_ne_u32 vcc, 0, v107
    v_add_u32 v122, v122, v117
    s_mov_b64 exec, vcc

    buffer_load_dwordx2 v[122:123], v122, s[8:11], s50 offen
    s_mov_b64 exec, -1
    v_lshrrev_b32 v117, 30, v108
    v_and_b32 v108, 0x3fffffff, v108
    v_mul_u32_u24 v117, 50000, v117
    v_cmp_ne_u32 vcc, 0, v108
    v_add_u32 v124, v124, v117
    s_mov_b64 exec, vcc

    buffer_load_dwordx2 v[124:125], v124, s[8:11], s50 offen
    s_mov_b64 exec, -1
    v_lshrrev_b32 v117, 30, v109
    v_and_b32 v109, 0x3fffffff, v109
    v_mul_u32_u24 v117, 50000, v117
    v_cmp_ne_u32 vcc, 0, v109
    v_add_u32 v126, v126, v117
    s_mov_b64 exec, vcc

    buffer_load_dwordx2 v[126:127], v126, s[8:11], s50 offen
    s_mov_b64 exec, -1
L_nt1_63:
    v_subrev_co_u32 v4, s[64:65], 2.0, v4
    v_subrev_co_u32 v5, s[66:67], 2.0, v5
    v_subrev_co_u32 v6, s[68:69], 2.0, v6
    v_subrev_co_u32 v7, s[70:71], 2.0, v7
    v_subrev_co_u32 v8, s[72:73], 2.0, v8
    v_subrev_co_u32 v9, s[74:75], 2.0, v9
    v_subrev_co_u32 v10, s[76:77], 2.0, v10
    v_subrev_co_u32 v11, s[78:79], 2.0, v11
    v_subrev_co_u32 v12, s[80:81], 2.0, v12
    v_subrev_co_u32 v13, s[82:83], 2.0, v13
    v_subrev_co_u32 v14, s[84:85], 2.0, v14
    v_subrev_co_u32 v15, s[86:87], 2.0, v15
    s_waitcnt lgkmcnt(0)
    s_barrier
    s_waitcnt vmcnt(3)
    ds_write_addtid_b32 v76 offset:0
    ds_write_addtid_b32 v77 offset:256
    ds_write_addtid_b32 v78 offset:512
    ds_write_addtid_b32 v79 offset:768
    s_waitcnt vmcnt(2)
    ds_write_addtid_b32 v80 offset:16384
    ds_write_addtid_b32 v81 offset:16640
    ds_write_addtid_b32 v82 offset:16896
    ds_write_addtid_b32 v83 offset:17152
    s_waitcnt vmcnt(1)
    ds_write_addtid_b32 v84 offset:32768
    ds_write_addtid_b32 v85 offset:33024
    ds_write_addtid_b32 v86 offset:33280
    ds_write_addtid_b32 v87 offset:33536
    v_lshlrev_b32 v119, 2, v0
    s_waitcnt vmcnt(0)
    s_mov_b64 exec, s[48:49]
    ds_write_b32 v119, v88 offset:49152
    s_mov_b64 exec, -1
    s_add_u32 s43, s43, 50048
    s_add_u32 s14, s43, 50000
    s_min_u32 s14, s14, s41
    buffer_load_dwordx4 v[76:79], v3, s[12:15], s43 offen
    s_waitcnt lgkmcnt(0)
    s_barrier
    s_add_u32 s52, s43, 16384
    buffer_load_dwordx4 v[80:83], v3, s[12:15], s52 offen
    s_add_u32 s52, s43, 32768
    buffer_load_dwordx4 v[84:87], v3, s[12:15], s52 offen
    s_add_u32 s52, s43, 49152
    v_lshlrev_b32 v119, 2, v0
    buffer_load_dword v88, v119, s[12:15], s52 offen
    s_mov_b64 exec, s[64:65]
    ds_read_b64 v[28:29], v28
    s_mov_b64 exec, s[66:67]
    ds_read_b64 v[30:31], v30
    s_mov_b64 exec, s[68:69]
    ds_read_b64 v[32:33], v32
    s_mov_b64 exec, s[70:71]
    ds_read_b64 v[34:35], v34
    s_mov_b64 exec, s[72:73]
    ds_read_b64 v[36:37], v36
    s_mov_b64 exec, s[74:75]
    ds_read_b64 v[38:39], v38
    s_mov_b64 exec, s[76:77]
    ds_read_b64 v[40:41], v40
    s_mov_b64 exec, s[78:79]
    ds_read_b64 v[42:43], v42
    s_mov_b64 exec, s[80:81]
    ds_read_b64 v[44:45], v44
    s_mov_b64 exec, s[82:83]
    ds_read_b64 v[46:47], v46
    s_mov_b64 exec, s[84:85]
    ds_read_b64 v[48:49], v48
    s_mov_b64 exec, s[86:87]
    ds_read_b64 v[50:51], v50
    s_mov_b64 exec, -1
    v_subrev_co_u32 v16, s[64:65], 2.0, v16
    v_subrev_co_u32 v17, s[66:67], 2.0, v17
    v_subrev_co_u32 v18, s[68:69], 2.0, v18
    v_subrev_co_u32 v19, s[70:71], 2.0, v19
    v_subrev_co_u32 v20, s[72:73], 2.0, v20
    v_subrev_co_u32 v21, s[74:75], 2.0, v21
    v_subrev_co_u32 v22, s[76:77], 2.0, v22
    v_subrev_co_u32 v23, s[78:79], 2.0, v23
    v_subrev_co_u32 v24, s[80:81], 2.0, v24
    v_subrev_co_u32 v25, s[82:83], 2.0, v25
    v_subrev_co_u32 v26, s[84:85], 2.0, v26
    v_subrev_co_u32 v27, s[86:87], 2.0, v27
    s_mov_b64 exec, s[64:65]
    ds_read_b64 v[52:53], v52
    s_mov_b64 exec, s[66:67]
    ds_read_b64 v[54:55], v54
    s_mov_b64 exec, s[68:69]
    ds_read_b64 v[56:57], v56
    s_mov_b64 exec, s[70:71]
    ds_read_b64 v[58:59], v58
    s_mov_b64 exec, s[72:73]
    ds_read_b64 v[60:61], v60
    s_mov_b64 exec, s[74:75]
    ds_read_b64 v[62:63], v62
    s_mov_b64 exec, s[76:77]
    ds_read_b64 v[64:65], v64
    s_mov_b64 exec, s[78:79]
    ds_read_b64 v[66:67], v66
    s_mov_b64 exec, s[80:81]
    ds_read_b64 v[68:69], v68
    s_mov_b64 exec, s[82:83]
    ds_read_b64 v[70:71], v70
    s_mov_b64 exec, s[84:85]
    ds_read_b64 v[72:73], v72
    s_mov_b64 exec, s[86:87]
    ds_read_b64 v[74:75], v74
    s_mov_b64 exec, -1
    s_movk_i32 s53, 10240
    buffer_load_dwordx4 v[98:101], v2, s[16:19], s53 offen
    buffer_load_dword v112, v2, s[16:19], s53 offen offset:16
    s_movk_i32 s53, 12800
    buffer_load_dwordx4 v[102:105], v2, s[16:19], s53 offen
    buffer_load_dword v113, v2, s[16:19], s53 offen offset:16
    s_cmp_le_i32 s42, 3072
    s_cbranch_scc1 L_nt2_64
    s_waitcnt vmcnt(8)
    v_cmp_ne_u32 s[56:57], 0, v106
    v_cmp_ne_u32 s[58:59], 0, v107
    v_cmp_ne_u32 s[98:99], 0, v108
    v_cmp_ne_u32 vcc, 0, v109
    s_mov_b64 exec, s[56:57]
    v_cvt_f32_i32_sdwa v118, sext(v106) dst_sel:DWORD dst_unused:UNUSED_PAD src0_sel:WORD_0
    v_lshlrev_b32 v116, 16, v120
    v_and_b32 v117, s32, v120
    v_mul_f32 v118, s33, v118
    v_lshlrev_b32 v120, 16, v121
    v_and_b32 v121, s32, v121
    v_lshlrev_b32_sdwa v106, 3, v106 dst_sel:DWORD dst_unused:UNUSED_PAD src0_sel:DWORD src1_sel:WORD_1
    v_pk_fma_f32 v[116:117], v[116:117], v[118:119], s[28:29] op_sel_hi:[1,0,1]
    v_pk_fma_f32 v[120:121], v[120:121], v[118:119], s[28:29] op_sel_hi:[1,0,1]
    v_perm_b32 v116, v117, v116, s35
    v_perm_b32 v117, v121, v120, s35
    v_lshl_add_u64 v[116:117], v[116:117], 0, s[30:31]
    ds_add_rtn_u64 v[120:121], v106, v[116:117] offset:50000

    s_mov_b64 exec, s[58:59]
    v_cvt_f32_i32_sdwa v118, sext(v107) dst_sel:DWORD dst_unused:UNUSED_PAD src0_sel:WORD_0
    v_lshlrev_b32 v116, 16, v122
    v_and_b32 v117, s32, v122
    v_mul_f32 v118, s33, v118
    v_lshlrev_b32 v122, 16, v123
    v_and_b32 v123, s32, v123
    v_lshlrev_b32_sdwa v107, 3, v107 dst_sel:DWORD dst_unused:UNUSED_PAD src0_sel:DWORD src1_sel:WORD_1
    v_pk_fma_f32 v[116:117], v[116:117], v[118:119], s[28:29] op_sel_hi:[1,0,1]
    v_pk_fma_f32 v[122:123], v[122:123], v[118:119], s[28:29] op_sel_hi:[1,0,1]
    v_perm_b32 v116, v117, v116, s35
    v_perm_b32 v117, v123, v122, s35
    v_lshl_add_u64 v[116:117], v[116:117], 0, s[30:31]
    ds_add_rtn_u64 v[122:123], v107, v[116:117] offset:50000

    s_mov_b64 exec, s[98:99]
    v_cvt_f32_i32_sdwa v118, sext(v108) dst_sel:DWORD dst_unused:UNUSED_PAD src0_sel:WORD_0
    v_lshlrev_b32 v116, 16, v124
    v_and_b32 v117, s32, v124
    v_mul_f32 v118, s33, v118
    v_lshlrev_b32 v124, 16, v125
    v_and_b32 v125, s32, v125
    v_lshlrev_b32_sdwa v108, 3, v108 dst_sel:DWORD dst_unused:UNUSED_PAD src0_sel:DWORD src1_sel:WORD_1
    v_pk_fma_f32 v[116:117], v[116:117], v[118:119], s[28:29] op_sel_hi:[1,0,1]
    v_pk_fma_f32 v[124:125], v[124:125], v[118:119], s[28:29] op_sel_hi:[1,0,1]
    v_perm_b32 v116, v117, v116, s35
    v_perm_b32 v117, v125, v124, s35
    v_lshl_add_u64 v[116:117], v[116:117], 0, s[30:31]
    ds_add_rtn_u64 v[124:125], v108, v[116:117] offset:50000

    s_mov_b64 exec, vcc
    v_cvt_f32_i32_sdwa v118, sext(v109) dst_sel:DWORD dst_unused:UNUSED_PAD src0_sel:WORD_0
    v_lshlrev_b32 v116, 16, v126
    v_and_b32 v117, s32, v126
    v_mul_f32 v118, s33, v118
    v_lshlrev_b32 v126, 16, v127
    v_and_b32 v127, s32, v127
    v_lshlrev_b32_sdwa v109, 3, v109 dst_sel:DWORD dst_unused:UNUSED_PAD src0_sel:DWORD src1_sel:WORD_1
    v_pk_fma_f32 v[116:117], v[116:117], v[118:119], s[28:29] op_sel_hi:[1,0,1]
    v_pk_fma_f32 v[126:127], v[126:127], v[118:119], s[28:29] op_sel_hi:[1,0,1]
    v_perm_b32 v116, v117, v116, s35
    v_perm_b32 v117, v127, v126, s35
    v_lshl_add_u64 v[116:117], v[116:117], 0, s[30:31]
    ds_add_rtn_u64 v[126:127], v109, v[116:117] offset:50000

    s_waitcnt lgkmcnt(0)
    s_mov_b64 exec, s[56:57]
    v_or3_b32 v1, v120, v121, v1
    s_mov_b64 exec, s[58:59]
    v_or3_b32 v1, v122, v123, v1
    s_mov_b64 exec, s[98:99]
    v_or3_b32 v1, v124, v125, v1
    s_mov_b64 exec, vcc
    v_or3_b32 v1, v126, v127, v1
    s_mov_b64 exec, -1
L_nt2_64:
    s_movk_i32 s53, 15360
    buffer_load_dwordx4 v[106:109], v2, s[16:19], s53 offen
    buffer_load_dword v114, v2, s[16:19], s53 offen offset:16
    s_cmp_le_u32 s40, 3584
    s_cbranch_scc1 L_noleft_65
    s_min_u32 s40, s40, 6524
    s_lshl_b32 s52, s38, 6
    s_add_u32 s52, s52, s36
    s_mul_i32 s52, s52, 32764
    s_and_b32 s52, s52, 0xffffff80
    s_add_u32 s20, s44, s52
    s_addc_u32 s21, s45, 0
    s_mul_i32 s52, s40, 5
    s_add_u32 s52, s52, 3
    s_and_b32 s22, s52, -4

    s_lshr_b32 s55, s39, 2
    s_add_u32 s55, s55, 3584
    v_and_b32 v120, 63, v0
    v_add_u32 v120, s55, v120
L_left_68:
    s_cmp_ge_u32 s55, s40
    s_cbranch_scc1 L_leftend_69
    v_mul_u32_u24 v121, 5, v120
    buffer_load_dword v122, v121, s[20:23], 0 offen
    buffer_load_ubyte v123, v121, s[20:23], 0 offen offset:4
    s_waitcnt vmcnt(0)

    v_perm_b32 v121, v123, v122, s24
    v_lshrrev_b32 v126, 30, v122
    v_and_b32 v121, 0x1fff, v121
    v_mul_u32_u24 v126, 6250, v126
    v_add_lshl_u32 v121, v121, v126, 3

    buffer_load_dwordx2 v[124:125], v121, s[8:11], s50 offen
    v_cmp_gt_u32 vcc, s40, v120
    s_waitcnt vmcnt(0)

    s_mov_b64 exec, vcc
    v_and_b32 v122, 0x3fffffff, v122
    v_cvt_f32_i32_sdwa v118, sext(v122) dst_sel:DWORD dst_unused:UNUSED_PAD src0_sel:WORD_0
    v_lshlrev_b32 v116, 16, v124
    v_and_b32 v117, s32, v124
    v_mul_f32 v118, s33, v118
    v_lshlrev_b32 v124, 16, v125
    v_and_b32 v125, s32, v125
    v_lshlrev_b32_sdwa v122, 3, v122 dst_sel:DWORD dst_unused:UNUSED_PAD src0_sel:DWORD src1_sel:WORD_1
    v_pk_fma_f32 v[116:117], v[116:117], v[118:119], s[28:29] op_sel_hi:[1,0,1]
    v_pk_fma_f32 v[124:125], v[124:125], v[118:119], s[28:29] op_sel_hi:[1,0,1]
    v_perm_b32 v116, v117, v116, s35
    v_perm_b32 v117, v125, v124, s35
    v_lshl_add_u64 v[116:117], v[116:117], 0, s[30:31]
    ds_add_rtn_u64 v[124:125], v122, v[116:117] offset:50000

    s_waitcnt lgkmcnt(0)
    v_or3_b32 v1, v124, v125, v1
    s_mov_b64 exec, -1
    v_add_u32 v120, 128, v120
    s_add_u32 s55, s55, 128
    s_branch L_left_68
L_leftend_69:

L_noleft_65:
    v_cmp_gt_u32 s[64:65], 2.0, v4
    v_and_b32 v4, 0x3fffffff, v4
    v_cmp_gt_u32 s[66:67], 2.0, v5
    v_and_b32 v5, 0x3fffffff, v5
    v_cmp_gt_u32 s[68:69], 2.0, v6
    v_and_b32 v6, 0x3fffffff, v6
    v_cmp_gt_u32 s[70:71], 2.0, v7
    v_and_b32 v7, 0x3fffffff, v7
    v_cmp_gt_u32 s[72:73], 2.0, v8
    v_and_b32 v8, 0x3fffffff, v8
    v_cmp_gt_u32 s[74:75], 2.0, v9
    v_and_b32 v9, 0x3fffffff, v9
    v_cmp_gt_u32 s[76:77], 2.0, v10
    v_and_b32 v10, 0x3fffffff, v10
    v_cmp_gt_u32 s[78:79], 2.0, v11
    v_and_b32 v11, 0x3fffffff, v11
    v_cmp_gt_u32 s[80:81], 2.0, v12
    v_and_b32 v12, 0x3fffffff, v12
    v_cmp_gt_u32 s[82:83], 2.0, v13
    v_and_b32 v13, 0x3fffffff, v13
    v_cmp_gt_u32 s[84:85], 2.0, v14
    v_and_b32 v14, 0x3fffffff, v14
    v_cmp_gt_u32 s[86:87], 2.0, v15
    v_and_b32 v15, 0x3fffffff, v15
    s_waitcnt lgkmcnt(0)
    s_barrier
    s_waitcnt vmcnt(9)
    ds_write_addtid_b32 v76 offset:0
    ds_write_addtid_b32 v77 offset:256
    ds_write_addtid_b32 v78 offset:512
    ds_write_addtid_b32 v79 offset:768
    s_waitcnt vmcnt(8)
    ds_write_addtid_b32 v80 offset:16384
    ds_write_addtid_b32 v81 offset:16640
    ds_write_addtid_b32 v82 offset:16896
    ds_write_addtid_b32 v83 offset:17152
    s_waitcnt vmcnt(7)
    ds_write_addtid_b32 v84 offset:32768
    ds_write_addtid_b32 v85 offset:33024
    ds_write_addtid_b32 v86 offset:33280
    ds_write_addtid_b32 v87 offset:33536
    v_lshlrev_b32 v119, 2, v0
    s_waitcnt vmcnt(6)
    s_mov_b64 exec, s[48:49]
    ds_write_b32 v119, v88 offset:49152
    s_mov_b64 exec, -1
    s_add_u32 s43, s43, 50048
    s_add_u32 s14, s43, 50000
    s_min_u32 s14, s14, s41
    buffer_load_dwordx4 v[76:79], v3, s[12:15], s43 offen
    s_waitcnt lgkmcnt(0)
    s_barrier
    s_add_u32 s52, s43, 16384
    buffer_load_dwordx4 v[80:83], v3, s[12:15], s52 offen
    s_add_u32 s52, s43, 32768
    buffer_load_dwordx4 v[84:87], v3, s[12:15], s52 offen
    s_add_u32 s52, s43, 49152
    v_lshlrev_b32 v119, 2, v0
    buffer_load_dword v88, v119, s[12:15], s52 offen
    s_mov_b64 exec, s[64:65]
    ds_read_b64 v[28:29], v28
    s_mov_b64 exec, s[66:67]
    ds_read_b64 v[30:31], v30
    s_mov_b64 exec, s[68:69]
    ds_read_b64 v[32:33], v32
    s_mov_b64 exec, s[70:71]
    ds_read_b64 v[34:35], v34
    s_mov_b64 exec, s[72:73]
    ds_read_b64 v[36:37], v36
    s_mov_b64 exec, s[74:75]
    ds_read_b64 v[38:39], v38
    s_mov_b64 exec, s[76:77]
    ds_read_b64 v[40:41], v40
    s_mov_b64 exec, s[78:79]
    ds_read_b64 v[42:43], v42
    s_mov_b64 exec, s[80:81]
    ds_read_b64 v[44:45], v44
    s_mov_b64 exec, s[82:83]
    ds_read_b64 v[46:47], v46
    s_mov_b64 exec, s[84:85]
    ds_read_b64 v[48:49], v48
    s_mov_b64 exec, s[86:87]
    ds_read_b64 v[50:51], v50
    s_mov_b64 exec, -1
    v_cmp_gt_u32 s[64:65], 2.0, v16
    v_and_b32 v16, 0x3fffffff, v16
    v_cmp_gt_u32 s[66:67], 2.0, v17
    v_and_b32 v17, 0x3fffffff, v17
    v_cmp_gt_u32 s[68:69], 2.0, v18
    v_and_b32 v18, 0x3fffffff, v18
    v_cmp_gt_u32 s[70:71], 2.0, v19
    v_and_b32 v19, 0x3fffffff, v19
    v_cmp_gt_u32 s[72:73], 2.0, v20
    v_and_b32 v20, 0x3fffffff, v20
    v_cmp_gt_u32 s[74:75], 2.0, v21
    v_and_b32 v21, 0x3fffffff, v21
    v_cmp_gt_u32 s[76:77], 2.0, v22
    v_and_b32 v22, 0x3fffffff, v22
    v_cmp_gt_u32 s[78:79], 2.0, v23
    v_and_b32 v23, 0x3fffffff, v23
    v_cmp_gt_u32 s[80:81], 2.0, v24
    v_and_b32 v24, 0x3fffffff, v24
    v_cmp_gt_u32 s[82:83], 2.0, v25
    v_and_b32 v25, 0x3fffffff, v25
    v_cmp_gt_u32 s[84:85], 2.0, v26
    v_and_b32 v26, 0x3fffffff, v26
    v_cmp_gt_u32 s[86:87], 2.0, v27
    v_and_b32 v27, 0x3fffffff, v27
    s_mov_b64 exec, s[64:65]
    ds_read_b64 v[52:53], v52
    s_mov_b64 exec, s[66:67]
    ds_read_b64 v[54:55], v54
    s_mov_b64 exec, s[68:69]
    ds_read_b64 v[56:57], v56
    s_mov_b64 exec, s[70:71]
    ds_read_b64 v[58:59], v58
    s_mov_b64 exec, s[72:73]
    ds_read_b64 v[60:61], v60
    s_mov_b64 exec, s[74:75]
    ds_read_b64 v[62:63], v62
    s_mov_b64 exec, s[76:77]
    ds_read_b64 v[64:65], v64
    s_mov_b64 exec, s[78:79]
    ds_read_b64 v[66:67], v66
    s_mov_b64 exec, s[80:81]
    ds_read_b64 v[68:69], v68
    s_mov_b64 exec, s[82:83]
    ds_read_b64 v[70:71], v70
    s_mov_b64 exec, s[84:85]
    ds_read_b64 v[72:73], v72
    s_mov_b64 exec, s[86:87]
    ds_read_b64 v[74:75], v74
    s_mov_b64 exec, -1
    s_cmp_ge_u32 s5, s4
    s_cbranch_scc1 L_bend_62
    s_waitcnt lgkmcnt(15)
    v_mad_i32_i16 v120, v28, v4, s96
    v_mad_i32_i16 v28, v28, v4, s96 op_sel:[1,0,0,0]
    v_mad_i32_i16 v121, v29, v4, s96
    v_mad_i32_i16 v29, v29, v4, s96 op_sel:[1,0,0,0]
    v_lshlrev_b32_sdwa v4, 3, v4 dst_sel:DWORD dst_unused:UNUSED_PAD src0_sel:DWORD src1_sel:WORD_1
    v_perm_b32 v28, v28, v120, s97
    v_perm_b32 v29, v29, v121, s97
    v_lshl_add_u64 v[28:29], v[28:29], 0, s[30:31]

    ds_add_rtn_u64 v[28:29], v4, v[28:29] offset:50000
    v_mad_i32_i16 v122, v30, v5, s96
    v_mad_i32_i16 v30, v30, v5, s96 op_sel:[1,0,0,0]
    v_mad_i32_i16 v123, v31, v5, s96
    v_mad_i32_i16 v31, v31, v5, s96 op_sel:[1,0,0,0]
    v_lshlrev_b32_sdwa v5, 3, v5 dst_sel:DWORD dst_unused:UNUSED_PAD src0_sel:DWORD src1_sel:WORD_1
    v_perm_b32 v30, v30, v122, s97
    v_perm_b32 v31, v31, v123, s97
    v_lshl_add_u64 v[30:31], v[30:31], 0, s[30:31]

    ds_add_rtn_u64 v[30:31], v5, v[30:31] offset:50000
    v_mad_i32_i16 v124, v32, v6, s96
    v_mad_i32_i16 v32, v32, v6, s96 op_sel:[1,0,0,0]
    v_mad_i32_i16 v125, v33, v6, s96
    v_mad_i32_i16 v33, v33, v6, s96 op_sel:[1,0,0,0]
    v_lshlrev_b32_sdwa v6, 3, v6 dst_sel:DWORD dst_unused:UNUSED_PAD src0_sel:DWORD src1_sel:WORD_1
    v_perm_b32 v32, v32, v124, s97
    v_perm_b32 v33, v33, v125, s97
    v_lshl_add_u64 v[32:33], v[32:33], 0, s[30:31]

    ds_add_rtn_u64 v[32:33], v6, v[32:33] offset:50000
    v_mad_i32_i16 v126, v34, v7, s96
    v_mad_i32_i16 v34, v34, v7, s96 op_sel:[1,0,0,0]
    v_mad_i32_i16 v127, v35, v7, s96
    v_mad_i32_i16 v35, v35, v7, s96 op_sel:[1,0,0,0]
    v_lshlrev_b32_sdwa v7, 3, v7 dst_sel:DWORD dst_unused:UNUSED_PAD src0_sel:DWORD src1_sel:WORD_1
    v_perm_b32 v34, v34, v126, s97
    v_perm_b32 v35, v35, v127, s97
    v_lshl_add_u64 v[34:35], v[34:35], 0, s[30:31]

    ds_add_rtn_u64 v[34:35], v7, v[34:35] offset:50000
    v_mad_i32_i16 v120, v36, v8, s96
    v_mad_i32_i16 v36, v36, v8, s96 op_sel:[1,0,0,0]
    v_mad_i32_i16 v121, v37, v8, s96
    v_mad_i32_i16 v37, v37, v8, s96 op_sel:[1,0,0,0]
    v_lshlrev_b32_sdwa v8, 3, v8 dst_sel:DWORD dst_unused:UNUSED_PAD src0_sel:DWORD src1_sel:WORD_1
    v_perm_b32 v36, v36, v120, s97
    v_perm_b32 v37, v37, v121, s97
    v_lshl_add_u64 v[36:37], v[36:37], 0, s[30:31]

    ds_add_rtn_u64 v[36:37], v8, v[36:37] offset:50000
    v_mad_i32_i16 v122, v38, v9, s96
    v_mad_i32_i16 v38, v38, v9, s96 op_sel:[1,0,0,0]
    v_mad_i32_i16 v123, v39, v9, s96
    v_mad_i32_i16 v39, v39, v9, s96 op_sel:[1,0,0,0]
    v_lshlrev_b32_sdwa v9, 3, v9 dst_sel:DWORD dst_unused:UNUSED_PAD src0_sel:DWORD src1_sel:WORD_1
    v_perm_b32 v38, v38, v122, s97
    v_perm_b32 v39, v39, v123, s97
    v_lshl_add_u64 v[38:39], v[38:39], 0, s[30:31]

    ds_add_rtn_u64 v[38:39], v9, v[38:39] offset:50000
    v_mad_i32_i16 v124, v40, v10, s96
    v_mad_i32_i16 v40, v40, v10, s96 op_sel:[1,0,0,0]
    v_mad_i32_i16 v125, v41, v10, s96
    v_mad_i32_i16 v41, v41, v10, s96 op_sel:[1,0,0,0]
    v_lshlrev_b32_sdwa v10, 3, v10 dst_sel:DWORD dst_unused:UNUSED_PAD src0_sel:DWORD src1_sel:WORD_1
    v_perm_b32 v40, v40, v124, s97
    v_perm_b32 v41, v41, v125, s97
    v_lshl_add_u64 v[40:41], v[40:41], 0, s[30:31]

    ds_add_rtn_u64 v[40:41], v10, v[40:41] offset:50000
    v_mad_i32_i16 v126, v42, v11, s96
    v_mad_i32_i16 v42, v42, v11, s96 op_sel:[1,0,0,0]
    v_mad_i32_i16 v127, v43, v11, s96
    v_mad_i32_i16 v43, v43, v11, s96 op_sel:[1,0,0,0]
    v_lshlrev_b32_sdwa v11, 3, v11 dst_sel:DWORD dst_unused:UNUSED_PAD src0_sel:DWORD src1_sel:WORD_1
    v_perm_b32 v42, v42, v126, s97
    v_perm_b32 v43, v43, v127, s97
    v_lshl_add_u64 v[42:43], v[42:43], 0, s[30:31]

    ds_add_rtn_u64 v[42:43], v11, v[42:43] offset:50000
    s_waitcnt lgkmcnt(4)
    v_or3_b32 v1, v28, v29, v1
    v_or3_b32 v1, v30, v31, v1
    v_or3_b32 v1, v32, v33, v1
    v_or3_b32 v1, v34, v35, v1
    s_movk_i32 s53, 0
    buffer_load_dwordx4 v[4:7], v2, s[16:19], s53 offen nt
    buffer_load_dword v35, v2, s[16:19], s53 offen offset:16 nt
    v_mad_i32_i16 v120, v44, v12, s96
    v_mad_i32_i16 v44, v44, v12, s96 op_sel:[1,0,0,0]
    v_mad_i32_i16 v121, v45, v12, s96
    v_mad_i32_i16 v45, v45, v12, s96 op_sel:[1,0,0,0]
    v_lshlrev_b32_sdwa v12, 3, v12 dst_sel:DWORD dst_unused:UNUSED_PAD src0_sel:DWORD src1_sel:WORD_1
    v_perm_b32 v44, v44, v120, s97
    v_perm_b32 v45, v45, v121, s97
    v_lshl_add_u64 v[44:45], v[44:45], 0, s[30:31]

    ds_add_rtn_u64 v[44:45], v12, v[44:45] offset:50000
    v_mad_i32_i16 v122, v46, v13, s96
    v_mad_i32_i16 v46, v46, v13, s96 op_sel:[1,0,0,0]
    v_mad_i32_i16 v123, v47, v13, s96
    v_mad_i32_i16 v47, v47, v13, s96 op_sel:[1,0,0,0]
    v_lshlrev_b32_sdwa v13, 3, v13 dst_sel:DWORD dst_unused:UNUSED_PAD src0_sel:DWORD src1_sel:WORD_1
    v_perm_b32 v46, v46, v122, s97
    v_perm_b32 v47, v47, v123, s97
    v_lshl_add_u64 v[46:47], v[46:47], 0, s[30:31]

    ds_add_rtn_u64 v[46:47], v13, v[46:47] offset:50000
    v_mad_i32_i16 v124, v48, v14, s96
    v_mad_i32_i16 v48, v48, v14, s96 op_sel:[1,0,0,0]
    v_mad_i32_i16 v125, v49, v14, s96
    v_mad_i32_i16 v49, v49, v14, s96 op_sel:[1,0,0,0]
    v_lshlrev_b32_sdwa v14, 3, v14 dst_sel:DWORD dst_unused:UNUSED_PAD src0_sel:DWORD src1_sel:WORD_1
    v_perm_b32 v48, v48, v124, s97
    v_perm_b32 v49, v49, v125, s97
    v_lshl_add_u64 v[48:49], v[48:49], 0, s[30:31]

    ds_add_rtn_u64 v[48:49], v14, v[48:49] offset:50000
    v_mad_i32_i16 v126, v50, v15, s96
    v_mad_i32_i16 v50, v50, v15, s96 op_sel:[1,0,0,0]
    v_mad_i32_i16 v127, v51, v15, s96
    v_mad_i32_i16 v51, v51, v15, s96 op_sel:[1,0,0,0]
    v_lshlrev_b32_sdwa v15, 3, v15 dst_sel:DWORD dst_unused:UNUSED_PAD src0_sel:DWORD src1_sel:WORD_1
    v_perm_b32 v50, v50, v126, s97
    v_perm_b32 v51, v51, v127, s97
    v_lshl_add_u64 v[50:51], v[50:51], 0, s[30:31]

    ds_add_rtn_u64 v[50:51], v15, v[50:51] offset:50000
    s_waitcnt lgkmcnt(4)
    v_or3_b32 v1, v36, v37, v1
    v_or3_b32 v1, v38, v39, v1
    v_or3_b32 v1, v40, v41, v1
    v_or3_b32 v1, v42, v43, v1
    s_movk_i32 s53, 2560
    buffer_load_dwordx4 v[8:11], v2, s[16:19], s53 offen
    buffer_load_dword v43, v2, s[16:19], s53 offen offset:16
    s_barrier
    s_waitcnt vmcnt(7)
    ds_write_addtid_b32 v76 offset:0
    ds_write_addtid_b32 v77 offset:256
    ds_write_addtid_b32 v78 offset:512
    ds_write_addtid_b32 v79 offset:768
    s_waitcnt vmcnt(6)
    ds_write_addtid_b32 v80 offset:16384
    ds_write_addtid_b32 v81 offset:16640
    ds_write_addtid_b32 v82 offset:16896
    ds_write_addtid_b32 v83 offset:17152
    s_waitcnt vmcnt(5)
    ds_write_addtid_b32 v84 offset:32768
    ds_write_addtid_b32 v85 offset:33024
    ds_write_addtid_b32 v86 offset:33280
    ds_write_addtid_b32 v87 offset:33536
    v_lshlrev_b32 v119, 2, v0
    s_waitcnt vmcnt(4)
    s_mov_b64 exec, s[48:49]
    ds_write_b32 v119, v88 offset:49152
    s_mov_b64 exec, -1
    s_add_u32 s43, s43, 50048
    s_add_u32 s14, s43, 50000
    s_min_u32 s14, s14, s41
    s_mov_b32 s40, s88
    s_sub_u32 s42, s40, s39

    s_add_u32 s55, s38, 2
    s_min_u32 s55, s55, 31
    s_mov_b32 s88, s89
    s_mov_b32 s89, s90
    s_mov_b32 s90, s91
    s_mov_b32 s91, s92
    s_mov_b32 s92, s93
    s_mov_b32 s93, s94
    s_mov_b32 s94, s95
    s_mov_b32 s95, 0
    s_min_u32 s88, s88, 6524
    s_lshl_b32 s52, s55, 6
    s_add_u32 s52, s52, s36
    s_mul_i32 s52, s52, 32764
    s_and_b32 s52, s52, 0xffffff80
    s_add_u32 s16, s44, s52
    s_addc_u32 s17, s45, 0
    s_mul_i32 s52, s88, 5
    s_add_u32 s52, s52, 3
    s_and_b32 s18, s52, -4

    v_mad_i32_i16 v120, v52, v16, s96
    v_mad_i32_i16 v52, v52, v16, s96 op_sel:[1,0,0,0]
    v_mad_i32_i16 v121, v53, v16, s96
    v_mad_i32_i16 v53, v53, v16, s96 op_sel:[1,0,0,0]
    v_lshlrev_b32_sdwa v16, 3, v16 dst_sel:DWORD dst_unused:UNUSED_PAD src0_sel:DWORD src1_sel:WORD_1
    v_perm_b32 v52, v52, v120, s97
    v_perm_b32 v53, v53, v121, s97
    v_lshl_add_u64 v[52:53], v[52:53], 0, s[30:31]

    ds_add_rtn_u64 v[52:53], v16, v[52:53] offset:50000
    v_mad_i32_i16 v122, v54, v17, s96
    v_mad_i32_i16 v54, v54, v17, s96 op_sel:[1,0,0,0]
    v_mad_i32_i16 v123, v55, v17, s96
    v_mad_i32_i16 v55, v55, v17, s96 op_sel:[1,0,0,0]
    v_lshlrev_b32_sdwa v17, 3, v17 dst_sel:DWORD dst_unused:UNUSED_PAD src0_sel:DWORD src1_sel:WORD_1
    v_perm_b32 v54, v54, v122, s97
    v_perm_b32 v55, v55, v123, s97
    v_lshl_add_u64 v[54:55], v[54:55], 0, s[30:31]

    ds_add_rtn_u64 v[54:55], v17, v[54:55] offset:50000
    v_mad_i32_i16 v124, v56, v18, s96
    v_mad_i32_i16 v56, v56, v18, s96 op_sel:[1,0,0,0]
    v_mad_i32_i16 v125, v57, v18, s96
    v_mad_i32_i16 v57, v57, v18, s96 op_sel:[1,0,0,0]
    v_lshlrev_b32_sdwa v18, 3, v18 dst_sel:DWORD dst_unused:UNUSED_PAD src0_sel:DWORD src1_sel:WORD_1
    v_perm_b32 v56, v56, v124, s97
    v_perm_b32 v57, v57, v125, s97
    v_lshl_add_u64 v[56:57], v[56:57], 0, s[30:31]

    ds_add_rtn_u64 v[56:57], v18, v[56:57] offset:50000
    v_mad_i32_i16 v126, v58, v19, s96
    v_mad_i32_i16 v58, v58, v19, s96 op_sel:[1,0,0,0]
    v_mad_i32_i16 v127, v59, v19, s96
    v_mad_i32_i16 v59, v59, v19, s96 op_sel:[1,0,0,0]
    v_lshlrev_b32_sdwa v19, 3, v19 dst_sel:DWORD dst_unused:UNUSED_PAD src0_sel:DWORD src1_sel:WORD_1
    v_perm_b32 v58, v58, v126, s97
    v_perm_b32 v59, v59, v127, s97
    v_lshl_add_u64 v[58:59], v[58:59], 0, s[30:31]

    ds_add_rtn_u64 v[58:59], v19, v[58:59] offset:50000
    s_waitcnt lgkmcnt(15)
    v_or3_b32 v1, v44, v45, v1
    v_or3_b32 v1, v46, v47, v1
    v_or3_b32 v1, v48, v49, v1
    v_or3_b32 v1, v50, v51, v1
    s_waitcnt vmcnt(24)
    v_perm_b32 v44, v91, v90, s24
    v_perm_b32 v46, v92, v91, s25
    v_perm_b32 v48, v93, v92, s26
    v_perm_b32 v50, v110, v93, s27
    v_mov_b32 v12, v90
    v_alignbyte_b32 v13, v92, v91, 1
    v_alignbyte_b32 v14, v93, v92, 2
    v_alignbyte_b32 v15, v110, v93, 3
    v_lshlrev_b32_sdwa v44, 3, v44 dst_sel:WORD_0 dst_unused:UNUSED_PAD src0_sel:DWORD src1_sel:DWORD
    v_lshlrev_b32_sdwa v46, 3, v46 dst_sel:WORD_0 dst_unused:UNUSED_PAD src0_sel:DWORD src1_sel:DWORD
    v_lshlrev_b32_sdwa v48, 3, v48 dst_sel:WORD_0 dst_unused:UNUSED_PAD src0_sel:DWORD src1_sel:DWORD
    v_lshlrev_b32_sdwa v50, 3, v50 dst_sel:WORD_0 dst_unused:UNUSED_PAD src0_sel:DWORD src1_sel:DWORD
    s_cmp_lt_i32 s42, 1280
    s_cbranch_scc1 L_ufix_70
L_uback_71:

    s_movk_i32 s53, 5120
    buffer_load_dwordx4 v[90:93], v2, s[16:19], s53 offen
    buffer_load_dword v110, v2, s[16:19], s53 offen offset:16
    s_waitcnt lgkmcnt(4)
    s_barrier
    v_subrev_co_u32 v12, s[80:81], 2.0, v12
    v_subrev_co_u32 v13, s[82:83], 2.0, v13
    v_subrev_co_u32 v14, s[84:85], 2.0, v14
    v_subrev_co_u32 v15, s[86:87], 2.0, v15
    s_mov_b64 exec, s[80:81]
    ds_read_b64 v[44:45], v44
    s_mov_b64 exec, s[82:83]
    ds_read_b64 v[46:47], v46
    s_mov_b64 exec, s[84:85]
    ds_read_b64 v[48:49], v48
    s_mov_b64 exec, s[86:87]
    ds_read_b64 v[50:51], v50
    s_mov_b64 exec, -1
    v_mad_i32_i16 v120, v60, v20, s96
    v_mad_i32_i16 v60, v60, v20, s96 op_sel:[1,0,0,0]
    v_mad_i32_i16 v121, v61, v20, s96
    v_mad_i32_i16 v61, v61, v20, s96 op_sel:[1,0,0,0]
    v_lshlrev_b32_sdwa v20, 3, v20 dst_sel:DWORD dst_unused:UNUSED_PAD src0_sel:DWORD src1_sel:WORD_1
    v_perm_b32 v60, v60, v120, s97
    v_perm_b32 v61, v61, v121, s97
    v_lshl_add_u64 v[60:61], v[60:61], 0, s[30:31]

    ds_add_rtn_u64 v[60:61], v20, v[60:61] offset:50000
    v_mad_i32_i16 v122, v62, v21, s96
    v_mad_i32_i16 v62, v62, v21, s96 op_sel:[1,0,0,0]
    v_mad_i32_i16 v123, v63, v21, s96
    v_mad_i32_i16 v63, v63, v21, s96 op_sel:[1,0,0,0]
    v_lshlrev_b32_sdwa v21, 3, v21 dst_sel:DWORD dst_unused:UNUSED_PAD src0_sel:DWORD src1_sel:WORD_1
    v_perm_b32 v62, v62, v122, s97
    v_perm_b32 v63, v63, v123, s97
    v_lshl_add_u64 v[62:63], v[62:63], 0, s[30:31]

    ds_add_rtn_u64 v[62:63], v21, v[62:63] offset:50000
    v_mad_i32_i16 v124, v64, v22, s96
    v_mad_i32_i16 v64, v64, v22, s96 op_sel:[1,0,0,0]
    v_mad_i32_i16 v125, v65, v22, s96
    v_mad_i32_i16 v65, v65, v22, s96 op_sel:[1,0,0,0]
    v_lshlrev_b32_sdwa v22, 3, v22 dst_sel:DWORD dst_unused:UNUSED_PAD src0_sel:DWORD src1_sel:WORD_1
    v_perm_b32 v64, v64, v124, s97
    v_perm_b32 v65, v65, v125, s97
    v_lshl_add_u64 v[64:65], v[64:65], 0, s[30:31]

    ds_add_rtn_u64 v[64:65], v22, v[64:65] offset:50000
    v_mad_i32_i16 v126, v66, v23, s96
    v_mad_i32_i16 v66, v66, v23, s96 op_sel:[1,0,0,0]
    v_mad_i32_i16 v127, v67, v23, s96
    v_mad_i32_i16 v67, v67, v23, s96 op_sel:[1,0,0,0]
    v_lshlrev_b32_sdwa v23, 3, v23 dst_sel:DWORD dst_unused:UNUSED_PAD src0_sel:DWORD src1_sel:WORD_1
    v_perm_b32 v66, v66, v126, s97
    v_perm_b32 v67, v67, v127, s97
    v_lshl_add_u64 v[66:67], v[66:67], 0, s[30:31]

    ds_add_rtn_u64 v[66:67], v23, v[66:67] offset:50000
    s_waitcnt lgkmcnt(8)
    v_or3_b32 v1, v52, v53, v1
    v_or3_b32 v1, v54, v55, v1
    v_or3_b32 v1, v56, v57, v1
    v_or3_b32 v1, v58, v59, v1
    s_waitcnt vmcnt(24)
    v_perm_b32 v52, v95, v94, s24
    v_perm_b32 v54, v96, v95, s25
    v_perm_b32 v56, v97, v96, s26
    v_perm_b32 v58, v111, v97, s27
    v_mov_b32 v16, v94
    v_alignbyte_b32 v17, v96, v95, 1
    v_alignbyte_b32 v18, v97, v96, 2
    v_alignbyte_b32 v19, v111, v97, 3
    v_lshlrev_b32_sdwa v52, 3, v52 dst_sel:WORD_0 dst_unused:UNUSED_PAD src0_sel:DWORD src1_sel:DWORD
    v_lshlrev_b32_sdwa v54, 3, v54 dst_sel:WORD_0 dst_unused:UNUSED_PAD src0_sel:DWORD src1_sel:DWORD
    v_lshlrev_b32_sdwa v56, 3, v56 dst_sel:WORD_0 dst_unused:UNUSED_PAD src0_sel:DWORD src1_sel:DWORD
    v_lshlrev_b32_sdwa v58, 3, v58 dst_sel:WORD_0 dst_unused:UNUSED_PAD src0_sel:DWORD src1_sel:DWORD
    s_cmp_lt_i32 s42, 1792
    s_cbranch_scc1 L_ufix_72
L_uback_73:

    v_subrev_co_u32 v16, s[64:65], 2.0, v16
    v_subrev_co_u32 v17, s[66:67], 2.0, v17
    v_subrev_co_u32 v18, s[68:69], 2.0, v18
    v_subrev_co_u32 v19, s[70:71], 2.0, v19
    s_mov_b64 exec, s[64:65]
    ds_read_b64 v[52:53], v52
    s_mov_b64 exec, s[66:67]
    ds_read_b64 v[54:55], v54
    s_mov_b64 exec, s[68:69]
    ds_read_b64 v[56:57], v56
    s_mov_b64 exec, s[70:71]
    ds_read_b64 v[58:59], v58
    s_mov_b64 exec, -1
    v_mad_i32_i16 v120, v68, v24, s96
    v_mad_i32_i16 v68, v68, v24, s96 op_sel:[1,0,0,0]
    v_mad_i32_i16 v121, v69, v24, s96
    v_mad_i32_i16 v69, v69, v24, s96 op_sel:[1,0,0,0]
    v_lshlrev_b32_sdwa v24, 3, v24 dst_sel:DWORD dst_unused:UNUSED_PAD src0_sel:DWORD src1_sel:WORD_1
    v_perm_b32 v68, v68, v120, s97
    v_perm_b32 v69, v69, v121, s97
    v_lshl_add_u64 v[68:69], v[68:69], 0, s[30:31]

    ds_add_rtn_u64 v[68:69], v24, v[68:69] offset:50000
    v_mad_i32_i16 v122, v70, v25, s96
    v_mad_i32_i16 v70, v70, v25, s96 op_sel:[1,0,0,0]
    v_mad_i32_i16 v123, v71, v25, s96
    v_mad_i32_i16 v71, v71, v25, s96 op_sel:[1,0,0,0]
    v_lshlrev_b32_sdwa v25, 3, v25 dst_sel:DWORD dst_unused:UNUSED_PAD src0_sel:DWORD src1_sel:WORD_1
    v_perm_b32 v70, v70, v122, s97
    v_perm_b32 v71, v71, v123, s97
    v_lshl_add_u64 v[70:71], v[70:71], 0, s[30:31]

    ds_add_rtn_u64 v[70:71], v25, v[70:71] offset:50000
    v_mad_i32_i16 v124, v72, v26, s96
    v_mad_i32_i16 v72, v72, v26, s96 op_sel:[1,0,0,0]
    v_mad_i32_i16 v125, v73, v26, s96
    v_mad_i32_i16 v73, v73, v26, s96 op_sel:[1,0,0,0]
    v_lshlrev_b32_sdwa v26, 3, v26 dst_sel:DWORD dst_unused:UNUSED_PAD src0_sel:DWORD src1_sel:WORD_1
    v_perm_b32 v72, v72, v124, s97
    v_perm_b32 v73, v73, v125, s97
    v_lshl_add_u64 v[72:73], v[72:73], 0, s[30:31]

    ds_add_rtn_u64 v[72:73], v26, v[72:73] offset:50000
    v_mad_i32_i16 v126, v74, v27, s96
    v_mad_i32_i16 v74, v74, v27, s96 op_sel:[1,0,0,0]
    v_mad_i32_i16 v127, v75, v27, s96
    v_mad_i32_i16 v75, v75, v27, s96 op_sel:[1,0,0,0]
    v_lshlrev_b32_sdwa v27, 3, v27 dst_sel:DWORD dst_unused:UNUSED_PAD src0_sel:DWORD src1_sel:WORD_1
    v_perm_b32 v74, v74, v126, s97
    v_perm_b32 v75, v75, v127, s97
    v_lshl_add_u64 v[74:75], v[74:75], 0, s[30:31]

    ds_add_rtn_u64 v[74:75], v27, v[74:75] offset:50000
    s_waitcnt lgkmcnt(8)
    v_or3_b32 v1, v60, v61, v1
    v_or3_b32 v1, v62, v63, v1
    v_or3_b32 v1, v64, v65, v1
    v_or3_b32 v1, v66, v67, v1
    s_waitcnt vmcnt(14)
    v_perm_b32 v60, v99, v98, s24
    v_perm_b32 v62, v100, v99, s25
    v_perm_b32 v64, v101, v100, s26
    v_perm_b32 v66, v112, v101, s27
    v_mov_b32 v20, v98
    v_alignbyte_b32 v21, v100, v99, 1
    v_alignbyte_b32 v22, v101, v100, 2
    v_alignbyte_b32 v23, v112, v101, 3
    v_lshlrev_b32_sdwa v60, 3, v60 dst_sel:WORD_0 dst_unused:UNUSED_PAD src0_sel:DWORD src1_sel:DWORD
    v_lshlrev_b32_sdwa v62, 3, v62 dst_sel:WORD_0 dst_unused:UNUSED_PAD src0_sel:DWORD src1_sel:DWORD
    v_lshlrev_b32_sdwa v64, 3, v64 dst_sel:WORD_0 dst_unused:UNUSED_PAD src0_sel:DWORD src1_sel:DWORD
    v_lshlrev_b32_sdwa v66, 3, v66 dst_sel:WORD_0 dst_unused:UNUSED_PAD src0_sel:DWORD src1_sel:DWORD
    s_cmp_lt_i32 s42, 2304
    s_cbranch_scc1 L_ufix_74
L_uback_75:

    v_subrev_co_u32 v20, s[72:73], 2.0, v20
    v_subrev_co_u32 v21, s[74:75], 2.0, v21
    v_subrev_co_u32 v22, s[76:77], 2.0, v22
    v_subrev_co_u32 v23, s[78:79], 2.0, v23
    s_mov_b64 exec, s[72:73]
    ds_read_b64 v[60:61], v60
    s_mov_b64 exec, s[74:75]
    ds_read_b64 v[62:63], v62
    s_mov_b64 exec, s[76:77]
    ds_read_b64 v[64:65], v64
    s_mov_b64 exec, s[78:79]
    ds_read_b64 v[66:67], v66
    s_mov_b64 exec, -1
    s_waitcnt lgkmcnt(4)
    v_or3_b32 v1, v68, v69, v1
    v_or3_b32 v1, v70, v71, v1
    v_or3_b32 v1, v72, v73, v1
    v_or3_b32 v1, v74, v75, v1
    s_waitcnt vmcnt(12)
    v_perm_b32 v68, v103, v102, s24
    v_perm_b32 v70, v104, v103, s25
    v_perm_b32 v72, v105, v104, s26
    v_perm_b32 v74, v113, v105, s27
    v_mov_b32 v24, v102
    v_alignbyte_b32 v25, v104, v103, 1
    v_alignbyte_b32 v26, v105, v104, 2
    v_alignbyte_b32 v27, v113, v105, 3
    v_lshlrev_b32_sdwa v68, 3, v68 dst_sel:WORD_0 dst_unused:UNUSED_PAD src0_sel:DWORD src1_sel:DWORD
    v_lshlrev_b32_sdwa v70, 3, v70 dst_sel:WORD_0 dst_unused:UNUSED_PAD src0_sel:DWORD src1_sel:DWORD
    v_lshlrev_b32_sdwa v72, 3, v72 dst_sel:WORD_0 dst_unused:UNUSED_PAD src0_sel:DWORD src1_sel:DWORD
    v_lshlrev_b32_sdwa v74, 3, v74 dst_sel:WORD_0 dst_unused:UNUSED_PAD src0_sel:DWORD src1_sel:DWORD
    s_cmp_lt_i32 s42, 2816
    s_cbranch_scc1 L_ufix_76
L_uback_77:

    v_subrev_co_u32 v24, s[80:81], 2.0, v24
    v_subrev_co_u32 v25, s[82:83], 2.0, v25
    v_subrev_co_u32 v26, s[84:85], 2.0, v26
    v_subrev_co_u32 v27, s[86:87], 2.0, v27
    s_mov_b64 exec, s[80:81]
    ds_read_b64 v[68:69], v68
    s_mov_b64 exec, s[82:83]
    ds_read_b64 v[70:71], v70
    s_mov_b64 exec, s[84:85]
    ds_read_b64 v[72:73], v72
    s_mov_b64 exec, s[86:87]
    ds_read_b64 v[74:75], v74
    s_mov_b64 exec, -1
    buffer_load_dwordx4 v[76:79], v3, s[12:15], s43 offen
    s_add_u32 s52, s43, 16384
    buffer_load_dwordx4 v[80:83], v3, s[12:15], s52 offen
    s_add_u32 s52, s43, 32768
    buffer_load_dwordx4 v[84:87], v3, s[12:15], s52 offen
    s_add_u32 s52, s43, 49152
    v_lshlrev_b32 v119, 2, v0
    buffer_load_dword v88, v119, s[12:15], s52 offen
    s_add_u32 s54, s43, 50048
    buffer_load_dword v115, v89, s[60:63], s54 offen
    s_add_u32 s54, s50, 200000
    buffer_load_dword v115, v89, s[8:11], s54 offen
    s_waitcnt vmcnt(10)
    v_perm_b32 v28, v5, v4, s24
    v_perm_b32 v30, v6, v5, s25
    v_perm_b32 v32, v7, v6, s26
    v_perm_b32 v34, v35, v7, s27
    v_alignbyte_b32 v5, v6, v5, 1
    v_alignbyte_b32 v6, v7, v6, 2
    v_alignbyte_b32 v7, v35, v7, 3
    v_lshlrev_b32_sdwa v28, 3, v28 dst_sel:WORD_0 dst_unused:UNUSED_PAD src0_sel:DWORD src1_sel:DWORD
    v_lshlrev_b32_sdwa v30, 3, v30 dst_sel:WORD_0 dst_unused:UNUSED_PAD src0_sel:DWORD src1_sel:DWORD
    v_lshlrev_b32_sdwa v32, 3, v32 dst_sel:WORD_0 dst_unused:UNUSED_PAD src0_sel:DWORD src1_sel:DWORD
    v_lshlrev_b32_sdwa v34, 3, v34 dst_sel:WORD_0 dst_unused:UNUSED_PAD src0_sel:DWORD src1_sel:DWORD
    s_cmp_lt_i32 s42, 256
    s_cbranch_scc1 L_ufix_78
L_uback_79:

    v_subrev_co_u32 v4, s[64:65], 2.0, v4
    v_subrev_co_u32 v5, s[66:67], 2.0, v5
    v_subrev_co_u32 v6, s[68:69], 2.0, v6
    v_subrev_co_u32 v7, s[70:71], 2.0, v7
    s_mov_b64 exec, s[64:65]
    ds_read_b64 v[28:29], v28
    s_mov_b64 exec, s[66:67]
    ds_read_b64 v[30:31], v30
    s_mov_b64 exec, s[68:69]
    ds_read_b64 v[32:33], v32
    s_mov_b64 exec, s[70:71]
    ds_read_b64 v[34:35], v34
    s_mov_b64 exec, -1
    s_waitcnt vmcnt(8)
    v_perm_b32 v36, v9, v8, s24
    v_perm_b32 v38, v10, v9, s25
    v_perm_b32 v40, v11, v10, s26
    v_perm_b32 v42, v43, v11, s27
    v_alignbyte_b32 v9, v10, v9, 1
    v_alignbyte_b32 v10, v11, v10, 2
    v_alignbyte_b32 v11, v43, v11, 3
    v_lshlrev_b32_sdwa v36, 3, v36 dst_sel:WORD_0 dst_unused:UNUSED_PAD src0_sel:DWORD src1_sel:DWORD
    v_lshlrev_b32_sdwa v38, 3, v38 dst_sel:WORD_0 dst_unused:UNUSED_PAD src0_sel:DWORD src1_sel:DWORD
    v_lshlrev_b32_sdwa v40, 3, v40 dst_sel:WORD_0 dst_unused:UNUSED_PAD src0_sel:DWORD src1_sel:DWORD
    v_lshlrev_b32_sdwa v42, 3, v42 dst_sel:WORD_0 dst_unused:UNUSED_PAD src0_sel:DWORD src1_sel:DWORD
    s_cmp_lt_i32 s42, 768
    s_cbranch_scc1 L_ufix_80
L_uback_81:

    v_subrev_co_u32 v8, s[72:73], 2.0, v8
    v_subrev_co_u32 v9, s[74:75], 2.0, v9
    v_subrev_co_u32 v10, s[76:77], 2.0, v10
    v_subrev_co_u32 v11, s[78:79], 2.0, v11
    s_mov_b64 exec, s[72:73]
    ds_read_b64 v[36:37], v36
    s_mov_b64 exec, s[74:75]
    ds_read_b64 v[38:39], v38
    s_mov_b64 exec, s[76:77]
    ds_read_b64 v[40:41], v40
    s_mov_b64 exec, s[78:79]
    ds_read_b64 v[42:43], v42
    s_mov_b64 exec, -1
    s_mov_b32 s38, s5
    s_add_u32 s50, s50, 200000
    s_branch L_batch_61
L_bend_62:

    s_waitcnt vmcnt(0)
    s_load_dwordx2 s[68:69], s[0:1], 24
    s_load_dwordx4 s[88:91], s[0:1], 72
    s_load_dwordx2 s[76:77], s[0:1], 88
    s_load_dwordx2 s[80:81], s[0:1], 96
    s_mov_b32 s70, 1600000
    s_mov_b32 s71, 0x20000
    s_mov_b32 s78, 6400000
    s_mov_b32 s79, 0x20000
    s_movk_i32 s82, 256
    s_mov_b32 s83, 0x20000
    s_lshl_b32 s48, s36, 2
    s_mov_b32 s41, s37

    s_add_u32 s84, s6, 8896512
    s_addc_u32 s85, s7, 0
    s_mov_b32 s86, 76800000
    s_mov_b32 s87, 0x20000
    s_add_u32 s72, s6, 393216
    s_addc_u32 s73, s7, 0
    s_mov_b32 s74, 2097152
    s_mov_b32 s75, 0x20000
    s_waitcnt lgkmcnt(15)
    v_mad_i32_i16 v120, v28, v4, s96
    v_mad_i32_i16 v28, v28, v4, s96 op_sel:[1,0,0,0]
    v_mad_i32_i16 v121, v29, v4, s96
    v_mad_i32_i16 v29, v29, v4, s96 op_sel:[1,0,0,0]
    v_lshlrev_b32_sdwa v4, 3, v4 dst_sel:DWORD dst_unused:UNUSED_PAD src0_sel:DWORD src1_sel:WORD_1
    v_perm_b32 v28, v28, v120, s97
    v_perm_b32 v29, v29, v121, s97
    v_lshl_add_u64 v[28:29], v[28:29], 0, s[30:31]

    ds_add_rtn_u64 v[28:29], v4, v[28:29] offset:50000
    v_mad_i32_i16 v122, v30, v5, s96
    v_mad_i32_i16 v30, v30, v5, s96 op_sel:[1,0,0,0]
    v_mad_i32_i16 v123, v31, v5, s96
    v_mad_i32_i16 v31, v31, v5, s96 op_sel:[1,0,0,0]
    v_lshlrev_b32_sdwa v5, 3, v5 dst_sel:DWORD dst_unused:UNUSED_PAD src0_sel:DWORD src1_sel:WORD_1
    v_perm_b32 v30, v30, v122, s97
    v_perm_b32 v31, v31, v123, s97
    v_lshl_add_u64 v[30:31], v[30:31], 0, s[30:31]

    ds_add_rtn_u64 v[30:31], v5, v[30:31] offset:50000
    v_mad_i32_i16 v124, v32, v6, s96
    v_mad_i32_i16 v32, v32, v6, s96 op_sel:[1,0,0,0]
    v_mad_i32_i16 v125, v33, v6, s96
    v_mad_i32_i16 v33, v33, v6, s96 op_sel:[1,0,0,0]
    v_lshlrev_b32_sdwa v6, 3, v6 dst_sel:DWORD dst_unused:UNUSED_PAD src0_sel:DWORD src1_sel:WORD_1
    v_perm_b32 v32, v32, v124, s97
    v_perm_b32 v33, v33, v125, s97
    v_lshl_add_u64 v[32:33], v[32:33], 0, s[30:31]

    ds_add_rtn_u64 v[32:33], v6, v[32:33] offset:50000
    v_mad_i32_i16 v126, v34, v7, s96
    v_mad_i32_i16 v34, v34, v7, s96 op_sel:[1,0,0,0]
    v_mad_i32_i16 v127, v35, v7, s96
    v_mad_i32_i16 v35, v35, v7, s96 op_sel:[1,0,0,0]
    v_lshlrev_b32_sdwa v7, 3, v7 dst_sel:DWORD dst_unused:UNUSED_PAD src0_sel:DWORD src1_sel:WORD_1
    v_perm_b32 v34, v34, v126, s97
    v_perm_b32 v35, v35, v127, s97
    v_lshl_add_u64 v[34:35], v[34:35], 0, s[30:31]

    ds_add_rtn_u64 v[34:35], v7, v[34:35] offset:50000
    s_waitcnt lgkmcnt(0)
    s_load_dwordx8 s[12:19], s[88:89], 0
    s_load_dwordx8 s[56:63], s[90:91], 0

    s_mul_i32 s28, s41, 3125
    s_add_u32 s29, s28, 3126
    s_add_u32 s28, s28, 1
    s_lshr_b32 s28, s28, 1
    s_lshr_b32 s29, s29, 1
    s_sub_u32 s29, s29, s28
    s_sub_u32 s5, s29, 782
    s_mul_i32 s3, s36, 6250
    v_add_u32 v78, s28, v0
    v_mov_b32 v82, 0x2000000
    v_add_u32 v79, 782, v78
    v_cmp_gt_u32 vcc, 782, v0
    v_add_u32 v76, s3, v78
    v_add_u32 v77, s3, v79
    v_cndmask_b32 v76, v82, v76, vcc
    v_cmp_gt_u32 vcc, s5, v0
    v_lshlrev_b32 v78, 4, v78
    v_lshlrev_b32 v79, 4, v79
    v_cndmask_b32 v77, v82, v77, vcc
    v_lshlrev_b32 v80, 2, v76
    v_lshlrev_b32 v76, 4, v76
    v_lshlrev_b32 v81, 2, v77
    v_lshlrev_b32 v77, 4, v77
    buffer_load_dword v80, v80, s[68:71], 0 offen
    buffer_load_dword v81, v81, s[68:71], 0 offen
    buffer_load_dwordx4 v[86:89], v76, s[8:11], 0 offen
    buffer_load_dwordx4 v[90:93], v77, s[8:11], 0 offen

    v_mad_i32_i16 v120, v36, v8, s96
    v_mad_i32_i16 v36, v36, v8, s96 op_sel:[1,0,0,0]
    v_mad_i32_i16 v121, v37, v8, s96
    v_mad_i32_i16 v37, v37, v8, s96 op_sel:[1,0,0,0]
    v_lshlrev_b32_sdwa v8, 3, v8 dst_sel:DWORD dst_unused:UNUSED_PAD src0_sel:DWORD src1_sel:WORD_1
    v_perm_b32 v36, v36, v120, s97
    v_perm_b32 v37, v37, v121, s97
    v_lshl_add_u64 v[36:37], v[36:37], 0, s[30:31]

    ds_add_rtn_u64 v[36:37], v8, v[36:37] offset:50000
    v_mad_i32_i16 v122, v38, v9, s96
    v_mad_i32_i16 v38, v38, v9, s96 op_sel:[1,0,0,0]
    v_mad_i32_i16 v123, v39, v9, s96
    v_mad_i32_i16 v39, v39, v9, s96 op_sel:[1,0,0,0]
    v_lshlrev_b32_sdwa v9, 3, v9 dst_sel:DWORD dst_unused:UNUSED_PAD src0_sel:DWORD src1_sel:WORD_1
    v_perm_b32 v38, v38, v122, s97
    v_perm_b32 v39, v39, v123, s97
    v_lshl_add_u64 v[38:39], v[38:39], 0, s[30:31]

    ds_add_rtn_u64 v[38:39], v9, v[38:39] offset:50000
    v_mad_i32_i16 v124, v40, v10, s96
    v_mad_i32_i16 v40, v40, v10, s96 op_sel:[1,0,0,0]
    v_mad_i32_i16 v125, v41, v10, s96
    v_mad_i32_i16 v41, v41, v10, s96 op_sel:[1,0,0,0]
    v_lshlrev_b32_sdwa v10, 3, v10 dst_sel:DWORD dst_unused:UNUSED_PAD src0_sel:DWORD src1_sel:WORD_1
    v_perm_b32 v40, v40, v124, s97
    v_perm_b32 v41, v41, v125, s97
    v_lshl_add_u64 v[40:41], v[40:41], 0, s[30:31]

    ds_add_rtn_u64 v[40:41], v10, v[40:41] offset:50000
    v_mad_i32_i16 v126, v42, v11, s96
    v_mad_i32_i16 v42, v42, v11, s96 op_sel:[1,0,0,0]
    v_mad_i32_i16 v127, v43, v11, s96
    v_mad_i32_i16 v43, v43, v11, s96 op_sel:[1,0,0,0]
    v_lshlrev_b32_sdwa v11, 3, v11 dst_sel:DWORD dst_unused:UNUSED_PAD src0_sel:DWORD src1_sel:WORD_1
    v_perm_b32 v42, v42, v126, s97
    v_perm_b32 v43, v43, v127, s97
    v_lshl_add_u64 v[42:43], v[42:43], 0, s[30:31]

    ds_add_rtn_u64 v[42:43], v11, v[42:43] offset:50000
    v_or3_b32 v1, v28, v29, v1
    v_or3_b32 v1, v30, v31, v1
    v_or3_b32 v1, v32, v33, v1
    v_or3_b32 v1, v34, v35, v1
    v_mad_i32_i16 v120, v44, v12, s96
    v_mad_i32_i16 v44, v44, v12, s96 op_sel:[1,0,0,0]
    v_mad_i32_i16 v121, v45, v12, s96
    v_mad_i32_i16 v45, v45, v12, s96 op_sel:[1,0,0,0]
    v_lshlrev_b32_sdwa v12, 3, v12 dst_sel:DWORD dst_unused:UNUSED_PAD src0_sel:DWORD src1_sel:WORD_1
    v_perm_b32 v44, v44, v120, s97
    v_perm_b32 v45, v45, v121, s97
    v_lshl_add_u64 v[44:45], v[44:45], 0, s[30:31]

    ds_add_rtn_u64 v[44:45], v12, v[44:45] offset:50000
    v_mad_i32_i16 v122, v46, v13, s96
    v_mad_i32_i16 v46, v46, v13, s96 op_sel:[1,0,0,0]
    v_mad_i32_i16 v123, v47, v13, s96
    v_mad_i32_i16 v47, v47, v13, s96 op_sel:[1,0,0,0]
    v_lshlrev_b32_sdwa v13, 3, v13 dst_sel:DWORD dst_unused:UNUSED_PAD src0_sel:DWORD src1_sel:WORD_1
    v_perm_b32 v46, v46, v122, s97
    v_perm_b32 v47, v47, v123, s97
    v_lshl_add_u64 v[46:47], v[46:47], 0, s[30:31]

    ds_add_rtn_u64 v[46:47], v13, v[46:47] offset:50000
    v_mad_i32_i16 v124, v48, v14, s96
    v_mad_i32_i16 v48, v48, v14, s96 op_sel:[1,0,0,0]
    v_mad_i32_i16 v125, v49, v14, s96
    v_mad_i32_i16 v49, v49, v14, s96 op_sel:[1,0,0,0]
    v_lshlrev_b32_sdwa v14, 3, v14 dst_sel:DWORD dst_unused:UNUSED_PAD src0_sel:DWORD src1_sel:WORD_1
    v_perm_b32 v48, v48, v124, s97
    v_perm_b32 v49, v49, v125, s97
    v_lshl_add_u64 v[48:49], v[48:49], 0, s[30:31]

    ds_add_rtn_u64 v[48:49], v14, v[48:49] offset:50000
    v_mad_i32_i16 v126, v50, v15, s96
    v_mad_i32_i16 v50, v50, v15, s96 op_sel:[1,0,0,0]
    v_mad_i32_i16 v127, v51, v15, s96
    v_mad_i32_i16 v51, v51, v15, s96 op_sel:[1,0,0,0]
    v_lshlrev_b32_sdwa v15, 3, v15 dst_sel:DWORD dst_unused:UNUSED_PAD src0_sel:DWORD src1_sel:WORD_1
    v_perm_b32 v50, v50, v126, s97
    v_perm_b32 v51, v51, v127, s97
    v_lshl_add_u64 v[50:51], v[50:51], 0, s[30:31]

    ds_add_rtn_u64 v[50:51], v15, v[50:51] offset:50000
    s_waitcnt lgkmcnt(4)
    v_or3_b32 v1, v36, v37, v1
    v_or3_b32 v1, v38, v39, v1
    v_or3_b32 v1, v40, v41, v1
    v_or3_b32 v1, v42, v43, v1
    v_mad_i32_i16 v120, v52, v16, s96
    v_mad_i32_i16 v52, v52, v16, s96 op_sel:[1,0,0,0]
    v_mad_i32_i16 v121, v53, v16, s96
    v_mad_i32_i16 v53, v53, v16, s96 op_sel:[1,0,0,0]
    v_lshlrev_b32_sdwa v16, 3, v16 dst_sel:DWORD dst_unused:UNUSED_PAD src0_sel:DWORD src1_sel:WORD_1
    v_perm_b32 v52, v52, v120, s97
    v_perm_b32 v53, v53, v121, s97
    v_lshl_add_u64 v[52:53], v[52:53], 0, s[30:31]

    ds_add_rtn_u64 v[52:53], v16, v[52:53] offset:50000
    v_mad_i32_i16 v122, v54, v17, s96
    v_mad_i32_i16 v54, v54, v17, s96 op_sel:[1,0,0,0]
    v_mad_i32_i16 v123, v55, v17, s96
    v_mad_i32_i16 v55, v55, v17, s96 op_sel:[1,0,0,0]
    v_lshlrev_b32_sdwa v17, 3, v17 dst_sel:DWORD dst_unused:UNUSED_PAD src0_sel:DWORD src1_sel:WORD_1
    v_perm_b32 v54, v54, v122, s97
    v_perm_b32 v55, v55, v123, s97
    v_lshl_add_u64 v[54:55], v[54:55], 0, s[30:31]

    ds_add_rtn_u64 v[54:55], v17, v[54:55] offset:50000
    v_mad_i32_i16 v124, v56, v18, s96
    v_mad_i32_i16 v56, v56, v18, s96 op_sel:[1,0,0,0]
    v_mad_i32_i16 v125, v57, v18, s96
    v_mad_i32_i16 v57, v57, v18, s96 op_sel:[1,0,0,0]
    v_lshlrev_b32_sdwa v18, 3, v18 dst_sel:DWORD dst_unused:UNUSED_PAD src0_sel:DWORD src1_sel:WORD_1
    v_perm_b32 v56, v56, v124, s97
    v_perm_b32 v57, v57, v125, s97
    v_lshl_add_u64 v[56:57], v[56:57], 0, s[30:31]

    ds_add_rtn_u64 v[56:57], v18, v[56:57] offset:50000
    v_mad_i32_i16 v126, v58, v19, s96
    v_mad_i32_i16 v58, v58, v19, s96 op_sel:[1,0,0,0]
    v_mad_i32_i16 v127, v59, v19, s96
    v_mad_i32_i16 v59, v59, v19, s96 op_sel:[1,0,0,0]
    v_lshlrev_b32_sdwa v19, 3, v19 dst_sel:DWORD dst_unused:UNUSED_PAD src0_sel:DWORD src1_sel:WORD_1
    v_perm_b32 v58, v58, v126, s97
    v_perm_b32 v59, v59, v127, s97
    v_lshl_add_u64 v[58:59], v[58:59], 0, s[30:31]

    ds_add_rtn_u64 v[58:59], v19, v[58:59] offset:50000
    s_waitcnt lgkmcnt(4)
    v_or3_b32 v1, v44, v45, v1
    v_or3_b32 v1, v46, v47, v1
    v_or3_b32 v1, v48, v49, v1
    v_or3_b32 v1, v50, v51, v1
    s_waitcnt vmcnt(2)
    v_lshlrev_b32_sdwa v82, 5, v80 dst_sel:DWORD dst_unused:UNUSED_PAD src0_sel:DWORD src1_sel:WORD_0
    v_lshlrev_b32_sdwa v83, 5, v80 dst_sel:DWORD dst_unused:UNUSED_PAD src0_sel:DWORD src1_sel:WORD_1
    v_lshlrev_b32_sdwa v84, 5, v81 dst_sel:DWORD dst_unused:UNUSED_PAD src0_sel:DWORD src1_sel:WORD_0
    v_lshlrev_b32_sdwa v85, 5, v81 dst_sel:DWORD dst_unused:UNUSED_PAD src0_sel:DWORD src1_sel:WORD_1
    buffer_load_dwordx4 v[94:97], v82, s[72:75], 0 offen
    buffer_load_dwordx2 v[110:111], v82, s[72:75], 0 offen offset:16

    buffer_load_dwordx4 v[98:101], v83, s[72:75], 0 offen
    buffer_load_dwordx2 v[112:113], v83, s[72:75], 0 offen offset:16

    buffer_load_dwordx4 v[102:105], v84, s[72:75], 0 offen
    buffer_load_dwordx2 v[114:115], v84, s[72:75], 0 offen offset:16

    buffer_load_dwordx4 v[106:109], v85, s[72:75], 0 offen
    buffer_load_dwordx2 v[116:117], v85, s[72:75], 0 offen offset:16

    v_mad_i32_i16 v120, v60, v20, s96
    v_mad_i32_i16 v60, v60, v20, s96 op_sel:[1,0,0,0]
    v_mad_i32_i16 v121, v61, v20, s96
    v_mad_i32_i16 v61, v61, v20, s96 op_sel:[1,0,0,0]
    v_lshlrev_b32_sdwa v20, 3, v20 dst_sel:DWORD dst_unused:UNUSED_PAD src0_sel:DWORD src1_sel:WORD_1
    v_perm_b32 v60, v60, v120, s97
    v_perm_b32 v61, v61, v121, s97
    v_lshl_add_u64 v[60:61], v[60:61], 0, s[30:31]

    ds_add_rtn_u64 v[60:61], v20, v[60:61] offset:50000
    v_mad_i32_i16 v122, v62, v21, s96
    v_mad_i32_i16 v62, v62, v21, s96 op_sel:[1,0,0,0]
    v_mad_i32_i16 v123, v63, v21, s96
    v_mad_i32_i16 v63, v63, v21, s96 op_sel:[1,0,0,0]
    v_lshlrev_b32_sdwa v21, 3, v21 dst_sel:DWORD dst_unused:UNUSED_PAD src0_sel:DWORD src1_sel:WORD_1
    v_perm_b32 v62, v62, v122, s97
    v_perm_b32 v63, v63, v123, s97
    v_lshl_add_u64 v[62:63], v[62:63], 0, s[30:31]

    ds_add_rtn_u64 v[62:63], v21, v[62:63] offset:50000
    v_mad_i32_i16 v124, v64, v22, s96
    v_mad_i32_i16 v64, v64, v22, s96 op_sel:[1,0,0,0]
    v_mad_i32_i16 v125, v65, v22, s96
    v_mad_i32_i16 v65, v65, v22, s96 op_sel:[1,0,0,0]
    v_lshlrev_b32_sdwa v22, 3, v22 dst_sel:DWORD dst_unused:UNUSED_PAD src0_sel:DWORD src1_sel:WORD_1
    v_perm_b32 v64, v64, v124, s97
    v_perm_b32 v65, v65, v125, s97
    v_lshl_add_u64 v[64:65], v[64:65], 0, s[30:31]

    ds_add_rtn_u64 v[64:65], v22, v[64:65] offset:50000
    v_mad_i32_i16 v126, v66, v23, s96
    v_mad_i32_i16 v66, v66, v23, s96 op_sel:[1,0,0,0]
    v_mad_i32_i16 v127, v67, v23, s96
    v_mad_i32_i16 v67, v67, v23, s96 op_sel:[1,0,0,0]
    v_lshlrev_b32_sdwa v23, 3, v23 dst_sel:DWORD dst_unused:UNUSED_PAD src0_sel:DWORD src1_sel:WORD_1
    v_perm_b32 v66, v66, v126, s97
    v_perm_b32 v67, v67, v127, s97
    v_lshl_add_u64 v[66:67], v[66:67], 0, s[30:31]

    ds_add_rtn_u64 v[66:67], v23, v[66:67] offset:50000
    s_waitcnt lgkmcnt(4)
    v_or3_b32 v1, v52, v53, v1
    v_or3_b32 v1, v54, v55, v1
    v_or3_b32 v1, v56, v57, v1
    v_or3_b32 v1, v58, v59, v1
    v_mad_i32_i16 v120, v68, v24, s96
    v_mad_i32_i16 v68, v68, v24, s96 op_sel:[1,0,0,0]
    v_mad_i32_i16 v121, v69, v24, s96
    v_mad_i32_i16 v69, v69, v24, s96 op_sel:[1,0,0,0]
    v_lshlrev_b32_sdwa v24, 3, v24 dst_sel:DWORD dst_unused:UNUSED_PAD src0_sel:DWORD src1_sel:WORD_1
    v_perm_b32 v68, v68, v120, s97
    v_perm_b32 v69, v69, v121, s97
    v_lshl_add_u64 v[68:69], v[68:69], 0, s[30:31]

    ds_add_rtn_u64 v[68:69], v24, v[68:69] offset:50000
    v_mad_i32_i16 v122, v70, v25, s96
    v_mad_i32_i16 v70, v70, v25, s96 op_sel:[1,0,0,0]
    v_mad_i32_i16 v123, v71, v25, s96
    v_mad_i32_i16 v71, v71, v25, s96 op_sel:[1,0,0,0]
    v_lshlrev_b32_sdwa v25, 3, v25 dst_sel:DWORD dst_unused:UNUSED_PAD src0_sel:DWORD src1_sel:WORD_1
    v_perm_b32 v70, v70, v122, s97
    v_perm_b32 v71, v71, v123, s97
    v_lshl_add_u64 v[70:71], v[70:71], 0, s[30:31]

    ds_add_rtn_u64 v[70:71], v25, v[70:71] offset:50000
    v_mad_i32_i16 v124, v72, v26, s96
    v_mad_i32_i16 v72, v72, v26, s96 op_sel:[1,0,0,0]
    v_mad_i32_i16 v125, v73, v26, s96
    v_mad_i32_i16 v73, v73, v26, s96 op_sel:[1,0,0,0]
    v_lshlrev_b32_sdwa v26, 3, v26 dst_sel:DWORD dst_unused:UNUSED_PAD src0_sel:DWORD src1_sel:WORD_1
    v_perm_b32 v72, v72, v124, s97
    v_perm_b32 v73, v73, v125, s97
    v_lshl_add_u64 v[72:73], v[72:73], 0, s[30:31]

    ds_add_rtn_u64 v[72:73], v26, v[72:73] offset:50000
    v_mad_i32_i16 v126, v74, v27, s96
    v_mad_i32_i16 v74, v74, v27, s96 op_sel:[1,0,0,0]
    v_mad_i32_i16 v127, v75, v27, s96
    v_mad_i32_i16 v75, v75, v27, s96 op_sel:[1,0,0,0]
    v_lshlrev_b32_sdwa v27, 3, v27 dst_sel:DWORD dst_unused:UNUSED_PAD src0_sel:DWORD src1_sel:WORD_1
    v_perm_b32 v74, v74, v126, s97
    v_perm_b32 v75, v75, v127, s97
    v_lshl_add_u64 v[74:75], v[74:75], 0, s[30:31]

    ds_add_rtn_u64 v[74:75], v27, v[74:75] offset:50000
    s_waitcnt lgkmcnt(4)
    v_or3_b32 v1, v60, v61, v1
    v_or3_b32 v1, v62, v63, v1
    v_or3_b32 v1, v64, v65, v1
    v_or3_b32 v1, v66, v67, v1
    s_waitcnt lgkmcnt(0)
    v_or3_b32 v1, v68, v69, v1
    v_or3_b32 v1, v70, v71, v1
    v_or3_b32 v1, v72, v73, v1
    v_or3_b32 v1, v74, v75, v1
    s_barrier

    v_add_u32 v40, 50000, v3
    v_add_u32 v41, 115536, v3
    v_cmp_gt_u32 vcc, 106, v0

    v_mov_b32 v28, 0
    v_mov_b32 v29, 0
    v_mov_b32 v30, 0
    v_mov_b32 v31, 0
    ds_read_b128 v[4:7], v40 offset:0
    ds_read_b128 v[8:11], v40 offset:16384
    ds_read_b128 v[12:15], v40 offset:32768
    ds_read_b128 v[16:19], v40 offset:49152
    ds_read_b128 v[20:23], v41 offset:0
    ds_read_b128 v[24:27], v41 offset:16384
    s_mov_b64 exec, vcc
    ds_read_b128 v[28:31], v41 offset:32768
    s_mov_b64 exec, -1
    s_mul_i32 s3, s37, 6400000
    s_mul_i32 s5, s36, 100000
    s_add_u32 s3, s3, s5
    s_add_u32 s3, s3, 8896512
    v_bfrev_b32 v42, 1

    s_add_u32 s20, s6, s3
    s_addc_u32 s21, s7, 0
    s_mov_b32 s22, 100000
    s_mov_b32 s23, 0x20000
    s_sub_u32 s3, 0, s28
    v_add_u32 v43, s3, v0
    v_cmp_gt_u32 vcc, s29, v43
    s_mov_b32 s3, 0
    s_waitcnt lgkmcnt(6)
    v_cndmask_b32 v43, v3, v42, vcc
    buffer_store_dwordx4 v[4:7], v43, s[20:23], s3 offen sc1

    s_sub_u32 s3, 1024, s28
    v_add_u32 v43, s3, v0
    v_cmp_gt_u32 vcc, s29, v43
    s_mov_b32 s3, 16384
    s_waitcnt lgkmcnt(5)
    v_cndmask_b32 v43, v3, v42, vcc
    buffer_store_dwordx4 v[8:11], v43, s[20:23], s3 offen sc1

    s_sub_u32 s3, 2048, s28
    v_add_u32 v43, s3, v0
    v_cmp_gt_u32 vcc, s29, v43
    s_mov_b32 s3, 32768
    s_waitcnt lgkmcnt(4)
    v_cndmask_b32 v43, v3, v42, vcc
    buffer_store_dwordx4 v[12:15], v43, s[20:23], s3 offen sc1

    s_sub_u32 s3, 3072, s28
    v_add_u32 v43, s3, v0
    v_cmp_gt_u32 vcc, s29, v43
    s_mov_b32 s3, 49152
    s_waitcnt lgkmcnt(3)
    v_cndmask_b32 v43, v3, v42, vcc
    buffer_store_dwordx4 v[16:19], v43, s[20:23], s3 offen sc1

    s_sub_u32 s3, 4096, s28
    v_add_u32 v43, s3, v0
    v_cmp_gt_u32 vcc, s29, v43
    s_mov_b32 s3, 65536
    s_waitcnt lgkmcnt(2)
    v_cndmask_b32 v43, v3, v42, vcc
    buffer_store_dwordx4 v[20:23], v43, s[20:23], s3 offen sc1

    s_sub_u32 s3, 5120, s28
    v_add_u32 v43, s3, v0
    v_cmp_gt_u32 vcc, s29, v43
    s_mov_b32 s3, 81920
    s_waitcnt lgkmcnt(1)
    v_cndmask_b32 v43, v3, v42, vcc
    buffer_store_dwordx4 v[24:27], v43, s[20:23], s3 offen sc1

    s_sub_u32 s3, 6144, s28
    v_add_u32 v43, s3, v0
    v_cmp_gt_u32 vcc, s29, v43
    s_mov_b32 s3, 98304
    s_waitcnt lgkmcnt(0)
    v_cndmask_b32 v43, v3, v42, vcc
    buffer_store_dwordx4 v[28:31], v43, s[20:23], s3 offen sc1

    v_or3_b32 v1, v4, v5, v1
    v_or3_b32 v1, v6, v7, v1
    v_or3_b32 v1, v8, v9, v1
    v_or3_b32 v1, v10, v11, v1
    v_or3_b32 v1, v12, v13, v1
    v_or3_b32 v1, v14, v15, v1
    v_or3_b32 v1, v16, v17, v1
    v_or3_b32 v1, v18, v19, v1
    v_or3_b32 v1, v20, v21, v1
    v_or3_b32 v1, v22, v23, v1
    v_or3_b32 v1, v24, v25, v1
    v_or3_b32 v1, v26, v27, v1
    v_or3_b32 v1, v28, v29, v1
    v_or3_b32 v1, v30, v31, v1
    v_and_b32 v1, 0x80008000, v1
    v_cmp_ne_u32 vcc, 0, v1
    v_mov_b32 v40, 150024
    v_mov_b32 v41, 1
    s_cbranch_vccz L_nf_82
    ds_write_b32 v40, v41
L_nf_82:
    s_mov_b32 s33, 1
    s_mov_b32 s49, s37
    s_waitcnt vmcnt(0) lgkmcnt(0)

    s_barrier
    ds_read_b32 v41, v40
    s_waitcnt lgkmcnt(0)
    v_readfirstlane_b32 s3, v41
    s_nop 1
    s_cmp_lg_u32 s3, 0
    s_cbranch_scc1 L_p2slow_48

L_meet_84:
    v_readfirstlane_b32 s3, v0
    v_mov_b32 v118, 150016
    s_nop 0
    s_cmp_eq_u32 s3, 960
    s_cbranch_scc1 L_sync_91
L_bcast_86:
    s_barrier

    ds_read_b32 v119, v118
    s_waitcnt lgkmcnt(0)
    v_readfirstlane_b32 s35, v119
    s_nop 1
    s_bitcmp1_b32 s35, 16
    s_cbranch_scc1 L_fend_92
L_post_88:
    v_cmp_gt_u32 vcc, 782, v0
    s_mov_b64 exec, vcc
    s_cbranch_execz L_postend_89

    s_cmp_eq_u32 s49, 0
    s_cbranch_scc1 L_own_98
    s_mov_b32 s3, 0
    buffer_load_dwordx4 v[36:39], v76, s[84:87], s3 offen sc1
    buffer_load_dwordx4 v[52:55], v77, s[84:87], s3 offen sc1
L_obk_99:
    s_cmp_eq_u32 s49, 1
    s_cbranch_scc1 L_own_100
    s_mov_b32 s3, 6400000
    buffer_load_dwordx4 v[40:43], v76, s[84:87], s3 offen sc1
    buffer_load_dwordx4 v[56:59], v77, s[84:87], s3 offen sc1
L_obk_101:
    s_cmp_eq_u32 s49, 2
    s_cbranch_scc1 L_own_102
    s_mov_b32 s3, 12800000
    buffer_load_dwordx4 v[44:47], v76, s[84:87], s3 offen sc1
    buffer_load_dwordx4 v[60:63], v77, s[84:87], s3 offen sc1
L_obk_103:
    s_cmp_eq_u32 s49, 3
    s_cbranch_scc1 L_own_104
    s_mov_b32 s3, 19200000
    buffer_load_dwordx4 v[48:51], v76, s[84:87], s3 offen sc1
    buffer_load_dwordx4 v[64:67], v77, s[84:87], s3 offen sc1
L_obk_105:
    s_and_b32 s3, s35, 0xf0
    s_waitcnt vmcnt(0) lgkmcnt(0)
    s_cbranch_scc1 L_fgen_106

    v_add_u32 v36, v36, v40
    v_add_u32 v44, v44, v48
    v_add_u32 v37, v37, v41
    v_add_u32 v45, v45, v49
    v_add_u32 v38, v38, v42
    v_add_u32 v46, v46, v50
    v_add_u32 v39, v39, v43
    v_add_u32 v47, v47, v51
    v_add_u32_sdwa v4, v36, v44 dst_sel:DWORD dst_unused:UNUSED_PAD src0_sel:WORD_0 src1_sel:WORD_0
    v_add_u32_sdwa v5, v36, v44 dst_sel:DWORD dst_unused:UNUSED_PAD src0_sel:WORD_1 src1_sel:WORD_1
    v_add_u32_sdwa v6, v37, v45 dst_sel:DWORD dst_unused:UNUSED_PAD src0_sel:WORD_0 src1_sel:WORD_0
    v_add_u32_sdwa v7, v37, v45 dst_sel:DWORD dst_unused:UNUSED_PAD src0_sel:WORD_1 src1_sel:WORD_1
    v_add_u32_sdwa v8, v38, v46 dst_sel:DWORD dst_unused:UNUSED_PAD src0_sel:WORD_0 src1_sel:WORD_0
    v_add_u32_sdwa v9, v38, v46 dst_sel:DWORD dst_unused:UNUSED_PAD src0_sel:WORD_1 src1_sel:WORD_1
    v_add_u32_sdwa v10, v39, v47 dst_sel:DWORD dst_unused:UNUSED_PAD src0_sel:WORD_0 src1_sel:WORD_0
    v_add_u32_sdwa v11, v39, v47 dst_sel:DWORD dst_unused:UNUSED_PAD src0_sel:WORD_1 src1_sel:WORD_1
    v_add_u32 v52, v52, v56
    v_add_u32 v60, v60, v64
    v_add_u32 v53, v53, v57
    v_add_u32 v61, v61, v65
    v_add_u32 v54, v54, v58
    v_add_u32 v62, v62, v66
    v_add_u32 v55, v55, v59
    v_add_u32 v63, v63, v67
    v_add_u32_sdwa v12, v52, v60 dst_sel:DWORD dst_unused:UNUSED_PAD src0_sel:WORD_0 src1_sel:WORD_0
    v_add_u32_sdwa v13, v52, v60 dst_sel:DWORD dst_unused:UNUSED_PAD src0_sel:WORD_1 src1_sel:WORD_1
    v_add_u32_sdwa v14, v53, v61 dst_sel:DWORD dst_unused:UNUSED_PAD src0_sel:WORD_0 src1_sel:WORD_0
    v_add_u32_sdwa v15, v53, v61 dst_sel:DWORD dst_unused:UNUSED_PAD src0_sel:WORD_1 src1_sel:WORD_1
    v_add_u32_sdwa v16, v54, v62 dst_sel:DWORD dst_unused:UNUSED_PAD src0_sel:WORD_0 src1_sel:WORD_0
    v_add_u32_sdwa v17, v54, v62 dst_sel:DWORD dst_unused:UNUSED_PAD src0_sel:WORD_1 src1_sel:WORD_1
    v_add_u32_sdwa v18, v55, v63 dst_sel:DWORD dst_unused:UNUSED_PAD src0_sel:WORD_0 src1_sel:WORD_0
    v_add_u32_sdwa v19, v55, v63 dst_sel:DWORD dst_unused:UNUSED_PAD src0_sel:WORD_1 src1_sel:WORD_1
    v_add_u32 v4, 0xffff0000, v4
    v_add_u32 v5, 0xffff0000, v5
    v_add_u32 v6, 0xffff0000, v6
    v_add_u32 v7, 0xffff0000, v7
    v_add_u32 v8, 0xffff0000, v8
    v_add_u32 v9, 0xffff0000, v9
    v_add_u32 v10, 0xffff0000, v10
    v_add_u32 v11, 0xffff0000, v11
    v_add_u32 v12, 0xffff0000, v12
    v_add_u32 v13, 0xffff0000, v13
    v_add_u32 v14, 0xffff0000, v14
    v_add_u32 v15, 0xffff0000, v15
    v_add_u32 v16, 0xffff0000, v16
    v_add_u32 v17, 0xffff0000, v17
    v_add_u32 v18, 0xffff0000, v18
    v_add_u32 v19, 0xffff0000, v19
    v_cvt_f32_i32 v4, v4
    v_cvt_f32_i32 v5, v5
    v_cvt_f32_i32 v6, v6
    v_cvt_f32_i32 v7, v7
    v_cvt_f32_i32 v8, v8
    v_cvt_f32_i32 v9, v9
    v_cvt_f32_i32 v10, v10
    v_cvt_f32_i32 v11, v11
    v_cvt_f32_i32 v12, v12
    v_cvt_f32_i32 v13, v13
    v_cvt_f32_i32 v14, v14
    v_cvt_f32_i32 v15, v15
    v_cvt_f32_i32 v16, v16
    v_cvt_f32_i32 v17, v17
    v_cvt_f32_i32 v18, v18
    v_cvt_f32_i32 v19, v19
    v_mul_f32 v4, s34, v4
    v_mul_f32 v5, s34, v5
    v_mul_f32 v6, s34, v6
    v_mul_f32 v7, s34, v7
    v_mul_f32 v8, s34, v8
    v_mul_f32 v9, s34, v9
    v_mul_f32 v10, s34, v10
    v_mul_f32 v11, s34, v11
    v_mul_f32 v12, s34, v12
    v_mul_f32 v13, s34, v13
    v_mul_f32 v14, s34, v14
    v_mul_f32 v15, s34, v15
    v_mul_f32 v16, s34, v16
    v_mul_f32 v17, s34, v17
    v_mul_f32 v18, s34, v18
    v_mul_f32 v19, s34, v19
L_fbk_107:
    s_lshl_b32 s52, s12, 16
    v_mul_f32 v20, s52, v4
    v_mul_f32 v24, s52, v8
    v_mul_f32 v28, s52, v12
    v_mul_f32 v32, s52, v16
    s_and_b32 s53, s12, s32
    v_mul_f32 v21, s53, v4
    v_mul_f32 v25, s53, v8
    v_mul_f32 v29, s53, v12
    v_mul_f32 v33, s53, v16
    s_lshl_b32 s52, s13, 16
    v_mul_f32 v22, s52, v4
    v_mul_f32 v26, s52, v8
    v_mul_f32 v30, s52, v12
    v_mul_f32 v34, s52, v16
    s_and_b32 s53, s13, s32
    v_mul_f32 v23, s53, v4
    v_mul_f32 v27, s53, v8
    v_mul_f32 v31, s53, v12
    v_mul_f32 v35, s53, v16
    s_lshl_b32 s52, s14, 16
    v_fmac_f32 v20, s52, v5
    v_fmac_f32 v24, s52, v9
    v_fmac_f32 v28, s52, v13
    v_fmac_f32 v32, s52, v17
    s_and_b32 s53, s14, s32
    v_fmac_f32 v21, s53, v5
    v_fmac_f32 v25, s53, v9
    v_fmac_f32 v29, s53, v13
    v_fmac_f32 v33, s53, v17
    s_lshl_b32 s52, s15, 16
    v_fmac_f32 v22, s52, v5
    v_fmac_f32 v26, s52, v9
    v_fmac_f32 v30, s52, v13
    v_fmac_f32 v34, s52, v17
    s_and_b32 s53, s15, s32
    v_fmac_f32 v23, s53, v5
    v_fmac_f32 v27, s53, v9
    v_fmac_f32 v31, s53, v13
    v_fmac_f32 v35, s53, v17
    s_lshl_b32 s52, s16, 16
    v_fmac_f32 v20, s52, v6
    v_fmac_f32 v24, s52, v10
    v_fmac_f32 v28, s52, v14
    v_fmac_f32 v32, s52, v18
    s_and_b32 s53, s16, s32
    v_fmac_f32 v21, s53, v6
    v_fmac_f32 v25, s53, v10
    v_fmac_f32 v29, s53, v14
    v_fmac_f32 v33, s53, v18
    s_lshl_b32 s52, s17, 16
    v_fmac_f32 v22, s52, v6
    v_fmac_f32 v26, s52, v10
    v_fmac_f32 v30, s52, v14
    v_fmac_f32 v34, s52, v18
    s_and_b32 s53, s17, s32
    v_fmac_f32 v23, s53, v6
    v_fmac_f32 v27, s53, v10
    v_fmac_f32 v31, s53, v14
    v_fmac_f32 v35, s53, v18
    s_lshl_b32 s52, s18, 16
    v_fmac_f32 v20, s52, v7
    v_fmac_f32 v24, s52, v11
    v_fmac_f32 v28, s52, v15
    v_fmac_f32 v32, s52, v19
    s_and_b32 s53, s18, s32
    v_fmac_f32 v21, s53, v7
    v_fmac_f32 v25, s53, v11
    v_fmac_f32 v29, s53, v15
    v_fmac_f32 v33, s53, v19
    s_lshl_b32 s52, s19, 16
    v_fmac_f32 v22, s52, v7
    v_fmac_f32 v26, s52, v11
    v_fmac_f32 v30, s52, v15
    v_fmac_f32 v34, s52, v19
    s_and_b32 s53, s19, s32
    v_fmac_f32 v23, s53, v7
    v_fmac_f32 v27, s53, v11
    v_fmac_f32 v31, s53, v15
    v_fmac_f32 v35, s53, v19
    v_mul_f32 v20, v20, v94
    v_mul_f32 v21, v21, v95
    v_mul_f32 v22, v22, v96
    v_mul_f32 v23, v23, v97
    v_mul_f32 v24, v24, v98
    v_mul_f32 v25, v25, v99
    v_mul_f32 v26, v26, v100
    v_mul_f32 v27, v27, v101
    v_mul_f32 v28, v28, v102
    v_mul_f32 v29, v29, v103
    v_mul_f32 v30, v30, v104
    v_mul_f32 v31, v31, v105
    v_mul_f32 v32, v32, v106
    v_mul_f32 v33, v33, v107
    v_mul_f32 v34, v34, v108
    v_mul_f32 v35, v35, v109
    v_cvt_pk_bf16_f32 v20, v20, v21
    v_cvt_pk_bf16_f32 v22, v22, v23
    v_cvt_pk_bf16_f32 v24, v24, v25
    v_cvt_pk_bf16_f32 v26, v26, v27
    v_cvt_pk_bf16_f32 v28, v28, v29
    v_cvt_pk_bf16_f32 v30, v30, v31
    v_cvt_pk_bf16_f32 v32, v32, v33
    v_cvt_pk_bf16_f32 v34, v34, v35
    s_pack_ll_b32_b16 s52, s56, s58
    v_dot2_f32_bf16 v4, v20, s52, 0
    v_dot2_f32_bf16 v8, v24, s52, 0
    v_dot2_f32_bf16 v12, v28, s52, 0
    v_dot2_f32_bf16 v16, v32, s52, 0
    s_pack_hh_b32_b16 s53, s56, s58
    v_dot2_f32_bf16 v5, v20, s53, 0
    v_dot2_f32_bf16 v9, v24, s53, 0
    v_dot2_f32_bf16 v13, v28, s53, 0
    v_dot2_f32_bf16 v17, v32, s53, 0
    s_pack_ll_b32_b16 s52, s57, s59
    v_dot2_f32_bf16 v6, v20, s52, 0
    v_dot2_f32_bf16 v10, v24, s52, 0
    v_dot2_f32_bf16 v14, v28, s52, 0
    v_dot2_f32_bf16 v18, v32, s52, 0
    s_pack_hh_b32_b16 s53, s57, s59
    v_dot2_f32_bf16 v7, v20, s53, 0
    v_dot2_f32_bf16 v11, v24, s53, 0
    v_dot2_f32_bf16 v15, v28, s53, 0
    v_dot2_f32_bf16 v19, v32, s53, 0
    s_pack_ll_b32_b16 s52, s60, s62
    v_dot2_f32_bf16 v4, v22, s52, v4
    v_dot2_f32_bf16 v8, v26, s52, v8
    v_dot2_f32_bf16 v12, v30, s52, v12
    v_dot2_f32_bf16 v16, v34, s52, v16
    s_pack_hh_b32_b16 s53, s60, s62
    v_dot2_f32_bf16 v5, v22, s53, v5
    v_dot2_f32_bf16 v9, v26, s53, v9
    v_dot2_f32_bf16 v13, v30, s53, v13
    v_dot2_f32_bf16 v17, v34, s53, v17
    s_pack_ll_b32_b16 s52, s61, s63
    v_dot2_f32_bf16 v6, v22, s52, v6
    v_dot2_f32_bf16 v10, v26, s52, v10
    v_dot2_f32_bf16 v14, v30, s52, v14
    v_dot2_f32_bf16 v18, v34, s52, v18
    s_pack_hh_b32_b16 s53, s61, s63
    v_dot2_f32_bf16 v7, v22, s53, v7
    v_dot2_f32_bf16 v11, v26, s53, v11
    v_dot2_f32_bf16 v15, v30, s53, v15
    v_dot2_f32_bf16 v19, v34, s53, v19
    v_lshlrev_b32 v36, 16, v86
    v_and_b32 v37, s32, v86
    v_lshlrev_b32 v52, 16, v110
    v_and_b32 v53, s32, v110
    v_lshlrev_b32 v38, 16, v87
    v_and_b32 v39, s32, v87
    v_lshlrev_b32 v54, 16, v111
    v_and_b32 v55, s32, v111
    v_lshlrev_b32 v40, 16, v88
    v_and_b32 v41, s32, v88
    v_lshlrev_b32 v56, 16, v112
    v_and_b32 v57, s32, v112
    v_lshlrev_b32 v42, 16, v89
    v_and_b32 v43, s32, v89
    v_lshlrev_b32 v58, 16, v113
    v_and_b32 v59, s32, v113
    v_lshlrev_b32 v44, 16, v90
    v_and_b32 v45, s32, v90
    v_lshlrev_b32 v60, 16, v114
    v_and_b32 v61, s32, v114
    v_lshlrev_b32 v46, 16, v91
    v_and_b32 v47, s32, v91
    v_lshlrev_b32 v62, 16, v115
    v_and_b32 v63, s32, v115
    v_lshlrev_b32 v48, 16, v92
    v_and_b32 v49, s32, v92
    v_lshlrev_b32 v64, 16, v116
    v_and_b32 v65, s32, v116
    v_lshlrev_b32 v50, 16, v93
    v_and_b32 v51, s32, v93
    v_lshlrev_b32 v66, 16, v117
    v_and_b32 v67, s32, v117
    v_cvt_pk_bf16_f32 v4, v4, v5
    v_cvt_pk_bf16_f32 v6, v6, v7
    v_cvt_pk_bf16_f32 v8, v8, v9
    v_cvt_pk_bf16_f32 v10, v10, v11
    v_cvt_pk_bf16_f32 v12, v12, v13
    v_cvt_pk_bf16_f32 v14, v14, v15
    v_cvt_pk_bf16_f32 v16, v16, v17
    v_cvt_pk_bf16_f32 v18, v18, v19
    v_and_b32 v5, s32, v4
    v_lshlrev_b32 v4, 16, v4
    v_and_b32 v7, s32, v6
    v_lshlrev_b32 v6, 16, v6
    v_and_b32 v9, s32, v8
    v_lshlrev_b32 v8, 16, v8
    v_and_b32 v11, s32, v10
    v_lshlrev_b32 v10, 16, v10
    v_and_b32 v13, s32, v12
    v_lshlrev_b32 v12, 16, v12
    v_and_b32 v15, s32, v14
    v_lshlrev_b32 v14, 16, v14
    v_and_b32 v17, s32, v16
    v_lshlrev_b32 v16, 16, v16
    v_and_b32 v19, s32, v18
    v_lshlrev_b32 v18, 16, v18
    v_mul_f32 v4, v4, v52
    v_mul_f32 v5, v5, v53
    v_mul_f32 v6, v6, v54
    v_mul_f32 v7, v7, v55
    v_mul_f32 v8, v8, v56
    v_mul_f32 v9, v9, v57
    v_mul_f32 v10, v10, v58
    v_mul_f32 v11, v11, v59
    v_mul_f32 v12, v12, v60
    v_mul_f32 v13, v13, v61
    v_mul_f32 v14, v14, v62
    v_mul_f32 v15, v15, v63
    v_mul_f32 v16, v16, v64
    v_mul_f32 v17, v17, v65
    v_mul_f32 v18, v18, v66
    v_mul_f32 v19, v19, v67
    v_cvt_pk_bf16_f32 v4, v4, v5
    v_cvt_pk_bf16_f32 v6, v6, v7
    v_cvt_pk_bf16_f32 v8, v8, v9
    v_cvt_pk_bf16_f32 v10, v10, v11
    v_cvt_pk_bf16_f32 v12, v12, v13
    v_cvt_pk_bf16_f32 v14, v14, v15
    v_cvt_pk_bf16_f32 v16, v16, v17
    v_cvt_pk_bf16_f32 v18, v18, v19
    v_and_b32 v5, s32, v4
    v_lshlrev_b32 v4, 16, v4
    v_and_b32 v7, s32, v6
    v_lshlrev_b32 v6, 16, v6
    v_and_b32 v9, s32, v8
    v_lshlrev_b32 v8, 16, v8
    v_and_b32 v11, s32, v10
    v_lshlrev_b32 v10, 16, v10
    v_and_b32 v13, s32, v12
    v_lshlrev_b32 v12, 16, v12
    v_and_b32 v15, s32, v14
    v_lshlrev_b32 v14, 16, v14
    v_and_b32 v17, s32, v16
    v_lshlrev_b32 v16, 16, v16
    v_and_b32 v19, s32, v18
    v_lshlrev_b32 v18, 16, v18
    v_add_f32 v4, v4, v36
    v_add_f32 v5, v5, v37
    v_add_f32 v6, v6, v38
    v_add_f32 v7, v7, v39
    v_add_f32 v8, v8, v40
    v_add_f32 v9, v9, v41
    v_add_f32 v10, v10, v42
    v_add_f32 v11, v11, v43
    v_add_f32 v12, v12, v44
    v_add_f32 v13, v13, v45
    v_add_f32 v14, v14, v46
    v_add_f32 v15, v15, v47
    v_add_f32 v16, v16, v48
    v_add_f32 v17, v17, v49
    v_add_f32 v18, v18, v50
    v_add_f32 v19, v19, v51
    v_cvt_pk_bf16_f32 v20, v4, v5
    v_cvt_pk_bf16_f32 v21, v6, v7
    v_cvt_pk_bf16_f32 v22, v8, v9
    v_cvt_pk_bf16_f32 v23, v10, v11
    v_cvt_pk_bf16_f32 v24, v12, v13
    v_cvt_pk_bf16_f32 v25, v14, v15
    v_cvt_pk_bf16_f32 v26, v16, v17
    v_cvt_pk_bf16_f32 v27, v18, v19
    buffer_store_dwordx4 v[20:23], v76, s[76:79], 0 offen
    buffer_store_dwordx4 v[24:27], v77, s[76:79], 0 offen
L_postend_89:
    s_mov_b64 exec, -1

    s_bfe_u32 s3, s35, 0x40008
    s_cbranch_scc0 L_fend_92
    s_ff1_i32_b32 s41, s3
    s_add_u32 s3, s41, 8
    s_bitset0_b32 s35, s3
    s_mov_b32 s49, -1

    s_mul_i32 s28, s41, 3125
    s_add_u32 s29, s28, 3126
    s_add_u32 s28, s28, 1
    s_lshr_b32 s28, s28, 1
    s_lshr_b32 s29, s29, 1
    s_sub_u32 s29, s29, s28
    s_sub_u32 s5, s29, 782
    s_mul_i32 s3, s36, 6250
    v_add_u32 v78, s28, v0
    v_mov_b32 v82, 0x2000000
    v_add_u32 v79, 782, v78
    v_cmp_gt_u32 vcc, 782, v0
    v_add_u32 v76, s3, v78
    v_add_u32 v77, s3, v79
    v_cndmask_b32 v76, v82, v76, vcc
    v_cmp_gt_u32 vcc, s5, v0
    v_lshlrev_b32 v78, 4, v78
    v_lshlrev_b32 v79, 4, v79
    v_cndmask_b32 v77, v82, v77, vcc
    v_lshlrev_b32 v80, 2, v76
    v_lshlrev_b32 v76, 4, v76
    v_lshlrev_b32 v81, 2, v77
    v_lshlrev_b32 v77, 4, v77
    buffer_load_dword v80, v80, s[68:71], 0 offen
    buffer_load_dword v81, v81, s[68:71], 0 offen
    buffer_load_dwordx4 v[86:89], v76, s[8:11], 0 offen
    buffer_load_dwordx4 v[90:93], v77, s[8:11], 0 offen

    s_waitcnt vmcnt(2)
    v_lshlrev_b32_sdwa v82, 5, v80 dst_sel:DWORD dst_unused:UNUSED_PAD src0_sel:DWORD src1_sel:WORD_0
    v_lshlrev_b32_sdwa v83, 5, v80 dst_sel:DWORD dst_unused:UNUSED_PAD src0_sel:DWORD src1_sel:WORD_1
    v_lshlrev_b32_sdwa v84, 5, v81 dst_sel:DWORD dst_unused:UNUSED_PAD src0_sel:DWORD src1_sel:WORD_0
    v_lshlrev_b32_sdwa v85, 5, v81 dst_sel:DWORD dst_unused:UNUSED_PAD src0_sel:DWORD src1_sel:WORD_1
    buffer_load_dwordx4 v[94:97], v82, s[72:75], 0 offen
    buffer_load_dwordx2 v[110:111], v82, s[72:75], 0 offen offset:16

    buffer_load_dwordx4 v[98:101], v83, s[72:75], 0 offen
    buffer_load_dwordx2 v[112:113], v83, s[72:75], 0 offen offset:16

    buffer_load_dwordx4 v[102:105], v84, s[72:75], 0 offen
    buffer_load_dwordx2 v[114:115], v84, s[72:75], 0 offen offset:16

    buffer_load_dwordx4 v[106:109], v85, s[72:75], 0 offen
    buffer_load_dwordx2 v[116:117], v85, s[72:75], 0 offen offset:16

    s_branch L_post_88
L_fin_83:

    s_load_dwordx2 s[68:69], s[0:1], 24
    s_load_dwordx4 s[88:91], s[0:1], 72
    s_load_dwordx2 s[76:77], s[0:1], 88
    s_load_dwordx2 s[80:81], s[0:1], 96
    s_mov_b32 s70, 1600000
    s_mov_b32 s71, 0x20000
    s_mov_b32 s78, 6400000
    s_mov_b32 s79, 0x20000
    s_movk_i32 s82, 256
    s_mov_b32 s83, 0x20000
    s_lshl_b32 s48, s36, 2
    s_mov_b32 s41, s37

    s_add_u32 s84, s6, 8896512
    s_addc_u32 s85, s7, 0
    s_mov_b32 s86, 76800000
    s_mov_b32 s87, 0x20000
    s_add_u32 s72, s6, 393216
    s_addc_u32 s73, s7, 0
    s_mov_b32 s74, 2097152
    s_mov_b32 s75, 0x20000
    s_mov_b32 s49, -1
    s_waitcnt lgkmcnt(0)
    s_load_dwordx8 s[12:19], s[88:89], 0
    s_load_dwordx8 s[56:63], s[90:91], 0

    s_mul_i32 s28, s41, 3125
    s_add_u32 s29, s28, 3126
    s_add_u32 s28, s28, 1
    s_lshr_b32 s28, s28, 1
    s_lshr_b32 s29, s29, 1
    s_sub_u32 s29, s29, s28
    s_sub_u32 s5, s29, 782
    s_mul_i32 s3, s36, 6250
    v_add_u32 v78, s28, v0
    v_mov_b32 v82, 0x2000000
    v_add_u32 v79, 782, v78
    v_cmp_gt_u32 vcc, 782, v0
    v_add_u32 v76, s3, v78
    v_add_u32 v77, s3, v79
    v_cndmask_b32 v76, v82, v76, vcc
    v_cmp_gt_u32 vcc, s5, v0
    v_lshlrev_b32 v78, 4, v78
    v_lshlrev_b32 v79, 4, v79
    v_cndmask_b32 v77, v82, v77, vcc
    v_lshlrev_b32 v80, 2, v76
    v_lshlrev_b32 v76, 4, v76
    v_lshlrev_b32 v81, 2, v77
    v_lshlrev_b32 v77, 4, v77
    buffer_load_dword v80, v80, s[68:71], 0 offen
    buffer_load_dword v81, v81, s[68:71], 0 offen
    buffer_load_dwordx4 v[86:89], v76, s[8:11], 0 offen
    buffer_load_dwordx4 v[90:93], v77, s[8:11], 0 offen

    s_waitcnt vmcnt(2)
    v_lshlrev_b32_sdwa v82, 5, v80 dst_sel:DWORD dst_unused:UNUSED_PAD src0_sel:DWORD src1_sel:WORD_0
    v_lshlrev_b32_sdwa v83, 5, v80 dst_sel:DWORD dst_unused:UNUSED_PAD src0_sel:DWORD src1_sel:WORD_1
    v_lshlrev_b32_sdwa v84, 5, v81 dst_sel:DWORD dst_unused:UNUSED_PAD src0_sel:DWORD src1_sel:WORD_0
    v_lshlrev_b32_sdwa v85, 5, v81 dst_sel:DWORD dst_unused:UNUSED_PAD src0_sel:DWORD src1_sel:WORD_1
    buffer_load_dwordx4 v[94:97], v82, s[72:75], 0 offen
    buffer_load_dwordx2 v[110:111], v82, s[72:75], 0 offen offset:16

    buffer_load_dwordx4 v[98:101], v83, s[72:75], 0 offen
    buffer_load_dwordx2 v[112:113], v83, s[72:75], 0 offen offset:16

    buffer_load_dwordx4 v[102:105], v84, s[72:75], 0 offen
    buffer_load_dwordx2 v[114:115], v84, s[72:75], 0 offen offset:16

    buffer_load_dwordx4 v[106:109], v85, s[72:75], 0 offen
    buffer_load_dwordx2 v[116:117], v85, s[72:75], 0 offen offset:16

    s_waitcnt vmcnt(0) lgkmcnt(0)
    s_barrier
    s_branch L_meet_84
L_fend_92:

L_p2done_47:
    s_endpgm

L_ufix_49:
    v_and_b32 v117, 63, v0
    v_lshlrev_b32 v117, 2, v117
    s_sub_i32 s54, s42, 1024
    v_cmp_le_i32 vcc, s54, v117
    s_mov_b64 exec, vcc
    v_mov_b32 v12, 0
    v_mov_b32 v44, 0
    s_mov_b64 exec, -1
    s_sub_i32 s54, s42, 1025
    v_cmp_le_i32 vcc, s54, v117
    s_mov_b64 exec, vcc
    v_mov_b32 v13, 0
    v_mov_b32 v46, 0
    s_mov_b64 exec, -1
    s_sub_i32 s54, s42, 1026
    v_cmp_le_i32 vcc, s54, v117
    s_mov_b64 exec, vcc
    v_mov_b32 v14, 0
    v_mov_b32 v48, 0
    s_mov_b64 exec, -1
    s_sub_i32 s54, s42, 1027
    v_cmp_le_i32 vcc, s54, v117
    s_mov_b64 exec, vcc
    v_mov_b32 v15, 0
    v_mov_b32 v50, 0
    s_mov_b64 exec, -1
    s_branch L_uback_50
L_ufix_51:
    v_and_b32 v117, 63, v0
    v_lshlrev_b32 v117, 2, v117
    s_sub_i32 s54, s42, 1536
    v_cmp_le_i32 vcc, s54, v117
    s_mov_b64 exec, vcc
    v_mov_b32 v16, 0
    v_mov_b32 v52, 0
    s_mov_b64 exec, -1
    s_sub_i32 s54, s42, 1537
    v_cmp_le_i32 vcc, s54, v117
    s_mov_b64 exec, vcc
    v_mov_b32 v17, 0
    v_mov_b32 v54, 0
    s_mov_b64 exec, -1
    s_sub_i32 s54, s42, 1538
    v_cmp_le_i32 vcc, s54, v117
    s_mov_b64 exec, vcc
    v_mov_b32 v18, 0
    v_mov_b32 v56, 0
    s_mov_b64 exec, -1
    s_sub_i32 s54, s42, 1539
    v_cmp_le_i32 vcc, s54, v117
    s_mov_b64 exec, vcc
    v_mov_b32 v19, 0
    v_mov_b32 v58, 0
    s_mov_b64 exec, -1
    s_branch L_uback_52
L_ufix_53:
    v_and_b32 v117, 63, v0
    v_lshlrev_b32 v117, 2, v117
    s_sub_i32 s54, s42, 2048
    v_cmp_le_i32 vcc, s54, v117
    s_mov_b64 exec, vcc
    v_mov_b32 v20, 0
    v_mov_b32 v60, 0
    s_mov_b64 exec, -1
    s_sub_i32 s54, s42, 2049
    v_cmp_le_i32 vcc, s54, v117
    s_mov_b64 exec, vcc
    v_mov_b32 v21, 0
    v_mov_b32 v62, 0
    s_mov_b64 exec, -1
    s_sub_i32 s54, s42, 2050
    v_cmp_le_i32 vcc, s54, v117
    s_mov_b64 exec, vcc
    v_mov_b32 v22, 0
    v_mov_b32 v64, 0
    s_mov_b64 exec, -1
    s_sub_i32 s54, s42, 2051
    v_cmp_le_i32 vcc, s54, v117
    s_mov_b64 exec, vcc
    v_mov_b32 v23, 0
    v_mov_b32 v66, 0
    s_mov_b64 exec, -1
    s_branch L_uback_54
L_ufix_55:
    v_and_b32 v117, 63, v0
    v_lshlrev_b32 v117, 2, v117
    s_sub_i32 s54, s42, 2560
    v_cmp_le_i32 vcc, s54, v117
    s_mov_b64 exec, vcc
    v_mov_b32 v24, 0
    v_mov_b32 v68, 0
    s_mov_b64 exec, -1
    s_sub_i32 s54, s42, 2561
    v_cmp_le_i32 vcc, s54, v117
    s_mov_b64 exec, vcc
    v_mov_b32 v25, 0
    v_mov_b32 v70, 0
    s_mov_b64 exec, -1
    s_sub_i32 s54, s42, 2562
    v_cmp_le_i32 vcc, s54, v117
    s_mov_b64 exec, vcc
    v_mov_b32 v26, 0
    v_mov_b32 v72, 0
    s_mov_b64 exec, -1
    s_sub_i32 s54, s42, 2563
    v_cmp_le_i32 vcc, s54, v117
    s_mov_b64 exec, vcc
    v_mov_b32 v27, 0
    v_mov_b32 v74, 0
    s_mov_b64 exec, -1
    s_branch L_uback_56
L_ufix_57:
    v_and_b32 v117, 63, v0
    v_lshlrev_b32 v117, 2, v117
    s_sub_i32 s54, s42, 0
    v_cmp_le_i32 vcc, s54, v117
    s_mov_b64 exec, vcc
    v_mov_b32 v4, 0
    v_mov_b32 v28, 0
    s_mov_b64 exec, -1
    s_sub_i32 s54, s42, 1
    v_cmp_le_i32 vcc, s54, v117
    s_mov_b64 exec, vcc
    v_mov_b32 v5, 0
    v_mov_b32 v30, 0
    s_mov_b64 exec, -1
    s_sub_i32 s54, s42, 2
    v_cmp_le_i32 vcc, s54, v117
    s_mov_b64 exec, vcc
    v_mov_b32 v6, 0
    v_mov_b32 v32, 0
    s_mov_b64 exec, -1
    s_sub_i32 s54, s42, 3
    v_cmp_le_i32 vcc, s54, v117
    s_mov_b64 exec, vcc
    v_mov_b32 v7, 0
    v_mov_b32 v34, 0
    s_mov_b64 exec, -1
    s_branch L_uback_58
L_ufix_59:
    v_and_b32 v117, 63, v0
    v_lshlrev_b32 v117, 2, v117
    s_sub_i32 s54, s42, 512
    v_cmp_le_i32 vcc, s54, v117
    s_mov_b64 exec, vcc
    v_mov_b32 v8, 0
    v_mov_b32 v36, 0
    s_mov_b64 exec, -1
    s_sub_i32 s54, s42, 513
    v_cmp_le_i32 vcc, s54, v117
    s_mov_b64 exec, vcc
    v_mov_b32 v9, 0
    v_mov_b32 v38, 0
    s_mov_b64 exec, -1
    s_sub_i32 s54, s42, 514
    v_cmp_le_i32 vcc, s54, v117
    s_mov_b64 exec, vcc
    v_mov_b32 v10, 0
    v_mov_b32 v40, 0
    s_mov_b64 exec, -1
    s_sub_i32 s54, s42, 515
    v_cmp_le_i32 vcc, s54, v117
    s_mov_b64 exec, vcc
    v_mov_b32 v11, 0
    v_mov_b32 v42, 0
    s_mov_b64 exec, -1
    s_branch L_uback_60
L_ufix_66:
    v_and_b32 v117, 63, v0
    v_lshlrev_b32 v117, 2, v117
    s_sub_i32 s54, s42, 3072
    v_cmp_le_i32 vcc, s54, v117
    s_mov_b64 exec, vcc
    v_mov_b32 v106, 0
    v_mov_b32 v120, 0
    s_mov_b64 exec, -1
    s_sub_i32 s54, s42, 3073
    v_cmp_le_i32 vcc, s54, v117
    s_mov_b64 exec, vcc
    v_mov_b32 v107, 0
    v_mov_b32 v122, 0
    s_mov_b64 exec, -1
    s_sub_i32 s54, s42, 3074
    v_cmp_le_i32 vcc, s54, v117
    s_mov_b64 exec, vcc
    v_mov_b32 v108, 0
    v_mov_b32 v124, 0
    s_mov_b64 exec, -1
    s_sub_i32 s54, s42, 3075
    v_cmp_le_i32 vcc, s54, v117
    s_mov_b64 exec, vcc
    v_mov_b32 v109, 0
    v_mov_b32 v126, 0
    s_mov_b64 exec, -1
    s_branch L_uback_67
L_ufix_70:
    v_and_b32 v117, 63, v0
    v_lshlrev_b32 v117, 2, v117
    s_sub_i32 s54, s42, 1024
    v_cmp_le_i32 vcc, s54, v117
    s_mov_b64 exec, vcc
    v_mov_b32 v12, 0
    v_mov_b32 v44, 0
    s_mov_b64 exec, -1
    s_sub_i32 s54, s42, 1025
    v_cmp_le_i32 vcc, s54, v117
    s_mov_b64 exec, vcc
    v_mov_b32 v13, 0
    v_mov_b32 v46, 0
    s_mov_b64 exec, -1
    s_sub_i32 s54, s42, 1026
    v_cmp_le_i32 vcc, s54, v117
    s_mov_b64 exec, vcc
    v_mov_b32 v14, 0
    v_mov_b32 v48, 0
    s_mov_b64 exec, -1
    s_sub_i32 s54, s42, 1027
    v_cmp_le_i32 vcc, s54, v117
    s_mov_b64 exec, vcc
    v_mov_b32 v15, 0
    v_mov_b32 v50, 0
    s_mov_b64 exec, -1
    s_branch L_uback_71
L_ufix_72:
    v_and_b32 v117, 63, v0
    v_lshlrev_b32 v117, 2, v117
    s_sub_i32 s54, s42, 1536
    v_cmp_le_i32 vcc, s54, v117
    s_mov_b64 exec, vcc
    v_mov_b32 v16, 0
    v_mov_b32 v52, 0
    s_mov_b64 exec, -1
    s_sub_i32 s54, s42, 1537
    v_cmp_le_i32 vcc, s54, v117
    s_mov_b64 exec, vcc
    v_mov_b32 v17, 0
    v_mov_b32 v54, 0
    s_mov_b64 exec, -1
    s_sub_i32 s54, s42, 1538
    v_cmp_le_i32 vcc, s54, v117
    s_mov_b64 exec, vcc
    v_mov_b32 v18, 0
    v_mov_b32 v56, 0
    s_mov_b64 exec, -1
    s_sub_i32 s54, s42, 1539
    v_cmp_le_i32 vcc, s54, v117
    s_mov_b64 exec, vcc
    v_mov_b32 v19, 0
    v_mov_b32 v58, 0
    s_mov_b64 exec, -1
    s_branch L_uback_73
L_ufix_74:
    v_and_b32 v117, 63, v0
    v_lshlrev_b32 v117, 2, v117
    s_sub_i32 s54, s42, 2048
    v_cmp_le_i32 vcc, s54, v117
    s_mov_b64 exec, vcc
    v_mov_b32 v20, 0
    v_mov_b32 v60, 0
    s_mov_b64 exec, -1
    s_sub_i32 s54, s42, 2049
    v_cmp_le_i32 vcc, s54, v117
    s_mov_b64 exec, vcc
    v_mov_b32 v21, 0
    v_mov_b32 v62, 0
    s_mov_b64 exec, -1
    s_sub_i32 s54, s42, 2050
    v_cmp_le_i32 vcc, s54, v117
    s_mov_b64 exec, vcc
    v_mov_b32 v22, 0
    v_mov_b32 v64, 0
    s_mov_b64 exec, -1
    s_sub_i32 s54, s42, 2051
    v_cmp_le_i32 vcc, s54, v117
    s_mov_b64 exec, vcc
    v_mov_b32 v23, 0
    v_mov_b32 v66, 0
    s_mov_b64 exec, -1
    s_branch L_uback_75
L_ufix_76:
    v_and_b32 v117, 63, v0
    v_lshlrev_b32 v117, 2, v117
    s_sub_i32 s54, s42, 2560
    v_cmp_le_i32 vcc, s54, v117
    s_mov_b64 exec, vcc
    v_mov_b32 v24, 0
    v_mov_b32 v68, 0
    s_mov_b64 exec, -1
    s_sub_i32 s54, s42, 2561
    v_cmp_le_i32 vcc, s54, v117
    s_mov_b64 exec, vcc
    v_mov_b32 v25, 0
    v_mov_b32 v70, 0
    s_mov_b64 exec, -1
    s_sub_i32 s54, s42, 2562
    v_cmp_le_i32 vcc, s54, v117
    s_mov_b64 exec, vcc
    v_mov_b32 v26, 0
    v_mov_b32 v72, 0
    s_mov_b64 exec, -1
    s_sub_i32 s54, s42, 2563
    v_cmp_le_i32 vcc, s54, v117
    s_mov_b64 exec, vcc
    v_mov_b32 v27, 0
    v_mov_b32 v74, 0
    s_mov_b64 exec, -1
    s_branch L_uback_77
L_ufix_78:
    v_and_b32 v117, 63, v0
    v_lshlrev_b32 v117, 2, v117
    s_sub_i32 s54, s42, 0
    v_cmp_le_i32 vcc, s54, v117
    s_mov_b64 exec, vcc
    v_mov_b32 v4, 0
    v_mov_b32 v28, 0
    s_mov_b64 exec, -1
    s_sub_i32 s54, s42, 1
    v_cmp_le_i32 vcc, s54, v117
    s_mov_b64 exec, vcc
    v_mov_b32 v5, 0
    v_mov_b32 v30, 0
    s_mov_b64 exec, -1
    s_sub_i32 s54, s42, 2
    v_cmp_le_i32 vcc, s54, v117
    s_mov_b64 exec, vcc
    v_mov_b32 v6, 0
    v_mov_b32 v32, 0
    s_mov_b64 exec, -1
    s_sub_i32 s54, s42, 3
    v_cmp_le_i32 vcc, s54, v117
    s_mov_b64 exec, vcc
    v_mov_b32 v7, 0
    v_mov_b32 v34, 0
    s_mov_b64 exec, -1
    s_branch L_uback_79
L_ufix_80:
    v_and_b32 v117, 63, v0
    v_lshlrev_b32 v117, 2, v117
    s_sub_i32 s54, s42, 512
    v_cmp_le_i32 vcc, s54, v117
    s_mov_b64 exec, vcc
    v_mov_b32 v8, 0
    v_mov_b32 v36, 0
    s_mov_b64 exec, -1
    s_sub_i32 s54, s42, 513
    v_cmp_le_i32 vcc, s54, v117
    s_mov_b64 exec, vcc
    v_mov_b32 v9, 0
    v_mov_b32 v38, 0
    s_mov_b64 exec, -1
    s_sub_i32 s54, s42, 514
    v_cmp_le_i32 vcc, s54, v117
    s_mov_b64 exec, vcc
    v_mov_b32 v10, 0
    v_mov_b32 v40, 0
    s_mov_b64 exec, -1
    s_sub_i32 s54, s42, 515
    v_cmp_le_i32 vcc, s54, v117
    s_mov_b64 exec, vcc
    v_mov_b32 v11, 0
    v_mov_b32 v42, 0
    s_mov_b64 exec, -1
    s_branch L_uback_81
L_sync_91:
    v_and_b32 v40, 63, v0
    v_lshlrev_b32 v41, 20, v40
    v_mov_b32 v42, s33
    buffer_atomic_add v42, v41, s[80:83], s48 offen sc0
    s_waitcnt vmcnt(0)
    v_readfirstlane_b32 s4, v42
    s_movk_i32 s5, 400
    s_nop 0
    s_add_u32 s4, s4, s33
    s_bitcmp1_b32 s4, 2
    s_cbranch_scc1 L_tell_95
L_poll_93:
    s_sub_u32 s5, s5, 1
    s_cbranch_scc1 L_gave_94
    v_mov_b32 v42, 0
    buffer_atomic_add v42, v41, s[80:83], s48 offen sc0
    s_waitcnt vmcnt(0)
    v_readfirstlane_b32 s4, v42
    s_nop 1
    s_and_b32 s4, s4, 0xff
    s_bitcmp0_b32 s4, 2
    s_cbranch_scc1 L_poll_93
    s_branch L_tell_95
L_gave_94:
    s_cmp_lg_u32 s49, s37
    s_cbranch_scc1 L_gno_97
    v_add_lshl_u32 v40, v40, s28, 4
    s_mov_b32 s5, 0
L_gl_96:
    v_min_u32 v43, 100000, v40
    ds_read_b128 v[44:47], v43 offset:50000
    s_waitcnt lgkmcnt(0)
    buffer_store_dwordx4 v[44:47], v40, s[20:23], 0 offen sc1
    s_waitcnt vmcnt(0)
    v_add_u32 v40, 1024, v40
    s_add_u32 s5, s5, 64
    s_cmp_lt_u32 s5, s29
    s_cbranch_scc1 L_gl_96
L_gno_97:
    s_lshl_b32 s4, 0x100, s37
    v_mov_b32 v42, s4
    buffer_atomic_or v42, v41, s[80:83], s48 offen sc0
    s_waitcnt vmcnt(0)
    v_readfirstlane_b32 s4, v42
    s_nop 1
    s_and_b32 s4, s4, 0xff
    s_bitcmp1_b32 s4, 2
    s_cselect_b32 s4, s4, 0x10000
L_tell_95:
    v_mov_b32 v42, s4
    ds_write_b32 v118, v42
    s_waitcnt lgkmcnt(0)
    s_branch L_bcast_86

L_own_98:
    ds_read_b128 v[36:39], v78 offset:50000
    ds_read_b128 v[52:55], v79 offset:50000
    s_branch L_obk_99

L_own_100:
    ds_read_b128 v[40:43], v78 offset:50000
    ds_read_b128 v[56:59], v79 offset:50000
    s_branch L_obk_101

L_own_102:
    ds_read_b128 v[44:47], v78 offset:50000
    ds_read_b128 v[60:63], v79 offset:50000
    s_branch L_obk_103

L_own_104:
    ds_read_b128 v[48:51], v78 offset:50000
    ds_read_b128 v[64:67], v79 offset:50000
    s_branch L_obk_105

L_fgen_106:
    v_lshlrev_b32 v82, 1, v76
    v_lshlrev_b32 v83, 1, v77
    v_mov_b32 v4, 0
    v_mov_b32 v5, 0
    v_mov_b32 v6, 0
    v_mov_b32 v7, 0
    v_mov_b32 v8, 0
    v_mov_b32 v9, 0
    v_mov_b32 v10, 0
    v_mov_b32 v11, 0
    v_mov_b32 v12, 0
    v_mov_b32 v13, 0
    v_mov_b32 v14, 0
    v_mov_b32 v15, 0
    v_mov_b32 v16, 0
    v_mov_b32 v17, 0
    v_mov_b32 v18, 0
    v_mov_b32 v19, 0
    s_bitcmp1_b32 s35, 4
    s_cbranch_scc1 L_ffl_108
    v_cvt_f32_u32_sdwa v20, v36 dst_sel:DWORD dst_unused:UNUSED_PAD src0_sel:WORD_0
    v_cvt_f32_u32_sdwa v21, v36 dst_sel:DWORD dst_unused:UNUSED_PAD src0_sel:WORD_1
    v_cvt_f32_u32_sdwa v22, v37 dst_sel:DWORD dst_unused:UNUSED_PAD src0_sel:WORD_0
    v_cvt_f32_u32_sdwa v23, v37 dst_sel:DWORD dst_unused:UNUSED_PAD src0_sel:WORD_1
    v_cvt_f32_u32_sdwa v24, v38 dst_sel:DWORD dst_unused:UNUSED_PAD src0_sel:WORD_0
    v_cvt_f32_u32_sdwa v25, v38 dst_sel:DWORD dst_unused:UNUSED_PAD src0_sel:WORD_1
    v_cvt_f32_u32_sdwa v26, v39 dst_sel:DWORD dst_unused:UNUSED_PAD src0_sel:WORD_0
    v_cvt_f32_u32_sdwa v27, v39 dst_sel:DWORD dst_unused:UNUSED_PAD src0_sel:WORD_1
    v_cvt_f32_u32_sdwa v28, v52 dst_sel:DWORD dst_unused:UNUSED_PAD src0_sel:WORD_0
    v_cvt_f32_u32_sdwa v29, v52 dst_sel:DWORD dst_unused:UNUSED_PAD src0_sel:WORD_1
    v_cvt_f32_u32_sdwa v30, v53 dst_sel:DWORD dst_unused:UNUSED_PAD src0_sel:WORD_0
    v_cvt_f32_u32_sdwa v31, v53 dst_sel:DWORD dst_unused:UNUSED_PAD src0_sel:WORD_1
    v_cvt_f32_u32_sdwa v32, v54 dst_sel:DWORD dst_unused:UNUSED_PAD src0_sel:WORD_0
    v_cvt_f32_u32_sdwa v33, v54 dst_sel:DWORD dst_unused:UNUSED_PAD src0_sel:WORD_1
    v_cvt_f32_u32_sdwa v34, v55 dst_sel:DWORD dst_unused:UNUSED_PAD src0_sel:WORD_0
    v_cvt_f32_u32_sdwa v35, v55 dst_sel:DWORD dst_unused:UNUSED_PAD src0_sel:WORD_1
    v_add_f32 v20, 0xc6800000, v20
    v_fmac_f32 v4, s34, v20
    v_add_f32 v21, 0xc6800000, v21
    v_fmac_f32 v5, s34, v21
    v_add_f32 v22, 0xc6800000, v22
    v_fmac_f32 v6, s34, v22
    v_add_f32 v23, 0xc6800000, v23
    v_fmac_f32 v7, s34, v23
    v_add_f32 v24, 0xc6800000, v24
    v_fmac_f32 v8, s34, v24
    v_add_f32 v25, 0xc6800000, v25
    v_fmac_f32 v9, s34, v25
    v_add_f32 v26, 0xc6800000, v26
    v_fmac_f32 v10, s34, v26
    v_add_f32 v27, 0xc6800000, v27
    v_fmac_f32 v11, s34, v27
    v_add_f32 v28, 0xc6800000, v28
    v_fmac_f32 v12, s34, v28
    v_add_f32 v29, 0xc6800000, v29
    v_fmac_f32 v13, s34, v29
    v_add_f32 v30, 0xc6800000, v30
    v_fmac_f32 v14, s34, v30
    v_add_f32 v31, 0xc6800000, v31
    v_fmac_f32 v15, s34, v31
    v_add_f32 v32, 0xc6800000, v32
    v_fmac_f32 v16, s34, v32
    v_add_f32 v33, 0xc6800000, v33
    v_fmac_f32 v17, s34, v33
    v_add_f32 v34, 0xc6800000, v34
    v_fmac_f32 v18, s34, v34
    v_add_f32 v35, 0xc6800000, v35
    v_fmac_f32 v19, s34, v35
    s_branch L_fnx_109
L_ffl_108:
    s_mov_b32 s3, 25600000
    buffer_load_dwordx4 v[20:23], v82, s[84:87], s3 offen offset:0 sc1
    buffer_load_dwordx4 v[24:27], v82, s[84:87], s3 offen offset:16 sc1
    buffer_load_dwordx4 v[28:31], v83, s[84:87], s3 offen offset:0 sc1
    buffer_load_dwordx4 v[32:35], v83, s[84:87], s3 offen offset:16 sc1
    s_waitcnt vmcnt(0)
    v_add_f32 v4, v4, v20
    v_add_f32 v5, v5, v21
    v_add_f32 v6, v6, v22
    v_add_f32 v7, v7, v23
    v_add_f32 v8, v8, v24
    v_add_f32 v9, v9, v25
    v_add_f32 v10, v10, v26
    v_add_f32 v11, v11, v27
    v_add_f32 v12, v12, v28
    v_add_f32 v13, v13, v29
    v_add_f32 v14, v14, v30
    v_add_f32 v15, v15, v31
    v_add_f32 v16, v16, v32
    v_add_f32 v17, v17, v33
    v_add_f32 v18, v18, v34
    v_add_f32 v19, v19, v35
L_fnx_109:
    s_bitcmp1_b32 s35, 5
    s_cbranch_scc1 L_ffl_110
    v_cvt_f32_u32_sdwa v20, v40 dst_sel:DWORD dst_unused:UNUSED_PAD src0_sel:WORD_0
    v_cvt_f32_u32_sdwa v21, v40 dst_sel:DWORD dst_unused:UNUSED_PAD src0_sel:WORD_1
    v_cvt_f32_u32_sdwa v22, v41 dst_sel:DWORD dst_unused:UNUSED_PAD src0_sel:WORD_0
    v_cvt_f32_u32_sdwa v23, v41 dst_sel:DWORD dst_unused:UNUSED_PAD src0_sel:WORD_1
    v_cvt_f32_u32_sdwa v24, v42 dst_sel:DWORD dst_unused:UNUSED_PAD src0_sel:WORD_0
    v_cvt_f32_u32_sdwa v25, v42 dst_sel:DWORD dst_unused:UNUSED_PAD src0_sel:WORD_1
    v_cvt_f32_u32_sdwa v26, v43 dst_sel:DWORD dst_unused:UNUSED_PAD src0_sel:WORD_0
    v_cvt_f32_u32_sdwa v27, v43 dst_sel:DWORD dst_unused:UNUSED_PAD src0_sel:WORD_1
    v_cvt_f32_u32_sdwa v28, v56 dst_sel:DWORD dst_unused:UNUSED_PAD src0_sel:WORD_0
    v_cvt_f32_u32_sdwa v29, v56 dst_sel:DWORD dst_unused:UNUSED_PAD src0_sel:WORD_1
    v_cvt_f32_u32_sdwa v30, v57 dst_sel:DWORD dst_unused:UNUSED_PAD src0_sel:WORD_0
    v_cvt_f32_u32_sdwa v31, v57 dst_sel:DWORD dst_unused:UNUSED_PAD src0_sel:WORD_1
    v_cvt_f32_u32_sdwa v32, v58 dst_sel:DWORD dst_unused:UNUSED_PAD src0_sel:WORD_0
    v_cvt_f32_u32_sdwa v33, v58 dst_sel:DWORD dst_unused:UNUSED_PAD src0_sel:WORD_1
    v_cvt_f32_u32_sdwa v34, v59 dst_sel:DWORD dst_unused:UNUSED_PAD src0_sel:WORD_0
    v_cvt_f32_u32_sdwa v35, v59 dst_sel:DWORD dst_unused:UNUSED_PAD src0_sel:WORD_1
    v_add_f32 v20, 0xc6800000, v20
    v_fmac_f32 v4, s34, v20
    v_add_f32 v21, 0xc6800000, v21
    v_fmac_f32 v5, s34, v21
    v_add_f32 v22, 0xc6800000, v22
    v_fmac_f32 v6, s34, v22
    v_add_f32 v23, 0xc6800000, v23
    v_fmac_f32 v7, s34, v23
    v_add_f32 v24, 0xc6800000, v24
    v_fmac_f32 v8, s34, v24
    v_add_f32 v25, 0xc6800000, v25
    v_fmac_f32 v9, s34, v25
    v_add_f32 v26, 0xc6800000, v26
    v_fmac_f32 v10, s34, v26
    v_add_f32 v27, 0xc6800000, v27
    v_fmac_f32 v11, s34, v27
    v_add_f32 v28, 0xc6800000, v28
    v_fmac_f32 v12, s34, v28
    v_add_f32 v29, 0xc6800000, v29
    v_fmac_f32 v13, s34, v29
    v_add_f32 v30, 0xc6800000, v30
    v_fmac_f32 v14, s34, v30
    v_add_f32 v31, 0xc6800000, v31
    v_fmac_f32 v15, s34, v31
    v_add_f32 v32, 0xc6800000, v32
    v_fmac_f32 v16, s34, v32
    v_add_f32 v33, 0xc6800000, v33
    v_fmac_f32 v17, s34, v33
    v_add_f32 v34, 0xc6800000, v34
    v_fmac_f32 v18, s34, v34
    v_add_f32 v35, 0xc6800000, v35
    v_fmac_f32 v19, s34, v35
    s_branch L_fnx_111
L_ffl_110:
    s_mov_b32 s3, 38400000
    buffer_load_dwordx4 v[20:23], v82, s[84:87], s3 offen offset:0 sc1
    buffer_load_dwordx4 v[24:27], v82, s[84:87], s3 offen offset:16 sc1
    buffer_load_dwordx4 v[28:31], v83, s[84:87], s3 offen offset:0 sc1
    buffer_load_dwordx4 v[32:35], v83, s[84:87], s3 offen offset:16 sc1
    s_waitcnt vmcnt(0)
    v_add_f32 v4, v4, v20
    v_add_f32 v5, v5, v21
    v_add_f32 v6, v6, v22
    v_add_f32 v7, v7, v23
    v_add_f32 v8, v8, v24
    v_add_f32 v9, v9, v25
    v_add_f32 v10, v10, v26
    v_add_f32 v11, v11, v27
    v_add_f32 v12, v12, v28
    v_add_f32 v13, v13, v29
    v_add_f32 v14, v14, v30
    v_add_f32 v15, v15, v31
    v_add_f32 v16, v16, v32
    v_add_f32 v17, v17, v33
    v_add_f32 v18, v18, v34
    v_add_f32 v19, v19, v35
L_fnx_111:
    s_bitcmp1_b32 s35, 6
    s_cbranch_scc1 L_ffl_112
    v_cvt_f32_u32_sdwa v20, v44 dst_sel:DWORD dst_unused:UNUSED_PAD src0_sel:WORD_0
    v_cvt_f32_u32_sdwa v21, v44 dst_sel:DWORD dst_unused:UNUSED_PAD src0_sel:WORD_1
    v_cvt_f32_u32_sdwa v22, v45 dst_sel:DWORD dst_unused:UNUSED_PAD src0_sel:WORD_0
    v_cvt_f32_u32_sdwa v23, v45 dst_sel:DWORD dst_unused:UNUSED_PAD src0_sel:WORD_1
    v_cvt_f32_u32_sdwa v24, v46 dst_sel:DWORD dst_unused:UNUSED_PAD src0_sel:WORD_0
    v_cvt_f32_u32_sdwa v25, v46 dst_sel:DWORD dst_unused:UNUSED_PAD src0_sel:WORD_1
    v_cvt_f32_u32_sdwa v26, v47 dst_sel:DWORD dst_unused:UNUSED_PAD src0_sel:WORD_0
    v_cvt_f32_u32_sdwa v27, v47 dst_sel:DWORD dst_unused:UNUSED_PAD src0_sel:WORD_1
    v_cvt_f32_u32_sdwa v28, v60 dst_sel:DWORD dst_unused:UNUSED_PAD src0_sel:WORD_0
    v_cvt_f32_u32_sdwa v29, v60 dst_sel:DWORD dst_unused:UNUSED_PAD src0_sel:WORD_1
    v_cvt_f32_u32_sdwa v30, v61 dst_sel:DWORD dst_unused:UNUSED_PAD src0_sel:WORD_0
    v_cvt_f32_u32_sdwa v31, v61 dst_sel:DWORD dst_unused:UNUSED_PAD src0_sel:WORD_1
    v_cvt_f32_u32_sdwa v32, v62 dst_sel:DWORD dst_unused:UNUSED_PAD src0_sel:WORD_0
    v_cvt_f32_u32_sdwa v33, v62 dst_sel:DWORD dst_unused:UNUSED_PAD src0_sel:WORD_1
    v_cvt_f32_u32_sdwa v34, v63 dst_sel:DWORD dst_unused:UNUSED_PAD src0_sel:WORD_0
    v_cvt_f32_u32_sdwa v35, v63 dst_sel:DWORD dst_unused:UNUSED_PAD src0_sel:WORD_1
    v_add_f32 v20, 0xc6800000, v20
    v_fmac_f32 v4, s34, v20
    v_add_f32 v21, 0xc6800000, v21
    v_fmac_f32 v5, s34, v21
    v_add_f32 v22, 0xc6800000, v22
    v_fmac_f32 v6, s34, v22
    v_add_f32 v23, 0xc6800000, v23
    v_fmac_f32 v7, s34, v23
    v_add_f32 v24, 0xc6800000, v24
    v_fmac_f32 v8, s34, v24
    v_add_f32 v25, 0xc6800000, v25
    v_fmac_f32 v9, s34, v25
    v_add_f32 v26, 0xc6800000, v26
    v_fmac_f32 v10, s34, v26
    v_add_f32 v27, 0xc6800000, v27
    v_fmac_f32 v11, s34, v27
    v_add_f32 v28, 0xc6800000, v28
    v_fmac_f32 v12, s34, v28
    v_add_f32 v29, 0xc6800000, v29
    v_fmac_f32 v13, s34, v29
    v_add_f32 v30, 0xc6800000, v30
    v_fmac_f32 v14, s34, v30
    v_add_f32 v31, 0xc6800000, v31
    v_fmac_f32 v15, s34, v31
    v_add_f32 v32, 0xc6800000, v32
    v_fmac_f32 v16, s34, v32
    v_add_f32 v33, 0xc6800000, v33
    v_fmac_f32 v17, s34, v33
    v_add_f32 v34, 0xc6800000, v34
    v_fmac_f32 v18, s34, v34
    v_add_f32 v35, 0xc6800000, v35
    v_fmac_f32 v19, s34, v35
    s_branch L_fnx_113
L_ffl_112:
    s_mov_b32 s3, 51200000
    buffer_load_dwordx4 v[20:23], v82, s[84:87], s3 offen offset:0 sc1
    buffer_load_dwordx4 v[24:27], v82, s[84:87], s3 offen offset:16 sc1
    buffer_load_dwordx4 v[28:31], v83, s[84:87], s3 offen offset:0 sc1
    buffer_load_dwordx4 v[32:35], v83, s[84:87], s3 offen offset:16 sc1
    s_waitcnt vmcnt(0)
    v_add_f32 v4, v4, v20
    v_add_f32 v5, v5, v21
    v_add_f32 v6, v6, v22
    v_add_f32 v7, v7, v23
    v_add_f32 v8, v8, v24
    v_add_f32 v9, v9, v25
    v_add_f32 v10, v10, v26
    v_add_f32 v11, v11, v27
    v_add_f32 v12, v12, v28
    v_add_f32 v13, v13, v29
    v_add_f32 v14, v14, v30
    v_add_f32 v15, v15, v31
    v_add_f32 v16, v16, v32
    v_add_f32 v17, v17, v33
    v_add_f32 v18, v18, v34
    v_add_f32 v19, v19, v35
L_fnx_113:
    s_bitcmp1_b32 s35, 7
    s_cbranch_scc1 L_ffl_114
    v_cvt_f32_u32_sdwa v20, v48 dst_sel:DWORD dst_unused:UNUSED_PAD src0_sel:WORD_0
    v_cvt_f32_u32_sdwa v21, v48 dst_sel:DWORD dst_unused:UNUSED_PAD src0_sel:WORD_1
    v_cvt_f32_u32_sdwa v22, v49 dst_sel:DWORD dst_unused:UNUSED_PAD src0_sel:WORD_0
    v_cvt_f32_u32_sdwa v23, v49 dst_sel:DWORD dst_unused:UNUSED_PAD src0_sel:WORD_1
    v_cvt_f32_u32_sdwa v24, v50 dst_sel:DWORD dst_unused:UNUSED_PAD src0_sel:WORD_0
    v_cvt_f32_u32_sdwa v25, v50 dst_sel:DWORD dst_unused:UNUSED_PAD src0_sel:WORD_1
    v_cvt_f32_u32_sdwa v26, v51 dst_sel:DWORD dst_unused:UNUSED_PAD src0_sel:WORD_0
    v_cvt_f32_u32_sdwa v27, v51 dst_sel:DWORD dst_unused:UNUSED_PAD src0_sel:WORD_1
    v_cvt_f32_u32_sdwa v28, v64 dst_sel:DWORD dst_unused:UNUSED_PAD src0_sel:WORD_0
    v_cvt_f32_u32_sdwa v29, v64 dst_sel:DWORD dst_unused:UNUSED_PAD src0_sel:WORD_1
    v_cvt_f32_u32_sdwa v30, v65 dst_sel:DWORD dst_unused:UNUSED_PAD src0_sel:WORD_0
    v_cvt_f32_u32_sdwa v31, v65 dst_sel:DWORD dst_unused:UNUSED_PAD src0_sel:WORD_1
    v_cvt_f32_u32_sdwa v32, v66 dst_sel:DWORD dst_unused:UNUSED_PAD src0_sel:WORD_0
    v_cvt_f32_u32_sdwa v33, v66 dst_sel:DWORD dst_unused:UNUSED_PAD src0_sel:WORD_1
    v_cvt_f32_u32_sdwa v34, v67 dst_sel:DWORD dst_unused:UNUSED_PAD src0_sel:WORD_0
    v_cvt_f32_u32_sdwa v35, v67 dst_sel:DWORD dst_unused:UNUSED_PAD src0_sel:WORD_1
    v_add_f32 v20, 0xc6800000, v20
    v_fmac_f32 v4, s34, v20
    v_add_f32 v21, 0xc6800000, v21
    v_fmac_f32 v5, s34, v21
    v_add_f32 v22, 0xc6800000, v22
    v_fmac_f32 v6, s34, v22
    v_add_f32 v23, 0xc6800000, v23
    v_fmac_f32 v7, s34, v23
    v_add_f32 v24, 0xc6800000, v24
    v_fmac_f32 v8, s34, v24
    v_add_f32 v25, 0xc6800000, v25
    v_fmac_f32 v9, s34, v25
    v_add_f32 v26, 0xc6800000, v26
    v_fmac_f32 v10, s34, v26
    v_add_f32 v27, 0xc6800000, v27
    v_fmac_f32 v11, s34, v27
    v_add_f32 v28, 0xc6800000, v28
    v_fmac_f32 v12, s34, v28
    v_add_f32 v29, 0xc6800000, v29
    v_fmac_f32 v13, s34, v29
    v_add_f32 v30, 0xc6800000, v30
    v_fmac_f32 v14, s34, v30
    v_add_f32 v31, 0xc6800000, v31
    v_fmac_f32 v15, s34, v31
    v_add_f32 v32, 0xc6800000, v32
    v_fmac_f32 v16, s34, v32
    v_add_f32 v33, 0xc6800000, v33
    v_fmac_f32 v17, s34, v33
    v_add_f32 v34, 0xc6800000, v34
    v_fmac_f32 v18, s34, v34
    v_add_f32 v35, 0xc6800000, v35
    v_fmac_f32 v19, s34, v35
    s_branch L_fnx_115
L_ffl_114:
    s_mov_b32 s3, 64000000
    buffer_load_dwordx4 v[20:23], v82, s[84:87], s3 offen offset:0 sc1
    buffer_load_dwordx4 v[24:27], v82, s[84:87], s3 offen offset:16 sc1
    buffer_load_dwordx4 v[28:31], v83, s[84:87], s3 offen offset:0 sc1
    buffer_load_dwordx4 v[32:35], v83, s[84:87], s3 offen offset:16 sc1
    s_waitcnt vmcnt(0)
    v_add_f32 v4, v4, v20
    v_add_f32 v5, v5, v21
    v_add_f32 v6, v6, v22
    v_add_f32 v7, v7, v23
    v_add_f32 v8, v8, v24
    v_add_f32 v9, v9, v25
    v_add_f32 v10, v10, v26
    v_add_f32 v11, v11, v27
    v_add_f32 v12, v12, v28
    v_add_f32 v13, v13, v29
    v_add_f32 v14, v14, v30
    v_add_f32 v15, v15, v31
    v_add_f32 v16, v16, v32
    v_add_f32 v17, v17, v33
    v_add_f32 v18, v18, v34
    v_add_f32 v19, v19, v35
L_fnx_115:
    s_branch L_fbk_107
L_p2slow_48:
    s_waitcnt vmcnt(0) lgkmcnt(0)
    s_mov_b32 s51, 0
    s_movk_i32 s43, 6250
L_sweep_116:
    s_barrier

    v_mov_b32 v28, 0x0
    v_mov_b32 v29, 0x0
    v_mov_b32 v30, 0x0
    v_mov_b32 v31, 0x0
    v_add_u32 v32, 50000, v3
    v_add_u32 v33, 65536, v32

    ds_write_b128 v32, v[28:31] offset:0
    ds_write_b128 v32, v[28:31] offset:16384
    ds_write_b128 v32, v[28:31] offset:32768
    ds_write_b128 v32, v[28:31] offset:49152
    ds_write_b128 v33, v[28:31] offset:0
    ds_write_b128 v33, v[28:31] offset:16384
    v_cmp_gt_u32 vcc, 971, v0
    s_mov_b64 exec, vcc
    ds_write_b128 v33, v[28:31] offset:32768
    s_mov_b64 exec, -1
    s_mov_b32 s3, 32768
    s_load_dword s40, s[6:7], s3
    s_waitcnt lgkmcnt(0)
    s_barrier
    s_cmp_lg_u32 s40, 0
    s_cbranch_scc1 L_raw_121
    s_sub_u32 s38, s4, 8
L_sbatch_117:
    s_lshl_b32 s52, s38, 6
    s_add_u32 s52, s52, s36
    s_lshr_b32 s52, s52, 1
    s_lshl_b32 s52, s52, 2
    s_load_dword s40, s[46:47], s52
    s_mul_i32 s50, s38, 200000
    s_and_b32 s3, s36, 1
    s_lshl_b32 s3, s3, 4
    s_or_b32 s3, s3, 0x100000
    s_waitcnt lgkmcnt(0)
    s_bfe_u32 s40, s40, s3

    s_min_u32 s40, s40, 6524
    s_lshl_b32 s52, s38, 6
    s_add_u32 s52, s52, s36
    s_mul_i32 s52, s52, 32764
    s_and_b32 s52, s52, 0xffffff80
    s_add_u32 s20, s44, s52
    s_addc_u32 s21, s45, 0
    s_mul_i32 s52, s40, 5
    s_add_u32 s52, s52, 3
    s_and_b32 s22, s52, -4

    s_lshr_b32 s55, s39, 2
    s_add_u32 s55, s55, 0
    v_and_b32 v36, 63, v0
    v_add_u32 v36, s55, v36
L_left_122:
    s_cmp_ge_u32 s55, s40
    s_cbranch_scc1 L_leftend_123
    v_mul_u32_u24 v37, 5, v36
    buffer_load_dword v38, v37, s[20:23], 0 offen
    buffer_load_ubyte v39, v37, s[20:23], 0 offen offset:4
    s_waitcnt vmcnt(0)

    v_perm_b32 v37, v39, v38, s24
    v_lshrrev_b32 v42, 30, v38
    v_and_b32 v37, 0x1fff, v37
    v_mul_u32_u24 v42, 6250, v42
    v_add_lshl_u32 v37, v37, v42, 3

    buffer_load_dwordx2 v[40:41], v37, s[8:11], s50 offen
    v_cmp_gt_u32 vcc, s40, v36
    s_waitcnt vmcnt(0)

    v_bfe_u32 v44, v38, 16, 14
    v_subrev_u32 v44, s51, v44
    v_cmp_gt_u32 s[64:65], s43, v44
    s_and_b64 exec, vcc, s[64:65]
    v_lshlrev_b32 v45, 8, v38
    v_cmpx_ne_u32 vcc, 0, v45
    v_lshlrev_b32 v44, 4, v44
    v_bfe_i32 v38, v38, 0, 16
    v_cvt_f32_i32 v38, v38
    v_mul_f32 v38, 0x38004020, v38
    v_lshlrev_b32 v45, 16, v40
    v_and_b32 v46, s32, v40
    v_lshlrev_b32 v47, 16, v41
    v_and_b32 v48, s32, v41

    v_mul_f32 v45, v45, v38
    ds_add_f32 v44, v45 offset:50000
    v_mul_f32 v46, v46, v38
    ds_add_f32 v44, v46 offset:50004
    v_mul_f32 v47, v47, v38
    ds_add_f32 v44, v47 offset:50008
    v_mul_f32 v48, v48, v38
    ds_add_f32 v44, v48 offset:50012
    s_mov_b64 exec, -1
    v_add_u32 v36, 128, v36
    s_add_u32 s55, s55, 128
    s_branch L_left_122
L_leftend_123:

    s_add_u32 s38, s38, 1
    s_cmp_lt_u32 s38, s4
    s_cbranch_scc1 L_sbatch_117
    s_branch L_swend_119

L_raw_121:
    s_load_dwordx2 s[68:69], s[0:1], 8
    s_load_dwordx2 s[72:73], s[0:1], 16
    s_load_dwordx2 s[76:77], s[0:1], 32
    s_load_dwordx2 s[80:81], s[0:1], 48
    s_mov_b32 s70, 204800000
    s_mov_b32 s71, 0x20000
    s_mov_b32 s74, 204800000
    s_mov_b32 s75, 0x20000
    s_mov_b32 s78, 102400000
    s_mov_b32 s79, 0x20000
    s_waitcnt lgkmcnt(0)
    s_load_dword s82, s[80:81], 0
    s_mul_i32 s83, s36, 12500
    s_add_u32 s83, s83, s51
    s_mul_i32 s84, s37, 200000
    s_mov_b32 s85, 200000
    s_mov_b32 s38, 0
    v_lshlrev_b32 v44, 5, v0
    v_mov_b32 v45, 0.15915494
    s_waitcnt lgkmcnt(0)
    s_lshl_b32 s82, s82, 16
    v_mul_f32 v45, s82, v45
L_rawl_118:
    s_lshr_b32 s3, s38, 1
    buffer_load_dwordx4 v[46:49], v44, s[72:75], s38 offen
    buffer_load_dwordx4 v[50:53], v44, s[72:75], s38 offen offset:16
    buffer_load_dwordx4 v[54:57], v44, s[68:71], s38 offen
    buffer_load_dwordx4 v[58:61], v44, s[68:71], s38 offen offset:16
    buffer_load_dwordx4 v[62:65], v3, s[76:79], s3 offen
    s_waitcnt vmcnt(1)

    v_subrev_u32 v46, s83, v46
    v_subrev_u32 v82, s84, v54
    v_cmp_gt_u32 vcc, s43, v46
    v_cmp_gt_u32 s[64:65], s85, v82
    v_lshlrev_b32 v54, 3, v54
    s_nand_b64 exec, vcc, s[64:65]
    v_bfrev_b32 v54, 1
    s_mov_b64 exec, -1
    buffer_load_dwordx2 v[66:67], v54, s[8:11], 0 offen

    v_subrev_u32 v47, s83, v47
    v_subrev_u32 v82, s84, v55
    v_cmp_gt_u32 vcc, s43, v47
    v_cmp_gt_u32 s[64:65], s85, v82
    v_lshlrev_b32 v55, 3, v55
    s_nand_b64 exec, vcc, s[64:65]
    v_bfrev_b32 v55, 1
    s_mov_b64 exec, -1
    buffer_load_dwordx2 v[68:69], v55, s[8:11], 0 offen

    v_subrev_u32 v48, s83, v48
    v_subrev_u32 v82, s84, v56
    v_cmp_gt_u32 vcc, s43, v48
    v_cmp_gt_u32 s[64:65], s85, v82
    v_lshlrev_b32 v56, 3, v56
    s_nand_b64 exec, vcc, s[64:65]
    v_bfrev_b32 v56, 1
    s_mov_b64 exec, -1
    buffer_load_dwordx2 v[70:71], v56, s[8:11], 0 offen

    v_subrev_u32 v49, s83, v49
    v_subrev_u32 v82, s84, v57
    v_cmp_gt_u32 vcc, s43, v49
    v_cmp_gt_u32 s[64:65], s85, v82
    v_lshlrev_b32 v57, 3, v57
    s_nand_b64 exec, vcc, s[64:65]
    v_bfrev_b32 v57, 1
    s_mov_b64 exec, -1
    buffer_load_dwordx2 v[72:73], v57, s[8:11], 0 offen

    v_subrev_u32 v50, s83, v50
    v_subrev_u32 v82, s84, v58
    v_cmp_gt_u32 vcc, s43, v50
    v_cmp_gt_u32 s[64:65], s85, v82
    v_lshlrev_b32 v58, 3, v58
    s_nand_b64 exec, vcc, s[64:65]
    v_bfrev_b32 v58, 1
    s_mov_b64 exec, -1
    buffer_load_dwordx2 v[74:75], v58, s[8:11], 0 offen

    v_subrev_u32 v51, s83, v51
    v_subrev_u32 v82, s84, v59
    v_cmp_gt_u32 vcc, s43, v51
    v_cmp_gt_u32 s[64:65], s85, v82
    v_lshlrev_b32 v59, 3, v59
    s_nand_b64 exec, vcc, s[64:65]
    v_bfrev_b32 v59, 1
    s_mov_b64 exec, -1
    buffer_load_dwordx2 v[76:77], v59, s[8:11], 0 offen

    v_subrev_u32 v52, s83, v52
    v_subrev_u32 v82, s84, v60
    v_cmp_gt_u32 vcc, s43, v52
    v_cmp_gt_u32 s[64:65], s85, v82
    v_lshlrev_b32 v60, 3, v60
    s_nand_b64 exec, vcc, s[64:65]
    v_bfrev_b32 v60, 1
    s_mov_b64 exec, -1
    buffer_load_dwordx2 v[78:79], v60, s[8:11], 0 offen

    v_subrev_u32 v53, s83, v53
    v_subrev_u32 v82, s84, v61
    v_cmp_gt_u32 vcc, s43, v53
    v_cmp_gt_u32 s[64:65], s85, v82
    v_lshlrev_b32 v61, 3, v61
    s_nand_b64 exec, vcc, s[64:65]
    v_bfrev_b32 v61, 1
    s_mov_b64 exec, -1
    buffer_load_dwordx2 v[80:81], v61, s[8:11], 0 offen

    s_waitcnt vmcnt(0)
    v_cmp_le_i32 vcc, 0, v54
    s_mov_b64 exec, vcc
    s_cbranch_execz L_rsk_124
    v_lshlrev_b32 v82, 16, v62
    v_mul_f32 v82, v82, v45
    v_fract_f32 v82, v82
    v_cos_f32 v82, v82
    v_lshlrev_b32 v46, 4, v46
    v_lshlrev_b32 v83, 16, v66
    v_and_b32 v84, s32, v66
    v_lshlrev_b32 v85, 16, v67
    v_and_b32 v86, s32, v67

    v_mul_f32 v83, v83, v82
    ds_add_f32 v46, v83 offset:50000
    v_mul_f32 v84, v84, v82
    ds_add_f32 v46, v84 offset:50004
    v_mul_f32 v85, v85, v82
    ds_add_f32 v46, v85 offset:50008
    v_mul_f32 v86, v86, v82
    ds_add_f32 v46, v86 offset:50012
L_rsk_124:
    s_mov_b64 exec, -1
    v_cmp_le_i32 vcc, 0, v55
    s_mov_b64 exec, vcc
    s_cbranch_execz L_rsk_125
    v_and_b32 v82, s32, v62
    v_mul_f32 v82, v82, v45
    v_fract_f32 v82, v82
    v_cos_f32 v82, v82
    v_lshlrev_b32 v47, 4, v47
    v_lshlrev_b32 v83, 16, v68
    v_and_b32 v84, s32, v68
    v_lshlrev_b32 v85, 16, v69
    v_and_b32 v86, s32, v69

    v_mul_f32 v83, v83, v82
    ds_add_f32 v47, v83 offset:50000
    v_mul_f32 v84, v84, v82
    ds_add_f32 v47, v84 offset:50004
    v_mul_f32 v85, v85, v82
    ds_add_f32 v47, v85 offset:50008
    v_mul_f32 v86, v86, v82
    ds_add_f32 v47, v86 offset:50012
L_rsk_125:
    s_mov_b64 exec, -1
    v_cmp_le_i32 vcc, 0, v56
    s_mov_b64 exec, vcc
    s_cbranch_execz L_rsk_126
    v_lshlrev_b32 v82, 16, v63
    v_mul_f32 v82, v82, v45
    v_fract_f32 v82, v82
    v_cos_f32 v82, v82
    v_lshlrev_b32 v48, 4, v48
    v_lshlrev_b32 v83, 16, v70
    v_and_b32 v84, s32, v70
    v_lshlrev_b32 v85, 16, v71
    v_and_b32 v86, s32, v71

    v_mul_f32 v83, v83, v82
    ds_add_f32 v48, v83 offset:50000
    v_mul_f32 v84, v84, v82
    ds_add_f32 v48, v84 offset:50004
    v_mul_f32 v85, v85, v82
    ds_add_f32 v48, v85 offset:50008
    v_mul_f32 v86, v86, v82
    ds_add_f32 v48, v86 offset:50012
L_rsk_126:
    s_mov_b64 exec, -1
    v_cmp_le_i32 vcc, 0, v57
    s_mov_b64 exec, vcc
    s_cbranch_execz L_rsk_127
    v_and_b32 v82, s32, v63
    v_mul_f32 v82, v82, v45
    v_fract_f32 v82, v82
    v_cos_f32 v82, v82
    v_lshlrev_b32 v49, 4, v49
    v_lshlrev_b32 v83, 16, v72
    v_and_b32 v84, s32, v72
    v_lshlrev_b32 v85, 16, v73
    v_and_b32 v86, s32, v73

    v_mul_f32 v83, v83, v82
    ds_add_f32 v49, v83 offset:50000
    v_mul_f32 v84, v84, v82
    ds_add_f32 v49, v84 offset:50004
    v_mul_f32 v85, v85, v82
    ds_add_f32 v49, v85 offset:50008
    v_mul_f32 v86, v86, v82
    ds_add_f32 v49, v86 offset:50012
L_rsk_127:
    s_mov_b64 exec, -1
    v_cmp_le_i32 vcc, 0, v58
    s_mov_b64 exec, vcc
    s_cbranch_execz L_rsk_128
    v_lshlrev_b32 v82, 16, v64
    v_mul_f32 v82, v82, v45
    v_fract_f32 v82, v82
    v_cos_f32 v82, v82
    v_lshlrev_b32 v50, 4, v50
    v_lshlrev_b32 v83, 16, v74
    v_and_b32 v84, s32, v74
    v_lshlrev_b32 v85, 16, v75
    v_and_b32 v86, s32, v75

    v_mul_f32 v83, v83, v82
    ds_add_f32 v50, v83 offset:50000
    v_mul_f32 v84, v84, v82
    ds_add_f32 v50, v84 offset:50004
    v_mul_f32 v85, v85, v82
    ds_add_f32 v50, v85 offset:50008
    v_mul_f32 v86, v86, v82
    ds_add_f32 v50, v86 offset:50012
L_rsk_128:
    s_mov_b64 exec, -1
    v_cmp_le_i32 vcc, 0, v59
    s_mov_b64 exec, vcc
    s_cbranch_execz L_rsk_129
    v_and_b32 v82, s32, v64
    v_mul_f32 v82, v82, v45
    v_fract_f32 v82, v82
    v_cos_f32 v82, v82
    v_lshlrev_b32 v51, 4, v51
    v_lshlrev_b32 v83, 16, v76
    v_and_b32 v84, s32, v76
    v_lshlrev_b32 v85, 16, v77
    v_and_b32 v86, s32, v77

    v_mul_f32 v83, v83, v82
    ds_add_f32 v51, v83 offset:50000
    v_mul_f32 v84, v84, v82
    ds_add_f32 v51, v84 offset:50004
    v_mul_f32 v85, v85, v82
    ds_add_f32 v51, v85 offset:50008
    v_mul_f32 v86, v86, v82
    ds_add_f32 v51, v86 offset:50012
L_rsk_129:
    s_mov_b64 exec, -1
    v_cmp_le_i32 vcc, 0, v60
    s_mov_b64 exec, vcc
    s_cbranch_execz L_rsk_130
    v_lshlrev_b32 v82, 16, v65
    v_mul_f32 v82, v82, v45
    v_fract_f32 v82, v82
    v_cos_f32 v82, v82
    v_lshlrev_b32 v52, 4, v52
    v_lshlrev_b32 v83, 16, v78
    v_and_b32 v84, s32, v78
    v_lshlrev_b32 v85, 16, v79
    v_and_b32 v86, s32, v79

    v_mul_f32 v83, v83, v82
    ds_add_f32 v52, v83 offset:50000
    v_mul_f32 v84, v84, v82
    ds_add_f32 v52, v84 offset:50004
    v_mul_f32 v85, v85, v82
    ds_add_f32 v52, v85 offset:50008
    v_mul_f32 v86, v86, v82
    ds_add_f32 v52, v86 offset:50012
L_rsk_130:
    s_mov_b64 exec, -1
    v_cmp_le_i32 vcc, 0, v61
    s_mov_b64 exec, vcc
    s_cbranch_execz L_rsk_131
    v_and_b32 v82, s32, v65
    v_mul_f32 v82, v82, v45
    v_fract_f32 v82, v82
    v_cos_f32 v82, v82
    v_lshlrev_b32 v53, 4, v53
    v_lshlrev_b32 v83, 16, v80
    v_and_b32 v84, s32, v80
    v_lshlrev_b32 v85, 16, v81
    v_and_b32 v86, s32, v81

    v_mul_f32 v83, v83, v82
    ds_add_f32 v53, v83 offset:50000
    v_mul_f32 v84, v84, v82
    ds_add_f32 v53, v84 offset:50004
    v_mul_f32 v85, v85, v82
    ds_add_f32 v53, v85 offset:50008
    v_mul_f32 v86, v86, v82
    ds_add_f32 v53, v86 offset:50012
L_rsk_131:
    s_mov_b64 exec, -1
    s_add_u32 s38, s38, 32768
    s_cmp_lt_u32 s38, 204800000
    s_cbranch_scc1 L_rawl_118
L_swend_119:
    s_waitcnt lgkmcnt(0)
    s_barrier
    s_mul_i32 s3, s37, 800000
    s_mul_i32 s5, s36, 12500
    s_add_u32 s3, s3, s5
    s_add_u32 s3, s3, s51
    s_lshl_b32 s3, s3, 4
    s_add_u32 s3, s3, 34496512

    s_add_u32 s20, s6, s3
    s_addc_u32 s21, s7, 0
    s_mov_b32 s22, 100000
    s_mov_b32 s23, 0x20000
    v_mov_b32 v36, v3
    s_mov_b32 s38, 0
L_wl_120:
    v_min_u32 v37, 100000, v36
    ds_read_b128 v[28:31], v37 offset:50000
    s_waitcnt lgkmcnt(0)
    buffer_store_dwordx4 v[28:31], v36, s[20:23], 0 offen sc1
    s_waitcnt vmcnt(0)
    v_add_u32 v36, 16384, v36
    s_add_u32 s38, s38, 1024
    s_cmp_lt_u32 s38, 6250
    s_cbranch_scc1 L_wl_120
    s_add_u32 s51, s51, 6250
    s_cmp_lt_u32 s51, 12500
    s_cbranch_scc1 L_sweep_116
    s_lshl_b32 s33, 16, s37
    s_add_u32 s33, s33, 1
    s_branch L_fin_83

.section .rodata,"a"
.p2align 6
.amdhsa_kernel g1_kernel
  .amdhsa_next_free_vgpr 128
  .amdhsa_next_free_sgpr 102
  .amdhsa_accum_offset 128
  .amdhsa_group_segment_fixed_size 0
  .amdhsa_kernarg_size 112
  .amdhsa_user_sgpr_count 2
  .amdhsa_user_sgpr_kernarg_segment_ptr 1
  .amdhsa_system_sgpr_workgroup_id_x 1
  .amdhsa_float_denorm_mode_32 3
.end_amdhsa_kernel
.p2align 6
.amdhsa_kernel standalone__molecular_angular_gemnet__graph_kernel
  .amdhsa_next_free_vgpr 128
  .amdhsa_next_free_sgpr 102
  .amdhsa_accum_offset 128
  .amdhsa_group_segment_fixed_size 0
  .amdhsa_kernarg_size 112
  .amdhsa_user_sgpr_count 2
  .amdhsa_user_sgpr_kernarg_segment_ptr 1
  .amdhsa_system_sgpr_workgroup_id_x 1
  .amdhsa_float_denorm_mode_32 3
.end_amdhsa_kernel
```

```asm
; @launch kernel=g1_kernel grid=(256,1,1) block=(1024,1,1) lds=163840
; @launch kernel=standalone__molecular_angular_gemnet__graph_kernel grid=(256,1,1) block=(1024,1,1) lds=163840
.amdgcn_target "amdgcn-amd-amdhsa--gfx950"
.text
.globl g1_kernel
.p2align 8
.type g1_kernel,@function
g1_kernel:
    s_cmp_ge_u32 s2, 256
    s_cbranch_scc1 L_p1done_1
    s_load_dwordx4 s[80:83], s[0:1], 8
    s_load_dwordx2 s[84:85], s[0:1], 32
    s_load_dwordx2 s[86:87], s[0:1], 48
    s_load_dwordx4 s[4:7], s[0:1], 96
    s_load_dwordx2 s[78:79], s[0:1], 0
    v_lshlrev_b32 v1, 4, v0
    v_lshlrev_b32 v2, 3, v0
    v_lshlrev_b32 v98, 20, v0
    s_waitcnt lgkmcnt(0)
    s_load_dword s88, s[86:87], 0

    s_mov_b32 s96, s4
    s_mov_b32 s97, s5
    s_mov_b32 s98, 256
    s_mov_b32 s99, 0x20000
    v_readfirstlane_b32 s74, v0
    s_nop 1
    s_or_b32 s74, s74, s2
    s_cbranch_scc1 L_noinit_2

    v_mov_b32 v110, 1
    buffer_atomic_add v110, v98, s[96:99], 0 offen offset:64 sc0
    s_waitcnt vmcnt(0)
    v_readfirstlane_b32 s74, v110
    s_nop 1
    s_cmp_lg_u32 s74, 0
    s_cbranch_scc1 L_zno_4

    s_mov_b32 s92, s6
    s_mov_b32 s93, s7
    s_mov_b32 s94, 32784
    s_mov_b32 s95, 0x20000
    v_mov_b32 v110, 0
    v_mov_b32 v111, 0
    v_mov_b32 v112, 0
    v_mov_b32 v113, 0
L_zl_3:
    buffer_store_dwordx4 v[110:113], v1, s[92:95], s74 offen sc0 sc1
    s_add_u32 s74, s74, 1024
    s_cmp_le_u32 s74, 32768
    s_cbranch_scc1 L_zl_3
    v_mov_b32 v114, 1
    s_waitcnt vmcnt(0)
    buffer_atomic_add v114, v98, s[96:99], 0 offen offset:128
L_zno_4:

L_noinit_2:
    s_mov_b32 s20, s78
    s_mov_b32 s21, s79
    s_mov_b32 s22, 6400000
    s_mov_b32 s23, 0x20000
    v_mul_u32_u24 v110, 6240, v0
    v_and_b32 v111, 63, v0
    v_and_b32 v112, 0x3c0, v0
    v_lshlrev_b32 v111, 2, v111
    v_lshl_or_b32 v111, v112, 4, v111
    v_lshlrev_b32 v100, 2, v0
    s_lshr_b32 s50, s2, 1
    s_and_b32 s53, s2, 1
    s_mul_i32 s3, s50, 50000
    s_mul_i32 s54, s53, 24576
    s_add_u32 s3, s3, s54

    buffer_load_dwordx4 v[56:59], v110, s[20:23], 0 offen
    s_add_u32 s20, s78, s3
    s_addc_u32 s21, s79, 0
    s_mov_b32 s22, 24576
    s_mov_b32 s23, 0x20000
    s_movk_i32 s3, 16384
    buffer_load_dword v44, v111, s[20:23], 0 offen offset:0
    buffer_load_dword v45, v111, s[20:23], 0 offen offset:256
    buffer_load_dword v46, v111, s[20:23], 0 offen offset:512
    buffer_load_dword v47, v111, s[20:23], 0 offen offset:768
    buffer_load_dword v48, v111, s[20:23], s3 offen offset:0
    buffer_load_dword v49, v111, s[20:23], s3 offen offset:256
    buffer_load_dword v50, v111, s[20:23], s3 offen offset:512
    buffer_load_dword v51, v111, s[20:23], s3 offen offset:768
    s_mul_i32 s22, s53, 25424
    s_movk_i32 s3, 24576

    buffer_load_dword v52, v100, s[20:23], s3 offen
    s_mul_i32 s3, s50, 50048
    s_add_u32 s3, s3, s54
    s_add_u32 s54, s3, 2490368

    v_readfirstlane_b32 s74, v0
    s_mov_b32 s55, 0x05040100
    s_nop 0
    s_cmp_lt_u32 s74, 768
    s_cbranch_scc1 L_nogate_5
    s_load_dwordx2 s[92:93], s[0:1], 40
    s_load_dwordx4 s[32:35], s[0:1], 56
    v_mov_b32 v110, 0
    s_waitcnt lgkmcnt(0)
    global_load_dwordx4 v[60:63], v110, s[92:93]

    global_load_dwordx4 v[64:67], v110, s[32:33] offset:0
    global_load_dwordx4 v[80:83], v110, s[34:35] offset:0
    global_load_dwordx4 v[68:71], v110, s[32:33] offset:16
    global_load_dwordx4 v[84:87], v110, s[34:35] offset:16
    global_load_dwordx4 v[72:75], v110, s[32:33] offset:32
    global_load_dwordx4 v[88:91], v110, s[34:35] offset:32
    global_load_dwordx4 v[76:79], v110, s[32:33] offset:48
    global_load_dwordx4 v[92:95], v110, s[34:35] offset:48
    s_lshl_b32 s74, s2, 8
    v_and_b32 v111, 255, v0
    v_add_u32 v111, s74, v111
    v_lshlrev_b32 v112, 16, v111
    v_lshlrev_b32 v111, 5, v111
    s_mov_b32 s75, 0x07060302
    s_waitcnt vmcnt(0)

    v_lshlrev_b32 v118, 16, v60
    v_and_b32 v119, 0xffff0000, v60
    v_lshlrev_b32 v120, 16, v61
    v_and_b32 v121, 0xffff0000, v61
    v_lshlrev_b32 v122, 16, v62
    v_and_b32 v123, 0xffff0000, v62
    v_lshlrev_b32 v124, 16, v63
    v_and_b32 v125, 0xffff0000, v63
    v_sub_f32 v118, v112, v118
    v_sub_f32 v119, v112, v119
    v_sub_f32 v120, v112, v120
    v_sub_f32 v121, v112, v121
    v_sub_f32 v122, v112, v122
    v_sub_f32 v123, v112, v123
    v_sub_f32 v124, v112, v124
    v_sub_f32 v125, v112, v125
    v_cvt_pk_bf16_f32 v118, v118, v119
    v_cvt_pk_bf16_f32 v120, v120, v121
    v_cvt_pk_bf16_f32 v122, v122, v123
    v_cvt_pk_bf16_f32 v124, v124, v125
    v_and_b32 v119, 0xffff0000, v118
    v_lshlrev_b32 v118, 16, v118
    v_and_b32 v121, 0xffff0000, v120
    v_lshlrev_b32 v120, 16, v120
    v_and_b32 v123, 0xffff0000, v122
    v_lshlrev_b32 v122, 16, v122
    v_and_b32 v125, 0xffff0000, v124
    v_lshlrev_b32 v124, 16, v124
    v_mul_f32 v118, v118, v118
    v_mul_f32 v119, v119, v119
    v_mul_f32 v120, v120, v120
    v_mul_f32 v121, v121, v121
    v_mul_f32 v122, v122, v122
    v_mul_f32 v123, v123, v123
    v_mul_f32 v124, v124, v124
    v_mul_f32 v125, v125, v125
    v_cvt_pk_bf16_f32 v118, v118, v119
    v_cvt_pk_bf16_f32 v120, v120, v121
    v_cvt_pk_bf16_f32 v122, v122, v123
    v_cvt_pk_bf16_f32 v124, v124, v125
    v_and_b32 v119, 0xffff0000, v118
    v_lshlrev_b32 v118, 16, v118
    v_and_b32 v121, 0xffff0000, v120
    v_lshlrev_b32 v120, 16, v120
    v_and_b32 v123, 0xffff0000, v122
    v_lshlrev_b32 v122, 16, v122
    v_and_b32 v125, 0xffff0000, v124
    v_lshlrev_b32 v124, 16, v124
    v_mul_f32 v118, 0xc1200000, v118
    v_mul_f32 v119, 0xc1200000, v119
    v_mul_f32 v120, 0xc1200000, v120
    v_mul_f32 v121, 0xc1200000, v121
    v_mul_f32 v122, 0xc1200000, v122
    v_mul_f32 v123, 0xc1200000, v123
    v_mul_f32 v124, 0xc1200000, v124
    v_mul_f32 v125, 0xc1200000, v125
    v_cvt_pk_bf16_f32 v118, v118, v119
    v_cvt_pk_bf16_f32 v120, v120, v121
    v_cvt_pk_bf16_f32 v122, v122, v123
    v_cvt_pk_bf16_f32 v124, v124, v125
    v_and_b32 v119, 0xffff0000, v118
    v_lshlrev_b32 v118, 16, v118
    v_and_b32 v121, 0xffff0000, v120
    v_lshlrev_b32 v120, 16, v120
    v_and_b32 v123, 0xffff0000, v122
    v_lshlrev_b32 v122, 16, v122
    v_and_b32 v125, 0xffff0000, v124
    v_lshlrev_b32 v124, 16, v124
    v_mul_f32 v118, 0x3fb8aa3b, v118
    v_mul_f32 v119, 0x3fb8aa3b, v119
    v_mul_f32 v120, 0x3fb8aa3b, v120
    v_mul_f32 v121, 0x3fb8aa3b, v121
    v_mul_f32 v122, 0x3fb8aa3b, v122
    v_mul_f32 v123, 0x3fb8aa3b, v123
    v_mul_f32 v124, 0x3fb8aa3b, v124
    v_mul_f32 v125, 0x3fb8aa3b, v125
    v_exp_f32 v118, v118
    v_exp_f32 v119, v119
    v_exp_f32 v120, v120
    v_exp_f32 v121, v121
    v_exp_f32 v122, v122
    v_exp_f32 v123, v123
    v_exp_f32 v124, v124
    v_exp_f32 v125, v125
    s_nop 0
    v_cvt_pk_bf16_f32 v118, v118, v119
    v_cvt_pk_bf16_f32 v120, v120, v121
    v_cvt_pk_bf16_f32 v122, v122, v123
    v_cvt_pk_bf16_f32 v124, v124, v125
    v_perm_b32 v113, v66, v64, s55
    v_dot2_f32_bf16 v114, v118, v113, 0

    v_perm_b32 v113, v66, v64, s75
    v_dot2_f32_bf16 v115, v118, v113, 0

    v_perm_b32 v113, v67, v65, s55
    v_dot2_f32_bf16 v116, v118, v113, 0

    v_perm_b32 v113, v67, v65, s75
    v_dot2_f32_bf16 v117, v118, v113, 0

    v_perm_b32 v113, v70, v68, s55
    v_dot2_f32_bf16 v114, v120, v113, v114

    v_perm_b32 v113, v70, v68, s75
    v_dot2_f32_bf16 v115, v120, v113, v115

    v_perm_b32 v113, v71, v69, s55
    v_dot2_f32_bf16 v116, v120, v113, v116

    v_perm_b32 v113, v71, v69, s75
    v_dot2_f32_bf16 v117, v120, v113, v117

    v_perm_b32 v113, v74, v72, s55
    v_dot2_f32_bf16 v114, v122, v113, v114

    v_perm_b32 v113, v74, v72, s75
    v_dot2_f32_bf16 v115, v122, v113, v115

    v_perm_b32 v113, v75, v73, s55
    v_dot2_f32_bf16 v116, v122, v113, v116

    v_perm_b32 v113, v75, v73, s75
    v_dot2_f32_bf16 v117, v122, v113, v117

    v_perm_b32 v113, v78, v76, s55
    v_dot2_f32_bf16 v114, v124, v113, v114

    v_perm_b32 v113, v78, v76, s75
    v_dot2_f32_bf16 v115, v124, v113, v115

    v_perm_b32 v113, v79, v77, s55
    v_dot2_f32_bf16 v116, v124, v113, v116

    v_perm_b32 v113, v79, v77, s75
    v_dot2_f32_bf16 v117, v124, v113, v117

    v_perm_b32 v113, v82, v80, s55
    v_dot2_f32_bf16 v60, v118, v113, 0

    v_perm_b32 v113, v82, v80, s75
    v_dot2_f32_bf16 v61, v118, v113, 0

    v_perm_b32 v113, v83, v81, s55
    v_dot2_f32_bf16 v62, v118, v113, 0

    v_perm_b32 v113, v83, v81, s75
    v_dot2_f32_bf16 v63, v118, v113, 0

    v_perm_b32 v113, v86, v84, s55
    v_dot2_f32_bf16 v60, v120, v113, v60

    v_perm_b32 v113, v86, v84, s75
    v_dot2_f32_bf16 v61, v120, v113, v61

    v_perm_b32 v113, v87, v85, s55
    v_dot2_f32_bf16 v62, v120, v113, v62

    v_perm_b32 v113, v87, v85, s75
    v_dot2_f32_bf16 v63, v120, v113, v63

    v_perm_b32 v113, v90, v88, s55
    v_dot2_f32_bf16 v60, v122, v113, v60

    v_perm_b32 v113, v90, v88, s75
    v_dot2_f32_bf16 v61, v122, v113, v61

    v_perm_b32 v113, v91, v89, s55
    v_dot2_f32_bf16 v62, v122, v113, v62

    v_perm_b32 v113, v91, v89, s75
    v_dot2_f32_bf16 v63, v122, v113, v63

    v_perm_b32 v113, v94, v92, s55
    v_dot2_f32_bf16 v60, v124, v113, v60

    v_perm_b32 v113, v94, v92, s75
    v_dot2_f32_bf16 v61, v124, v113, v61

    v_perm_b32 v113, v95, v93, s55
    v_dot2_f32_bf16 v62, v124, v113, v62

    v_perm_b32 v113, v95, v93, s75
    v_dot2_f32_bf16 v63, v124, v113, v63

    s_add_u32 s92, s6, 393216
    s_addc_u32 s93, s7, 0
    s_mov_b32 s94, 2097152
    s_mov_b32 s95, 0x20000
    v_cvt_pk_bf16_f32 v114, v114, v115
    v_cvt_pk_bf16_f32 v115, v116, v117
    buffer_store_dwordx4 v[60:63], v111, s[92:95], 0 offen
    buffer_store_dwordx2 v[114:115], v111, s[92:95], 0 offen offset:16
    s_nop 1
L_nogate_5:

    s_mov_b32 s8, s80
    s_mov_b32 s9, s81
    s_mov_b32 s10, 0
    s_mov_b32 s11, 0x20000
    s_mov_b32 s12, s82
    s_mov_b32 s13, s83
    s_mov_b32 s14, 0
    s_mov_b32 s15, 0x20000
    s_mov_b32 s16, s84
    s_mov_b32 s17, s85
    s_mov_b32 s18, 0
    s_mov_b32 s19, 0x20000
    s_lshr_b32 s74, s2, 1
    s_and_b32 s74, s74, 28
    s_lshr_b32 s86, 0x00102010, s74
    s_lshr_b32 s87, 0x44414241, s74
    s_lshr_b32 s41, 0x43221100, s74
    s_and_b32 s86, s86, 15
    s_and_b32 s87, s87, 15
    s_and_b32 s41, s41, 15
    s_lshr_b32 s74, s2, 6
    s_lshl_b32 s74, s74, 3
    s_and_b32 s75, s2, 7
    s_add_u32 s74, s74, s75
    s_mul_i32 s74, s74, 5
    s_add_u32 s41, s41, s74

    s_mul_i32 s78, s41, 16384
    s_add_u32 s49, s78, 16384
    s_cmp_ge_u32 s41, 3125
    s_cmovk_i32 s49, 0
    s_cmovk_i32 s78, 0
    s_lshl_b32 s10, s49, 2
    s_lshl_b32 s14, s49, 2
    s_lshl_b32 s18, s49, 1
    s_sub_u32 s79, s87, s86
    s_bfm_b32 s85, s79, s86
    s_lshl_b32 s86, s86, 12
    s_lshl_b32 s87, s87, 12
    s_min_u32 s87, s87, 16384

    s_add_u32 s79, s78, 0
    s_bitcmp1_b32 s85, 0
    s_cselect_b32 s79, s79, 0x1ff00000
    s_lshl_b32 s56, s79, 2
    s_lshl_b32 s61, s79, 1

    s_add_u32 s79, s78, 4096
    s_bitcmp1_b32 s85, 1
    s_cselect_b32 s79, s79, 0x1ff00000
    s_lshl_b32 s57, s79, 2
    s_lshl_b32 s62, s79, 1

    s_add_u32 s79, s78, 8192
    s_bitcmp1_b32 s85, 2
    s_cselect_b32 s79, s79, 0x1ff00000
    s_lshl_b32 s58, s79, 2
    s_lshl_b32 s63, s79, 1

    s_add_u32 s79, s78, 12288
    s_bitcmp1_b32 s85, 3
    s_cselect_b32 s79, s79, 0x1ff00000
    s_lshl_b32 s59, s79, 2
    s_lshl_b32 s64, s79, 1

    s_mov_b32 s82, s85
    s_mov_b32 s83, s86
    s_mov_b32 s84, s87
    s_add_u32 s41, s2, 160
    s_mul_i32 s74, s41, 16384
    s_mov_b32 s10, 204800000
    s_mov_b32 s14, 204800000
    s_mov_b32 s18, 102400000

    s_add_u32 s75, s74, 0
    s_lshl_b32 s76, s75, 2
    s_lshl_b32 s75, s75, 1
    s_bitcmp1_b32 s82, 0
    s_cselect_b32 s56, s56, s76
    s_cselect_b32 s61, s61, s75

    s_add_u32 s75, s74, 4096
    s_lshl_b32 s76, s75, 2
    s_lshl_b32 s75, s75, 1
    s_bitcmp1_b32 s82, 1
    s_cselect_b32 s57, s57, s76
    s_cselect_b32 s62, s62, s75

    s_add_u32 s75, s74, 8192
    s_lshl_b32 s76, s75, 2
    s_lshl_b32 s75, s75, 1
    s_bitcmp1_b32 s82, 2
    s_cselect_b32 s58, s58, s76
    s_cselect_b32 s63, s63, s75

    s_add_u32 s75, s74, 12288
    s_lshl_b32 s76, s75, 2
    s_lshl_b32 s75, s75, 1
    s_bitcmp1_b32 s82, 3
    s_cselect_b32 s59, s59, s76
    s_cselect_b32 s64, s64, s75

    buffer_load_dwordx4 v[20:23], v1, s[12:15], s56 offen nt
    buffer_load_dwordx4 v[4:7], v1, s[8:11], s56 offen nt
    buffer_load_dwordx2 v[36:37], v2, s[16:19], s61 offen nt
    buffer_load_dwordx4 v[24:27], v1, s[12:15], s57 offen nt
    buffer_load_dwordx4 v[8:11], v1, s[8:11], s57 offen nt
    buffer_load_dwordx2 v[38:39], v2, s[16:19], s62 offen nt
    buffer_load_dwordx4 v[28:31], v1, s[12:15], s58 offen nt
    buffer_load_dwordx4 v[12:15], v1, s[8:11], s58 offen nt
    buffer_load_dwordx2 v[40:41], v2, s[16:19], s63 offen nt
    buffer_load_dwordx4 v[32:35], v1, s[12:15], s59 offen nt
    buffer_load_dwordx4 v[16:19], v1, s[8:11], s59 offen nt
    buffer_load_dwordx2 v[42:43], v2, s[16:19], s64 offen nt
    s_mov_b32 s86, 0
    s_mov_b32 s87, 4
    s_mul_i32 s78, s41, 16384
    s_add_u32 s49, s78, 16384
    s_cmp_ge_u32 s41, 3125
    s_cmovk_i32 s49, 0
    s_cmovk_i32 s78, 0
    s_lshl_b32 s10, s49, 2
    s_lshl_b32 s14, s49, 2
    s_lshl_b32 s18, s49, 1
    s_sub_u32 s79, s87, s86
    s_bfm_b32 s85, s79, s86
    s_lshl_b32 s86, s86, 12
    s_lshl_b32 s87, s87, 12
    s_min_u32 s87, s87, 16384

    s_add_u32 s79, s78, 0
    s_bitcmp1_b32 s85, 0
    s_cselect_b32 s79, s79, 0x1ff00000
    s_lshl_b32 s56, s79, 2
    s_lshl_b32 s61, s79, 1

    s_add_u32 s79, s78, 4096
    s_bitcmp1_b32 s85, 1
    s_cselect_b32 s79, s79, 0x1ff00000
    s_lshl_b32 s57, s79, 2
    s_lshl_b32 s62, s79, 1

    s_add_u32 s79, s78, 8192
    s_bitcmp1_b32 s85, 2
    s_cselect_b32 s79, s79, 0x1ff00000
    s_lshl_b32 s58, s79, 2
    s_lshl_b32 s63, s79, 1

    s_add_u32 s79, s78, 12288
    s_bitcmp1_b32 s85, 3
    s_cselect_b32 s79, s79, 0x1ff00000
    s_lshl_b32 s59, s79, 2
    s_lshl_b32 s64, s79, 1

    s_getreg_b32 s5, hwreg(HW_REG_XCC_ID)
    s_and_b32 s5, s5, 7
    s_mul_i32 s3, s5, 4096

    s_add_u32 s20, s6, s3
    s_addc_u32 s21, s7, 0
    s_mov_b32 s22, 4096
    s_mov_b32 s23, 0x20000
    s_mul_i32 s3, s5, 67117056
    s_add_u32 s3, s3, 85721088
    s_add_u32 s24, s6, s3
    s_addc_u32 s25, s7, 0
    s_mov_b32 s26, 67117056
    s_mov_b32 s27, 0x20000
    s_add_u32 s36, s6, 32768
    s_addc_u32 s37, s7, 0
    s_mov_b32 s38, 4
    s_mov_b32 s39, 0x20000
    s_mov_b32 s40, 687195
    s_mov_b32 s42, -6250
    s_mov_b32 s43, 1942
    s_mov_b32 s45, 0x06050400
    s_mov_b32 s46, 0x05040c00
    s_mov_b32 s47, 0x04020100
    s_mov_b32 s48, 6524
    s_mov_b32 s50, 0
    v_mov_b32 v104, 1
    v_mov_b32 v105, 0x46ff8000
    s_mov_b32 s55, 0x05040100
    v_mul_u32_u24 v106, 5, v0
    v_mov_b32 v108, 16384
    v_mov_b32 v114, 0
    v_mov_b32 v115, 0
    v_mov_b32 v116, 0
    v_mov_b32 v117, -1
    ds_write_b64 v2, v[114:115]
    s_movk_i32 s3, 1024
    v_cmp_gt_u32 s[66:67], s3, v0
    s_movk_i32 s3, 1024
    v_cmp_gt_u32 s[68:69], s3, v0
    s_mov_b64 exec, 1
    ds_write_b128 v108, v[114:117]
    s_mov_b64 exec, -1
    s_waitcnt lgkmcnt(0)
    s_lshl_b32 s88, s88, 16
    v_mov_b32 v110, 0.15915494
    v_mul_f32 v110, s88, v110
    s_mov_b32 s3, 0x7fff7fff
    v_readfirstlane_b32 s44, v110

    s_waitcnt vmcnt(12)
    v_mov_b32 v61, 0
    v_mov_b32 v62, 0
    v_mov_b32 v63, 0
    v_dot2_f32_bf16 v61, v44, v44, v61
    v_dot2_f32_bf16 v61, v45, v45, v61
    v_dot2_f32_bf16 v61, v46, v46, v61
    v_dot2_f32_bf16 v61, v47, v47, v61
    v_dot2_f32_bf16 v61, v48, v48, v61
    v_dot2_f32_bf16 v61, v49, v49, v61
    v_dot2_f32_bf16 v61, v50, v50, v61
    v_dot2_f32_bf16 v61, v51, v51, v61
    v_dot2_f32_bf16 v61, v52, v52, v61
    v_dot2_f32_bf16 v62, v56, v56, v62
    v_dot2_f32_bf16 v62, v57, v57, v62
    v_dot2_f32_bf16 v62, v58, v58, v62
    v_dot2_f32_bf16 v62, v59, v59, v62
    v_and_b32 v60, s3, v44
    v_and_b32 v64, s3, v45
    v_pk_max_u16 v60, v60, v64
    v_and_b32 v64, s3, v46
    v_pk_max_u16 v60, v60, v64
    v_and_b32 v64, s3, v47
    v_pk_max_u16 v60, v60, v64
    v_and_b32 v64, s3, v48
    v_pk_max_u16 v60, v60, v64
    v_and_b32 v64, s3, v49
    v_pk_max_u16 v60, v60, v64
    v_and_b32 v64, s3, v50
    v_pk_max_u16 v60, v60, v64
    v_and_b32 v64, s3, v51
    v_pk_max_u16 v60, v60, v64
    v_and_b32 v64, s3, v52
    v_pk_max_u16 v60, v60, v64
    v_lshrrev_b32 v64, 16, v60
    v_and_b32 v60, 0xffff, v60
    v_max_u32 v60, v60, v64

    s_nop 1
    v_max_u32_dpp v60, v60, v60 row_shr:1 row_mask:0xf bank_mask:0xf
    s_nop 1
    v_max_u32_dpp v60, v60, v60 row_shr:2 row_mask:0xf bank_mask:0xf
    s_nop 1
    v_max_u32_dpp v60, v60, v60 row_shr:4 row_mask:0xf bank_mask:0xf
    s_nop 1
    v_max_u32_dpp v60, v60, v60 row_shr:8 row_mask:0xf bank_mask:0xf
    s_nop 1
    v_max_u32_dpp v60, v60, v60 row_bcast:15 row_mask:0xa bank_mask:0xf
    s_nop 1
    v_max_u32_dpp v60, v60, v60 row_bcast:31 row_mask:0xc bank_mask:0xf
    s_nop 1
    v_add_f32_dpp v61, v61, v61 row_shr:1 row_mask:0xf bank_mask:0xf
    s_nop 1
    v_add_f32_dpp v61, v61, v61 row_shr:2 row_mask:0xf bank_mask:0xf
    s_nop 1
    v_add_f32_dpp v61, v61, v61 row_shr:4 row_mask:0xf bank_mask:0xf
    s_nop 1
    v_add_f32_dpp v61, v61, v61 row_shr:8 row_mask:0xf bank_mask:0xf
    s_nop 1
    v_add_f32_dpp v61, v61, v61 row_bcast:15 row_mask:0xa bank_mask:0xf
    s_nop 1
    v_add_f32_dpp v61, v61, v61 row_bcast:31 row_mask:0xc bank_mask:0xf
    s_nop 1
    v_add_f32_dpp v62, v62, v62 row_shr:1 row_mask:0xf bank_mask:0xf
    s_nop 1
    v_add_f32_dpp v62, v62, v62 row_shr:2 row_mask:0xf bank_mask:0xf
    s_nop 1
    v_add_f32_dpp v62, v62, v62 row_shr:4 row_mask:0xf bank_mask:0xf
    s_nop 1
    v_add_f32_dpp v62, v62, v62 row_shr:8 row_mask:0xf bank_mask:0xf
    s_nop 1
    v_add_f32_dpp v62, v62, v62 row_bcast:15 row_mask:0xa bank_mask:0xf
    s_nop 1
    v_add_f32_dpp v62, v62, v62 row_bcast:31 row_mask:0xc bank_mask:0xf
    v_lshrrev_b32 v64, 6, v0
    v_lshlrev_b32 v64, 4, v64
    s_mov_b32 exec_lo, 0
    s_brev_b32 exec_hi, 1
    ds_write_b128 v64, v[60:63] offset:8192
    s_mov_b64 exec, -1
    v_and_b32 v64, 15, v0
    v_lshlrev_b32 v64, 4, v64
    s_waitcnt lgkmcnt(0)
    s_barrier
    ds_read_b128 v[60:63], v64 offset:8192
    s_waitcnt lgkmcnt(0)

    s_nop 0
    v_max_u32_dpp v60, v60, v60 row_ror:1 row_mask:0xf bank_mask:0xf
    v_add_f32_dpp v61, v61, v61 row_ror:1 row_mask:0xf bank_mask:0xf
    v_add_f32_dpp v62, v62, v62 row_ror:1 row_mask:0xf bank_mask:0xf

    s_nop 0
    v_max_u32_dpp v60, v60, v60 row_ror:2 row_mask:0xf bank_mask:0xf
    v_add_f32_dpp v61, v61, v61 row_ror:2 row_mask:0xf bank_mask:0xf
    v_add_f32_dpp v62, v62, v62 row_ror:2 row_mask:0xf bank_mask:0xf

    s_nop 0
    v_max_u32_dpp v60, v60, v60 row_ror:4 row_mask:0xf bank_mask:0xf
    v_add_f32_dpp v61, v61, v61 row_ror:4 row_mask:0xf bank_mask:0xf
    v_add_f32_dpp v62, v62, v62 row_ror:4 row_mask:0xf bank_mask:0xf

    s_nop 0
    v_max_u32_dpp v60, v60, v60 row_ror:8 row_mask:0xf bank_mask:0xf
    v_add_f32_dpp v61, v61, v61 row_ror:8 row_mask:0xf bank_mask:0xf
    v_add_f32_dpp v62, v62, v62 row_ror:8 row_mask:0xf bank_mask:0xf

    v_rsq_f32 v62, v62
    v_mov_b32 v65, 0x4b400000
    v_mul_f32 v62, 0x47decb04, v62
    s_nop 0
    v_readfirstlane_b32 s74, v62

    s_add_u32 s92, s6, 135168
    s_addc_u32 s93, s7, 0
    s_mov_b32 s94, 4096
    s_mov_b32 s95, 0x20000
    s_lshl_b32 s3, s2, 4
    buffer_store_dwordx4 v[60:63], v98, s[92:95], s3 offen
    v_lshlrev_b32 v66, 16, v44
    v_and_b32 v44, 0xffff0000, v44
    v_fma_f32 v66, v66, s74, v65
    v_fma_f32 v44, v44, s74, v65
    v_perm_b32 v44, v44, v66, s55

    v_lshlrev_b32 v66, 16, v45
    v_and_b32 v45, 0xffff0000, v45
    v_fma_f32 v66, v66, s74, v65
    v_fma_f32 v45, v45, s74, v65
    v_perm_b32 v45, v45, v66, s55

    v_lshlrev_b32 v66, 16, v46
    v_and_b32 v46, 0xffff0000, v46
    v_fma_f32 v66, v66, s74, v65
    v_fma_f32 v46, v46, s74, v65
    v_perm_b32 v46, v46, v66, s55

    v_lshlrev_b32 v66, 16, v47
    v_and_b32 v47, 0xffff0000, v47
    v_fma_f32 v66, v66, s74, v65
    v_fma_f32 v47, v47, s74, v65
    v_perm_b32 v47, v47, v66, s55

    v_lshlrev_b32 v66, 16, v48
    v_and_b32 v48, 0xffff0000, v48
    v_fma_f32 v66, v66, s74, v65
    v_fma_f32 v48, v48, s74, v65
    v_perm_b32 v48, v48, v66, s55

    v_lshlrev_b32 v66, 16, v49
    v_and_b32 v49, 0xffff0000, v49
    v_fma_f32 v66, v66, s74, v65
    v_fma_f32 v49, v49, s74, v65
    v_perm_b32 v49, v49, v66, s55

    v_lshlrev_b32 v66, 16, v50
    v_and_b32 v50, 0xffff0000, v50
    v_fma_f32 v66, v66, s74, v65
    v_fma_f32 v50, v50, s74, v65
    v_perm_b32 v50, v50, v66, s55

    v_lshlrev_b32 v66, 16, v51
    v_and_b32 v51, 0xffff0000, v51
    v_fma_f32 v66, v66, s74, v65
    v_fma_f32 v51, v51, s74, v65
    v_perm_b32 v51, v51, v66, s55

    v_lshlrev_b32 v66, 16, v52
    v_and_b32 v52, 0xffff0000, v52
    v_fma_f32 v66, v66, s74, v65
    v_fma_f32 v52, v52, s74, v65
    v_perm_b32 v52, v52, v66, s55

    s_add_u32 s92, s6, s54
    s_addc_u32 s93, s7, 0
    s_mov_b32 s94, 24576
    s_mov_b32 s95, 0x20000
    s_movk_i32 s3, 16384
    buffer_store_dwordx4 v[44:47], v1, s[92:95], 0 offen
    buffer_store_dwordx4 v[48:51], v1, s[92:95], s3 offen
    s_mul_i32 s94, s53, 25424
    s_movk_i32 s3, 24576

    buffer_store_dword v52, v100, s[92:95], s3 offen
    s_nop 1
    v_mov_b32 v100, 0
    buffer_atomic_add v100, v98, s[96:99], 0 offen offset:128 sc0
    s_bitcmp0_b32 s82, 0
    s_cbranch_scc1 L_ska_8
    s_waitcnt vmcnt(14)
    v_mul_hi_u32_u24 v45, s40, v20
    v_mul_hi_u32_u24 v44, s40, v4
    v_mul_hi_u32_u24 v47, s40, v21
    v_mul_hi_u32_u24 v46, s40, v5
    v_mul_hi_u32_u24 v49, s40, v22
    v_mul_hi_u32_u24 v48, s40, v6
    v_mul_hi_u32_u24 v51, s40, v23
    v_mul_hi_u32_u24 v50, s40, v7
    v_and_b32 v45, -2, v45
    v_mad_u32_u24 v4, v44, s43, v4
    v_and_b32 v76, -4, v44
    v_and_b32 v47, -2, v47
    v_mad_u32_u24 v5, v46, s43, v5
    v_and_b32 v77, -4, v46
    v_and_b32 v49, -2, v49
    v_mad_u32_u24 v6, v48, s43, v6
    v_and_b32 v78, -4, v48
    v_and_b32 v51, -2, v51
    v_mad_u32_u24 v7, v50, s43, v7
    v_and_b32 v79, -4, v50
    v_mad_i32_i24 v20, v45, s42, v20
    v_lshl_add_u32 v45, v76, 5, v45
    v_mad_i32_i24 v21, v47, s42, v21
    v_lshl_add_u32 v47, v77, 5, v47
    v_mad_i32_i24 v22, v49, s42, v22
    v_lshl_add_u32 v49, v78, 5, v49
    v_mad_i32_i24 v23, v51, s42, v23
    v_lshl_add_u32 v51, v79, 5, v51
    v_add_u32 v45, v45, v45
    ds_add_rtn_u32 v76, v45, v104
    v_add_u32 v47, v47, v47
    ds_add_rtn_u32 v77, v47, v104
    v_add_u32 v49, v49, v49
    ds_add_rtn_u32 v78, v49, v104
    v_add_u32 v51, v51, v51
    ds_add_rtn_u32 v79, v51, v104
    v_lshlrev_b32 v110, 16, v36
    v_and_b32 v111, 0xffff0000, v36
    v_lshlrev_b32 v112, 16, v37
    v_and_b32 v113, 0xffff0000, v37
    v_mul_f32 v110, s44, v110
    v_mul_f32 v111, s44, v111
    v_mul_f32 v112, s44, v112
    v_mul_f32 v113, s44, v113
    v_fract_f32 v110, v110
    v_fract_f32 v111, v111
    v_fract_f32 v112, v112
    v_fract_f32 v113, v113
    v_cos_f32 v110, v110
    v_cos_f32 v111, v111
    v_cos_f32 v112, v112
    v_cos_f32 v113, v113
    v_lshl_or_b32 v44, v44, 14, v20
    v_perm_b32 v45, v45, v4, s46
    v_bfe_u32 v4, v4, 8, 5

    v_lshl_or_b32 v46, v46, 14, v21
    v_perm_b32 v47, v47, v5, s46
    v_bfe_u32 v5, v5, 8, 5

    v_lshl_or_b32 v48, v48, 14, v22
    v_perm_b32 v49, v49, v6, s46
    v_bfe_u32 v6, v6, 8, 5

    v_lshl_or_b32 v50, v50, 14, v23
    v_perm_b32 v51, v51, v7, s46
    v_bfe_u32 v7, v7, 8, 5

    v_fmaak_f32 v110, v110, v105, 0x4b400010
    v_fmaak_f32 v111, v111, v105, 0x4b400010
    v_fmaak_f32 v112, v112, v105, 0x4b400010
    v_fmaak_f32 v113, v113, v105, 0x4b400010
    v_sub_u32 v110, v110, v4
    v_sub_u32 v111, v111, v5
    v_sub_u32 v112, v112, v6
    v_sub_u32 v113, v113, v7
    v_bfi_b32 v110, 31, v4, v110
    v_bfi_b32 v111, 31, v5, v111
    v_bfi_b32 v112, 31, v6, v112
    v_bfi_b32 v113, 31, v7, v113
    v_perm_b32 v44, v44, v110, s55
    v_perm_b32 v46, v46, v111, s55
    v_perm_b32 v48, v48, v112, s55
    v_perm_b32 v50, v50, v113, s55
    buffer_load_dwordx4 v[20:23], v1, s[12:15], s56 offen nt
    buffer_load_dwordx4 v[4:7], v1, s[8:11], s56 offen nt
    buffer_load_dwordx2 v[36:37], v2, s[16:19], s61 offen nt
L_bka_9:
    s_bitcmp0_b32 s82, 1
    s_cbranch_scc1 L_ska_10
    s_waitcnt vmcnt(14)
    v_mul_hi_u32_u24 v53, s40, v24
    v_mul_hi_u32_u24 v52, s40, v8
    v_mul_hi_u32_u24 v55, s40, v25
    v_mul_hi_u32_u24 v54, s40, v9
    v_mul_hi_u32_u24 v57, s40, v26
    v_mul_hi_u32_u24 v56, s40, v10
    v_mul_hi_u32_u24 v59, s40, v27
    v_mul_hi_u32_u24 v58, s40, v11
    v_and_b32 v53, -2, v53
    v_mad_u32_u24 v8, v52, s43, v8
    v_and_b32 v80, -4, v52
    v_and_b32 v55, -2, v55
    v_mad_u32_u24 v9, v54, s43, v9
    v_and_b32 v81, -4, v54
    v_and_b32 v57, -2, v57
    v_mad_u32_u24 v10, v56, s43, v10
    v_and_b32 v82, -4, v56
    v_and_b32 v59, -2, v59
    v_mad_u32_u24 v11, v58, s43, v11
    v_and_b32 v83, -4, v58
    v_mad_i32_i24 v24, v53, s42, v24
    v_lshl_add_u32 v53, v80, 5, v53
    v_mad_i32_i24 v25, v55, s42, v25
    v_lshl_add_u32 v55, v81, 5, v55
    v_mad_i32_i24 v26, v57, s42, v26
    v_lshl_add_u32 v57, v82, 5, v57
    v_mad_i32_i24 v27, v59, s42, v27
    v_lshl_add_u32 v59, v83, 5, v59
    v_add_u32 v53, v53, v53
    ds_add_rtn_u32 v80, v53, v104
    v_add_u32 v55, v55, v55
    ds_add_rtn_u32 v81, v55, v104
    v_add_u32 v57, v57, v57
    ds_add_rtn_u32 v82, v57, v104
    v_add_u32 v59, v59, v59
    ds_add_rtn_u32 v83, v59, v104
    v_lshlrev_b32 v110, 16, v38
    v_and_b32 v111, 0xffff0000, v38
    v_lshlrev_b32 v112, 16, v39
    v_and_b32 v113, 0xffff0000, v39
    v_mul_f32 v110, s44, v110
    v_mul_f32 v111, s44, v111
    v_mul_f32 v112, s44, v112
    v_mul_f32 v113, s44, v113
    v_fract_f32 v110, v110
    v_fract_f32 v111, v111
    v_fract_f32 v112, v112
    v_fract_f32 v113, v113
    v_cos_f32 v110, v110
    v_cos_f32 v111, v111
    v_cos_f32 v112, v112
    v_cos_f32 v113, v113
    v_lshl_or_b32 v52, v52, 14, v24
    v_perm_b32 v53, v53, v8, s46
    v_bfe_u32 v8, v8, 8, 5

    v_lshl_or_b32 v54, v54, 14, v25
    v_perm_b32 v55, v55, v9, s46
    v_bfe_u32 v9, v9, 8, 5

    v_lshl_or_b32 v56, v56, 14, v26
    v_perm_b32 v57, v57, v10, s46
    v_bfe_u32 v10, v10, 8, 5

    v_lshl_or_b32 v58, v58, 14, v27
    v_perm_b32 v59, v59, v11, s46
    v_bfe_u32 v11, v11, 8, 5

    v_fmaak_f32 v110, v110, v105, 0x4b400010
    v_fmaak_f32 v111, v111, v105, 0x4b400010
    v_fmaak_f32 v112, v112, v105, 0x4b400010
    v_fmaak_f32 v113, v113, v105, 0x4b400010
    v_sub_u32 v110, v110, v8
    v_sub_u32 v111, v111, v9
    v_sub_u32 v112, v112, v10
    v_sub_u32 v113, v113, v11
    v_bfi_b32 v110, 31, v8, v110
    v_bfi_b32 v111, 31, v9, v111
    v_bfi_b32 v112, 31, v10, v112
    v_bfi_b32 v113, 31, v11, v113
    v_perm_b32 v52, v52, v110, s55
    v_perm_b32 v54, v54, v111, s55
    v_perm_b32 v56, v56, v112, s55
    v_perm_b32 v58, v58, v113, s55
    buffer_load_dwordx4 v[24:27], v1, s[12:15], s57 offen nt
    buffer_load_dwordx4 v[8:11], v1, s[8:11], s57 offen nt
    buffer_load_dwordx2 v[38:39], v2, s[16:19], s62 offen nt
L_bka_11:
    s_bitcmp0_b32 s82, 2
    s_cbranch_scc1 L_ska_12
    s_waitcnt vmcnt(14)
    v_mul_hi_u32_u24 v61, s40, v28
    v_mul_hi_u32_u24 v60, s40, v12
    v_mul_hi_u32_u24 v63, s40, v29
    v_mul_hi_u32_u24 v62, s40, v13
    v_mul_hi_u32_u24 v65, s40, v30
    v_mul_hi_u32_u24 v64, s40, v14
    v_mul_hi_u32_u24 v67, s40, v31
    v_mul_hi_u32_u24 v66, s40, v15
    v_and_b32 v61, -2, v61
    v_mad_u32_u24 v12, v60, s43, v12
    v_and_b32 v84, -4, v60
    v_and_b32 v63, -2, v63
    v_mad_u32_u24 v13, v62, s43, v13
    v_and_b32 v85, -4, v62
    v_and_b32 v65, -2, v65
    v_mad_u32_u24 v14, v64, s43, v14
    v_and_b32 v86, -4, v64
    v_and_b32 v67, -2, v67
    v_mad_u32_u24 v15, v66, s43, v15
    v_and_b32 v87, -4, v66
    v_mad_i32_i24 v28, v61, s42, v28
    v_lshl_add_u32 v61, v84, 5, v61
    v_mad_i32_i24 v29, v63, s42, v29
    v_lshl_add_u32 v63, v85, 5, v63
    v_mad_i32_i24 v30, v65, s42, v30
    v_lshl_add_u32 v65, v86, 5, v65
    v_mad_i32_i24 v31, v67, s42, v31
    v_lshl_add_u32 v67, v87, 5, v67
    v_add_u32 v61, v61, v61
    ds_add_rtn_u32 v84, v61, v104
    v_add_u32 v63, v63, v63
    ds_add_rtn_u32 v85, v63, v104
    v_add_u32 v65, v65, v65
    ds_add_rtn_u32 v86, v65, v104
    v_add_u32 v67, v67, v67
    ds_add_rtn_u32 v87, v67, v104
    v_lshlrev_b32 v110, 16, v40
    v_and_b32 v111, 0xffff0000, v40
    v_lshlrev_b32 v112, 16, v41
    v_and_b32 v113, 0xffff0000, v41
    v_mul_f32 v110, s44, v110
    v_mul_f32 v111, s44, v111
    v_mul_f32 v112, s44, v112
    v_mul_f32 v113, s44, v113
    v_fract_f32 v110, v110
    v_fract_f32 v111, v111
    v_fract_f32 v112, v112
    v_fract_f32 v113, v113
    v_cos_f32 v110, v110
    v_cos_f32 v111, v111
    v_cos_f32 v112, v112
    v_cos_f32 v113, v113
    v_lshl_or_b32 v60, v60, 14, v28
    v_perm_b32 v61, v61, v12, s46
    v_bfe_u32 v12, v12, 8, 5

    v_lshl_or_b32 v62, v62, 14, v29
    v_perm_b32 v63, v63, v13, s46
    v_bfe_u32 v13, v13, 8, 5

    v_lshl_or_b32 v64, v64, 14, v30
    v_perm_b32 v65, v65, v14, s46
    v_bfe_u32 v14, v14, 8, 5

    v_lshl_or_b32 v66, v66, 14, v31
    v_perm_b32 v67, v67, v15, s46
    v_bfe_u32 v15, v15, 8, 5

    v_fmaak_f32 v110, v110, v105, 0x4b400010
    v_fmaak_f32 v111, v111, v105, 0x4b400010
    v_fmaak_f32 v112, v112, v105, 0x4b400010
    v_fmaak_f32 v113, v113, v105, 0x4b400010
    v_sub_u32 v110, v110, v12
    v_sub_u32 v111, v111, v13
    v_sub_u32 v112, v112, v14
    v_sub_u32 v113, v113, v15
    v_bfi_b32 v110, 31, v12, v110
    v_bfi_b32 v111, 31, v13, v111
    v_bfi_b32 v112, 31, v14, v112
    v_bfi_b32 v113, 31, v15, v113
    v_perm_b32 v60, v60, v110, s55
    v_perm_b32 v62, v62, v111, s55
    v_perm_b32 v64, v64, v112, s55
    v_perm_b32 v66, v66, v113, s55
    buffer_load_dwordx4 v[28:31], v1, s[12:15], s58 offen nt
    buffer_load_dwordx4 v[12:15], v1, s[8:11], s58 offen nt
    buffer_load_dwordx2 v[40:41], v2, s[16:19], s63 offen nt
L_bka_13:
    s_bitcmp0_b32 s82, 3
    s_cbranch_scc1 L_ska_14
    s_waitcnt vmcnt(14)
    s_mov_b64 exec, s[66:67]
    v_mul_hi_u32_u24 v69, s40, v32
    v_mul_hi_u32_u24 v68, s40, v16
    v_mul_hi_u32_u24 v71, s40, v33
    v_mul_hi_u32_u24 v70, s40, v17
    v_mul_hi_u32_u24 v73, s40, v34
    v_mul_hi_u32_u24 v72, s40, v18
    v_mul_hi_u32_u24 v75, s40, v35
    v_mul_hi_u32_u24 v74, s40, v19
    v_and_b32 v69, -2, v69
    v_mad_u32_u24 v16, v68, s43, v16
    v_and_b32 v88, -4, v68
    v_and_b32 v71, -2, v71
    v_mad_u32_u24 v17, v70, s43, v17
    v_and_b32 v89, -4, v70
    v_and_b32 v73, -2, v73
    v_mad_u32_u24 v18, v72, s43, v18
    v_and_b32 v90, -4, v72
    v_and_b32 v75, -2, v75
    v_mad_u32_u24 v19, v74, s43, v19
    v_and_b32 v91, -4, v74
    v_mad_i32_i24 v32, v69, s42, v32
    v_lshl_add_u32 v69, v88, 5, v69
    v_mad_i32_i24 v33, v71, s42, v33
    v_lshl_add_u32 v71, v89, 5, v71
    v_mad_i32_i24 v34, v73, s42, v34
    v_lshl_add_u32 v73, v90, 5, v73
    v_mad_i32_i24 v35, v75, s42, v35
    v_lshl_add_u32 v75, v91, 5, v75
    v_add_u32 v69, v69, v69
    ds_add_rtn_u32 v88, v69, v104
    v_add_u32 v71, v71, v71
    ds_add_rtn_u32 v89, v71, v104
    v_add_u32 v73, v73, v73
    ds_add_rtn_u32 v90, v73, v104
    v_add_u32 v75, v75, v75
    ds_add_rtn_u32 v91, v75, v104
    v_lshlrev_b32 v110, 16, v42
    v_and_b32 v111, 0xffff0000, v42
    v_lshlrev_b32 v112, 16, v43
    v_and_b32 v113, 0xffff0000, v43
    v_mul_f32 v110, s44, v110
    v_mul_f32 v111, s44, v111
    v_mul_f32 v112, s44, v112
    v_mul_f32 v113, s44, v113
    v_fract_f32 v110, v110
    v_fract_f32 v111, v111
    v_fract_f32 v112, v112
    v_fract_f32 v113, v113
    v_cos_f32 v110, v110
    v_cos_f32 v111, v111
    v_cos_f32 v112, v112
    v_cos_f32 v113, v113
    v_lshl_or_b32 v68, v68, 14, v32
    v_perm_b32 v69, v69, v16, s46
    v_bfe_u32 v16, v16, 8, 5

    v_lshl_or_b32 v70, v70, 14, v33
    v_perm_b32 v71, v71, v17, s46
    v_bfe_u32 v17, v17, 8, 5

    v_lshl_or_b32 v72, v72, 14, v34
    v_perm_b32 v73, v73, v18, s46
    v_bfe_u32 v18, v18, 8, 5

    v_lshl_or_b32 v74, v74, 14, v35
    v_perm_b32 v75, v75, v19, s46
    v_bfe_u32 v19, v19, 8, 5

    v_fmaak_f32 v110, v110, v105, 0x4b400010
    v_fmaak_f32 v111, v111, v105, 0x4b400010
    v_fmaak_f32 v112, v112, v105, 0x4b400010
    v_fmaak_f32 v113, v113, v105, 0x4b400010
    v_sub_u32 v110, v110, v16
    v_sub_u32 v111, v111, v17
    v_sub_u32 v112, v112, v18
    v_sub_u32 v113, v113, v19
    v_bfi_b32 v110, 31, v16, v110
    v_bfi_b32 v111, 31, v17, v111
    v_bfi_b32 v112, 31, v18, v112
    v_bfi_b32 v113, 31, v19, v113
    v_perm_b32 v68, v68, v110, s55
    v_perm_b32 v70, v70, v111, s55
    v_perm_b32 v72, v72, v112, s55
    v_perm_b32 v74, v74, v113, s55
    s_mov_b64 exec, -1
    buffer_load_dwordx4 v[32:35], v1, s[12:15], s59 offen nt
    buffer_load_dwordx4 v[16:19], v1, s[8:11], s59 offen nt
    buffer_load_dwordx2 v[42:43], v2, s[16:19], s64 offen nt
L_bka_15:
    v_readfirstlane_b32 s74, v0
    s_nop 1
    s_cmp_lg_u32 s74, 0
    s_cbranch_scc1 L_ready_17

    s_waitcnt vmcnt(12)
    v_readfirstlane_b32 s74, v100
    s_nop 1
    s_cmp_lg_u32 s74, 0
    s_cbranch_scc1 L_ready_17

    v_mov_b32 v110, 1
    buffer_atomic_add v110, v98, s[96:99], 0 offen offset:64 sc0
    s_waitcnt vmcnt(0)
    v_readfirstlane_b32 s74, v110
    s_nop 1
    s_cmp_lg_u32 s74, 0
    s_cbranch_scc1 L_zno_19

    s_mov_b32 s92, s6
    s_mov_b32 s93, s7
    s_mov_b32 s94, 32784
    s_mov_b32 s95, 0x20000
    v_mov_b32 v110, 0
    v_mov_b32 v111, 0
    v_mov_b32 v112, 0
    v_mov_b32 v113, 0
L_zl_18:
    buffer_store_dwordx4 v[110:113], v1, s[92:95], s74 offen sc0 sc1
    s_add_u32 s74, s74, 1024
    s_cmp_le_u32 s74, 32768
    s_cbranch_scc1 L_zl_18
    v_mov_b32 v114, 1
    s_waitcnt vmcnt(0)
    buffer_atomic_add v114, v98, s[96:99], 0 offen offset:128
L_zno_19:

L_spin_16:
    v_mov_b32 v100, 0
    buffer_atomic_add v100, v98, s[96:99], 0 offen offset:128 sc0
    s_waitcnt vmcnt(0)
    v_readfirstlane_b32 s74, v100
    s_nop 1
    s_cmp_eq_u32 s74, 0
    s_cbranch_scc1 L_spin_16
L_ready_17:

    s_waitcnt lgkmcnt(0)
    s_barrier

    ds_read_b64 v[94:95], v2
    s_waitcnt lgkmcnt(0)
    v_and_b32 v94, 0xffff, v94
    v_and_b32 v95, 0xffff, v95
    v_add_u32 v97, v94, v95
    s_nop 1
    v_add_u32_dpp v97, v97, v97 row_shr:1 row_mask:0xf bank_mask:0xf
    s_nop 1
    v_add_u32_dpp v97, v97, v97 row_shr:2 row_mask:0xf bank_mask:0xf
    s_nop 1
    v_add_u32_dpp v97, v97, v97 row_shr:4 row_mask:0xf bank_mask:0xf
    s_nop 1
    v_add_u32_dpp v97, v97, v97 row_shr:8 row_mask:0xf bank_mask:0xf
    s_nop 1
    v_add_u32_dpp v97, v97, v97 row_bcast:15 row_mask:0xa bank_mask:0xf
    s_nop 1
    v_add_u32_dpp v97, v97, v97 row_bcast:31 row_mask:0xc bank_mask:0xf
    s_mov_b32 exec_lo, 0
    s_brev_b32 exec_hi, 1
    ds_add_rtn_u32 v96, v108, v97
    s_mov_b64 exec, -1

    v_add_u32 v92, v94, v94
    v_add_u32 v93, v95, v95
    v_med3_u32 v92, v94, 2, v92
    v_med3_u32 v93, v95, 2, v93
    v_lshl_or_b32 v92, v93, 16, v92
    v_lshlrev_b32 v93, 2, v0
    buffer_atomic_add v92, v93, s[20:23], 0 offen sc0
    s_waitcnt lgkmcnt(0)
    v_readlane_b32 s77, v96, 63
    v_mul_u32_u24 v114, 65528, v0
    v_sub_u32 v97, v97, v95
    s_sub_u32 s50, s50, s83
    s_sub_u32 s77, s77, s50
    v_add_u32 v97, s77, v97
    v_sub_u32 v96, v97, v94
    v_lshlrev_b32 v111, 16, v97
    v_lshlrev_b32 v110, 16, v96
    ds_write_b64 v2, v[110:111]
    v_add_u32 v115, 32764, v114
    v_and_b32 v114, 0xffffff80, v114
    v_and_b32 v115, 0xffffff80, v115
    v_mad_i32_i24 v96, v96, -5, v114
    v_mad_i32_i24 v97, v97, -5, v115
    s_add_u32 s50, s50, s84
    s_mov_b32 s28, s82
    s_mov_b32 s29, s83
    s_mov_b32 s30, s84
    s_lshl_b32 s74, s29, 3
    s_lshl_b32 s75, s30, 3
    v_mov_b32 v125, s74
    v_mov_b32 v126, s75
    v_mov_b32 v127, -1

    s_waitcnt lgkmcnt(0)
    s_barrier

    s_mov_b64 exec, 1
    ds_write_b32 v125, v127 offset:16396
    ds_write_b32 v126, v127 offset:16404
    s_mov_b64 exec, -1

    s_bitcmp0_b32 s28, 0
    s_cbranch_scc1 L_skz_20
    v_lshrrev_b32 v110, 16, v45
    ds_read_b32 v110, v110
    v_lshrrev_b32 v111, 16, v47
    ds_read_b32 v111, v111
    v_lshrrev_b32 v112, 16, v49
    ds_read_b32 v112, v112
    v_lshrrev_b32 v113, 16, v51
    ds_read_b32 v113, v113
    s_waitcnt lgkmcnt(3)
    v_add_u32_sdwa v110, v110, v76 dst_sel:DWORD dst_unused:UNUSED_PAD src0_sel:WORD_1 src1_sel:WORD_0
    v_lshlrev_b32 v110, 3, v110
    ds_write_b64 v110, v[44:45] offset:16400

    s_waitcnt lgkmcnt(3)
    v_add_u32_sdwa v111, v111, v77 dst_sel:DWORD dst_unused:UNUSED_PAD src0_sel:WORD_1 src1_sel:WORD_0
    v_lshlrev_b32 v111, 3, v111
    ds_write_b64 v111, v[46:47] offset:16400

    s_waitcnt lgkmcnt(3)
    v_add_u32_sdwa v112, v112, v78 dst_sel:DWORD dst_unused:UNUSED_PAD src0_sel:WORD_1 src1_sel:WORD_0
    v_lshlrev_b32 v112, 3, v112
    ds_write_b64 v112, v[48:49] offset:16400

    s_waitcnt lgkmcnt(3)
    v_add_u32_sdwa v113, v113, v79 dst_sel:DWORD dst_unused:UNUSED_PAD src0_sel:WORD_1 src1_sel:WORD_0
    v_lshlrev_b32 v113, 3, v113
    ds_write_b64 v113, v[50:51] offset:16400

L_skz_20:
    s_bitcmp0_b32 s28, 1
    s_cbranch_scc1 L_skz_21
    v_lshrrev_b32 v110, 16, v53
    ds_read_b32 v110, v110
    v_lshrrev_b32 v111, 16, v55
    ds_read_b32 v111, v111
    v_lshrrev_b32 v112, 16, v57
    ds_read_b32 v112, v112
    v_lshrrev_b32 v113, 16, v59
    ds_read_b32 v113, v113
    s_waitcnt lgkmcnt(3)
    v_add_u32_sdwa v110, v110, v80 dst_sel:DWORD dst_unused:UNUSED_PAD src0_sel:WORD_1 src1_sel:WORD_0
    v_lshlrev_b32 v110, 3, v110
    ds_write_b64 v110, v[52:53] offset:16400

    s_waitcnt lgkmcnt(3)
    v_add_u32_sdwa v111, v111, v81 dst_sel:DWORD dst_unused:UNUSED_PAD src0_sel:WORD_1 src1_sel:WORD_0
    v_lshlrev_b32 v111, 3, v111
    ds_write_b64 v111, v[54:55] offset:16400

    s_waitcnt lgkmcnt(3)
    v_add_u32_sdwa v112, v112, v82 dst_sel:DWORD dst_unused:UNUSED_PAD src0_sel:WORD_1 src1_sel:WORD_0
    v_lshlrev_b32 v112, 3, v112
    ds_write_b64 v112, v[56:57] offset:16400

    s_waitcnt lgkmcnt(3)
    v_add_u32_sdwa v113, v113, v83 dst_sel:DWORD dst_unused:UNUSED_PAD src0_sel:WORD_1 src1_sel:WORD_0
    v_lshlrev_b32 v113, 3, v113
    ds_write_b64 v113, v[58:59] offset:16400

L_skz_21:
    s_bitcmp0_b32 s28, 2
    s_cbranch_scc1 L_skz_22
    v_lshrrev_b32 v110, 16, v61
    ds_read_b32 v110, v110
    v_lshrrev_b32 v111, 16, v63
    ds_read_b32 v111, v111
    v_lshrrev_b32 v112, 16, v65
    ds_read_b32 v112, v112
    v_lshrrev_b32 v113, 16, v67
    ds_read_b32 v113, v113
    s_waitcnt lgkmcnt(3)
    v_add_u32_sdwa v110, v110, v84 dst_sel:DWORD dst_unused:UNUSED_PAD src0_sel:WORD_1 src1_sel:WORD_0
    v_lshlrev_b32 v110, 3, v110
    ds_write_b64 v110, v[60:61] offset:16400

    s_waitcnt lgkmcnt(3)
    v_add_u32_sdwa v111, v111, v85 dst_sel:DWORD dst_unused:UNUSED_PAD src0_sel:WORD_1 src1_sel:WORD_0
    v_lshlrev_b32 v111, 3, v111
    ds_write_b64 v111, v[62:63] offset:16400

    s_waitcnt lgkmcnt(3)
    v_add_u32_sdwa v112, v112, v86 dst_sel:DWORD dst_unused:UNUSED_PAD src0_sel:WORD_1 src1_sel:WORD_0
    v_lshlrev_b32 v112, 3, v112
    ds_write_b64 v112, v[64:65] offset:16400

    s_waitcnt lgkmcnt(3)
    v_add_u32_sdwa v113, v113, v87 dst_sel:DWORD dst_unused:UNUSED_PAD src0_sel:WORD_1 src1_sel:WORD_0
    v_lshlrev_b32 v113, 3, v113
    ds_write_b64 v113, v[66:67] offset:16400

L_skz_22:
    s_bitcmp0_b32 s28, 3
    s_cbranch_scc1 L_skz_23
    s_mov_b64 exec, s[66:67]
    v_lshrrev_b32 v110, 16, v69
    ds_read_b32 v110, v110
    v_lshrrev_b32 v111, 16, v71
    ds_read_b32 v111, v111
    v_lshrrev_b32 v112, 16, v73
    ds_read_b32 v112, v112
    v_lshrrev_b32 v113, 16, v75
    ds_read_b32 v113, v113
    s_waitcnt lgkmcnt(3)
    v_add_u32_sdwa v110, v110, v88 dst_sel:DWORD dst_unused:UNUSED_PAD src0_sel:WORD_1 src1_sel:WORD_0
    v_lshlrev_b32 v110, 3, v110
    ds_write_b64 v110, v[68:69] offset:16400

    s_waitcnt lgkmcnt(3)
    v_add_u32_sdwa v111, v111, v89 dst_sel:DWORD dst_unused:UNUSED_PAD src0_sel:WORD_1 src1_sel:WORD_0
    v_lshlrev_b32 v111, 3, v111
    ds_write_b64 v111, v[70:71] offset:16400

    s_waitcnt lgkmcnt(3)
    v_add_u32_sdwa v112, v112, v90 dst_sel:DWORD dst_unused:UNUSED_PAD src0_sel:WORD_1 src1_sel:WORD_0
    v_lshlrev_b32 v112, 3, v112
    ds_write_b64 v112, v[72:73] offset:16400

    s_waitcnt lgkmcnt(3)
    v_add_u32_sdwa v113, v113, v91 dst_sel:DWORD dst_unused:UNUSED_PAD src0_sel:WORD_1 src1_sel:WORD_0
    v_lshlrev_b32 v113, 3, v113
    ds_write_b64 v113, v[74:75] offset:16400

    s_mov_b64 exec, -1
L_skz_23:
    s_cmp_eq_u32 s49, 0
    s_cbranch_scc1 L_p1epi_7
L_p1loop_6:
    s_mov_b32 s82, s85
    s_mov_b32 s83, s86
    s_mov_b32 s84, s87
    v_mov_b32 v99, 1
    buffer_atomic_add v99, v98, s[96:99], 0 offen sc0
    s_bitcmp0_b32 s82, 0
    s_cbranch_scc1 L_ska_24
    s_waitcnt vmcnt(11)
    v_mul_hi_u32_u24 v45, s40, v20
    v_mul_hi_u32_u24 v44, s40, v4
    v_mul_hi_u32_u24 v47, s40, v21
    v_mul_hi_u32_u24 v46, s40, v5
    v_mul_hi_u32_u24 v49, s40, v22
    v_mul_hi_u32_u24 v48, s40, v6
    v_mul_hi_u32_u24 v51, s40, v23
    v_mul_hi_u32_u24 v50, s40, v7
    v_and_b32 v45, -2, v45
    v_mad_u32_u24 v4, v44, s43, v4
    v_and_b32 v76, -4, v44
    v_and_b32 v47, -2, v47
    v_mad_u32_u24 v5, v46, s43, v5
    v_and_b32 v77, -4, v46
    v_and_b32 v49, -2, v49
    v_mad_u32_u24 v6, v48, s43, v6
    v_and_b32 v78, -4, v48
    v_and_b32 v51, -2, v51
    v_mad_u32_u24 v7, v50, s43, v7
    v_and_b32 v79, -4, v50
    v_mad_i32_i24 v20, v45, s42, v20
    v_lshl_add_u32 v45, v76, 5, v45
    v_mad_i32_i24 v21, v47, s42, v21
    v_lshl_add_u32 v47, v77, 5, v47
    v_mad_i32_i24 v22, v49, s42, v22
    v_lshl_add_u32 v49, v78, 5, v49
    v_mad_i32_i24 v23, v51, s42, v23
    v_lshl_add_u32 v51, v79, 5, v51
    v_add_u32 v45, v45, v45
    ds_add_rtn_u32 v76, v45, v104
    v_add_u32 v47, v47, v47
    ds_add_rtn_u32 v77, v47, v104
    v_add_u32 v49, v49, v49
    ds_add_rtn_u32 v78, v49, v104
    v_add_u32 v51, v51, v51
    ds_add_rtn_u32 v79, v51, v104
    v_lshlrev_b32 v110, 16, v36
    v_and_b32 v111, 0xffff0000, v36
    v_lshlrev_b32 v112, 16, v37
    v_and_b32 v113, 0xffff0000, v37
    v_mul_f32 v110, s44, v110
    v_mul_f32 v111, s44, v111
    v_mul_f32 v112, s44, v112
    v_mul_f32 v113, s44, v113
    v_fract_f32 v110, v110
    v_fract_f32 v111, v111
    v_fract_f32 v112, v112
    v_fract_f32 v113, v113
    v_cos_f32 v110, v110
    v_cos_f32 v111, v111
    v_cos_f32 v112, v112
    v_cos_f32 v113, v113
    v_lshl_or_b32 v44, v44, 14, v20
    v_perm_b32 v45, v45, v4, s46
    v_bfe_u32 v4, v4, 8, 5

    v_lshl_or_b32 v46, v46, 14, v21
    v_perm_b32 v47, v47, v5, s46
    v_bfe_u32 v5, v5, 8, 5

    v_lshl_or_b32 v48, v48, 14, v22
    v_perm_b32 v49, v49, v6, s46
    v_bfe_u32 v6, v6, 8, 5

    v_lshl_or_b32 v50, v50, 14, v23
    v_perm_b32 v51, v51, v7, s46
    v_bfe_u32 v7, v7, 8, 5

    v_fmaak_f32 v110, v110, v105, 0x4b400010
    v_fmaak_f32 v111, v111, v105, 0x4b400010
    v_fmaak_f32 v112, v112, v105, 0x4b400010
    v_fmaak_f32 v113, v113, v105, 0x4b400010
    v_sub_u32 v110, v110, v4
    v_sub_u32 v111, v111, v5
    v_sub_u32 v112, v112, v6
    v_sub_u32 v113, v113, v7
    v_bfi_b32 v110, 31, v4, v110
    v_bfi_b32 v111, 31, v5, v111
    v_bfi_b32 v112, 31, v6, v112
    v_bfi_b32 v113, 31, v7, v113
    v_perm_b32 v44, v44, v110, s55
    v_perm_b32 v46, v46, v111, s55
    v_perm_b32 v48, v48, v112, s55
    v_perm_b32 v50, v50, v113, s55
L_ska_24:
    s_bitcmp0_b32 s82, 1
    s_cbranch_scc1 L_ska_25
    s_waitcnt vmcnt(8)
    v_mul_hi_u32_u24 v53, s40, v24
    v_mul_hi_u32_u24 v52, s40, v8
    v_mul_hi_u32_u24 v55, s40, v25
    v_mul_hi_u32_u24 v54, s40, v9
    v_mul_hi_u32_u24 v57, s40, v26
    v_mul_hi_u32_u24 v56, s40, v10
    v_mul_hi_u32_u24 v59, s40, v27
    v_mul_hi_u32_u24 v58, s40, v11
    v_and_b32 v53, -2, v53
    v_mad_u32_u24 v8, v52, s43, v8
    v_and_b32 v80, -4, v52
    v_and_b32 v55, -2, v55
    v_mad_u32_u24 v9, v54, s43, v9
    v_and_b32 v81, -4, v54
    v_and_b32 v57, -2, v57
    v_mad_u32_u24 v10, v56, s43, v10
    v_and_b32 v82, -4, v56
    v_and_b32 v59, -2, v59
    v_mad_u32_u24 v11, v58, s43, v11
    v_and_b32 v83, -4, v58
    v_mad_i32_i24 v24, v53, s42, v24
    v_lshl_add_u32 v53, v80, 5, v53
    v_mad_i32_i24 v25, v55, s42, v25
    v_lshl_add_u32 v55, v81, 5, v55
    v_mad_i32_i24 v26, v57, s42, v26
    v_lshl_add_u32 v57, v82, 5, v57
    v_mad_i32_i24 v27, v59, s42, v27
    v_lshl_add_u32 v59, v83, 5, v59
    v_add_u32 v53, v53, v53
    ds_add_rtn_u32 v80, v53, v104
    v_add_u32 v55, v55, v55
    ds_add_rtn_u32 v81, v55, v104
    v_add_u32 v57, v57, v57
    ds_add_rtn_u32 v82, v57, v104
    v_add_u32 v59, v59, v59
    ds_add_rtn_u32 v83, v59, v104
    v_lshlrev_b32 v110, 16, v38
    v_and_b32 v111, 0xffff0000, v38
    v_lshlrev_b32 v112, 16, v39
    v_and_b32 v113, 0xffff0000, v39
    v_mul_f32 v110, s44, v110
    v_mul_f32 v111, s44, v111
    v_mul_f32 v112, s44, v112
    v_mul_f32 v113, s44, v113
    v_fract_f32 v110, v110
    v_fract_f32 v111, v111
    v_fract_f32 v112, v112
    v_fract_f32 v113, v113
    v_cos_f32 v110, v110
    v_cos_f32 v111, v111
    v_cos_f32 v112, v112
    v_cos_f32 v113, v113
    v_lshl_or_b32 v52, v52, 14, v24
    v_perm_b32 v53, v53, v8, s46
    v_bfe_u32 v8, v8, 8, 5

    v_lshl_or_b32 v54, v54, 14, v25
    v_perm_b32 v55, v55, v9, s46
    v_bfe_u32 v9, v9, 8, 5

    v_lshl_or_b32 v56, v56, 14, v26
    v_perm_b32 v57, v57, v10, s46
    v_bfe_u32 v10, v10, 8, 5

    v_lshl_or_b32 v58, v58, 14, v27
    v_perm_b32 v59, v59, v11, s46
    v_bfe_u32 v11, v11, 8, 5

    v_fmaak_f32 v110, v110, v105, 0x4b400010
    v_fmaak_f32 v111, v111, v105, 0x4b400010
    v_fmaak_f32 v112, v112, v105, 0x4b400010
    v_fmaak_f32 v113, v113, v105, 0x4b400010
    v_sub_u32 v110, v110, v8
    v_sub_u32 v111, v111, v9
    v_sub_u32 v112, v112, v10
    v_sub_u32 v113, v113, v11
    v_bfi_b32 v110, 31, v8, v110
    v_bfi_b32 v111, 31, v9, v111
    v_bfi_b32 v112, 31, v10, v112
    v_bfi_b32 v113, 31, v11, v113
    v_perm_b32 v52, v52, v110, s55
    v_perm_b32 v54, v54, v111, s55
    v_perm_b32 v56, v56, v112, s55
    v_perm_b32 v58, v58, v113, s55
L_ska_25:
    s_bitcmp0_b32 s82, 2
    s_cbranch_scc1 L_ska_26
    s_waitcnt vmcnt(4)
    v_mul_hi_u32_u24 v61, s40, v28
    v_mul_hi_u32_u24 v60, s40, v12
    v_mul_hi_u32_u24 v63, s40, v29
    v_mul_hi_u32_u24 v62, s40, v13
    v_mul_hi_u32_u24 v65, s40, v30
    v_mul_hi_u32_u24 v64, s40, v14
    v_mul_hi_u32_u24 v67, s40, v31
    v_mul_hi_u32_u24 v66, s40, v15
    v_and_b32 v61, -2, v61
    v_mad_u32_u24 v12, v60, s43, v12
    v_and_b32 v84, -4, v60
    v_and_b32 v63, -2, v63
    v_mad_u32_u24 v13, v62, s43, v13
    v_and_b32 v85, -4, v62
    v_and_b32 v65, -2, v65
    v_mad_u32_u24 v14, v64, s43, v14
    v_and_b32 v86, -4, v64
    v_and_b32 v67, -2, v67
    v_mad_u32_u24 v15, v66, s43, v15
    v_and_b32 v87, -4, v66
    v_mad_i32_i24 v28, v61, s42, v28
    v_lshl_add_u32 v61, v84, 5, v61
    v_mad_i32_i24 v29, v63, s42, v29
    v_lshl_add_u32 v63, v85, 5, v63
    v_mad_i32_i24 v30, v65, s42, v30
    v_lshl_add_u32 v65, v86, 5, v65
    v_mad_i32_i24 v31, v67, s42, v31
    v_lshl_add_u32 v67, v87, 5, v67
    v_add_u32 v61, v61, v61
    ds_add_rtn_u32 v84, v61, v104
    v_add_u32 v63, v63, v63
    ds_add_rtn_u32 v85, v63, v104
    v_add_u32 v65, v65, v65
    ds_add_rtn_u32 v86, v65, v104
    v_add_u32 v67, v67, v67
    ds_add_rtn_u32 v87, v67, v104
    v_lshlrev_b32 v110, 16, v40
    v_and_b32 v111, 0xffff0000, v40
    v_lshlrev_b32 v112, 16, v41
    v_and_b32 v113, 0xffff0000, v41
    v_mul_f32 v110, s44, v110
    v_mul_f32 v111, s44, v111
    v_mul_f32 v112, s44, v112
    v_mul_f32 v113, s44, v113
    v_fract_f32 v110, v110
    v_fract_f32 v111, v111
    v_fract_f32 v112, v112
    v_fract_f32 v113, v113
    v_cos_f32 v110, v110
    v_cos_f32 v111, v111
    v_cos_f32 v112, v112
    v_cos_f32 v113, v113
    v_lshl_or_b32 v60, v60, 14, v28
    v_perm_b32 v61, v61, v12, s46
    v_bfe_u32 v12, v12, 8, 5

    v_lshl_or_b32 v62, v62, 14, v29
    v_perm_b32 v63, v63, v13, s46
    v_bfe_u32 v13, v13, 8, 5

    v_lshl_or_b32 v64, v64, 14, v30
    v_perm_b32 v65, v65, v14, s46
    v_bfe_u32 v14, v14, 8, 5

    v_lshl_or_b32 v66, v66, 14, v31
    v_perm_b32 v67, v67, v15, s46
    v_bfe_u32 v15, v15, 8, 5

    v_fmaak_f32 v110, v110, v105, 0x4b400010
    v_fmaak_f32 v111, v111, v105, 0x4b400010
    v_fmaak_f32 v112, v112, v105, 0x4b400010
    v_fmaak_f32 v113, v113, v105, 0x4b400010
    v_sub_u32 v110, v110, v12
    v_sub_u32 v111, v111, v13
    v_sub_u32 v112, v112, v14
    v_sub_u32 v113, v113, v15
    v_bfi_b32 v110, 31, v12, v110
    v_bfi_b32 v111, 31, v13, v111
    v_bfi_b32 v112, 31, v14, v112
    v_bfi_b32 v113, 31, v15, v113
    v_perm_b32 v60, v60, v110, s55
    v_perm_b32 v62, v62, v111, s55
    v_perm_b32 v64, v64, v112, s55
    v_perm_b32 v66, v66, v113, s55
L_ska_26:
    s_waitcnt vmcnt(1)
    s_waitcnt vmcnt(0)
    v_cmp_eq_u32 vcc, 0, v0
    s_mov_b64 exec, vcc
    ds_write_b32 v108, v99 offset:8
    s_mov_b64 exec, -1
    s_waitcnt vmcnt(1)
    v_lshrrev_b32 v93, 16, v92
    v_and_b32 v92, 0xffff, v92
    v_add_u32 v110, v92, v94
    v_mad_u32_u24 v92, v92, 5, v96
    v_add_u32 v111, v93, v95
    v_mad_u32_u24 v93, v93, 5, v97
    v_max_u32 v110, v110, v111
    v_cmp_le_u32 vcc, s48, v110
    s_cbranch_vccnz L_full_27
L_fback_28:
    ds_write_b64 v2, v[92:93] offset:8192

    s_waitcnt lgkmcnt(0)
    s_barrier
    ds_read_b32 v111, v108 offset:8
    s_waitcnt lgkmcnt(0)
    v_readfirstlane_b32 s41, v111
    s_nop 1

    s_add_u32 s41, s41, 416
    s_sub_u32 s78, s41, 2965
    s_lshr_b32 s79, s78, 1
    s_add_u32 s79, s79, 2965
    s_and_b32 s86, s78, 1
    s_lshl_b32 s86, s86, 1
    s_add_u32 s87, s86, 2
    s_cmp_lt_u32 s41, 2965
    s_cselect_b32 s41, s41, s79
    s_cmovk_i32 s86, 0
    s_cmovk_i32 s87, 4

    s_mul_i32 s78, s41, 16384
    s_add_u32 s49, s78, 16384
    s_cmp_ge_u32 s41, 3125
    s_cmovk_i32 s49, 0
    s_cmovk_i32 s78, 0
    s_lshl_b32 s10, s49, 2
    s_lshl_b32 s14, s49, 2
    s_lshl_b32 s18, s49, 1
    s_sub_u32 s79, s87, s86
    s_bfm_b32 s85, s79, s86
    s_lshl_b32 s86, s86, 12
    s_lshl_b32 s87, s87, 12
    s_min_u32 s87, s87, 16384

    s_add_u32 s79, s78, 0
    s_bitcmp1_b32 s85, 0
    s_cselect_b32 s79, s79, 0x1ff00000
    s_lshl_b32 s56, s79, 2
    s_lshl_b32 s61, s79, 1

    s_add_u32 s79, s78, 4096
    s_bitcmp1_b32 s85, 1
    s_cselect_b32 s79, s79, 0x1ff00000
    s_lshl_b32 s57, s79, 2
    s_lshl_b32 s62, s79, 1

    s_add_u32 s79, s78, 8192
    s_bitcmp1_b32 s85, 2
    s_cselect_b32 s79, s79, 0x1ff00000
    s_lshl_b32 s58, s79, 2
    s_lshl_b32 s63, s79, 1

    s_add_u32 s79, s78, 12288
    s_bitcmp1_b32 s85, 3
    s_cselect_b32 s79, s79, 0x1ff00000
    s_lshl_b32 s59, s79, 2
    s_lshl_b32 s64, s79, 1

    s_bitcmp0_b32 s28, 0
    s_cbranch_scc1 L_skw_29
    ds_read_b64 v[110:111], v2 offset:16400
    ds_read_b64 v[112:113], v2 offset:16408
    ds_read_b64 v[114:115], v2 offset:16392

    ds_read_b64 v[118:119], v2 offset:24592
    ds_read_b64 v[120:121], v2 offset:24600
    ds_read_b64 v[122:123], v2 offset:24584

    s_waitcnt lgkmcnt(3)
    v_lshrrev_b32 v116, 16, v111
    ds_read_b32 v116, v116 offset:8192

    s_waitcnt lgkmcnt(1)
    v_lshrrev_b32 v124, 16, v119
    ds_read_b32 v124, v124 offset:8192

    v_cmp_ne_u32_sdwa s[80:81], v111, v113 src0_sel:WORD_1 src1_sel:WORD_1
    v_cmp_ne_u32_sdwa vcc, v111, v115 src0_sel:WORD_1 src1_sel:WORD_1
    v_alignbyte_b32 v114, v115, v114, 2
    s_mov_b32 s54, -3
    v_alignbyte_b32 v111, v111, v110, 1
    v_perm_b32 v110, v110, v114, s47
    s_waitcnt lgkmcnt(1)
    v_add3_u32 v116, v116, v106, s54
    v_sub_u32 v117, 0, v116
    v_and_b32 v117, 3, v117
    s_mov_b64 exec, s[80:81]
    v_mov_b32 v117, 0
    v_mov_b32 v112, 0
    s_mov_b64 exec, vcc
    v_mov_b32 v117, 3

    s_mov_b64 exec, -1
    v_alignbyte_b32 v110, v111, v110, v117
    v_alignbyte_b32 v111, v112, v111, v117
    v_add_u32 v116, v116, v117

    buffer_store_dwordx2 v[110:111], v116, s[24:27], 0 offen
    v_cmp_ne_u32_sdwa s[80:81], v119, v121 src0_sel:WORD_1 src1_sel:WORD_1
    v_cmp_ne_u32_sdwa vcc, v119, v123 src0_sel:WORD_1 src1_sel:WORD_1
    v_alignbyte_b32 v122, v123, v122, 2
    s_mov_b32 s54, 5117
    v_alignbyte_b32 v119, v119, v118, 1
    v_perm_b32 v118, v118, v122, s47
    s_waitcnt lgkmcnt(0)
    v_add3_u32 v124, v124, v106, s54
    v_sub_u32 v125, 0, v124
    v_and_b32 v125, 3, v125
    s_mov_b64 exec, s[80:81]
    v_mov_b32 v125, 0
    v_mov_b32 v120, 0
    s_mov_b64 exec, vcc
    v_mov_b32 v125, 3

    s_mov_b64 exec, -1
    v_alignbyte_b32 v118, v119, v118, v125
    v_alignbyte_b32 v119, v120, v119, v125
    v_add_u32 v124, v124, v125

    buffer_store_dwordx2 v[118:119], v124, s[24:27], 0 offen
L_skw_29:
    s_bitcmp0_b32 s28, 0
    s_cbranch_scc1 L_skw_30
    ds_read_b64 v[110:111], v2 offset:32784
    ds_read_b64 v[112:113], v2 offset:32792
    ds_read_b64 v[114:115], v2 offset:32776

    ds_read_b64 v[118:119], v2 offset:40976
    ds_read_b64 v[120:121], v2 offset:40984
    ds_read_b64 v[122:123], v2 offset:40968

    s_waitcnt lgkmcnt(3)
    v_lshrrev_b32 v116, 16, v111
    ds_read_b32 v116, v116 offset:8192

    s_waitcnt lgkmcnt(1)
    v_lshrrev_b32 v124, 16, v119
    ds_read_b32 v124, v124 offset:8192

    v_cmp_ne_u32_sdwa s[80:81], v111, v113 src0_sel:WORD_1 src1_sel:WORD_1
    v_cmp_ne_u32_sdwa vcc, v111, v115 src0_sel:WORD_1 src1_sel:WORD_1
    v_alignbyte_b32 v114, v115, v114, 2
    s_mov_b32 s54, 10237
    v_alignbyte_b32 v111, v111, v110, 1
    v_perm_b32 v110, v110, v114, s47
    s_waitcnt lgkmcnt(1)
    v_add3_u32 v116, v116, v106, s54
    v_sub_u32 v117, 0, v116
    v_and_b32 v117, 3, v117
    s_mov_b64 exec, s[80:81]
    v_mov_b32 v117, 0
    v_mov_b32 v112, 0
    s_mov_b64 exec, vcc
    v_mov_b32 v117, 3

    s_mov_b64 exec, -1
    v_alignbyte_b32 v110, v111, v110, v117
    v_alignbyte_b32 v111, v112, v111, v117
    v_add_u32 v116, v116, v117

    buffer_store_dwordx2 v[110:111], v116, s[24:27], 0 offen
    v_cmp_ne_u32_sdwa s[80:81], v119, v121 src0_sel:WORD_1 src1_sel:WORD_1
    v_cmp_ne_u32_sdwa vcc, v119, v123 src0_sel:WORD_1 src1_sel:WORD_1
    v_alignbyte_b32 v122, v123, v122, 2
    s_mov_b32 s54, 15357
    v_alignbyte_b32 v119, v119, v118, 1
    v_perm_b32 v118, v118, v122, s47
    s_waitcnt lgkmcnt(0)
    v_add3_u32 v124, v124, v106, s54
    v_sub_u32 v125, 0, v124
    v_and_b32 v125, 3, v125
    s_mov_b64 exec, s[80:81]
    v_mov_b32 v125, 0
    v_mov_b32 v120, 0
    s_mov_b64 exec, vcc
    v_mov_b32 v125, 3

    s_mov_b64 exec, -1
    v_alignbyte_b32 v118, v119, v118, v125
    v_alignbyte_b32 v119, v120, v119, v125
    v_add_u32 v124, v124, v125

    buffer_store_dwordx2 v[118:119], v124, s[24:27], 0 offen
L_skw_30:
    s_bitcmp0_b32 s28, 1
    s_cbranch_scc1 L_skw_31
    v_add_u32 v107, 32768, v2
    ds_read_b64 v[110:111], v107 offset:16400
    ds_read_b64 v[112:113], v107 offset:16408
    ds_read_b64 v[114:115], v107 offset:16392

    ds_read_b64 v[118:119], v107 offset:24592
    ds_read_b64 v[120:121], v107 offset:24600
    ds_read_b64 v[122:123], v107 offset:24584

    s_waitcnt lgkmcnt(3)
    v_lshrrev_b32 v116, 16, v111
    ds_read_b32 v116, v116 offset:8192

    s_waitcnt lgkmcnt(1)
    v_lshrrev_b32 v124, 16, v119
    ds_read_b32 v124, v124 offset:8192

    v_cmp_ne_u32_sdwa s[80:81], v111, v113 src0_sel:WORD_1 src1_sel:WORD_1
    v_cmp_ne_u32_sdwa vcc, v111, v115 src0_sel:WORD_1 src1_sel:WORD_1
    v_alignbyte_b32 v114, v115, v114, 2
    s_mov_b32 s54, 20477
    v_alignbyte_b32 v111, v111, v110, 1
    v_perm_b32 v110, v110, v114, s47
    s_waitcnt lgkmcnt(1)
    v_add3_u32 v116, v116, v106, s54
    v_sub_u32 v117, 0, v116
    v_and_b32 v117, 3, v117
    s_mov_b64 exec, s[80:81]
    v_mov_b32 v117, 0
    v_mov_b32 v112, 0
    s_mov_b64 exec, vcc
    v_mov_b32 v117, 3

    s_mov_b64 exec, -1
    v_alignbyte_b32 v110, v111, v110, v117
    v_alignbyte_b32 v111, v112, v111, v117
    v_add_u32 v116, v116, v117

    buffer_store_dwordx2 v[110:111], v116, s[24:27], 0 offen
    v_cmp_ne_u32_sdwa s[80:81], v119, v121 src0_sel:WORD_1 src1_sel:WORD_1
    v_cmp_ne_u32_sdwa vcc, v119, v123 src0_sel:WORD_1 src1_sel:WORD_1
    v_alignbyte_b32 v122, v123, v122, 2
    s_mov_b32 s54, 25597
    v_alignbyte_b32 v119, v119, v118, 1
    v_perm_b32 v118, v118, v122, s47
    s_waitcnt lgkmcnt(0)
    v_add3_u32 v124, v124, v106, s54
    v_sub_u32 v125, 0, v124
    v_and_b32 v125, 3, v125
    s_mov_b64 exec, s[80:81]
    v_mov_b32 v125, 0
    v_mov_b32 v120, 0
    s_mov_b64 exec, vcc
    v_mov_b32 v125, 3

    s_mov_b64 exec, -1
    v_alignbyte_b32 v118, v119, v118, v125
    v_alignbyte_b32 v119, v120, v119, v125
    v_add_u32 v124, v124, v125

    buffer_store_dwordx2 v[118:119], v124, s[24:27], 0 offen
L_skw_31:
    s_bitcmp0_b32 s28, 1
    s_cbranch_scc1 L_skw_32
    v_add_u32 v107, 32768, v2
    ds_read_b64 v[110:111], v107 offset:32784
    ds_read_b64 v[112:113], v107 offset:32792
    ds_read_b64 v[114:115], v107 offset:32776

    ds_read_b64 v[118:119], v107 offset:40976
    ds_read_b64 v[120:121], v107 offset:40984
    ds_read_b64 v[122:123], v107 offset:40968

    s_waitcnt lgkmcnt(3)
    v_lshrrev_b32 v116, 16, v111
    ds_read_b32 v116, v116 offset:8192

    s_waitcnt lgkmcnt(1)
    v_lshrrev_b32 v124, 16, v119
    ds_read_b32 v124, v124 offset:8192

    v_cmp_ne_u32_sdwa s[80:81], v111, v113 src0_sel:WORD_1 src1_sel:WORD_1
    v_cmp_ne_u32_sdwa vcc, v111, v115 src0_sel:WORD_1 src1_sel:WORD_1
    v_alignbyte_b32 v114, v115, v114, 2
    s_mov_b32 s54, 30717
    v_alignbyte_b32 v111, v111, v110, 1
    v_perm_b32 v110, v110, v114, s47
    s_waitcnt lgkmcnt(1)
    v_add3_u32 v116, v116, v106, s54
    v_sub_u32 v117, 0, v116
    v_and_b32 v117, 3, v117
    s_mov_b64 exec, s[80:81]
    v_mov_b32 v117, 0
    v_mov_b32 v112, 0
    s_mov_b64 exec, vcc
    v_mov_b32 v117, 3

    s_mov_b64 exec, -1
    v_alignbyte_b32 v110, v111, v110, v117
    v_alignbyte_b32 v111, v112, v111, v117
    v_add_u32 v116, v116, v117

    buffer_store_dwordx2 v[110:111], v116, s[24:27], 0 offen
    v_cmp_ne_u32_sdwa s[80:81], v119, v121 src0_sel:WORD_1 src1_sel:WORD_1
    v_cmp_ne_u32_sdwa vcc, v119, v123 src0_sel:WORD_1 src1_sel:WORD_1
    v_alignbyte_b32 v122, v123, v122, 2
    s_mov_b32 s54, 35837
    v_alignbyte_b32 v119, v119, v118, 1
    v_perm_b32 v118, v118, v122, s47
    s_waitcnt lgkmcnt(0)
    v_add3_u32 v124, v124, v106, s54
    v_sub_u32 v125, 0, v124
    v_and_b32 v125, 3, v125
    s_mov_b64 exec, s[80:81]
    v_mov_b32 v125, 0
    v_mov_b32 v120, 0
    s_mov_b64 exec, vcc
    v_mov_b32 v125, 3

    s_mov_b64 exec, -1
    v_alignbyte_b32 v118, v119, v118, v125
    v_alignbyte_b32 v119, v120, v119, v125
    v_add_u32 v124, v124, v125

    buffer_store_dwordx2 v[118:119], v124, s[24:27], 0 offen
L_skw_32:
    s_bitcmp0_b32 s82, 3
    s_cbranch_scc1 L_ska_33
    s_mov_b64 exec, s[66:67]
    v_mul_hi_u32_u24 v69, s40, v32
    v_mul_hi_u32_u24 v68, s40, v16
    v_mul_hi_u32_u24 v71, s40, v33
    v_mul_hi_u32_u24 v70, s40, v17
    v_mul_hi_u32_u24 v73, s40, v34
    v_mul_hi_u32_u24 v72, s40, v18
    v_mul_hi_u32_u24 v75, s40, v35
    v_mul_hi_u32_u24 v74, s40, v19
    v_and_b32 v69, -2, v69
    v_mad_u32_u24 v16, v68, s43, v16
    v_and_b32 v88, -4, v68
    v_and_b32 v71, -2, v71
    v_mad_u32_u24 v17, v70, s43, v17
    v_and_b32 v89, -4, v70
    v_and_b32 v73, -2, v73
    v_mad_u32_u24 v18, v72, s43, v18
    v_and_b32 v90, -4, v72
    v_and_b32 v75, -2, v75
    v_mad_u32_u24 v19, v74, s43, v19
    v_and_b32 v91, -4, v74
    v_mad_i32_i24 v32, v69, s42, v32
    v_lshl_add_u32 v69, v88, 5, v69
    v_mad_i32_i24 v33, v71, s42, v33
    v_lshl_add_u32 v71, v89, 5, v71
    v_mad_i32_i24 v34, v73, s42, v34
    v_lshl_add_u32 v73, v90, 5, v73
    v_mad_i32_i24 v35, v75, s42, v35
    v_lshl_add_u32 v75, v91, 5, v75
    v_add_u32 v69, v69, v69
    ds_add_rtn_u32 v88, v69, v104
    v_add_u32 v71, v71, v71
    ds_add_rtn_u32 v89, v71, v104
    v_add_u32 v73, v73, v73
    ds_add_rtn_u32 v90, v73, v104
    v_add_u32 v75, v75, v75
    ds_add_rtn_u32 v91, v75, v104
    v_lshlrev_b32 v110, 16, v42
    v_and_b32 v111, 0xffff0000, v42
    v_lshlrev_b32 v112, 16, v43
    v_and_b32 v113, 0xffff0000, v43
    v_mul_f32 v110, s44, v110
    v_mul_f32 v111, s44, v111
    v_mul_f32 v112, s44, v112
    v_mul_f32 v113, s44, v113
    v_fract_f32 v110, v110
    v_fract_f32 v111, v111
    v_fract_f32 v112, v112
    v_fract_f32 v113, v113
    v_cos_f32 v110, v110
    v_cos_f32 v111, v111
    v_cos_f32 v112, v112
    v_cos_f32 v113, v113
    v_lshl_or_b32 v68, v68, 14, v32
    v_perm_b32 v69, v69, v16, s46
    v_bfe_u32 v16, v16, 8, 5

    v_lshl_or_b32 v70, v70, 14, v33
    v_perm_b32 v71, v71, v17, s46
    v_bfe_u32 v17, v17, 8, 5

    v_lshl_or_b32 v72, v72, 14, v34
    v_perm_b32 v73, v73, v18, s46
    v_bfe_u32 v18, v18, 8, 5

    v_lshl_or_b32 v74, v74, 14, v35
    v_perm_b32 v75, v75, v19, s46
    v_bfe_u32 v19, v19, 8, 5

    v_fmaak_f32 v110, v110, v105, 0x4b400010
    v_fmaak_f32 v111, v111, v105, 0x4b400010
    v_fmaak_f32 v112, v112, v105, 0x4b400010
    v_fmaak_f32 v113, v113, v105, 0x4b400010
    v_sub_u32 v110, v110, v16
    v_sub_u32 v111, v111, v17
    v_sub_u32 v112, v112, v18
    v_sub_u32 v113, v113, v19
    v_bfi_b32 v110, 31, v16, v110
    v_bfi_b32 v111, 31, v17, v111
    v_bfi_b32 v112, 31, v18, v112
    v_bfi_b32 v113, 31, v19, v113
    v_perm_b32 v68, v68, v110, s55
    v_perm_b32 v70, v70, v111, s55
    v_perm_b32 v72, v72, v112, s55
    v_perm_b32 v74, v74, v113, s55
    s_mov_b64 exec, -1
L_ska_33:
    s_bitcmp0_b32 s28, 2
    s_cbranch_scc1 L_skw_34
    v_add_u32 v107, 65536, v2
    ds_read_b64 v[110:111], v107 offset:16400
    ds_read_b64 v[112:113], v107 offset:16408
    ds_read_b64 v[114:115], v107 offset:16392

    ds_read_b64 v[118:119], v107 offset:24592
    ds_read_b64 v[120:121], v107 offset:24600
    ds_read_b64 v[122:123], v107 offset:24584

    s_waitcnt lgkmcnt(3)
    v_lshrrev_b32 v116, 16, v111
    ds_read_b32 v116, v116 offset:8192

    s_waitcnt lgkmcnt(1)
    v_lshrrev_b32 v124, 16, v119
    ds_read_b32 v124, v124 offset:8192

    v_cmp_ne_u32_sdwa s[80:81], v111, v113 src0_sel:WORD_1 src1_sel:WORD_1
    v_cmp_ne_u32_sdwa vcc, v111, v115 src0_sel:WORD_1 src1_sel:WORD_1
    v_alignbyte_b32 v114, v115, v114, 2
    s_mov_b32 s54, 40957
    v_alignbyte_b32 v111, v111, v110, 1
    v_perm_b32 v110, v110, v114, s47
    s_waitcnt lgkmcnt(1)
    v_add3_u32 v116, v116, v106, s54
    v_sub_u32 v117, 0, v116
    v_and_b32 v117, 3, v117
    s_mov_b64 exec, s[80:81]
    v_mov_b32 v117, 0
    v_mov_b32 v112, 0
    s_mov_b64 exec, vcc
    v_mov_b32 v117, 3

    s_mov_b64 exec, -1
    v_alignbyte_b32 v110, v111, v110, v117
    v_alignbyte_b32 v111, v112, v111, v117
    v_add_u32 v116, v116, v117

    buffer_store_dwordx2 v[110:111], v116, s[24:27], 0 offen
    v_cmp_ne_u32_sdwa s[80:81], v119, v121 src0_sel:WORD_1 src1_sel:WORD_1
    v_cmp_ne_u32_sdwa vcc, v119, v123 src0_sel:WORD_1 src1_sel:WORD_1
    v_alignbyte_b32 v122, v123, v122, 2
    s_mov_b32 s54, 46077
    v_alignbyte_b32 v119, v119, v118, 1
    v_perm_b32 v118, v118, v122, s47
    s_waitcnt lgkmcnt(0)
    v_add3_u32 v124, v124, v106, s54
    v_sub_u32 v125, 0, v124
    v_and_b32 v125, 3, v125
    s_mov_b64 exec, s[80:81]
    v_mov_b32 v125, 0
    v_mov_b32 v120, 0
    s_mov_b64 exec, vcc
    v_mov_b32 v125, 3

    s_mov_b64 exec, -1
    v_alignbyte_b32 v118, v119, v118, v125
    v_alignbyte_b32 v119, v120, v119, v125
    v_add_u32 v124, v124, v125

    buffer_store_dwordx2 v[118:119], v124, s[24:27], 0 offen
L_skw_34:
    s_bitcmp0_b32 s28, 2
    s_cbranch_scc1 L_skw_35
    v_add_u32 v107, 65536, v2
    ds_read_b64 v[110:111], v107 offset:32784
    ds_read_b64 v[112:113], v107 offset:32792
    ds_read_b64 v[114:115], v107 offset:32776

    ds_read_b64 v[118:119], v107 offset:40976
    ds_read_b64 v[120:121], v107 offset:40984
    ds_read_b64 v[122:123], v107 offset:40968

    s_waitcnt lgkmcnt(3)
    v_lshrrev_b32 v116, 16, v111
    ds_read_b32 v116, v116 offset:8192

    s_waitcnt lgkmcnt(1)
    v_lshrrev_b32 v124, 16, v119
    ds_read_b32 v124, v124 offset:8192

    v_cmp_ne_u32_sdwa s[80:81], v111, v113 src0_sel:WORD_1 src1_sel:WORD_1
    v_cmp_ne_u32_sdwa vcc, v111, v115 src0_sel:WORD_1 src1_sel:WORD_1
    v_alignbyte_b32 v114, v115, v114, 2
    s_mov_b32 s54, 51197
    v_alignbyte_b32 v111, v111, v110, 1
    v_perm_b32 v110, v110, v114, s47
    s_waitcnt lgkmcnt(1)
    v_add3_u32 v116, v116, v106, s54
    v_sub_u32 v117, 0, v116
    v_and_b32 v117, 3, v117
    s_mov_b64 exec, s[80:81]
    v_mov_b32 v117, 0
    v_mov_b32 v112, 0
    s_mov_b64 exec, vcc
    v_mov_b32 v117, 3

    s_mov_b64 exec, -1
    v_alignbyte_b32 v110, v111, v110, v117
    v_alignbyte_b32 v111, v112, v111, v117
    v_add_u32 v116, v116, v117

    buffer_store_dwordx2 v[110:111], v116, s[24:27], 0 offen
    v_cmp_ne_u32_sdwa s[80:81], v119, v121 src0_sel:WORD_1 src1_sel:WORD_1
    v_cmp_ne_u32_sdwa vcc, v119, v123 src0_sel:WORD_1 src1_sel:WORD_1
    v_alignbyte_b32 v122, v123, v122, 2
    s_mov_b32 s54, 56317
    v_alignbyte_b32 v119, v119, v118, 1
    v_perm_b32 v118, v118, v122, s47
    s_waitcnt lgkmcnt(0)
    v_add3_u32 v124, v124, v106, s54
    v_sub_u32 v125, 0, v124
    v_and_b32 v125, 3, v125
    s_mov_b64 exec, s[80:81]
    v_mov_b32 v125, 0
    v_mov_b32 v120, 0
    s_mov_b64 exec, vcc
    v_mov_b32 v125, 3

    s_mov_b64 exec, -1
    v_alignbyte_b32 v118, v119, v118, v125
    v_alignbyte_b32 v119, v120, v119, v125
    v_add_u32 v124, v124, v125

    buffer_store_dwordx2 v[118:119], v124, s[24:27], 0 offen
L_skw_35:
    s_bitcmp0_b32 s28, 3
    s_cbranch_scc1 L_skw_36
    v_add_u32 v107, 98304, v2
    ds_read_b64 v[110:111], v107 offset:16400
    ds_read_b64 v[112:113], v107 offset:16408
    ds_read_b64 v[114:115], v107 offset:16392

    ds_read_b64 v[118:119], v107 offset:24592
    ds_read_b64 v[120:121], v107 offset:24600
    ds_read_b64 v[122:123], v107 offset:24584

    s_waitcnt lgkmcnt(3)
    v_lshrrev_b32 v116, 16, v111
    ds_read_b32 v116, v116 offset:8192

    s_waitcnt lgkmcnt(1)
    v_lshrrev_b32 v124, 16, v119
    ds_read_b32 v124, v124 offset:8192

    v_cmp_ne_u32_sdwa s[80:81], v111, v113 src0_sel:WORD_1 src1_sel:WORD_1
    v_cmp_ne_u32_sdwa vcc, v111, v115 src0_sel:WORD_1 src1_sel:WORD_1
    v_alignbyte_b32 v114, v115, v114, 2
    s_mov_b32 s54, 61437
    v_alignbyte_b32 v111, v111, v110, 1
    v_perm_b32 v110, v110, v114, s47
    s_waitcnt lgkmcnt(1)
    v_add3_u32 v116, v116, v106, s54
    v_sub_u32 v117, 0, v116
    v_and_b32 v117, 3, v117
    s_mov_b64 exec, s[80:81]
    v_mov_b32 v117, 0
    v_mov_b32 v112, 0
    s_mov_b64 exec, vcc
    v_mov_b32 v117, 3

    s_mov_b64 exec, -1
    v_alignbyte_b32 v110, v111, v110, v117
    v_alignbyte_b32 v111, v112, v111, v117
    v_add_u32 v116, v116, v117

    buffer_store_dwordx2 v[110:111], v116, s[24:27], 0 offen
    v_cmp_ne_u32_sdwa s[80:81], v119, v121 src0_sel:WORD_1 src1_sel:WORD_1
    v_cmp_ne_u32_sdwa vcc, v119, v123 src0_sel:WORD_1 src1_sel:WORD_1
    v_alignbyte_b32 v122, v123, v122, 2
    s_mov_b32 s54, 66557
    v_alignbyte_b32 v119, v119, v118, 1
    v_perm_b32 v118, v118, v122, s47
    s_waitcnt lgkmcnt(0)
    v_add3_u32 v124, v124, v106, s54
    v_sub_u32 v125, 0, v124
    v_and_b32 v125, 3, v125
    s_mov_b64 exec, s[80:81]
    v_mov_b32 v125, 0
    v_mov_b32 v120, 0
    s_mov_b64 exec, vcc
    v_mov_b32 v125, 3

    s_mov_b64 exec, -1
    v_alignbyte_b32 v118, v119, v118, v125
    v_alignbyte_b32 v119, v120, v119, v125
    v_add_u32 v124, v124, v125

    buffer_store_dwordx2 v[118:119], v124, s[24:27], 0 offen
L_skw_36:
    s_bitcmp0_b32 s28, 3
    s_cbranch_scc1 L_skw_37
    v_add_u32 v107, 98304, v2
    ds_read_b64 v[110:111], v107 offset:32784
    ds_read_b64 v[112:113], v107 offset:32792
    ds_read_b64 v[114:115], v107 offset:32776

    ds_read_b64 v[118:119], v107 offset:40976
    ds_read_b64 v[120:121], v107 offset:40984
    ds_read_b64 v[122:123], v107 offset:40968

    s_waitcnt lgkmcnt(3)
    v_lshrrev_b32 v116, 16, v111
    ds_read_b32 v116, v116 offset:8192

    s_waitcnt lgkmcnt(1)
    v_lshrrev_b32 v124, 16, v119
    ds_read_b32 v124, v124 offset:8192

    v_cmp_ne_u32_sdwa s[80:81], v111, v113 src0_sel:WORD_1 src1_sel:WORD_1
    v_cmp_ne_u32_sdwa vcc, v111, v115 src0_sel:WORD_1 src1_sel:WORD_1
    v_alignbyte_b32 v114, v115, v114, 2
    s_mov_b32 s54, 71677
    v_alignbyte_b32 v111, v111, v110, 1
    v_perm_b32 v110, v110, v114, s47
    s_waitcnt lgkmcnt(1)
    v_add3_u32 v116, v116, v106, s54
    v_sub_u32 v117, 0, v116
    v_and_b32 v117, 3, v117
    s_mov_b64 exec, s[80:81]
    v_mov_b32 v117, 0
    v_mov_b32 v112, 0
    s_mov_b64 exec, vcc
    v_mov_b32 v117, 3

    s_mov_b64 exec, -1
    v_alignbyte_b32 v110, v111, v110, v117
    v_alignbyte_b32 v111, v112, v111, v117
    v_add_u32 v116, v116, v117

    buffer_store_dwordx2 v[110:111], v116, s[24:27], 0 offen
    v_cmp_ne_u32_sdwa s[80:81], v119, v121 src0_sel:WORD_1 src1_sel:WORD_1
    v_cmp_ne_u32_sdwa vcc, v119, v123 src0_sel:WORD_1 src1_sel:WORD_1
    v_alignbyte_b32 v122, v123, v122, 2
    s_mov_b32 s54, 76797
    v_alignbyte_b32 v119, v119, v118, 1
    v_perm_b32 v118, v118, v122, s47
    s_waitcnt lgkmcnt(0)
    v_add3_u32 v124, v124, v106, s54
    v_sub_u32 v125, 0, v124
    v_and_b32 v125, 3, v125
    s_mov_b64 exec, s[80:81]
    v_mov_b32 v125, 0
    v_mov_b32 v120, 0
    s_mov_b64 exec, vcc
    v_mov_b32 v125, 3

    s_andn2_b64 exec, -1, s[68:69]
    v_bfrev_b32 v124, 1
    s_mov_b64 exec, -1
    v_alignbyte_b32 v118, v119, v118, v125
    v_alignbyte_b32 v119, v120, v119, v125
    v_add_u32 v124, v124, v125

    buffer_store_dwordx2 v[118:119], v124, s[24:27], 0 offen
L_skw_37:
    s_waitcnt lgkmcnt(0)
    s_barrier

    buffer_load_dwordx4 v[20:23], v1, s[12:15], s56 offen nt
    buffer_load_dwordx4 v[4:7], v1, s[8:11], s56 offen nt
    buffer_load_dwordx2 v[36:37], v2, s[16:19], s61 offen nt
    buffer_load_dwordx4 v[24:27], v1, s[12:15], s57 offen nt
    buffer_load_dwordx4 v[8:11], v1, s[8:11], s57 offen nt
    buffer_load_dwordx2 v[38:39], v2, s[16:19], s62 offen nt
    ds_read_b64 v[94:95], v2
    s_waitcnt lgkmcnt(0)
    v_and_b32 v94, 0xffff, v94
    v_and_b32 v95, 0xffff, v95
    v_add_u32 v97, v94, v95
    s_nop 1
    v_add_u32_dpp v97, v97, v97 row_shr:1 row_mask:0xf bank_mask:0xf
    s_nop 1
    v_add_u32_dpp v97, v97, v97 row_shr:2 row_mask:0xf bank_mask:0xf
    s_nop 1
    v_add_u32_dpp v97, v97, v97 row_shr:4 row_mask:0xf bank_mask:0xf
    s_nop 1
    v_add_u32_dpp v97, v97, v97 row_shr:8 row_mask:0xf bank_mask:0xf
    s_nop 1
    v_add_u32_dpp v97, v97, v97 row_bcast:15 row_mask:0xa bank_mask:0xf
    s_nop 1
    v_add_u32_dpp v97, v97, v97 row_bcast:31 row_mask:0xc bank_mask:0xf
    s_mov_b32 exec_lo, 0
    s_brev_b32 exec_hi, 1
    ds_add_rtn_u32 v96, v108, v97
    s_mov_b64 exec, -1

    v_add_u32 v92, v94, v94
    v_add_u32 v93, v95, v95
    v_med3_u32 v92, v94, 2, v92
    v_med3_u32 v93, v95, 2, v93
    v_lshl_or_b32 v92, v93, 16, v92
    v_lshlrev_b32 v93, 2, v0
    buffer_atomic_add v92, v93, s[20:23], 0 offen sc0
    s_waitcnt lgkmcnt(0)
    v_readlane_b32 s77, v96, 63
    v_mul_u32_u24 v114, 65528, v0
    v_sub_u32 v97, v97, v95
    s_sub_u32 s50, s50, s83
    s_sub_u32 s77, s77, s50
    v_add_u32 v97, s77, v97
    v_sub_u32 v96, v97, v94
    v_lshlrev_b32 v111, 16, v97
    v_lshlrev_b32 v110, 16, v96
    ds_write_b64 v2, v[110:111]
    v_add_u32 v115, 32764, v114
    v_and_b32 v114, 0xffffff80, v114
    v_and_b32 v115, 0xffffff80, v115
    v_mad_i32_i24 v96, v96, -5, v114
    v_mad_i32_i24 v97, v97, -5, v115
    s_add_u32 s50, s50, s84
    s_mov_b32 s28, s82
    s_mov_b32 s29, s83
    s_mov_b32 s30, s84
    s_lshl_b32 s74, s29, 3
    s_lshl_b32 s75, s30, 3
    v_mov_b32 v125, s74
    v_mov_b32 v126, s75
    v_mov_b32 v127, -1

    s_waitcnt lgkmcnt(0)
    s_barrier

    s_mov_b64 exec, 1
    ds_write_b32 v125, v127 offset:16396
    ds_write_b32 v126, v127 offset:16404
    s_mov_b64 exec, -1

    s_bitcmp0_b32 s28, 0
    s_cbranch_scc1 L_skz_38
    v_lshrrev_b32 v110, 16, v45
    ds_read_b32 v110, v110
    v_lshrrev_b32 v111, 16, v47
    ds_read_b32 v111, v111
    v_lshrrev_b32 v112, 16, v49
    ds_read_b32 v112, v112
    v_lshrrev_b32 v113, 16, v51
    ds_read_b32 v113, v113
    v_lshrrev_b32 v114, 16, v53
    ds_read_b32 v114, v114
    v_lshrrev_b32 v115, 16, v55
    ds_read_b32 v115, v115
    v_lshrrev_b32 v116, 16, v57
    ds_read_b32 v116, v116
    v_lshrrev_b32 v117, 16, v59
    ds_read_b32 v117, v117
    s_waitcnt lgkmcnt(7)
    v_add_u32_sdwa v110, v110, v76 dst_sel:DWORD dst_unused:UNUSED_PAD src0_sel:WORD_1 src1_sel:WORD_0
    v_lshlrev_b32 v110, 3, v110
    ds_write_b64 v110, v[44:45] offset:16400

    s_waitcnt lgkmcnt(7)
    v_add_u32_sdwa v111, v111, v77 dst_sel:DWORD dst_unused:UNUSED_PAD src0_sel:WORD_1 src1_sel:WORD_0
    v_lshlrev_b32 v111, 3, v111
    ds_write_b64 v111, v[46:47] offset:16400

    s_waitcnt lgkmcnt(7)
    v_add_u32_sdwa v112, v112, v78 dst_sel:DWORD dst_unused:UNUSED_PAD src0_sel:WORD_1 src1_sel:WORD_0
    v_lshlrev_b32 v112, 3, v112
    ds_write_b64 v112, v[48:49] offset:16400

    s_waitcnt lgkmcnt(7)
    v_add_u32_sdwa v113, v113, v79 dst_sel:DWORD dst_unused:UNUSED_PAD src0_sel:WORD_1 src1_sel:WORD_0
    v_lshlrev_b32 v113, 3, v113
    ds_write_b64 v113, v[50:51] offset:16400

    s_waitcnt lgkmcnt(7)
    v_add_u32_sdwa v114, v114, v80 dst_sel:DWORD dst_unused:UNUSED_PAD src0_sel:WORD_1 src1_sel:WORD_0
    v_lshlrev_b32 v114, 3, v114
    ds_write_b64 v114, v[52:53] offset:16400

    s_waitcnt lgkmcnt(7)
    v_add_u32_sdwa v115, v115, v81 dst_sel:DWORD dst_unused:UNUSED_PAD src0_sel:WORD_1 src1_sel:WORD_0
    v_lshlrev_b32 v115, 3, v115
    ds_write_b64 v115, v[54:55] offset:16400

    s_waitcnt lgkmcnt(7)
    v_add_u32_sdwa v116, v116, v82 dst_sel:DWORD dst_unused:UNUSED_PAD src0_sel:WORD_1 src1_sel:WORD_0
    v_lshlrev_b32 v116, 3, v116
    ds_write_b64 v116, v[56:57] offset:16400

    s_waitcnt lgkmcnt(7)
    v_add_u32_sdwa v117, v117, v83 dst_sel:DWORD dst_unused:UNUSED_PAD src0_sel:WORD_1 src1_sel:WORD_0
    v_lshlrev_b32 v117, 3, v117
    ds_write_b64 v117, v[58:59] offset:16400

L_skz_38:
    buffer_load_dwordx4 v[28:31], v1, s[12:15], s58 offen nt
    buffer_load_dwordx4 v[12:15], v1, s[8:11], s58 offen nt
    buffer_load_dwordx2 v[40:41], v2, s[16:19], s63 offen nt
    s_bitcmp0_b32 s28, 2
    s_cbranch_scc1 L_skz_39
    v_lshrrev_b32 v110, 16, v61
    ds_read_b32 v110, v110
    v_lshrrev_b32 v111, 16, v63
    ds_read_b32 v111, v111
    v_lshrrev_b32 v112, 16, v65
    ds_read_b32 v112, v112
    v_lshrrev_b32 v113, 16, v67
    ds_read_b32 v113, v113
    s_waitcnt lgkmcnt(3)
    v_add_u32_sdwa v110, v110, v84 dst_sel:DWORD dst_unused:UNUSED_PAD src0_sel:WORD_1 src1_sel:WORD_0
    v_lshlrev_b32 v110, 3, v110
    ds_write_b64 v110, v[60:61] offset:16400

    s_waitcnt lgkmcnt(3)
    v_add_u32_sdwa v111, v111, v85 dst_sel:DWORD dst_unused:UNUSED_PAD src0_sel:WORD_1 src1_sel:WORD_0
    v_lshlrev_b32 v111, 3, v111
    ds_write_b64 v111, v[62:63] offset:16400

    s_waitcnt lgkmcnt(3)
    v_add_u32_sdwa v112, v112, v86 dst_sel:DWORD dst_unused:UNUSED_PAD src0_sel:WORD_1 src1_sel:WORD_0
    v_lshlrev_b32 v112, 3, v112
    ds_write_b64 v112, v[64:65] offset:16400

    s_waitcnt lgkmcnt(3)
    v_add_u32_sdwa v113, v113, v87 dst_sel:DWORD dst_unused:UNUSED_PAD src0_sel:WORD_1 src1_sel:WORD_0
    v_lshlrev_b32 v113, 3, v113
    ds_write_b64 v113, v[66:67] offset:16400

L_skz_39:
    s_bitcmp0_b32 s28, 3
    s_cbranch_scc1 L_skz_40
    s_mov_b64 exec, s[66:67]
    v_lshrrev_b32 v110, 16, v69
    ds_read_b32 v110, v110
    v_lshrrev_b32 v111, 16, v71
    ds_read_b32 v111, v111
    v_lshrrev_b32 v112, 16, v73
    ds_read_b32 v112, v112
    v_lshrrev_b32 v113, 16, v75
    ds_read_b32 v113, v113
    s_waitcnt lgkmcnt(3)
    v_add_u32_sdwa v110, v110, v88 dst_sel:DWORD dst_unused:UNUSED_PAD src0_sel:WORD_1 src1_sel:WORD_0
    v_lshlrev_b32 v110, 3, v110
    ds_write_b64 v110, v[68:69] offset:16400

    s_waitcnt lgkmcnt(3)
    v_add_u32_sdwa v111, v111, v89 dst_sel:DWORD dst_unused:UNUSED_PAD src0_sel:WORD_1 src1_sel:WORD_0
    v_lshlrev_b32 v111, 3, v111
    ds_write_b64 v111, v[70:71] offset:16400

    s_waitcnt lgkmcnt(3)
    v_add_u32_sdwa v112, v112, v90 dst_sel:DWORD dst_unused:UNUSED_PAD src0_sel:WORD_1 src1_sel:WORD_0
    v_lshlrev_b32 v112, 3, v112
    ds_write_b64 v112, v[72:73] offset:16400

    s_waitcnt lgkmcnt(3)
    v_add_u32_sdwa v113, v113, v91 dst_sel:DWORD dst_unused:UNUSED_PAD src0_sel:WORD_1 src1_sel:WORD_0
    v_lshlrev_b32 v113, 3, v113
    ds_write_b64 v113, v[74:75] offset:16400

    s_mov_b64 exec, -1
L_skz_40:
    buffer_load_dwordx4 v[32:35], v1, s[12:15], s59 offen nt
    buffer_load_dwordx4 v[16:19], v1, s[8:11], s59 offen nt
    buffer_load_dwordx2 v[42:43], v2, s[16:19], s64 offen nt
    s_cmp_lg_u32 s49, 0
    s_cbranch_scc1 L_p1loop_6
L_p1epi_7:
    s_waitcnt vmcnt(0)
    s_waitcnt vmcnt(0)
    v_lshrrev_b32 v93, 16, v92
    v_and_b32 v92, 0xffff, v92
    v_add_u32 v110, v92, v94
    v_mad_u32_u24 v92, v92, 5, v96
    v_add_u32 v111, v93, v95
    v_mad_u32_u24 v93, v93, 5, v97
    v_max_u32 v110, v110, v111
    v_cmp_le_u32 vcc, s48, v110
    s_cbranch_vccnz L_full_41
L_fback_42:
    ds_write_b64 v2, v[92:93] offset:8192

    s_waitcnt lgkmcnt(0)
    s_barrier

    s_bitcmp0_b32 s28, 0
    s_cbranch_scc1 L_skw_43
    ds_read_b64 v[4:5], v2 offset:16400
    ds_read_b64 v[6:7], v2 offset:16408
    ds_read_b64 v[8:9], v2 offset:16392

    ds_read_b64 v[12:13], v2 offset:24592
    ds_read_b64 v[14:15], v2 offset:24600
    ds_read_b64 v[16:17], v2 offset:24584

    ds_read_b64 v[20:21], v2 offset:32784
    ds_read_b64 v[22:23], v2 offset:32792
    ds_read_b64 v[24:25], v2 offset:32776

    ds_read_b64 v[28:29], v2 offset:40976
    ds_read_b64 v[30:31], v2 offset:40984
    ds_read_b64 v[32:33], v2 offset:40968

    s_waitcnt lgkmcnt(9)
    v_lshrrev_b32 v10, 16, v5
    ds_read_b32 v10, v10 offset:8192

    s_waitcnt lgkmcnt(7)
    v_lshrrev_b32 v18, 16, v13
    ds_read_b32 v18, v18 offset:8192

    s_waitcnt lgkmcnt(5)
    v_lshrrev_b32 v26, 16, v21
    ds_read_b32 v26, v26 offset:8192

    s_waitcnt lgkmcnt(3)
    v_lshrrev_b32 v34, 16, v29
    ds_read_b32 v34, v34 offset:8192

    v_cmp_ne_u32_sdwa s[80:81], v5, v7 src0_sel:WORD_1 src1_sel:WORD_1
    v_cmp_ne_u32_sdwa vcc, v5, v9 src0_sel:WORD_1 src1_sel:WORD_1
    v_alignbyte_b32 v8, v9, v8, 2
    s_mov_b32 s54, -3
    v_alignbyte_b32 v5, v5, v4, 1
    v_perm_b32 v4, v4, v8, s47
    s_waitcnt lgkmcnt(3)
    v_add3_u32 v10, v10, v106, s54
    v_sub_u32 v11, 0, v10
    v_and_b32 v11, 3, v11
    s_mov_b64 exec, s[80:81]
    v_mov_b32 v11, 0
    v_mov_b32 v6, 0
    s_mov_b64 exec, vcc
    v_mov_b32 v11, 3

    s_mov_b64 exec, -1
    v_alignbyte_b32 v4, v5, v4, v11
    v_alignbyte_b32 v5, v6, v5, v11
    v_add_u32 v10, v10, v11

    buffer_store_dwordx2 v[4:5], v10, s[24:27], 0 offen
    v_cmp_ne_u32_sdwa s[80:81], v13, v15 src0_sel:WORD_1 src1_sel:WORD_1
    v_cmp_ne_u32_sdwa vcc, v13, v17 src0_sel:WORD_1 src1_sel:WORD_1
    v_alignbyte_b32 v16, v17, v16, 2
    s_mov_b32 s54, 5117
    v_alignbyte_b32 v13, v13, v12, 1
    v_perm_b32 v12, v12, v16, s47
    s_waitcnt lgkmcnt(2)
    v_add3_u32 v18, v18, v106, s54
    v_sub_u32 v19, 0, v18
    v_and_b32 v19, 3, v19
    s_mov_b64 exec, s[80:81]
    v_mov_b32 v19, 0
    v_mov_b32 v14, 0
    s_mov_b64 exec, vcc
    v_mov_b32 v19, 3

    s_mov_b64 exec, -1
    v_alignbyte_b32 v12, v13, v12, v19
    v_alignbyte_b32 v13, v14, v13, v19
    v_add_u32 v18, v18, v19

    buffer_store_dwordx2 v[12:13], v18, s[24:27], 0 offen
    v_cmp_ne_u32_sdwa s[80:81], v21, v23 src0_sel:WORD_1 src1_sel:WORD_1
    v_cmp_ne_u32_sdwa vcc, v21, v25 src0_sel:WORD_1 src1_sel:WORD_1
    v_alignbyte_b32 v24, v25, v24, 2
    s_mov_b32 s54, 10237
    v_alignbyte_b32 v21, v21, v20, 1
    v_perm_b32 v20, v20, v24, s47
    s_waitcnt lgkmcnt(1)
    v_add3_u32 v26, v26, v106, s54
    v_sub_u32 v27, 0, v26
    v_and_b32 v27, 3, v27
    s_mov_b64 exec, s[80:81]
    v_mov_b32 v27, 0
    v_mov_b32 v22, 0
    s_mov_b64 exec, vcc
    v_mov_b32 v27, 3

    s_mov_b64 exec, -1
    v_alignbyte_b32 v20, v21, v20, v27
    v_alignbyte_b32 v21, v22, v21, v27
    v_add_u32 v26, v26, v27

    buffer_store_dwordx2 v[20:21], v26, s[24:27], 0 offen
    v_cmp_ne_u32_sdwa s[80:81], v29, v31 src0_sel:WORD_1 src1_sel:WORD_1
    v_cmp_ne_u32_sdwa vcc, v29, v33 src0_sel:WORD_1 src1_sel:WORD_1
    v_alignbyte_b32 v32, v33, v32, 2
    s_mov_b32 s54, 15357
    v_alignbyte_b32 v29, v29, v28, 1
    v_perm_b32 v28, v28, v32, s47
    s_waitcnt lgkmcnt(0)
    v_add3_u32 v34, v34, v106, s54
    v_sub_u32 v35, 0, v34
    v_and_b32 v35, 3, v35
    s_mov_b64 exec, s[80:81]
    v_mov_b32 v35, 0
    v_mov_b32 v30, 0
    s_mov_b64 exec, vcc
    v_mov_b32 v35, 3

    s_mov_b64 exec, -1
    v_alignbyte_b32 v28, v29, v28, v35
    v_alignbyte_b32 v29, v30, v29, v35
    v_add_u32 v34, v34, v35

    buffer_store_dwordx2 v[28:29], v34, s[24:27], 0 offen
L_skw_43:
    s_bitcmp0_b32 s28, 1
    s_cbranch_scc1 L_skw_44
    v_add_u32 v107, 32768, v2
    ds_read_b64 v[4:5], v107 offset:16400
    ds_read_b64 v[6:7], v107 offset:16408
    ds_read_b64 v[8:9], v107 offset:16392

    ds_read_b64 v[12:13], v107 offset:24592
    ds_read_b64 v[14:15], v107 offset:24600
    ds_read_b64 v[16:17], v107 offset:24584

    ds_read_b64 v[20:21], v107 offset:32784
    ds_read_b64 v[22:23], v107 offset:32792
    ds_read_b64 v[24:25], v107 offset:32776

    ds_read_b64 v[28:29], v107 offset:40976
    ds_read_b64 v[30:31], v107 offset:40984
    ds_read_b64 v[32:33], v107 offset:40968

    s_waitcnt lgkmcnt(9)
    v_lshrrev_b32 v10, 16, v5
    ds_read_b32 v10, v10 offset:8192

    s_waitcnt lgkmcnt(7)
    v_lshrrev_b32 v18, 16, v13
    ds_read_b32 v18, v18 offset:8192

    s_waitcnt lgkmcnt(5)
    v_lshrrev_b32 v26, 16, v21
    ds_read_b32 v26, v26 offset:8192

    s_waitcnt lgkmcnt(3)
    v_lshrrev_b32 v34, 16, v29
    ds_read_b32 v34, v34 offset:8192

    v_cmp_ne_u32_sdwa s[80:81], v5, v7 src0_sel:WORD_1 src1_sel:WORD_1
    v_cmp_ne_u32_sdwa vcc, v5, v9 src0_sel:WORD_1 src1_sel:WORD_1
    v_alignbyte_b32 v8, v9, v8, 2
    s_mov_b32 s54, 20477
    v_alignbyte_b32 v5, v5, v4, 1
    v_perm_b32 v4, v4, v8, s47
    s_waitcnt lgkmcnt(3)
    v_add3_u32 v10, v10, v106, s54
    v_sub_u32 v11, 0, v10
    v_and_b32 v11, 3, v11
    s_mov_b64 exec, s[80:81]
    v_mov_b32 v11, 0
    v_mov_b32 v6, 0
    s_mov_b64 exec, vcc
    v_mov_b32 v11, 3

    s_mov_b64 exec, -1
    v_alignbyte_b32 v4, v5, v4, v11
    v_alignbyte_b32 v5, v6, v5, v11
    v_add_u32 v10, v10, v11

    buffer_store_dwordx2 v[4:5], v10, s[24:27], 0 offen
    v_cmp_ne_u32_sdwa s[80:81], v13, v15 src0_sel:WORD_1 src1_sel:WORD_1
    v_cmp_ne_u32_sdwa vcc, v13, v17 src0_sel:WORD_1 src1_sel:WORD_1
    v_alignbyte_b32 v16, v17, v16, 2
    s_mov_b32 s54, 25597
    v_alignbyte_b32 v13, v13, v12, 1
    v_perm_b32 v12, v12, v16, s47
    s_waitcnt lgkmcnt(2)
    v_add3_u32 v18, v18, v106, s54
    v_sub_u32 v19, 0, v18
    v_and_b32 v19, 3, v19
    s_mov_b64 exec, s[80:81]
    v_mov_b32 v19, 0
    v_mov_b32 v14, 0
    s_mov_b64 exec, vcc
    v_mov_b32 v19, 3

    s_mov_b64 exec, -1
    v_alignbyte_b32 v12, v13, v12, v19
    v_alignbyte_b32 v13, v14, v13, v19
    v_add_u32 v18, v18, v19

    buffer_store_dwordx2 v[12:13], v18, s[24:27], 0 offen
    v_cmp_ne_u32_sdwa s[80:81], v21, v23 src0_sel:WORD_1 src1_sel:WORD_1
    v_cmp_ne_u32_sdwa vcc, v21, v25 src0_sel:WORD_1 src1_sel:WORD_1
    v_alignbyte_b32 v24, v25, v24, 2
    s_mov_b32 s54, 30717
    v_alignbyte_b32 v21, v21, v20, 1
    v_perm_b32 v20, v20, v24, s47
    s_waitcnt lgkmcnt(1)
    v_add3_u32 v26, v26, v106, s54
    v_sub_u32 v27, 0, v26
    v_and_b32 v27, 3, v27
    s_mov_b64 exec, s[80:81]
    v_mov_b32 v27, 0
    v_mov_b32 v22, 0
    s_mov_b64 exec, vcc
    v_mov_b32 v27, 3

    s_mov_b64 exec, -1
    v_alignbyte_b32 v20, v21, v20, v27
    v_alignbyte_b32 v21, v22, v21, v27
    v_add_u32 v26, v26, v27

    buffer_store_dwordx2 v[20:21], v26, s[24:27], 0 offen
    v_cmp_ne_u32_sdwa s[80:81], v29, v31 src0_sel:WORD_1 src1_sel:WORD_1
    v_cmp_ne_u32_sdwa vcc, v29, v33 src0_sel:WORD_1 src1_sel:WORD_1
    v_alignbyte_b32 v32, v33, v32, 2
    s_mov_b32 s54, 35837
    v_alignbyte_b32 v29, v29, v28, 1
    v_perm_b32 v28, v28, v32, s47
    s_waitcnt lgkmcnt(0)
    v_add3_u32 v34, v34, v106, s54
    v_sub_u32 v35, 0, v34
    v_and_b32 v35, 3, v35
    s_mov_b64 exec, s[80:81]
    v_mov_b32 v35, 0
    v_mov_b32 v30, 0
    s_mov_b64 exec, vcc
    v_mov_b32 v35, 3

    s_mov_b64 exec, -1
    v_alignbyte_b32 v28, v29, v28, v35
    v_alignbyte_b32 v29, v30, v29, v35
    v_add_u32 v34, v34, v35

    buffer_store_dwordx2 v[28:29], v34, s[24:27], 0 offen
L_skw_44:
    s_bitcmp0_b32 s28, 2
    s_cbranch_scc1 L_skw_45
    v_add_u32 v107, 65536, v2
    ds_read_b64 v[4:5], v107 offset:16400
    ds_read_b64 v[6:7], v107 offset:16408
    ds_read_b64 v[8:9], v107 offset:16392

    ds_read_b64 v[12:13], v107 offset:24592
    ds_read_b64 v[14:15], v107 offset:24600
    ds_read_b64 v[16:17], v107 offset:24584

    ds_read_b64 v[20:21], v107 offset:32784
    ds_read_b64 v[22:23], v107 offset:32792
    ds_read_b64 v[24:25], v107 offset:32776

    ds_read_b64 v[28:29], v107 offset:40976
    ds_read_b64 v[30:31], v107 offset:40984
    ds_read_b64 v[32:33], v107 offset:40968

    s_waitcnt lgkmcnt(9)
    v_lshrrev_b32 v10, 16, v5
    ds_read_b32 v10, v10 offset:8192

    s_waitcnt lgkmcnt(7)
    v_lshrrev_b32 v18, 16, v13
    ds_read_b32 v18, v18 offset:8192

    s_waitcnt lgkmcnt(5)
    v_lshrrev_b32 v26, 16, v21
    ds_read_b32 v26, v26 offset:8192

    s_waitcnt lgkmcnt(3)
    v_lshrrev_b32 v34, 16, v29
    ds_read_b32 v34, v34 offset:8192

    v_cmp_ne_u32_sdwa s[80:81], v5, v7 src0_sel:WORD_1 src1_sel:WORD_1
    v_cmp_ne_u32_sdwa vcc, v5, v9 src0_sel:WORD_1 src1_sel:WORD_1
    v_alignbyte_b32 v8, v9, v8, 2
    s_mov_b32 s54, 40957
    v_alignbyte_b32 v5, v5, v4, 1
    v_perm_b32 v4, v4, v8, s47
    s_waitcnt lgkmcnt(3)
    v_add3_u32 v10, v10, v106, s54
    v_sub_u32 v11, 0, v10
    v_and_b32 v11, 3, v11
    s_mov_b64 exec, s[80:81]
    v_mov_b32 v11, 0
    v_mov_b32 v6, 0
    s_mov_b64 exec, vcc
    v_mov_b32 v11, 3

    s_mov_b64 exec, -1
    v_alignbyte_b32 v4, v5, v4, v11
    v_alignbyte_b32 v5, v6, v5, v11
    v_add_u32 v10, v10, v11

    buffer_store_dwordx2 v[4:5], v10, s[24:27], 0 offen
    v_cmp_ne_u32_sdwa s[80:81], v13, v15 src0_sel:WORD_1 src1_sel:WORD_1
    v_cmp_ne_u32_sdwa vcc, v13, v17 src0_sel:WORD_1 src1_sel:WORD_1
    v_alignbyte_b32 v16, v17, v16, 2
    s_mov_b32 s54, 46077
    v_alignbyte_b32 v13, v13, v12, 1
    v_perm_b32 v12, v12, v16, s47
    s_waitcnt lgkmcnt(2)
    v_add3_u32 v18, v18, v106, s54
    v_sub_u32 v19, 0, v18
    v_and_b32 v19, 3, v19
    s_mov_b64 exec, s[80:81]
    v_mov_b32 v19, 0
    v_mov_b32 v14, 0
    s_mov_b64 exec, vcc
    v_mov_b32 v19, 3

    s_mov_b64 exec, -1
    v_alignbyte_b32 v12, v13, v12, v19
    v_alignbyte_b32 v13, v14, v13, v19
    v_add_u32 v18, v18, v19

    buffer_store_dwordx2 v[12:13], v18, s[24:27], 0 offen
    v_cmp_ne_u32_sdwa s[80:81], v21, v23 src0_sel:WORD_1 src1_sel:WORD_1
    v_cmp_ne_u32_sdwa vcc, v21, v25 src0_sel:WORD_1 src1_sel:WORD_1
    v_alignbyte_b32 v24, v25, v24, 2
    s_mov_b32 s54, 51197
    v_alignbyte_b32 v21, v21, v20, 1
    v_perm_b32 v20, v20, v24, s47
    s_waitcnt lgkmcnt(1)
    v_add3_u32 v26, v26, v106, s54
    v_sub_u32 v27, 0, v26
    v_and_b32 v27, 3, v27
    s_mov_b64 exec, s[80:81]
    v_mov_b32 v27, 0
    v_mov_b32 v22, 0
    s_mov_b64 exec, vcc
    v_mov_b32 v27, 3

    s_mov_b64 exec, -1
    v_alignbyte_b32 v20, v21, v20, v27
    v_alignbyte_b32 v21, v22, v21, v27
    v_add_u32 v26, v26, v27

    buffer_store_dwordx2 v[20:21], v26, s[24:27], 0 offen
    v_cmp_ne_u32_sdwa s[80:81], v29, v31 src0_sel:WORD_1 src1_sel:WORD_1
    v_cmp_ne_u32_sdwa vcc, v29, v33 src0_sel:WORD_1 src1_sel:WORD_1
    v_alignbyte_b32 v32, v33, v32, 2
    s_mov_b32 s54, 56317
    v_alignbyte_b32 v29, v29, v28, 1
    v_perm_b32 v28, v28, v32, s47
    s_waitcnt lgkmcnt(0)
    v_add3_u32 v34, v34, v106, s54
    v_sub_u32 v35, 0, v34
    v_and_b32 v35, 3, v35
    s_mov_b64 exec, s[80:81]
    v_mov_b32 v35, 0
    v_mov_b32 v30, 0
    s_mov_b64 exec, vcc
    v_mov_b32 v35, 3

    s_mov_b64 exec, -1
    v_alignbyte_b32 v28, v29, v28, v35
    v_alignbyte_b32 v29, v30, v29, v35
    v_add_u32 v34, v34, v35

    buffer_store_dwordx2 v[28:29], v34, s[24:27], 0 offen
L_skw_45:
    s_bitcmp0_b32 s28, 3
    s_cbranch_scc1 L_skw_46
    v_add_u32 v107, 98304, v2
    ds_read_b64 v[4:5], v107 offset:16400
    ds_read_b64 v[6:7], v107 offset:16408
    ds_read_b64 v[8:9], v107 offset:16392

    ds_read_b64 v[12:13], v107 offset:24592
    ds_read_b64 v[14:15], v107 offset:24600
    ds_read_b64 v[16:17], v107 offset:24584

    ds_read_b64 v[20:21], v107 offset:32784
    ds_read_b64 v[22:23], v107 offset:32792
    ds_read_b64 v[24:25], v107 offset:32776

    ds_read_b64 v[28:29], v107 offset:40976
    ds_read_b64 v[30:31], v107 offset:40984
    ds_read_b64 v[32:33], v107 offset:40968

    s_waitcnt lgkmcnt(9)
    v_lshrrev_b32 v10, 16, v5
    ds_read_b32 v10, v10 offset:8192

    s_waitcnt lgkmcnt(7)
    v_lshrrev_b32 v18, 16, v13
    ds_read_b32 v18, v18 offset:8192

    s_waitcnt lgkmcnt(5)
    v_lshrrev_b32 v26, 16, v21
    ds_read_b32 v26, v26 offset:8192

    s_waitcnt lgkmcnt(3)
    v_lshrrev_b32 v34, 16, v29
    ds_read_b32 v34, v34 offset:8192

    v_cmp_ne_u32_sdwa s[80:81], v5, v7 src0_sel:WORD_1 src1_sel:WORD_1
    v_cmp_ne_u32_sdwa vcc, v5, v9 src0_sel:WORD_1 src1_sel:WORD_1
    v_alignbyte_b32 v8, v9, v8, 2
    s_mov_b32 s54, 61437
    v_alignbyte_b32 v5, v5, v4, 1
    v_perm_b32 v4, v4, v8, s47
    s_waitcnt lgkmcnt(3)
    v_add3_u32 v10, v10, v106, s54
    v_sub_u32 v11, 0, v10
    v_and_b32 v11, 3, v11
    s_mov_b64 exec, s[80:81]
    v_mov_b32 v11, 0
    v_mov_b32 v6, 0
    s_mov_b64 exec, vcc
    v_mov_b32 v11, 3

    s_mov_b64 exec, -1
    v_alignbyte_b32 v4, v5, v4, v11
    v_alignbyte_b32 v5, v6, v5, v11
    v_add_u32 v10, v10, v11

    buffer_store_dwordx2 v[4:5], v10, s[24:27], 0 offen
    v_cmp_ne_u32_sdwa s[80:81], v13, v15 src0_sel:WORD_1 src1_sel:WORD_1
    v_cmp_ne_u32_sdwa vcc, v13, v17 src0_sel:WORD_1 src1_sel:WORD_1
    v_alignbyte_b32 v16, v17, v16, 2
    s_mov_b32 s54, 66557
    v_alignbyte_b32 v13, v13, v12, 1
    v_perm_b32 v12, v12, v16, s47
    s_waitcnt lgkmcnt(2)
    v_add3_u32 v18, v18, v106, s54
    v_sub_u32 v19, 0, v18
    v_and_b32 v19, 3, v19
    s_mov_b64 exec, s[80:81]
    v_mov_b32 v19, 0
    v_mov_b32 v14, 0
    s_mov_b64 exec, vcc
    v_mov_b32 v19, 3

    s_mov_b64 exec, -1
    v_alignbyte_b32 v12, v13, v12, v19
    v_alignbyte_b32 v13, v14, v13, v19
    v_add_u32 v18, v18, v19

    buffer_store_dwordx2 v[12:13], v18, s[24:27], 0 offen
    v_cmp_ne_u32_sdwa s[80:81], v21, v23 src0_sel:WORD_1 src1_sel:WORD_1
    v_cmp_ne_u32_sdwa vcc, v21, v25 src0_sel:WORD_1 src1_sel:WORD_1
    v_alignbyte_b32 v24, v25, v24, 2
    s_mov_b32 s54, 71677
    v_alignbyte_b32 v21, v21, v20, 1
    v_perm_b32 v20, v20, v24, s47
    s_waitcnt lgkmcnt(1)
    v_add3_u32 v26, v26, v106, s54
    v_sub_u32 v27, 0, v26
    v_and_b32 v27, 3, v27
    s_mov_b64 exec, s[80:81]
    v_mov_b32 v27, 0
    v_mov_b32 v22, 0
    s_mov_b64 exec, vcc
    v_mov_b32 v27, 3

    s_mov_b64 exec, -1
    v_alignbyte_b32 v20, v21, v20, v27
    v_alignbyte_b32 v21, v22, v21, v27
    v_add_u32 v26, v26, v27

    buffer_store_dwordx2 v[20:21], v26, s[24:27], 0 offen
    v_cmp_ne_u32_sdwa s[80:81], v29, v31 src0_sel:WORD_1 src1_sel:WORD_1
    v_cmp_ne_u32_sdwa vcc, v29, v33 src0_sel:WORD_1 src1_sel:WORD_1
    v_alignbyte_b32 v32, v33, v32, 2
    s_mov_b32 s54, 76797
    v_alignbyte_b32 v29, v29, v28, 1
    v_perm_b32 v28, v28, v32, s47
    s_waitcnt lgkmcnt(0)
    v_add3_u32 v34, v34, v106, s54
    v_sub_u32 v35, 0, v34
    v_and_b32 v35, 3, v35
    s_mov_b64 exec, s[80:81]
    v_mov_b32 v35, 0
    v_mov_b32 v30, 0
    s_mov_b64 exec, vcc
    v_mov_b32 v35, 3

    s_andn2_b64 exec, -1, s[68:69]
    v_bfrev_b32 v34, 1
    s_mov_b64 exec, -1
    v_alignbyte_b32 v28, v29, v28, v35
    v_alignbyte_b32 v29, v30, v29, v35
    v_add_u32 v34, v34, v35

    buffer_store_dwordx2 v[28:29], v34, s[24:27], 0 offen
L_skw_46:
L_p1done_1:
    s_endpgm

L_ska_8:
    v_bfrev_b32 v126, 1
    buffer_load_dword v3, v126, s[96:99], 0 offen
    buffer_load_dword v3, v126, s[96:99], 0 offen
    buffer_load_dword v3, v126, s[96:99], 0 offen
    s_branch L_bka_9
L_ska_10:
    v_bfrev_b32 v126, 1
    buffer_load_dword v3, v126, s[96:99], 0 offen
    buffer_load_dword v3, v126, s[96:99], 0 offen
    buffer_load_dword v3, v126, s[96:99], 0 offen
    s_branch L_bka_11
L_ska_12:
    v_bfrev_b32 v126, 1
    buffer_load_dword v3, v126, s[96:99], 0 offen
    buffer_load_dword v3, v126, s[96:99], 0 offen
    buffer_load_dword v3, v126, s[96:99], 0 offen
    s_branch L_bka_13
L_ska_14:
    v_bfrev_b32 v126, 1
    buffer_load_dword v3, v126, s[96:99], 0 offen
    buffer_load_dword v3, v126, s[96:99], 0 offen
    buffer_load_dword v3, v126, s[96:99], 0 offen
    s_branch L_bka_15
L_full_27:
    v_mov_b32 v110, 0
    s_mov_b64 exec, vcc
    v_bfrev_b32 v92, 1
    v_bfrev_b32 v93, 1
    s_mov_b64 exec, 1
    buffer_atomic_or v104, v110, s[36:39], 0 offen
    s_mov_b64 exec, -1
    s_branch L_fback_28

L_full_41:
    v_mov_b32 v110, 0
    s_mov_b64 exec, vcc
    v_bfrev_b32 v92, 1
    v_bfrev_b32 v93, 1
    s_mov_b64 exec, 1
    buffer_atomic_or v104, v110, s[36:39], 0 offen
    s_mov_b64 exec, -1
    s_branch L_fback_42

.globl standalone__molecular_angular_gemnet__graph_kernel
.p2align 8
.type standalone__molecular_angular_gemnet__graph_kernel,@function
standalone__molecular_angular_gemnet__graph_kernel:
    s_cmp_ge_u32 s2, 256
    s_cbranch_scc1 L_p2done_47
    s_load_dwordx2 s[8:9], s[0:1], 0
    s_load_dwordx2 s[6:7], s[0:1], 104
    v_lshrrev_b32 v4, 6, v0

    s_lshr_b32 s37, s2, 1
    s_and_b32 s37, s37, 3
    s_lshr_b32 s36, s2, 3
    s_lshl_b32 s36, s36, 1
    s_and_b32 s3, s2, 1
    s_or_b32 s36, s36, s3

    v_readfirstlane_b32 s4, v4
    v_and_b32 v2, 63, v0
    v_lshrrev_b32 v3, 9, v0
    v_lshl_or_b32 v2, v3, 6, v2
    v_mul_u32_u24 v2, 20, v2
    v_lshlrev_b32 v3, 4, v0

    s_waitcnt lgkmcnt(0)
    s_lshl_b32 m0, s4, 10
    s_and_b32 s5, s4, 7
    s_lshr_b32 s39, s4, 3
    s_lshl_b32 s39, s39, 8
    s_mul_i32 s3, s5, 4096
    s_add_u32 s46, s6, s3
    s_addc_u32 s47, s7, 0
    s_mul_i32 s3, s5, 67117056
    s_add_u32 s3, s3, 85721088
    s_add_u32 s44, s6, s3
    s_addc_u32 s45, s7, 0
    s_mul_i32 s38, s37, 8
    s_add_u32 s4, s38, 8
    s_lshl_b32 s3, s38, 6
    s_add_u32 s3, s3, s36
    s_lshr_b32 s3, s3, 1
    s_lshl_b32 s3, s3, 2
    s_add_u32 s52, s46, s3
    s_addc_u32 s53, s47, 0

    s_load_dword s88, s[52:53], 0
    s_load_dword s89, s[52:53], 128
    s_load_dword s90, s[52:53], 256
    s_load_dword s91, s[52:53], 384
    s_load_dword s92, s[52:53], 512
    s_load_dword s93, s[52:53], 640
    s_load_dword s94, s[52:53], 768
    s_load_dword s95, s[52:53], 896
    s_mov_b32 s3, 32768
    s_load_dword s51, s[6:7], s3
    s_mov_b32 s10, 6400000
    s_mov_b32 s11, 0x20000

    s_add_u32 s12, s6, 2490368
    s_addc_u32 s13, s7, 0
    s_mov_b32 s14, 0
    s_mov_b32 s15, 0x20000
    s_add_u32 s60, s6, 2490368
    s_addc_u32 s61, s7, 0
    s_mov_b32 s62, 6406144
    s_mov_b32 s63, 0x20000
    s_mov_b32 s3, 135176
    s_load_dword s33, s[6:7], s3

    s_mul_i32 s43, s38, 200192
    s_mul_i32 s41, s4, 200192
    s_mul_i32 s50, s38, 200000
    s_add_u32 s14, s43, 50000

    buffer_load_dwordx4 v[76:79], v3, s[12:15], s43 offen
    s_add_u32 s52, s43, 16384
    buffer_load_dwordx4 v[80:83], v3, s[12:15], s52 offen
    s_add_u32 s52, s43, 32768
    buffer_load_dwordx4 v[84:87], v3, s[12:15], s52 offen
    s_add_u32 s52, s43, 49152
    v_lshlrev_b32 v119, 2, v0
    buffer_load_dword v88, v119, s[12:15], s52 offen
    s_add_u32 s20, s6, 135168
    s_addc_u32 s21, s7, 0
    s_mov_b32 s22, 4096
    s_mov_b32 s23, 0x20000
    v_and_b32 v44, 63, v0
    v_lshlrev_b32 v44, 4, v44
    buffer_load_dwordx2 v[120:121], v44, s[20:23], 0 offen offset:0
    buffer_load_dwordx2 v[122:123], v44, s[20:23], 0 offen offset:1024
    buffer_load_dwordx2 v[124:125], v44, s[20:23], 0 offen offset:2048
    buffer_load_dwordx2 v[126:127], v44, s[20:23], 0 offen offset:3072
    s_movk_i32 s40, 3072
    s_mov_b32 s19, 0x20000
    s_min_u32 s40, s40, 6524
    s_lshl_b32 s52, s38, 6
    s_add_u32 s52, s52, s36
    s_mul_i32 s52, s52, 32764
    s_and_b32 s52, s52, 0xffffff80
    s_add_u32 s16, s44, s52
    s_addc_u32 s17, s45, 0
    s_mul_i32 s52, s40, 5
    s_add_u32 s52, s52, 3
    s_and_b32 s18, s52, -4

    s_movk_i32 s53, 5120
    buffer_load_dwordx4 v[90:93], v2, s[16:19], s53 offen
    buffer_load_dword v110, v2, s[16:19], s53 offen offset:16
    s_movk_i32 s53, 7680
    buffer_load_dwordx4 v[94:97], v2, s[16:19], s53 offen
    buffer_load_dword v111, v2, s[16:19], s53 offen offset:16
    s_movk_i32 s53, 10240
    buffer_load_dwordx4 v[98:101], v2, s[16:19], s53 offen
    buffer_load_dword v112, v2, s[16:19], s53 offen offset:16
    s_lshr_b32 s3, s2, 3
    s_mul_i32 s3, s3, 49
    v_add_lshl_u32 v89, v0, s3, 7
    v_cmp_gt_u32 vcc, 49, v0
    v_bfrev_b32 v28, 1
    s_nop 0
    v_cndmask_b32 v89, v28, v89, vcc

    s_mov_b32 s19, 0x20000
    s_mov_b32 s28, 0x4b404000
    s_mov_b32 s29, 0x4b404000
    s_mov_b32 s30, 0xbfffc000
    s_mov_b32 s31, 0xbfffbfff
    s_mov_b32 s32, 0xffff0000
    s_mov_b32 s35, 0x05040100
    s_mov_b32 s97, 0x07060302
    s_mov_b32 s96, 0x40008000
    s_movk_i32 s3, 212
    v_cmp_gt_u32 s[48:49], s3, v0

    v_mov_b32 v1, 0
    s_mov_b32 s24, 0xc0c0004
    s_mov_b32 s25, 0xc0c0105
    s_mov_b32 s26, 0xc0c0206
    s_mov_b32 s27, 0xc0c0307
    v_mov_b32 v28, 0x40004000
    v_mov_b32 v29, 0x40004000
    v_mov_b32 v30, 0x40004000
    v_mov_b32 v31, 0x40004000
    v_add_u32 v32, 50000, v3
    v_add_u32 v33, 65536, v32

    ds_write_b128 v32, v[28:31] offset:0
    ds_write_b128 v32, v[28:31] offset:16384
    ds_write_b128 v32, v[28:31] offset:32768
    ds_write_b128 v32, v[28:31] offset:49152
    ds_write_b128 v33, v[28:31] offset:0
    ds_write_b128 v33, v[28:31] offset:16384
    v_cmp_gt_u32 vcc, 971, v0
    s_mov_b64 exec, vcc
    ds_write_b128 v33, v[28:31] offset:32768
    s_mov_b64 exec, -1
    s_waitcnt vmcnt(13)
    ds_write_addtid_b32 v76 offset:0
    ds_write_addtid_b32 v77 offset:256
    ds_write_addtid_b32 v78 offset:512
    ds_write_addtid_b32 v79 offset:768
    s_waitcnt vmcnt(12)
    ds_write_addtid_b32 v80 offset:16384
    ds_write_addtid_b32 v81 offset:16640
    ds_write_addtid_b32 v82 offset:16896
    ds_write_addtid_b32 v83 offset:17152
    s_waitcnt vmcnt(11)
    ds_write_addtid_b32 v84 offset:32768
    ds_write_addtid_b32 v85 offset:33024
    ds_write_addtid_b32 v86 offset:33280
    ds_write_addtid_b32 v87 offset:33536
    v_lshlrev_b32 v119, 2, v0
    s_waitcnt vmcnt(10)
    s_mov_b64 exec, s[48:49]
    ds_write_b32 v119, v88 offset:49152
    s_mov_b64 exec, -1
    s_add_u32 s43, s43, 50048
    s_add_u32 s14, s43, 50000
    s_min_u32 s14, s14, s41
    s_and_b32 s3, s36, 1
    s_lshl_b32 s3, s3, 4
    s_or_b32 s3, s3, 0x100000
    s_waitcnt lgkmcnt(0)

    s_bfe_u32 s88, s88, s3
    s_bfe_u32 s89, s89, s3
    s_bfe_u32 s90, s90, s3
    s_bfe_u32 s91, s91, s3
    s_bfe_u32 s92, s92, s3
    s_bfe_u32 s93, s93, s3
    s_bfe_u32 s94, s94, s3
    s_bfe_u32 s95, s95, s3
    s_waitcnt vmcnt(6)
    v_max3_u32 v120, v120, v122, v124
    v_add_f32 v121, v121, v123
    v_add_f32 v125, v125, v127
    v_max_u32 v120, v120, v126
    v_add_f32 v121, v121, v125

    s_nop 1
    v_max_u32_dpp v120, v120, v120 row_shr:1 row_mask:0xf bank_mask:0xf
    s_nop 1
    v_max_u32_dpp v120, v120, v120 row_shr:2 row_mask:0xf bank_mask:0xf
    s_nop 1
    v_max_u32_dpp v120, v120, v120 row_shr:4 row_mask:0xf bank_mask:0xf
    s_nop 1
    v_max_u32_dpp v120, v120, v120 row_shr:8 row_mask:0xf bank_mask:0xf
    s_nop 1
    v_max_u32_dpp v120, v120, v120 row_bcast:15 row_mask:0xa bank_mask:0xf
    s_nop 1
    v_max_u32_dpp v120, v120, v120 row_bcast:31 row_mask:0xc bank_mask:0xf
    s_nop 1
    v_add_f32_dpp v121, v121, v121 row_shr:1 row_mask:0xf bank_mask:0xf
    s_nop 1
    v_add_f32_dpp v121, v121, v121 row_shr:2 row_mask:0xf bank_mask:0xf
    s_nop 1
    v_add_f32_dpp v121, v121, v121 row_shr:4 row_mask:0xf bank_mask:0xf
    s_nop 1
    v_add_f32_dpp v121, v121, v121 row_shr:8 row_mask:0xf bank_mask:0xf
    s_nop 1
    v_add_f32_dpp v121, v121, v121 row_bcast:15 row_mask:0xa bank_mask:0xf
    s_nop 1
    v_add_f32_dpp v121, v121, v121 row_bcast:31 row_mask:0xc bank_mask:0xf
    v_lshlrev_b32 v120, 16, v120
    v_mul_f32 v121, 0x34a7c5ac, v121
    v_sqrt_f32 v121, v121
    v_mul_f32 v120, s33, v120
    v_mul_f32 v121, s33, v121
    v_cmp_gt_f32 vcc, 0x46fde800, v120
    s_mov_b64 s[64:65], vcc
    v_cmp_lt_f32 vcc, 0x44000000, v121
    v_mov_b32 v120, 0x37800000
    v_mul_f32 v120, s33, v120
    s_and_b64 vcc, vcc, s[64:65]
    v_mul_f32 v121, 0x46ff8000, v120
    v_rcp_f32 v121, v121
    v_readfirstlane_b32 s33, v120
    s_waitcnt lgkmcnt(0)
    s_barrier
    v_readfirstlane_b32 s34, v121
    v_mov_b32 v120, 150016
    v_mov_b32 v121, 0
    ds_write_b32 v120, v121 offset:8
    s_bitcmp0_b64 vcc, 63
    s_cbranch_scc1 L_p2slow_48
    s_cmp_lg_u32 s51, 0
    s_cbranch_scc1 L_p2slow_48

    s_min_u32 s88, s88, 6524
    s_lshl_b32 s52, s38, 6
    s_add_u32 s52, s52, s36
    s_mul_i32 s52, s52, 32764
    s_and_b32 s52, s52, 0xffffff80
    s_add_u32 s16, s44, s52
    s_addc_u32 s17, s45, 0
    s_mul_i32 s52, s88, 5
    s_add_u32 s52, s52, 3
    s_and_b32 s18, s52, -4

    s_movk_i32 s53, 12800
    buffer_load_dwordx4 v[102:105], v2, s[16:19], s53 offen
    buffer_load_dword v113, v2, s[16:19], s53 offen offset:16
    s_movk_i32 s53, 0
    buffer_load_dwordx4 v[4:7], v2, s[16:19], s53 offen nt
    buffer_load_dword v35, v2, s[16:19], s53 offen offset:16 nt
    s_movk_i32 s53, 2560
    buffer_load_dwordx4 v[8:11], v2, s[16:19], s53 offen
    buffer_load_dword v43, v2, s[16:19], s53 offen offset:16
    s_movk_i32 s53, 15360
    buffer_load_dwordx4 v[106:109], v2, s[16:19], s53 offen
    buffer_load_dword v114, v2, s[16:19], s53 offen offset:16
    s_mov_b32 s40, s88
    s_sub_u32 s42, s40, s39

    s_add_u32 s55, s38, 1
    s_min_u32 s55, s55, 31
    s_mov_b32 s88, s89
    s_mov_b32 s89, s90
    s_mov_b32 s90, s91
    s_mov_b32 s91, s92
    s_mov_b32 s92, s93
    s_mov_b32 s93, s94
    s_mov_b32 s94, s95
    s_mov_b32 s95, 0
    s_min_u32 s88, s88, 6524
    s_lshl_b32 s52, s55, 6
    s_add_u32 s52, s52, s36
    s_mul_i32 s52, s52, 32764
    s_and_b32 s52, s52, 0xffffff80
    s_add_u32 s16, s44, s52
    s_addc_u32 s17, s45, 0
    s_mul_i32 s52, s88, 5
    s_add_u32 s52, s52, 3
    s_and_b32 s18, s52, -4

    s_waitcnt vmcnt(12)
    v_perm_b32 v44, v91, v90, s24
    v_perm_b32 v46, v92, v91, s25
    v_perm_b32 v48, v93, v92, s26
    v_perm_b32 v50, v110, v93, s27
    v_mov_b32 v12, v90
    v_alignbyte_b32 v13, v92, v91, 1
    v_alignbyte_b32 v14, v93, v92, 2
    v_alignbyte_b32 v15, v110, v93, 3
    v_lshlrev_b32_sdwa v44, 3, v44 dst_sel:WORD_0 dst_unused:UNUSED_PAD src0_sel:DWORD src1_sel:DWORD
    v_lshlrev_b32_sdwa v46, 3, v46 dst_sel:WORD_0 dst_unused:UNUSED_PAD src0_sel:DWORD src1_sel:DWORD
    v_lshlrev_b32_sdwa v48, 3, v48 dst_sel:WORD_0 dst_unused:UNUSED_PAD src0_sel:DWORD src1_sel:DWORD
    v_lshlrev_b32_sdwa v50, 3, v50 dst_sel:WORD_0 dst_unused:UNUSED_PAD src0_sel:DWORD src1_sel:DWORD
    s_cmp_lt_i32 s42, 1280
    s_cbranch_scc1 L_ufix_49
L_uback_50:

    v_subrev_co_u32 v12, s[80:81], 2.0, v12
    v_subrev_co_u32 v13, s[82:83], 2.0, v13
    v_subrev_co_u32 v14, s[84:85], 2.0, v14
    v_subrev_co_u32 v15, s[86:87], 2.0, v15
    s_mov_b64 exec, s[80:81]
    ds_read_b64 v[44:45], v44
    s_mov_b64 exec, s[82:83]
    ds_read_b64 v[46:47], v46
    s_mov_b64 exec, s[84:85]
    ds_read_b64 v[48:49], v48
    s_mov_b64 exec, s[86:87]
    ds_read_b64 v[50:51], v50
    s_mov_b64 exec, -1
    s_waitcnt vmcnt(10)
    v_perm_b32 v52, v95, v94, s24
    v_perm_b32 v54, v96, v95, s25
    v_perm_b32 v56, v97, v96, s26
    v_perm_b32 v58, v111, v97, s27
    v_mov_b32 v16, v94
    v_alignbyte_b32 v17, v96, v95, 1
    v_alignbyte_b32 v18, v97, v96, 2
    v_alignbyte_b32 v19, v111, v97, 3
    v_lshlrev_b32_sdwa v52, 3, v52 dst_sel:WORD_0 dst_unused:UNUSED_PAD src0_sel:DWORD src1_sel:DWORD
    v_lshlrev_b32_sdwa v54, 3, v54 dst_sel:WORD_0 dst_unused:UNUSED_PAD src0_sel:DWORD src1_sel:DWORD
    v_lshlrev_b32_sdwa v56, 3, v56 dst_sel:WORD_0 dst_unused:UNUSED_PAD src0_sel:DWORD src1_sel:DWORD
    v_lshlrev_b32_sdwa v58, 3, v58 dst_sel:WORD_0 dst_unused:UNUSED_PAD src0_sel:DWORD src1_sel:DWORD
    s_cmp_lt_i32 s42, 1792
    s_cbranch_scc1 L_ufix_51
L_uback_52:

    v_subrev_co_u32 v16, s[64:65], 2.0, v16
    v_subrev_co_u32 v17, s[66:67], 2.0, v17
    v_subrev_co_u32 v18, s[68:69], 2.0, v18
    v_subrev_co_u32 v19, s[70:71], 2.0, v19
    s_mov_b64 exec, s[64:65]
    ds_read_b64 v[52:53], v52
    s_mov_b64 exec, s[66:67]
    ds_read_b64 v[54:55], v54
    s_mov_b64 exec, s[68:69]
    ds_read_b64 v[56:57], v56
    s_mov_b64 exec, s[70:71]
    ds_read_b64 v[58:59], v58
    s_mov_b64 exec, -1
    s_waitcnt vmcnt(8)
    v_perm_b32 v60, v99, v98, s24
    v_perm_b32 v62, v100, v99, s25
    v_perm_b32 v64, v101, v100, s26
    v_perm_b32 v66, v112, v101, s27
    v_mov_b32 v20, v98
    v_alignbyte_b32 v21, v100, v99, 1
    v_alignbyte_b32 v22, v101, v100, 2
    v_alignbyte_b32 v23, v112, v101, 3
    v_lshlrev_b32_sdwa v60, 3, v60 dst_sel:WORD_0 dst_unused:UNUSED_PAD src0_sel:DWORD src1_sel:DWORD
    v_lshlrev_b32_sdwa v62, 3, v62 dst_sel:WORD_0 dst_unused:UNUSED_PAD src0_sel:DWORD src1_sel:DWORD
    v_lshlrev_b32_sdwa v64, 3, v64 dst_sel:WORD_0 dst_unused:UNUSED_PAD src0_sel:DWORD src1_sel:DWORD
    v_lshlrev_b32_sdwa v66, 3, v66 dst_sel:WORD_0 dst_unused:UNUSED_PAD src0_sel:DWORD src1_sel:DWORD
    s_cmp_lt_i32 s42, 2304
    s_cbranch_scc1 L_ufix_53
L_uback_54:

    v_subrev_co_u32 v20, s[72:73], 2.0, v20
    v_subrev_co_u32 v21, s[74:75], 2.0, v21
    v_subrev_co_u32 v22, s[76:77], 2.0, v22
    v_subrev_co_u32 v23, s[78:79], 2.0, v23
    s_mov_b64 exec, s[72:73]
    ds_read_b64 v[60:61], v60
    s_mov_b64 exec, s[74:75]
    ds_read_b64 v[62:63], v62
    s_mov_b64 exec, s[76:77]
    ds_read_b64 v[64:65], v64
    s_mov_b64 exec, s[78:79]
    ds_read_b64 v[66:67], v66
    s_mov_b64 exec, -1
    s_waitcnt vmcnt(6)
    v_perm_b32 v68, v103, v102, s24
    v_perm_b32 v70, v104, v103, s25
    v_perm_b32 v72, v105, v104, s26
    v_perm_b32 v74, v113, v105, s27
    v_mov_b32 v24, v102
    v_alignbyte_b32 v25, v104, v103, 1
    v_alignbyte_b32 v26, v105, v104, 2
    v_alignbyte_b32 v27, v113, v105, 3
    v_lshlrev_b32_sdwa v68, 3, v68 dst_sel:WORD_0 dst_unused:UNUSED_PAD src0_sel:DWORD src1_sel:DWORD
    v_lshlrev_b32_sdwa v70, 3, v70 dst_sel:WORD_0 dst_unused:UNUSED_PAD src0_sel:DWORD src1_sel:DWORD
    v_lshlrev_b32_sdwa v72, 3, v72 dst_sel:WORD_0 dst_unused:UNUSED_PAD src0_sel:DWORD src1_sel:DWORD
    v_lshlrev_b32_sdwa v74, 3, v74 dst_sel:WORD_0 dst_unused:UNUSED_PAD src0_sel:DWORD src1_sel:DWORD
    s_cmp_lt_i32 s42, 2816
    s_cbranch_scc1 L_ufix_55
L_uback_56:

    v_subrev_co_u32 v24, s[80:81], 2.0, v24
    v_subrev_co_u32 v25, s[82:83], 2.0, v25
    v_subrev_co_u32 v26, s[84:85], 2.0, v26
    v_subrev_co_u32 v27, s[86:87], 2.0, v27
    s_mov_b64 exec, s[80:81]
    ds_read_b64 v[68:69], v68
    s_mov_b64 exec, s[82:83]
    ds_read_b64 v[70:71], v70
    s_mov_b64 exec, s[84:85]
    ds_read_b64 v[72:73], v72
    s_mov_b64 exec, s[86:87]
    ds_read_b64 v[74:75], v74
    s_mov_b64 exec, -1
    s_waitcnt vmcnt(4)
    v_perm_b32 v28, v5, v4, s24
    v_perm_b32 v30, v6, v5, s25
    v_perm_b32 v32, v7, v6, s26
    v_perm_b32 v34, v35, v7, s27
    v_alignbyte_b32 v5, v6, v5, 1
    v_alignbyte_b32 v6, v7, v6, 2
    v_alignbyte_b32 v7, v35, v7, 3
    v_lshlrev_b32_sdwa v28, 3, v28 dst_sel:WORD_0 dst_unused:UNUSED_PAD src0_sel:DWORD src1_sel:DWORD
    v_lshlrev_b32_sdwa v30, 3, v30 dst_sel:WORD_0 dst_unused:UNUSED_PAD src0_sel:DWORD src1_sel:DWORD
    v_lshlrev_b32_sdwa v32, 3, v32 dst_sel:WORD_0 dst_unused:UNUSED_PAD src0_sel:DWORD src1_sel:DWORD
    v_lshlrev_b32_sdwa v34, 3, v34 dst_sel:WORD_0 dst_unused:UNUSED_PAD src0_sel:DWORD src1_sel:DWORD
    s_cmp_lt_i32 s42, 256
    s_cbranch_scc1 L_ufix_57
L_uback_58:

    v_subrev_co_u32 v4, s[64:65], 2.0, v4
    v_subrev_co_u32 v5, s[66:67], 2.0, v5
    v_subrev_co_u32 v6, s[68:69], 2.0, v6
    v_subrev_co_u32 v7, s[70:71], 2.0, v7
    s_mov_b64 exec, s[64:65]
    ds_read_b64 v[28:29], v28
    s_mov_b64 exec, s[66:67]
    ds_read_b64 v[30:31], v30
    s_mov_b64 exec, s[68:69]
    ds_read_b64 v[32:33], v32
    s_mov_b64 exec, s[70:71]
    ds_read_b64 v[34:35], v34
    s_mov_b64 exec, -1
    buffer_load_dwordx4 v[76:79], v3, s[12:15], s43 offen
    s_add_u32 s52, s43, 16384
    buffer_load_dwordx4 v[80:83], v3, s[12:15], s52 offen
    s_add_u32 s52, s43, 32768
    buffer_load_dwordx4 v[84:87], v3, s[12:15], s52 offen
    s_add_u32 s52, s43, 49152
    v_lshlrev_b32 v119, 2, v0
    buffer_load_dword v88, v119, s[12:15], s52 offen
    s_add_u32 s54, s43, 50048
    buffer_load_dword v115, v89, s[60:63], s54 offen
    s_add_u32 s54, s50, 0
    buffer_load_dword v115, v89, s[8:11], s54 offen
    s_waitcnt vmcnt(8)
    v_perm_b32 v36, v9, v8, s24
    v_perm_b32 v38, v10, v9, s25
    v_perm_b32 v40, v11, v10, s26
    v_perm_b32 v42, v43, v11, s27
    v_alignbyte_b32 v9, v10, v9, 1
    v_alignbyte_b32 v10, v11, v10, 2
    v_alignbyte_b32 v11, v43, v11, 3
    v_lshlrev_b32_sdwa v36, 3, v36 dst_sel:WORD_0 dst_unused:UNUSED_PAD src0_sel:DWORD src1_sel:DWORD
    v_lshlrev_b32_sdwa v38, 3, v38 dst_sel:WORD_0 dst_unused:UNUSED_PAD src0_sel:DWORD src1_sel:DWORD
    v_lshlrev_b32_sdwa v40, 3, v40 dst_sel:WORD_0 dst_unused:UNUSED_PAD src0_sel:DWORD src1_sel:DWORD
    v_lshlrev_b32_sdwa v42, 3, v42 dst_sel:WORD_0 dst_unused:UNUSED_PAD src0_sel:DWORD src1_sel:DWORD
    s_cmp_lt_i32 s42, 768
    s_cbranch_scc1 L_ufix_59
L_uback_60:

    v_subrev_co_u32 v8, s[72:73], 2.0, v8
    v_subrev_co_u32 v9, s[74:75], 2.0, v9
    v_subrev_co_u32 v10, s[76:77], 2.0, v10
    v_subrev_co_u32 v11, s[78:79], 2.0, v11
    s_mov_b64 exec, s[72:73]
    ds_read_b64 v[36:37], v36
    s_mov_b64 exec, s[74:75]
    ds_read_b64 v[38:39], v38
    s_mov_b64 exec, s[76:77]
    ds_read_b64 v[40:41], v40
    s_mov_b64 exec, s[78:79]
    ds_read_b64 v[42:43], v42
    s_mov_b64 exec, -1
    s_movk_i32 s53, 5120
    buffer_load_dwordx4 v[90:93], v2, s[16:19], s53 offen
    buffer_load_dword v110, v2, s[16:19], s53 offen offset:16
L_batch_61:
    s_add_u32 s5, s38, 1

    s_movk_i32 s53, 7680
    buffer_load_dwordx4 v[94:97], v2, s[16:19], s53 offen
    buffer_load_dword v111, v2, s[16:19], s53 offen offset:16
    v_subrev_co_u32 v4, s[64:65], 2.0, v4
    v_subrev_co_u32 v5, s[66:67], 2.0, v5
    v_subrev_co_u32 v6, s[68:69], 2.0, v6
    v_subrev_co_u32 v7, s[70:71], 2.0, v7
    v_subrev_co_u32 v8, s[72:73], 2.0, v8
    v_subrev_co_u32 v9, s[74:75], 2.0, v9
    v_subrev_co_u32 v10, s[76:77], 2.0, v10
    v_subrev_co_u32 v11, s[78:79], 2.0, v11
    v_subrev_co_u32 v12, s[80:81], 2.0, v12
    v_subrev_co_u32 v13, s[82:83], 2.0, v13
    v_subrev_co_u32 v14, s[84:85], 2.0, v14
    v_subrev_co_u32 v15, s[86:87], 2.0, v15
    s_waitcnt lgkmcnt(0)
    s_barrier
    s_waitcnt vmcnt(7)
    ds_write_addtid_b32 v76 offset:0
    ds_write_addtid_b32 v77 offset:256
    ds_write_addtid_b32 v78 offset:512
    ds_write_addtid_b32 v79 offset:768
    s_waitcnt vmcnt(6)
    ds_write_addtid_b32 v80 offset:16384
    ds_write_addtid_b32 v81 offset:16640
    ds_write_addtid_b32 v82 offset:16896
    ds_write_addtid_b32 v83 offset:17152
    s_waitcnt vmcnt(5)
    ds_write_addtid_b32 v84 offset:32768
    ds_write_addtid_b32 v85 offset:33024
    ds_write_addtid_b32 v86 offset:33280
    ds_write_addtid_b32 v87 offset:33536
    v_lshlrev_b32 v119, 2, v0
    s_waitcnt vmcnt(4)
    s_mov_b64 exec, s[48:49]
    ds_write_b32 v119, v88 offset:49152
    s_mov_b64 exec, -1
    s_add_u32 s43, s43, 50048
    s_add_u32 s14, s43, 50000
    s_min_u32 s14, s14, s41
    buffer_load_dwordx4 v[76:79], v3, s[12:15], s43 offen
    s_waitcnt lgkmcnt(0)
    s_barrier
    s_add_u32 s52, s43, 16384
    buffer_load_dwordx4 v[80:83], v3, s[12:15], s52 offen
    s_add_u32 s52, s43, 32768
    buffer_load_dwordx4 v[84:87], v3, s[12:15], s52 offen
    s_add_u32 s52, s43, 49152
    v_lshlrev_b32 v119, 2, v0
    buffer_load_dword v88, v119, s[12:15], s52 offen
    s_mov_b64 exec, s[64:65]
    ds_read_b64 v[28:29], v28
    s_mov_b64 exec, s[66:67]
    ds_read_b64 v[30:31], v30
    s_mov_b64 exec, s[68:69]
    ds_read_b64 v[32:33], v32
    s_mov_b64 exec, s[70:71]
    ds_read_b64 v[34:35], v34
    s_mov_b64 exec, s[72:73]
    ds_read_b64 v[36:37], v36
    s_mov_b64 exec, s[74:75]
    ds_read_b64 v[38:39], v38
    s_mov_b64 exec, s[76:77]
    ds_read_b64 v[40:41], v40
    s_mov_b64 exec, s[78:79]
    ds_read_b64 v[42:43], v42
    s_mov_b64 exec, s[80:81]
    ds_read_b64 v[44:45], v44
    s_mov_b64 exec, s[82:83]
    ds_read_b64 v[46:47], v46
    s_mov_b64 exec, s[84:85]
    ds_read_b64 v[48:49], v48
    s_mov_b64 exec, s[86:87]
    ds_read_b64 v[50:51], v50
    s_mov_b64 exec, -1
    v_subrev_co_u32 v16, s[64:65], 2.0, v16
    v_subrev_co_u32 v17, s[66:67], 2.0, v17
    v_subrev_co_u32 v18, s[68:69], 2.0, v18
    v_subrev_co_u32 v19, s[70:71], 2.0, v19
    v_subrev_co_u32 v20, s[72:73], 2.0, v20
    v_subrev_co_u32 v21, s[74:75], 2.0, v21
    v_subrev_co_u32 v22, s[76:77], 2.0, v22
    v_subrev_co_u32 v23, s[78:79], 2.0, v23
    v_subrev_co_u32 v24, s[80:81], 2.0, v24
    v_subrev_co_u32 v25, s[82:83], 2.0, v25
    v_subrev_co_u32 v26, s[84:85], 2.0, v26
    v_subrev_co_u32 v27, s[86:87], 2.0, v27
    s_mov_b64 exec, s[64:65]
    ds_read_b64 v[52:53], v52
    s_mov_b64 exec, s[66:67]
    ds_read_b64 v[54:55], v54
    s_mov_b64 exec, s[68:69]
    ds_read_b64 v[56:57], v56
    s_mov_b64 exec, s[70:71]
    ds_read_b64 v[58:59], v58
    s_mov_b64 exec, s[72:73]
    ds_read_b64 v[60:61], v60
    s_mov_b64 exec, s[74:75]
    ds_read_b64 v[62:63], v62
    s_mov_b64 exec, s[76:77]
    ds_read_b64 v[64:65], v64
    s_mov_b64 exec, s[78:79]
    ds_read_b64 v[66:67], v66
    s_mov_b64 exec, s[80:81]
    ds_read_b64 v[68:69], v68
    s_mov_b64 exec, s[82:83]
    ds_read_b64 v[70:71], v70
    s_mov_b64 exec, s[84:85]
    ds_read_b64 v[72:73], v72
    s_mov_b64 exec, s[86:87]
    ds_read_b64 v[74:75], v74
    s_mov_b64 exec, -1
    s_cmp_le_i32 s42, 3072
    s_cbranch_scc1 L_nt1_63
    s_waitcnt vmcnt(14)
    v_perm_b32 v120, v107, v106, s24
    v_perm_b32 v122, v108, v107, s25
    v_perm_b32 v124, v109, v108, s26
    v_perm_b32 v126, v114, v109, s27
    v_alignbyte_b32 v107, v108, v107, 1
    v_alignbyte_b32 v108, v109, v108, 2
    v_alignbyte_b32 v109, v114, v109, 3
    v_lshlrev_b32_sdwa v120, 3, v120 dst_sel:WORD_0 dst_unused:UNUSED_PAD src0_sel:DWORD src1_sel:DWORD
    v_lshlrev_b32_sdwa v122, 3, v122 dst_sel:WORD_0 dst_unused:UNUSED_PAD src0_sel:DWORD src1_sel:DWORD
    v_lshlrev_b32_sdwa v124, 3, v124 dst_sel:WORD_0 dst_unused:UNUSED_PAD src0_sel:DWORD src1_sel:DWORD
    v_lshlrev_b32_sdwa v126, 3, v126 dst_sel:WORD_0 dst_unused:UNUSED_PAD src0_sel:DWORD src1_sel:DWORD
    s_cmp_lt_i32 s42, 3328
    s_cbranch_scc1 L_ufix_66
L_uback_67:

    v_lshrrev_b32 v117, 30, v106
    v_and_b32 v106, 0x3fffffff, v106
    v_mul_u32_u24 v117, 50000, v117
    v_cmp_ne_u32 vcc, 0, v106
    v_add_u32 v120, v120, v117
    s_mov_b64 exec, vcc

    buffer_load_dwordx2 v[120:121], v120, s[8:11], s50 offen
    s_mov_b64 exec, -1
    v_lshrrev_b32 v117, 30, v107
    v_and_b32 v107, 0x3fffffff, v107
    v_mul_u32_u24 v117, 50000, v117
    v_cmp_ne_u32 vcc, 0, v107
    v_add_u32 v122, v122, v117
    s_mov_b64 exec, vcc

    buffer_load_dwordx2 v[122:123], v122, s[8:11], s50 offen
    s_mov_b64 exec, -1
    v_lshrrev_b32 v117, 30, v108
    v_and_b32 v108, 0x3fffffff, v108
    v_mul_u32_u24 v117, 50000, v117
    v_cmp_ne_u32 vcc, 0, v108
    v_add_u32 v124, v124, v117
    s_mov_b64 exec, vcc

    buffer_load_dwordx2 v[124:125], v124, s[8:11], s50 offen
    s_mov_b64 exec, -1
    v_lshrrev_b32 v117, 30, v109
    v_and_b32 v109, 0x3fffffff, v109
    v_mul_u32_u24 v117, 50000, v117
    v_cmp_ne_u32 vcc, 0, v109
    v_add_u32 v126, v126, v117
    s_mov_b64 exec, vcc

    buffer_load_dwordx2 v[126:127], v126, s[8:11], s50 offen
    s_mov_b64 exec, -1
L_nt1_63:
    v_subrev_co_u32 v4, s[64:65], 2.0, v4
    v_subrev_co_u32 v5, s[66:67], 2.0, v5
    v_subrev_co_u32 v6, s[68:69], 2.0, v6
    v_subrev_co_u32 v7, s[70:71], 2.0, v7
    v_subrev_co_u32 v8, s[72:73], 2.0, v8
    v_subrev_co_u32 v9, s[74:75], 2.0, v9
    v_subrev_co_u32 v10, s[76:77], 2.0, v10
    v_subrev_co_u32 v11, s[78:79], 2.0, v11
    v_subrev_co_u32 v12, s[80:81], 2.0, v12
    v_subrev_co_u32 v13, s[82:83], 2.0, v13
    v_subrev_co_u32 v14, s[84:85], 2.0, v14
    v_subrev_co_u32 v15, s[86:87], 2.0, v15
    s_waitcnt lgkmcnt(0)
    s_barrier
    s_waitcnt vmcnt(3)
    ds_write_addtid_b32 v76 offset:0
    ds_write_addtid_b32 v77 offset:256
    ds_write_addtid_b32 v78 offset:512
    ds_write_addtid_b32 v79 offset:768
    s_waitcnt vmcnt(2)
    ds_write_addtid_b32 v80 offset:16384
    ds_write_addtid_b32 v81 offset:16640
    ds_write_addtid_b32 v82 offset:16896
    ds_write_addtid_b32 v83 offset:17152
    s_waitcnt vmcnt(1)
    ds_write_addtid_b32 v84 offset:32768
    ds_write_addtid_b32 v85 offset:33024
    ds_write_addtid_b32 v86 offset:33280
    ds_write_addtid_b32 v87 offset:33536
    v_lshlrev_b32 v119, 2, v0
    s_waitcnt vmcnt(0)
    s_mov_b64 exec, s[48:49]
    ds_write_b32 v119, v88 offset:49152
    s_mov_b64 exec, -1
    s_add_u32 s43, s43, 50048
    s_add_u32 s14, s43, 50000
    s_min_u32 s14, s14, s41
    buffer_load_dwordx4 v[76:79], v3, s[12:15], s43 offen
    s_waitcnt lgkmcnt(0)
    s_barrier
    s_add_u32 s52, s43, 16384
    buffer_load_dwordx4 v[80:83], v3, s[12:15], s52 offen
    s_add_u32 s52, s43, 32768
    buffer_load_dwordx4 v[84:87], v3, s[12:15], s52 offen
    s_add_u32 s52, s43, 49152
    v_lshlrev_b32 v119, 2, v0
    buffer_load_dword v88, v119, s[12:15], s52 offen
    s_mov_b64 exec, s[64:65]
    ds_read_b64 v[28:29], v28
    s_mov_b64 exec, s[66:67]
    ds_read_b64 v[30:31], v30
    s_mov_b64 exec, s[68:69]
    ds_read_b64 v[32:33], v32
    s_mov_b64 exec, s[70:71]
    ds_read_b64 v[34:35], v34
    s_mov_b64 exec, s[72:73]
    ds_read_b64 v[36:37], v36
    s_mov_b64 exec, s[74:75]
    ds_read_b64 v[38:39], v38
    s_mov_b64 exec, s[76:77]
    ds_read_b64 v[40:41], v40
    s_mov_b64 exec, s[78:79]
    ds_read_b64 v[42:43], v42
    s_mov_b64 exec, s[80:81]
    ds_read_b64 v[44:45], v44
    s_mov_b64 exec, s[82:83]
    ds_read_b64 v[46:47], v46
    s_mov_b64 exec, s[84:85]
    ds_read_b64 v[48:49], v48
    s_mov_b64 exec, s[86:87]
    ds_read_b64 v[50:51], v50
    s_mov_b64 exec, -1
    v_subrev_co_u32 v16, s[64:65], 2.0, v16
    v_subrev_co_u32 v17, s[66:67], 2.0, v17
    v_subrev_co_u32 v18, s[68:69], 2.0, v18
    v_subrev_co_u32 v19, s[70:71], 2.0, v19
    v_subrev_co_u32 v20, s[72:73], 2.0, v20
    v_subrev_co_u32 v21, s[74:75], 2.0, v21
    v_subrev_co_u32 v22, s[76:77], 2.0, v22
    v_subrev_co_u32 v23, s[78:79], 2.0, v23
    v_subrev_co_u32 v24, s[80:81], 2.0, v24
    v_subrev_co_u32 v25, s[82:83], 2.0, v25
    v_subrev_co_u32 v26, s[84:85], 2.0, v26
    v_subrev_co_u32 v27, s[86:87], 2.0, v27
    s_mov_b64 exec, s[64:65]
    ds_read_b64 v[52:53], v52
    s_mov_b64 exec, s[66:67]
    ds_read_b64 v[54:55], v54
    s_mov_b64 exec, s[68:69]
    ds_read_b64 v[56:57], v56
    s_mov_b64 exec, s[70:71]
    ds_read_b64 v[58:59], v58
    s_mov_b64 exec, s[72:73]
    ds_read_b64 v[60:61], v60
    s_mov_b64 exec, s[74:75]
    ds_read_b64 v[62:63], v62
    s_mov_b64 exec, s[76:77]
    ds_read_b64 v[64:65], v64
    s_mov_b64 exec, s[78:79]
    ds_read_b64 v[66:67], v66
    s_mov_b64 exec, s[80:81]
    ds_read_b64 v[68:69], v68
    s_mov_b64 exec, s[82:83]
    ds_read_b64 v[70:71], v70
    s_mov_b64 exec, s[84:85]
    ds_read_b64 v[72:73], v72
    s_mov_b64 exec, s[86:87]
    ds_read_b64 v[74:75], v74
    s_mov_b64 exec, -1
    s_movk_i32 s53, 10240
    buffer_load_dwordx4 v[98:101], v2, s[16:19], s53 offen
    buffer_load_dword v112, v2, s[16:19], s53 offen offset:16
    s_movk_i32 s53, 12800
    buffer_load_dwordx4 v[102:105], v2, s[16:19], s53 offen
    buffer_load_dword v113, v2, s[16:19], s53 offen offset:16
    s_cmp_le_i32 s42, 3072
    s_cbranch_scc1 L_nt2_64
    s_waitcnt vmcnt(8)
    v_cmp_ne_u32 s[56:57], 0, v106
    v_cmp_ne_u32 s[58:59], 0, v107
    v_cmp_ne_u32 s[98:99], 0, v108
    v_cmp_ne_u32 vcc, 0, v109
    s_mov_b64 exec, s[56:57]
    v_cvt_f32_i32_sdwa v118, sext(v106) dst_sel:DWORD dst_unused:UNUSED_PAD src0_sel:WORD_0
    v_lshlrev_b32 v116, 16, v120
    v_and_b32 v117, s32, v120
    v_mul_f32 v118, s33, v118
    v_lshlrev_b32 v120, 16, v121
    v_and_b32 v121, s32, v121
    v_lshlrev_b32_sdwa v106, 3, v106 dst_sel:DWORD dst_unused:UNUSED_PAD src0_sel:DWORD src1_sel:WORD_1
    v_pk_fma_f32 v[116:117], v[116:117], v[118:119], s[28:29] op_sel_hi:[1,0,1]
    v_pk_fma_f32 v[120:121], v[120:121], v[118:119], s[28:29] op_sel_hi:[1,0,1]
    v_perm_b32 v116, v117, v116, s35
    v_perm_b32 v117, v121, v120, s35
    v_lshl_add_u64 v[116:117], v[116:117], 0, s[30:31]
    ds_add_rtn_u64 v[120:121], v106, v[116:117] offset:50000

    s_mov_b64 exec, s[58:59]
    v_cvt_f32_i32_sdwa v118, sext(v107) dst_sel:DWORD dst_unused:UNUSED_PAD src0_sel:WORD_0
    v_lshlrev_b32 v116, 16, v122
    v_and_b32 v117, s32, v122
    v_mul_f32 v118, s33, v118
    v_lshlrev_b32 v122, 16, v123
    v_and_b32 v123, s32, v123
    v_lshlrev_b32_sdwa v107, 3, v107 dst_sel:DWORD dst_unused:UNUSED_PAD src0_sel:DWORD src1_sel:WORD_1
    v_pk_fma_f32 v[116:117], v[116:117], v[118:119], s[28:29] op_sel_hi:[1,0,1]
    v_pk_fma_f32 v[122:123], v[122:123], v[118:119], s[28:29] op_sel_hi:[1,0,1]
    v_perm_b32 v116, v117, v116, s35
    v_perm_b32 v117, v123, v122, s35
    v_lshl_add_u64 v[116:117], v[116:117], 0, s[30:31]
    ds_add_rtn_u64 v[122:123], v107, v[116:117] offset:50000

    s_mov_b64 exec, s[98:99]
    v_cvt_f32_i32_sdwa v118, sext(v108) dst_sel:DWORD dst_unused:UNUSED_PAD src0_sel:WORD_0
    v_lshlrev_b32 v116, 16, v124
    v_and_b32 v117, s32, v124
    v_mul_f32 v118, s33, v118
    v_lshlrev_b32 v124, 16, v125
    v_and_b32 v125, s32, v125
    v_lshlrev_b32_sdwa v108, 3, v108 dst_sel:DWORD dst_unused:UNUSED_PAD src0_sel:DWORD src1_sel:WORD_1
    v_pk_fma_f32 v[116:117], v[116:117], v[118:119], s[28:29] op_sel_hi:[1,0,1]
    v_pk_fma_f32 v[124:125], v[124:125], v[118:119], s[28:29] op_sel_hi:[1,0,1]
    v_perm_b32 v116, v117, v116, s35
    v_perm_b32 v117, v125, v124, s35
    v_lshl_add_u64 v[116:117], v[116:117], 0, s[30:31]
    ds_add_rtn_u64 v[124:125], v108, v[116:117] offset:50000

    s_mov_b64 exec, vcc
    v_cvt_f32_i32_sdwa v118, sext(v109) dst_sel:DWORD dst_unused:UNUSED_PAD src0_sel:WORD_0
    v_lshlrev_b32 v116, 16, v126
    v_and_b32 v117, s32, v126
    v_mul_f32 v118, s33, v118
    v_lshlrev_b32 v126, 16, v127
    v_and_b32 v127, s32, v127
    v_lshlrev_b32_sdwa v109, 3, v109 dst_sel:DWORD dst_unused:UNUSED_PAD src0_sel:DWORD src1_sel:WORD_1
    v_pk_fma_f32 v[116:117], v[116:117], v[118:119], s[28:29] op_sel_hi:[1,0,1]
    v_pk_fma_f32 v[126:127], v[126:127], v[118:119], s[28:29] op_sel_hi:[1,0,1]
    v_perm_b32 v116, v117, v116, s35
    v_perm_b32 v117, v127, v126, s35
    v_lshl_add_u64 v[116:117], v[116:117], 0, s[30:31]
    ds_add_rtn_u64 v[126:127], v109, v[116:117] offset:50000

    s_waitcnt lgkmcnt(0)
    s_mov_b64 exec, s[56:57]
    v_or3_b32 v1, v120, v121, v1
    s_mov_b64 exec, s[58:59]
    v_or3_b32 v1, v122, v123, v1
    s_mov_b64 exec, s[98:99]
    v_or3_b32 v1, v124, v125, v1
    s_mov_b64 exec, vcc
    v_or3_b32 v1, v126, v127, v1
    s_mov_b64 exec, -1
L_nt2_64:
    s_movk_i32 s53, 15360
    buffer_load_dwordx4 v[106:109], v2, s[16:19], s53 offen
    buffer_load_dword v114, v2, s[16:19], s53 offen offset:16
    s_cmp_le_u32 s40, 3584
    s_cbranch_scc1 L_noleft_65
    s_min_u32 s40, s40, 6524
    s_lshl_b32 s52, s38, 6
    s_add_u32 s52, s52, s36
    s_mul_i32 s52, s52, 32764
    s_and_b32 s52, s52, 0xffffff80
    s_add_u32 s20, s44, s52
    s_addc_u32 s21, s45, 0
    s_mul_i32 s52, s40, 5
    s_add_u32 s52, s52, 3
    s_and_b32 s22, s52, -4

    s_lshr_b32 s55, s39, 2
    s_add_u32 s55, s55, 3584
    v_and_b32 v120, 63, v0
    v_add_u32 v120, s55, v120
L_left_68:
    s_cmp_ge_u32 s55, s40
    s_cbranch_scc1 L_leftend_69
    v_mul_u32_u24 v121, 5, v120
    buffer_load_dword v122, v121, s[20:23], 0 offen
    buffer_load_ubyte v123, v121, s[20:23], 0 offen offset:4
    s_waitcnt vmcnt(0)

    v_perm_b32 v121, v123, v122, s24
    v_lshrrev_b32 v126, 30, v122
    v_and_b32 v121, 0x1fff, v121
    v_mul_u32_u24 v126, 6250, v126
    v_add_lshl_u32 v121, v121, v126, 3

    buffer_load_dwordx2 v[124:125], v121, s[8:11], s50 offen
    v_cmp_gt_u32 vcc, s40, v120
    s_waitcnt vmcnt(0)

    s_mov_b64 exec, vcc
    v_and_b32 v122, 0x3fffffff, v122
    v_cvt_f32_i32_sdwa v118, sext(v122) dst_sel:DWORD dst_unused:UNUSED_PAD src0_sel:WORD_0
    v_lshlrev_b32 v116, 16, v124
    v_and_b32 v117, s32, v124
    v_mul_f32 v118, s33, v118
    v_lshlrev_b32 v124, 16, v125
    v_and_b32 v125, s32, v125
    v_lshlrev_b32_sdwa v122, 3, v122 dst_sel:DWORD dst_unused:UNUSED_PAD src0_sel:DWORD src1_sel:WORD_1
    v_pk_fma_f32 v[116:117], v[116:117], v[118:119], s[28:29] op_sel_hi:[1,0,1]
    v_pk_fma_f32 v[124:125], v[124:125], v[118:119], s[28:29] op_sel_hi:[1,0,1]
    v_perm_b32 v116, v117, v116, s35
    v_perm_b32 v117, v125, v124, s35
    v_lshl_add_u64 v[116:117], v[116:117], 0, s[30:31]
    ds_add_rtn_u64 v[124:125], v122, v[116:117] offset:50000

    s_waitcnt lgkmcnt(0)
    v_or3_b32 v1, v124, v125, v1
    s_mov_b64 exec, -1
    v_add_u32 v120, 128, v120
    s_add_u32 s55, s55, 128
    s_branch L_left_68
L_leftend_69:

L_noleft_65:
    v_cmp_gt_u32 s[64:65], 2.0, v4
    v_and_b32 v4, 0x3fffffff, v4
    v_cmp_gt_u32 s[66:67], 2.0, v5
    v_and_b32 v5, 0x3fffffff, v5
    v_cmp_gt_u32 s[68:69], 2.0, v6
    v_and_b32 v6, 0x3fffffff, v6
    v_cmp_gt_u32 s[70:71], 2.0, v7
    v_and_b32 v7, 0x3fffffff, v7
    v_cmp_gt_u32 s[72:73], 2.0, v8
    v_and_b32 v8, 0x3fffffff, v8
    v_cmp_gt_u32 s[74:75], 2.0, v9
    v_and_b32 v9, 0x3fffffff, v9
    v_cmp_gt_u32 s[76:77], 2.0, v10
    v_and_b32 v10, 0x3fffffff, v10
    v_cmp_gt_u32 s[78:79], 2.0, v11
    v_and_b32 v11, 0x3fffffff, v11
    v_cmp_gt_u32 s[80:81], 2.0, v12
    v_and_b32 v12, 0x3fffffff, v12
    v_cmp_gt_u32 s[82:83], 2.0, v13
    v_and_b32 v13, 0x3fffffff, v13
    v_cmp_gt_u32 s[84:85], 2.0, v14
    v_and_b32 v14, 0x3fffffff, v14
    v_cmp_gt_u32 s[86:87], 2.0, v15
    v_and_b32 v15, 0x3fffffff, v15
    s_waitcnt lgkmcnt(0)
    s_barrier
    s_waitcnt vmcnt(9)
    ds_write_addtid_b32 v76 offset:0
    ds_write_addtid_b32 v77 offset:256
    ds_write_addtid_b32 v78 offset:512
    ds_write_addtid_b32 v79 offset:768
    s_waitcnt vmcnt(8)
    ds_write_addtid_b32 v80 offset:16384
    ds_write_addtid_b32 v81 offset:16640
    ds_write_addtid_b32 v82 offset:16896
    ds_write_addtid_b32 v83 offset:17152
    s_waitcnt vmcnt(7)
    ds_write_addtid_b32 v84 offset:32768
    ds_write_addtid_b32 v85 offset:33024
    ds_write_addtid_b32 v86 offset:33280
    ds_write_addtid_b32 v87 offset:33536
    v_lshlrev_b32 v119, 2, v0
    s_waitcnt vmcnt(6)
    s_mov_b64 exec, s[48:49]
    ds_write_b32 v119, v88 offset:49152
    s_mov_b64 exec, -1
    s_add_u32 s43, s43, 50048
    s_add_u32 s14, s43, 50000
    s_min_u32 s14, s14, s41
    buffer_load_dwordx4 v[76:79], v3, s[12:15], s43 offen
    s_waitcnt lgkmcnt(0)
    s_barrier
    s_add_u32 s52, s43, 16384
    buffer_load_dwordx4 v[80:83], v3, s[12:15], s52 offen
    s_add_u32 s52, s43, 32768
    buffer_load_dwordx4 v[84:87], v3, s[12:15], s52 offen
    s_add_u32 s52, s43, 49152
    v_lshlrev_b32 v119, 2, v0
    buffer_load_dword v88, v119, s[12:15], s52 offen
    s_mov_b64 exec, s[64:65]
    ds_read_b64 v[28:29], v28
    s_mov_b64 exec, s[66:67]
    ds_read_b64 v[30:31], v30
    s_mov_b64 exec, s[68:69]
    ds_read_b64 v[32:33], v32
    s_mov_b64 exec, s[70:71]
    ds_read_b64 v[34:35], v34
    s_mov_b64 exec, s[72:73]
    ds_read_b64 v[36:37], v36
    s_mov_b64 exec, s[74:75]
    ds_read_b64 v[38:39], v38
    s_mov_b64 exec, s[76:77]
    ds_read_b64 v[40:41], v40
    s_mov_b64 exec, s[78:79]
    ds_read_b64 v[42:43], v42
    s_mov_b64 exec, s[80:81]
    ds_read_b64 v[44:45], v44
    s_mov_b64 exec, s[82:83]
    ds_read_b64 v[46:47], v46
    s_mov_b64 exec, s[84:85]
    ds_read_b64 v[48:49], v48
    s_mov_b64 exec, s[86:87]
    ds_read_b64 v[50:51], v50
    s_mov_b64 exec, -1
    v_cmp_gt_u32 s[64:65], 2.0, v16
    v_and_b32 v16, 0x3fffffff, v16
    v_cmp_gt_u32 s[66:67], 2.0, v17
    v_and_b32 v17, 0x3fffffff, v17
    v_cmp_gt_u32 s[68:69], 2.0, v18
    v_and_b32 v18, 0x3fffffff, v18
    v_cmp_gt_u32 s[70:71], 2.0, v19
    v_and_b32 v19, 0x3fffffff, v19
    v_cmp_gt_u32 s[72:73], 2.0, v20
    v_and_b32 v20, 0x3fffffff, v20
    v_cmp_gt_u32 s[74:75], 2.0, v21
    v_and_b32 v21, 0x3fffffff, v21
    v_cmp_gt_u32 s[76:77], 2.0, v22
    v_and_b32 v22, 0x3fffffff, v22
    v_cmp_gt_u32 s[78:79], 2.0, v23
    v_and_b32 v23, 0x3fffffff, v23
    v_cmp_gt_u32 s[80:81], 2.0, v24
    v_and_b32 v24, 0x3fffffff, v24
    v_cmp_gt_u32 s[82:83], 2.0, v25
    v_and_b32 v25, 0x3fffffff, v25
    v_cmp_gt_u32 s[84:85], 2.0, v26
    v_and_b32 v26, 0x3fffffff, v26
    v_cmp_gt_u32 s[86:87], 2.0, v27
    v_and_b32 v27, 0x3fffffff, v27
    s_mov_b64 exec, s[64:65]
    ds_read_b64 v[52:53], v52
    s_mov_b64 exec, s[66:67]
    ds_read_b64 v[54:55], v54
    s_mov_b64 exec, s[68:69]
    ds_read_b64 v[56:57], v56
    s_mov_b64 exec, s[70:71]
    ds_read_b64 v[58:59], v58
    s_mov_b64 exec, s[72:73]
    ds_read_b64 v[60:61], v60
    s_mov_b64 exec, s[74:75]
    ds_read_b64 v[62:63], v62
    s_mov_b64 exec, s[76:77]
    ds_read_b64 v[64:65], v64
    s_mov_b64 exec, s[78:79]
    ds_read_b64 v[66:67], v66
    s_mov_b64 exec, s[80:81]
    ds_read_b64 v[68:69], v68
    s_mov_b64 exec, s[82:83]
    ds_read_b64 v[70:71], v70
    s_mov_b64 exec, s[84:85]
    ds_read_b64 v[72:73], v72
    s_mov_b64 exec, s[86:87]
    ds_read_b64 v[74:75], v74
    s_mov_b64 exec, -1
    s_cmp_ge_u32 s5, s4
    s_cbranch_scc1 L_bend_62
    s_waitcnt lgkmcnt(15)
    v_mad_i32_i16 v120, v28, v4, s96
    v_mad_i32_i16 v28, v28, v4, s96 op_sel:[1,0,0,0]
    v_mad_i32_i16 v121, v29, v4, s96
    v_mad_i32_i16 v29, v29, v4, s96 op_sel:[1,0,0,0]
    v_lshlrev_b32_sdwa v4, 3, v4 dst_sel:DWORD dst_unused:UNUSED_PAD src0_sel:DWORD src1_sel:WORD_1
    v_perm_b32 v28, v28, v120, s97
    v_perm_b32 v29, v29, v121, s97
    v_lshl_add_u64 v[28:29], v[28:29], 0, s[30:31]

    ds_add_rtn_u64 v[28:29], v4, v[28:29] offset:50000
    v_mad_i32_i16 v122, v30, v5, s96
    v_mad_i32_i16 v30, v30, v5, s96 op_sel:[1,0,0,0]
    v_mad_i32_i16 v123, v31, v5, s96
    v_mad_i32_i16 v31, v31, v5, s96 op_sel:[1,0,0,0]
    v_lshlrev_b32_sdwa v5, 3, v5 dst_sel:DWORD dst_unused:UNUSED_PAD src0_sel:DWORD src1_sel:WORD_1
    v_perm_b32 v30, v30, v122, s97
    v_perm_b32 v31, v31, v123, s97
    v_lshl_add_u64 v[30:31], v[30:31], 0, s[30:31]

    ds_add_rtn_u64 v[30:31], v5, v[30:31] offset:50000
    v_mad_i32_i16 v124, v32, v6, s96
    v_mad_i32_i16 v32, v32, v6, s96 op_sel:[1,0,0,0]
    v_mad_i32_i16 v125, v33, v6, s96
    v_mad_i32_i16 v33, v33, v6, s96 op_sel:[1,0,0,0]
    v_lshlrev_b32_sdwa v6, 3, v6 dst_sel:DWORD dst_unused:UNUSED_PAD src0_sel:DWORD src1_sel:WORD_1
    v_perm_b32 v32, v32, v124, s97
    v_perm_b32 v33, v33, v125, s97
    v_lshl_add_u64 v[32:33], v[32:33], 0, s[30:31]

    ds_add_rtn_u64 v[32:33], v6, v[32:33] offset:50000
    v_mad_i32_i16 v126, v34, v7, s96
    v_mad_i32_i16 v34, v34, v7, s96 op_sel:[1,0,0,0]
    v_mad_i32_i16 v127, v35, v7, s96
    v_mad_i32_i16 v35, v35, v7, s96 op_sel:[1,0,0,0]
    v_lshlrev_b32_sdwa v7, 3, v7 dst_sel:DWORD dst_unused:UNUSED_PAD src0_sel:DWORD src1_sel:WORD_1
    v_perm_b32 v34, v34, v126, s97
    v_perm_b32 v35, v35, v127, s97
    v_lshl_add_u64 v[34:35], v[34:35], 0, s[30:31]

    ds_add_rtn_u64 v[34:35], v7, v[34:35] offset:50000
    v_mad_i32_i16 v120, v36, v8, s96
    v_mad_i32_i16 v36, v36, v8, s96 op_sel:[1,0,0,0]
    v_mad_i32_i16 v121, v37, v8, s96
    v_mad_i32_i16 v37, v37, v8, s96 op_sel:[1,0,0,0]
    v_lshlrev_b32_sdwa v8, 3, v8 dst_sel:DWORD dst_unused:UNUSED_PAD src0_sel:DWORD src1_sel:WORD_1
    v_perm_b32 v36, v36, v120, s97
    v_perm_b32 v37, v37, v121, s97
    v_lshl_add_u64 v[36:37], v[36:37], 0, s[30:31]

    ds_add_rtn_u64 v[36:37], v8, v[36:37] offset:50000
    v_mad_i32_i16 v122, v38, v9, s96
    v_mad_i32_i16 v38, v38, v9, s96 op_sel:[1,0,0,0]
    v_mad_i32_i16 v123, v39, v9, s96
    v_mad_i32_i16 v39, v39, v9, s96 op_sel:[1,0,0,0]
    v_lshlrev_b32_sdwa v9, 3, v9 dst_sel:DWORD dst_unused:UNUSED_PAD src0_sel:DWORD src1_sel:WORD_1
    v_perm_b32 v38, v38, v122, s97
    v_perm_b32 v39, v39, v123, s97
    v_lshl_add_u64 v[38:39], v[38:39], 0, s[30:31]

    ds_add_rtn_u64 v[38:39], v9, v[38:39] offset:50000
    v_mad_i32_i16 v124, v40, v10, s96
    v_mad_i32_i16 v40, v40, v10, s96 op_sel:[1,0,0,0]
    v_mad_i32_i16 v125, v41, v10, s96
    v_mad_i32_i16 v41, v41, v10, s96 op_sel:[1,0,0,0]
    v_lshlrev_b32_sdwa v10, 3, v10 dst_sel:DWORD dst_unused:UNUSED_PAD src0_sel:DWORD src1_sel:WORD_1
    v_perm_b32 v40, v40, v124, s97
    v_perm_b32 v41, v41, v125, s97
    v_lshl_add_u64 v[40:41], v[40:41], 0, s[30:31]

    ds_add_rtn_u64 v[40:41], v10, v[40:41] offset:50000
    v_mad_i32_i16 v126, v42, v11, s96
    v_mad_i32_i16 v42, v42, v11, s96 op_sel:[1,0,0,0]
    v_mad_i32_i16 v127, v43, v11, s96
    v_mad_i32_i16 v43, v43, v11, s96 op_sel:[1,0,0,0]
    v_lshlrev_b32_sdwa v11, 3, v11 dst_sel:DWORD dst_unused:UNUSED_PAD src0_sel:DWORD src1_sel:WORD_1
    v_perm_b32 v42, v42, v126, s97
    v_perm_b32 v43, v43, v127, s97
    v_lshl_add_u64 v[42:43], v[42:43], 0, s[30:31]

    ds_add_rtn_u64 v[42:43], v11, v[42:43] offset:50000
    s_waitcnt lgkmcnt(4)
    v_or3_b32 v1, v28, v29, v1
    v_or3_b32 v1, v30, v31, v1
    v_or3_b32 v1, v32, v33, v1
    v_or3_b32 v1, v34, v35, v1
    s_movk_i32 s53, 0
    buffer_load_dwordx4 v[4:7], v2, s[16:19], s53 offen nt
    buffer_load_dword v35, v2, s[16:19], s53 offen offset:16 nt
    v_mad_i32_i16 v120, v44, v12, s96
    v_mad_i32_i16 v44, v44, v12, s96 op_sel:[1,0,0,0]
    v_mad_i32_i16 v121, v45, v12, s96
    v_mad_i32_i16 v45, v45, v12, s96 op_sel:[1,0,0,0]
    v_lshlrev_b32_sdwa v12, 3, v12 dst_sel:DWORD dst_unused:UNUSED_PAD src0_sel:DWORD src1_sel:WORD_1
    v_perm_b32 v44, v44, v120, s97
    v_perm_b32 v45, v45, v121, s97
    v_lshl_add_u64 v[44:45], v[44:45], 0, s[30:31]

    ds_add_rtn_u64 v[44:45], v12, v[44:45] offset:50000
    v_mad_i32_i16 v122, v46, v13, s96
    v_mad_i32_i16 v46, v46, v13, s96 op_sel:[1,0,0,0]
    v_mad_i32_i16 v123, v47, v13, s96
    v_mad_i32_i16 v47, v47, v13, s96 op_sel:[1,0,0,0]
    v_lshlrev_b32_sdwa v13, 3, v13 dst_sel:DWORD dst_unused:UNUSED_PAD src0_sel:DWORD src1_sel:WORD_1
    v_perm_b32 v46, v46, v122, s97
    v_perm_b32 v47, v47, v123, s97
    v_lshl_add_u64 v[46:47], v[46:47], 0, s[30:31]

    ds_add_rtn_u64 v[46:47], v13, v[46:47] offset:50000
    v_mad_i32_i16 v124, v48, v14, s96
    v_mad_i32_i16 v48, v48, v14, s96 op_sel:[1,0,0,0]
    v_mad_i32_i16 v125, v49, v14, s96
    v_mad_i32_i16 v49, v49, v14, s96 op_sel:[1,0,0,0]
    v_lshlrev_b32_sdwa v14, 3, v14 dst_sel:DWORD dst_unused:UNUSED_PAD src0_sel:DWORD src1_sel:WORD_1
    v_perm_b32 v48, v48, v124, s97
    v_perm_b32 v49, v49, v125, s97
    v_lshl_add_u64 v[48:49], v[48:49], 0, s[30:31]

    ds_add_rtn_u64 v[48:49], v14, v[48:49] offset:50000
    v_mad_i32_i16 v126, v50, v15, s96
    v_mad_i32_i16 v50, v50, v15, s96 op_sel:[1,0,0,0]
    v_mad_i32_i16 v127, v51, v15, s96
    v_mad_i32_i16 v51, v51, v15, s96 op_sel:[1,0,0,0]
    v_lshlrev_b32_sdwa v15, 3, v15 dst_sel:DWORD dst_unused:UNUSED_PAD src0_sel:DWORD src1_sel:WORD_1
    v_perm_b32 v50, v50, v126, s97
    v_perm_b32 v51, v51, v127, s97
    v_lshl_add_u64 v[50:51], v[50:51], 0, s[30:31]

    ds_add_rtn_u64 v[50:51], v15, v[50:51] offset:50000
    s_waitcnt lgkmcnt(4)
    v_or3_b32 v1, v36, v37, v1
    v_or3_b32 v1, v38, v39, v1
    v_or3_b32 v1, v40, v41, v1
    v_or3_b32 v1, v42, v43, v1
    s_movk_i32 s53, 2560
    buffer_load_dwordx4 v[8:11], v2, s[16:19], s53 offen
    buffer_load_dword v43, v2, s[16:19], s53 offen offset:16
    s_barrier
    s_waitcnt vmcnt(7)
    ds_write_addtid_b32 v76 offset:0
    ds_write_addtid_b32 v77 offset:256
    ds_write_addtid_b32 v78 offset:512
    ds_write_addtid_b32 v79 offset:768
    s_waitcnt vmcnt(6)
    ds_write_addtid_b32 v80 offset:16384
    ds_write_addtid_b32 v81 offset:16640
    ds_write_addtid_b32 v82 offset:16896
    ds_write_addtid_b32 v83 offset:17152
    s_waitcnt vmcnt(5)
    ds_write_addtid_b32 v84 offset:32768
    ds_write_addtid_b32 v85 offset:33024
    ds_write_addtid_b32 v86 offset:33280
    ds_write_addtid_b32 v87 offset:33536
    v_lshlrev_b32 v119, 2, v0
    s_waitcnt vmcnt(4)
    s_mov_b64 exec, s[48:49]
    ds_write_b32 v119, v88 offset:49152
    s_mov_b64 exec, -1
    s_add_u32 s43, s43, 50048
    s_add_u32 s14, s43, 50000
    s_min_u32 s14, s14, s41
    s_mov_b32 s40, s88
    s_sub_u32 s42, s40, s39

    s_add_u32 s55, s38, 2
    s_min_u32 s55, s55, 31
    s_mov_b32 s88, s89
    s_mov_b32 s89, s90
    s_mov_b32 s90, s91
    s_mov_b32 s91, s92
    s_mov_b32 s92, s93
    s_mov_b32 s93, s94
    s_mov_b32 s94, s95
    s_mov_b32 s95, 0
    s_min_u32 s88, s88, 6524
    s_lshl_b32 s52, s55, 6
    s_add_u32 s52, s52, s36
    s_mul_i32 s52, s52, 32764
    s_and_b32 s52, s52, 0xffffff80
    s_add_u32 s16, s44, s52
    s_addc_u32 s17, s45, 0
    s_mul_i32 s52, s88, 5
    s_add_u32 s52, s52, 3
    s_and_b32 s18, s52, -4

    v_mad_i32_i16 v120, v52, v16, s96
    v_mad_i32_i16 v52, v52, v16, s96 op_sel:[1,0,0,0]
    v_mad_i32_i16 v121, v53, v16, s96
    v_mad_i32_i16 v53, v53, v16, s96 op_sel:[1,0,0,0]
    v_lshlrev_b32_sdwa v16, 3, v16 dst_sel:DWORD dst_unused:UNUSED_PAD src0_sel:DWORD src1_sel:WORD_1
    v_perm_b32 v52, v52, v120, s97
    v_perm_b32 v53, v53, v121, s97
    v_lshl_add_u64 v[52:53], v[52:53], 0, s[30:31]

    ds_add_rtn_u64 v[52:53], v16, v[52:53] offset:50000
    v_mad_i32_i16 v122, v54, v17, s96
    v_mad_i32_i16 v54, v54, v17, s96 op_sel:[1,0,0,0]
    v_mad_i32_i16 v123, v55, v17, s96
    v_mad_i32_i16 v55, v55, v17, s96 op_sel:[1,0,0,0]
    v_lshlrev_b32_sdwa v17, 3, v17 dst_sel:DWORD dst_unused:UNUSED_PAD src0_sel:DWORD src1_sel:WORD_1
    v_perm_b32 v54, v54, v122, s97
    v_perm_b32 v55, v55, v123, s97
    v_lshl_add_u64 v[54:55], v[54:55], 0, s[30:31]

    ds_add_rtn_u64 v[54:55], v17, v[54:55] offset:50000
    v_mad_i32_i16 v124, v56, v18, s96
    v_mad_i32_i16 v56, v56, v18, s96 op_sel:[1,0,0,0]
    v_mad_i32_i16 v125, v57, v18, s96
    v_mad_i32_i16 v57, v57, v18, s96 op_sel:[1,0,0,0]
    v_lshlrev_b32_sdwa v18, 3, v18 dst_sel:DWORD dst_unused:UNUSED_PAD src0_sel:DWORD src1_sel:WORD_1
    v_perm_b32 v56, v56, v124, s97
    v_perm_b32 v57, v57, v125, s97
    v_lshl_add_u64 v[56:57], v[56:57], 0, s[30:31]

    ds_add_rtn_u64 v[56:57], v18, v[56:57] offset:50000
    v_mad_i32_i16 v126, v58, v19, s96
    v_mad_i32_i16 v58, v58, v19, s96 op_sel:[1,0,0,0]
    v_mad_i32_i16 v127, v59, v19, s96
    v_mad_i32_i16 v59, v59, v19, s96 op_sel:[1,0,0,0]
    v_lshlrev_b32_sdwa v19, 3, v19 dst_sel:DWORD dst_unused:UNUSED_PAD src0_sel:DWORD src1_sel:WORD_1
    v_perm_b32 v58, v58, v126, s97
    v_perm_b32 v59, v59, v127, s97
    v_lshl_add_u64 v[58:59], v[58:59], 0, s[30:31]

    ds_add_rtn_u64 v[58:59], v19, v[58:59] offset:50000
    s_waitcnt lgkmcnt(15)
    v_or3_b32 v1, v44, v45, v1
    v_or3_b32 v1, v46, v47, v1
    v_or3_b32 v1, v48, v49, v1
    v_or3_b32 v1, v50, v51, v1
    s_waitcnt vmcnt(24)
    v_perm_b32 v44, v91, v90, s24
    v_perm_b32 v46, v92, v91, s25
    v_perm_b32 v48, v93, v92, s26
    v_perm_b32 v50, v110, v93, s27
    v_mov_b32 v12, v90
    v_alignbyte_b32 v13, v92, v91, 1
    v_alignbyte_b32 v14, v93, v92, 2
    v_alignbyte_b32 v15, v110, v93, 3
    v_lshlrev_b32_sdwa v44, 3, v44 dst_sel:WORD_0 dst_unused:UNUSED_PAD src0_sel:DWORD src1_sel:DWORD
    v_lshlrev_b32_sdwa v46, 3, v46 dst_sel:WORD_0 dst_unused:UNUSED_PAD src0_sel:DWORD src1_sel:DWORD
    v_lshlrev_b32_sdwa v48, 3, v48 dst_sel:WORD_0 dst_unused:UNUSED_PAD src0_sel:DWORD src1_sel:DWORD
    v_lshlrev_b32_sdwa v50, 3, v50 dst_sel:WORD_0 dst_unused:UNUSED_PAD src0_sel:DWORD src1_sel:DWORD
    s_cmp_lt_i32 s42, 1280
    s_cbranch_scc1 L_ufix_70
L_uback_71:

    s_movk_i32 s53, 5120
    buffer_load_dwordx4 v[90:93], v2, s[16:19], s53 offen
    buffer_load_dword v110, v2, s[16:19], s53 offen offset:16
    s_waitcnt lgkmcnt(4)
    s_barrier
    v_subrev_co_u32 v12, s[80:81], 2.0, v12
    v_subrev_co_u32 v13, s[82:83], 2.0, v13
    v_subrev_co_u32 v14, s[84:85], 2.0, v14
    v_subrev_co_u32 v15, s[86:87], 2.0, v15
    s_mov_b64 exec, s[80:81]
    ds_read_b64 v[44:45], v44
    s_mov_b64 exec, s[82:83]
    ds_read_b64 v[46:47], v46
    s_mov_b64 exec, s[84:85]
    ds_read_b64 v[48:49], v48
    s_mov_b64 exec, s[86:87]
    ds_read_b64 v[50:51], v50
    s_mov_b64 exec, -1
    v_mad_i32_i16 v120, v60, v20, s96
    v_mad_i32_i16 v60, v60, v20, s96 op_sel:[1,0,0,0]
    v_mad_i32_i16 v121, v61, v20, s96
    v_mad_i32_i16 v61, v61, v20, s96 op_sel:[1,0,0,0]
    v_lshlrev_b32_sdwa v20, 3, v20 dst_sel:DWORD dst_unused:UNUSED_PAD src0_sel:DWORD src1_sel:WORD_1
    v_perm_b32 v60, v60, v120, s97
    v_perm_b32 v61, v61, v121, s97
    v_lshl_add_u64 v[60:61], v[60:61], 0, s[30:31]

    ds_add_rtn_u64 v[60:61], v20, v[60:61] offset:50000
    v_mad_i32_i16 v122, v62, v21, s96
    v_mad_i32_i16 v62, v62, v21, s96 op_sel:[1,0,0,0]
    v_mad_i32_i16 v123, v63, v21, s96
    v_mad_i32_i16 v63, v63, v21, s96 op_sel:[1,0,0,0]
    v_lshlrev_b32_sdwa v21, 3, v21 dst_sel:DWORD dst_unused:UNUSED_PAD src0_sel:DWORD src1_sel:WORD_1
    v_perm_b32 v62, v62, v122, s97
    v_perm_b32 v63, v63, v123, s97
    v_lshl_add_u64 v[62:63], v[62:63], 0, s[30:31]

    ds_add_rtn_u64 v[62:63], v21, v[62:63] offset:50000
    v_mad_i32_i16 v124, v64, v22, s96
    v_mad_i32_i16 v64, v64, v22, s96 op_sel:[1,0,0,0]
    v_mad_i32_i16 v125, v65, v22, s96
    v_mad_i32_i16 v65, v65, v22, s96 op_sel:[1,0,0,0]
    v_lshlrev_b32_sdwa v22, 3, v22 dst_sel:DWORD dst_unused:UNUSED_PAD src0_sel:DWORD src1_sel:WORD_1
    v_perm_b32 v64, v64, v124, s97
    v_perm_b32 v65, v65, v125, s97
    v_lshl_add_u64 v[64:65], v[64:65], 0, s[30:31]

    ds_add_rtn_u64 v[64:65], v22, v[64:65] offset:50000
    v_mad_i32_i16 v126, v66, v23, s96
    v_mad_i32_i16 v66, v66, v23, s96 op_sel:[1,0,0,0]
    v_mad_i32_i16 v127, v67, v23, s96
    v_mad_i32_i16 v67, v67, v23, s96 op_sel:[1,0,0,0]
    v_lshlrev_b32_sdwa v23, 3, v23 dst_sel:DWORD dst_unused:UNUSED_PAD src0_sel:DWORD src1_sel:WORD_1
    v_perm_b32 v66, v66, v126, s97
    v_perm_b32 v67, v67, v127, s97
    v_lshl_add_u64 v[66:67], v[66:67], 0, s[30:31]

    ds_add_rtn_u64 v[66:67], v23, v[66:67] offset:50000
    s_waitcnt lgkmcnt(8)
    v_or3_b32 v1, v52, v53, v1
    v_or3_b32 v1, v54, v55, v1
    v_or3_b32 v1, v56, v57, v1
    v_or3_b32 v1, v58, v59, v1
    s_waitcnt vmcnt(24)
    v_perm_b32 v52, v95, v94, s24
    v_perm_b32 v54, v96, v95, s25
    v_perm_b32 v56, v97, v96, s26
    v_perm_b32 v58, v111, v97, s27
    v_mov_b32 v16, v94
    v_alignbyte_b32 v17, v96, v95, 1
    v_alignbyte_b32 v18, v97, v96, 2
    v_alignbyte_b32 v19, v111, v97, 3
    v_lshlrev_b32_sdwa v52, 3, v52 dst_sel:WORD_0 dst_unused:UNUSED_PAD src0_sel:DWORD src1_sel:DWORD
    v_lshlrev_b32_sdwa v54, 3, v54 dst_sel:WORD_0 dst_unused:UNUSED_PAD src0_sel:DWORD src1_sel:DWORD
    v_lshlrev_b32_sdwa v56, 3, v56 dst_sel:WORD_0 dst_unused:UNUSED_PAD src0_sel:DWORD src1_sel:DWORD
    v_lshlrev_b32_sdwa v58, 3, v58 dst_sel:WORD_0 dst_unused:UNUSED_PAD src0_sel:DWORD src1_sel:DWORD
    s_cmp_lt_i32 s42, 1792
    s_cbranch_scc1 L_ufix_72
L_uback_73:

    v_subrev_co_u32 v16, s[64:65], 2.0, v16
    v_subrev_co_u32 v17, s[66:67], 2.0, v17
    v_subrev_co_u32 v18, s[68:69], 2.0, v18
    v_subrev_co_u32 v19, s[70:71], 2.0, v19
    s_mov_b64 exec, s[64:65]
    ds_read_b64 v[52:53], v52
    s_mov_b64 exec, s[66:67]
    ds_read_b64 v[54:55], v54
    s_mov_b64 exec, s[68:69]
    ds_read_b64 v[56:57], v56
    s_mov_b64 exec, s[70:71]
    ds_read_b64 v[58:59], v58
    s_mov_b64 exec, -1
    v_mad_i32_i16 v120, v68, v24, s96
    v_mad_i32_i16 v68, v68, v24, s96 op_sel:[1,0,0,0]
    v_mad_i32_i16 v121, v69, v24, s96
    v_mad_i32_i16 v69, v69, v24, s96 op_sel:[1,0,0,0]
    v_lshlrev_b32_sdwa v24, 3, v24 dst_sel:DWORD dst_unused:UNUSED_PAD src0_sel:DWORD src1_sel:WORD_1
    v_perm_b32 v68, v68, v120, s97
    v_perm_b32 v69, v69, v121, s97
    v_lshl_add_u64 v[68:69], v[68:69], 0, s[30:31]

    ds_add_rtn_u64 v[68:69], v24, v[68:69] offset:50000
    v_mad_i32_i16 v122, v70, v25, s96
    v_mad_i32_i16 v70, v70, v25, s96 op_sel:[1,0,0,0]
    v_mad_i32_i16 v123, v71, v25, s96
    v_mad_i32_i16 v71, v71, v25, s96 op_sel:[1,0,0,0]
    v_lshlrev_b32_sdwa v25, 3, v25 dst_sel:DWORD dst_unused:UNUSED_PAD src0_sel:DWORD src1_sel:WORD_1
    v_perm_b32 v70, v70, v122, s97
    v_perm_b32 v71, v71, v123, s97
    v_lshl_add_u64 v[70:71], v[70:71], 0, s[30:31]

    ds_add_rtn_u64 v[70:71], v25, v[70:71] offset:50000
    v_mad_i32_i16 v124, v72, v26, s96
    v_mad_i32_i16 v72, v72, v26, s96 op_sel:[1,0,0,0]
    v_mad_i32_i16 v125, v73, v26, s96
    v_mad_i32_i16 v73, v73, v26, s96 op_sel:[1,0,0,0]
    v_lshlrev_b32_sdwa v26, 3, v26 dst_sel:DWORD dst_unused:UNUSED_PAD src0_sel:DWORD src1_sel:WORD_1
    v_perm_b32 v72, v72, v124, s97
    v_perm_b32 v73, v73, v125, s97
    v_lshl_add_u64 v[72:73], v[72:73], 0, s[30:31]

    ds_add_rtn_u64 v[72:73], v26, v[72:73] offset:50000
    v_mad_i32_i16 v126, v74, v27, s96
    v_mad_i32_i16 v74, v74, v27, s96 op_sel:[1,0,0,0]
    v_mad_i32_i16 v127, v75, v27, s96
    v_mad_i32_i16 v75, v75, v27, s96 op_sel:[1,0,0,0]
    v_lshlrev_b32_sdwa v27, 3, v27 dst_sel:DWORD dst_unused:UNUSED_PAD src0_sel:DWORD src1_sel:WORD_1
    v_perm_b32 v74, v74, v126, s97
    v_perm_b32 v75, v75, v127, s97
    v_lshl_add_u64 v[74:75], v[74:75], 0, s[30:31]

    ds_add_rtn_u64 v[74:75], v27, v[74:75] offset:50000
    s_waitcnt lgkmcnt(8)
    v_or3_b32 v1, v60, v61, v1
    v_or3_b32 v1, v62, v63, v1
    v_or3_b32 v1, v64, v65, v1
    v_or3_b32 v1, v66, v67, v1
    s_waitcnt vmcnt(14)
    v_perm_b32 v60, v99, v98, s24
    v_perm_b32 v62, v100, v99, s25
    v_perm_b32 v64, v101, v100, s26
    v_perm_b32 v66, v112, v101, s27
    v_mov_b32 v20, v98
    v_alignbyte_b32 v21, v100, v99, 1
    v_alignbyte_b32 v22, v101, v100, 2
    v_alignbyte_b32 v23, v112, v101, 3
    v_lshlrev_b32_sdwa v60, 3, v60 dst_sel:WORD_0 dst_unused:UNUSED_PAD src0_sel:DWORD src1_sel:DWORD
    v_lshlrev_b32_sdwa v62, 3, v62 dst_sel:WORD_0 dst_unused:UNUSED_PAD src0_sel:DWORD src1_sel:DWORD
    v_lshlrev_b32_sdwa v64, 3, v64 dst_sel:WORD_0 dst_unused:UNUSED_PAD src0_sel:DWORD src1_sel:DWORD
    v_lshlrev_b32_sdwa v66, 3, v66 dst_sel:WORD_0 dst_unused:UNUSED_PAD src0_sel:DWORD src1_sel:DWORD
    s_cmp_lt_i32 s42, 2304
    s_cbranch_scc1 L_ufix_74
L_uback_75:

    v_subrev_co_u32 v20, s[72:73], 2.0, v20
    v_subrev_co_u32 v21, s[74:75], 2.0, v21
    v_subrev_co_u32 v22, s[76:77], 2.0, v22
    v_subrev_co_u32 v23, s[78:79], 2.0, v23
    s_mov_b64 exec, s[72:73]
    ds_read_b64 v[60:61], v60
    s_mov_b64 exec, s[74:75]
    ds_read_b64 v[62:63], v62
    s_mov_b64 exec, s[76:77]
    ds_read_b64 v[64:65], v64
    s_mov_b64 exec, s[78:79]
    ds_read_b64 v[66:67], v66
    s_mov_b64 exec, -1
    s_waitcnt lgkmcnt(4)
    v_or3_b32 v1, v68, v69, v1
    v_or3_b32 v1, v70, v71, v1
    v_or3_b32 v1, v72, v73, v1
    v_or3_b32 v1, v74, v75, v1
    s_waitcnt vmcnt(12)
    v_perm_b32 v68, v103, v102, s24
    v_perm_b32 v70, v104, v103, s25
    v_perm_b32 v72, v105, v104, s26
    v_perm_b32 v74, v113, v105, s27
    v_mov_b32 v24, v102
    v_alignbyte_b32 v25, v104, v103, 1
    v_alignbyte_b32 v26, v105, v104, 2
    v_alignbyte_b32 v27, v113, v105, 3
    v_lshlrev_b32_sdwa v68, 3, v68 dst_sel:WORD_0 dst_unused:UNUSED_PAD src0_sel:DWORD src1_sel:DWORD
    v_lshlrev_b32_sdwa v70, 3, v70 dst_sel:WORD_0 dst_unused:UNUSED_PAD src0_sel:DWORD src1_sel:DWORD
    v_lshlrev_b32_sdwa v72, 3, v72 dst_sel:WORD_0 dst_unused:UNUSED_PAD src0_sel:DWORD src1_sel:DWORD
    v_lshlrev_b32_sdwa v74, 3, v74 dst_sel:WORD_0 dst_unused:UNUSED_PAD src0_sel:DWORD src1_sel:DWORD
    s_cmp_lt_i32 s42, 2816
    s_cbranch_scc1 L_ufix_76
L_uback_77:

    v_subrev_co_u32 v24, s[80:81], 2.0, v24
    v_subrev_co_u32 v25, s[82:83], 2.0, v25
    v_subrev_co_u32 v26, s[84:85], 2.0, v26
    v_subrev_co_u32 v27, s[86:87], 2.0, v27
    s_mov_b64 exec, s[80:81]
    ds_read_b64 v[68:69], v68
    s_mov_b64 exec, s[82:83]
    ds_read_b64 v[70:71], v70
    s_mov_b64 exec, s[84:85]
    ds_read_b64 v[72:73], v72
    s_mov_b64 exec, s[86:87]
    ds_read_b64 v[74:75], v74
    s_mov_b64 exec, -1
    buffer_load_dwordx4 v[76:79], v3, s[12:15], s43 offen
    s_add_u32 s52, s43, 16384
    buffer_load_dwordx4 v[80:83], v3, s[12:15], s52 offen
    s_add_u32 s52, s43, 32768
    buffer_load_dwordx4 v[84:87], v3, s[12:15], s52 offen
    s_add_u32 s52, s43, 49152
    v_lshlrev_b32 v119, 2, v0
    buffer_load_dword v88, v119, s[12:15], s52 offen
    s_add_u32 s54, s43, 50048
    buffer_load_dword v115, v89, s[60:63], s54 offen
    s_add_u32 s54, s50, 200000
    buffer_load_dword v115, v89, s[8:11], s54 offen
    s_waitcnt vmcnt(10)
    v_perm_b32 v28, v5, v4, s24
    v_perm_b32 v30, v6, v5, s25
    v_perm_b32 v32, v7, v6, s26
    v_perm_b32 v34, v35, v7, s27
    v_alignbyte_b32 v5, v6, v5, 1
    v_alignbyte_b32 v6, v7, v6, 2
    v_alignbyte_b32 v7, v35, v7, 3
    v_lshlrev_b32_sdwa v28, 3, v28 dst_sel:WORD_0 dst_unused:UNUSED_PAD src0_sel:DWORD src1_sel:DWORD
    v_lshlrev_b32_sdwa v30, 3, v30 dst_sel:WORD_0 dst_unused:UNUSED_PAD src0_sel:DWORD src1_sel:DWORD
    v_lshlrev_b32_sdwa v32, 3, v32 dst_sel:WORD_0 dst_unused:UNUSED_PAD src0_sel:DWORD src1_sel:DWORD
    v_lshlrev_b32_sdwa v34, 3, v34 dst_sel:WORD_0 dst_unused:UNUSED_PAD src0_sel:DWORD src1_sel:DWORD
    s_cmp_lt_i32 s42, 256
    s_cbranch_scc1 L_ufix_78
L_uback_79:

    v_subrev_co_u32 v4, s[64:65], 2.0, v4
    v_subrev_co_u32 v5, s[66:67], 2.0, v5
    v_subrev_co_u32 v6, s[68:69], 2.0, v6
    v_subrev_co_u32 v7, s[70:71], 2.0, v7
    s_mov_b64 exec, s[64:65]
    ds_read_b64 v[28:29], v28
    s_mov_b64 exec, s[66:67]
    ds_read_b64 v[30:31], v30
    s_mov_b64 exec, s[68:69]
    ds_read_b64 v[32:33], v32
    s_mov_b64 exec, s[70:71]
    ds_read_b64 v[34:35], v34
    s_mov_b64 exec, -1
    s_waitcnt vmcnt(8)
    v_perm_b32 v36, v9, v8, s24
    v_perm_b32 v38, v10, v9, s25
    v_perm_b32 v40, v11, v10, s26
    v_perm_b32 v42, v43, v11, s27
    v_alignbyte_b32 v9, v10, v9, 1
    v_alignbyte_b32 v10, v11, v10, 2
    v_alignbyte_b32 v11, v43, v11, 3
    v_lshlrev_b32_sdwa v36, 3, v36 dst_sel:WORD_0 dst_unused:UNUSED_PAD src0_sel:DWORD src1_sel:DWORD
    v_lshlrev_b32_sdwa v38, 3, v38 dst_sel:WORD_0 dst_unused:UNUSED_PAD src0_sel:DWORD src1_sel:DWORD
    v_lshlrev_b32_sdwa v40, 3, v40 dst_sel:WORD_0 dst_unused:UNUSED_PAD src0_sel:DWORD src1_sel:DWORD
    v_lshlrev_b32_sdwa v42, 3, v42 dst_sel:WORD_0 dst_unused:UNUSED_PAD src0_sel:DWORD src1_sel:DWORD
    s_cmp_lt_i32 s42, 768
    s_cbranch_scc1 L_ufix_80
L_uback_81:

    v_subrev_co_u32 v8, s[72:73], 2.0, v8
    v_subrev_co_u32 v9, s[74:75], 2.0, v9
    v_subrev_co_u32 v10, s[76:77], 2.0, v10
    v_subrev_co_u32 v11, s[78:79], 2.0, v11
    s_mov_b64 exec, s[72:73]
    ds_read_b64 v[36:37], v36
    s_mov_b64 exec, s[74:75]
    ds_read_b64 v[38:39], v38
    s_mov_b64 exec, s[76:77]
    ds_read_b64 v[40:41], v40
    s_mov_b64 exec, s[78:79]
    ds_read_b64 v[42:43], v42
    s_mov_b64 exec, -1
    s_mov_b32 s38, s5
    s_add_u32 s50, s50, 200000
    s_branch L_batch_61
L_bend_62:

    s_waitcnt vmcnt(0)
    s_load_dwordx2 s[68:69], s[0:1], 24
    s_load_dwordx4 s[88:91], s[0:1], 72
    s_load_dwordx2 s[76:77], s[0:1], 88
    s_load_dwordx2 s[80:81], s[0:1], 96
    s_mov_b32 s70, 1600000
    s_mov_b32 s71, 0x20000
    s_mov_b32 s78, 6400000
    s_mov_b32 s79, 0x20000
    s_movk_i32 s82, 256
    s_mov_b32 s83, 0x20000
    s_lshl_b32 s48, s36, 2
    s_mov_b32 s41, s37

    s_add_u32 s84, s6, 8896512
    s_addc_u32 s85, s7, 0
    s_mov_b32 s86, 76800000
    s_mov_b32 s87, 0x20000
    s_add_u32 s72, s6, 393216
    s_addc_u32 s73, s7, 0
    s_mov_b32 s74, 2097152
    s_mov_b32 s75, 0x20000
    s_waitcnt lgkmcnt(15)
    v_mad_i32_i16 v120, v28, v4, s96
    v_mad_i32_i16 v28, v28, v4, s96 op_sel:[1,0,0,0]
    v_mad_i32_i16 v121, v29, v4, s96
    v_mad_i32_i16 v29, v29, v4, s96 op_sel:[1,0,0,0]
    v_lshlrev_b32_sdwa v4, 3, v4 dst_sel:DWORD dst_unused:UNUSED_PAD src0_sel:DWORD src1_sel:WORD_1
    v_perm_b32 v28, v28, v120, s97
    v_perm_b32 v29, v29, v121, s97
    v_lshl_add_u64 v[28:29], v[28:29], 0, s[30:31]

    ds_add_rtn_u64 v[28:29], v4, v[28:29] offset:50000
    v_mad_i32_i16 v122, v30, v5, s96
    v_mad_i32_i16 v30, v30, v5, s96 op_sel:[1,0,0,0]
    v_mad_i32_i16 v123, v31, v5, s96
    v_mad_i32_i16 v31, v31, v5, s96 op_sel:[1,0,0,0]
    v_lshlrev_b32_sdwa v5, 3, v5 dst_sel:DWORD dst_unused:UNUSED_PAD src0_sel:DWORD src1_sel:WORD_1
    v_perm_b32 v30, v30, v122, s97
    v_perm_b32 v31, v31, v123, s97
    v_lshl_add_u64 v[30:31], v[30:31], 0, s[30:31]

    ds_add_rtn_u64 v[30:31], v5, v[30:31] offset:50000
    v_mad_i32_i16 v124, v32, v6, s96
    v_mad_i32_i16 v32, v32, v6, s96 op_sel:[1,0,0,0]
    v_mad_i32_i16 v125, v33, v6, s96
    v_mad_i32_i16 v33, v33, v6, s96 op_sel:[1,0,0,0]
    v_lshlrev_b32_sdwa v6, 3, v6 dst_sel:DWORD dst_unused:UNUSED_PAD src0_sel:DWORD src1_sel:WORD_1
    v_perm_b32 v32, v32, v124, s97
    v_perm_b32 v33, v33, v125, s97
    v_lshl_add_u64 v[32:33], v[32:33], 0, s[30:31]

    ds_add_rtn_u64 v[32:33], v6, v[32:33] offset:50000
    v_mad_i32_i16 v126, v34, v7, s96
    v_mad_i32_i16 v34, v34, v7, s96 op_sel:[1,0,0,0]
    v_mad_i32_i16 v127, v35, v7, s96
    v_mad_i32_i16 v35, v35, v7, s96 op_sel:[1,0,0,0]
    v_lshlrev_b32_sdwa v7, 3, v7 dst_sel:DWORD dst_unused:UNUSED_PAD src0_sel:DWORD src1_sel:WORD_1
    v_perm_b32 v34, v34, v126, s97
    v_perm_b32 v35, v35, v127, s97
    v_lshl_add_u64 v[34:35], v[34:35], 0, s[30:31]

    ds_add_rtn_u64 v[34:35], v7, v[34:35] offset:50000
    s_waitcnt lgkmcnt(0)
    s_load_dwordx8 s[12:19], s[88:89], 0
    s_load_dwordx8 s[56:63], s[90:91], 0

    s_mul_i32 s28, s41, 3125
    s_add_u32 s29, s28, 3126
    s_add_u32 s28, s28, 1
    s_lshr_b32 s28, s28, 1
    s_lshr_b32 s29, s29, 1
    s_sub_u32 s29, s29, s28
    s_sub_u32 s5, s29, 782
    s_mul_i32 s3, s36, 6250
    v_add_u32 v78, s28, v0
    v_mov_b32 v82, 0x2000000
    v_add_u32 v79, 782, v78
    v_cmp_gt_u32 vcc, 782, v0
    v_add_u32 v76, s3, v78
    v_add_u32 v77, s3, v79
    v_cndmask_b32 v76, v82, v76, vcc
    v_cmp_gt_u32 vcc, s5, v0
    v_lshlrev_b32 v78, 4, v78
    v_lshlrev_b32 v79, 4, v79
    v_cndmask_b32 v77, v82, v77, vcc
    v_lshlrev_b32 v80, 2, v76
    v_lshlrev_b32 v76, 4, v76
    v_lshlrev_b32 v81, 2, v77
    v_lshlrev_b32 v77, 4, v77
    buffer_load_dword v80, v80, s[68:71], 0 offen
    buffer_load_dword v81, v81, s[68:71], 0 offen
    buffer_load_dwordx4 v[86:89], v76, s[8:11], 0 offen
    buffer_load_dwordx4 v[90:93], v77, s[8:11], 0 offen

    v_mad_i32_i16 v120, v36, v8, s96
    v_mad_i32_i16 v36, v36, v8, s96 op_sel:[1,0,0,0]
    v_mad_i32_i16 v121, v37, v8, s96
    v_mad_i32_i16 v37, v37, v8, s96 op_sel:[1,0,0,0]
    v_lshlrev_b32_sdwa v8, 3, v8 dst_sel:DWORD dst_unused:UNUSED_PAD src0_sel:DWORD src1_sel:WORD_1
    v_perm_b32 v36, v36, v120, s97
    v_perm_b32 v37, v37, v121, s97
    v_lshl_add_u64 v[36:37], v[36:37], 0, s[30:31]

    ds_add_rtn_u64 v[36:37], v8, v[36:37] offset:50000
    v_mad_i32_i16 v122, v38, v9, s96
    v_mad_i32_i16 v38, v38, v9, s96 op_sel:[1,0,0,0]
    v_mad_i32_i16 v123, v39, v9, s96
    v_mad_i32_i16 v39, v39, v9, s96 op_sel:[1,0,0,0]
    v_lshlrev_b32_sdwa v9, 3, v9 dst_sel:DWORD dst_unused:UNUSED_PAD src0_sel:DWORD src1_sel:WORD_1
    v_perm_b32 v38, v38, v122, s97
    v_perm_b32 v39, v39, v123, s97
    v_lshl_add_u64 v[38:39], v[38:39], 0, s[30:31]

    ds_add_rtn_u64 v[38:39], v9, v[38:39] offset:50000
    v_mad_i32_i16 v124, v40, v10, s96
    v_mad_i32_i16 v40, v40, v10, s96 op_sel:[1,0,0,0]
    v_mad_i32_i16 v125, v41, v10, s96
    v_mad_i32_i16 v41, v41, v10, s96 op_sel:[1,0,0,0]
    v_lshlrev_b32_sdwa v10, 3, v10 dst_sel:DWORD dst_unused:UNUSED_PAD src0_sel:DWORD src1_sel:WORD_1
    v_perm_b32 v40, v40, v124, s97
    v_perm_b32 v41, v41, v125, s97
    v_lshl_add_u64 v[40:41], v[40:41], 0, s[30:31]

    ds_add_rtn_u64 v[40:41], v10, v[40:41] offset:50000
    v_mad_i32_i16 v126, v42, v11, s96
    v_mad_i32_i16 v42, v42, v11, s96 op_sel:[1,0,0,0]
    v_mad_i32_i16 v127, v43, v11, s96
    v_mad_i32_i16 v43, v43, v11, s96 op_sel:[1,0,0,0]
    v_lshlrev_b32_sdwa v11, 3, v11 dst_sel:DWORD dst_unused:UNUSED_PAD src0_sel:DWORD src1_sel:WORD_1
    v_perm_b32 v42, v42, v126, s97
    v_perm_b32 v43, v43, v127, s97
    v_lshl_add_u64 v[42:43], v[42:43], 0, s[30:31]

    ds_add_rtn_u64 v[42:43], v11, v[42:43] offset:50000
    v_or3_b32 v1, v28, v29, v1
    v_or3_b32 v1, v30, v31, v1
    v_or3_b32 v1, v32, v33, v1
    v_or3_b32 v1, v34, v35, v1
    v_mad_i32_i16 v120, v44, v12, s96
    v_mad_i32_i16 v44, v44, v12, s96 op_sel:[1,0,0,0]
    v_mad_i32_i16 v121, v45, v12, s96
    v_mad_i32_i16 v45, v45, v12, s96 op_sel:[1,0,0,0]
    v_lshlrev_b32_sdwa v12, 3, v12 dst_sel:DWORD dst_unused:UNUSED_PAD src0_sel:DWORD src1_sel:WORD_1
    v_perm_b32 v44, v44, v120, s97
    v_perm_b32 v45, v45, v121, s97
    v_lshl_add_u64 v[44:45], v[44:45], 0, s[30:31]

    ds_add_rtn_u64 v[44:45], v12, v[44:45] offset:50000
    v_mad_i32_i16 v122, v46, v13, s96
    v_mad_i32_i16 v46, v46, v13, s96 op_sel:[1,0,0,0]
    v_mad_i32_i16 v123, v47, v13, s96
    v_mad_i32_i16 v47, v47, v13, s96 op_sel:[1,0,0,0]
    v_lshlrev_b32_sdwa v13, 3, v13 dst_sel:DWORD dst_unused:UNUSED_PAD src0_sel:DWORD src1_sel:WORD_1
    v_perm_b32 v46, v46, v122, s97
    v_perm_b32 v47, v47, v123, s97
    v_lshl_add_u64 v[46:47], v[46:47], 0, s[30:31]

    ds_add_rtn_u64 v[46:47], v13, v[46:47] offset:50000
    v_mad_i32_i16 v124, v48, v14, s96
    v_mad_i32_i16 v48, v48, v14, s96 op_sel:[1,0,0,0]
    v_mad_i32_i16 v125, v49, v14, s96
    v_mad_i32_i16 v49, v49, v14, s96 op_sel:[1,0,0,0]
    v_lshlrev_b32_sdwa v14, 3, v14 dst_sel:DWORD dst_unused:UNUSED_PAD src0_sel:DWORD src1_sel:WORD_1
    v_perm_b32 v48, v48, v124, s97
    v_perm_b32 v49, v49, v125, s97
    v_lshl_add_u64 v[48:49], v[48:49], 0, s[30:31]

    ds_add_rtn_u64 v[48:49], v14, v[48:49] offset:50000
    v_mad_i32_i16 v126, v50, v15, s96
    v_mad_i32_i16 v50, v50, v15, s96 op_sel:[1,0,0,0]
    v_mad_i32_i16 v127, v51, v15, s96
    v_mad_i32_i16 v51, v51, v15, s96 op_sel:[1,0,0,0]
    v_lshlrev_b32_sdwa v15, 3, v15 dst_sel:DWORD dst_unused:UNUSED_PAD src0_sel:DWORD src1_sel:WORD_1
    v_perm_b32 v50, v50, v126, s97
    v_perm_b32 v51, v51, v127, s97
    v_lshl_add_u64 v[50:51], v[50:51], 0, s[30:31]

    ds_add_rtn_u64 v[50:51], v15, v[50:51] offset:50000
    s_waitcnt lgkmcnt(4)
    v_or3_b32 v1, v36, v37, v1
    v_or3_b32 v1, v38, v39, v1
    v_or3_b32 v1, v40, v41, v1
    v_or3_b32 v1, v42, v43, v1
    v_mad_i32_i16 v120, v52, v16, s96
    v_mad_i32_i16 v52, v52, v16, s96 op_sel:[1,0,0,0]
    v_mad_i32_i16 v121, v53, v16, s96
    v_mad_i32_i16 v53, v53, v16, s96 op_sel:[1,0,0,0]
    v_lshlrev_b32_sdwa v16, 3, v16 dst_sel:DWORD dst_unused:UNUSED_PAD src0_sel:DWORD src1_sel:WORD_1
    v_perm_b32 v52, v52, v120, s97
    v_perm_b32 v53, v53, v121, s97
    v_lshl_add_u64 v[52:53], v[52:53], 0, s[30:31]

    ds_add_rtn_u64 v[52:53], v16, v[52:53] offset:50000
    v_mad_i32_i16 v122, v54, v17, s96
    v_mad_i32_i16 v54, v54, v17, s96 op_sel:[1,0,0,0]
    v_mad_i32_i16 v123, v55, v17, s96
    v_mad_i32_i16 v55, v55, v17, s96 op_sel:[1,0,0,0]
    v_lshlrev_b32_sdwa v17, 3, v17 dst_sel:DWORD dst_unused:UNUSED_PAD src0_sel:DWORD src1_sel:WORD_1
    v_perm_b32 v54, v54, v122, s97
    v_perm_b32 v55, v55, v123, s97
    v_lshl_add_u64 v[54:55], v[54:55], 0, s[30:31]

    ds_add_rtn_u64 v[54:55], v17, v[54:55] offset:50000
    v_mad_i32_i16 v124, v56, v18, s96
    v_mad_i32_i16 v56, v56, v18, s96 op_sel:[1,0,0,0]
    v_mad_i32_i16 v125, v57, v18, s96
    v_mad_i32_i16 v57, v57, v18, s96 op_sel:[1,0,0,0]
    v_lshlrev_b32_sdwa v18, 3, v18 dst_sel:DWORD dst_unused:UNUSED_PAD src0_sel:DWORD src1_sel:WORD_1
    v_perm_b32 v56, v56, v124, s97
    v_perm_b32 v57, v57, v125, s97
    v_lshl_add_u64 v[56:57], v[56:57], 0, s[30:31]

    ds_add_rtn_u64 v[56:57], v18, v[56:57] offset:50000
    v_mad_i32_i16 v126, v58, v19, s96
    v_mad_i32_i16 v58, v58, v19, s96 op_sel:[1,0,0,0]
    v_mad_i32_i16 v127, v59, v19, s96
    v_mad_i32_i16 v59, v59, v19, s96 op_sel:[1,0,0,0]
    v_lshlrev_b32_sdwa v19, 3, v19 dst_sel:DWORD dst_unused:UNUSED_PAD src0_sel:DWORD src1_sel:WORD_1
    v_perm_b32 v58, v58, v126, s97
    v_perm_b32 v59, v59, v127, s97
    v_lshl_add_u64 v[58:59], v[58:59], 0, s[30:31]

    ds_add_rtn_u64 v[58:59], v19, v[58:59] offset:50000
    s_waitcnt lgkmcnt(4)
    v_or3_b32 v1, v44, v45, v1
    v_or3_b32 v1, v46, v47, v1
    v_or3_b32 v1, v48, v49, v1
    v_or3_b32 v1, v50, v51, v1
    s_waitcnt vmcnt(2)
    v_lshlrev_b32_sdwa v82, 5, v80 dst_sel:DWORD dst_unused:UNUSED_PAD src0_sel:DWORD src1_sel:WORD_0
    v_lshlrev_b32_sdwa v83, 5, v80 dst_sel:DWORD dst_unused:UNUSED_PAD src0_sel:DWORD src1_sel:WORD_1
    v_lshlrev_b32_sdwa v84, 5, v81 dst_sel:DWORD dst_unused:UNUSED_PAD src0_sel:DWORD src1_sel:WORD_0
    v_lshlrev_b32_sdwa v85, 5, v81 dst_sel:DWORD dst_unused:UNUSED_PAD src0_sel:DWORD src1_sel:WORD_1
    buffer_load_dwordx4 v[94:97], v82, s[72:75], 0 offen
    buffer_load_dwordx2 v[110:111], v82, s[72:75], 0 offen offset:16

    buffer_load_dwordx4 v[98:101], v83, s[72:75], 0 offen
    buffer_load_dwordx2 v[112:113], v83, s[72:75], 0 offen offset:16

    buffer_load_dwordx4 v[102:105], v84, s[72:75], 0 offen
    buffer_load_dwordx2 v[114:115], v84, s[72:75], 0 offen offset:16

    buffer_load_dwordx4 v[106:109], v85, s[72:75], 0 offen
    buffer_load_dwordx2 v[116:117], v85, s[72:75], 0 offen offset:16

    v_mad_i32_i16 v120, v60, v20, s96
    v_mad_i32_i16 v60, v60, v20, s96 op_sel:[1,0,0,0]
    v_mad_i32_i16 v121, v61, v20, s96
    v_mad_i32_i16 v61, v61, v20, s96 op_sel:[1,0,0,0]
    v_lshlrev_b32_sdwa v20, 3, v20 dst_sel:DWORD dst_unused:UNUSED_PAD src0_sel:DWORD src1_sel:WORD_1
    v_perm_b32 v60, v60, v120, s97
    v_perm_b32 v61, v61, v121, s97
    v_lshl_add_u64 v[60:61], v[60:61], 0, s[30:31]

    ds_add_rtn_u64 v[60:61], v20, v[60:61] offset:50000
    v_mad_i32_i16 v122, v62, v21, s96
    v_mad_i32_i16 v62, v62, v21, s96 op_sel:[1,0,0,0]
    v_mad_i32_i16 v123, v63, v21, s96
    v_mad_i32_i16 v63, v63, v21, s96 op_sel:[1,0,0,0]
    v_lshlrev_b32_sdwa v21, 3, v21 dst_sel:DWORD dst_unused:UNUSED_PAD src0_sel:DWORD src1_sel:WORD_1
    v_perm_b32 v62, v62, v122, s97
    v_perm_b32 v63, v63, v123, s97
    v_lshl_add_u64 v[62:63], v[62:63], 0, s[30:31]

    ds_add_rtn_u64 v[62:63], v21, v[62:63] offset:50000
    v_mad_i32_i16 v124, v64, v22, s96
    v_mad_i32_i16 v64, v64, v22, s96 op_sel:[1,0,0,0]
    v_mad_i32_i16 v125, v65, v22, s96
    v_mad_i32_i16 v65, v65, v22, s96 op_sel:[1,0,0,0]
    v_lshlrev_b32_sdwa v22, 3, v22 dst_sel:DWORD dst_unused:UNUSED_PAD src0_sel:DWORD src1_sel:WORD_1
    v_perm_b32 v64, v64, v124, s97
    v_perm_b32 v65, v65, v125, s97
    v_lshl_add_u64 v[64:65], v[64:65], 0, s[30:31]

    ds_add_rtn_u64 v[64:65], v22, v[64:65] offset:50000
    v_mad_i32_i16 v126, v66, v23, s96
    v_mad_i32_i16 v66, v66, v23, s96 op_sel:[1,0,0,0]
    v_mad_i32_i16 v127, v67, v23, s96
    v_mad_i32_i16 v67, v67, v23, s96 op_sel:[1,0,0,0]
    v_lshlrev_b32_sdwa v23, 3, v23 dst_sel:DWORD dst_unused:UNUSED_PAD src0_sel:DWORD src1_sel:WORD_1
    v_perm_b32 v66, v66, v126, s97
    v_perm_b32 v67, v67, v127, s97
    v_lshl_add_u64 v[66:67], v[66:67], 0, s[30:31]

    ds_add_rtn_u64 v[66:67], v23, v[66:67] offset:50000
    s_waitcnt lgkmcnt(4)
    v_or3_b32 v1, v52, v53, v1
    v_or3_b32 v1, v54, v55, v1
    v_or3_b32 v1, v56, v57, v1
    v_or3_b32 v1, v58, v59, v1
    v_mad_i32_i16 v120, v68, v24, s96
    v_mad_i32_i16 v68, v68, v24, s96 op_sel:[1,0,0,0]
    v_mad_i32_i16 v121, v69, v24, s96
    v_mad_i32_i16 v69, v69, v24, s96 op_sel:[1,0,0,0]
    v_lshlrev_b32_sdwa v24, 3, v24 dst_sel:DWORD dst_unused:UNUSED_PAD src0_sel:DWORD src1_sel:WORD_1
    v_perm_b32 v68, v68, v120, s97
    v_perm_b32 v69, v69, v121, s97
    v_lshl_add_u64 v[68:69], v[68:69], 0, s[30:31]

    ds_add_rtn_u64 v[68:69], v24, v[68:69] offset:50000
    v_mad_i32_i16 v122, v70, v25, s96
    v_mad_i32_i16 v70, v70, v25, s96 op_sel:[1,0,0,0]
    v_mad_i32_i16 v123, v71, v25, s96
    v_mad_i32_i16 v71, v71, v25, s96 op_sel:[1,0,0,0]
    v_lshlrev_b32_sdwa v25, 3, v25 dst_sel:DWORD dst_unused:UNUSED_PAD src0_sel:DWORD src1_sel:WORD_1
    v_perm_b32 v70, v70, v122, s97
    v_perm_b32 v71, v71, v123, s97
    v_lshl_add_u64 v[70:71], v[70:71], 0, s[30:31]

    ds_add_rtn_u64 v[70:71], v25, v[70:71] offset:50000
    v_mad_i32_i16 v124, v72, v26, s96
    v_mad_i32_i16 v72, v72, v26, s96 op_sel:[1,0,0,0]
    v_mad_i32_i16 v125, v73, v26, s96
    v_mad_i32_i16 v73, v73, v26, s96 op_sel:[1,0,0,0]
    v_lshlrev_b32_sdwa v26, 3, v26 dst_sel:DWORD dst_unused:UNUSED_PAD src0_sel:DWORD src1_sel:WORD_1
    v_perm_b32 v72, v72, v124, s97
    v_perm_b32 v73, v73, v125, s97
    v_lshl_add_u64 v[72:73], v[72:73], 0, s[30:31]

    ds_add_rtn_u64 v[72:73], v26, v[72:73] offset:50000
    v_mad_i32_i16 v126, v74, v27, s96
    v_mad_i32_i16 v74, v74, v27, s96 op_sel:[1,0,0,0]
    v_mad_i32_i16 v127, v75, v27, s96
    v_mad_i32_i16 v75, v75, v27, s96 op_sel:[1,0,0,0]
    v_lshlrev_b32_sdwa v27, 3, v27 dst_sel:DWORD dst_unused:UNUSED_PAD src0_sel:DWORD src1_sel:WORD_1
    v_perm_b32 v74, v74, v126, s97
    v_perm_b32 v75, v75, v127, s97
    v_lshl_add_u64 v[74:75], v[74:75], 0, s[30:31]

    ds_add_rtn_u64 v[74:75], v27, v[74:75] offset:50000
    s_waitcnt lgkmcnt(4)
    v_or3_b32 v1, v60, v61, v1
    v_or3_b32 v1, v62, v63, v1
    v_or3_b32 v1, v64, v65, v1
    v_or3_b32 v1, v66, v67, v1
    s_waitcnt lgkmcnt(0)
    v_or3_b32 v1, v68, v69, v1
    v_or3_b32 v1, v70, v71, v1
    v_or3_b32 v1, v72, v73, v1
    v_or3_b32 v1, v74, v75, v1
    s_barrier

    v_add_u32 v40, 50000, v3
    v_add_u32 v41, 115536, v3
    v_cmp_gt_u32 vcc, 106, v0

    v_mov_b32 v28, 0
    v_mov_b32 v29, 0
    v_mov_b32 v30, 0
    v_mov_b32 v31, 0
    ds_read_b128 v[4:7], v40 offset:0
    ds_read_b128 v[8:11], v40 offset:16384
    ds_read_b128 v[12:15], v40 offset:32768
    ds_read_b128 v[16:19], v40 offset:49152
    ds_read_b128 v[20:23], v41 offset:0
    ds_read_b128 v[24:27], v41 offset:16384
    s_mov_b64 exec, vcc
    ds_read_b128 v[28:31], v41 offset:32768
    s_mov_b64 exec, -1
    s_mul_i32 s3, s37, 6400000
    s_mul_i32 s5, s36, 100000
    s_add_u32 s3, s3, s5
    s_add_u32 s3, s3, 8896512
    v_bfrev_b32 v42, 1

    s_add_u32 s20, s6, s3
    s_addc_u32 s21, s7, 0
    s_mov_b32 s22, 100000
    s_mov_b32 s23, 0x20000
    s_sub_u32 s3, 0, s28
    v_add_u32 v43, s3, v0
    v_cmp_gt_u32 vcc, s29, v43
    s_mov_b32 s3, 0
    s_waitcnt lgkmcnt(6)
    v_cndmask_b32 v43, v3, v42, vcc
    buffer_store_dwordx4 v[4:7], v43, s[20:23], s3 offen sc1

    s_sub_u32 s3, 1024, s28
    v_add_u32 v43, s3, v0
    v_cmp_gt_u32 vcc, s29, v43
    s_mov_b32 s3, 16384
    s_waitcnt lgkmcnt(5)
    v_cndmask_b32 v43, v3, v42, vcc
    buffer_store_dwordx4 v[8:11], v43, s[20:23], s3 offen sc1

    s_sub_u32 s3, 2048, s28
    v_add_u32 v43, s3, v0
    v_cmp_gt_u32 vcc, s29, v43
    s_mov_b32 s3, 32768
    s_waitcnt lgkmcnt(4)
    v_cndmask_b32 v43, v3, v42, vcc
    buffer_store_dwordx4 v[12:15], v43, s[20:23], s3 offen sc1

    s_sub_u32 s3, 3072, s28
    v_add_u32 v43, s3, v0
    v_cmp_gt_u32 vcc, s29, v43
    s_mov_b32 s3, 49152
    s_waitcnt lgkmcnt(3)
    v_cndmask_b32 v43, v3, v42, vcc
    buffer_store_dwordx4 v[16:19], v43, s[20:23], s3 offen sc1

    s_sub_u32 s3, 4096, s28
    v_add_u32 v43, s3, v0
    v_cmp_gt_u32 vcc, s29, v43
    s_mov_b32 s3, 65536
    s_waitcnt lgkmcnt(2)
    v_cndmask_b32 v43, v3, v42, vcc
    buffer_store_dwordx4 v[20:23], v43, s[20:23], s3 offen sc1

    s_sub_u32 s3, 5120, s28
    v_add_u32 v43, s3, v0
    v_cmp_gt_u32 vcc, s29, v43
    s_mov_b32 s3, 81920
    s_waitcnt lgkmcnt(1)
    v_cndmask_b32 v43, v3, v42, vcc
    buffer_store_dwordx4 v[24:27], v43, s[20:23], s3 offen sc1

    s_sub_u32 s3, 6144, s28
    v_add_u32 v43, s3, v0
    v_cmp_gt_u32 vcc, s29, v43
    s_mov_b32 s3, 98304
    s_waitcnt lgkmcnt(0)
    v_cndmask_b32 v43, v3, v42, vcc
    buffer_store_dwordx4 v[28:31], v43, s[20:23], s3 offen sc1

    v_or3_b32 v1, v4, v5, v1
    v_or3_b32 v1, v6, v7, v1
    v_or3_b32 v1, v8, v9, v1
    v_or3_b32 v1, v10, v11, v1
    v_or3_b32 v1, v12, v13, v1
    v_or3_b32 v1, v14, v15, v1
    v_or3_b32 v1, v16, v17, v1
    v_or3_b32 v1, v18, v19, v1
    v_or3_b32 v1, v20, v21, v1
    v_or3_b32 v1, v22, v23, v1
    v_or3_b32 v1, v24, v25, v1
    v_or3_b32 v1, v26, v27, v1
    v_or3_b32 v1, v28, v29, v1
    v_or3_b32 v1, v30, v31, v1
    v_and_b32 v1, 0x80008000, v1
    v_cmp_ne_u32 vcc, 0, v1
    v_mov_b32 v40, 150024
    v_mov_b32 v41, 1
    s_cbranch_vccz L_nf_82
    ds_write_b32 v40, v41
L_nf_82:
    s_mov_b32 s33, 1
    s_mov_b32 s49, s37
    s_waitcnt vmcnt(0) lgkmcnt(0)

    s_barrier
    ds_read_b32 v41, v40
    s_waitcnt lgkmcnt(0)
    v_readfirstlane_b32 s3, v41
    s_nop 1
    s_cmp_lg_u32 s3, 0
    s_cbranch_scc1 L_p2slow_48

L_meet_84:
    v_readfirstlane_b32 s3, v0
    v_mov_b32 v118, 150016
    s_nop 0
    s_cmp_eq_u32 s3, 960
    s_cbranch_scc1 L_sync_91
L_bcast_86:
    s_barrier

    ds_read_b32 v119, v118
    s_waitcnt lgkmcnt(0)
    v_readfirstlane_b32 s35, v119
    s_nop 1
    s_bitcmp1_b32 s35, 16
    s_cbranch_scc1 L_fend_92
L_post_88:
    v_cmp_gt_u32 vcc, 782, v0
    s_mov_b64 exec, vcc
    s_cbranch_execz L_postend_89

    s_cmp_eq_u32 s49, 0
    s_cbranch_scc1 L_own_98
    s_mov_b32 s3, 0
    buffer_load_dwordx4 v[36:39], v76, s[84:87], s3 offen sc1
    buffer_load_dwordx4 v[52:55], v77, s[84:87], s3 offen sc1
L_obk_99:
    s_cmp_eq_u32 s49, 1
    s_cbranch_scc1 L_own_100
    s_mov_b32 s3, 6400000
    buffer_load_dwordx4 v[40:43], v76, s[84:87], s3 offen sc1
    buffer_load_dwordx4 v[56:59], v77, s[84:87], s3 offen sc1
L_obk_101:
    s_cmp_eq_u32 s49, 2
    s_cbranch_scc1 L_own_102
    s_mov_b32 s3, 12800000
    buffer_load_dwordx4 v[44:47], v76, s[84:87], s3 offen sc1
    buffer_load_dwordx4 v[60:63], v77, s[84:87], s3 offen sc1
L_obk_103:
    s_cmp_eq_u32 s49, 3
    s_cbranch_scc1 L_own_104
    s_mov_b32 s3, 19200000
    buffer_load_dwordx4 v[48:51], v76, s[84:87], s3 offen sc1
    buffer_load_dwordx4 v[64:67], v77, s[84:87], s3 offen sc1
L_obk_105:
    s_and_b32 s3, s35, 0xf0
    s_waitcnt vmcnt(0) lgkmcnt(0)
    s_cbranch_scc1 L_fgen_106

    v_add_u32 v36, v36, v40
    v_add_u32 v44, v44, v48
    v_add_u32 v37, v37, v41
    v_add_u32 v45, v45, v49
    v_add_u32 v38, v38, v42
    v_add_u32 v46, v46, v50
    v_add_u32 v39, v39, v43
    v_add_u32 v47, v47, v51
    v_add_u32_sdwa v4, v36, v44 dst_sel:DWORD dst_unused:UNUSED_PAD src0_sel:WORD_0 src1_sel:WORD_0
    v_add_u32_sdwa v5, v36, v44 dst_sel:DWORD dst_unused:UNUSED_PAD src0_sel:WORD_1 src1_sel:WORD_1
    v_add_u32_sdwa v6, v37, v45 dst_sel:DWORD dst_unused:UNUSED_PAD src0_sel:WORD_0 src1_sel:WORD_0
    v_add_u32_sdwa v7, v37, v45 dst_sel:DWORD dst_unused:UNUSED_PAD src0_sel:WORD_1 src1_sel:WORD_1
    v_add_u32_sdwa v8, v38, v46 dst_sel:DWORD dst_unused:UNUSED_PAD src0_sel:WORD_0 src1_sel:WORD_0
    v_add_u32_sdwa v9, v38, v46 dst_sel:DWORD dst_unused:UNUSED_PAD src0_sel:WORD_1 src1_sel:WORD_1
    v_add_u32_sdwa v10, v39, v47 dst_sel:DWORD dst_unused:UNUSED_PAD src0_sel:WORD_0 src1_sel:WORD_0
    v_add_u32_sdwa v11, v39, v47 dst_sel:DWORD dst_unused:UNUSED_PAD src0_sel:WORD_1 src1_sel:WORD_1
    v_add_u32 v52, v52, v56
    v_add_u32 v60, v60, v64
    v_add_u32 v53, v53, v57
    v_add_u32 v61, v61, v65
    v_add_u32 v54, v54, v58
    v_add_u32 v62, v62, v66
    v_add_u32 v55, v55, v59
    v_add_u32 v63, v63, v67
    v_add_u32_sdwa v12, v52, v60 dst_sel:DWORD dst_unused:UNUSED_PAD src0_sel:WORD_0 src1_sel:WORD_0
    v_add_u32_sdwa v13, v52, v60 dst_sel:DWORD dst_unused:UNUSED_PAD src0_sel:WORD_1 src1_sel:WORD_1
    v_add_u32_sdwa v14, v53, v61 dst_sel:DWORD dst_unused:UNUSED_PAD src0_sel:WORD_0 src1_sel:WORD_0
    v_add_u32_sdwa v15, v53, v61 dst_sel:DWORD dst_unused:UNUSED_PAD src0_sel:WORD_1 src1_sel:WORD_1
    v_add_u32_sdwa v16, v54, v62 dst_sel:DWORD dst_unused:UNUSED_PAD src0_sel:WORD_0 src1_sel:WORD_0
    v_add_u32_sdwa v17, v54, v62 dst_sel:DWORD dst_unused:UNUSED_PAD src0_sel:WORD_1 src1_sel:WORD_1
    v_add_u32_sdwa v18, v55, v63 dst_sel:DWORD dst_unused:UNUSED_PAD src0_sel:WORD_0 src1_sel:WORD_0
    v_add_u32_sdwa v19, v55, v63 dst_sel:DWORD dst_unused:UNUSED_PAD src0_sel:WORD_1 src1_sel:WORD_1
    v_add_u32 v4, 0xffff0000, v4
    v_add_u32 v5, 0xffff0000, v5
    v_add_u32 v6, 0xffff0000, v6
    v_add_u32 v7, 0xffff0000, v7
    v_add_u32 v8, 0xffff0000, v8
    v_add_u32 v9, 0xffff0000, v9
    v_add_u32 v10, 0xffff0000, v10
    v_add_u32 v11, 0xffff0000, v11
    v_add_u32 v12, 0xffff0000, v12
    v_add_u32 v13, 0xffff0000, v13
    v_add_u32 v14, 0xffff0000, v14
    v_add_u32 v15, 0xffff0000, v15
    v_add_u32 v16, 0xffff0000, v16
    v_add_u32 v17, 0xffff0000, v17
    v_add_u32 v18, 0xffff0000, v18
    v_add_u32 v19, 0xffff0000, v19
    v_cvt_f32_i32 v4, v4
    v_cvt_f32_i32 v5, v5
    v_cvt_f32_i32 v6, v6
    v_cvt_f32_i32 v7, v7
    v_cvt_f32_i32 v8, v8
    v_cvt_f32_i32 v9, v9
    v_cvt_f32_i32 v10, v10
    v_cvt_f32_i32 v11, v11
    v_cvt_f32_i32 v12, v12
    v_cvt_f32_i32 v13, v13
    v_cvt_f32_i32 v14, v14
    v_cvt_f32_i32 v15, v15
    v_cvt_f32_i32 v16, v16
    v_cvt_f32_i32 v17, v17
    v_cvt_f32_i32 v18, v18
    v_cvt_f32_i32 v19, v19
    v_mul_f32 v4, s34, v4
    v_mul_f32 v5, s34, v5
    v_mul_f32 v6, s34, v6
    v_mul_f32 v7, s34, v7
    v_mul_f32 v8, s34, v8
    v_mul_f32 v9, s34, v9
    v_mul_f32 v10, s34, v10
    v_mul_f32 v11, s34, v11
    v_mul_f32 v12, s34, v12
    v_mul_f32 v13, s34, v13
    v_mul_f32 v14, s34, v14
    v_mul_f32 v15, s34, v15
    v_mul_f32 v16, s34, v16
    v_mul_f32 v17, s34, v17
    v_mul_f32 v18, s34, v18
    v_mul_f32 v19, s34, v19
L_fbk_107:
    s_lshl_b32 s52, s12, 16
    v_mul_f32 v20, s52, v4
    v_mul_f32 v24, s52, v8
    v_mul_f32 v28, s52, v12
    v_mul_f32 v32, s52, v16
    s_and_b32 s53, s12, s32
    v_mul_f32 v21, s53, v4
    v_mul_f32 v25, s53, v8
    v_mul_f32 v29, s53, v12
    v_mul_f32 v33, s53, v16
    s_lshl_b32 s52, s13, 16
    v_mul_f32 v22, s52, v4
    v_mul_f32 v26, s52, v8
    v_mul_f32 v30, s52, v12
    v_mul_f32 v34, s52, v16
    s_and_b32 s53, s13, s32
    v_mul_f32 v23, s53, v4
    v_mul_f32 v27, s53, v8
    v_mul_f32 v31, s53, v12
    v_mul_f32 v35, s53, v16
    s_lshl_b32 s52, s14, 16
    v_fmac_f32 v20, s52, v5
    v_fmac_f32 v24, s52, v9
    v_fmac_f32 v28, s52, v13
    v_fmac_f32 v32, s52, v17
    s_and_b32 s53, s14, s32
    v_fmac_f32 v21, s53, v5
    v_fmac_f32 v25, s53, v9
    v_fmac_f32 v29, s53, v13
    v_fmac_f32 v33, s53, v17
    s_lshl_b32 s52, s15, 16
    v_fmac_f32 v22, s52, v5
    v_fmac_f32 v26, s52, v9
    v_fmac_f32 v30, s52, v13
    v_fmac_f32 v34, s52, v17
    s_and_b32 s53, s15, s32
    v_fmac_f32 v23, s53, v5
    v_fmac_f32 v27, s53, v9
    v_fmac_f32 v31, s53, v13
    v_fmac_f32 v35, s53, v17
    s_lshl_b32 s52, s16, 16
    v_fmac_f32 v20, s52, v6
    v_fmac_f32 v24, s52, v10
    v_fmac_f32 v28, s52, v14
    v_fmac_f32 v32, s52, v18
    s_and_b32 s53, s16, s32
    v_fmac_f32 v21, s53, v6
    v_fmac_f32 v25, s53, v10
    v_fmac_f32 v29, s53, v14
    v_fmac_f32 v33, s53, v18
    s_lshl_b32 s52, s17, 16
    v_fmac_f32 v22, s52, v6
    v_fmac_f32 v26, s52, v10
    v_fmac_f32 v30, s52, v14
    v_fmac_f32 v34, s52, v18
    s_and_b32 s53, s17, s32
    v_fmac_f32 v23, s53, v6
    v_fmac_f32 v27, s53, v10
    v_fmac_f32 v31, s53, v14
    v_fmac_f32 v35, s53, v18
    s_lshl_b32 s52, s18, 16
    v_fmac_f32 v20, s52, v7
    v_fmac_f32 v24, s52, v11
    v_fmac_f32 v28, s52, v15
    v_fmac_f32 v32, s52, v19
    s_and_b32 s53, s18, s32
    v_fmac_f32 v21, s53, v7
    v_fmac_f32 v25, s53, v11
    v_fmac_f32 v29, s53, v15
    v_fmac_f32 v33, s53, v19
    s_lshl_b32 s52, s19, 16
    v_fmac_f32 v22, s52, v7
    v_fmac_f32 v26, s52, v11
    v_fmac_f32 v30, s52, v15
    v_fmac_f32 v34, s52, v19
    s_and_b32 s53, s19, s32
    v_fmac_f32 v23, s53, v7
    v_fmac_f32 v27, s53, v11
    v_fmac_f32 v31, s53, v15
    v_fmac_f32 v35, s53, v19
    v_mul_f32 v20, v20, v94
    v_mul_f32 v21, v21, v95
    v_mul_f32 v22, v22, v96
    v_mul_f32 v23, v23, v97
    v_mul_f32 v24, v24, v98
    v_mul_f32 v25, v25, v99
    v_mul_f32 v26, v26, v100
    v_mul_f32 v27, v27, v101
    v_mul_f32 v28, v28, v102
    v_mul_f32 v29, v29, v103
    v_mul_f32 v30, v30, v104
    v_mul_f32 v31, v31, v105
    v_mul_f32 v32, v32, v106
    v_mul_f32 v33, v33, v107
    v_mul_f32 v34, v34, v108
    v_mul_f32 v35, v35, v109
    v_cvt_pk_bf16_f32 v20, v20, v21
    v_cvt_pk_bf16_f32 v22, v22, v23
    v_cvt_pk_bf16_f32 v24, v24, v25
    v_cvt_pk_bf16_f32 v26, v26, v27
    v_cvt_pk_bf16_f32 v28, v28, v29
    v_cvt_pk_bf16_f32 v30, v30, v31
    v_cvt_pk_bf16_f32 v32, v32, v33
    v_cvt_pk_bf16_f32 v34, v34, v35
    s_pack_ll_b32_b16 s52, s56, s58
    v_dot2_f32_bf16 v4, v20, s52, 0
    v_dot2_f32_bf16 v8, v24, s52, 0
    v_dot2_f32_bf16 v12, v28, s52, 0
    v_dot2_f32_bf16 v16, v32, s52, 0
    s_pack_hh_b32_b16 s53, s56, s58
    v_dot2_f32_bf16 v5, v20, s53, 0
    v_dot2_f32_bf16 v9, v24, s53, 0
    v_dot2_f32_bf16 v13, v28, s53, 0
    v_dot2_f32_bf16 v17, v32, s53, 0
    s_pack_ll_b32_b16 s52, s57, s59
    v_dot2_f32_bf16 v6, v20, s52, 0
    v_dot2_f32_bf16 v10, v24, s52, 0
    v_dot2_f32_bf16 v14, v28, s52, 0
    v_dot2_f32_bf16 v18, v32, s52, 0
    s_pack_hh_b32_b16 s53, s57, s59
    v_dot2_f32_bf16 v7, v20, s53, 0
    v_dot2_f32_bf16 v11, v24, s53, 0
    v_dot2_f32_bf16 v15, v28, s53, 0
    v_dot2_f32_bf16 v19, v32, s53, 0
    s_pack_ll_b32_b16 s52, s60, s62
    v_dot2_f32_bf16 v4, v22, s52, v4
    v_dot2_f32_bf16 v8, v26, s52, v8
    v_dot2_f32_bf16 v12, v30, s52, v12
    v_dot2_f32_bf16 v16, v34, s52, v16
    s_pack_hh_b32_b16 s53, s60, s62
    v_dot2_f32_bf16 v5, v22, s53, v5
    v_dot2_f32_bf16 v9, v26, s53, v9
    v_dot2_f32_bf16 v13, v30, s53, v13
    v_dot2_f32_bf16 v17, v34, s53, v17
    s_pack_ll_b32_b16 s52, s61, s63
    v_dot2_f32_bf16 v6, v22, s52, v6
    v_dot2_f32_bf16 v10, v26, s52, v10
    v_dot2_f32_bf16 v14, v30, s52, v14
    v_dot2_f32_bf16 v18, v34, s52, v18
    s_pack_hh_b32_b16 s53, s61, s63
    v_dot2_f32_bf16 v7, v22, s53, v7
    v_dot2_f32_bf16 v11, v26, s53, v11
    v_dot2_f32_bf16 v15, v30, s53, v15
    v_dot2_f32_bf16 v19, v34, s53, v19
    v_lshlrev_b32 v36, 16, v86
    v_and_b32 v37, s32, v86
    v_lshlrev_b32 v52, 16, v110
    v_and_b32 v53, s32, v110
    v_lshlrev_b32 v38, 16, v87
    v_and_b32 v39, s32, v87
    v_lshlrev_b32 v54, 16, v111
    v_and_b32 v55, s32, v111
    v_lshlrev_b32 v40, 16, v88
    v_and_b32 v41, s32, v88
    v_lshlrev_b32 v56, 16, v112
    v_and_b32 v57, s32, v112
    v_lshlrev_b32 v42, 16, v89
    v_and_b32 v43, s32, v89
    v_lshlrev_b32 v58, 16, v113
    v_and_b32 v59, s32, v113
    v_lshlrev_b32 v44, 16, v90
    v_and_b32 v45, s32, v90
    v_lshlrev_b32 v60, 16, v114
    v_and_b32 v61, s32, v114
    v_lshlrev_b32 v46, 16, v91
    v_and_b32 v47, s32, v91
    v_lshlrev_b32 v62, 16, v115
    v_and_b32 v63, s32, v115
    v_lshlrev_b32 v48, 16, v92
    v_and_b32 v49, s32, v92
    v_lshlrev_b32 v64, 16, v116
    v_and_b32 v65, s32, v116
    v_lshlrev_b32 v50, 16, v93
    v_and_b32 v51, s32, v93
    v_lshlrev_b32 v66, 16, v117
    v_and_b32 v67, s32, v117
    v_cvt_pk_bf16_f32 v4, v4, v5
    v_cvt_pk_bf16_f32 v6, v6, v7
    v_cvt_pk_bf16_f32 v8, v8, v9
    v_cvt_pk_bf16_f32 v10, v10, v11
    v_cvt_pk_bf16_f32 v12, v12, v13
    v_cvt_pk_bf16_f32 v14, v14, v15
    v_cvt_pk_bf16_f32 v16, v16, v17
    v_cvt_pk_bf16_f32 v18, v18, v19
    v_and_b32 v5, s32, v4
    v_lshlrev_b32 v4, 16, v4
    v_and_b32 v7, s32, v6
    v_lshlrev_b32 v6, 16, v6
    v_and_b32 v9, s32, v8
    v_lshlrev_b32 v8, 16, v8
    v_and_b32 v11, s32, v10
    v_lshlrev_b32 v10, 16, v10
    v_and_b32 v13, s32, v12
    v_lshlrev_b32 v12, 16, v12
    v_and_b32 v15, s32, v14
    v_lshlrev_b32 v14, 16, v14
    v_and_b32 v17, s32, v16
    v_lshlrev_b32 v16, 16, v16
    v_and_b32 v19, s32, v18
    v_lshlrev_b32 v18, 16, v18
    v_mul_f32 v4, v4, v52
    v_mul_f32 v5, v5, v53
    v_mul_f32 v6, v6, v54
    v_mul_f32 v7, v7, v55
    v_mul_f32 v8, v8, v56
    v_mul_f32 v9, v9, v57
    v_mul_f32 v10, v10, v58
    v_mul_f32 v11, v11, v59
    v_mul_f32 v12, v12, v60
    v_mul_f32 v13, v13, v61
    v_mul_f32 v14, v14, v62
    v_mul_f32 v15, v15, v63
    v_mul_f32 v16, v16, v64
    v_mul_f32 v17, v17, v65
    v_mul_f32 v18, v18, v66
    v_mul_f32 v19, v19, v67
    v_cvt_pk_bf16_f32 v4, v4, v5
    v_cvt_pk_bf16_f32 v6, v6, v7
    v_cvt_pk_bf16_f32 v8, v8, v9
    v_cvt_pk_bf16_f32 v10, v10, v11
    v_cvt_pk_bf16_f32 v12, v12, v13
    v_cvt_pk_bf16_f32 v14, v14, v15
    v_cvt_pk_bf16_f32 v16, v16, v17
    v_cvt_pk_bf16_f32 v18, v18, v19
    v_and_b32 v5, s32, v4
    v_lshlrev_b32 v4, 16, v4
    v_and_b32 v7, s32, v6
    v_lshlrev_b32 v6, 16, v6
    v_and_b32 v9, s32, v8
    v_lshlrev_b32 v8, 16, v8
    v_and_b32 v11, s32, v10
    v_lshlrev_b32 v10, 16, v10
    v_and_b32 v13, s32, v12
    v_lshlrev_b32 v12, 16, v12
    v_and_b32 v15, s32, v14
    v_lshlrev_b32 v14, 16, v14
    v_and_b32 v17, s32, v16
    v_lshlrev_b32 v16, 16, v16
    v_and_b32 v19, s32, v18
    v_lshlrev_b32 v18, 16, v18
    v_add_f32 v4, v4, v36
    v_add_f32 v5, v5, v37
    v_add_f32 v6, v6, v38
    v_add_f32 v7, v7, v39
    v_add_f32 v8, v8, v40
    v_add_f32 v9, v9, v41
    v_add_f32 v10, v10, v42
    v_add_f32 v11, v11, v43
    v_add_f32 v12, v12, v44
    v_add_f32 v13, v13, v45
    v_add_f32 v14, v14, v46
    v_add_f32 v15, v15, v47
    v_add_f32 v16, v16, v48
    v_add_f32 v17, v17, v49
    v_add_f32 v18, v18, v50
    v_add_f32 v19, v19, v51
    v_cvt_pk_bf16_f32 v20, v4, v5
    v_cvt_pk_bf16_f32 v21, v6, v7
    v_cvt_pk_bf16_f32 v22, v8, v9
    v_cvt_pk_bf16_f32 v23, v10, v11
    v_cvt_pk_bf16_f32 v24, v12, v13
    v_cvt_pk_bf16_f32 v25, v14, v15
    v_cvt_pk_bf16_f32 v26, v16, v17
    v_cvt_pk_bf16_f32 v27, v18, v19
    buffer_store_dwordx4 v[20:23], v76, s[76:79], 0 offen
    buffer_store_dwordx4 v[24:27], v77, s[76:79], 0 offen
L_postend_89:
    s_mov_b64 exec, -1

    s_bfe_u32 s3, s35, 0x40008
    s_cbranch_scc0 L_fend_92
    s_ff1_i32_b32 s41, s3
    s_add_u32 s3, s41, 8
    s_bitset0_b32 s35, s3
    s_mov_b32 s49, -1

    s_mul_i32 s28, s41, 3125
    s_add_u32 s29, s28, 3126
    s_add_u32 s28, s28, 1
    s_lshr_b32 s28, s28, 1
    s_lshr_b32 s29, s29, 1
    s_sub_u32 s29, s29, s28
    s_sub_u32 s5, s29, 782
    s_mul_i32 s3, s36, 6250
    v_add_u32 v78, s28, v0
    v_mov_b32 v82, 0x2000000
    v_add_u32 v79, 782, v78
    v_cmp_gt_u32 vcc, 782, v0
    v_add_u32 v76, s3, v78
    v_add_u32 v77, s3, v79
    v_cndmask_b32 v76, v82, v76, vcc
    v_cmp_gt_u32 vcc, s5, v0
    v_lshlrev_b32 v78, 4, v78
    v_lshlrev_b32 v79, 4, v79
    v_cndmask_b32 v77, v82, v77, vcc
    v_lshlrev_b32 v80, 2, v76
    v_lshlrev_b32 v76, 4, v76
    v_lshlrev_b32 v81, 2, v77
    v_lshlrev_b32 v77, 4, v77
    buffer_load_dword v80, v80, s[68:71], 0 offen
    buffer_load_dword v81, v81, s[68:71], 0 offen
    buffer_load_dwordx4 v[86:89], v76, s[8:11], 0 offen
    buffer_load_dwordx4 v[90:93], v77, s[8:11], 0 offen

    s_waitcnt vmcnt(2)
    v_lshlrev_b32_sdwa v82, 5, v80 dst_sel:DWORD dst_unused:UNUSED_PAD src0_sel:DWORD src1_sel:WORD_0
    v_lshlrev_b32_sdwa v83, 5, v80 dst_sel:DWORD dst_unused:UNUSED_PAD src0_sel:DWORD src1_sel:WORD_1
    v_lshlrev_b32_sdwa v84, 5, v81 dst_sel:DWORD dst_unused:UNUSED_PAD src0_sel:DWORD src1_sel:WORD_0
    v_lshlrev_b32_sdwa v85, 5, v81 dst_sel:DWORD dst_unused:UNUSED_PAD src0_sel:DWORD src1_sel:WORD_1
    buffer_load_dwordx4 v[94:97], v82, s[72:75], 0 offen
    buffer_load_dwordx2 v[110:111], v82, s[72:75], 0 offen offset:16

    buffer_load_dwordx4 v[98:101], v83, s[72:75], 0 offen
    buffer_load_dwordx2 v[112:113], v83, s[72:75], 0 offen offset:16

    buffer_load_dwordx4 v[102:105], v84, s[72:75], 0 offen
    buffer_load_dwordx2 v[114:115], v84, s[72:75], 0 offen offset:16

    buffer_load_dwordx4 v[106:109], v85, s[72:75], 0 offen
    buffer_load_dwordx2 v[116:117], v85, s[72:75], 0 offen offset:16

    s_branch L_post_88
L_fin_83:

    s_load_dwordx2 s[68:69], s[0:1], 24
    s_load_dwordx4 s[88:91], s[0:1], 72
    s_load_dwordx2 s[76:77], s[0:1], 88
    s_load_dwordx2 s[80:81], s[0:1], 96
    s_mov_b32 s70, 1600000
    s_mov_b32 s71, 0x20000
    s_mov_b32 s78, 6400000
    s_mov_b32 s79, 0x20000
    s_movk_i32 s82, 256
    s_mov_b32 s83, 0x20000
    s_lshl_b32 s48, s36, 2
    s_mov_b32 s41, s37

    s_add_u32 s84, s6, 8896512
    s_addc_u32 s85, s7, 0
    s_mov_b32 s86, 76800000
    s_mov_b32 s87, 0x20000
    s_add_u32 s72, s6, 393216
    s_addc_u32 s73, s7, 0
    s_mov_b32 s74, 2097152
    s_mov_b32 s75, 0x20000
    s_mov_b32 s49, -1
    s_waitcnt lgkmcnt(0)
    s_load_dwordx8 s[12:19], s[88:89], 0
    s_load_dwordx8 s[56:63], s[90:91], 0

    s_mul_i32 s28, s41, 3125
    s_add_u32 s29, s28, 3126
    s_add_u32 s28, s28, 1
    s_lshr_b32 s28, s28, 1
    s_lshr_b32 s29, s29, 1
    s_sub_u32 s29, s29, s28
    s_sub_u32 s5, s29, 782
    s_mul_i32 s3, s36, 6250
    v_add_u32 v78, s28, v0
    v_mov_b32 v82, 0x2000000
    v_add_u32 v79, 782, v78
    v_cmp_gt_u32 vcc, 782, v0
    v_add_u32 v76, s3, v78
    v_add_u32 v77, s3, v79
    v_cndmask_b32 v76, v82, v76, vcc
    v_cmp_gt_u32 vcc, s5, v0
    v_lshlrev_b32 v78, 4, v78
    v_lshlrev_b32 v79, 4, v79
    v_cndmask_b32 v77, v82, v77, vcc
    v_lshlrev_b32 v80, 2, v76
    v_lshlrev_b32 v76, 4, v76
    v_lshlrev_b32 v81, 2, v77
    v_lshlrev_b32 v77, 4, v77
    buffer_load_dword v80, v80, s[68:71], 0 offen
    buffer_load_dword v81, v81, s[68:71], 0 offen
    buffer_load_dwordx4 v[86:89], v76, s[8:11], 0 offen
    buffer_load_dwordx4 v[90:93], v77, s[8:11], 0 offen

    s_waitcnt vmcnt(2)
    v_lshlrev_b32_sdwa v82, 5, v80 dst_sel:DWORD dst_unused:UNUSED_PAD src0_sel:DWORD src1_sel:WORD_0
    v_lshlrev_b32_sdwa v83, 5, v80 dst_sel:DWORD dst_unused:UNUSED_PAD src0_sel:DWORD src1_sel:WORD_1
    v_lshlrev_b32_sdwa v84, 5, v81 dst_sel:DWORD dst_unused:UNUSED_PAD src0_sel:DWORD src1_sel:WORD_0
    v_lshlrev_b32_sdwa v85, 5, v81 dst_sel:DWORD dst_unused:UNUSED_PAD src0_sel:DWORD src1_sel:WORD_1
    buffer_load_dwordx4 v[94:97], v82, s[72:75], 0 offen
    buffer_load_dwordx2 v[110:111], v82, s[72:75], 0 offen offset:16

    buffer_load_dwordx4 v[98:101], v83, s[72:75], 0 offen
    buffer_load_dwordx2 v[112:113], v83, s[72:75], 0 offen offset:16

    buffer_load_dwordx4 v[102:105], v84, s[72:75], 0 offen
    buffer_load_dwordx2 v[114:115], v84, s[72:75], 0 offen offset:16

    buffer_load_dwordx4 v[106:109], v85, s[72:75], 0 offen
    buffer_load_dwordx2 v[116:117], v85, s[72:75], 0 offen offset:16

    s_waitcnt vmcnt(0) lgkmcnt(0)
    s_barrier
    s_branch L_meet_84
L_fend_92:

L_p2done_47:
    s_endpgm

L_ufix_49:
    v_and_b32 v117, 63, v0
    v_lshlrev_b32 v117, 2, v117
    s_sub_i32 s54, s42, 1024
    v_cmp_le_i32 vcc, s54, v117
    s_mov_b64 exec, vcc
    v_mov_b32 v12, 0
    v_mov_b32 v44, 0
    s_mov_b64 exec, -1
    s_sub_i32 s54, s42, 1025
    v_cmp_le_i32 vcc, s54, v117
    s_mov_b64 exec, vcc
    v_mov_b32 v13, 0
    v_mov_b32 v46, 0
    s_mov_b64 exec, -1
    s_sub_i32 s54, s42, 1026
    v_cmp_le_i32 vcc, s54, v117
    s_mov_b64 exec, vcc
    v_mov_b32 v14, 0
    v_mov_b32 v48, 0
    s_mov_b64 exec, -1
    s_sub_i32 s54, s42, 1027
    v_cmp_le_i32 vcc, s54, v117
    s_mov_b64 exec, vcc
    v_mov_b32 v15, 0
    v_mov_b32 v50, 0
    s_mov_b64 exec, -1
    s_branch L_uback_50
L_ufix_51:
    v_and_b32 v117, 63, v0
    v_lshlrev_b32 v117, 2, v117
    s_sub_i32 s54, s42, 1536
    v_cmp_le_i32 vcc, s54, v117
    s_mov_b64 exec, vcc
    v_mov_b32 v16, 0
    v_mov_b32 v52, 0
    s_mov_b64 exec, -1
    s_sub_i32 s54, s42, 1537
    v_cmp_le_i32 vcc, s54, v117
    s_mov_b64 exec, vcc
    v_mov_b32 v17, 0
    v_mov_b32 v54, 0
    s_mov_b64 exec, -1
    s_sub_i32 s54, s42, 1538
    v_cmp_le_i32 vcc, s54, v117
    s_mov_b64 exec, vcc
    v_mov_b32 v18, 0
    v_mov_b32 v56, 0
    s_mov_b64 exec, -1
    s_sub_i32 s54, s42, 1539
    v_cmp_le_i32 vcc, s54, v117
    s_mov_b64 exec, vcc
    v_mov_b32 v19, 0
    v_mov_b32 v58, 0
    s_mov_b64 exec, -1
    s_branch L_uback_52
L_ufix_53:
    v_and_b32 v117, 63, v0
    v_lshlrev_b32 v117, 2, v117
    s_sub_i32 s54, s42, 2048
    v_cmp_le_i32 vcc, s54, v117
    s_mov_b64 exec, vcc
    v_mov_b32 v20, 0
    v_mov_b32 v60, 0
    s_mov_b64 exec, -1
    s_sub_i32 s54, s42, 2049
    v_cmp_le_i32 vcc, s54, v117
    s_mov_b64 exec, vcc
    v_mov_b32 v21, 0
    v_mov_b32 v62, 0
    s_mov_b64 exec, -1
    s_sub_i32 s54, s42, 2050
    v_cmp_le_i32 vcc, s54, v117
    s_mov_b64 exec, vcc
    v_mov_b32 v22, 0
    v_mov_b32 v64, 0
    s_mov_b64 exec, -1
    s_sub_i32 s54, s42, 2051
    v_cmp_le_i32 vcc, s54, v117
    s_mov_b64 exec, vcc
    v_mov_b32 v23, 0
    v_mov_b32 v66, 0
    s_mov_b64 exec, -1
    s_branch L_uback_54
L_ufix_55:
    v_and_b32 v117, 63, v0
    v_lshlrev_b32 v117, 2, v117
    s_sub_i32 s54, s42, 2560
    v_cmp_le_i32 vcc, s54, v117
    s_mov_b64 exec, vcc
    v_mov_b32 v24, 0
    v_mov_b32 v68, 0
    s_mov_b64 exec, -1
    s_sub_i32 s54, s42, 2561
    v_cmp_le_i32 vcc, s54, v117
    s_mov_b64 exec, vcc
    v_mov_b32 v25, 0
    v_mov_b32 v70, 0
    s_mov_b64 exec, -1
    s_sub_i32 s54, s42, 2562
    v_cmp_le_i32 vcc, s54, v117
    s_mov_b64 exec, vcc
    v_mov_b32 v26, 0
    v_mov_b32 v72, 0
    s_mov_b64 exec, -1
    s_sub_i32 s54, s42, 2563
    v_cmp_le_i32 vcc, s54, v117
    s_mov_b64 exec, vcc
    v_mov_b32 v27, 0
    v_mov_b32 v74, 0
    s_mov_b64 exec, -1
    s_branch L_uback_56
L_ufix_57:
    v_and_b32 v117, 63, v0
    v_lshlrev_b32 v117, 2, v117
    s_sub_i32 s54, s42, 0
    v_cmp_le_i32 vcc, s54, v117
    s_mov_b64 exec, vcc
    v_mov_b32 v4, 0
    v_mov_b32 v28, 0
    s_mov_b64 exec, -1
    s_sub_i32 s54, s42, 1
    v_cmp_le_i32 vcc, s54, v117
    s_mov_b64 exec, vcc
    v_mov_b32 v5, 0
    v_mov_b32 v30, 0
    s_mov_b64 exec, -1
    s_sub_i32 s54, s42, 2
    v_cmp_le_i32 vcc, s54, v117
    s_mov_b64 exec, vcc
    v_mov_b32 v6, 0
    v_mov_b32 v32, 0
    s_mov_b64 exec, -1
    s_sub_i32 s54, s42, 3
    v_cmp_le_i32 vcc, s54, v117
    s_mov_b64 exec, vcc
    v_mov_b32 v7, 0
    v_mov_b32 v34, 0
    s_mov_b64 exec, -1
    s_branch L_uback_58
L_ufix_59:
    v_and_b32 v117, 63, v0
    v_lshlrev_b32 v117, 2, v117
    s_sub_i32 s54, s42, 512
    v_cmp_le_i32 vcc, s54, v117
    s_mov_b64 exec, vcc
    v_mov_b32 v8, 0
    v_mov_b32 v36, 0
    s_mov_b64 exec, -1
    s_sub_i32 s54, s42, 513
    v_cmp_le_i32 vcc, s54, v117
    s_mov_b64 exec, vcc
    v_mov_b32 v9, 0
    v_mov_b32 v38, 0
    s_mov_b64 exec, -1
    s_sub_i32 s54, s42, 514
    v_cmp_le_i32 vcc, s54, v117
    s_mov_b64 exec, vcc
    v_mov_b32 v10, 0
    v_mov_b32 v40, 0
    s_mov_b64 exec, -1
    s_sub_i32 s54, s42, 515
    v_cmp_le_i32 vcc, s54, v117
    s_mov_b64 exec, vcc
    v_mov_b32 v11, 0
    v_mov_b32 v42, 0
    s_mov_b64 exec, -1
    s_branch L_uback_60
L_ufix_66:
    v_and_b32 v117, 63, v0
    v_lshlrev_b32 v117, 2, v117
    s_sub_i32 s54, s42, 3072
    v_cmp_le_i32 vcc, s54, v117
    s_mov_b64 exec, vcc
    v_mov_b32 v106, 0
    v_mov_b32 v120, 0
    s_mov_b64 exec, -1
    s_sub_i32 s54, s42, 3073
    v_cmp_le_i32 vcc, s54, v117
    s_mov_b64 exec, vcc
    v_mov_b32 v107, 0
    v_mov_b32 v122, 0
    s_mov_b64 exec, -1
    s_sub_i32 s54, s42, 3074
    v_cmp_le_i32 vcc, s54, v117
    s_mov_b64 exec, vcc
    v_mov_b32 v108, 0
    v_mov_b32 v124, 0
    s_mov_b64 exec, -1
    s_sub_i32 s54, s42, 3075
    v_cmp_le_i32 vcc, s54, v117
    s_mov_b64 exec, vcc
    v_mov_b32 v109, 0
    v_mov_b32 v126, 0
    s_mov_b64 exec, -1
    s_branch L_uback_67
L_ufix_70:
    v_and_b32 v117, 63, v0
    v_lshlrev_b32 v117, 2, v117
    s_sub_i32 s54, s42, 1024
    v_cmp_le_i32 vcc, s54, v117
    s_mov_b64 exec, vcc
    v_mov_b32 v12, 0
    v_mov_b32 v44, 0
    s_mov_b64 exec, -1
    s_sub_i32 s54, s42, 1025
    v_cmp_le_i32 vcc, s54, v117
    s_mov_b64 exec, vcc
    v_mov_b32 v13, 0
    v_mov_b32 v46, 0
    s_mov_b64 exec, -1
    s_sub_i32 s54, s42, 1026
    v_cmp_le_i32 vcc, s54, v117
    s_mov_b64 exec, vcc
    v_mov_b32 v14, 0
    v_mov_b32 v48, 0
    s_mov_b64 exec, -1
    s_sub_i32 s54, s42, 1027
    v_cmp_le_i32 vcc, s54, v117
    s_mov_b64 exec, vcc
    v_mov_b32 v15, 0
    v_mov_b32 v50, 0
    s_mov_b64 exec, -1
    s_branch L_uback_71
L_ufix_72:
    v_and_b32 v117, 63, v0
    v_lshlrev_b32 v117, 2, v117
    s_sub_i32 s54, s42, 1536
    v_cmp_le_i32 vcc, s54, v117
    s_mov_b64 exec, vcc
    v_mov_b32 v16, 0
    v_mov_b32 v52, 0
    s_mov_b64 exec, -1
    s_sub_i32 s54, s42, 1537
    v_cmp_le_i32 vcc, s54, v117
    s_mov_b64 exec, vcc
    v_mov_b32 v17, 0
    v_mov_b32 v54, 0
    s_mov_b64 exec, -1
    s_sub_i32 s54, s42, 1538
    v_cmp_le_i32 vcc, s54, v117
    s_mov_b64 exec, vcc
    v_mov_b32 v18, 0
    v_mov_b32 v56, 0
    s_mov_b64 exec, -1
    s_sub_i32 s54, s42, 1539
    v_cmp_le_i32 vcc, s54, v117
    s_mov_b64 exec, vcc
    v_mov_b32 v19, 0
    v_mov_b32 v58, 0
    s_mov_b64 exec, -1
    s_branch L_uback_73
L_ufix_74:
    v_and_b32 v117, 63, v0
    v_lshlrev_b32 v117, 2, v117
    s_sub_i32 s54, s42, 2048
    v_cmp_le_i32 vcc, s54, v117
    s_mov_b64 exec, vcc
    v_mov_b32 v20, 0
    v_mov_b32 v60, 0
    s_mov_b64 exec, -1
    s_sub_i32 s54, s42, 2049
    v_cmp_le_i32 vcc, s54, v117
    s_mov_b64 exec, vcc
    v_mov_b32 v21, 0
    v_mov_b32 v62, 0
    s_mov_b64 exec, -1
    s_sub_i32 s54, s42, 2050
    v_cmp_le_i32 vcc, s54, v117
    s_mov_b64 exec, vcc
    v_mov_b32 v22, 0
    v_mov_b32 v64, 0
    s_mov_b64 exec, -1
    s_sub_i32 s54, s42, 2051
    v_cmp_le_i32 vcc, s54, v117
    s_mov_b64 exec, vcc
    v_mov_b32 v23, 0
    v_mov_b32 v66, 0
    s_mov_b64 exec, -1
    s_branch L_uback_75
L_ufix_76:
    v_and_b32 v117, 63, v0
    v_lshlrev_b32 v117, 2, v117
    s_sub_i32 s54, s42, 2560
    v_cmp_le_i32 vcc, s54, v117
    s_mov_b64 exec, vcc
    v_mov_b32 v24, 0
    v_mov_b32 v68, 0
    s_mov_b64 exec, -1
    s_sub_i32 s54, s42, 2561
    v_cmp_le_i32 vcc, s54, v117
    s_mov_b64 exec, vcc
    v_mov_b32 v25, 0
    v_mov_b32 v70, 0
    s_mov_b64 exec, -1
    s_sub_i32 s54, s42, 2562
    v_cmp_le_i32 vcc, s54, v117
    s_mov_b64 exec, vcc
    v_mov_b32 v26, 0
    v_mov_b32 v72, 0
    s_mov_b64 exec, -1
    s_sub_i32 s54, s42, 2563
    v_cmp_le_i32 vcc, s54, v117
    s_mov_b64 exec, vcc
    v_mov_b32 v27, 0
    v_mov_b32 v74, 0
    s_mov_b64 exec, -1
    s_branch L_uback_77
L_ufix_78:
    v_and_b32 v117, 63, v0
    v_lshlrev_b32 v117, 2, v117
    s_sub_i32 s54, s42, 0
    v_cmp_le_i32 vcc, s54, v117
    s_mov_b64 exec, vcc
    v_mov_b32 v4, 0
    v_mov_b32 v28, 0
    s_mov_b64 exec, -1
    s_sub_i32 s54, s42, 1
    v_cmp_le_i32 vcc, s54, v117
    s_mov_b64 exec, vcc
    v_mov_b32 v5, 0
    v_mov_b32 v30, 0
    s_mov_b64 exec, -1
    s_sub_i32 s54, s42, 2
    v_cmp_le_i32 vcc, s54, v117
    s_mov_b64 exec, vcc
    v_mov_b32 v6, 0
    v_mov_b32 v32, 0
    s_mov_b64 exec, -1
    s_sub_i32 s54, s42, 3
    v_cmp_le_i32 vcc, s54, v117
    s_mov_b64 exec, vcc
    v_mov_b32 v7, 0
    v_mov_b32 v34, 0
    s_mov_b64 exec, -1
    s_branch L_uback_79
L_ufix_80:
    v_and_b32 v117, 63, v0
    v_lshlrev_b32 v117, 2, v117
    s_sub_i32 s54, s42, 512
    v_cmp_le_i32 vcc, s54, v117
    s_mov_b64 exec, vcc
    v_mov_b32 v8, 0
    v_mov_b32 v36, 0
    s_mov_b64 exec, -1
    s_sub_i32 s54, s42, 513
    v_cmp_le_i32 vcc, s54, v117
    s_mov_b64 exec, vcc
    v_mov_b32 v9, 0
    v_mov_b32 v38, 0
    s_mov_b64 exec, -1
    s_sub_i32 s54, s42, 514
    v_cmp_le_i32 vcc, s54, v117
    s_mov_b64 exec, vcc
    v_mov_b32 v10, 0
    v_mov_b32 v40, 0
    s_mov_b64 exec, -1
    s_sub_i32 s54, s42, 515
    v_cmp_le_i32 vcc, s54, v117
    s_mov_b64 exec, vcc
    v_mov_b32 v11, 0
    v_mov_b32 v42, 0
    s_mov_b64 exec, -1
    s_branch L_uback_81
L_sync_91:
    v_and_b32 v40, 63, v0
    v_lshlrev_b32 v41, 20, v40
    v_mov_b32 v42, s33
    buffer_atomic_add v42, v41, s[80:83], s48 offen sc0
    s_waitcnt vmcnt(0)
    v_readfirstlane_b32 s4, v42
    s_movk_i32 s5, 400
    s_nop 0
    s_add_u32 s4, s4, s33
    s_bitcmp1_b32 s4, 2
    s_cbranch_scc1 L_tell_95
L_poll_93:
    s_sub_u32 s5, s5, 1
    s_cbranch_scc1 L_gave_94
    v_mov_b32 v42, 0
    buffer_atomic_add v42, v41, s[80:83], s48 offen sc0
    s_waitcnt vmcnt(0)
    v_readfirstlane_b32 s4, v42
    s_nop 1
    s_and_b32 s4, s4, 0xff
    s_bitcmp0_b32 s4, 2
    s_cbranch_scc1 L_poll_93
    s_branch L_tell_95
L_gave_94:
    s_cmp_lg_u32 s49, s37
    s_cbranch_scc1 L_gno_97
    v_add_lshl_u32 v40, v40, s28, 4
    s_mov_b32 s5, 0
L_gl_96:
    v_min_u32 v43, 100000, v40
    ds_read_b128 v[44:47], v43 offset:50000
    s_waitcnt lgkmcnt(0)
    buffer_store_dwordx4 v[44:47], v40, s[20:23], 0 offen sc1
    s_waitcnt vmcnt(0)
    v_add_u32 v40, 1024, v40
    s_add_u32 s5, s5, 64
    s_cmp_lt_u32 s5, s29
    s_cbranch_scc1 L_gl_96
L_gno_97:
    s_lshl_b32 s4, 0x100, s37
    v_mov_b32 v42, s4
    buffer_atomic_or v42, v41, s[80:83], s48 offen sc0
    s_waitcnt vmcnt(0)
    v_readfirstlane_b32 s4, v42
    s_nop 1
    s_and_b32 s4, s4, 0xff
    s_bitcmp1_b32 s4, 2
    s_cselect_b32 s4, s4, 0x10000
L_tell_95:
    v_mov_b32 v42, s4
    ds_write_b32 v118, v42
    s_waitcnt lgkmcnt(0)
    s_branch L_bcast_86

L_own_98:
    ds_read_b128 v[36:39], v78 offset:50000
    ds_read_b128 v[52:55], v79 offset:50000
    s_branch L_obk_99

L_own_100:
    ds_read_b128 v[40:43], v78 offset:50000
    ds_read_b128 v[56:59], v79 offset:50000
    s_branch L_obk_101

L_own_102:
    ds_read_b128 v[44:47], v78 offset:50000
    ds_read_b128 v[60:63], v79 offset:50000
    s_branch L_obk_103

L_own_104:
    ds_read_b128 v[48:51], v78 offset:50000
    ds_read_b128 v[64:67], v79 offset:50000
    s_branch L_obk_105

L_fgen_106:
    v_lshlrev_b32 v82, 1, v76
    v_lshlrev_b32 v83, 1, v77
    v_mov_b32 v4, 0
    v_mov_b32 v5, 0
    v_mov_b32 v6, 0
    v_mov_b32 v7, 0
    v_mov_b32 v8, 0
    v_mov_b32 v9, 0
    v_mov_b32 v10, 0
    v_mov_b32 v11, 0
    v_mov_b32 v12, 0
    v_mov_b32 v13, 0
    v_mov_b32 v14, 0
    v_mov_b32 v15, 0
    v_mov_b32 v16, 0
    v_mov_b32 v17, 0
    v_mov_b32 v18, 0
    v_mov_b32 v19, 0
    s_bitcmp1_b32 s35, 4
    s_cbranch_scc1 L_ffl_108
    v_cvt_f32_u32_sdwa v20, v36 dst_sel:DWORD dst_unused:UNUSED_PAD src0_sel:WORD_0
    v_cvt_f32_u32_sdwa v21, v36 dst_sel:DWORD dst_unused:UNUSED_PAD src0_sel:WORD_1
    v_cvt_f32_u32_sdwa v22, v37 dst_sel:DWORD dst_unused:UNUSED_PAD src0_sel:WORD_0
    v_cvt_f32_u32_sdwa v23, v37 dst_sel:DWORD dst_unused:UNUSED_PAD src0_sel:WORD_1
    v_cvt_f32_u32_sdwa v24, v38 dst_sel:DWORD dst_unused:UNUSED_PAD src0_sel:WORD_0
    v_cvt_f32_u32_sdwa v25, v38 dst_sel:DWORD dst_unused:UNUSED_PAD src0_sel:WORD_1
    v_cvt_f32_u32_sdwa v26, v39 dst_sel:DWORD dst_unused:UNUSED_PAD src0_sel:WORD_0
    v_cvt_f32_u32_sdwa v27, v39 dst_sel:DWORD dst_unused:UNUSED_PAD src0_sel:WORD_1
    v_cvt_f32_u32_sdwa v28, v52 dst_sel:DWORD dst_unused:UNUSED_PAD src0_sel:WORD_0
    v_cvt_f32_u32_sdwa v29, v52 dst_sel:DWORD dst_unused:UNUSED_PAD src0_sel:WORD_1
    v_cvt_f32_u32_sdwa v30, v53 dst_sel:DWORD dst_unused:UNUSED_PAD src0_sel:WORD_0
    v_cvt_f32_u32_sdwa v31, v53 dst_sel:DWORD dst_unused:UNUSED_PAD src0_sel:WORD_1
    v_cvt_f32_u32_sdwa v32, v54 dst_sel:DWORD dst_unused:UNUSED_PAD src0_sel:WORD_0
    v_cvt_f32_u32_sdwa v33, v54 dst_sel:DWORD dst_unused:UNUSED_PAD src0_sel:WORD_1
    v_cvt_f32_u32_sdwa v34, v55 dst_sel:DWORD dst_unused:UNUSED_PAD src0_sel:WORD_0
    v_cvt_f32_u32_sdwa v35, v55 dst_sel:DWORD dst_unused:UNUSED_PAD src0_sel:WORD_1
    v_add_f32 v20, 0xc6800000, v20
    v_fmac_f32 v4, s34, v20
    v_add_f32 v21, 0xc6800000, v21
    v_fmac_f32 v5, s34, v21
    v_add_f32 v22, 0xc6800000, v22
    v_fmac_f32 v6, s34, v22
    v_add_f32 v23, 0xc6800000, v23
    v_fmac_f32 v7, s34, v23
    v_add_f32 v24, 0xc6800000, v24
    v_fmac_f32 v8, s34, v24
    v_add_f32 v25, 0xc6800000, v25
    v_fmac_f32 v9, s34, v25
    v_add_f32 v26, 0xc6800000, v26
    v_fmac_f32 v10, s34, v26
    v_add_f32 v27, 0xc6800000, v27
    v_fmac_f32 v11, s34, v27
    v_add_f32 v28, 0xc6800000, v28
    v_fmac_f32 v12, s34, v28
    v_add_f32 v29, 0xc6800000, v29
    v_fmac_f32 v13, s34, v29
    v_add_f32 v30, 0xc6800000, v30
    v_fmac_f32 v14, s34, v30
    v_add_f32 v31, 0xc6800000, v31
    v_fmac_f32 v15, s34, v31
    v_add_f32 v32, 0xc6800000, v32
    v_fmac_f32 v16, s34, v32
    v_add_f32 v33, 0xc6800000, v33
    v_fmac_f32 v17, s34, v33
    v_add_f32 v34, 0xc6800000, v34
    v_fmac_f32 v18, s34, v34
    v_add_f32 v35, 0xc6800000, v35
    v_fmac_f32 v19, s34, v35
    s_branch L_fnx_109
L_ffl_108:
    s_mov_b32 s3, 25600000
    buffer_load_dwordx4 v[20:23], v82, s[84:87], s3 offen offset:0 sc1
    buffer_load_dwordx4 v[24:27], v82, s[84:87], s3 offen offset:16 sc1
    buffer_load_dwordx4 v[28:31], v83, s[84:87], s3 offen offset:0 sc1
    buffer_load_dwordx4 v[32:35], v83, s[84:87], s3 offen offset:16 sc1
    s_waitcnt vmcnt(0)
    v_add_f32 v4, v4, v20
    v_add_f32 v5, v5, v21
    v_add_f32 v6, v6, v22
    v_add_f32 v7, v7, v23
    v_add_f32 v8, v8, v24
    v_add_f32 v9, v9, v25
    v_add_f32 v10, v10, v26
    v_add_f32 v11, v11, v27
    v_add_f32 v12, v12, v28
    v_add_f32 v13, v13, v29
    v_add_f32 v14, v14, v30
    v_add_f32 v15, v15, v31
    v_add_f32 v16, v16, v32
    v_add_f32 v17, v17, v33
    v_add_f32 v18, v18, v34
    v_add_f32 v19, v19, v35
L_fnx_109:
    s_bitcmp1_b32 s35, 5
    s_cbranch_scc1 L_ffl_110
    v_cvt_f32_u32_sdwa v20, v40 dst_sel:DWORD dst_unused:UNUSED_PAD src0_sel:WORD_0
    v_cvt_f32_u32_sdwa v21, v40 dst_sel:DWORD dst_unused:UNUSED_PAD src0_sel:WORD_1
    v_cvt_f32_u32_sdwa v22, v41 dst_sel:DWORD dst_unused:UNUSED_PAD src0_sel:WORD_0
    v_cvt_f32_u32_sdwa v23, v41 dst_sel:DWORD dst_unused:UNUSED_PAD src0_sel:WORD_1
    v_cvt_f32_u32_sdwa v24, v42 dst_sel:DWORD dst_unused:UNUSED_PAD src0_sel:WORD_0
    v_cvt_f32_u32_sdwa v25, v42 dst_sel:DWORD dst_unused:UNUSED_PAD src0_sel:WORD_1
    v_cvt_f32_u32_sdwa v26, v43 dst_sel:DWORD dst_unused:UNUSED_PAD src0_sel:WORD_0
    v_cvt_f32_u32_sdwa v27, v43 dst_sel:DWORD dst_unused:UNUSED_PAD src0_sel:WORD_1
    v_cvt_f32_u32_sdwa v28, v56 dst_sel:DWORD dst_unused:UNUSED_PAD src0_sel:WORD_0
    v_cvt_f32_u32_sdwa v29, v56 dst_sel:DWORD dst_unused:UNUSED_PAD src0_sel:WORD_1
    v_cvt_f32_u32_sdwa v30, v57 dst_sel:DWORD dst_unused:UNUSED_PAD src0_sel:WORD_0
    v_cvt_f32_u32_sdwa v31, v57 dst_sel:DWORD dst_unused:UNUSED_PAD src0_sel:WORD_1
    v_cvt_f32_u32_sdwa v32, v58 dst_sel:DWORD dst_unused:UNUSED_PAD src0_sel:WORD_0
    v_cvt_f32_u32_sdwa v33, v58 dst_sel:DWORD dst_unused:UNUSED_PAD src0_sel:WORD_1
    v_cvt_f32_u32_sdwa v34, v59 dst_sel:DWORD dst_unused:UNUSED_PAD src0_sel:WORD_0
    v_cvt_f32_u32_sdwa v35, v59 dst_sel:DWORD dst_unused:UNUSED_PAD src0_sel:WORD_1
    v_add_f32 v20, 0xc6800000, v20
    v_fmac_f32 v4, s34, v20
    v_add_f32 v21, 0xc6800000, v21
    v_fmac_f32 v5, s34, v21
    v_add_f32 v22, 0xc6800000, v22
    v_fmac_f32 v6, s34, v22
    v_add_f32 v23, 0xc6800000, v23
    v_fmac_f32 v7, s34, v23
    v_add_f32 v24, 0xc6800000, v24
    v_fmac_f32 v8, s34, v24
    v_add_f32 v25, 0xc6800000, v25
    v_fmac_f32 v9, s34, v25
    v_add_f32 v26, 0xc6800000, v26
    v_fmac_f32 v10, s34, v26
    v_add_f32 v27, 0xc6800000, v27
    v_fmac_f32 v11, s34, v27
    v_add_f32 v28, 0xc6800000, v28
    v_fmac_f32 v12, s34, v28
    v_add_f32 v29, 0xc6800000, v29
    v_fmac_f32 v13, s34, v29
    v_add_f32 v30, 0xc6800000, v30
    v_fmac_f32 v14, s34, v30
    v_add_f32 v31, 0xc6800000, v31
    v_fmac_f32 v15, s34, v31
    v_add_f32 v32, 0xc6800000, v32
    v_fmac_f32 v16, s34, v32
    v_add_f32 v33, 0xc6800000, v33
    v_fmac_f32 v17, s34, v33
    v_add_f32 v34, 0xc6800000, v34
    v_fmac_f32 v18, s34, v34
    v_add_f32 v35, 0xc6800000, v35
    v_fmac_f32 v19, s34, v35
    s_branch L_fnx_111
L_ffl_110:
    s_mov_b32 s3, 38400000
    buffer_load_dwordx4 v[20:23], v82, s[84:87], s3 offen offset:0 sc1
    buffer_load_dwordx4 v[24:27], v82, s[84:87], s3 offen offset:16 sc1
    buffer_load_dwordx4 v[28:31], v83, s[84:87], s3 offen offset:0 sc1
    buffer_load_dwordx4 v[32:35], v83, s[84:87], s3 offen offset:16 sc1
    s_waitcnt vmcnt(0)
    v_add_f32 v4, v4, v20
    v_add_f32 v5, v5, v21
    v_add_f32 v6, v6, v22
    v_add_f32 v7, v7, v23
    v_add_f32 v8, v8, v24
    v_add_f32 v9, v9, v25
    v_add_f32 v10, v10, v26
    v_add_f32 v11, v11, v27
    v_add_f32 v12, v12, v28
    v_add_f32 v13, v13, v29
    v_add_f32 v14, v14, v30
    v_add_f32 v15, v15, v31
    v_add_f32 v16, v16, v32
    v_add_f32 v17, v17, v33
    v_add_f32 v18, v18, v34
    v_add_f32 v19, v19, v35
L_fnx_111:
    s_bitcmp1_b32 s35, 6
    s_cbranch_scc1 L_ffl_112
    v_cvt_f32_u32_sdwa v20, v44 dst_sel:DWORD dst_unused:UNUSED_PAD src0_sel:WORD_0
    v_cvt_f32_u32_sdwa v21, v44 dst_sel:DWORD dst_unused:UNUSED_PAD src0_sel:WORD_1
    v_cvt_f32_u32_sdwa v22, v45 dst_sel:DWORD dst_unused:UNUSED_PAD src0_sel:WORD_0
    v_cvt_f32_u32_sdwa v23, v45 dst_sel:DWORD dst_unused:UNUSED_PAD src0_sel:WORD_1
    v_cvt_f32_u32_sdwa v24, v46 dst_sel:DWORD dst_unused:UNUSED_PAD src0_sel:WORD_0
    v_cvt_f32_u32_sdwa v25, v46 dst_sel:DWORD dst_unused:UNUSED_PAD src0_sel:WORD_1
    v_cvt_f32_u32_sdwa v26, v47 dst_sel:DWORD dst_unused:UNUSED_PAD src0_sel:WORD_0
    v_cvt_f32_u32_sdwa v27, v47 dst_sel:DWORD dst_unused:UNUSED_PAD src0_sel:WORD_1
    v_cvt_f32_u32_sdwa v28, v60 dst_sel:DWORD dst_unused:UNUSED_PAD src0_sel:WORD_0
    v_cvt_f32_u32_sdwa v29, v60 dst_sel:DWORD dst_unused:UNUSED_PAD src0_sel:WORD_1
    v_cvt_f32_u32_sdwa v30, v61 dst_sel:DWORD dst_unused:UNUSED_PAD src0_sel:WORD_0
    v_cvt_f32_u32_sdwa v31, v61 dst_sel:DWORD dst_unused:UNUSED_PAD src0_sel:WORD_1
    v_cvt_f32_u32_sdwa v32, v62 dst_sel:DWORD dst_unused:UNUSED_PAD src0_sel:WORD_0
    v_cvt_f32_u32_sdwa v33, v62 dst_sel:DWORD dst_unused:UNUSED_PAD src0_sel:WORD_1
    v_cvt_f32_u32_sdwa v34, v63 dst_sel:DWORD dst_unused:UNUSED_PAD src0_sel:WORD_0
    v_cvt_f32_u32_sdwa v35, v63 dst_sel:DWORD dst_unused:UNUSED_PAD src0_sel:WORD_1
    v_add_f32 v20, 0xc6800000, v20
    v_fmac_f32 v4, s34, v20
    v_add_f32 v21, 0xc6800000, v21
    v_fmac_f32 v5, s34, v21
    v_add_f32 v22, 0xc6800000, v22
    v_fmac_f32 v6, s34, v22
    v_add_f32 v23, 0xc6800000, v23
    v_fmac_f32 v7, s34, v23
    v_add_f32 v24, 0xc6800000, v24
    v_fmac_f32 v8, s34, v24
    v_add_f32 v25, 0xc6800000, v25
    v_fmac_f32 v9, s34, v25
    v_add_f32 v26, 0xc6800000, v26
    v_fmac_f32 v10, s34, v26
    v_add_f32 v27, 0xc6800000, v27
    v_fmac_f32 v11, s34, v27
    v_add_f32 v28, 0xc6800000, v28
    v_fmac_f32 v12, s34, v28
    v_add_f32 v29, 0xc6800000, v29
    v_fmac_f32 v13, s34, v29
    v_add_f32 v30, 0xc6800000, v30
    v_fmac_f32 v14, s34, v30
    v_add_f32 v31, 0xc6800000, v31
    v_fmac_f32 v15, s34, v31
    v_add_f32 v32, 0xc6800000, v32
    v_fmac_f32 v16, s34, v32
    v_add_f32 v33, 0xc6800000, v33
    v_fmac_f32 v17, s34, v33
    v_add_f32 v34, 0xc6800000, v34
    v_fmac_f32 v18, s34, v34
    v_add_f32 v35, 0xc6800000, v35
    v_fmac_f32 v19, s34, v35
    s_branch L_fnx_113
L_ffl_112:
    s_mov_b32 s3, 51200000
    buffer_load_dwordx4 v[20:23], v82, s[84:87], s3 offen offset:0 sc1
    buffer_load_dwordx4 v[24:27], v82, s[84:87], s3 offen offset:16 sc1
    buffer_load_dwordx4 v[28:31], v83, s[84:87], s3 offen offset:0 sc1
    buffer_load_dwordx4 v[32:35], v83, s[84:87], s3 offen offset:16 sc1
    s_waitcnt vmcnt(0)
    v_add_f32 v4, v4, v20
    v_add_f32 v5, v5, v21
    v_add_f32 v6, v6, v22
    v_add_f32 v7, v7, v23
    v_add_f32 v8, v8, v24
    v_add_f32 v9, v9, v25
    v_add_f32 v10, v10, v26
    v_add_f32 v11, v11, v27
    v_add_f32 v12, v12, v28
    v_add_f32 v13, v13, v29
    v_add_f32 v14, v14, v30
    v_add_f32 v15, v15, v31
    v_add_f32 v16, v16, v32
    v_add_f32 v17, v17, v33
    v_add_f32 v18, v18, v34
    v_add_f32 v19, v19, v35
L_fnx_113:
    s_bitcmp1_b32 s35, 7
    s_cbranch_scc1 L_ffl_114
    v_cvt_f32_u32_sdwa v20, v48 dst_sel:DWORD dst_unused:UNUSED_PAD src0_sel:WORD_0
    v_cvt_f32_u32_sdwa v21, v48 dst_sel:DWORD dst_unused:UNUSED_PAD src0_sel:WORD_1
    v_cvt_f32_u32_sdwa v22, v49 dst_sel:DWORD dst_unused:UNUSED_PAD src0_sel:WORD_0
    v_cvt_f32_u32_sdwa v23, v49 dst_sel:DWORD dst_unused:UNUSED_PAD src0_sel:WORD_1
    v_cvt_f32_u32_sdwa v24, v50 dst_sel:DWORD dst_unused:UNUSED_PAD src0_sel:WORD_0
    v_cvt_f32_u32_sdwa v25, v50 dst_sel:DWORD dst_unused:UNUSED_PAD src0_sel:WORD_1
    v_cvt_f32_u32_sdwa v26, v51 dst_sel:DWORD dst_unused:UNUSED_PAD src0_sel:WORD_0
    v_cvt_f32_u32_sdwa v27, v51 dst_sel:DWORD dst_unused:UNUSED_PAD src0_sel:WORD_1
    v_cvt_f32_u32_sdwa v28, v64 dst_sel:DWORD dst_unused:UNUSED_PAD src0_sel:WORD_0
    v_cvt_f32_u32_sdwa v29, v64 dst_sel:DWORD dst_unused:UNUSED_PAD src0_sel:WORD_1
    v_cvt_f32_u32_sdwa v30, v65 dst_sel:DWORD dst_unused:UNUSED_PAD src0_sel:WORD_0
    v_cvt_f32_u32_sdwa v31, v65 dst_sel:DWORD dst_unused:UNUSED_PAD src0_sel:WORD_1
    v_cvt_f32_u32_sdwa v32, v66 dst_sel:DWORD dst_unused:UNUSED_PAD src0_sel:WORD_0
    v_cvt_f32_u32_sdwa v33, v66 dst_sel:DWORD dst_unused:UNUSED_PAD src0_sel:WORD_1
    v_cvt_f32_u32_sdwa v34, v67 dst_sel:DWORD dst_unused:UNUSED_PAD src0_sel:WORD_0
    v_cvt_f32_u32_sdwa v35, v67 dst_sel:DWORD dst_unused:UNUSED_PAD src0_sel:WORD_1
    v_add_f32 v20, 0xc6800000, v20
    v_fmac_f32 v4, s34, v20
    v_add_f32 v21, 0xc6800000, v21
    v_fmac_f32 v5, s34, v21
    v_add_f32 v22, 0xc6800000, v22
    v_fmac_f32 v6, s34, v22
    v_add_f32 v23, 0xc6800000, v23
    v_fmac_f32 v7, s34, v23
    v_add_f32 v24, 0xc6800000, v24
    v_fmac_f32 v8, s34, v24
    v_add_f32 v25, 0xc6800000, v25
    v_fmac_f32 v9, s34, v25
    v_add_f32 v26, 0xc6800000, v26
    v_fmac_f32 v10, s34, v26
    v_add_f32 v27, 0xc6800000, v27
    v_fmac_f32 v11, s34, v27
    v_add_f32 v28, 0xc6800000, v28
    v_fmac_f32 v12, s34, v28
    v_add_f32 v29, 0xc6800000, v29
    v_fmac_f32 v13, s34, v29
    v_add_f32 v30, 0xc6800000, v30
    v_fmac_f32 v14, s34, v30
    v_add_f32 v31, 0xc6800000, v31
    v_fmac_f32 v15, s34, v31
    v_add_f32 v32, 0xc6800000, v32
    v_fmac_f32 v16, s34, v32
    v_add_f32 v33, 0xc6800000, v33
    v_fmac_f32 v17, s34, v33
    v_add_f32 v34, 0xc6800000, v34
    v_fmac_f32 v18, s34, v34
    v_add_f32 v35, 0xc6800000, v35
    v_fmac_f32 v19, s34, v35
    s_branch L_fnx_115
L_ffl_114:
    s_mov_b32 s3, 64000000
    buffer_load_dwordx4 v[20:23], v82, s[84:87], s3 offen offset:0 sc1
    buffer_load_dwordx4 v[24:27], v82, s[84:87], s3 offen offset:16 sc1
    buffer_load_dwordx4 v[28:31], v83, s[84:87], s3 offen offset:0 sc1
    buffer_load_dwordx4 v[32:35], v83, s[84:87], s3 offen offset:16 sc1
    s_waitcnt vmcnt(0)
    v_add_f32 v4, v4, v20
    v_add_f32 v5, v5, v21
    v_add_f32 v6, v6, v22
    v_add_f32 v7, v7, v23
    v_add_f32 v8, v8, v24
    v_add_f32 v9, v9, v25
    v_add_f32 v10, v10, v26
    v_add_f32 v11, v11, v27
    v_add_f32 v12, v12, v28
    v_add_f32 v13, v13, v29
    v_add_f32 v14, v14, v30
    v_add_f32 v15, v15, v31
    v_add_f32 v16, v16, v32
    v_add_f32 v17, v17, v33
    v_add_f32 v18, v18, v34
    v_add_f32 v19, v19, v35
L_fnx_115:
    s_branch L_fbk_107
L_p2slow_48:
    s_waitcnt vmcnt(0) lgkmcnt(0)
    s_mov_b32 s51, 0
    s_movk_i32 s43, 6250
L_sweep_116:
    s_barrier

    v_mov_b32 v28, 0x0
    v_mov_b32 v29, 0x0
    v_mov_b32 v30, 0x0
    v_mov_b32 v31, 0x0
    v_add_u32 v32, 50000, v3
    v_add_u32 v33, 65536, v32

    ds_write_b128 v32, v[28:31] offset:0
    ds_write_b128 v32, v[28:31] offset:16384
    ds_write_b128 v32, v[28:31] offset:32768
    ds_write_b128 v32, v[28:31] offset:49152
    ds_write_b128 v33, v[28:31] offset:0
    ds_write_b128 v33, v[28:31] offset:16384
    v_cmp_gt_u32 vcc, 971, v0
    s_mov_b64 exec, vcc
    ds_write_b128 v33, v[28:31] offset:32768
    s_mov_b64 exec, -1
    s_mov_b32 s3, 32768
    s_load_dword s40, s[6:7], s3
    s_waitcnt lgkmcnt(0)
    s_barrier
    s_cmp_lg_u32 s40, 0
    s_cbranch_scc1 L_raw_121
    s_sub_u32 s38, s4, 8
L_sbatch_117:
    s_lshl_b32 s52, s38, 6
    s_add_u32 s52, s52, s36
    s_lshr_b32 s52, s52, 1
    s_lshl_b32 s52, s52, 2
    s_load_dword s40, s[46:47], s52
    s_mul_i32 s50, s38, 200000
    s_and_b32 s3, s36, 1
    s_lshl_b32 s3, s3, 4
    s_or_b32 s3, s3, 0x100000
    s_waitcnt lgkmcnt(0)
    s_bfe_u32 s40, s40, s3

    s_min_u32 s40, s40, 6524
    s_lshl_b32 s52, s38, 6
    s_add_u32 s52, s52, s36
    s_mul_i32 s52, s52, 32764
    s_and_b32 s52, s52, 0xffffff80
    s_add_u32 s20, s44, s52
    s_addc_u32 s21, s45, 0
    s_mul_i32 s52, s40, 5
    s_add_u32 s52, s52, 3
    s_and_b32 s22, s52, -4

    s_lshr_b32 s55, s39, 2
    s_add_u32 s55, s55, 0
    v_and_b32 v36, 63, v0
    v_add_u32 v36, s55, v36
L_left_122:
    s_cmp_ge_u32 s55, s40
    s_cbranch_scc1 L_leftend_123
    v_mul_u32_u24 v37, 5, v36
    buffer_load_dword v38, v37, s[20:23], 0 offen
    buffer_load_ubyte v39, v37, s[20:23], 0 offen offset:4
    s_waitcnt vmcnt(0)

    v_perm_b32 v37, v39, v38, s24
    v_lshrrev_b32 v42, 30, v38
    v_and_b32 v37, 0x1fff, v37
    v_mul_u32_u24 v42, 6250, v42
    v_add_lshl_u32 v37, v37, v42, 3

    buffer_load_dwordx2 v[40:41], v37, s[8:11], s50 offen
    v_cmp_gt_u32 vcc, s40, v36
    s_waitcnt vmcnt(0)

    v_bfe_u32 v44, v38, 16, 14
    v_subrev_u32 v44, s51, v44
    v_cmp_gt_u32 s[64:65], s43, v44
    s_and_b64 exec, vcc, s[64:65]
    v_lshlrev_b32 v45, 8, v38
    v_cmpx_ne_u32 vcc, 0, v45
    v_lshlrev_b32 v44, 4, v44
    v_bfe_i32 v38, v38, 0, 16
    v_cvt_f32_i32 v38, v38
    v_mul_f32 v38, 0x38004020, v38
    v_lshlrev_b32 v45, 16, v40
    v_and_b32 v46, s32, v40
    v_lshlrev_b32 v47, 16, v41
    v_and_b32 v48, s32, v41

    v_mul_f32 v45, v45, v38
    ds_add_f32 v44, v45 offset:50000
    v_mul_f32 v46, v46, v38
    ds_add_f32 v44, v46 offset:50004
    v_mul_f32 v47, v47, v38
    ds_add_f32 v44, v47 offset:50008
    v_mul_f32 v48, v48, v38
    ds_add_f32 v44, v48 offset:50012
    s_mov_b64 exec, -1
    v_add_u32 v36, 128, v36
    s_add_u32 s55, s55, 128
    s_branch L_left_122
L_leftend_123:

    s_add_u32 s38, s38, 1
    s_cmp_lt_u32 s38, s4
    s_cbranch_scc1 L_sbatch_117
    s_branch L_swend_119

L_raw_121:
    s_load_dwordx2 s[68:69], s[0:1], 8
    s_load_dwordx2 s[72:73], s[0:1], 16
    s_load_dwordx2 s[76:77], s[0:1], 32
    s_load_dwordx2 s[80:81], s[0:1], 48
    s_mov_b32 s70, 204800000
    s_mov_b32 s71, 0x20000
    s_mov_b32 s74, 204800000
    s_mov_b32 s75, 0x20000
    s_mov_b32 s78, 102400000
    s_mov_b32 s79, 0x20000
    s_waitcnt lgkmcnt(0)
    s_load_dword s82, s[80:81], 0
    s_mul_i32 s83, s36, 12500
    s_add_u32 s83, s83, s51
    s_mul_i32 s84, s37, 200000
    s_mov_b32 s85, 200000
    s_mov_b32 s38, 0
    v_lshlrev_b32 v44, 5, v0
    v_mov_b32 v45, 0.15915494
    s_waitcnt lgkmcnt(0)
    s_lshl_b32 s82, s82, 16
    v_mul_f32 v45, s82, v45
L_rawl_118:
    s_lshr_b32 s3, s38, 1
    buffer_load_dwordx4 v[46:49], v44, s[72:75], s38 offen
    buffer_load_dwordx4 v[50:53], v44, s[72:75], s38 offen offset:16
    buffer_load_dwordx4 v[54:57], v44, s[68:71], s38 offen
    buffer_load_dwordx4 v[58:61], v44, s[68:71], s38 offen offset:16
    buffer_load_dwordx4 v[62:65], v3, s[76:79], s3 offen
    s_waitcnt vmcnt(1)

    v_subrev_u32 v46, s83, v46
    v_subrev_u32 v82, s84, v54
    v_cmp_gt_u32 vcc, s43, v46
    v_cmp_gt_u32 s[64:65], s85, v82
    v_lshlrev_b32 v54, 3, v54
    s_nand_b64 exec, vcc, s[64:65]
    v_bfrev_b32 v54, 1
    s_mov_b64 exec, -1
    buffer_load_dwordx2 v[66:67], v54, s[8:11], 0 offen

    v_subrev_u32 v47, s83, v47
    v_subrev_u32 v82, s84, v55
    v_cmp_gt_u32 vcc, s43, v47
    v_cmp_gt_u32 s[64:65], s85, v82
    v_lshlrev_b32 v55, 3, v55
    s_nand_b64 exec, vcc, s[64:65]
    v_bfrev_b32 v55, 1
    s_mov_b64 exec, -1
    buffer_load_dwordx2 v[68:69], v55, s[8:11], 0 offen

    v_subrev_u32 v48, s83, v48
    v_subrev_u32 v82, s84, v56
    v_cmp_gt_u32 vcc, s43, v48
    v_cmp_gt_u32 s[64:65], s85, v82
    v_lshlrev_b32 v56, 3, v56
    s_nand_b64 exec, vcc, s[64:65]
    v_bfrev_b32 v56, 1
    s_mov_b64 exec, -1
    buffer_load_dwordx2 v[70:71], v56, s[8:11], 0 offen

    v_subrev_u32 v49, s83, v49
    v_subrev_u32 v82, s84, v57
    v_cmp_gt_u32 vcc, s43, v49
    v_cmp_gt_u32 s[64:65], s85, v82
    v_lshlrev_b32 v57, 3, v57
    s_nand_b64 exec, vcc, s[64:65]
    v_bfrev_b32 v57, 1
    s_mov_b64 exec, -1
    buffer_load_dwordx2 v[72:73], v57, s[8:11], 0 offen

    v_subrev_u32 v50, s83, v50
    v_subrev_u32 v82, s84, v58
    v_cmp_gt_u32 vcc, s43, v50
    v_cmp_gt_u32 s[64:65], s85, v82
    v_lshlrev_b32 v58, 3, v58
    s_nand_b64 exec, vcc, s[64:65]
    v_bfrev_b32 v58, 1
    s_mov_b64 exec, -1
    buffer_load_dwordx2 v[74:75], v58, s[8:11], 0 offen

    v_subrev_u32 v51, s83, v51
    v_subrev_u32 v82, s84, v59
    v_cmp_gt_u32 vcc, s43, v51
    v_cmp_gt_u32 s[64:65], s85, v82
    v_lshlrev_b32 v59, 3, v59
    s_nand_b64 exec, vcc, s[64:65]
    v_bfrev_b32 v59, 1
    s_mov_b64 exec, -1
    buffer_load_dwordx2 v[76:77], v59, s[8:11], 0 offen

    v_subrev_u32 v52, s83, v52
    v_subrev_u32 v82, s84, v60
    v_cmp_gt_u32 vcc, s43, v52
    v_cmp_gt_u32 s[64:65], s85, v82
    v_lshlrev_b32 v60, 3, v60
    s_nand_b64 exec, vcc, s[64:65]
    v_bfrev_b32 v60, 1
    s_mov_b64 exec, -1
    buffer_load_dwordx2 v[78:79], v60, s[8:11], 0 offen

    v_subrev_u32 v53, s83, v53
    v_subrev_u32 v82, s84, v61
    v_cmp_gt_u32 vcc, s43, v53
    v_cmp_gt_u32 s[64:65], s85, v82
    v_lshlrev_b32 v61, 3, v61
    s_nand_b64 exec, vcc, s[64:65]
    v_bfrev_b32 v61, 1
    s_mov_b64 exec, -1
    buffer_load_dwordx2 v[80:81], v61, s[8:11], 0 offen

    s_waitcnt vmcnt(0)
    v_cmp_le_i32 vcc, 0, v54
    s_mov_b64 exec, vcc
    s_cbranch_execz L_rsk_124
    v_lshlrev_b32 v82, 16, v62
    v_mul_f32 v82, v82, v45
    v_fract_f32 v82, v82
    v_cos_f32 v82, v82
    v_lshlrev_b32 v46, 4, v46
    v_lshlrev_b32 v83, 16, v66
    v_and_b32 v84, s32, v66
    v_lshlrev_b32 v85, 16, v67
    v_and_b32 v86, s32, v67

    v_mul_f32 v83, v83, v82
    ds_add_f32 v46, v83 offset:50000
    v_mul_f32 v84, v84, v82
    ds_add_f32 v46, v84 offset:50004
    v_mul_f32 v85, v85, v82
    ds_add_f32 v46, v85 offset:50008
    v_mul_f32 v86, v86, v82
    ds_add_f32 v46, v86 offset:50012
L_rsk_124:
    s_mov_b64 exec, -1
    v_cmp_le_i32 vcc, 0, v55
    s_mov_b64 exec, vcc
    s_cbranch_execz L_rsk_125
    v_and_b32 v82, s32, v62
    v_mul_f32 v82, v82, v45
    v_fract_f32 v82, v82
    v_cos_f32 v82, v82
    v_lshlrev_b32 v47, 4, v47
    v_lshlrev_b32 v83, 16, v68
    v_and_b32 v84, s32, v68
    v_lshlrev_b32 v85, 16, v69
    v_and_b32 v86, s32, v69

    v_mul_f32 v83, v83, v82
    ds_add_f32 v47, v83 offset:50000
    v_mul_f32 v84, v84, v82
    ds_add_f32 v47, v84 offset:50004
    v_mul_f32 v85, v85, v82
    ds_add_f32 v47, v85 offset:50008
    v_mul_f32 v86, v86, v82
    ds_add_f32 v47, v86 offset:50012
L_rsk_125:
    s_mov_b64 exec, -1
    v_cmp_le_i32 vcc, 0, v56
    s_mov_b64 exec, vcc
    s_cbranch_execz L_rsk_126
    v_lshlrev_b32 v82, 16, v63
    v_mul_f32 v82, v82, v45
    v_fract_f32 v82, v82
    v_cos_f32 v82, v82
    v_lshlrev_b32 v48, 4, v48
    v_lshlrev_b32 v83, 16, v70
    v_and_b32 v84, s32, v70
    v_lshlrev_b32 v85, 16, v71
    v_and_b32 v86, s32, v71

    v_mul_f32 v83, v83, v82
    ds_add_f32 v48, v83 offset:50000
    v_mul_f32 v84, v84, v82
    ds_add_f32 v48, v84 offset:50004
    v_mul_f32 v85, v85, v82
    ds_add_f32 v48, v85 offset:50008
    v_mul_f32 v86, v86, v82
    ds_add_f32 v48, v86 offset:50012
L_rsk_126:
    s_mov_b64 exec, -1
    v_cmp_le_i32 vcc, 0, v57
    s_mov_b64 exec, vcc
    s_cbranch_execz L_rsk_127
    v_and_b32 v82, s32, v63
    v_mul_f32 v82, v82, v45
    v_fract_f32 v82, v82
    v_cos_f32 v82, v82
    v_lshlrev_b32 v49, 4, v49
    v_lshlrev_b32 v83, 16, v72
    v_and_b32 v84, s32, v72
    v_lshlrev_b32 v85, 16, v73
    v_and_b32 v86, s32, v73

    v_mul_f32 v83, v83, v82
    ds_add_f32 v49, v83 offset:50000
    v_mul_f32 v84, v84, v82
    ds_add_f32 v49, v84 offset:50004
    v_mul_f32 v85, v85, v82
    ds_add_f32 v49, v85 offset:50008
    v_mul_f32 v86, v86, v82
    ds_add_f32 v49, v86 offset:50012
L_rsk_127:
    s_mov_b64 exec, -1
    v_cmp_le_i32 vcc, 0, v58
    s_mov_b64 exec, vcc
    s_cbranch_execz L_rsk_128
    v_lshlrev_b32 v82, 16, v64
    v_mul_f32 v82, v82, v45
    v_fract_f32 v82, v82
    v_cos_f32 v82, v82
    v_lshlrev_b32 v50, 4, v50
    v_lshlrev_b32 v83, 16, v74
    v_and_b32 v84, s32, v74
    v_lshlrev_b32 v85, 16, v75
    v_and_b32 v86, s32, v75

    v_mul_f32 v83, v83, v82
    ds_add_f32 v50, v83 offset:50000
    v_mul_f32 v84, v84, v82
    ds_add_f32 v50, v84 offset:50004
    v_mul_f32 v85, v85, v82
    ds_add_f32 v50, v85 offset:50008
    v_mul_f32 v86, v86, v82
    ds_add_f32 v50, v86 offset:50012
L_rsk_128:
    s_mov_b64 exec, -1
    v_cmp_le_i32 vcc, 0, v59
    s_mov_b64 exec, vcc
    s_cbranch_execz L_rsk_129
    v_and_b32 v82, s32, v64
    v_mul_f32 v82, v82, v45
    v_fract_f32 v82, v82
    v_cos_f32 v82, v82
    v_lshlrev_b32 v51, 4, v51
    v_lshlrev_b32 v83, 16, v76
    v_and_b32 v84, s32, v76
    v_lshlrev_b32 v85, 16, v77
    v_and_b32 v86, s32, v77

    v_mul_f32 v83, v83, v82
    ds_add_f32 v51, v83 offset:50000
    v_mul_f32 v84, v84, v82
    ds_add_f32 v51, v84 offset:50004
    v_mul_f32 v85, v85, v82
    ds_add_f32 v51, v85 offset:50008
    v_mul_f32 v86, v86, v82
    ds_add_f32 v51, v86 offset:50012
L_rsk_129:
    s_mov_b64 exec, -1
    v_cmp_le_i32 vcc, 0, v60
    s_mov_b64 exec, vcc
    s_cbranch_execz L_rsk_130
    v_lshlrev_b32 v82, 16, v65
    v_mul_f32 v82, v82, v45
    v_fract_f32 v82, v82
    v_cos_f32 v82, v82
    v_lshlrev_b32 v52, 4, v52
    v_lshlrev_b32 v83, 16, v78
    v_and_b32 v84, s32, v78
    v_lshlrev_b32 v85, 16, v79
    v_and_b32 v86, s32, v79

    v_mul_f32 v83, v83, v82
    ds_add_f32 v52, v83 offset:50000
    v_mul_f32 v84, v84, v82
    ds_add_f32 v52, v84 offset:50004
    v_mul_f32 v85, v85, v82
    ds_add_f32 v52, v85 offset:50008
    v_mul_f32 v86, v86, v82
    ds_add_f32 v52, v86 offset:50012
L_rsk_130:
    s_mov_b64 exec, -1
    v_cmp_le_i32 vcc, 0, v61
    s_mov_b64 exec, vcc
    s_cbranch_execz L_rsk_131
    v_and_b32 v82, s32, v65
    v_mul_f32 v82, v82, v45
    v_fract_f32 v82, v82
    v_cos_f32 v82, v82
    v_lshlrev_b32 v53, 4, v53
    v_lshlrev_b32 v83, 16, v80
    v_and_b32 v84, s32, v80
    v_lshlrev_b32 v85, 16, v81
    v_and_b32 v86, s32, v81

    v_mul_f32 v83, v83, v82
    ds_add_f32 v53, v83 offset:50000
    v_mul_f32 v84, v84, v82
    ds_add_f32 v53, v84 offset:50004
    v_mul_f32 v85, v85, v82
    ds_add_f32 v53, v85 offset:50008
    v_mul_f32 v86, v86, v82
    ds_add_f32 v53, v86 offset:50012
L_rsk_131:
    s_mov_b64 exec, -1
    s_add_u32 s38, s38, 32768
    s_cmp_lt_u32 s38, 204800000
    s_cbranch_scc1 L_rawl_118
L_swend_119:
    s_waitcnt lgkmcnt(0)
    s_barrier
    s_mul_i32 s3, s37, 800000
    s_mul_i32 s5, s36, 12500
    s_add_u32 s3, s3, s5
    s_add_u32 s3, s3, s51
    s_lshl_b32 s3, s3, 4
    s_add_u32 s3, s3, 34496512

    s_add_u32 s20, s6, s3
    s_addc_u32 s21, s7, 0
    s_mov_b32 s22, 100000
    s_mov_b32 s23, 0x20000
    v_mov_b32 v36, v3
    s_mov_b32 s38, 0
L_wl_120:
    v_min_u32 v37, 100000, v36
    ds_read_b128 v[28:31], v37 offset:50000
    s_waitcnt lgkmcnt(0)
    buffer_store_dwordx4 v[28:31], v36, s[20:23], 0 offen sc1
    s_waitcnt vmcnt(0)
    v_add_u32 v36, 16384, v36
    s_add_u32 s38, s38, 1024
    s_cmp_lt_u32 s38, 6250
    s_cbranch_scc1 L_wl_120
    s_add_u32 s51, s51, 6250
    s_cmp_lt_u32 s51, 12500
    s_cbranch_scc1 L_sweep_116
    s_lshl_b32 s33, 16, s37
    s_add_u32 s33, s33, 1
    s_branch L_fin_83

.section .rodata,"a"
.p2align 6
.amdhsa_kernel g1_kernel
  .amdhsa_next_free_vgpr 128
  .amdhsa_next_free_sgpr 102
  .amdhsa_accum_offset 128
  .amdhsa_group_segment_fixed_size 0
  .amdhsa_kernarg_size 112
  .amdhsa_user_sgpr_count 2
  .amdhsa_user_sgpr_kernarg_segment_ptr 1
  .amdhsa_system_sgpr_workgroup_id_x 1
  .amdhsa_float_denorm_mode_32 3
.end_amdhsa_kernel
.p2align 6
.amdhsa_kernel standalone__molecular_angular_gemnet__graph_kernel
  .amdhsa_next_free_vgpr 128
  .amdhsa_next_free_sgpr 102
  .amdhsa_accum_offset 128
  .amdhsa_group_segment_fixed_size 0
  .amdhsa_kernarg_size 112
  .amdhsa_user_sgpr_count 2
  .amdhsa_user_sgpr_kernarg_segment_ptr 1
  .amdhsa_system_sgpr_workgroup_id_x 1
  .amdhsa_float_denorm_mode_32 3
.end_amdhsa_kernel
```

```asm
; @launch kernel=g1_kernel grid=(256,1,1) block=(1024,1,1) lds=163840
; @launch kernel=standalone__molecular_angular_gemnet__graph_kernel grid=(256,1,1) block=(1024,1,1) lds=163840
.amdgcn_target "amdgcn-amd-amdhsa--gfx950"
.text
.globl g1_kernel
.p2align 8
.type g1_kernel,@function
g1_kernel:
    s_cmp_ge_u32 s2, 256
    s_cbranch_scc1 L_p1done_1
    s_load_dwordx4 s[80:83], s[0:1], 8
    s_load_dwordx2 s[84:85], s[0:1], 32
    s_load_dwordx2 s[86:87], s[0:1], 48
    s_load_dwordx4 s[4:7], s[0:1], 96
    s_load_dwordx2 s[78:79], s[0:1], 0
    v_lshlrev_b32 v1, 4, v0
    v_lshlrev_b32 v2, 3, v0
    v_lshlrev_b32 v98, 20, v0
    s_waitcnt lgkmcnt(0)
    s_load_dword s88, s[86:87], 0

    s_mov_b32 s96, s4
    s_mov_b32 s97, s5
    s_mov_b32 s98, 256
    s_mov_b32 s99, 0x20000
    v_readfirstlane_b32 s74, v0
    s_nop 1
    s_or_b32 s74, s74, s2
    s_cbranch_scc1 L_noinit_2

    v_mov_b32 v110, 1
    buffer_atomic_add v110, v98, s[96:99], 0 offen offset:64 sc0
    s_waitcnt vmcnt(0)
    v_readfirstlane_b32 s74, v110
    s_nop 1
    s_cmp_lg_u32 s74, 0
    s_cbranch_scc1 L_zno_4

    s_mov_b32 s92, s6
    s_mov_b32 s93, s7
    s_mov_b32 s94, 32784
    s_mov_b32 s95, 0x20000
    v_mov_b32 v110, 0
    v_mov_b32 v111, 0
    v_mov_b32 v112, 0
    v_mov_b32 v113, 0
L_zl_3:
    buffer_store_dwordx4 v[110:113], v1, s[92:95], s74 offen sc0 sc1
    s_add_u32 s74, s74, 1024
    s_cmp_le_u32 s74, 32768
    s_cbranch_scc1 L_zl_3
    v_mov_b32 v114, 1
    s_waitcnt vmcnt(0)
    buffer_atomic_add v114, v98, s[96:99], 0 offen offset:128
L_zno_4:

L_noinit_2:
    s_mov_b32 s20, s78
    s_mov_b32 s21, s79
    s_mov_b32 s22, 6400000
    s_mov_b32 s23, 0x20000
    v_mul_u32_u24 v110, 6240, v0
    v_and_b32 v111, 63, v0
    v_and_b32 v112, 0x3c0, v0
    v_lshlrev_b32 v111, 2, v111
    v_lshl_or_b32 v111, v112, 4, v111
    v_lshlrev_b32 v100, 2, v0
    s_lshr_b32 s50, s2, 1
    s_and_b32 s53, s2, 1
    s_mul_i32 s3, s50, 50000
    s_mul_i32 s54, s53, 24576
    s_add_u32 s3, s3, s54

    buffer_load_dwordx4 v[56:59], v110, s[20:23], 0 offen
    s_add_u32 s20, s78, s3
    s_addc_u32 s21, s79, 0
    s_mov_b32 s22, 24576
    s_mov_b32 s23, 0x20000
    s_movk_i32 s3, 16384
    buffer_load_dword v44, v111, s[20:23], 0 offen offset:0
    buffer_load_dword v45, v111, s[20:23], 0 offen offset:256
    buffer_load_dword v46, v111, s[20:23], 0 offen offset:512
    buffer_load_dword v47, v111, s[20:23], 0 offen offset:768
    buffer_load_dword v48, v111, s[20:23], s3 offen offset:0
    buffer_load_dword v49, v111, s[20:23], s3 offen offset:256
    buffer_load_dword v50, v111, s[20:23], s3 offen offset:512
    buffer_load_dword v51, v111, s[20:23], s3 offen offset:768
    s_mul_i32 s22, s53, 25424
    s_movk_i32 s3, 24576

    buffer_load_dword v52, v100, s[20:23], s3 offen
    s_mul_i32 s3, s50, 50048
    s_add_u32 s3, s3, s54
    s_add_u32 s54, s3, 2490368

    v_readfirstlane_b32 s74, v0
    s_mov_b32 s55, 0x05040100
    s_nop 0
    s_cmp_lt_u32 s74, 768
    s_cbranch_scc1 L_nogate_5
    s_load_dwordx2 s[92:93], s[0:1], 40
    s_load_dwordx4 s[32:35], s[0:1], 56
    v_mov_b32 v110, 0
    s_waitcnt lgkmcnt(0)
    global_load_dwordx4 v[60:63], v110, s[92:93]

    global_load_dwordx4 v[64:67], v110, s[32:33] offset:0
    global_load_dwordx4 v[80:83], v110, s[34:35] offset:0
    global_load_dwordx4 v[68:71], v110, s[32:33] offset:16
    global_load_dwordx4 v[84:87], v110, s[34:35] offset:16
    global_load_dwordx4 v[72:75], v110, s[32:33] offset:32
    global_load_dwordx4 v[88:91], v110, s[34:35] offset:32
    global_load_dwordx4 v[76:79], v110, s[32:33] offset:48
    global_load_dwordx4 v[92:95], v110, s[34:35] offset:48
    s_lshl_b32 s74, s2, 8
    v_and_b32 v111, 255, v0
    v_add_u32 v111, s74, v111
    v_lshlrev_b32 v112, 16, v111
    v_lshlrev_b32 v111, 5, v111
    s_mov_b32 s75, 0x07060302
    s_waitcnt vmcnt(0)

    v_lshlrev_b32 v118, 16, v60
    v_and_b32 v119, 0xffff0000, v60
    v_lshlrev_b32 v120, 16, v61
    v_and_b32 v121, 0xffff0000, v61
    v_lshlrev_b32 v122, 16, v62
    v_and_b32 v123, 0xffff0000, v62
    v_lshlrev_b32 v124, 16, v63
    v_and_b32 v125, 0xffff0000, v63
    v_sub_f32 v118, v112, v118
    v_sub_f32 v119, v112, v119
    v_sub_f32 v120, v112, v120
    v_sub_f32 v121, v112, v121
    v_sub_f32 v122, v112, v122
    v_sub_f32 v123, v112, v123
    v_sub_f32 v124, v112, v124
    v_sub_f32 v125, v112, v125
    v_cvt_pk_bf16_f32 v118, v118, v119
    v_cvt_pk_bf16_f32 v120, v120, v121
    v_cvt_pk_bf16_f32 v122, v122, v123
    v_cvt_pk_bf16_f32 v124, v124, v125
    v_and_b32 v119, 0xffff0000, v118
    v_lshlrev_b32 v118, 16, v118
    v_and_b32 v121, 0xffff0000, v120
    v_lshlrev_b32 v120, 16, v120
    v_and_b32 v123, 0xffff0000, v122
    v_lshlrev_b32 v122, 16, v122
    v_and_b32 v125, 0xffff0000, v124
    v_lshlrev_b32 v124, 16, v124
    v_mul_f32 v118, v118, v118
    v_mul_f32 v119, v119, v119
    v_mul_f32 v120, v120, v120
    v_mul_f32 v121, v121, v121
    v_mul_f32 v122, v122, v122
    v_mul_f32 v123, v123, v123
    v_mul_f32 v124, v124, v124
    v_mul_f32 v125, v125, v125
    v_cvt_pk_bf16_f32 v118, v118, v119
    v_cvt_pk_bf16_f32 v120, v120, v121
    v_cvt_pk_bf16_f32 v122, v122, v123
    v_cvt_pk_bf16_f32 v124, v124, v125
    v_and_b32 v119, 0xffff0000, v118
    v_lshlrev_b32 v118, 16, v118
    v_and_b32 v121, 0xffff0000, v120
    v_lshlrev_b32 v120, 16, v120
    v_and_b32 v123, 0xffff0000, v122
    v_lshlrev_b32 v122, 16, v122
    v_and_b32 v125, 0xffff0000, v124
    v_lshlrev_b32 v124, 16, v124
    v_mul_f32 v118, 0xc1200000, v118
    v_mul_f32 v119, 0xc1200000, v119
    v_mul_f32 v120, 0xc1200000, v120
    v_mul_f32 v121, 0xc1200000, v121
    v_mul_f32 v122, 0xc1200000, v122
    v_mul_f32 v123, 0xc1200000, v123
    v_mul_f32 v124, 0xc1200000, v124
    v_mul_f32 v125, 0xc1200000, v125
    v_cvt_pk_bf16_f32 v118, v118, v119
    v_cvt_pk_bf16_f32 v120, v120, v121
    v_cvt_pk_bf16_f32 v122, v122, v123
    v_cvt_pk_bf16_f32 v124, v124, v125
    v_and_b32 v119, 0xffff0000, v118
    v_lshlrev_b32 v118, 16, v118
    v_and_b32 v121, 0xffff0000, v120
    v_lshlrev_b32 v120, 16, v120
    v_and_b32 v123, 0xffff0000, v122
    v_lshlrev_b32 v122, 16, v122
    v_and_b32 v125, 0xffff0000, v124
    v_lshlrev_b32 v124, 16, v124
    v_mul_f32 v118, 0x3fb8aa3b, v118
    v_mul_f32 v119, 0x3fb8aa3b, v119
    v_mul_f32 v120, 0x3fb8aa3b, v120
    v_mul_f32 v121, 0x3fb8aa3b, v121
    v_mul_f32 v122, 0x3fb8aa3b, v122
    v_mul_f32 v123, 0x3fb8aa3b, v123
    v_mul_f32 v124, 0x3fb8aa3b, v124
    v_mul_f32 v125, 0x3fb8aa3b, v125
    v_exp_f32 v118, v118
    v_exp_f32 v119, v119
    v_exp_f32 v120, v120
    v_exp_f32 v121, v121
    v_exp_f32 v122, v122
    v_exp_f32 v123, v123
    v_exp_f32 v124, v124
    v_exp_f32 v125, v125
    s_nop 0
    v_cvt_pk_bf16_f32 v118, v118, v119
    v_cvt_pk_bf16_f32 v120, v120, v121
    v_cvt_pk_bf16_f32 v122, v122, v123
    v_cvt_pk_bf16_f32 v124, v124, v125
    v_perm_b32 v113, v66, v64, s55
    v_dot2_f32_bf16 v114, v118, v113, 0

    v_perm_b32 v113, v66, v64, s75
    v_dot2_f32_bf16 v115, v118, v113, 0

    v_perm_b32 v113, v67, v65, s55
    v_dot2_f32_bf16 v116, v118, v113, 0

    v_perm_b32 v113, v67, v65, s75
    v_dot2_f32_bf16 v117, v118, v113, 0

    v_perm_b32 v113, v70, v68, s55
    v_dot2_f32_bf16 v114, v120, v113, v114

    v_perm_b32 v113, v70, v68, s75
    v_dot2_f32_bf16 v115, v120, v113, v115

    v_perm_b32 v113, v71, v69, s55
    v_dot2_f32_bf16 v116, v120, v113, v116

    v_perm_b32 v113, v71, v69, s75
    v_dot2_f32_bf16 v117, v120, v113, v117

    v_perm_b32 v113, v74, v72, s55
    v_dot2_f32_bf16 v114, v122, v113, v114

    v_perm_b32 v113, v74, v72, s75
    v_dot2_f32_bf16 v115, v122, v113, v115

    v_perm_b32 v113, v75, v73, s55
    v_dot2_f32_bf16 v116, v122, v113, v116

    v_perm_b32 v113, v75, v73, s75
    v_dot2_f32_bf16 v117, v122, v113, v117

    v_perm_b32 v113, v78, v76, s55
    v_dot2_f32_bf16 v114, v124, v113, v114

    v_perm_b32 v113, v78, v76, s75
    v_dot2_f32_bf16 v115, v124, v113, v115

    v_perm_b32 v113, v79, v77, s55
    v_dot2_f32_bf16 v116, v124, v113, v116

    v_perm_b32 v113, v79, v77, s75
    v_dot2_f32_bf16 v117, v124, v113, v117

    v_perm_b32 v113, v82, v80, s55
    v_dot2_f32_bf16 v60, v118, v113, 0

    v_perm_b32 v113, v82, v80, s75
    v_dot2_f32_bf16 v61, v118, v113, 0

    v_perm_b32 v113, v83, v81, s55
    v_dot2_f32_bf16 v62, v118, v113, 0

    v_perm_b32 v113, v83, v81, s75
    v_dot2_f32_bf16 v63, v118, v113, 0

    v_perm_b32 v113, v86, v84, s55
    v_dot2_f32_bf16 v60, v120, v113, v60

    v_perm_b32 v113, v86, v84, s75
    v_dot2_f32_bf16 v61, v120, v113, v61

    v_perm_b32 v113, v87, v85, s55
    v_dot2_f32_bf16 v62, v120, v113, v62

    v_perm_b32 v113, v87, v85, s75
    v_dot2_f32_bf16 v63, v120, v113, v63

    v_perm_b32 v113, v90, v88, s55
    v_dot2_f32_bf16 v60, v122, v113, v60

    v_perm_b32 v113, v90, v88, s75
    v_dot2_f32_bf16 v61, v122, v113, v61

    v_perm_b32 v113, v91, v89, s55
    v_dot2_f32_bf16 v62, v122, v113, v62

    v_perm_b32 v113, v91, v89, s75
    v_dot2_f32_bf16 v63, v122, v113, v63

    v_perm_b32 v113, v94, v92, s55
    v_dot2_f32_bf16 v60, v124, v113, v60

    v_perm_b32 v113, v94, v92, s75
    v_dot2_f32_bf16 v61, v124, v113, v61

    v_perm_b32 v113, v95, v93, s55
    v_dot2_f32_bf16 v62, v124, v113, v62

    v_perm_b32 v113, v95, v93, s75
    v_dot2_f32_bf16 v63, v124, v113, v63

    s_add_u32 s92, s6, 393216
    s_addc_u32 s93, s7, 0
    s_mov_b32 s94, 2097152
    s_mov_b32 s95, 0x20000
    v_cvt_pk_bf16_f32 v114, v114, v115
    v_cvt_pk_bf16_f32 v115, v116, v117
    buffer_store_dwordx4 v[60:63], v111, s[92:95], 0 offen
    buffer_store_dwordx2 v[114:115], v111, s[92:95], 0 offen offset:16
    s_nop 1
L_nogate_5:

    s_mov_b32 s8, s80
    s_mov_b32 s9, s81
    s_mov_b32 s10, 0
    s_mov_b32 s11, 0x20000
    s_mov_b32 s12, s82
    s_mov_b32 s13, s83
    s_mov_b32 s14, 0
    s_mov_b32 s15, 0x20000
    s_mov_b32 s16, s84
    s_mov_b32 s17, s85
    s_mov_b32 s18, 0
    s_mov_b32 s19, 0x20000
    s_lshr_b32 s74, s2, 1
    s_and_b32 s74, s74, 28
    s_lshr_b32 s86, 0x00102010, s74
    s_lshr_b32 s87, 0x44414241, s74
    s_lshr_b32 s41, 0x43221100, s74
    s_and_b32 s86, s86, 15
    s_and_b32 s87, s87, 15
    s_and_b32 s41, s41, 15
    s_lshr_b32 s74, s2, 6
    s_lshl_b32 s74, s74, 3
    s_and_b32 s75, s2, 7
    s_add_u32 s74, s74, s75
    s_mul_i32 s74, s74, 5
    s_add_u32 s41, s41, s74

    s_mul_i32 s78, s41, 16384
    s_add_u32 s49, s78, 16384
    s_cmp_ge_u32 s41, 3125
    s_cmovk_i32 s49, 0
    s_cmovk_i32 s78, 0
    s_lshl_b32 s10, s49, 2
    s_lshl_b32 s14, s49, 2
    s_lshl_b32 s18, s49, 1
    s_sub_u32 s79, s87, s86
    s_bfm_b32 s85, s79, s86
    s_lshl_b32 s86, s86, 12
    s_lshl_b32 s87, s87, 12
    s_min_u32 s87, s87, 16384

    s_add_u32 s79, s78, 0
    s_bitcmp1_b32 s85, 0
    s_cselect_b32 s79, s79, 0x1ff00000
    s_lshl_b32 s56, s79, 2
    s_lshl_b32 s61, s79, 1

    s_add_u32 s79, s78, 4096
    s_bitcmp1_b32 s85, 1
    s_cselect_b32 s79, s79, 0x1ff00000
    s_lshl_b32 s57, s79, 2
    s_lshl_b32 s62, s79, 1

    s_add_u32 s79, s78, 8192
    s_bitcmp1_b32 s85, 2
    s_cselect_b32 s79, s79, 0x1ff00000
    s_lshl_b32 s58, s79, 2
    s_lshl_b32 s63, s79, 1

    s_add_u32 s79, s78, 12288
    s_bitcmp1_b32 s85, 3
    s_cselect_b32 s79, s79, 0x1ff00000
    s_lshl_b32 s59, s79, 2
    s_lshl_b32 s64, s79, 1

    s_mov_b32 s82, s85
    s_mov_b32 s83, s86
    s_mov_b32 s84, s87
    s_add_u32 s41, s2, 160
    s_mul_i32 s74, s41, 16384
    s_mov_b32 s10, 204800000
    s_mov_b32 s14, 204800000
    s_mov_b32 s18, 102400000

    s_add_u32 s75, s74, 0
    s_lshl_b32 s76, s75, 2
    s_lshl_b32 s75, s75, 1
    s_bitcmp1_b32 s82, 0
    s_cselect_b32 s56, s56, s76
    s_cselect_b32 s61, s61, s75

    s_add_u32 s75, s74, 4096
    s_lshl_b32 s76, s75, 2
    s_lshl_b32 s75, s75, 1
    s_bitcmp1_b32 s82, 1
    s_cselect_b32 s57, s57, s76
    s_cselect_b32 s62, s62, s75

    s_add_u32 s75, s74, 8192
    s_lshl_b32 s76, s75, 2
    s_lshl_b32 s75, s75, 1
    s_bitcmp1_b32 s82, 2
    s_cselect_b32 s58, s58, s76
    s_cselect_b32 s63, s63, s75

    s_add_u32 s75, s74, 12288
    s_lshl_b32 s76, s75, 2
    s_lshl_b32 s75, s75, 1
    s_bitcmp1_b32 s82, 3
    s_cselect_b32 s59, s59, s76
    s_cselect_b32 s64, s64, s75

    buffer_load_dwordx4 v[20:23], v1, s[12:15], s56 offen nt
    buffer_load_dwordx4 v[4:7], v1, s[8:11], s56 offen nt
    buffer_load_dwordx2 v[36:37], v2, s[16:19], s61 offen nt
    buffer_load_dwordx4 v[24:27], v1, s[12:15], s57 offen nt
    buffer_load_dwordx4 v[8:11], v1, s[8:11], s57 offen nt
    buffer_load_dwordx2 v[38:39], v2, s[16:19], s62 offen nt
    buffer_load_dwordx4 v[28:31], v1, s[12:15], s58 offen nt
    buffer_load_dwordx4 v[12:15], v1, s[8:11], s58 offen nt
    buffer_load_dwordx2 v[40:41], v2, s[16:19], s63 offen nt
    buffer_load_dwordx4 v[32:35], v1, s[12:15], s59 offen nt
    buffer_load_dwordx4 v[16:19], v1, s[8:11], s59 offen nt
    buffer_load_dwordx2 v[42:43], v2, s[16:19], s64 offen nt
    s_mov_b32 s86, 0
    s_mov_b32 s87, 4
    s_mul_i32 s78, s41, 16384
    s_add_u32 s49, s78, 16384
    s_cmp_ge_u32 s41, 3125
    s_cmovk_i32 s49, 0
    s_cmovk_i32 s78, 0
    s_lshl_b32 s10, s49, 2
    s_lshl_b32 s14, s49, 2
    s_lshl_b32 s18, s49, 1
    s_sub_u32 s79, s87, s86
    s_bfm_b32 s85, s79, s86
    s_lshl_b32 s86, s86, 12
    s_lshl_b32 s87, s87, 12
    s_min_u32 s87, s87, 16384

    s_add_u32 s79, s78, 0
    s_bitcmp1_b32 s85, 0
    s_cselect_b32 s79, s79, 0x1ff00000
    s_lshl_b32 s56, s79, 2
    s_lshl_b32 s61, s79, 1

    s_add_u32 s79, s78, 4096
    s_bitcmp1_b32 s85, 1
    s_cselect_b32 s79, s79, 0x1ff00000
    s_lshl_b32 s57, s79, 2
    s_lshl_b32 s62, s79, 1

    s_add_u32 s79, s78, 8192
    s_bitcmp1_b32 s85, 2
    s_cselect_b32 s79, s79, 0x1ff00000
    s_lshl_b32 s58, s79, 2
    s_lshl_b32 s63, s79, 1

    s_add_u32 s79, s78, 12288
    s_bitcmp1_b32 s85, 3
    s_cselect_b32 s79, s79, 0x1ff00000
    s_lshl_b32 s59, s79, 2
    s_lshl_b32 s64, s79, 1

    s_getreg_b32 s5, hwreg(HW_REG_XCC_ID)
    s_and_b32 s5, s5, 7
    s_mul_i32 s3, s5, 4096

    s_add_u32 s20, s6, s3
    s_addc_u32 s21, s7, 0
    s_mov_b32 s22, 4096
    s_mov_b32 s23, 0x20000
    s_mul_i32 s3, s5, 67117056
    s_add_u32 s3, s3, 85721088
    s_add_u32 s24, s6, s3
    s_addc_u32 s25, s7, 0
    s_mov_b32 s26, 67117056
    s_mov_b32 s27, 0x20000
    s_add_u32 s36, s6, 32768
    s_addc_u32 s37, s7, 0
    s_mov_b32 s38, 4
    s_mov_b32 s39, 0x20000
    s_mov_b32 s40, 687195
    s_mov_b32 s42, -6250
    s_mov_b32 s43, 1942
    s_mov_b32 s45, 0x06050400
    s_mov_b32 s46, 0x05040c00
    s_mov_b32 s48, 6524
    s_mov_b32 s50, 0
    v_mov_b32 v104, 1
    v_mov_b32 v105, 0x46ff8000
    s_mov_b32 s55, 0x05040100
    v_mul_u32_u24 v106, 5, v0

    v_and_b32 v102, 15, v0
    v_lshrrev_b32 v103, 4, v0
    v_lshl_add_u32 v102, v102, 7, v103
    v_mul_u32_u24 v102, 32764, v102
    v_add_u32 v103, 2096896, v102

    v_and_b32 v102, 0xffffff80, v102
    v_and_b32 v103, 0xffffff80, v103
    v_mov_b32 v108, 24576
    v_mov_b32 v114, 0
    v_mov_b32 v115, 0
    v_mov_b32 v116, 0
    v_mov_b32 v117, -1
    ds_write_b64 v2, v[114:115]
    s_movk_i32 s3, 1024
    v_cmp_gt_u32 s[66:67], s3, v0
    s_movk_i32 s3, 1024
    v_cmp_gt_u32 s[68:69], s3, v0
    s_mov_b64 exec, 1
    ds_write_b128 v108, v[114:117]
    s_mov_b64 exec, -1
    s_waitcnt lgkmcnt(0)
    s_lshl_b32 s88, s88, 16
    v_mov_b32 v110, 0.15915494
    v_mul_f32 v110, s88, v110
    s_mov_b32 s3, 0x7fff7fff
    v_readfirstlane_b32 s44, v110

    s_waitcnt vmcnt(12)
    v_mov_b32 v61, 0
    v_mov_b32 v62, 0
    v_mov_b32 v63, 0
    v_dot2_f32_bf16 v61, v44, v44, v61
    v_dot2_f32_bf16 v61, v45, v45, v61
    v_dot2_f32_bf16 v61, v46, v46, v61
    v_dot2_f32_bf16 v61, v47, v47, v61
    v_dot2_f32_bf16 v61, v48, v48, v61
    v_dot2_f32_bf16 v61, v49, v49, v61
    v_dot2_f32_bf16 v61, v50, v50, v61
    v_dot2_f32_bf16 v61, v51, v51, v61
    v_dot2_f32_bf16 v61, v52, v52, v61
    v_dot2_f32_bf16 v62, v56, v56, v62
    v_dot2_f32_bf16 v62, v57, v57, v62
    v_dot2_f32_bf16 v62, v58, v58, v62
    v_dot2_f32_bf16 v62, v59, v59, v62
    v_and_b32 v60, s3, v44
    v_and_b32 v64, s3, v45
    v_pk_max_u16 v60, v60, v64
    v_and_b32 v64, s3, v46
    v_pk_max_u16 v60, v60, v64
    v_and_b32 v64, s3, v47
    v_pk_max_u16 v60, v60, v64
    v_and_b32 v64, s3, v48
    v_pk_max_u16 v60, v60, v64
    v_and_b32 v64, s3, v49
    v_pk_max_u16 v60, v60, v64
    v_and_b32 v64, s3, v50
    v_pk_max_u16 v60, v60, v64
    v_and_b32 v64, s3, v51
    v_pk_max_u16 v60, v60, v64
    v_and_b32 v64, s3, v52
    v_pk_max_u16 v60, v60, v64
    v_lshrrev_b32 v64, 16, v60
    v_and_b32 v60, 0xffff, v60
    v_max_u32 v60, v60, v64

    s_nop 1
    v_max_u32_dpp v60, v60, v60 row_shr:1 row_mask:0xf bank_mask:0xf
    s_nop 1
    v_max_u32_dpp v60, v60, v60 row_shr:2 row_mask:0xf bank_mask:0xf
    s_nop 1
    v_max_u32_dpp v60, v60, v60 row_shr:4 row_mask:0xf bank_mask:0xf
    s_nop 1
    v_max_u32_dpp v60, v60, v60 row_shr:8 row_mask:0xf bank_mask:0xf
    s_nop 1
    v_max_u32_dpp v60, v60, v60 row_bcast:15 row_mask:0xa bank_mask:0xf
    s_nop 1
    v_max_u32_dpp v60, v60, v60 row_bcast:31 row_mask:0xc bank_mask:0xf
    s_nop 1
    v_add_f32_dpp v61, v61, v61 row_shr:1 row_mask:0xf bank_mask:0xf
    s_nop 1
    v_add_f32_dpp v61, v61, v61 row_shr:2 row_mask:0xf bank_mask:0xf
    s_nop 1
    v_add_f32_dpp v61, v61, v61 row_shr:4 row_mask:0xf bank_mask:0xf
    s_nop 1
    v_add_f32_dpp v61, v61, v61 row_shr:8 row_mask:0xf bank_mask:0xf
    s_nop 1
    v_add_f32_dpp v61, v61, v61 row_bcast:15 row_mask:0xa bank_mask:0xf
    s_nop 1
    v_add_f32_dpp v61, v61, v61 row_bcast:31 row_mask:0xc bank_mask:0xf
    s_nop 1
    v_add_f32_dpp v62, v62, v62 row_shr:1 row_mask:0xf bank_mask:0xf
    s_nop 1
    v_add_f32_dpp v62, v62, v62 row_shr:2 row_mask:0xf bank_mask:0xf
    s_nop 1
    v_add_f32_dpp v62, v62, v62 row_shr:4 row_mask:0xf bank_mask:0xf
    s_nop 1
    v_add_f32_dpp v62, v62, v62 row_shr:8 row_mask:0xf bank_mask:0xf
    s_nop 1
    v_add_f32_dpp v62, v62, v62 row_bcast:15 row_mask:0xa bank_mask:0xf
    s_nop 1
    v_add_f32_dpp v62, v62, v62 row_bcast:31 row_mask:0xc bank_mask:0xf
    v_lshrrev_b32 v64, 6, v0
    v_lshlrev_b32 v64, 4, v64
    s_mov_b32 exec_lo, 0
    s_brev_b32 exec_hi, 1
    ds_write_b128 v64, v[60:63] offset:16384
    s_mov_b64 exec, -1
    v_and_b32 v64, 15, v0
    v_lshlrev_b32 v64, 4, v64
    s_waitcnt lgkmcnt(0)
    s_barrier
    ds_read_b128 v[60:63], v64 offset:16384
    s_waitcnt lgkmcnt(0)

    s_nop 0
    v_max_u32_dpp v60, v60, v60 row_ror:1 row_mask:0xf bank_mask:0xf
    v_add_f32_dpp v61, v61, v61 row_ror:1 row_mask:0xf bank_mask:0xf
    v_add_f32_dpp v62, v62, v62 row_ror:1 row_mask:0xf bank_mask:0xf

    s_nop 0
    v_max_u32_dpp v60, v60, v60 row_ror:2 row_mask:0xf bank_mask:0xf
    v_add_f32_dpp v61, v61, v61 row_ror:2 row_mask:0xf bank_mask:0xf
    v_add_f32_dpp v62, v62, v62 row_ror:2 row_mask:0xf bank_mask:0xf

    s_nop 0
    v_max_u32_dpp v60, v60, v60 row_ror:4 row_mask:0xf bank_mask:0xf
    v_add_f32_dpp v61, v61, v61 row_ror:4 row_mask:0xf bank_mask:0xf
    v_add_f32_dpp v62, v62, v62 row_ror:4 row_mask:0xf bank_mask:0xf

    s_nop 0
    v_max_u32_dpp v60, v60, v60 row_ror:8 row_mask:0xf bank_mask:0xf
    v_add_f32_dpp v61, v61, v61 row_ror:8 row_mask:0xf bank_mask:0xf
    v_add_f32_dpp v62, v62, v62 row_ror:8 row_mask:0xf bank_mask:0xf

    v_rsq_f32 v62, v62
    v_mov_b32 v65, 0x4b400000
    v_mul_f32 v62, 0x47decb04, v62
    s_nop 0
    v_readfirstlane_b32 s74, v62

    s_add_u32 s92, s6, 135168
    s_addc_u32 s93, s7, 0
    s_mov_b32 s94, 4096
    s_mov_b32 s95, 0x20000
    s_lshl_b32 s3, s2, 4
    buffer_store_dwordx4 v[60:63], v98, s[92:95], s3 offen
    v_lshlrev_b32 v66, 16, v44
    v_and_b32 v44, 0xffff0000, v44
    v_fma_f32 v66, v66, s74, v65
    v_fma_f32 v44, v44, s74, v65
    v_perm_b32 v44, v44, v66, s55

    v_lshlrev_b32 v66, 16, v45
    v_and_b32 v45, 0xffff0000, v45
    v_fma_f32 v66, v66, s74, v65
    v_fma_f32 v45, v45, s74, v65
    v_perm_b32 v45, v45, v66, s55

    v_lshlrev_b32 v66, 16, v46
    v_and_b32 v46, 0xffff0000, v46
    v_fma_f32 v66, v66, s74, v65
    v_fma_f32 v46, v46, s74, v65
    v_perm_b32 v46, v46, v66, s55

    v_lshlrev_b32 v66, 16, v47
    v_and_b32 v47, 0xffff0000, v47
    v_fma_f32 v66, v66, s74, v65
    v_fma_f32 v47, v47, s74, v65
    v_perm_b32 v47, v47, v66, s55

    v_lshlrev_b32 v66, 16, v48
    v_and_b32 v48, 0xffff0000, v48
    v_fma_f32 v66, v66, s74, v65
    v_fma_f32 v48, v48, s74, v65
    v_perm_b32 v48, v48, v66, s55

    v_lshlrev_b32 v66, 16, v49
    v_and_b32 v49, 0xffff0000, v49
    v_fma_f32 v66, v66, s74, v65
    v_fma_f32 v49, v49, s74, v65
    v_perm_b32 v49, v49, v66, s55

    v_lshlrev_b32 v66, 16, v50
    v_and_b32 v50, 0xffff0000, v50
    v_fma_f32 v66, v66, s74, v65
    v_fma_f32 v50, v50, s74, v65
    v_perm_b32 v50, v50, v66, s55

    v_lshlrev_b32 v66, 16, v51
    v_and_b32 v51, 0xffff0000, v51
    v_fma_f32 v66, v66, s74, v65
    v_fma_f32 v51, v51, s74, v65
    v_perm_b32 v51, v51, v66, s55

    v_lshlrev_b32 v66, 16, v52
    v_and_b32 v52, 0xffff0000, v52
    v_fma_f32 v66, v66, s74, v65
    v_fma_f32 v52, v52, s74, v65
    v_perm_b32 v52, v52, v66, s55

    s_add_u32 s92, s6, s54
    s_addc_u32 s93, s7, 0
    s_mov_b32 s94, 24576
    s_mov_b32 s95, 0x20000
    s_movk_i32 s3, 16384
    buffer_store_dwordx4 v[44:47], v1, s[92:95], 0 offen
    buffer_store_dwordx4 v[48:51], v1, s[92:95], s3 offen
    s_mul_i32 s94, s53, 25424
    s_movk_i32 s3, 24576

    buffer_store_dword v52, v100, s[92:95], s3 offen
    s_nop 1
    v_mov_b32 v100, 0
    buffer_atomic_add v100, v98, s[96:99], 0 offen offset:128 sc0
    s_bitcmp0_b32 s82, 0
    s_cbranch_scc1 L_ska_8
    s_waitcnt vmcnt(14)
    v_mul_hi_u32_u24 v45, s40, v20
    v_mul_hi_u32_u24 v44, s40, v4
    v_mul_hi_u32_u24 v47, s40, v21
    v_mul_hi_u32_u24 v46, s40, v5
    v_mul_hi_u32_u24 v49, s40, v22
    v_mul_hi_u32_u24 v48, s40, v6
    v_mul_hi_u32_u24 v51, s40, v23
    v_mul_hi_u32_u24 v50, s40, v7
    v_and_b32 v45, -2, v45
    v_mad_u32_u24 v4, v44, s43, v4
    v_and_b32 v76, -4, v44
    v_and_b32 v47, -2, v47
    v_mad_u32_u24 v5, v46, s43, v5
    v_and_b32 v77, -4, v46
    v_and_b32 v49, -2, v49
    v_mad_u32_u24 v6, v48, s43, v6
    v_and_b32 v78, -4, v48
    v_and_b32 v51, -2, v51
    v_mad_u32_u24 v7, v50, s43, v7
    v_and_b32 v79, -4, v50
    v_mad_i32_i24 v20, v45, s42, v20
    v_lshl_add_u32 v45, v45, 6, v76
    v_mad_i32_i24 v21, v47, s42, v21
    v_lshl_add_u32 v47, v47, 6, v77
    v_mad_i32_i24 v22, v49, s42, v22
    v_lshl_add_u32 v49, v49, 6, v78
    v_mad_i32_i24 v23, v51, s42, v23
    v_lshl_add_u32 v51, v51, 6, v79
    ds_add_rtn_u32 v76, v45, v104
    ds_add_rtn_u32 v77, v47, v104
    ds_add_rtn_u32 v78, v49, v104
    ds_add_rtn_u32 v79, v51, v104
    v_lshlrev_b32 v110, 16, v36
    v_and_b32 v111, 0xffff0000, v36
    v_lshlrev_b32 v112, 16, v37
    v_and_b32 v113, 0xffff0000, v37
    v_mul_f32 v110, s44, v110
    v_mul_f32 v111, s44, v111
    v_mul_f32 v112, s44, v112
    v_mul_f32 v113, s44, v113
    v_fract_f32 v110, v110
    v_fract_f32 v111, v111
    v_fract_f32 v112, v112
    v_fract_f32 v113, v113
    v_cos_f32 v110, v110
    v_cos_f32 v111, v111
    v_cos_f32 v112, v112
    v_cos_f32 v113, v113
    v_lshl_or_b32 v44, v44, 14, v20
    v_perm_b32 v45, v45, v4, s46
    v_bfe_u32 v4, v4, 8, 5

    v_lshl_or_b32 v46, v46, 14, v21
    v_perm_b32 v47, v47, v5, s46
    v_bfe_u32 v5, v5, 8, 5

    v_lshl_or_b32 v48, v48, 14, v22
    v_perm_b32 v49, v49, v6, s46
    v_bfe_u32 v6, v6, 8, 5

    v_lshl_or_b32 v50, v50, 14, v23
    v_perm_b32 v51, v51, v7, s46
    v_bfe_u32 v7, v7, 8, 5

    v_fmaak_f32 v110, v110, v105, 0x4b400010
    v_fmaak_f32 v111, v111, v105, 0x4b400010
    v_fmaak_f32 v112, v112, v105, 0x4b400010
    v_fmaak_f32 v113, v113, v105, 0x4b400010
    v_sub_u32 v110, v110, v4
    v_sub_u32 v111, v111, v5
    v_sub_u32 v112, v112, v6
    v_sub_u32 v113, v113, v7
    v_bfi_b32 v110, 31, v4, v110
    v_bfi_b32 v111, 31, v5, v111
    v_bfi_b32 v112, 31, v6, v112
    v_bfi_b32 v113, 31, v7, v113
    v_perm_b32 v44, v44, v110, s55
    v_perm_b32 v46, v46, v111, s55
    v_perm_b32 v48, v48, v112, s55
    v_perm_b32 v50, v50, v113, s55
    buffer_load_dwordx4 v[20:23], v1, s[12:15], s56 offen nt
    buffer_load_dwordx4 v[4:7], v1, s[8:11], s56 offen nt
    buffer_load_dwordx2 v[36:37], v2, s[16:19], s61 offen nt
L_bka_9:
    s_bitcmp0_b32 s82, 1
    s_cbranch_scc1 L_ska_10
    s_waitcnt vmcnt(14)
    v_mul_hi_u32_u24 v53, s40, v24
    v_mul_hi_u32_u24 v52, s40, v8
    v_mul_hi_u32_u24 v55, s40, v25
    v_mul_hi_u32_u24 v54, s40, v9
    v_mul_hi_u32_u24 v57, s40, v26
    v_mul_hi_u32_u24 v56, s40, v10
    v_mul_hi_u32_u24 v59, s40, v27
    v_mul_hi_u32_u24 v58, s40, v11
    v_and_b32 v53, -2, v53
    v_mad_u32_u24 v8, v52, s43, v8
    v_and_b32 v80, -4, v52
    v_and_b32 v55, -2, v55
    v_mad_u32_u24 v9, v54, s43, v9
    v_and_b32 v81, -4, v54
    v_and_b32 v57, -2, v57
    v_mad_u32_u24 v10, v56, s43, v10
    v_and_b32 v82, -4, v56
    v_and_b32 v59, -2, v59
    v_mad_u32_u24 v11, v58, s43, v11
    v_and_b32 v83, -4, v58
    v_mad_i32_i24 v24, v53, s42, v24
    v_lshl_add_u32 v53, v53, 6, v80
    v_mad_i32_i24 v25, v55, s42, v25
    v_lshl_add_u32 v55, v55, 6, v81
    v_mad_i32_i24 v26, v57, s42, v26
    v_lshl_add_u32 v57, v57, 6, v82
    v_mad_i32_i24 v27, v59, s42, v27
    v_lshl_add_u32 v59, v59, 6, v83
    ds_add_rtn_u32 v80, v53, v104
    ds_add_rtn_u32 v81, v55, v104
    ds_add_rtn_u32 v82, v57, v104
    ds_add_rtn_u32 v83, v59, v104
    v_lshlrev_b32 v110, 16, v38
    v_and_b32 v111, 0xffff0000, v38
    v_lshlrev_b32 v112, 16, v39
    v_and_b32 v113, 0xffff0000, v39
    v_mul_f32 v110, s44, v110
    v_mul_f32 v111, s44, v111
    v_mul_f32 v112, s44, v112
    v_mul_f32 v113, s44, v113
    v_fract_f32 v110, v110
    v_fract_f32 v111, v111
    v_fract_f32 v112, v112
    v_fract_f32 v113, v113
    v_cos_f32 v110, v110
    v_cos_f32 v111, v111
    v_cos_f32 v112, v112
    v_cos_f32 v113, v113
    v_lshl_or_b32 v52, v52, 14, v24
    v_perm_b32 v53, v53, v8, s46
    v_bfe_u32 v8, v8, 8, 5

    v_lshl_or_b32 v54, v54, 14, v25
    v_perm_b32 v55, v55, v9, s46
    v_bfe_u32 v9, v9, 8, 5

    v_lshl_or_b32 v56, v56, 14, v26
    v_perm_b32 v57, v57, v10, s46
    v_bfe_u32 v10, v10, 8, 5

    v_lshl_or_b32 v58, v58, 14, v27
    v_perm_b32 v59, v59, v11, s46
    v_bfe_u32 v11, v11, 8, 5

    v_fmaak_f32 v110, v110, v105, 0x4b400010
    v_fmaak_f32 v111, v111, v105, 0x4b400010
    v_fmaak_f32 v112, v112, v105, 0x4b400010
    v_fmaak_f32 v113, v113, v105, 0x4b400010
    v_sub_u32 v110, v110, v8
    v_sub_u32 v111, v111, v9
    v_sub_u32 v112, v112, v10
    v_sub_u32 v113, v113, v11
    v_bfi_b32 v110, 31, v8, v110
    v_bfi_b32 v111, 31, v9, v111
    v_bfi_b32 v112, 31, v10, v112
    v_bfi_b32 v113, 31, v11, v113
    v_perm_b32 v52, v52, v110, s55
    v_perm_b32 v54, v54, v111, s55
    v_perm_b32 v56, v56, v112, s55
    v_perm_b32 v58, v58, v113, s55
    buffer_load_dwordx4 v[24:27], v1, s[12:15], s57 offen nt
    buffer_load_dwordx4 v[8:11], v1, s[8:11], s57 offen nt
    buffer_load_dwordx2 v[38:39], v2, s[16:19], s62 offen nt
L_bka_11:
    s_bitcmp0_b32 s82, 2
    s_cbranch_scc1 L_ska_12
    s_waitcnt vmcnt(14)
    v_mul_hi_u32_u24 v61, s40, v28
    v_mul_hi_u32_u24 v60, s40, v12
    v_mul_hi_u32_u24 v63, s40, v29
    v_mul_hi_u32_u24 v62, s40, v13
    v_mul_hi_u32_u24 v65, s40, v30
    v_mul_hi_u32_u24 v64, s40, v14
    v_mul_hi_u32_u24 v67, s40, v31
    v_mul_hi_u32_u24 v66, s40, v15
    v_and_b32 v61, -2, v61
    v_mad_u32_u24 v12, v60, s43, v12
    v_and_b32 v84, -4, v60
    v_and_b32 v63, -2, v63
    v_mad_u32_u24 v13, v62, s43, v13
    v_and_b32 v85, -4, v62
    v_and_b32 v65, -2, v65
    v_mad_u32_u24 v14, v64, s43, v14
    v_and_b32 v86, -4, v64
    v_and_b32 v67, -2, v67
    v_mad_u32_u24 v15, v66, s43, v15
    v_and_b32 v87, -4, v66
    v_mad_i32_i24 v28, v61, s42, v28
    v_lshl_add_u32 v61, v61, 6, v84
    v_mad_i32_i24 v29, v63, s42, v29
    v_lshl_add_u32 v63, v63, 6, v85
    v_mad_i32_i24 v30, v65, s42, v30
    v_lshl_add_u32 v65, v65, 6, v86
    v_mad_i32_i24 v31, v67, s42, v31
    v_lshl_add_u32 v67, v67, 6, v87
    ds_add_rtn_u32 v84, v61, v104
    ds_add_rtn_u32 v85, v63, v104
    ds_add_rtn_u32 v86, v65, v104
    ds_add_rtn_u32 v87, v67, v104
    v_lshlrev_b32 v110, 16, v40
    v_and_b32 v111, 0xffff0000, v40
    v_lshlrev_b32 v112, 16, v41
    v_and_b32 v113, 0xffff0000, v41
    v_mul_f32 v110, s44, v110
    v_mul_f32 v111, s44, v111
    v_mul_f32 v112, s44, v112
    v_mul_f32 v113, s44, v113
    v_fract_f32 v110, v110
    v_fract_f32 v111, v111
    v_fract_f32 v112, v112
    v_fract_f32 v113, v113
    v_cos_f32 v110, v110
    v_cos_f32 v111, v111
    v_cos_f32 v112, v112
    v_cos_f32 v113, v113
    v_lshl_or_b32 v60, v60, 14, v28
    v_perm_b32 v61, v61, v12, s46
    v_bfe_u32 v12, v12, 8, 5

    v_lshl_or_b32 v62, v62, 14, v29
    v_perm_b32 v63, v63, v13, s46
    v_bfe_u32 v13, v13, 8, 5

    v_lshl_or_b32 v64, v64, 14, v30
    v_perm_b32 v65, v65, v14, s46
    v_bfe_u32 v14, v14, 8, 5

    v_lshl_or_b32 v66, v66, 14, v31
    v_perm_b32 v67, v67, v15, s46
    v_bfe_u32 v15, v15, 8, 5

    v_fmaak_f32 v110, v110, v105, 0x4b400010
    v_fmaak_f32 v111, v111, v105, 0x4b400010
    v_fmaak_f32 v112, v112, v105, 0x4b400010
    v_fmaak_f32 v113, v113, v105, 0x4b400010
    v_sub_u32 v110, v110, v12
    v_sub_u32 v111, v111, v13
    v_sub_u32 v112, v112, v14
    v_sub_u32 v113, v113, v15
    v_bfi_b32 v110, 31, v12, v110
    v_bfi_b32 v111, 31, v13, v111
    v_bfi_b32 v112, 31, v14, v112
    v_bfi_b32 v113, 31, v15, v113
    v_perm_b32 v60, v60, v110, s55
    v_perm_b32 v62, v62, v111, s55
    v_perm_b32 v64, v64, v112, s55
    v_perm_b32 v66, v66, v113, s55
    buffer_load_dwordx4 v[28:31], v1, s[12:15], s58 offen nt
    buffer_load_dwordx4 v[12:15], v1, s[8:11], s58 offen nt
    buffer_load_dwordx2 v[40:41], v2, s[16:19], s63 offen nt
L_bka_13:
    s_bitcmp0_b32 s82, 3
    s_cbranch_scc1 L_ska_14
    s_waitcnt vmcnt(14)
    s_mov_b64 exec, s[66:67]
    v_mul_hi_u32_u24 v69, s40, v32
    v_mul_hi_u32_u24 v68, s40, v16
    v_mul_hi_u32_u24 v71, s40, v33
    v_mul_hi_u32_u24 v70, s40, v17
    v_mul_hi_u32_u24 v73, s40, v34
    v_mul_hi_u32_u24 v72, s40, v18
    v_mul_hi_u32_u24 v75, s40, v35
    v_mul_hi_u32_u24 v74, s40, v19
    v_and_b32 v69, -2, v69
    v_mad_u32_u24 v16, v68, s43, v16
    v_and_b32 v88, -4, v68
    v_and_b32 v71, -2, v71
    v_mad_u32_u24 v17, v70, s43, v17
    v_and_b32 v89, -4, v70
    v_and_b32 v73, -2, v73
    v_mad_u32_u24 v18, v72, s43, v18
    v_and_b32 v90, -4, v72
    v_and_b32 v75, -2, v75
    v_mad_u32_u24 v19, v74, s43, v19
    v_and_b32 v91, -4, v74
    v_mad_i32_i24 v32, v69, s42, v32
    v_lshl_add_u32 v69, v69, 6, v88
    v_mad_i32_i24 v33, v71, s42, v33
    v_lshl_add_u32 v71, v71, 6, v89
    v_mad_i32_i24 v34, v73, s42, v34
    v_lshl_add_u32 v73, v73, 6, v90
    v_mad_i32_i24 v35, v75, s42, v35
    v_lshl_add_u32 v75, v75, 6, v91
    ds_add_rtn_u32 v88, v69, v104
    ds_add_rtn_u32 v89, v71, v104
    ds_add_rtn_u32 v90, v73, v104
    ds_add_rtn_u32 v91, v75, v104
    v_lshlrev_b32 v110, 16, v42
    v_and_b32 v111, 0xffff0000, v42
    v_lshlrev_b32 v112, 16, v43
    v_and_b32 v113, 0xffff0000, v43
    v_mul_f32 v110, s44, v110
    v_mul_f32 v111, s44, v111
    v_mul_f32 v112, s44, v112
    v_mul_f32 v113, s44, v113
    v_fract_f32 v110, v110
    v_fract_f32 v111, v111
    v_fract_f32 v112, v112
    v_fract_f32 v113, v113
    v_cos_f32 v110, v110
    v_cos_f32 v111, v111
    v_cos_f32 v112, v112
    v_cos_f32 v113, v113
    v_lshl_or_b32 v68, v68, 14, v32
    v_perm_b32 v69, v69, v16, s46
    v_bfe_u32 v16, v16, 8, 5

    v_lshl_or_b32 v70, v70, 14, v33
    v_perm_b32 v71, v71, v17, s46
    v_bfe_u32 v17, v17, 8, 5

    v_lshl_or_b32 v72, v72, 14, v34
    v_perm_b32 v73, v73, v18, s46
    v_bfe_u32 v18, v18, 8, 5

    v_lshl_or_b32 v74, v74, 14, v35
    v_perm_b32 v75, v75, v19, s46
    v_bfe_u32 v19, v19, 8, 5

    v_fmaak_f32 v110, v110, v105, 0x4b400010
    v_fmaak_f32 v111, v111, v105, 0x4b400010
    v_fmaak_f32 v112, v112, v105, 0x4b400010
    v_fmaak_f32 v113, v113, v105, 0x4b400010
    v_sub_u32 v110, v110, v16
    v_sub_u32 v111, v111, v17
    v_sub_u32 v112, v112, v18
    v_sub_u32 v113, v113, v19
    v_bfi_b32 v110, 31, v16, v110
    v_bfi_b32 v111, 31, v17, v111
    v_bfi_b32 v112, 31, v18, v112
    v_bfi_b32 v113, 31, v19, v113
    v_perm_b32 v68, v68, v110, s55
    v_perm_b32 v70, v70, v111, s55
    v_perm_b32 v72, v72, v112, s55
    v_perm_b32 v74, v74, v113, s55
    s_mov_b64 exec, -1
    buffer_load_dwordx4 v[32:35], v1, s[12:15], s59 offen nt
    buffer_load_dwordx4 v[16:19], v1, s[8:11], s59 offen nt
    buffer_load_dwordx2 v[42:43], v2, s[16:19], s64 offen nt
L_bka_15:
    v_readfirstlane_b32 s74, v0
    s_nop 1
    s_cmp_lg_u32 s74, 0
    s_cbranch_scc1 L_ready_17

    s_waitcnt vmcnt(12)
    v_readfirstlane_b32 s74, v100
    s_nop 1
    s_cmp_lg_u32 s74, 0
    s_cbranch_scc1 L_ready_17

    v_mov_b32 v110, 1
    buffer_atomic_add v110, v98, s[96:99], 0 offen offset:64 sc0
    s_waitcnt vmcnt(0)
    v_readfirstlane_b32 s74, v110
    s_nop 1
    s_cmp_lg_u32 s74, 0
    s_cbranch_scc1 L_zno_19

    s_mov_b32 s92, s6
    s_mov_b32 s93, s7
    s_mov_b32 s94, 32784
    s_mov_b32 s95, 0x20000
    v_mov_b32 v110, 0
    v_mov_b32 v111, 0
    v_mov_b32 v112, 0
    v_mov_b32 v113, 0
L_zl_18:
    buffer_store_dwordx4 v[110:113], v1, s[92:95], s74 offen sc0 sc1
    s_add_u32 s74, s74, 1024
    s_cmp_le_u32 s74, 32768
    s_cbranch_scc1 L_zl_18
    v_mov_b32 v114, 1
    s_waitcnt vmcnt(0)
    buffer_atomic_add v114, v98, s[96:99], 0 offen offset:128
L_zno_19:

L_spin_16:
    v_mov_b32 v100, 0
    buffer_atomic_add v100, v98, s[96:99], 0 offen offset:128 sc0
    s_waitcnt vmcnt(0)
    v_readfirstlane_b32 s74, v100
    s_nop 1
    s_cmp_eq_u32 s74, 0
    s_cbranch_scc1 L_spin_16
L_ready_17:

    s_waitcnt lgkmcnt(0)
    s_barrier

    ds_read_b64 v[94:95], v2
    s_waitcnt lgkmcnt(0)
    v_add_u32 v97, v94, v95
    s_nop 1
    v_add_u32_dpp v97, v97, v97 row_shr:1 row_mask:0xf bank_mask:0xf
    s_nop 1
    v_add_u32_dpp v97, v97, v97 row_shr:2 row_mask:0xf bank_mask:0xf
    s_nop 1
    v_add_u32_dpp v97, v97, v97 row_shr:4 row_mask:0xf bank_mask:0xf
    s_nop 1
    v_add_u32_dpp v97, v97, v97 row_shr:8 row_mask:0xf bank_mask:0xf
    s_nop 1
    v_add_u32_dpp v97, v97, v97 row_bcast:15 row_mask:0xa bank_mask:0xf
    s_nop 1
    v_add_u32_dpp v97, v97, v97 row_bcast:31 row_mask:0xc bank_mask:0xf
    s_mov_b32 exec_lo, 0
    s_brev_b32 exec_hi, 1
    ds_add_rtn_u32 v96, v108, v97
    s_mov_b64 exec, -1

    v_add_u32 v92, v94, v94
    v_add_u32 v93, v95, v95
    v_med3_u32 v92, v94, 2, v92
    v_med3_u32 v93, v95, 2, v93
    v_lshl_or_b32 v92, v93, 16, v92
    v_lshlrev_b32 v93, 2, v0
    buffer_atomic_add v92, v93, s[20:23], 0 offen sc0
    s_waitcnt lgkmcnt(0)
    v_readlane_b32 s77, v96, 63
    v_sub_u32 v97, v97, v95
    s_sub_u32 s50, s50, s83
    s_sub_u32 s77, s77, s50
    v_add_u32 v97, s77, v97
    v_sub_u32 v96, v97, v94
    v_lshlrev_b32 v111, 3, v97
    v_lshlrev_b32 v110, 3, v96
    v_mov_b32 v112, 0
    v_mov_b32 v113, 0
    ds_write_b64 v2, v[110:111] offset:8192
    ds_write_b64 v2, v[112:113]
    v_mad_i32_i24 v96, v96, -5, v102
    v_mad_i32_i24 v97, v97, -5, v103
    s_add_u32 s50, s50, s84
    s_mov_b32 s28, s82
    s_mov_b32 s29, s83
    s_mov_b32 s30, s84
    s_lshl_b32 s74, s29, 3
    s_lshl_b32 s75, s30, 3
    v_mov_b32 v125, s74
    v_mov_b32 v126, s75
    v_mov_b32 v127, -1

    s_waitcnt lgkmcnt(0)
    s_barrier

    s_mov_b64 exec, 1
    ds_write_b32 v125, v127 offset:24588
    ds_write_b32 v126, v127 offset:24596
    s_mov_b64 exec, -1

    s_bitcmp0_b32 s28, 0
    s_cbranch_scc1 L_skz_20
    v_lshrrev_b32 v110, 16, v45
    ds_read_b32 v110, v110 offset:8192
    v_lshrrev_b32 v111, 16, v47
    ds_read_b32 v111, v111 offset:8192
    v_lshrrev_b32 v112, 16, v49
    ds_read_b32 v112, v112 offset:8192
    v_lshrrev_b32 v113, 16, v51
    ds_read_b32 v113, v113 offset:8192
    s_waitcnt lgkmcnt(3)
    v_lshl_add_u32 v110, v76, 3, v110
    ds_write_b64 v110, v[44:45] offset:24592

    s_waitcnt lgkmcnt(3)
    v_lshl_add_u32 v111, v77, 3, v111
    ds_write_b64 v111, v[46:47] offset:24592

    s_waitcnt lgkmcnt(3)
    v_lshl_add_u32 v112, v78, 3, v112
    ds_write_b64 v112, v[48:49] offset:24592

    s_waitcnt lgkmcnt(3)
    v_lshl_add_u32 v113, v79, 3, v113
    ds_write_b64 v113, v[50:51] offset:24592

L_skz_20:
    s_bitcmp0_b32 s28, 1
    s_cbranch_scc1 L_skz_21
    v_lshrrev_b32 v110, 16, v53
    ds_read_b32 v110, v110 offset:8192
    v_lshrrev_b32 v111, 16, v55
    ds_read_b32 v111, v111 offset:8192
    v_lshrrev_b32 v112, 16, v57
    ds_read_b32 v112, v112 offset:8192
    v_lshrrev_b32 v113, 16, v59
    ds_read_b32 v113, v113 offset:8192
    s_waitcnt lgkmcnt(3)
    v_lshl_add_u32 v110, v80, 3, v110
    ds_write_b64 v110, v[52:53] offset:24592

    s_waitcnt lgkmcnt(3)
    v_lshl_add_u32 v111, v81, 3, v111
    ds_write_b64 v111, v[54:55] offset:24592

    s_waitcnt lgkmcnt(3)
    v_lshl_add_u32 v112, v82, 3, v112
    ds_write_b64 v112, v[56:57] offset:24592

    s_waitcnt lgkmcnt(3)
    v_lshl_add_u32 v113, v83, 3, v113
    ds_write_b64 v113, v[58:59] offset:24592

L_skz_21:
    s_bitcmp0_b32 s28, 2
    s_cbranch_scc1 L_skz_22
    v_lshrrev_b32 v110, 16, v61
    ds_read_b32 v110, v110 offset:8192
    v_lshrrev_b32 v111, 16, v63
    ds_read_b32 v111, v111 offset:8192
    v_lshrrev_b32 v112, 16, v65
    ds_read_b32 v112, v112 offset:8192
    v_lshrrev_b32 v113, 16, v67
    ds_read_b32 v113, v113 offset:8192
    s_waitcnt lgkmcnt(3)
    v_lshl_add_u32 v110, v84, 3, v110
    ds_write_b64 v110, v[60:61] offset:24592

    s_waitcnt lgkmcnt(3)
    v_lshl_add_u32 v111, v85, 3, v111
    ds_write_b64 v111, v[62:63] offset:24592

    s_waitcnt lgkmcnt(3)
    v_lshl_add_u32 v112, v86, 3, v112
    ds_write_b64 v112, v[64:65] offset:24592

    s_waitcnt lgkmcnt(3)
    v_lshl_add_u32 v113, v87, 3, v113
    ds_write_b64 v113, v[66:67] offset:24592

L_skz_22:
    s_bitcmp0_b32 s28, 3
    s_cbranch_scc1 L_skz_23
    s_mov_b64 exec, s[66:67]
    v_lshrrev_b32 v110, 16, v69
    ds_read_b32 v110, v110 offset:8192
    v_lshrrev_b32 v111, 16, v71
    ds_read_b32 v111, v111 offset:8192
    v_lshrrev_b32 v112, 16, v73
    ds_read_b32 v112, v112 offset:8192
    v_lshrrev_b32 v113, 16, v75
    ds_read_b32 v113, v113 offset:8192
    s_waitcnt lgkmcnt(3)
    v_lshl_add_u32 v110, v88, 3, v110
    ds_write_b64 v110, v[68:69] offset:24592

    s_waitcnt lgkmcnt(3)
    v_lshl_add_u32 v111, v89, 3, v111
    ds_write_b64 v111, v[70:71] offset:24592

    s_waitcnt lgkmcnt(3)
    v_lshl_add_u32 v112, v90, 3, v112
    ds_write_b64 v112, v[72:73] offset:24592

    s_waitcnt lgkmcnt(3)
    v_lshl_add_u32 v113, v91, 3, v113
    ds_write_b64 v113, v[74:75] offset:24592

    s_mov_b64 exec, -1
L_skz_23:
    s_cmp_eq_u32 s49, 0
    s_cbranch_scc1 L_p1epi_7
L_p1loop_6:
    s_mov_b32 s82, s85
    s_mov_b32 s83, s86
    s_mov_b32 s84, s87
    v_mov_b32 v99, 1
    buffer_atomic_add v99, v98, s[96:99], 0 offen sc0
    s_bitcmp0_b32 s82, 0
    s_cbranch_scc1 L_ska_24
    s_waitcnt vmcnt(11)
    v_mul_hi_u32_u24 v45, s40, v20
    v_mul_hi_u32_u24 v44, s40, v4
    v_mul_hi_u32_u24 v47, s40, v21
    v_mul_hi_u32_u24 v46, s40, v5
    v_mul_hi_u32_u24 v49, s40, v22
    v_mul_hi_u32_u24 v48, s40, v6
    v_mul_hi_u32_u24 v51, s40, v23
    v_mul_hi_u32_u24 v50, s40, v7
    v_and_b32 v45, -2, v45
    v_mad_u32_u24 v4, v44, s43, v4
    v_and_b32 v76, -4, v44
    v_and_b32 v47, -2, v47
    v_mad_u32_u24 v5, v46, s43, v5
    v_and_b32 v77, -4, v46
    v_and_b32 v49, -2, v49
    v_mad_u32_u24 v6, v48, s43, v6
    v_and_b32 v78, -4, v48
    v_and_b32 v51, -2, v51
    v_mad_u32_u24 v7, v50, s43, v7
    v_and_b32 v79, -4, v50
    v_mad_i32_i24 v20, v45, s42, v20
    v_lshl_add_u32 v45, v45, 6, v76
    v_mad_i32_i24 v21, v47, s42, v21
    v_lshl_add_u32 v47, v47, 6, v77
    v_mad_i32_i24 v22, v49, s42, v22
    v_lshl_add_u32 v49, v49, 6, v78
    v_mad_i32_i24 v23, v51, s42, v23
    v_lshl_add_u32 v51, v51, 6, v79
    ds_add_rtn_u32 v76, v45, v104
    ds_add_rtn_u32 v77, v47, v104
    ds_add_rtn_u32 v78, v49, v104
    ds_add_rtn_u32 v79, v51, v104
    v_lshlrev_b32 v110, 16, v36
    v_and_b32 v111, 0xffff0000, v36
    v_lshlrev_b32 v112, 16, v37
    v_and_b32 v113, 0xffff0000, v37
    v_mul_f32 v110, s44, v110
    v_mul_f32 v111, s44, v111
    v_mul_f32 v112, s44, v112
    v_mul_f32 v113, s44, v113
    v_fract_f32 v110, v110
    v_fract_f32 v111, v111
    v_fract_f32 v112, v112
    v_fract_f32 v113, v113
    v_cos_f32 v110, v110
    v_cos_f32 v111, v111
    v_cos_f32 v112, v112
    v_cos_f32 v113, v113
    v_lshl_or_b32 v44, v44, 14, v20
    v_perm_b32 v45, v45, v4, s46
    v_bfe_u32 v4, v4, 8, 5

    v_lshl_or_b32 v46, v46, 14, v21
    v_perm_b32 v47, v47, v5, s46
    v_bfe_u32 v5, v5, 8, 5

    v_lshl_or_b32 v48, v48, 14, v22
    v_perm_b32 v49, v49, v6, s46
    v_bfe_u32 v6, v6, 8, 5

    v_lshl_or_b32 v50, v50, 14, v23
    v_perm_b32 v51, v51, v7, s46
    v_bfe_u32 v7, v7, 8, 5

    v_fmaak_f32 v110, v110, v105, 0x4b400010
    v_fmaak_f32 v111, v111, v105, 0x4b400010
    v_fmaak_f32 v112, v112, v105, 0x4b400010
    v_fmaak_f32 v113, v113, v105, 0x4b400010
    v_sub_u32 v110, v110, v4
    v_sub_u32 v111, v111, v5
    v_sub_u32 v112, v112, v6
    v_sub_u32 v113, v113, v7
    v_bfi_b32 v110, 31, v4, v110
    v_bfi_b32 v111, 31, v5, v111
    v_bfi_b32 v112, 31, v6, v112
    v_bfi_b32 v113, 31, v7, v113
    v_perm_b32 v44, v44, v110, s55
    v_perm_b32 v46, v46, v111, s55
    v_perm_b32 v48, v48, v112, s55
    v_perm_b32 v50, v50, v113, s55
L_ska_24:
    s_bitcmp0_b32 s82, 1
    s_cbranch_scc1 L_ska_25
    s_waitcnt vmcnt(8)
    v_mul_hi_u32_u24 v53, s40, v24
    v_mul_hi_u32_u24 v52, s40, v8
    v_mul_hi_u32_u24 v55, s40, v25
    v_mul_hi_u32_u24 v54, s40, v9
    v_mul_hi_u32_u24 v57, s40, v26
    v_mul_hi_u32_u24 v56, s40, v10
    v_mul_hi_u32_u24 v59, s40, v27
    v_mul_hi_u32_u24 v58, s40, v11
    v_and_b32 v53, -2, v53
    v_mad_u32_u24 v8, v52, s43, v8
    v_and_b32 v80, -4, v52
    v_and_b32 v55, -2, v55
    v_mad_u32_u24 v9, v54, s43, v9
    v_and_b32 v81, -4, v54
    v_and_b32 v57, -2, v57
    v_mad_u32_u24 v10, v56, s43, v10
    v_and_b32 v82, -4, v56
    v_and_b32 v59, -2, v59
    v_mad_u32_u24 v11, v58, s43, v11
    v_and_b32 v83, -4, v58
    v_mad_i32_i24 v24, v53, s42, v24
    v_lshl_add_u32 v53, v53, 6, v80
    v_mad_i32_i24 v25, v55, s42, v25
    v_lshl_add_u32 v55, v55, 6, v81
    v_mad_i32_i24 v26, v57, s42, v26
    v_lshl_add_u32 v57, v57, 6, v82
    v_mad_i32_i24 v27, v59, s42, v27
    v_lshl_add_u32 v59, v59, 6, v83
    ds_add_rtn_u32 v80, v53, v104
    ds_add_rtn_u32 v81, v55, v104
    ds_add_rtn_u32 v82, v57, v104
    ds_add_rtn_u32 v83, v59, v104
    v_lshlrev_b32 v110, 16, v38
    v_and_b32 v111, 0xffff0000, v38
    v_lshlrev_b32 v112, 16, v39
    v_and_b32 v113, 0xffff0000, v39
    v_mul_f32 v110, s44, v110
    v_mul_f32 v111, s44, v111
    v_mul_f32 v112, s44, v112
    v_mul_f32 v113, s44, v113
    v_fract_f32 v110, v110
    v_fract_f32 v111, v111
    v_fract_f32 v112, v112
    v_fract_f32 v113, v113
    v_cos_f32 v110, v110
    v_cos_f32 v111, v111
    v_cos_f32 v112, v112
    v_cos_f32 v113, v113
    v_lshl_or_b32 v52, v52, 14, v24
    v_perm_b32 v53, v53, v8, s46
    v_bfe_u32 v8, v8, 8, 5

    v_lshl_or_b32 v54, v54, 14, v25
    v_perm_b32 v55, v55, v9, s46
    v_bfe_u32 v9, v9, 8, 5

    v_lshl_or_b32 v56, v56, 14, v26
    v_perm_b32 v57, v57, v10, s46
    v_bfe_u32 v10, v10, 8, 5

    v_lshl_or_b32 v58, v58, 14, v27
    v_perm_b32 v59, v59, v11, s46
    v_bfe_u32 v11, v11, 8, 5

    v_fmaak_f32 v110, v110, v105, 0x4b400010
    v_fmaak_f32 v111, v111, v105, 0x4b400010
    v_fmaak_f32 v112, v112, v105, 0x4b400010
    v_fmaak_f32 v113, v113, v105, 0x4b400010
    v_sub_u32 v110, v110, v8
    v_sub_u32 v111, v111, v9
    v_sub_u32 v112, v112, v10
    v_sub_u32 v113, v113, v11
    v_bfi_b32 v110, 31, v8, v110
    v_bfi_b32 v111, 31, v9, v111
    v_bfi_b32 v112, 31, v10, v112
    v_bfi_b32 v113, 31, v11, v113
    v_perm_b32 v52, v52, v110, s55
    v_perm_b32 v54, v54, v111, s55
    v_perm_b32 v56, v56, v112, s55
    v_perm_b32 v58, v58, v113, s55
L_ska_25:
    s_bitcmp0_b32 s82, 2
    s_cbranch_scc1 L_ska_26
    s_waitcnt vmcnt(4)
    v_mul_hi_u32_u24 v61, s40, v28
    v_mul_hi_u32_u24 v60, s40, v12
    v_mul_hi_u32_u24 v63, s40, v29
    v_mul_hi_u32_u24 v62, s40, v13
    v_mul_hi_u32_u24 v65, s40, v30
    v_mul_hi_u32_u24 v64, s40, v14
    v_mul_hi_u32_u24 v67, s40, v31
    v_mul_hi_u32_u24 v66, s40, v15
    v_and_b32 v61, -2, v61
    v_mad_u32_u24 v12, v60, s43, v12
    v_and_b32 v84, -4, v60
    v_and_b32 v63, -2, v63
    v_mad_u32_u24 v13, v62, s43, v13
    v_and_b32 v85, -4, v62
    v_and_b32 v65, -2, v65
    v_mad_u32_u24 v14, v64, s43, v14
    v_and_b32 v86, -4, v64
    v_and_b32 v67, -2, v67
    v_mad_u32_u24 v15, v66, s43, v15
    v_and_b32 v87, -4, v66
    v_mad_i32_i24 v28, v61, s42, v28
    v_lshl_add_u32 v61, v61, 6, v84
    v_mad_i32_i24 v29, v63, s42, v29
    v_lshl_add_u32 v63, v63, 6, v85
    v_mad_i32_i24 v30, v65, s42, v30
    v_lshl_add_u32 v65, v65, 6, v86
    v_mad_i32_i24 v31, v67, s42, v31
    v_lshl_add_u32 v67, v67, 6, v87
    ds_add_rtn_u32 v84, v61, v104
    ds_add_rtn_u32 v85, v63, v104
    ds_add_rtn_u32 v86, v65, v104
    ds_add_rtn_u32 v87, v67, v104
    v_lshlrev_b32 v110, 16, v40
    v_and_b32 v111, 0xffff0000, v40
    v_lshlrev_b32 v112, 16, v41
    v_and_b32 v113, 0xffff0000, v41
    v_mul_f32 v110, s44, v110
    v_mul_f32 v111, s44, v111
    v_mul_f32 v112, s44, v112
    v_mul_f32 v113, s44, v113
    v_fract_f32 v110, v110
    v_fract_f32 v111, v111
    v_fract_f32 v112, v112
    v_fract_f32 v113, v113
    v_cos_f32 v110, v110
    v_cos_f32 v111, v111
    v_cos_f32 v112, v112
    v_cos_f32 v113, v113
    v_lshl_or_b32 v60, v60, 14, v28
    v_perm_b32 v61, v61, v12, s46
    v_bfe_u32 v12, v12, 8, 5

    v_lshl_or_b32 v62, v62, 14, v29
    v_perm_b32 v63, v63, v13, s46
    v_bfe_u32 v13, v13, 8, 5

    v_lshl_or_b32 v64, v64, 14, v30
    v_perm_b32 v65, v65, v14, s46
    v_bfe_u32 v14, v14, 8, 5

    v_lshl_or_b32 v66, v66, 14, v31
    v_perm_b32 v67, v67, v15, s46
    v_bfe_u32 v15, v15, 8, 5

    v_fmaak_f32 v110, v110, v105, 0x4b400010
    v_fmaak_f32 v111, v111, v105, 0x4b400010
    v_fmaak_f32 v112, v112, v105, 0x4b400010
    v_fmaak_f32 v113, v113, v105, 0x4b400010
    v_sub_u32 v110, v110, v12
    v_sub_u32 v111, v111, v13
    v_sub_u32 v112, v112, v14
    v_sub_u32 v113, v113, v15
    v_bfi_b32 v110, 31, v12, v110
    v_bfi_b32 v111, 31, v13, v111
    v_bfi_b32 v112, 31, v14, v112
    v_bfi_b32 v113, 31, v15, v113
    v_perm_b32 v60, v60, v110, s55
    v_perm_b32 v62, v62, v111, s55
    v_perm_b32 v64, v64, v112, s55
    v_perm_b32 v66, v66, v113, s55
L_ska_26:
    s_waitcnt vmcnt(1)
    s_waitcnt vmcnt(0)
    v_cmp_eq_u32 vcc, 0, v0
    s_mov_b64 exec, vcc
    ds_write_b32 v108, v99 offset:8
    s_mov_b64 exec, -1
    s_waitcnt vmcnt(1)
    v_lshrrev_b32 v93, 16, v92
    v_and_b32 v92, 0xffff, v92
    v_add_u32 v110, v92, v94
    v_mad_u32_u24 v92, v92, 5, v96
    v_add_u32 v111, v93, v95
    v_mad_u32_u24 v93, v93, 5, v97
    v_max_u32 v110, v110, v111
    v_cmp_le_u32 vcc, s48, v110
    s_cbranch_vccnz L_full_27
L_fback_28:
    ds_write_b64 v2, v[92:93] offset:16384

    s_waitcnt lgkmcnt(0)
    s_barrier
    ds_read_b32 v111, v108 offset:8
    s_waitcnt lgkmcnt(0)
    v_readfirstlane_b32 s41, v111
    s_nop 1

    s_add_u32 s41, s41, 416
    s_sub_u32 s78, s41, 2965
    s_lshr_b32 s79, s78, 1
    s_add_u32 s79, s79, 2965
    s_and_b32 s86, s78, 1
    s_lshl_b32 s86, s86, 1
    s_add_u32 s87, s86, 2
    s_cmp_lt_u32 s41, 2965
    s_cselect_b32 s41, s41, s79
    s_cmovk_i32 s86, 0
    s_cmovk_i32 s87, 4

    s_mul_i32 s78, s41, 16384
    s_add_u32 s49, s78, 16384
    s_cmp_ge_u32 s41, 3125
    s_cmovk_i32 s49, 0
    s_cmovk_i32 s78, 0
    s_lshl_b32 s10, s49, 2
    s_lshl_b32 s14, s49, 2
    s_lshl_b32 s18, s49, 1
    s_sub_u32 s79, s87, s86
    s_bfm_b32 s85, s79, s86
    s_lshl_b32 s86, s86, 12
    s_lshl_b32 s87, s87, 12
    s_min_u32 s87, s87, 16384

    s_add_u32 s79, s78, 0
    s_bitcmp1_b32 s85, 0
    s_cselect_b32 s79, s79, 0x1ff00000
    s_lshl_b32 s56, s79, 2
    s_lshl_b32 s61, s79, 1

    s_add_u32 s79, s78, 4096
    s_bitcmp1_b32 s85, 1
    s_cselect_b32 s79, s79, 0x1ff00000
    s_lshl_b32 s57, s79, 2
    s_lshl_b32 s62, s79, 1

    s_add_u32 s79, s78, 8192
    s_bitcmp1_b32 s85, 2
    s_cselect_b32 s79, s79, 0x1ff00000
    s_lshl_b32 s58, s79, 2
    s_lshl_b32 s63, s79, 1

    s_add_u32 s79, s78, 12288
    s_bitcmp1_b32 s85, 3
    s_cselect_b32 s79, s79, 0x1ff00000
    s_lshl_b32 s59, s79, 2
    s_lshl_b32 s64, s79, 1

    s_bitcmp0_b32 s28, 0
    s_cbranch_scc1 L_skw_29
    ds_read_b64 v[110:111], v2 offset:24592
    ds_read_b64 v[112:113], v2 offset:24600
    ds_read_b64 v[114:115], v2 offset:24584

    ds_read_b64 v[118:119], v2 offset:32784
    ds_read_b64 v[120:121], v2 offset:32792
    ds_read_b64 v[122:123], v2 offset:32776

    s_waitcnt lgkmcnt(3)
    v_lshrrev_b32 v116, 16, v111
    ds_read_b32 v116, v116 offset:16384

    s_waitcnt lgkmcnt(1)
    v_lshrrev_b32 v124, 16, v119
    ds_read_b32 v124, v124 offset:16384

    v_cmp_ne_u32_sdwa s[80:81], v111, v113 src0_sel:WORD_1 src1_sel:WORD_1
    v_cmp_ne_u32_sdwa vcc, v111, v115 src0_sel:WORD_1 src1_sel:WORD_1
    v_alignbyte_b32 v114, v111, v114, 1
    s_mov_b32 s54, -3
    v_perm_b32 v112, v112, v113, s45
    s_waitcnt lgkmcnt(1)
    v_add3_u32 v116, v116, v106, s54
    v_sub_u32 v117, 0, v116
    v_and_b32 v117, 3, v117
    s_mov_b64 exec, s[80:81]
    v_mov_b32 v117, 0
    v_mov_b32 v112, 0
    s_mov_b64 exec, vcc
    v_mov_b32 v117, 3

    s_mov_b64 exec, -1
    v_alignbyte_b32 v111, v112, v110, v117
    v_alignbyte_b32 v110, v110, v114, v117
    v_add_u32 v116, v116, v117

    buffer_store_dwordx2 v[110:111], v116, s[24:27], 0 offen
    v_cmp_ne_u32_sdwa s[80:81], v119, v121 src0_sel:WORD_1 src1_sel:WORD_1
    v_cmp_ne_u32_sdwa vcc, v119, v123 src0_sel:WORD_1 src1_sel:WORD_1
    v_alignbyte_b32 v122, v119, v122, 1
    s_mov_b32 s54, 5117
    v_perm_b32 v120, v120, v121, s45
    s_waitcnt lgkmcnt(0)
    v_add3_u32 v124, v124, v106, s54
    v_sub_u32 v125, 0, v124
    v_and_b32 v125, 3, v125
    s_mov_b64 exec, s[80:81]
    v_mov_b32 v125, 0
    v_mov_b32 v120, 0
    s_mov_b64 exec, vcc
    v_mov_b32 v125, 3

    s_mov_b64 exec, -1
    v_alignbyte_b32 v119, v120, v118, v125
    v_alignbyte_b32 v118, v118, v122, v125
    v_add_u32 v124, v124, v125

    buffer_store_dwordx2 v[118:119], v124, s[24:27], 0 offen
L_skw_29:
    s_bitcmp0_b32 s28, 0
    s_cbranch_scc1 L_skw_30
    ds_read_b64 v[110:111], v2 offset:40976
    ds_read_b64 v[112:113], v2 offset:40984
    ds_read_b64 v[114:115], v2 offset:40968

    ds_read_b64 v[118:119], v2 offset:49168
    ds_read_b64 v[120:121], v2 offset:49176
    ds_read_b64 v[122:123], v2 offset:49160

    s_waitcnt lgkmcnt(3)
    v_lshrrev_b32 v116, 16, v111
    ds_read_b32 v116, v116 offset:16384

    s_waitcnt lgkmcnt(1)
    v_lshrrev_b32 v124, 16, v119
    ds_read_b32 v124, v124 offset:16384

    v_cmp_ne_u32_sdwa s[80:81], v111, v113 src0_sel:WORD_1 src1_sel:WORD_1
    v_cmp_ne_u32_sdwa vcc, v111, v115 src0_sel:WORD_1 src1_sel:WORD_1
    v_alignbyte_b32 v114, v111, v114, 1
    s_mov_b32 s54, 10237
    v_perm_b32 v112, v112, v113, s45
    s_waitcnt lgkmcnt(1)
    v_add3_u32 v116, v116, v106, s54
    v_sub_u32 v117, 0, v116
    v_and_b32 v117, 3, v117
    s_mov_b64 exec, s[80:81]
    v_mov_b32 v117, 0
    v_mov_b32 v112, 0
    s_mov_b64 exec, vcc
    v_mov_b32 v117, 3

    s_mov_b64 exec, -1
    v_alignbyte_b32 v111, v112, v110, v117
    v_alignbyte_b32 v110, v110, v114, v117
    v_add_u32 v116, v116, v117

    buffer_store_dwordx2 v[110:111], v116, s[24:27], 0 offen
    v_cmp_ne_u32_sdwa s[80:81], v119, v121 src0_sel:WORD_1 src1_sel:WORD_1
    v_cmp_ne_u32_sdwa vcc, v119, v123 src0_sel:WORD_1 src1_sel:WORD_1
    v_alignbyte_b32 v122, v119, v122, 1
    s_mov_b32 s54, 15357
    v_perm_b32 v120, v120, v121, s45
    s_waitcnt lgkmcnt(0)
    v_add3_u32 v124, v124, v106, s54
    v_sub_u32 v125, 0, v124
    v_and_b32 v125, 3, v125
    s_mov_b64 exec, s[80:81]
    v_mov_b32 v125, 0
    v_mov_b32 v120, 0
    s_mov_b64 exec, vcc
    v_mov_b32 v125, 3

    s_mov_b64 exec, -1
    v_alignbyte_b32 v119, v120, v118, v125
    v_alignbyte_b32 v118, v118, v122, v125
    v_add_u32 v124, v124, v125

    buffer_store_dwordx2 v[118:119], v124, s[24:27], 0 offen
L_skw_30:
    s_bitcmp0_b32 s28, 1
    s_cbranch_scc1 L_skw_31
    v_add_u32 v107, 32768, v2
    ds_read_b64 v[110:111], v107 offset:24592
    ds_read_b64 v[112:113], v107 offset:24600
    ds_read_b64 v[114:115], v107 offset:24584

    ds_read_b64 v[118:119], v107 offset:32784
    ds_read_b64 v[120:121], v107 offset:32792
    ds_read_b64 v[122:123], v107 offset:32776

    s_waitcnt lgkmcnt(3)
    v_lshrrev_b32 v116, 16, v111
    ds_read_b32 v116, v116 offset:16384

    s_waitcnt lgkmcnt(1)
    v_lshrrev_b32 v124, 16, v119
    ds_read_b32 v124, v124 offset:16384

    v_cmp_ne_u32_sdwa s[80:81], v111, v113 src0_sel:WORD_1 src1_sel:WORD_1
    v_cmp_ne_u32_sdwa vcc, v111, v115 src0_sel:WORD_1 src1_sel:WORD_1
    v_alignbyte_b32 v114, v111, v114, 1
    s_mov_b32 s54, 20477
    v_perm_b32 v112, v112, v113, s45
    s_waitcnt lgkmcnt(1)
    v_add3_u32 v116, v116, v106, s54
    v_sub_u32 v117, 0, v116
    v_and_b32 v117, 3, v117
    s_mov_b64 exec, s[80:81]
    v_mov_b32 v117, 0
    v_mov_b32 v112, 0
    s_mov_b64 exec, vcc
    v_mov_b32 v117, 3

    s_mov_b64 exec, -1
    v_alignbyte_b32 v111, v112, v110, v117
    v_alignbyte_b32 v110, v110, v114, v117
    v_add_u32 v116, v116, v117

    buffer_store_dwordx2 v[110:111], v116, s[24:27], 0 offen
    v_cmp_ne_u32_sdwa s[80:81], v119, v121 src0_sel:WORD_1 src1_sel:WORD_1
    v_cmp_ne_u32_sdwa vcc, v119, v123 src0_sel:WORD_1 src1_sel:WORD_1
    v_alignbyte_b32 v122, v119, v122, 1
    s_mov_b32 s54, 25597
    v_perm_b32 v120, v120, v121, s45
    s_waitcnt lgkmcnt(0)
    v_add3_u32 v124, v124, v106, s54
    v_sub_u32 v125, 0, v124
    v_and_b32 v125, 3, v125
    s_mov_b64 exec, s[80:81]
    v_mov_b32 v125, 0
    v_mov_b32 v120, 0
    s_mov_b64 exec, vcc
    v_mov_b32 v125, 3

    s_mov_b64 exec, -1
    v_alignbyte_b32 v119, v120, v118, v125
    v_alignbyte_b32 v118, v118, v122, v125
    v_add_u32 v124, v124, v125

    buffer_store_dwordx2 v[118:119], v124, s[24:27], 0 offen
L_skw_31:
    s_bitcmp0_b32 s28, 1
    s_cbranch_scc1 L_skw_32
    v_add_u32 v107, 32768, v2
    ds_read_b64 v[110:111], v107 offset:40976
    ds_read_b64 v[112:113], v107 offset:40984
    ds_read_b64 v[114:115], v107 offset:40968

    ds_read_b64 v[118:119], v107 offset:49168
    ds_read_b64 v[120:121], v107 offset:49176
    ds_read_b64 v[122:123], v107 offset:49160

    s_waitcnt lgkmcnt(3)
    v_lshrrev_b32 v116, 16, v111
    ds_read_b32 v116, v116 offset:16384

    s_waitcnt lgkmcnt(1)
    v_lshrrev_b32 v124, 16, v119
    ds_read_b32 v124, v124 offset:16384

    v_cmp_ne_u32_sdwa s[80:81], v111, v113 src0_sel:WORD_1 src1_sel:WORD_1
    v_cmp_ne_u32_sdwa vcc, v111, v115 src0_sel:WORD_1 src1_sel:WORD_1
    v_alignbyte_b32 v114, v111, v114, 1
    s_mov_b32 s54, 30717
    v_perm_b32 v112, v112, v113, s45
    s_waitcnt lgkmcnt(1)
    v_add3_u32 v116, v116, v106, s54
    v_sub_u32 v117, 0, v116
    v_and_b32 v117, 3, v117
    s_mov_b64 exec, s[80:81]
    v_mov_b32 v117, 0
    v_mov_b32 v112, 0
    s_mov_b64 exec, vcc
    v_mov_b32 v117, 3

    s_mov_b64 exec, -1
    v_alignbyte_b32 v111, v112, v110, v117
    v_alignbyte_b32 v110, v110, v114, v117
    v_add_u32 v116, v116, v117

    buffer_store_dwordx2 v[110:111], v116, s[24:27], 0 offen
    v_cmp_ne_u32_sdwa s[80:81], v119, v121 src0_sel:WORD_1 src1_sel:WORD_1
    v_cmp_ne_u32_sdwa vcc, v119, v123 src0_sel:WORD_1 src1_sel:WORD_1
    v_alignbyte_b32 v122, v119, v122, 1
    s_mov_b32 s54, 35837
    v_perm_b32 v120, v120, v121, s45
    s_waitcnt lgkmcnt(0)
    v_add3_u32 v124, v124, v106, s54
    v_sub_u32 v125, 0, v124
    v_and_b32 v125, 3, v125
    s_mov_b64 exec, s[80:81]
    v_mov_b32 v125, 0
    v_mov_b32 v120, 0
    s_mov_b64 exec, vcc
    v_mov_b32 v125, 3

    s_mov_b64 exec, -1
    v_alignbyte_b32 v119, v120, v118, v125
    v_alignbyte_b32 v118, v118, v122, v125
    v_add_u32 v124, v124, v125

    buffer_store_dwordx2 v[118:119], v124, s[24:27], 0 offen
L_skw_32:
    s_bitcmp0_b32 s82, 3
    s_cbranch_scc1 L_ska_33
    s_mov_b64 exec, s[66:67]
    v_mul_hi_u32_u24 v69, s40, v32
    v_mul_hi_u32_u24 v68, s40, v16
    v_mul_hi_u32_u24 v71, s40, v33
    v_mul_hi_u32_u24 v70, s40, v17
    v_mul_hi_u32_u24 v73, s40, v34
    v_mul_hi_u32_u24 v72, s40, v18
    v_mul_hi_u32_u24 v75, s40, v35
    v_mul_hi_u32_u24 v74, s40, v19
    v_and_b32 v69, -2, v69
    v_mad_u32_u24 v16, v68, s43, v16
    v_and_b32 v88, -4, v68
    v_and_b32 v71, -2, v71
    v_mad_u32_u24 v17, v70, s43, v17
    v_and_b32 v89, -4, v70
    v_and_b32 v73, -2, v73
    v_mad_u32_u24 v18, v72, s43, v18
    v_and_b32 v90, -4, v72
    v_and_b32 v75, -2, v75
    v_mad_u32_u24 v19, v74, s43, v19
    v_and_b32 v91, -4, v74
    v_mad_i32_i24 v32, v69, s42, v32
    v_lshl_add_u32 v69, v69, 6, v88
    v_mad_i32_i24 v33, v71, s42, v33
    v_lshl_add_u32 v71, v71, 6, v89
    v_mad_i32_i24 v34, v73, s42, v34
    v_lshl_add_u32 v73, v73, 6, v90
    v_mad_i32_i24 v35, v75, s42, v35
    v_lshl_add_u32 v75, v75, 6, v91
    ds_add_rtn_u32 v88, v69, v104
    ds_add_rtn_u32 v89, v71, v104
    ds_add_rtn_u32 v90, v73, v104
    ds_add_rtn_u32 v91, v75, v104
    v_lshlrev_b32 v110, 16, v42
    v_and_b32 v111, 0xffff0000, v42
    v_lshlrev_b32 v112, 16, v43
    v_and_b32 v113, 0xffff0000, v43
    v_mul_f32 v110, s44, v110
    v_mul_f32 v111, s44, v111
    v_mul_f32 v112, s44, v112
    v_mul_f32 v113, s44, v113
    v_fract_f32 v110, v110
    v_fract_f32 v111, v111
    v_fract_f32 v112, v112
    v_fract_f32 v113, v113
    v_cos_f32 v110, v110
    v_cos_f32 v111, v111
    v_cos_f32 v112, v112
    v_cos_f32 v113, v113
    v_lshl_or_b32 v68, v68, 14, v32
    v_perm_b32 v69, v69, v16, s46
    v_bfe_u32 v16, v16, 8, 5

    v_lshl_or_b32 v70, v70, 14, v33
    v_perm_b32 v71, v71, v17, s46
    v_bfe_u32 v17, v17, 8, 5

    v_lshl_or_b32 v72, v72, 14, v34
    v_perm_b32 v73, v73, v18, s46
    v_bfe_u32 v18, v18, 8, 5

    v_lshl_or_b32 v74, v74, 14, v35
    v_perm_b32 v75, v75, v19, s46
    v_bfe_u32 v19, v19, 8, 5

    v_fmaak_f32 v110, v110, v105, 0x4b400010
    v_fmaak_f32 v111, v111, v105, 0x4b400010
    v_fmaak_f32 v112, v112, v105, 0x4b400010
    v_fmaak_f32 v113, v113, v105, 0x4b400010
    v_sub_u32 v110, v110, v16
    v_sub_u32 v111, v111, v17
    v_sub_u32 v112, v112, v18
    v_sub_u32 v113, v113, v19
    v_bfi_b32 v110, 31, v16, v110
    v_bfi_b32 v111, 31, v17, v111
    v_bfi_b32 v112, 31, v18, v112
    v_bfi_b32 v113, 31, v19, v113
    v_perm_b32 v68, v68, v110, s55
    v_perm_b32 v70, v70, v111, s55
    v_perm_b32 v72, v72, v112, s55
    v_perm_b32 v74, v74, v113, s55
    s_mov_b64 exec, -1
L_ska_33:
    s_bitcmp0_b32 s28, 2
    s_cbranch_scc1 L_skw_34
    v_add_u32 v107, 65536, v2
    ds_read_b64 v[110:111], v107 offset:24592
    ds_read_b64 v[112:113], v107 offset:24600
    ds_read_b64 v[114:115], v107 offset:24584

    ds_read_b64 v[118:119], v107 offset:32784
    ds_read_b64 v[120:121], v107 offset:32792
    ds_read_b64 v[122:123], v107 offset:32776

    s_waitcnt lgkmcnt(3)
    v_lshrrev_b32 v116, 16, v111
    ds_read_b32 v116, v116 offset:16384

    s_waitcnt lgkmcnt(1)
    v_lshrrev_b32 v124, 16, v119
    ds_read_b32 v124, v124 offset:16384

    v_cmp_ne_u32_sdwa s[80:81], v111, v113 src0_sel:WORD_1 src1_sel:WORD_1
    v_cmp_ne_u32_sdwa vcc, v111, v115 src0_sel:WORD_1 src1_sel:WORD_1
    v_alignbyte_b32 v114, v111, v114, 1
    s_mov_b32 s54, 40957
    v_perm_b32 v112, v112, v113, s45
    s_waitcnt lgkmcnt(1)
    v_add3_u32 v116, v116, v106, s54
    v_sub_u32 v117, 0, v116
    v_and_b32 v117, 3, v117
    s_mov_b64 exec, s[80:81]
    v_mov_b32 v117, 0
    v_mov_b32 v112, 0
    s_mov_b64 exec, vcc
    v_mov_b32 v117, 3

    s_mov_b64 exec, -1
    v_alignbyte_b32 v111, v112, v110, v117
    v_alignbyte_b32 v110, v110, v114, v117
    v_add_u32 v116, v116, v117

    buffer_store_dwordx2 v[110:111], v116, s[24:27], 0 offen
    v_cmp_ne_u32_sdwa s[80:81], v119, v121 src0_sel:WORD_1 src1_sel:WORD_1
    v_cmp_ne_u32_sdwa vcc, v119, v123 src0_sel:WORD_1 src1_sel:WORD_1
    v_alignbyte_b32 v122, v119, v122, 1
    s_mov_b32 s54, 46077
    v_perm_b32 v120, v120, v121, s45
    s_waitcnt lgkmcnt(0)
    v_add3_u32 v124, v124, v106, s54
    v_sub_u32 v125, 0, v124
    v_and_b32 v125, 3, v125
    s_mov_b64 exec, s[80:81]
    v_mov_b32 v125, 0
    v_mov_b32 v120, 0
    s_mov_b64 exec, vcc
    v_mov_b32 v125, 3

    s_mov_b64 exec, -1
    v_alignbyte_b32 v119, v120, v118, v125
    v_alignbyte_b32 v118, v118, v122, v125
    v_add_u32 v124, v124, v125

    buffer_store_dwordx2 v[118:119], v124, s[24:27], 0 offen
L_skw_34:
    s_bitcmp0_b32 s28, 2
    s_cbranch_scc1 L_skw_35
    v_add_u32 v107, 65536, v2
    ds_read_b64 v[110:111], v107 offset:40976
    ds_read_b64 v[112:113], v107 offset:40984
    ds_read_b64 v[114:115], v107 offset:40968

    ds_read_b64 v[118:119], v107 offset:49168
    ds_read_b64 v[120:121], v107 offset:49176
    ds_read_b64 v[122:123], v107 offset:49160

    s_waitcnt lgkmcnt(3)
    v_lshrrev_b32 v116, 16, v111
    ds_read_b32 v116, v116 offset:16384

    s_waitcnt lgkmcnt(1)
    v_lshrrev_b32 v124, 16, v119
    ds_read_b32 v124, v124 offset:16384

    v_cmp_ne_u32_sdwa s[80:81], v111, v113 src0_sel:WORD_1 src1_sel:WORD_1
    v_cmp_ne_u32_sdwa vcc, v111, v115 src0_sel:WORD_1 src1_sel:WORD_1
    v_alignbyte_b32 v114, v111, v114, 1
    s_mov_b32 s54, 51197
    v_perm_b32 v112, v112, v113, s45
    s_waitcnt lgkmcnt(1)
    v_add3_u32 v116, v116, v106, s54
    v_sub_u32 v117, 0, v116
    v_and_b32 v117, 3, v117
    s_mov_b64 exec, s[80:81]
    v_mov_b32 v117, 0
    v_mov_b32 v112, 0
    s_mov_b64 exec, vcc
    v_mov_b32 v117, 3

    s_mov_b64 exec, -1
    v_alignbyte_b32 v111, v112, v110, v117
    v_alignbyte_b32 v110, v110, v114, v117
    v_add_u32 v116, v116, v117

    buffer_store_dwordx2 v[110:111], v116, s[24:27], 0 offen
    v_cmp_ne_u32_sdwa s[80:81], v119, v121 src0_sel:WORD_1 src1_sel:WORD_1
    v_cmp_ne_u32_sdwa vcc, v119, v123 src0_sel:WORD_1 src1_sel:WORD_1
    v_alignbyte_b32 v122, v119, v122, 1
    s_mov_b32 s54, 56317
    v_perm_b32 v120, v120, v121, s45
    s_waitcnt lgkmcnt(0)
    v_add3_u32 v124, v124, v106, s54
    v_sub_u32 v125, 0, v124
    v_and_b32 v125, 3, v125
    s_mov_b64 exec, s[80:81]
    v_mov_b32 v125, 0
    v_mov_b32 v120, 0
    s_mov_b64 exec, vcc
    v_mov_b32 v125, 3

    s_mov_b64 exec, -1
    v_alignbyte_b32 v119, v120, v118, v125
    v_alignbyte_b32 v118, v118, v122, v125
    v_add_u32 v124, v124, v125

    buffer_store_dwordx2 v[118:119], v124, s[24:27], 0 offen
L_skw_35:
    s_bitcmp0_b32 s28, 3
    s_cbranch_scc1 L_skw_36
    v_add_u32 v107, 98304, v2
    ds_read_b64 v[110:111], v107 offset:24592
    ds_read_b64 v[112:113], v107 offset:24600
    ds_read_b64 v[114:115], v107 offset:24584

    ds_read_b64 v[118:119], v107 offset:32784
    ds_read_b64 v[120:121], v107 offset:32792
    ds_read_b64 v[122:123], v107 offset:32776

    s_waitcnt lgkmcnt(3)
    v_lshrrev_b32 v116, 16, v111
    ds_read_b32 v116, v116 offset:16384

    s_waitcnt lgkmcnt(1)
    v_lshrrev_b32 v124, 16, v119
    ds_read_b32 v124, v124 offset:16384

    v_cmp_ne_u32_sdwa s[80:81], v111, v113 src0_sel:WORD_1 src1_sel:WORD_1
    v_cmp_ne_u32_sdwa vcc, v111, v115 src0_sel:WORD_1 src1_sel:WORD_1
    v_alignbyte_b32 v114, v111, v114, 1
    s_mov_b32 s54, 61437
    v_perm_b32 v112, v112, v113, s45
    s_waitcnt lgkmcnt(1)
    v_add3_u32 v116, v116, v106, s54
    v_sub_u32 v117, 0, v116
    v_and_b32 v117, 3, v117
    s_mov_b64 exec, s[80:81]
    v_mov_b32 v117, 0
    v_mov_b32 v112, 0
    s_mov_b64 exec, vcc
    v_mov_b32 v117, 3

    s_mov_b64 exec, -1
    v_alignbyte_b32 v111, v112, v110, v117
    v_alignbyte_b32 v110, v110, v114, v117
    v_add_u32 v116, v116, v117

    buffer_store_dwordx2 v[110:111], v116, s[24:27], 0 offen
    v_cmp_ne_u32_sdwa s[80:81], v119, v121 src0_sel:WORD_1 src1_sel:WORD_1
    v_cmp_ne_u32_sdwa vcc, v119, v123 src0_sel:WORD_1 src1_sel:WORD_1
    v_alignbyte_b32 v122, v119, v122, 1
    s_mov_b32 s54, 66557
    v_perm_b32 v120, v120, v121, s45
    s_waitcnt lgkmcnt(0)
    v_add3_u32 v124, v124, v106, s54
    v_sub_u32 v125, 0, v124
    v_and_b32 v125, 3, v125
    s_mov_b64 exec, s[80:81]
    v_mov_b32 v125, 0
    v_mov_b32 v120, 0
    s_mov_b64 exec, vcc
    v_mov_b32 v125, 3

    s_mov_b64 exec, -1
    v_alignbyte_b32 v119, v120, v118, v125
    v_alignbyte_b32 v118, v118, v122, v125
    v_add_u32 v124, v124, v125

    buffer_store_dwordx2 v[118:119], v124, s[24:27], 0 offen
L_skw_36:
    s_bitcmp0_b32 s28, 3
    s_cbranch_scc1 L_skw_37
    v_add_u32 v107, 98304, v2
    ds_read_b64 v[110:111], v107 offset:40976
    ds_read_b64 v[112:113], v107 offset:40984
    ds_read_b64 v[114:115], v107 offset:40968

    ds_read_b64 v[118:119], v107 offset:49168
    ds_read_b64 v[120:121], v107 offset:49176
    ds_read_b64 v[122:123], v107 offset:49160

    s_waitcnt lgkmcnt(3)
    v_lshrrev_b32 v116, 16, v111
    ds_read_b32 v116, v116 offset:16384

    s_waitcnt lgkmcnt(1)
    v_lshrrev_b32 v124, 16, v119
    ds_read_b32 v124, v124 offset:16384

    v_cmp_ne_u32_sdwa s[80:81], v111, v113 src0_sel:WORD_1 src1_sel:WORD_1
    v_cmp_ne_u32_sdwa vcc, v111, v115 src0_sel:WORD_1 src1_sel:WORD_1
    v_alignbyte_b32 v114, v111, v114, 1
    s_mov_b32 s54, 71677
    v_perm_b32 v112, v112, v113, s45
    s_waitcnt lgkmcnt(1)
    v_add3_u32 v116, v116, v106, s54
    v_sub_u32 v117, 0, v116
    v_and_b32 v117, 3, v117
    s_mov_b64 exec, s[80:81]
    v_mov_b32 v117, 0
    v_mov_b32 v112, 0
    s_mov_b64 exec, vcc
    v_mov_b32 v117, 3

    s_mov_b64 exec, -1
    v_alignbyte_b32 v111, v112, v110, v117
    v_alignbyte_b32 v110, v110, v114, v117
    v_add_u32 v116, v116, v117

    buffer_store_dwordx2 v[110:111], v116, s[24:27], 0 offen
    v_cmp_ne_u32_sdwa s[80:81], v119, v121 src0_sel:WORD_1 src1_sel:WORD_1
    v_cmp_ne_u32_sdwa vcc, v119, v123 src0_sel:WORD_1 src1_sel:WORD_1
    v_alignbyte_b32 v122, v119, v122, 1
    s_mov_b32 s54, 76797
    v_perm_b32 v120, v120, v121, s45
    s_waitcnt lgkmcnt(0)
    v_add3_u32 v124, v124, v106, s54
    v_sub_u32 v125, 0, v124
    v_and_b32 v125, 3, v125
    s_mov_b64 exec, s[80:81]
    v_mov_b32 v125, 0
    v_mov_b32 v120, 0
    s_mov_b64 exec, vcc
    v_mov_b32 v125, 3

    s_mov_b64 exec, -1
    v_alignbyte_b32 v119, v120, v118, v125
    v_alignbyte_b32 v118, v118, v122, v125
    v_add_u32 v124, v124, v125

    buffer_store_dwordx2 v[118:119], v124, s[24:27], 0 offen
L_skw_37:
    s_waitcnt lgkmcnt(0)
    s_barrier

    buffer_load_dwordx4 v[20:23], v1, s[12:15], s56 offen nt
    buffer_load_dwordx4 v[4:7], v1, s[8:11], s56 offen nt
    buffer_load_dwordx2 v[36:37], v2, s[16:19], s61 offen nt
    buffer_load_dwordx4 v[24:27], v1, s[12:15], s57 offen nt
    buffer_load_dwordx4 v[8:11], v1, s[8:11], s57 offen nt
    buffer_load_dwordx2 v[38:39], v2, s[16:19], s62 offen nt
    ds_read_b64 v[94:95], v2
    s_waitcnt lgkmcnt(0)
    v_add_u32 v97, v94, v95
    s_nop 1
    v_add_u32_dpp v97, v97, v97 row_shr:1 row_mask:0xf bank_mask:0xf
    s_nop 1
    v_add_u32_dpp v97, v97, v97 row_shr:2 row_mask:0xf bank_mask:0xf
    s_nop 1
    v_add_u32_dpp v97, v97, v97 row_shr:4 row_mask:0xf bank_mask:0xf
    s_nop 1
    v_add_u32_dpp v97, v97, v97 row_shr:8 row_mask:0xf bank_mask:0xf
    s_nop 1
    v_add_u32_dpp v97, v97, v97 row_bcast:15 row_mask:0xa bank_mask:0xf
    s_nop 1
    v_add_u32_dpp v97, v97, v97 row_bcast:31 row_mask:0xc bank_mask:0xf
    s_mov_b32 exec_lo, 0
    s_brev_b32 exec_hi, 1
    ds_add_rtn_u32 v96, v108, v97
    s_mov_b64 exec, -1

    v_add_u32 v92, v94, v94
    v_add_u32 v93, v95, v95
    v_med3_u32 v92, v94, 2, v92
    v_med3_u32 v93, v95, 2, v93
    v_lshl_or_b32 v92, v93, 16, v92
    v_lshlrev_b32 v93, 2, v0
    buffer_atomic_add v92, v93, s[20:23], 0 offen sc0
    s_waitcnt lgkmcnt(0)
    v_readlane_b32 s77, v96, 63
    v_sub_u32 v97, v97, v95
    s_sub_u32 s50, s50, s83
    s_sub_u32 s77, s77, s50
    v_add_u32 v97, s77, v97
    v_sub_u32 v96, v97, v94
    v_lshlrev_b32 v111, 3, v97
    v_lshlrev_b32 v110, 3, v96
    v_mov_b32 v112, 0
    v_mov_b32 v113, 0
    ds_write_b64 v2, v[110:111] offset:8192
    ds_write_b64 v2, v[112:113]
    v_mad_i32_i24 v96, v96, -5, v102
    v_mad_i32_i24 v97, v97, -5, v103
    s_add_u32 s50, s50, s84
    s_mov_b32 s28, s82
    s_mov_b32 s29, s83
    s_mov_b32 s30, s84
    s_lshl_b32 s74, s29, 3
    s_lshl_b32 s75, s30, 3
    v_mov_b32 v125, s74
    v_mov_b32 v126, s75
    v_mov_b32 v127, -1

    s_waitcnt lgkmcnt(0)
    s_barrier

    s_mov_b64 exec, 1
    ds_write_b32 v125, v127 offset:24588
    ds_write_b32 v126, v127 offset:24596
    s_mov_b64 exec, -1

    s_bitcmp0_b32 s28, 0
    s_cbranch_scc1 L_skz_38
    v_lshrrev_b32 v110, 16, v45
    ds_read_b32 v110, v110 offset:8192
    v_lshrrev_b32 v111, 16, v47
    ds_read_b32 v111, v111 offset:8192
    v_lshrrev_b32 v112, 16, v49
    ds_read_b32 v112, v112 offset:8192
    v_lshrrev_b32 v113, 16, v51
    ds_read_b32 v113, v113 offset:8192
    v_lshrrev_b32 v114, 16, v53
    ds_read_b32 v114, v114 offset:8192
    v_lshrrev_b32 v115, 16, v55
    ds_read_b32 v115, v115 offset:8192
    v_lshrrev_b32 v116, 16, v57
    ds_read_b32 v116, v116 offset:8192
    v_lshrrev_b32 v117, 16, v59
    ds_read_b32 v117, v117 offset:8192
    s_waitcnt lgkmcnt(7)
    v_lshl_add_u32 v110, v76, 3, v110
    ds_write_b64 v110, v[44:45] offset:24592

    s_waitcnt lgkmcnt(7)
    v_lshl_add_u32 v111, v77, 3, v111
    ds_write_b64 v111, v[46:47] offset:24592

    s_waitcnt lgkmcnt(7)
    v_lshl_add_u32 v112, v78, 3, v112
    ds_write_b64 v112, v[48:49] offset:24592

    s_waitcnt lgkmcnt(7)
    v_lshl_add_u32 v113, v79, 3, v113
    ds_write_b64 v113, v[50:51] offset:24592

    s_waitcnt lgkmcnt(7)
    v_lshl_add_u32 v114, v80, 3, v114
    ds_write_b64 v114, v[52:53] offset:24592

    s_waitcnt lgkmcnt(7)
    v_lshl_add_u32 v115, v81, 3, v115
    ds_write_b64 v115, v[54:55] offset:24592

    s_waitcnt lgkmcnt(7)
    v_lshl_add_u32 v116, v82, 3, v116
    ds_write_b64 v116, v[56:57] offset:24592

    s_waitcnt lgkmcnt(7)
    v_lshl_add_u32 v117, v83, 3, v117
    ds_write_b64 v117, v[58:59] offset:24592

L_skz_38:
    buffer_load_dwordx4 v[28:31], v1, s[12:15], s58 offen nt
    buffer_load_dwordx4 v[12:15], v1, s[8:11], s58 offen nt
    buffer_load_dwordx2 v[40:41], v2, s[16:19], s63 offen nt
    s_bitcmp0_b32 s28, 2
    s_cbranch_scc1 L_skz_39
    v_lshrrev_b32 v110, 16, v61
    ds_read_b32 v110, v110 offset:8192
    v_lshrrev_b32 v111, 16, v63
    ds_read_b32 v111, v111 offset:8192
    v_lshrrev_b32 v112, 16, v65
    ds_read_b32 v112, v112 offset:8192
    v_lshrrev_b32 v113, 16, v67
    ds_read_b32 v113, v113 offset:8192
    s_waitcnt lgkmcnt(3)
    v_lshl_add_u32 v110, v84, 3, v110
    ds_write_b64 v110, v[60:61] offset:24592

    s_waitcnt lgkmcnt(3)
    v_lshl_add_u32 v111, v85, 3, v111
    ds_write_b64 v111, v[62:63] offset:24592

    s_waitcnt lgkmcnt(3)
    v_lshl_add_u32 v112, v86, 3, v112
    ds_write_b64 v112, v[64:65] offset:24592

    s_waitcnt lgkmcnt(3)
    v_lshl_add_u32 v113, v87, 3, v113
    ds_write_b64 v113, v[66:67] offset:24592

L_skz_39:
    s_bitcmp0_b32 s28, 3
    s_cbranch_scc1 L_skz_40
    s_mov_b64 exec, s[66:67]
    v_lshrrev_b32 v110, 16, v69
    ds_read_b32 v110, v110 offset:8192
    v_lshrrev_b32 v111, 16, v71
    ds_read_b32 v111, v111 offset:8192
    v_lshrrev_b32 v112, 16, v73
    ds_read_b32 v112, v112 offset:8192
    v_lshrrev_b32 v113, 16, v75
    ds_read_b32 v113, v113 offset:8192
    s_waitcnt lgkmcnt(3)
    v_lshl_add_u32 v110, v88, 3, v110
    ds_write_b64 v110, v[68:69] offset:24592

    s_waitcnt lgkmcnt(3)
    v_lshl_add_u32 v111, v89, 3, v111
    ds_write_b64 v111, v[70:71] offset:24592

    s_waitcnt lgkmcnt(3)
    v_lshl_add_u32 v112, v90, 3, v112
    ds_write_b64 v112, v[72:73] offset:24592

    s_waitcnt lgkmcnt(3)
    v_lshl_add_u32 v113, v91, 3, v113
    ds_write_b64 v113, v[74:75] offset:24592

    s_mov_b64 exec, -1
L_skz_40:
    buffer_load_dwordx4 v[32:35], v1, s[12:15], s59 offen nt
    buffer_load_dwordx4 v[16:19], v1, s[8:11], s59 offen nt
    buffer_load_dwordx2 v[42:43], v2, s[16:19], s64 offen nt
    s_cmp_lg_u32 s49, 0
    s_cbranch_scc1 L_p1loop_6
L_p1epi_7:
    s_waitcnt vmcnt(0)
    s_waitcnt vmcnt(0)
    v_lshrrev_b32 v93, 16, v92
    v_and_b32 v92, 0xffff, v92
    v_add_u32 v110, v92, v94
    v_mad_u32_u24 v92, v92, 5, v96
    v_add_u32 v111, v93, v95
    v_mad_u32_u24 v93, v93, 5, v97
    v_max_u32 v110, v110, v111
    v_cmp_le_u32 vcc, s48, v110
    s_cbranch_vccnz L_full_41
L_fback_42:
    ds_write_b64 v2, v[92:93] offset:16384

    s_waitcnt lgkmcnt(0)
    s_barrier

    s_bitcmp0_b32 s28, 0
    s_cbranch_scc1 L_skw_43
    ds_read_b64 v[4:5], v2 offset:24592
    ds_read_b64 v[6:7], v2 offset:24600
    ds_read_b64 v[8:9], v2 offset:24584

    ds_read_b64 v[12:13], v2 offset:32784
    ds_read_b64 v[14:15], v2 offset:32792
    ds_read_b64 v[16:17], v2 offset:32776

    ds_read_b64 v[20:21], v2 offset:40976
    ds_read_b64 v[22:23], v2 offset:40984
    ds_read_b64 v[24:25], v2 offset:40968

    ds_read_b64 v[28:29], v2 offset:49168
    ds_read_b64 v[30:31], v2 offset:49176
    ds_read_b64 v[32:33], v2 offset:49160

    s_waitcnt lgkmcnt(9)
    v_lshrrev_b32 v10, 16, v5
    ds_read_b32 v10, v10 offset:16384

    s_waitcnt lgkmcnt(7)
    v_lshrrev_b32 v18, 16, v13
    ds_read_b32 v18, v18 offset:16384

    s_waitcnt lgkmcnt(5)
    v_lshrrev_b32 v26, 16, v21
    ds_read_b32 v26, v26 offset:16384

    s_waitcnt lgkmcnt(3)
    v_lshrrev_b32 v34, 16, v29
    ds_read_b32 v34, v34 offset:16384

    v_cmp_ne_u32_sdwa s[80:81], v5, v7 src0_sel:WORD_1 src1_sel:WORD_1
    v_cmp_ne_u32_sdwa vcc, v5, v9 src0_sel:WORD_1 src1_sel:WORD_1
    v_alignbyte_b32 v8, v5, v8, 1
    s_mov_b32 s54, -3
    v_perm_b32 v6, v6, v7, s45
    s_waitcnt lgkmcnt(3)
    v_add3_u32 v10, v10, v106, s54
    v_sub_u32 v11, 0, v10
    v_and_b32 v11, 3, v11
    s_mov_b64 exec, s[80:81]
    v_mov_b32 v11, 0
    v_mov_b32 v6, 0
    s_mov_b64 exec, vcc
    v_mov_b32 v11, 3

    s_mov_b64 exec, -1
    v_alignbyte_b32 v5, v6, v4, v11
    v_alignbyte_b32 v4, v4, v8, v11
    v_add_u32 v10, v10, v11

    buffer_store_dwordx2 v[4:5], v10, s[24:27], 0 offen
    v_cmp_ne_u32_sdwa s[80:81], v13, v15 src0_sel:WORD_1 src1_sel:WORD_1
    v_cmp_ne_u32_sdwa vcc, v13, v17 src0_sel:WORD_1 src1_sel:WORD_1
    v_alignbyte_b32 v16, v13, v16, 1
    s_mov_b32 s54, 5117
    v_perm_b32 v14, v14, v15, s45
    s_waitcnt lgkmcnt(2)
    v_add3_u32 v18, v18, v106, s54
    v_sub_u32 v19, 0, v18
    v_and_b32 v19, 3, v19
    s_mov_b64 exec, s[80:81]
    v_mov_b32 v19, 0
    v_mov_b32 v14, 0
    s_mov_b64 exec, vcc
    v_mov_b32 v19, 3

    s_mov_b64 exec, -1
    v_alignbyte_b32 v13, v14, v12, v19
    v_alignbyte_b32 v12, v12, v16, v19
    v_add_u32 v18, v18, v19

    buffer_store_dwordx2 v[12:13], v18, s[24:27], 0 offen
    v_cmp_ne_u32_sdwa s[80:81], v21, v23 src0_sel:WORD_1 src1_sel:WORD_1
    v_cmp_ne_u32_sdwa vcc, v21, v25 src0_sel:WORD_1 src1_sel:WORD_1
    v_alignbyte_b32 v24, v21, v24, 1
    s_mov_b32 s54, 10237
    v_perm_b32 v22, v22, v23, s45
    s_waitcnt lgkmcnt(1)
    v_add3_u32 v26, v26, v106, s54
    v_sub_u32 v27, 0, v26
    v_and_b32 v27, 3, v27
    s_mov_b64 exec, s[80:81]
    v_mov_b32 v27, 0
    v_mov_b32 v22, 0
    s_mov_b64 exec, vcc
    v_mov_b32 v27, 3

    s_mov_b64 exec, -1
    v_alignbyte_b32 v21, v22, v20, v27
    v_alignbyte_b32 v20, v20, v24, v27
    v_add_u32 v26, v26, v27

    buffer_store_dwordx2 v[20:21], v26, s[24:27], 0 offen
    v_cmp_ne_u32_sdwa s[80:81], v29, v31 src0_sel:WORD_1 src1_sel:WORD_1
    v_cmp_ne_u32_sdwa vcc, v29, v33 src0_sel:WORD_1 src1_sel:WORD_1
    v_alignbyte_b32 v32, v29, v32, 1
    s_mov_b32 s54, 15357
    v_perm_b32 v30, v30, v31, s45
    s_waitcnt lgkmcnt(0)
    v_add3_u32 v34, v34, v106, s54
    v_sub_u32 v35, 0, v34
    v_and_b32 v35, 3, v35
    s_mov_b64 exec, s[80:81]
    v_mov_b32 v35, 0
    v_mov_b32 v30, 0
    s_mov_b64 exec, vcc
    v_mov_b32 v35, 3

    s_mov_b64 exec, -1
    v_alignbyte_b32 v29, v30, v28, v35
    v_alignbyte_b32 v28, v28, v32, v35
    v_add_u32 v34, v34, v35

    buffer_store_dwordx2 v[28:29], v34, s[24:27], 0 offen
L_skw_43:
    s_bitcmp0_b32 s28, 1
    s_cbranch_scc1 L_skw_44
    v_add_u32 v107, 32768, v2
    ds_read_b64 v[4:5], v107 offset:24592
    ds_read_b64 v[6:7], v107 offset:24600
    ds_read_b64 v[8:9], v107 offset:24584

    ds_read_b64 v[12:13], v107 offset:32784
    ds_read_b64 v[14:15], v107 offset:32792
    ds_read_b64 v[16:17], v107 offset:32776

    ds_read_b64 v[20:21], v107 offset:40976
    ds_read_b64 v[22:23], v107 offset:40984
    ds_read_b64 v[24:25], v107 offset:40968

    ds_read_b64 v[28:29], v107 offset:49168
    ds_read_b64 v[30:31], v107 offset:49176
    ds_read_b64 v[32:33], v107 offset:49160

    s_waitcnt lgkmcnt(9)
    v_lshrrev_b32 v10, 16, v5
    ds_read_b32 v10, v10 offset:16384

    s_waitcnt lgkmcnt(7)
    v_lshrrev_b32 v18, 16, v13
    ds_read_b32 v18, v18 offset:16384

    s_waitcnt lgkmcnt(5)
    v_lshrrev_b32 v26, 16, v21
    ds_read_b32 v26, v26 offset:16384

    s_waitcnt lgkmcnt(3)
    v_lshrrev_b32 v34, 16, v29
    ds_read_b32 v34, v34 offset:16384

    v_cmp_ne_u32_sdwa s[80:81], v5, v7 src0_sel:WORD_1 src1_sel:WORD_1
    v_cmp_ne_u32_sdwa vcc, v5, v9 src0_sel:WORD_1 src1_sel:WORD_1
    v_alignbyte_b32 v8, v5, v8, 1
    s_mov_b32 s54, 20477
    v_perm_b32 v6, v6, v7, s45
    s_waitcnt lgkmcnt(3)
    v_add3_u32 v10, v10, v106, s54
    v_sub_u32 v11, 0, v10
    v_and_b32 v11, 3, v11
    s_mov_b64 exec, s[80:81]
    v_mov_b32 v11, 0
    v_mov_b32 v6, 0
    s_mov_b64 exec, vcc
    v_mov_b32 v11, 3

    s_mov_b64 exec, -1
    v_alignbyte_b32 v5, v6, v4, v11
    v_alignbyte_b32 v4, v4, v8, v11
    v_add_u32 v10, v10, v11

    buffer_store_dwordx2 v[4:5], v10, s[24:27], 0 offen
    v_cmp_ne_u32_sdwa s[80:81], v13, v15 src0_sel:WORD_1 src1_sel:WORD_1
    v_cmp_ne_u32_sdwa vcc, v13, v17 src0_sel:WORD_1 src1_sel:WORD_1
    v_alignbyte_b32 v16, v13, v16, 1
    s_mov_b32 s54, 25597
    v_perm_b32 v14, v14, v15, s45
    s_waitcnt lgkmcnt(2)
    v_add3_u32 v18, v18, v106, s54
    v_sub_u32 v19, 0, v18
    v_and_b32 v19, 3, v19
    s_mov_b64 exec, s[80:81]
    v_mov_b32 v19, 0
    v_mov_b32 v14, 0
    s_mov_b64 exec, vcc
    v_mov_b32 v19, 3

    s_mov_b64 exec, -1
    v_alignbyte_b32 v13, v14, v12, v19
    v_alignbyte_b32 v12, v12, v16, v19
    v_add_u32 v18, v18, v19

    buffer_store_dwordx2 v[12:13], v18, s[24:27], 0 offen
    v_cmp_ne_u32_sdwa s[80:81], v21, v23 src0_sel:WORD_1 src1_sel:WORD_1
    v_cmp_ne_u32_sdwa vcc, v21, v25 src0_sel:WORD_1 src1_sel:WORD_1
    v_alignbyte_b32 v24, v21, v24, 1
    s_mov_b32 s54, 30717
    v_perm_b32 v22, v22, v23, s45
    s_waitcnt lgkmcnt(1)
    v_add3_u32 v26, v26, v106, s54
    v_sub_u32 v27, 0, v26
    v_and_b32 v27, 3, v27
    s_mov_b64 exec, s[80:81]
    v_mov_b32 v27, 0
    v_mov_b32 v22, 0
    s_mov_b64 exec, vcc
    v_mov_b32 v27, 3

    s_mov_b64 exec, -1
    v_alignbyte_b32 v21, v22, v20, v27
    v_alignbyte_b32 v20, v20, v24, v27
    v_add_u32 v26, v26, v27

    buffer_store_dwordx2 v[20:21], v26, s[24:27], 0 offen
    v_cmp_ne_u32_sdwa s[80:81], v29, v31 src0_sel:WORD_1 src1_sel:WORD_1
    v_cmp_ne_u32_sdwa vcc, v29, v33 src0_sel:WORD_1 src1_sel:WORD_1
    v_alignbyte_b32 v32, v29, v32, 1
    s_mov_b32 s54, 35837
    v_perm_b32 v30, v30, v31, s45
    s_waitcnt lgkmcnt(0)
    v_add3_u32 v34, v34, v106, s54
    v_sub_u32 v35, 0, v34
    v_and_b32 v35, 3, v35
    s_mov_b64 exec, s[80:81]
    v_mov_b32 v35, 0
    v_mov_b32 v30, 0
    s_mov_b64 exec, vcc
    v_mov_b32 v35, 3

    s_mov_b64 exec, -1
    v_alignbyte_b32 v29, v30, v28, v35
    v_alignbyte_b32 v28, v28, v32, v35
    v_add_u32 v34, v34, v35

    buffer_store_dwordx2 v[28:29], v34, s[24:27], 0 offen
L_skw_44:
    s_bitcmp0_b32 s28, 2
    s_cbranch_scc1 L_skw_45
    v_add_u32 v107, 65536, v2
    ds_read_b64 v[4:5], v107 offset:24592
    ds_read_b64 v[6:7], v107 offset:24600
    ds_read_b64 v[8:9], v107 offset:24584

    ds_read_b64 v[12:13], v107 offset:32784
    ds_read_b64 v[14:15], v107 offset:32792
    ds_read_b64 v[16:17], v107 offset:32776

    ds_read_b64 v[20:21], v107 offset:40976
    ds_read_b64 v[22:23], v107 offset:40984
    ds_read_b64 v[24:25], v107 offset:40968

    ds_read_b64 v[28:29], v107 offset:49168
    ds_read_b64 v[30:31], v107 offset:49176
    ds_read_b64 v[32:33], v107 offset:49160

    s_waitcnt lgkmcnt(9)
    v_lshrrev_b32 v10, 16, v5
    ds_read_b32 v10, v10 offset:16384

    s_waitcnt lgkmcnt(7)
    v_lshrrev_b32 v18, 16, v13
    ds_read_b32 v18, v18 offset:16384

    s_waitcnt lgkmcnt(5)
    v_lshrrev_b32 v26, 16, v21
    ds_read_b32 v26, v26 offset:16384

    s_waitcnt lgkmcnt(3)
    v_lshrrev_b32 v34, 16, v29
    ds_read_b32 v34, v34 offset:16384

    v_cmp_ne_u32_sdwa s[80:81], v5, v7 src0_sel:WORD_1 src1_sel:WORD_1
    v_cmp_ne_u32_sdwa vcc, v5, v9 src0_sel:WORD_1 src1_sel:WORD_1
    v_alignbyte_b32 v8, v5, v8, 1
    s_mov_b32 s54, 40957
    v_perm_b32 v6, v6, v7, s45
    s_waitcnt lgkmcnt(3)
    v_add3_u32 v10, v10, v106, s54
    v_sub_u32 v11, 0, v10
    v_and_b32 v11, 3, v11
    s_mov_b64 exec, s[80:81]
    v_mov_b32 v11, 0
    v_mov_b32 v6, 0
    s_mov_b64 exec, vcc
    v_mov_b32 v11, 3

    s_mov_b64 exec, -1
    v_alignbyte_b32 v5, v6, v4, v11
    v_alignbyte_b32 v4, v4, v8, v11
    v_add_u32 v10, v10, v11

    buffer_store_dwordx2 v[4:5], v10, s[24:27], 0 offen
    v_cmp_ne_u32_sdwa s[80:81], v13, v15 src0_sel:WORD_1 src1_sel:WORD_1
    v_cmp_ne_u32_sdwa vcc, v13, v17 src0_sel:WORD_1 src1_sel:WORD_1
    v_alignbyte_b32 v16, v13, v16, 1
    s_mov_b32 s54, 46077
    v_perm_b32 v14, v14, v15, s45
    s_waitcnt lgkmcnt(2)
    v_add3_u32 v18, v18, v106, s54
    v_sub_u32 v19, 0, v18
    v_and_b32 v19, 3, v19
    s_mov_b64 exec, s[80:81]
    v_mov_b32 v19, 0
    v_mov_b32 v14, 0
    s_mov_b64 exec, vcc
    v_mov_b32 v19, 3

    s_mov_b64 exec, -1
    v_alignbyte_b32 v13, v14, v12, v19
    v_alignbyte_b32 v12, v12, v16, v19
    v_add_u32 v18, v18, v19

    buffer_store_dwordx2 v[12:13], v18, s[24:27], 0 offen
    v_cmp_ne_u32_sdwa s[80:81], v21, v23 src0_sel:WORD_1 src1_sel:WORD_1
    v_cmp_ne_u32_sdwa vcc, v21, v25 src0_sel:WORD_1 src1_sel:WORD_1
    v_alignbyte_b32 v24, v21, v24, 1
    s_mov_b32 s54, 51197
    v_perm_b32 v22, v22, v23, s45
    s_waitcnt lgkmcnt(1)
    v_add3_u32 v26, v26, v106, s54
    v_sub_u32 v27, 0, v26
    v_and_b32 v27, 3, v27
    s_mov_b64 exec, s[80:81]
    v_mov_b32 v27, 0
    v_mov_b32 v22, 0
    s_mov_b64 exec, vcc
    v_mov_b32 v27, 3

    s_mov_b64 exec, -1
    v_alignbyte_b32 v21, v22, v20, v27
    v_alignbyte_b32 v20, v20, v24, v27
    v_add_u32 v26, v26, v27

    buffer_store_dwordx2 v[20:21], v26, s[24:27], 0 offen
    v_cmp_ne_u32_sdwa s[80:81], v29, v31 src0_sel:WORD_1 src1_sel:WORD_1
    v_cmp_ne_u32_sdwa vcc, v29, v33 src0_sel:WORD_1 src1_sel:WORD_1
    v_alignbyte_b32 v32, v29, v32, 1
    s_mov_b32 s54, 56317
    v_perm_b32 v30, v30, v31, s45
    s_waitcnt lgkmcnt(0)
    v_add3_u32 v34, v34, v106, s54
    v_sub_u32 v35, 0, v34
    v_and_b32 v35, 3, v35
    s_mov_b64 exec, s[80:81]
    v_mov_b32 v35, 0
    v_mov_b32 v30, 0
    s_mov_b64 exec, vcc
    v_mov_b32 v35, 3

    s_mov_b64 exec, -1
    v_alignbyte_b32 v29, v30, v28, v35
    v_alignbyte_b32 v28, v28, v32, v35
    v_add_u32 v34, v34, v35

    buffer_store_dwordx2 v[28:29], v34, s[24:27], 0 offen
L_skw_45:
    s_bitcmp0_b32 s28, 3
    s_cbranch_scc1 L_skw_46
    v_add_u32 v107, 98304, v2
    ds_read_b64 v[4:5], v107 offset:24592
    ds_read_b64 v[6:7], v107 offset:24600
    ds_read_b64 v[8:9], v107 offset:24584

    ds_read_b64 v[12:13], v107 offset:32784
    ds_read_b64 v[14:15], v107 offset:32792
    ds_read_b64 v[16:17], v107 offset:32776

    ds_read_b64 v[20:21], v107 offset:40976
    ds_read_b64 v[22:23], v107 offset:40984
    ds_read_b64 v[24:25], v107 offset:40968

    ds_read_b64 v[28:29], v107 offset:49168
    ds_read_b64 v[30:31], v107 offset:49176
    ds_read_b64 v[32:33], v107 offset:49160

    s_waitcnt lgkmcnt(9)
    v_lshrrev_b32 v10, 16, v5
    ds_read_b32 v10, v10 offset:16384

    s_waitcnt lgkmcnt(7)
    v_lshrrev_b32 v18, 16, v13
    ds_read_b32 v18, v18 offset:16384

    s_waitcnt lgkmcnt(5)
    v_lshrrev_b32 v26, 16, v21
    ds_read_b32 v26, v26 offset:16384

    s_waitcnt lgkmcnt(3)
    v_lshrrev_b32 v34, 16, v29
    ds_read_b32 v34, v34 offset:16384

    v_cmp_ne_u32_sdwa s[80:81], v5, v7 src0_sel:WORD_1 src1_sel:WORD_1
    v_cmp_ne_u32_sdwa vcc, v5, v9 src0_sel:WORD_1 src1_sel:WORD_1
    v_alignbyte_b32 v8, v5, v8, 1
    s_mov_b32 s54, 61437
    v_perm_b32 v6, v6, v7, s45
    s_waitcnt lgkmcnt(3)
    v_add3_u32 v10, v10, v106, s54
    v_sub_u32 v11, 0, v10
    v_and_b32 v11, 3, v11
    s_mov_b64 exec, s[80:81]
    v_mov_b32 v11, 0
    v_mov_b32 v6, 0
    s_mov_b64 exec, vcc
    v_mov_b32 v11, 3

    s_mov_b64 exec, -1
    v_alignbyte_b32 v5, v6, v4, v11
    v_alignbyte_b32 v4, v4, v8, v11
    v_add_u32 v10, v10, v11

    buffer_store_dwordx2 v[4:5], v10, s[24:27], 0 offen
    v_cmp_ne_u32_sdwa s[80:81], v13, v15 src0_sel:WORD_1 src1_sel:WORD_1
    v_cmp_ne_u32_sdwa vcc, v13, v17 src0_sel:WORD_1 src1_sel:WORD_1
    v_alignbyte_b32 v16, v13, v16, 1
    s_mov_b32 s54, 66557
    v_perm_b32 v14, v14, v15, s45
    s_waitcnt lgkmcnt(2)
    v_add3_u32 v18, v18, v106, s54
    v_sub_u32 v19, 0, v18
    v_and_b32 v19, 3, v19
    s_mov_b64 exec, s[80:81]
    v_mov_b32 v19, 0
    v_mov_b32 v14, 0
    s_mov_b64 exec, vcc
    v_mov_b32 v19, 3

    s_mov_b64 exec, -1
    v_alignbyte_b32 v13, v14, v12, v19
    v_alignbyte_b32 v12, v12, v16, v19
    v_add_u32 v18, v18, v19

    buffer_store_dwordx2 v[12:13], v18, s[24:27], 0 offen
    v_cmp_ne_u32_sdwa s[80:81], v21, v23 src0_sel:WORD_1 src1_sel:WORD_1
    v_cmp_ne_u32_sdwa vcc, v21, v25 src0_sel:WORD_1 src1_sel:WORD_1
    v_alignbyte_b32 v24, v21, v24, 1
    s_mov_b32 s54, 71677
    v_perm_b32 v22, v22, v23, s45
    s_waitcnt lgkmcnt(1)
    v_add3_u32 v26, v26, v106, s54
    v_sub_u32 v27, 0, v26
    v_and_b32 v27, 3, v27
    s_mov_b64 exec, s[80:81]
    v_mov_b32 v27, 0
    v_mov_b32 v22, 0
    s_mov_b64 exec, vcc
    v_mov_b32 v27, 3

    s_mov_b64 exec, -1
    v_alignbyte_b32 v21, v22, v20, v27
    v_alignbyte_b32 v20, v20, v24, v27
    v_add_u32 v26, v26, v27

    buffer_store_dwordx2 v[20:21], v26, s[24:27], 0 offen
    v_cmp_ne_u32_sdwa s[80:81], v29, v31 src0_sel:WORD_1 src1_sel:WORD_1
    v_cmp_ne_u32_sdwa vcc, v29, v33 src0_sel:WORD_1 src1_sel:WORD_1
    v_alignbyte_b32 v32, v29, v32, 1
    s_mov_b32 s54, 76797
    v_perm_b32 v30, v30, v31, s45
    s_waitcnt lgkmcnt(0)
    v_add3_u32 v34, v34, v106, s54
    v_sub_u32 v35, 0, v34
    v_and_b32 v35, 3, v35
    s_mov_b64 exec, s[80:81]
    v_mov_b32 v35, 0
    v_mov_b32 v30, 0
    s_mov_b64 exec, vcc
    v_mov_b32 v35, 3

    s_mov_b64 exec, -1
    v_alignbyte_b32 v29, v30, v28, v35
    v_alignbyte_b32 v28, v28, v32, v35
    v_add_u32 v34, v34, v35

    buffer_store_dwordx2 v[28:29], v34, s[24:27], 0 offen
L_skw_46:
L_p1done_1:
    s_endpgm

L_ska_8:
    v_bfrev_b32 v126, 1
    buffer_load_dword v3, v126, s[96:99], 0 offen
    buffer_load_dword v3, v126, s[96:99], 0 offen
    buffer_load_dword v3, v126, s[96:99], 0 offen
    s_branch L_bka_9
L_ska_10:
    v_bfrev_b32 v126, 1
    buffer_load_dword v3, v126, s[96:99], 0 offen
    buffer_load_dword v3, v126, s[96:99], 0 offen
    buffer_load_dword v3, v126, s[96:99], 0 offen
    s_branch L_bka_11
L_ska_12:
    v_bfrev_b32 v126, 1
    buffer_load_dword v3, v126, s[96:99], 0 offen
    buffer_load_dword v3, v126, s[96:99], 0 offen
    buffer_load_dword v3, v126, s[96:99], 0 offen
    s_branch L_bka_13
L_ska_14:
    v_bfrev_b32 v126, 1
    buffer_load_dword v3, v126, s[96:99], 0 offen
    buffer_load_dword v3, v126, s[96:99], 0 offen
    buffer_load_dword v3, v126, s[96:99], 0 offen
    s_branch L_bka_15
L_full_27:
    v_mov_b32 v110, 0
    s_mov_b64 exec, vcc
    v_bfrev_b32 v92, 1
    v_bfrev_b32 v93, 1
    s_mov_b64 exec, 1
    buffer_atomic_or v104, v110, s[36:39], 0 offen
    s_mov_b64 exec, -1
    s_branch L_fback_28

L_full_41:
    v_mov_b32 v110, 0
    s_mov_b64 exec, vcc
    v_bfrev_b32 v92, 1
    v_bfrev_b32 v93, 1
    s_mov_b64 exec, 1
    buffer_atomic_or v104, v110, s[36:39], 0 offen
    s_mov_b64 exec, -1
    s_branch L_fback_42

.globl standalone__molecular_angular_gemnet__graph_kernel
.p2align 8
.type standalone__molecular_angular_gemnet__graph_kernel,@function
standalone__molecular_angular_gemnet__graph_kernel:
    s_cmp_ge_u32 s2, 256
    s_cbranch_scc1 L_p2done_47
    s_load_dwordx2 s[8:9], s[0:1], 0
    s_load_dwordx2 s[6:7], s[0:1], 104
    v_lshrrev_b32 v4, 6, v0
    s_lshr_b32 s37, s2, 1
    s_and_b32 s37, s37, 3
    s_lshr_b32 s36, s2, 3
    s_lshl_b32 s36, s36, 1
    s_and_b32 s3, s2, 1
    s_or_b32 s36, s36, s3
    v_readfirstlane_b32 s4, v4
    v_and_b32 v2, 63, v0
    v_lshrrev_b32 v3, 9, v0
    v_lshl_or_b32 v2, v3, 6, v2
    v_mul_u32_u24 v2, 20, v2
    v_lshlrev_b32 v3, 4, v0

    s_waitcnt lgkmcnt(0)
    s_lshl_b32 m0, s4, 10
    s_and_b32 s5, s4, 7
    s_lshr_b32 s39, s4, 3
    s_lshl_b32 s39, s39, 8
    s_mul_i32 s3, s5, 4096
    s_add_u32 s46, s6, s3
    s_addc_u32 s47, s7, 0
    s_mul_i32 s3, s5, 67117056
    s_add_u32 s3, s3, 85721088
    s_add_u32 s44, s6, s3
    s_addc_u32 s45, s7, 0
    s_mul_i32 s38, s37, 8
    s_add_u32 s4, s38, 8
    s_lshl_b32 s3, s36, 5
    s_add_u32 s3, s3, s38
    s_lshl_b32 s3, s3, 1
    s_load_dwordx4 s[92:95], s[46:47], s3
    s_mov_b32 s3, 32768
    s_load_dword s51, s[6:7], s3
    s_mov_b32 s10, 6400000
    s_mov_b32 s11, 0x20000

    s_add_u32 s12, s6, 2490368
    s_addc_u32 s13, s7, 0
    s_mov_b32 s14, 0
    s_mov_b32 s15, 0x20000
    s_add_u32 s60, s6, 2490368
    s_addc_u32 s61, s7, 0
    s_mov_b32 s62, 6406144
    s_mov_b32 s63, 0x20000
    s_mov_b32 s3, 135176
    s_load_dword s33, s[6:7], s3

    s_mul_i32 s43, s38, 200192
    s_mul_i32 s41, s4, 200192
    s_mul_i32 s50, s38, 200000
    s_add_u32 s14, s43, 50000

    buffer_load_dwordx4 v[76:79], v3, s[12:15], s43 offen
    s_add_u32 s52, s43, 16384
    buffer_load_dwordx4 v[80:83], v3, s[12:15], s52 offen
    s_add_u32 s52, s43, 32768
    buffer_load_dwordx4 v[84:87], v3, s[12:15], s52 offen
    s_add_u32 s52, s43, 49152
    v_lshlrev_b32 v119, 2, v0
    buffer_load_dword v88, v119, s[12:15], s52 offen
    s_add_u32 s20, s6, 135168
    s_addc_u32 s21, s7, 0
    s_mov_b32 s22, 4096
    s_mov_b32 s23, 0x20000
    v_and_b32 v44, 63, v0
    v_lshlrev_b32 v44, 4, v44
    buffer_load_dwordx2 v[120:121], v44, s[20:23], 0 offen offset:0
    buffer_load_dwordx2 v[122:123], v44, s[20:23], 0 offen offset:1024
    buffer_load_dwordx2 v[124:125], v44, s[20:23], 0 offen offset:2048
    buffer_load_dwordx2 v[126:127], v44, s[20:23], 0 offen offset:3072
    s_movk_i32 s40, 3072
    s_mov_b32 s19, 0x20000
    s_min_u32 s40, s40, 6524
    s_lshl_b32 s52, s38, 6
    s_add_u32 s52, s52, s36
    s_mul_i32 s52, s52, 32764
    s_and_b32 s52, s52, 0xffffff80
    s_add_u32 s16, s44, s52
    s_addc_u32 s17, s45, 0
    s_mul_i32 s52, s40, 5
    s_add_u32 s52, s52, 3
    s_and_b32 s18, s52, -4

    s_movk_i32 s53, 5120
    buffer_load_dwordx4 v[90:93], v2, s[16:19], s53 offen offset:4
    buffer_load_dword v110, v2, s[16:19], s53 offen
    s_movk_i32 s53, 7680
    buffer_load_dwordx4 v[94:97], v2, s[16:19], s53 offen offset:4
    buffer_load_dword v111, v2, s[16:19], s53 offen
    s_movk_i32 s53, 10240
    buffer_load_dwordx4 v[98:101], v2, s[16:19], s53 offen offset:4
    buffer_load_dword v112, v2, s[16:19], s53 offen
    s_lshr_b32 s3, s2, 3
    s_mul_i32 s3, s3, 49
    v_add_lshl_u32 v89, v0, s3, 7
    v_cmp_gt_u32 vcc, 49, v0
    v_bfrev_b32 v28, 1
    s_nop 0
    v_cndmask_b32 v89, v28, v89, vcc

    s_mov_b32 s19, 0x20000
    s_mov_b32 s28, 0x4b404000
    s_mov_b32 s29, 0x4b404000
    s_mov_b32 s30, 0xbfffc000
    s_mov_b32 s31, 0xbfffbfff
    s_mov_b32 s32, 0xffff0000
    s_mov_b32 s35, 0x05040100
    s_mov_b32 s97, 0x07060302
    s_mov_b32 s96, 0x40008000
    s_movk_i32 s3, 212
    v_cmp_gt_u32 s[48:49], s3, v0

    v_mov_b32 v1, 0
    s_mov_b32 s24, 0x0c0c0004
    v_mov_b32 v28, 0x40004000
    v_mov_b32 v29, 0x40004000
    v_mov_b32 v30, 0x40004000
    v_mov_b32 v31, 0x40004000
    v_add_u32 v32, 50000, v3
    v_add_u32 v33, 65536, v32

    ds_write_b128 v32, v[28:31] offset:0
    ds_write_b128 v32, v[28:31] offset:16384
    ds_write_b128 v32, v[28:31] offset:32768
    ds_write_b128 v32, v[28:31] offset:49152
    ds_write_b128 v33, v[28:31] offset:0
    ds_write_b128 v33, v[28:31] offset:16384
    v_cmp_gt_u32 vcc, 971, v0
    s_mov_b64 exec, vcc
    ds_write_b128 v33, v[28:31] offset:32768
    s_mov_b64 exec, -1
    s_waitcnt vmcnt(13)
    ds_write_addtid_b32 v76 offset:0
    ds_write_addtid_b32 v77 offset:256
    ds_write_addtid_b32 v78 offset:512
    ds_write_addtid_b32 v79 offset:768
    s_waitcnt vmcnt(12)
    ds_write_addtid_b32 v80 offset:16384
    ds_write_addtid_b32 v81 offset:16640
    ds_write_addtid_b32 v82 offset:16896
    ds_write_addtid_b32 v83 offset:17152
    s_waitcnt vmcnt(11)
    ds_write_addtid_b32 v84 offset:32768
    ds_write_addtid_b32 v85 offset:33024
    ds_write_addtid_b32 v86 offset:33280
    ds_write_addtid_b32 v87 offset:33536
    v_lshlrev_b32 v119, 2, v0
    s_waitcnt vmcnt(10)
    s_mov_b64 exec, s[48:49]
    ds_write_b32 v119, v88 offset:49152
    s_mov_b64 exec, -1
    s_add_u32 s43, s43, 50048
    s_add_u32 s14, s43, 50000
    s_min_u32 s14, s14, s41
    s_waitcnt lgkmcnt(0)
    s_and_b32 s88, s92, 0xffff
    s_lshr_b32 s89, s92, 16
    s_and_b32 s90, s93, 0xffff
    s_lshr_b32 s91, s93, 16
    s_and_b32 s92, s94, 0xffff
    s_lshr_b32 s93, s94, 16
    s_and_b32 s94, s95, 0xffff
    s_lshr_b32 s95, s95, 16
    s_waitcnt vmcnt(6)
    v_max3_u32 v120, v120, v122, v124
    v_add_f32 v121, v121, v123
    v_add_f32 v125, v125, v127
    v_max_u32 v120, v120, v126
    v_add_f32 v121, v121, v125

    s_nop 1
    v_max_u32_dpp v120, v120, v120 row_shr:1 row_mask:0xf bank_mask:0xf
    s_nop 1
    v_max_u32_dpp v120, v120, v120 row_shr:2 row_mask:0xf bank_mask:0xf
    s_nop 1
    v_max_u32_dpp v120, v120, v120 row_shr:4 row_mask:0xf bank_mask:0xf
    s_nop 1
    v_max_u32_dpp v120, v120, v120 row_shr:8 row_mask:0xf bank_mask:0xf
    s_nop 1
    v_max_u32_dpp v120, v120, v120 row_bcast:15 row_mask:0xa bank_mask:0xf
    s_nop 1
    v_max_u32_dpp v120, v120, v120 row_bcast:31 row_mask:0xc bank_mask:0xf
    s_nop 1
    v_add_f32_dpp v121, v121, v121 row_shr:1 row_mask:0xf bank_mask:0xf
    s_nop 1
    v_add_f32_dpp v121, v121, v121 row_shr:2 row_mask:0xf bank_mask:0xf
    s_nop 1
    v_add_f32_dpp v121, v121, v121 row_shr:4 row_mask:0xf bank_mask:0xf
    s_nop 1
    v_add_f32_dpp v121, v121, v121 row_shr:8 row_mask:0xf bank_mask:0xf
    s_nop 1
    v_add_f32_dpp v121, v121, v121 row_bcast:15 row_mask:0xa bank_mask:0xf
    s_nop 1
    v_add_f32_dpp v121, v121, v121 row_bcast:31 row_mask:0xc bank_mask:0xf
    v_lshlrev_b32 v120, 16, v120
    v_mul_f32 v121, 0x34a7c5ac, v121
    v_sqrt_f32 v121, v121
    v_mul_f32 v120, s33, v120
    v_mul_f32 v121, s33, v121
    v_cmp_gt_f32 vcc, 0x46fde800, v120
    s_mov_b64 s[64:65], vcc
    v_cmp_lt_f32 vcc, 0x44000000, v121
    v_mov_b32 v120, 0x37800000
    v_mul_f32 v120, s33, v120
    s_and_b64 vcc, vcc, s[64:65]
    v_mul_f32 v121, 0x46ff8000, v120
    v_rcp_f32 v121, v121
    v_readfirstlane_b32 s33, v120
    s_waitcnt lgkmcnt(0)
    s_barrier
    v_readfirstlane_b32 s34, v121
    v_mov_b32 v120, 150016
    v_mov_b32 v121, 0
    ds_write_b32 v120, v121 offset:8
    s_bitcmp0_b64 vcc, 63
    s_cbranch_scc1 L_p2slow_48
    s_cmp_lg_u32 s51, 0
    s_cbranch_scc1 L_p2slow_48

    s_min_u32 s88, s88, 6524
    s_lshl_b32 s52, s38, 6
    s_add_u32 s52, s52, s36
    s_mul_i32 s52, s52, 32764
    s_and_b32 s52, s52, 0xffffff80
    s_add_u32 s16, s44, s52
    s_addc_u32 s17, s45, 0
    s_mul_i32 s52, s88, 5
    s_add_u32 s52, s52, 3
    s_and_b32 s18, s52, -4

    s_movk_i32 s53, 12800
    buffer_load_dwordx4 v[102:105], v2, s[16:19], s53 offen offset:4
    buffer_load_dword v113, v2, s[16:19], s53 offen
    s_movk_i32 s53, 0
    buffer_load_dwordx4 v[4:7], v2, s[16:19], s53 offen offset:4 nt
    buffer_load_dword v35, v2, s[16:19], s53 offen nt
    s_movk_i32 s53, 2560
    buffer_load_dwordx4 v[8:11], v2, s[16:19], s53 offen offset:4
    buffer_load_dword v43, v2, s[16:19], s53 offen
    s_movk_i32 s53, 15360
    buffer_load_dwordx4 v[106:109], v2, s[16:19], s53 offen offset:4
    buffer_load_dword v114, v2, s[16:19], s53 offen
    s_mov_b32 s40, s88
    s_sub_u32 s42, s40, s39

    s_add_u32 s55, s38, 1
    s_min_u32 s55, s55, 31
    s_mov_b32 s88, s89
    s_mov_b32 s89, s90
    s_mov_b32 s90, s91
    s_mov_b32 s91, s92
    s_mov_b32 s92, s93
    s_mov_b32 s93, s94
    s_mov_b32 s94, s95
    s_mov_b32 s95, 0
    s_min_u32 s88, s88, 6524
    s_lshl_b32 s52, s55, 6
    s_add_u32 s52, s52, s36
    s_mul_i32 s52, s52, 32764
    s_and_b32 s52, s52, 0xffffff80
    s_add_u32 s16, s44, s52
    s_addc_u32 s17, s45, 0
    s_mul_i32 s52, s88, 5
    s_add_u32 s52, s52, 3
    s_and_b32 s18, s52, -4

    s_waitcnt vmcnt(12)
    v_lshlrev_b32_sdwa v44, 3, v110 dst_sel:WORD_0 dst_unused:UNUSED_PAD src0_sel:DWORD src1_sel:DWORD
    v_lshrrev_b32 v46, 5, v90
    v_lshlrev_b32_sdwa v48, 3, v91 dst_sel:WORD_0 dst_unused:UNUSED_PAD src0_sel:DWORD src1_sel:WORD_1
    v_alignbit_b32 v50, v93, v92, 21

    v_mov_b32 v15, v93
    v_alignbyte_b32 v14, v92, v91, 3
    v_alignbyte_b32 v13, v91, v90, 2
    v_alignbyte_b32 v12, v90, v110, 1
    v_and_b32 v46, 0xfff8, v46
    v_and_b32 v50, 0xfff8, v50
    s_cmp_lt_i32 s42, 1280
    s_cbranch_scc1 L_ufix_49
L_uback_50:

    v_subrev_co_u32 v12, s[80:81], 2.0, v12
    v_subrev_co_u32 v13, s[82:83], 2.0, v13
    v_subrev_co_u32 v14, s[84:85], 2.0, v14
    v_subrev_co_u32 v15, s[86:87], 2.0, v15
    s_mov_b64 exec, s[80:81]
    ds_read_b64 v[44:45], v44
    s_mov_b64 exec, s[82:83]
    ds_read_b64 v[46:47], v46
    s_mov_b64 exec, s[84:85]
    ds_read_b64 v[48:49], v48
    s_mov_b64 exec, s[86:87]
    ds_read_b64 v[50:51], v50
    s_mov_b64 exec, -1
    s_waitcnt vmcnt(10)
    v_lshlrev_b32_sdwa v52, 3, v111 dst_sel:WORD_0 dst_unused:UNUSED_PAD src0_sel:DWORD src1_sel:DWORD
    v_lshrrev_b32 v54, 5, v94
    v_lshlrev_b32_sdwa v56, 3, v95 dst_sel:WORD_0 dst_unused:UNUSED_PAD src0_sel:DWORD src1_sel:WORD_1
    v_alignbit_b32 v58, v97, v96, 21

    v_mov_b32 v19, v97
    v_alignbyte_b32 v18, v96, v95, 3
    v_alignbyte_b32 v17, v95, v94, 2
    v_alignbyte_b32 v16, v94, v111, 1
    v_and_b32 v54, 0xfff8, v54
    v_and_b32 v58, 0xfff8, v58
    s_cmp_lt_i32 s42, 1792
    s_cbranch_scc1 L_ufix_51
L_uback_52:

    v_subrev_co_u32 v16, s[64:65], 2.0, v16
    v_subrev_co_u32 v17, s[66:67], 2.0, v17
    v_subrev_co_u32 v18, s[68:69], 2.0, v18
    v_subrev_co_u32 v19, s[70:71], 2.0, v19
    s_mov_b64 exec, s[64:65]
    ds_read_b64 v[52:53], v52
    s_mov_b64 exec, s[66:67]
    ds_read_b64 v[54:55], v54
    s_mov_b64 exec, s[68:69]
    ds_read_b64 v[56:57], v56
    s_mov_b64 exec, s[70:71]
    ds_read_b64 v[58:59], v58
    s_mov_b64 exec, -1
    s_waitcnt vmcnt(8)
    v_lshlrev_b32_sdwa v60, 3, v112 dst_sel:WORD_0 dst_unused:UNUSED_PAD src0_sel:DWORD src1_sel:DWORD
    v_lshrrev_b32 v62, 5, v98
    v_lshlrev_b32_sdwa v64, 3, v99 dst_sel:WORD_0 dst_unused:UNUSED_PAD src0_sel:DWORD src1_sel:WORD_1
    v_alignbit_b32 v66, v101, v100, 21

    v_mov_b32 v23, v101
    v_alignbyte_b32 v22, v100, v99, 3
    v_alignbyte_b32 v21, v99, v98, 2
    v_alignbyte_b32 v20, v98, v112, 1
    v_and_b32 v62, 0xfff8, v62
    v_and_b32 v66, 0xfff8, v66
    s_cmp_lt_i32 s42, 2304
    s_cbranch_scc1 L_ufix_53
L_uback_54:

    v_subrev_co_u32 v20, s[72:73], 2.0, v20
    v_subrev_co_u32 v21, s[74:75], 2.0, v21
    v_subrev_co_u32 v22, s[76:77], 2.0, v22
    v_subrev_co_u32 v23, s[78:79], 2.0, v23
    s_mov_b64 exec, s[72:73]
    ds_read_b64 v[60:61], v60
    s_mov_b64 exec, s[74:75]
    ds_read_b64 v[62:63], v62
    s_mov_b64 exec, s[76:77]
    ds_read_b64 v[64:65], v64
    s_mov_b64 exec, s[78:79]
    ds_read_b64 v[66:67], v66
    s_mov_b64 exec, -1
    s_waitcnt vmcnt(6)
    v_lshlrev_b32_sdwa v68, 3, v113 dst_sel:WORD_0 dst_unused:UNUSED_PAD src0_sel:DWORD src1_sel:DWORD
    v_lshrrev_b32 v70, 5, v102
    v_lshlrev_b32_sdwa v72, 3, v103 dst_sel:WORD_0 dst_unused:UNUSED_PAD src0_sel:DWORD src1_sel:WORD_1
    v_alignbit_b32 v74, v105, v104, 21

    v_mov_b32 v27, v105
    v_alignbyte_b32 v26, v104, v103, 3
    v_alignbyte_b32 v25, v103, v102, 2
    v_alignbyte_b32 v24, v102, v113, 1
    v_and_b32 v70, 0xfff8, v70
    v_and_b32 v74, 0xfff8, v74
    s_cmp_lt_i32 s42, 2816
    s_cbranch_scc1 L_ufix_55
L_uback_56:

    v_subrev_co_u32 v24, s[80:81], 2.0, v24
    v_subrev_co_u32 v25, s[82:83], 2.0, v25
    v_subrev_co_u32 v26, s[84:85], 2.0, v26
    v_subrev_co_u32 v27, s[86:87], 2.0, v27
    s_mov_b64 exec, s[80:81]
    ds_read_b64 v[68:69], v68
    s_mov_b64 exec, s[82:83]
    ds_read_b64 v[70:71], v70
    s_mov_b64 exec, s[84:85]
    ds_read_b64 v[72:73], v72
    s_mov_b64 exec, s[86:87]
    ds_read_b64 v[74:75], v74
    s_mov_b64 exec, -1
    s_waitcnt vmcnt(4)
    v_lshlrev_b32_sdwa v28, 3, v35 dst_sel:WORD_0 dst_unused:UNUSED_PAD src0_sel:DWORD src1_sel:DWORD
    v_lshrrev_b32 v30, 5, v4
    v_lshlrev_b32_sdwa v32, 3, v5 dst_sel:WORD_0 dst_unused:UNUSED_PAD src0_sel:DWORD src1_sel:WORD_1
    v_alignbit_b32 v34, v7, v6, 21

    v_alignbyte_b32 v6, v6, v5, 3
    v_alignbyte_b32 v5, v5, v4, 2
    v_alignbyte_b32 v4, v4, v35, 1
    v_and_b32 v30, 0xfff8, v30
    v_and_b32 v34, 0xfff8, v34
    s_cmp_lt_i32 s42, 256
    s_cbranch_scc1 L_ufix_57
L_uback_58:

    v_subrev_co_u32 v4, s[64:65], 2.0, v4
    v_subrev_co_u32 v5, s[66:67], 2.0, v5
    v_subrev_co_u32 v6, s[68:69], 2.0, v6
    v_subrev_co_u32 v7, s[70:71], 2.0, v7
    s_mov_b64 exec, s[64:65]
    ds_read_b64 v[28:29], v28
    s_mov_b64 exec, s[66:67]
    ds_read_b64 v[30:31], v30
    s_mov_b64 exec, s[68:69]
    ds_read_b64 v[32:33], v32
    s_mov_b64 exec, s[70:71]
    ds_read_b64 v[34:35], v34
    s_mov_b64 exec, -1
    buffer_load_dwordx4 v[76:79], v3, s[12:15], s43 offen
    s_add_u32 s52, s43, 16384
    buffer_load_dwordx4 v[80:83], v3, s[12:15], s52 offen
    s_add_u32 s52, s43, 32768
    buffer_load_dwordx4 v[84:87], v3, s[12:15], s52 offen
    s_add_u32 s52, s43, 49152
    v_lshlrev_b32 v119, 2, v0
    buffer_load_dword v88, v119, s[12:15], s52 offen
    s_add_u32 s54, s43, 50048
    buffer_load_dword v115, v89, s[60:63], s54 offen
    s_add_u32 s54, s50, 0
    buffer_load_dword v115, v89, s[8:11], s54 offen
    s_waitcnt vmcnt(8)
    v_lshlrev_b32_sdwa v36, 3, v43 dst_sel:WORD_0 dst_unused:UNUSED_PAD src0_sel:DWORD src1_sel:DWORD
    v_lshrrev_b32 v38, 5, v8
    v_lshlrev_b32_sdwa v40, 3, v9 dst_sel:WORD_0 dst_unused:UNUSED_PAD src0_sel:DWORD src1_sel:WORD_1
    v_alignbit_b32 v42, v11, v10, 21

    v_alignbyte_b32 v10, v10, v9, 3
    v_alignbyte_b32 v9, v9, v8, 2
    v_alignbyte_b32 v8, v8, v43, 1
    v_and_b32 v38, 0xfff8, v38
    v_and_b32 v42, 0xfff8, v42
    s_cmp_lt_i32 s42, 768
    s_cbranch_scc1 L_ufix_59
L_uback_60:

    v_subrev_co_u32 v8, s[72:73], 2.0, v8
    v_subrev_co_u32 v9, s[74:75], 2.0, v9
    v_subrev_co_u32 v10, s[76:77], 2.0, v10
    v_subrev_co_u32 v11, s[78:79], 2.0, v11
    s_mov_b64 exec, s[72:73]
    ds_read_b64 v[36:37], v36
    s_mov_b64 exec, s[74:75]
    ds_read_b64 v[38:39], v38
    s_mov_b64 exec, s[76:77]
    ds_read_b64 v[40:41], v40
    s_mov_b64 exec, s[78:79]
    ds_read_b64 v[42:43], v42
    s_mov_b64 exec, -1
    s_movk_i32 s53, 5120
    buffer_load_dwordx4 v[90:93], v2, s[16:19], s53 offen offset:4
    buffer_load_dword v110, v2, s[16:19], s53 offen
L_batch_61:
    s_add_u32 s5, s38, 1

    s_movk_i32 s53, 7680
    buffer_load_dwordx4 v[94:97], v2, s[16:19], s53 offen offset:4
    buffer_load_dword v111, v2, s[16:19], s53 offen
    v_subrev_co_u32 v4, s[64:65], 2.0, v4
    v_subrev_co_u32 v5, s[66:67], 2.0, v5
    v_subrev_co_u32 v6, s[68:69], 2.0, v6
    v_subrev_co_u32 v7, s[70:71], 2.0, v7
    v_subrev_co_u32 v8, s[72:73], 2.0, v8
    v_subrev_co_u32 v9, s[74:75], 2.0, v9
    v_subrev_co_u32 v10, s[76:77], 2.0, v10
    v_subrev_co_u32 v11, s[78:79], 2.0, v11
    v_subrev_co_u32 v12, s[80:81], 2.0, v12
    v_subrev_co_u32 v13, s[82:83], 2.0, v13
    v_subrev_co_u32 v14, s[84:85], 2.0, v14
    v_subrev_co_u32 v15, s[86:87], 2.0, v15
    s_waitcnt lgkmcnt(0)
    s_barrier
    s_waitcnt vmcnt(7)
    ds_write_addtid_b32 v76 offset:0
    ds_write_addtid_b32 v77 offset:256
    ds_write_addtid_b32 v78 offset:512
    ds_write_addtid_b32 v79 offset:768
    s_waitcnt vmcnt(6)
    ds_write_addtid_b32 v80 offset:16384
    ds_write_addtid_b32 v81 offset:16640
    ds_write_addtid_b32 v82 offset:16896
    ds_write_addtid_b32 v83 offset:17152
    s_waitcnt vmcnt(5)
    ds_write_addtid_b32 v84 offset:32768
    ds_write_addtid_b32 v85 offset:33024
    ds_write_addtid_b32 v86 offset:33280
    ds_write_addtid_b32 v87 offset:33536
    v_lshlrev_b32 v119, 2, v0
    s_waitcnt vmcnt(4)
    s_mov_b64 exec, s[48:49]
    ds_write_b32 v119, v88 offset:49152
    s_mov_b64 exec, -1
    s_add_u32 s43, s43, 50048
    s_add_u32 s14, s43, 50000
    s_min_u32 s14, s14, s41
    buffer_load_dwordx4 v[76:79], v3, s[12:15], s43 offen
    s_waitcnt lgkmcnt(0)
    s_barrier
    s_add_u32 s52, s43, 16384
    buffer_load_dwordx4 v[80:83], v3, s[12:15], s52 offen
    s_add_u32 s52, s43, 32768
    buffer_load_dwordx4 v[84:87], v3, s[12:15], s52 offen
    s_add_u32 s52, s43, 49152
    v_lshlrev_b32 v119, 2, v0
    buffer_load_dword v88, v119, s[12:15], s52 offen
    s_mov_b64 exec, s[64:65]
    ds_read_b64 v[28:29], v28
    s_mov_b64 exec, s[66:67]
    ds_read_b64 v[30:31], v30
    s_mov_b64 exec, s[68:69]
    ds_read_b64 v[32:33], v32
    s_mov_b64 exec, s[70:71]
    ds_read_b64 v[34:35], v34
    s_mov_b64 exec, s[72:73]
    ds_read_b64 v[36:37], v36
    s_mov_b64 exec, s[74:75]
    ds_read_b64 v[38:39], v38
    s_mov_b64 exec, s[76:77]
    ds_read_b64 v[40:41], v40
    s_mov_b64 exec, s[78:79]
    ds_read_b64 v[42:43], v42
    s_mov_b64 exec, s[80:81]
    ds_read_b64 v[44:45], v44
    s_mov_b64 exec, s[82:83]
    ds_read_b64 v[46:47], v46
    s_mov_b64 exec, s[84:85]
    ds_read_b64 v[48:49], v48
    s_mov_b64 exec, s[86:87]
    ds_read_b64 v[50:51], v50
    s_mov_b64 exec, -1
    v_subrev_co_u32 v16, s[64:65], 2.0, v16
    v_subrev_co_u32 v17, s[66:67], 2.0, v17
    v_subrev_co_u32 v18, s[68:69], 2.0, v18
    v_subrev_co_u32 v19, s[70:71], 2.0, v19
    v_subrev_co_u32 v20, s[72:73], 2.0, v20
    v_subrev_co_u32 v21, s[74:75], 2.0, v21
    v_subrev_co_u32 v22, s[76:77], 2.0, v22
    v_subrev_co_u32 v23, s[78:79], 2.0, v23
    v_subrev_co_u32 v24, s[80:81], 2.0, v24
    v_subrev_co_u32 v25, s[82:83], 2.0, v25
    v_subrev_co_u32 v26, s[84:85], 2.0, v26
    v_subrev_co_u32 v27, s[86:87], 2.0, v27
    s_mov_b64 exec, s[64:65]
    ds_read_b64 v[52:53], v52
    s_mov_b64 exec, s[66:67]
    ds_read_b64 v[54:55], v54
    s_mov_b64 exec, s[68:69]
    ds_read_b64 v[56:57], v56
    s_mov_b64 exec, s[70:71]
    ds_read_b64 v[58:59], v58
    s_mov_b64 exec, s[72:73]
    ds_read_b64 v[60:61], v60
    s_mov_b64 exec, s[74:75]
    ds_read_b64 v[62:63], v62
    s_mov_b64 exec, s[76:77]
    ds_read_b64 v[64:65], v64
    s_mov_b64 exec, s[78:79]
    ds_read_b64 v[66:67], v66
    s_mov_b64 exec, s[80:81]
    ds_read_b64 v[68:69], v68
    s_mov_b64 exec, s[82:83]
    ds_read_b64 v[70:71], v70
    s_mov_b64 exec, s[84:85]
    ds_read_b64 v[72:73], v72
    s_mov_b64 exec, s[86:87]
    ds_read_b64 v[74:75], v74
    s_mov_b64 exec, -1
    s_cmp_le_i32 s42, 3072
    s_cbranch_scc1 L_nt1_63
    s_waitcnt vmcnt(14)
    v_lshlrev_b32_sdwa v120, 3, v114 dst_sel:WORD_0 dst_unused:UNUSED_PAD src0_sel:DWORD src1_sel:DWORD
    v_lshrrev_b32 v122, 5, v106
    v_lshlrev_b32_sdwa v124, 3, v107 dst_sel:WORD_0 dst_unused:UNUSED_PAD src0_sel:DWORD src1_sel:WORD_1
    v_alignbit_b32 v126, v109, v108, 21

    v_alignbyte_b32 v108, v108, v107, 3
    v_alignbyte_b32 v107, v107, v106, 2
    v_alignbyte_b32 v106, v106, v114, 1
    v_and_b32 v122, 0xfff8, v122
    v_and_b32 v126, 0xfff8, v126
    s_cmp_lt_i32 s42, 3328
    s_cbranch_scc1 L_ufix_66
L_uback_67:

    v_lshrrev_b32 v117, 30, v106
    v_and_b32 v106, 0x3fffffff, v106
    v_mul_u32_u24 v117, 50000, v117
    v_cmp_ne_u32 vcc, 0, v106
    v_add_u32 v120, v120, v117
    s_mov_b64 exec, vcc

    buffer_load_dwordx2 v[120:121], v120, s[8:11], s50 offen
    s_mov_b64 exec, -1
    v_lshrrev_b32 v117, 30, v107
    v_and_b32 v107, 0x3fffffff, v107
    v_mul_u32_u24 v117, 50000, v117
    v_cmp_ne_u32 vcc, 0, v107
    v_add_u32 v122, v122, v117
    s_mov_b64 exec, vcc

    buffer_load_dwordx2 v[122:123], v122, s[8:11], s50 offen
    s_mov_b64 exec, -1
    v_lshrrev_b32 v117, 30, v108
    v_and_b32 v108, 0x3fffffff, v108
    v_mul_u32_u24 v117, 50000, v117
    v_cmp_ne_u32 vcc, 0, v108
    v_add_u32 v124, v124, v117
    s_mov_b64 exec, vcc

    buffer_load_dwordx2 v[124:125], v124, s[8:11], s50 offen
    s_mov_b64 exec, -1
    v_lshrrev_b32 v117, 30, v109
    v_and_b32 v109, 0x3fffffff, v109
    v_mul_u32_u24 v117, 50000, v117
    v_cmp_ne_u32 vcc, 0, v109
    v_add_u32 v126, v126, v117
    s_mov_b64 exec, vcc

    buffer_load_dwordx2 v[126:127], v126, s[8:11], s50 offen
    s_mov_b64 exec, -1
L_nt1_63:
    v_subrev_co_u32 v4, s[64:65], 2.0, v4
    v_subrev_co_u32 v5, s[66:67], 2.0, v5
    v_subrev_co_u32 v6, s[68:69], 2.0, v6
    v_subrev_co_u32 v7, s[70:71], 2.0, v7
    v_subrev_co_u32 v8, s[72:73], 2.0, v8
    v_subrev_co_u32 v9, s[74:75], 2.0, v9
    v_subrev_co_u32 v10, s[76:77], 2.0, v10
    v_subrev_co_u32 v11, s[78:79], 2.0, v11
    v_subrev_co_u32 v12, s[80:81], 2.0, v12
    v_subrev_co_u32 v13, s[82:83], 2.0, v13
    v_subrev_co_u32 v14, s[84:85], 2.0, v14
    v_subrev_co_u32 v15, s[86:87], 2.0, v15
    s_waitcnt lgkmcnt(0)
    s_barrier
    s_waitcnt vmcnt(3)
    ds_write_addtid_b32 v76 offset:0
    ds_write_addtid_b32 v77 offset:256
    ds_write_addtid_b32 v78 offset:512
    ds_write_addtid_b32 v79 offset:768
    s_waitcnt vmcnt(2)
    ds_write_addtid_b32 v80 offset:16384
    ds_write_addtid_b32 v81 offset:16640
    ds_write_addtid_b32 v82 offset:16896
    ds_write_addtid_b32 v83 offset:17152
    s_waitcnt vmcnt(1)
    ds_write_addtid_b32 v84 offset:32768
    ds_write_addtid_b32 v85 offset:33024
    ds_write_addtid_b32 v86 offset:33280
    ds_write_addtid_b32 v87 offset:33536
    v_lshlrev_b32 v119, 2, v0
    s_waitcnt vmcnt(0)
    s_mov_b64 exec, s[48:49]
    ds_write_b32 v119, v88 offset:49152
    s_mov_b64 exec, -1
    s_add_u32 s43, s43, 50048
    s_add_u32 s14, s43, 50000
    s_min_u32 s14, s14, s41
    buffer_load_dwordx4 v[76:79], v3, s[12:15], s43 offen
    s_waitcnt lgkmcnt(0)
    s_barrier
    s_add_u32 s52, s43, 16384
    buffer_load_dwordx4 v[80:83], v3, s[12:15], s52 offen
    s_add_u32 s52, s43, 32768
    buffer_load_dwordx4 v[84:87], v3, s[12:15], s52 offen
    s_add_u32 s52, s43, 49152
    v_lshlrev_b32 v119, 2, v0
    buffer_load_dword v88, v119, s[12:15], s52 offen
    s_mov_b64 exec, s[64:65]
    ds_read_b64 v[28:29], v28
    s_mov_b64 exec, s[66:67]
    ds_read_b64 v[30:31], v30
    s_mov_b64 exec, s[68:69]
    ds_read_b64 v[32:33], v32
    s_mov_b64 exec, s[70:71]
    ds_read_b64 v[34:35], v34
    s_mov_b64 exec, s[72:73]
    ds_read_b64 v[36:37], v36
    s_mov_b64 exec, s[74:75]
    ds_read_b64 v[38:39], v38
    s_mov_b64 exec, s[76:77]
    ds_read_b64 v[40:41], v40
    s_mov_b64 exec, s[78:79]
    ds_read_b64 v[42:43], v42
    s_mov_b64 exec, s[80:81]
    ds_read_b64 v[44:45], v44
    s_mov_b64 exec, s[82:83]
    ds_read_b64 v[46:47], v46
    s_mov_b64 exec, s[84:85]
    ds_read_b64 v[48:49], v48
    s_mov_b64 exec, s[86:87]
    ds_read_b64 v[50:51], v50
    s_mov_b64 exec, -1
    v_subrev_co_u32 v16, s[64:65], 2.0, v16
    v_subrev_co_u32 v17, s[66:67], 2.0, v17
    v_subrev_co_u32 v18, s[68:69], 2.0, v18
    v_subrev_co_u32 v19, s[70:71], 2.0, v19
    v_subrev_co_u32 v20, s[72:73], 2.0, v20
    v_subrev_co_u32 v21, s[74:75], 2.0, v21
    v_subrev_co_u32 v22, s[76:77], 2.0, v22
    v_subrev_co_u32 v23, s[78:79], 2.0, v23
    v_subrev_co_u32 v24, s[80:81], 2.0, v24
    v_subrev_co_u32 v25, s[82:83], 2.0, v25
    v_subrev_co_u32 v26, s[84:85], 2.0, v26
    v_subrev_co_u32 v27, s[86:87], 2.0, v27
    s_mov_b64 exec, s[64:65]
    ds_read_b64 v[52:53], v52
    s_mov_b64 exec, s[66:67]
    ds_read_b64 v[54:55], v54
    s_mov_b64 exec, s[68:69]
    ds_read_b64 v[56:57], v56
    s_mov_b64 exec, s[70:71]
    ds_read_b64 v[58:59], v58
    s_mov_b64 exec, s[72:73]
    ds_read_b64 v[60:61], v60
    s_mov_b64 exec, s[74:75]
    ds_read_b64 v[62:63], v62
    s_mov_b64 exec, s[76:77]
    ds_read_b64 v[64:65], v64
    s_mov_b64 exec, s[78:79]
    ds_read_b64 v[66:67], v66
    s_mov_b64 exec, s[80:81]
    ds_read_b64 v[68:69], v68
    s_mov_b64 exec, s[82:83]
    ds_read_b64 v[70:71], v70
    s_mov_b64 exec, s[84:85]
    ds_read_b64 v[72:73], v72
    s_mov_b64 exec, s[86:87]
    ds_read_b64 v[74:75], v74
    s_mov_b64 exec, -1
    s_movk_i32 s53, 10240
    buffer_load_dwordx4 v[98:101], v2, s[16:19], s53 offen offset:4
    buffer_load_dword v112, v2, s[16:19], s53 offen
    s_movk_i32 s53, 12800
    buffer_load_dwordx4 v[102:105], v2, s[16:19], s53 offen offset:4
    buffer_load_dword v113, v2, s[16:19], s53 offen
    s_cmp_le_i32 s42, 3072
    s_cbranch_scc1 L_nt2_64
    s_waitcnt vmcnt(8)
    v_cmp_ne_u32 s[56:57], 0, v106
    v_cmp_ne_u32 s[58:59], 0, v107
    v_cmp_ne_u32 s[98:99], 0, v108
    v_cmp_ne_u32 vcc, 0, v109
    s_mov_b64 exec, s[56:57]
    v_cvt_f32_i32_sdwa v118, sext(v106) dst_sel:DWORD dst_unused:UNUSED_PAD src0_sel:WORD_0
    v_lshlrev_b32 v116, 16, v120
    v_and_b32 v117, s32, v120
    v_mul_f32 v118, s33, v118
    v_lshlrev_b32 v120, 16, v121
    v_and_b32 v121, s32, v121
    v_lshlrev_b32_sdwa v106, 3, v106 dst_sel:DWORD dst_unused:UNUSED_PAD src0_sel:DWORD src1_sel:WORD_1
    v_pk_fma_f32 v[116:117], v[116:117], v[118:119], s[28:29] op_sel_hi:[1,0,1]
    v_pk_fma_f32 v[120:121], v[120:121], v[118:119], s[28:29] op_sel_hi:[1,0,1]
    v_perm_b32 v116, v117, v116, s35
    v_perm_b32 v117, v121, v120, s35
    v_lshl_add_u64 v[116:117], v[116:117], 0, s[30:31]
    ds_add_rtn_u64 v[120:121], v106, v[116:117] offset:50000

    s_mov_b64 exec, s[58:59]
    v_cvt_f32_i32_sdwa v118, sext(v107) dst_sel:DWORD dst_unused:UNUSED_PAD src0_sel:WORD_0
    v_lshlrev_b32 v116, 16, v122
    v_and_b32 v117, s32, v122
    v_mul_f32 v118, s33, v118
    v_lshlrev_b32 v122, 16, v123
    v_and_b32 v123, s32, v123
    v_lshlrev_b32_sdwa v107, 3, v107 dst_sel:DWORD dst_unused:UNUSED_PAD src0_sel:DWORD src1_sel:WORD_1
    v_pk_fma_f32 v[116:117], v[116:117], v[118:119], s[28:29] op_sel_hi:[1,0,1]
    v_pk_fma_f32 v[122:123], v[122:123], v[118:119], s[28:29] op_sel_hi:[1,0,1]
    v_perm_b32 v116, v117, v116, s35
    v_perm_b32 v117, v123, v122, s35
    v_lshl_add_u64 v[116:117], v[116:117], 0, s[30:31]
    ds_add_rtn_u64 v[122:123], v107, v[116:117] offset:50000

    s_mov_b64 exec, s[98:99]
    v_cvt_f32_i32_sdwa v118, sext(v108) dst_sel:DWORD dst_unused:UNUSED_PAD src0_sel:WORD_0
    v_lshlrev_b32 v116, 16, v124
    v_and_b32 v117, s32, v124
    v_mul_f32 v118, s33, v118
    v_lshlrev_b32 v124, 16, v125
    v_and_b32 v125, s32, v125
    v_lshlrev_b32_sdwa v108, 3, v108 dst_sel:DWORD dst_unused:UNUSED_PAD src0_sel:DWORD src1_sel:WORD_1
    v_pk_fma_f32 v[116:117], v[116:117], v[118:119], s[28:29] op_sel_hi:[1,0,1]
    v_pk_fma_f32 v[124:125], v[124:125], v[118:119], s[28:29] op_sel_hi:[1,0,1]
    v_perm_b32 v116, v117, v116, s35
    v_perm_b32 v117, v125, v124, s35
    v_lshl_add_u64 v[116:117], v[116:117], 0, s[30:31]
    ds_add_rtn_u64 v[124:125], v108, v[116:117] offset:50000

    s_mov_b64 exec, vcc
    v_cvt_f32_i32_sdwa v118, sext(v109) dst_sel:DWORD dst_unused:UNUSED_PAD src0_sel:WORD_0
    v_lshlrev_b32 v116, 16, v126
    v_and_b32 v117, s32, v126
    v_mul_f32 v118, s33, v118
    v_lshlrev_b32 v126, 16, v127
    v_and_b32 v127, s32, v127
    v_lshlrev_b32_sdwa v109, 3, v109 dst_sel:DWORD dst_unused:UNUSED_PAD src0_sel:DWORD src1_sel:WORD_1
    v_pk_fma_f32 v[116:117], v[116:117], v[118:119], s[28:29] op_sel_hi:[1,0,1]
    v_pk_fma_f32 v[126:127], v[126:127], v[118:119], s[28:29] op_sel_hi:[1,0,1]
    v_perm_b32 v116, v117, v116, s35
    v_perm_b32 v117, v127, v126, s35
    v_lshl_add_u64 v[116:117], v[116:117], 0, s[30:31]
    ds_add_rtn_u64 v[126:127], v109, v[116:117] offset:50000

    s_waitcnt lgkmcnt(0)
    s_mov_b64 exec, s[56:57]
    v_or3_b32 v1, v120, v121, v1
    s_mov_b64 exec, s[58:59]
    v_or3_b32 v1, v122, v123, v1
    s_mov_b64 exec, s[98:99]
    v_or3_b32 v1, v124, v125, v1
    s_mov_b64 exec, vcc
    v_or3_b32 v1, v126, v127, v1
    s_mov_b64 exec, -1
L_nt2_64:
    s_movk_i32 s53, 15360
    buffer_load_dwordx4 v[106:109], v2, s[16:19], s53 offen offset:4
    buffer_load_dword v114, v2, s[16:19], s53 offen
    s_cmp_le_u32 s40, 3584
    s_cbranch_scc1 L_noleft_65
    s_min_u32 s40, s40, 6524
    s_lshl_b32 s52, s38, 6
    s_add_u32 s52, s52, s36
    s_mul_i32 s52, s52, 32764
    s_and_b32 s52, s52, 0xffffff80
    s_add_u32 s20, s44, s52
    s_addc_u32 s21, s45, 0
    s_mul_i32 s52, s40, 5
    s_add_u32 s52, s52, 3
    s_and_b32 s22, s52, -4

    s_lshr_b32 s55, s39, 2
    s_add_u32 s55, s55, 3584
    v_and_b32 v120, 63, v0
    v_add_u32 v120, s55, v120
L_left_68:
    s_cmp_ge_u32 s55, s40
    s_cbranch_scc1 L_leftend_69
    v_mul_u32_u24 v121, 5, v120
    buffer_load_dword v122, v121, s[20:23], 0 offen offset:1
    buffer_load_ubyte v123, v121, s[20:23], 0 offen
    s_waitcnt vmcnt(0)

    v_perm_b32 v121, v123, v122, s24
    v_lshrrev_b32 v126, 30, v122
    v_and_b32 v121, 0x1fff, v121
    v_mul_u32_u24 v126, 6250, v126
    v_add_lshl_u32 v121, v121, v126, 3

    buffer_load_dwordx2 v[124:125], v121, s[8:11], s50 offen
    v_cmp_gt_u32 vcc, s40, v120
    s_waitcnt vmcnt(0)

    s_mov_b64 exec, vcc
    v_and_b32 v122, 0x3fffffff, v122
    v_cvt_f32_i32_sdwa v118, sext(v122) dst_sel:DWORD dst_unused:UNUSED_PAD src0_sel:WORD_0
    v_lshlrev_b32 v116, 16, v124
    v_and_b32 v117, s32, v124
    v_mul_f32 v118, s33, v118
    v_lshlrev_b32 v124, 16, v125
    v_and_b32 v125, s32, v125
    v_lshlrev_b32_sdwa v122, 3, v122 dst_sel:DWORD dst_unused:UNUSED_PAD src0_sel:DWORD src1_sel:WORD_1
    v_pk_fma_f32 v[116:117], v[116:117], v[118:119], s[28:29] op_sel_hi:[1,0,1]
    v_pk_fma_f32 v[124:125], v[124:125], v[118:119], s[28:29] op_sel_hi:[1,0,1]
    v_perm_b32 v116, v117, v116, s35
    v_perm_b32 v117, v125, v124, s35
    v_lshl_add_u64 v[116:117], v[116:117], 0, s[30:31]
    ds_add_rtn_u64 v[124:125], v122, v[116:117] offset:50000

    s_waitcnt lgkmcnt(0)
    v_or3_b32 v1, v124, v125, v1
    s_mov_b64 exec, -1
    v_add_u32 v120, 128, v120
    s_add_u32 s55, s55, 128
    s_branch L_left_68
L_leftend_69:

L_noleft_65:
    v_cmp_gt_u32 s[64:65], 2.0, v4
    v_and_b32 v4, 0x3fffffff, v4
    v_cmp_gt_u32 s[66:67], 2.0, v5
    v_and_b32 v5, 0x3fffffff, v5
    v_cmp_gt_u32 s[68:69], 2.0, v6
    v_and_b32 v6, 0x3fffffff, v6
    v_cmp_gt_u32 s[70:71], 2.0, v7
    v_and_b32 v7, 0x3fffffff, v7
    v_cmp_gt_u32 s[72:73], 2.0, v8
    v_and_b32 v8, 0x3fffffff, v8
    v_cmp_gt_u32 s[74:75], 2.0, v9
    v_and_b32 v9, 0x3fffffff, v9
    v_cmp_gt_u32 s[76:77], 2.0, v10
    v_and_b32 v10, 0x3fffffff, v10
    v_cmp_gt_u32 s[78:79], 2.0, v11
    v_and_b32 v11, 0x3fffffff, v11
    v_cmp_gt_u32 s[80:81], 2.0, v12
    v_and_b32 v12, 0x3fffffff, v12
    v_cmp_gt_u32 s[82:83], 2.0, v13
    v_and_b32 v13, 0x3fffffff, v13
    v_cmp_gt_u32 s[84:85], 2.0, v14
    v_and_b32 v14, 0x3fffffff, v14
    v_cmp_gt_u32 s[86:87], 2.0, v15
    v_and_b32 v15, 0x3fffffff, v15
    s_waitcnt lgkmcnt(0)
    s_barrier
    s_waitcnt vmcnt(9)
    ds_write_addtid_b32 v76 offset:0
    ds_write_addtid_b32 v77 offset:256
    ds_write_addtid_b32 v78 offset:512
    ds_write_addtid_b32 v79 offset:768
    s_waitcnt vmcnt(8)
    ds_write_addtid_b32 v80 offset:16384
    ds_write_addtid_b32 v81 offset:16640
    ds_write_addtid_b32 v82 offset:16896
    ds_write_addtid_b32 v83 offset:17152
    s_waitcnt vmcnt(7)
    ds_write_addtid_b32 v84 offset:32768
    ds_write_addtid_b32 v85 offset:33024
    ds_write_addtid_b32 v86 offset:33280
    ds_write_addtid_b32 v87 offset:33536
    v_lshlrev_b32 v119, 2, v0
    s_waitcnt vmcnt(6)
    s_mov_b64 exec, s[48:49]
    ds_write_b32 v119, v88 offset:49152
    s_mov_b64 exec, -1
    s_add_u32 s43, s43, 50048
    s_add_u32 s14, s43, 50000
    s_min_u32 s14, s14, s41
    buffer_load_dwordx4 v[76:79], v3, s[12:15], s43 offen
    s_waitcnt lgkmcnt(0)
    s_barrier
    s_add_u32 s52, s43, 16384
    buffer_load_dwordx4 v[80:83], v3, s[12:15], s52 offen
    s_add_u32 s52, s43, 32768
    buffer_load_dwordx4 v[84:87], v3, s[12:15], s52 offen
    s_add_u32 s52, s43, 49152
    v_lshlrev_b32 v119, 2, v0
    buffer_load_dword v88, v119, s[12:15], s52 offen
    s_mov_b64 exec, s[64:65]
    ds_read_b64 v[28:29], v28
    s_mov_b64 exec, s[66:67]
    ds_read_b64 v[30:31], v30
    s_mov_b64 exec, s[68:69]
    ds_read_b64 v[32:33], v32
    s_mov_b64 exec, s[70:71]
    ds_read_b64 v[34:35], v34
    s_mov_b64 exec, s[72:73]
    ds_read_b64 v[36:37], v36
    s_mov_b64 exec, s[74:75]
    ds_read_b64 v[38:39], v38
    s_mov_b64 exec, s[76:77]
    ds_read_b64 v[40:41], v40
    s_mov_b64 exec, s[78:79]
    ds_read_b64 v[42:43], v42
    s_mov_b64 exec, s[80:81]
    ds_read_b64 v[44:45], v44
    s_mov_b64 exec, s[82:83]
    ds_read_b64 v[46:47], v46
    s_mov_b64 exec, s[84:85]
    ds_read_b64 v[48:49], v48
    s_mov_b64 exec, s[86:87]
    ds_read_b64 v[50:51], v50
    s_mov_b64 exec, -1
    v_cmp_gt_u32 s[64:65], 2.0, v16
    v_and_b32 v16, 0x3fffffff, v16
    v_cmp_gt_u32 s[66:67], 2.0, v17
    v_and_b32 v17, 0x3fffffff, v17
    v_cmp_gt_u32 s[68:69], 2.0, v18
    v_and_b32 v18, 0x3fffffff, v18
    v_cmp_gt_u32 s[70:71], 2.0, v19
    v_and_b32 v19, 0x3fffffff, v19
    v_cmp_gt_u32 s[72:73], 2.0, v20
    v_and_b32 v20, 0x3fffffff, v20
    v_cmp_gt_u32 s[74:75], 2.0, v21
    v_and_b32 v21, 0x3fffffff, v21
    v_cmp_gt_u32 s[76:77], 2.0, v22
    v_and_b32 v22, 0x3fffffff, v22
    v_cmp_gt_u32 s[78:79], 2.0, v23
    v_and_b32 v23, 0x3fffffff, v23
    v_cmp_gt_u32 s[80:81], 2.0, v24
    v_and_b32 v24, 0x3fffffff, v24
    v_cmp_gt_u32 s[82:83], 2.0, v25
    v_and_b32 v25, 0x3fffffff, v25
    v_cmp_gt_u32 s[84:85], 2.0, v26
    v_and_b32 v26, 0x3fffffff, v26
    v_cmp_gt_u32 s[86:87], 2.0, v27
    v_and_b32 v27, 0x3fffffff, v27
    s_mov_b64 exec, s[64:65]
    ds_read_b64 v[52:53], v52
    s_mov_b64 exec, s[66:67]
    ds_read_b64 v[54:55], v54
    s_mov_b64 exec, s[68:69]
    ds_read_b64 v[56:57], v56
    s_mov_b64 exec, s[70:71]
    ds_read_b64 v[58:59], v58
    s_mov_b64 exec, s[72:73]
    ds_read_b64 v[60:61], v60
    s_mov_b64 exec, s[74:75]
    ds_read_b64 v[62:63], v62
    s_mov_b64 exec, s[76:77]
    ds_read_b64 v[64:65], v64
    s_mov_b64 exec, s[78:79]
    ds_read_b64 v[66:67], v66
    s_mov_b64 exec, s[80:81]
    ds_read_b64 v[68:69], v68
    s_mov_b64 exec, s[82:83]
    ds_read_b64 v[70:71], v70
    s_mov_b64 exec, s[84:85]
    ds_read_b64 v[72:73], v72
    s_mov_b64 exec, s[86:87]
    ds_read_b64 v[74:75], v74
    s_mov_b64 exec, -1
    s_cmp_ge_u32 s5, s4
    s_cbranch_scc1 L_bend_62
    s_waitcnt lgkmcnt(15)
    v_mad_i32_i16 v120, v28, v4, s96
    v_mad_i32_i16 v28, v28, v4, s96 op_sel:[1,0,0,0]
    v_mad_i32_i16 v121, v29, v4, s96
    v_mad_i32_i16 v29, v29, v4, s96 op_sel:[1,0,0,0]
    v_lshlrev_b32_sdwa v4, 3, v4 dst_sel:DWORD dst_unused:UNUSED_PAD src0_sel:DWORD src1_sel:WORD_1
    v_perm_b32 v28, v28, v120, s97
    v_perm_b32 v29, v29, v121, s97
    v_lshl_add_u64 v[28:29], v[28:29], 0, s[30:31]

    ds_add_rtn_u64 v[28:29], v4, v[28:29] offset:50000
    v_mad_i32_i16 v122, v30, v5, s96
    v_mad_i32_i16 v30, v30, v5, s96 op_sel:[1,0,0,0]
    v_mad_i32_i16 v123, v31, v5, s96
    v_mad_i32_i16 v31, v31, v5, s96 op_sel:[1,0,0,0]
    v_lshlrev_b32_sdwa v5, 3, v5 dst_sel:DWORD dst_unused:UNUSED_PAD src0_sel:DWORD src1_sel:WORD_1
    v_perm_b32 v30, v30, v122, s97
    v_perm_b32 v31, v31, v123, s97
    v_lshl_add_u64 v[30:31], v[30:31], 0, s[30:31]

    ds_add_rtn_u64 v[30:31], v5, v[30:31] offset:50000
    v_mad_i32_i16 v124, v32, v6, s96
    v_mad_i32_i16 v32, v32, v6, s96 op_sel:[1,0,0,0]
    v_mad_i32_i16 v125, v33, v6, s96
    v_mad_i32_i16 v33, v33, v6, s96 op_sel:[1,0,0,0]
    v_lshlrev_b32_sdwa v6, 3, v6 dst_sel:DWORD dst_unused:UNUSED_PAD src0_sel:DWORD src1_sel:WORD_1
    v_perm_b32 v32, v32, v124, s97
    v_perm_b32 v33, v33, v125, s97
    v_lshl_add_u64 v[32:33], v[32:33], 0, s[30:31]

    ds_add_rtn_u64 v[32:33], v6, v[32:33] offset:50000
    v_mad_i32_i16 v126, v34, v7, s96
    v_mad_i32_i16 v34, v34, v7, s96 op_sel:[1,0,0,0]
    v_mad_i32_i16 v127, v35, v7, s96
    v_mad_i32_i16 v35, v35, v7, s96 op_sel:[1,0,0,0]
    v_lshlrev_b32_sdwa v7, 3, v7 dst_sel:DWORD dst_unused:UNUSED_PAD src0_sel:DWORD src1_sel:WORD_1
    v_perm_b32 v34, v34, v126, s97
    v_perm_b32 v35, v35, v127, s97
    v_lshl_add_u64 v[34:35], v[34:35], 0, s[30:31]

    ds_add_rtn_u64 v[34:35], v7, v[34:35] offset:50000
    v_mad_i32_i16 v120, v36, v8, s96
    v_mad_i32_i16 v36, v36, v8, s96 op_sel:[1,0,0,0]
    v_mad_i32_i16 v121, v37, v8, s96
    v_mad_i32_i16 v37, v37, v8, s96 op_sel:[1,0,0,0]
    v_lshlrev_b32_sdwa v8, 3, v8 dst_sel:DWORD dst_unused:UNUSED_PAD src0_sel:DWORD src1_sel:WORD_1
    v_perm_b32 v36, v36, v120, s97
    v_perm_b32 v37, v37, v121, s97
    v_lshl_add_u64 v[36:37], v[36:37], 0, s[30:31]

    ds_add_rtn_u64 v[36:37], v8, v[36:37] offset:50000
    v_mad_i32_i16 v122, v38, v9, s96
    v_mad_i32_i16 v38, v38, v9, s96 op_sel:[1,0,0,0]
    v_mad_i32_i16 v123, v39, v9, s96
    v_mad_i32_i16 v39, v39, v9, s96 op_sel:[1,0,0,0]
    v_lshlrev_b32_sdwa v9, 3, v9 dst_sel:DWORD dst_unused:UNUSED_PAD src0_sel:DWORD src1_sel:WORD_1
    v_perm_b32 v38, v38, v122, s97
    v_perm_b32 v39, v39, v123, s97
    v_lshl_add_u64 v[38:39], v[38:39], 0, s[30:31]

    ds_add_rtn_u64 v[38:39], v9, v[38:39] offset:50000
    v_mad_i32_i16 v124, v40, v10, s96
    v_mad_i32_i16 v40, v40, v10, s96 op_sel:[1,0,0,0]
    v_mad_i32_i16 v125, v41, v10, s96
    v_mad_i32_i16 v41, v41, v10, s96 op_sel:[1,0,0,0]
    v_lshlrev_b32_sdwa v10, 3, v10 dst_sel:DWORD dst_unused:UNUSED_PAD src0_sel:DWORD src1_sel:WORD_1
    v_perm_b32 v40, v40, v124, s97
    v_perm_b32 v41, v41, v125, s97
    v_lshl_add_u64 v[40:41], v[40:41], 0, s[30:31]

    ds_add_rtn_u64 v[40:41], v10, v[40:41] offset:50000
    v_mad_i32_i16 v126, v42, v11, s96
    v_mad_i32_i16 v42, v42, v11, s96 op_sel:[1,0,0,0]
    v_mad_i32_i16 v127, v43, v11, s96
    v_mad_i32_i16 v43, v43, v11, s96 op_sel:[1,0,0,0]
    v_lshlrev_b32_sdwa v11, 3, v11 dst_sel:DWORD dst_unused:UNUSED_PAD src0_sel:DWORD src1_sel:WORD_1
    v_perm_b32 v42, v42, v126, s97
    v_perm_b32 v43, v43, v127, s97
    v_lshl_add_u64 v[42:43], v[42:43], 0, s[30:31]

    ds_add_rtn_u64 v[42:43], v11, v[42:43] offset:50000
    s_waitcnt lgkmcnt(4)
    v_or3_b32 v1, v28, v29, v1
    v_or3_b32 v1, v30, v31, v1
    v_or3_b32 v1, v32, v33, v1
    v_or3_b32 v1, v34, v35, v1
    s_movk_i32 s53, 0
    buffer_load_dwordx4 v[4:7], v2, s[16:19], s53 offen offset:4 nt
    buffer_load_dword v35, v2, s[16:19], s53 offen nt
    v_mad_i32_i16 v120, v44, v12, s96
    v_mad_i32_i16 v44, v44, v12, s96 op_sel:[1,0,0,0]
    v_mad_i32_i16 v121, v45, v12, s96
    v_mad_i32_i16 v45, v45, v12, s96 op_sel:[1,0,0,0]
    v_lshlrev_b32_sdwa v12, 3, v12 dst_sel:DWORD dst_unused:UNUSED_PAD src0_sel:DWORD src1_sel:WORD_1
    v_perm_b32 v44, v44, v120, s97
    v_perm_b32 v45, v45, v121, s97
    v_lshl_add_u64 v[44:45], v[44:45], 0, s[30:31]

    ds_add_rtn_u64 v[44:45], v12, v[44:45] offset:50000
    v_mad_i32_i16 v122, v46, v13, s96
    v_mad_i32_i16 v46, v46, v13, s96 op_sel:[1,0,0,0]
    v_mad_i32_i16 v123, v47, v13, s96
    v_mad_i32_i16 v47, v47, v13, s96 op_sel:[1,0,0,0]
    v_lshlrev_b32_sdwa v13, 3, v13 dst_sel:DWORD dst_unused:UNUSED_PAD src0_sel:DWORD src1_sel:WORD_1
    v_perm_b32 v46, v46, v122, s97
    v_perm_b32 v47, v47, v123, s97
    v_lshl_add_u64 v[46:47], v[46:47], 0, s[30:31]

    ds_add_rtn_u64 v[46:47], v13, v[46:47] offset:50000
    v_mad_i32_i16 v124, v48, v14, s96
    v_mad_i32_i16 v48, v48, v14, s96 op_sel:[1,0,0,0]
    v_mad_i32_i16 v125, v49, v14, s96
    v_mad_i32_i16 v49, v49, v14, s96 op_sel:[1,0,0,0]
    v_lshlrev_b32_sdwa v14, 3, v14 dst_sel:DWORD dst_unused:UNUSED_PAD src0_sel:DWORD src1_sel:WORD_1
    v_perm_b32 v48, v48, v124, s97
    v_perm_b32 v49, v49, v125, s97
    v_lshl_add_u64 v[48:49], v[48:49], 0, s[30:31]

    ds_add_rtn_u64 v[48:49], v14, v[48:49] offset:50000
    v_mad_i32_i16 v126, v50, v15, s96
    v_mad_i32_i16 v50, v50, v15, s96 op_sel:[1,0,0,0]
    v_mad_i32_i16 v127, v51, v15, s96
    v_mad_i32_i16 v51, v51, v15, s96 op_sel:[1,0,0,0]
    v_lshlrev_b32_sdwa v15, 3, v15 dst_sel:DWORD dst_unused:UNUSED_PAD src0_sel:DWORD src1_sel:WORD_1
    v_perm_b32 v50, v50, v126, s97
    v_perm_b32 v51, v51, v127, s97
    v_lshl_add_u64 v[50:51], v[50:51], 0, s[30:31]

    ds_add_rtn_u64 v[50:51], v15, v[50:51] offset:50000
    s_waitcnt lgkmcnt(4)
    v_or3_b32 v1, v36, v37, v1
    v_or3_b32 v1, v38, v39, v1
    v_or3_b32 v1, v40, v41, v1
    v_or3_b32 v1, v42, v43, v1
    s_movk_i32 s53, 2560
    buffer_load_dwordx4 v[8:11], v2, s[16:19], s53 offen offset:4
    buffer_load_dword v43, v2, s[16:19], s53 offen
    s_barrier
    s_waitcnt vmcnt(7)
    ds_write_addtid_b32 v76 offset:0
    ds_write_addtid_b32 v77 offset:256
    ds_write_addtid_b32 v78 offset:512
    ds_write_addtid_b32 v79 offset:768
    s_waitcnt vmcnt(6)
    ds_write_addtid_b32 v80 offset:16384
    ds_write_addtid_b32 v81 offset:16640
    ds_write_addtid_b32 v82 offset:16896
    ds_write_addtid_b32 v83 offset:17152
    s_waitcnt vmcnt(5)
    ds_write_addtid_b32 v84 offset:32768
    ds_write_addtid_b32 v85 offset:33024
    ds_write_addtid_b32 v86 offset:33280
    ds_write_addtid_b32 v87 offset:33536
    v_lshlrev_b32 v119, 2, v0
    s_waitcnt vmcnt(4)
    s_mov_b64 exec, s[48:49]
    ds_write_b32 v119, v88 offset:49152
    s_mov_b64 exec, -1
    s_add_u32 s43, s43, 50048
    s_add_u32 s14, s43, 50000
    s_min_u32 s14, s14, s41
    s_mov_b32 s40, s88
    s_sub_u32 s42, s40, s39

    s_add_u32 s55, s38, 2
    s_min_u32 s55, s55, 31
    s_mov_b32 s88, s89
    s_mov_b32 s89, s90
    s_mov_b32 s90, s91
    s_mov_b32 s91, s92
    s_mov_b32 s92, s93
    s_mov_b32 s93, s94
    s_mov_b32 s94, s95
    s_mov_b32 s95, 0
    s_min_u32 s88, s88, 6524
    s_lshl_b32 s52, s55, 6
    s_add_u32 s52, s52, s36
    s_mul_i32 s52, s52, 32764
    s_and_b32 s52, s52, 0xffffff80
    s_add_u32 s16, s44, s52
    s_addc_u32 s17, s45, 0
    s_mul_i32 s52, s88, 5
    s_add_u32 s52, s52, 3
    s_and_b32 s18, s52, -4

    v_mad_i32_i16 v120, v52, v16, s96
    v_mad_i32_i16 v52, v52, v16, s96 op_sel:[1,0,0,0]
    v_mad_i32_i16 v121, v53, v16, s96
    v_mad_i32_i16 v53, v53, v16, s96 op_sel:[1,0,0,0]
    v_lshlrev_b32_sdwa v16, 3, v16 dst_sel:DWORD dst_unused:UNUSED_PAD src0_sel:DWORD src1_sel:WORD_1
    v_perm_b32 v52, v52, v120, s97
    v_perm_b32 v53, v53, v121, s97
    v_lshl_add_u64 v[52:53], v[52:53], 0, s[30:31]

    ds_add_rtn_u64 v[52:53], v16, v[52:53] offset:50000
    v_mad_i32_i16 v122, v54, v17, s96
    v_mad_i32_i16 v54, v54, v17, s96 op_sel:[1,0,0,0]
    v_mad_i32_i16 v123, v55, v17, s96
    v_mad_i32_i16 v55, v55, v17, s96 op_sel:[1,0,0,0]
    v_lshlrev_b32_sdwa v17, 3, v17 dst_sel:DWORD dst_unused:UNUSED_PAD src0_sel:DWORD src1_sel:WORD_1
    v_perm_b32 v54, v54, v122, s97
    v_perm_b32 v55, v55, v123, s97
    v_lshl_add_u64 v[54:55], v[54:55], 0, s[30:31]

    ds_add_rtn_u64 v[54:55], v17, v[54:55] offset:50000
    v_mad_i32_i16 v124, v56, v18, s96
    v_mad_i32_i16 v56, v56, v18, s96 op_sel:[1,0,0,0]
    v_mad_i32_i16 v125, v57, v18, s96
    v_mad_i32_i16 v57, v57, v18, s96 op_sel:[1,0,0,0]
    v_lshlrev_b32_sdwa v18, 3, v18 dst_sel:DWORD dst_unused:UNUSED_PAD src0_sel:DWORD src1_sel:WORD_1
    v_perm_b32 v56, v56, v124, s97
    v_perm_b32 v57, v57, v125, s97
    v_lshl_add_u64 v[56:57], v[56:57], 0, s[30:31]

    ds_add_rtn_u64 v[56:57], v18, v[56:57] offset:50000
    v_mad_i32_i16 v126, v58, v19, s96
    v_mad_i32_i16 v58, v58, v19, s96 op_sel:[1,0,0,0]
    v_mad_i32_i16 v127, v59, v19, s96
    v_mad_i32_i16 v59, v59, v19, s96 op_sel:[1,0,0,0]
    v_lshlrev_b32_sdwa v19, 3, v19 dst_sel:DWORD dst_unused:UNUSED_PAD src0_sel:DWORD src1_sel:WORD_1
    v_perm_b32 v58, v58, v126, s97
    v_perm_b32 v59, v59, v127, s97
    v_lshl_add_u64 v[58:59], v[58:59], 0, s[30:31]

    ds_add_rtn_u64 v[58:59], v19, v[58:59] offset:50000
    s_waitcnt lgkmcnt(15)
    v_or3_b32 v1, v44, v45, v1
    v_or3_b32 v1, v46, v47, v1
    v_or3_b32 v1, v48, v49, v1
    v_or3_b32 v1, v50, v51, v1
    s_waitcnt vmcnt(24)
    v_lshlrev_b32_sdwa v44, 3, v110 dst_sel:WORD_0 dst_unused:UNUSED_PAD src0_sel:DWORD src1_sel:DWORD
    v_lshrrev_b32 v46, 5, v90
    v_lshlrev_b32_sdwa v48, 3, v91 dst_sel:WORD_0 dst_unused:UNUSED_PAD src0_sel:DWORD src1_sel:WORD_1
    v_alignbit_b32 v50, v93, v92, 21

    v_mov_b32 v15, v93
    v_alignbyte_b32 v14, v92, v91, 3
    v_alignbyte_b32 v13, v91, v90, 2
    v_alignbyte_b32 v12, v90, v110, 1
    v_and_b32 v46, 0xfff8, v46
    v_and_b32 v50, 0xfff8, v50
    s_cmp_lt_i32 s42, 1280
    s_cbranch_scc1 L_ufix_70
L_uback_71:

    s_movk_i32 s53, 5120
    buffer_load_dwordx4 v[90:93], v2, s[16:19], s53 offen offset:4
    buffer_load_dword v110, v2, s[16:19], s53 offen
    s_waitcnt lgkmcnt(4)
    s_barrier
    v_subrev_co_u32 v12, s[80:81], 2.0, v12
    v_subrev_co_u32 v13, s[82:83], 2.0, v13
    v_subrev_co_u32 v14, s[84:85], 2.0, v14
    v_subrev_co_u32 v15, s[86:87], 2.0, v15
    s_mov_b64 exec, s[80:81]
    ds_read_b64 v[44:45], v44
    s_mov_b64 exec, s[82:83]
    ds_read_b64 v[46:47], v46
    s_mov_b64 exec, s[84:85]
    ds_read_b64 v[48:49], v48
    s_mov_b64 exec, s[86:87]
    ds_read_b64 v[50:51], v50
    s_mov_b64 exec, -1
    v_mad_i32_i16 v120, v60, v20, s96
    v_mad_i32_i16 v60, v60, v20, s96 op_sel:[1,0,0,0]
    v_mad_i32_i16 v121, v61, v20, s96
    v_mad_i32_i16 v61, v61, v20, s96 op_sel:[1,0,0,0]
    v_lshlrev_b32_sdwa v20, 3, v20 dst_sel:DWORD dst_unused:UNUSED_PAD src0_sel:DWORD src1_sel:WORD_1
    v_perm_b32 v60, v60, v120, s97
    v_perm_b32 v61, v61, v121, s97
    v_lshl_add_u64 v[60:61], v[60:61], 0, s[30:31]

    ds_add_rtn_u64 v[60:61], v20, v[60:61] offset:50000
    v_mad_i32_i16 v122, v62, v21, s96
    v_mad_i32_i16 v62, v62, v21, s96 op_sel:[1,0,0,0]
    v_mad_i32_i16 v123, v63, v21, s96
    v_mad_i32_i16 v63, v63, v21, s96 op_sel:[1,0,0,0]
    v_lshlrev_b32_sdwa v21, 3, v21 dst_sel:DWORD dst_unused:UNUSED_PAD src0_sel:DWORD src1_sel:WORD_1
    v_perm_b32 v62, v62, v122, s97
    v_perm_b32 v63, v63, v123, s97
    v_lshl_add_u64 v[62:63], v[62:63], 0, s[30:31]

    ds_add_rtn_u64 v[62:63], v21, v[62:63] offset:50000
    v_mad_i32_i16 v124, v64, v22, s96
    v_mad_i32_i16 v64, v64, v22, s96 op_sel:[1,0,0,0]
    v_mad_i32_i16 v125, v65, v22, s96
    v_mad_i32_i16 v65, v65, v22, s96 op_sel:[1,0,0,0]
    v_lshlrev_b32_sdwa v22, 3, v22 dst_sel:DWORD dst_unused:UNUSED_PAD src0_sel:DWORD src1_sel:WORD_1
    v_perm_b32 v64, v64, v124, s97
    v_perm_b32 v65, v65, v125, s97
    v_lshl_add_u64 v[64:65], v[64:65], 0, s[30:31]

    ds_add_rtn_u64 v[64:65], v22, v[64:65] offset:50000
    v_mad_i32_i16 v126, v66, v23, s96
    v_mad_i32_i16 v66, v66, v23, s96 op_sel:[1,0,0,0]
    v_mad_i32_i16 v127, v67, v23, s96
    v_mad_i32_i16 v67, v67, v23, s96 op_sel:[1,0,0,0]
    v_lshlrev_b32_sdwa v23, 3, v23 dst_sel:DWORD dst_unused:UNUSED_PAD src0_sel:DWORD src1_sel:WORD_1
    v_perm_b32 v66, v66, v126, s97
    v_perm_b32 v67, v67, v127, s97
    v_lshl_add_u64 v[66:67], v[66:67], 0, s[30:31]

    ds_add_rtn_u64 v[66:67], v23, v[66:67] offset:50000
    s_waitcnt lgkmcnt(8)
    v_or3_b32 v1, v52, v53, v1
    v_or3_b32 v1, v54, v55, v1
    v_or3_b32 v1, v56, v57, v1
    v_or3_b32 v1, v58, v59, v1
    s_waitcnt vmcnt(24)
    v_lshlrev_b32_sdwa v52, 3, v111 dst_sel:WORD_0 dst_unused:UNUSED_PAD src0_sel:DWORD src1_sel:DWORD
    v_lshrrev_b32 v54, 5, v94
    v_lshlrev_b32_sdwa v56, 3, v95 dst_sel:WORD_0 dst_unused:UNUSED_PAD src0_sel:DWORD src1_sel:WORD_1
    v_alignbit_b32 v58, v97, v96, 21

    v_mov_b32 v19, v97
    v_alignbyte_b32 v18, v96, v95, 3
    v_alignbyte_b32 v17, v95, v94, 2
    v_alignbyte_b32 v16, v94, v111, 1
    v_and_b32 v54, 0xfff8, v54
    v_and_b32 v58, 0xfff8, v58
    s_cmp_lt_i32 s42, 1792
    s_cbranch_scc1 L_ufix_72
L_uback_73:

    v_subrev_co_u32 v16, s[64:65], 2.0, v16
    v_subrev_co_u32 v17, s[66:67], 2.0, v17
    v_subrev_co_u32 v18, s[68:69], 2.0, v18
    v_subrev_co_u32 v19, s[70:71], 2.0, v19
    s_mov_b64 exec, s[64:65]
    ds_read_b64 v[52:53], v52
    s_mov_b64 exec, s[66:67]
    ds_read_b64 v[54:55], v54
    s_mov_b64 exec, s[68:69]
    ds_read_b64 v[56:57], v56
    s_mov_b64 exec, s[70:71]
    ds_read_b64 v[58:59], v58
    s_mov_b64 exec, -1
    v_mad_i32_i16 v120, v68, v24, s96
    v_mad_i32_i16 v68, v68, v24, s96 op_sel:[1,0,0,0]
    v_mad_i32_i16 v121, v69, v24, s96
    v_mad_i32_i16 v69, v69, v24, s96 op_sel:[1,0,0,0]
    v_lshlrev_b32_sdwa v24, 3, v24 dst_sel:DWORD dst_unused:UNUSED_PAD src0_sel:DWORD src1_sel:WORD_1
    v_perm_b32 v68, v68, v120, s97
    v_perm_b32 v69, v69, v121, s97
    v_lshl_add_u64 v[68:69], v[68:69], 0, s[30:31]

    ds_add_rtn_u64 v[68:69], v24, v[68:69] offset:50000
    v_mad_i32_i16 v122, v70, v25, s96
    v_mad_i32_i16 v70, v70, v25, s96 op_sel:[1,0,0,0]
    v_mad_i32_i16 v123, v71, v25, s96
    v_mad_i32_i16 v71, v71, v25, s96 op_sel:[1,0,0,0]
    v_lshlrev_b32_sdwa v25, 3, v25 dst_sel:DWORD dst_unused:UNUSED_PAD src0_sel:DWORD src1_sel:WORD_1
    v_perm_b32 v70, v70, v122, s97
    v_perm_b32 v71, v71, v123, s97
    v_lshl_add_u64 v[70:71], v[70:71], 0, s[30:31]

    ds_add_rtn_u64 v[70:71], v25, v[70:71] offset:50000
    v_mad_i32_i16 v124, v72, v26, s96
    v_mad_i32_i16 v72, v72, v26, s96 op_sel:[1,0,0,0]
    v_mad_i32_i16 v125, v73, v26, s96
    v_mad_i32_i16 v73, v73, v26, s96 op_sel:[1,0,0,0]
    v_lshlrev_b32_sdwa v26, 3, v26 dst_sel:DWORD dst_unused:UNUSED_PAD src0_sel:DWORD src1_sel:WORD_1
    v_perm_b32 v72, v72, v124, s97
    v_perm_b32 v73, v73, v125, s97
    v_lshl_add_u64 v[72:73], v[72:73], 0, s[30:31]

    ds_add_rtn_u64 v[72:73], v26, v[72:73] offset:50000
    v_mad_i32_i16 v126, v74, v27, s96
    v_mad_i32_i16 v74, v74, v27, s96 op_sel:[1,0,0,0]
    v_mad_i32_i16 v127, v75, v27, s96
    v_mad_i32_i16 v75, v75, v27, s96 op_sel:[1,0,0,0]
    v_lshlrev_b32_sdwa v27, 3, v27 dst_sel:DWORD dst_unused:UNUSED_PAD src0_sel:DWORD src1_sel:WORD_1
    v_perm_b32 v74, v74, v126, s97
    v_perm_b32 v75, v75, v127, s97
    v_lshl_add_u64 v[74:75], v[74:75], 0, s[30:31]

    ds_add_rtn_u64 v[74:75], v27, v[74:75] offset:50000
    s_waitcnt lgkmcnt(8)
    v_or3_b32 v1, v60, v61, v1
    v_or3_b32 v1, v62, v63, v1
    v_or3_b32 v1, v64, v65, v1
    v_or3_b32 v1, v66, v67, v1
    s_waitcnt vmcnt(14)
    v_lshlrev_b32_sdwa v60, 3, v112 dst_sel:WORD_0 dst_unused:UNUSED_PAD src0_sel:DWORD src1_sel:DWORD
    v_lshrrev_b32 v62, 5, v98
    v_lshlrev_b32_sdwa v64, 3, v99 dst_sel:WORD_0 dst_unused:UNUSED_PAD src0_sel:DWORD src1_sel:WORD_1
    v_alignbit_b32 v66, v101, v100, 21

    v_mov_b32 v23, v101
    v_alignbyte_b32 v22, v100, v99, 3
    v_alignbyte_b32 v21, v99, v98, 2
    v_alignbyte_b32 v20, v98, v112, 1
    v_and_b32 v62, 0xfff8, v62
    v_and_b32 v66, 0xfff8, v66
    s_cmp_lt_i32 s42, 2304
    s_cbranch_scc1 L_ufix_74
L_uback_75:

    v_subrev_co_u32 v20, s[72:73], 2.0, v20
    v_subrev_co_u32 v21, s[74:75], 2.0, v21
    v_subrev_co_u32 v22, s[76:77], 2.0, v22
    v_subrev_co_u32 v23, s[78:79], 2.0, v23
    s_mov_b64 exec, s[72:73]
    ds_read_b64 v[60:61], v60
    s_mov_b64 exec, s[74:75]
    ds_read_b64 v[62:63], v62
    s_mov_b64 exec, s[76:77]
    ds_read_b64 v[64:65], v64
    s_mov_b64 exec, s[78:79]
    ds_read_b64 v[66:67], v66
    s_mov_b64 exec, -1
    s_waitcnt lgkmcnt(4)
    v_or3_b32 v1, v68, v69, v1
    v_or3_b32 v1, v70, v71, v1
    v_or3_b32 v1, v72, v73, v1
    v_or3_b32 v1, v74, v75, v1
    s_waitcnt vmcnt(12)
    v_lshlrev_b32_sdwa v68, 3, v113 dst_sel:WORD_0 dst_unused:UNUSED_PAD src0_sel:DWORD src1_sel:DWORD
    v_lshrrev_b32 v70, 5, v102
    v_lshlrev_b32_sdwa v72, 3, v103 dst_sel:WORD_0 dst_unused:UNUSED_PAD src0_sel:DWORD src1_sel:WORD_1
    v_alignbit_b32 v74, v105, v104, 21

    v_mov_b32 v27, v105
    v_alignbyte_b32 v26, v104, v103, 3
    v_alignbyte_b32 v25, v103, v102, 2
    v_alignbyte_b32 v24, v102, v113, 1
    v_and_b32 v70, 0xfff8, v70
    v_and_b32 v74, 0xfff8, v74
    s_cmp_lt_i32 s42, 2816
    s_cbranch_scc1 L_ufix_76
L_uback_77:

    v_subrev_co_u32 v24, s[80:81], 2.0, v24
    v_subrev_co_u32 v25, s[82:83], 2.0, v25
    v_subrev_co_u32 v26, s[84:85], 2.0, v26
    v_subrev_co_u32 v27, s[86:87], 2.0, v27
    s_mov_b64 exec, s[80:81]
    ds_read_b64 v[68:69], v68
    s_mov_b64 exec, s[82:83]
    ds_read_b64 v[70:71], v70
    s_mov_b64 exec, s[84:85]
    ds_read_b64 v[72:73], v72
    s_mov_b64 exec, s[86:87]
    ds_read_b64 v[74:75], v74
    s_mov_b64 exec, -1
    buffer_load_dwordx4 v[76:79], v3, s[12:15], s43 offen
    s_add_u32 s52, s43, 16384
    buffer_load_dwordx4 v[80:83], v3, s[12:15], s52 offen
    s_add_u32 s52, s43, 32768
    buffer_load_dwordx4 v[84:87], v3, s[12:15], s52 offen
    s_add_u32 s52, s43, 49152
    v_lshlrev_b32 v119, 2, v0
    buffer_load_dword v88, v119, s[12:15], s52 offen
    s_add_u32 s54, s43, 50048
    buffer_load_dword v115, v89, s[60:63], s54 offen
    s_add_u32 s54, s50, 200000
    buffer_load_dword v115, v89, s[8:11], s54 offen
    s_waitcnt vmcnt(10)
    v_lshlrev_b32_sdwa v28, 3, v35 dst_sel:WORD_0 dst_unused:UNUSED_PAD src0_sel:DWORD src1_sel:DWORD
    v_lshrrev_b32 v30, 5, v4
    v_lshlrev_b32_sdwa v32, 3, v5 dst_sel:WORD_0 dst_unused:UNUSED_PAD src0_sel:DWORD src1_sel:WORD_1
    v_alignbit_b32 v34, v7, v6, 21

    v_alignbyte_b32 v6, v6, v5, 3
    v_alignbyte_b32 v5, v5, v4, 2
    v_alignbyte_b32 v4, v4, v35, 1
    v_and_b32 v30, 0xfff8, v30
    v_and_b32 v34, 0xfff8, v34
    s_cmp_lt_i32 s42, 256
    s_cbranch_scc1 L_ufix_78
L_uback_79:

    v_subrev_co_u32 v4, s[64:65], 2.0, v4
    v_subrev_co_u32 v5, s[66:67], 2.0, v5
    v_subrev_co_u32 v6, s[68:69], 2.0, v6
    v_subrev_co_u32 v7, s[70:71], 2.0, v7
    s_mov_b64 exec, s[64:65]
    ds_read_b64 v[28:29], v28
    s_mov_b64 exec, s[66:67]
    ds_read_b64 v[30:31], v30
    s_mov_b64 exec, s[68:69]
    ds_read_b64 v[32:33], v32
    s_mov_b64 exec, s[70:71]
    ds_read_b64 v[34:35], v34
    s_mov_b64 exec, -1
    s_waitcnt vmcnt(8)
    v_lshlrev_b32_sdwa v36, 3, v43 dst_sel:WORD_0 dst_unused:UNUSED_PAD src0_sel:DWORD src1_sel:DWORD
    v_lshrrev_b32 v38, 5, v8
    v_lshlrev_b32_sdwa v40, 3, v9 dst_sel:WORD_0 dst_unused:UNUSED_PAD src0_sel:DWORD src1_sel:WORD_1
    v_alignbit_b32 v42, v11, v10, 21

    v_alignbyte_b32 v10, v10, v9, 3
    v_alignbyte_b32 v9, v9, v8, 2
    v_alignbyte_b32 v8, v8, v43, 1
    v_and_b32 v38, 0xfff8, v38
    v_and_b32 v42, 0xfff8, v42
    s_cmp_lt_i32 s42, 768
    s_cbranch_scc1 L_ufix_80
L_uback_81:

    v_subrev_co_u32 v8, s[72:73], 2.0, v8
    v_subrev_co_u32 v9, s[74:75], 2.0, v9
    v_subrev_co_u32 v10, s[76:77], 2.0, v10
    v_subrev_co_u32 v11, s[78:79], 2.0, v11
    s_mov_b64 exec, s[72:73]
    ds_read_b64 v[36:37], v36
    s_mov_b64 exec, s[74:75]
    ds_read_b64 v[38:39], v38
    s_mov_b64 exec, s[76:77]
    ds_read_b64 v[40:41], v40
    s_mov_b64 exec, s[78:79]
    ds_read_b64 v[42:43], v42
    s_mov_b64 exec, -1
    s_mov_b32 s38, s5
    s_add_u32 s50, s50, 200000
    s_branch L_batch_61
L_bend_62:

    s_waitcnt vmcnt(0)
    s_load_dwordx2 s[68:69], s[0:1], 24
    s_load_dwordx4 s[88:91], s[0:1], 72
    s_load_dwordx2 s[76:77], s[0:1], 88
    s_load_dwordx2 s[80:81], s[0:1], 96
    s_mov_b32 s70, 1600000
    s_mov_b32 s71, 0x20000
    s_mov_b32 s78, 6400000
    s_mov_b32 s79, 0x20000
    s_movk_i32 s82, 256
    s_mov_b32 s83, 0x20000
    s_lshl_b32 s48, s36, 2
    s_mov_b32 s41, s37

    s_add_u32 s84, s6, 8896512
    s_addc_u32 s85, s7, 0
    s_mov_b32 s86, 76800000
    s_mov_b32 s87, 0x20000
    s_add_u32 s72, s6, 393216
    s_addc_u32 s73, s7, 0
    s_mov_b32 s74, 2097152
    s_mov_b32 s75, 0x20000
    s_waitcnt lgkmcnt(15)
    v_mad_i32_i16 v120, v28, v4, s96
    v_mad_i32_i16 v28, v28, v4, s96 op_sel:[1,0,0,0]
    v_mad_i32_i16 v121, v29, v4, s96
    v_mad_i32_i16 v29, v29, v4, s96 op_sel:[1,0,0,0]
    v_lshlrev_b32_sdwa v4, 3, v4 dst_sel:DWORD dst_unused:UNUSED_PAD src0_sel:DWORD src1_sel:WORD_1
    v_perm_b32 v28, v28, v120, s97
    v_perm_b32 v29, v29, v121, s97
    v_lshl_add_u64 v[28:29], v[28:29], 0, s[30:31]

    ds_add_rtn_u64 v[28:29], v4, v[28:29] offset:50000
    v_mad_i32_i16 v122, v30, v5, s96
    v_mad_i32_i16 v30, v30, v5, s96 op_sel:[1,0,0,0]
    v_mad_i32_i16 v123, v31, v5, s96
    v_mad_i32_i16 v31, v31, v5, s96 op_sel:[1,0,0,0]
    v_lshlrev_b32_sdwa v5, 3, v5 dst_sel:DWORD dst_unused:UNUSED_PAD src0_sel:DWORD src1_sel:WORD_1
    v_perm_b32 v30, v30, v122, s97
    v_perm_b32 v31, v31, v123, s97
    v_lshl_add_u64 v[30:31], v[30:31], 0, s[30:31]

    ds_add_rtn_u64 v[30:31], v5, v[30:31] offset:50000
    v_mad_i32_i16 v124, v32, v6, s96
    v_mad_i32_i16 v32, v32, v6, s96 op_sel:[1,0,0,0]
    v_mad_i32_i16 v125, v33, v6, s96
    v_mad_i32_i16 v33, v33, v6, s96 op_sel:[1,0,0,0]
    v_lshlrev_b32_sdwa v6, 3, v6 dst_sel:DWORD dst_unused:UNUSED_PAD src0_sel:DWORD src1_sel:WORD_1
    v_perm_b32 v32, v32, v124, s97
    v_perm_b32 v33, v33, v125, s97
    v_lshl_add_u64 v[32:33], v[32:33], 0, s[30:31]

    ds_add_rtn_u64 v[32:33], v6, v[32:33] offset:50000
    v_mad_i32_i16 v126, v34, v7, s96
    v_mad_i32_i16 v34, v34, v7, s96 op_sel:[1,0,0,0]
    v_mad_i32_i16 v127, v35, v7, s96
    v_mad_i32_i16 v35, v35, v7, s96 op_sel:[1,0,0,0]
    v_lshlrev_b32_sdwa v7, 3, v7 dst_sel:DWORD dst_unused:UNUSED_PAD src0_sel:DWORD src1_sel:WORD_1
    v_perm_b32 v34, v34, v126, s97
    v_perm_b32 v35, v35, v127, s97
    v_lshl_add_u64 v[34:35], v[34:35], 0, s[30:31]

    ds_add_rtn_u64 v[34:35], v7, v[34:35] offset:50000
    s_waitcnt lgkmcnt(0)
    s_load_dwordx8 s[12:19], s[88:89], 0
    s_load_dwordx8 s[56:63], s[90:91], 0

    s_mul_i32 s28, s41, 3125
    s_add_u32 s29, s28, 3126
    s_add_u32 s28, s28, 1
    s_lshr_b32 s28, s28, 1
    s_lshr_b32 s29, s29, 1
    s_sub_u32 s29, s29, s28
    s_sub_u32 s5, s29, 782
    s_mul_i32 s3, s36, 6250
    v_add_u32 v78, s28, v0
    v_mov_b32 v82, 0x2000000
    v_add_u32 v79, 782, v78
    v_cmp_gt_u32 vcc, 782, v0
    v_add_u32 v76, s3, v78
    v_add_u32 v77, s3, v79
    v_cndmask_b32 v76, v82, v76, vcc
    v_cmp_gt_u32 vcc, s5, v0
    v_lshlrev_b32 v78, 4, v78
    v_lshlrev_b32 v79, 4, v79
    v_cndmask_b32 v77, v82, v77, vcc
    v_lshlrev_b32 v80, 2, v76
    v_lshlrev_b32 v76, 4, v76
    v_lshlrev_b32 v81, 2, v77
    v_lshlrev_b32 v77, 4, v77
    buffer_load_dword v80, v80, s[68:71], 0 offen
    buffer_load_dword v81, v81, s[68:71], 0 offen
    buffer_load_dwordx4 v[86:89], v76, s[8:11], 0 offen
    buffer_load_dwordx4 v[90:93], v77, s[8:11], 0 offen

    v_mad_i32_i16 v120, v36, v8, s96
    v_mad_i32_i16 v36, v36, v8, s96 op_sel:[1,0,0,0]
    v_mad_i32_i16 v121, v37, v8, s96
    v_mad_i32_i16 v37, v37, v8, s96 op_sel:[1,0,0,0]
    v_lshlrev_b32_sdwa v8, 3, v8 dst_sel:DWORD dst_unused:UNUSED_PAD src0_sel:DWORD src1_sel:WORD_1
    v_perm_b32 v36, v36, v120, s97
    v_perm_b32 v37, v37, v121, s97
    v_lshl_add_u64 v[36:37], v[36:37], 0, s[30:31]

    ds_add_rtn_u64 v[36:37], v8, v[36:37] offset:50000
    v_mad_i32_i16 v122, v38, v9, s96
    v_mad_i32_i16 v38, v38, v9, s96 op_sel:[1,0,0,0]
    v_mad_i32_i16 v123, v39, v9, s96
    v_mad_i32_i16 v39, v39, v9, s96 op_sel:[1,0,0,0]
    v_lshlrev_b32_sdwa v9, 3, v9 dst_sel:DWORD dst_unused:UNUSED_PAD src0_sel:DWORD src1_sel:WORD_1
    v_perm_b32 v38, v38, v122, s97
    v_perm_b32 v39, v39, v123, s97
    v_lshl_add_u64 v[38:39], v[38:39], 0, s[30:31]

    ds_add_rtn_u64 v[38:39], v9, v[38:39] offset:50000
    v_mad_i32_i16 v124, v40, v10, s96
    v_mad_i32_i16 v40, v40, v10, s96 op_sel:[1,0,0,0]
    v_mad_i32_i16 v125, v41, v10, s96
    v_mad_i32_i16 v41, v41, v10, s96 op_sel:[1,0,0,0]
    v_lshlrev_b32_sdwa v10, 3, v10 dst_sel:DWORD dst_unused:UNUSED_PAD src0_sel:DWORD src1_sel:WORD_1
    v_perm_b32 v40, v40, v124, s97
    v_perm_b32 v41, v41, v125, s97
    v_lshl_add_u64 v[40:41], v[40:41], 0, s[30:31]

    ds_add_rtn_u64 v[40:41], v10, v[40:41] offset:50000
    v_mad_i32_i16 v126, v42, v11, s96
    v_mad_i32_i16 v42, v42, v11, s96 op_sel:[1,0,0,0]
    v_mad_i32_i16 v127, v43, v11, s96
    v_mad_i32_i16 v43, v43, v11, s96 op_sel:[1,0,0,0]
    v_lshlrev_b32_sdwa v11, 3, v11 dst_sel:DWORD dst_unused:UNUSED_PAD src0_sel:DWORD src1_sel:WORD_1
    v_perm_b32 v42, v42, v126, s97
    v_perm_b32 v43, v43, v127, s97
    v_lshl_add_u64 v[42:43], v[42:43], 0, s[30:31]

    ds_add_rtn_u64 v[42:43], v11, v[42:43] offset:50000
    v_or3_b32 v1, v28, v29, v1
    v_or3_b32 v1, v30, v31, v1
    v_or3_b32 v1, v32, v33, v1
    v_or3_b32 v1, v34, v35, v1
    v_mad_i32_i16 v120, v44, v12, s96
    v_mad_i32_i16 v44, v44, v12, s96 op_sel:[1,0,0,0]
    v_mad_i32_i16 v121, v45, v12, s96
    v_mad_i32_i16 v45, v45, v12, s96 op_sel:[1,0,0,0]
    v_lshlrev_b32_sdwa v12, 3, v12 dst_sel:DWORD dst_unused:UNUSED_PAD src0_sel:DWORD src1_sel:WORD_1
    v_perm_b32 v44, v44, v120, s97
    v_perm_b32 v45, v45, v121, s97
    v_lshl_add_u64 v[44:45], v[44:45], 0, s[30:31]

    ds_add_rtn_u64 v[44:45], v12, v[44:45] offset:50000
    v_mad_i32_i16 v122, v46, v13, s96
    v_mad_i32_i16 v46, v46, v13, s96 op_sel:[1,0,0,0]
    v_mad_i32_i16 v123, v47, v13, s96
    v_mad_i32_i16 v47, v47, v13, s96 op_sel:[1,0,0,0]
    v_lshlrev_b32_sdwa v13, 3, v13 dst_sel:DWORD dst_unused:UNUSED_PAD src0_sel:DWORD src1_sel:WORD_1
    v_perm_b32 v46, v46, v122, s97
    v_perm_b32 v47, v47, v123, s97
    v_lshl_add_u64 v[46:47], v[46:47], 0, s[30:31]

    ds_add_rtn_u64 v[46:47], v13, v[46:47] offset:50000
    v_mad_i32_i16 v124, v48, v14, s96
    v_mad_i32_i16 v48, v48, v14, s96 op_sel:[1,0,0,0]
    v_mad_i32_i16 v125, v49, v14, s96
    v_mad_i32_i16 v49, v49, v14, s96 op_sel:[1,0,0,0]
    v_lshlrev_b32_sdwa v14, 3, v14 dst_sel:DWORD dst_unused:UNUSED_PAD src0_sel:DWORD src1_sel:WORD_1
    v_perm_b32 v48, v48, v124, s97
    v_perm_b32 v49, v49, v125, s97
    v_lshl_add_u64 v[48:49], v[48:49], 0, s[30:31]

    ds_add_rtn_u64 v[48:49], v14, v[48:49] offset:50000
    v_mad_i32_i16 v126, v50, v15, s96
    v_mad_i32_i16 v50, v50, v15, s96 op_sel:[1,0,0,0]
    v_mad_i32_i16 v127, v51, v15, s96
    v_mad_i32_i16 v51, v51, v15, s96 op_sel:[1,0,0,0]
    v_lshlrev_b32_sdwa v15, 3, v15 dst_sel:DWORD dst_unused:UNUSED_PAD src0_sel:DWORD src1_sel:WORD_1
    v_perm_b32 v50, v50, v126, s97
    v_perm_b32 v51, v51, v127, s97
    v_lshl_add_u64 v[50:51], v[50:51], 0, s[30:31]

    ds_add_rtn_u64 v[50:51], v15, v[50:51] offset:50000
    s_waitcnt lgkmcnt(4)
    v_or3_b32 v1, v36, v37, v1
    v_or3_b32 v1, v38, v39, v1
    v_or3_b32 v1, v40, v41, v1
    v_or3_b32 v1, v42, v43, v1
    v_mad_i32_i16 v120, v52, v16, s96
    v_mad_i32_i16 v52, v52, v16, s96 op_sel:[1,0,0,0]
    v_mad_i32_i16 v121, v53, v16, s96
    v_mad_i32_i16 v53, v53, v16, s96 op_sel:[1,0,0,0]
    v_lshlrev_b32_sdwa v16, 3, v16 dst_sel:DWORD dst_unused:UNUSED_PAD src0_sel:DWORD src1_sel:WORD_1
    v_perm_b32 v52, v52, v120, s97
    v_perm_b32 v53, v53, v121, s97
    v_lshl_add_u64 v[52:53], v[52:53], 0, s[30:31]

    ds_add_rtn_u64 v[52:53], v16, v[52:53] offset:50000
    v_mad_i32_i16 v122, v54, v17, s96
    v_mad_i32_i16 v54, v54, v17, s96 op_sel:[1,0,0,0]
    v_mad_i32_i16 v123, v55, v17, s96
    v_mad_i32_i16 v55, v55, v17, s96 op_sel:[1,0,0,0]
    v_lshlrev_b32_sdwa v17, 3, v17 dst_sel:DWORD dst_unused:UNUSED_PAD src0_sel:DWORD src1_sel:WORD_1
    v_perm_b32 v54, v54, v122, s97
    v_perm_b32 v55, v55, v123, s97
    v_lshl_add_u64 v[54:55], v[54:55], 0, s[30:31]

    ds_add_rtn_u64 v[54:55], v17, v[54:55] offset:50000
    v_mad_i32_i16 v124, v56, v18, s96
    v_mad_i32_i16 v56, v56, v18, s96 op_sel:[1,0,0,0]
    v_mad_i32_i16 v125, v57, v18, s96
    v_mad_i32_i16 v57, v57, v18, s96 op_sel:[1,0,0,0]
    v_lshlrev_b32_sdwa v18, 3, v18 dst_sel:DWORD dst_unused:UNUSED_PAD src0_sel:DWORD src1_sel:WORD_1
    v_perm_b32 v56, v56, v124, s97
    v_perm_b32 v57, v57, v125, s97
    v_lshl_add_u64 v[56:57], v[56:57], 0, s[30:31]

    ds_add_rtn_u64 v[56:57], v18, v[56:57] offset:50000
    v_mad_i32_i16 v126, v58, v19, s96
    v_mad_i32_i16 v58, v58, v19, s96 op_sel:[1,0,0,0]
    v_mad_i32_i16 v127, v59, v19, s96
    v_mad_i32_i16 v59, v59, v19, s96 op_sel:[1,0,0,0]
    v_lshlrev_b32_sdwa v19, 3, v19 dst_sel:DWORD dst_unused:UNUSED_PAD src0_sel:DWORD src1_sel:WORD_1
    v_perm_b32 v58, v58, v126, s97
    v_perm_b32 v59, v59, v127, s97
    v_lshl_add_u64 v[58:59], v[58:59], 0, s[30:31]

    ds_add_rtn_u64 v[58:59], v19, v[58:59] offset:50000
    s_waitcnt lgkmcnt(4)
    v_or3_b32 v1, v44, v45, v1
    v_or3_b32 v1, v46, v47, v1
    v_or3_b32 v1, v48, v49, v1
    v_or3_b32 v1, v50, v51, v1
    s_waitcnt vmcnt(2)
    v_lshlrev_b32_sdwa v82, 5, v80 dst_sel:DWORD dst_unused:UNUSED_PAD src0_sel:DWORD src1_sel:WORD_0
    v_lshlrev_b32_sdwa v83, 5, v80 dst_sel:DWORD dst_unused:UNUSED_PAD src0_sel:DWORD src1_sel:WORD_1
    v_lshlrev_b32_sdwa v84, 5, v81 dst_sel:DWORD dst_unused:UNUSED_PAD src0_sel:DWORD src1_sel:WORD_0
    v_lshlrev_b32_sdwa v85, 5, v81 dst_sel:DWORD dst_unused:UNUSED_PAD src0_sel:DWORD src1_sel:WORD_1
    buffer_load_dwordx4 v[94:97], v82, s[72:75], 0 offen
    buffer_load_dwordx2 v[110:111], v82, s[72:75], 0 offen offset:16

    buffer_load_dwordx4 v[98:101], v83, s[72:75], 0 offen
    buffer_load_dwordx2 v[112:113], v83, s[72:75], 0 offen offset:16

    buffer_load_dwordx4 v[102:105], v84, s[72:75], 0 offen
    buffer_load_dwordx2 v[114:115], v84, s[72:75], 0 offen offset:16

    buffer_load_dwordx4 v[106:109], v85, s[72:75], 0 offen
    buffer_load_dwordx2 v[116:117], v85, s[72:75], 0 offen offset:16

    v_mad_i32_i16 v120, v60, v20, s96
    v_mad_i32_i16 v60, v60, v20, s96 op_sel:[1,0,0,0]
    v_mad_i32_i16 v121, v61, v20, s96
    v_mad_i32_i16 v61, v61, v20, s96 op_sel:[1,0,0,0]
    v_lshlrev_b32_sdwa v20, 3, v20 dst_sel:DWORD dst_unused:UNUSED_PAD src0_sel:DWORD src1_sel:WORD_1
    v_perm_b32 v60, v60, v120, s97
    v_perm_b32 v61, v61, v121, s97
    v_lshl_add_u64 v[60:61], v[60:61], 0, s[30:31]

    ds_add_rtn_u64 v[60:61], v20, v[60:61] offset:50000
    v_mad_i32_i16 v122, v62, v21, s96
    v_mad_i32_i16 v62, v62, v21, s96 op_sel:[1,0,0,0]
    v_mad_i32_i16 v123, v63, v21, s96
    v_mad_i32_i16 v63, v63, v21, s96 op_sel:[1,0,0,0]
    v_lshlrev_b32_sdwa v21, 3, v21 dst_sel:DWORD dst_unused:UNUSED_PAD src0_sel:DWORD src1_sel:WORD_1
    v_perm_b32 v62, v62, v122, s97
    v_perm_b32 v63, v63, v123, s97
    v_lshl_add_u64 v[62:63], v[62:63], 0, s[30:31]

    ds_add_rtn_u64 v[62:63], v21, v[62:63] offset:50000
    v_mad_i32_i16 v124, v64, v22, s96
    v_mad_i32_i16 v64, v64, v22, s96 op_sel:[1,0,0,0]
    v_mad_i32_i16 v125, v65, v22, s96
    v_mad_i32_i16 v65, v65, v22, s96 op_sel:[1,0,0,0]
    v_lshlrev_b32_sdwa v22, 3, v22 dst_sel:DWORD dst_unused:UNUSED_PAD src0_sel:DWORD src1_sel:WORD_1
    v_perm_b32 v64, v64, v124, s97
    v_perm_b32 v65, v65, v125, s97
    v_lshl_add_u64 v[64:65], v[64:65], 0, s[30:31]

    ds_add_rtn_u64 v[64:65], v22, v[64:65] offset:50000
    v_mad_i32_i16 v126, v66, v23, s96
    v_mad_i32_i16 v66, v66, v23, s96 op_sel:[1,0,0,0]
    v_mad_i32_i16 v127, v67, v23, s96
    v_mad_i32_i16 v67, v67, v23, s96 op_sel:[1,0,0,0]
    v_lshlrev_b32_sdwa v23, 3, v23 dst_sel:DWORD dst_unused:UNUSED_PAD src0_sel:DWORD src1_sel:WORD_1
    v_perm_b32 v66, v66, v126, s97
    v_perm_b32 v67, v67, v127, s97
    v_lshl_add_u64 v[66:67], v[66:67], 0, s[30:31]

    ds_add_rtn_u64 v[66:67], v23, v[66:67] offset:50000
    s_waitcnt lgkmcnt(4)
    v_or3_b32 v1, v52, v53, v1
    v_or3_b32 v1, v54, v55, v1
    v_or3_b32 v1, v56, v57, v1
    v_or3_b32 v1, v58, v59, v1
    v_mad_i32_i16 v120, v68, v24, s96
    v_mad_i32_i16 v68, v68, v24, s96 op_sel:[1,0,0,0]
    v_mad_i32_i16 v121, v69, v24, s96
    v_mad_i32_i16 v69, v69, v24, s96 op_sel:[1,0,0,0]
    v_lshlrev_b32_sdwa v24, 3, v24 dst_sel:DWORD dst_unused:UNUSED_PAD src0_sel:DWORD src1_sel:WORD_1
    v_perm_b32 v68, v68, v120, s97
    v_perm_b32 v69, v69, v121, s97
    v_lshl_add_u64 v[68:69], v[68:69], 0, s[30:31]

    ds_add_rtn_u64 v[68:69], v24, v[68:69] offset:50000
    v_mad_i32_i16 v122, v70, v25, s96
    v_mad_i32_i16 v70, v70, v25, s96 op_sel:[1,0,0,0]
    v_mad_i32_i16 v123, v71, v25, s96
    v_mad_i32_i16 v71, v71, v25, s96 op_sel:[1,0,0,0]
    v_lshlrev_b32_sdwa v25, 3, v25 dst_sel:DWORD dst_unused:UNUSED_PAD src0_sel:DWORD src1_sel:WORD_1
    v_perm_b32 v70, v70, v122, s97
    v_perm_b32 v71, v71, v123, s97
    v_lshl_add_u64 v[70:71], v[70:71], 0, s[30:31]

    ds_add_rtn_u64 v[70:71], v25, v[70:71] offset:50000
    v_mad_i32_i16 v124, v72, v26, s96
    v_mad_i32_i16 v72, v72, v26, s96 op_sel:[1,0,0,0]
    v_mad_i32_i16 v125, v73, v26, s96
    v_mad_i32_i16 v73, v73, v26, s96 op_sel:[1,0,0,0]
    v_lshlrev_b32_sdwa v26, 3, v26 dst_sel:DWORD dst_unused:UNUSED_PAD src0_sel:DWORD src1_sel:WORD_1
    v_perm_b32 v72, v72, v124, s97
    v_perm_b32 v73, v73, v125, s97
    v_lshl_add_u64 v[72:73], v[72:73], 0, s[30:31]

    ds_add_rtn_u64 v[72:73], v26, v[72:73] offset:50000
    v_mad_i32_i16 v126, v74, v27, s96
    v_mad_i32_i16 v74, v74, v27, s96 op_sel:[1,0,0,0]
    v_mad_i32_i16 v127, v75, v27, s96
    v_mad_i32_i16 v75, v75, v27, s96 op_sel:[1,0,0,0]
    v_lshlrev_b32_sdwa v27, 3, v27 dst_sel:DWORD dst_unused:UNUSED_PAD src0_sel:DWORD src1_sel:WORD_1
    v_perm_b32 v74, v74, v126, s97
    v_perm_b32 v75, v75, v127, s97
    v_lshl_add_u64 v[74:75], v[74:75], 0, s[30:31]

    ds_add_rtn_u64 v[74:75], v27, v[74:75] offset:50000
    s_waitcnt lgkmcnt(4)
    v_or3_b32 v1, v60, v61, v1
    v_or3_b32 v1, v62, v63, v1
    v_or3_b32 v1, v64, v65, v1
    v_or3_b32 v1, v66, v67, v1
    s_waitcnt lgkmcnt(0)
    v_or3_b32 v1, v68, v69, v1
    v_or3_b32 v1, v70, v71, v1
    v_or3_b32 v1, v72, v73, v1
    v_or3_b32 v1, v74, v75, v1
    s_barrier

    v_add_u32 v40, 50000, v3
    v_add_u32 v41, 115536, v3
    v_cmp_gt_u32 vcc, 106, v0

    v_mov_b32 v28, 0
    v_mov_b32 v29, 0
    v_mov_b32 v30, 0
    v_mov_b32 v31, 0
    ds_read_b128 v[4:7], v40 offset:0
    ds_read_b128 v[8:11], v40 offset:16384
    ds_read_b128 v[12:15], v40 offset:32768
    ds_read_b128 v[16:19], v40 offset:49152
    ds_read_b128 v[20:23], v41 offset:0
    ds_read_b128 v[24:27], v41 offset:16384
    s_mov_b64 exec, vcc
    ds_read_b128 v[28:31], v41 offset:32768
    s_mov_b64 exec, -1
    s_mul_i32 s3, s37, 6400000
    s_mul_i32 s5, s36, 100000
    s_add_u32 s3, s3, s5
    s_add_u32 s3, s3, 8896512
    v_bfrev_b32 v42, 1

    s_add_u32 s20, s6, s3
    s_addc_u32 s21, s7, 0
    s_mov_b32 s22, 100000
    s_mov_b32 s23, 0x20000
    s_sub_u32 s3, 0, s28
    v_add_u32 v43, s3, v0
    v_cmp_gt_u32 vcc, s29, v43
    s_mov_b32 s3, 0
    s_waitcnt lgkmcnt(6)
    v_cndmask_b32 v43, v3, v42, vcc
    buffer_store_dwordx4 v[4:7], v43, s[20:23], s3 offen sc1

    s_sub_u32 s3, 1024, s28
    v_add_u32 v43, s3, v0
    v_cmp_gt_u32 vcc, s29, v43
    s_mov_b32 s3, 16384
    s_waitcnt lgkmcnt(5)
    v_cndmask_b32 v43, v3, v42, vcc
    buffer_store_dwordx4 v[8:11], v43, s[20:23], s3 offen sc1

    s_sub_u32 s3, 2048, s28
    v_add_u32 v43, s3, v0
    v_cmp_gt_u32 vcc, s29, v43
    s_mov_b32 s3, 32768
    s_waitcnt lgkmcnt(4)
    v_cndmask_b32 v43, v3, v42, vcc
    buffer_store_dwordx4 v[12:15], v43, s[20:23], s3 offen sc1

    s_sub_u32 s3, 3072, s28
    v_add_u32 v43, s3, v0
    v_cmp_gt_u32 vcc, s29, v43
    s_mov_b32 s3, 49152
    s_waitcnt lgkmcnt(3)
    v_cndmask_b32 v43, v3, v42, vcc
    buffer_store_dwordx4 v[16:19], v43, s[20:23], s3 offen sc1

    s_sub_u32 s3, 4096, s28
    v_add_u32 v43, s3, v0
    v_cmp_gt_u32 vcc, s29, v43
    s_mov_b32 s3, 65536
    s_waitcnt lgkmcnt(2)
    v_cndmask_b32 v43, v3, v42, vcc
    buffer_store_dwordx4 v[20:23], v43, s[20:23], s3 offen sc1

    s_sub_u32 s3, 5120, s28
    v_add_u32 v43, s3, v0
    v_cmp_gt_u32 vcc, s29, v43
    s_mov_b32 s3, 81920
    s_waitcnt lgkmcnt(1)
    v_cndmask_b32 v43, v3, v42, vcc
    buffer_store_dwordx4 v[24:27], v43, s[20:23], s3 offen sc1

    s_sub_u32 s3, 6144, s28
    v_add_u32 v43, s3, v0
    v_cmp_gt_u32 vcc, s29, v43
    s_mov_b32 s3, 98304
    s_waitcnt lgkmcnt(0)
    v_cndmask_b32 v43, v3, v42, vcc
    buffer_store_dwordx4 v[28:31], v43, s[20:23], s3 offen sc1

    v_or3_b32 v1, v4, v5, v1
    v_or3_b32 v1, v6, v7, v1
    v_or3_b32 v1, v8, v9, v1
    v_or3_b32 v1, v10, v11, v1
    v_or3_b32 v1, v12, v13, v1
    v_or3_b32 v1, v14, v15, v1
    v_or3_b32 v1, v16, v17, v1
    v_or3_b32 v1, v18, v19, v1
    v_or3_b32 v1, v20, v21, v1
    v_or3_b32 v1, v22, v23, v1
    v_or3_b32 v1, v24, v25, v1
    v_or3_b32 v1, v26, v27, v1
    v_or3_b32 v1, v28, v29, v1
    v_or3_b32 v1, v30, v31, v1
    v_and_b32 v1, 0x80008000, v1
    v_cmp_ne_u32 vcc, 0, v1
    v_mov_b32 v40, 150024
    v_mov_b32 v41, 1
    s_cbranch_vccz L_nf_82
    ds_write_b32 v40, v41
L_nf_82:
    s_mov_b32 s33, 1
    s_mov_b32 s49, s37
    s_waitcnt vmcnt(0) lgkmcnt(0)

    s_barrier
    ds_read_b32 v41, v40
    s_waitcnt lgkmcnt(0)
    v_readfirstlane_b32 s3, v41
    s_nop 1
    s_cmp_lg_u32 s3, 0
    s_cbranch_scc1 L_p2slow_48

L_meet_84:
    v_readfirstlane_b32 s3, v0
    v_mov_b32 v118, 150016
    s_nop 0
    s_cmp_eq_u32 s3, 960
    s_cbranch_scc1 L_sync_91
L_bcast_86:
    s_barrier

    ds_read_b32 v119, v118
    s_waitcnt lgkmcnt(0)
    v_readfirstlane_b32 s35, v119
    s_nop 1
    s_bitcmp1_b32 s35, 16
    s_cbranch_scc1 L_fend_92
L_post_88:
    v_cmp_gt_u32 vcc, 782, v0
    s_mov_b64 exec, vcc
    s_cbranch_execz L_postend_89

    s_cmp_eq_u32 s49, 0
    s_cbranch_scc1 L_own_98
    s_mov_b32 s3, 0
    buffer_load_dwordx4 v[36:39], v76, s[84:87], s3 offen sc1
    buffer_load_dwordx4 v[52:55], v77, s[84:87], s3 offen sc1
L_obk_99:
    s_cmp_eq_u32 s49, 1
    s_cbranch_scc1 L_own_100
    s_mov_b32 s3, 6400000
    buffer_load_dwordx4 v[40:43], v76, s[84:87], s3 offen sc1
    buffer_load_dwordx4 v[56:59], v77, s[84:87], s3 offen sc1
L_obk_101:
    s_cmp_eq_u32 s49, 2
    s_cbranch_scc1 L_own_102
    s_mov_b32 s3, 12800000
    buffer_load_dwordx4 v[44:47], v76, s[84:87], s3 offen sc1
    buffer_load_dwordx4 v[60:63], v77, s[84:87], s3 offen sc1
L_obk_103:
    s_cmp_eq_u32 s49, 3
    s_cbranch_scc1 L_own_104
    s_mov_b32 s3, 19200000
    buffer_load_dwordx4 v[48:51], v76, s[84:87], s3 offen sc1
    buffer_load_dwordx4 v[64:67], v77, s[84:87], s3 offen sc1
L_obk_105:
    s_and_b32 s3, s35, 0xf0
    s_waitcnt vmcnt(0) lgkmcnt(0)
    s_cbranch_scc1 L_fgen_106

    v_add_u32 v36, v36, v40
    v_add_u32 v44, v44, v48
    v_add_u32 v37, v37, v41
    v_add_u32 v45, v45, v49
    v_add_u32 v38, v38, v42
    v_add_u32 v46, v46, v50
    v_add_u32 v39, v39, v43
    v_add_u32 v47, v47, v51
    v_add_u32_sdwa v4, v36, v44 dst_sel:DWORD dst_unused:UNUSED_PAD src0_sel:WORD_0 src1_sel:WORD_0
    v_add_u32_sdwa v5, v36, v44 dst_sel:DWORD dst_unused:UNUSED_PAD src0_sel:WORD_1 src1_sel:WORD_1
    v_add_u32_sdwa v6, v37, v45 dst_sel:DWORD dst_unused:UNUSED_PAD src0_sel:WORD_0 src1_sel:WORD_0
    v_add_u32_sdwa v7, v37, v45 dst_sel:DWORD dst_unused:UNUSED_PAD src0_sel:WORD_1 src1_sel:WORD_1
    v_add_u32_sdwa v8, v38, v46 dst_sel:DWORD dst_unused:UNUSED_PAD src0_sel:WORD_0 src1_sel:WORD_0
    v_add_u32_sdwa v9, v38, v46 dst_sel:DWORD dst_unused:UNUSED_PAD src0_sel:WORD_1 src1_sel:WORD_1
    v_add_u32_sdwa v10, v39, v47 dst_sel:DWORD dst_unused:UNUSED_PAD src0_sel:WORD_0 src1_sel:WORD_0
    v_add_u32_sdwa v11, v39, v47 dst_sel:DWORD dst_unused:UNUSED_PAD src0_sel:WORD_1 src1_sel:WORD_1
    v_add_u32 v52, v52, v56
    v_add_u32 v60, v60, v64
    v_add_u32 v53, v53, v57
    v_add_u32 v61, v61, v65
    v_add_u32 v54, v54, v58
    v_add_u32 v62, v62, v66
    v_add_u32 v55, v55, v59
    v_add_u32 v63, v63, v67
    v_add_u32_sdwa v12, v52, v60 dst_sel:DWORD dst_unused:UNUSED_PAD src0_sel:WORD_0 src1_sel:WORD_0
    v_add_u32_sdwa v13, v52, v60 dst_sel:DWORD dst_unused:UNUSED_PAD src0_sel:WORD_1 src1_sel:WORD_1
    v_add_u32_sdwa v14, v53, v61 dst_sel:DWORD dst_unused:UNUSED_PAD src0_sel:WORD_0 src1_sel:WORD_0
    v_add_u32_sdwa v15, v53, v61 dst_sel:DWORD dst_unused:UNUSED_PAD src0_sel:WORD_1 src1_sel:WORD_1
    v_add_u32_sdwa v16, v54, v62 dst_sel:DWORD dst_unused:UNUSED_PAD src0_sel:WORD_0 src1_sel:WORD_0
    v_add_u32_sdwa v17, v54, v62 dst_sel:DWORD dst_unused:UNUSED_PAD src0_sel:WORD_1 src1_sel:WORD_1
    v_add_u32_sdwa v18, v55, v63 dst_sel:DWORD dst_unused:UNUSED_PAD src0_sel:WORD_0 src1_sel:WORD_0
    v_add_u32_sdwa v19, v55, v63 dst_sel:DWORD dst_unused:UNUSED_PAD src0_sel:WORD_1 src1_sel:WORD_1
    v_add_u32 v4, 0xffff0000, v4
    v_add_u32 v5, 0xffff0000, v5
    v_add_u32 v6, 0xffff0000, v6
    v_add_u32 v7, 0xffff0000, v7
    v_add_u32 v8, 0xffff0000, v8
    v_add_u32 v9, 0xffff0000, v9
    v_add_u32 v10, 0xffff0000, v10
    v_add_u32 v11, 0xffff0000, v11
    v_add_u32 v12, 0xffff0000, v12
    v_add_u32 v13, 0xffff0000, v13
    v_add_u32 v14, 0xffff0000, v14
    v_add_u32 v15, 0xffff0000, v15
    v_add_u32 v16, 0xffff0000, v16
    v_add_u32 v17, 0xffff0000, v17
    v_add_u32 v18, 0xffff0000, v18
    v_add_u32 v19, 0xffff0000, v19
    v_cvt_f32_i32 v4, v4
    v_cvt_f32_i32 v5, v5
    v_cvt_f32_i32 v6, v6
    v_cvt_f32_i32 v7, v7
    v_cvt_f32_i32 v8, v8
    v_cvt_f32_i32 v9, v9
    v_cvt_f32_i32 v10, v10
    v_cvt_f32_i32 v11, v11
    v_cvt_f32_i32 v12, v12
    v_cvt_f32_i32 v13, v13
    v_cvt_f32_i32 v14, v14
    v_cvt_f32_i32 v15, v15
    v_cvt_f32_i32 v16, v16
    v_cvt_f32_i32 v17, v17
    v_cvt_f32_i32 v18, v18
    v_cvt_f32_i32 v19, v19
    v_mul_f32 v4, s34, v4
    v_mul_f32 v5, s34, v5
    v_mul_f32 v6, s34, v6
    v_mul_f32 v7, s34, v7
    v_mul_f32 v8, s34, v8
    v_mul_f32 v9, s34, v9
    v_mul_f32 v10, s34, v10
    v_mul_f32 v11, s34, v11
    v_mul_f32 v12, s34, v12
    v_mul_f32 v13, s34, v13
    v_mul_f32 v14, s34, v14
    v_mul_f32 v15, s34, v15
    v_mul_f32 v16, s34, v16
    v_mul_f32 v17, s34, v17
    v_mul_f32 v18, s34, v18
    v_mul_f32 v19, s34, v19
L_fbk_107:
    s_lshl_b32 s52, s12, 16
    v_mul_f32 v20, s52, v4
    v_mul_f32 v24, s52, v8
    v_mul_f32 v28, s52, v12
    v_mul_f32 v32, s52, v16
    s_and_b32 s53, s12, s32
    v_mul_f32 v21, s53, v4
    v_mul_f32 v25, s53, v8
    v_mul_f32 v29, s53, v12
    v_mul_f32 v33, s53, v16
    s_lshl_b32 s52, s13, 16
    v_mul_f32 v22, s52, v4
    v_mul_f32 v26, s52, v8
    v_mul_f32 v30, s52, v12
    v_mul_f32 v34, s52, v16
    s_and_b32 s53, s13, s32
    v_mul_f32 v23, s53, v4
    v_mul_f32 v27, s53, v8
    v_mul_f32 v31, s53, v12
    v_mul_f32 v35, s53, v16
    s_lshl_b32 s52, s14, 16
    v_fmac_f32 v20, s52, v5
    v_fmac_f32 v24, s52, v9
    v_fmac_f32 v28, s52, v13
    v_fmac_f32 v32, s52, v17
    s_and_b32 s53, s14, s32
    v_fmac_f32 v21, s53, v5
    v_fmac_f32 v25, s53, v9
    v_fmac_f32 v29, s53, v13
    v_fmac_f32 v33, s53, v17
    s_lshl_b32 s52, s15, 16
    v_fmac_f32 v22, s52, v5
    v_fmac_f32 v26, s52, v9
    v_fmac_f32 v30, s52, v13
    v_fmac_f32 v34, s52, v17
    s_and_b32 s53, s15, s32
    v_fmac_f32 v23, s53, v5
    v_fmac_f32 v27, s53, v9
    v_fmac_f32 v31, s53, v13
    v_fmac_f32 v35, s53, v17
    s_lshl_b32 s52, s16, 16
    v_fmac_f32 v20, s52, v6
    v_fmac_f32 v24, s52, v10
    v_fmac_f32 v28, s52, v14
    v_fmac_f32 v32, s52, v18
    s_and_b32 s53, s16, s32
    v_fmac_f32 v21, s53, v6
    v_fmac_f32 v25, s53, v10
    v_fmac_f32 v29, s53, v14
    v_fmac_f32 v33, s53, v18
    s_lshl_b32 s52, s17, 16
    v_fmac_f32 v22, s52, v6
    v_fmac_f32 v26, s52, v10
    v_fmac_f32 v30, s52, v14
    v_fmac_f32 v34, s52, v18
    s_and_b32 s53, s17, s32
    v_fmac_f32 v23, s53, v6
    v_fmac_f32 v27, s53, v10
    v_fmac_f32 v31, s53, v14
    v_fmac_f32 v35, s53, v18
    s_lshl_b32 s52, s18, 16
    v_fmac_f32 v20, s52, v7
    v_fmac_f32 v24, s52, v11
    v_fmac_f32 v28, s52, v15
    v_fmac_f32 v32, s52, v19
    s_and_b32 s53, s18, s32
    v_fmac_f32 v21, s53, v7
    v_fmac_f32 v25, s53, v11
    v_fmac_f32 v29, s53, v15
    v_fmac_f32 v33, s53, v19
    s_lshl_b32 s52, s19, 16
    v_fmac_f32 v22, s52, v7
    v_fmac_f32 v26, s52, v11
    v_fmac_f32 v30, s52, v15
    v_fmac_f32 v34, s52, v19
    s_and_b32 s53, s19, s32
    v_fmac_f32 v23, s53, v7
    v_fmac_f32 v27, s53, v11
    v_fmac_f32 v31, s53, v15
    v_fmac_f32 v35, s53, v19
    v_mul_f32 v20, v20, v94
    v_mul_f32 v21, v21, v95
    v_mul_f32 v22, v22, v96
    v_mul_f32 v23, v23, v97
    v_mul_f32 v24, v24, v98
    v_mul_f32 v25, v25, v99
    v_mul_f32 v26, v26, v100
    v_mul_f32 v27, v27, v101
    v_mul_f32 v28, v28, v102
    v_mul_f32 v29, v29, v103
    v_mul_f32 v30, v30, v104
    v_mul_f32 v31, v31, v105
    v_mul_f32 v32, v32, v106
    v_mul_f32 v33, v33, v107
    v_mul_f32 v34, v34, v108
    v_mul_f32 v35, v35, v109
    v_cvt_pk_bf16_f32 v20, v20, v21
    v_cvt_pk_bf16_f32 v22, v22, v23
    v_cvt_pk_bf16_f32 v24, v24, v25
    v_cvt_pk_bf16_f32 v26, v26, v27
    v_cvt_pk_bf16_f32 v28, v28, v29
    v_cvt_pk_bf16_f32 v30, v30, v31
    v_cvt_pk_bf16_f32 v32, v32, v33
    v_cvt_pk_bf16_f32 v34, v34, v35
    s_pack_ll_b32_b16 s52, s56, s58
    v_dot2_f32_bf16 v4, v20, s52, 0
    v_dot2_f32_bf16 v8, v24, s52, 0
    v_dot2_f32_bf16 v12, v28, s52, 0
    v_dot2_f32_bf16 v16, v32, s52, 0
    s_pack_hh_b32_b16 s53, s56, s58
    v_dot2_f32_bf16 v5, v20, s53, 0
    v_dot2_f32_bf16 v9, v24, s53, 0
    v_dot2_f32_bf16 v13, v28, s53, 0
    v_dot2_f32_bf16 v17, v32, s53, 0
    s_pack_ll_b32_b16 s52, s57, s59
    v_dot2_f32_bf16 v6, v20, s52, 0
    v_dot2_f32_bf16 v10, v24, s52, 0
    v_dot2_f32_bf16 v14, v28, s52, 0
    v_dot2_f32_bf16 v18, v32, s52, 0
    s_pack_hh_b32_b16 s53, s57, s59
    v_dot2_f32_bf16 v7, v20, s53, 0
    v_dot2_f32_bf16 v11, v24, s53, 0
    v_dot2_f32_bf16 v15, v28, s53, 0
    v_dot2_f32_bf16 v19, v32, s53, 0
    s_pack_ll_b32_b16 s52, s60, s62
    v_dot2_f32_bf16 v4, v22, s52, v4
    v_dot2_f32_bf16 v8, v26, s52, v8
    v_dot2_f32_bf16 v12, v30, s52, v12
    v_dot2_f32_bf16 v16, v34, s52, v16
    s_pack_hh_b32_b16 s53, s60, s62
    v_dot2_f32_bf16 v5, v22, s53, v5
    v_dot2_f32_bf16 v9, v26, s53, v9
    v_dot2_f32_bf16 v13, v30, s53, v13
    v_dot2_f32_bf16 v17, v34, s53, v17
    s_pack_ll_b32_b16 s52, s61, s63
    v_dot2_f32_bf16 v6, v22, s52, v6
    v_dot2_f32_bf16 v10, v26, s52, v10
    v_dot2_f32_bf16 v14, v30, s52, v14
    v_dot2_f32_bf16 v18, v34, s52, v18
    s_pack_hh_b32_b16 s53, s61, s63
    v_dot2_f32_bf16 v7, v22, s53, v7
    v_dot2_f32_bf16 v11, v26, s53, v11
    v_dot2_f32_bf16 v15, v30, s53, v15
    v_dot2_f32_bf16 v19, v34, s53, v19
    v_lshlrev_b32 v36, 16, v86
    v_and_b32 v37, s32, v86
    v_lshlrev_b32 v52, 16, v110
    v_and_b32 v53, s32, v110
    v_lshlrev_b32 v38, 16, v87
    v_and_b32 v39, s32, v87
    v_lshlrev_b32 v54, 16, v111
    v_and_b32 v55, s32, v111
    v_lshlrev_b32 v40, 16, v88
    v_and_b32 v41, s32, v88
    v_lshlrev_b32 v56, 16, v112
    v_and_b32 v57, s32, v112
    v_lshlrev_b32 v42, 16, v89
    v_and_b32 v43, s32, v89
    v_lshlrev_b32 v58, 16, v113
    v_and_b32 v59, s32, v113
    v_lshlrev_b32 v44, 16, v90
    v_and_b32 v45, s32, v90
    v_lshlrev_b32 v60, 16, v114
    v_and_b32 v61, s32, v114
    v_lshlrev_b32 v46, 16, v91
    v_and_b32 v47, s32, v91
    v_lshlrev_b32 v62, 16, v115
    v_and_b32 v63, s32, v115
    v_lshlrev_b32 v48, 16, v92
    v_and_b32 v49, s32, v92
    v_lshlrev_b32 v64, 16, v116
    v_and_b32 v65, s32, v116
    v_lshlrev_b32 v50, 16, v93
    v_and_b32 v51, s32, v93
    v_lshlrev_b32 v66, 16, v117
    v_and_b32 v67, s32, v117
    v_cvt_pk_bf16_f32 v4, v4, v5
    v_cvt_pk_bf16_f32 v6, v6, v7
    v_cvt_pk_bf16_f32 v8, v8, v9
    v_cvt_pk_bf16_f32 v10, v10, v11
    v_cvt_pk_bf16_f32 v12, v12, v13
    v_cvt_pk_bf16_f32 v14, v14, v15
    v_cvt_pk_bf16_f32 v16, v16, v17
    v_cvt_pk_bf16_f32 v18, v18, v19
    v_and_b32 v5, s32, v4
    v_lshlrev_b32 v4, 16, v4
    v_and_b32 v7, s32, v6
    v_lshlrev_b32 v6, 16, v6
    v_and_b32 v9, s32, v8
    v_lshlrev_b32 v8, 16, v8
    v_and_b32 v11, s32, v10
    v_lshlrev_b32 v10, 16, v10
    v_and_b32 v13, s32, v12
    v_lshlrev_b32 v12, 16, v12
    v_and_b32 v15, s32, v14
    v_lshlrev_b32 v14, 16, v14
    v_and_b32 v17, s32, v16
    v_lshlrev_b32 v16, 16, v16
    v_and_b32 v19, s32, v18
    v_lshlrev_b32 v18, 16, v18
    v_mul_f32 v4, v4, v52
    v_mul_f32 v5, v5, v53
    v_mul_f32 v6, v6, v54
    v_mul_f32 v7, v7, v55
    v_mul_f32 v8, v8, v56
    v_mul_f32 v9, v9, v57
    v_mul_f32 v10, v10, v58
    v_mul_f32 v11, v11, v59
    v_mul_f32 v12, v12, v60
    v_mul_f32 v13, v13, v61
    v_mul_f32 v14, v14, v62
    v_mul_f32 v15, v15, v63
    v_mul_f32 v16, v16, v64
    v_mul_f32 v17, v17, v65
    v_mul_f32 v18, v18, v66
    v_mul_f32 v19, v19, v67
    v_cvt_pk_bf16_f32 v4, v4, v5
    v_cvt_pk_bf16_f32 v6, v6, v7
    v_cvt_pk_bf16_f32 v8, v8, v9
    v_cvt_pk_bf16_f32 v10, v10, v11
    v_cvt_pk_bf16_f32 v12, v12, v13
    v_cvt_pk_bf16_f32 v14, v14, v15
    v_cvt_pk_bf16_f32 v16, v16, v17
    v_cvt_pk_bf16_f32 v18, v18, v19
    v_and_b32 v5, s32, v4
    v_lshlrev_b32 v4, 16, v4
    v_and_b32 v7, s32, v6
    v_lshlrev_b32 v6, 16, v6
    v_and_b32 v9, s32, v8
    v_lshlrev_b32 v8, 16, v8
    v_and_b32 v11, s32, v10
    v_lshlrev_b32 v10, 16, v10
    v_and_b32 v13, s32, v12
    v_lshlrev_b32 v12, 16, v12
    v_and_b32 v15, s32, v14
    v_lshlrev_b32 v14, 16, v14
    v_and_b32 v17, s32, v16
    v_lshlrev_b32 v16, 16, v16
    v_and_b32 v19, s32, v18
    v_lshlrev_b32 v18, 16, v18
    v_add_f32 v4, v4, v36
    v_add_f32 v5, v5, v37
    v_add_f32 v6, v6, v38
    v_add_f32 v7, v7, v39
    v_add_f32 v8, v8, v40
    v_add_f32 v9, v9, v41
    v_add_f32 v10, v10, v42
    v_add_f32 v11, v11, v43
    v_add_f32 v12, v12, v44
    v_add_f32 v13, v13, v45
    v_add_f32 v14, v14, v46
    v_add_f32 v15, v15, v47
    v_add_f32 v16, v16, v48
    v_add_f32 v17, v17, v49
    v_add_f32 v18, v18, v50
    v_add_f32 v19, v19, v51
    v_cvt_pk_bf16_f32 v20, v4, v5
    v_cvt_pk_bf16_f32 v21, v6, v7
    v_cvt_pk_bf16_f32 v22, v8, v9
    v_cvt_pk_bf16_f32 v23, v10, v11
    v_cvt_pk_bf16_f32 v24, v12, v13
    v_cvt_pk_bf16_f32 v25, v14, v15
    v_cvt_pk_bf16_f32 v26, v16, v17
    v_cvt_pk_bf16_f32 v27, v18, v19
    buffer_store_dwordx4 v[20:23], v76, s[76:79], 0 offen
    buffer_store_dwordx4 v[24:27], v77, s[76:79], 0 offen
L_postend_89:
    s_mov_b64 exec, -1

    s_bfe_u32 s3, s35, 0x40008
    s_cbranch_scc0 L_fend_92
    s_ff1_i32_b32 s41, s3
    s_add_u32 s3, s41, 8
    s_bitset0_b32 s35, s3
    s_mov_b32 s49, -1

    s_mul_i32 s28, s41, 3125
    s_add_u32 s29, s28, 3126
    s_add_u32 s28, s28, 1
    s_lshr_b32 s28, s28, 1
    s_lshr_b32 s29, s29, 1
    s_sub_u32 s29, s29, s28
    s_sub_u32 s5, s29, 782
    s_mul_i32 s3, s36, 6250
    v_add_u32 v78, s28, v0
    v_mov_b32 v82, 0x2000000
    v_add_u32 v79, 782, v78
    v_cmp_gt_u32 vcc, 782, v0
    v_add_u32 v76, s3, v78
    v_add_u32 v77, s3, v79
    v_cndmask_b32 v76, v82, v76, vcc
    v_cmp_gt_u32 vcc, s5, v0
    v_lshlrev_b32 v78, 4, v78
    v_lshlrev_b32 v79, 4, v79
    v_cndmask_b32 v77, v82, v77, vcc
    v_lshlrev_b32 v80, 2, v76
    v_lshlrev_b32 v76, 4, v76
    v_lshlrev_b32 v81, 2, v77
    v_lshlrev_b32 v77, 4, v77
    buffer_load_dword v80, v80, s[68:71], 0 offen
    buffer_load_dword v81, v81, s[68:71], 0 offen
    buffer_load_dwordx4 v[86:89], v76, s[8:11], 0 offen
    buffer_load_dwordx4 v[90:93], v77, s[8:11], 0 offen

    s_waitcnt vmcnt(2)
    v_lshlrev_b32_sdwa v82, 5, v80 dst_sel:DWORD dst_unused:UNUSED_PAD src0_sel:DWORD src1_sel:WORD_0
    v_lshlrev_b32_sdwa v83, 5, v80 dst_sel:DWORD dst_unused:UNUSED_PAD src0_sel:DWORD src1_sel:WORD_1
    v_lshlrev_b32_sdwa v84, 5, v81 dst_sel:DWORD dst_unused:UNUSED_PAD src0_sel:DWORD src1_sel:WORD_0
    v_lshlrev_b32_sdwa v85, 5, v81 dst_sel:DWORD dst_unused:UNUSED_PAD src0_sel:DWORD src1_sel:WORD_1
    buffer_load_dwordx4 v[94:97], v82, s[72:75], 0 offen
    buffer_load_dwordx2 v[110:111], v82, s[72:75], 0 offen offset:16

    buffer_load_dwordx4 v[98:101], v83, s[72:75], 0 offen
    buffer_load_dwordx2 v[112:113], v83, s[72:75], 0 offen offset:16

    buffer_load_dwordx4 v[102:105], v84, s[72:75], 0 offen
    buffer_load_dwordx2 v[114:115], v84, s[72:75], 0 offen offset:16

    buffer_load_dwordx4 v[106:109], v85, s[72:75], 0 offen
    buffer_load_dwordx2 v[116:117], v85, s[72:75], 0 offen offset:16

    s_branch L_post_88
L_fin_83:

    s_load_dwordx2 s[68:69], s[0:1], 24
    s_load_dwordx4 s[88:91], s[0:1], 72
    s_load_dwordx2 s[76:77], s[0:1], 88
    s_load_dwordx2 s[80:81], s[0:1], 96
    s_mov_b32 s70, 1600000
    s_mov_b32 s71, 0x20000
    s_mov_b32 s78, 6400000
    s_mov_b32 s79, 0x20000
    s_movk_i32 s82, 256
    s_mov_b32 s83, 0x20000
    s_lshl_b32 s48, s36, 2
    s_mov_b32 s41, s37

    s_add_u32 s84, s6, 8896512
    s_addc_u32 s85, s7, 0
    s_mov_b32 s86, 76800000
    s_mov_b32 s87, 0x20000
    s_add_u32 s72, s6, 393216
    s_addc_u32 s73, s7, 0
    s_mov_b32 s74, 2097152
    s_mov_b32 s75, 0x20000
    s_mov_b32 s49, -1
    s_waitcnt lgkmcnt(0)
    s_load_dwordx8 s[12:19], s[88:89], 0
    s_load_dwordx8 s[56:63], s[90:91], 0

    s_mul_i32 s28, s41, 3125
    s_add_u32 s29, s28, 3126
    s_add_u32 s28, s28, 1
    s_lshr_b32 s28, s28, 1
    s_lshr_b32 s29, s29, 1
    s_sub_u32 s29, s29, s28
    s_sub_u32 s5, s29, 782
    s_mul_i32 s3, s36, 6250
    v_add_u32 v78, s28, v0
    v_mov_b32 v82, 0x2000000
    v_add_u32 v79, 782, v78
    v_cmp_gt_u32 vcc, 782, v0
    v_add_u32 v76, s3, v78
    v_add_u32 v77, s3, v79
    v_cndmask_b32 v76, v82, v76, vcc
    v_cmp_gt_u32 vcc, s5, v0
    v_lshlrev_b32 v78, 4, v78
    v_lshlrev_b32 v79, 4, v79
    v_cndmask_b32 v77, v82, v77, vcc
    v_lshlrev_b32 v80, 2, v76
    v_lshlrev_b32 v76, 4, v76
    v_lshlrev_b32 v81, 2, v77
    v_lshlrev_b32 v77, 4, v77
    buffer_load_dword v80, v80, s[68:71], 0 offen
    buffer_load_dword v81, v81, s[68:71], 0 offen
    buffer_load_dwordx4 v[86:89], v76, s[8:11], 0 offen
    buffer_load_dwordx4 v[90:93], v77, s[8:11], 0 offen

    s_waitcnt vmcnt(2)
    v_lshlrev_b32_sdwa v82, 5, v80 dst_sel:DWORD dst_unused:UNUSED_PAD src0_sel:DWORD src1_sel:WORD_0
    v_lshlrev_b32_sdwa v83, 5, v80 dst_sel:DWORD dst_unused:UNUSED_PAD src0_sel:DWORD src1_sel:WORD_1
    v_lshlrev_b32_sdwa v84, 5, v81 dst_sel:DWORD dst_unused:UNUSED_PAD src0_sel:DWORD src1_sel:WORD_0
    v_lshlrev_b32_sdwa v85, 5, v81 dst_sel:DWORD dst_unused:UNUSED_PAD src0_sel:DWORD src1_sel:WORD_1
    buffer_load_dwordx4 v[94:97], v82, s[72:75], 0 offen
    buffer_load_dwordx2 v[110:111], v82, s[72:75], 0 offen offset:16

    buffer_load_dwordx4 v[98:101], v83, s[72:75], 0 offen
    buffer_load_dwordx2 v[112:113], v83, s[72:75], 0 offen offset:16

    buffer_load_dwordx4 v[102:105], v84, s[72:75], 0 offen
    buffer_load_dwordx2 v[114:115], v84, s[72:75], 0 offen offset:16

    buffer_load_dwordx4 v[106:109], v85, s[72:75], 0 offen
    buffer_load_dwordx2 v[116:117], v85, s[72:75], 0 offen offset:16

    s_waitcnt vmcnt(0) lgkmcnt(0)
    s_barrier
    s_branch L_meet_84
L_fend_92:

L_p2done_47:
    s_endpgm

L_ufix_49:
    v_and_b32 v117, 63, v0
    v_lshlrev_b32 v117, 2, v117
    s_sub_i32 s54, s42, 1024
    v_cmp_le_i32 vcc, s54, v117
    s_mov_b64 exec, vcc
    v_mov_b32 v12, 0
    v_mov_b32 v44, 0
    s_mov_b64 exec, -1
    s_sub_i32 s54, s42, 1025
    v_cmp_le_i32 vcc, s54, v117
    s_mov_b64 exec, vcc
    v_mov_b32 v13, 0
    v_mov_b32 v46, 0
    s_mov_b64 exec, -1
    s_sub_i32 s54, s42, 1026
    v_cmp_le_i32 vcc, s54, v117
    s_mov_b64 exec, vcc
    v_mov_b32 v14, 0
    v_mov_b32 v48, 0
    s_mov_b64 exec, -1
    s_sub_i32 s54, s42, 1027
    v_cmp_le_i32 vcc, s54, v117
    s_mov_b64 exec, vcc
    v_mov_b32 v15, 0
    v_mov_b32 v50, 0
    s_mov_b64 exec, -1
    s_branch L_uback_50
L_ufix_51:
    v_and_b32 v117, 63, v0
    v_lshlrev_b32 v117, 2, v117
    s_sub_i32 s54, s42, 1536
    v_cmp_le_i32 vcc, s54, v117
    s_mov_b64 exec, vcc
    v_mov_b32 v16, 0
    v_mov_b32 v52, 0
    s_mov_b64 exec, -1
    s_sub_i32 s54, s42, 1537
    v_cmp_le_i32 vcc, s54, v117
    s_mov_b64 exec, vcc
    v_mov_b32 v17, 0
    v_mov_b32 v54, 0
    s_mov_b64 exec, -1
    s_sub_i32 s54, s42, 1538
    v_cmp_le_i32 vcc, s54, v117
    s_mov_b64 exec, vcc
    v_mov_b32 v18, 0
    v_mov_b32 v56, 0
    s_mov_b64 exec, -1
    s_sub_i32 s54, s42, 1539
    v_cmp_le_i32 vcc, s54, v117
    s_mov_b64 exec, vcc
    v_mov_b32 v19, 0
    v_mov_b32 v58, 0
    s_mov_b64 exec, -1
    s_branch L_uback_52
L_ufix_53:
    v_and_b32 v117, 63, v0
    v_lshlrev_b32 v117, 2, v117
    s_sub_i32 s54, s42, 2048
    v_cmp_le_i32 vcc, s54, v117
    s_mov_b64 exec, vcc
    v_mov_b32 v20, 0
    v_mov_b32 v60, 0
    s_mov_b64 exec, -1
    s_sub_i32 s54, s42, 2049
    v_cmp_le_i32 vcc, s54, v117
    s_mov_b64 exec, vcc
    v_mov_b32 v21, 0
    v_mov_b32 v62, 0
    s_mov_b64 exec, -1
    s_sub_i32 s54, s42, 2050
    v_cmp_le_i32 vcc, s54, v117
    s_mov_b64 exec, vcc
    v_mov_b32 v22, 0
    v_mov_b32 v64, 0
    s_mov_b64 exec, -1
    s_sub_i32 s54, s42, 2051
    v_cmp_le_i32 vcc, s54, v117
    s_mov_b64 exec, vcc
    v_mov_b32 v23, 0
    v_mov_b32 v66, 0
    s_mov_b64 exec, -1
    s_branch L_uback_54
L_ufix_55:
    v_and_b32 v117, 63, v0
    v_lshlrev_b32 v117, 2, v117
    s_sub_i32 s54, s42, 2560
    v_cmp_le_i32 vcc, s54, v117
    s_mov_b64 exec, vcc
    v_mov_b32 v24, 0
    v_mov_b32 v68, 0
    s_mov_b64 exec, -1
    s_sub_i32 s54, s42, 2561
    v_cmp_le_i32 vcc, s54, v117
    s_mov_b64 exec, vcc
    v_mov_b32 v25, 0
    v_mov_b32 v70, 0
    s_mov_b64 exec, -1
    s_sub_i32 s54, s42, 2562
    v_cmp_le_i32 vcc, s54, v117
    s_mov_b64 exec, vcc
    v_mov_b32 v26, 0
    v_mov_b32 v72, 0
    s_mov_b64 exec, -1
    s_sub_i32 s54, s42, 2563
    v_cmp_le_i32 vcc, s54, v117
    s_mov_b64 exec, vcc
    v_mov_b32 v27, 0
    v_mov_b32 v74, 0
    s_mov_b64 exec, -1
    s_branch L_uback_56
L_ufix_57:
    v_and_b32 v117, 63, v0
    v_lshlrev_b32 v117, 2, v117
    s_sub_i32 s54, s42, 0
    v_cmp_le_i32 vcc, s54, v117
    s_mov_b64 exec, vcc
    v_mov_b32 v4, 0
    v_mov_b32 v28, 0
    s_mov_b64 exec, -1
    s_sub_i32 s54, s42, 1
    v_cmp_le_i32 vcc, s54, v117
    s_mov_b64 exec, vcc
    v_mov_b32 v5, 0
    v_mov_b32 v30, 0
    s_mov_b64 exec, -1
    s_sub_i32 s54, s42, 2
    v_cmp_le_i32 vcc, s54, v117
    s_mov_b64 exec, vcc
    v_mov_b32 v6, 0
    v_mov_b32 v32, 0
    s_mov_b64 exec, -1
    s_sub_i32 s54, s42, 3
    v_cmp_le_i32 vcc, s54, v117
    s_mov_b64 exec, vcc
    v_mov_b32 v7, 0
    v_mov_b32 v34, 0
    s_mov_b64 exec, -1
    s_branch L_uback_58
L_ufix_59:
    v_and_b32 v117, 63, v0
    v_lshlrev_b32 v117, 2, v117
    s_sub_i32 s54, s42, 512
    v_cmp_le_i32 vcc, s54, v117
    s_mov_b64 exec, vcc
    v_mov_b32 v8, 0
    v_mov_b32 v36, 0
    s_mov_b64 exec, -1
    s_sub_i32 s54, s42, 513
    v_cmp_le_i32 vcc, s54, v117
    s_mov_b64 exec, vcc
    v_mov_b32 v9, 0
    v_mov_b32 v38, 0
    s_mov_b64 exec, -1
    s_sub_i32 s54, s42, 514
    v_cmp_le_i32 vcc, s54, v117
    s_mov_b64 exec, vcc
    v_mov_b32 v10, 0
    v_mov_b32 v40, 0
    s_mov_b64 exec, -1
    s_sub_i32 s54, s42, 515
    v_cmp_le_i32 vcc, s54, v117
    s_mov_b64 exec, vcc
    v_mov_b32 v11, 0
    v_mov_b32 v42, 0
    s_mov_b64 exec, -1
    s_branch L_uback_60
L_ufix_66:
    v_and_b32 v117, 63, v0
    v_lshlrev_b32 v117, 2, v117
    s_sub_i32 s54, s42, 3072
    v_cmp_le_i32 vcc, s54, v117
    s_mov_b64 exec, vcc
    v_mov_b32 v106, 0
    v_mov_b32 v120, 0
    s_mov_b64 exec, -1
    s_sub_i32 s54, s42, 3073
    v_cmp_le_i32 vcc, s54, v117
    s_mov_b64 exec, vcc
    v_mov_b32 v107, 0
    v_mov_b32 v122, 0
    s_mov_b64 exec, -1
    s_sub_i32 s54, s42, 3074
    v_cmp_le_i32 vcc, s54, v117
    s_mov_b64 exec, vcc
    v_mov_b32 v108, 0
    v_mov_b32 v124, 0
    s_mov_b64 exec, -1
    s_sub_i32 s54, s42, 3075
    v_cmp_le_i32 vcc, s54, v117
    s_mov_b64 exec, vcc
    v_mov_b32 v109, 0
    v_mov_b32 v126, 0
    s_mov_b64 exec, -1
    s_branch L_uback_67
L_ufix_70:
    v_and_b32 v117, 63, v0
    v_lshlrev_b32 v117, 2, v117
    s_sub_i32 s54, s42, 1024
    v_cmp_le_i32 vcc, s54, v117
    s_mov_b64 exec, vcc
    v_mov_b32 v12, 0
    v_mov_b32 v44, 0
    s_mov_b64 exec, -1
    s_sub_i32 s54, s42, 1025
    v_cmp_le_i32 vcc, s54, v117
    s_mov_b64 exec, vcc
    v_mov_b32 v13, 0
    v_mov_b32 v46, 0
    s_mov_b64 exec, -1
    s_sub_i32 s54, s42, 1026
    v_cmp_le_i32 vcc, s54, v117
    s_mov_b64 exec, vcc
    v_mov_b32 v14, 0
    v_mov_b32 v48, 0
    s_mov_b64 exec, -1
    s_sub_i32 s54, s42, 1027
    v_cmp_le_i32 vcc, s54, v117
    s_mov_b64 exec, vcc
    v_mov_b32 v15, 0
    v_mov_b32 v50, 0
    s_mov_b64 exec, -1
    s_branch L_uback_71
L_ufix_72:
    v_and_b32 v117, 63, v0
    v_lshlrev_b32 v117, 2, v117
    s_sub_i32 s54, s42, 1536
    v_cmp_le_i32 vcc, s54, v117
    s_mov_b64 exec, vcc
    v_mov_b32 v16, 0
    v_mov_b32 v52, 0
    s_mov_b64 exec, -1
    s_sub_i32 s54, s42, 1537
    v_cmp_le_i32 vcc, s54, v117
    s_mov_b64 exec, vcc
    v_mov_b32 v17, 0
    v_mov_b32 v54, 0
    s_mov_b64 exec, -1
    s_sub_i32 s54, s42, 1538
    v_cmp_le_i32 vcc, s54, v117
    s_mov_b64 exec, vcc
    v_mov_b32 v18, 0
    v_mov_b32 v56, 0
    s_mov_b64 exec, -1
    s_sub_i32 s54, s42, 1539
    v_cmp_le_i32 vcc, s54, v117
    s_mov_b64 exec, vcc
    v_mov_b32 v19, 0
    v_mov_b32 v58, 0
    s_mov_b64 exec, -1
    s_branch L_uback_73
L_ufix_74:
    v_and_b32 v117, 63, v0
    v_lshlrev_b32 v117, 2, v117
    s_sub_i32 s54, s42, 2048
    v_cmp_le_i32 vcc, s54, v117
    s_mov_b64 exec, vcc
    v_mov_b32 v20, 0
    v_mov_b32 v60, 0
    s_mov_b64 exec, -1
    s_sub_i32 s54, s42, 2049
    v_cmp_le_i32 vcc, s54, v117
    s_mov_b64 exec, vcc
    v_mov_b32 v21, 0
    v_mov_b32 v62, 0
    s_mov_b64 exec, -1
    s_sub_i32 s54, s42, 2050
    v_cmp_le_i32 vcc, s54, v117
    s_mov_b64 exec, vcc
    v_mov_b32 v22, 0
    v_mov_b32 v64, 0
    s_mov_b64 exec, -1
    s_sub_i32 s54, s42, 2051
    v_cmp_le_i32 vcc, s54, v117
    s_mov_b64 exec, vcc
    v_mov_b32 v23, 0
    v_mov_b32 v66, 0
    s_mov_b64 exec, -1
    s_branch L_uback_75
L_ufix_76:
    v_and_b32 v117, 63, v0
    v_lshlrev_b32 v117, 2, v117
    s_sub_i32 s54, s42, 2560
    v_cmp_le_i32 vcc, s54, v117
    s_mov_b64 exec, vcc
    v_mov_b32 v24, 0
    v_mov_b32 v68, 0
    s_mov_b64 exec, -1
    s_sub_i32 s54, s42, 2561
    v_cmp_le_i32 vcc, s54, v117
    s_mov_b64 exec, vcc
    v_mov_b32 v25, 0
    v_mov_b32 v70, 0
    s_mov_b64 exec, -1
    s_sub_i32 s54, s42, 2562
    v_cmp_le_i32 vcc, s54, v117
    s_mov_b64 exec, vcc
    v_mov_b32 v26, 0
    v_mov_b32 v72, 0
    s_mov_b64 exec, -1
    s_sub_i32 s54, s42, 2563
    v_cmp_le_i32 vcc, s54, v117
    s_mov_b64 exec, vcc
    v_mov_b32 v27, 0
    v_mov_b32 v74, 0
    s_mov_b64 exec, -1
    s_branch L_uback_77
L_ufix_78:
    v_and_b32 v117, 63, v0
    v_lshlrev_b32 v117, 2, v117
    s_sub_i32 s54, s42, 0
    v_cmp_le_i32 vcc, s54, v117
    s_mov_b64 exec, vcc
    v_mov_b32 v4, 0
    v_mov_b32 v28, 0
    s_mov_b64 exec, -1
    s_sub_i32 s54, s42, 1
    v_cmp_le_i32 vcc, s54, v117
    s_mov_b64 exec, vcc
    v_mov_b32 v5, 0
    v_mov_b32 v30, 0
    s_mov_b64 exec, -1
    s_sub_i32 s54, s42, 2
    v_cmp_le_i32 vcc, s54, v117
    s_mov_b64 exec, vcc
    v_mov_b32 v6, 0
    v_mov_b32 v32, 0
    s_mov_b64 exec, -1
    s_sub_i32 s54, s42, 3
    v_cmp_le_i32 vcc, s54, v117
    s_mov_b64 exec, vcc
    v_mov_b32 v7, 0
    v_mov_b32 v34, 0
    s_mov_b64 exec, -1
    s_branch L_uback_79
L_ufix_80:
    v_and_b32 v117, 63, v0
    v_lshlrev_b32 v117, 2, v117
    s_sub_i32 s54, s42, 512
    v_cmp_le_i32 vcc, s54, v117
    s_mov_b64 exec, vcc
    v_mov_b32 v8, 0
    v_mov_b32 v36, 0
    s_mov_b64 exec, -1
    s_sub_i32 s54, s42, 513
    v_cmp_le_i32 vcc, s54, v117
    s_mov_b64 exec, vcc
    v_mov_b32 v9, 0
    v_mov_b32 v38, 0
    s_mov_b64 exec, -1
    s_sub_i32 s54, s42, 514
    v_cmp_le_i32 vcc, s54, v117
    s_mov_b64 exec, vcc
    v_mov_b32 v10, 0
    v_mov_b32 v40, 0
    s_mov_b64 exec, -1
    s_sub_i32 s54, s42, 515
    v_cmp_le_i32 vcc, s54, v117
    s_mov_b64 exec, vcc
    v_mov_b32 v11, 0
    v_mov_b32 v42, 0
    s_mov_b64 exec, -1
    s_branch L_uback_81
L_sync_91:
    v_and_b32 v40, 63, v0
    v_lshlrev_b32 v41, 20, v40
    v_mov_b32 v42, s33
    buffer_atomic_add v42, v41, s[80:83], s48 offen sc0
    s_waitcnt vmcnt(0)
    v_readfirstlane_b32 s4, v42
    s_movk_i32 s5, 400
    s_nop 0
    s_add_u32 s4, s4, s33
    s_bitcmp1_b32 s4, 2
    s_cbranch_scc1 L_tell_95
L_poll_93:
    s_sub_u32 s5, s5, 1
    s_cbranch_scc1 L_gave_94
    v_mov_b32 v42, 0
    buffer_atomic_add v42, v41, s[80:83], s48 offen sc0
    s_waitcnt vmcnt(0)
    v_readfirstlane_b32 s4, v42
    s_nop 1
    s_and_b32 s4, s4, 0xff
    s_bitcmp0_b32 s4, 2
    s_cbranch_scc1 L_poll_93
    s_branch L_tell_95
L_gave_94:
    s_cmp_lg_u32 s49, s37
    s_cbranch_scc1 L_gno_97
    v_add_lshl_u32 v40, v40, s28, 4
    s_mov_b32 s5, 0
L_gl_96:
    v_min_u32 v43, 100000, v40
    ds_read_b128 v[44:47], v43 offset:50000
    s_waitcnt lgkmcnt(0)
    buffer_store_dwordx4 v[44:47], v40, s[20:23], 0 offen sc1
    s_waitcnt vmcnt(0)
    v_add_u32 v40, 1024, v40
    s_add_u32 s5, s5, 64
    s_cmp_lt_u32 s5, s29
    s_cbranch_scc1 L_gl_96
L_gno_97:
    s_lshl_b32 s4, 0x100, s37
    v_mov_b32 v42, s4
    buffer_atomic_or v42, v41, s[80:83], s48 offen sc0
    s_waitcnt vmcnt(0)
    v_readfirstlane_b32 s4, v42
    s_nop 1
    s_and_b32 s4, s4, 0xff
    s_bitcmp1_b32 s4, 2
    s_cselect_b32 s4, s4, 0x10000
L_tell_95:
    v_mov_b32 v42, s4
    ds_write_b32 v118, v42
    s_waitcnt lgkmcnt(0)
    s_branch L_bcast_86

L_own_98:
    ds_read_b128 v[36:39], v78 offset:50000
    ds_read_b128 v[52:55], v79 offset:50000
    s_branch L_obk_99

L_own_100:
    ds_read_b128 v[40:43], v78 offset:50000
    ds_read_b128 v[56:59], v79 offset:50000
    s_branch L_obk_101

L_own_102:
    ds_read_b128 v[44:47], v78 offset:50000
    ds_read_b128 v[60:63], v79 offset:50000
    s_branch L_obk_103

L_own_104:
    ds_read_b128 v[48:51], v78 offset:50000
    ds_read_b128 v[64:67], v79 offset:50000
    s_branch L_obk_105

L_fgen_106:
    v_lshlrev_b32 v82, 1, v76
    v_lshlrev_b32 v83, 1, v77
    v_mov_b32 v4, 0
    v_mov_b32 v5, 0
    v_mov_b32 v6, 0
    v_mov_b32 v7, 0
    v_mov_b32 v8, 0
    v_mov_b32 v9, 0
    v_mov_b32 v10, 0
    v_mov_b32 v11, 0
    v_mov_b32 v12, 0
    v_mov_b32 v13, 0
    v_mov_b32 v14, 0
    v_mov_b32 v15, 0
    v_mov_b32 v16, 0
    v_mov_b32 v17, 0
    v_mov_b32 v18, 0
    v_mov_b32 v19, 0
    s_bitcmp1_b32 s35, 4
    s_cbranch_scc1 L_ffl_108
    v_cvt_f32_u32_sdwa v20, v36 dst_sel:DWORD dst_unused:UNUSED_PAD src0_sel:WORD_0
    v_cvt_f32_u32_sdwa v21, v36 dst_sel:DWORD dst_unused:UNUSED_PAD src0_sel:WORD_1
    v_cvt_f32_u32_sdwa v22, v37 dst_sel:DWORD dst_unused:UNUSED_PAD src0_sel:WORD_0
    v_cvt_f32_u32_sdwa v23, v37 dst_sel:DWORD dst_unused:UNUSED_PAD src0_sel:WORD_1
    v_cvt_f32_u32_sdwa v24, v38 dst_sel:DWORD dst_unused:UNUSED_PAD src0_sel:WORD_0
    v_cvt_f32_u32_sdwa v25, v38 dst_sel:DWORD dst_unused:UNUSED_PAD src0_sel:WORD_1
    v_cvt_f32_u32_sdwa v26, v39 dst_sel:DWORD dst_unused:UNUSED_PAD src0_sel:WORD_0
    v_cvt_f32_u32_sdwa v27, v39 dst_sel:DWORD dst_unused:UNUSED_PAD src0_sel:WORD_1
    v_cvt_f32_u32_sdwa v28, v52 dst_sel:DWORD dst_unused:UNUSED_PAD src0_sel:WORD_0
    v_cvt_f32_u32_sdwa v29, v52 dst_sel:DWORD dst_unused:UNUSED_PAD src0_sel:WORD_1
    v_cvt_f32_u32_sdwa v30, v53 dst_sel:DWORD dst_unused:UNUSED_PAD src0_sel:WORD_0
    v_cvt_f32_u32_sdwa v31, v53 dst_sel:DWORD dst_unused:UNUSED_PAD src0_sel:WORD_1
    v_cvt_f32_u32_sdwa v32, v54 dst_sel:DWORD dst_unused:UNUSED_PAD src0_sel:WORD_0
    v_cvt_f32_u32_sdwa v33, v54 dst_sel:DWORD dst_unused:UNUSED_PAD src0_sel:WORD_1
    v_cvt_f32_u32_sdwa v34, v55 dst_sel:DWORD dst_unused:UNUSED_PAD src0_sel:WORD_0
    v_cvt_f32_u32_sdwa v35, v55 dst_sel:DWORD dst_unused:UNUSED_PAD src0_sel:WORD_1
    v_add_f32 v20, 0xc6800000, v20
    v_fmac_f32 v4, s34, v20
    v_add_f32 v21, 0xc6800000, v21
    v_fmac_f32 v5, s34, v21
    v_add_f32 v22, 0xc6800000, v22
    v_fmac_f32 v6, s34, v22
    v_add_f32 v23, 0xc6800000, v23
    v_fmac_f32 v7, s34, v23
    v_add_f32 v24, 0xc6800000, v24
    v_fmac_f32 v8, s34, v24
    v_add_f32 v25, 0xc6800000, v25
    v_fmac_f32 v9, s34, v25
    v_add_f32 v26, 0xc6800000, v26
    v_fmac_f32 v10, s34, v26
    v_add_f32 v27, 0xc6800000, v27
    v_fmac_f32 v11, s34, v27
    v_add_f32 v28, 0xc6800000, v28
    v_fmac_f32 v12, s34, v28
    v_add_f32 v29, 0xc6800000, v29
    v_fmac_f32 v13, s34, v29
    v_add_f32 v30, 0xc6800000, v30
    v_fmac_f32 v14, s34, v30
    v_add_f32 v31, 0xc6800000, v31
    v_fmac_f32 v15, s34, v31
    v_add_f32 v32, 0xc6800000, v32
    v_fmac_f32 v16, s34, v32
    v_add_f32 v33, 0xc6800000, v33
    v_fmac_f32 v17, s34, v33
    v_add_f32 v34, 0xc6800000, v34
    v_fmac_f32 v18, s34, v34
    v_add_f32 v35, 0xc6800000, v35
    v_fmac_f32 v19, s34, v35
    s_branch L_fnx_109
L_ffl_108:
    s_mov_b32 s3, 25600000
    buffer_load_dwordx4 v[20:23], v82, s[84:87], s3 offen offset:0 sc1
    buffer_load_dwordx4 v[24:27], v82, s[84:87], s3 offen offset:16 sc1
    buffer_load_dwordx4 v[28:31], v83, s[84:87], s3 offen offset:0 sc1
    buffer_load_dwordx4 v[32:35], v83, s[84:87], s3 offen offset:16 sc1
    s_waitcnt vmcnt(0)
    v_add_f32 v4, v4, v20
    v_add_f32 v5, v5, v21
    v_add_f32 v6, v6, v22
    v_add_f32 v7, v7, v23
    v_add_f32 v8, v8, v24
    v_add_f32 v9, v9, v25
    v_add_f32 v10, v10, v26
    v_add_f32 v11, v11, v27
    v_add_f32 v12, v12, v28
    v_add_f32 v13, v13, v29
    v_add_f32 v14, v14, v30
    v_add_f32 v15, v15, v31
    v_add_f32 v16, v16, v32
    v_add_f32 v17, v17, v33
    v_add_f32 v18, v18, v34
    v_add_f32 v19, v19, v35
L_fnx_109:
    s_bitcmp1_b32 s35, 5
    s_cbranch_scc1 L_ffl_110
    v_cvt_f32_u32_sdwa v20, v40 dst_sel:DWORD dst_unused:UNUSED_PAD src0_sel:WORD_0
    v_cvt_f32_u32_sdwa v21, v40 dst_sel:DWORD dst_unused:UNUSED_PAD src0_sel:WORD_1
    v_cvt_f32_u32_sdwa v22, v41 dst_sel:DWORD dst_unused:UNUSED_PAD src0_sel:WORD_0
    v_cvt_f32_u32_sdwa v23, v41 dst_sel:DWORD dst_unused:UNUSED_PAD src0_sel:WORD_1
    v_cvt_f32_u32_sdwa v24, v42 dst_sel:DWORD dst_unused:UNUSED_PAD src0_sel:WORD_0
    v_cvt_f32_u32_sdwa v25, v42 dst_sel:DWORD dst_unused:UNUSED_PAD src0_sel:WORD_1
    v_cvt_f32_u32_sdwa v26, v43 dst_sel:DWORD dst_unused:UNUSED_PAD src0_sel:WORD_0
    v_cvt_f32_u32_sdwa v27, v43 dst_sel:DWORD dst_unused:UNUSED_PAD src0_sel:WORD_1
    v_cvt_f32_u32_sdwa v28, v56 dst_sel:DWORD dst_unused:UNUSED_PAD src0_sel:WORD_0
    v_cvt_f32_u32_sdwa v29, v56 dst_sel:DWORD dst_unused:UNUSED_PAD src0_sel:WORD_1
    v_cvt_f32_u32_sdwa v30, v57 dst_sel:DWORD dst_unused:UNUSED_PAD src0_sel:WORD_0
    v_cvt_f32_u32_sdwa v31, v57 dst_sel:DWORD dst_unused:UNUSED_PAD src0_sel:WORD_1
    v_cvt_f32_u32_sdwa v32, v58 dst_sel:DWORD dst_unused:UNUSED_PAD src0_sel:WORD_0
    v_cvt_f32_u32_sdwa v33, v58 dst_sel:DWORD dst_unused:UNUSED_PAD src0_sel:WORD_1
    v_cvt_f32_u32_sdwa v34, v59 dst_sel:DWORD dst_unused:UNUSED_PAD src0_sel:WORD_0
    v_cvt_f32_u32_sdwa v35, v59 dst_sel:DWORD dst_unused:UNUSED_PAD src0_sel:WORD_1
    v_add_f32 v20, 0xc6800000, v20
    v_fmac_f32 v4, s34, v20
    v_add_f32 v21, 0xc6800000, v21
    v_fmac_f32 v5, s34, v21
    v_add_f32 v22, 0xc6800000, v22
    v_fmac_f32 v6, s34, v22
    v_add_f32 v23, 0xc6800000, v23
    v_fmac_f32 v7, s34, v23
    v_add_f32 v24, 0xc6800000, v24
    v_fmac_f32 v8, s34, v24
    v_add_f32 v25, 0xc6800000, v25
    v_fmac_f32 v9, s34, v25
    v_add_f32 v26, 0xc6800000, v26
    v_fmac_f32 v10, s34, v26
    v_add_f32 v27, 0xc6800000, v27
    v_fmac_f32 v11, s34, v27
    v_add_f32 v28, 0xc6800000, v28
    v_fmac_f32 v12, s34, v28
    v_add_f32 v29, 0xc6800000, v29
    v_fmac_f32 v13, s34, v29
    v_add_f32 v30, 0xc6800000, v30
    v_fmac_f32 v14, s34, v30
    v_add_f32 v31, 0xc6800000, v31
    v_fmac_f32 v15, s34, v31
    v_add_f32 v32, 0xc6800000, v32
    v_fmac_f32 v16, s34, v32
    v_add_f32 v33, 0xc6800000, v33
    v_fmac_f32 v17, s34, v33
    v_add_f32 v34, 0xc6800000, v34
    v_fmac_f32 v18, s34, v34
    v_add_f32 v35, 0xc6800000, v35
    v_fmac_f32 v19, s34, v35
    s_branch L_fnx_111
L_ffl_110:
    s_mov_b32 s3, 38400000
    buffer_load_dwordx4 v[20:23], v82, s[84:87], s3 offen offset:0 sc1
    buffer_load_dwordx4 v[24:27], v82, s[84:87], s3 offen offset:16 sc1
    buffer_load_dwordx4 v[28:31], v83, s[84:87], s3 offen offset:0 sc1
    buffer_load_dwordx4 v[32:35], v83, s[84:87], s3 offen offset:16 sc1
    s_waitcnt vmcnt(0)
    v_add_f32 v4, v4, v20
    v_add_f32 v5, v5, v21
    v_add_f32 v6, v6, v22
    v_add_f32 v7, v7, v23
    v_add_f32 v8, v8, v24
    v_add_f32 v9, v9, v25
    v_add_f32 v10, v10, v26
    v_add_f32 v11, v11, v27
    v_add_f32 v12, v12, v28
    v_add_f32 v13, v13, v29
    v_add_f32 v14, v14, v30
    v_add_f32 v15, v15, v31
    v_add_f32 v16, v16, v32
    v_add_f32 v17, v17, v33
    v_add_f32 v18, v18, v34
    v_add_f32 v19, v19, v35
L_fnx_111:
    s_bitcmp1_b32 s35, 6
    s_cbranch_scc1 L_ffl_112
    v_cvt_f32_u32_sdwa v20, v44 dst_sel:DWORD dst_unused:UNUSED_PAD src0_sel:WORD_0
    v_cvt_f32_u32_sdwa v21, v44 dst_sel:DWORD dst_unused:UNUSED_PAD src0_sel:WORD_1
    v_cvt_f32_u32_sdwa v22, v45 dst_sel:DWORD dst_unused:UNUSED_PAD src0_sel:WORD_0
    v_cvt_f32_u32_sdwa v23, v45 dst_sel:DWORD dst_unused:UNUSED_PAD src0_sel:WORD_1
    v_cvt_f32_u32_sdwa v24, v46 dst_sel:DWORD dst_unused:UNUSED_PAD src0_sel:WORD_0
    v_cvt_f32_u32_sdwa v25, v46 dst_sel:DWORD dst_unused:UNUSED_PAD src0_sel:WORD_1
    v_cvt_f32_u32_sdwa v26, v47 dst_sel:DWORD dst_unused:UNUSED_PAD src0_sel:WORD_0
    v_cvt_f32_u32_sdwa v27, v47 dst_sel:DWORD dst_unused:UNUSED_PAD src0_sel:WORD_1
    v_cvt_f32_u32_sdwa v28, v60 dst_sel:DWORD dst_unused:UNUSED_PAD src0_sel:WORD_0
    v_cvt_f32_u32_sdwa v29, v60 dst_sel:DWORD dst_unused:UNUSED_PAD src0_sel:WORD_1
    v_cvt_f32_u32_sdwa v30, v61 dst_sel:DWORD dst_unused:UNUSED_PAD src0_sel:WORD_0
    v_cvt_f32_u32_sdwa v31, v61 dst_sel:DWORD dst_unused:UNUSED_PAD src0_sel:WORD_1
    v_cvt_f32_u32_sdwa v32, v62 dst_sel:DWORD dst_unused:UNUSED_PAD src0_sel:WORD_0
    v_cvt_f32_u32_sdwa v33, v62 dst_sel:DWORD dst_unused:UNUSED_PAD src0_sel:WORD_1
    v_cvt_f32_u32_sdwa v34, v63 dst_sel:DWORD dst_unused:UNUSED_PAD src0_sel:WORD_0
    v_cvt_f32_u32_sdwa v35, v63 dst_sel:DWORD dst_unused:UNUSED_PAD src0_sel:WORD_1
    v_add_f32 v20, 0xc6800000, v20
    v_fmac_f32 v4, s34, v20
    v_add_f32 v21, 0xc6800000, v21
    v_fmac_f32 v5, s34, v21
    v_add_f32 v22, 0xc6800000, v22
    v_fmac_f32 v6, s34, v22
    v_add_f32 v23, 0xc6800000, v23
    v_fmac_f32 v7, s34, v23
    v_add_f32 v24, 0xc6800000, v24
    v_fmac_f32 v8, s34, v24
    v_add_f32 v25, 0xc6800000, v25
    v_fmac_f32 v9, s34, v25
    v_add_f32 v26, 0xc6800000, v26
    v_fmac_f32 v10, s34, v26
    v_add_f32 v27, 0xc6800000, v27
    v_fmac_f32 v11, s34, v27
    v_add_f32 v28, 0xc6800000, v28
    v_fmac_f32 v12, s34, v28
    v_add_f32 v29, 0xc6800000, v29
    v_fmac_f32 v13, s34, v29
    v_add_f32 v30, 0xc6800000, v30
    v_fmac_f32 v14, s34, v30
    v_add_f32 v31, 0xc6800000, v31
    v_fmac_f32 v15, s34, v31
    v_add_f32 v32, 0xc6800000, v32
    v_fmac_f32 v16, s34, v32
    v_add_f32 v33, 0xc6800000, v33
    v_fmac_f32 v17, s34, v33
    v_add_f32 v34, 0xc6800000, v34
    v_fmac_f32 v18, s34, v34
    v_add_f32 v35, 0xc6800000, v35
    v_fmac_f32 v19, s34, v35
    s_branch L_fnx_113
L_ffl_112:
    s_mov_b32 s3, 51200000
    buffer_load_dwordx4 v[20:23], v82, s[84:87], s3 offen offset:0 sc1
    buffer_load_dwordx4 v[24:27], v82, s[84:87], s3 offen offset:16 sc1
    buffer_load_dwordx4 v[28:31], v83, s[84:87], s3 offen offset:0 sc1
    buffer_load_dwordx4 v[32:35], v83, s[84:87], s3 offen offset:16 sc1
    s_waitcnt vmcnt(0)
    v_add_f32 v4, v4, v20
    v_add_f32 v5, v5, v21
    v_add_f32 v6, v6, v22
    v_add_f32 v7, v7, v23
    v_add_f32 v8, v8, v24
    v_add_f32 v9, v9, v25
    v_add_f32 v10, v10, v26
    v_add_f32 v11, v11, v27
    v_add_f32 v12, v12, v28
    v_add_f32 v13, v13, v29
    v_add_f32 v14, v14, v30
    v_add_f32 v15, v15, v31
    v_add_f32 v16, v16, v32
    v_add_f32 v17, v17, v33
    v_add_f32 v18, v18, v34
    v_add_f32 v19, v19, v35
L_fnx_113:
    s_bitcmp1_b32 s35, 7
    s_cbranch_scc1 L_ffl_114
    v_cvt_f32_u32_sdwa v20, v48 dst_sel:DWORD dst_unused:UNUSED_PAD src0_sel:WORD_0
    v_cvt_f32_u32_sdwa v21, v48 dst_sel:DWORD dst_unused:UNUSED_PAD src0_sel:WORD_1
    v_cvt_f32_u32_sdwa v22, v49 dst_sel:DWORD dst_unused:UNUSED_PAD src0_sel:WORD_0
    v_cvt_f32_u32_sdwa v23, v49 dst_sel:DWORD dst_unused:UNUSED_PAD src0_sel:WORD_1
    v_cvt_f32_u32_sdwa v24, v50 dst_sel:DWORD dst_unused:UNUSED_PAD src0_sel:WORD_0
    v_cvt_f32_u32_sdwa v25, v50 dst_sel:DWORD dst_unused:UNUSED_PAD src0_sel:WORD_1
    v_cvt_f32_u32_sdwa v26, v51 dst_sel:DWORD dst_unused:UNUSED_PAD src0_sel:WORD_0
    v_cvt_f32_u32_sdwa v27, v51 dst_sel:DWORD dst_unused:UNUSED_PAD src0_sel:WORD_1
    v_cvt_f32_u32_sdwa v28, v64 dst_sel:DWORD dst_unused:UNUSED_PAD src0_sel:WORD_0
    v_cvt_f32_u32_sdwa v29, v64 dst_sel:DWORD dst_unused:UNUSED_PAD src0_sel:WORD_1
    v_cvt_f32_u32_sdwa v30, v65 dst_sel:DWORD dst_unused:UNUSED_PAD src0_sel:WORD_0
    v_cvt_f32_u32_sdwa v31, v65 dst_sel:DWORD dst_unused:UNUSED_PAD src0_sel:WORD_1
    v_cvt_f32_u32_sdwa v32, v66 dst_sel:DWORD dst_unused:UNUSED_PAD src0_sel:WORD_0
    v_cvt_f32_u32_sdwa v33, v66 dst_sel:DWORD dst_unused:UNUSED_PAD src0_sel:WORD_1
    v_cvt_f32_u32_sdwa v34, v67 dst_sel:DWORD dst_unused:UNUSED_PAD src0_sel:WORD_0
    v_cvt_f32_u32_sdwa v35, v67 dst_sel:DWORD dst_unused:UNUSED_PAD src0_sel:WORD_1
    v_add_f32 v20, 0xc6800000, v20
    v_fmac_f32 v4, s34, v20
    v_add_f32 v21, 0xc6800000, v21
    v_fmac_f32 v5, s34, v21
    v_add_f32 v22, 0xc6800000, v22
    v_fmac_f32 v6, s34, v22
    v_add_f32 v23, 0xc6800000, v23
    v_fmac_f32 v7, s34, v23
    v_add_f32 v24, 0xc6800000, v24
    v_fmac_f32 v8, s34, v24
    v_add_f32 v25, 0xc6800000, v25
    v_fmac_f32 v9, s34, v25
    v_add_f32 v26, 0xc6800000, v26
    v_fmac_f32 v10, s34, v26
    v_add_f32 v27, 0xc6800000, v27
    v_fmac_f32 v11, s34, v27
    v_add_f32 v28, 0xc6800000, v28
    v_fmac_f32 v12, s34, v28
    v_add_f32 v29, 0xc6800000, v29
    v_fmac_f32 v13, s34, v29
    v_add_f32 v30, 0xc6800000, v30
    v_fmac_f32 v14, s34, v30
    v_add_f32 v31, 0xc6800000, v31
    v_fmac_f32 v15, s34, v31
    v_add_f32 v32, 0xc6800000, v32
    v_fmac_f32 v16, s34, v32
    v_add_f32 v33, 0xc6800000, v33
    v_fmac_f32 v17, s34, v33
    v_add_f32 v34, 0xc6800000, v34
    v_fmac_f32 v18, s34, v34
    v_add_f32 v35, 0xc6800000, v35
    v_fmac_f32 v19, s34, v35
    s_branch L_fnx_115
L_ffl_114:
    s_mov_b32 s3, 64000000
    buffer_load_dwordx4 v[20:23], v82, s[84:87], s3 offen offset:0 sc1
    buffer_load_dwordx4 v[24:27], v82, s[84:87], s3 offen offset:16 sc1
    buffer_load_dwordx4 v[28:31], v83, s[84:87], s3 offen offset:0 sc1
    buffer_load_dwordx4 v[32:35], v83, s[84:87], s3 offen offset:16 sc1
    s_waitcnt vmcnt(0)
    v_add_f32 v4, v4, v20
    v_add_f32 v5, v5, v21
    v_add_f32 v6, v6, v22
    v_add_f32 v7, v7, v23
    v_add_f32 v8, v8, v24
    v_add_f32 v9, v9, v25
    v_add_f32 v10, v10, v26
    v_add_f32 v11, v11, v27
    v_add_f32 v12, v12, v28
    v_add_f32 v13, v13, v29
    v_add_f32 v14, v14, v30
    v_add_f32 v15, v15, v31
    v_add_f32 v16, v16, v32
    v_add_f32 v17, v17, v33
    v_add_f32 v18, v18, v34
    v_add_f32 v19, v19, v35
L_fnx_115:
    s_branch L_fbk_107
L_p2slow_48:
    s_waitcnt vmcnt(0) lgkmcnt(0)
    s_mov_b32 s51, 0
    s_movk_i32 s43, 6250
L_sweep_116:
    s_barrier

    v_mov_b32 v28, 0x0
    v_mov_b32 v29, 0x0
    v_mov_b32 v30, 0x0
    v_mov_b32 v31, 0x0
    v_add_u32 v32, 50000, v3
    v_add_u32 v33, 65536, v32

    ds_write_b128 v32, v[28:31] offset:0
    ds_write_b128 v32, v[28:31] offset:16384
    ds_write_b128 v32, v[28:31] offset:32768
    ds_write_b128 v32, v[28:31] offset:49152
    ds_write_b128 v33, v[28:31] offset:0
    ds_write_b128 v33, v[28:31] offset:16384
    v_cmp_gt_u32 vcc, 971, v0
    s_mov_b64 exec, vcc
    ds_write_b128 v33, v[28:31] offset:32768
    s_mov_b64 exec, -1
    s_mov_b32 s3, 32768
    s_load_dword s40, s[6:7], s3
    s_waitcnt lgkmcnt(0)
    s_barrier
    s_cmp_lg_u32 s40, 0
    s_cbranch_scc1 L_raw_121
    s_sub_u32 s38, s4, 8
L_sbatch_117:
    s_lshl_b32 s52, s36, 5
    s_add_u32 s52, s52, s38
    s_lshr_b32 s52, s52, 1
    s_lshl_b32 s52, s52, 2
    s_load_dword s40, s[46:47], s52
    s_mul_i32 s50, s38, 200000
    s_and_b32 s3, s38, 1
    s_lshl_b32 s3, s3, 4
    s_or_b32 s3, s3, 0x100000
    s_waitcnt lgkmcnt(0)
    s_bfe_u32 s40, s40, s3

    s_min_u32 s40, s40, 6524
    s_lshl_b32 s52, s38, 6
    s_add_u32 s52, s52, s36
    s_mul_i32 s52, s52, 32764
    s_and_b32 s52, s52, 0xffffff80
    s_add_u32 s20, s44, s52
    s_addc_u32 s21, s45, 0
    s_mul_i32 s52, s40, 5
    s_add_u32 s52, s52, 3
    s_and_b32 s22, s52, -4

    s_lshr_b32 s55, s39, 2
    s_add_u32 s55, s55, 0
    v_and_b32 v36, 63, v0
    v_add_u32 v36, s55, v36
L_left_122:
    s_cmp_ge_u32 s55, s40
    s_cbranch_scc1 L_leftend_123
    v_mul_u32_u24 v37, 5, v36
    buffer_load_dword v38, v37, s[20:23], 0 offen offset:1
    buffer_load_ubyte v39, v37, s[20:23], 0 offen
    s_waitcnt vmcnt(0)

    v_perm_b32 v37, v39, v38, s24
    v_lshrrev_b32 v42, 30, v38
    v_and_b32 v37, 0x1fff, v37
    v_mul_u32_u24 v42, 6250, v42
    v_add_lshl_u32 v37, v37, v42, 3

    buffer_load_dwordx2 v[40:41], v37, s[8:11], s50 offen
    v_cmp_gt_u32 vcc, s40, v36
    s_waitcnt vmcnt(0)

    v_bfe_u32 v44, v38, 16, 14
    v_subrev_u32 v44, s51, v44
    v_cmp_gt_u32 s[64:65], s43, v44
    s_and_b64 exec, vcc, s[64:65]
    v_lshlrev_b32 v45, 16, v38
    v_cmpx_ne_u32 vcc, 0, v45
    v_lshlrev_b32 v44, 4, v44
    v_bfe_i32 v38, v38, 0, 16
    v_cvt_f32_i32 v38, v38
    v_mul_f32 v38, 0x38004020, v38
    v_lshlrev_b32 v45, 16, v40
    v_and_b32 v46, s32, v40
    v_lshlrev_b32 v47, 16, v41
    v_and_b32 v48, s32, v41

    v_mul_f32 v45, v45, v38
    ds_add_f32 v44, v45 offset:50000
    v_mul_f32 v46, v46, v38
    ds_add_f32 v44, v46 offset:50004
    v_mul_f32 v47, v47, v38
    ds_add_f32 v44, v47 offset:50008
    v_mul_f32 v48, v48, v38
    ds_add_f32 v44, v48 offset:50012
    s_mov_b64 exec, -1
    v_add_u32 v36, 128, v36
    s_add_u32 s55, s55, 128
    s_branch L_left_122
L_leftend_123:

    s_add_u32 s38, s38, 1
    s_cmp_lt_u32 s38, s4
    s_cbranch_scc1 L_sbatch_117
    s_branch L_swend_119

L_raw_121:
    s_load_dwordx2 s[68:69], s[0:1], 8
    s_load_dwordx2 s[72:73], s[0:1], 16
    s_load_dwordx2 s[76:77], s[0:1], 32
    s_load_dwordx2 s[80:81], s[0:1], 48
    s_mov_b32 s70, 204800000
    s_mov_b32 s71, 0x20000
    s_mov_b32 s74, 204800000
    s_mov_b32 s75, 0x20000
    s_mov_b32 s78, 102400000
    s_mov_b32 s79, 0x20000
    s_waitcnt lgkmcnt(0)
    s_load_dword s82, s[80:81], 0
    s_mul_i32 s83, s36, 12500
    s_add_u32 s83, s83, s51
    s_mul_i32 s84, s37, 200000
    s_mov_b32 s85, 200000
    s_mov_b32 s38, 0
    v_lshlrev_b32 v44, 5, v0
    v_mov_b32 v45, 0.15915494
    s_waitcnt lgkmcnt(0)
    s_lshl_b32 s82, s82, 16
    v_mul_f32 v45, s82, v45
L_rawl_118:
    s_lshr_b32 s3, s38, 1
    buffer_load_dwordx4 v[46:49], v44, s[72:75], s38 offen
    buffer_load_dwordx4 v[50:53], v44, s[72:75], s38 offen offset:16
    buffer_load_dwordx4 v[54:57], v44, s[68:71], s38 offen
    buffer_load_dwordx4 v[58:61], v44, s[68:71], s38 offen offset:16
    buffer_load_dwordx4 v[62:65], v3, s[76:79], s3 offen
    s_waitcnt vmcnt(1)

    v_subrev_u32 v46, s83, v46
    v_subrev_u32 v82, s84, v54
    v_cmp_gt_u32 vcc, s43, v46
    v_cmp_gt_u32 s[64:65], s85, v82
    v_lshlrev_b32 v54, 3, v54
    s_nand_b64 exec, vcc, s[64:65]
    v_bfrev_b32 v54, 1
    s_mov_b64 exec, -1
    buffer_load_dwordx2 v[66:67], v54, s[8:11], 0 offen

    v_subrev_u32 v47, s83, v47
    v_subrev_u32 v82, s84, v55
    v_cmp_gt_u32 vcc, s43, v47
    v_cmp_gt_u32 s[64:65], s85, v82
    v_lshlrev_b32 v55, 3, v55
    s_nand_b64 exec, vcc, s[64:65]
    v_bfrev_b32 v55, 1
    s_mov_b64 exec, -1
    buffer_load_dwordx2 v[68:69], v55, s[8:11], 0 offen

    v_subrev_u32 v48, s83, v48
    v_subrev_u32 v82, s84, v56
    v_cmp_gt_u32 vcc, s43, v48
    v_cmp_gt_u32 s[64:65], s85, v82
    v_lshlrev_b32 v56, 3, v56
    s_nand_b64 exec, vcc, s[64:65]
    v_bfrev_b32 v56, 1
    s_mov_b64 exec, -1
    buffer_load_dwordx2 v[70:71], v56, s[8:11], 0 offen

    v_subrev_u32 v49, s83, v49
    v_subrev_u32 v82, s84, v57
    v_cmp_gt_u32 vcc, s43, v49
    v_cmp_gt_u32 s[64:65], s85, v82
    v_lshlrev_b32 v57, 3, v57
    s_nand_b64 exec, vcc, s[64:65]
    v_bfrev_b32 v57, 1
    s_mov_b64 exec, -1
    buffer_load_dwordx2 v[72:73], v57, s[8:11], 0 offen

    v_subrev_u32 v50, s83, v50
    v_subrev_u32 v82, s84, v58
    v_cmp_gt_u32 vcc, s43, v50
    v_cmp_gt_u32 s[64:65], s85, v82
    v_lshlrev_b32 v58, 3, v58
    s_nand_b64 exec, vcc, s[64:65]
    v_bfrev_b32 v58, 1
    s_mov_b64 exec, -1
    buffer_load_dwordx2 v[74:75], v58, s[8:11], 0 offen

    v_subrev_u32 v51, s83, v51
    v_subrev_u32 v82, s84, v59
    v_cmp_gt_u32 vcc, s43, v51
    v_cmp_gt_u32 s[64:65], s85, v82
    v_lshlrev_b32 v59, 3, v59
    s_nand_b64 exec, vcc, s[64:65]
    v_bfrev_b32 v59, 1
    s_mov_b64 exec, -1
    buffer_load_dwordx2 v[76:77], v59, s[8:11], 0 offen

    v_subrev_u32 v52, s83, v52
    v_subrev_u32 v82, s84, v60
    v_cmp_gt_u32 vcc, s43, v52
    v_cmp_gt_u32 s[64:65], s85, v82
    v_lshlrev_b32 v60, 3, v60
    s_nand_b64 exec, vcc, s[64:65]
    v_bfrev_b32 v60, 1
    s_mov_b64 exec, -1
    buffer_load_dwordx2 v[78:79], v60, s[8:11], 0 offen

    v_subrev_u32 v53, s83, v53
    v_subrev_u32 v82, s84, v61
    v_cmp_gt_u32 vcc, s43, v53
    v_cmp_gt_u32 s[64:65], s85, v82
    v_lshlrev_b32 v61, 3, v61
    s_nand_b64 exec, vcc, s[64:65]
    v_bfrev_b32 v61, 1
    s_mov_b64 exec, -1
    buffer_load_dwordx2 v[80:81], v61, s[8:11], 0 offen

    s_waitcnt vmcnt(0)
    v_cmp_le_i32 vcc, 0, v54
    s_mov_b64 exec, vcc
    s_cbranch_execz L_rsk_124
    v_lshlrev_b32 v82, 16, v62
    v_mul_f32 v82, v82, v45
    v_fract_f32 v82, v82
    v_cos_f32 v82, v82
    v_lshlrev_b32 v46, 4, v46
    v_lshlrev_b32 v83, 16, v66
    v_and_b32 v84, s32, v66
    v_lshlrev_b32 v85, 16, v67
    v_and_b32 v86, s32, v67

    v_mul_f32 v83, v83, v82
    ds_add_f32 v46, v83 offset:50000
    v_mul_f32 v84, v84, v82
    ds_add_f32 v46, v84 offset:50004
    v_mul_f32 v85, v85, v82
    ds_add_f32 v46, v85 offset:50008
    v_mul_f32 v86, v86, v82
    ds_add_f32 v46, v86 offset:50012
L_rsk_124:
    s_mov_b64 exec, -1
    v_cmp_le_i32 vcc, 0, v55
    s_mov_b64 exec, vcc
    s_cbranch_execz L_rsk_125
    v_and_b32 v82, s32, v62
    v_mul_f32 v82, v82, v45
    v_fract_f32 v82, v82
    v_cos_f32 v82, v82
    v_lshlrev_b32 v47, 4, v47
    v_lshlrev_b32 v83, 16, v68
    v_and_b32 v84, s32, v68
    v_lshlrev_b32 v85, 16, v69
    v_and_b32 v86, s32, v69

    v_mul_f32 v83, v83, v82
    ds_add_f32 v47, v83 offset:50000
    v_mul_f32 v84, v84, v82
    ds_add_f32 v47, v84 offset:50004
    v_mul_f32 v85, v85, v82
    ds_add_f32 v47, v85 offset:50008
    v_mul_f32 v86, v86, v82
    ds_add_f32 v47, v86 offset:50012
L_rsk_125:
    s_mov_b64 exec, -1
    v_cmp_le_i32 vcc, 0, v56
    s_mov_b64 exec, vcc
    s_cbranch_execz L_rsk_126
    v_lshlrev_b32 v82, 16, v63
    v_mul_f32 v82, v82, v45
    v_fract_f32 v82, v82
    v_cos_f32 v82, v82
    v_lshlrev_b32 v48, 4, v48
    v_lshlrev_b32 v83, 16, v70
    v_and_b32 v84, s32, v70
    v_lshlrev_b32 v85, 16, v71
    v_and_b32 v86, s32, v71

    v_mul_f32 v83, v83, v82
    ds_add_f32 v48, v83 offset:50000
    v_mul_f32 v84, v84, v82
    ds_add_f32 v48, v84 offset:50004
    v_mul_f32 v85, v85, v82
    ds_add_f32 v48, v85 offset:50008
    v_mul_f32 v86, v86, v82
    ds_add_f32 v48, v86 offset:50012
L_rsk_126:
    s_mov_b64 exec, -1
    v_cmp_le_i32 vcc, 0, v57
    s_mov_b64 exec, vcc
    s_cbranch_execz L_rsk_127
    v_and_b32 v82, s32, v63
    v_mul_f32 v82, v82, v45
    v_fract_f32 v82, v82
    v_cos_f32 v82, v82
    v_lshlrev_b32 v49, 4, v49
    v_lshlrev_b32 v83, 16, v72
    v_and_b32 v84, s32, v72
    v_lshlrev_b32 v85, 16, v73
    v_and_b32 v86, s32, v73

    v_mul_f32 v83, v83, v82
    ds_add_f32 v49, v83 offset:50000
    v_mul_f32 v84, v84, v82
    ds_add_f32 v49, v84 offset:50004
    v_mul_f32 v85, v85, v82
    ds_add_f32 v49, v85 offset:50008
    v_mul_f32 v86, v86, v82
    ds_add_f32 v49, v86 offset:50012
L_rsk_127:
    s_mov_b64 exec, -1
    v_cmp_le_i32 vcc, 0, v58
    s_mov_b64 exec, vcc
    s_cbranch_execz L_rsk_128
    v_lshlrev_b32 v82, 16, v64
    v_mul_f32 v82, v82, v45
    v_fract_f32 v82, v82
    v_cos_f32 v82, v82
    v_lshlrev_b32 v50, 4, v50
    v_lshlrev_b32 v83, 16, v74
    v_and_b32 v84, s32, v74
    v_lshlrev_b32 v85, 16, v75
    v_and_b32 v86, s32, v75

    v_mul_f32 v83, v83, v82
    ds_add_f32 v50, v83 offset:50000
    v_mul_f32 v84, v84, v82
    ds_add_f32 v50, v84 offset:50004
    v_mul_f32 v85, v85, v82
    ds_add_f32 v50, v85 offset:50008
    v_mul_f32 v86, v86, v82
    ds_add_f32 v50, v86 offset:50012
L_rsk_128:
    s_mov_b64 exec, -1
    v_cmp_le_i32 vcc, 0, v59
    s_mov_b64 exec, vcc
    s_cbranch_execz L_rsk_129
    v_and_b32 v82, s32, v64
    v_mul_f32 v82, v82, v45
    v_fract_f32 v82, v82
    v_cos_f32 v82, v82
    v_lshlrev_b32 v51, 4, v51
    v_lshlrev_b32 v83, 16, v76
    v_and_b32 v84, s32, v76
    v_lshlrev_b32 v85, 16, v77
    v_and_b32 v86, s32, v77

    v_mul_f32 v83, v83, v82
    ds_add_f32 v51, v83 offset:50000
    v_mul_f32 v84, v84, v82
    ds_add_f32 v51, v84 offset:50004
    v_mul_f32 v85, v85, v82
    ds_add_f32 v51, v85 offset:50008
    v_mul_f32 v86, v86, v82
    ds_add_f32 v51, v86 offset:50012
L_rsk_129:
    s_mov_b64 exec, -1
    v_cmp_le_i32 vcc, 0, v60
    s_mov_b64 exec, vcc
    s_cbranch_execz L_rsk_130
    v_lshlrev_b32 v82, 16, v65
    v_mul_f32 v82, v82, v45
    v_fract_f32 v82, v82
    v_cos_f32 v82, v82
    v_lshlrev_b32 v52, 4, v52
    v_lshlrev_b32 v83, 16, v78
    v_and_b32 v84, s32, v78
    v_lshlrev_b32 v85, 16, v79
    v_and_b32 v86, s32, v79

    v_mul_f32 v83, v83, v82
    ds_add_f32 v52, v83 offset:50000
    v_mul_f32 v84, v84, v82
    ds_add_f32 v52, v84 offset:50004
    v_mul_f32 v85, v85, v82
    ds_add_f32 v52, v85 offset:50008
    v_mul_f32 v86, v86, v82
    ds_add_f32 v52, v86 offset:50012
L_rsk_130:
    s_mov_b64 exec, -1
    v_cmp_le_i32 vcc, 0, v61
    s_mov_b64 exec, vcc
    s_cbranch_execz L_rsk_131
    v_and_b32 v82, s32, v65
    v_mul_f32 v82, v82, v45
    v_fract_f32 v82, v82
    v_cos_f32 v82, v82
    v_lshlrev_b32 v53, 4, v53
    v_lshlrev_b32 v83, 16, v80
    v_and_b32 v84, s32, v80
    v_lshlrev_b32 v85, 16, v81
    v_and_b32 v86, s32, v81

    v_mul_f32 v83, v83, v82
    ds_add_f32 v53, v83 offset:50000
    v_mul_f32 v84, v84, v82
    ds_add_f32 v53, v84 offset:50004
    v_mul_f32 v85, v85, v82
    ds_add_f32 v53, v85 offset:50008
    v_mul_f32 v86, v86, v82
    ds_add_f32 v53, v86 offset:50012
L_rsk_131:
    s_mov_b64 exec, -1
    s_add_u32 s38, s38, 32768
    s_cmp_lt_u32 s38, 204800000
    s_cbranch_scc1 L_rawl_118
L_swend_119:
    s_waitcnt lgkmcnt(0)
    s_barrier
    s_mul_i32 s3, s37, 800000
    s_mul_i32 s5, s36, 12500
    s_add_u32 s3, s3, s5
    s_add_u32 s3, s3, s51
    s_lshl_b32 s3, s3, 4
    s_add_u32 s3, s3, 34496512

    s_add_u32 s20, s6, s3
    s_addc_u32 s21, s7, 0
    s_mov_b32 s22, 100000
    s_mov_b32 s23, 0x20000
    v_mov_b32 v36, v3
    s_mov_b32 s38, 0
L_wl_120:
    v_min_u32 v37, 100000, v36
    ds_read_b128 v[28:31], v37 offset:50000
    s_waitcnt lgkmcnt(0)
    buffer_store_dwordx4 v[28:31], v36, s[20:23], 0 offen sc1
    s_waitcnt vmcnt(0)
    v_add_u32 v36, 16384, v36
    s_add_u32 s38, s38, 1024
    s_cmp_lt_u32 s38, 6250
    s_cbranch_scc1 L_wl_120
    s_add_u32 s51, s51, 6250
    s_cmp_lt_u32 s51, 12500
    s_cbranch_scc1 L_sweep_116
    s_lshl_b32 s33, 16, s37
    s_add_u32 s33, s33, 1
    s_branch L_fin_83

.section .rodata,"a"
.p2align 6
.amdhsa_kernel g1_kernel
  .amdhsa_next_free_vgpr 128
  .amdhsa_next_free_sgpr 102
  .amdhsa_accum_offset 128
  .amdhsa_group_segment_fixed_size 0
  .amdhsa_kernarg_size 112
  .amdhsa_user_sgpr_count 2
  .amdhsa_user_sgpr_kernarg_segment_ptr 1
  .amdhsa_system_sgpr_workgroup_id_x 1
  .amdhsa_float_denorm_mode_32 3
.end_amdhsa_kernel
.p2align 6
.amdhsa_kernel standalone__molecular_angular_gemnet__graph_kernel
  .amdhsa_next_free_vgpr 128
  .amdhsa_next_free_sgpr 102
  .amdhsa_accum_offset 128
  .amdhsa_group_segment_fixed_size 0
  .amdhsa_kernarg_size 112
  .amdhsa_user_sgpr_count 2
  .amdhsa_user_sgpr_kernarg_segment_ptr 1
  .amdhsa_system_sgpr_workgroup_id_x 1
  .amdhsa_float_denorm_mode_32 3
.end_amdhsa_kernel
```

```asm
; @launch kernel=g1_kernel grid=(256,1,1) block=(1024,1,1) lds=163840
; @launch kernel=standalone__molecular_angular_gemnet__graph_kernel grid=(256,1,1) block=(1024,1,1) lds=163840
.amdgcn_target "amdgcn-amd-amdhsa--gfx950"
.text
.globl g1_kernel
.p2align 8
.type g1_kernel,@function
g1_kernel:
    s_cmp_ge_u32 s2, 256
    s_cbranch_scc1 L_p1done_1
    s_load_dwordx4 s[80:83], s[0:1], 8
    s_load_dwordx2 s[84:85], s[0:1], 32
    s_load_dwordx2 s[86:87], s[0:1], 48
    s_load_dwordx4 s[4:7], s[0:1], 96
    s_load_dwordx2 s[78:79], s[0:1], 0
    v_lshlrev_b32 v1, 4, v0
    v_lshlrev_b32 v2, 3, v0
    v_lshlrev_b32 v98, 20, v0
    v_mov_b32 v108, 24576
    v_mov_b32 v110, 0
    v_mov_b32 v111, 0
    ds_write_b64 v2, v[110:111]
    s_mov_b64 exec, 1
    ds_write_b32 v108, v110
    s_mov_b64 exec, -1
    s_waitcnt lgkmcnt(0)
    s_load_dword s88, s[86:87], 0

    s_mov_b32 s96, s4
    s_mov_b32 s97, s5
    s_mov_b32 s98, 256
    s_mov_b32 s99, 0x20000
    v_readfirstlane_b32 s74, v0
    s_nop 1
    s_or_b32 s74, s74, s2
    s_cbranch_scc1 L_noinit_2

    v_mov_b32 v110, 1
    buffer_atomic_add v110, v98, s[96:99], 0 offen offset:64 sc0
    s_waitcnt vmcnt(0)
    v_readfirstlane_b32 s74, v110
    s_nop 1
    s_cmp_lg_u32 s74, 0
    s_cbranch_scc1 L_zno_4

    s_mov_b32 s92, s6
    s_mov_b32 s93, s7
    s_mov_b32 s94, 32784
    s_mov_b32 s95, 0x20000
    v_mov_b32 v110, 0
    v_mov_b32 v111, 0
    v_mov_b32 v112, 0
    v_mov_b32 v113, 0
L_zl_3:
    buffer_store_dwordx4 v[110:113], v1, s[92:95], s74 offen sc0 sc1
    s_add_u32 s74, s74, 1024
    s_cmp_le_u32 s74, 32768
    s_cbranch_scc1 L_zl_3
    v_mov_b32 v114, 1
    s_waitcnt vmcnt(0)
    buffer_atomic_add v114, v98, s[96:99], 0 offen offset:128
L_zno_4:

L_noinit_2:
    s_barrier
    s_mov_b32 s20, s78
    s_mov_b32 s21, s79
    s_mov_b32 s22, 6400000
    s_mov_b32 s23, 0x20000
    v_lshrrev_b32 v110, 3, v0
    v_and_b32 v111, 7, v0
    v_mul_u32_u24 v110, 49920, v110
    v_lshl_add_u32 v110, v111, 4, v110
    v_and_b32 v111, 63, v0
    v_and_b32 v112, 0x3c0, v0
    v_lshlrev_b32 v111, 2, v111
    v_lshl_or_b32 v111, v112, 4, v111
    v_lshlrev_b32 v100, 2, v0
    s_lshr_b32 s50, s2, 1
    s_and_b32 s53, s2, 1
    s_mul_i32 s3, s50, 50000
    s_mul_i32 s54, s53, 24576
    s_add_u32 s3, s3, s54

    buffer_load_dwordx4 v[56:59], v110, s[20:23], 0 offen
    s_add_u32 s20, s78, s3
    s_addc_u32 s21, s79, 0
    s_mov_b32 s22, 24576
    s_mov_b32 s23, 0x20000
    s_movk_i32 s3, 16384
    buffer_load_dword v116, v111, s[20:23], 0 offen offset:0
    buffer_load_dword v117, v111, s[20:23], 0 offen offset:256
    buffer_load_dword v118, v111, s[20:23], 0 offen offset:512
    buffer_load_dword v119, v111, s[20:23], 0 offen offset:768
    buffer_load_dword v120, v111, s[20:23], s3 offen offset:0
    buffer_load_dword v121, v111, s[20:23], s3 offen offset:256
    buffer_load_dword v122, v111, s[20:23], s3 offen offset:512
    buffer_load_dword v123, v111, s[20:23], s3 offen offset:768
    s_mul_i32 s22, s53, 25424
    s_movk_i32 s3, 24576

    buffer_load_dword v124, v100, s[20:23], s3 offen
    s_mul_i32 s3, s50, 50048
    s_add_u32 s3, s3, s54
    s_add_u32 s54, s3, 2490368

    v_readfirstlane_b32 s74, v0
    s_mov_b32 s55, 0x05040100
    s_nop 0
    s_cmp_lt_u32 s74, 768
    s_cbranch_scc1 L_nogate_5
    s_load_dwordx2 s[92:93], s[0:1], 40
    s_load_dwordx4 s[32:35], s[0:1], 56
    v_mov_b32 v110, 0
    s_waitcnt lgkmcnt(0)
    global_load_dwordx4 v[60:63], v110, s[92:93]

    global_load_dwordx4 v[64:67], v110, s[32:33] offset:0
    global_load_dwordx4 v[80:83], v110, s[34:35] offset:0
    global_load_dwordx4 v[68:71], v110, s[32:33] offset:16
    global_load_dwordx4 v[84:87], v110, s[34:35] offset:16
    global_load_dwordx4 v[72:75], v110, s[32:33] offset:32
    global_load_dwordx4 v[88:91], v110, s[34:35] offset:32
    global_load_dwordx4 v[76:79], v110, s[32:33] offset:48
    global_load_dwordx4 v[92:95], v110, s[34:35] offset:48
    s_lshl_b32 s74, s2, 8
    v_and_b32 v111, 255, v0
    v_add_u32 v111, s74, v111
    v_lshlrev_b32 v112, 16, v111
    v_lshlrev_b32 v111, 5, v111
    s_mov_b32 s75, 0x07060302
    s_waitcnt vmcnt(0)

    v_lshlrev_b32 v44, 16, v60
    v_and_b32 v45, 0xffff0000, v60
    v_lshlrev_b32 v46, 16, v61
    v_and_b32 v47, 0xffff0000, v61
    v_lshlrev_b32 v48, 16, v62
    v_and_b32 v49, 0xffff0000, v62
    v_lshlrev_b32 v50, 16, v63
    v_and_b32 v51, 0xffff0000, v63
    v_sub_f32 v44, v112, v44
    v_sub_f32 v45, v112, v45
    v_sub_f32 v46, v112, v46
    v_sub_f32 v47, v112, v47
    v_sub_f32 v48, v112, v48
    v_sub_f32 v49, v112, v49
    v_sub_f32 v50, v112, v50
    v_sub_f32 v51, v112, v51
    v_cvt_pk_bf16_f32 v44, v44, v45
    v_cvt_pk_bf16_f32 v46, v46, v47
    v_cvt_pk_bf16_f32 v48, v48, v49
    v_cvt_pk_bf16_f32 v50, v50, v51
    v_and_b32 v45, 0xffff0000, v44
    v_lshlrev_b32 v44, 16, v44
    v_and_b32 v47, 0xffff0000, v46
    v_lshlrev_b32 v46, 16, v46
    v_and_b32 v49, 0xffff0000, v48
    v_lshlrev_b32 v48, 16, v48
    v_and_b32 v51, 0xffff0000, v50
    v_lshlrev_b32 v50, 16, v50
    v_mul_f32 v44, v44, v44
    v_mul_f32 v45, v45, v45
    v_mul_f32 v46, v46, v46
    v_mul_f32 v47, v47, v47
    v_mul_f32 v48, v48, v48
    v_mul_f32 v49, v49, v49
    v_mul_f32 v50, v50, v50
    v_mul_f32 v51, v51, v51
    v_cvt_pk_bf16_f32 v44, v44, v45
    v_cvt_pk_bf16_f32 v46, v46, v47
    v_cvt_pk_bf16_f32 v48, v48, v49
    v_cvt_pk_bf16_f32 v50, v50, v51
    v_and_b32 v45, 0xffff0000, v44
    v_lshlrev_b32 v44, 16, v44
    v_and_b32 v47, 0xffff0000, v46
    v_lshlrev_b32 v46, 16, v46
    v_and_b32 v49, 0xffff0000, v48
    v_lshlrev_b32 v48, 16, v48
    v_and_b32 v51, 0xffff0000, v50
    v_lshlrev_b32 v50, 16, v50
    v_mul_f32 v44, 0xc1200000, v44
    v_mul_f32 v45, 0xc1200000, v45
    v_mul_f32 v46, 0xc1200000, v46
    v_mul_f32 v47, 0xc1200000, v47
    v_mul_f32 v48, 0xc1200000, v48
    v_mul_f32 v49, 0xc1200000, v49
    v_mul_f32 v50, 0xc1200000, v50
    v_mul_f32 v51, 0xc1200000, v51
    v_cvt_pk_bf16_f32 v44, v44, v45
    v_cvt_pk_bf16_f32 v46, v46, v47
    v_cvt_pk_bf16_f32 v48, v48, v49
    v_cvt_pk_bf16_f32 v50, v50, v51
    v_and_b32 v45, 0xffff0000, v44
    v_lshlrev_b32 v44, 16, v44
    v_and_b32 v47, 0xffff0000, v46
    v_lshlrev_b32 v46, 16, v46
    v_and_b32 v49, 0xffff0000, v48
    v_lshlrev_b32 v48, 16, v48
    v_and_b32 v51, 0xffff0000, v50
    v_lshlrev_b32 v50, 16, v50
    v_mul_f32 v44, 0x3fb8aa3b, v44
    v_mul_f32 v45, 0x3fb8aa3b, v45
    v_mul_f32 v46, 0x3fb8aa3b, v46
    v_mul_f32 v47, 0x3fb8aa3b, v47
    v_mul_f32 v48, 0x3fb8aa3b, v48
    v_mul_f32 v49, 0x3fb8aa3b, v49
    v_mul_f32 v50, 0x3fb8aa3b, v50
    v_mul_f32 v51, 0x3fb8aa3b, v51
    v_exp_f32 v44, v44
    v_exp_f32 v45, v45
    v_exp_f32 v46, v46
    v_exp_f32 v47, v47
    v_exp_f32 v48, v48
    v_exp_f32 v49, v49
    v_exp_f32 v50, v50
    v_exp_f32 v51, v51
    s_nop 0
    v_cvt_pk_bf16_f32 v44, v44, v45
    v_cvt_pk_bf16_f32 v46, v46, v47
    v_cvt_pk_bf16_f32 v48, v48, v49
    v_cvt_pk_bf16_f32 v50, v50, v51
    v_perm_b32 v113, v66, v64, s55
    v_dot2_f32_bf16 v52, v44, v113, 0

    v_perm_b32 v113, v66, v64, s75
    v_dot2_f32_bf16 v53, v44, v113, 0

    v_perm_b32 v113, v67, v65, s55
    v_dot2_f32_bf16 v54, v44, v113, 0

    v_perm_b32 v113, v67, v65, s75
    v_dot2_f32_bf16 v55, v44, v113, 0

    v_perm_b32 v113, v70, v68, s55
    v_dot2_f32_bf16 v52, v46, v113, v52

    v_perm_b32 v113, v70, v68, s75
    v_dot2_f32_bf16 v53, v46, v113, v53

    v_perm_b32 v113, v71, v69, s55
    v_dot2_f32_bf16 v54, v46, v113, v54

    v_perm_b32 v113, v71, v69, s75
    v_dot2_f32_bf16 v55, v46, v113, v55

    v_perm_b32 v113, v74, v72, s55
    v_dot2_f32_bf16 v52, v48, v113, v52

    v_perm_b32 v113, v74, v72, s75
    v_dot2_f32_bf16 v53, v48, v113, v53

    v_perm_b32 v113, v75, v73, s55
    v_dot2_f32_bf16 v54, v48, v113, v54

    v_perm_b32 v113, v75, v73, s75
    v_dot2_f32_bf16 v55, v48, v113, v55

    v_perm_b32 v113, v78, v76, s55
    v_dot2_f32_bf16 v52, v50, v113, v52

    v_perm_b32 v113, v78, v76, s75
    v_dot2_f32_bf16 v53, v50, v113, v53

    v_perm_b32 v113, v79, v77, s55
    v_dot2_f32_bf16 v54, v50, v113, v54

    v_perm_b32 v113, v79, v77, s75
    v_dot2_f32_bf16 v55, v50, v113, v55

    v_perm_b32 v113, v82, v80, s55
    v_dot2_f32_bf16 v60, v44, v113, 0

    v_perm_b32 v113, v82, v80, s75
    v_dot2_f32_bf16 v61, v44, v113, 0

    v_perm_b32 v113, v83, v81, s55
    v_dot2_f32_bf16 v62, v44, v113, 0

    v_perm_b32 v113, v83, v81, s75
    v_dot2_f32_bf16 v63, v44, v113, 0

    v_perm_b32 v113, v86, v84, s55
    v_dot2_f32_bf16 v60, v46, v113, v60

    v_perm_b32 v113, v86, v84, s75
    v_dot2_f32_bf16 v61, v46, v113, v61

    v_perm_b32 v113, v87, v85, s55
    v_dot2_f32_bf16 v62, v46, v113, v62

    v_perm_b32 v113, v87, v85, s75
    v_dot2_f32_bf16 v63, v46, v113, v63

    v_perm_b32 v113, v90, v88, s55
    v_dot2_f32_bf16 v60, v48, v113, v60

    v_perm_b32 v113, v90, v88, s75
    v_dot2_f32_bf16 v61, v48, v113, v61

    v_perm_b32 v113, v91, v89, s55
    v_dot2_f32_bf16 v62, v48, v113, v62

    v_perm_b32 v113, v91, v89, s75
    v_dot2_f32_bf16 v63, v48, v113, v63

    v_perm_b32 v113, v94, v92, s55
    v_dot2_f32_bf16 v60, v50, v113, v60

    v_perm_b32 v113, v94, v92, s75
    v_dot2_f32_bf16 v61, v50, v113, v61

    v_perm_b32 v113, v95, v93, s55
    v_dot2_f32_bf16 v62, v50, v113, v62

    v_perm_b32 v113, v95, v93, s75
    v_dot2_f32_bf16 v63, v50, v113, v63

    s_add_u32 s92, s6, 393216
    s_addc_u32 s93, s7, 0
    s_mov_b32 s94, 2097152
    s_mov_b32 s95, 0x20000
    v_cvt_pk_bf16_f32 v52, v52, v53
    v_cvt_pk_bf16_f32 v53, v54, v55
    buffer_store_dwordx4 v[60:63], v111, s[92:95], 0 offen
    buffer_store_dwordx2 v[52:53], v111, s[92:95], 0 offen offset:16
    s_nop 1
L_nogate_5:

    s_mov_b32 s8, s80
    s_mov_b32 s9, s81
    s_mov_b32 s10, 0
    s_mov_b32 s11, 0x20000
    s_mov_b32 s12, s82
    s_mov_b32 s13, s83
    s_mov_b32 s14, 0
    s_mov_b32 s15, 0x20000
    s_mov_b32 s16, s84
    s_mov_b32 s17, s85
    s_mov_b32 s18, 0
    s_mov_b32 s19, 0x20000
    s_lshr_b32 s74, s2, 1
    s_and_b32 s74, s74, 28
    s_lshr_b32 s86, 0x00102010, s74
    s_lshr_b32 s87, 0x44414241, s74
    s_lshr_b32 s41, 0x43221100, s74
    s_and_b32 s86, s86, 15
    s_and_b32 s87, s87, 15
    s_and_b32 s41, s41, 15
    s_lshr_b32 s74, s2, 6
    s_lshl_b32 s74, s74, 3
    s_and_b32 s75, s2, 7
    s_add_u32 s74, s74, s75
    s_mul_i32 s74, s74, 5
    s_add_u32 s41, s41, s74

    s_mul_i32 s78, s41, 16384
    s_add_u32 s49, s78, 16384
    s_cmp_ge_u32 s41, 3125
    s_cmovk_i32 s49, 0
    s_cmovk_i32 s78, 0
    s_lshl_b32 s10, s49, 2
    s_lshl_b32 s14, s49, 2
    s_lshl_b32 s18, s49, 1
    s_sub_u32 s79, s87, s86
    s_bfm_b32 s85, s79, s86
    s_lshl_b32 s86, s86, 12
    s_lshl_b32 s87, s87, 12
    s_min_u32 s87, s87, 16384

    s_add_u32 s79, s78, 0
    s_bitcmp1_b32 s85, 0
    s_cselect_b32 s79, s79, 0x1ff00000
    s_lshl_b32 s56, s79, 2
    s_lshl_b32 s61, s79, 1

    s_add_u32 s79, s78, 4096
    s_bitcmp1_b32 s85, 1
    s_cselect_b32 s79, s79, 0x1ff00000
    s_lshl_b32 s57, s79, 2
    s_lshl_b32 s62, s79, 1

    s_add_u32 s79, s78, 8192
    s_bitcmp1_b32 s85, 2
    s_cselect_b32 s79, s79, 0x1ff00000
    s_lshl_b32 s58, s79, 2
    s_lshl_b32 s63, s79, 1

    s_add_u32 s79, s78, 12288
    s_bitcmp1_b32 s85, 3
    s_cselect_b32 s79, s79, 0x1ff00000
    s_lshl_b32 s59, s79, 2
    s_lshl_b32 s64, s79, 1

    s_mov_b32 s82, s85
    s_mov_b32 s83, s86
    s_mov_b32 s84, s87
    s_add_u32 s41, s2, 160
    s_mul_i32 s74, s41, 16384
    s_mov_b32 s10, 204800000
    s_mov_b32 s14, 204800000
    s_mov_b32 s18, 102400000

    s_add_u32 s75, s74, 0
    s_lshl_b32 s76, s75, 2
    s_lshl_b32 s75, s75, 1
    s_bitcmp1_b32 s82, 0
    s_cselect_b32 s56, s56, s76
    s_cselect_b32 s61, s61, s75

    s_add_u32 s75, s74, 4096
    s_lshl_b32 s76, s75, 2
    s_lshl_b32 s75, s75, 1
    s_bitcmp1_b32 s82, 1
    s_cselect_b32 s57, s57, s76
    s_cselect_b32 s62, s62, s75

    s_add_u32 s75, s74, 8192
    s_lshl_b32 s76, s75, 2
    s_lshl_b32 s75, s75, 1
    s_bitcmp1_b32 s82, 2
    s_cselect_b32 s58, s58, s76
    s_cselect_b32 s63, s63, s75

    s_add_u32 s75, s74, 12288
    s_lshl_b32 s76, s75, 2
    s_lshl_b32 s75, s75, 1
    s_bitcmp1_b32 s82, 3
    s_cselect_b32 s59, s59, s76
    s_cselect_b32 s64, s64, s75

    buffer_load_dwordx4 v[20:23], v1, s[12:15], s56 offen nt
    buffer_load_dwordx4 v[4:7], v1, s[8:11], s56 offen nt
    buffer_load_dwordx2 v[36:37], v2, s[16:19], s61 offen nt
    buffer_load_dwordx4 v[24:27], v1, s[12:15], s57 offen nt
    buffer_load_dwordx4 v[8:11], v1, s[8:11], s57 offen nt
    buffer_load_dwordx2 v[38:39], v2, s[16:19], s62 offen nt
    buffer_load_dwordx4 v[28:31], v1, s[12:15], s58 offen nt
    buffer_load_dwordx4 v[12:15], v1, s[8:11], s58 offen nt
    buffer_load_dwordx2 v[40:41], v2, s[16:19], s63 offen nt
    buffer_load_dwordx4 v[32:35], v1, s[12:15], s59 offen nt
    buffer_load_dwordx4 v[16:19], v1, s[8:11], s59 offen nt
    buffer_load_dwordx2 v[42:43], v2, s[16:19], s64 offen nt
    s_mov_b32 s86, 0
    s_mov_b32 s87, 4
    s_mul_i32 s78, s41, 16384
    s_add_u32 s49, s78, 16384
    s_cmp_ge_u32 s41, 3125
    s_cmovk_i32 s49, 0
    s_cmovk_i32 s78, 0
    s_lshl_b32 s10, s49, 2
    s_lshl_b32 s14, s49, 2
    s_lshl_b32 s18, s49, 1
    s_sub_u32 s79, s87, s86
    s_bfm_b32 s85, s79, s86
    s_lshl_b32 s86, s86, 12
    s_lshl_b32 s87, s87, 12
    s_min_u32 s87, s87, 16384

    s_add_u32 s79, s78, 0
    s_bitcmp1_b32 s85, 0
    s_cselect_b32 s79, s79, 0x1ff00000
    s_lshl_b32 s56, s79, 2
    s_lshl_b32 s61, s79, 1

    s_add_u32 s79, s78, 4096
    s_bitcmp1_b32 s85, 1
    s_cselect_b32 s79, s79, 0x1ff00000
    s_lshl_b32 s57, s79, 2
    s_lshl_b32 s62, s79, 1

    s_add_u32 s79, s78, 8192
    s_bitcmp1_b32 s85, 2
    s_cselect_b32 s79, s79, 0x1ff00000
    s_lshl_b32 s58, s79, 2
    s_lshl_b32 s63, s79, 1

    s_add_u32 s79, s78, 12288
    s_bitcmp1_b32 s85, 3
    s_cselect_b32 s79, s79, 0x1ff00000
    s_lshl_b32 s59, s79, 2
    s_lshl_b32 s64, s79, 1

    s_getreg_b32 s5, hwreg(HW_REG_XCC_ID)
    s_and_b32 s5, s5, 7
    s_mul_i32 s3, s5, 4096

    s_add_u32 s20, s6, s3
    s_addc_u32 s21, s7, 0
    s_mov_b32 s22, 4096
    s_mov_b32 s23, 0x20000
    s_mul_i32 s3, s5, 67117056
    s_add_u32 s3, s3, 85721088
    s_add_u32 s24, s6, s3
    s_addc_u32 s25, s7, 0
    s_mov_b32 s26, 67117056
    s_mov_b32 s27, 0x20000
    s_add_u32 s36, s6, 32768
    s_addc_u32 s37, s7, 0
    s_mov_b32 s38, 4
    s_mov_b32 s39, 0x20000
    s_mov_b32 s40, 687195
    s_mov_b32 s42, -6250
    s_mov_b32 s43, 1942
    s_mov_b32 s45, 0x06050400
    s_mov_b32 s46, 0x05040c00
    s_mov_b32 s48, 6524
    s_mov_b32 s50, 0
    v_mov_b32 v104, 1
    v_mov_b32 v105, 0x46ff8000
    s_mov_b32 s55, 0x05040100
    v_mul_u32_u24 v106, 5, v0

    v_and_b32 v102, 15, v0
    v_lshrrev_b32 v103, 4, v0
    v_lshl_add_u32 v102, v102, 7, v103
    v_mul_u32_u24 v102, 32764, v102
    v_add_u32 v103, 2096896, v102

    v_and_b32 v102, 0xffffff80, v102
    v_and_b32 v103, 0xffffff80, v103
    s_movk_i32 s3, 1024
    v_cmp_gt_u32 s[66:67], s3, v0
    s_movk_i32 s3, 1024
    v_cmp_gt_u32 s[68:69], s3, v0
    s_waitcnt lgkmcnt(0)
    s_lshl_b32 s88, s88, 16
    v_mov_b32 v110, 0.15915494
    v_mul_f32 v110, s88, v110
    s_mov_b32 s3, 0x7fff7fff
    v_readfirstlane_b32 s44, v110

    s_waitcnt vmcnt(12)
    v_mov_b32 v61, 0
    v_mov_b32 v62, 0
    v_mov_b32 v63, 0
    v_dot2_f32_bf16 v61, v116, v116, v61
    v_dot2_f32_bf16 v61, v117, v117, v61
    v_dot2_f32_bf16 v61, v118, v118, v61
    v_dot2_f32_bf16 v61, v119, v119, v61
    v_dot2_f32_bf16 v61, v120, v120, v61
    v_dot2_f32_bf16 v61, v121, v121, v61
    v_dot2_f32_bf16 v61, v122, v122, v61
    v_dot2_f32_bf16 v61, v123, v123, v61
    v_dot2_f32_bf16 v61, v124, v124, v61
    v_dot2_f32_bf16 v62, v56, v56, v62
    v_dot2_f32_bf16 v62, v57, v57, v62
    v_dot2_f32_bf16 v62, v58, v58, v62
    v_dot2_f32_bf16 v62, v59, v59, v62
    v_and_b32 v60, s3, v116
    v_and_b32 v64, s3, v117
    v_pk_max_u16 v60, v60, v64
    v_and_b32 v64, s3, v118
    v_pk_max_u16 v60, v60, v64
    v_and_b32 v64, s3, v119
    v_pk_max_u16 v60, v60, v64
    v_and_b32 v64, s3, v120
    v_pk_max_u16 v60, v60, v64
    v_and_b32 v64, s3, v121
    v_pk_max_u16 v60, v60, v64
    v_and_b32 v64, s3, v122
    v_pk_max_u16 v60, v60, v64
    v_and_b32 v64, s3, v123
    v_pk_max_u16 v60, v60, v64
    v_and_b32 v64, s3, v124
    v_pk_max_u16 v60, v60, v64
    v_lshrrev_b32 v64, 16, v60
    v_and_b32 v60, 0xffff, v60
    v_max_u32 v60, v60, v64

    s_nop 1
    v_max_u32_dpp v60, v60, v60 row_shr:1 row_mask:0xf bank_mask:0xf
    s_nop 1
    v_max_u32_dpp v60, v60, v60 row_shr:2 row_mask:0xf bank_mask:0xf
    s_nop 1
    v_max_u32_dpp v60, v60, v60 row_shr:4 row_mask:0xf bank_mask:0xf
    s_nop 1
    v_max_u32_dpp v60, v60, v60 row_shr:8 row_mask:0xf bank_mask:0xf
    s_nop 1
    v_max_u32_dpp v60, v60, v60 row_bcast:15 row_mask:0xa bank_mask:0xf
    s_nop 1
    v_max_u32_dpp v60, v60, v60 row_bcast:31 row_mask:0xc bank_mask:0xf
    s_nop 1
    v_add_f32_dpp v61, v61, v61 row_shr:1 row_mask:0xf bank_mask:0xf
    s_nop 1
    v_add_f32_dpp v61, v61, v61 row_shr:2 row_mask:0xf bank_mask:0xf
    s_nop 1
    v_add_f32_dpp v61, v61, v61 row_shr:4 row_mask:0xf bank_mask:0xf
    s_nop 1
    v_add_f32_dpp v61, v61, v61 row_shr:8 row_mask:0xf bank_mask:0xf
    s_nop 1
    v_add_f32_dpp v61, v61, v61 row_bcast:15 row_mask:0xa bank_mask:0xf
    s_nop 1
    v_add_f32_dpp v61, v61, v61 row_bcast:31 row_mask:0xc bank_mask:0xf
    s_nop 1
    v_add_f32_dpp v62, v62, v62 row_shr:1 row_mask:0xf bank_mask:0xf
    s_nop 1
    v_add_f32_dpp v62, v62, v62 row_shr:2 row_mask:0xf bank_mask:0xf
    s_nop 1
    v_add_f32_dpp v62, v62, v62 row_shr:4 row_mask:0xf bank_mask:0xf
    s_nop 1
    v_add_f32_dpp v62, v62, v62 row_shr:8 row_mask:0xf bank_mask:0xf
    s_nop 1
    v_add_f32_dpp v62, v62, v62 row_bcast:15 row_mask:0xa bank_mask:0xf
    s_nop 1
    v_add_f32_dpp v62, v62, v62 row_bcast:31 row_mask:0xc bank_mask:0xf
    v_lshrrev_b32 v64, 6, v0
    v_lshlrev_b32 v64, 4, v64
    s_mov_b32 exec_lo, 0
    s_brev_b32 exec_hi, 1
    ds_write_b128 v64, v[60:63] offset:16384
    s_mov_b64 exec, -1

    s_bitcmp0_b32 s82, 0
    s_cbranch_scc1 L_ska_8
    s_waitcnt vmcnt(9)
    v_mul_hi_u32_u24 v45, s40, v20
    v_mul_hi_u32_u24 v44, s40, v4
    v_mul_hi_u32_u24 v47, s40, v21
    v_mul_hi_u32_u24 v46, s40, v5
    v_mul_hi_u32_u24 v49, s40, v22
    v_mul_hi_u32_u24 v48, s40, v6
    v_mul_hi_u32_u24 v51, s40, v23
    v_mul_hi_u32_u24 v50, s40, v7
    v_and_b32 v45, -2, v45
    v_mad_u32_u24 v4, v44, s43, v4
    v_and_b32 v76, -4, v44
    v_and_b32 v47, -2, v47
    v_mad_u32_u24 v5, v46, s43, v5
    v_and_b32 v77, -4, v46
    v_and_b32 v49, -2, v49
    v_mad_u32_u24 v6, v48, s43, v6
    v_and_b32 v78, -4, v48
    v_and_b32 v51, -2, v51
    v_mad_u32_u24 v7, v50, s43, v7
    v_and_b32 v79, -4, v50
    v_mad_i32_i24 v20, v45, s42, v20
    v_lshl_add_u32 v45, v45, 6, v76
    v_mad_i32_i24 v21, v47, s42, v21
    v_lshl_add_u32 v47, v47, 6, v77
    v_mad_i32_i24 v22, v49, s42, v22
    v_lshl_add_u32 v49, v49, 6, v78
    v_mad_i32_i24 v23, v51, s42, v23
    v_lshl_add_u32 v51, v51, 6, v79
    ds_add_rtn_u32 v76, v45, v104
    ds_add_rtn_u32 v77, v47, v104
    ds_add_rtn_u32 v78, v49, v104
    ds_add_rtn_u32 v79, v51, v104
    v_lshlrev_b32 v110, 16, v36
    v_and_b32 v111, 0xffff0000, v36
    v_lshlrev_b32 v112, 16, v37
    v_and_b32 v113, 0xffff0000, v37
    v_mul_f32 v110, s44, v110
    v_mul_f32 v111, s44, v111
    v_mul_f32 v112, s44, v112
    v_mul_f32 v113, s44, v113
    v_fract_f32 v110, v110
    v_fract_f32 v111, v111
    v_fract_f32 v112, v112
    v_fract_f32 v113, v113
    v_cos_f32 v110, v110
    v_cos_f32 v111, v111
    v_cos_f32 v112, v112
    v_cos_f32 v113, v113
    v_lshl_or_b32 v44, v44, 14, v20
    v_perm_b32 v45, v45, v4, s46
    v_bfe_u32 v4, v4, 8, 5

    v_lshl_or_b32 v46, v46, 14, v21
    v_perm_b32 v47, v47, v5, s46
    v_bfe_u32 v5, v5, 8, 5

    v_lshl_or_b32 v48, v48, 14, v22
    v_perm_b32 v49, v49, v6, s46
    v_bfe_u32 v6, v6, 8, 5

    v_lshl_or_b32 v50, v50, 14, v23
    v_perm_b32 v51, v51, v7, s46
    v_bfe_u32 v7, v7, 8, 5

    v_fmaak_f32 v110, v110, v105, 0x4b400010
    v_fmaak_f32 v111, v111, v105, 0x4b400010
    v_fmaak_f32 v112, v112, v105, 0x4b400010
    v_fmaak_f32 v113, v113, v105, 0x4b400010
    v_sub_u32 v110, v110, v4
    v_sub_u32 v111, v111, v5
    v_sub_u32 v112, v112, v6
    v_sub_u32 v113, v113, v7
    v_bfi_b32 v110, 31, v4, v110
    v_bfi_b32 v111, 31, v5, v111
    v_bfi_b32 v112, 31, v6, v112
    v_bfi_b32 v113, 31, v7, v113
    v_perm_b32 v44, v44, v110, s55
    v_perm_b32 v46, v46, v111, s55
    v_perm_b32 v48, v48, v112, s55
    v_perm_b32 v50, v50, v113, s55
    buffer_load_dwordx4 v[20:23], v1, s[12:15], s56 offen nt
    buffer_load_dwordx4 v[4:7], v1, s[8:11], s56 offen nt
    buffer_load_dwordx2 v[36:37], v2, s[16:19], s61 offen nt
L_bka_9:
    s_bitcmp0_b32 s82, 1
    s_cbranch_scc1 L_ska_10
    s_waitcnt vmcnt(9)
    v_mul_hi_u32_u24 v53, s40, v24
    v_mul_hi_u32_u24 v52, s40, v8
    v_mul_hi_u32_u24 v55, s40, v25
    v_mul_hi_u32_u24 v54, s40, v9
    v_mul_hi_u32_u24 v57, s40, v26
    v_mul_hi_u32_u24 v56, s40, v10
    v_mul_hi_u32_u24 v59, s40, v27
    v_mul_hi_u32_u24 v58, s40, v11
    v_and_b32 v53, -2, v53
    v_mad_u32_u24 v8, v52, s43, v8
    v_and_b32 v80, -4, v52
    v_and_b32 v55, -2, v55
    v_mad_u32_u24 v9, v54, s43, v9
    v_and_b32 v81, -4, v54
    v_and_b32 v57, -2, v57
    v_mad_u32_u24 v10, v56, s43, v10
    v_and_b32 v82, -4, v56
    v_and_b32 v59, -2, v59
    v_mad_u32_u24 v11, v58, s43, v11
    v_and_b32 v83, -4, v58
    v_mad_i32_i24 v24, v53, s42, v24
    v_lshl_add_u32 v53, v53, 6, v80
    v_mad_i32_i24 v25, v55, s42, v25
    v_lshl_add_u32 v55, v55, 6, v81
    v_mad_i32_i24 v26, v57, s42, v26
    v_lshl_add_u32 v57, v57, 6, v82
    v_mad_i32_i24 v27, v59, s42, v27
    v_lshl_add_u32 v59, v59, 6, v83
    ds_add_rtn_u32 v80, v53, v104
    ds_add_rtn_u32 v81, v55, v104
    ds_add_rtn_u32 v82, v57, v104
    ds_add_rtn_u32 v83, v59, v104
    v_lshlrev_b32 v110, 16, v38
    v_and_b32 v111, 0xffff0000, v38
    v_lshlrev_b32 v112, 16, v39
    v_and_b32 v113, 0xffff0000, v39
    v_mul_f32 v110, s44, v110
    v_mul_f32 v111, s44, v111
    v_mul_f32 v112, s44, v112
    v_mul_f32 v113, s44, v113
    v_fract_f32 v110, v110
    v_fract_f32 v111, v111
    v_fract_f32 v112, v112
    v_fract_f32 v113, v113
    v_cos_f32 v110, v110
    v_cos_f32 v111, v111
    v_cos_f32 v112, v112
    v_cos_f32 v113, v113
    v_lshl_or_b32 v52, v52, 14, v24
    v_perm_b32 v53, v53, v8, s46
    v_bfe_u32 v8, v8, 8, 5

    v_lshl_or_b32 v54, v54, 14, v25
    v_perm_b32 v55, v55, v9, s46
    v_bfe_u32 v9, v9, 8, 5

    v_lshl_or_b32 v56, v56, 14, v26
    v_perm_b32 v57, v57, v10, s46
    v_bfe_u32 v10, v10, 8, 5

    v_lshl_or_b32 v58, v58, 14, v27
    v_perm_b32 v59, v59, v11, s46
    v_bfe_u32 v11, v11, 8, 5

    v_fmaak_f32 v110, v110, v105, 0x4b400010
    v_fmaak_f32 v111, v111, v105, 0x4b400010
    v_fmaak_f32 v112, v112, v105, 0x4b400010
    v_fmaak_f32 v113, v113, v105, 0x4b400010
    v_sub_u32 v110, v110, v8
    v_sub_u32 v111, v111, v9
    v_sub_u32 v112, v112, v10
    v_sub_u32 v113, v113, v11
    v_bfi_b32 v110, 31, v8, v110
    v_bfi_b32 v111, 31, v9, v111
    v_bfi_b32 v112, 31, v10, v112
    v_bfi_b32 v113, 31, v11, v113
    v_perm_b32 v52, v52, v110, s55
    v_perm_b32 v54, v54, v111, s55
    v_perm_b32 v56, v56, v112, s55
    v_perm_b32 v58, v58, v113, s55
    buffer_load_dwordx4 v[24:27], v1, s[12:15], s57 offen nt
    buffer_load_dwordx4 v[8:11], v1, s[8:11], s57 offen nt
    buffer_load_dwordx2 v[38:39], v2, s[16:19], s62 offen nt
L_bka_11:
    s_bitcmp0_b32 s82, 2
    s_cbranch_scc1 L_ska_12
    s_waitcnt vmcnt(9)
    v_mul_hi_u32_u24 v61, s40, v28
    v_mul_hi_u32_u24 v60, s40, v12
    v_mul_hi_u32_u24 v63, s40, v29
    v_mul_hi_u32_u24 v62, s40, v13
    v_mul_hi_u32_u24 v65, s40, v30
    v_mul_hi_u32_u24 v64, s40, v14
    v_mul_hi_u32_u24 v67, s40, v31
    v_mul_hi_u32_u24 v66, s40, v15
    v_and_b32 v61, -2, v61
    v_mad_u32_u24 v12, v60, s43, v12
    v_and_b32 v84, -4, v60
    v_and_b32 v63, -2, v63
    v_mad_u32_u24 v13, v62, s43, v13
    v_and_b32 v85, -4, v62
    v_and_b32 v65, -2, v65
    v_mad_u32_u24 v14, v64, s43, v14
    v_and_b32 v86, -4, v64
    v_and_b32 v67, -2, v67
    v_mad_u32_u24 v15, v66, s43, v15
    v_and_b32 v87, -4, v66
    v_mad_i32_i24 v28, v61, s42, v28
    v_lshl_add_u32 v61, v61, 6, v84
    v_mad_i32_i24 v29, v63, s42, v29
    v_lshl_add_u32 v63, v63, 6, v85
    v_mad_i32_i24 v30, v65, s42, v30
    v_lshl_add_u32 v65, v65, 6, v86
    v_mad_i32_i24 v31, v67, s42, v31
    v_lshl_add_u32 v67, v67, 6, v87
    ds_add_rtn_u32 v84, v61, v104
    ds_add_rtn_u32 v85, v63, v104
    ds_add_rtn_u32 v86, v65, v104
    ds_add_rtn_u32 v87, v67, v104
    v_lshlrev_b32 v110, 16, v40
    v_and_b32 v111, 0xffff0000, v40
    v_lshlrev_b32 v112, 16, v41
    v_and_b32 v113, 0xffff0000, v41
    v_mul_f32 v110, s44, v110
    v_mul_f32 v111, s44, v111
    v_mul_f32 v112, s44, v112
    v_mul_f32 v113, s44, v113
    v_fract_f32 v110, v110
    v_fract_f32 v111, v111
    v_fract_f32 v112, v112
    v_fract_f32 v113, v113
    v_cos_f32 v110, v110
    v_cos_f32 v111, v111
    v_cos_f32 v112, v112
    v_cos_f32 v113, v113
    v_lshl_or_b32 v60, v60, 14, v28
    v_perm_b32 v61, v61, v12, s46
    v_bfe_u32 v12, v12, 8, 5

    v_lshl_or_b32 v62, v62, 14, v29
    v_perm_b32 v63, v63, v13, s46
    v_bfe_u32 v13, v13, 8, 5

    v_lshl_or_b32 v64, v64, 14, v30
    v_perm_b32 v65, v65, v14, s46
    v_bfe_u32 v14, v14, 8, 5

    v_lshl_or_b32 v66, v66, 14, v31
    v_perm_b32 v67, v67, v15, s46
    v_bfe_u32 v15, v15, 8, 5

    v_fmaak_f32 v110, v110, v105, 0x4b400010
    v_fmaak_f32 v111, v111, v105, 0x4b400010
    v_fmaak_f32 v112, v112, v105, 0x4b400010
    v_fmaak_f32 v113, v113, v105, 0x4b400010
    v_sub_u32 v110, v110, v12
    v_sub_u32 v111, v111, v13
    v_sub_u32 v112, v112, v14
    v_sub_u32 v113, v113, v15
    v_bfi_b32 v110, 31, v12, v110
    v_bfi_b32 v111, 31, v13, v111
    v_bfi_b32 v112, 31, v14, v112
    v_bfi_b32 v113, 31, v15, v113
    v_perm_b32 v60, v60, v110, s55
    v_perm_b32 v62, v62, v111, s55
    v_perm_b32 v64, v64, v112, s55
    v_perm_b32 v66, v66, v113, s55
    buffer_load_dwordx4 v[28:31], v1, s[12:15], s58 offen nt
    buffer_load_dwordx4 v[12:15], v1, s[8:11], s58 offen nt
    buffer_load_dwordx2 v[40:41], v2, s[16:19], s63 offen nt
L_bka_13:
    s_bitcmp0_b32 s82, 3
    s_cbranch_scc1 L_ska_14
    s_waitcnt vmcnt(9)
    s_mov_b64 exec, s[66:67]
    v_mul_hi_u32_u24 v69, s40, v32
    v_mul_hi_u32_u24 v68, s40, v16
    v_mul_hi_u32_u24 v71, s40, v33
    v_mul_hi_u32_u24 v70, s40, v17
    v_mul_hi_u32_u24 v73, s40, v34
    v_mul_hi_u32_u24 v72, s40, v18
    v_mul_hi_u32_u24 v75, s40, v35
    v_mul_hi_u32_u24 v74, s40, v19
    v_and_b32 v69, -2, v69
    v_mad_u32_u24 v16, v68, s43, v16
    v_and_b32 v88, -4, v68
    v_and_b32 v71, -2, v71
    v_mad_u32_u24 v17, v70, s43, v17
    v_and_b32 v89, -4, v70
    v_and_b32 v73, -2, v73
    v_mad_u32_u24 v18, v72, s43, v18
    v_and_b32 v90, -4, v72
    v_and_b32 v75, -2, v75
    v_mad_u32_u24 v19, v74, s43, v19
    v_and_b32 v91, -4, v74
    v_mad_i32_i24 v32, v69, s42, v32
    v_lshl_add_u32 v69, v69, 6, v88
    v_mad_i32_i24 v33, v71, s42, v33
    v_lshl_add_u32 v71, v71, 6, v89
    v_mad_i32_i24 v34, v73, s42, v34
    v_lshl_add_u32 v73, v73, 6, v90
    v_mad_i32_i24 v35, v75, s42, v35
    v_lshl_add_u32 v75, v75, 6, v91
    ds_add_rtn_u32 v88, v69, v104
    ds_add_rtn_u32 v89, v71, v104
    ds_add_rtn_u32 v90, v73, v104
    ds_add_rtn_u32 v91, v75, v104
    v_lshlrev_b32 v110, 16, v42
    v_and_b32 v111, 0xffff0000, v42
    v_lshlrev_b32 v112, 16, v43
    v_and_b32 v113, 0xffff0000, v43
    v_mul_f32 v110, s44, v110
    v_mul_f32 v111, s44, v111
    v_mul_f32 v112, s44, v112
    v_mul_f32 v113, s44, v113
    v_fract_f32 v110, v110
    v_fract_f32 v111, v111
    v_fract_f32 v112, v112
    v_fract_f32 v113, v113
    v_cos_f32 v110, v110
    v_cos_f32 v111, v111
    v_cos_f32 v112, v112
    v_cos_f32 v113, v113
    v_lshl_or_b32 v68, v68, 14, v32
    v_perm_b32 v69, v69, v16, s46
    v_bfe_u32 v16, v16, 8, 5

    v_lshl_or_b32 v70, v70, 14, v33
    v_perm_b32 v71, v71, v17, s46
    v_bfe_u32 v17, v17, 8, 5

    v_lshl_or_b32 v72, v72, 14, v34
    v_perm_b32 v73, v73, v18, s46
    v_bfe_u32 v18, v18, 8, 5

    v_lshl_or_b32 v74, v74, 14, v35
    v_perm_b32 v75, v75, v19, s46
    v_bfe_u32 v19, v19, 8, 5

    v_fmaak_f32 v110, v110, v105, 0x4b400010
    v_fmaak_f32 v111, v111, v105, 0x4b400010
    v_fmaak_f32 v112, v112, v105, 0x4b400010
    v_fmaak_f32 v113, v113, v105, 0x4b400010
    v_sub_u32 v110, v110, v16
    v_sub_u32 v111, v111, v17
    v_sub_u32 v112, v112, v18
    v_sub_u32 v113, v113, v19
    v_bfi_b32 v110, 31, v16, v110
    v_bfi_b32 v111, 31, v17, v111
    v_bfi_b32 v112, 31, v18, v112
    v_bfi_b32 v113, 31, v19, v113
    v_perm_b32 v68, v68, v110, s55
    v_perm_b32 v70, v70, v111, s55
    v_perm_b32 v72, v72, v112, s55
    v_perm_b32 v74, v74, v113, s55
    s_mov_b64 exec, -1
    buffer_load_dwordx4 v[32:35], v1, s[12:15], s59 offen nt
    buffer_load_dwordx4 v[16:19], v1, s[8:11], s59 offen nt
    buffer_load_dwordx2 v[42:43], v2, s[16:19], s64 offen nt
L_bka_15:
    v_readfirstlane_b32 s74, v0
    s_nop 1
    s_cmp_lg_u32 s74, 0
    s_cbranch_scc1 L_ready_17

    v_mov_b32 v100, 0
    buffer_atomic_add v100, v98, s[96:99], 0 offen offset:128 sc0
    s_waitcnt vmcnt(0)
    v_readfirstlane_b32 s74, v100
    s_nop 1
    s_cmp_lg_u32 s74, 0
    s_cbranch_scc1 L_ready_17

    v_mov_b32 v110, 1
    buffer_atomic_add v110, v98, s[96:99], 0 offen offset:64 sc0
    s_waitcnt vmcnt(0)
    v_readfirstlane_b32 s74, v110
    s_nop 1
    s_cmp_lg_u32 s74, 0
    s_cbranch_scc1 L_zno_19

    s_mov_b32 s92, s6
    s_mov_b32 s93, s7
    s_mov_b32 s94, 32784
    s_mov_b32 s95, 0x20000
    v_mov_b32 v110, 0
    v_mov_b32 v111, 0
    v_mov_b32 v112, 0
    v_mov_b32 v113, 0
L_zl_18:
    buffer_store_dwordx4 v[110:113], v1, s[92:95], s74 offen sc0 sc1
    s_add_u32 s74, s74, 1024
    s_cmp_le_u32 s74, 32768
    s_cbranch_scc1 L_zl_18
    v_mov_b32 v114, 1
    s_waitcnt vmcnt(0)
    buffer_atomic_add v114, v98, s[96:99], 0 offen offset:128
L_zno_19:

L_spin_16:
    v_mov_b32 v100, 0
    buffer_atomic_add v100, v98, s[96:99], 0 offen offset:128 sc0
    s_waitcnt vmcnt(0)
    v_readfirstlane_b32 s74, v100
    s_nop 1
    s_cmp_eq_u32 s74, 0
    s_cbranch_scc1 L_spin_16
L_ready_17:

    s_waitcnt lgkmcnt(0)
    s_barrier

    v_and_b32 v114, 15, v0
    v_lshlrev_b32 v114, 4, v114
    ds_read_b128 v[110:113], v114 offset:16384
    s_waitcnt lgkmcnt(0)

    s_nop 0
    v_max_u32_dpp v110, v110, v110 row_ror:1 row_mask:0xf bank_mask:0xf
    v_add_f32_dpp v111, v111, v111 row_ror:1 row_mask:0xf bank_mask:0xf
    v_add_f32_dpp v112, v112, v112 row_ror:1 row_mask:0xf bank_mask:0xf

    s_nop 0
    v_max_u32_dpp v110, v110, v110 row_ror:2 row_mask:0xf bank_mask:0xf
    v_add_f32_dpp v111, v111, v111 row_ror:2 row_mask:0xf bank_mask:0xf
    v_add_f32_dpp v112, v112, v112 row_ror:2 row_mask:0xf bank_mask:0xf

    s_nop 0
    v_max_u32_dpp v110, v110, v110 row_ror:4 row_mask:0xf bank_mask:0xf
    v_add_f32_dpp v111, v111, v111 row_ror:4 row_mask:0xf bank_mask:0xf
    v_add_f32_dpp v112, v112, v112 row_ror:4 row_mask:0xf bank_mask:0xf

    s_nop 0
    v_max_u32_dpp v110, v110, v110 row_ror:8 row_mask:0xf bank_mask:0xf
    v_add_f32_dpp v111, v111, v111 row_ror:8 row_mask:0xf bank_mask:0xf
    v_add_f32_dpp v112, v112, v112 row_ror:8 row_mask:0xf bank_mask:0xf

    v_rsq_f32 v112, v112
    v_readfirstlane_b32 s32, v110
    v_mul_f32 v112, 0x47decb04, v112
    v_readfirstlane_b32 s33, v111
    v_readfirstlane_b32 s34, v112

    ds_read_b64 v[94:95], v2
    s_waitcnt lgkmcnt(0)
    v_add_u32 v97, v94, v95
    s_nop 1
    v_add_u32_dpp v97, v97, v97 row_shr:1 row_mask:0xf bank_mask:0xf
    s_nop 1
    v_add_u32_dpp v97, v97, v97 row_shr:2 row_mask:0xf bank_mask:0xf
    s_nop 1
    v_add_u32_dpp v97, v97, v97 row_shr:4 row_mask:0xf bank_mask:0xf
    s_nop 1
    v_add_u32_dpp v97, v97, v97 row_shr:8 row_mask:0xf bank_mask:0xf
    s_nop 1
    v_add_u32_dpp v97, v97, v97 row_bcast:15 row_mask:0xa bank_mask:0xf
    s_nop 1
    v_add_u32_dpp v97, v97, v97 row_bcast:31 row_mask:0xc bank_mask:0xf
    s_mov_b32 exec_lo, 0
    s_brev_b32 exec_hi, 1
    ds_add_rtn_u32 v96, v108, v97
    s_mov_b64 exec, -1

    v_add_u32 v92, v94, v94
    v_add_u32 v93, v95, v95
    v_med3_u32 v92, v94, 2, v92
    v_med3_u32 v93, v95, 2, v93
    v_lshl_or_b32 v92, v93, 16, v92
    v_lshlrev_b32 v93, 2, v0
    buffer_atomic_add v92, v93, s[20:23], 0 offen sc0
    s_waitcnt lgkmcnt(0)
    v_readlane_b32 s77, v96, 63
    v_sub_u32 v97, v97, v95
    s_sub_u32 s50, s50, s83
    s_sub_u32 s77, s77, s50
    v_add_u32 v97, s77, v97
    v_sub_u32 v96, v97, v94
    v_lshlrev_b32 v111, 3, v97
    v_lshlrev_b32 v110, 3, v96
    v_mov_b32 v112, 0
    v_mov_b32 v113, 0
    ds_write_b64 v2, v[110:111] offset:8192
    ds_write_b64 v2, v[112:113]
    v_mad_i32_i24 v96, v96, -5, v102
    v_mad_i32_i24 v97, v97, -5, v103
    s_add_u32 s50, s50, s84
    s_mov_b32 s28, s82
    s_mov_b32 s29, s83
    s_mov_b32 s30, s84
    s_lshl_b32 s74, s29, 3
    s_lshl_b32 s75, s30, 3
    v_mov_b32 v125, s74
    v_mov_b32 v126, s75
    v_mov_b32 v127, -1

    s_waitcnt lgkmcnt(0)
    s_barrier

    s_mov_b64 exec, 1
    ds_write_b32 v125, v127 offset:24588
    ds_write_b32 v126, v127 offset:24596
    s_mov_b64 exec, -1

    s_bitcmp0_b32 s28, 0
    s_cbranch_scc1 L_skz_20
    v_lshrrev_b32 v110, 16, v45
    ds_read_b32 v110, v110 offset:8192
    v_lshrrev_b32 v111, 16, v47
    ds_read_b32 v111, v111 offset:8192
    v_lshrrev_b32 v112, 16, v49
    ds_read_b32 v112, v112 offset:8192
    v_lshrrev_b32 v113, 16, v51
    ds_read_b32 v113, v113 offset:8192
    s_waitcnt lgkmcnt(3)
    v_lshl_add_u32 v110, v76, 3, v110
    ds_write_b64 v110, v[44:45] offset:24592

    s_waitcnt lgkmcnt(3)
    v_lshl_add_u32 v111, v77, 3, v111
    ds_write_b64 v111, v[46:47] offset:24592

    s_waitcnt lgkmcnt(3)
    v_lshl_add_u32 v112, v78, 3, v112
    ds_write_b64 v112, v[48:49] offset:24592

    s_waitcnt lgkmcnt(3)
    v_lshl_add_u32 v113, v79, 3, v113
    ds_write_b64 v113, v[50:51] offset:24592

L_skz_20:
    s_bitcmp0_b32 s28, 1
    s_cbranch_scc1 L_skz_21
    v_lshrrev_b32 v110, 16, v53
    ds_read_b32 v110, v110 offset:8192
    v_lshrrev_b32 v111, 16, v55
    ds_read_b32 v111, v111 offset:8192
    v_lshrrev_b32 v112, 16, v57
    ds_read_b32 v112, v112 offset:8192
    v_lshrrev_b32 v113, 16, v59
    ds_read_b32 v113, v113 offset:8192
    s_waitcnt lgkmcnt(3)
    v_lshl_add_u32 v110, v80, 3, v110
    ds_write_b64 v110, v[52:53] offset:24592

    s_waitcnt lgkmcnt(3)
    v_lshl_add_u32 v111, v81, 3, v111
    ds_write_b64 v111, v[54:55] offset:24592

    s_waitcnt lgkmcnt(3)
    v_lshl_add_u32 v112, v82, 3, v112
    ds_write_b64 v112, v[56:57] offset:24592

    s_waitcnt lgkmcnt(3)
    v_lshl_add_u32 v113, v83, 3, v113
    ds_write_b64 v113, v[58:59] offset:24592

L_skz_21:
    s_bitcmp0_b32 s28, 2
    s_cbranch_scc1 L_skz_22
    v_lshrrev_b32 v110, 16, v61
    ds_read_b32 v110, v110 offset:8192
    v_lshrrev_b32 v111, 16, v63
    ds_read_b32 v111, v111 offset:8192
    v_lshrrev_b32 v112, 16, v65
    ds_read_b32 v112, v112 offset:8192
    v_lshrrev_b32 v113, 16, v67
    ds_read_b32 v113, v113 offset:8192
    s_waitcnt lgkmcnt(3)
    v_lshl_add_u32 v110, v84, 3, v110
    ds_write_b64 v110, v[60:61] offset:24592

    s_waitcnt lgkmcnt(3)
    v_lshl_add_u32 v111, v85, 3, v111
    ds_write_b64 v111, v[62:63] offset:24592

    s_waitcnt lgkmcnt(3)
    v_lshl_add_u32 v112, v86, 3, v112
    ds_write_b64 v112, v[64:65] offset:24592

    s_waitcnt lgkmcnt(3)
    v_lshl_add_u32 v113, v87, 3, v113
    ds_write_b64 v113, v[66:67] offset:24592

L_skz_22:
    s_bitcmp0_b32 s28, 3
    s_cbranch_scc1 L_skz_23
    s_mov_b64 exec, s[66:67]
    v_lshrrev_b32 v110, 16, v69
    ds_read_b32 v110, v110 offset:8192
    v_lshrrev_b32 v111, 16, v71
    ds_read_b32 v111, v111 offset:8192
    v_lshrrev_b32 v112, 16, v73
    ds_read_b32 v112, v112 offset:8192
    v_lshrrev_b32 v113, 16, v75
    ds_read_b32 v113, v113 offset:8192
    s_waitcnt lgkmcnt(3)
    v_lshl_add_u32 v110, v88, 3, v110
    ds_write_b64 v110, v[68:69] offset:24592

    s_waitcnt lgkmcnt(3)
    v_lshl_add_u32 v111, v89, 3, v111
    ds_write_b64 v111, v[70:71] offset:24592

    s_waitcnt lgkmcnt(3)
    v_lshl_add_u32 v112, v90, 3, v112
    ds_write_b64 v112, v[72:73] offset:24592

    s_waitcnt lgkmcnt(3)
    v_lshl_add_u32 v113, v91, 3, v113
    ds_write_b64 v113, v[74:75] offset:24592

    s_mov_b64 exec, -1
L_skz_23:
    v_mov_b32 v110, s32
    v_mov_b32 v111, s33
    v_mov_b32 v112, s34
    v_mov_b32 v113, 0
    v_mov_b32 v115, 0x4b400000

    s_add_u32 s92, s6, 135168
    s_addc_u32 s93, s7, 0
    s_mov_b32 s94, 4096
    s_mov_b32 s95, 0x20000
    s_lshl_b32 s3, s2, 4
    buffer_store_dwordx4 v[110:113], v98, s[92:95], s3 offen
    v_lshlrev_b32 v107, 16, v116
    v_and_b32 v116, 0xffff0000, v116
    v_fma_f32 v107, v107, s34, v115
    v_fma_f32 v116, v116, s34, v115
    v_perm_b32 v116, v116, v107, s55

    v_lshlrev_b32 v107, 16, v117
    v_and_b32 v117, 0xffff0000, v117
    v_fma_f32 v107, v107, s34, v115
    v_fma_f32 v117, v117, s34, v115
    v_perm_b32 v117, v117, v107, s55

    v_lshlrev_b32 v107, 16, v118
    v_and_b32 v118, 0xffff0000, v118
    v_fma_f32 v107, v107, s34, v115
    v_fma_f32 v118, v118, s34, v115
    v_perm_b32 v118, v118, v107, s55

    v_lshlrev_b32 v107, 16, v119
    v_and_b32 v119, 0xffff0000, v119
    v_fma_f32 v107, v107, s34, v115
    v_fma_f32 v119, v119, s34, v115
    v_perm_b32 v119, v119, v107, s55

    v_lshlrev_b32 v107, 16, v120
    v_and_b32 v120, 0xffff0000, v120
    v_fma_f32 v107, v107, s34, v115
    v_fma_f32 v120, v120, s34, v115
    v_perm_b32 v120, v120, v107, s55

    v_lshlrev_b32 v107, 16, v121
    v_and_b32 v121, 0xffff0000, v121
    v_fma_f32 v107, v107, s34, v115
    v_fma_f32 v121, v121, s34, v115
    v_perm_b32 v121, v121, v107, s55

    v_lshlrev_b32 v107, 16, v122
    v_and_b32 v122, 0xffff0000, v122
    v_fma_f32 v107, v107, s34, v115
    v_fma_f32 v122, v122, s34, v115
    v_perm_b32 v122, v122, v107, s55

    v_lshlrev_b32 v107, 16, v123
    v_and_b32 v123, 0xffff0000, v123
    v_fma_f32 v107, v107, s34, v115
    v_fma_f32 v123, v123, s34, v115
    v_perm_b32 v123, v123, v107, s55

    v_lshlrev_b32 v107, 16, v124
    v_and_b32 v124, 0xffff0000, v124
    v_fma_f32 v107, v107, s34, v115
    v_fma_f32 v124, v124, s34, v115
    v_perm_b32 v124, v124, v107, s55

    s_add_u32 s92, s6, s54
    s_addc_u32 s93, s7, 0
    s_mov_b32 s94, 24576
    s_mov_b32 s95, 0x20000
    s_movk_i32 s3, 16384
    buffer_store_dwordx4 v[116:119], v1, s[92:95], 0 offen
    buffer_store_dwordx4 v[120:123], v1, s[92:95], s3 offen
    s_mul_i32 s94, s53, 25424
    s_movk_i32 s3, 24576
    v_lshlrev_b32 v107, 2, v0

    buffer_store_dword v124, v107, s[92:95], s3 offen
    s_nop 1
    s_cmp_eq_u32 s49, 0
    s_cbranch_scc1 L_p1epi_7
L_p1loop_6:
    s_mov_b32 s82, s85
    s_mov_b32 s83, s86
    s_mov_b32 s84, s87
    v_mov_b32 v99, 1
    buffer_atomic_add v99, v98, s[96:99], 0 offen sc0
    s_bitcmp0_b32 s82, 0
    s_cbranch_scc1 L_ska_24
    s_waitcnt vmcnt(11)
    v_mul_hi_u32_u24 v45, s40, v20
    v_mul_hi_u32_u24 v44, s40, v4
    v_mul_hi_u32_u24 v47, s40, v21
    v_mul_hi_u32_u24 v46, s40, v5
    v_mul_hi_u32_u24 v49, s40, v22
    v_mul_hi_u32_u24 v48, s40, v6
    v_mul_hi_u32_u24 v51, s40, v23
    v_mul_hi_u32_u24 v50, s40, v7
    v_and_b32 v45, -2, v45
    v_mad_u32_u24 v4, v44, s43, v4
    v_and_b32 v76, -4, v44
    v_and_b32 v47, -2, v47
    v_mad_u32_u24 v5, v46, s43, v5
    v_and_b32 v77, -4, v46
    v_and_b32 v49, -2, v49
    v_mad_u32_u24 v6, v48, s43, v6
    v_and_b32 v78, -4, v48
    v_and_b32 v51, -2, v51
    v_mad_u32_u24 v7, v50, s43, v7
    v_and_b32 v79, -4, v50
    v_mad_i32_i24 v20, v45, s42, v20
    v_lshl_add_u32 v45, v45, 6, v76
    v_mad_i32_i24 v21, v47, s42, v21
    v_lshl_add_u32 v47, v47, 6, v77
    v_mad_i32_i24 v22, v49, s42, v22
    v_lshl_add_u32 v49, v49, 6, v78
    v_mad_i32_i24 v23, v51, s42, v23
    v_lshl_add_u32 v51, v51, 6, v79
    ds_add_rtn_u32 v76, v45, v104
    ds_add_rtn_u32 v77, v47, v104
    ds_add_rtn_u32 v78, v49, v104
    ds_add_rtn_u32 v79, v51, v104
    v_lshlrev_b32 v110, 16, v36
    v_and_b32 v111, 0xffff0000, v36
    v_lshlrev_b32 v112, 16, v37
    v_and_b32 v113, 0xffff0000, v37
    v_mul_f32 v110, s44, v110
    v_mul_f32 v111, s44, v111
    v_mul_f32 v112, s44, v112
    v_mul_f32 v113, s44, v113
    v_fract_f32 v110, v110
    v_fract_f32 v111, v111
    v_fract_f32 v112, v112
    v_fract_f32 v113, v113
    v_cos_f32 v110, v110
    v_cos_f32 v111, v111
    v_cos_f32 v112, v112
    v_cos_f32 v113, v113
    v_lshl_or_b32 v44, v44, 14, v20
    v_perm_b32 v45, v45, v4, s46
    v_bfe_u32 v4, v4, 8, 5

    v_lshl_or_b32 v46, v46, 14, v21
    v_perm_b32 v47, v47, v5, s46
    v_bfe_u32 v5, v5, 8, 5

    v_lshl_or_b32 v48, v48, 14, v22
    v_perm_b32 v49, v49, v6, s46
    v_bfe_u32 v6, v6, 8, 5

    v_lshl_or_b32 v50, v50, 14, v23
    v_perm_b32 v51, v51, v7, s46
    v_bfe_u32 v7, v7, 8, 5

    v_fmaak_f32 v110, v110, v105, 0x4b400010
    v_fmaak_f32 v111, v111, v105, 0x4b400010
    v_fmaak_f32 v112, v112, v105, 0x4b400010
    v_fmaak_f32 v113, v113, v105, 0x4b400010
    v_sub_u32 v110, v110, v4
    v_sub_u32 v111, v111, v5
    v_sub_u32 v112, v112, v6
    v_sub_u32 v113, v113, v7
    v_bfi_b32 v110, 31, v4, v110
    v_bfi_b32 v111, 31, v5, v111
    v_bfi_b32 v112, 31, v6, v112
    v_bfi_b32 v113, 31, v7, v113
    v_perm_b32 v44, v44, v110, s55
    v_perm_b32 v46, v46, v111, s55
    v_perm_b32 v48, v48, v112, s55
    v_perm_b32 v50, v50, v113, s55
L_ska_24:
    s_bitcmp0_b32 s82, 1
    s_cbranch_scc1 L_ska_25
    s_waitcnt vmcnt(8)
    v_mul_hi_u32_u24 v53, s40, v24
    v_mul_hi_u32_u24 v52, s40, v8
    v_mul_hi_u32_u24 v55, s40, v25
    v_mul_hi_u32_u24 v54, s40, v9
    v_mul_hi_u32_u24 v57, s40, v26
    v_mul_hi_u32_u24 v56, s40, v10
    v_mul_hi_u32_u24 v59, s40, v27
    v_mul_hi_u32_u24 v58, s40, v11
    v_and_b32 v53, -2, v53
    v_mad_u32_u24 v8, v52, s43, v8
    v_and_b32 v80, -4, v52
    v_and_b32 v55, -2, v55
    v_mad_u32_u24 v9, v54, s43, v9
    v_and_b32 v81, -4, v54
    v_and_b32 v57, -2, v57
    v_mad_u32_u24 v10, v56, s43, v10
    v_and_b32 v82, -4, v56
    v_and_b32 v59, -2, v59
    v_mad_u32_u24 v11, v58, s43, v11
    v_and_b32 v83, -4, v58
    v_mad_i32_i24 v24, v53, s42, v24
    v_lshl_add_u32 v53, v53, 6, v80
    v_mad_i32_i24 v25, v55, s42, v25
    v_lshl_add_u32 v55, v55, 6, v81
    v_mad_i32_i24 v26, v57, s42, v26
    v_lshl_add_u32 v57, v57, 6, v82
    v_mad_i32_i24 v27, v59, s42, v27
    v_lshl_add_u32 v59, v59, 6, v83
    ds_add_rtn_u32 v80, v53, v104
    ds_add_rtn_u32 v81, v55, v104
    ds_add_rtn_u32 v82, v57, v104
    ds_add_rtn_u32 v83, v59, v104
    v_lshlrev_b32 v110, 16, v38
    v_and_b32 v111, 0xffff0000, v38
    v_lshlrev_b32 v112, 16, v39
    v_and_b32 v113, 0xffff0000, v39
    v_mul_f32 v110, s44, v110
    v_mul_f32 v111, s44, v111
    v_mul_f32 v112, s44, v112
    v_mul_f32 v113, s44, v113
    v_fract_f32 v110, v110
    v_fract_f32 v111, v111
    v_fract_f32 v112, v112
    v_fract_f32 v113, v113
    v_cos_f32 v110, v110
    v_cos_f32 v111, v111
    v_cos_f32 v112, v112
    v_cos_f32 v113, v113
    v_lshl_or_b32 v52, v52, 14, v24
    v_perm_b32 v53, v53, v8, s46
    v_bfe_u32 v8, v8, 8, 5

    v_lshl_or_b32 v54, v54, 14, v25
    v_perm_b32 v55, v55, v9, s46
    v_bfe_u32 v9, v9, 8, 5

    v_lshl_or_b32 v56, v56, 14, v26
    v_perm_b32 v57, v57, v10, s46
    v_bfe_u32 v10, v10, 8, 5

    v_lshl_or_b32 v58, v58, 14, v27
    v_perm_b32 v59, v59, v11, s46
    v_bfe_u32 v11, v11, 8, 5

    v_fmaak_f32 v110, v110, v105, 0x4b400010
    v_fmaak_f32 v111, v111, v105, 0x4b400010
    v_fmaak_f32 v112, v112, v105, 0x4b400010
    v_fmaak_f32 v113, v113, v105, 0x4b400010
    v_sub_u32 v110, v110, v8
    v_sub_u32 v111, v111, v9
    v_sub_u32 v112, v112, v10
    v_sub_u32 v113, v113, v11
    v_bfi_b32 v110, 31, v8, v110
    v_bfi_b32 v111, 31, v9, v111
    v_bfi_b32 v112, 31, v10, v112
    v_bfi_b32 v113, 31, v11, v113
    v_perm_b32 v52, v52, v110, s55
    v_perm_b32 v54, v54, v111, s55
    v_perm_b32 v56, v56, v112, s55
    v_perm_b32 v58, v58, v113, s55
L_ska_25:
    s_bitcmp0_b32 s82, 2
    s_cbranch_scc1 L_ska_26
    s_waitcnt vmcnt(4)
    v_mul_hi_u32_u24 v61, s40, v28
    v_mul_hi_u32_u24 v60, s40, v12
    v_mul_hi_u32_u24 v63, s40, v29
    v_mul_hi_u32_u24 v62, s40, v13
    v_mul_hi_u32_u24 v65, s40, v30
    v_mul_hi_u32_u24 v64, s40, v14
    v_mul_hi_u32_u24 v67, s40, v31
    v_mul_hi_u32_u24 v66, s40, v15
    v_and_b32 v61, -2, v61
    v_mad_u32_u24 v12, v60, s43, v12
    v_and_b32 v84, -4, v60
    v_and_b32 v63, -2, v63
    v_mad_u32_u24 v13, v62, s43, v13
    v_and_b32 v85, -4, v62
    v_and_b32 v65, -2, v65
    v_mad_u32_u24 v14, v64, s43, v14
    v_and_b32 v86, -4, v64
    v_and_b32 v67, -2, v67
    v_mad_u32_u24 v15, v66, s43, v15
    v_and_b32 v87, -4, v66
    v_mad_i32_i24 v28, v61, s42, v28
    v_lshl_add_u32 v61, v61, 6, v84
    v_mad_i32_i24 v29, v63, s42, v29
    v_lshl_add_u32 v63, v63, 6, v85
    v_mad_i32_i24 v30, v65, s42, v30
    v_lshl_add_u32 v65, v65, 6, v86
    v_mad_i32_i24 v31, v67, s42, v31
    v_lshl_add_u32 v67, v67, 6, v87
    ds_add_rtn_u32 v84, v61, v104
    ds_add_rtn_u32 v85, v63, v104
    ds_add_rtn_u32 v86, v65, v104
    ds_add_rtn_u32 v87, v67, v104
    v_lshlrev_b32 v110, 16, v40
    v_and_b32 v111, 0xffff0000, v40
    v_lshlrev_b32 v112, 16, v41
    v_and_b32 v113, 0xffff0000, v41
    v_mul_f32 v110, s44, v110
    v_mul_f32 v111, s44, v111
    v_mul_f32 v112, s44, v112
    v_mul_f32 v113, s44, v113
    v_fract_f32 v110, v110
    v_fract_f32 v111, v111
    v_fract_f32 v112, v112
    v_fract_f32 v113, v113
    v_cos_f32 v110, v110
    v_cos_f32 v111, v111
    v_cos_f32 v112, v112
    v_cos_f32 v113, v113
    v_lshl_or_b32 v60, v60, 14, v28
    v_perm_b32 v61, v61, v12, s46
    v_bfe_u32 v12, v12, 8, 5

    v_lshl_or_b32 v62, v62, 14, v29
    v_perm_b32 v63, v63, v13, s46
    v_bfe_u32 v13, v13, 8, 5

    v_lshl_or_b32 v64, v64, 14, v30
    v_perm_b32 v65, v65, v14, s46
    v_bfe_u32 v14, v14, 8, 5

    v_lshl_or_b32 v66, v66, 14, v31
    v_perm_b32 v67, v67, v15, s46
    v_bfe_u32 v15, v15, 8, 5

    v_fmaak_f32 v110, v110, v105, 0x4b400010
    v_fmaak_f32 v111, v111, v105, 0x4b400010
    v_fmaak_f32 v112, v112, v105, 0x4b400010
    v_fmaak_f32 v113, v113, v105, 0x4b400010
    v_sub_u32 v110, v110, v12
    v_sub_u32 v111, v111, v13
    v_sub_u32 v112, v112, v14
    v_sub_u32 v113, v113, v15
    v_bfi_b32 v110, 31, v12, v110
    v_bfi_b32 v111, 31, v13, v111
    v_bfi_b32 v112, 31, v14, v112
    v_bfi_b32 v113, 31, v15, v113
    v_perm_b32 v60, v60, v110, s55
    v_perm_b32 v62, v62, v111, s55
    v_perm_b32 v64, v64, v112, s55
    v_perm_b32 v66, v66, v113, s55
L_ska_26:
    s_waitcnt vmcnt(1)
    s_waitcnt vmcnt(0)
    v_cmp_eq_u32 vcc, 0, v0
    s_mov_b64 exec, vcc
    ds_write_b32 v108, v99 offset:8
    s_mov_b64 exec, -1
    s_waitcnt vmcnt(5)
    v_lshrrev_b32 v93, 16, v92
    v_and_b32 v92, 0xffff, v92
    v_add_u32 v110, v92, v94
    v_mad_u32_u24 v92, v92, 5, v96
    v_add_u32 v111, v93, v95
    v_mad_u32_u24 v93, v93, 5, v97
    v_max_u32 v110, v110, v111
    v_cmp_le_u32 vcc, s48, v110
    s_cbranch_vccnz L_full_27
L_fback_28:
    ds_write_b64 v2, v[92:93] offset:16384

    s_waitcnt lgkmcnt(0)
    s_barrier
    ds_read_b32 v111, v108 offset:8
    s_waitcnt lgkmcnt(0)
    v_readfirstlane_b32 s41, v111
    s_nop 1

    s_add_u32 s41, s41, 416
    s_sub_u32 s78, s41, 2965
    s_lshr_b32 s79, s78, 1
    s_add_u32 s79, s79, 2965
    s_and_b32 s86, s78, 1
    s_lshl_b32 s86, s86, 1
    s_add_u32 s87, s86, 2
    s_cmp_lt_u32 s41, 2965
    s_cselect_b32 s41, s41, s79
    s_cmovk_i32 s86, 0
    s_cmovk_i32 s87, 4

    s_mul_i32 s78, s41, 16384
    s_add_u32 s49, s78, 16384
    s_cmp_ge_u32 s41, 3125
    s_cmovk_i32 s49, 0
    s_cmovk_i32 s78, 0
    s_lshl_b32 s10, s49, 2
    s_lshl_b32 s14, s49, 2
    s_lshl_b32 s18, s49, 1
    s_sub_u32 s79, s87, s86
    s_bfm_b32 s85, s79, s86
    s_lshl_b32 s86, s86, 12
    s_lshl_b32 s87, s87, 12
    s_min_u32 s87, s87, 16384

    s_add_u32 s79, s78, 0
    s_bitcmp1_b32 s85, 0
    s_cselect_b32 s79, s79, 0x1ff00000
    s_lshl_b32 s56, s79, 2
    s_lshl_b32 s61, s79, 1

    s_add_u32 s79, s78, 4096
    s_bitcmp1_b32 s85, 1
    s_cselect_b32 s79, s79, 0x1ff00000
    s_lshl_b32 s57, s79, 2
    s_lshl_b32 s62, s79, 1

    s_add_u32 s79, s78, 8192
    s_bitcmp1_b32 s85, 2
    s_cselect_b32 s79, s79, 0x1ff00000
    s_lshl_b32 s58, s79, 2
    s_lshl_b32 s63, s79, 1

    s_add_u32 s79, s78, 12288
    s_bitcmp1_b32 s85, 3
    s_cselect_b32 s79, s79, 0x1ff00000
    s_lshl_b32 s59, s79, 2
    s_lshl_b32 s64, s79, 1

    s_bitcmp0_b32 s28, 0
    s_cbranch_scc1 L_skw_29
    ds_read_b64 v[110:111], v2 offset:24592
    ds_read_b64 v[112:113], v2 offset:24600
    ds_read_b64 v[114:115], v2 offset:24584

    ds_read_b64 v[118:119], v2 offset:32784
    ds_read_b64 v[120:121], v2 offset:32792
    ds_read_b64 v[122:123], v2 offset:32776

    s_waitcnt lgkmcnt(3)
    v_lshrrev_b32 v116, 16, v111
    ds_read_b32 v116, v116 offset:16384

    s_waitcnt lgkmcnt(1)
    v_lshrrev_b32 v124, 16, v119
    ds_read_b32 v124, v124 offset:16384

    v_cmp_ne_u32_sdwa s[80:81], v111, v113 src0_sel:WORD_1 src1_sel:WORD_1
    v_cmp_ne_u32_sdwa vcc, v111, v115 src0_sel:WORD_1 src1_sel:WORD_1
    v_alignbyte_b32 v114, v111, v114, 1
    s_mov_b32 s54, -3
    v_perm_b32 v112, v112, v113, s45
    s_waitcnt lgkmcnt(1)
    v_add3_u32 v116, v116, v106, s54
    v_sub_u32 v117, 0, v116
    v_and_b32 v117, 3, v117
    s_mov_b64 exec, s[80:81]
    v_mov_b32 v117, 0
    v_mov_b32 v112, 0
    s_mov_b64 exec, vcc
    v_mov_b32 v117, 3

    s_mov_b64 exec, -1
    v_alignbyte_b32 v111, v112, v110, v117
    v_alignbyte_b32 v110, v110, v114, v117
    v_add_u32 v116, v116, v117

    buffer_store_dwordx2 v[110:111], v116, s[24:27], 0 offen
    v_cmp_ne_u32_sdwa s[80:81], v119, v121 src0_sel:WORD_1 src1_sel:WORD_1
    v_cmp_ne_u32_sdwa vcc, v119, v123 src0_sel:WORD_1 src1_sel:WORD_1
    v_alignbyte_b32 v122, v119, v122, 1
    s_mov_b32 s54, 5117
    v_perm_b32 v120, v120, v121, s45
    s_waitcnt lgkmcnt(0)
    v_add3_u32 v124, v124, v106, s54
    v_sub_u32 v125, 0, v124
    v_and_b32 v125, 3, v125
    s_mov_b64 exec, s[80:81]
    v_mov_b32 v125, 0
    v_mov_b32 v120, 0
    s_mov_b64 exec, vcc
    v_mov_b32 v125, 3

    s_mov_b64 exec, -1
    v_alignbyte_b32 v119, v120, v118, v125
    v_alignbyte_b32 v118, v118, v122, v125
    v_add_u32 v124, v124, v125

    buffer_store_dwordx2 v[118:119], v124, s[24:27], 0 offen
L_skw_29:
    s_bitcmp0_b32 s28, 0
    s_cbranch_scc1 L_skw_30
    ds_read_b64 v[110:111], v2 offset:40976
    ds_read_b64 v[112:113], v2 offset:40984
    ds_read_b64 v[114:115], v2 offset:40968

    ds_read_b64 v[118:119], v2 offset:49168
    ds_read_b64 v[120:121], v2 offset:49176
    ds_read_b64 v[122:123], v2 offset:49160

    s_waitcnt lgkmcnt(3)
    v_lshrrev_b32 v116, 16, v111
    ds_read_b32 v116, v116 offset:16384

    s_waitcnt lgkmcnt(1)
    v_lshrrev_b32 v124, 16, v119
    ds_read_b32 v124, v124 offset:16384

    v_cmp_ne_u32_sdwa s[80:81], v111, v113 src0_sel:WORD_1 src1_sel:WORD_1
    v_cmp_ne_u32_sdwa vcc, v111, v115 src0_sel:WORD_1 src1_sel:WORD_1
    v_alignbyte_b32 v114, v111, v114, 1
    s_mov_b32 s54, 10237
    v_perm_b32 v112, v112, v113, s45
    s_waitcnt lgkmcnt(1)
    v_add3_u32 v116, v116, v106, s54
    v_sub_u32 v117, 0, v116
    v_and_b32 v117, 3, v117
    s_mov_b64 exec, s[80:81]
    v_mov_b32 v117, 0
    v_mov_b32 v112, 0
    s_mov_b64 exec, vcc
    v_mov_b32 v117, 3

    s_mov_b64 exec, -1
    v_alignbyte_b32 v111, v112, v110, v117
    v_alignbyte_b32 v110, v110, v114, v117
    v_add_u32 v116, v116, v117

    buffer_store_dwordx2 v[110:111], v116, s[24:27], 0 offen
    v_cmp_ne_u32_sdwa s[80:81], v119, v121 src0_sel:WORD_1 src1_sel:WORD_1
    v_cmp_ne_u32_sdwa vcc, v119, v123 src0_sel:WORD_1 src1_sel:WORD_1
    v_alignbyte_b32 v122, v119, v122, 1
    s_mov_b32 s54, 15357
    v_perm_b32 v120, v120, v121, s45
    s_waitcnt lgkmcnt(0)
    v_add3_u32 v124, v124, v106, s54
    v_sub_u32 v125, 0, v124
    v_and_b32 v125, 3, v125
    s_mov_b64 exec, s[80:81]
    v_mov_b32 v125, 0
    v_mov_b32 v120, 0
    s_mov_b64 exec, vcc
    v_mov_b32 v125, 3

    s_mov_b64 exec, -1
    v_alignbyte_b32 v119, v120, v118, v125
    v_alignbyte_b32 v118, v118, v122, v125
    v_add_u32 v124, v124, v125

    buffer_store_dwordx2 v[118:119], v124, s[24:27], 0 offen
L_skw_30:
    s_bitcmp0_b32 s28, 1
    s_cbranch_scc1 L_skw_31
    v_add_u32 v107, 32768, v2
    ds_read_b64 v[110:111], v107 offset:24592
    ds_read_b64 v[112:113], v107 offset:24600
    ds_read_b64 v[114:115], v107 offset:24584

    ds_read_b64 v[118:119], v107 offset:32784
    ds_read_b64 v[120:121], v107 offset:32792
    ds_read_b64 v[122:123], v107 offset:32776

    s_waitcnt lgkmcnt(3)
    v_lshrrev_b32 v116, 16, v111
    ds_read_b32 v116, v116 offset:16384

    s_waitcnt lgkmcnt(1)
    v_lshrrev_b32 v124, 16, v119
    ds_read_b32 v124, v124 offset:16384

    v_cmp_ne_u32_sdwa s[80:81], v111, v113 src0_sel:WORD_1 src1_sel:WORD_1
    v_cmp_ne_u32_sdwa vcc, v111, v115 src0_sel:WORD_1 src1_sel:WORD_1
    v_alignbyte_b32 v114, v111, v114, 1
    s_mov_b32 s54, 20477
    v_perm_b32 v112, v112, v113, s45
    s_waitcnt lgkmcnt(1)
    v_add3_u32 v116, v116, v106, s54
    v_sub_u32 v117, 0, v116
    v_and_b32 v117, 3, v117
    s_mov_b64 exec, s[80:81]
    v_mov_b32 v117, 0
    v_mov_b32 v112, 0
    s_mov_b64 exec, vcc
    v_mov_b32 v117, 3

    s_mov_b64 exec, -1
    v_alignbyte_b32 v111, v112, v110, v117
    v_alignbyte_b32 v110, v110, v114, v117
    v_add_u32 v116, v116, v117

    buffer_store_dwordx2 v[110:111], v116, s[24:27], 0 offen
    v_cmp_ne_u32_sdwa s[80:81], v119, v121 src0_sel:WORD_1 src1_sel:WORD_1
    v_cmp_ne_u32_sdwa vcc, v119, v123 src0_sel:WORD_1 src1_sel:WORD_1
    v_alignbyte_b32 v122, v119, v122, 1
    s_mov_b32 s54, 25597
    v_perm_b32 v120, v120, v121, s45
    s_waitcnt lgkmcnt(0)
    v_add3_u32 v124, v124, v106, s54
    v_sub_u32 v125, 0, v124
    v_and_b32 v125, 3, v125
    s_mov_b64 exec, s[80:81]
    v_mov_b32 v125, 0
    v_mov_b32 v120, 0
    s_mov_b64 exec, vcc
    v_mov_b32 v125, 3

    s_mov_b64 exec, -1
    v_alignbyte_b32 v119, v120, v118, v125
    v_alignbyte_b32 v118, v118, v122, v125
    v_add_u32 v124, v124, v125

    buffer_store_dwordx2 v[118:119], v124, s[24:27], 0 offen
L_skw_31:
    s_bitcmp0_b32 s28, 1
    s_cbranch_scc1 L_skw_32
    v_add_u32 v107, 32768, v2
    ds_read_b64 v[110:111], v107 offset:40976
    ds_read_b64 v[112:113], v107 offset:40984
    ds_read_b64 v[114:115], v107 offset:40968

    ds_read_b64 v[118:119], v107 offset:49168
    ds_read_b64 v[120:121], v107 offset:49176
    ds_read_b64 v[122:123], v107 offset:49160

    s_waitcnt lgkmcnt(3)
    v_lshrrev_b32 v116, 16, v111
    ds_read_b32 v116, v116 offset:16384

    s_waitcnt lgkmcnt(1)
    v_lshrrev_b32 v124, 16, v119
    ds_read_b32 v124, v124 offset:16384

    v_cmp_ne_u32_sdwa s[80:81], v111, v113 src0_sel:WORD_1 src1_sel:WORD_1
    v_cmp_ne_u32_sdwa vcc, v111, v115 src0_sel:WORD_1 src1_sel:WORD_1
    v_alignbyte_b32 v114, v111, v114, 1
    s_mov_b32 s54, 30717
    v_perm_b32 v112, v112, v113, s45
    s_waitcnt lgkmcnt(1)
    v_add3_u32 v116, v116, v106, s54
    v_sub_u32 v117, 0, v116
    v_and_b32 v117, 3, v117
    s_mov_b64 exec, s[80:81]
    v_mov_b32 v117, 0
    v_mov_b32 v112, 0
    s_mov_b64 exec, vcc
    v_mov_b32 v117, 3

    s_mov_b64 exec, -1
    v_alignbyte_b32 v111, v112, v110, v117
    v_alignbyte_b32 v110, v110, v114, v117
    v_add_u32 v116, v116, v117

    buffer_store_dwordx2 v[110:111], v116, s[24:27], 0 offen
    v_cmp_ne_u32_sdwa s[80:81], v119, v121 src0_sel:WORD_1 src1_sel:WORD_1
    v_cmp_ne_u32_sdwa vcc, v119, v123 src0_sel:WORD_1 src1_sel:WORD_1
    v_alignbyte_b32 v122, v119, v122, 1
    s_mov_b32 s54, 35837
    v_perm_b32 v120, v120, v121, s45
    s_waitcnt lgkmcnt(0)
    v_add3_u32 v124, v124, v106, s54
    v_sub_u32 v125, 0, v124
    v_and_b32 v125, 3, v125
    s_mov_b64 exec, s[80:81]
    v_mov_b32 v125, 0
    v_mov_b32 v120, 0
    s_mov_b64 exec, vcc
    v_mov_b32 v125, 3

    s_mov_b64 exec, -1
    v_alignbyte_b32 v119, v120, v118, v125
    v_alignbyte_b32 v118, v118, v122, v125
    v_add_u32 v124, v124, v125

    buffer_store_dwordx2 v[118:119], v124, s[24:27], 0 offen
L_skw_32:
    s_bitcmp0_b32 s82, 3
    s_cbranch_scc1 L_ska_33
    s_mov_b64 exec, s[66:67]
    v_mul_hi_u32_u24 v69, s40, v32
    v_mul_hi_u32_u24 v68, s40, v16
    v_mul_hi_u32_u24 v71, s40, v33
    v_mul_hi_u32_u24 v70, s40, v17
    v_mul_hi_u32_u24 v73, s40, v34
    v_mul_hi_u32_u24 v72, s40, v18
    v_mul_hi_u32_u24 v75, s40, v35
    v_mul_hi_u32_u24 v74, s40, v19
    v_and_b32 v69, -2, v69
    v_mad_u32_u24 v16, v68, s43, v16
    v_and_b32 v88, -4, v68
    v_and_b32 v71, -2, v71
    v_mad_u32_u24 v17, v70, s43, v17
    v_and_b32 v89, -4, v70
    v_and_b32 v73, -2, v73
    v_mad_u32_u24 v18, v72, s43, v18
    v_and_b32 v90, -4, v72
    v_and_b32 v75, -2, v75
    v_mad_u32_u24 v19, v74, s43, v19
    v_and_b32 v91, -4, v74
    v_mad_i32_i24 v32, v69, s42, v32
    v_lshl_add_u32 v69, v69, 6, v88
    v_mad_i32_i24 v33, v71, s42, v33
    v_lshl_add_u32 v71, v71, 6, v89
    v_mad_i32_i24 v34, v73, s42, v34
    v_lshl_add_u32 v73, v73, 6, v90
    v_mad_i32_i24 v35, v75, s42, v35
    v_lshl_add_u32 v75, v75, 6, v91
    ds_add_rtn_u32 v88, v69, v104
    ds_add_rtn_u32 v89, v71, v104
    ds_add_rtn_u32 v90, v73, v104
    ds_add_rtn_u32 v91, v75, v104
    v_lshlrev_b32 v110, 16, v42
    v_and_b32 v111, 0xffff0000, v42
    v_lshlrev_b32 v112, 16, v43
    v_and_b32 v113, 0xffff0000, v43
    v_mul_f32 v110, s44, v110
    v_mul_f32 v111, s44, v111
    v_mul_f32 v112, s44, v112
    v_mul_f32 v113, s44, v113
    v_fract_f32 v110, v110
    v_fract_f32 v111, v111
    v_fract_f32 v112, v112
    v_fract_f32 v113, v113
    v_cos_f32 v110, v110
    v_cos_f32 v111, v111
    v_cos_f32 v112, v112
    v_cos_f32 v113, v113
    v_lshl_or_b32 v68, v68, 14, v32
    v_perm_b32 v69, v69, v16, s46
    v_bfe_u32 v16, v16, 8, 5

    v_lshl_or_b32 v70, v70, 14, v33
    v_perm_b32 v71, v71, v17, s46
    v_bfe_u32 v17, v17, 8, 5

    v_lshl_or_b32 v72, v72, 14, v34
    v_perm_b32 v73, v73, v18, s46
    v_bfe_u32 v18, v18, 8, 5

    v_lshl_or_b32 v74, v74, 14, v35
    v_perm_b32 v75, v75, v19, s46
    v_bfe_u32 v19, v19, 8, 5

    v_fmaak_f32 v110, v110, v105, 0x4b400010
    v_fmaak_f32 v111, v111, v105, 0x4b400010
    v_fmaak_f32 v112, v112, v105, 0x4b400010
    v_fmaak_f32 v113, v113, v105, 0x4b400010
    v_sub_u32 v110, v110, v16
    v_sub_u32 v111, v111, v17
    v_sub_u32 v112, v112, v18
    v_sub_u32 v113, v113, v19
    v_bfi_b32 v110, 31, v16, v110
    v_bfi_b32 v111, 31, v17, v111
    v_bfi_b32 v112, 31, v18, v112
    v_bfi_b32 v113, 31, v19, v113
    v_perm_b32 v68, v68, v110, s55
    v_perm_b32 v70, v70, v111, s55
    v_perm_b32 v72, v72, v112, s55
    v_perm_b32 v74, v74, v113, s55
    s_mov_b64 exec, -1
L_ska_33:
    s_bitcmp0_b32 s28, 2
    s_cbranch_scc1 L_skw_34
    v_add_u32 v107, 65536, v2
    ds_read_b64 v[110:111], v107 offset:24592
    ds_read_b64 v[112:113], v107 offset:24600
    ds_read_b64 v[114:115], v107 offset:24584

    ds_read_b64 v[118:119], v107 offset:32784
    ds_read_b64 v[120:121], v107 offset:32792
    ds_read_b64 v[122:123], v107 offset:32776

    s_waitcnt lgkmcnt(3)
    v_lshrrev_b32 v116, 16, v111
    ds_read_b32 v116, v116 offset:16384

    s_waitcnt lgkmcnt(1)
    v_lshrrev_b32 v124, 16, v119
    ds_read_b32 v124, v124 offset:16384

    v_cmp_ne_u32_sdwa s[80:81], v111, v113 src0_sel:WORD_1 src1_sel:WORD_1
    v_cmp_ne_u32_sdwa vcc, v111, v115 src0_sel:WORD_1 src1_sel:WORD_1
    v_alignbyte_b32 v114, v111, v114, 1
    s_mov_b32 s54, 40957
    v_perm_b32 v112, v112, v113, s45
    s_waitcnt lgkmcnt(1)
    v_add3_u32 v116, v116, v106, s54
    v_sub_u32 v117, 0, v116
    v_and_b32 v117, 3, v117
    s_mov_b64 exec, s[80:81]
    v_mov_b32 v117, 0
    v_mov_b32 v112, 0
    s_mov_b64 exec, vcc
    v_mov_b32 v117, 3

    s_mov_b64 exec, -1
    v_alignbyte_b32 v111, v112, v110, v117
    v_alignbyte_b32 v110, v110, v114, v117
    v_add_u32 v116, v116, v117

    buffer_store_dwordx2 v[110:111], v116, s[24:27], 0 offen
    v_cmp_ne_u32_sdwa s[80:81], v119, v121 src0_sel:WORD_1 src1_sel:WORD_1
    v_cmp_ne_u32_sdwa vcc, v119, v123 src0_sel:WORD_1 src1_sel:WORD_1
    v_alignbyte_b32 v122, v119, v122, 1
    s_mov_b32 s54, 46077
    v_perm_b32 v120, v120, v121, s45
    s_waitcnt lgkmcnt(0)
    v_add3_u32 v124, v124, v106, s54
    v_sub_u32 v125, 0, v124
    v_and_b32 v125, 3, v125
    s_mov_b64 exec, s[80:81]
    v_mov_b32 v125, 0
    v_mov_b32 v120, 0
    s_mov_b64 exec, vcc
    v_mov_b32 v125, 3

    s_mov_b64 exec, -1
    v_alignbyte_b32 v119, v120, v118, v125
    v_alignbyte_b32 v118, v118, v122, v125
    v_add_u32 v124, v124, v125

    buffer_store_dwordx2 v[118:119], v124, s[24:27], 0 offen
L_skw_34:
    s_bitcmp0_b32 s28, 2
    s_cbranch_scc1 L_skw_35
    v_add_u32 v107, 65536, v2
    ds_read_b64 v[110:111], v107 offset:40976
    ds_read_b64 v[112:113], v107 offset:40984
    ds_read_b64 v[114:115], v107 offset:40968

    ds_read_b64 v[118:119], v107 offset:49168
    ds_read_b64 v[120:121], v107 offset:49176
    ds_read_b64 v[122:123], v107 offset:49160

    s_waitcnt lgkmcnt(3)
    v_lshrrev_b32 v116, 16, v111
    ds_read_b32 v116, v116 offset:16384

    s_waitcnt lgkmcnt(1)
    v_lshrrev_b32 v124, 16, v119
    ds_read_b32 v124, v124 offset:16384

    v_cmp_ne_u32_sdwa s[80:81], v111, v113 src0_sel:WORD_1 src1_sel:WORD_1
    v_cmp_ne_u32_sdwa vcc, v111, v115 src0_sel:WORD_1 src1_sel:WORD_1
    v_alignbyte_b32 v114, v111, v114, 1
    s_mov_b32 s54, 51197
    v_perm_b32 v112, v112, v113, s45
    s_waitcnt lgkmcnt(1)
    v_add3_u32 v116, v116, v106, s54
    v_sub_u32 v117, 0, v116
    v_and_b32 v117, 3, v117
    s_mov_b64 exec, s[80:81]
    v_mov_b32 v117, 0
    v_mov_b32 v112, 0
    s_mov_b64 exec, vcc
    v_mov_b32 v117, 3

    s_mov_b64 exec, -1
    v_alignbyte_b32 v111, v112, v110, v117
    v_alignbyte_b32 v110, v110, v114, v117
    v_add_u32 v116, v116, v117

    buffer_store_dwordx2 v[110:111], v116, s[24:27], 0 offen
    v_cmp_ne_u32_sdwa s[80:81], v119, v121 src0_sel:WORD_1 src1_sel:WORD_1
    v_cmp_ne_u32_sdwa vcc, v119, v123 src0_sel:WORD_1 src1_sel:WORD_1
    v_alignbyte_b32 v122, v119, v122, 1
    s_mov_b32 s54, 56317
    v_perm_b32 v120, v120, v121, s45
    s_waitcnt lgkmcnt(0)
    v_add3_u32 v124, v124, v106, s54
    v_sub_u32 v125, 0, v124
    v_and_b32 v125, 3, v125
    s_mov_b64 exec, s[80:81]
    v_mov_b32 v125, 0
    v_mov_b32 v120, 0
    s_mov_b64 exec, vcc
    v_mov_b32 v125, 3

    s_mov_b64 exec, -1
    v_alignbyte_b32 v119, v120, v118, v125
    v_alignbyte_b32 v118, v118, v122, v125
    v_add_u32 v124, v124, v125

    buffer_store_dwordx2 v[118:119], v124, s[24:27], 0 offen
L_skw_35:
    s_bitcmp0_b32 s28, 3
    s_cbranch_scc1 L_skw_36
    v_add_u32 v107, 98304, v2
    ds_read_b64 v[110:111], v107 offset:24592
    ds_read_b64 v[112:113], v107 offset:24600
    ds_read_b64 v[114:115], v107 offset:24584

    ds_read_b64 v[118:119], v107 offset:32784
    ds_read_b64 v[120:121], v107 offset:32792
    ds_read_b64 v[122:123], v107 offset:32776

    s_waitcnt lgkmcnt(3)
    v_lshrrev_b32 v116, 16, v111
    ds_read_b32 v116, v116 offset:16384

    s_waitcnt lgkmcnt(1)
    v_lshrrev_b32 v124, 16, v119
    ds_read_b32 v124, v124 offset:16384

    v_cmp_ne_u32_sdwa s[80:81], v111, v113 src0_sel:WORD_1 src1_sel:WORD_1
    v_cmp_ne_u32_sdwa vcc, v111, v115 src0_sel:WORD_1 src1_sel:WORD_1
    v_alignbyte_b32 v114, v111, v114, 1
    s_mov_b32 s54, 61437
    v_perm_b32 v112, v112, v113, s45
    s_waitcnt lgkmcnt(1)
    v_add3_u32 v116, v116, v106, s54
    v_sub_u32 v117, 0, v116
    v_and_b32 v117, 3, v117
    s_mov_b64 exec, s[80:81]
    v_mov_b32 v117, 0
    v_mov_b32 v112, 0
    s_mov_b64 exec, vcc
    v_mov_b32 v117, 3

    s_mov_b64 exec, -1
    v_alignbyte_b32 v111, v112, v110, v117
    v_alignbyte_b32 v110, v110, v114, v117
    v_add_u32 v116, v116, v117

    buffer_store_dwordx2 v[110:111], v116, s[24:27], 0 offen
    v_cmp_ne_u32_sdwa s[80:81], v119, v121 src0_sel:WORD_1 src1_sel:WORD_1
    v_cmp_ne_u32_sdwa vcc, v119, v123 src0_sel:WORD_1 src1_sel:WORD_1
    v_alignbyte_b32 v122, v119, v122, 1
    s_mov_b32 s54, 66557
    v_perm_b32 v120, v120, v121, s45
    s_waitcnt lgkmcnt(0)
    v_add3_u32 v124, v124, v106, s54
    v_sub_u32 v125, 0, v124
    v_and_b32 v125, 3, v125
    s_mov_b64 exec, s[80:81]
    v_mov_b32 v125, 0
    v_mov_b32 v120, 0
    s_mov_b64 exec, vcc
    v_mov_b32 v125, 3

    s_mov_b64 exec, -1
    v_alignbyte_b32 v119, v120, v118, v125
    v_alignbyte_b32 v118, v118, v122, v125
    v_add_u32 v124, v124, v125

    buffer_store_dwordx2 v[118:119], v124, s[24:27], 0 offen
L_skw_36:
    s_bitcmp0_b32 s28, 3
    s_cbranch_scc1 L_skw_37
    v_add_u32 v107, 98304, v2
    ds_read_b64 v[110:111], v107 offset:40976
    ds_read_b64 v[112:113], v107 offset:40984
    ds_read_b64 v[114:115], v107 offset:40968

    ds_read_b64 v[118:119], v107 offset:49168
    ds_read_b64 v[120:121], v107 offset:49176
    ds_read_b64 v[122:123], v107 offset:49160

    s_waitcnt lgkmcnt(3)
    v_lshrrev_b32 v116, 16, v111
    ds_read_b32 v116, v116 offset:16384

    s_waitcnt lgkmcnt(1)
    v_lshrrev_b32 v124, 16, v119
    ds_read_b32 v124, v124 offset:16384

    v_cmp_ne_u32_sdwa s[80:81], v111, v113 src0_sel:WORD_1 src1_sel:WORD_1
    v_cmp_ne_u32_sdwa vcc, v111, v115 src0_sel:WORD_1 src1_sel:WORD_1
    v_alignbyte_b32 v114, v111, v114, 1
    s_mov_b32 s54, 71677
    v_perm_b32 v112, v112, v113, s45
    s_waitcnt lgkmcnt(1)
    v_add3_u32 v116, v116, v106, s54
    v_sub_u32 v117, 0, v116
    v_and_b32 v117, 3, v117
    s_mov_b64 exec, s[80:81]
    v_mov_b32 v117, 0
    v_mov_b32 v112, 0
    s_mov_b64 exec, vcc
    v_mov_b32 v117, 3

    s_mov_b64 exec, -1
    v_alignbyte_b32 v111, v112, v110, v117
    v_alignbyte_b32 v110, v110, v114, v117
    v_add_u32 v116, v116, v117

    buffer_store_dwordx2 v[110:111], v116, s[24:27], 0 offen
    v_cmp_ne_u32_sdwa s[80:81], v119, v121 src0_sel:WORD_1 src1_sel:WORD_1
    v_cmp_ne_u32_sdwa vcc, v119, v123 src0_sel:WORD_1 src1_sel:WORD_1
    v_alignbyte_b32 v122, v119, v122, 1
    s_mov_b32 s54, 76797
    v_perm_b32 v120, v120, v121, s45
    s_waitcnt lgkmcnt(0)
    v_add3_u32 v124, v124, v106, s54
    v_sub_u32 v125, 0, v124
    v_and_b32 v125, 3, v125
    s_mov_b64 exec, s[80:81]
    v_mov_b32 v125, 0
    v_mov_b32 v120, 0
    s_mov_b64 exec, vcc
    v_mov_b32 v125, 3

    s_mov_b64 exec, -1
    v_alignbyte_b32 v119, v120, v118, v125
    v_alignbyte_b32 v118, v118, v122, v125
    v_add_u32 v124, v124, v125

    buffer_store_dwordx2 v[118:119], v124, s[24:27], 0 offen
L_skw_37:
    s_waitcnt lgkmcnt(0)
    s_barrier

    buffer_load_dwordx4 v[20:23], v1, s[12:15], s56 offen nt
    buffer_load_dwordx4 v[4:7], v1, s[8:11], s56 offen nt
    buffer_load_dwordx2 v[36:37], v2, s[16:19], s61 offen nt
    buffer_load_dwordx4 v[24:27], v1, s[12:15], s57 offen nt
    buffer_load_dwordx4 v[8:11], v1, s[8:11], s57 offen nt
    buffer_load_dwordx2 v[38:39], v2, s[16:19], s62 offen nt
    ds_read_b64 v[94:95], v2
    s_waitcnt lgkmcnt(0)
    v_add_u32 v97, v94, v95
    s_nop 1
    v_add_u32_dpp v97, v97, v97 row_shr:1 row_mask:0xf bank_mask:0xf
    s_nop 1
    v_add_u32_dpp v97, v97, v97 row_shr:2 row_mask:0xf bank_mask:0xf
    s_nop 1
    v_add_u32_dpp v97, v97, v97 row_shr:4 row_mask:0xf bank_mask:0xf
    s_nop 1
    v_add_u32_dpp v97, v97, v97 row_shr:8 row_mask:0xf bank_mask:0xf
    s_nop 1
    v_add_u32_dpp v97, v97, v97 row_bcast:15 row_mask:0xa bank_mask:0xf
    s_nop 1
    v_add_u32_dpp v97, v97, v97 row_bcast:31 row_mask:0xc bank_mask:0xf
    s_mov_b32 exec_lo, 0
    s_brev_b32 exec_hi, 1
    ds_add_rtn_u32 v96, v108, v97
    s_mov_b64 exec, -1

    v_add_u32 v92, v94, v94
    v_add_u32 v93, v95, v95
    v_med3_u32 v92, v94, 2, v92
    v_med3_u32 v93, v95, 2, v93
    v_lshl_or_b32 v92, v93, 16, v92
    v_lshlrev_b32 v93, 2, v0
    buffer_atomic_add v92, v93, s[20:23], 0 offen sc0
    s_waitcnt lgkmcnt(0)
    v_readlane_b32 s77, v96, 63
    v_sub_u32 v97, v97, v95
    s_sub_u32 s50, s50, s83
    s_sub_u32 s77, s77, s50
    v_add_u32 v97, s77, v97
    v_sub_u32 v96, v97, v94
    v_lshlrev_b32 v111, 3, v97
    v_lshlrev_b32 v110, 3, v96
    v_mov_b32 v112, 0
    v_mov_b32 v113, 0
    ds_write_b64 v2, v[110:111] offset:8192
    ds_write_b64 v2, v[112:113]
    v_mad_i32_i24 v96, v96, -5, v102
    v_mad_i32_i24 v97, v97, -5, v103
    s_add_u32 s50, s50, s84
    s_mov_b32 s28, s82
    s_mov_b32 s29, s83
    s_mov_b32 s30, s84
    s_lshl_b32 s74, s29, 3
    s_lshl_b32 s75, s30, 3
    v_mov_b32 v125, s74
    v_mov_b32 v126, s75
    v_mov_b32 v127, -1

    s_waitcnt lgkmcnt(0)
    s_barrier

    s_mov_b64 exec, 1
    ds_write_b32 v125, v127 offset:24588
    ds_write_b32 v126, v127 offset:24596
    s_mov_b64 exec, -1

    s_bitcmp0_b32 s28, 0
    s_cbranch_scc1 L_skz_38
    v_lshrrev_b32 v110, 16, v45
    ds_read_b32 v110, v110 offset:8192
    v_lshrrev_b32 v111, 16, v47
    ds_read_b32 v111, v111 offset:8192
    v_lshrrev_b32 v112, 16, v49
    ds_read_b32 v112, v112 offset:8192
    v_lshrrev_b32 v113, 16, v51
    ds_read_b32 v113, v113 offset:8192
    v_lshrrev_b32 v114, 16, v53
    ds_read_b32 v114, v114 offset:8192
    v_lshrrev_b32 v115, 16, v55
    ds_read_b32 v115, v115 offset:8192
    v_lshrrev_b32 v116, 16, v57
    ds_read_b32 v116, v116 offset:8192
    v_lshrrev_b32 v117, 16, v59
    ds_read_b32 v117, v117 offset:8192
    s_waitcnt lgkmcnt(7)
    v_lshl_add_u32 v110, v76, 3, v110
    ds_write_b64 v110, v[44:45] offset:24592

    s_waitcnt lgkmcnt(7)
    v_lshl_add_u32 v111, v77, 3, v111
    ds_write_b64 v111, v[46:47] offset:24592

    s_waitcnt lgkmcnt(7)
    v_lshl_add_u32 v112, v78, 3, v112
    ds_write_b64 v112, v[48:49] offset:24592

    s_waitcnt lgkmcnt(7)
    v_lshl_add_u32 v113, v79, 3, v113
    ds_write_b64 v113, v[50:51] offset:24592

    s_waitcnt lgkmcnt(7)
    v_lshl_add_u32 v114, v80, 3, v114
    ds_write_b64 v114, v[52:53] offset:24592

    s_waitcnt lgkmcnt(7)
    v_lshl_add_u32 v115, v81, 3, v115
    ds_write_b64 v115, v[54:55] offset:24592

    s_waitcnt lgkmcnt(7)
    v_lshl_add_u32 v116, v82, 3, v116
    ds_write_b64 v116, v[56:57] offset:24592

    s_waitcnt lgkmcnt(7)
    v_lshl_add_u32 v117, v83, 3, v117
    ds_write_b64 v117, v[58:59] offset:24592

L_skz_38:
    buffer_load_dwordx4 v[28:31], v1, s[12:15], s58 offen nt
    buffer_load_dwordx4 v[12:15], v1, s[8:11], s58 offen nt
    buffer_load_dwordx2 v[40:41], v2, s[16:19], s63 offen nt
    s_bitcmp0_b32 s28, 2
    s_cbranch_scc1 L_skz_39
    v_lshrrev_b32 v110, 16, v61
    ds_read_b32 v110, v110 offset:8192
    v_lshrrev_b32 v111, 16, v63
    ds_read_b32 v111, v111 offset:8192
    v_lshrrev_b32 v112, 16, v65
    ds_read_b32 v112, v112 offset:8192
    v_lshrrev_b32 v113, 16, v67
    ds_read_b32 v113, v113 offset:8192
    s_waitcnt lgkmcnt(3)
    v_lshl_add_u32 v110, v84, 3, v110
    ds_write_b64 v110, v[60:61] offset:24592

    s_waitcnt lgkmcnt(3)
    v_lshl_add_u32 v111, v85, 3, v111
    ds_write_b64 v111, v[62:63] offset:24592

    s_waitcnt lgkmcnt(3)
    v_lshl_add_u32 v112, v86, 3, v112
    ds_write_b64 v112, v[64:65] offset:24592

    s_waitcnt lgkmcnt(3)
    v_lshl_add_u32 v113, v87, 3, v113
    ds_write_b64 v113, v[66:67] offset:24592

L_skz_39:
    s_bitcmp0_b32 s28, 3
    s_cbranch_scc1 L_skz_40
    s_mov_b64 exec, s[66:67]
    v_lshrrev_b32 v110, 16, v69
    ds_read_b32 v110, v110 offset:8192
    v_lshrrev_b32 v111, 16, v71
    ds_read_b32 v111, v111 offset:8192
    v_lshrrev_b32 v112, 16, v73
    ds_read_b32 v112, v112 offset:8192
    v_lshrrev_b32 v113, 16, v75
    ds_read_b32 v113, v113 offset:8192
    s_waitcnt lgkmcnt(3)
    v_lshl_add_u32 v110, v88, 3, v110
    ds_write_b64 v110, v[68:69] offset:24592

    s_waitcnt lgkmcnt(3)
    v_lshl_add_u32 v111, v89, 3, v111
    ds_write_b64 v111, v[70:71] offset:24592

    s_waitcnt lgkmcnt(3)
    v_lshl_add_u32 v112, v90, 3, v112
    ds_write_b64 v112, v[72:73] offset:24592

    s_waitcnt lgkmcnt(3)
    v_lshl_add_u32 v113, v91, 3, v113
    ds_write_b64 v113, v[74:75] offset:24592

    s_mov_b64 exec, -1
L_skz_40:
    buffer_load_dwordx4 v[32:35], v1, s[12:15], s59 offen nt
    buffer_load_dwordx4 v[16:19], v1, s[8:11], s59 offen nt
    buffer_load_dwordx2 v[42:43], v2, s[16:19], s64 offen nt
    s_cmp_lg_u32 s49, 0
    s_cbranch_scc1 L_p1loop_6
L_p1epi_7:
    s_waitcnt vmcnt(0)
    s_waitcnt vmcnt(4)
    v_lshrrev_b32 v93, 16, v92
    v_and_b32 v92, 0xffff, v92
    v_add_u32 v110, v92, v94
    v_mad_u32_u24 v92, v92, 5, v96
    v_add_u32 v111, v93, v95
    v_mad_u32_u24 v93, v93, 5, v97
    v_max_u32 v110, v110, v111
    v_cmp_le_u32 vcc, s48, v110
    s_cbranch_vccnz L_full_41
L_fback_42:
    ds_write_b64 v2, v[92:93] offset:16384

    s_waitcnt lgkmcnt(0)
    s_barrier

    s_bitcmp0_b32 s28, 0
    s_cbranch_scc1 L_skw_43
    ds_read_b64 v[4:5], v2 offset:24592
    ds_read_b64 v[6:7], v2 offset:24600
    ds_read_b64 v[8:9], v2 offset:24584

    ds_read_b64 v[12:13], v2 offset:32784
    ds_read_b64 v[14:15], v2 offset:32792
    ds_read_b64 v[16:17], v2 offset:32776

    ds_read_b64 v[20:21], v2 offset:40976
    ds_read_b64 v[22:23], v2 offset:40984
    ds_read_b64 v[24:25], v2 offset:40968

    ds_read_b64 v[28:29], v2 offset:49168
    ds_read_b64 v[30:31], v2 offset:49176
    ds_read_b64 v[32:33], v2 offset:49160

    s_waitcnt lgkmcnt(9)
    v_lshrrev_b32 v10, 16, v5
    ds_read_b32 v10, v10 offset:16384

    s_waitcnt lgkmcnt(7)
    v_lshrrev_b32 v18, 16, v13
    ds_read_b32 v18, v18 offset:16384

    s_waitcnt lgkmcnt(5)
    v_lshrrev_b32 v26, 16, v21
    ds_read_b32 v26, v26 offset:16384

    s_waitcnt lgkmcnt(3)
    v_lshrrev_b32 v34, 16, v29
    ds_read_b32 v34, v34 offset:16384

    v_cmp_ne_u32_sdwa s[80:81], v5, v7 src0_sel:WORD_1 src1_sel:WORD_1
    v_cmp_ne_u32_sdwa vcc, v5, v9 src0_sel:WORD_1 src1_sel:WORD_1
    v_alignbyte_b32 v8, v5, v8, 1
    s_mov_b32 s54, -3
    v_perm_b32 v6, v6, v7, s45
    s_waitcnt lgkmcnt(3)
    v_add3_u32 v10, v10, v106, s54
    v_sub_u32 v11, 0, v10
    v_and_b32 v11, 3, v11
    s_mov_b64 exec, s[80:81]
    v_mov_b32 v11, 0
    v_mov_b32 v6, 0
    s_mov_b64 exec, vcc
    v_mov_b32 v11, 3

    s_mov_b64 exec, -1
    v_alignbyte_b32 v5, v6, v4, v11
    v_alignbyte_b32 v4, v4, v8, v11
    v_add_u32 v10, v10, v11

    buffer_store_dwordx2 v[4:5], v10, s[24:27], 0 offen
    v_cmp_ne_u32_sdwa s[80:81], v13, v15 src0_sel:WORD_1 src1_sel:WORD_1
    v_cmp_ne_u32_sdwa vcc, v13, v17 src0_sel:WORD_1 src1_sel:WORD_1
    v_alignbyte_b32 v16, v13, v16, 1
    s_mov_b32 s54, 5117
    v_perm_b32 v14, v14, v15, s45
    s_waitcnt lgkmcnt(2)
    v_add3_u32 v18, v18, v106, s54
    v_sub_u32 v19, 0, v18
    v_and_b32 v19, 3, v19
    s_mov_b64 exec, s[80:81]
    v_mov_b32 v19, 0
    v_mov_b32 v14, 0
    s_mov_b64 exec, vcc
    v_mov_b32 v19, 3

    s_mov_b64 exec, -1
    v_alignbyte_b32 v13, v14, v12, v19
    v_alignbyte_b32 v12, v12, v16, v19
    v_add_u32 v18, v18, v19

    buffer_store_dwordx2 v[12:13], v18, s[24:27], 0 offen
    v_cmp_ne_u32_sdwa s[80:81], v21, v23 src0_sel:WORD_1 src1_sel:WORD_1
    v_cmp_ne_u32_sdwa vcc, v21, v25 src0_sel:WORD_1 src1_sel:WORD_1
    v_alignbyte_b32 v24, v21, v24, 1
    s_mov_b32 s54, 10237
    v_perm_b32 v22, v22, v23, s45
    s_waitcnt lgkmcnt(1)
    v_add3_u32 v26, v26, v106, s54
    v_sub_u32 v27, 0, v26
    v_and_b32 v27, 3, v27
    s_mov_b64 exec, s[80:81]
    v_mov_b32 v27, 0
    v_mov_b32 v22, 0
    s_mov_b64 exec, vcc
    v_mov_b32 v27, 3

    s_mov_b64 exec, -1
    v_alignbyte_b32 v21, v22, v20, v27
    v_alignbyte_b32 v20, v20, v24, v27
    v_add_u32 v26, v26, v27

    buffer_store_dwordx2 v[20:21], v26, s[24:27], 0 offen
    v_cmp_ne_u32_sdwa s[80:81], v29, v31 src0_sel:WORD_1 src1_sel:WORD_1
    v_cmp_ne_u32_sdwa vcc, v29, v33 src0_sel:WORD_1 src1_sel:WORD_1
    v_alignbyte_b32 v32, v29, v32, 1
    s_mov_b32 s54, 15357
    v_perm_b32 v30, v30, v31, s45
    s_waitcnt lgkmcnt(0)
    v_add3_u32 v34, v34, v106, s54
    v_sub_u32 v35, 0, v34
    v_and_b32 v35, 3, v35
    s_mov_b64 exec, s[80:81]
    v_mov_b32 v35, 0
    v_mov_b32 v30, 0
    s_mov_b64 exec, vcc
    v_mov_b32 v35, 3

    s_mov_b64 exec, -1
    v_alignbyte_b32 v29, v30, v28, v35
    v_alignbyte_b32 v28, v28, v32, v35
    v_add_u32 v34, v34, v35

    buffer_store_dwordx2 v[28:29], v34, s[24:27], 0 offen
L_skw_43:
    s_bitcmp0_b32 s28, 1
    s_cbranch_scc1 L_skw_44
    v_add_u32 v107, 32768, v2
    ds_read_b64 v[4:5], v107 offset:24592
    ds_read_b64 v[6:7], v107 offset:24600
    ds_read_b64 v[8:9], v107 offset:24584

    ds_read_b64 v[12:13], v107 offset:32784
    ds_read_b64 v[14:15], v107 offset:32792
    ds_read_b64 v[16:17], v107 offset:32776

    ds_read_b64 v[20:21], v107 offset:40976
    ds_read_b64 v[22:23], v107 offset:40984
    ds_read_b64 v[24:25], v107 offset:40968

    ds_read_b64 v[28:29], v107 offset:49168
    ds_read_b64 v[30:31], v107 offset:49176
    ds_read_b64 v[32:33], v107 offset:49160

    s_waitcnt lgkmcnt(9)
    v_lshrrev_b32 v10, 16, v5
    ds_read_b32 v10, v10 offset:16384

    s_waitcnt lgkmcnt(7)
    v_lshrrev_b32 v18, 16, v13
    ds_read_b32 v18, v18 offset:16384

    s_waitcnt lgkmcnt(5)
    v_lshrrev_b32 v26, 16, v21
    ds_read_b32 v26, v26 offset:16384

    s_waitcnt lgkmcnt(3)
    v_lshrrev_b32 v34, 16, v29
    ds_read_b32 v34, v34 offset:16384

    v_cmp_ne_u32_sdwa s[80:81], v5, v7 src0_sel:WORD_1 src1_sel:WORD_1
    v_cmp_ne_u32_sdwa vcc, v5, v9 src0_sel:WORD_1 src1_sel:WORD_1
    v_alignbyte_b32 v8, v5, v8, 1
    s_mov_b32 s54, 20477
    v_perm_b32 v6, v6, v7, s45
    s_waitcnt lgkmcnt(3)
    v_add3_u32 v10, v10, v106, s54
    v_sub_u32 v11, 0, v10
    v_and_b32 v11, 3, v11
    s_mov_b64 exec, s[80:81]
    v_mov_b32 v11, 0
    v_mov_b32 v6, 0
    s_mov_b64 exec, vcc
    v_mov_b32 v11, 3

    s_mov_b64 exec, -1
    v_alignbyte_b32 v5, v6, v4, v11
    v_alignbyte_b32 v4, v4, v8, v11
    v_add_u32 v10, v10, v11

    buffer_store_dwordx2 v[4:5], v10, s[24:27], 0 offen
    v_cmp_ne_u32_sdwa s[80:81], v13, v15 src0_sel:WORD_1 src1_sel:WORD_1
    v_cmp_ne_u32_sdwa vcc, v13, v17 src0_sel:WORD_1 src1_sel:WORD_1
    v_alignbyte_b32 v16, v13, v16, 1
    s_mov_b32 s54, 25597
    v_perm_b32 v14, v14, v15, s45
    s_waitcnt lgkmcnt(2)
    v_add3_u32 v18, v18, v106, s54
    v_sub_u32 v19, 0, v18
    v_and_b32 v19, 3, v19
    s_mov_b64 exec, s[80:81]
    v_mov_b32 v19, 0
    v_mov_b32 v14, 0
    s_mov_b64 exec, vcc
    v_mov_b32 v19, 3

    s_mov_b64 exec, -1
    v_alignbyte_b32 v13, v14, v12, v19
    v_alignbyte_b32 v12, v12, v16, v19
    v_add_u32 v18, v18, v19

    buffer_store_dwordx2 v[12:13], v18, s[24:27], 0 offen
    v_cmp_ne_u32_sdwa s[80:81], v21, v23 src0_sel:WORD_1 src1_sel:WORD_1
    v_cmp_ne_u32_sdwa vcc, v21, v25 src0_sel:WORD_1 src1_sel:WORD_1
    v_alignbyte_b32 v24, v21, v24, 1
    s_mov_b32 s54, 30717
    v_perm_b32 v22, v22, v23, s45
    s_waitcnt lgkmcnt(1)
    v_add3_u32 v26, v26, v106, s54
    v_sub_u32 v27, 0, v26
    v_and_b32 v27, 3, v27
    s_mov_b64 exec, s[80:81]
    v_mov_b32 v27, 0
    v_mov_b32 v22, 0
    s_mov_b64 exec, vcc
    v_mov_b32 v27, 3

    s_mov_b64 exec, -1
    v_alignbyte_b32 v21, v22, v20, v27
    v_alignbyte_b32 v20, v20, v24, v27
    v_add_u32 v26, v26, v27

    buffer_store_dwordx2 v[20:21], v26, s[24:27], 0 offen
    v_cmp_ne_u32_sdwa s[80:81], v29, v31 src0_sel:WORD_1 src1_sel:WORD_1
    v_cmp_ne_u32_sdwa vcc, v29, v33 src0_sel:WORD_1 src1_sel:WORD_1
    v_alignbyte_b32 v32, v29, v32, 1
    s_mov_b32 s54, 35837
    v_perm_b32 v30, v30, v31, s45
    s_waitcnt lgkmcnt(0)
    v_add3_u32 v34, v34, v106, s54
    v_sub_u32 v35, 0, v34
    v_and_b32 v35, 3, v35
    s_mov_b64 exec, s[80:81]
    v_mov_b32 v35, 0
    v_mov_b32 v30, 0
    s_mov_b64 exec, vcc
    v_mov_b32 v35, 3

    s_mov_b64 exec, -1
    v_alignbyte_b32 v29, v30, v28, v35
    v_alignbyte_b32 v28, v28, v32, v35
    v_add_u32 v34, v34, v35

    buffer_store_dwordx2 v[28:29], v34, s[24:27], 0 offen
L_skw_44:
    s_bitcmp0_b32 s28, 2
    s_cbranch_scc1 L_skw_45
    v_add_u32 v107, 65536, v2
    ds_read_b64 v[4:5], v107 offset:24592
    ds_read_b64 v[6:7], v107 offset:24600
    ds_read_b64 v[8:9], v107 offset:24584

    ds_read_b64 v[12:13], v107 offset:32784
    ds_read_b64 v[14:15], v107 offset:32792
    ds_read_b64 v[16:17], v107 offset:32776

    ds_read_b64 v[20:21], v107 offset:40976
    ds_read_b64 v[22:23], v107 offset:40984
    ds_read_b64 v[24:25], v107 offset:40968

    ds_read_b64 v[28:29], v107 offset:49168
    ds_read_b64 v[30:31], v107 offset:49176
    ds_read_b64 v[32:33], v107 offset:49160

    s_waitcnt lgkmcnt(9)
    v_lshrrev_b32 v10, 16, v5
    ds_read_b32 v10, v10 offset:16384

    s_waitcnt lgkmcnt(7)
    v_lshrrev_b32 v18, 16, v13
    ds_read_b32 v18, v18 offset:16384

    s_waitcnt lgkmcnt(5)
    v_lshrrev_b32 v26, 16, v21
    ds_read_b32 v26, v26 offset:16384

    s_waitcnt lgkmcnt(3)
    v_lshrrev_b32 v34, 16, v29
    ds_read_b32 v34, v34 offset:16384

    v_cmp_ne_u32_sdwa s[80:81], v5, v7 src0_sel:WORD_1 src1_sel:WORD_1
    v_cmp_ne_u32_sdwa vcc, v5, v9 src0_sel:WORD_1 src1_sel:WORD_1
    v_alignbyte_b32 v8, v5, v8, 1
    s_mov_b32 s54, 40957
    v_perm_b32 v6, v6, v7, s45
    s_waitcnt lgkmcnt(3)
    v_add3_u32 v10, v10, v106, s54
    v_sub_u32 v11, 0, v10
    v_and_b32 v11, 3, v11
    s_mov_b64 exec, s[80:81]
    v_mov_b32 v11, 0
    v_mov_b32 v6, 0
    s_mov_b64 exec, vcc
    v_mov_b32 v11, 3

    s_mov_b64 exec, -1
    v_alignbyte_b32 v5, v6, v4, v11
    v_alignbyte_b32 v4, v4, v8, v11
    v_add_u32 v10, v10, v11

    buffer_store_dwordx2 v[4:5], v10, s[24:27], 0 offen
    v_cmp_ne_u32_sdwa s[80:81], v13, v15 src0_sel:WORD_1 src1_sel:WORD_1
    v_cmp_ne_u32_sdwa vcc, v13, v17 src0_sel:WORD_1 src1_sel:WORD_1
    v_alignbyte_b32 v16, v13, v16, 1
    s_mov_b32 s54, 46077
    v_perm_b32 v14, v14, v15, s45
    s_waitcnt lgkmcnt(2)
    v_add3_u32 v18, v18, v106, s54
    v_sub_u32 v19, 0, v18
    v_and_b32 v19, 3, v19
    s_mov_b64 exec, s[80:81]
    v_mov_b32 v19, 0
    v_mov_b32 v14, 0
    s_mov_b64 exec, vcc
    v_mov_b32 v19, 3

    s_mov_b64 exec, -1
    v_alignbyte_b32 v13, v14, v12, v19
    v_alignbyte_b32 v12, v12, v16, v19
    v_add_u32 v18, v18, v19

    buffer_store_dwordx2 v[12:13], v18, s[24:27], 0 offen
    v_cmp_ne_u32_sdwa s[80:81], v21, v23 src0_sel:WORD_1 src1_sel:WORD_1
    v_cmp_ne_u32_sdwa vcc, v21, v25 src0_sel:WORD_1 src1_sel:WORD_1
    v_alignbyte_b32 v24, v21, v24, 1
    s_mov_b32 s54, 51197
    v_perm_b32 v22, v22, v23, s45
    s_waitcnt lgkmcnt(1)
    v_add3_u32 v26, v26, v106, s54
    v_sub_u32 v27, 0, v26
    v_and_b32 v27, 3, v27
    s_mov_b64 exec, s[80:81]
    v_mov_b32 v27, 0
    v_mov_b32 v22, 0
    s_mov_b64 exec, vcc
    v_mov_b32 v27, 3

    s_mov_b64 exec, -1
    v_alignbyte_b32 v21, v22, v20, v27
    v_alignbyte_b32 v20, v20, v24, v27
    v_add_u32 v26, v26, v27

    buffer_store_dwordx2 v[20:21], v26, s[24:27], 0 offen
    v_cmp_ne_u32_sdwa s[80:81], v29, v31 src0_sel:WORD_1 src1_sel:WORD_1
    v_cmp_ne_u32_sdwa vcc, v29, v33 src0_sel:WORD_1 src1_sel:WORD_1
    v_alignbyte_b32 v32, v29, v32, 1
    s_mov_b32 s54, 56317
    v_perm_b32 v30, v30, v31, s45
    s_waitcnt lgkmcnt(0)
    v_add3_u32 v34, v34, v106, s54
    v_sub_u32 v35, 0, v34
    v_and_b32 v35, 3, v35
    s_mov_b64 exec, s[80:81]
    v_mov_b32 v35, 0
    v_mov_b32 v30, 0
    s_mov_b64 exec, vcc
    v_mov_b32 v35, 3

    s_mov_b64 exec, -1
    v_alignbyte_b32 v29, v30, v28, v35
    v_alignbyte_b32 v28, v28, v32, v35
    v_add_u32 v34, v34, v35

    buffer_store_dwordx2 v[28:29], v34, s[24:27], 0 offen
L_skw_45:
    s_bitcmp0_b32 s28, 3
    s_cbranch_scc1 L_skw_46
    v_add_u32 v107, 98304, v2
    ds_read_b64 v[4:5], v107 offset:24592
    ds_read_b64 v[6:7], v107 offset:24600
    ds_read_b64 v[8:9], v107 offset:24584

    ds_read_b64 v[12:13], v107 offset:32784
    ds_read_b64 v[14:15], v107 offset:32792
    ds_read_b64 v[16:17], v107 offset:32776

    ds_read_b64 v[20:21], v107 offset:40976
    ds_read_b64 v[22:23], v107 offset:40984
    ds_read_b64 v[24:25], v107 offset:40968

    ds_read_b64 v[28:29], v107 offset:49168
    ds_read_b64 v[30:31], v107 offset:49176
    ds_read_b64 v[32:33], v107 offset:49160

    s_waitcnt lgkmcnt(9)
    v_lshrrev_b32 v10, 16, v5
    ds_read_b32 v10, v10 offset:16384

    s_waitcnt lgkmcnt(7)
    v_lshrrev_b32 v18, 16, v13
    ds_read_b32 v18, v18 offset:16384

    s_waitcnt lgkmcnt(5)
    v_lshrrev_b32 v26, 16, v21
    ds_read_b32 v26, v26 offset:16384

    s_waitcnt lgkmcnt(3)
    v_lshrrev_b32 v34, 16, v29
    ds_read_b32 v34, v34 offset:16384

    v_cmp_ne_u32_sdwa s[80:81], v5, v7 src0_sel:WORD_1 src1_sel:WORD_1
    v_cmp_ne_u32_sdwa vcc, v5, v9 src0_sel:WORD_1 src1_sel:WORD_1
    v_alignbyte_b32 v8, v5, v8, 1
    s_mov_b32 s54, 61437
    v_perm_b32 v6, v6, v7, s45
    s_waitcnt lgkmcnt(3)
    v_add3_u32 v10, v10, v106, s54
    v_sub_u32 v11, 0, v10
    v_and_b32 v11, 3, v11
    s_mov_b64 exec, s[80:81]
    v_mov_b32 v11, 0
    v_mov_b32 v6, 0
    s_mov_b64 exec, vcc
    v_mov_b32 v11, 3

    s_mov_b64 exec, -1
    v_alignbyte_b32 v5, v6, v4, v11
    v_alignbyte_b32 v4, v4, v8, v11
    v_add_u32 v10, v10, v11

    buffer_store_dwordx2 v[4:5], v10, s[24:27], 0 offen
    v_cmp_ne_u32_sdwa s[80:81], v13, v15 src0_sel:WORD_1 src1_sel:WORD_1
    v_cmp_ne_u32_sdwa vcc, v13, v17 src0_sel:WORD_1 src1_sel:WORD_1
    v_alignbyte_b32 v16, v13, v16, 1
    s_mov_b32 s54, 66557
    v_perm_b32 v14, v14, v15, s45
    s_waitcnt lgkmcnt(2)
    v_add3_u32 v18, v18, v106, s54
    v_sub_u32 v19, 0, v18
    v_and_b32 v19, 3, v19
    s_mov_b64 exec, s[80:81]
    v_mov_b32 v19, 0
    v_mov_b32 v14, 0
    s_mov_b64 exec, vcc
    v_mov_b32 v19, 3

    s_mov_b64 exec, -1
    v_alignbyte_b32 v13, v14, v12, v19
    v_alignbyte_b32 v12, v12, v16, v19
    v_add_u32 v18, v18, v19

    buffer_store_dwordx2 v[12:13], v18, s[24:27], 0 offen
    v_cmp_ne_u32_sdwa s[80:81], v21, v23 src0_sel:WORD_1 src1_sel:WORD_1
    v_cmp_ne_u32_sdwa vcc, v21, v25 src0_sel:WORD_1 src1_sel:WORD_1
    v_alignbyte_b32 v24, v21, v24, 1
    s_mov_b32 s54, 71677
    v_perm_b32 v22, v22, v23, s45
    s_waitcnt lgkmcnt(1)
    v_add3_u32 v26, v26, v106, s54
    v_sub_u32 v27, 0, v26
    v_and_b32 v27, 3, v27
    s_mov_b64 exec, s[80:81]
    v_mov_b32 v27, 0
    v_mov_b32 v22, 0
    s_mov_b64 exec, vcc
    v_mov_b32 v27, 3

    s_mov_b64 exec, -1
    v_alignbyte_b32 v21, v22, v20, v27
    v_alignbyte_b32 v20, v20, v24, v27
    v_add_u32 v26, v26, v27

    buffer_store_dwordx2 v[20:21], v26, s[24:27], 0 offen
    v_cmp_ne_u32_sdwa s[80:81], v29, v31 src0_sel:WORD_1 src1_sel:WORD_1
    v_cmp_ne_u32_sdwa vcc, v29, v33 src0_sel:WORD_1 src1_sel:WORD_1
    v_alignbyte_b32 v32, v29, v32, 1
    s_mov_b32 s54, 76797
    v_perm_b32 v30, v30, v31, s45
    s_waitcnt lgkmcnt(0)
    v_add3_u32 v34, v34, v106, s54
    v_sub_u32 v35, 0, v34
    v_and_b32 v35, 3, v35
    s_mov_b64 exec, s[80:81]
    v_mov_b32 v35, 0
    v_mov_b32 v30, 0
    s_mov_b64 exec, vcc
    v_mov_b32 v35, 3

    s_mov_b64 exec, -1
    v_alignbyte_b32 v29, v30, v28, v35
    v_alignbyte_b32 v28, v28, v32, v35
    v_add_u32 v34, v34, v35

    buffer_store_dwordx2 v[28:29], v34, s[24:27], 0 offen
L_skw_46:
L_p1done_1:
    s_endpgm

L_ska_8:
    v_bfrev_b32 v126, 1
    buffer_load_dword v3, v126, s[96:99], 0 offen
    buffer_load_dword v3, v126, s[96:99], 0 offen
    buffer_load_dword v3, v126, s[96:99], 0 offen
    s_branch L_bka_9
L_ska_10:
    v_bfrev_b32 v126, 1
    buffer_load_dword v3, v126, s[96:99], 0 offen
    buffer_load_dword v3, v126, s[96:99], 0 offen
    buffer_load_dword v3, v126, s[96:99], 0 offen
    s_branch L_bka_11
L_ska_12:
    v_bfrev_b32 v126, 1
    buffer_load_dword v3, v126, s[96:99], 0 offen
    buffer_load_dword v3, v126, s[96:99], 0 offen
    buffer_load_dword v3, v126, s[96:99], 0 offen
    s_branch L_bka_13
L_ska_14:
    v_bfrev_b32 v126, 1
    buffer_load_dword v3, v126, s[96:99], 0 offen
    buffer_load_dword v3, v126, s[96:99], 0 offen
    buffer_load_dword v3, v126, s[96:99], 0 offen
    s_branch L_bka_15
L_full_27:
    v_mov_b32 v110, 0
    s_mov_b64 exec, vcc
    v_bfrev_b32 v92, 1
    v_bfrev_b32 v93, 1
    s_mov_b64 exec, 1
    buffer_atomic_or v104, v110, s[36:39], 0 offen
    s_mov_b64 exec, -1
    s_branch L_fback_28

L_full_41:
    v_mov_b32 v110, 0
    s_mov_b64 exec, vcc
    v_bfrev_b32 v92, 1
    v_bfrev_b32 v93, 1
    s_mov_b64 exec, 1
    buffer_atomic_or v104, v110, s[36:39], 0 offen
    s_mov_b64 exec, -1
    s_branch L_fback_42

.globl standalone__molecular_angular_gemnet__graph_kernel
.p2align 8
.type standalone__molecular_angular_gemnet__graph_kernel,@function
standalone__molecular_angular_gemnet__graph_kernel:
    s_cmp_ge_u32 s2, 256
    s_cbranch_scc1 L_p2done_47
    s_load_dwordx2 s[8:9], s[0:1], 0
    s_load_dwordx2 s[6:7], s[0:1], 104
    v_lshrrev_b32 v4, 6, v0
    s_lshr_b32 s37, s2, 1
    s_and_b32 s37, s37, 3
    s_lshr_b32 s36, s2, 3
    s_lshl_b32 s36, s36, 1
    s_and_b32 s3, s2, 1
    s_or_b32 s36, s36, s3
    v_readfirstlane_b32 s4, v4
    v_and_b32 v2, 63, v0
    v_lshrrev_b32 v3, 9, v0
    v_lshl_or_b32 v2, v3, 6, v2
    v_mul_u32_u24 v2, 20, v2
    v_lshlrev_b32 v3, 4, v0

    s_waitcnt lgkmcnt(0)
    s_lshl_b32 m0, s4, 10
    s_and_b32 s5, s4, 7
    s_lshr_b32 s39, s4, 3
    s_lshl_b32 s39, s39, 8
    s_mul_i32 s3, s5, 4096
    s_add_u32 s46, s6, s3
    s_addc_u32 s47, s7, 0
    s_mul_i32 s3, s5, 67117056
    s_add_u32 s3, s3, 85721088
    s_add_u32 s44, s6, s3
    s_addc_u32 s45, s7, 0
    s_mul_i32 s38, s37, 8
    s_add_u32 s4, s38, 8
    s_lshl_b32 s3, s36, 5
    s_add_u32 s3, s3, s38
    s_lshl_b32 s3, s3, 1
    s_load_dwordx4 s[92:95], s[46:47], s3
    s_mov_b32 s3, 32768
    s_load_dword s51, s[6:7], s3
    s_mov_b32 s10, 6400000
    s_mov_b32 s11, 0x20000

    s_add_u32 s12, s6, 2490368
    s_addc_u32 s13, s7, 0
    s_mov_b32 s14, 0
    s_mov_b32 s15, 0x20000
    s_add_u32 s60, s6, 2490368
    s_addc_u32 s61, s7, 0
    s_mov_b32 s62, 6406144
    s_mov_b32 s63, 0x20000
    s_mov_b32 s3, 135176
    s_load_dword s33, s[6:7], s3

    s_mul_i32 s43, s38, 200192
    s_mul_i32 s41, s4, 200192
    s_mul_i32 s50, s38, 200000
    s_add_u32 s14, s43, 50000

    buffer_load_dwordx4 v[76:79], v3, s[12:15], s43 offen
    s_add_u32 s52, s43, 16384
    buffer_load_dwordx4 v[80:83], v3, s[12:15], s52 offen
    s_add_u32 s52, s43, 32768
    buffer_load_dwordx4 v[84:87], v3, s[12:15], s52 offen
    s_add_u32 s52, s43, 49152
    v_lshlrev_b32 v119, 2, v0
    buffer_load_dword v88, v119, s[12:15], s52 offen
    s_add_u32 s20, s6, 135168
    s_addc_u32 s21, s7, 0
    s_mov_b32 s22, 4096
    s_mov_b32 s23, 0x20000
    v_and_b32 v44, 63, v0
    v_lshlrev_b32 v44, 4, v44
    buffer_load_dwordx2 v[120:121], v44, s[20:23], 0 offen offset:0
    buffer_load_dwordx2 v[122:123], v44, s[20:23], 0 offen offset:1024
    buffer_load_dwordx2 v[124:125], v44, s[20:23], 0 offen offset:2048
    buffer_load_dwordx2 v[126:127], v44, s[20:23], 0 offen offset:3072
    s_movk_i32 s40, 3072
    s_mov_b32 s19, 0x20000
    s_min_u32 s40, s40, 6524
    s_lshl_b32 s52, s38, 6
    s_add_u32 s52, s52, s36
    s_mul_i32 s52, s52, 32764
    s_and_b32 s52, s52, 0xffffff80
    s_add_u32 s16, s44, s52
    s_addc_u32 s17, s45, 0
    s_mul_i32 s52, s40, 5
    s_add_u32 s52, s52, 3
    s_and_b32 s18, s52, -4

    s_movk_i32 s53, 5120
    buffer_load_dwordx4 v[90:93], v2, s[16:19], s53 offen offset:4
    buffer_load_dword v110, v2, s[16:19], s53 offen
    s_movk_i32 s53, 7680
    buffer_load_dwordx4 v[94:97], v2, s[16:19], s53 offen offset:4
    buffer_load_dword v111, v2, s[16:19], s53 offen
    s_movk_i32 s53, 10240
    buffer_load_dwordx4 v[98:101], v2, s[16:19], s53 offen offset:4
    buffer_load_dword v112, v2, s[16:19], s53 offen
    s_lshr_b32 s3, s2, 3
    s_mul_i32 s3, s3, 49
    v_add_lshl_u32 v89, v0, s3, 7
    v_cmp_gt_u32 vcc, 49, v0
    v_bfrev_b32 v28, 1
    s_nop 0
    v_cndmask_b32 v89, v28, v89, vcc

    s_mov_b32 s19, 0x20000
    s_mov_b32 s28, 0x4b404000
    s_mov_b32 s29, 0x4b404000
    s_mov_b32 s30, 0xbfffc000
    s_mov_b32 s31, 0xbfffbfff
    s_mov_b32 s32, 0xffff0000
    s_mov_b32 s35, 0x05040100
    s_mov_b32 s97, 0x07060302
    s_mov_b32 s96, 0x40008000
    s_movk_i32 s3, 212
    v_cmp_gt_u32 s[48:49], s3, v0

    v_mov_b32 v1, 0
    s_mov_b32 s24, 0x0c0c0004
    v_mov_b32 v28, 0x40004000
    v_mov_b32 v29, 0x40004000
    v_mov_b32 v30, 0x40004000
    v_mov_b32 v31, 0x40004000
    v_add_u32 v32, 50000, v3
    v_add_u32 v33, 65536, v32

    ds_write_b128 v32, v[28:31] offset:0
    ds_write_b128 v32, v[28:31] offset:16384
    ds_write_b128 v32, v[28:31] offset:32768
    ds_write_b128 v32, v[28:31] offset:49152
    ds_write_b128 v33, v[28:31] offset:0
    ds_write_b128 v33, v[28:31] offset:16384
    v_cmp_gt_u32 vcc, 971, v0
    s_mov_b64 exec, vcc
    ds_write_b128 v33, v[28:31] offset:32768
    s_mov_b64 exec, -1
    s_waitcnt vmcnt(13)
    ds_write_addtid_b32 v76 offset:0
    ds_write_addtid_b32 v77 offset:256
    ds_write_addtid_b32 v78 offset:512
    ds_write_addtid_b32 v79 offset:768
    s_waitcnt vmcnt(12)
    ds_write_addtid_b32 v80 offset:16384
    ds_write_addtid_b32 v81 offset:16640
    ds_write_addtid_b32 v82 offset:16896
    ds_write_addtid_b32 v83 offset:17152
    s_waitcnt vmcnt(11)
    ds_write_addtid_b32 v84 offset:32768
    ds_write_addtid_b32 v85 offset:33024
    ds_write_addtid_b32 v86 offset:33280
    ds_write_addtid_b32 v87 offset:33536
    v_lshlrev_b32 v119, 2, v0
    s_waitcnt vmcnt(10)
    s_mov_b64 exec, s[48:49]
    ds_write_b32 v119, v88 offset:49152
    s_mov_b64 exec, -1
    s_add_u32 s43, s43, 50048
    s_add_u32 s14, s43, 50000
    s_min_u32 s14, s14, s41
    s_waitcnt lgkmcnt(0)
    s_and_b32 s88, s92, 0xffff
    s_lshr_b32 s89, s92, 16
    s_and_b32 s90, s93, 0xffff
    s_lshr_b32 s91, s93, 16
    s_and_b32 s92, s94, 0xffff
    s_lshr_b32 s93, s94, 16
    s_and_b32 s94, s95, 0xffff
    s_lshr_b32 s95, s95, 16
    s_waitcnt vmcnt(6)
    v_max3_u32 v120, v120, v122, v124
    v_add_f32 v121, v121, v123
    v_add_f32 v125, v125, v127
    v_max_u32 v120, v120, v126
    v_add_f32 v121, v121, v125

    s_nop 1
    v_max_u32_dpp v120, v120, v120 row_shr:1 row_mask:0xf bank_mask:0xf
    s_nop 1
    v_max_u32_dpp v120, v120, v120 row_shr:2 row_mask:0xf bank_mask:0xf
    s_nop 1
    v_max_u32_dpp v120, v120, v120 row_shr:4 row_mask:0xf bank_mask:0xf
    s_nop 1
    v_max_u32_dpp v120, v120, v120 row_shr:8 row_mask:0xf bank_mask:0xf
    s_nop 1
    v_max_u32_dpp v120, v120, v120 row_bcast:15 row_mask:0xa bank_mask:0xf
    s_nop 1
    v_max_u32_dpp v120, v120, v120 row_bcast:31 row_mask:0xc bank_mask:0xf
    s_nop 1
    v_add_f32_dpp v121, v121, v121 row_shr:1 row_mask:0xf bank_mask:0xf
    s_nop 1
    v_add_f32_dpp v121, v121, v121 row_shr:2 row_mask:0xf bank_mask:0xf
    s_nop 1
    v_add_f32_dpp v121, v121, v121 row_shr:4 row_mask:0xf bank_mask:0xf
    s_nop 1
    v_add_f32_dpp v121, v121, v121 row_shr:8 row_mask:0xf bank_mask:0xf
    s_nop 1
    v_add_f32_dpp v121, v121, v121 row_bcast:15 row_mask:0xa bank_mask:0xf
    s_nop 1
    v_add_f32_dpp v121, v121, v121 row_bcast:31 row_mask:0xc bank_mask:0xf
    v_lshlrev_b32 v120, 16, v120
    v_mul_f32 v121, 0x34a7c5ac, v121
    v_sqrt_f32 v121, v121
    v_mul_f32 v120, s33, v120
    v_mul_f32 v121, s33, v121
    v_cmp_gt_f32 vcc, 0x46fde800, v120
    s_mov_b64 s[64:65], vcc
    v_cmp_lt_f32 vcc, 0x44000000, v121
    v_mov_b32 v120, 0x37800000
    v_mul_f32 v120, s33, v120
    s_and_b64 vcc, vcc, s[64:65]
    v_mul_f32 v121, 0x46ff8000, v120
    v_rcp_f32 v121, v121
    v_readfirstlane_b32 s33, v120
    s_waitcnt lgkmcnt(0)
    s_barrier
    v_readfirstlane_b32 s34, v121
    v_mov_b32 v120, 150016
    v_mov_b32 v121, 0
    ds_write_b32 v120, v121 offset:8
    s_bitcmp0_b64 vcc, 63
    s_cbranch_scc1 L_p2slow_48
    s_cmp_lg_u32 s51, 0
    s_cbranch_scc1 L_p2slow_48

    s_min_u32 s88, s88, 6524
    s_lshl_b32 s52, s38, 6
    s_add_u32 s52, s52, s36
    s_mul_i32 s52, s52, 32764
    s_and_b32 s52, s52, 0xffffff80
    s_add_u32 s16, s44, s52
    s_addc_u32 s17, s45, 0
    s_mul_i32 s52, s88, 5
    s_add_u32 s52, s52, 3
    s_and_b32 s18, s52, -4

    s_movk_i32 s53, 12800
    buffer_load_dwordx4 v[102:105], v2, s[16:19], s53 offen offset:4
    buffer_load_dword v113, v2, s[16:19], s53 offen
    s_movk_i32 s53, 0
    buffer_load_dwordx4 v[4:7], v2, s[16:19], s53 offen offset:4 nt
    buffer_load_dword v35, v2, s[16:19], s53 offen nt
    s_movk_i32 s53, 2560
    buffer_load_dwordx4 v[8:11], v2, s[16:19], s53 offen offset:4
    buffer_load_dword v43, v2, s[16:19], s53 offen
    s_movk_i32 s53, 15360
    buffer_load_dwordx4 v[106:109], v2, s[16:19], s53 offen offset:4
    buffer_load_dword v114, v2, s[16:19], s53 offen
    s_mov_b32 s40, s88
    s_sub_u32 s42, s40, s39

    s_add_u32 s55, s38, 1
    s_min_u32 s55, s55, 31
    s_mov_b32 s88, s89
    s_mov_b32 s89, s90
    s_mov_b32 s90, s91
    s_mov_b32 s91, s92
    s_mov_b32 s92, s93
    s_mov_b32 s93, s94
    s_mov_b32 s94, s95
    s_mov_b32 s95, 0
    s_min_u32 s88, s88, 6524
    s_lshl_b32 s52, s55, 6
    s_add_u32 s52, s52, s36
    s_mul_i32 s52, s52, 32764
    s_and_b32 s52, s52, 0xffffff80
    s_add_u32 s16, s44, s52
    s_addc_u32 s17, s45, 0
    s_mul_i32 s52, s88, 5
    s_add_u32 s52, s52, 3
    s_and_b32 s18, s52, -4

    s_waitcnt vmcnt(12)
    v_lshlrev_b32_sdwa v44, 3, v110 dst_sel:WORD_0 dst_unused:UNUSED_PAD src0_sel:DWORD src1_sel:DWORD
    v_lshrrev_b32 v46, 5, v90
    v_lshlrev_b32_sdwa v48, 3, v91 dst_sel:WORD_0 dst_unused:UNUSED_PAD src0_sel:DWORD src1_sel:WORD_1
    v_alignbit_b32 v50, v93, v92, 21

    v_mov_b32 v15, v93
    v_alignbyte_b32 v14, v92, v91, 3
    v_alignbyte_b32 v13, v91, v90, 2
    v_alignbyte_b32 v12, v90, v110, 1
    v_and_b32 v46, 0xfff8, v46
    v_and_b32 v50, 0xfff8, v50
    s_cmp_lt_i32 s42, 1280
    s_cbranch_scc1 L_ufix_49
L_uback_50:

    v_subrev_co_u32 v12, s[80:81], 2.0, v12
    v_subrev_co_u32 v13, s[82:83], 2.0, v13
    v_subrev_co_u32 v14, s[84:85], 2.0, v14
    v_subrev_co_u32 v15, s[86:87], 2.0, v15
    s_mov_b64 exec, s[80:81]
    ds_read_b64 v[44:45], v44
    s_mov_b64 exec, s[82:83]
    ds_read_b64 v[46:47], v46
    s_mov_b64 exec, s[84:85]
    ds_read_b64 v[48:49], v48
    s_mov_b64 exec, s[86:87]
    ds_read_b64 v[50:51], v50
    s_mov_b64 exec, -1
    s_waitcnt vmcnt(10)
    v_lshlrev_b32_sdwa v52, 3, v111 dst_sel:WORD_0 dst_unused:UNUSED_PAD src0_sel:DWORD src1_sel:DWORD
    v_lshrrev_b32 v54, 5, v94
    v_lshlrev_b32_sdwa v56, 3, v95 dst_sel:WORD_0 dst_unused:UNUSED_PAD src0_sel:DWORD src1_sel:WORD_1
    v_alignbit_b32 v58, v97, v96, 21

    v_mov_b32 v19, v97
    v_alignbyte_b32 v18, v96, v95, 3
    v_alignbyte_b32 v17, v95, v94, 2
    v_alignbyte_b32 v16, v94, v111, 1
    v_and_b32 v54, 0xfff8, v54
    v_and_b32 v58, 0xfff8, v58
    s_cmp_lt_i32 s42, 1792
    s_cbranch_scc1 L_ufix_51
L_uback_52:

    v_subrev_co_u32 v16, s[64:65], 2.0, v16
    v_subrev_co_u32 v17, s[66:67], 2.0, v17
    v_subrev_co_u32 v18, s[68:69], 2.0, v18
    v_subrev_co_u32 v19, s[70:71], 2.0, v19
    s_mov_b64 exec, s[64:65]
    ds_read_b64 v[52:53], v52
    s_mov_b64 exec, s[66:67]
    ds_read_b64 v[54:55], v54
    s_mov_b64 exec, s[68:69]
    ds_read_b64 v[56:57], v56
    s_mov_b64 exec, s[70:71]
    ds_read_b64 v[58:59], v58
    s_mov_b64 exec, -1
    s_waitcnt vmcnt(8)
    v_lshlrev_b32_sdwa v60, 3, v112 dst_sel:WORD_0 dst_unused:UNUSED_PAD src0_sel:DWORD src1_sel:DWORD
    v_lshrrev_b32 v62, 5, v98
    v_lshlrev_b32_sdwa v64, 3, v99 dst_sel:WORD_0 dst_unused:UNUSED_PAD src0_sel:DWORD src1_sel:WORD_1
    v_alignbit_b32 v66, v101, v100, 21

    v_mov_b32 v23, v101
    v_alignbyte_b32 v22, v100, v99, 3
    v_alignbyte_b32 v21, v99, v98, 2
    v_alignbyte_b32 v20, v98, v112, 1
    v_and_b32 v62, 0xfff8, v62
    v_and_b32 v66, 0xfff8, v66
    s_cmp_lt_i32 s42, 2304
    s_cbranch_scc1 L_ufix_53
L_uback_54:

    v_subrev_co_u32 v20, s[72:73], 2.0, v20
    v_subrev_co_u32 v21, s[74:75], 2.0, v21
    v_subrev_co_u32 v22, s[76:77], 2.0, v22
    v_subrev_co_u32 v23, s[78:79], 2.0, v23
    s_mov_b64 exec, s[72:73]
    ds_read_b64 v[60:61], v60
    s_mov_b64 exec, s[74:75]
    ds_read_b64 v[62:63], v62
    s_mov_b64 exec, s[76:77]
    ds_read_b64 v[64:65], v64
    s_mov_b64 exec, s[78:79]
    ds_read_b64 v[66:67], v66
    s_mov_b64 exec, -1
    s_waitcnt vmcnt(6)
    v_lshlrev_b32_sdwa v68, 3, v113 dst_sel:WORD_0 dst_unused:UNUSED_PAD src0_sel:DWORD src1_sel:DWORD
    v_lshrrev_b32 v70, 5, v102
    v_lshlrev_b32_sdwa v72, 3, v103 dst_sel:WORD_0 dst_unused:UNUSED_PAD src0_sel:DWORD src1_sel:WORD_1
    v_alignbit_b32 v74, v105, v104, 21

    v_mov_b32 v27, v105
    v_alignbyte_b32 v26, v104, v103, 3
    v_alignbyte_b32 v25, v103, v102, 2
    v_alignbyte_b32 v24, v102, v113, 1
    v_and_b32 v70, 0xfff8, v70
    v_and_b32 v74, 0xfff8, v74
    s_cmp_lt_i32 s42, 2816
    s_cbranch_scc1 L_ufix_55
L_uback_56:

    v_subrev_co_u32 v24, s[80:81], 2.0, v24
    v_subrev_co_u32 v25, s[82:83], 2.0, v25
    v_subrev_co_u32 v26, s[84:85], 2.0, v26
    v_subrev_co_u32 v27, s[86:87], 2.0, v27
    s_mov_b64 exec, s[80:81]
    ds_read_b64 v[68:69], v68
    s_mov_b64 exec, s[82:83]
    ds_read_b64 v[70:71], v70
    s_mov_b64 exec, s[84:85]
    ds_read_b64 v[72:73], v72
    s_mov_b64 exec, s[86:87]
    ds_read_b64 v[74:75], v74
    s_mov_b64 exec, -1
    s_waitcnt vmcnt(4)
    v_lshlrev_b32_sdwa v28, 3, v35 dst_sel:WORD_0 dst_unused:UNUSED_PAD src0_sel:DWORD src1_sel:DWORD
    v_lshrrev_b32 v30, 5, v4
    v_lshlrev_b32_sdwa v32, 3, v5 dst_sel:WORD_0 dst_unused:UNUSED_PAD src0_sel:DWORD src1_sel:WORD_1
    v_alignbit_b32 v34, v7, v6, 21

    v_alignbyte_b32 v6, v6, v5, 3
    v_alignbyte_b32 v5, v5, v4, 2
    v_alignbyte_b32 v4, v4, v35, 1
    v_and_b32 v30, 0xfff8, v30
    v_and_b32 v34, 0xfff8, v34
    s_cmp_lt_i32 s42, 256
    s_cbranch_scc1 L_ufix_57
L_uback_58:

    v_subrev_co_u32 v4, s[64:65], 2.0, v4
    v_subrev_co_u32 v5, s[66:67], 2.0, v5
    v_subrev_co_u32 v6, s[68:69], 2.0, v6
    v_subrev_co_u32 v7, s[70:71], 2.0, v7
    s_mov_b64 exec, s[64:65]
    ds_read_b64 v[28:29], v28
    s_mov_b64 exec, s[66:67]
    ds_read_b64 v[30:31], v30
    s_mov_b64 exec, s[68:69]
    ds_read_b64 v[32:33], v32
    s_mov_b64 exec, s[70:71]
    ds_read_b64 v[34:35], v34
    s_mov_b64 exec, -1
    buffer_load_dwordx4 v[76:79], v3, s[12:15], s43 offen
    s_add_u32 s52, s43, 16384
    buffer_load_dwordx4 v[80:83], v3, s[12:15], s52 offen
    s_add_u32 s52, s43, 32768
    buffer_load_dwordx4 v[84:87], v3, s[12:15], s52 offen
    s_add_u32 s52, s43, 49152
    v_lshlrev_b32 v119, 2, v0
    buffer_load_dword v88, v119, s[12:15], s52 offen
    s_add_u32 s54, s43, 50048
    buffer_load_dword v115, v89, s[60:63], s54 offen
    s_add_u32 s54, s50, 0
    buffer_load_dword v115, v89, s[8:11], s54 offen
    s_waitcnt vmcnt(8)
    v_lshlrev_b32_sdwa v36, 3, v43 dst_sel:WORD_0 dst_unused:UNUSED_PAD src0_sel:DWORD src1_sel:DWORD
    v_lshrrev_b32 v38, 5, v8
    v_lshlrev_b32_sdwa v40, 3, v9 dst_sel:WORD_0 dst_unused:UNUSED_PAD src0_sel:DWORD src1_sel:WORD_1
    v_alignbit_b32 v42, v11, v10, 21

    v_alignbyte_b32 v10, v10, v9, 3
    v_alignbyte_b32 v9, v9, v8, 2
    v_alignbyte_b32 v8, v8, v43, 1
    v_and_b32 v38, 0xfff8, v38
    v_and_b32 v42, 0xfff8, v42
    s_cmp_lt_i32 s42, 768
    s_cbranch_scc1 L_ufix_59
L_uback_60:

    v_subrev_co_u32 v8, s[72:73], 2.0, v8
    v_subrev_co_u32 v9, s[74:75], 2.0, v9
    v_subrev_co_u32 v10, s[76:77], 2.0, v10
    v_subrev_co_u32 v11, s[78:79], 2.0, v11
    s_mov_b64 exec, s[72:73]
    ds_read_b64 v[36:37], v36
    s_mov_b64 exec, s[74:75]
    ds_read_b64 v[38:39], v38
    s_mov_b64 exec, s[76:77]
    ds_read_b64 v[40:41], v40
    s_mov_b64 exec, s[78:79]
    ds_read_b64 v[42:43], v42
    s_mov_b64 exec, -1
    s_movk_i32 s53, 5120
    buffer_load_dwordx4 v[90:93], v2, s[16:19], s53 offen offset:4
    buffer_load_dword v110, v2, s[16:19], s53 offen
L_batch_61:
    s_add_u32 s5, s38, 1

    s_movk_i32 s53, 7680
    buffer_load_dwordx4 v[94:97], v2, s[16:19], s53 offen offset:4
    buffer_load_dword v111, v2, s[16:19], s53 offen
    v_subrev_co_u32 v4, s[64:65], 2.0, v4
    v_subrev_co_u32 v5, s[66:67], 2.0, v5
    v_subrev_co_u32 v6, s[68:69], 2.0, v6
    v_subrev_co_u32 v7, s[70:71], 2.0, v7
    v_subrev_co_u32 v8, s[72:73], 2.0, v8
    v_subrev_co_u32 v9, s[74:75], 2.0, v9
    v_subrev_co_u32 v10, s[76:77], 2.0, v10
    v_subrev_co_u32 v11, s[78:79], 2.0, v11
    v_subrev_co_u32 v12, s[80:81], 2.0, v12
    v_subrev_co_u32 v13, s[82:83], 2.0, v13
    v_subrev_co_u32 v14, s[84:85], 2.0, v14
    v_subrev_co_u32 v15, s[86:87], 2.0, v15
    s_waitcnt lgkmcnt(0)
    s_barrier
    s_waitcnt vmcnt(7)
    ds_write_addtid_b32 v76 offset:0
    ds_write_addtid_b32 v77 offset:256
    ds_write_addtid_b32 v78 offset:512
    ds_write_addtid_b32 v79 offset:768
    s_waitcnt vmcnt(6)
    ds_write_addtid_b32 v80 offset:16384
    ds_write_addtid_b32 v81 offset:16640
    ds_write_addtid_b32 v82 offset:16896
    ds_write_addtid_b32 v83 offset:17152
    s_waitcnt vmcnt(5)
    ds_write_addtid_b32 v84 offset:32768
    ds_write_addtid_b32 v85 offset:33024
    ds_write_addtid_b32 v86 offset:33280
    ds_write_addtid_b32 v87 offset:33536
    v_lshlrev_b32 v119, 2, v0
    s_waitcnt vmcnt(4)
    s_mov_b64 exec, s[48:49]
    ds_write_b32 v119, v88 offset:49152
    s_mov_b64 exec, -1
    s_add_u32 s43, s43, 50048
    s_add_u32 s14, s43, 50000
    s_min_u32 s14, s14, s41
    buffer_load_dwordx4 v[76:79], v3, s[12:15], s43 offen
    s_waitcnt lgkmcnt(0)
    s_barrier
    s_add_u32 s52, s43, 16384
    buffer_load_dwordx4 v[80:83], v3, s[12:15], s52 offen
    s_add_u32 s52, s43, 32768
    buffer_load_dwordx4 v[84:87], v3, s[12:15], s52 offen
    s_add_u32 s52, s43, 49152
    v_lshlrev_b32 v119, 2, v0
    buffer_load_dword v88, v119, s[12:15], s52 offen
    s_mov_b64 exec, s[64:65]
    ds_read_b64 v[28:29], v28
    s_mov_b64 exec, s[66:67]
    ds_read_b64 v[30:31], v30
    s_mov_b64 exec, s[68:69]
    ds_read_b64 v[32:33], v32
    s_mov_b64 exec, s[70:71]
    ds_read_b64 v[34:35], v34
    s_mov_b64 exec, s[72:73]
    ds_read_b64 v[36:37], v36
    s_mov_b64 exec, s[74:75]
    ds_read_b64 v[38:39], v38
    s_mov_b64 exec, s[76:77]
    ds_read_b64 v[40:41], v40
    s_mov_b64 exec, s[78:79]
    ds_read_b64 v[42:43], v42
    s_mov_b64 exec, s[80:81]
    ds_read_b64 v[44:45], v44
    s_mov_b64 exec, s[82:83]
    ds_read_b64 v[46:47], v46
    s_mov_b64 exec, s[84:85]
    ds_read_b64 v[48:49], v48
    s_mov_b64 exec, s[86:87]
    ds_read_b64 v[50:51], v50
    s_mov_b64 exec, -1
    v_subrev_co_u32 v16, s[64:65], 2.0, v16
    v_subrev_co_u32 v17, s[66:67], 2.0, v17
    v_subrev_co_u32 v18, s[68:69], 2.0, v18
    v_subrev_co_u32 v19, s[70:71], 2.0, v19
    v_subrev_co_u32 v20, s[72:73], 2.0, v20
    v_subrev_co_u32 v21, s[74:75], 2.0, v21
    v_subrev_co_u32 v22, s[76:77], 2.0, v22
    v_subrev_co_u32 v23, s[78:79], 2.0, v23
    v_subrev_co_u32 v24, s[80:81], 2.0, v24
    v_subrev_co_u32 v25, s[82:83], 2.0, v25
    v_subrev_co_u32 v26, s[84:85], 2.0, v26
    v_subrev_co_u32 v27, s[86:87], 2.0, v27
    s_mov_b64 exec, s[64:65]
    ds_read_b64 v[52:53], v52
    s_mov_b64 exec, s[66:67]
    ds_read_b64 v[54:55], v54
    s_mov_b64 exec, s[68:69]
    ds_read_b64 v[56:57], v56
    s_mov_b64 exec, s[70:71]
    ds_read_b64 v[58:59], v58
    s_mov_b64 exec, s[72:73]
    ds_read_b64 v[60:61], v60
    s_mov_b64 exec, s[74:75]
    ds_read_b64 v[62:63], v62
    s_mov_b64 exec, s[76:77]
    ds_read_b64 v[64:65], v64
    s_mov_b64 exec, s[78:79]
    ds_read_b64 v[66:67], v66
    s_mov_b64 exec, s[80:81]
    ds_read_b64 v[68:69], v68
    s_mov_b64 exec, s[82:83]
    ds_read_b64 v[70:71], v70
    s_mov_b64 exec, s[84:85]
    ds_read_b64 v[72:73], v72
    s_mov_b64 exec, s[86:87]
    ds_read_b64 v[74:75], v74
    s_mov_b64 exec, -1
    s_cmp_le_i32 s42, 3072
    s_cbranch_scc1 L_nt1_63
    s_waitcnt vmcnt(14)
    v_lshlrev_b32_sdwa v120, 3, v114 dst_sel:WORD_0 dst_unused:UNUSED_PAD src0_sel:DWORD src1_sel:DWORD
    v_lshrrev_b32 v122, 5, v106
    v_lshlrev_b32_sdwa v124, 3, v107 dst_sel:WORD_0 dst_unused:UNUSED_PAD src0_sel:DWORD src1_sel:WORD_1
    v_alignbit_b32 v126, v109, v108, 21

    v_alignbyte_b32 v108, v108, v107, 3
    v_alignbyte_b32 v107, v107, v106, 2
    v_alignbyte_b32 v106, v106, v114, 1
    v_and_b32 v122, 0xfff8, v122
    v_and_b32 v126, 0xfff8, v126
    s_cmp_lt_i32 s42, 3328
    s_cbranch_scc1 L_ufix_66
L_uback_67:

    v_lshrrev_b32 v117, 30, v106
    v_and_b32 v106, 0x3fffffff, v106
    v_mul_u32_u24 v117, 50000, v117
    v_cmp_ne_u32 vcc, 0, v106
    v_add_u32 v120, v120, v117
    s_mov_b64 exec, vcc

    buffer_load_dwordx2 v[120:121], v120, s[8:11], s50 offen
    s_mov_b64 exec, -1
    v_lshrrev_b32 v117, 30, v107
    v_and_b32 v107, 0x3fffffff, v107
    v_mul_u32_u24 v117, 50000, v117
    v_cmp_ne_u32 vcc, 0, v107
    v_add_u32 v122, v122, v117
    s_mov_b64 exec, vcc

    buffer_load_dwordx2 v[122:123], v122, s[8:11], s50 offen
    s_mov_b64 exec, -1
    v_lshrrev_b32 v117, 30, v108
    v_and_b32 v108, 0x3fffffff, v108
    v_mul_u32_u24 v117, 50000, v117
    v_cmp_ne_u32 vcc, 0, v108
    v_add_u32 v124, v124, v117
    s_mov_b64 exec, vcc

    buffer_load_dwordx2 v[124:125], v124, s[8:11], s50 offen
    s_mov_b64 exec, -1
    v_lshrrev_b32 v117, 30, v109
    v_and_b32 v109, 0x3fffffff, v109
    v_mul_u32_u24 v117, 50000, v117
    v_cmp_ne_u32 vcc, 0, v109
    v_add_u32 v126, v126, v117
    s_mov_b64 exec, vcc

    buffer_load_dwordx2 v[126:127], v126, s[8:11], s50 offen
    s_mov_b64 exec, -1
L_nt1_63:
    v_subrev_co_u32 v4, s[64:65], 2.0, v4
    v_subrev_co_u32 v5, s[66:67], 2.0, v5
    v_subrev_co_u32 v6, s[68:69], 2.0, v6
    v_subrev_co_u32 v7, s[70:71], 2.0, v7
    v_subrev_co_u32 v8, s[72:73], 2.0, v8
    v_subrev_co_u32 v9, s[74:75], 2.0, v9
    v_subrev_co_u32 v10, s[76:77], 2.0, v10
    v_subrev_co_u32 v11, s[78:79], 2.0, v11
    v_subrev_co_u32 v12, s[80:81], 2.0, v12
    v_subrev_co_u32 v13, s[82:83], 2.0, v13
    v_subrev_co_u32 v14, s[84:85], 2.0, v14
    v_subrev_co_u32 v15, s[86:87], 2.0, v15
    s_waitcnt lgkmcnt(0)
    s_barrier
    s_waitcnt vmcnt(3)
    ds_write_addtid_b32 v76 offset:0
    ds_write_addtid_b32 v77 offset:256
    ds_write_addtid_b32 v78 offset:512
    ds_write_addtid_b32 v79 offset:768
    s_waitcnt vmcnt(2)
    ds_write_addtid_b32 v80 offset:16384
    ds_write_addtid_b32 v81 offset:16640
    ds_write_addtid_b32 v82 offset:16896
    ds_write_addtid_b32 v83 offset:17152
    s_waitcnt vmcnt(1)
    ds_write_addtid_b32 v84 offset:32768
    ds_write_addtid_b32 v85 offset:33024
    ds_write_addtid_b32 v86 offset:33280
    ds_write_addtid_b32 v87 offset:33536
    v_lshlrev_b32 v119, 2, v0
    s_waitcnt vmcnt(0)
    s_mov_b64 exec, s[48:49]
    ds_write_b32 v119, v88 offset:49152
    s_mov_b64 exec, -1
    s_add_u32 s43, s43, 50048
    s_add_u32 s14, s43, 50000
    s_min_u32 s14, s14, s41
    buffer_load_dwordx4 v[76:79], v3, s[12:15], s43 offen
    s_waitcnt lgkmcnt(0)
    s_barrier
    s_add_u32 s52, s43, 16384
    buffer_load_dwordx4 v[80:83], v3, s[12:15], s52 offen
    s_add_u32 s52, s43, 32768
    buffer_load_dwordx4 v[84:87], v3, s[12:15], s52 offen
    s_add_u32 s52, s43, 49152
    v_lshlrev_b32 v119, 2, v0
    buffer_load_dword v88, v119, s[12:15], s52 offen
    s_mov_b64 exec, s[64:65]
    ds_read_b64 v[28:29], v28
    s_mov_b64 exec, s[66:67]
    ds_read_b64 v[30:31], v30
    s_mov_b64 exec, s[68:69]
    ds_read_b64 v[32:33], v32
    s_mov_b64 exec, s[70:71]
    ds_read_b64 v[34:35], v34
    s_mov_b64 exec, s[72:73]
    ds_read_b64 v[36:37], v36
    s_mov_b64 exec, s[74:75]
    ds_read_b64 v[38:39], v38
    s_mov_b64 exec, s[76:77]
    ds_read_b64 v[40:41], v40
    s_mov_b64 exec, s[78:79]
    ds_read_b64 v[42:43], v42
    s_mov_b64 exec, s[80:81]
    ds_read_b64 v[44:45], v44
    s_mov_b64 exec, s[82:83]
    ds_read_b64 v[46:47], v46
    s_mov_b64 exec, s[84:85]
    ds_read_b64 v[48:49], v48
    s_mov_b64 exec, s[86:87]
    ds_read_b64 v[50:51], v50
    s_mov_b64 exec, -1
    v_subrev_co_u32 v16, s[64:65], 2.0, v16
    v_subrev_co_u32 v17, s[66:67], 2.0, v17
    v_subrev_co_u32 v18, s[68:69], 2.0, v18
    v_subrev_co_u32 v19, s[70:71], 2.0, v19
    v_subrev_co_u32 v20, s[72:73], 2.0, v20
    v_subrev_co_u32 v21, s[74:75], 2.0, v21
    v_subrev_co_u32 v22, s[76:77], 2.0, v22
    v_subrev_co_u32 v23, s[78:79], 2.0, v23
    v_subrev_co_u32 v24, s[80:81], 2.0, v24
    v_subrev_co_u32 v25, s[82:83], 2.0, v25
    v_subrev_co_u32 v26, s[84:85], 2.0, v26
    v_subrev_co_u32 v27, s[86:87], 2.0, v27
    s_mov_b64 exec, s[64:65]
    ds_read_b64 v[52:53], v52
    s_mov_b64 exec, s[66:67]
    ds_read_b64 v[54:55], v54
    s_mov_b64 exec, s[68:69]
    ds_read_b64 v[56:57], v56
    s_mov_b64 exec, s[70:71]
    ds_read_b64 v[58:59], v58
    s_mov_b64 exec, s[72:73]
    ds_read_b64 v[60:61], v60
    s_mov_b64 exec, s[74:75]
    ds_read_b64 v[62:63], v62
    s_mov_b64 exec, s[76:77]
    ds_read_b64 v[64:65], v64
    s_mov_b64 exec, s[78:79]
    ds_read_b64 v[66:67], v66
    s_mov_b64 exec, s[80:81]
    ds_read_b64 v[68:69], v68
    s_mov_b64 exec, s[82:83]
    ds_read_b64 v[70:71], v70
    s_mov_b64 exec, s[84:85]
    ds_read_b64 v[72:73], v72
    s_mov_b64 exec, s[86:87]
    ds_read_b64 v[74:75], v74
    s_mov_b64 exec, -1
    s_movk_i32 s53, 10240
    buffer_load_dwordx4 v[98:101], v2, s[16:19], s53 offen offset:4
    buffer_load_dword v112, v2, s[16:19], s53 offen
    s_movk_i32 s53, 12800
    buffer_load_dwordx4 v[102:105], v2, s[16:19], s53 offen offset:4
    buffer_load_dword v113, v2, s[16:19], s53 offen
    s_cmp_le_i32 s42, 3072
    s_cbranch_scc1 L_nt2_64
    s_waitcnt vmcnt(8)
    v_cmp_ne_u32 s[56:57], 0, v106
    v_cmp_ne_u32 s[58:59], 0, v107
    v_cmp_ne_u32 s[98:99], 0, v108
    v_cmp_ne_u32 vcc, 0, v109
    s_mov_b64 exec, s[56:57]
    v_cvt_f32_i32_sdwa v118, sext(v106) dst_sel:DWORD dst_unused:UNUSED_PAD src0_sel:WORD_0
    v_lshlrev_b32 v116, 16, v120
    v_and_b32 v117, s32, v120
    v_mul_f32 v118, s33, v118
    v_lshlrev_b32 v120, 16, v121
    v_and_b32 v121, s32, v121
    v_lshlrev_b32_sdwa v106, 3, v106 dst_sel:DWORD dst_unused:UNUSED_PAD src0_sel:DWORD src1_sel:WORD_1
    v_pk_fma_f32 v[116:117], v[116:117], v[118:119], s[28:29] op_sel_hi:[1,0,1]
    v_pk_fma_f32 v[120:121], v[120:121], v[118:119], s[28:29] op_sel_hi:[1,0,1]
    v_perm_b32 v116, v117, v116, s35
    v_perm_b32 v117, v121, v120, s35
    v_lshl_add_u64 v[116:117], v[116:117], 0, s[30:31]
    ds_add_rtn_u64 v[120:121], v106, v[116:117] offset:50000

    s_mov_b64 exec, s[58:59]
    v_cvt_f32_i32_sdwa v118, sext(v107) dst_sel:DWORD dst_unused:UNUSED_PAD src0_sel:WORD_0
    v_lshlrev_b32 v116, 16, v122
    v_and_b32 v117, s32, v122
    v_mul_f32 v118, s33, v118
    v_lshlrev_b32 v122, 16, v123
    v_and_b32 v123, s32, v123
    v_lshlrev_b32_sdwa v107, 3, v107 dst_sel:DWORD dst_unused:UNUSED_PAD src0_sel:DWORD src1_sel:WORD_1
    v_pk_fma_f32 v[116:117], v[116:117], v[118:119], s[28:29] op_sel_hi:[1,0,1]
    v_pk_fma_f32 v[122:123], v[122:123], v[118:119], s[28:29] op_sel_hi:[1,0,1]
    v_perm_b32 v116, v117, v116, s35
    v_perm_b32 v117, v123, v122, s35
    v_lshl_add_u64 v[116:117], v[116:117], 0, s[30:31]
    ds_add_rtn_u64 v[122:123], v107, v[116:117] offset:50000

    s_mov_b64 exec, s[98:99]
    v_cvt_f32_i32_sdwa v118, sext(v108) dst_sel:DWORD dst_unused:UNUSED_PAD src0_sel:WORD_0
    v_lshlrev_b32 v116, 16, v124
    v_and_b32 v117, s32, v124
    v_mul_f32 v118, s33, v118
    v_lshlrev_b32 v124, 16, v125
    v_and_b32 v125, s32, v125
    v_lshlrev_b32_sdwa v108, 3, v108 dst_sel:DWORD dst_unused:UNUSED_PAD src0_sel:DWORD src1_sel:WORD_1
    v_pk_fma_f32 v[116:117], v[116:117], v[118:119], s[28:29] op_sel_hi:[1,0,1]
    v_pk_fma_f32 v[124:125], v[124:125], v[118:119], s[28:29] op_sel_hi:[1,0,1]
    v_perm_b32 v116, v117, v116, s35
    v_perm_b32 v117, v125, v124, s35
    v_lshl_add_u64 v[116:117], v[116:117], 0, s[30:31]
    ds_add_rtn_u64 v[124:125], v108, v[116:117] offset:50000

    s_mov_b64 exec, vcc
    v_cvt_f32_i32_sdwa v118, sext(v109) dst_sel:DWORD dst_unused:UNUSED_PAD src0_sel:WORD_0
    v_lshlrev_b32 v116, 16, v126
    v_and_b32 v117, s32, v126
    v_mul_f32 v118, s33, v118
    v_lshlrev_b32 v126, 16, v127
    v_and_b32 v127, s32, v127
    v_lshlrev_b32_sdwa v109, 3, v109 dst_sel:DWORD dst_unused:UNUSED_PAD src0_sel:DWORD src1_sel:WORD_1
    v_pk_fma_f32 v[116:117], v[116:117], v[118:119], s[28:29] op_sel_hi:[1,0,1]
    v_pk_fma_f32 v[126:127], v[126:127], v[118:119], s[28:29] op_sel_hi:[1,0,1]
    v_perm_b32 v116, v117, v116, s35
    v_perm_b32 v117, v127, v126, s35
    v_lshl_add_u64 v[116:117], v[116:117], 0, s[30:31]
    ds_add_rtn_u64 v[126:127], v109, v[116:117] offset:50000

    s_waitcnt lgkmcnt(0)
    s_mov_b64 exec, s[56:57]
    v_or3_b32 v1, v120, v121, v1
    s_mov_b64 exec, s[58:59]
    v_or3_b32 v1, v122, v123, v1
    s_mov_b64 exec, s[98:99]
    v_or3_b32 v1, v124, v125, v1
    s_mov_b64 exec, vcc
    v_or3_b32 v1, v126, v127, v1
    s_mov_b64 exec, -1
L_nt2_64:
    s_movk_i32 s53, 15360
    buffer_load_dwordx4 v[106:109], v2, s[16:19], s53 offen offset:4
    buffer_load_dword v114, v2, s[16:19], s53 offen
    s_cmp_le_u32 s40, 3584
    s_cbranch_scc1 L_noleft_65
    s_min_u32 s40, s40, 6524
    s_lshl_b32 s52, s38, 6
    s_add_u32 s52, s52, s36
    s_mul_i32 s52, s52, 32764
    s_and_b32 s52, s52, 0xffffff80
    s_add_u32 s20, s44, s52
    s_addc_u32 s21, s45, 0
    s_mul_i32 s52, s40, 5
    s_add_u32 s52, s52, 3
    s_and_b32 s22, s52, -4

    s_lshr_b32 s55, s39, 2
    s_add_u32 s55, s55, 3584
    v_and_b32 v120, 63, v0
    v_add_u32 v120, s55, v120
L_left_68:
    s_cmp_ge_u32 s55, s40
    s_cbranch_scc1 L_leftend_69
    v_mul_u32_u24 v121, 5, v120
    buffer_load_dword v122, v121, s[20:23], 0 offen offset:1
    buffer_load_ubyte v123, v121, s[20:23], 0 offen
    s_waitcnt vmcnt(0)

    v_perm_b32 v121, v123, v122, s24
    v_lshrrev_b32 v126, 30, v122
    v_and_b32 v121, 0x1fff, v121
    v_mul_u32_u24 v126, 6250, v126
    v_add_lshl_u32 v121, v121, v126, 3

    buffer_load_dwordx2 v[124:125], v121, s[8:11], s50 offen
    v_cmp_gt_u32 vcc, s40, v120
    s_waitcnt vmcnt(0)

    s_mov_b64 exec, vcc
    v_and_b32 v122, 0x3fffffff, v122
    v_cvt_f32_i32_sdwa v118, sext(v122) dst_sel:DWORD dst_unused:UNUSED_PAD src0_sel:WORD_0
    v_lshlrev_b32 v116, 16, v124
    v_and_b32 v117, s32, v124
    v_mul_f32 v118, s33, v118
    v_lshlrev_b32 v124, 16, v125
    v_and_b32 v125, s32, v125
    v_lshlrev_b32_sdwa v122, 3, v122 dst_sel:DWORD dst_unused:UNUSED_PAD src0_sel:DWORD src1_sel:WORD_1
    v_pk_fma_f32 v[116:117], v[116:117], v[118:119], s[28:29] op_sel_hi:[1,0,1]
    v_pk_fma_f32 v[124:125], v[124:125], v[118:119], s[28:29] op_sel_hi:[1,0,1]
    v_perm_b32 v116, v117, v116, s35
    v_perm_b32 v117, v125, v124, s35
    v_lshl_add_u64 v[116:117], v[116:117], 0, s[30:31]
    ds_add_rtn_u64 v[124:125], v122, v[116:117] offset:50000

    s_waitcnt lgkmcnt(0)
    v_or3_b32 v1, v124, v125, v1
    s_mov_b64 exec, -1
    v_add_u32 v120, 128, v120
    s_add_u32 s55, s55, 128
    s_branch L_left_68
L_leftend_69:

L_noleft_65:
    v_cmp_gt_u32 s[64:65], 2.0, v4
    v_and_b32 v4, 0x3fffffff, v4
    v_cmp_gt_u32 s[66:67], 2.0, v5
    v_and_b32 v5, 0x3fffffff, v5
    v_cmp_gt_u32 s[68:69], 2.0, v6
    v_and_b32 v6, 0x3fffffff, v6
    v_cmp_gt_u32 s[70:71], 2.0, v7
    v_and_b32 v7, 0x3fffffff, v7
    v_cmp_gt_u32 s[72:73], 2.0, v8
    v_and_b32 v8, 0x3fffffff, v8
    v_cmp_gt_u32 s[74:75], 2.0, v9
    v_and_b32 v9, 0x3fffffff, v9
    v_cmp_gt_u32 s[76:77], 2.0, v10
    v_and_b32 v10, 0x3fffffff, v10
    v_cmp_gt_u32 s[78:79], 2.0, v11
    v_and_b32 v11, 0x3fffffff, v11
    v_cmp_gt_u32 s[80:81], 2.0, v12
    v_and_b32 v12, 0x3fffffff, v12
    v_cmp_gt_u32 s[82:83], 2.0, v13
    v_and_b32 v13, 0x3fffffff, v13
    v_cmp_gt_u32 s[84:85], 2.0, v14
    v_and_b32 v14, 0x3fffffff, v14
    v_cmp_gt_u32 s[86:87], 2.0, v15
    v_and_b32 v15, 0x3fffffff, v15
    s_waitcnt lgkmcnt(0)
    s_barrier
    s_waitcnt vmcnt(9)
    ds_write_addtid_b32 v76 offset:0
    ds_write_addtid_b32 v77 offset:256
    ds_write_addtid_b32 v78 offset:512
    ds_write_addtid_b32 v79 offset:768
    s_waitcnt vmcnt(8)
    ds_write_addtid_b32 v80 offset:16384
    ds_write_addtid_b32 v81 offset:16640
    ds_write_addtid_b32 v82 offset:16896
    ds_write_addtid_b32 v83 offset:17152
    s_waitcnt vmcnt(7)
    ds_write_addtid_b32 v84 offset:32768
    ds_write_addtid_b32 v85 offset:33024
    ds_write_addtid_b32 v86 offset:33280
    ds_write_addtid_b32 v87 offset:33536
    v_lshlrev_b32 v119, 2, v0
    s_waitcnt vmcnt(6)
    s_mov_b64 exec, s[48:49]
    ds_write_b32 v119, v88 offset:49152
    s_mov_b64 exec, -1
    s_add_u32 s43, s43, 50048
    s_add_u32 s14, s43, 50000
    s_min_u32 s14, s14, s41
    buffer_load_dwordx4 v[76:79], v3, s[12:15], s43 offen
    s_waitcnt lgkmcnt(0)
    s_barrier
    s_add_u32 s52, s43, 16384
    buffer_load_dwordx4 v[80:83], v3, s[12:15], s52 offen
    s_add_u32 s52, s43, 32768
    buffer_load_dwordx4 v[84:87], v3, s[12:15], s52 offen
    s_add_u32 s52, s43, 49152
    v_lshlrev_b32 v119, 2, v0
    buffer_load_dword v88, v119, s[12:15], s52 offen
    s_mov_b64 exec, s[64:65]
    ds_read_b64 v[28:29], v28
    s_mov_b64 exec, s[66:67]
    ds_read_b64 v[30:31], v30
    s_mov_b64 exec, s[68:69]
    ds_read_b64 v[32:33], v32
    s_mov_b64 exec, s[70:71]
    ds_read_b64 v[34:35], v34
    s_mov_b64 exec, s[72:73]
    ds_read_b64 v[36:37], v36
    s_mov_b64 exec, s[74:75]
    ds_read_b64 v[38:39], v38
    s_mov_b64 exec, s[76:77]
    ds_read_b64 v[40:41], v40
    s_mov_b64 exec, s[78:79]
    ds_read_b64 v[42:43], v42
    s_mov_b64 exec, s[80:81]
    ds_read_b64 v[44:45], v44
    s_mov_b64 exec, s[82:83]
    ds_read_b64 v[46:47], v46
    s_mov_b64 exec, s[84:85]
    ds_read_b64 v[48:49], v48
    s_mov_b64 exec, s[86:87]
    ds_read_b64 v[50:51], v50
    s_mov_b64 exec, -1
    v_cmp_gt_u32 s[64:65], 2.0, v16
    v_and_b32 v16, 0x3fffffff, v16
    v_cmp_gt_u32 s[66:67], 2.0, v17
    v_and_b32 v17, 0x3fffffff, v17
    v_cmp_gt_u32 s[68:69], 2.0, v18
    v_and_b32 v18, 0x3fffffff, v18
    v_cmp_gt_u32 s[70:71], 2.0, v19
    v_and_b32 v19, 0x3fffffff, v19
    v_cmp_gt_u32 s[72:73], 2.0, v20
    v_and_b32 v20, 0x3fffffff, v20
    v_cmp_gt_u32 s[74:75], 2.0, v21
    v_and_b32 v21, 0x3fffffff, v21
    v_cmp_gt_u32 s[76:77], 2.0, v22
    v_and_b32 v22, 0x3fffffff, v22
    v_cmp_gt_u32 s[78:79], 2.0, v23
    v_and_b32 v23, 0x3fffffff, v23
    v_cmp_gt_u32 s[80:81], 2.0, v24
    v_and_b32 v24, 0x3fffffff, v24
    v_cmp_gt_u32 s[82:83], 2.0, v25
    v_and_b32 v25, 0x3fffffff, v25
    v_cmp_gt_u32 s[84:85], 2.0, v26
    v_and_b32 v26, 0x3fffffff, v26
    v_cmp_gt_u32 s[86:87], 2.0, v27
    v_and_b32 v27, 0x3fffffff, v27
    s_mov_b64 exec, s[64:65]
    ds_read_b64 v[52:53], v52
    s_mov_b64 exec, s[66:67]
    ds_read_b64 v[54:55], v54
    s_mov_b64 exec, s[68:69]
    ds_read_b64 v[56:57], v56
    s_mov_b64 exec, s[70:71]
    ds_read_b64 v[58:59], v58
    s_mov_b64 exec, s[72:73]
    ds_read_b64 v[60:61], v60
    s_mov_b64 exec, s[74:75]
    ds_read_b64 v[62:63], v62
    s_mov_b64 exec, s[76:77]
    ds_read_b64 v[64:65], v64
    s_mov_b64 exec, s[78:79]
    ds_read_b64 v[66:67], v66
    s_mov_b64 exec, s[80:81]
    ds_read_b64 v[68:69], v68
    s_mov_b64 exec, s[82:83]
    ds_read_b64 v[70:71], v70
    s_mov_b64 exec, s[84:85]
    ds_read_b64 v[72:73], v72
    s_mov_b64 exec, s[86:87]
    ds_read_b64 v[74:75], v74
    s_mov_b64 exec, -1
    s_cmp_ge_u32 s5, s4
    s_cbranch_scc1 L_bend_62
    s_waitcnt lgkmcnt(15)
    v_mad_i32_i16 v120, v28, v4, s96
    v_mad_i32_i16 v28, v28, v4, s96 op_sel:[1,0,0,0]
    v_mad_i32_i16 v121, v29, v4, s96
    v_mad_i32_i16 v29, v29, v4, s96 op_sel:[1,0,0,0]
    v_lshlrev_b32_sdwa v4, 3, v4 dst_sel:DWORD dst_unused:UNUSED_PAD src0_sel:DWORD src1_sel:WORD_1
    v_perm_b32 v28, v28, v120, s97
    v_perm_b32 v29, v29, v121, s97
    v_lshl_add_u64 v[28:29], v[28:29], 0, s[30:31]

    ds_add_rtn_u64 v[28:29], v4, v[28:29] offset:50000
    v_mad_i32_i16 v122, v30, v5, s96
    v_mad_i32_i16 v30, v30, v5, s96 op_sel:[1,0,0,0]
    v_mad_i32_i16 v123, v31, v5, s96
    v_mad_i32_i16 v31, v31, v5, s96 op_sel:[1,0,0,0]
    v_lshlrev_b32_sdwa v5, 3, v5 dst_sel:DWORD dst_unused:UNUSED_PAD src0_sel:DWORD src1_sel:WORD_1
    v_perm_b32 v30, v30, v122, s97
    v_perm_b32 v31, v31, v123, s97
    v_lshl_add_u64 v[30:31], v[30:31], 0, s[30:31]

    ds_add_rtn_u64 v[30:31], v5, v[30:31] offset:50000
    v_mad_i32_i16 v124, v32, v6, s96
    v_mad_i32_i16 v32, v32, v6, s96 op_sel:[1,0,0,0]
    v_mad_i32_i16 v125, v33, v6, s96
    v_mad_i32_i16 v33, v33, v6, s96 op_sel:[1,0,0,0]
    v_lshlrev_b32_sdwa v6, 3, v6 dst_sel:DWORD dst_unused:UNUSED_PAD src0_sel:DWORD src1_sel:WORD_1
    v_perm_b32 v32, v32, v124, s97
    v_perm_b32 v33, v33, v125, s97
    v_lshl_add_u64 v[32:33], v[32:33], 0, s[30:31]

    ds_add_rtn_u64 v[32:33], v6, v[32:33] offset:50000
    v_mad_i32_i16 v126, v34, v7, s96
    v_mad_i32_i16 v34, v34, v7, s96 op_sel:[1,0,0,0]
    v_mad_i32_i16 v127, v35, v7, s96
    v_mad_i32_i16 v35, v35, v7, s96 op_sel:[1,0,0,0]
    v_lshlrev_b32_sdwa v7, 3, v7 dst_sel:DWORD dst_unused:UNUSED_PAD src0_sel:DWORD src1_sel:WORD_1
    v_perm_b32 v34, v34, v126, s97
    v_perm_b32 v35, v35, v127, s97
    v_lshl_add_u64 v[34:35], v[34:35], 0, s[30:31]

    ds_add_rtn_u64 v[34:35], v7, v[34:35] offset:50000
    v_mad_i32_i16 v120, v36, v8, s96
    v_mad_i32_i16 v36, v36, v8, s96 op_sel:[1,0,0,0]
    v_mad_i32_i16 v121, v37, v8, s96
    v_mad_i32_i16 v37, v37, v8, s96 op_sel:[1,0,0,0]
    v_lshlrev_b32_sdwa v8, 3, v8 dst_sel:DWORD dst_unused:UNUSED_PAD src0_sel:DWORD src1_sel:WORD_1
    v_perm_b32 v36, v36, v120, s97
    v_perm_b32 v37, v37, v121, s97
    v_lshl_add_u64 v[36:37], v[36:37], 0, s[30:31]

    ds_add_rtn_u64 v[36:37], v8, v[36:37] offset:50000
    v_mad_i32_i16 v122, v38, v9, s96
    v_mad_i32_i16 v38, v38, v9, s96 op_sel:[1,0,0,0]
    v_mad_i32_i16 v123, v39, v9, s96
    v_mad_i32_i16 v39, v39, v9, s96 op_sel:[1,0,0,0]
    v_lshlrev_b32_sdwa v9, 3, v9 dst_sel:DWORD dst_unused:UNUSED_PAD src0_sel:DWORD src1_sel:WORD_1
    v_perm_b32 v38, v38, v122, s97
    v_perm_b32 v39, v39, v123, s97
    v_lshl_add_u64 v[38:39], v[38:39], 0, s[30:31]

    ds_add_rtn_u64 v[38:39], v9, v[38:39] offset:50000
    v_mad_i32_i16 v124, v40, v10, s96
    v_mad_i32_i16 v40, v40, v10, s96 op_sel:[1,0,0,0]
    v_mad_i32_i16 v125, v41, v10, s96
    v_mad_i32_i16 v41, v41, v10, s96 op_sel:[1,0,0,0]
    v_lshlrev_b32_sdwa v10, 3, v10 dst_sel:DWORD dst_unused:UNUSED_PAD src0_sel:DWORD src1_sel:WORD_1
    v_perm_b32 v40, v40, v124, s97
    v_perm_b32 v41, v41, v125, s97
    v_lshl_add_u64 v[40:41], v[40:41], 0, s[30:31]

    ds_add_rtn_u64 v[40:41], v10, v[40:41] offset:50000
    v_mad_i32_i16 v126, v42, v11, s96
    v_mad_i32_i16 v42, v42, v11, s96 op_sel:[1,0,0,0]
    v_mad_i32_i16 v127, v43, v11, s96
    v_mad_i32_i16 v43, v43, v11, s96 op_sel:[1,0,0,0]
    v_lshlrev_b32_sdwa v11, 3, v11 dst_sel:DWORD dst_unused:UNUSED_PAD src0_sel:DWORD src1_sel:WORD_1
    v_perm_b32 v42, v42, v126, s97
    v_perm_b32 v43, v43, v127, s97
    v_lshl_add_u64 v[42:43], v[42:43], 0, s[30:31]

    ds_add_rtn_u64 v[42:43], v11, v[42:43] offset:50000
    s_waitcnt lgkmcnt(4)
    v_or3_b32 v1, v28, v29, v1
    v_or3_b32 v1, v30, v31, v1
    v_or3_b32 v1, v32, v33, v1
    v_or3_b32 v1, v34, v35, v1
    s_movk_i32 s53, 0
    buffer_load_dwordx4 v[4:7], v2, s[16:19], s53 offen offset:4 nt
    buffer_load_dword v35, v2, s[16:19], s53 offen nt
    v_mad_i32_i16 v120, v44, v12, s96
    v_mad_i32_i16 v44, v44, v12, s96 op_sel:[1,0,0,0]
    v_mad_i32_i16 v121, v45, v12, s96
    v_mad_i32_i16 v45, v45, v12, s96 op_sel:[1,0,0,0]
    v_lshlrev_b32_sdwa v12, 3, v12 dst_sel:DWORD dst_unused:UNUSED_PAD src0_sel:DWORD src1_sel:WORD_1
    v_perm_b32 v44, v44, v120, s97
    v_perm_b32 v45, v45, v121, s97
    v_lshl_add_u64 v[44:45], v[44:45], 0, s[30:31]

    ds_add_rtn_u64 v[44:45], v12, v[44:45] offset:50000
    v_mad_i32_i16 v122, v46, v13, s96
    v_mad_i32_i16 v46, v46, v13, s96 op_sel:[1,0,0,0]
    v_mad_i32_i16 v123, v47, v13, s96
    v_mad_i32_i16 v47, v47, v13, s96 op_sel:[1,0,0,0]
    v_lshlrev_b32_sdwa v13, 3, v13 dst_sel:DWORD dst_unused:UNUSED_PAD src0_sel:DWORD src1_sel:WORD_1
    v_perm_b32 v46, v46, v122, s97
    v_perm_b32 v47, v47, v123, s97
    v_lshl_add_u64 v[46:47], v[46:47], 0, s[30:31]

    ds_add_rtn_u64 v[46:47], v13, v[46:47] offset:50000
    v_mad_i32_i16 v124, v48, v14, s96
    v_mad_i32_i16 v48, v48, v14, s96 op_sel:[1,0,0,0]
    v_mad_i32_i16 v125, v49, v14, s96
    v_mad_i32_i16 v49, v49, v14, s96 op_sel:[1,0,0,0]
    v_lshlrev_b32_sdwa v14, 3, v14 dst_sel:DWORD dst_unused:UNUSED_PAD src0_sel:DWORD src1_sel:WORD_1
    v_perm_b32 v48, v48, v124, s97
    v_perm_b32 v49, v49, v125, s97
    v_lshl_add_u64 v[48:49], v[48:49], 0, s[30:31]

    ds_add_rtn_u64 v[48:49], v14, v[48:49] offset:50000
    v_mad_i32_i16 v126, v50, v15, s96
    v_mad_i32_i16 v50, v50, v15, s96 op_sel:[1,0,0,0]
    v_mad_i32_i16 v127, v51, v15, s96
    v_mad_i32_i16 v51, v51, v15, s96 op_sel:[1,0,0,0]
    v_lshlrev_b32_sdwa v15, 3, v15 dst_sel:DWORD dst_unused:UNUSED_PAD src0_sel:DWORD src1_sel:WORD_1
    v_perm_b32 v50, v50, v126, s97
    v_perm_b32 v51, v51, v127, s97
    v_lshl_add_u64 v[50:51], v[50:51], 0, s[30:31]

    ds_add_rtn_u64 v[50:51], v15, v[50:51] offset:50000
    s_waitcnt lgkmcnt(4)
    v_or3_b32 v1, v36, v37, v1
    v_or3_b32 v1, v38, v39, v1
    v_or3_b32 v1, v40, v41, v1
    v_or3_b32 v1, v42, v43, v1
    s_movk_i32 s53, 2560
    buffer_load_dwordx4 v[8:11], v2, s[16:19], s53 offen offset:4
    buffer_load_dword v43, v2, s[16:19], s53 offen
    s_barrier
    s_waitcnt vmcnt(7)
    ds_write_addtid_b32 v76 offset:0
    ds_write_addtid_b32 v77 offset:256
    ds_write_addtid_b32 v78 offset:512
    ds_write_addtid_b32 v79 offset:768
    s_waitcnt vmcnt(6)
    ds_write_addtid_b32 v80 offset:16384
    ds_write_addtid_b32 v81 offset:16640
    ds_write_addtid_b32 v82 offset:16896
    ds_write_addtid_b32 v83 offset:17152
    s_waitcnt vmcnt(5)
    ds_write_addtid_b32 v84 offset:32768
    ds_write_addtid_b32 v85 offset:33024
    ds_write_addtid_b32 v86 offset:33280
    ds_write_addtid_b32 v87 offset:33536
    v_lshlrev_b32 v119, 2, v0
    s_waitcnt vmcnt(4)
    s_mov_b64 exec, s[48:49]
    ds_write_b32 v119, v88 offset:49152
    s_mov_b64 exec, -1
    s_add_u32 s43, s43, 50048
    s_add_u32 s14, s43, 50000
    s_min_u32 s14, s14, s41
    s_mov_b32 s40, s88
    s_sub_u32 s42, s40, s39

    s_add_u32 s55, s38, 2
    s_min_u32 s55, s55, 31
    s_mov_b32 s88, s89
    s_mov_b32 s89, s90
    s_mov_b32 s90, s91
    s_mov_b32 s91, s92
    s_mov_b32 s92, s93
    s_mov_b32 s93, s94
    s_mov_b32 s94, s95
    s_mov_b32 s95, 0
    s_min_u32 s88, s88, 6524
    s_lshl_b32 s52, s55, 6
    s_add_u32 s52, s52, s36
    s_mul_i32 s52, s52, 32764
    s_and_b32 s52, s52, 0xffffff80
    s_add_u32 s16, s44, s52
    s_addc_u32 s17, s45, 0
    s_mul_i32 s52, s88, 5
    s_add_u32 s52, s52, 3
    s_and_b32 s18, s52, -4

    v_mad_i32_i16 v120, v52, v16, s96
    v_mad_i32_i16 v52, v52, v16, s96 op_sel:[1,0,0,0]
    v_mad_i32_i16 v121, v53, v16, s96
    v_mad_i32_i16 v53, v53, v16, s96 op_sel:[1,0,0,0]
    v_lshlrev_b32_sdwa v16, 3, v16 dst_sel:DWORD dst_unused:UNUSED_PAD src0_sel:DWORD src1_sel:WORD_1
    v_perm_b32 v52, v52, v120, s97
    v_perm_b32 v53, v53, v121, s97
    v_lshl_add_u64 v[52:53], v[52:53], 0, s[30:31]

    ds_add_rtn_u64 v[52:53], v16, v[52:53] offset:50000
    v_mad_i32_i16 v122, v54, v17, s96
    v_mad_i32_i16 v54, v54, v17, s96 op_sel:[1,0,0,0]
    v_mad_i32_i16 v123, v55, v17, s96
    v_mad_i32_i16 v55, v55, v17, s96 op_sel:[1,0,0,0]
    v_lshlrev_b32_sdwa v17, 3, v17 dst_sel:DWORD dst_unused:UNUSED_PAD src0_sel:DWORD src1_sel:WORD_1
    v_perm_b32 v54, v54, v122, s97
    v_perm_b32 v55, v55, v123, s97
    v_lshl_add_u64 v[54:55], v[54:55], 0, s[30:31]

    ds_add_rtn_u64 v[54:55], v17, v[54:55] offset:50000
    v_mad_i32_i16 v124, v56, v18, s96
    v_mad_i32_i16 v56, v56, v18, s96 op_sel:[1,0,0,0]
    v_mad_i32_i16 v125, v57, v18, s96
    v_mad_i32_i16 v57, v57, v18, s96 op_sel:[1,0,0,0]
    v_lshlrev_b32_sdwa v18, 3, v18 dst_sel:DWORD dst_unused:UNUSED_PAD src0_sel:DWORD src1_sel:WORD_1
    v_perm_b32 v56, v56, v124, s97
    v_perm_b32 v57, v57, v125, s97
    v_lshl_add_u64 v[56:57], v[56:57], 0, s[30:31]

    ds_add_rtn_u64 v[56:57], v18, v[56:57] offset:50000
    v_mad_i32_i16 v126, v58, v19, s96
    v_mad_i32_i16 v58, v58, v19, s96 op_sel:[1,0,0,0]
    v_mad_i32_i16 v127, v59, v19, s96
    v_mad_i32_i16 v59, v59, v19, s96 op_sel:[1,0,0,0]
    v_lshlrev_b32_sdwa v19, 3, v19 dst_sel:DWORD dst_unused:UNUSED_PAD src0_sel:DWORD src1_sel:WORD_1
    v_perm_b32 v58, v58, v126, s97
    v_perm_b32 v59, v59, v127, s97
    v_lshl_add_u64 v[58:59], v[58:59], 0, s[30:31]

    ds_add_rtn_u64 v[58:59], v19, v[58:59] offset:50000
    s_waitcnt lgkmcnt(15)
    v_or3_b32 v1, v44, v45, v1
    v_or3_b32 v1, v46, v47, v1
    v_or3_b32 v1, v48, v49, v1
    v_or3_b32 v1, v50, v51, v1
    s_waitcnt vmcnt(24)
    v_lshlrev_b32_sdwa v44, 3, v110 dst_sel:WORD_0 dst_unused:UNUSED_PAD src0_sel:DWORD src1_sel:DWORD
    v_lshrrev_b32 v46, 5, v90
    v_lshlrev_b32_sdwa v48, 3, v91 dst_sel:WORD_0 dst_unused:UNUSED_PAD src0_sel:DWORD src1_sel:WORD_1
    v_alignbit_b32 v50, v93, v92, 21

    v_mov_b32 v15, v93
    v_alignbyte_b32 v14, v92, v91, 3
    v_alignbyte_b32 v13, v91, v90, 2
    v_alignbyte_b32 v12, v90, v110, 1
    v_and_b32 v46, 0xfff8, v46
    v_and_b32 v50, 0xfff8, v50
    s_cmp_lt_i32 s42, 1280
    s_cbranch_scc1 L_ufix_70
L_uback_71:

    s_movk_i32 s53, 5120
    buffer_load_dwordx4 v[90:93], v2, s[16:19], s53 offen offset:4
    buffer_load_dword v110, v2, s[16:19], s53 offen
    s_waitcnt lgkmcnt(4)
    s_barrier
    v_subrev_co_u32 v12, s[80:81], 2.0, v12
    v_subrev_co_u32 v13, s[82:83], 2.0, v13
    v_subrev_co_u32 v14, s[84:85], 2.0, v14
    v_subrev_co_u32 v15, s[86:87], 2.0, v15
    s_mov_b64 exec, s[80:81]
    ds_read_b64 v[44:45], v44
    s_mov_b64 exec, s[82:83]
    ds_read_b64 v[46:47], v46
    s_mov_b64 exec, s[84:85]
    ds_read_b64 v[48:49], v48
    s_mov_b64 exec, s[86:87]
    ds_read_b64 v[50:51], v50
    s_mov_b64 exec, -1
    v_mad_i32_i16 v120, v60, v20, s96
    v_mad_i32_i16 v60, v60, v20, s96 op_sel:[1,0,0,0]
    v_mad_i32_i16 v121, v61, v20, s96
    v_mad_i32_i16 v61, v61, v20, s96 op_sel:[1,0,0,0]
    v_lshlrev_b32_sdwa v20, 3, v20 dst_sel:DWORD dst_unused:UNUSED_PAD src0_sel:DWORD src1_sel:WORD_1
    v_perm_b32 v60, v60, v120, s97
    v_perm_b32 v61, v61, v121, s97
    v_lshl_add_u64 v[60:61], v[60:61], 0, s[30:31]

    ds_add_rtn_u64 v[60:61], v20, v[60:61] offset:50000
    v_mad_i32_i16 v122, v62, v21, s96
    v_mad_i32_i16 v62, v62, v21, s96 op_sel:[1,0,0,0]
    v_mad_i32_i16 v123, v63, v21, s96
    v_mad_i32_i16 v63, v63, v21, s96 op_sel:[1,0,0,0]
    v_lshlrev_b32_sdwa v21, 3, v21 dst_sel:DWORD dst_unused:UNUSED_PAD src0_sel:DWORD src1_sel:WORD_1
    v_perm_b32 v62, v62, v122, s97
    v_perm_b32 v63, v63, v123, s97
    v_lshl_add_u64 v[62:63], v[62:63], 0, s[30:31]

    ds_add_rtn_u64 v[62:63], v21, v[62:63] offset:50000
    v_mad_i32_i16 v124, v64, v22, s96
    v_mad_i32_i16 v64, v64, v22, s96 op_sel:[1,0,0,0]
    v_mad_i32_i16 v125, v65, v22, s96
    v_mad_i32_i16 v65, v65, v22, s96 op_sel:[1,0,0,0]
    v_lshlrev_b32_sdwa v22, 3, v22 dst_sel:DWORD dst_unused:UNUSED_PAD src0_sel:DWORD src1_sel:WORD_1
    v_perm_b32 v64, v64, v124, s97
    v_perm_b32 v65, v65, v125, s97
    v_lshl_add_u64 v[64:65], v[64:65], 0, s[30:31]

    ds_add_rtn_u64 v[64:65], v22, v[64:65] offset:50000
    v_mad_i32_i16 v126, v66, v23, s96
    v_mad_i32_i16 v66, v66, v23, s96 op_sel:[1,0,0,0]
    v_mad_i32_i16 v127, v67, v23, s96
    v_mad_i32_i16 v67, v67, v23, s96 op_sel:[1,0,0,0]
    v_lshlrev_b32_sdwa v23, 3, v23 dst_sel:DWORD dst_unused:UNUSED_PAD src0_sel:DWORD src1_sel:WORD_1
    v_perm_b32 v66, v66, v126, s97
    v_perm_b32 v67, v67, v127, s97
    v_lshl_add_u64 v[66:67], v[66:67], 0, s[30:31]

    ds_add_rtn_u64 v[66:67], v23, v[66:67] offset:50000
    s_waitcnt lgkmcnt(8)
    v_or3_b32 v1, v52, v53, v1
    v_or3_b32 v1, v54, v55, v1
    v_or3_b32 v1, v56, v57, v1
    v_or3_b32 v1, v58, v59, v1
    s_waitcnt vmcnt(24)
    v_lshlrev_b32_sdwa v52, 3, v111 dst_sel:WORD_0 dst_unused:UNUSED_PAD src0_sel:DWORD src1_sel:DWORD
    v_lshrrev_b32 v54, 5, v94
    v_lshlrev_b32_sdwa v56, 3, v95 dst_sel:WORD_0 dst_unused:UNUSED_PAD src0_sel:DWORD src1_sel:WORD_1
    v_alignbit_b32 v58, v97, v96, 21

    v_mov_b32 v19, v97
    v_alignbyte_b32 v18, v96, v95, 3
    v_alignbyte_b32 v17, v95, v94, 2
    v_alignbyte_b32 v16, v94, v111, 1
    v_and_b32 v54, 0xfff8, v54
    v_and_b32 v58, 0xfff8, v58
    s_cmp_lt_i32 s42, 1792
    s_cbranch_scc1 L_ufix_72
L_uback_73:

    v_subrev_co_u32 v16, s[64:65], 2.0, v16
    v_subrev_co_u32 v17, s[66:67], 2.0, v17
    v_subrev_co_u32 v18, s[68:69], 2.0, v18
    v_subrev_co_u32 v19, s[70:71], 2.0, v19
    s_mov_b64 exec, s[64:65]
    ds_read_b64 v[52:53], v52
    s_mov_b64 exec, s[66:67]
    ds_read_b64 v[54:55], v54
    s_mov_b64 exec, s[68:69]
    ds_read_b64 v[56:57], v56
    s_mov_b64 exec, s[70:71]
    ds_read_b64 v[58:59], v58
    s_mov_b64 exec, -1
    v_mad_i32_i16 v120, v68, v24, s96
    v_mad_i32_i16 v68, v68, v24, s96 op_sel:[1,0,0,0]
    v_mad_i32_i16 v121, v69, v24, s96
    v_mad_i32_i16 v69, v69, v24, s96 op_sel:[1,0,0,0]
    v_lshlrev_b32_sdwa v24, 3, v24 dst_sel:DWORD dst_unused:UNUSED_PAD src0_sel:DWORD src1_sel:WORD_1
    v_perm_b32 v68, v68, v120, s97
    v_perm_b32 v69, v69, v121, s97
    v_lshl_add_u64 v[68:69], v[68:69], 0, s[30:31]

    ds_add_rtn_u64 v[68:69], v24, v[68:69] offset:50000
    v_mad_i32_i16 v122, v70, v25, s96
    v_mad_i32_i16 v70, v70, v25, s96 op_sel:[1,0,0,0]
    v_mad_i32_i16 v123, v71, v25, s96
    v_mad_i32_i16 v71, v71, v25, s96 op_sel:[1,0,0,0]
    v_lshlrev_b32_sdwa v25, 3, v25 dst_sel:DWORD dst_unused:UNUSED_PAD src0_sel:DWORD src1_sel:WORD_1
    v_perm_b32 v70, v70, v122, s97
    v_perm_b32 v71, v71, v123, s97
    v_lshl_add_u64 v[70:71], v[70:71], 0, s[30:31]

    ds_add_rtn_u64 v[70:71], v25, v[70:71] offset:50000
    v_mad_i32_i16 v124, v72, v26, s96
    v_mad_i32_i16 v72, v72, v26, s96 op_sel:[1,0,0,0]
    v_mad_i32_i16 v125, v73, v26, s96
    v_mad_i32_i16 v73, v73, v26, s96 op_sel:[1,0,0,0]
    v_lshlrev_b32_sdwa v26, 3, v26 dst_sel:DWORD dst_unused:UNUSED_PAD src0_sel:DWORD src1_sel:WORD_1
    v_perm_b32 v72, v72, v124, s97
    v_perm_b32 v73, v73, v125, s97
    v_lshl_add_u64 v[72:73], v[72:73], 0, s[30:31]

    ds_add_rtn_u64 v[72:73], v26, v[72:73] offset:50000
    v_mad_i32_i16 v126, v74, v27, s96
    v_mad_i32_i16 v74, v74, v27, s96 op_sel:[1,0,0,0]
    v_mad_i32_i16 v127, v75, v27, s96
    v_mad_i32_i16 v75, v75, v27, s96 op_sel:[1,0,0,0]
    v_lshlrev_b32_sdwa v27, 3, v27 dst_sel:DWORD dst_unused:UNUSED_PAD src0_sel:DWORD src1_sel:WORD_1
    v_perm_b32 v74, v74, v126, s97
    v_perm_b32 v75, v75, v127, s97
    v_lshl_add_u64 v[74:75], v[74:75], 0, s[30:31]

    ds_add_rtn_u64 v[74:75], v27, v[74:75] offset:50000
    s_waitcnt lgkmcnt(8)
    v_or3_b32 v1, v60, v61, v1
    v_or3_b32 v1, v62, v63, v1
    v_or3_b32 v1, v64, v65, v1
    v_or3_b32 v1, v66, v67, v1
    s_waitcnt vmcnt(14)
    v_lshlrev_b32_sdwa v60, 3, v112 dst_sel:WORD_0 dst_unused:UNUSED_PAD src0_sel:DWORD src1_sel:DWORD
    v_lshrrev_b32 v62, 5, v98
    v_lshlrev_b32_sdwa v64, 3, v99 dst_sel:WORD_0 dst_unused:UNUSED_PAD src0_sel:DWORD src1_sel:WORD_1
    v_alignbit_b32 v66, v101, v100, 21

    v_mov_b32 v23, v101
    v_alignbyte_b32 v22, v100, v99, 3
    v_alignbyte_b32 v21, v99, v98, 2
    v_alignbyte_b32 v20, v98, v112, 1
    v_and_b32 v62, 0xfff8, v62
    v_and_b32 v66, 0xfff8, v66
    s_cmp_lt_i32 s42, 2304
    s_cbranch_scc1 L_ufix_74
L_uback_75:

    v_subrev_co_u32 v20, s[72:73], 2.0, v20
    v_subrev_co_u32 v21, s[74:75], 2.0, v21
    v_subrev_co_u32 v22, s[76:77], 2.0, v22
    v_subrev_co_u32 v23, s[78:79], 2.0, v23
    s_mov_b64 exec, s[72:73]
    ds_read_b64 v[60:61], v60
    s_mov_b64 exec, s[74:75]
    ds_read_b64 v[62:63], v62
    s_mov_b64 exec, s[76:77]
    ds_read_b64 v[64:65], v64
    s_mov_b64 exec, s[78:79]
    ds_read_b64 v[66:67], v66
    s_mov_b64 exec, -1
    s_waitcnt lgkmcnt(4)
    v_or3_b32 v1, v68, v69, v1
    v_or3_b32 v1, v70, v71, v1
    v_or3_b32 v1, v72, v73, v1
    v_or3_b32 v1, v74, v75, v1
    s_waitcnt vmcnt(12)
    v_lshlrev_b32_sdwa v68, 3, v113 dst_sel:WORD_0 dst_unused:UNUSED_PAD src0_sel:DWORD src1_sel:DWORD
    v_lshrrev_b32 v70, 5, v102
    v_lshlrev_b32_sdwa v72, 3, v103 dst_sel:WORD_0 dst_unused:UNUSED_PAD src0_sel:DWORD src1_sel:WORD_1
    v_alignbit_b32 v74, v105, v104, 21

    v_mov_b32 v27, v105
    v_alignbyte_b32 v26, v104, v103, 3
    v_alignbyte_b32 v25, v103, v102, 2
    v_alignbyte_b32 v24, v102, v113, 1
    v_and_b32 v70, 0xfff8, v70
    v_and_b32 v74, 0xfff8, v74
    s_cmp_lt_i32 s42, 2816
    s_cbranch_scc1 L_ufix_76
L_uback_77:

    v_subrev_co_u32 v24, s[80:81], 2.0, v24
    v_subrev_co_u32 v25, s[82:83], 2.0, v25
    v_subrev_co_u32 v26, s[84:85], 2.0, v26
    v_subrev_co_u32 v27, s[86:87], 2.0, v27
    s_mov_b64 exec, s[80:81]
    ds_read_b64 v[68:69], v68
    s_mov_b64 exec, s[82:83]
    ds_read_b64 v[70:71], v70
    s_mov_b64 exec, s[84:85]
    ds_read_b64 v[72:73], v72
    s_mov_b64 exec, s[86:87]
    ds_read_b64 v[74:75], v74
    s_mov_b64 exec, -1
    buffer_load_dwordx4 v[76:79], v3, s[12:15], s43 offen
    s_add_u32 s52, s43, 16384
    buffer_load_dwordx4 v[80:83], v3, s[12:15], s52 offen
    s_add_u32 s52, s43, 32768
    buffer_load_dwordx4 v[84:87], v3, s[12:15], s52 offen
    s_add_u32 s52, s43, 49152
    v_lshlrev_b32 v119, 2, v0
    buffer_load_dword v88, v119, s[12:15], s52 offen
    s_add_u32 s54, s43, 50048
    buffer_load_dword v115, v89, s[60:63], s54 offen
    s_add_u32 s54, s50, 200000
    buffer_load_dword v115, v89, s[8:11], s54 offen
    s_waitcnt vmcnt(10)
    v_lshlrev_b32_sdwa v28, 3, v35 dst_sel:WORD_0 dst_unused:UNUSED_PAD src0_sel:DWORD src1_sel:DWORD
    v_lshrrev_b32 v30, 5, v4
    v_lshlrev_b32_sdwa v32, 3, v5 dst_sel:WORD_0 dst_unused:UNUSED_PAD src0_sel:DWORD src1_sel:WORD_1
    v_alignbit_b32 v34, v7, v6, 21

    v_alignbyte_b32 v6, v6, v5, 3
    v_alignbyte_b32 v5, v5, v4, 2
    v_alignbyte_b32 v4, v4, v35, 1
    v_and_b32 v30, 0xfff8, v30
    v_and_b32 v34, 0xfff8, v34
    s_cmp_lt_i32 s42, 256
    s_cbranch_scc1 L_ufix_78
L_uback_79:

    v_subrev_co_u32 v4, s[64:65], 2.0, v4
    v_subrev_co_u32 v5, s[66:67], 2.0, v5
    v_subrev_co_u32 v6, s[68:69], 2.0, v6
    v_subrev_co_u32 v7, s[70:71], 2.0, v7
    s_mov_b64 exec, s[64:65]
    ds_read_b64 v[28:29], v28
    s_mov_b64 exec, s[66:67]
    ds_read_b64 v[30:31], v30
    s_mov_b64 exec, s[68:69]
    ds_read_b64 v[32:33], v32
    s_mov_b64 exec, s[70:71]
    ds_read_b64 v[34:35], v34
    s_mov_b64 exec, -1
    s_waitcnt vmcnt(8)
    v_lshlrev_b32_sdwa v36, 3, v43 dst_sel:WORD_0 dst_unused:UNUSED_PAD src0_sel:DWORD src1_sel:DWORD
    v_lshrrev_b32 v38, 5, v8
    v_lshlrev_b32_sdwa v40, 3, v9 dst_sel:WORD_0 dst_unused:UNUSED_PAD src0_sel:DWORD src1_sel:WORD_1
    v_alignbit_b32 v42, v11, v10, 21

    v_alignbyte_b32 v10, v10, v9, 3
    v_alignbyte_b32 v9, v9, v8, 2
    v_alignbyte_b32 v8, v8, v43, 1
    v_and_b32 v38, 0xfff8, v38
    v_and_b32 v42, 0xfff8, v42
    s_cmp_lt_i32 s42, 768
    s_cbranch_scc1 L_ufix_80
L_uback_81:

    v_subrev_co_u32 v8, s[72:73], 2.0, v8
    v_subrev_co_u32 v9, s[74:75], 2.0, v9
    v_subrev_co_u32 v10, s[76:77], 2.0, v10
    v_subrev_co_u32 v11, s[78:79], 2.0, v11
    s_mov_b64 exec, s[72:73]
    ds_read_b64 v[36:37], v36
    s_mov_b64 exec, s[74:75]
    ds_read_b64 v[38:39], v38
    s_mov_b64 exec, s[76:77]
    ds_read_b64 v[40:41], v40
    s_mov_b64 exec, s[78:79]
    ds_read_b64 v[42:43], v42
    s_mov_b64 exec, -1
    s_mov_b32 s38, s5
    s_add_u32 s50, s50, 200000
    s_branch L_batch_61
L_bend_62:

    s_waitcnt vmcnt(0)
    s_load_dwordx2 s[68:69], s[0:1], 24
    s_load_dwordx4 s[88:91], s[0:1], 72
    s_load_dwordx2 s[76:77], s[0:1], 88
    s_load_dwordx2 s[80:81], s[0:1], 96
    s_mov_b32 s70, 1600000
    s_mov_b32 s71, 0x20000
    s_mov_b32 s78, 6400000
    s_mov_b32 s79, 0x20000
    s_movk_i32 s82, 256
    s_mov_b32 s83, 0x20000
    s_lshl_b32 s48, s36, 2
    s_mov_b32 s41, s37

    s_add_u32 s84, s6, 8896512
    s_addc_u32 s85, s7, 0
    s_mov_b32 s86, 76800000
    s_mov_b32 s87, 0x20000
    s_add_u32 s72, s6, 393216
    s_addc_u32 s73, s7, 0
    s_mov_b32 s74, 2097152
    s_mov_b32 s75, 0x20000
    s_waitcnt lgkmcnt(15)
    v_mad_i32_i16 v120, v28, v4, s96
    v_mad_i32_i16 v28, v28, v4, s96 op_sel:[1,0,0,0]
    v_mad_i32_i16 v121, v29, v4, s96
    v_mad_i32_i16 v29, v29, v4, s96 op_sel:[1,0,0,0]
    v_lshlrev_b32_sdwa v4, 3, v4 dst_sel:DWORD dst_unused:UNUSED_PAD src0_sel:DWORD src1_sel:WORD_1
    v_perm_b32 v28, v28, v120, s97
    v_perm_b32 v29, v29, v121, s97
    v_lshl_add_u64 v[28:29], v[28:29], 0, s[30:31]

    ds_add_rtn_u64 v[28:29], v4, v[28:29] offset:50000
    v_mad_i32_i16 v122, v30, v5, s96
    v_mad_i32_i16 v30, v30, v5, s96 op_sel:[1,0,0,0]
    v_mad_i32_i16 v123, v31, v5, s96
    v_mad_i32_i16 v31, v31, v5, s96 op_sel:[1,0,0,0]
    v_lshlrev_b32_sdwa v5, 3, v5 dst_sel:DWORD dst_unused:UNUSED_PAD src0_sel:DWORD src1_sel:WORD_1
    v_perm_b32 v30, v30, v122, s97
    v_perm_b32 v31, v31, v123, s97
    v_lshl_add_u64 v[30:31], v[30:31], 0, s[30:31]

    ds_add_rtn_u64 v[30:31], v5, v[30:31] offset:50000
    v_mad_i32_i16 v124, v32, v6, s96
    v_mad_i32_i16 v32, v32, v6, s96 op_sel:[1,0,0,0]
    v_mad_i32_i16 v125, v33, v6, s96
    v_mad_i32_i16 v33, v33, v6, s96 op_sel:[1,0,0,0]
    v_lshlrev_b32_sdwa v6, 3, v6 dst_sel:DWORD dst_unused:UNUSED_PAD src0_sel:DWORD src1_sel:WORD_1
    v_perm_b32 v32, v32, v124, s97
    v_perm_b32 v33, v33, v125, s97
    v_lshl_add_u64 v[32:33], v[32:33], 0, s[30:31]

    ds_add_rtn_u64 v[32:33], v6, v[32:33] offset:50000
    v_mad_i32_i16 v126, v34, v7, s96
    v_mad_i32_i16 v34, v34, v7, s96 op_sel:[1,0,0,0]
    v_mad_i32_i16 v127, v35, v7, s96
    v_mad_i32_i16 v35, v35, v7, s96 op_sel:[1,0,0,0]
    v_lshlrev_b32_sdwa v7, 3, v7 dst_sel:DWORD dst_unused:UNUSED_PAD src0_sel:DWORD src1_sel:WORD_1
    v_perm_b32 v34, v34, v126, s97
    v_perm_b32 v35, v35, v127, s97
    v_lshl_add_u64 v[34:35], v[34:35], 0, s[30:31]

    ds_add_rtn_u64 v[34:35], v7, v[34:35] offset:50000
    s_waitcnt lgkmcnt(0)
    s_load_dwordx8 s[12:19], s[88:89], 0
    s_load_dwordx8 s[56:63], s[90:91], 0

    s_mul_i32 s28, s41, 3125
    s_add_u32 s29, s28, 3126
    s_add_u32 s28, s28, 1
    s_lshr_b32 s28, s28, 1
    s_lshr_b32 s29, s29, 1
    s_sub_u32 s29, s29, s28
    s_sub_u32 s5, s29, 782
    s_mul_i32 s3, s36, 6250
    v_add_u32 v78, s28, v0
    v_mov_b32 v82, 0x2000000
    v_add_u32 v79, 782, v78
    v_cmp_gt_u32 vcc, 782, v0
    v_add_u32 v76, s3, v78
    v_add_u32 v77, s3, v79
    v_cndmask_b32 v76, v82, v76, vcc
    v_cmp_gt_u32 vcc, s5, v0
    v_lshlrev_b32 v78, 4, v78
    v_lshlrev_b32 v79, 4, v79
    v_cndmask_b32 v77, v82, v77, vcc
    v_lshlrev_b32 v80, 2, v76
    v_lshlrev_b32 v76, 4, v76
    v_lshlrev_b32 v81, 2, v77
    v_lshlrev_b32 v77, 4, v77
    buffer_load_dword v80, v80, s[68:71], 0 offen
    buffer_load_dword v81, v81, s[68:71], 0 offen
    buffer_load_dwordx4 v[86:89], v76, s[8:11], 0 offen
    buffer_load_dwordx4 v[90:93], v77, s[8:11], 0 offen

    v_mad_i32_i16 v120, v36, v8, s96
    v_mad_i32_i16 v36, v36, v8, s96 op_sel:[1,0,0,0]
    v_mad_i32_i16 v121, v37, v8, s96
    v_mad_i32_i16 v37, v37, v8, s96 op_sel:[1,0,0,0]
    v_lshlrev_b32_sdwa v8, 3, v8 dst_sel:DWORD dst_unused:UNUSED_PAD src0_sel:DWORD src1_sel:WORD_1
    v_perm_b32 v36, v36, v120, s97
    v_perm_b32 v37, v37, v121, s97
    v_lshl_add_u64 v[36:37], v[36:37], 0, s[30:31]

    ds_add_rtn_u64 v[36:37], v8, v[36:37] offset:50000
    v_mad_i32_i16 v122, v38, v9, s96
    v_mad_i32_i16 v38, v38, v9, s96 op_sel:[1,0,0,0]
    v_mad_i32_i16 v123, v39, v9, s96
    v_mad_i32_i16 v39, v39, v9, s96 op_sel:[1,0,0,0]
    v_lshlrev_b32_sdwa v9, 3, v9 dst_sel:DWORD dst_unused:UNUSED_PAD src0_sel:DWORD src1_sel:WORD_1
    v_perm_b32 v38, v38, v122, s97
    v_perm_b32 v39, v39, v123, s97
    v_lshl_add_u64 v[38:39], v[38:39], 0, s[30:31]

    ds_add_rtn_u64 v[38:39], v9, v[38:39] offset:50000
    v_mad_i32_i16 v124, v40, v10, s96
    v_mad_i32_i16 v40, v40, v10, s96 op_sel:[1,0,0,0]
    v_mad_i32_i16 v125, v41, v10, s96
    v_mad_i32_i16 v41, v41, v10, s96 op_sel:[1,0,0,0]
    v_lshlrev_b32_sdwa v10, 3, v10 dst_sel:DWORD dst_unused:UNUSED_PAD src0_sel:DWORD src1_sel:WORD_1
    v_perm_b32 v40, v40, v124, s97
    v_perm_b32 v41, v41, v125, s97
    v_lshl_add_u64 v[40:41], v[40:41], 0, s[30:31]

    ds_add_rtn_u64 v[40:41], v10, v[40:41] offset:50000
    v_mad_i32_i16 v126, v42, v11, s96
    v_mad_i32_i16 v42, v42, v11, s96 op_sel:[1,0,0,0]
    v_mad_i32_i16 v127, v43, v11, s96
    v_mad_i32_i16 v43, v43, v11, s96 op_sel:[1,0,0,0]
    v_lshlrev_b32_sdwa v11, 3, v11 dst_sel:DWORD dst_unused:UNUSED_PAD src0_sel:DWORD src1_sel:WORD_1
    v_perm_b32 v42, v42, v126, s97
    v_perm_b32 v43, v43, v127, s97
    v_lshl_add_u64 v[42:43], v[42:43], 0, s[30:31]

    ds_add_rtn_u64 v[42:43], v11, v[42:43] offset:50000
    v_or3_b32 v1, v28, v29, v1
    v_or3_b32 v1, v30, v31, v1
    v_or3_b32 v1, v32, v33, v1
    v_or3_b32 v1, v34, v35, v1
    v_mad_i32_i16 v120, v44, v12, s96
    v_mad_i32_i16 v44, v44, v12, s96 op_sel:[1,0,0,0]
    v_mad_i32_i16 v121, v45, v12, s96
    v_mad_i32_i16 v45, v45, v12, s96 op_sel:[1,0,0,0]
    v_lshlrev_b32_sdwa v12, 3, v12 dst_sel:DWORD dst_unused:UNUSED_PAD src0_sel:DWORD src1_sel:WORD_1
    v_perm_b32 v44, v44, v120, s97
    v_perm_b32 v45, v45, v121, s97
    v_lshl_add_u64 v[44:45], v[44:45], 0, s[30:31]

    ds_add_rtn_u64 v[44:45], v12, v[44:45] offset:50000
    v_mad_i32_i16 v122, v46, v13, s96
    v_mad_i32_i16 v46, v46, v13, s96 op_sel:[1,0,0,0]
    v_mad_i32_i16 v123, v47, v13, s96
    v_mad_i32_i16 v47, v47, v13, s96 op_sel:[1,0,0,0]
    v_lshlrev_b32_sdwa v13, 3, v13 dst_sel:DWORD dst_unused:UNUSED_PAD src0_sel:DWORD src1_sel:WORD_1
    v_perm_b32 v46, v46, v122, s97
    v_perm_b32 v47, v47, v123, s97
    v_lshl_add_u64 v[46:47], v[46:47], 0, s[30:31]

    ds_add_rtn_u64 v[46:47], v13, v[46:47] offset:50000
    v_mad_i32_i16 v124, v48, v14, s96
    v_mad_i32_i16 v48, v48, v14, s96 op_sel:[1,0,0,0]
    v_mad_i32_i16 v125, v49, v14, s96
    v_mad_i32_i16 v49, v49, v14, s96 op_sel:[1,0,0,0]
    v_lshlrev_b32_sdwa v14, 3, v14 dst_sel:DWORD dst_unused:UNUSED_PAD src0_sel:DWORD src1_sel:WORD_1
    v_perm_b32 v48, v48, v124, s97
    v_perm_b32 v49, v49, v125, s97
    v_lshl_add_u64 v[48:49], v[48:49], 0, s[30:31]

    ds_add_rtn_u64 v[48:49], v14, v[48:49] offset:50000
    v_mad_i32_i16 v126, v50, v15, s96
    v_mad_i32_i16 v50, v50, v15, s96 op_sel:[1,0,0,0]
    v_mad_i32_i16 v127, v51, v15, s96
    v_mad_i32_i16 v51, v51, v15, s96 op_sel:[1,0,0,0]
    v_lshlrev_b32_sdwa v15, 3, v15 dst_sel:DWORD dst_unused:UNUSED_PAD src0_sel:DWORD src1_sel:WORD_1
    v_perm_b32 v50, v50, v126, s97
    v_perm_b32 v51, v51, v127, s97
    v_lshl_add_u64 v[50:51], v[50:51], 0, s[30:31]

    ds_add_rtn_u64 v[50:51], v15, v[50:51] offset:50000
    s_waitcnt lgkmcnt(4)
    v_or3_b32 v1, v36, v37, v1
    v_or3_b32 v1, v38, v39, v1
    v_or3_b32 v1, v40, v41, v1
    v_or3_b32 v1, v42, v43, v1
    v_mad_i32_i16 v120, v52, v16, s96
    v_mad_i32_i16 v52, v52, v16, s96 op_sel:[1,0,0,0]
    v_mad_i32_i16 v121, v53, v16, s96
    v_mad_i32_i16 v53, v53, v16, s96 op_sel:[1,0,0,0]
    v_lshlrev_b32_sdwa v16, 3, v16 dst_sel:DWORD dst_unused:UNUSED_PAD src0_sel:DWORD src1_sel:WORD_1
    v_perm_b32 v52, v52, v120, s97
    v_perm_b32 v53, v53, v121, s97
    v_lshl_add_u64 v[52:53], v[52:53], 0, s[30:31]

    ds_add_rtn_u64 v[52:53], v16, v[52:53] offset:50000
    v_mad_i32_i16 v122, v54, v17, s96
    v_mad_i32_i16 v54, v54, v17, s96 op_sel:[1,0,0,0]
    v_mad_i32_i16 v123, v55, v17, s96
    v_mad_i32_i16 v55, v55, v17, s96 op_sel:[1,0,0,0]
    v_lshlrev_b32_sdwa v17, 3, v17 dst_sel:DWORD dst_unused:UNUSED_PAD src0_sel:DWORD src1_sel:WORD_1
    v_perm_b32 v54, v54, v122, s97
    v_perm_b32 v55, v55, v123, s97
    v_lshl_add_u64 v[54:55], v[54:55], 0, s[30:31]

    ds_add_rtn_u64 v[54:55], v17, v[54:55] offset:50000
    v_mad_i32_i16 v124, v56, v18, s96
    v_mad_i32_i16 v56, v56, v18, s96 op_sel:[1,0,0,0]
    v_mad_i32_i16 v125, v57, v18, s96
    v_mad_i32_i16 v57, v57, v18, s96 op_sel:[1,0,0,0]
    v_lshlrev_b32_sdwa v18, 3, v18 dst_sel:DWORD dst_unused:UNUSED_PAD src0_sel:DWORD src1_sel:WORD_1
    v_perm_b32 v56, v56, v124, s97
    v_perm_b32 v57, v57, v125, s97
    v_lshl_add_u64 v[56:57], v[56:57], 0, s[30:31]

    ds_add_rtn_u64 v[56:57], v18, v[56:57] offset:50000
    v_mad_i32_i16 v126, v58, v19, s96
    v_mad_i32_i16 v58, v58, v19, s96 op_sel:[1,0,0,0]
    v_mad_i32_i16 v127, v59, v19, s96
    v_mad_i32_i16 v59, v59, v19, s96 op_sel:[1,0,0,0]
    v_lshlrev_b32_sdwa v19, 3, v19 dst_sel:DWORD dst_unused:UNUSED_PAD src0_sel:DWORD src1_sel:WORD_1
    v_perm_b32 v58, v58, v126, s97
    v_perm_b32 v59, v59, v127, s97
    v_lshl_add_u64 v[58:59], v[58:59], 0, s[30:31]

    ds_add_rtn_u64 v[58:59], v19, v[58:59] offset:50000
    s_waitcnt lgkmcnt(4)
    v_or3_b32 v1, v44, v45, v1
    v_or3_b32 v1, v46, v47, v1
    v_or3_b32 v1, v48, v49, v1
    v_or3_b32 v1, v50, v51, v1
    s_waitcnt vmcnt(2)
    v_lshlrev_b32_sdwa v82, 5, v80 dst_sel:DWORD dst_unused:UNUSED_PAD src0_sel:DWORD src1_sel:WORD_0
    v_lshlrev_b32_sdwa v83, 5, v80 dst_sel:DWORD dst_unused:UNUSED_PAD src0_sel:DWORD src1_sel:WORD_1
    v_lshlrev_b32_sdwa v84, 5, v81 dst_sel:DWORD dst_unused:UNUSED_PAD src0_sel:DWORD src1_sel:WORD_0
    v_lshlrev_b32_sdwa v85, 5, v81 dst_sel:DWORD dst_unused:UNUSED_PAD src0_sel:DWORD src1_sel:WORD_1
    buffer_load_dwordx4 v[94:97], v82, s[72:75], 0 offen
    buffer_load_dwordx2 v[110:111], v82, s[72:75], 0 offen offset:16

    buffer_load_dwordx4 v[98:101], v83, s[72:75], 0 offen
    buffer_load_dwordx2 v[112:113], v83, s[72:75], 0 offen offset:16

    buffer_load_dwordx4 v[102:105], v84, s[72:75], 0 offen
    buffer_load_dwordx2 v[114:115], v84, s[72:75], 0 offen offset:16

    buffer_load_dwordx4 v[106:109], v85, s[72:75], 0 offen
    buffer_load_dwordx2 v[116:117], v85, s[72:75], 0 offen offset:16

    v_mad_i32_i16 v120, v60, v20, s96
    v_mad_i32_i16 v60, v60, v20, s96 op_sel:[1,0,0,0]
    v_mad_i32_i16 v121, v61, v20, s96
    v_mad_i32_i16 v61, v61, v20, s96 op_sel:[1,0,0,0]
    v_lshlrev_b32_sdwa v20, 3, v20 dst_sel:DWORD dst_unused:UNUSED_PAD src0_sel:DWORD src1_sel:WORD_1
    v_perm_b32 v60, v60, v120, s97
    v_perm_b32 v61, v61, v121, s97
    v_lshl_add_u64 v[60:61], v[60:61], 0, s[30:31]

    ds_add_rtn_u64 v[60:61], v20, v[60:61] offset:50000
    v_mad_i32_i16 v122, v62, v21, s96
    v_mad_i32_i16 v62, v62, v21, s96 op_sel:[1,0,0,0]
    v_mad_i32_i16 v123, v63, v21, s96
    v_mad_i32_i16 v63, v63, v21, s96 op_sel:[1,0,0,0]
    v_lshlrev_b32_sdwa v21, 3, v21 dst_sel:DWORD dst_unused:UNUSED_PAD src0_sel:DWORD src1_sel:WORD_1
    v_perm_b32 v62, v62, v122, s97
    v_perm_b32 v63, v63, v123, s97
    v_lshl_add_u64 v[62:63], v[62:63], 0, s[30:31]

    ds_add_rtn_u64 v[62:63], v21, v[62:63] offset:50000
    v_mad_i32_i16 v124, v64, v22, s96
    v_mad_i32_i16 v64, v64, v22, s96 op_sel:[1,0,0,0]
    v_mad_i32_i16 v125, v65, v22, s96
    v_mad_i32_i16 v65, v65, v22, s96 op_sel:[1,0,0,0]
    v_lshlrev_b32_sdwa v22, 3, v22 dst_sel:DWORD dst_unused:UNUSED_PAD src0_sel:DWORD src1_sel:WORD_1
    v_perm_b32 v64, v64, v124, s97
    v_perm_b32 v65, v65, v125, s97
    v_lshl_add_u64 v[64:65], v[64:65], 0, s[30:31]

    ds_add_rtn_u64 v[64:65], v22, v[64:65] offset:50000
    v_mad_i32_i16 v126, v66, v23, s96
    v_mad_i32_i16 v66, v66, v23, s96 op_sel:[1,0,0,0]
    v_mad_i32_i16 v127, v67, v23, s96
    v_mad_i32_i16 v67, v67, v23, s96 op_sel:[1,0,0,0]
    v_lshlrev_b32_sdwa v23, 3, v23 dst_sel:DWORD dst_unused:UNUSED_PAD src0_sel:DWORD src1_sel:WORD_1
    v_perm_b32 v66, v66, v126, s97
    v_perm_b32 v67, v67, v127, s97
    v_lshl_add_u64 v[66:67], v[66:67], 0, s[30:31]

    ds_add_rtn_u64 v[66:67], v23, v[66:67] offset:50000
    s_waitcnt lgkmcnt(4)
    v_or3_b32 v1, v52, v53, v1
    v_or3_b32 v1, v54, v55, v1
    v_or3_b32 v1, v56, v57, v1
    v_or3_b32 v1, v58, v59, v1
    v_mad_i32_i16 v120, v68, v24, s96
    v_mad_i32_i16 v68, v68, v24, s96 op_sel:[1,0,0,0]
    v_mad_i32_i16 v121, v69, v24, s96
    v_mad_i32_i16 v69, v69, v24, s96 op_sel:[1,0,0,0]
    v_lshlrev_b32_sdwa v24, 3, v24 dst_sel:DWORD dst_unused:UNUSED_PAD src0_sel:DWORD src1_sel:WORD_1
    v_perm_b32 v68, v68, v120, s97
    v_perm_b32 v69, v69, v121, s97
    v_lshl_add_u64 v[68:69], v[68:69], 0, s[30:31]

    ds_add_rtn_u64 v[68:69], v24, v[68:69] offset:50000
    v_mad_i32_i16 v122, v70, v25, s96
    v_mad_i32_i16 v70, v70, v25, s96 op_sel:[1,0,0,0]
    v_mad_i32_i16 v123, v71, v25, s96
    v_mad_i32_i16 v71, v71, v25, s96 op_sel:[1,0,0,0]
    v_lshlrev_b32_sdwa v25, 3, v25 dst_sel:DWORD dst_unused:UNUSED_PAD src0_sel:DWORD src1_sel:WORD_1
    v_perm_b32 v70, v70, v122, s97
    v_perm_b32 v71, v71, v123, s97
    v_lshl_add_u64 v[70:71], v[70:71], 0, s[30:31]

    ds_add_rtn_u64 v[70:71], v25, v[70:71] offset:50000
    v_mad_i32_i16 v124, v72, v26, s96
    v_mad_i32_i16 v72, v72, v26, s96 op_sel:[1,0,0,0]
    v_mad_i32_i16 v125, v73, v26, s96
    v_mad_i32_i16 v73, v73, v26, s96 op_sel:[1,0,0,0]
    v_lshlrev_b32_sdwa v26, 3, v26 dst_sel:DWORD dst_unused:UNUSED_PAD src0_sel:DWORD src1_sel:WORD_1
    v_perm_b32 v72, v72, v124, s97
    v_perm_b32 v73, v73, v125, s97
    v_lshl_add_u64 v[72:73], v[72:73], 0, s[30:31]

    ds_add_rtn_u64 v[72:73], v26, v[72:73] offset:50000
    v_mad_i32_i16 v126, v74, v27, s96
    v_mad_i32_i16 v74, v74, v27, s96 op_sel:[1,0,0,0]
    v_mad_i32_i16 v127, v75, v27, s96
    v_mad_i32_i16 v75, v75, v27, s96 op_sel:[1,0,0,0]
    v_lshlrev_b32_sdwa v27, 3, v27 dst_sel:DWORD dst_unused:UNUSED_PAD src0_sel:DWORD src1_sel:WORD_1
    v_perm_b32 v74, v74, v126, s97
    v_perm_b32 v75, v75, v127, s97
    v_lshl_add_u64 v[74:75], v[74:75], 0, s[30:31]

    ds_add_rtn_u64 v[74:75], v27, v[74:75] offset:50000
    s_waitcnt lgkmcnt(4)
    v_or3_b32 v1, v60, v61, v1
    v_or3_b32 v1, v62, v63, v1
    v_or3_b32 v1, v64, v65, v1
    v_or3_b32 v1, v66, v67, v1
    s_waitcnt lgkmcnt(0)
    v_or3_b32 v1, v68, v69, v1
    v_or3_b32 v1, v70, v71, v1
    v_or3_b32 v1, v72, v73, v1
    v_or3_b32 v1, v74, v75, v1
    s_barrier

    v_add_u32 v40, 50000, v3
    v_add_u32 v41, 115536, v3
    v_cmp_gt_u32 vcc, 106, v0

    v_mov_b32 v28, 0
    v_mov_b32 v29, 0
    v_mov_b32 v30, 0
    v_mov_b32 v31, 0
    ds_read_b128 v[4:7], v40 offset:0
    ds_read_b128 v[8:11], v40 offset:16384
    ds_read_b128 v[12:15], v40 offset:32768
    ds_read_b128 v[16:19], v40 offset:49152
    ds_read_b128 v[20:23], v41 offset:0
    ds_read_b128 v[24:27], v41 offset:16384
    s_mov_b64 exec, vcc
    ds_read_b128 v[28:31], v41 offset:32768
    s_mov_b64 exec, -1
    s_mul_i32 s3, s37, 6400000
    s_mul_i32 s5, s36, 100000
    s_add_u32 s3, s3, s5
    s_add_u32 s3, s3, 8896512
    v_bfrev_b32 v42, 1

    s_add_u32 s20, s6, s3
    s_addc_u32 s21, s7, 0
    s_mov_b32 s22, 100000
    s_mov_b32 s23, 0x20000
    s_sub_u32 s3, 0, s28
    v_add_u32 v43, s3, v0
    v_cmp_gt_u32 vcc, s29, v43
    s_mov_b32 s3, 0
    s_waitcnt lgkmcnt(6)
    v_cndmask_b32 v43, v3, v42, vcc
    buffer_store_dwordx4 v[4:7], v43, s[20:23], s3 offen sc1

    s_sub_u32 s3, 1024, s28
    v_add_u32 v43, s3, v0
    v_cmp_gt_u32 vcc, s29, v43
    s_mov_b32 s3, 16384
    s_waitcnt lgkmcnt(5)
    v_cndmask_b32 v43, v3, v42, vcc
    buffer_store_dwordx4 v[8:11], v43, s[20:23], s3 offen sc1

    s_sub_u32 s3, 2048, s28
    v_add_u32 v43, s3, v0
    v_cmp_gt_u32 vcc, s29, v43
    s_mov_b32 s3, 32768
    s_waitcnt lgkmcnt(4)
    v_cndmask_b32 v43, v3, v42, vcc
    buffer_store_dwordx4 v[12:15], v43, s[20:23], s3 offen sc1

    s_sub_u32 s3, 3072, s28
    v_add_u32 v43, s3, v0
    v_cmp_gt_u32 vcc, s29, v43
    s_mov_b32 s3, 49152
    s_waitcnt lgkmcnt(3)
    v_cndmask_b32 v43, v3, v42, vcc
    buffer_store_dwordx4 v[16:19], v43, s[20:23], s3 offen sc1

    s_sub_u32 s3, 4096, s28
    v_add_u32 v43, s3, v0
    v_cmp_gt_u32 vcc, s29, v43
    s_mov_b32 s3, 65536
    s_waitcnt lgkmcnt(2)
    v_cndmask_b32 v43, v3, v42, vcc
    buffer_store_dwordx4 v[20:23], v43, s[20:23], s3 offen sc1

    s_sub_u32 s3, 5120, s28
    v_add_u32 v43, s3, v0
    v_cmp_gt_u32 vcc, s29, v43
    s_mov_b32 s3, 81920
    s_waitcnt lgkmcnt(1)
    v_cndmask_b32 v43, v3, v42, vcc
    buffer_store_dwordx4 v[24:27], v43, s[20:23], s3 offen sc1

    s_sub_u32 s3, 6144, s28
    v_add_u32 v43, s3, v0
    v_cmp_gt_u32 vcc, s29, v43
    s_mov_b32 s3, 98304
    s_waitcnt lgkmcnt(0)
    v_cndmask_b32 v43, v3, v42, vcc
    buffer_store_dwordx4 v[28:31], v43, s[20:23], s3 offen sc1

    v_or3_b32 v1, v4, v5, v1
    v_or3_b32 v1, v6, v7, v1
    v_or3_b32 v1, v8, v9, v1
    v_or3_b32 v1, v10, v11, v1
    v_or3_b32 v1, v12, v13, v1
    v_or3_b32 v1, v14, v15, v1
    v_or3_b32 v1, v16, v17, v1
    v_or3_b32 v1, v18, v19, v1
    v_or3_b32 v1, v20, v21, v1
    v_or3_b32 v1, v22, v23, v1
    v_or3_b32 v1, v24, v25, v1
    v_or3_b32 v1, v26, v27, v1
    v_or3_b32 v1, v28, v29, v1
    v_or3_b32 v1, v30, v31, v1
    v_and_b32 v1, 0x80008000, v1
    v_cmp_ne_u32 vcc, 0, v1
    v_mov_b32 v40, 150024
    v_mov_b32 v41, 1
    s_cbranch_vccz L_nf_82
    ds_write_b32 v40, v41
L_nf_82:
    s_mov_b32 s33, 1
    s_mov_b32 s49, s37
    s_waitcnt vmcnt(0) lgkmcnt(0)

    s_barrier
    ds_read_b32 v41, v40
    s_waitcnt lgkmcnt(0)
    v_readfirstlane_b32 s3, v41
    s_nop 1
    s_cmp_lg_u32 s3, 0
    s_cbranch_scc1 L_p2slow_48

L_meet_84:
    v_readfirstlane_b32 s3, v0
    v_mov_b32 v118, 150016
    s_nop 0
    s_cmp_eq_u32 s3, 960
    s_cbranch_scc1 L_sync_91
L_bcast_86:
    s_barrier

    ds_read_b32 v119, v118
    s_waitcnt lgkmcnt(0)
    v_readfirstlane_b32 s35, v119
    s_nop 1
    s_bitcmp1_b32 s35, 16
    s_cbranch_scc1 L_fend_92
L_post_88:
    v_cmp_gt_u32 vcc, 782, v0
    s_mov_b64 exec, vcc
    s_cbranch_execz L_postend_89

    s_cmp_eq_u32 s49, 0
    s_cbranch_scc1 L_own_98
    s_mov_b32 s3, 0
    buffer_load_dwordx4 v[36:39], v76, s[84:87], s3 offen sc1
    buffer_load_dwordx4 v[52:55], v77, s[84:87], s3 offen sc1
L_obk_99:
    s_cmp_eq_u32 s49, 1
    s_cbranch_scc1 L_own_100
    s_mov_b32 s3, 6400000
    buffer_load_dwordx4 v[40:43], v76, s[84:87], s3 offen sc1
    buffer_load_dwordx4 v[56:59], v77, s[84:87], s3 offen sc1
L_obk_101:
    s_cmp_eq_u32 s49, 2
    s_cbranch_scc1 L_own_102
    s_mov_b32 s3, 12800000
    buffer_load_dwordx4 v[44:47], v76, s[84:87], s3 offen sc1
    buffer_load_dwordx4 v[60:63], v77, s[84:87], s3 offen sc1
L_obk_103:
    s_cmp_eq_u32 s49, 3
    s_cbranch_scc1 L_own_104
    s_mov_b32 s3, 19200000
    buffer_load_dwordx4 v[48:51], v76, s[84:87], s3 offen sc1
    buffer_load_dwordx4 v[64:67], v77, s[84:87], s3 offen sc1
L_obk_105:
    s_and_b32 s3, s35, 0xf0
    s_waitcnt vmcnt(0) lgkmcnt(0)
    s_cbranch_scc1 L_fgen_106

    v_add_u32 v36, v36, v40
    v_add_u32 v44, v44, v48
    v_add_u32 v37, v37, v41
    v_add_u32 v45, v45, v49
    v_add_u32 v38, v38, v42
    v_add_u32 v46, v46, v50
    v_add_u32 v39, v39, v43
    v_add_u32 v47, v47, v51
    v_add_u32_sdwa v4, v36, v44 dst_sel:DWORD dst_unused:UNUSED_PAD src0_sel:WORD_0 src1_sel:WORD_0
    v_add_u32_sdwa v5, v36, v44 dst_sel:DWORD dst_unused:UNUSED_PAD src0_sel:WORD_1 src1_sel:WORD_1
    v_add_u32_sdwa v6, v37, v45 dst_sel:DWORD dst_unused:UNUSED_PAD src0_sel:WORD_0 src1_sel:WORD_0
    v_add_u32_sdwa v7, v37, v45 dst_sel:DWORD dst_unused:UNUSED_PAD src0_sel:WORD_1 src1_sel:WORD_1
    v_add_u32_sdwa v8, v38, v46 dst_sel:DWORD dst_unused:UNUSED_PAD src0_sel:WORD_0 src1_sel:WORD_0
    v_add_u32_sdwa v9, v38, v46 dst_sel:DWORD dst_unused:UNUSED_PAD src0_sel:WORD_1 src1_sel:WORD_1
    v_add_u32_sdwa v10, v39, v47 dst_sel:DWORD dst_unused:UNUSED_PAD src0_sel:WORD_0 src1_sel:WORD_0
    v_add_u32_sdwa v11, v39, v47 dst_sel:DWORD dst_unused:UNUSED_PAD src0_sel:WORD_1 src1_sel:WORD_1
    v_add_u32 v52, v52, v56
    v_add_u32 v60, v60, v64
    v_add_u32 v53, v53, v57
    v_add_u32 v61, v61, v65
    v_add_u32 v54, v54, v58
    v_add_u32 v62, v62, v66
    v_add_u32 v55, v55, v59
    v_add_u32 v63, v63, v67
    v_add_u32_sdwa v12, v52, v60 dst_sel:DWORD dst_unused:UNUSED_PAD src0_sel:WORD_0 src1_sel:WORD_0
    v_add_u32_sdwa v13, v52, v60 dst_sel:DWORD dst_unused:UNUSED_PAD src0_sel:WORD_1 src1_sel:WORD_1
    v_add_u32_sdwa v14, v53, v61 dst_sel:DWORD dst_unused:UNUSED_PAD src0_sel:WORD_0 src1_sel:WORD_0
    v_add_u32_sdwa v15, v53, v61 dst_sel:DWORD dst_unused:UNUSED_PAD src0_sel:WORD_1 src1_sel:WORD_1
    v_add_u32_sdwa v16, v54, v62 dst_sel:DWORD dst_unused:UNUSED_PAD src0_sel:WORD_0 src1_sel:WORD_0
    v_add_u32_sdwa v17, v54, v62 dst_sel:DWORD dst_unused:UNUSED_PAD src0_sel:WORD_1 src1_sel:WORD_1
    v_add_u32_sdwa v18, v55, v63 dst_sel:DWORD dst_unused:UNUSED_PAD src0_sel:WORD_0 src1_sel:WORD_0
    v_add_u32_sdwa v19, v55, v63 dst_sel:DWORD dst_unused:UNUSED_PAD src0_sel:WORD_1 src1_sel:WORD_1
    v_add_u32 v4, 0xffff0000, v4
    v_add_u32 v5, 0xffff0000, v5
    v_add_u32 v6, 0xffff0000, v6
    v_add_u32 v7, 0xffff0000, v7
    v_add_u32 v8, 0xffff0000, v8
    v_add_u32 v9, 0xffff0000, v9
    v_add_u32 v10, 0xffff0000, v10
    v_add_u32 v11, 0xffff0000, v11
    v_add_u32 v12, 0xffff0000, v12
    v_add_u32 v13, 0xffff0000, v13
    v_add_u32 v14, 0xffff0000, v14
    v_add_u32 v15, 0xffff0000, v15
    v_add_u32 v16, 0xffff0000, v16
    v_add_u32 v17, 0xffff0000, v17
    v_add_u32 v18, 0xffff0000, v18
    v_add_u32 v19, 0xffff0000, v19
    v_cvt_f32_i32 v4, v4
    v_cvt_f32_i32 v5, v5
    v_cvt_f32_i32 v6, v6
    v_cvt_f32_i32 v7, v7
    v_cvt_f32_i32 v8, v8
    v_cvt_f32_i32 v9, v9
    v_cvt_f32_i32 v10, v10
    v_cvt_f32_i32 v11, v11
    v_cvt_f32_i32 v12, v12
    v_cvt_f32_i32 v13, v13
    v_cvt_f32_i32 v14, v14
    v_cvt_f32_i32 v15, v15
    v_cvt_f32_i32 v16, v16
    v_cvt_f32_i32 v17, v17
    v_cvt_f32_i32 v18, v18
    v_cvt_f32_i32 v19, v19
    v_mul_f32 v4, s34, v4
    v_mul_f32 v5, s34, v5
    v_mul_f32 v6, s34, v6
    v_mul_f32 v7, s34, v7
    v_mul_f32 v8, s34, v8
    v_mul_f32 v9, s34, v9
    v_mul_f32 v10, s34, v10
    v_mul_f32 v11, s34, v11
    v_mul_f32 v12, s34, v12
    v_mul_f32 v13, s34, v13
    v_mul_f32 v14, s34, v14
    v_mul_f32 v15, s34, v15
    v_mul_f32 v16, s34, v16
    v_mul_f32 v17, s34, v17
    v_mul_f32 v18, s34, v18
    v_mul_f32 v19, s34, v19
L_fbk_107:
    s_lshl_b32 s52, s12, 16
    v_mul_f32 v20, s52, v4
    v_mul_f32 v24, s52, v8
    v_mul_f32 v28, s52, v12
    v_mul_f32 v32, s52, v16
    s_and_b32 s53, s12, s32
    v_mul_f32 v21, s53, v4
    v_mul_f32 v25, s53, v8
    v_mul_f32 v29, s53, v12
    v_mul_f32 v33, s53, v16
    s_lshl_b32 s52, s13, 16
    v_mul_f32 v22, s52, v4
    v_mul_f32 v26, s52, v8
    v_mul_f32 v30, s52, v12
    v_mul_f32 v34, s52, v16
    s_and_b32 s53, s13, s32
    v_mul_f32 v23, s53, v4
    v_mul_f32 v27, s53, v8
    v_mul_f32 v31, s53, v12
    v_mul_f32 v35, s53, v16
    s_lshl_b32 s52, s14, 16
    v_fmac_f32 v20, s52, v5
    v_fmac_f32 v24, s52, v9
    v_fmac_f32 v28, s52, v13
    v_fmac_f32 v32, s52, v17
    s_and_b32 s53, s14, s32
    v_fmac_f32 v21, s53, v5
    v_fmac_f32 v25, s53, v9
    v_fmac_f32 v29, s53, v13
    v_fmac_f32 v33, s53, v17
    s_lshl_b32 s52, s15, 16
    v_fmac_f32 v22, s52, v5
    v_fmac_f32 v26, s52, v9
    v_fmac_f32 v30, s52, v13
    v_fmac_f32 v34, s52, v17
    s_and_b32 s53, s15, s32
    v_fmac_f32 v23, s53, v5
    v_fmac_f32 v27, s53, v9
    v_fmac_f32 v31, s53, v13
    v_fmac_f32 v35, s53, v17
    s_lshl_b32 s52, s16, 16
    v_fmac_f32 v20, s52, v6
    v_fmac_f32 v24, s52, v10
    v_fmac_f32 v28, s52, v14
    v_fmac_f32 v32, s52, v18
    s_and_b32 s53, s16, s32
    v_fmac_f32 v21, s53, v6
    v_fmac_f32 v25, s53, v10
    v_fmac_f32 v29, s53, v14
    v_fmac_f32 v33, s53, v18
    s_lshl_b32 s52, s17, 16
    v_fmac_f32 v22, s52, v6
    v_fmac_f32 v26, s52, v10
    v_fmac_f32 v30, s52, v14
    v_fmac_f32 v34, s52, v18
    s_and_b32 s53, s17, s32
    v_fmac_f32 v23, s53, v6
    v_fmac_f32 v27, s53, v10
    v_fmac_f32 v31, s53, v14
    v_fmac_f32 v35, s53, v18
    s_lshl_b32 s52, s18, 16
    v_fmac_f32 v20, s52, v7
    v_fmac_f32 v24, s52, v11
    v_fmac_f32 v28, s52, v15
    v_fmac_f32 v32, s52, v19
    s_and_b32 s53, s18, s32
    v_fmac_f32 v21, s53, v7
    v_fmac_f32 v25, s53, v11
    v_fmac_f32 v29, s53, v15
    v_fmac_f32 v33, s53, v19
    s_lshl_b32 s52, s19, 16
    v_fmac_f32 v22, s52, v7
    v_fmac_f32 v26, s52, v11
    v_fmac_f32 v30, s52, v15
    v_fmac_f32 v34, s52, v19
    s_and_b32 s53, s19, s32
    v_fmac_f32 v23, s53, v7
    v_fmac_f32 v27, s53, v11
    v_fmac_f32 v31, s53, v15
    v_fmac_f32 v35, s53, v19
    v_mul_f32 v20, v20, v94
    v_mul_f32 v21, v21, v95
    v_mul_f32 v22, v22, v96
    v_mul_f32 v23, v23, v97
    v_mul_f32 v24, v24, v98
    v_mul_f32 v25, v25, v99
    v_mul_f32 v26, v26, v100
    v_mul_f32 v27, v27, v101
    v_mul_f32 v28, v28, v102
    v_mul_f32 v29, v29, v103
    v_mul_f32 v30, v30, v104
    v_mul_f32 v31, v31, v105
    v_mul_f32 v32, v32, v106
    v_mul_f32 v33, v33, v107
    v_mul_f32 v34, v34, v108
    v_mul_f32 v35, v35, v109
    v_cvt_pk_bf16_f32 v20, v20, v21
    v_cvt_pk_bf16_f32 v22, v22, v23
    v_cvt_pk_bf16_f32 v24, v24, v25
    v_cvt_pk_bf16_f32 v26, v26, v27
    v_cvt_pk_bf16_f32 v28, v28, v29
    v_cvt_pk_bf16_f32 v30, v30, v31
    v_cvt_pk_bf16_f32 v32, v32, v33
    v_cvt_pk_bf16_f32 v34, v34, v35
    s_pack_ll_b32_b16 s52, s56, s58
    v_dot2_f32_bf16 v4, v20, s52, 0
    v_dot2_f32_bf16 v8, v24, s52, 0
    v_dot2_f32_bf16 v12, v28, s52, 0
    v_dot2_f32_bf16 v16, v32, s52, 0
    s_pack_hh_b32_b16 s53, s56, s58
    v_dot2_f32_bf16 v5, v20, s53, 0
    v_dot2_f32_bf16 v9, v24, s53, 0
    v_dot2_f32_bf16 v13, v28, s53, 0
    v_dot2_f32_bf16 v17, v32, s53, 0
    s_pack_ll_b32_b16 s52, s57, s59
    v_dot2_f32_bf16 v6, v20, s52, 0
    v_dot2_f32_bf16 v10, v24, s52, 0
    v_dot2_f32_bf16 v14, v28, s52, 0
    v_dot2_f32_bf16 v18, v32, s52, 0
    s_pack_hh_b32_b16 s53, s57, s59
    v_dot2_f32_bf16 v7, v20, s53, 0
    v_dot2_f32_bf16 v11, v24, s53, 0
    v_dot2_f32_bf16 v15, v28, s53, 0
    v_dot2_f32_bf16 v19, v32, s53, 0
    s_pack_ll_b32_b16 s52, s60, s62
    v_dot2_f32_bf16 v4, v22, s52, v4
    v_dot2_f32_bf16 v8, v26, s52, v8
    v_dot2_f32_bf16 v12, v30, s52, v12
    v_dot2_f32_bf16 v16, v34, s52, v16
    s_pack_hh_b32_b16 s53, s60, s62
    v_dot2_f32_bf16 v5, v22, s53, v5
    v_dot2_f32_bf16 v9, v26, s53, v9
    v_dot2_f32_bf16 v13, v30, s53, v13
    v_dot2_f32_bf16 v17, v34, s53, v17
    s_pack_ll_b32_b16 s52, s61, s63
    v_dot2_f32_bf16 v6, v22, s52, v6
    v_dot2_f32_bf16 v10, v26, s52, v10
    v_dot2_f32_bf16 v14, v30, s52, v14
    v_dot2_f32_bf16 v18, v34, s52, v18
    s_pack_hh_b32_b16 s53, s61, s63
    v_dot2_f32_bf16 v7, v22, s53, v7
    v_dot2_f32_bf16 v11, v26, s53, v11
    v_dot2_f32_bf16 v15, v30, s53, v15
    v_dot2_f32_bf16 v19, v34, s53, v19
    v_lshlrev_b32 v36, 16, v86
    v_and_b32 v37, s32, v86
    v_lshlrev_b32 v52, 16, v110
    v_and_b32 v53, s32, v110
    v_lshlrev_b32 v38, 16, v87
    v_and_b32 v39, s32, v87
    v_lshlrev_b32 v54, 16, v111
    v_and_b32 v55, s32, v111
    v_lshlrev_b32 v40, 16, v88
    v_and_b32 v41, s32, v88
    v_lshlrev_b32 v56, 16, v112
    v_and_b32 v57, s32, v112
    v_lshlrev_b32 v42, 16, v89
    v_and_b32 v43, s32, v89
    v_lshlrev_b32 v58, 16, v113
    v_and_b32 v59, s32, v113
    v_lshlrev_b32 v44, 16, v90
    v_and_b32 v45, s32, v90
    v_lshlrev_b32 v60, 16, v114
    v_and_b32 v61, s32, v114
    v_lshlrev_b32 v46, 16, v91
    v_and_b32 v47, s32, v91
    v_lshlrev_b32 v62, 16, v115
    v_and_b32 v63, s32, v115
    v_lshlrev_b32 v48, 16, v92
    v_and_b32 v49, s32, v92
    v_lshlrev_b32 v64, 16, v116
    v_and_b32 v65, s32, v116
    v_lshlrev_b32 v50, 16, v93
    v_and_b32 v51, s32, v93
    v_lshlrev_b32 v66, 16, v117
    v_and_b32 v67, s32, v117
    v_cvt_pk_bf16_f32 v4, v4, v5
    v_cvt_pk_bf16_f32 v6, v6, v7
    v_cvt_pk_bf16_f32 v8, v8, v9
    v_cvt_pk_bf16_f32 v10, v10, v11
    v_cvt_pk_bf16_f32 v12, v12, v13
    v_cvt_pk_bf16_f32 v14, v14, v15
    v_cvt_pk_bf16_f32 v16, v16, v17
    v_cvt_pk_bf16_f32 v18, v18, v19
    v_and_b32 v5, s32, v4
    v_lshlrev_b32 v4, 16, v4
    v_and_b32 v7, s32, v6
    v_lshlrev_b32 v6, 16, v6
    v_and_b32 v9, s32, v8
    v_lshlrev_b32 v8, 16, v8
    v_and_b32 v11, s32, v10
    v_lshlrev_b32 v10, 16, v10
    v_and_b32 v13, s32, v12
    v_lshlrev_b32 v12, 16, v12
    v_and_b32 v15, s32, v14
    v_lshlrev_b32 v14, 16, v14
    v_and_b32 v17, s32, v16
    v_lshlrev_b32 v16, 16, v16
    v_and_b32 v19, s32, v18
    v_lshlrev_b32 v18, 16, v18
    v_mul_f32 v4, v4, v52
    v_mul_f32 v5, v5, v53
    v_mul_f32 v6, v6, v54
    v_mul_f32 v7, v7, v55
    v_mul_f32 v8, v8, v56
    v_mul_f32 v9, v9, v57
    v_mul_f32 v10, v10, v58
    v_mul_f32 v11, v11, v59
    v_mul_f32 v12, v12, v60
    v_mul_f32 v13, v13, v61
    v_mul_f32 v14, v14, v62
    v_mul_f32 v15, v15, v63
    v_mul_f32 v16, v16, v64
    v_mul_f32 v17, v17, v65
    v_mul_f32 v18, v18, v66
    v_mul_f32 v19, v19, v67
    v_cvt_pk_bf16_f32 v4, v4, v5
    v_cvt_pk_bf16_f32 v6, v6, v7
    v_cvt_pk_bf16_f32 v8, v8, v9
    v_cvt_pk_bf16_f32 v10, v10, v11
    v_cvt_pk_bf16_f32 v12, v12, v13
    v_cvt_pk_bf16_f32 v14, v14, v15
    v_cvt_pk_bf16_f32 v16, v16, v17
    v_cvt_pk_bf16_f32 v18, v18, v19
    v_and_b32 v5, s32, v4
    v_lshlrev_b32 v4, 16, v4
    v_and_b32 v7, s32, v6
    v_lshlrev_b32 v6, 16, v6
    v_and_b32 v9, s32, v8
    v_lshlrev_b32 v8, 16, v8
    v_and_b32 v11, s32, v10
    v_lshlrev_b32 v10, 16, v10
    v_and_b32 v13, s32, v12
    v_lshlrev_b32 v12, 16, v12
    v_and_b32 v15, s32, v14
    v_lshlrev_b32 v14, 16, v14
    v_and_b32 v17, s32, v16
    v_lshlrev_b32 v16, 16, v16
    v_and_b32 v19, s32, v18
    v_lshlrev_b32 v18, 16, v18
    v_add_f32 v4, v4, v36
    v_add_f32 v5, v5, v37
    v_add_f32 v6, v6, v38
    v_add_f32 v7, v7, v39
    v_add_f32 v8, v8, v40
    v_add_f32 v9, v9, v41
    v_add_f32 v10, v10, v42
    v_add_f32 v11, v11, v43
    v_add_f32 v12, v12, v44
    v_add_f32 v13, v13, v45
    v_add_f32 v14, v14, v46
    v_add_f32 v15, v15, v47
    v_add_f32 v16, v16, v48
    v_add_f32 v17, v17, v49
    v_add_f32 v18, v18, v50
    v_add_f32 v19, v19, v51
    v_cvt_pk_bf16_f32 v20, v4, v5
    v_cvt_pk_bf16_f32 v21, v6, v7
    v_cvt_pk_bf16_f32 v22, v8, v9
    v_cvt_pk_bf16_f32 v23, v10, v11
    v_cvt_pk_bf16_f32 v24, v12, v13
    v_cvt_pk_bf16_f32 v25, v14, v15
    v_cvt_pk_bf16_f32 v26, v16, v17
    v_cvt_pk_bf16_f32 v27, v18, v19
    buffer_store_dwordx4 v[20:23], v76, s[76:79], 0 offen
    buffer_store_dwordx4 v[24:27], v77, s[76:79], 0 offen
L_postend_89:
    s_mov_b64 exec, -1

    s_bfe_u32 s3, s35, 0x40008
    s_cbranch_scc0 L_fend_92
    s_ff1_i32_b32 s41, s3
    s_add_u32 s3, s41, 8
    s_bitset0_b32 s35, s3
    s_mov_b32 s49, -1

    s_mul_i32 s28, s41, 3125
    s_add_u32 s29, s28, 3126
    s_add_u32 s28, s28, 1
    s_lshr_b32 s28, s28, 1
    s_lshr_b32 s29, s29, 1
    s_sub_u32 s29, s29, s28
    s_sub_u32 s5, s29, 782
    s_mul_i32 s3, s36, 6250
    v_add_u32 v78, s28, v0
    v_mov_b32 v82, 0x2000000
    v_add_u32 v79, 782, v78
    v_cmp_gt_u32 vcc, 782, v0
    v_add_u32 v76, s3, v78
    v_add_u32 v77, s3, v79
    v_cndmask_b32 v76, v82, v76, vcc
    v_cmp_gt_u32 vcc, s5, v0
    v_lshlrev_b32 v78, 4, v78
    v_lshlrev_b32 v79, 4, v79
    v_cndmask_b32 v77, v82, v77, vcc
    v_lshlrev_b32 v80, 2, v76
    v_lshlrev_b32 v76, 4, v76
    v_lshlrev_b32 v81, 2, v77
    v_lshlrev_b32 v77, 4, v77
    buffer_load_dword v80, v80, s[68:71], 0 offen
    buffer_load_dword v81, v81, s[68:71], 0 offen
    buffer_load_dwordx4 v[86:89], v76, s[8:11], 0 offen
    buffer_load_dwordx4 v[90:93], v77, s[8:11], 0 offen

    s_waitcnt vmcnt(2)
    v_lshlrev_b32_sdwa v82, 5, v80 dst_sel:DWORD dst_unused:UNUSED_PAD src0_sel:DWORD src1_sel:WORD_0
    v_lshlrev_b32_sdwa v83, 5, v80 dst_sel:DWORD dst_unused:UNUSED_PAD src0_sel:DWORD src1_sel:WORD_1
    v_lshlrev_b32_sdwa v84, 5, v81 dst_sel:DWORD dst_unused:UNUSED_PAD src0_sel:DWORD src1_sel:WORD_0
    v_lshlrev_b32_sdwa v85, 5, v81 dst_sel:DWORD dst_unused:UNUSED_PAD src0_sel:DWORD src1_sel:WORD_1
    buffer_load_dwordx4 v[94:97], v82, s[72:75], 0 offen
    buffer_load_dwordx2 v[110:111], v82, s[72:75], 0 offen offset:16

    buffer_load_dwordx4 v[98:101], v83, s[72:75], 0 offen
    buffer_load_dwordx2 v[112:113], v83, s[72:75], 0 offen offset:16

    buffer_load_dwordx4 v[102:105], v84, s[72:75], 0 offen
    buffer_load_dwordx2 v[114:115], v84, s[72:75], 0 offen offset:16

    buffer_load_dwordx4 v[106:109], v85, s[72:75], 0 offen
    buffer_load_dwordx2 v[116:117], v85, s[72:75], 0 offen offset:16

    s_branch L_post_88
L_fin_83:

    s_load_dwordx2 s[68:69], s[0:1], 24
    s_load_dwordx4 s[88:91], s[0:1], 72
    s_load_dwordx2 s[76:77], s[0:1], 88
    s_load_dwordx2 s[80:81], s[0:1], 96
    s_mov_b32 s70, 1600000
    s_mov_b32 s71, 0x20000
    s_mov_b32 s78, 6400000
    s_mov_b32 s79, 0x20000
    s_movk_i32 s82, 256
    s_mov_b32 s83, 0x20000
    s_lshl_b32 s48, s36, 2
    s_mov_b32 s41, s37

    s_add_u32 s84, s6, 8896512
    s_addc_u32 s85, s7, 0
    s_mov_b32 s86, 76800000
    s_mov_b32 s87, 0x20000
    s_add_u32 s72, s6, 393216
    s_addc_u32 s73, s7, 0
    s_mov_b32 s74, 2097152
    s_mov_b32 s75, 0x20000
    s_mov_b32 s49, -1
    s_waitcnt lgkmcnt(0)
    s_load_dwordx8 s[12:19], s[88:89], 0
    s_load_dwordx8 s[56:63], s[90:91], 0

    s_mul_i32 s28, s41, 3125
    s_add_u32 s29, s28, 3126
    s_add_u32 s28, s28, 1
    s_lshr_b32 s28, s28, 1
    s_lshr_b32 s29, s29, 1
    s_sub_u32 s29, s29, s28
    s_sub_u32 s5, s29, 782
    s_mul_i32 s3, s36, 6250
    v_add_u32 v78, s28, v0
    v_mov_b32 v82, 0x2000000
    v_add_u32 v79, 782, v78
    v_cmp_gt_u32 vcc, 782, v0
    v_add_u32 v76, s3, v78
    v_add_u32 v77, s3, v79
    v_cndmask_b32 v76, v82, v76, vcc
    v_cmp_gt_u32 vcc, s5, v0
    v_lshlrev_b32 v78, 4, v78
    v_lshlrev_b32 v79, 4, v79
    v_cndmask_b32 v77, v82, v77, vcc
    v_lshlrev_b32 v80, 2, v76
    v_lshlrev_b32 v76, 4, v76
    v_lshlrev_b32 v81, 2, v77
    v_lshlrev_b32 v77, 4, v77
    buffer_load_dword v80, v80, s[68:71], 0 offen
    buffer_load_dword v81, v81, s[68:71], 0 offen
    buffer_load_dwordx4 v[86:89], v76, s[8:11], 0 offen
    buffer_load_dwordx4 v[90:93], v77, s[8:11], 0 offen

    s_waitcnt vmcnt(2)
    v_lshlrev_b32_sdwa v82, 5, v80 dst_sel:DWORD dst_unused:UNUSED_PAD src0_sel:DWORD src1_sel:WORD_0
    v_lshlrev_b32_sdwa v83, 5, v80 dst_sel:DWORD dst_unused:UNUSED_PAD src0_sel:DWORD src1_sel:WORD_1
    v_lshlrev_b32_sdwa v84, 5, v81 dst_sel:DWORD dst_unused:UNUSED_PAD src0_sel:DWORD src1_sel:WORD_0
    v_lshlrev_b32_sdwa v85, 5, v81 dst_sel:DWORD dst_unused:UNUSED_PAD src0_sel:DWORD src1_sel:WORD_1
    buffer_load_dwordx4 v[94:97], v82, s[72:75], 0 offen
    buffer_load_dwordx2 v[110:111], v82, s[72:75], 0 offen offset:16

    buffer_load_dwordx4 v[98:101], v83, s[72:75], 0 offen
    buffer_load_dwordx2 v[112:113], v83, s[72:75], 0 offen offset:16

    buffer_load_dwordx4 v[102:105], v84, s[72:75], 0 offen
    buffer_load_dwordx2 v[114:115], v84, s[72:75], 0 offen offset:16

    buffer_load_dwordx4 v[106:109], v85, s[72:75], 0 offen
    buffer_load_dwordx2 v[116:117], v85, s[72:75], 0 offen offset:16

    s_waitcnt vmcnt(0) lgkmcnt(0)
    s_barrier
    s_branch L_meet_84
L_fend_92:

L_p2done_47:
    s_endpgm

L_ufix_49:
    v_and_b32 v117, 63, v0
    v_lshlrev_b32 v117, 2, v117
    s_sub_i32 s54, s42, 1024
    v_cmp_le_i32 vcc, s54, v117
    s_mov_b64 exec, vcc
    v_mov_b32 v12, 0
    v_mov_b32 v44, 0
    s_mov_b64 exec, -1
    s_sub_i32 s54, s42, 1025
    v_cmp_le_i32 vcc, s54, v117
    s_mov_b64 exec, vcc
    v_mov_b32 v13, 0
    v_mov_b32 v46, 0
    s_mov_b64 exec, -1
    s_sub_i32 s54, s42, 1026
    v_cmp_le_i32 vcc, s54, v117
    s_mov_b64 exec, vcc
    v_mov_b32 v14, 0
    v_mov_b32 v48, 0
    s_mov_b64 exec, -1
    s_sub_i32 s54, s42, 1027
    v_cmp_le_i32 vcc, s54, v117
    s_mov_b64 exec, vcc
    v_mov_b32 v15, 0
    v_mov_b32 v50, 0
    s_mov_b64 exec, -1
    s_branch L_uback_50
L_ufix_51:
    v_and_b32 v117, 63, v0
    v_lshlrev_b32 v117, 2, v117
    s_sub_i32 s54, s42, 1536
    v_cmp_le_i32 vcc, s54, v117
    s_mov_b64 exec, vcc
    v_mov_b32 v16, 0
    v_mov_b32 v52, 0
    s_mov_b64 exec, -1
    s_sub_i32 s54, s42, 1537
    v_cmp_le_i32 vcc, s54, v117
    s_mov_b64 exec, vcc
    v_mov_b32 v17, 0
    v_mov_b32 v54, 0
    s_mov_b64 exec, -1
    s_sub_i32 s54, s42, 1538
    v_cmp_le_i32 vcc, s54, v117
    s_mov_b64 exec, vcc
    v_mov_b32 v18, 0
    v_mov_b32 v56, 0
    s_mov_b64 exec, -1
    s_sub_i32 s54, s42, 1539
    v_cmp_le_i32 vcc, s54, v117
    s_mov_b64 exec, vcc
    v_mov_b32 v19, 0
    v_mov_b32 v58, 0
    s_mov_b64 exec, -1
    s_branch L_uback_52
L_ufix_53:
    v_and_b32 v117, 63, v0
    v_lshlrev_b32 v117, 2, v117
    s_sub_i32 s54, s42, 2048
    v_cmp_le_i32 vcc, s54, v117
    s_mov_b64 exec, vcc
    v_mov_b32 v20, 0
    v_mov_b32 v60, 0
    s_mov_b64 exec, -1
    s_sub_i32 s54, s42, 2049
    v_cmp_le_i32 vcc, s54, v117
    s_mov_b64 exec, vcc
    v_mov_b32 v21, 0
    v_mov_b32 v62, 0
    s_mov_b64 exec, -1
    s_sub_i32 s54, s42, 2050
    v_cmp_le_i32 vcc, s54, v117
    s_mov_b64 exec, vcc
    v_mov_b32 v22, 0
    v_mov_b32 v64, 0
    s_mov_b64 exec, -1
    s_sub_i32 s54, s42, 2051
    v_cmp_le_i32 vcc, s54, v117
    s_mov_b64 exec, vcc
    v_mov_b32 v23, 0
    v_mov_b32 v66, 0
    s_mov_b64 exec, -1
    s_branch L_uback_54
L_ufix_55:
    v_and_b32 v117, 63, v0
    v_lshlrev_b32 v117, 2, v117
    s_sub_i32 s54, s42, 2560
    v_cmp_le_i32 vcc, s54, v117
    s_mov_b64 exec, vcc
    v_mov_b32 v24, 0
    v_mov_b32 v68, 0
    s_mov_b64 exec, -1
    s_sub_i32 s54, s42, 2561
    v_cmp_le_i32 vcc, s54, v117
    s_mov_b64 exec, vcc
    v_mov_b32 v25, 0
    v_mov_b32 v70, 0
    s_mov_b64 exec, -1
    s_sub_i32 s54, s42, 2562
    v_cmp_le_i32 vcc, s54, v117
    s_mov_b64 exec, vcc
    v_mov_b32 v26, 0
    v_mov_b32 v72, 0
    s_mov_b64 exec, -1
    s_sub_i32 s54, s42, 2563
    v_cmp_le_i32 vcc, s54, v117
    s_mov_b64 exec, vcc
    v_mov_b32 v27, 0
    v_mov_b32 v74, 0
    s_mov_b64 exec, -1
    s_branch L_uback_56
L_ufix_57:
    v_and_b32 v117, 63, v0
    v_lshlrev_b32 v117, 2, v117
    s_sub_i32 s54, s42, 0
    v_cmp_le_i32 vcc, s54, v117
    s_mov_b64 exec, vcc
    v_mov_b32 v4, 0
    v_mov_b32 v28, 0
    s_mov_b64 exec, -1
    s_sub_i32 s54, s42, 1
    v_cmp_le_i32 vcc, s54, v117
    s_mov_b64 exec, vcc
    v_mov_b32 v5, 0
    v_mov_b32 v30, 0
    s_mov_b64 exec, -1
    s_sub_i32 s54, s42, 2
    v_cmp_le_i32 vcc, s54, v117
    s_mov_b64 exec, vcc
    v_mov_b32 v6, 0
    v_mov_b32 v32, 0
    s_mov_b64 exec, -1
    s_sub_i32 s54, s42, 3
    v_cmp_le_i32 vcc, s54, v117
    s_mov_b64 exec, vcc
    v_mov_b32 v7, 0
    v_mov_b32 v34, 0
    s_mov_b64 exec, -1
    s_branch L_uback_58
L_ufix_59:
    v_and_b32 v117, 63, v0
    v_lshlrev_b32 v117, 2, v117
    s_sub_i32 s54, s42, 512
    v_cmp_le_i32 vcc, s54, v117
    s_mov_b64 exec, vcc
    v_mov_b32 v8, 0
    v_mov_b32 v36, 0
    s_mov_b64 exec, -1
    s_sub_i32 s54, s42, 513
    v_cmp_le_i32 vcc, s54, v117
    s_mov_b64 exec, vcc
    v_mov_b32 v9, 0
    v_mov_b32 v38, 0
    s_mov_b64 exec, -1
    s_sub_i32 s54, s42, 514
    v_cmp_le_i32 vcc, s54, v117
    s_mov_b64 exec, vcc
    v_mov_b32 v10, 0
    v_mov_b32 v40, 0
    s_mov_b64 exec, -1
    s_sub_i32 s54, s42, 515
    v_cmp_le_i32 vcc, s54, v117
    s_mov_b64 exec, vcc
    v_mov_b32 v11, 0
    v_mov_b32 v42, 0
    s_mov_b64 exec, -1
    s_branch L_uback_60
L_ufix_66:
    v_and_b32 v117, 63, v0
    v_lshlrev_b32 v117, 2, v117
    s_sub_i32 s54, s42, 3072
    v_cmp_le_i32 vcc, s54, v117
    s_mov_b64 exec, vcc
    v_mov_b32 v106, 0
    v_mov_b32 v120, 0
    s_mov_b64 exec, -1
    s_sub_i32 s54, s42, 3073
    v_cmp_le_i32 vcc, s54, v117
    s_mov_b64 exec, vcc
    v_mov_b32 v107, 0
    v_mov_b32 v122, 0
    s_mov_b64 exec, -1
    s_sub_i32 s54, s42, 3074
    v_cmp_le_i32 vcc, s54, v117
    s_mov_b64 exec, vcc
    v_mov_b32 v108, 0
    v_mov_b32 v124, 0
    s_mov_b64 exec, -1
    s_sub_i32 s54, s42, 3075
    v_cmp_le_i32 vcc, s54, v117
    s_mov_b64 exec, vcc
    v_mov_b32 v109, 0
    v_mov_b32 v126, 0
    s_mov_b64 exec, -1
    s_branch L_uback_67
L_ufix_70:
    v_and_b32 v117, 63, v0
    v_lshlrev_b32 v117, 2, v117
    s_sub_i32 s54, s42, 1024
    v_cmp_le_i32 vcc, s54, v117
    s_mov_b64 exec, vcc
    v_mov_b32 v12, 0
    v_mov_b32 v44, 0
    s_mov_b64 exec, -1
    s_sub_i32 s54, s42, 1025
    v_cmp_le_i32 vcc, s54, v117
    s_mov_b64 exec, vcc
    v_mov_b32 v13, 0
    v_mov_b32 v46, 0
    s_mov_b64 exec, -1
    s_sub_i32 s54, s42, 1026
    v_cmp_le_i32 vcc, s54, v117
    s_mov_b64 exec, vcc
    v_mov_b32 v14, 0
    v_mov_b32 v48, 0
    s_mov_b64 exec, -1
    s_sub_i32 s54, s42, 1027
    v_cmp_le_i32 vcc, s54, v117
    s_mov_b64 exec, vcc
    v_mov_b32 v15, 0
    v_mov_b32 v50, 0
    s_mov_b64 exec, -1
    s_branch L_uback_71
L_ufix_72:
    v_and_b32 v117, 63, v0
    v_lshlrev_b32 v117, 2, v117
    s_sub_i32 s54, s42, 1536
    v_cmp_le_i32 vcc, s54, v117
    s_mov_b64 exec, vcc
    v_mov_b32 v16, 0
    v_mov_b32 v52, 0
    s_mov_b64 exec, -1
    s_sub_i32 s54, s42, 1537
    v_cmp_le_i32 vcc, s54, v117
    s_mov_b64 exec, vcc
    v_mov_b32 v17, 0
    v_mov_b32 v54, 0
    s_mov_b64 exec, -1
    s_sub_i32 s54, s42, 1538
    v_cmp_le_i32 vcc, s54, v117
    s_mov_b64 exec, vcc
    v_mov_b32 v18, 0
    v_mov_b32 v56, 0
    s_mov_b64 exec, -1
    s_sub_i32 s54, s42, 1539
    v_cmp_le_i32 vcc, s54, v117
    s_mov_b64 exec, vcc
    v_mov_b32 v19, 0
    v_mov_b32 v58, 0
    s_mov_b64 exec, -1
    s_branch L_uback_73
L_ufix_74:
    v_and_b32 v117, 63, v0
    v_lshlrev_b32 v117, 2, v117
    s_sub_i32 s54, s42, 2048
    v_cmp_le_i32 vcc, s54, v117
    s_mov_b64 exec, vcc
    v_mov_b32 v20, 0
    v_mov_b32 v60, 0
    s_mov_b64 exec, -1
    s_sub_i32 s54, s42, 2049
    v_cmp_le_i32 vcc, s54, v117
    s_mov_b64 exec, vcc
    v_mov_b32 v21, 0
    v_mov_b32 v62, 0
    s_mov_b64 exec, -1
    s_sub_i32 s54, s42, 2050
    v_cmp_le_i32 vcc, s54, v117
    s_mov_b64 exec, vcc
    v_mov_b32 v22, 0
    v_mov_b32 v64, 0
    s_mov_b64 exec, -1
    s_sub_i32 s54, s42, 2051
    v_cmp_le_i32 vcc, s54, v117
    s_mov_b64 exec, vcc
    v_mov_b32 v23, 0
    v_mov_b32 v66, 0
    s_mov_b64 exec, -1
    s_branch L_uback_75
L_ufix_76:
    v_and_b32 v117, 63, v0
    v_lshlrev_b32 v117, 2, v117
    s_sub_i32 s54, s42, 2560
    v_cmp_le_i32 vcc, s54, v117
    s_mov_b64 exec, vcc
    v_mov_b32 v24, 0
    v_mov_b32 v68, 0
    s_mov_b64 exec, -1
    s_sub_i32 s54, s42, 2561
    v_cmp_le_i32 vcc, s54, v117
    s_mov_b64 exec, vcc
    v_mov_b32 v25, 0
    v_mov_b32 v70, 0
    s_mov_b64 exec, -1
    s_sub_i32 s54, s42, 2562
    v_cmp_le_i32 vcc, s54, v117
    s_mov_b64 exec, vcc
    v_mov_b32 v26, 0
    v_mov_b32 v72, 0
    s_mov_b64 exec, -1
    s_sub_i32 s54, s42, 2563
    v_cmp_le_i32 vcc, s54, v117
    s_mov_b64 exec, vcc
    v_mov_b32 v27, 0
    v_mov_b32 v74, 0
    s_mov_b64 exec, -1
    s_branch L_uback_77
L_ufix_78:
    v_and_b32 v117, 63, v0
    v_lshlrev_b32 v117, 2, v117
    s_sub_i32 s54, s42, 0
    v_cmp_le_i32 vcc, s54, v117
    s_mov_b64 exec, vcc
    v_mov_b32 v4, 0
    v_mov_b32 v28, 0
    s_mov_b64 exec, -1
    s_sub_i32 s54, s42, 1
    v_cmp_le_i32 vcc, s54, v117
    s_mov_b64 exec, vcc
    v_mov_b32 v5, 0
    v_mov_b32 v30, 0
    s_mov_b64 exec, -1
    s_sub_i32 s54, s42, 2
    v_cmp_le_i32 vcc, s54, v117
    s_mov_b64 exec, vcc
    v_mov_b32 v6, 0
    v_mov_b32 v32, 0
    s_mov_b64 exec, -1
    s_sub_i32 s54, s42, 3
    v_cmp_le_i32 vcc, s54, v117
    s_mov_b64 exec, vcc
    v_mov_b32 v7, 0
    v_mov_b32 v34, 0
    s_mov_b64 exec, -1
    s_branch L_uback_79
L_ufix_80:
    v_and_b32 v117, 63, v0
    v_lshlrev_b32 v117, 2, v117
    s_sub_i32 s54, s42, 512
    v_cmp_le_i32 vcc, s54, v117
    s_mov_b64 exec, vcc
    v_mov_b32 v8, 0
    v_mov_b32 v36, 0
    s_mov_b64 exec, -1
    s_sub_i32 s54, s42, 513
    v_cmp_le_i32 vcc, s54, v117
    s_mov_b64 exec, vcc
    v_mov_b32 v9, 0
    v_mov_b32 v38, 0
    s_mov_b64 exec, -1
    s_sub_i32 s54, s42, 514
    v_cmp_le_i32 vcc, s54, v117
    s_mov_b64 exec, vcc
    v_mov_b32 v10, 0
    v_mov_b32 v40, 0
    s_mov_b64 exec, -1
    s_sub_i32 s54, s42, 515
    v_cmp_le_i32 vcc, s54, v117
    s_mov_b64 exec, vcc
    v_mov_b32 v11, 0
    v_mov_b32 v42, 0
    s_mov_b64 exec, -1
    s_branch L_uback_81
L_sync_91:
    v_and_b32 v40, 63, v0
    v_lshlrev_b32 v41, 20, v40
    v_mov_b32 v42, s33
    buffer_atomic_add v42, v41, s[80:83], s48 offen sc0
    s_waitcnt vmcnt(0)
    v_readfirstlane_b32 s4, v42
    s_movk_i32 s5, 400
    s_nop 0
    s_add_u32 s4, s4, s33
    s_bitcmp1_b32 s4, 2
    s_cbranch_scc1 L_tell_95
L_poll_93:
    s_sub_u32 s5, s5, 1
    s_cbranch_scc1 L_gave_94
    v_mov_b32 v42, 0
    buffer_atomic_add v42, v41, s[80:83], s48 offen sc0
    s_waitcnt vmcnt(0)
    v_readfirstlane_b32 s4, v42
    s_nop 1
    s_and_b32 s4, s4, 0xff
    s_bitcmp0_b32 s4, 2
    s_cbranch_scc1 L_poll_93
    s_branch L_tell_95
L_gave_94:
    s_cmp_lg_u32 s49, s37
    s_cbranch_scc1 L_gno_97
    v_add_lshl_u32 v40, v40, s28, 4
    s_mov_b32 s5, 0
L_gl_96:
    v_min_u32 v43, 100000, v40
    ds_read_b128 v[44:47], v43 offset:50000
    s_waitcnt lgkmcnt(0)
    buffer_store_dwordx4 v[44:47], v40, s[20:23], 0 offen sc1
    s_waitcnt vmcnt(0)
    v_add_u32 v40, 1024, v40
    s_add_u32 s5, s5, 64
    s_cmp_lt_u32 s5, s29
    s_cbranch_scc1 L_gl_96
L_gno_97:
    s_lshl_b32 s4, 0x100, s37
    v_mov_b32 v42, s4
    buffer_atomic_or v42, v41, s[80:83], s48 offen sc0
    s_waitcnt vmcnt(0)
    v_readfirstlane_b32 s4, v42
    s_nop 1
    s_and_b32 s4, s4, 0xff
    s_bitcmp1_b32 s4, 2
    s_cselect_b32 s4, s4, 0x10000
L_tell_95:
    v_mov_b32 v42, s4
    ds_write_b32 v118, v42
    s_waitcnt lgkmcnt(0)
    s_branch L_bcast_86

L_own_98:
    ds_read_b128 v[36:39], v78 offset:50000
    ds_read_b128 v[52:55], v79 offset:50000
    s_branch L_obk_99

L_own_100:
    ds_read_b128 v[40:43], v78 offset:50000
    ds_read_b128 v[56:59], v79 offset:50000
    s_branch L_obk_101

L_own_102:
    ds_read_b128 v[44:47], v78 offset:50000
    ds_read_b128 v[60:63], v79 offset:50000
    s_branch L_obk_103

L_own_104:
    ds_read_b128 v[48:51], v78 offset:50000
    ds_read_b128 v[64:67], v79 offset:50000
    s_branch L_obk_105

L_fgen_106:
    v_lshlrev_b32 v82, 1, v76
    v_lshlrev_b32 v83, 1, v77
    v_mov_b32 v4, 0
    v_mov_b32 v5, 0
    v_mov_b32 v6, 0
    v_mov_b32 v7, 0
    v_mov_b32 v8, 0
    v_mov_b32 v9, 0
    v_mov_b32 v10, 0
    v_mov_b32 v11, 0
    v_mov_b32 v12, 0
    v_mov_b32 v13, 0
    v_mov_b32 v14, 0
    v_mov_b32 v15, 0
    v_mov_b32 v16, 0
    v_mov_b32 v17, 0
    v_mov_b32 v18, 0
    v_mov_b32 v19, 0
    s_bitcmp1_b32 s35, 4
    s_cbranch_scc1 L_ffl_108
    v_cvt_f32_u32_sdwa v20, v36 dst_sel:DWORD dst_unused:UNUSED_PAD src0_sel:WORD_0
    v_cvt_f32_u32_sdwa v21, v36 dst_sel:DWORD dst_unused:UNUSED_PAD src0_sel:WORD_1
    v_cvt_f32_u32_sdwa v22, v37 dst_sel:DWORD dst_unused:UNUSED_PAD src0_sel:WORD_0
    v_cvt_f32_u32_sdwa v23, v37 dst_sel:DWORD dst_unused:UNUSED_PAD src0_sel:WORD_1
    v_cvt_f32_u32_sdwa v24, v38 dst_sel:DWORD dst_unused:UNUSED_PAD src0_sel:WORD_0
    v_cvt_f32_u32_sdwa v25, v38 dst_sel:DWORD dst_unused:UNUSED_PAD src0_sel:WORD_1
    v_cvt_f32_u32_sdwa v26, v39 dst_sel:DWORD dst_unused:UNUSED_PAD src0_sel:WORD_0
    v_cvt_f32_u32_sdwa v27, v39 dst_sel:DWORD dst_unused:UNUSED_PAD src0_sel:WORD_1
    v_cvt_f32_u32_sdwa v28, v52 dst_sel:DWORD dst_unused:UNUSED_PAD src0_sel:WORD_0
    v_cvt_f32_u32_sdwa v29, v52 dst_sel:DWORD dst_unused:UNUSED_PAD src0_sel:WORD_1
    v_cvt_f32_u32_sdwa v30, v53 dst_sel:DWORD dst_unused:UNUSED_PAD src0_sel:WORD_0
    v_cvt_f32_u32_sdwa v31, v53 dst_sel:DWORD dst_unused:UNUSED_PAD src0_sel:WORD_1
    v_cvt_f32_u32_sdwa v32, v54 dst_sel:DWORD dst_unused:UNUSED_PAD src0_sel:WORD_0
    v_cvt_f32_u32_sdwa v33, v54 dst_sel:DWORD dst_unused:UNUSED_PAD src0_sel:WORD_1
    v_cvt_f32_u32_sdwa v34, v55 dst_sel:DWORD dst_unused:UNUSED_PAD src0_sel:WORD_0
    v_cvt_f32_u32_sdwa v35, v55 dst_sel:DWORD dst_unused:UNUSED_PAD src0_sel:WORD_1
    v_add_f32 v20, 0xc6800000, v20
    v_fmac_f32 v4, s34, v20
    v_add_f32 v21, 0xc6800000, v21
    v_fmac_f32 v5, s34, v21
    v_add_f32 v22, 0xc6800000, v22
    v_fmac_f32 v6, s34, v22
    v_add_f32 v23, 0xc6800000, v23
    v_fmac_f32 v7, s34, v23
    v_add_f32 v24, 0xc6800000, v24
    v_fmac_f32 v8, s34, v24
    v_add_f32 v25, 0xc6800000, v25
    v_fmac_f32 v9, s34, v25
    v_add_f32 v26, 0xc6800000, v26
    v_fmac_f32 v10, s34, v26
    v_add_f32 v27, 0xc6800000, v27
    v_fmac_f32 v11, s34, v27
    v_add_f32 v28, 0xc6800000, v28
    v_fmac_f32 v12, s34, v28
    v_add_f32 v29, 0xc6800000, v29
    v_fmac_f32 v13, s34, v29
    v_add_f32 v30, 0xc6800000, v30
    v_fmac_f32 v14, s34, v30
    v_add_f32 v31, 0xc6800000, v31
    v_fmac_f32 v15, s34, v31
    v_add_f32 v32, 0xc6800000, v32
    v_fmac_f32 v16, s34, v32
    v_add_f32 v33, 0xc6800000, v33
    v_fmac_f32 v17, s34, v33
    v_add_f32 v34, 0xc6800000, v34
    v_fmac_f32 v18, s34, v34
    v_add_f32 v35, 0xc6800000, v35
    v_fmac_f32 v19, s34, v35
    s_branch L_fnx_109
L_ffl_108:
    s_mov_b32 s3, 25600000
    buffer_load_dwordx4 v[20:23], v82, s[84:87], s3 offen offset:0 sc1
    buffer_load_dwordx4 v[24:27], v82, s[84:87], s3 offen offset:16 sc1
    buffer_load_dwordx4 v[28:31], v83, s[84:87], s3 offen offset:0 sc1
    buffer_load_dwordx4 v[32:35], v83, s[84:87], s3 offen offset:16 sc1
    s_waitcnt vmcnt(0)
    v_add_f32 v4, v4, v20
    v_add_f32 v5, v5, v21
    v_add_f32 v6, v6, v22
    v_add_f32 v7, v7, v23
    v_add_f32 v8, v8, v24
    v_add_f32 v9, v9, v25
    v_add_f32 v10, v10, v26
    v_add_f32 v11, v11, v27
    v_add_f32 v12, v12, v28
    v_add_f32 v13, v13, v29
    v_add_f32 v14, v14, v30
    v_add_f32 v15, v15, v31
    v_add_f32 v16, v16, v32
    v_add_f32 v17, v17, v33
    v_add_f32 v18, v18, v34
    v_add_f32 v19, v19, v35
L_fnx_109:
    s_bitcmp1_b32 s35, 5
    s_cbranch_scc1 L_ffl_110
    v_cvt_f32_u32_sdwa v20, v40 dst_sel:DWORD dst_unused:UNUSED_PAD src0_sel:WORD_0
    v_cvt_f32_u32_sdwa v21, v40 dst_sel:DWORD dst_unused:UNUSED_PAD src0_sel:WORD_1
    v_cvt_f32_u32_sdwa v22, v41 dst_sel:DWORD dst_unused:UNUSED_PAD src0_sel:WORD_0
    v_cvt_f32_u32_sdwa v23, v41 dst_sel:DWORD dst_unused:UNUSED_PAD src0_sel:WORD_1
    v_cvt_f32_u32_sdwa v24, v42 dst_sel:DWORD dst_unused:UNUSED_PAD src0_sel:WORD_0
    v_cvt_f32_u32_sdwa v25, v42 dst_sel:DWORD dst_unused:UNUSED_PAD src0_sel:WORD_1
    v_cvt_f32_u32_sdwa v26, v43 dst_sel:DWORD dst_unused:UNUSED_PAD src0_sel:WORD_0
    v_cvt_f32_u32_sdwa v27, v43 dst_sel:DWORD dst_unused:UNUSED_PAD src0_sel:WORD_1
    v_cvt_f32_u32_sdwa v28, v56 dst_sel:DWORD dst_unused:UNUSED_PAD src0_sel:WORD_0
    v_cvt_f32_u32_sdwa v29, v56 dst_sel:DWORD dst_unused:UNUSED_PAD src0_sel:WORD_1
    v_cvt_f32_u32_sdwa v30, v57 dst_sel:DWORD dst_unused:UNUSED_PAD src0_sel:WORD_0
    v_cvt_f32_u32_sdwa v31, v57 dst_sel:DWORD dst_unused:UNUSED_PAD src0_sel:WORD_1
    v_cvt_f32_u32_sdwa v32, v58 dst_sel:DWORD dst_unused:UNUSED_PAD src0_sel:WORD_0
    v_cvt_f32_u32_sdwa v33, v58 dst_sel:DWORD dst_unused:UNUSED_PAD src0_sel:WORD_1
    v_cvt_f32_u32_sdwa v34, v59 dst_sel:DWORD dst_unused:UNUSED_PAD src0_sel:WORD_0
    v_cvt_f32_u32_sdwa v35, v59 dst_sel:DWORD dst_unused:UNUSED_PAD src0_sel:WORD_1
    v_add_f32 v20, 0xc6800000, v20
    v_fmac_f32 v4, s34, v20
    v_add_f32 v21, 0xc6800000, v21
    v_fmac_f32 v5, s34, v21
    v_add_f32 v22, 0xc6800000, v22
    v_fmac_f32 v6, s34, v22
    v_add_f32 v23, 0xc6800000, v23
    v_fmac_f32 v7, s34, v23
    v_add_f32 v24, 0xc6800000, v24
    v_fmac_f32 v8, s34, v24
    v_add_f32 v25, 0xc6800000, v25
    v_fmac_f32 v9, s34, v25
    v_add_f32 v26, 0xc6800000, v26
    v_fmac_f32 v10, s34, v26
    v_add_f32 v27, 0xc6800000, v27
    v_fmac_f32 v11, s34, v27
    v_add_f32 v28, 0xc6800000, v28
    v_fmac_f32 v12, s34, v28
    v_add_f32 v29, 0xc6800000, v29
    v_fmac_f32 v13, s34, v29
    v_add_f32 v30, 0xc6800000, v30
    v_fmac_f32 v14, s34, v30
    v_add_f32 v31, 0xc6800000, v31
    v_fmac_f32 v15, s34, v31
    v_add_f32 v32, 0xc6800000, v32
    v_fmac_f32 v16, s34, v32
    v_add_f32 v33, 0xc6800000, v33
    v_fmac_f32 v17, s34, v33
    v_add_f32 v34, 0xc6800000, v34
    v_fmac_f32 v18, s34, v34
    v_add_f32 v35, 0xc6800000, v35
    v_fmac_f32 v19, s34, v35
    s_branch L_fnx_111
L_ffl_110:
    s_mov_b32 s3, 38400000
    buffer_load_dwordx4 v[20:23], v82, s[84:87], s3 offen offset:0 sc1
    buffer_load_dwordx4 v[24:27], v82, s[84:87], s3 offen offset:16 sc1
    buffer_load_dwordx4 v[28:31], v83, s[84:87], s3 offen offset:0 sc1
    buffer_load_dwordx4 v[32:35], v83, s[84:87], s3 offen offset:16 sc1
    s_waitcnt vmcnt(0)
    v_add_f32 v4, v4, v20
    v_add_f32 v5, v5, v21
    v_add_f32 v6, v6, v22
    v_add_f32 v7, v7, v23
    v_add_f32 v8, v8, v24
    v_add_f32 v9, v9, v25
    v_add_f32 v10, v10, v26
    v_add_f32 v11, v11, v27
    v_add_f32 v12, v12, v28
    v_add_f32 v13, v13, v29
    v_add_f32 v14, v14, v30
    v_add_f32 v15, v15, v31
    v_add_f32 v16, v16, v32
    v_add_f32 v17, v17, v33
    v_add_f32 v18, v18, v34
    v_add_f32 v19, v19, v35
L_fnx_111:
    s_bitcmp1_b32 s35, 6
    s_cbranch_scc1 L_ffl_112
    v_cvt_f32_u32_sdwa v20, v44 dst_sel:DWORD dst_unused:UNUSED_PAD src0_sel:WORD_0
    v_cvt_f32_u32_sdwa v21, v44 dst_sel:DWORD dst_unused:UNUSED_PAD src0_sel:WORD_1
    v_cvt_f32_u32_sdwa v22, v45 dst_sel:DWORD dst_unused:UNUSED_PAD src0_sel:WORD_0
    v_cvt_f32_u32_sdwa v23, v45 dst_sel:DWORD dst_unused:UNUSED_PAD src0_sel:WORD_1
    v_cvt_f32_u32_sdwa v24, v46 dst_sel:DWORD dst_unused:UNUSED_PAD src0_sel:WORD_0
    v_cvt_f32_u32_sdwa v25, v46 dst_sel:DWORD dst_unused:UNUSED_PAD src0_sel:WORD_1
    v_cvt_f32_u32_sdwa v26, v47 dst_sel:DWORD dst_unused:UNUSED_PAD src0_sel:WORD_0
    v_cvt_f32_u32_sdwa v27, v47 dst_sel:DWORD dst_unused:UNUSED_PAD src0_sel:WORD_1
    v_cvt_f32_u32_sdwa v28, v60 dst_sel:DWORD dst_unused:UNUSED_PAD src0_sel:WORD_0
    v_cvt_f32_u32_sdwa v29, v60 dst_sel:DWORD dst_unused:UNUSED_PAD src0_sel:WORD_1
    v_cvt_f32_u32_sdwa v30, v61 dst_sel:DWORD dst_unused:UNUSED_PAD src0_sel:WORD_0
    v_cvt_f32_u32_sdwa v31, v61 dst_sel:DWORD dst_unused:UNUSED_PAD src0_sel:WORD_1
    v_cvt_f32_u32_sdwa v32, v62 dst_sel:DWORD dst_unused:UNUSED_PAD src0_sel:WORD_0
    v_cvt_f32_u32_sdwa v33, v62 dst_sel:DWORD dst_unused:UNUSED_PAD src0_sel:WORD_1
    v_cvt_f32_u32_sdwa v34, v63 dst_sel:DWORD dst_unused:UNUSED_PAD src0_sel:WORD_0
    v_cvt_f32_u32_sdwa v35, v63 dst_sel:DWORD dst_unused:UNUSED_PAD src0_sel:WORD_1
    v_add_f32 v20, 0xc6800000, v20
    v_fmac_f32 v4, s34, v20
    v_add_f32 v21, 0xc6800000, v21
    v_fmac_f32 v5, s34, v21
    v_add_f32 v22, 0xc6800000, v22
    v_fmac_f32 v6, s34, v22
    v_add_f32 v23, 0xc6800000, v23
    v_fmac_f32 v7, s34, v23
    v_add_f32 v24, 0xc6800000, v24
    v_fmac_f32 v8, s34, v24
    v_add_f32 v25, 0xc6800000, v25
    v_fmac_f32 v9, s34, v25
    v_add_f32 v26, 0xc6800000, v26
    v_fmac_f32 v10, s34, v26
    v_add_f32 v27, 0xc6800000, v27
    v_fmac_f32 v11, s34, v27
    v_add_f32 v28, 0xc6800000, v28
    v_fmac_f32 v12, s34, v28
    v_add_f32 v29, 0xc6800000, v29
    v_fmac_f32 v13, s34, v29
    v_add_f32 v30, 0xc6800000, v30
    v_fmac_f32 v14, s34, v30
    v_add_f32 v31, 0xc6800000, v31
    v_fmac_f32 v15, s34, v31
    v_add_f32 v32, 0xc6800000, v32
    v_fmac_f32 v16, s34, v32
    v_add_f32 v33, 0xc6800000, v33
    v_fmac_f32 v17, s34, v33
    v_add_f32 v34, 0xc6800000, v34
    v_fmac_f32 v18, s34, v34
    v_add_f32 v35, 0xc6800000, v35
    v_fmac_f32 v19, s34, v35
    s_branch L_fnx_113
L_ffl_112:
    s_mov_b32 s3, 51200000
    buffer_load_dwordx4 v[20:23], v82, s[84:87], s3 offen offset:0 sc1
    buffer_load_dwordx4 v[24:27], v82, s[84:87], s3 offen offset:16 sc1
    buffer_load_dwordx4 v[28:31], v83, s[84:87], s3 offen offset:0 sc1
    buffer_load_dwordx4 v[32:35], v83, s[84:87], s3 offen offset:16 sc1
    s_waitcnt vmcnt(0)
    v_add_f32 v4, v4, v20
    v_add_f32 v5, v5, v21
    v_add_f32 v6, v6, v22
    v_add_f32 v7, v7, v23
    v_add_f32 v8, v8, v24
    v_add_f32 v9, v9, v25
    v_add_f32 v10, v10, v26
    v_add_f32 v11, v11, v27
    v_add_f32 v12, v12, v28
    v_add_f32 v13, v13, v29
    v_add_f32 v14, v14, v30
    v_add_f32 v15, v15, v31
    v_add_f32 v16, v16, v32
    v_add_f32 v17, v17, v33
    v_add_f32 v18, v18, v34
    v_add_f32 v19, v19, v35
L_fnx_113:
    s_bitcmp1_b32 s35, 7
    s_cbranch_scc1 L_ffl_114
    v_cvt_f32_u32_sdwa v20, v48 dst_sel:DWORD dst_unused:UNUSED_PAD src0_sel:WORD_0
    v_cvt_f32_u32_sdwa v21, v48 dst_sel:DWORD dst_unused:UNUSED_PAD src0_sel:WORD_1
    v_cvt_f32_u32_sdwa v22, v49 dst_sel:DWORD dst_unused:UNUSED_PAD src0_sel:WORD_0
    v_cvt_f32_u32_sdwa v23, v49 dst_sel:DWORD dst_unused:UNUSED_PAD src0_sel:WORD_1
    v_cvt_f32_u32_sdwa v24, v50 dst_sel:DWORD dst_unused:UNUSED_PAD src0_sel:WORD_0
    v_cvt_f32_u32_sdwa v25, v50 dst_sel:DWORD dst_unused:UNUSED_PAD src0_sel:WORD_1
    v_cvt_f32_u32_sdwa v26, v51 dst_sel:DWORD dst_unused:UNUSED_PAD src0_sel:WORD_0
    v_cvt_f32_u32_sdwa v27, v51 dst_sel:DWORD dst_unused:UNUSED_PAD src0_sel:WORD_1
    v_cvt_f32_u32_sdwa v28, v64 dst_sel:DWORD dst_unused:UNUSED_PAD src0_sel:WORD_0
    v_cvt_f32_u32_sdwa v29, v64 dst_sel:DWORD dst_unused:UNUSED_PAD src0_sel:WORD_1
    v_cvt_f32_u32_sdwa v30, v65 dst_sel:DWORD dst_unused:UNUSED_PAD src0_sel:WORD_0
    v_cvt_f32_u32_sdwa v31, v65 dst_sel:DWORD dst_unused:UNUSED_PAD src0_sel:WORD_1
    v_cvt_f32_u32_sdwa v32, v66 dst_sel:DWORD dst_unused:UNUSED_PAD src0_sel:WORD_0
    v_cvt_f32_u32_sdwa v33, v66 dst_sel:DWORD dst_unused:UNUSED_PAD src0_sel:WORD_1
    v_cvt_f32_u32_sdwa v34, v67 dst_sel:DWORD dst_unused:UNUSED_PAD src0_sel:WORD_0
    v_cvt_f32_u32_sdwa v35, v67 dst_sel:DWORD dst_unused:UNUSED_PAD src0_sel:WORD_1
    v_add_f32 v20, 0xc6800000, v20
    v_fmac_f32 v4, s34, v20
    v_add_f32 v21, 0xc6800000, v21
    v_fmac_f32 v5, s34, v21
    v_add_f32 v22, 0xc6800000, v22
    v_fmac_f32 v6, s34, v22
    v_add_f32 v23, 0xc6800000, v23
    v_fmac_f32 v7, s34, v23
    v_add_f32 v24, 0xc6800000, v24
    v_fmac_f32 v8, s34, v24
    v_add_f32 v25, 0xc6800000, v25
    v_fmac_f32 v9, s34, v25
    v_add_f32 v26, 0xc6800000, v26
    v_fmac_f32 v10, s34, v26
    v_add_f32 v27, 0xc6800000, v27
    v_fmac_f32 v11, s34, v27
    v_add_f32 v28, 0xc6800000, v28
    v_fmac_f32 v12, s34, v28
    v_add_f32 v29, 0xc6800000, v29
    v_fmac_f32 v13, s34, v29
    v_add_f32 v30, 0xc6800000, v30
    v_fmac_f32 v14, s34, v30
    v_add_f32 v31, 0xc6800000, v31
    v_fmac_f32 v15, s34, v31
    v_add_f32 v32, 0xc6800000, v32
    v_fmac_f32 v16, s34, v32
    v_add_f32 v33, 0xc6800000, v33
    v_fmac_f32 v17, s34, v33
    v_add_f32 v34, 0xc6800000, v34
    v_fmac_f32 v18, s34, v34
    v_add_f32 v35, 0xc6800000, v35
    v_fmac_f32 v19, s34, v35
    s_branch L_fnx_115
L_ffl_114:
    s_mov_b32 s3, 64000000
    buffer_load_dwordx4 v[20:23], v82, s[84:87], s3 offen offset:0 sc1
    buffer_load_dwordx4 v[24:27], v82, s[84:87], s3 offen offset:16 sc1
    buffer_load_dwordx4 v[28:31], v83, s[84:87], s3 offen offset:0 sc1
    buffer_load_dwordx4 v[32:35], v83, s[84:87], s3 offen offset:16 sc1
    s_waitcnt vmcnt(0)
    v_add_f32 v4, v4, v20
    v_add_f32 v5, v5, v21
    v_add_f32 v6, v6, v22
    v_add_f32 v7, v7, v23
    v_add_f32 v8, v8, v24
    v_add_f32 v9, v9, v25
    v_add_f32 v10, v10, v26
    v_add_f32 v11, v11, v27
    v_add_f32 v12, v12, v28
    v_add_f32 v13, v13, v29
    v_add_f32 v14, v14, v30
    v_add_f32 v15, v15, v31
    v_add_f32 v16, v16, v32
    v_add_f32 v17, v17, v33
    v_add_f32 v18, v18, v34
    v_add_f32 v19, v19, v35
L_fnx_115:
    s_branch L_fbk_107
L_p2slow_48:
    s_waitcnt vmcnt(0) lgkmcnt(0)
    s_mov_b32 s51, 0
    s_movk_i32 s43, 6250
L_sweep_116:
    s_barrier

    v_mov_b32 v28, 0x0
    v_mov_b32 v29, 0x0
    v_mov_b32 v30, 0x0
    v_mov_b32 v31, 0x0
    v_add_u32 v32, 50000, v3
    v_add_u32 v33, 65536, v32

    ds_write_b128 v32, v[28:31] offset:0
    ds_write_b128 v32, v[28:31] offset:16384
    ds_write_b128 v32, v[28:31] offset:32768
    ds_write_b128 v32, v[28:31] offset:49152
    ds_write_b128 v33, v[28:31] offset:0
    ds_write_b128 v33, v[28:31] offset:16384
    v_cmp_gt_u32 vcc, 971, v0
    s_mov_b64 exec, vcc
    ds_write_b128 v33, v[28:31] offset:32768
    s_mov_b64 exec, -1
    s_mov_b32 s3, 32768
    s_load_dword s40, s[6:7], s3
    s_waitcnt lgkmcnt(0)
    s_barrier
    s_cmp_lg_u32 s40, 0
    s_cbranch_scc1 L_raw_121
    s_sub_u32 s38, s4, 8
L_sbatch_117:
    s_lshl_b32 s52, s36, 5
    s_add_u32 s52, s52, s38
    s_lshr_b32 s52, s52, 1
    s_lshl_b32 s52, s52, 2
    s_load_dword s40, s[46:47], s52
    s_mul_i32 s50, s38, 200000
    s_and_b32 s3, s38, 1
    s_lshl_b32 s3, s3, 4
    s_or_b32 s3, s3, 0x100000
    s_waitcnt lgkmcnt(0)
    s_bfe_u32 s40, s40, s3

    s_min_u32 s40, s40, 6524
    s_lshl_b32 s52, s38, 6
    s_add_u32 s52, s52, s36
    s_mul_i32 s52, s52, 32764
    s_and_b32 s52, s52, 0xffffff80
    s_add_u32 s20, s44, s52
    s_addc_u32 s21, s45, 0
    s_mul_i32 s52, s40, 5
    s_add_u32 s52, s52, 3
    s_and_b32 s22, s52, -4

    s_lshr_b32 s55, s39, 2
    s_add_u32 s55, s55, 0
    v_and_b32 v36, 63, v0
    v_add_u32 v36, s55, v36
L_left_122:
    s_cmp_ge_u32 s55, s40
    s_cbranch_scc1 L_leftend_123
    v_mul_u32_u24 v37, 5, v36
    buffer_load_dword v38, v37, s[20:23], 0 offen offset:1
    buffer_load_ubyte v39, v37, s[20:23], 0 offen
    s_waitcnt vmcnt(0)

    v_perm_b32 v37, v39, v38, s24
    v_lshrrev_b32 v42, 30, v38
    v_and_b32 v37, 0x1fff, v37
    v_mul_u32_u24 v42, 6250, v42
    v_add_lshl_u32 v37, v37, v42, 3

    buffer_load_dwordx2 v[40:41], v37, s[8:11], s50 offen
    v_cmp_gt_u32 vcc, s40, v36
    s_waitcnt vmcnt(0)

    v_bfe_u32 v44, v38, 16, 14
    v_subrev_u32 v44, s51, v44
    v_cmp_gt_u32 s[64:65], s43, v44
    s_and_b64 exec, vcc, s[64:65]
    v_lshlrev_b32 v45, 16, v38
    v_cmpx_ne_u32 vcc, 0, v45
    v_lshlrev_b32 v44, 4, v44
    v_bfe_i32 v38, v38, 0, 16
    v_cvt_f32_i32 v38, v38
    v_mul_f32 v38, 0x38004020, v38
    v_lshlrev_b32 v45, 16, v40
    v_and_b32 v46, s32, v40
    v_lshlrev_b32 v47, 16, v41
    v_and_b32 v48, s32, v41

    v_mul_f32 v45, v45, v38
    ds_add_f32 v44, v45 offset:50000
    v_mul_f32 v46, v46, v38
    ds_add_f32 v44, v46 offset:50004
    v_mul_f32 v47, v47, v38
    ds_add_f32 v44, v47 offset:50008
    v_mul_f32 v48, v48, v38
    ds_add_f32 v44, v48 offset:50012
    s_mov_b64 exec, -1
    v_add_u32 v36, 128, v36
    s_add_u32 s55, s55, 128
    s_branch L_left_122
L_leftend_123:

    s_add_u32 s38, s38, 1
    s_cmp_lt_u32 s38, s4
    s_cbranch_scc1 L_sbatch_117
    s_branch L_swend_119

L_raw_121:
    s_load_dwordx2 s[68:69], s[0:1], 8
    s_load_dwordx2 s[72:73], s[0:1], 16
    s_load_dwordx2 s[76:77], s[0:1], 32
    s_load_dwordx2 s[80:81], s[0:1], 48
    s_mov_b32 s70, 204800000
    s_mov_b32 s71, 0x20000
    s_mov_b32 s74, 204800000
    s_mov_b32 s75, 0x20000
    s_mov_b32 s78, 102400000
    s_mov_b32 s79, 0x20000
    s_waitcnt lgkmcnt(0)
    s_load_dword s82, s[80:81], 0
    s_mul_i32 s83, s36, 12500
    s_add_u32 s83, s83, s51
    s_mul_i32 s84, s37, 200000
    s_mov_b32 s85, 200000
    s_mov_b32 s38, 0
    v_lshlrev_b32 v44, 5, v0
    v_mov_b32 v45, 0.15915494
    s_waitcnt lgkmcnt(0)
    s_lshl_b32 s82, s82, 16
    v_mul_f32 v45, s82, v45
L_rawl_118:
    s_lshr_b32 s3, s38, 1
    buffer_load_dwordx4 v[46:49], v44, s[72:75], s38 offen
    buffer_load_dwordx4 v[50:53], v44, s[72:75], s38 offen offset:16
    buffer_load_dwordx4 v[54:57], v44, s[68:71], s38 offen
    buffer_load_dwordx4 v[58:61], v44, s[68:71], s38 offen offset:16
    buffer_load_dwordx4 v[62:65], v3, s[76:79], s3 offen
    s_waitcnt vmcnt(1)

    v_subrev_u32 v46, s83, v46
    v_subrev_u32 v82, s84, v54
    v_cmp_gt_u32 vcc, s43, v46
    v_cmp_gt_u32 s[64:65], s85, v82
    v_lshlrev_b32 v54, 3, v54
    s_nand_b64 exec, vcc, s[64:65]
    v_bfrev_b32 v54, 1
    s_mov_b64 exec, -1
    buffer_load_dwordx2 v[66:67], v54, s[8:11], 0 offen

    v_subrev_u32 v47, s83, v47
    v_subrev_u32 v82, s84, v55
    v_cmp_gt_u32 vcc, s43, v47
    v_cmp_gt_u32 s[64:65], s85, v82
    v_lshlrev_b32 v55, 3, v55
    s_nand_b64 exec, vcc, s[64:65]
    v_bfrev_b32 v55, 1
    s_mov_b64 exec, -1
    buffer_load_dwordx2 v[68:69], v55, s[8:11], 0 offen

    v_subrev_u32 v48, s83, v48
    v_subrev_u32 v82, s84, v56
    v_cmp_gt_u32 vcc, s43, v48
    v_cmp_gt_u32 s[64:65], s85, v82
    v_lshlrev_b32 v56, 3, v56
    s_nand_b64 exec, vcc, s[64:65]
    v_bfrev_b32 v56, 1
    s_mov_b64 exec, -1
    buffer_load_dwordx2 v[70:71], v56, s[8:11], 0 offen

    v_subrev_u32 v49, s83, v49
    v_subrev_u32 v82, s84, v57
    v_cmp_gt_u32 vcc, s43, v49
    v_cmp_gt_u32 s[64:65], s85, v82
    v_lshlrev_b32 v57, 3, v57
    s_nand_b64 exec, vcc, s[64:65]
    v_bfrev_b32 v57, 1
    s_mov_b64 exec, -1
    buffer_load_dwordx2 v[72:73], v57, s[8:11], 0 offen

    v_subrev_u32 v50, s83, v50
    v_subrev_u32 v82, s84, v58
    v_cmp_gt_u32 vcc, s43, v50
    v_cmp_gt_u32 s[64:65], s85, v82
    v_lshlrev_b32 v58, 3, v58
    s_nand_b64 exec, vcc, s[64:65]
    v_bfrev_b32 v58, 1
    s_mov_b64 exec, -1
    buffer_load_dwordx2 v[74:75], v58, s[8:11], 0 offen

    v_subrev_u32 v51, s83, v51
    v_subrev_u32 v82, s84, v59
    v_cmp_gt_u32 vcc, s43, v51
    v_cmp_gt_u32 s[64:65], s85, v82
    v_lshlrev_b32 v59, 3, v59
    s_nand_b64 exec, vcc, s[64:65]
    v_bfrev_b32 v59, 1
    s_mov_b64 exec, -1
    buffer_load_dwordx2 v[76:77], v59, s[8:11], 0 offen

    v_subrev_u32 v52, s83, v52
    v_subrev_u32 v82, s84, v60
    v_cmp_gt_u32 vcc, s43, v52
    v_cmp_gt_u32 s[64:65], s85, v82
    v_lshlrev_b32 v60, 3, v60
    s_nand_b64 exec, vcc, s[64:65]
    v_bfrev_b32 v60, 1
    s_mov_b64 exec, -1
    buffer_load_dwordx2 v[78:79], v60, s[8:11], 0 offen

    v_subrev_u32 v53, s83, v53
    v_subrev_u32 v82, s84, v61
    v_cmp_gt_u32 vcc, s43, v53
    v_cmp_gt_u32 s[64:65], s85, v82
    v_lshlrev_b32 v61, 3, v61
    s_nand_b64 exec, vcc, s[64:65]
    v_bfrev_b32 v61, 1
    s_mov_b64 exec, -1
    buffer_load_dwordx2 v[80:81], v61, s[8:11], 0 offen

    s_waitcnt vmcnt(0)
    v_cmp_le_i32 vcc, 0, v54
    s_mov_b64 exec, vcc
    s_cbranch_execz L_rsk_124
    v_lshlrev_b32 v82, 16, v62
    v_mul_f32 v82, v82, v45
    v_fract_f32 v82, v82
    v_cos_f32 v82, v82
    v_lshlrev_b32 v46, 4, v46
    v_lshlrev_b32 v83, 16, v66
    v_and_b32 v84, s32, v66
    v_lshlrev_b32 v85, 16, v67
    v_and_b32 v86, s32, v67

    v_mul_f32 v83, v83, v82
    ds_add_f32 v46, v83 offset:50000
    v_mul_f32 v84, v84, v82
    ds_add_f32 v46, v84 offset:50004
    v_mul_f32 v85, v85, v82
    ds_add_f32 v46, v85 offset:50008
    v_mul_f32 v86, v86, v82
    ds_add_f32 v46, v86 offset:50012
L_rsk_124:
    s_mov_b64 exec, -1
    v_cmp_le_i32 vcc, 0, v55
    s_mov_b64 exec, vcc
    s_cbranch_execz L_rsk_125
    v_and_b32 v82, s32, v62
    v_mul_f32 v82, v82, v45
    v_fract_f32 v82, v82
    v_cos_f32 v82, v82
    v_lshlrev_b32 v47, 4, v47
    v_lshlrev_b32 v83, 16, v68
    v_and_b32 v84, s32, v68
    v_lshlrev_b32 v85, 16, v69
    v_and_b32 v86, s32, v69

    v_mul_f32 v83, v83, v82
    ds_add_f32 v47, v83 offset:50000
    v_mul_f32 v84, v84, v82
    ds_add_f32 v47, v84 offset:50004
    v_mul_f32 v85, v85, v82
    ds_add_f32 v47, v85 offset:50008
    v_mul_f32 v86, v86, v82
    ds_add_f32 v47, v86 offset:50012
L_rsk_125:
    s_mov_b64 exec, -1
    v_cmp_le_i32 vcc, 0, v56
    s_mov_b64 exec, vcc
    s_cbranch_execz L_rsk_126
    v_lshlrev_b32 v82, 16, v63
    v_mul_f32 v82, v82, v45
    v_fract_f32 v82, v82
    v_cos_f32 v82, v82
    v_lshlrev_b32 v48, 4, v48
    v_lshlrev_b32 v83, 16, v70
    v_and_b32 v84, s32, v70
    v_lshlrev_b32 v85, 16, v71
    v_and_b32 v86, s32, v71

    v_mul_f32 v83, v83, v82
    ds_add_f32 v48, v83 offset:50000
    v_mul_f32 v84, v84, v82
    ds_add_f32 v48, v84 offset:50004
    v_mul_f32 v85, v85, v82
    ds_add_f32 v48, v85 offset:50008
    v_mul_f32 v86, v86, v82
    ds_add_f32 v48, v86 offset:50012
L_rsk_126:
    s_mov_b64 exec, -1
    v_cmp_le_i32 vcc, 0, v57
    s_mov_b64 exec, vcc
    s_cbranch_execz L_rsk_127
    v_and_b32 v82, s32, v63
    v_mul_f32 v82, v82, v45
    v_fract_f32 v82, v82
    v_cos_f32 v82, v82
    v_lshlrev_b32 v49, 4, v49
    v_lshlrev_b32 v83, 16, v72
    v_and_b32 v84, s32, v72
    v_lshlrev_b32 v85, 16, v73
    v_and_b32 v86, s32, v73

    v_mul_f32 v83, v83, v82
    ds_add_f32 v49, v83 offset:50000
    v_mul_f32 v84, v84, v82
    ds_add_f32 v49, v84 offset:50004
    v_mul_f32 v85, v85, v82
    ds_add_f32 v49, v85 offset:50008
    v_mul_f32 v86, v86, v82
    ds_add_f32 v49, v86 offset:50012
L_rsk_127:
    s_mov_b64 exec, -1
    v_cmp_le_i32 vcc, 0, v58
    s_mov_b64 exec, vcc
    s_cbranch_execz L_rsk_128
    v_lshlrev_b32 v82, 16, v64
    v_mul_f32 v82, v82, v45
    v_fract_f32 v82, v82
    v_cos_f32 v82, v82
    v_lshlrev_b32 v50, 4, v50
    v_lshlrev_b32 v83, 16, v74
    v_and_b32 v84, s32, v74
    v_lshlrev_b32 v85, 16, v75
    v_and_b32 v86, s32, v75

    v_mul_f32 v83, v83, v82
    ds_add_f32 v50, v83 offset:50000
    v_mul_f32 v84, v84, v82
    ds_add_f32 v50, v84 offset:50004
    v_mul_f32 v85, v85, v82
    ds_add_f32 v50, v85 offset:50008
    v_mul_f32 v86, v86, v82
    ds_add_f32 v50, v86 offset:50012
L_rsk_128:
    s_mov_b64 exec, -1
    v_cmp_le_i32 vcc, 0, v59
    s_mov_b64 exec, vcc
    s_cbranch_execz L_rsk_129
    v_and_b32 v82, s32, v64
    v_mul_f32 v82, v82, v45
    v_fract_f32 v82, v82
    v_cos_f32 v82, v82
    v_lshlrev_b32 v51, 4, v51
    v_lshlrev_b32 v83, 16, v76
    v_and_b32 v84, s32, v76
    v_lshlrev_b32 v85, 16, v77
    v_and_b32 v86, s32, v77

    v_mul_f32 v83, v83, v82
    ds_add_f32 v51, v83 offset:50000
    v_mul_f32 v84, v84, v82
    ds_add_f32 v51, v84 offset:50004
    v_mul_f32 v85, v85, v82
    ds_add_f32 v51, v85 offset:50008
    v_mul_f32 v86, v86, v82
    ds_add_f32 v51, v86 offset:50012
L_rsk_129:
    s_mov_b64 exec, -1
    v_cmp_le_i32 vcc, 0, v60
    s_mov_b64 exec, vcc
    s_cbranch_execz L_rsk_130
    v_lshlrev_b32 v82, 16, v65
    v_mul_f32 v82, v82, v45
    v_fract_f32 v82, v82
    v_cos_f32 v82, v82
    v_lshlrev_b32 v52, 4, v52
    v_lshlrev_b32 v83, 16, v78
    v_and_b32 v84, s32, v78
    v_lshlrev_b32 v85, 16, v79
    v_and_b32 v86, s32, v79

    v_mul_f32 v83, v83, v82
    ds_add_f32 v52, v83 offset:50000
    v_mul_f32 v84, v84, v82
    ds_add_f32 v52, v84 offset:50004
    v_mul_f32 v85, v85, v82
    ds_add_f32 v52, v85 offset:50008
    v_mul_f32 v86, v86, v82
    ds_add_f32 v52, v86 offset:50012
L_rsk_130:
    s_mov_b64 exec, -1
    v_cmp_le_i32 vcc, 0, v61
    s_mov_b64 exec, vcc
    s_cbranch_execz L_rsk_131
    v_and_b32 v82, s32, v65
    v_mul_f32 v82, v82, v45
    v_fract_f32 v82, v82
    v_cos_f32 v82, v82
    v_lshlrev_b32 v53, 4, v53
    v_lshlrev_b32 v83, 16, v80
    v_and_b32 v84, s32, v80
    v_lshlrev_b32 v85, 16, v81
    v_and_b32 v86, s32, v81

    v_mul_f32 v83, v83, v82
    ds_add_f32 v53, v83 offset:50000
    v_mul_f32 v84, v84, v82
    ds_add_f32 v53, v84 offset:50004
    v_mul_f32 v85, v85, v82
    ds_add_f32 v53, v85 offset:50008
    v_mul_f32 v86, v86, v82
    ds_add_f32 v53, v86 offset:50012
L_rsk_131:
    s_mov_b64 exec, -1
    s_add_u32 s38, s38, 32768
    s_cmp_lt_u32 s38, 204800000
    s_cbranch_scc1 L_rawl_118
L_swend_119:
    s_waitcnt lgkmcnt(0)
    s_barrier
    s_mul_i32 s3, s37, 800000
    s_mul_i32 s5, s36, 12500
    s_add_u32 s3, s3, s5
    s_add_u32 s3, s3, s51
    s_lshl_b32 s3, s3, 4
    s_add_u32 s3, s3, 34496512

    s_add_u32 s20, s6, s3
    s_addc_u32 s21, s7, 0
    s_mov_b32 s22, 100000
    s_mov_b32 s23, 0x20000
    v_mov_b32 v36, v3
    s_mov_b32 s38, 0
L_wl_120:
    v_min_u32 v37, 100000, v36
    ds_read_b128 v[28:31], v37 offset:50000
    s_waitcnt lgkmcnt(0)
    buffer_store_dwordx4 v[28:31], v36, s[20:23], 0 offen sc1
    s_waitcnt vmcnt(0)
    v_add_u32 v36, 16384, v36
    s_add_u32 s38, s38, 1024
    s_cmp_lt_u32 s38, 6250
    s_cbranch_scc1 L_wl_120
    s_add_u32 s51, s51, 6250
    s_cmp_lt_u32 s51, 12500
    s_cbranch_scc1 L_sweep_116
    s_lshl_b32 s33, 16, s37
    s_add_u32 s33, s33, 1
    s_branch L_fin_83

.section .rodata,"a"
.p2align 6
.amdhsa_kernel g1_kernel
  .amdhsa_next_free_vgpr 128
  .amdhsa_next_free_sgpr 102
  .amdhsa_accum_offset 128
  .amdhsa_group_segment_fixed_size 0
  .amdhsa_kernarg_size 112
  .amdhsa_user_sgpr_count 2
  .amdhsa_user_sgpr_kernarg_segment_ptr 1
  .amdhsa_system_sgpr_workgroup_id_x 1
  .amdhsa_float_denorm_mode_32 3
.end_amdhsa_kernel
.p2align 6
.amdhsa_kernel standalone__molecular_angular_gemnet__graph_kernel
  .amdhsa_next_free_vgpr 128
  .amdhsa_next_free_sgpr 102
  .amdhsa_accum_offset 128
  .amdhsa_group_segment_fixed_size 0
  .amdhsa_kernarg_size 112
  .amdhsa_user_sgpr_count 2
  .amdhsa_user_sgpr_kernarg_segment_ptr 1
  .amdhsa_system_sgpr_workgroup_id_x 1
  .amdhsa_float_denorm_mode_32 3
.end_amdhsa_kernel
```

```asm
; @launch kernel=g1_kernel grid=(256,1,1) block=(1024,1,1) lds=163840
; @launch kernel=standalone__molecular_angular_gemnet__graph_kernel grid=(256,1,1) block=(1024,1,1) lds=163840
.amdgcn_target "amdgcn-amd-amdhsa--gfx950"
.text
.globl g1_kernel
.p2align 8
.type g1_kernel,@function
g1_kernel:
    s_cmp_ge_u32 s2, 256
    s_cbranch_scc1 L_p1done_1
    s_load_dwordx4 s[80:83], s[0:1], 8
    s_load_dwordx2 s[84:85], s[0:1], 32
    s_load_dwordx2 s[86:87], s[0:1], 48
    s_load_dwordx4 s[4:7], s[0:1], 96
    s_load_dwordx2 s[78:79], s[0:1], 0
    v_lshlrev_b32 v1, 4, v0
    v_lshlrev_b32 v2, 3, v0
    v_lshlrev_b32 v98, 20, v0
    v_mov_b32 v108, 24576
    v_mov_b32 v110, 0
    v_mov_b32 v111, 0
    ds_write_b64 v2, v[110:111]
    s_mov_b64 exec, 1
    ds_write_b32 v108, v110
    s_mov_b64 exec, -1
    s_waitcnt lgkmcnt(0)
    s_load_dword s88, s[86:87], 0

    s_mov_b32 s96, s4
    s_mov_b32 s97, s5
    s_mov_b32 s98, 256
    s_mov_b32 s99, 0x20000
    v_readfirstlane_b32 s74, v0
    s_nop 1
    s_or_b32 s74, s74, s2
    s_cbranch_scc1 L_noinit_2

    v_mov_b32 v110, 1
    buffer_atomic_add v110, v98, s[96:99], 0 offen offset:64 sc0
    s_waitcnt vmcnt(0)
    v_readfirstlane_b32 s74, v110
    s_nop 1
    s_cmp_lg_u32 s74, 0
    s_cbranch_scc1 L_zno_4

    s_mov_b32 s92, s6
    s_mov_b32 s93, s7
    s_mov_b32 s94, 32784
    s_mov_b32 s95, 0x20000
    v_mov_b32 v110, 0
    v_mov_b32 v111, 0
    v_mov_b32 v112, 0
    v_mov_b32 v113, 0
L_zl_3:
    buffer_store_dwordx4 v[110:113], v1, s[92:95], s74 offen sc0 sc1
    s_add_u32 s74, s74, 1024
    s_cmp_le_u32 s74, 32768
    s_cbranch_scc1 L_zl_3
    v_mov_b32 v114, 1
    s_waitcnt vmcnt(0)
    buffer_atomic_add v114, v98, s[96:99], 0 offen offset:128
L_zno_4:

L_noinit_2:
    s_barrier
    s_mov_b32 s20, s78
    s_mov_b32 s21, s79
    s_mov_b32 s22, 6400000
    s_mov_b32 s23, 0x20000
    v_lshrrev_b32 v110, 3, v0
    v_and_b32 v111, 7, v0
    v_mul_u32_u24 v110, 49920, v110
    v_lshl_add_u32 v110, v111, 4, v110
    v_and_b32 v111, 63, v0
    v_and_b32 v112, 0x3c0, v0
    v_lshlrev_b32 v111, 2, v111
    v_lshl_or_b32 v111, v112, 4, v111
    v_lshlrev_b32 v100, 2, v0
    s_lshr_b32 s50, s2, 1
    s_and_b32 s53, s2, 1
    s_mul_i32 s3, s50, 50000
    s_mul_i32 s54, s53, 24576
    s_add_u32 s3, s3, s54

    buffer_load_dwordx4 v[56:59], v110, s[20:23], 0 offen
    s_add_u32 s20, s78, s3
    s_addc_u32 s21, s79, 0
    s_mov_b32 s22, 24576
    s_mov_b32 s23, 0x20000
    s_movk_i32 s3, 16384
    buffer_load_dword v116, v111, s[20:23], 0 offen offset:0
    buffer_load_dword v117, v111, s[20:23], 0 offen offset:256
    buffer_load_dword v118, v111, s[20:23], 0 offen offset:512
    buffer_load_dword v119, v111, s[20:23], 0 offen offset:768
    buffer_load_dword v120, v111, s[20:23], s3 offen offset:0
    buffer_load_dword v121, v111, s[20:23], s3 offen offset:256
    buffer_load_dword v122, v111, s[20:23], s3 offen offset:512
    buffer_load_dword v123, v111, s[20:23], s3 offen offset:768
    s_mul_i32 s22, s53, 25424
    s_movk_i32 s3, 24576

    buffer_load_dword v124, v100, s[20:23], s3 offen
    s_mul_i32 s3, s50, 50048
    s_add_u32 s3, s3, s54
    s_add_u32 s54, s3, 2490368

    v_readfirstlane_b32 s74, v0
    s_mov_b32 s55, 0x05040100
    s_nop 0
    s_cmp_lt_u32 s74, 768
    s_cbranch_scc1 L_nogate_5
    s_load_dwordx2 s[92:93], s[0:1], 40
    s_load_dwordx4 s[32:35], s[0:1], 56
    v_mov_b32 v110, 0
    s_waitcnt lgkmcnt(0)
    global_load_dwordx4 v[60:63], v110, s[92:93]

    global_load_dwordx4 v[64:67], v110, s[32:33] offset:0
    global_load_dwordx4 v[80:83], v110, s[34:35] offset:0
    global_load_dwordx4 v[68:71], v110, s[32:33] offset:16
    global_load_dwordx4 v[84:87], v110, s[34:35] offset:16
    global_load_dwordx4 v[72:75], v110, s[32:33] offset:32
    global_load_dwordx4 v[88:91], v110, s[34:35] offset:32
    global_load_dwordx4 v[76:79], v110, s[32:33] offset:48
    global_load_dwordx4 v[92:95], v110, s[34:35] offset:48
    s_lshl_b32 s74, s2, 8
    v_and_b32 v111, 255, v0
    v_add_u32 v111, s74, v111
    v_lshlrev_b32 v112, 16, v111
    v_lshlrev_b32 v111, 5, v111
    s_mov_b32 s75, 0x07060302
    s_waitcnt vmcnt(0)

    v_lshlrev_b32 v44, 16, v60
    v_and_b32 v45, 0xffff0000, v60
    v_lshlrev_b32 v46, 16, v61
    v_and_b32 v47, 0xffff0000, v61
    v_lshlrev_b32 v48, 16, v62
    v_and_b32 v49, 0xffff0000, v62
    v_lshlrev_b32 v50, 16, v63
    v_and_b32 v51, 0xffff0000, v63
    v_sub_f32 v44, v112, v44
    v_sub_f32 v45, v112, v45
    v_sub_f32 v46, v112, v46
    v_sub_f32 v47, v112, v47
    v_sub_f32 v48, v112, v48
    v_sub_f32 v49, v112, v49
    v_sub_f32 v50, v112, v50
    v_sub_f32 v51, v112, v51
    v_cvt_pk_bf16_f32 v44, v44, v45
    v_cvt_pk_bf16_f32 v46, v46, v47
    v_cvt_pk_bf16_f32 v48, v48, v49
    v_cvt_pk_bf16_f32 v50, v50, v51
    v_and_b32 v45, 0xffff0000, v44
    v_lshlrev_b32 v44, 16, v44
    v_and_b32 v47, 0xffff0000, v46
    v_lshlrev_b32 v46, 16, v46
    v_and_b32 v49, 0xffff0000, v48
    v_lshlrev_b32 v48, 16, v48
    v_and_b32 v51, 0xffff0000, v50
    v_lshlrev_b32 v50, 16, v50
    v_mul_f32 v44, v44, v44
    v_mul_f32 v45, v45, v45
    v_mul_f32 v46, v46, v46
    v_mul_f32 v47, v47, v47
    v_mul_f32 v48, v48, v48
    v_mul_f32 v49, v49, v49
    v_mul_f32 v50, v50, v50
    v_mul_f32 v51, v51, v51
    v_cvt_pk_bf16_f32 v44, v44, v45
    v_cvt_pk_bf16_f32 v46, v46, v47
    v_cvt_pk_bf16_f32 v48, v48, v49
    v_cvt_pk_bf16_f32 v50, v50, v51
    v_and_b32 v45, 0xffff0000, v44
    v_lshlrev_b32 v44, 16, v44
    v_and_b32 v47, 0xffff0000, v46
    v_lshlrev_b32 v46, 16, v46
    v_and_b32 v49, 0xffff0000, v48
    v_lshlrev_b32 v48, 16, v48
    v_and_b32 v51, 0xffff0000, v50
    v_lshlrev_b32 v50, 16, v50
    v_mul_f32 v44, 0xc1200000, v44
    v_mul_f32 v45, 0xc1200000, v45
    v_mul_f32 v46, 0xc1200000, v46
    v_mul_f32 v47, 0xc1200000, v47
    v_mul_f32 v48, 0xc1200000, v48
    v_mul_f32 v49, 0xc1200000, v49
    v_mul_f32 v50, 0xc1200000, v50
    v_mul_f32 v51, 0xc1200000, v51
    v_cvt_pk_bf16_f32 v44, v44, v45
    v_cvt_pk_bf16_f32 v46, v46, v47
    v_cvt_pk_bf16_f32 v48, v48, v49
    v_cvt_pk_bf16_f32 v50, v50, v51
    v_and_b32 v45, 0xffff0000, v44
    v_lshlrev_b32 v44, 16, v44
    v_and_b32 v47, 0xffff0000, v46
    v_lshlrev_b32 v46, 16, v46
    v_and_b32 v49, 0xffff0000, v48
    v_lshlrev_b32 v48, 16, v48
    v_and_b32 v51, 0xffff0000, v50
    v_lshlrev_b32 v50, 16, v50
    v_mul_f32 v44, 0x3fb8aa3b, v44
    v_mul_f32 v45, 0x3fb8aa3b, v45
    v_mul_f32 v46, 0x3fb8aa3b, v46
    v_mul_f32 v47, 0x3fb8aa3b, v47
    v_mul_f32 v48, 0x3fb8aa3b, v48
    v_mul_f32 v49, 0x3fb8aa3b, v49
    v_mul_f32 v50, 0x3fb8aa3b, v50
    v_mul_f32 v51, 0x3fb8aa3b, v51
    v_exp_f32 v44, v44
    v_exp_f32 v45, v45
    v_exp_f32 v46, v46
    v_exp_f32 v47, v47
    v_exp_f32 v48, v48
    v_exp_f32 v49, v49
    v_exp_f32 v50, v50
    v_exp_f32 v51, v51
    s_nop 0
    v_cvt_pk_bf16_f32 v44, v44, v45
    v_cvt_pk_bf16_f32 v46, v46, v47
    v_cvt_pk_bf16_f32 v48, v48, v49
    v_cvt_pk_bf16_f32 v50, v50, v51
    v_perm_b32 v113, v66, v64, s55
    v_dot2_f32_bf16 v52, v44, v113, 0

    v_perm_b32 v113, v66, v64, s75
    v_dot2_f32_bf16 v53, v44, v113, 0

    v_perm_b32 v113, v67, v65, s55
    v_dot2_f32_bf16 v54, v44, v113, 0

    v_perm_b32 v113, v67, v65, s75
    v_dot2_f32_bf16 v55, v44, v113, 0

    v_perm_b32 v113, v70, v68, s55
    v_dot2_f32_bf16 v52, v46, v113, v52

    v_perm_b32 v113, v70, v68, s75
    v_dot2_f32_bf16 v53, v46, v113, v53

    v_perm_b32 v113, v71, v69, s55
    v_dot2_f32_bf16 v54, v46, v113, v54

    v_perm_b32 v113, v71, v69, s75
    v_dot2_f32_bf16 v55, v46, v113, v55

    v_perm_b32 v113, v74, v72, s55
    v_dot2_f32_bf16 v52, v48, v113, v52

    v_perm_b32 v113, v74, v72, s75
    v_dot2_f32_bf16 v53, v48, v113, v53

    v_perm_b32 v113, v75, v73, s55
    v_dot2_f32_bf16 v54, v48, v113, v54

    v_perm_b32 v113, v75, v73, s75
    v_dot2_f32_bf16 v55, v48, v113, v55

    v_perm_b32 v113, v78, v76, s55
    v_dot2_f32_bf16 v52, v50, v113, v52

    v_perm_b32 v113, v78, v76, s75
    v_dot2_f32_bf16 v53, v50, v113, v53

    v_perm_b32 v113, v79, v77, s55
    v_dot2_f32_bf16 v54, v50, v113, v54

    v_perm_b32 v113, v79, v77, s75
    v_dot2_f32_bf16 v55, v50, v113, v55

    v_perm_b32 v113, v82, v80, s55
    v_dot2_f32_bf16 v60, v44, v113, 0

    v_perm_b32 v113, v82, v80, s75
    v_dot2_f32_bf16 v61, v44, v113, 0

    v_perm_b32 v113, v83, v81, s55
    v_dot2_f32_bf16 v62, v44, v113, 0

    v_perm_b32 v113, v83, v81, s75
    v_dot2_f32_bf16 v63, v44, v113, 0

    v_perm_b32 v113, v86, v84, s55
    v_dot2_f32_bf16 v60, v46, v113, v60

    v_perm_b32 v113, v86, v84, s75
    v_dot2_f32_bf16 v61, v46, v113, v61

    v_perm_b32 v113, v87, v85, s55
    v_dot2_f32_bf16 v62, v46, v113, v62

    v_perm_b32 v113, v87, v85, s75
    v_dot2_f32_bf16 v63, v46, v113, v63

    v_perm_b32 v113, v90, v88, s55
    v_dot2_f32_bf16 v60, v48, v113, v60

    v_perm_b32 v113, v90, v88, s75
    v_dot2_f32_bf16 v61, v48, v113, v61

    v_perm_b32 v113, v91, v89, s55
    v_dot2_f32_bf16 v62, v48, v113, v62

    v_perm_b32 v113, v91, v89, s75
    v_dot2_f32_bf16 v63, v48, v113, v63

    v_perm_b32 v113, v94, v92, s55
    v_dot2_f32_bf16 v60, v50, v113, v60

    v_perm_b32 v113, v94, v92, s75
    v_dot2_f32_bf16 v61, v50, v113, v61

    v_perm_b32 v113, v95, v93, s55
    v_dot2_f32_bf16 v62, v50, v113, v62

    v_perm_b32 v113, v95, v93, s75
    v_dot2_f32_bf16 v63, v50, v113, v63

    s_add_u32 s92, s6, 393216
    s_addc_u32 s93, s7, 0
    s_mov_b32 s94, 2097152
    s_mov_b32 s95, 0x20000
    v_cvt_pk_bf16_f32 v52, v52, v53
    v_cvt_pk_bf16_f32 v53, v54, v55
    buffer_store_dwordx4 v[60:63], v111, s[92:95], 0 offen
    buffer_store_dwordx2 v[52:53], v111, s[92:95], 0 offen offset:16
    s_nop 1
L_nogate_5:

    s_mov_b32 s8, s80
    s_mov_b32 s9, s81
    s_mov_b32 s10, 0
    s_mov_b32 s11, 0x20000
    s_mov_b32 s12, s82
    s_mov_b32 s13, s83
    s_mov_b32 s14, 0
    s_mov_b32 s15, 0x20000
    s_mov_b32 s16, s84
    s_mov_b32 s17, s85
    s_mov_b32 s18, 0
    s_mov_b32 s19, 0x20000
    s_lshr_b32 s74, s2, 1
    s_and_b32 s74, s74, 28
    s_lshr_b32 s86, 0x00102010, s74
    s_lshr_b32 s87, 0x44414241, s74
    s_lshr_b32 s41, 0x43221100, s74
    s_and_b32 s86, s86, 15
    s_and_b32 s87, s87, 15
    s_and_b32 s41, s41, 15
    s_lshr_b32 s74, s2, 6
    s_lshl_b32 s74, s74, 3
    s_and_b32 s75, s2, 7
    s_add_u32 s74, s74, s75
    s_mul_i32 s74, s74, 5
    s_add_u32 s41, s41, s74

    s_mul_i32 s78, s41, 16384
    s_add_u32 s49, s78, 16384
    s_cmp_ge_u32 s41, 3125
    s_cmovk_i32 s49, 0
    s_cmovk_i32 s78, 0
    s_lshl_b32 s10, s49, 2
    s_lshl_b32 s14, s49, 2
    s_lshl_b32 s18, s49, 1
    s_sub_u32 s79, s87, s86
    s_bfm_b32 s85, s79, s86
    s_lshl_b32 s86, s86, 12
    s_lshl_b32 s87, s87, 12
    s_min_u32 s87, s87, 16384

    s_add_u32 s79, s78, 0
    s_bitcmp1_b32 s85, 0
    s_cselect_b32 s79, s79, 0x1ff00000
    s_lshl_b32 s56, s79, 2
    s_lshl_b32 s61, s79, 1

    s_add_u32 s79, s78, 4096
    s_bitcmp1_b32 s85, 1
    s_cselect_b32 s79, s79, 0x1ff00000
    s_lshl_b32 s57, s79, 2
    s_lshl_b32 s62, s79, 1

    s_add_u32 s79, s78, 8192
    s_bitcmp1_b32 s85, 2
    s_cselect_b32 s79, s79, 0x1ff00000
    s_lshl_b32 s58, s79, 2
    s_lshl_b32 s63, s79, 1

    s_add_u32 s79, s78, 12288
    s_bitcmp1_b32 s85, 3
    s_cselect_b32 s79, s79, 0x1ff00000
    s_lshl_b32 s59, s79, 2
    s_lshl_b32 s64, s79, 1

    s_mov_b32 s82, s85
    s_mov_b32 s83, s86
    s_mov_b32 s84, s87
    s_add_u32 s41, s2, 160
    s_mul_i32 s74, s41, 16384
    s_mov_b32 s10, 204800000
    s_mov_b32 s14, 204800000
    s_mov_b32 s18, 102400000

    s_add_u32 s75, s74, 0
    s_lshl_b32 s76, s75, 2
    s_lshl_b32 s75, s75, 1
    s_bitcmp1_b32 s82, 0
    s_cselect_b32 s56, s56, s76
    s_cselect_b32 s61, s61, s75

    s_add_u32 s75, s74, 4096
    s_lshl_b32 s76, s75, 2
    s_lshl_b32 s75, s75, 1
    s_bitcmp1_b32 s82, 1
    s_cselect_b32 s57, s57, s76
    s_cselect_b32 s62, s62, s75

    s_add_u32 s75, s74, 8192
    s_lshl_b32 s76, s75, 2
    s_lshl_b32 s75, s75, 1
    s_bitcmp1_b32 s82, 2
    s_cselect_b32 s58, s58, s76
    s_cselect_b32 s63, s63, s75

    s_add_u32 s75, s74, 12288
    s_lshl_b32 s76, s75, 2
    s_lshl_b32 s75, s75, 1
    s_bitcmp1_b32 s82, 3
    s_cselect_b32 s59, s59, s76
    s_cselect_b32 s64, s64, s75

    buffer_load_dwordx4 v[20:23], v1, s[12:15], s56 offen nt
    buffer_load_dwordx4 v[4:7], v1, s[8:11], s56 offen nt
    buffer_load_dwordx2 v[36:37], v2, s[16:19], s61 offen nt
    buffer_load_dwordx4 v[24:27], v1, s[12:15], s57 offen nt
    buffer_load_dwordx4 v[8:11], v1, s[8:11], s57 offen nt
    buffer_load_dwordx2 v[38:39], v2, s[16:19], s62 offen nt
    buffer_load_dwordx4 v[28:31], v1, s[12:15], s58 offen nt
    buffer_load_dwordx4 v[12:15], v1, s[8:11], s58 offen nt
    buffer_load_dwordx2 v[40:41], v2, s[16:19], s63 offen nt
    buffer_load_dwordx4 v[32:35], v1, s[12:15], s59 offen nt
    buffer_load_dwordx4 v[16:19], v1, s[8:11], s59 offen nt
    buffer_load_dwordx2 v[42:43], v2, s[16:19], s64 offen nt
    s_mov_b32 s86, 0
    s_mov_b32 s87, 4
    s_mul_i32 s78, s41, 16384
    s_add_u32 s49, s78, 16384
    s_cmp_ge_u32 s41, 3125
    s_cmovk_i32 s49, 0
    s_cmovk_i32 s78, 0
    s_lshl_b32 s10, s49, 2
    s_lshl_b32 s14, s49, 2
    s_lshl_b32 s18, s49, 1
    s_sub_u32 s79, s87, s86
    s_bfm_b32 s85, s79, s86
    s_lshl_b32 s86, s86, 12
    s_lshl_b32 s87, s87, 12
    s_min_u32 s87, s87, 16384

    s_add_u32 s79, s78, 0
    s_bitcmp1_b32 s85, 0
    s_cselect_b32 s79, s79, 0x1ff00000
    s_lshl_b32 s56, s79, 2
    s_lshl_b32 s61, s79, 1

    s_add_u32 s79, s78, 4096
    s_bitcmp1_b32 s85, 1
    s_cselect_b32 s79, s79, 0x1ff00000
    s_lshl_b32 s57, s79, 2
    s_lshl_b32 s62, s79, 1

    s_add_u32 s79, s78, 8192
    s_bitcmp1_b32 s85, 2
    s_cselect_b32 s79, s79, 0x1ff00000
    s_lshl_b32 s58, s79, 2
    s_lshl_b32 s63, s79, 1

    s_add_u32 s79, s78, 12288
    s_bitcmp1_b32 s85, 3
    s_cselect_b32 s79, s79, 0x1ff00000
    s_lshl_b32 s59, s79, 2
    s_lshl_b32 s64, s79, 1

    s_getreg_b32 s5, hwreg(HW_REG_XCC_ID)
    s_and_b32 s5, s5, 7
    s_mul_i32 s3, s5, 4096

    s_add_u32 s20, s6, s3
    s_addc_u32 s21, s7, 0
    s_mov_b32 s22, 4096
    s_mov_b32 s23, 0x20000
    s_mul_i32 s3, s5, 67117056
    s_add_u32 s3, s3, 85721088
    s_add_u32 s24, s6, s3
    s_addc_u32 s25, s7, 0
    s_mov_b32 s26, 67117056
    s_mov_b32 s27, 0x20000
    s_add_u32 s36, s6, 32768
    s_addc_u32 s37, s7, 0
    s_mov_b32 s38, 4
    s_mov_b32 s39, 0x20000
    s_mov_b32 s40, 687195
    s_mov_b32 s42, -6250
    s_mov_b32 s43, 1942
    s_mov_b32 s45, 0x06050400
    s_mov_b32 s46, 0x05040c00
    s_mov_b32 s48, 6524
    s_mov_b32 s50, 0
    v_mov_b32 v104, 1
    v_mov_b32 v105, 0x46ff8000
    s_mov_b32 s55, 0x05040100
    v_mul_u32_u24 v106, 5, v0

    v_and_b32 v102, 15, v0
    v_lshrrev_b32 v103, 4, v0
    v_lshl_add_u32 v102, v102, 7, v103
    v_mul_u32_u24 v102, 32764, v102
    v_add_u32 v103, 2096896, v102

    v_and_b32 v102, 0xffffff80, v102
    v_and_b32 v103, 0xffffff80, v103
    s_movk_i32 s3, 1024
    v_cmp_gt_u32 s[66:67], s3, v0
    s_movk_i32 s3, 1024
    v_cmp_gt_u32 s[68:69], s3, v0
    s_waitcnt lgkmcnt(0)
    s_lshl_b32 s88, s88, 16
    v_mov_b32 v110, 0.15915494
    v_mul_f32 v110, s88, v110
    s_mov_b32 s3, 0x7fff7fff
    v_readfirstlane_b32 s44, v110

    s_waitcnt vmcnt(12)
    v_mov_b32 v61, 0
    v_mov_b32 v62, 0
    v_mov_b32 v63, 0
    v_dot2_f32_bf16 v61, v116, v116, v61
    v_dot2_f32_bf16 v61, v117, v117, v61
    v_dot2_f32_bf16 v61, v118, v118, v61
    v_dot2_f32_bf16 v61, v119, v119, v61
    v_dot2_f32_bf16 v61, v120, v120, v61
    v_dot2_f32_bf16 v61, v121, v121, v61
    v_dot2_f32_bf16 v61, v122, v122, v61
    v_dot2_f32_bf16 v61, v123, v123, v61
    v_dot2_f32_bf16 v61, v124, v124, v61
    v_dot2_f32_bf16 v62, v56, v56, v62
    v_dot2_f32_bf16 v62, v57, v57, v62
    v_dot2_f32_bf16 v62, v58, v58, v62
    v_dot2_f32_bf16 v62, v59, v59, v62
    v_and_b32 v60, s3, v116
    v_and_b32 v64, s3, v117
    v_pk_max_u16 v60, v60, v64
    v_and_b32 v64, s3, v118
    v_pk_max_u16 v60, v60, v64
    v_and_b32 v64, s3, v119
    v_pk_max_u16 v60, v60, v64
    v_and_b32 v64, s3, v120
    v_pk_max_u16 v60, v60, v64
    v_and_b32 v64, s3, v121
    v_pk_max_u16 v60, v60, v64
    v_and_b32 v64, s3, v122
    v_pk_max_u16 v60, v60, v64
    v_and_b32 v64, s3, v123
    v_pk_max_u16 v60, v60, v64
    v_and_b32 v64, s3, v124
    v_pk_max_u16 v60, v60, v64
    v_lshrrev_b32 v64, 16, v60
    v_and_b32 v60, 0xffff, v60
    v_max_u32 v60, v60, v64

    s_nop 1
    v_max_u32_dpp v60, v60, v60 row_shr:1 row_mask:0xf bank_mask:0xf
    s_nop 1
    v_max_u32_dpp v60, v60, v60 row_shr:2 row_mask:0xf bank_mask:0xf
    s_nop 1
    v_max_u32_dpp v60, v60, v60 row_shr:4 row_mask:0xf bank_mask:0xf
    s_nop 1
    v_max_u32_dpp v60, v60, v60 row_shr:8 row_mask:0xf bank_mask:0xf
    s_nop 1
    v_max_u32_dpp v60, v60, v60 row_bcast:15 row_mask:0xa bank_mask:0xf
    s_nop 1
    v_max_u32_dpp v60, v60, v60 row_bcast:31 row_mask:0xc bank_mask:0xf
    s_nop 1
    v_add_f32_dpp v61, v61, v61 row_shr:1 row_mask:0xf bank_mask:0xf
    s_nop 1
    v_add_f32_dpp v61, v61, v61 row_shr:2 row_mask:0xf bank_mask:0xf
    s_nop 1
    v_add_f32_dpp v61, v61, v61 row_shr:4 row_mask:0xf bank_mask:0xf
    s_nop 1
    v_add_f32_dpp v61, v61, v61 row_shr:8 row_mask:0xf bank_mask:0xf
    s_nop 1
    v_add_f32_dpp v61, v61, v61 row_bcast:15 row_mask:0xa bank_mask:0xf
    s_nop 1
    v_add_f32_dpp v61, v61, v61 row_bcast:31 row_mask:0xc bank_mask:0xf
    s_nop 1
    v_add_f32_dpp v62, v62, v62 row_shr:1 row_mask:0xf bank_mask:0xf
    s_nop 1
    v_add_f32_dpp v62, v62, v62 row_shr:2 row_mask:0xf bank_mask:0xf
    s_nop 1
    v_add_f32_dpp v62, v62, v62 row_shr:4 row_mask:0xf bank_mask:0xf
    s_nop 1
    v_add_f32_dpp v62, v62, v62 row_shr:8 row_mask:0xf bank_mask:0xf
    s_nop 1
    v_add_f32_dpp v62, v62, v62 row_bcast:15 row_mask:0xa bank_mask:0xf
    s_nop 1
    v_add_f32_dpp v62, v62, v62 row_bcast:31 row_mask:0xc bank_mask:0xf
    v_lshrrev_b32 v64, 6, v0
    v_lshlrev_b32 v64, 4, v64
    s_mov_b32 exec_lo, 0
    s_brev_b32 exec_hi, 1
    ds_write_b128 v64, v[60:63] offset:16384
    s_mov_b64 exec, -1

    s_bitcmp0_b32 s82, 0
    s_cbranch_scc1 L_ska_8
    s_waitcnt vmcnt(9)
    v_mul_hi_u32_u24 v45, s40, v20
    v_mul_hi_u32_u24 v44, s40, v4
    v_mul_hi_u32_u24 v47, s40, v21
    v_mul_hi_u32_u24 v46, s40, v5
    v_mul_hi_u32_u24 v49, s40, v22
    v_mul_hi_u32_u24 v48, s40, v6
    v_mul_hi_u32_u24 v51, s40, v23
    v_mul_hi_u32_u24 v50, s40, v7
    v_and_b32 v45, -2, v45
    v_mad_u32_u24 v4, v44, s43, v4
    v_and_b32 v76, -4, v44
    v_and_b32 v47, -2, v47
    v_mad_u32_u24 v5, v46, s43, v5
    v_and_b32 v77, -4, v46
    v_and_b32 v49, -2, v49
    v_mad_u32_u24 v6, v48, s43, v6
    v_and_b32 v78, -4, v48
    v_and_b32 v51, -2, v51
    v_mad_u32_u24 v7, v50, s43, v7
    v_and_b32 v79, -4, v50
    v_mad_i32_i24 v20, v45, s42, v20
    v_lshl_add_u32 v45, v45, 6, v76
    v_mad_i32_i24 v21, v47, s42, v21
    v_lshl_add_u32 v47, v47, 6, v77
    v_mad_i32_i24 v22, v49, s42, v22
    v_lshl_add_u32 v49, v49, 6, v78
    v_mad_i32_i24 v23, v51, s42, v23
    v_lshl_add_u32 v51, v51, 6, v79
    ds_add_rtn_u32 v76, v45, v104
    ds_add_rtn_u32 v77, v47, v104
    ds_add_rtn_u32 v78, v49, v104
    ds_add_rtn_u32 v79, v51, v104
    v_lshlrev_b32 v110, 16, v36
    v_and_b32 v111, 0xffff0000, v36
    v_lshlrev_b32 v112, 16, v37
    v_and_b32 v113, 0xffff0000, v37
    v_mul_f32 v110, s44, v110
    v_mul_f32 v111, s44, v111
    v_mul_f32 v112, s44, v112
    v_mul_f32 v113, s44, v113
    v_fract_f32 v110, v110
    v_fract_f32 v111, v111
    v_fract_f32 v112, v112
    v_fract_f32 v113, v113
    v_cos_f32 v110, v110
    v_cos_f32 v111, v111
    v_cos_f32 v112, v112
    v_cos_f32 v113, v113
    v_lshl_or_b32 v44, v44, 14, v20
    v_perm_b32 v45, v45, v4, s46
    v_bfe_u32 v4, v4, 8, 5

    v_lshl_or_b32 v46, v46, 14, v21
    v_perm_b32 v47, v47, v5, s46
    v_bfe_u32 v5, v5, 8, 5

    v_lshl_or_b32 v48, v48, 14, v22
    v_perm_b32 v49, v49, v6, s46
    v_bfe_u32 v6, v6, 8, 5

    v_lshl_or_b32 v50, v50, 14, v23
    v_perm_b32 v51, v51, v7, s46
    v_bfe_u32 v7, v7, 8, 5

    v_fmaak_f32 v110, v110, v105, 0x4b400010
    v_fmaak_f32 v111, v111, v105, 0x4b400010
    v_fmaak_f32 v112, v112, v105, 0x4b400010
    v_fmaak_f32 v113, v113, v105, 0x4b400010
    v_sub_u32 v110, v110, v4
    v_sub_u32 v111, v111, v5
    v_sub_u32 v112, v112, v6
    v_sub_u32 v113, v113, v7
    v_bfi_b32 v110, 31, v4, v110
    v_bfi_b32 v111, 31, v5, v111
    v_bfi_b32 v112, 31, v6, v112
    v_bfi_b32 v113, 31, v7, v113
    v_perm_b32 v44, v44, v110, s55
    v_perm_b32 v46, v46, v111, s55
    v_perm_b32 v48, v48, v112, s55
    v_perm_b32 v50, v50, v113, s55
    buffer_load_dwordx4 v[20:23], v1, s[12:15], s56 offen nt
    buffer_load_dwordx4 v[4:7], v1, s[8:11], s56 offen nt
    buffer_load_dwordx2 v[36:37], v2, s[16:19], s61 offen nt
L_bka_9:
    s_bitcmp0_b32 s82, 1
    s_cbranch_scc1 L_ska_10
    s_waitcnt vmcnt(9)
    v_mul_hi_u32_u24 v53, s40, v24
    v_mul_hi_u32_u24 v52, s40, v8
    v_mul_hi_u32_u24 v55, s40, v25
    v_mul_hi_u32_u24 v54, s40, v9
    v_mul_hi_u32_u24 v57, s40, v26
    v_mul_hi_u32_u24 v56, s40, v10
    v_mul_hi_u32_u24 v59, s40, v27
    v_mul_hi_u32_u24 v58, s40, v11
    v_and_b32 v53, -2, v53
    v_mad_u32_u24 v8, v52, s43, v8
    v_and_b32 v80, -4, v52
    v_and_b32 v55, -2, v55
    v_mad_u32_u24 v9, v54, s43, v9
    v_and_b32 v81, -4, v54
    v_and_b32 v57, -2, v57
    v_mad_u32_u24 v10, v56, s43, v10
    v_and_b32 v82, -4, v56
    v_and_b32 v59, -2, v59
    v_mad_u32_u24 v11, v58, s43, v11
    v_and_b32 v83, -4, v58
    v_mad_i32_i24 v24, v53, s42, v24
    v_lshl_add_u32 v53, v53, 6, v80
    v_mad_i32_i24 v25, v55, s42, v25
    v_lshl_add_u32 v55, v55, 6, v81
    v_mad_i32_i24 v26, v57, s42, v26
    v_lshl_add_u32 v57, v57, 6, v82
    v_mad_i32_i24 v27, v59, s42, v27
    v_lshl_add_u32 v59, v59, 6, v83
    ds_add_rtn_u32 v80, v53, v104
    ds_add_rtn_u32 v81, v55, v104
    ds_add_rtn_u32 v82, v57, v104
    ds_add_rtn_u32 v83, v59, v104
    v_lshlrev_b32 v110, 16, v38
    v_and_b32 v111, 0xffff0000, v38
    v_lshlrev_b32 v112, 16, v39
    v_and_b32 v113, 0xffff0000, v39
    v_mul_f32 v110, s44, v110
    v_mul_f32 v111, s44, v111
    v_mul_f32 v112, s44, v112
    v_mul_f32 v113, s44, v113
    v_fract_f32 v110, v110
    v_fract_f32 v111, v111
    v_fract_f32 v112, v112
    v_fract_f32 v113, v113
    v_cos_f32 v110, v110
    v_cos_f32 v111, v111
    v_cos_f32 v112, v112
    v_cos_f32 v113, v113
    v_lshl_or_b32 v52, v52, 14, v24
    v_perm_b32 v53, v53, v8, s46
    v_bfe_u32 v8, v8, 8, 5

    v_lshl_or_b32 v54, v54, 14, v25
    v_perm_b32 v55, v55, v9, s46
    v_bfe_u32 v9, v9, 8, 5

    v_lshl_or_b32 v56, v56, 14, v26
    v_perm_b32 v57, v57, v10, s46
    v_bfe_u32 v10, v10, 8, 5

    v_lshl_or_b32 v58, v58, 14, v27
    v_perm_b32 v59, v59, v11, s46
    v_bfe_u32 v11, v11, 8, 5

    v_fmaak_f32 v110, v110, v105, 0x4b400010
    v_fmaak_f32 v111, v111, v105, 0x4b400010
    v_fmaak_f32 v112, v112, v105, 0x4b400010
    v_fmaak_f32 v113, v113, v105, 0x4b400010
    v_sub_u32 v110, v110, v8
    v_sub_u32 v111, v111, v9
    v_sub_u32 v112, v112, v10
    v_sub_u32 v113, v113, v11
    v_bfi_b32 v110, 31, v8, v110
    v_bfi_b32 v111, 31, v9, v111
    v_bfi_b32 v112, 31, v10, v112
    v_bfi_b32 v113, 31, v11, v113
    v_perm_b32 v52, v52, v110, s55
    v_perm_b32 v54, v54, v111, s55
    v_perm_b32 v56, v56, v112, s55
    v_perm_b32 v58, v58, v113, s55
    buffer_load_dwordx4 v[24:27], v1, s[12:15], s57 offen nt
    buffer_load_dwordx4 v[8:11], v1, s[8:11], s57 offen nt
    buffer_load_dwordx2 v[38:39], v2, s[16:19], s62 offen nt
L_bka_11:
    s_bitcmp0_b32 s82, 2
    s_cbranch_scc1 L_ska_12
    s_waitcnt vmcnt(9)
    v_mul_hi_u32_u24 v61, s40, v28
    v_mul_hi_u32_u24 v60, s40, v12
    v_mul_hi_u32_u24 v63, s40, v29
    v_mul_hi_u32_u24 v62, s40, v13
    v_mul_hi_u32_u24 v65, s40, v30
    v_mul_hi_u32_u24 v64, s40, v14
    v_mul_hi_u32_u24 v67, s40, v31
    v_mul_hi_u32_u24 v66, s40, v15
    v_and_b32 v61, -2, v61
    v_mad_u32_u24 v12, v60, s43, v12
    v_and_b32 v84, -4, v60
    v_and_b32 v63, -2, v63
    v_mad_u32_u24 v13, v62, s43, v13
    v_and_b32 v85, -4, v62
    v_and_b32 v65, -2, v65
    v_mad_u32_u24 v14, v64, s43, v14
    v_and_b32 v86, -4, v64
    v_and_b32 v67, -2, v67
    v_mad_u32_u24 v15, v66, s43, v15
    v_and_b32 v87, -4, v66
    v_mad_i32_i24 v28, v61, s42, v28
    v_lshl_add_u32 v61, v61, 6, v84
    v_mad_i32_i24 v29, v63, s42, v29
    v_lshl_add_u32 v63, v63, 6, v85
    v_mad_i32_i24 v30, v65, s42, v30
    v_lshl_add_u32 v65, v65, 6, v86
    v_mad_i32_i24 v31, v67, s42, v31
    v_lshl_add_u32 v67, v67, 6, v87
    ds_add_rtn_u32 v84, v61, v104
    ds_add_rtn_u32 v85, v63, v104
    ds_add_rtn_u32 v86, v65, v104
    ds_add_rtn_u32 v87, v67, v104
    v_lshlrev_b32 v110, 16, v40
    v_and_b32 v111, 0xffff0000, v40
    v_lshlrev_b32 v112, 16, v41
    v_and_b32 v113, 0xffff0000, v41
    v_mul_f32 v110, s44, v110
    v_mul_f32 v111, s44, v111
    v_mul_f32 v112, s44, v112
    v_mul_f32 v113, s44, v113
    v_fract_f32 v110, v110
    v_fract_f32 v111, v111
    v_fract_f32 v112, v112
    v_fract_f32 v113, v113
    v_cos_f32 v110, v110
    v_cos_f32 v111, v111
    v_cos_f32 v112, v112
    v_cos_f32 v113, v113
    v_lshl_or_b32 v60, v60, 14, v28
    v_perm_b32 v61, v61, v12, s46
    v_bfe_u32 v12, v12, 8, 5

    v_lshl_or_b32 v62, v62, 14, v29
    v_perm_b32 v63, v63, v13, s46
    v_bfe_u32 v13, v13, 8, 5

    v_lshl_or_b32 v64, v64, 14, v30
    v_perm_b32 v65, v65, v14, s46
    v_bfe_u32 v14, v14, 8, 5

    v_lshl_or_b32 v66, v66, 14, v31
    v_perm_b32 v67, v67, v15, s46
    v_bfe_u32 v15, v15, 8, 5

    v_fmaak_f32 v110, v110, v105, 0x4b400010
    v_fmaak_f32 v111, v111, v105, 0x4b400010
    v_fmaak_f32 v112, v112, v105, 0x4b400010
    v_fmaak_f32 v113, v113, v105, 0x4b400010
    v_sub_u32 v110, v110, v12
    v_sub_u32 v111, v111, v13
    v_sub_u32 v112, v112, v14
    v_sub_u32 v113, v113, v15
    v_bfi_b32 v110, 31, v12, v110
    v_bfi_b32 v111, 31, v13, v111
    v_bfi_b32 v112, 31, v14, v112
    v_bfi_b32 v113, 31, v15, v113
    v_perm_b32 v60, v60, v110, s55
    v_perm_b32 v62, v62, v111, s55
    v_perm_b32 v64, v64, v112, s55
    v_perm_b32 v66, v66, v113, s55
    buffer_load_dwordx4 v[28:31], v1, s[12:15], s58 offen nt
    buffer_load_dwordx4 v[12:15], v1, s[8:11], s58 offen nt
    buffer_load_dwordx2 v[40:41], v2, s[16:19], s63 offen nt
L_bka_13:
    s_bitcmp0_b32 s82, 3
    s_cbranch_scc1 L_ska_14
    s_waitcnt vmcnt(9)
    s_mov_b64 exec, s[66:67]
    v_mul_hi_u32_u24 v69, s40, v32
    v_mul_hi_u32_u24 v68, s40, v16
    v_mul_hi_u32_u24 v71, s40, v33
    v_mul_hi_u32_u24 v70, s40, v17
    v_mul_hi_u32_u24 v73, s40, v34
    v_mul_hi_u32_u24 v72, s40, v18
    v_mul_hi_u32_u24 v75, s40, v35
    v_mul_hi_u32_u24 v74, s40, v19
    v_and_b32 v69, -2, v69
    v_mad_u32_u24 v16, v68, s43, v16
    v_and_b32 v88, -4, v68
    v_and_b32 v71, -2, v71
    v_mad_u32_u24 v17, v70, s43, v17
    v_and_b32 v89, -4, v70
    v_and_b32 v73, -2, v73
    v_mad_u32_u24 v18, v72, s43, v18
    v_and_b32 v90, -4, v72
    v_and_b32 v75, -2, v75
    v_mad_u32_u24 v19, v74, s43, v19
    v_and_b32 v91, -4, v74
    v_mad_i32_i24 v32, v69, s42, v32
    v_lshl_add_u32 v69, v69, 6, v88
    v_mad_i32_i24 v33, v71, s42, v33
    v_lshl_add_u32 v71, v71, 6, v89
    v_mad_i32_i24 v34, v73, s42, v34
    v_lshl_add_u32 v73, v73, 6, v90
    v_mad_i32_i24 v35, v75, s42, v35
    v_lshl_add_u32 v75, v75, 6, v91
    ds_add_rtn_u32 v88, v69, v104
    ds_add_rtn_u32 v89, v71, v104
    ds_add_rtn_u32 v90, v73, v104
    ds_add_rtn_u32 v91, v75, v104
    v_lshlrev_b32 v110, 16, v42
    v_and_b32 v111, 0xffff0000, v42
    v_lshlrev_b32 v112, 16, v43
    v_and_b32 v113, 0xffff0000, v43
    v_mul_f32 v110, s44, v110
    v_mul_f32 v111, s44, v111
    v_mul_f32 v112, s44, v112
    v_mul_f32 v113, s44, v113
    v_fract_f32 v110, v110
    v_fract_f32 v111, v111
    v_fract_f32 v112, v112
    v_fract_f32 v113, v113
    v_cos_f32 v110, v110
    v_cos_f32 v111, v111
    v_cos_f32 v112, v112
    v_cos_f32 v113, v113
    v_lshl_or_b32 v68, v68, 14, v32
    v_perm_b32 v69, v69, v16, s46
    v_bfe_u32 v16, v16, 8, 5

    v_lshl_or_b32 v70, v70, 14, v33
    v_perm_b32 v71, v71, v17, s46
    v_bfe_u32 v17, v17, 8, 5

    v_lshl_or_b32 v72, v72, 14, v34
    v_perm_b32 v73, v73, v18, s46
    v_bfe_u32 v18, v18, 8, 5

    v_lshl_or_b32 v74, v74, 14, v35
    v_perm_b32 v75, v75, v19, s46
    v_bfe_u32 v19, v19, 8, 5

    v_fmaak_f32 v110, v110, v105, 0x4b400010
    v_fmaak_f32 v111, v111, v105, 0x4b400010
    v_fmaak_f32 v112, v112, v105, 0x4b400010
    v_fmaak_f32 v113, v113, v105, 0x4b400010
    v_sub_u32 v110, v110, v16
    v_sub_u32 v111, v111, v17
    v_sub_u32 v112, v112, v18
    v_sub_u32 v113, v113, v19
    v_bfi_b32 v110, 31, v16, v110
    v_bfi_b32 v111, 31, v17, v111
    v_bfi_b32 v112, 31, v18, v112
    v_bfi_b32 v113, 31, v19, v113
    v_perm_b32 v68, v68, v110, s55
    v_perm_b32 v70, v70, v111, s55
    v_perm_b32 v72, v72, v112, s55
    v_perm_b32 v74, v74, v113, s55
    s_mov_b64 exec, -1
    buffer_load_dwordx4 v[32:35], v1, s[12:15], s59 offen nt
    buffer_load_dwordx4 v[16:19], v1, s[8:11], s59 offen nt
    buffer_load_dwordx2 v[42:43], v2, s[16:19], s64 offen nt
L_bka_15:
    v_readfirstlane_b32 s74, v0
    s_nop 1
    s_cmp_lg_u32 s74, 0
    s_cbranch_scc1 L_ready_17

    v_mov_b32 v100, 0
    buffer_atomic_add v100, v98, s[96:99], 0 offen offset:128 sc0
    s_waitcnt vmcnt(0)
    v_readfirstlane_b32 s74, v100
    s_nop 1
    s_cmp_lg_u32 s74, 0
    s_cbranch_scc1 L_ready_17

    v_mov_b32 v110, 1
    buffer_atomic_add v110, v98, s[96:99], 0 offen offset:64 sc0
    s_waitcnt vmcnt(0)
    v_readfirstlane_b32 s74, v110
    s_nop 1
    s_cmp_lg_u32 s74, 0
    s_cbranch_scc1 L_zno_19

    s_mov_b32 s92, s6
    s_mov_b32 s93, s7
    s_mov_b32 s94, 32784
    s_mov_b32 s95, 0x20000
    v_mov_b32 v110, 0
    v_mov_b32 v111, 0
    v_mov_b32 v112, 0
    v_mov_b32 v113, 0
L_zl_18:
    buffer_store_dwordx4 v[110:113], v1, s[92:95], s74 offen sc0 sc1
    s_add_u32 s74, s74, 1024
    s_cmp_le_u32 s74, 32768
    s_cbranch_scc1 L_zl_18
    v_mov_b32 v114, 1
    s_waitcnt vmcnt(0)
    buffer_atomic_add v114, v98, s[96:99], 0 offen offset:128
L_zno_19:

L_spin_16:
    v_mov_b32 v100, 0
    buffer_atomic_add v100, v98, s[96:99], 0 offen offset:128 sc0
    s_waitcnt vmcnt(0)
    v_readfirstlane_b32 s74, v100
    s_nop 1
    s_cmp_eq_u32 s74, 0
    s_cbranch_scc1 L_spin_16
L_ready_17:

    s_waitcnt lgkmcnt(0)
    s_barrier

    v_and_b32 v114, 15, v0
    v_lshlrev_b32 v114, 4, v114
    ds_read_b128 v[110:113], v114 offset:16384
    s_waitcnt lgkmcnt(0)

    s_nop 0
    v_max_u32_dpp v110, v110, v110 row_ror:1 row_mask:0xf bank_mask:0xf
    v_add_f32_dpp v111, v111, v111 row_ror:1 row_mask:0xf bank_mask:0xf
    v_add_f32_dpp v112, v112, v112 row_ror:1 row_mask:0xf bank_mask:0xf

    s_nop 0
    v_max_u32_dpp v110, v110, v110 row_ror:2 row_mask:0xf bank_mask:0xf
    v_add_f32_dpp v111, v111, v111 row_ror:2 row_mask:0xf bank_mask:0xf
    v_add_f32_dpp v112, v112, v112 row_ror:2 row_mask:0xf bank_mask:0xf

    s_nop 0
    v_max_u32_dpp v110, v110, v110 row_ror:4 row_mask:0xf bank_mask:0xf
    v_add_f32_dpp v111, v111, v111 row_ror:4 row_mask:0xf bank_mask:0xf
    v_add_f32_dpp v112, v112, v112 row_ror:4 row_mask:0xf bank_mask:0xf

    s_nop 0
    v_max_u32_dpp v110, v110, v110 row_ror:8 row_mask:0xf bank_mask:0xf
    v_add_f32_dpp v111, v111, v111 row_ror:8 row_mask:0xf bank_mask:0xf
    v_add_f32_dpp v112, v112, v112 row_ror:8 row_mask:0xf bank_mask:0xf

    v_rsq_f32 v112, v112
    v_readfirstlane_b32 s32, v110
    v_mul_f32 v112, 0x47decb04, v112
    v_readfirstlane_b32 s33, v111
    v_readfirstlane_b32 s34, v112

    ds_read_b64 v[94:95], v2
    s_waitcnt lgkmcnt(0)
    v_add_u32 v97, v94, v95
    s_nop 1
    v_add_u32_dpp v97, v97, v97 row_shr:1 row_mask:0xf bank_mask:0xf
    s_nop 1
    v_add_u32_dpp v97, v97, v97 row_shr:2 row_mask:0xf bank_mask:0xf
    s_nop 1
    v_add_u32_dpp v97, v97, v97 row_shr:4 row_mask:0xf bank_mask:0xf
    s_nop 1
    v_add_u32_dpp v97, v97, v97 row_shr:8 row_mask:0xf bank_mask:0xf
    s_nop 1
    v_add_u32_dpp v97, v97, v97 row_bcast:15 row_mask:0xa bank_mask:0xf
    s_nop 1
    v_add_u32_dpp v97, v97, v97 row_bcast:31 row_mask:0xc bank_mask:0xf
    s_mov_b32 exec_lo, 0
    s_brev_b32 exec_hi, 1
    ds_add_rtn_u32 v96, v108, v97
    s_mov_b64 exec, -1

    v_add_u32 v92, v94, v94
    v_add_u32 v93, v95, v95
    v_med3_u32 v92, v94, 2, v92
    v_med3_u32 v93, v95, 2, v93
    v_lshl_or_b32 v92, v93, 16, v92
    v_lshlrev_b32 v93, 2, v0
    buffer_atomic_add v92, v93, s[20:23], 0 offen sc0
    s_waitcnt lgkmcnt(0)
    v_readlane_b32 s77, v96, 63
    v_sub_u32 v97, v97, v95
    s_sub_u32 s50, s50, s83
    s_sub_u32 s77, s77, s50
    v_add_u32 v97, s77, v97
    v_sub_u32 v96, v97, v94
    v_lshlrev_b32 v111, 3, v97
    v_lshlrev_b32 v110, 3, v96
    v_mov_b32 v112, 0
    v_mov_b32 v113, 0
    ds_write_b64 v2, v[110:111] offset:8192
    ds_write_b64 v2, v[112:113]
    v_mad_i32_i24 v96, v96, -5, v102
    v_mad_i32_i24 v97, v97, -5, v103
    s_add_u32 s50, s50, s84
    s_mov_b32 s28, s82
    s_mov_b32 s29, s83
    s_mov_b32 s30, s84
    s_lshl_b32 s74, s29, 3
    s_lshl_b32 s75, s30, 3
    v_mov_b32 v125, s74
    v_mov_b32 v126, s75
    v_mov_b32 v127, -1

    s_waitcnt lgkmcnt(0)
    s_barrier

    s_mov_b64 exec, 1
    ds_write_b32 v125, v127 offset:24588
    ds_write_b32 v126, v127 offset:24596
    s_mov_b64 exec, -1

    s_bitcmp0_b32 s28, 0
    s_cbranch_scc1 L_skz_20
    v_lshrrev_b32 v110, 16, v45
    ds_read_b32 v110, v110 offset:8192
    v_lshrrev_b32 v111, 16, v47
    ds_read_b32 v111, v111 offset:8192
    v_lshrrev_b32 v112, 16, v49
    ds_read_b32 v112, v112 offset:8192
    v_lshrrev_b32 v113, 16, v51
    ds_read_b32 v113, v113 offset:8192
    s_waitcnt lgkmcnt(3)
    v_lshl_add_u32 v110, v76, 3, v110
    ds_write_b64 v110, v[44:45] offset:24592

    s_waitcnt lgkmcnt(3)
    v_lshl_add_u32 v111, v77, 3, v111
    ds_write_b64 v111, v[46:47] offset:24592

    s_waitcnt lgkmcnt(3)
    v_lshl_add_u32 v112, v78, 3, v112
    ds_write_b64 v112, v[48:49] offset:24592

    s_waitcnt lgkmcnt(3)
    v_lshl_add_u32 v113, v79, 3, v113
    ds_write_b64 v113, v[50:51] offset:24592

L_skz_20:
    s_bitcmp0_b32 s28, 1
    s_cbranch_scc1 L_skz_21
    v_lshrrev_b32 v110, 16, v53
    ds_read_b32 v110, v110 offset:8192
    v_lshrrev_b32 v111, 16, v55
    ds_read_b32 v111, v111 offset:8192
    v_lshrrev_b32 v112, 16, v57
    ds_read_b32 v112, v112 offset:8192
    v_lshrrev_b32 v113, 16, v59
    ds_read_b32 v113, v113 offset:8192
    s_waitcnt lgkmcnt(3)
    v_lshl_add_u32 v110, v80, 3, v110
    ds_write_b64 v110, v[52:53] offset:24592

    s_waitcnt lgkmcnt(3)
    v_lshl_add_u32 v111, v81, 3, v111
    ds_write_b64 v111, v[54:55] offset:24592

    s_waitcnt lgkmcnt(3)
    v_lshl_add_u32 v112, v82, 3, v112
    ds_write_b64 v112, v[56:57] offset:24592

    s_waitcnt lgkmcnt(3)
    v_lshl_add_u32 v113, v83, 3, v113
    ds_write_b64 v113, v[58:59] offset:24592

L_skz_21:
    s_bitcmp0_b32 s28, 2
    s_cbranch_scc1 L_skz_22
    v_lshrrev_b32 v110, 16, v61
    ds_read_b32 v110, v110 offset:8192
    v_lshrrev_b32 v111, 16, v63
    ds_read_b32 v111, v111 offset:8192
    v_lshrrev_b32 v112, 16, v65
    ds_read_b32 v112, v112 offset:8192
    v_lshrrev_b32 v113, 16, v67
    ds_read_b32 v113, v113 offset:8192
    s_waitcnt lgkmcnt(3)
    v_lshl_add_u32 v110, v84, 3, v110
    ds_write_b64 v110, v[60:61] offset:24592

    s_waitcnt lgkmcnt(3)
    v_lshl_add_u32 v111, v85, 3, v111
    ds_write_b64 v111, v[62:63] offset:24592

    s_waitcnt lgkmcnt(3)
    v_lshl_add_u32 v112, v86, 3, v112
    ds_write_b64 v112, v[64:65] offset:24592

    s_waitcnt lgkmcnt(3)
    v_lshl_add_u32 v113, v87, 3, v113
    ds_write_b64 v113, v[66:67] offset:24592

L_skz_22:
    s_bitcmp0_b32 s28, 3
    s_cbranch_scc1 L_skz_23
    s_mov_b64 exec, s[66:67]
    v_lshrrev_b32 v110, 16, v69
    ds_read_b32 v110, v110 offset:8192
    v_lshrrev_b32 v111, 16, v71
    ds_read_b32 v111, v111 offset:8192
    v_lshrrev_b32 v112, 16, v73
    ds_read_b32 v112, v112 offset:8192
    v_lshrrev_b32 v113, 16, v75
    ds_read_b32 v113, v113 offset:8192
    s_waitcnt lgkmcnt(3)
    v_lshl_add_u32 v110, v88, 3, v110
    ds_write_b64 v110, v[68:69] offset:24592

    s_waitcnt lgkmcnt(3)
    v_lshl_add_u32 v111, v89, 3, v111
    ds_write_b64 v111, v[70:71] offset:24592

    s_waitcnt lgkmcnt(3)
    v_lshl_add_u32 v112, v90, 3, v112
    ds_write_b64 v112, v[72:73] offset:24592

    s_waitcnt lgkmcnt(3)
    v_lshl_add_u32 v113, v91, 3, v113
    ds_write_b64 v113, v[74:75] offset:24592

    s_mov_b64 exec, -1
L_skz_23:
    v_mov_b32 v110, s32
    v_mov_b32 v111, s33
    v_mov_b32 v112, s34
    v_mov_b32 v113, 0
    v_mov_b32 v115, 0x4b400000

    s_add_u32 s92, s6, 135168
    s_addc_u32 s93, s7, 0
    s_mov_b32 s94, 4096
    s_mov_b32 s95, 0x20000
    s_lshl_b32 s3, s2, 4
    buffer_store_dwordx4 v[110:113], v98, s[92:95], s3 offen
    v_lshlrev_b32 v107, 16, v116
    v_and_b32 v116, 0xffff0000, v116
    v_fma_f32 v107, v107, s34, v115
    v_fma_f32 v116, v116, s34, v115
    v_perm_b32 v116, v116, v107, s55

    v_lshlrev_b32 v107, 16, v117
    v_and_b32 v117, 0xffff0000, v117
    v_fma_f32 v107, v107, s34, v115
    v_fma_f32 v117, v117, s34, v115
    v_perm_b32 v117, v117, v107, s55

    v_lshlrev_b32 v107, 16, v118
    v_and_b32 v118, 0xffff0000, v118
    v_fma_f32 v107, v107, s34, v115
    v_fma_f32 v118, v118, s34, v115
    v_perm_b32 v118, v118, v107, s55

    v_lshlrev_b32 v107, 16, v119
    v_and_b32 v119, 0xffff0000, v119
    v_fma_f32 v107, v107, s34, v115
    v_fma_f32 v119, v119, s34, v115
    v_perm_b32 v119, v119, v107, s55

    v_lshlrev_b32 v107, 16, v120
    v_and_b32 v120, 0xffff0000, v120
    v_fma_f32 v107, v107, s34, v115
    v_fma_f32 v120, v120, s34, v115
    v_perm_b32 v120, v120, v107, s55

    v_lshlrev_b32 v107, 16, v121
    v_and_b32 v121, 0xffff0000, v121
    v_fma_f32 v107, v107, s34, v115
    v_fma_f32 v121, v121, s34, v115
    v_perm_b32 v121, v121, v107, s55

    v_lshlrev_b32 v107, 16, v122
    v_and_b32 v122, 0xffff0000, v122
    v_fma_f32 v107, v107, s34, v115
    v_fma_f32 v122, v122, s34, v115
    v_perm_b32 v122, v122, v107, s55

    v_lshlrev_b32 v107, 16, v123
    v_and_b32 v123, 0xffff0000, v123
    v_fma_f32 v107, v107, s34, v115
    v_fma_f32 v123, v123, s34, v115
    v_perm_b32 v123, v123, v107, s55

    v_lshlrev_b32 v107, 16, v124
    v_and_b32 v124, 0xffff0000, v124
    v_fma_f32 v107, v107, s34, v115
    v_fma_f32 v124, v124, s34, v115
    v_perm_b32 v124, v124, v107, s55

    s_add_u32 s92, s6, s54
    s_addc_u32 s93, s7, 0
    s_mov_b32 s94, 24576
    s_mov_b32 s95, 0x20000
    s_movk_i32 s3, 16384
    buffer_store_dwordx4 v[116:119], v1, s[92:95], 0 offen
    buffer_store_dwordx4 v[120:123], v1, s[92:95], s3 offen
    s_mul_i32 s94, s53, 25424
    s_movk_i32 s3, 24576
    v_lshlrev_b32 v107, 2, v0

    buffer_store_dword v124, v107, s[92:95], s3 offen
    s_nop 1
    s_cmp_eq_u32 s49, 0
    s_cbranch_scc1 L_p1epi_7
L_p1loop_6:
    s_mov_b32 s82, s85
    s_mov_b32 s83, s86
    s_mov_b32 s84, s87
    v_mov_b32 v99, 1
    buffer_atomic_add v99, v98, s[96:99], 0 offen sc0
    s_bitcmp0_b32 s82, 0
    s_cbranch_scc1 L_ska_24
    s_waitcnt vmcnt(11)
    v_mul_hi_u32_u24 v45, s40, v20
    v_mul_hi_u32_u24 v44, s40, v4
    v_mul_hi_u32_u24 v47, s40, v21
    v_mul_hi_u32_u24 v46, s40, v5
    v_mul_hi_u32_u24 v49, s40, v22
    v_mul_hi_u32_u24 v48, s40, v6
    v_mul_hi_u32_u24 v51, s40, v23
    v_mul_hi_u32_u24 v50, s40, v7
    v_and_b32 v45, -2, v45
    v_mad_u32_u24 v4, v44, s43, v4
    v_and_b32 v76, -4, v44
    v_and_b32 v47, -2, v47
    v_mad_u32_u24 v5, v46, s43, v5
    v_and_b32 v77, -4, v46
    v_and_b32 v49, -2, v49
    v_mad_u32_u24 v6, v48, s43, v6
    v_and_b32 v78, -4, v48
    v_and_b32 v51, -2, v51
    v_mad_u32_u24 v7, v50, s43, v7
    v_and_b32 v79, -4, v50
    v_mad_i32_i24 v20, v45, s42, v20
    v_lshl_add_u32 v45, v45, 6, v76
    v_mad_i32_i24 v21, v47, s42, v21
    v_lshl_add_u32 v47, v47, 6, v77
    v_mad_i32_i24 v22, v49, s42, v22
    v_lshl_add_u32 v49, v49, 6, v78
    v_mad_i32_i24 v23, v51, s42, v23
    v_lshl_add_u32 v51, v51, 6, v79
    ds_add_rtn_u32 v76, v45, v104
    ds_add_rtn_u32 v77, v47, v104
    ds_add_rtn_u32 v78, v49, v104
    ds_add_rtn_u32 v79, v51, v104
    v_lshlrev_b32 v110, 16, v36
    v_and_b32 v111, 0xffff0000, v36
    v_lshlrev_b32 v112, 16, v37
    v_and_b32 v113, 0xffff0000, v37
    v_mul_f32 v110, s44, v110
    v_mul_f32 v111, s44, v111
    v_mul_f32 v112, s44, v112
    v_mul_f32 v113, s44, v113
    v_fract_f32 v110, v110
    v_fract_f32 v111, v111
    v_fract_f32 v112, v112
    v_fract_f32 v113, v113
    v_cos_f32 v110, v110
    v_cos_f32 v111, v111
    v_cos_f32 v112, v112
    v_cos_f32 v113, v113
    v_lshl_or_b32 v44, v44, 14, v20
    v_perm_b32 v45, v45, v4, s46
    v_bfe_u32 v4, v4, 8, 5

    v_lshl_or_b32 v46, v46, 14, v21
    v_perm_b32 v47, v47, v5, s46
    v_bfe_u32 v5, v5, 8, 5

    v_lshl_or_b32 v48, v48, 14, v22
    v_perm_b32 v49, v49, v6, s46
    v_bfe_u32 v6, v6, 8, 5

    v_lshl_or_b32 v50, v50, 14, v23
    v_perm_b32 v51, v51, v7, s46
    v_bfe_u32 v7, v7, 8, 5

    v_fmaak_f32 v110, v110, v105, 0x4b400010
    v_fmaak_f32 v111, v111, v105, 0x4b400010
    v_fmaak_f32 v112, v112, v105, 0x4b400010
    v_fmaak_f32 v113, v113, v105, 0x4b400010
    v_sub_u32 v110, v110, v4
    v_sub_u32 v111, v111, v5
    v_sub_u32 v112, v112, v6
    v_sub_u32 v113, v113, v7
    v_bfi_b32 v110, 31, v4, v110
    v_bfi_b32 v111, 31, v5, v111
    v_bfi_b32 v112, 31, v6, v112
    v_bfi_b32 v113, 31, v7, v113
    v_perm_b32 v44, v44, v110, s55
    v_perm_b32 v46, v46, v111, s55
    v_perm_b32 v48, v48, v112, s55
    v_perm_b32 v50, v50, v113, s55
L_ska_24:
    s_bitcmp0_b32 s82, 1
    s_cbranch_scc1 L_ska_25
    s_waitcnt vmcnt(8)
    v_mul_hi_u32_u24 v53, s40, v24
    v_mul_hi_u32_u24 v52, s40, v8
    v_mul_hi_u32_u24 v55, s40, v25
    v_mul_hi_u32_u24 v54, s40, v9
    v_mul_hi_u32_u24 v57, s40, v26
    v_mul_hi_u32_u24 v56, s40, v10
    v_mul_hi_u32_u24 v59, s40, v27
    v_mul_hi_u32_u24 v58, s40, v11
    v_and_b32 v53, -2, v53
    v_mad_u32_u24 v8, v52, s43, v8
    v_and_b32 v80, -4, v52
    v_and_b32 v55, -2, v55
    v_mad_u32_u24 v9, v54, s43, v9
    v_and_b32 v81, -4, v54
    v_and_b32 v57, -2, v57
    v_mad_u32_u24 v10, v56, s43, v10
    v_and_b32 v82, -4, v56
    v_and_b32 v59, -2, v59
    v_mad_u32_u24 v11, v58, s43, v11
    v_and_b32 v83, -4, v58
    v_mad_i32_i24 v24, v53, s42, v24
    v_lshl_add_u32 v53, v53, 6, v80
    v_mad_i32_i24 v25, v55, s42, v25
    v_lshl_add_u32 v55, v55, 6, v81
    v_mad_i32_i24 v26, v57, s42, v26
    v_lshl_add_u32 v57, v57, 6, v82
    v_mad_i32_i24 v27, v59, s42, v27
    v_lshl_add_u32 v59, v59, 6, v83
    ds_add_rtn_u32 v80, v53, v104
    ds_add_rtn_u32 v81, v55, v104
    ds_add_rtn_u32 v82, v57, v104
    ds_add_rtn_u32 v83, v59, v104
    v_lshlrev_b32 v110, 16, v38
    v_and_b32 v111, 0xffff0000, v38
    v_lshlrev_b32 v112, 16, v39
    v_and_b32 v113, 0xffff0000, v39
    v_mul_f32 v110, s44, v110
    v_mul_f32 v111, s44, v111
    v_mul_f32 v112, s44, v112
    v_mul_f32 v113, s44, v113
    v_fract_f32 v110, v110
    v_fract_f32 v111, v111
    v_fract_f32 v112, v112
    v_fract_f32 v113, v113
    v_cos_f32 v110, v110
    v_cos_f32 v111, v111
    v_cos_f32 v112, v112
    v_cos_f32 v113, v113
    v_lshl_or_b32 v52, v52, 14, v24
    v_perm_b32 v53, v53, v8, s46
    v_bfe_u32 v8, v8, 8, 5

    v_lshl_or_b32 v54, v54, 14, v25
    v_perm_b32 v55, v55, v9, s46
    v_bfe_u32 v9, v9, 8, 5

    v_lshl_or_b32 v56, v56, 14, v26
    v_perm_b32 v57, v57, v10, s46
    v_bfe_u32 v10, v10, 8, 5

    v_lshl_or_b32 v58, v58, 14, v27
    v_perm_b32 v59, v59, v11, s46
    v_bfe_u32 v11, v11, 8, 5

    v_fmaak_f32 v110, v110, v105, 0x4b400010
    v_fmaak_f32 v111, v111, v105, 0x4b400010
    v_fmaak_f32 v112, v112, v105, 0x4b400010
    v_fmaak_f32 v113, v113, v105, 0x4b400010
    v_sub_u32 v110, v110, v8
    v_sub_u32 v111, v111, v9
    v_sub_u32 v112, v112, v10
    v_sub_u32 v113, v113, v11
    v_bfi_b32 v110, 31, v8, v110
    v_bfi_b32 v111, 31, v9, v111
    v_bfi_b32 v112, 31, v10, v112
    v_bfi_b32 v113, 31, v11, v113
    v_perm_b32 v52, v52, v110, s55
    v_perm_b32 v54, v54, v111, s55
    v_perm_b32 v56, v56, v112, s55
    v_perm_b32 v58, v58, v113, s55
L_ska_25:
    s_bitcmp0_b32 s82, 2
    s_cbranch_scc1 L_ska_26
    s_waitcnt vmcnt(4)
    v_mul_hi_u32_u24 v61, s40, v28
    v_mul_hi_u32_u24 v60, s40, v12
    v_mul_hi_u32_u24 v63, s40, v29
    v_mul_hi_u32_u24 v62, s40, v13
    v_mul_hi_u32_u24 v65, s40, v30
    v_mul_hi_u32_u24 v64, s40, v14
    v_mul_hi_u32_u24 v67, s40, v31
    v_mul_hi_u32_u24 v66, s40, v15
    v_and_b32 v61, -2, v61
    v_mad_u32_u24 v12, v60, s43, v12
    v_and_b32 v84, -4, v60
    v_and_b32 v63, -2, v63
    v_mad_u32_u24 v13, v62, s43, v13
    v_and_b32 v85, -4, v62
    v_and_b32 v65, -2, v65
    v_mad_u32_u24 v14, v64, s43, v14
    v_and_b32 v86, -4, v64
    v_and_b32 v67, -2, v67
    v_mad_u32_u24 v15, v66, s43, v15
    v_and_b32 v87, -4, v66
    v_mad_i32_i24 v28, v61, s42, v28
    v_lshl_add_u32 v61, v61, 6, v84
    v_mad_i32_i24 v29, v63, s42, v29
    v_lshl_add_u32 v63, v63, 6, v85
    v_mad_i32_i24 v30, v65, s42, v30
    v_lshl_add_u32 v65, v65, 6, v86
    v_mad_i32_i24 v31, v67, s42, v31
    v_lshl_add_u32 v67, v67, 6, v87
    ds_add_rtn_u32 v84, v61, v104
    ds_add_rtn_u32 v85, v63, v104
    ds_add_rtn_u32 v86, v65, v104
    ds_add_rtn_u32 v87, v67, v104
    v_lshlrev_b32 v110, 16, v40
    v_and_b32 v111, 0xffff0000, v40
    v_lshlrev_b32 v112, 16, v41
    v_and_b32 v113, 0xffff0000, v41
    v_mul_f32 v110, s44, v110
    v_mul_f32 v111, s44, v111
    v_mul_f32 v112, s44, v112
    v_mul_f32 v113, s44, v113
    v_fract_f32 v110, v110
    v_fract_f32 v111, v111
    v_fract_f32 v112, v112
    v_fract_f32 v113, v113
    v_cos_f32 v110, v110
    v_cos_f32 v111, v111
    v_cos_f32 v112, v112
    v_cos_f32 v113, v113
    v_lshl_or_b32 v60, v60, 14, v28
    v_perm_b32 v61, v61, v12, s46
    v_bfe_u32 v12, v12, 8, 5

    v_lshl_or_b32 v62, v62, 14, v29
    v_perm_b32 v63, v63, v13, s46
    v_bfe_u32 v13, v13, 8, 5

    v_lshl_or_b32 v64, v64, 14, v30
    v_perm_b32 v65, v65, v14, s46
    v_bfe_u32 v14, v14, 8, 5

    v_lshl_or_b32 v66, v66, 14, v31
    v_perm_b32 v67, v67, v15, s46
    v_bfe_u32 v15, v15, 8, 5

    v_fmaak_f32 v110, v110, v105, 0x4b400010
    v_fmaak_f32 v111, v111, v105, 0x4b400010
    v_fmaak_f32 v112, v112, v105, 0x4b400010
    v_fmaak_f32 v113, v113, v105, 0x4b400010
    v_sub_u32 v110, v110, v12
    v_sub_u32 v111, v111, v13
    v_sub_u32 v112, v112, v14
    v_sub_u32 v113, v113, v15
    v_bfi_b32 v110, 31, v12, v110
    v_bfi_b32 v111, 31, v13, v111
    v_bfi_b32 v112, 31, v14, v112
    v_bfi_b32 v113, 31, v15, v113
    v_perm_b32 v60, v60, v110, s55
    v_perm_b32 v62, v62, v111, s55
    v_perm_b32 v64, v64, v112, s55
    v_perm_b32 v66, v66, v113, s55
L_ska_26:
    s_waitcnt vmcnt(1)
    s_waitcnt vmcnt(0)
    v_cmp_eq_u32 vcc, 0, v0
    s_mov_b64 exec, vcc
    ds_write_b32 v108, v99 offset:8
    s_mov_b64 exec, -1
    s_waitcnt vmcnt(5)
    v_lshrrev_b32 v93, 16, v92
    v_and_b32 v92, 0xffff, v92
    v_add_u32 v110, v92, v94
    v_mad_u32_u24 v92, v92, 5, v96
    v_add_u32 v111, v93, v95
    v_mad_u32_u24 v93, v93, 5, v97
    v_max_u32 v110, v110, v111
    v_cmp_le_u32 vcc, s48, v110
    s_cbranch_vccnz L_full_27
L_fback_28:
    ds_write_b64 v2, v[92:93] offset:16384

    s_waitcnt lgkmcnt(0)
    s_barrier
    ds_read_b32 v111, v108 offset:8
    s_waitcnt lgkmcnt(0)
    v_readfirstlane_b32 s41, v111
    s_nop 1

    s_add_u32 s41, s41, 416
    s_sub_u32 s78, s41, 2965
    s_lshr_b32 s79, s78, 1
    s_add_u32 s79, s79, 2965
    s_and_b32 s86, s78, 1
    s_lshl_b32 s86, s86, 1
    s_add_u32 s87, s86, 2
    s_cmp_lt_u32 s41, 2965
    s_cselect_b32 s41, s41, s79
    s_cmovk_i32 s86, 0
    s_cmovk_i32 s87, 4

    s_mul_i32 s78, s41, 16384
    s_add_u32 s49, s78, 16384
    s_cmp_ge_u32 s41, 3125
    s_cmovk_i32 s49, 0
    s_cmovk_i32 s78, 0
    s_lshl_b32 s10, s49, 2
    s_lshl_b32 s14, s49, 2
    s_lshl_b32 s18, s49, 1
    s_sub_u32 s79, s87, s86
    s_bfm_b32 s85, s79, s86
    s_lshl_b32 s86, s86, 12
    s_lshl_b32 s87, s87, 12
    s_min_u32 s87, s87, 16384

    s_add_u32 s79, s78, 0
    s_bitcmp1_b32 s85, 0
    s_cselect_b32 s79, s79, 0x1ff00000
    s_lshl_b32 s56, s79, 2
    s_lshl_b32 s61, s79, 1

    s_add_u32 s79, s78, 4096
    s_bitcmp1_b32 s85, 1
    s_cselect_b32 s79, s79, 0x1ff00000
    s_lshl_b32 s57, s79, 2
    s_lshl_b32 s62, s79, 1

    s_add_u32 s79, s78, 8192
    s_bitcmp1_b32 s85, 2
    s_cselect_b32 s79, s79, 0x1ff00000
    s_lshl_b32 s58, s79, 2
    s_lshl_b32 s63, s79, 1

    s_add_u32 s79, s78, 12288
    s_bitcmp1_b32 s85, 3
    s_cselect_b32 s79, s79, 0x1ff00000
    s_lshl_b32 s59, s79, 2
    s_lshl_b32 s64, s79, 1

    s_bitcmp0_b32 s28, 0
    s_cbranch_scc1 L_skw_29
    ds_read_b64 v[110:111], v2 offset:24592
    ds_read_b64 v[112:113], v2 offset:24600
    ds_read_b64 v[114:115], v2 offset:24584

    ds_read_b64 v[118:119], v2 offset:32784
    ds_read_b64 v[120:121], v2 offset:32792
    ds_read_b64 v[122:123], v2 offset:32776

    s_waitcnt lgkmcnt(3)
    v_lshrrev_b32 v116, 16, v111
    ds_read_b32 v116, v116 offset:16384

    s_waitcnt lgkmcnt(1)
    v_lshrrev_b32 v124, 16, v119
    ds_read_b32 v124, v124 offset:16384

    v_cmp_ne_u32_sdwa s[80:81], v111, v113 src0_sel:WORD_1 src1_sel:WORD_1
    v_cmp_ne_u32_sdwa vcc, v111, v115 src0_sel:WORD_1 src1_sel:WORD_1
    v_alignbyte_b32 v114, v111, v114, 1
    s_mov_b32 s54, -3
    v_perm_b32 v112, v112, v113, s45
    s_waitcnt lgkmcnt(1)
    v_add3_u32 v116, v116, v106, s54
    v_sub_u32 v117, 0, v116
    v_and_b32 v117, 3, v117
    s_mov_b64 exec, s[80:81]
    v_mov_b32 v117, 0
    v_mov_b32 v112, 0
    s_mov_b64 exec, vcc
    v_mov_b32 v117, 3

    s_mov_b64 exec, -1
    v_alignbyte_b32 v111, v112, v110, v117
    v_alignbyte_b32 v110, v110, v114, v117
    v_add_u32 v116, v116, v117

    buffer_store_dwordx2 v[110:111], v116, s[24:27], 0 offen
    v_cmp_ne_u32_sdwa s[80:81], v119, v121 src0_sel:WORD_1 src1_sel:WORD_1
    v_cmp_ne_u32_sdwa vcc, v119, v123 src0_sel:WORD_1 src1_sel:WORD_1
    v_alignbyte_b32 v122, v119, v122, 1
    s_mov_b32 s54, 5117
    v_perm_b32 v120, v120, v121, s45
    s_waitcnt lgkmcnt(0)
    v_add3_u32 v124, v124, v106, s54
    v_sub_u32 v125, 0, v124
    v_and_b32 v125, 3, v125
    s_mov_b64 exec, s[80:81]
    v_mov_b32 v125, 0
    v_mov_b32 v120, 0
    s_mov_b64 exec, vcc
    v_mov_b32 v125, 3

    s_mov_b64 exec, -1
    v_alignbyte_b32 v119, v120, v118, v125
    v_alignbyte_b32 v118, v118, v122, v125
    v_add_u32 v124, v124, v125

    buffer_store_dwordx2 v[118:119], v124, s[24:27], 0 offen
L_skw_29:
    s_bitcmp0_b32 s28, 0
    s_cbranch_scc1 L_skw_30
    ds_read_b64 v[110:111], v2 offset:40976
    ds_read_b64 v[112:113], v2 offset:40984
    ds_read_b64 v[114:115], v2 offset:40968

    ds_read_b64 v[118:119], v2 offset:49168
    ds_read_b64 v[120:121], v2 offset:49176
    ds_read_b64 v[122:123], v2 offset:49160

    s_waitcnt lgkmcnt(3)
    v_lshrrev_b32 v116, 16, v111
    ds_read_b32 v116, v116 offset:16384

    s_waitcnt lgkmcnt(1)
    v_lshrrev_b32 v124, 16, v119
    ds_read_b32 v124, v124 offset:16384

    v_cmp_ne_u32_sdwa s[80:81], v111, v113 src0_sel:WORD_1 src1_sel:WORD_1
    v_cmp_ne_u32_sdwa vcc, v111, v115 src0_sel:WORD_1 src1_sel:WORD_1
    v_alignbyte_b32 v114, v111, v114, 1
    s_mov_b32 s54, 10237
    v_perm_b32 v112, v112, v113, s45
    s_waitcnt lgkmcnt(1)
    v_add3_u32 v116, v116, v106, s54
    v_sub_u32 v117, 0, v116
    v_and_b32 v117, 3, v117
    s_mov_b64 exec, s[80:81]
    v_mov_b32 v117, 0
    v_mov_b32 v112, 0
    s_mov_b64 exec, vcc
    v_mov_b32 v117, 3

    s_mov_b64 exec, -1
    v_alignbyte_b32 v111, v112, v110, v117
    v_alignbyte_b32 v110, v110, v114, v117
    v_add_u32 v116, v116, v117

    buffer_store_dwordx2 v[110:111], v116, s[24:27], 0 offen
    v_cmp_ne_u32_sdwa s[80:81], v119, v121 src0_sel:WORD_1 src1_sel:WORD_1
    v_cmp_ne_u32_sdwa vcc, v119, v123 src0_sel:WORD_1 src1_sel:WORD_1
    v_alignbyte_b32 v122, v119, v122, 1
    s_mov_b32 s54, 15357
    v_perm_b32 v120, v120, v121, s45
    s_waitcnt lgkmcnt(0)
    v_add3_u32 v124, v124, v106, s54
    v_sub_u32 v125, 0, v124
    v_and_b32 v125, 3, v125
    s_mov_b64 exec, s[80:81]
    v_mov_b32 v125, 0
    v_mov_b32 v120, 0
    s_mov_b64 exec, vcc
    v_mov_b32 v125, 3

    s_mov_b64 exec, -1
    v_alignbyte_b32 v119, v120, v118, v125
    v_alignbyte_b32 v118, v118, v122, v125
    v_add_u32 v124, v124, v125

    buffer_store_dwordx2 v[118:119], v124, s[24:27], 0 offen
L_skw_30:
    s_bitcmp0_b32 s28, 1
    s_cbranch_scc1 L_skw_31
    v_add_u32 v107, 32768, v2
    ds_read_b64 v[110:111], v107 offset:24592
    ds_read_b64 v[112:113], v107 offset:24600
    ds_read_b64 v[114:115], v107 offset:24584

    ds_read_b64 v[118:119], v107 offset:32784
    ds_read_b64 v[120:121], v107 offset:32792
    ds_read_b64 v[122:123], v107 offset:32776

    s_waitcnt lgkmcnt(3)
    v_lshrrev_b32 v116, 16, v111
    ds_read_b32 v116, v116 offset:16384

    s_waitcnt lgkmcnt(1)
    v_lshrrev_b32 v124, 16, v119
    ds_read_b32 v124, v124 offset:16384

    v_cmp_ne_u32_sdwa s[80:81], v111, v113 src0_sel:WORD_1 src1_sel:WORD_1
    v_cmp_ne_u32_sdwa vcc, v111, v115 src0_sel:WORD_1 src1_sel:WORD_1
    v_alignbyte_b32 v114, v111, v114, 1
    s_mov_b32 s54, 20477
    v_perm_b32 v112, v112, v113, s45
    s_waitcnt lgkmcnt(1)
    v_add3_u32 v116, v116, v106, s54
    v_sub_u32 v117, 0, v116
    v_and_b32 v117, 3, v117
    s_mov_b64 exec, s[80:81]
    v_mov_b32 v117, 0
    v_mov_b32 v112, 0
    s_mov_b64 exec, vcc
    v_mov_b32 v117, 3

    s_mov_b64 exec, -1
    v_alignbyte_b32 v111, v112, v110, v117
    v_alignbyte_b32 v110, v110, v114, v117
    v_add_u32 v116, v116, v117

    buffer_store_dwordx2 v[110:111], v116, s[24:27], 0 offen
    v_cmp_ne_u32_sdwa s[80:81], v119, v121 src0_sel:WORD_1 src1_sel:WORD_1
    v_cmp_ne_u32_sdwa vcc, v119, v123 src0_sel:WORD_1 src1_sel:WORD_1
    v_alignbyte_b32 v122, v119, v122, 1
    s_mov_b32 s54, 25597
    v_perm_b32 v120, v120, v121, s45
    s_waitcnt lgkmcnt(0)
    v_add3_u32 v124, v124, v106, s54
    v_sub_u32 v125, 0, v124
    v_and_b32 v125, 3, v125
    s_mov_b64 exec, s[80:81]
    v_mov_b32 v125, 0
    v_mov_b32 v120, 0
    s_mov_b64 exec, vcc
    v_mov_b32 v125, 3

    s_mov_b64 exec, -1
    v_alignbyte_b32 v119, v120, v118, v125
    v_alignbyte_b32 v118, v118, v122, v125
    v_add_u32 v124, v124, v125

    buffer_store_dwordx2 v[118:119], v124, s[24:27], 0 offen
L_skw_31:
    s_bitcmp0_b32 s28, 1
    s_cbranch_scc1 L_skw_32
    v_add_u32 v107, 32768, v2
    ds_read_b64 v[110:111], v107 offset:40976
    ds_read_b64 v[112:113], v107 offset:40984
    ds_read_b64 v[114:115], v107 offset:40968

    ds_read_b64 v[118:119], v107 offset:49168
    ds_read_b64 v[120:121], v107 offset:49176
    ds_read_b64 v[122:123], v107 offset:49160

    s_waitcnt lgkmcnt(3)
    v_lshrrev_b32 v116, 16, v111
    ds_read_b32 v116, v116 offset:16384

    s_waitcnt lgkmcnt(1)
    v_lshrrev_b32 v124, 16, v119
    ds_read_b32 v124, v124 offset:16384

    v_cmp_ne_u32_sdwa s[80:81], v111, v113 src0_sel:WORD_1 src1_sel:WORD_1
    v_cmp_ne_u32_sdwa vcc, v111, v115 src0_sel:WORD_1 src1_sel:WORD_1
    v_alignbyte_b32 v114, v111, v114, 1
    s_mov_b32 s54, 30717
    v_perm_b32 v112, v112, v113, s45
    s_waitcnt lgkmcnt(1)
    v_add3_u32 v116, v116, v106, s54
    v_sub_u32 v117, 0, v116
    v_and_b32 v117, 3, v117
    s_mov_b64 exec, s[80:81]
    v_mov_b32 v117, 0
    v_mov_b32 v112, 0
    s_mov_b64 exec, vcc
    v_mov_b32 v117, 3

    s_mov_b64 exec, -1
    v_alignbyte_b32 v111, v112, v110, v117
    v_alignbyte_b32 v110, v110, v114, v117
    v_add_u32 v116, v116, v117

    buffer_store_dwordx2 v[110:111], v116, s[24:27], 0 offen
    v_cmp_ne_u32_sdwa s[80:81], v119, v121 src0_sel:WORD_1 src1_sel:WORD_1
    v_cmp_ne_u32_sdwa vcc, v119, v123 src0_sel:WORD_1 src1_sel:WORD_1
    v_alignbyte_b32 v122, v119, v122, 1
    s_mov_b32 s54, 35837
    v_perm_b32 v120, v120, v121, s45
    s_waitcnt lgkmcnt(0)
    v_add3_u32 v124, v124, v106, s54
    v_sub_u32 v125, 0, v124
    v_and_b32 v125, 3, v125
    s_mov_b64 exec, s[80:81]
    v_mov_b32 v125, 0
    v_mov_b32 v120, 0
    s_mov_b64 exec, vcc
    v_mov_b32 v125, 3

    s_mov_b64 exec, -1
    v_alignbyte_b32 v119, v120, v118, v125
    v_alignbyte_b32 v118, v118, v122, v125
    v_add_u32 v124, v124, v125

    buffer_store_dwordx2 v[118:119], v124, s[24:27], 0 offen
L_skw_32:
    s_bitcmp0_b32 s82, 3
    s_cbranch_scc1 L_ska_33
    s_mov_b64 exec, s[66:67]
    v_mul_hi_u32_u24 v69, s40, v32
    v_mul_hi_u32_u24 v68, s40, v16
    v_mul_hi_u32_u24 v71, s40, v33
    v_mul_hi_u32_u24 v70, s40, v17
    v_mul_hi_u32_u24 v73, s40, v34
    v_mul_hi_u32_u24 v72, s40, v18
    v_mul_hi_u32_u24 v75, s40, v35
    v_mul_hi_u32_u24 v74, s40, v19
    v_and_b32 v69, -2, v69
    v_mad_u32_u24 v16, v68, s43, v16
    v_and_b32 v88, -4, v68
    v_and_b32 v71, -2, v71
    v_mad_u32_u24 v17, v70, s43, v17
    v_and_b32 v89, -4, v70
    v_and_b32 v73, -2, v73
    v_mad_u32_u24 v18, v72, s43, v18
    v_and_b32 v90, -4, v72
    v_and_b32 v75, -2, v75
    v_mad_u32_u24 v19, v74, s43, v19
    v_and_b32 v91, -4, v74
    v_mad_i32_i24 v32, v69, s42, v32
    v_lshl_add_u32 v69, v69, 6, v88
    v_mad_i32_i24 v33, v71, s42, v33
    v_lshl_add_u32 v71, v71, 6, v89
    v_mad_i32_i24 v34, v73, s42, v34
    v_lshl_add_u32 v73, v73, 6, v90
    v_mad_i32_i24 v35, v75, s42, v35
    v_lshl_add_u32 v75, v75, 6, v91
    ds_add_rtn_u32 v88, v69, v104
    ds_add_rtn_u32 v89, v71, v104
    ds_add_rtn_u32 v90, v73, v104
    ds_add_rtn_u32 v91, v75, v104
    v_lshlrev_b32 v110, 16, v42
    v_and_b32 v111, 0xffff0000, v42
    v_lshlrev_b32 v112, 16, v43
    v_and_b32 v113, 0xffff0000, v43
    v_mul_f32 v110, s44, v110
    v_mul_f32 v111, s44, v111
    v_mul_f32 v112, s44, v112
    v_mul_f32 v113, s44, v113
    v_fract_f32 v110, v110
    v_fract_f32 v111, v111
    v_fract_f32 v112, v112
    v_fract_f32 v113, v113
    v_cos_f32 v110, v110
    v_cos_f32 v111, v111
    v_cos_f32 v112, v112
    v_cos_f32 v113, v113
    v_lshl_or_b32 v68, v68, 14, v32
    v_perm_b32 v69, v69, v16, s46
    v_bfe_u32 v16, v16, 8, 5

    v_lshl_or_b32 v70, v70, 14, v33
    v_perm_b32 v71, v71, v17, s46
    v_bfe_u32 v17, v17, 8, 5

    v_lshl_or_b32 v72, v72, 14, v34
    v_perm_b32 v73, v73, v18, s46
    v_bfe_u32 v18, v18, 8, 5

    v_lshl_or_b32 v74, v74, 14, v35
    v_perm_b32 v75, v75, v19, s46
    v_bfe_u32 v19, v19, 8, 5

    v_fmaak_f32 v110, v110, v105, 0x4b400010
    v_fmaak_f32 v111, v111, v105, 0x4b400010
    v_fmaak_f32 v112, v112, v105, 0x4b400010
    v_fmaak_f32 v113, v113, v105, 0x4b400010
    v_sub_u32 v110, v110, v16
    v_sub_u32 v111, v111, v17
    v_sub_u32 v112, v112, v18
    v_sub_u32 v113, v113, v19
    v_bfi_b32 v110, 31, v16, v110
    v_bfi_b32 v111, 31, v17, v111
    v_bfi_b32 v112, 31, v18, v112
    v_bfi_b32 v113, 31, v19, v113
    v_perm_b32 v68, v68, v110, s55
    v_perm_b32 v70, v70, v111, s55
    v_perm_b32 v72, v72, v112, s55
    v_perm_b32 v74, v74, v113, s55
    s_mov_b64 exec, -1
L_ska_33:
    s_bitcmp0_b32 s28, 2
    s_cbranch_scc1 L_skw_34
    v_add_u32 v107, 65536, v2
    ds_read_b64 v[110:111], v107 offset:24592
    ds_read_b64 v[112:113], v107 offset:24600
    ds_read_b64 v[114:115], v107 offset:24584

    ds_read_b64 v[118:119], v107 offset:32784
    ds_read_b64 v[120:121], v107 offset:32792
    ds_read_b64 v[122:123], v107 offset:32776

    s_waitcnt lgkmcnt(3)
    v_lshrrev_b32 v116, 16, v111
    ds_read_b32 v116, v116 offset:16384

    s_waitcnt lgkmcnt(1)
    v_lshrrev_b32 v124, 16, v119
    ds_read_b32 v124, v124 offset:16384

    v_cmp_ne_u32_sdwa s[80:81], v111, v113 src0_sel:WORD_1 src1_sel:WORD_1
    v_cmp_ne_u32_sdwa vcc, v111, v115 src0_sel:WORD_1 src1_sel:WORD_1
    v_alignbyte_b32 v114, v111, v114, 1
    s_mov_b32 s54, 40957
    v_perm_b32 v112, v112, v113, s45
    s_waitcnt lgkmcnt(1)
    v_add3_u32 v116, v116, v106, s54
    v_sub_u32 v117, 0, v116
    v_and_b32 v117, 3, v117
    s_mov_b64 exec, s[80:81]
    v_mov_b32 v117, 0
    v_mov_b32 v112, 0
    s_mov_b64 exec, vcc
    v_mov_b32 v117, 3

    s_mov_b64 exec, -1
    v_alignbyte_b32 v111, v112, v110, v117
    v_alignbyte_b32 v110, v110, v114, v117
    v_add_u32 v116, v116, v117

    buffer_store_dwordx2 v[110:111], v116, s[24:27], 0 offen
    v_cmp_ne_u32_sdwa s[80:81], v119, v121 src0_sel:WORD_1 src1_sel:WORD_1
    v_cmp_ne_u32_sdwa vcc, v119, v123 src0_sel:WORD_1 src1_sel:WORD_1
    v_alignbyte_b32 v122, v119, v122, 1
    s_mov_b32 s54, 46077
    v_perm_b32 v120, v120, v121, s45
    s_waitcnt lgkmcnt(0)
    v_add3_u32 v124, v124, v106, s54
    v_sub_u32 v125, 0, v124
    v_and_b32 v125, 3, v125
    s_mov_b64 exec, s[80:81]
    v_mov_b32 v125, 0
    v_mov_b32 v120, 0
    s_mov_b64 exec, vcc
    v_mov_b32 v125, 3

    s_mov_b64 exec, -1
    v_alignbyte_b32 v119, v120, v118, v125
    v_alignbyte_b32 v118, v118, v122, v125
    v_add_u32 v124, v124, v125

    buffer_store_dwordx2 v[118:119], v124, s[24:27], 0 offen
L_skw_34:
    s_bitcmp0_b32 s28, 2
    s_cbranch_scc1 L_skw_35
    v_add_u32 v107, 65536, v2
    ds_read_b64 v[110:111], v107 offset:40976
    ds_read_b64 v[112:113], v107 offset:40984
    ds_read_b64 v[114:115], v107 offset:40968

    ds_read_b64 v[118:119], v107 offset:49168
    ds_read_b64 v[120:121], v107 offset:49176
    ds_read_b64 v[122:123], v107 offset:49160

    s_waitcnt lgkmcnt(3)
    v_lshrrev_b32 v116, 16, v111
    ds_read_b32 v116, v116 offset:16384

    s_waitcnt lgkmcnt(1)
    v_lshrrev_b32 v124, 16, v119
    ds_read_b32 v124, v124 offset:16384

    v_cmp_ne_u32_sdwa s[80:81], v111, v113 src0_sel:WORD_1 src1_sel:WORD_1
    v_cmp_ne_u32_sdwa vcc, v111, v115 src0_sel:WORD_1 src1_sel:WORD_1
    v_alignbyte_b32 v114, v111, v114, 1
    s_mov_b32 s54, 51197
    v_perm_b32 v112, v112, v113, s45
    s_waitcnt lgkmcnt(1)
    v_add3_u32 v116, v116, v106, s54
    v_sub_u32 v117, 0, v116
    v_and_b32 v117, 3, v117
    s_mov_b64 exec, s[80:81]
    v_mov_b32 v117, 0
    v_mov_b32 v112, 0
    s_mov_b64 exec, vcc
    v_mov_b32 v117, 3

    s_mov_b64 exec, -1
    v_alignbyte_b32 v111, v112, v110, v117
    v_alignbyte_b32 v110, v110, v114, v117
    v_add_u32 v116, v116, v117

    buffer_store_dwordx2 v[110:111], v116, s[24:27], 0 offen
    v_cmp_ne_u32_sdwa s[80:81], v119, v121 src0_sel:WORD_1 src1_sel:WORD_1
    v_cmp_ne_u32_sdwa vcc, v119, v123 src0_sel:WORD_1 src1_sel:WORD_1
    v_alignbyte_b32 v122, v119, v122, 1
    s_mov_b32 s54, 56317
    v_perm_b32 v120, v120, v121, s45
    s_waitcnt lgkmcnt(0)
    v_add3_u32 v124, v124, v106, s54
    v_sub_u32 v125, 0, v124
    v_and_b32 v125, 3, v125
    s_mov_b64 exec, s[80:81]
    v_mov_b32 v125, 0
    v_mov_b32 v120, 0
    s_mov_b64 exec, vcc
    v_mov_b32 v125, 3

    s_mov_b64 exec, -1
    v_alignbyte_b32 v119, v120, v118, v125
    v_alignbyte_b32 v118, v118, v122, v125
    v_add_u32 v124, v124, v125

    buffer_store_dwordx2 v[118:119], v124, s[24:27], 0 offen
L_skw_35:
    s_bitcmp0_b32 s28, 3
    s_cbranch_scc1 L_skw_36
    v_add_u32 v107, 98304, v2
    ds_read_b64 v[110:111], v107 offset:24592
    ds_read_b64 v[112:113], v107 offset:24600
    ds_read_b64 v[114:115], v107 offset:24584

    ds_read_b64 v[118:119], v107 offset:32784
    ds_read_b64 v[120:121], v107 offset:32792
    ds_read_b64 v[122:123], v107 offset:32776

    s_waitcnt lgkmcnt(3)
    v_lshrrev_b32 v116, 16, v111
    ds_read_b32 v116, v116 offset:16384

    s_waitcnt lgkmcnt(1)
    v_lshrrev_b32 v124, 16, v119
    ds_read_b32 v124, v124 offset:16384

    v_cmp_ne_u32_sdwa s[80:81], v111, v113 src0_sel:WORD_1 src1_sel:WORD_1
    v_cmp_ne_u32_sdwa vcc, v111, v115 src0_sel:WORD_1 src1_sel:WORD_1
    v_alignbyte_b32 v114, v111, v114, 1
    s_mov_b32 s54, 61437
    v_perm_b32 v112, v112, v113, s45
    s_waitcnt lgkmcnt(1)
    v_add3_u32 v116, v116, v106, s54
    v_sub_u32 v117, 0, v116
    v_and_b32 v117, 3, v117
    s_mov_b64 exec, s[80:81]
    v_mov_b32 v117, 0
    v_mov_b32 v112, 0
    s_mov_b64 exec, vcc
    v_mov_b32 v117, 3

    s_mov_b64 exec, -1
    v_alignbyte_b32 v111, v112, v110, v117
    v_alignbyte_b32 v110, v110, v114, v117
    v_add_u32 v116, v116, v117

    buffer_store_dwordx2 v[110:111], v116, s[24:27], 0 offen
    v_cmp_ne_u32_sdwa s[80:81], v119, v121 src0_sel:WORD_1 src1_sel:WORD_1
    v_cmp_ne_u32_sdwa vcc, v119, v123 src0_sel:WORD_1 src1_sel:WORD_1
    v_alignbyte_b32 v122, v119, v122, 1
    s_mov_b32 s54, 66557
    v_perm_b32 v120, v120, v121, s45
    s_waitcnt lgkmcnt(0)
    v_add3_u32 v124, v124, v106, s54
    v_sub_u32 v125, 0, v124
    v_and_b32 v125, 3, v125
    s_mov_b64 exec, s[80:81]
    v_mov_b32 v125, 0
    v_mov_b32 v120, 0
    s_mov_b64 exec, vcc
    v_mov_b32 v125, 3

    s_mov_b64 exec, -1
    v_alignbyte_b32 v119, v120, v118, v125
    v_alignbyte_b32 v118, v118, v122, v125
    v_add_u32 v124, v124, v125

    buffer_store_dwordx2 v[118:119], v124, s[24:27], 0 offen
L_skw_36:
    s_bitcmp0_b32 s28, 3
    s_cbranch_scc1 L_skw_37
    v_add_u32 v107, 98304, v2
    ds_read_b64 v[110:111], v107 offset:40976
    ds_read_b64 v[112:113], v107 offset:40984
    ds_read_b64 v[114:115], v107 offset:40968

    ds_read_b64 v[118:119], v107 offset:49168
    ds_read_b64 v[120:121], v107 offset:49176
    ds_read_b64 v[122:123], v107 offset:49160

    s_waitcnt lgkmcnt(3)
    v_lshrrev_b32 v116, 16, v111
    ds_read_b32 v116, v116 offset:16384

    s_waitcnt lgkmcnt(1)
    v_lshrrev_b32 v124, 16, v119
    ds_read_b32 v124, v124 offset:16384

    v_cmp_ne_u32_sdwa s[80:81], v111, v113 src0_sel:WORD_1 src1_sel:WORD_1
    v_cmp_ne_u32_sdwa vcc, v111, v115 src0_sel:WORD_1 src1_sel:WORD_1
    v_alignbyte_b32 v114, v111, v114, 1
    s_mov_b32 s54, 71677
    v_perm_b32 v112, v112, v113, s45
    s_waitcnt lgkmcnt(1)
    v_add3_u32 v116, v116, v106, s54
    v_sub_u32 v117, 0, v116
    v_and_b32 v117, 3, v117
    s_mov_b64 exec, s[80:81]
    v_mov_b32 v117, 0
    v_mov_b32 v112, 0
    s_mov_b64 exec, vcc
    v_mov_b32 v117, 3

    s_mov_b64 exec, -1
    v_alignbyte_b32 v111, v112, v110, v117
    v_alignbyte_b32 v110, v110, v114, v117
    v_add_u32 v116, v116, v117

    buffer_store_dwordx2 v[110:111], v116, s[24:27], 0 offen
    v_cmp_ne_u32_sdwa s[80:81], v119, v121 src0_sel:WORD_1 src1_sel:WORD_1
    v_cmp_ne_u32_sdwa vcc, v119, v123 src0_sel:WORD_1 src1_sel:WORD_1
    v_alignbyte_b32 v122, v119, v122, 1
    s_mov_b32 s54, 76797
    v_perm_b32 v120, v120, v121, s45
    s_waitcnt lgkmcnt(0)
    v_add3_u32 v124, v124, v106, s54
    v_sub_u32 v125, 0, v124
    v_and_b32 v125, 3, v125
    s_mov_b64 exec, s[80:81]
    v_mov_b32 v125, 0
    v_mov_b32 v120, 0
    s_mov_b64 exec, vcc
    v_mov_b32 v125, 3

    s_mov_b64 exec, -1
    v_alignbyte_b32 v119, v120, v118, v125
    v_alignbyte_b32 v118, v118, v122, v125
    v_add_u32 v124, v124, v125

    buffer_store_dwordx2 v[118:119], v124, s[24:27], 0 offen
L_skw_37:
    s_waitcnt lgkmcnt(0)
    s_barrier

    buffer_load_dwordx4 v[20:23], v1, s[12:15], s56 offen nt
    buffer_load_dwordx4 v[4:7], v1, s[8:11], s56 offen nt
    buffer_load_dwordx2 v[36:37], v2, s[16:19], s61 offen nt
    buffer_load_dwordx4 v[24:27], v1, s[12:15], s57 offen nt
    buffer_load_dwordx4 v[8:11], v1, s[8:11], s57 offen nt
    buffer_load_dwordx2 v[38:39], v2, s[16:19], s62 offen nt
    ds_read_b64 v[94:95], v2
    s_waitcnt lgkmcnt(0)
    v_add_u32 v97, v94, v95
    s_nop 1
    v_add_u32_dpp v97, v97, v97 row_shr:1 row_mask:0xf bank_mask:0xf
    s_nop 1
    v_add_u32_dpp v97, v97, v97 row_shr:2 row_mask:0xf bank_mask:0xf
    s_nop 1
    v_add_u32_dpp v97, v97, v97 row_shr:4 row_mask:0xf bank_mask:0xf
    s_nop 1
    v_add_u32_dpp v97, v97, v97 row_shr:8 row_mask:0xf bank_mask:0xf
    s_nop 1
    v_add_u32_dpp v97, v97, v97 row_bcast:15 row_mask:0xa bank_mask:0xf
    s_nop 1
    v_add_u32_dpp v97, v97, v97 row_bcast:31 row_mask:0xc bank_mask:0xf
    s_mov_b32 exec_lo, 0
    s_brev_b32 exec_hi, 1
    ds_add_rtn_u32 v96, v108, v97
    s_mov_b64 exec, -1

    v_add_u32 v92, v94, v94
    v_add_u32 v93, v95, v95
    v_med3_u32 v92, v94, 2, v92
    v_med3_u32 v93, v95, 2, v93
    v_lshl_or_b32 v92, v93, 16, v92
    v_lshlrev_b32 v93, 2, v0
    buffer_atomic_add v92, v93, s[20:23], 0 offen sc0
    s_waitcnt lgkmcnt(0)
    v_readlane_b32 s77, v96, 63
    v_sub_u32 v97, v97, v95
    s_sub_u32 s50, s50, s83
    s_sub_u32 s77, s77, s50
    v_add_u32 v97, s77, v97
    v_sub_u32 v96, v97, v94
    v_lshlrev_b32 v111, 3, v97
    v_lshlrev_b32 v110, 3, v96
    v_mov_b32 v112, 0
    v_mov_b32 v113, 0
    ds_write_b64 v2, v[110:111] offset:8192
    ds_write_b64 v2, v[112:113]
    v_mad_i32_i24 v96, v96, -5, v102
    v_mad_i32_i24 v97, v97, -5, v103
    s_add_u32 s50, s50, s84
    s_mov_b32 s28, s82
    s_mov_b32 s29, s83
    s_mov_b32 s30, s84
    s_lshl_b32 s74, s29, 3
    s_lshl_b32 s75, s30, 3
    v_mov_b32 v125, s74
    v_mov_b32 v126, s75
    v_mov_b32 v127, -1

    s_waitcnt lgkmcnt(0)
    s_barrier

    s_mov_b64 exec, 1
    ds_write_b32 v125, v127 offset:24588
    ds_write_b32 v126, v127 offset:24596
    s_mov_b64 exec, -1

    s_bitcmp0_b32 s28, 0
    s_cbranch_scc1 L_skz_38
    v_lshrrev_b32 v110, 16, v45
    ds_read_b32 v110, v110 offset:8192
    v_lshrrev_b32 v111, 16, v47
    ds_read_b32 v111, v111 offset:8192
    v_lshrrev_b32 v112, 16, v49
    ds_read_b32 v112, v112 offset:8192
    v_lshrrev_b32 v113, 16, v51
    ds_read_b32 v113, v113 offset:8192
    v_lshrrev_b32 v114, 16, v53
    ds_read_b32 v114, v114 offset:8192
    v_lshrrev_b32 v115, 16, v55
    ds_read_b32 v115, v115 offset:8192
    v_lshrrev_b32 v116, 16, v57
    ds_read_b32 v116, v116 offset:8192
    v_lshrrev_b32 v117, 16, v59
    ds_read_b32 v117, v117 offset:8192
    s_waitcnt lgkmcnt(7)
    v_lshl_add_u32 v110, v76, 3, v110
    ds_write_b64 v110, v[44:45] offset:24592

    s_waitcnt lgkmcnt(7)
    v_lshl_add_u32 v111, v77, 3, v111
    ds_write_b64 v111, v[46:47] offset:24592

    s_waitcnt lgkmcnt(7)
    v_lshl_add_u32 v112, v78, 3, v112
    ds_write_b64 v112, v[48:49] offset:24592

    s_waitcnt lgkmcnt(7)
    v_lshl_add_u32 v113, v79, 3, v113
    ds_write_b64 v113, v[50:51] offset:24592

    s_waitcnt lgkmcnt(7)
    v_lshl_add_u32 v114, v80, 3, v114
    ds_write_b64 v114, v[52:53] offset:24592

    s_waitcnt lgkmcnt(7)
    v_lshl_add_u32 v115, v81, 3, v115
    ds_write_b64 v115, v[54:55] offset:24592

    s_waitcnt lgkmcnt(7)
    v_lshl_add_u32 v116, v82, 3, v116
    ds_write_b64 v116, v[56:57] offset:24592

    s_waitcnt lgkmcnt(7)
    v_lshl_add_u32 v117, v83, 3, v117
    ds_write_b64 v117, v[58:59] offset:24592

L_skz_38:
    buffer_load_dwordx4 v[28:31], v1, s[12:15], s58 offen nt
    buffer_load_dwordx4 v[12:15], v1, s[8:11], s58 offen nt
    buffer_load_dwordx2 v[40:41], v2, s[16:19], s63 offen nt
    s_bitcmp0_b32 s28, 2
    s_cbranch_scc1 L_skz_39
    v_lshrrev_b32 v110, 16, v61
    ds_read_b32 v110, v110 offset:8192
    v_lshrrev_b32 v111, 16, v63
    ds_read_b32 v111, v111 offset:8192
    v_lshrrev_b32 v112, 16, v65
    ds_read_b32 v112, v112 offset:8192
    v_lshrrev_b32 v113, 16, v67
    ds_read_b32 v113, v113 offset:8192
    s_waitcnt lgkmcnt(3)
    v_lshl_add_u32 v110, v84, 3, v110
    ds_write_b64 v110, v[60:61] offset:24592

    s_waitcnt lgkmcnt(3)
    v_lshl_add_u32 v111, v85, 3, v111
    ds_write_b64 v111, v[62:63] offset:24592

    s_waitcnt lgkmcnt(3)
    v_lshl_add_u32 v112, v86, 3, v112
    ds_write_b64 v112, v[64:65] offset:24592

    s_waitcnt lgkmcnt(3)
    v_lshl_add_u32 v113, v87, 3, v113
    ds_write_b64 v113, v[66:67] offset:24592

L_skz_39:
    s_bitcmp0_b32 s28, 3
    s_cbranch_scc1 L_skz_40
    s_mov_b64 exec, s[66:67]
    v_lshrrev_b32 v110, 16, v69
    ds_read_b32 v110, v110 offset:8192
    v_lshrrev_b32 v111, 16, v71
    ds_read_b32 v111, v111 offset:8192
    v_lshrrev_b32 v112, 16, v73
    ds_read_b32 v112, v112 offset:8192
    v_lshrrev_b32 v113, 16, v75
    ds_read_b32 v113, v113 offset:8192
    s_waitcnt lgkmcnt(3)
    v_lshl_add_u32 v110, v88, 3, v110
    ds_write_b64 v110, v[68:69] offset:24592

    s_waitcnt lgkmcnt(3)
    v_lshl_add_u32 v111, v89, 3, v111
    ds_write_b64 v111, v[70:71] offset:24592

    s_waitcnt lgkmcnt(3)
    v_lshl_add_u32 v112, v90, 3, v112
    ds_write_b64 v112, v[72:73] offset:24592

    s_waitcnt lgkmcnt(3)
    v_lshl_add_u32 v113, v91, 3, v113
    ds_write_b64 v113, v[74:75] offset:24592

    s_mov_b64 exec, -1
L_skz_40:
    buffer_load_dwordx4 v[32:35], v1, s[12:15], s59 offen nt
    buffer_load_dwordx4 v[16:19], v1, s[8:11], s59 offen nt
    buffer_load_dwordx2 v[42:43], v2, s[16:19], s64 offen nt
    s_cmp_lg_u32 s49, 0
    s_cbranch_scc1 L_p1loop_6
L_p1epi_7:
    s_waitcnt vmcnt(0)
    s_waitcnt vmcnt(4)
    v_lshrrev_b32 v93, 16, v92
    v_and_b32 v92, 0xffff, v92
    v_add_u32 v110, v92, v94
    v_mad_u32_u24 v92, v92, 5, v96
    v_add_u32 v111, v93, v95
    v_mad_u32_u24 v93, v93, 5, v97
    v_max_u32 v110, v110, v111
    v_cmp_le_u32 vcc, s48, v110
    s_cbranch_vccnz L_full_41
L_fback_42:
    ds_write_b64 v2, v[92:93] offset:16384

    s_waitcnt lgkmcnt(0)
    s_barrier

    s_bitcmp0_b32 s28, 0
    s_cbranch_scc1 L_skw_43
    ds_read_b64 v[4:5], v2 offset:24592
    ds_read_b64 v[6:7], v2 offset:24600
    ds_read_b64 v[8:9], v2 offset:24584

    ds_read_b64 v[12:13], v2 offset:32784
    ds_read_b64 v[14:15], v2 offset:32792
    ds_read_b64 v[16:17], v2 offset:32776

    ds_read_b64 v[20:21], v2 offset:40976
    ds_read_b64 v[22:23], v2 offset:40984
    ds_read_b64 v[24:25], v2 offset:40968

    ds_read_b64 v[28:29], v2 offset:49168
    ds_read_b64 v[30:31], v2 offset:49176
    ds_read_b64 v[32:33], v2 offset:49160

    s_waitcnt lgkmcnt(9)
    v_lshrrev_b32 v10, 16, v5
    ds_read_b32 v10, v10 offset:16384

    s_waitcnt lgkmcnt(7)
    v_lshrrev_b32 v18, 16, v13
    ds_read_b32 v18, v18 offset:16384

    s_waitcnt lgkmcnt(5)
    v_lshrrev_b32 v26, 16, v21
    ds_read_b32 v26, v26 offset:16384

    s_waitcnt lgkmcnt(3)
    v_lshrrev_b32 v34, 16, v29
    ds_read_b32 v34, v34 offset:16384

    v_cmp_ne_u32_sdwa s[80:81], v5, v7 src0_sel:WORD_1 src1_sel:WORD_1
    v_cmp_ne_u32_sdwa vcc, v5, v9 src0_sel:WORD_1 src1_sel:WORD_1
    v_alignbyte_b32 v8, v5, v8, 1
    s_mov_b32 s54, -3
    v_perm_b32 v6, v6, v7, s45
    s_waitcnt lgkmcnt(3)
    v_add3_u32 v10, v10, v106, s54
    v_sub_u32 v11, 0, v10
    v_and_b32 v11, 3, v11
    s_mov_b64 exec, s[80:81]
    v_mov_b32 v11, 0
    v_mov_b32 v6, 0
    s_mov_b64 exec, vcc
    v_mov_b32 v11, 3

    s_mov_b64 exec, -1
    v_alignbyte_b32 v5, v6, v4, v11
    v_alignbyte_b32 v4, v4, v8, v11
    v_add_u32 v10, v10, v11

    buffer_store_dwordx2 v[4:5], v10, s[24:27], 0 offen
    v_cmp_ne_u32_sdwa s[80:81], v13, v15 src0_sel:WORD_1 src1_sel:WORD_1
    v_cmp_ne_u32_sdwa vcc, v13, v17 src0_sel:WORD_1 src1_sel:WORD_1
    v_alignbyte_b32 v16, v13, v16, 1
    s_mov_b32 s54, 5117
    v_perm_b32 v14, v14, v15, s45
    s_waitcnt lgkmcnt(2)
    v_add3_u32 v18, v18, v106, s54
    v_sub_u32 v19, 0, v18
    v_and_b32 v19, 3, v19
    s_mov_b64 exec, s[80:81]
    v_mov_b32 v19, 0
    v_mov_b32 v14, 0
    s_mov_b64 exec, vcc
    v_mov_b32 v19, 3

    s_mov_b64 exec, -1
    v_alignbyte_b32 v13, v14, v12, v19
    v_alignbyte_b32 v12, v12, v16, v19
    v_add_u32 v18, v18, v19

    buffer_store_dwordx2 v[12:13], v18, s[24:27], 0 offen
    v_cmp_ne_u32_sdwa s[80:81], v21, v23 src0_sel:WORD_1 src1_sel:WORD_1
    v_cmp_ne_u32_sdwa vcc, v21, v25 src0_sel:WORD_1 src1_sel:WORD_1
    v_alignbyte_b32 v24, v21, v24, 1
    s_mov_b32 s54, 10237
    v_perm_b32 v22, v22, v23, s45
    s_waitcnt lgkmcnt(1)
    v_add3_u32 v26, v26, v106, s54
    v_sub_u32 v27, 0, v26
    v_and_b32 v27, 3, v27
    s_mov_b64 exec, s[80:81]
    v_mov_b32 v27, 0
    v_mov_b32 v22, 0
    s_mov_b64 exec, vcc
    v_mov_b32 v27, 3

    s_mov_b64 exec, -1
    v_alignbyte_b32 v21, v22, v20, v27
    v_alignbyte_b32 v20, v20, v24, v27
    v_add_u32 v26, v26, v27

    buffer_store_dwordx2 v[20:21], v26, s[24:27], 0 offen
    v_cmp_ne_u32_sdwa s[80:81], v29, v31 src0_sel:WORD_1 src1_sel:WORD_1
    v_cmp_ne_u32_sdwa vcc, v29, v33 src0_sel:WORD_1 src1_sel:WORD_1
    v_alignbyte_b32 v32, v29, v32, 1
    s_mov_b32 s54, 15357
    v_perm_b32 v30, v30, v31, s45
    s_waitcnt lgkmcnt(0)
    v_add3_u32 v34, v34, v106, s54
    v_sub_u32 v35, 0, v34
    v_and_b32 v35, 3, v35
    s_mov_b64 exec, s[80:81]
    v_mov_b32 v35, 0
    v_mov_b32 v30, 0
    s_mov_b64 exec, vcc
    v_mov_b32 v35, 3

    s_mov_b64 exec, -1
    v_alignbyte_b32 v29, v30, v28, v35
    v_alignbyte_b32 v28, v28, v32, v35
    v_add_u32 v34, v34, v35

    buffer_store_dwordx2 v[28:29], v34, s[24:27], 0 offen
L_skw_43:
    s_bitcmp0_b32 s28, 1
    s_cbranch_scc1 L_skw_44
    v_add_u32 v107, 32768, v2
    ds_read_b64 v[4:5], v107 offset:24592
    ds_read_b64 v[6:7], v107 offset:24600
    ds_read_b64 v[8:9], v107 offset:24584

    ds_read_b64 v[12:13], v107 offset:32784
    ds_read_b64 v[14:15], v107 offset:32792
    ds_read_b64 v[16:17], v107 offset:32776

    ds_read_b64 v[20:21], v107 offset:40976
    ds_read_b64 v[22:23], v107 offset:40984
    ds_read_b64 v[24:25], v107 offset:40968

    ds_read_b64 v[28:29], v107 offset:49168
    ds_read_b64 v[30:31], v107 offset:49176
    ds_read_b64 v[32:33], v107 offset:49160

    s_waitcnt lgkmcnt(9)
    v_lshrrev_b32 v10, 16, v5
    ds_read_b32 v10, v10 offset:16384

    s_waitcnt lgkmcnt(7)
    v_lshrrev_b32 v18, 16, v13
    ds_read_b32 v18, v18 offset:16384

    s_waitcnt lgkmcnt(5)
    v_lshrrev_b32 v26, 16, v21
    ds_read_b32 v26, v26 offset:16384

    s_waitcnt lgkmcnt(3)
    v_lshrrev_b32 v34, 16, v29
    ds_read_b32 v34, v34 offset:16384

    v_cmp_ne_u32_sdwa s[80:81], v5, v7 src0_sel:WORD_1 src1_sel:WORD_1
    v_cmp_ne_u32_sdwa vcc, v5, v9 src0_sel:WORD_1 src1_sel:WORD_1
    v_alignbyte_b32 v8, v5, v8, 1
    s_mov_b32 s54, 20477
    v_perm_b32 v6, v6, v7, s45
    s_waitcnt lgkmcnt(3)
    v_add3_u32 v10, v10, v106, s54
    v_sub_u32 v11, 0, v10
    v_and_b32 v11, 3, v11
    s_mov_b64 exec, s[80:81]
    v_mov_b32 v11, 0
    v_mov_b32 v6, 0
    s_mov_b64 exec, vcc
    v_mov_b32 v11, 3

    s_mov_b64 exec, -1
    v_alignbyte_b32 v5, v6, v4, v11
    v_alignbyte_b32 v4, v4, v8, v11
    v_add_u32 v10, v10, v11

    buffer_store_dwordx2 v[4:5], v10, s[24:27], 0 offen
    v_cmp_ne_u32_sdwa s[80:81], v13, v15 src0_sel:WORD_1 src1_sel:WORD_1
    v_cmp_ne_u32_sdwa vcc, v13, v17 src0_sel:WORD_1 src1_sel:WORD_1
    v_alignbyte_b32 v16, v13, v16, 1
    s_mov_b32 s54, 25597
    v_perm_b32 v14, v14, v15, s45
    s_waitcnt lgkmcnt(2)
    v_add3_u32 v18, v18, v106, s54
    v_sub_u32 v19, 0, v18
    v_and_b32 v19, 3, v19
    s_mov_b64 exec, s[80:81]
    v_mov_b32 v19, 0
    v_mov_b32 v14, 0
    s_mov_b64 exec, vcc
    v_mov_b32 v19, 3

    s_mov_b64 exec, -1
    v_alignbyte_b32 v13, v14, v12, v19
    v_alignbyte_b32 v12, v12, v16, v19
    v_add_u32 v18, v18, v19

    buffer_store_dwordx2 v[12:13], v18, s[24:27], 0 offen
    v_cmp_ne_u32_sdwa s[80:81], v21, v23 src0_sel:WORD_1 src1_sel:WORD_1
    v_cmp_ne_u32_sdwa vcc, v21, v25 src0_sel:WORD_1 src1_sel:WORD_1
    v_alignbyte_b32 v24, v21, v24, 1
    s_mov_b32 s54, 30717
    v_perm_b32 v22, v22, v23, s45
    s_waitcnt lgkmcnt(1)
    v_add3_u32 v26, v26, v106, s54
    v_sub_u32 v27, 0, v26
    v_and_b32 v27, 3, v27
    s_mov_b64 exec, s[80:81]
    v_mov_b32 v27, 0
    v_mov_b32 v22, 0
    s_mov_b64 exec, vcc
    v_mov_b32 v27, 3

    s_mov_b64 exec, -1
    v_alignbyte_b32 v21, v22, v20, v27
    v_alignbyte_b32 v20, v20, v24, v27
    v_add_u32 v26, v26, v27

    buffer_store_dwordx2 v[20:21], v26, s[24:27], 0 offen
    v_cmp_ne_u32_sdwa s[80:81], v29, v31 src0_sel:WORD_1 src1_sel:WORD_1
    v_cmp_ne_u32_sdwa vcc, v29, v33 src0_sel:WORD_1 src1_sel:WORD_1
    v_alignbyte_b32 v32, v29, v32, 1
    s_mov_b32 s54, 35837
    v_perm_b32 v30, v30, v31, s45
    s_waitcnt lgkmcnt(0)
    v_add3_u32 v34, v34, v106, s54
    v_sub_u32 v35, 0, v34
    v_and_b32 v35, 3, v35
    s_mov_b64 exec, s[80:81]
    v_mov_b32 v35, 0
    v_mov_b32 v30, 0
    s_mov_b64 exec, vcc
    v_mov_b32 v35, 3

    s_mov_b64 exec, -1
    v_alignbyte_b32 v29, v30, v28, v35
    v_alignbyte_b32 v28, v28, v32, v35
    v_add_u32 v34, v34, v35

    buffer_store_dwordx2 v[28:29], v34, s[24:27], 0 offen
L_skw_44:
    s_bitcmp0_b32 s28, 2
    s_cbranch_scc1 L_skw_45
    v_add_u32 v107, 65536, v2
    ds_read_b64 v[4:5], v107 offset:24592
    ds_read_b64 v[6:7], v107 offset:24600
    ds_read_b64 v[8:9], v107 offset:24584

    ds_read_b64 v[12:13], v107 offset:32784
    ds_read_b64 v[14:15], v107 offset:32792
    ds_read_b64 v[16:17], v107 offset:32776

    ds_read_b64 v[20:21], v107 offset:40976
    ds_read_b64 v[22:23], v107 offset:40984
    ds_read_b64 v[24:25], v107 offset:40968

    ds_read_b64 v[28:29], v107 offset:49168
    ds_read_b64 v[30:31], v107 offset:49176
    ds_read_b64 v[32:33], v107 offset:49160

    s_waitcnt lgkmcnt(9)
    v_lshrrev_b32 v10, 16, v5
    ds_read_b32 v10, v10 offset:16384

    s_waitcnt lgkmcnt(7)
    v_lshrrev_b32 v18, 16, v13
    ds_read_b32 v18, v18 offset:16384

    s_waitcnt lgkmcnt(5)
    v_lshrrev_b32 v26, 16, v21
    ds_read_b32 v26, v26 offset:16384

    s_waitcnt lgkmcnt(3)
    v_lshrrev_b32 v34, 16, v29
    ds_read_b32 v34, v34 offset:16384

    v_cmp_ne_u32_sdwa s[80:81], v5, v7 src0_sel:WORD_1 src1_sel:WORD_1
    v_cmp_ne_u32_sdwa vcc, v5, v9 src0_sel:WORD_1 src1_sel:WORD_1
    v_alignbyte_b32 v8, v5, v8, 1
    s_mov_b32 s54, 40957
    v_perm_b32 v6, v6, v7, s45
    s_waitcnt lgkmcnt(3)
    v_add3_u32 v10, v10, v106, s54
    v_sub_u32 v11, 0, v10
    v_and_b32 v11, 3, v11
    s_mov_b64 exec, s[80:81]
    v_mov_b32 v11, 0
    v_mov_b32 v6, 0
    s_mov_b64 exec, vcc
    v_mov_b32 v11, 3

    s_mov_b64 exec, -1
    v_alignbyte_b32 v5, v6, v4, v11
    v_alignbyte_b32 v4, v4, v8, v11
    v_add_u32 v10, v10, v11

    buffer_store_dwordx2 v[4:5], v10, s[24:27], 0 offen
    v_cmp_ne_u32_sdwa s[80:81], v13, v15 src0_sel:WORD_1 src1_sel:WORD_1
    v_cmp_ne_u32_sdwa vcc, v13, v17 src0_sel:WORD_1 src1_sel:WORD_1
    v_alignbyte_b32 v16, v13, v16, 1
    s_mov_b32 s54, 46077
    v_perm_b32 v14, v14, v15, s45
    s_waitcnt lgkmcnt(2)
    v_add3_u32 v18, v18, v106, s54
    v_sub_u32 v19, 0, v18
    v_and_b32 v19, 3, v19
    s_mov_b64 exec, s[80:81]
    v_mov_b32 v19, 0
    v_mov_b32 v14, 0
    s_mov_b64 exec, vcc
    v_mov_b32 v19, 3

    s_mov_b64 exec, -1
    v_alignbyte_b32 v13, v14, v12, v19
    v_alignbyte_b32 v12, v12, v16, v19
    v_add_u32 v18, v18, v19

    buffer_store_dwordx2 v[12:13], v18, s[24:27], 0 offen
    v_cmp_ne_u32_sdwa s[80:81], v21, v23 src0_sel:WORD_1 src1_sel:WORD_1
    v_cmp_ne_u32_sdwa vcc, v21, v25 src0_sel:WORD_1 src1_sel:WORD_1
    v_alignbyte_b32 v24, v21, v24, 1
    s_mov_b32 s54, 51197
    v_perm_b32 v22, v22, v23, s45
    s_waitcnt lgkmcnt(1)
    v_add3_u32 v26, v26, v106, s54
    v_sub_u32 v27, 0, v26
    v_and_b32 v27, 3, v27
    s_mov_b64 exec, s[80:81]
    v_mov_b32 v27, 0
    v_mov_b32 v22, 0
    s_mov_b64 exec, vcc
    v_mov_b32 v27, 3

    s_mov_b64 exec, -1
    v_alignbyte_b32 v21, v22, v20, v27
    v_alignbyte_b32 v20, v20, v24, v27
    v_add_u32 v26, v26, v27

    buffer_store_dwordx2 v[20:21], v26, s[24:27], 0 offen
    v_cmp_ne_u32_sdwa s[80:81], v29, v31 src0_sel:WORD_1 src1_sel:WORD_1
    v_cmp_ne_u32_sdwa vcc, v29, v33 src0_sel:WORD_1 src1_sel:WORD_1
    v_alignbyte_b32 v32, v29, v32, 1
    s_mov_b32 s54, 56317
    v_perm_b32 v30, v30, v31, s45
    s_waitcnt lgkmcnt(0)
    v_add3_u32 v34, v34, v106, s54
    v_sub_u32 v35, 0, v34
    v_and_b32 v35, 3, v35
    s_mov_b64 exec, s[80:81]
    v_mov_b32 v35, 0
    v_mov_b32 v30, 0
    s_mov_b64 exec, vcc
    v_mov_b32 v35, 3

    s_mov_b64 exec, -1
    v_alignbyte_b32 v29, v30, v28, v35
    v_alignbyte_b32 v28, v28, v32, v35
    v_add_u32 v34, v34, v35

    buffer_store_dwordx2 v[28:29], v34, s[24:27], 0 offen
L_skw_45:
    s_bitcmp0_b32 s28, 3
    s_cbranch_scc1 L_skw_46
    v_add_u32 v107, 98304, v2
    ds_read_b64 v[4:5], v107 offset:24592
    ds_read_b64 v[6:7], v107 offset:24600
    ds_read_b64 v[8:9], v107 offset:24584

    ds_read_b64 v[12:13], v107 offset:32784
    ds_read_b64 v[14:15], v107 offset:32792
    ds_read_b64 v[16:17], v107 offset:32776

    ds_read_b64 v[20:21], v107 offset:40976
    ds_read_b64 v[22:23], v107 offset:40984
    ds_read_b64 v[24:25], v107 offset:40968

    ds_read_b64 v[28:29], v107 offset:49168
    ds_read_b64 v[30:31], v107 offset:49176
    ds_read_b64 v[32:33], v107 offset:49160

    s_waitcnt lgkmcnt(9)
    v_lshrrev_b32 v10, 16, v5
    ds_read_b32 v10, v10 offset:16384

    s_waitcnt lgkmcnt(7)
    v_lshrrev_b32 v18, 16, v13
    ds_read_b32 v18, v18 offset:16384

    s_waitcnt lgkmcnt(5)
    v_lshrrev_b32 v26, 16, v21
    ds_read_b32 v26, v26 offset:16384

    s_waitcnt lgkmcnt(3)
    v_lshrrev_b32 v34, 16, v29
    ds_read_b32 v34, v34 offset:16384

    v_cmp_ne_u32_sdwa s[80:81], v5, v7 src0_sel:WORD_1 src1_sel:WORD_1
    v_cmp_ne_u32_sdwa vcc, v5, v9 src0_sel:WORD_1 src1_sel:WORD_1
    v_alignbyte_b32 v8, v5, v8, 1
    s_mov_b32 s54, 61437
    v_perm_b32 v6, v6, v7, s45
    s_waitcnt lgkmcnt(3)
    v_add3_u32 v10, v10, v106, s54
    v_sub_u32 v11, 0, v10
    v_and_b32 v11, 3, v11
    s_mov_b64 exec, s[80:81]
    v_mov_b32 v11, 0
    v_mov_b32 v6, 0
    s_mov_b64 exec, vcc
    v_mov_b32 v11, 3

    s_mov_b64 exec, -1
    v_alignbyte_b32 v5, v6, v4, v11
    v_alignbyte_b32 v4, v4, v8, v11
    v_add_u32 v10, v10, v11

    buffer_store_dwordx2 v[4:5], v10, s[24:27], 0 offen
    v_cmp_ne_u32_sdwa s[80:81], v13, v15 src0_sel:WORD_1 src1_sel:WORD_1
    v_cmp_ne_u32_sdwa vcc, v13, v17 src0_sel:WORD_1 src1_sel:WORD_1
    v_alignbyte_b32 v16, v13, v16, 1
    s_mov_b32 s54, 66557
    v_perm_b32 v14, v14, v15, s45
    s_waitcnt lgkmcnt(2)
    v_add3_u32 v18, v18, v106, s54
    v_sub_u32 v19, 0, v18
    v_and_b32 v19, 3, v19
    s_mov_b64 exec, s[80:81]
    v_mov_b32 v19, 0
    v_mov_b32 v14, 0
    s_mov_b64 exec, vcc
    v_mov_b32 v19, 3

    s_mov_b64 exec, -1
    v_alignbyte_b32 v13, v14, v12, v19
    v_alignbyte_b32 v12, v12, v16, v19
    v_add_u32 v18, v18, v19

    buffer_store_dwordx2 v[12:13], v18, s[24:27], 0 offen
    v_cmp_ne_u32_sdwa s[80:81], v21, v23 src0_sel:WORD_1 src1_sel:WORD_1
    v_cmp_ne_u32_sdwa vcc, v21, v25 src0_sel:WORD_1 src1_sel:WORD_1
    v_alignbyte_b32 v24, v21, v24, 1
    s_mov_b32 s54, 71677
    v_perm_b32 v22, v22, v23, s45
    s_waitcnt lgkmcnt(1)
    v_add3_u32 v26, v26, v106, s54
    v_sub_u32 v27, 0, v26
    v_and_b32 v27, 3, v27
    s_mov_b64 exec, s[80:81]
    v_mov_b32 v27, 0
    v_mov_b32 v22, 0
    s_mov_b64 exec, vcc
    v_mov_b32 v27, 3

    s_mov_b64 exec, -1
    v_alignbyte_b32 v21, v22, v20, v27
    v_alignbyte_b32 v20, v20, v24, v27
    v_add_u32 v26, v26, v27

    buffer_store_dwordx2 v[20:21], v26, s[24:27], 0 offen
    v_cmp_ne_u32_sdwa s[80:81], v29, v31 src0_sel:WORD_1 src1_sel:WORD_1
    v_cmp_ne_u32_sdwa vcc, v29, v33 src0_sel:WORD_1 src1_sel:WORD_1
    v_alignbyte_b32 v32, v29, v32, 1
    s_mov_b32 s54, 76797
    v_perm_b32 v30, v30, v31, s45
    s_waitcnt lgkmcnt(0)
    v_add3_u32 v34, v34, v106, s54
    v_sub_u32 v35, 0, v34
    v_and_b32 v35, 3, v35
    s_mov_b64 exec, s[80:81]
    v_mov_b32 v35, 0
    v_mov_b32 v30, 0
    s_mov_b64 exec, vcc
    v_mov_b32 v35, 3

    s_mov_b64 exec, -1
    v_alignbyte_b32 v29, v30, v28, v35
    v_alignbyte_b32 v28, v28, v32, v35
    v_add_u32 v34, v34, v35

    buffer_store_dwordx2 v[28:29], v34, s[24:27], 0 offen
L_skw_46:
L_p1done_1:
    s_endpgm

L_ska_8:
    v_bfrev_b32 v126, 1
    buffer_load_dword v3, v126, s[96:99], 0 offen
    buffer_load_dword v3, v126, s[96:99], 0 offen
    buffer_load_dword v3, v126, s[96:99], 0 offen
    s_branch L_bka_9
L_ska_10:
    v_bfrev_b32 v126, 1
    buffer_load_dword v3, v126, s[96:99], 0 offen
    buffer_load_dword v3, v126, s[96:99], 0 offen
    buffer_load_dword v3, v126, s[96:99], 0 offen
    s_branch L_bka_11
L_ska_12:
    v_bfrev_b32 v126, 1
    buffer_load_dword v3, v126, s[96:99], 0 offen
    buffer_load_dword v3, v126, s[96:99], 0 offen
    buffer_load_dword v3, v126, s[96:99], 0 offen
    s_branch L_bka_13
L_ska_14:
    v_bfrev_b32 v126, 1
    buffer_load_dword v3, v126, s[96:99], 0 offen
    buffer_load_dword v3, v126, s[96:99], 0 offen
    buffer_load_dword v3, v126, s[96:99], 0 offen
    s_branch L_bka_15
L_full_27:
    v_mov_b32 v110, 0
    s_mov_b64 exec, vcc
    v_bfrev_b32 v92, 1
    v_bfrev_b32 v93, 1
    s_mov_b64 exec, 1
    buffer_atomic_or v104, v110, s[36:39], 0 offen
    s_mov_b64 exec, -1
    s_branch L_fback_28

L_full_41:
    v_mov_b32 v110, 0
    s_mov_b64 exec, vcc
    v_bfrev_b32 v92, 1
    v_bfrev_b32 v93, 1
    s_mov_b64 exec, 1
    buffer_atomic_or v104, v110, s[36:39], 0 offen
    s_mov_b64 exec, -1
    s_branch L_fback_42

.globl standalone__molecular_angular_gemnet__graph_kernel
.p2align 8
.type standalone__molecular_angular_gemnet__graph_kernel,@function
standalone__molecular_angular_gemnet__graph_kernel:
    s_cmp_ge_u32 s2, 256
    s_cbranch_scc1 L_p2done_47
    s_load_dwordx2 s[8:9], s[0:1], 0
    s_load_dwordx2 s[6:7], s[0:1], 104
    v_lshrrev_b32 v4, 6, v0
    s_lshr_b32 s37, s2, 1
    s_and_b32 s37, s37, 3
    s_lshr_b32 s36, s2, 3
    s_lshl_b32 s36, s36, 1
    s_and_b32 s3, s2, 1
    s_or_b32 s36, s36, s3
    v_readfirstlane_b32 s4, v4
    v_and_b32 v2, 63, v0
    v_lshrrev_b32 v3, 9, v0
    v_lshl_or_b32 v2, v3, 6, v2
    v_mul_u32_u24 v2, 20, v2
    v_lshlrev_b32 v3, 4, v0

    s_waitcnt lgkmcnt(0)
    s_lshl_b32 m0, s4, 10
    s_mov_b32 s25, s4
    s_and_b32 s5, s4, 7
    s_lshr_b32 s39, s4, 3
    s_lshl_b32 s39, s39, 8
    s_mul_i32 s3, s5, 4096
    s_add_u32 s46, s6, s3
    s_addc_u32 s47, s7, 0
    s_mul_i32 s3, s5, 67117056
    s_add_u32 s3, s3, 85721088
    s_add_u32 s44, s6, s3
    s_addc_u32 s45, s7, 0
    s_mul_i32 s38, s37, 8
    s_add_u32 s4, s38, 8
    s_lshl_b32 s3, s36, 5
    s_add_u32 s3, s3, s38
    s_lshl_b32 s3, s3, 1
    s_load_dwordx4 s[92:95], s[46:47], s3
    s_mov_b32 s3, 32768
    s_load_dword s51, s[6:7], s3
    s_mov_b32 s10, 6400000
    s_mov_b32 s11, 0x20000

    s_add_u32 s12, s6, 2490368
    s_addc_u32 s13, s7, 0
    s_mov_b32 s14, 0
    s_mov_b32 s15, 0x20000
    s_add_u32 s60, s6, 2490368
    s_addc_u32 s61, s7, 0
    s_mov_b32 s62, 6406144
    s_mov_b32 s63, 0x20000
    s_mov_b32 s3, 135176
    s_load_dword s33, s[6:7], s3

    s_mul_i32 s43, s38, 200192
    s_mul_i32 s41, s4, 200192
    s_mul_i32 s50, s38, 200000
    s_add_u32 s14, s43, 50000

    s_add_u32 s52, s43, 49152
    s_cmp_ge_u32 s25, 4
    s_cbranch_scc1 L_sk3_49
    v_lshlrev_b32 v119, 2, v0
    buffer_load_dword v88, v119, s[12:15], s52 offen
L_sk3_49:
    buffer_load_dwordx4 v[76:79], v3, s[12:15], s43 offen
    s_add_u32 s52, s43, 16384
    buffer_load_dwordx4 v[80:83], v3, s[12:15], s52 offen
    s_add_u32 s52, s43, 32768
    buffer_load_dwordx4 v[84:87], v3, s[12:15], s52 offen
    s_add_u32 s20, s6, 135168
    s_addc_u32 s21, s7, 0
    s_mov_b32 s22, 4096
    s_mov_b32 s23, 0x20000
    v_and_b32 v44, 63, v0
    v_lshlrev_b32 v44, 4, v44
    buffer_load_dwordx2 v[120:121], v44, s[20:23], 0 offen offset:0
    buffer_load_dwordx2 v[122:123], v44, s[20:23], 0 offen offset:1024
    buffer_load_dwordx2 v[124:125], v44, s[20:23], 0 offen offset:2048
    buffer_load_dwordx2 v[126:127], v44, s[20:23], 0 offen offset:3072
    s_movk_i32 s40, 3072
    s_mov_b32 s19, 0x20000
    s_min_u32 s40, s40, 6524
    s_lshl_b32 s52, s38, 6
    s_add_u32 s52, s52, s36
    s_mul_i32 s52, s52, 32764
    s_and_b32 s52, s52, 0xffffff80
    s_add_u32 s16, s44, s52
    s_addc_u32 s17, s45, 0
    s_mul_i32 s52, s40, 5
    s_add_u32 s52, s52, 3
    s_and_b32 s18, s52, -4

    s_movk_i32 s53, 5120
    buffer_load_dwordx4 v[90:93], v2, s[16:19], s53 offen offset:4
    buffer_load_dword v110, v2, s[16:19], s53 offen
    s_movk_i32 s53, 7680
    buffer_load_dwordx4 v[94:97], v2, s[16:19], s53 offen offset:4
    buffer_load_dword v111, v2, s[16:19], s53 offen
    s_movk_i32 s53, 10240
    buffer_load_dwordx4 v[98:101], v2, s[16:19], s53 offen offset:4
    buffer_load_dword v112, v2, s[16:19], s53 offen
    s_lshr_b32 s3, s2, 3
    s_mul_i32 s3, s3, 49
    v_add_lshl_u32 v89, v0, s3, 7
    v_cmp_gt_u32 vcc, 49, v0
    v_bfrev_b32 v28, 1
    s_nop 0
    v_cndmask_b32 v89, v28, v89, vcc

    s_mov_b32 s19, 0x20000
    s_mov_b32 s28, 0x4b404000
    s_mov_b32 s29, 0x4b404000
    s_mov_b32 s30, 0xbfffc000
    s_mov_b32 s31, 0xbfffbfff
    s_mov_b32 s32, 0xffff0000
    s_mov_b32 s35, 0x05040100
    s_mov_b32 s97, 0x07060302
    s_mov_b32 s96, 0x40008000
    s_movk_i32 s3, 212
    v_cmp_gt_u32 s[48:49], s3, v0

    v_mov_b32 v1, 0
    s_mov_b32 s24, 0x0c0c0004
    v_mov_b32 v28, 0x40004000
    v_mov_b32 v29, 0x40004000
    v_mov_b32 v30, 0x40004000
    v_mov_b32 v31, 0x40004000
    v_add_u32 v32, 50000, v3
    v_add_u32 v33, 65536, v32

    ds_write_b128 v32, v[28:31] offset:0
    ds_write_b128 v32, v[28:31] offset:16384
    ds_write_b128 v32, v[28:31] offset:32768
    ds_write_b128 v32, v[28:31] offset:49152
    ds_write_b128 v33, v[28:31] offset:0
    ds_write_b128 v33, v[28:31] offset:16384
    v_cmp_gt_u32 vcc, 971, v0
    s_mov_b64 exec, vcc
    ds_write_b128 v33, v[28:31] offset:32768
    s_mov_b64 exec, -1
    s_waitcnt vmcnt(12)
    ds_write_addtid_b32 v76 offset:0
    ds_write_addtid_b32 v77 offset:256
    ds_write_addtid_b32 v78 offset:512
    ds_write_addtid_b32 v79 offset:768
    s_waitcnt vmcnt(11)
    ds_write_addtid_b32 v80 offset:16384
    ds_write_addtid_b32 v81 offset:16640
    ds_write_addtid_b32 v82 offset:16896
    ds_write_addtid_b32 v83 offset:17152
    s_waitcnt vmcnt(10)
    ds_write_addtid_b32 v84 offset:32768
    ds_write_addtid_b32 v85 offset:33024
    ds_write_addtid_b32 v86 offset:33280
    ds_write_addtid_b32 v87 offset:33536
    v_lshlrev_b32 v119, 2, v0
    s_waitcnt vmcnt(13)
    s_mov_b64 exec, s[48:49]
    ds_write_b32 v119, v88 offset:49152
    s_mov_b64 exec, -1
    s_add_u32 s43, s43, 50048
    s_add_u32 s14, s43, 50000
    s_min_u32 s14, s14, s41
    s_waitcnt lgkmcnt(0)
    s_and_b32 s88, s92, 0xffff
    s_lshr_b32 s89, s92, 16
    s_and_b32 s90, s93, 0xffff
    s_lshr_b32 s91, s93, 16
    s_and_b32 s92, s94, 0xffff
    s_lshr_b32 s93, s94, 16
    s_and_b32 s94, s95, 0xffff
    s_lshr_b32 s95, s95, 16
    s_waitcnt vmcnt(6)
    v_max3_u32 v120, v120, v122, v124
    v_add_f32 v121, v121, v123
    v_add_f32 v125, v125, v127
    v_max_u32 v120, v120, v126
    v_add_f32 v121, v121, v125

    s_nop 1
    v_max_u32_dpp v120, v120, v120 row_shr:1 row_mask:0xf bank_mask:0xf
    s_nop 1
    v_max_u32_dpp v120, v120, v120 row_shr:2 row_mask:0xf bank_mask:0xf
    s_nop 1
    v_max_u32_dpp v120, v120, v120 row_shr:4 row_mask:0xf bank_mask:0xf
    s_nop 1
    v_max_u32_dpp v120, v120, v120 row_shr:8 row_mask:0xf bank_mask:0xf
    s_nop 1
    v_max_u32_dpp v120, v120, v120 row_bcast:15 row_mask:0xa bank_mask:0xf
    s_nop 1
    v_max_u32_dpp v120, v120, v120 row_bcast:31 row_mask:0xc bank_mask:0xf
    s_nop 1
    v_add_f32_dpp v121, v121, v121 row_shr:1 row_mask:0xf bank_mask:0xf
    s_nop 1
    v_add_f32_dpp v121, v121, v121 row_shr:2 row_mask:0xf bank_mask:0xf
    s_nop 1
    v_add_f32_dpp v121, v121, v121 row_shr:4 row_mask:0xf bank_mask:0xf
    s_nop 1
    v_add_f32_dpp v121, v121, v121 row_shr:8 row_mask:0xf bank_mask:0xf
    s_nop 1
    v_add_f32_dpp v121, v121, v121 row_bcast:15 row_mask:0xa bank_mask:0xf
    s_nop 1
    v_add_f32_dpp v121, v121, v121 row_bcast:31 row_mask:0xc bank_mask:0xf
    v_lshlrev_b32 v120, 16, v120
    v_mul_f32 v121, 0x34a7c5ac, v121
    v_sqrt_f32 v121, v121
    v_mul_f32 v120, s33, v120
    v_mul_f32 v121, s33, v121
    v_cmp_gt_f32 vcc, 0x46fde800, v120
    s_mov_b64 s[64:65], vcc
    v_cmp_lt_f32 vcc, 0x44000000, v121
    v_mov_b32 v120, 0x37800000
    v_mul_f32 v120, s33, v120
    s_and_b64 vcc, vcc, s[64:65]
    v_mul_f32 v121, 0x46ff8000, v120
    v_rcp_f32 v121, v121
    v_readfirstlane_b32 s33, v120
    s_waitcnt lgkmcnt(0)
    s_barrier
    v_readfirstlane_b32 s34, v121
    v_mov_b32 v120, 150016
    v_mov_b32 v121, 0
    ds_write_b32 v120, v121 offset:8
    s_bitcmp0_b64 vcc, 63
    s_cbranch_scc1 L_p2slow_48
    s_cmp_lg_u32 s51, 0
    s_cbranch_scc1 L_p2slow_48

    s_min_u32 s88, s88, 6524
    s_lshl_b32 s52, s38, 6
    s_add_u32 s52, s52, s36
    s_mul_i32 s52, s52, 32764
    s_and_b32 s52, s52, 0xffffff80
    s_add_u32 s16, s44, s52
    s_addc_u32 s17, s45, 0
    s_mul_i32 s52, s88, 5
    s_add_u32 s52, s52, 3
    s_and_b32 s18, s52, -4

    s_movk_i32 s53, 12800
    buffer_load_dwordx4 v[102:105], v2, s[16:19], s53 offen offset:4
    buffer_load_dword v113, v2, s[16:19], s53 offen
    s_movk_i32 s53, 0
    buffer_load_dwordx4 v[4:7], v2, s[16:19], s53 offen offset:4 nt
    buffer_load_dword v35, v2, s[16:19], s53 offen nt
    s_movk_i32 s53, 2560
    buffer_load_dwordx4 v[8:11], v2, s[16:19], s53 offen offset:4
    buffer_load_dword v43, v2, s[16:19], s53 offen
    s_sub_u32 s53, s88, s39
    s_cmp_le_i32 s53, 3072
    s_cbranch_scc1 L_skt_56
    s_movk_i32 s53, 15360
    buffer_load_dwordx4 v[106:109], v2, s[16:19], s53 offen offset:4
    buffer_load_dword v114, v2, s[16:19], s53 offen
L_skt_56:
    s_mov_b32 s40, s88
    s_sub_u32 s42, s40, s39

    s_add_u32 s55, s38, 1
    s_min_u32 s55, s55, 31
    s_mov_b32 s88, s89
    s_mov_b32 s89, s90
    s_mov_b32 s90, s91
    s_mov_b32 s91, s92
    s_mov_b32 s92, s93
    s_mov_b32 s93, s94
    s_mov_b32 s94, s95
    s_mov_b32 s95, 0
    s_min_u32 s88, s88, 6524
    s_lshl_b32 s52, s55, 6
    s_add_u32 s52, s52, s36
    s_mul_i32 s52, s52, 32764
    s_and_b32 s52, s52, 0xffffff80
    s_add_u32 s16, s44, s52
    s_addc_u32 s17, s45, 0
    s_mul_i32 s52, s88, 5
    s_add_u32 s52, s52, 3
    s_and_b32 s18, s52, -4

    s_waitcnt vmcnt(10)
    v_lshlrev_b32_sdwa v44, 3, v110 dst_sel:WORD_0 dst_unused:UNUSED_PAD src0_sel:DWORD src1_sel:DWORD
    v_lshrrev_b32 v46, 5, v90
    v_lshlrev_b32_sdwa v48, 3, v91 dst_sel:WORD_0 dst_unused:UNUSED_PAD src0_sel:DWORD src1_sel:WORD_1
    v_alignbit_b32 v50, v93, v92, 21

    v_mov_b32 v15, v93
    v_alignbyte_b32 v14, v92, v91, 3
    v_alignbyte_b32 v13, v91, v90, 2
    v_alignbyte_b32 v12, v90, v110, 1
    v_and_b32 v46, 0xfff8, v46
    v_and_b32 v50, 0xfff8, v50
    s_cmp_lt_i32 s42, 1280
    s_cbranch_scc1 L_ufix_57
L_uback_58:

    v_subrev_co_u32 v12, s[80:81], 2.0, v12
    v_subrev_co_u32 v13, s[82:83], 2.0, v13
    v_subrev_co_u32 v14, s[84:85], 2.0, v14
    v_subrev_co_u32 v15, s[86:87], 2.0, v15
    s_mov_b64 exec, s[80:81]
    ds_read_b64 v[44:45], v44
    s_mov_b64 exec, s[82:83]
    ds_read_b64 v[46:47], v46
    s_mov_b64 exec, s[84:85]
    ds_read_b64 v[48:49], v48
    s_mov_b64 exec, s[86:87]
    ds_read_b64 v[50:51], v50
    s_mov_b64 exec, -1
    s_waitcnt vmcnt(8)
    v_lshlrev_b32_sdwa v52, 3, v111 dst_sel:WORD_0 dst_unused:UNUSED_PAD src0_sel:DWORD src1_sel:DWORD
    v_lshrrev_b32 v54, 5, v94
    v_lshlrev_b32_sdwa v56, 3, v95 dst_sel:WORD_0 dst_unused:UNUSED_PAD src0_sel:DWORD src1_sel:WORD_1
    v_alignbit_b32 v58, v97, v96, 21

    v_mov_b32 v19, v97
    v_alignbyte_b32 v18, v96, v95, 3
    v_alignbyte_b32 v17, v95, v94, 2
    v_alignbyte_b32 v16, v94, v111, 1
    v_and_b32 v54, 0xfff8, v54
    v_and_b32 v58, 0xfff8, v58
    s_cmp_lt_i32 s42, 1792
    s_cbranch_scc1 L_ufix_59
L_uback_60:

    v_subrev_co_u32 v16, s[64:65], 2.0, v16
    v_subrev_co_u32 v17, s[66:67], 2.0, v17
    v_subrev_co_u32 v18, s[68:69], 2.0, v18
    v_subrev_co_u32 v19, s[70:71], 2.0, v19
    s_mov_b64 exec, s[64:65]
    ds_read_b64 v[52:53], v52
    s_mov_b64 exec, s[66:67]
    ds_read_b64 v[54:55], v54
    s_mov_b64 exec, s[68:69]
    ds_read_b64 v[56:57], v56
    s_mov_b64 exec, s[70:71]
    ds_read_b64 v[58:59], v58
    s_mov_b64 exec, -1
    s_waitcnt vmcnt(6)
    v_lshlrev_b32_sdwa v60, 3, v112 dst_sel:WORD_0 dst_unused:UNUSED_PAD src0_sel:DWORD src1_sel:DWORD
    v_lshrrev_b32 v62, 5, v98
    v_lshlrev_b32_sdwa v64, 3, v99 dst_sel:WORD_0 dst_unused:UNUSED_PAD src0_sel:DWORD src1_sel:WORD_1
    v_alignbit_b32 v66, v101, v100, 21

    v_mov_b32 v23, v101
    v_alignbyte_b32 v22, v100, v99, 3
    v_alignbyte_b32 v21, v99, v98, 2
    v_alignbyte_b32 v20, v98, v112, 1
    v_and_b32 v62, 0xfff8, v62
    v_and_b32 v66, 0xfff8, v66
    s_cmp_lt_i32 s42, 2304
    s_cbranch_scc1 L_ufix_61
L_uback_62:

    v_subrev_co_u32 v20, s[72:73], 2.0, v20
    v_subrev_co_u32 v21, s[74:75], 2.0, v21
    v_subrev_co_u32 v22, s[76:77], 2.0, v22
    v_subrev_co_u32 v23, s[78:79], 2.0, v23
    s_mov_b64 exec, s[72:73]
    ds_read_b64 v[60:61], v60
    s_mov_b64 exec, s[74:75]
    ds_read_b64 v[62:63], v62
    s_mov_b64 exec, s[76:77]
    ds_read_b64 v[64:65], v64
    s_mov_b64 exec, s[78:79]
    ds_read_b64 v[66:67], v66
    s_mov_b64 exec, -1
    s_waitcnt vmcnt(4)
    v_lshlrev_b32_sdwa v68, 3, v113 dst_sel:WORD_0 dst_unused:UNUSED_PAD src0_sel:DWORD src1_sel:DWORD
    v_lshrrev_b32 v70, 5, v102
    v_lshlrev_b32_sdwa v72, 3, v103 dst_sel:WORD_0 dst_unused:UNUSED_PAD src0_sel:DWORD src1_sel:WORD_1
    v_alignbit_b32 v74, v105, v104, 21

    v_mov_b32 v27, v105
    v_alignbyte_b32 v26, v104, v103, 3
    v_alignbyte_b32 v25, v103, v102, 2
    v_alignbyte_b32 v24, v102, v113, 1
    v_and_b32 v70, 0xfff8, v70
    v_and_b32 v74, 0xfff8, v74
    s_cmp_lt_i32 s42, 2816
    s_cbranch_scc1 L_ufix_63
L_uback_64:

    v_subrev_co_u32 v24, s[80:81], 2.0, v24
    v_subrev_co_u32 v25, s[82:83], 2.0, v25
    v_subrev_co_u32 v26, s[84:85], 2.0, v26
    v_subrev_co_u32 v27, s[86:87], 2.0, v27
    s_mov_b64 exec, s[80:81]
    ds_read_b64 v[68:69], v68
    s_mov_b64 exec, s[82:83]
    ds_read_b64 v[70:71], v70
    s_mov_b64 exec, s[84:85]
    ds_read_b64 v[72:73], v72
    s_mov_b64 exec, s[86:87]
    ds_read_b64 v[74:75], v74
    s_mov_b64 exec, -1
    s_waitcnt vmcnt(2)
    v_lshlrev_b32_sdwa v28, 3, v35 dst_sel:WORD_0 dst_unused:UNUSED_PAD src0_sel:DWORD src1_sel:DWORD
    v_lshrrev_b32 v30, 5, v4
    v_lshlrev_b32_sdwa v32, 3, v5 dst_sel:WORD_0 dst_unused:UNUSED_PAD src0_sel:DWORD src1_sel:WORD_1
    v_alignbit_b32 v34, v7, v6, 21

    v_alignbyte_b32 v6, v6, v5, 3
    v_alignbyte_b32 v5, v5, v4, 2
    v_alignbyte_b32 v4, v4, v35, 1
    v_and_b32 v30, 0xfff8, v30
    v_and_b32 v34, 0xfff8, v34
    s_cmp_lt_i32 s42, 256
    s_cbranch_scc1 L_ufix_65
L_uback_66:

    v_subrev_co_u32 v4, s[64:65], 2.0, v4
    v_subrev_co_u32 v5, s[66:67], 2.0, v5
    v_subrev_co_u32 v6, s[68:69], 2.0, v6
    v_subrev_co_u32 v7, s[70:71], 2.0, v7
    s_mov_b64 exec, s[64:65]
    ds_read_b64 v[28:29], v28
    s_mov_b64 exec, s[66:67]
    ds_read_b64 v[30:31], v30
    s_mov_b64 exec, s[68:69]
    ds_read_b64 v[32:33], v32
    s_mov_b64 exec, s[70:71]
    ds_read_b64 v[34:35], v34
    s_mov_b64 exec, -1
    s_add_u32 s52, s43, 49152
    s_cmp_ge_u32 s25, 4
    s_cbranch_scc1 L_sk3_67
    v_lshlrev_b32 v119, 2, v0
    buffer_load_dword v88, v119, s[12:15], s52 offen
L_sk3_67:
    buffer_load_dwordx4 v[76:79], v3, s[12:15], s43 offen
    s_add_u32 s52, s43, 16384
    buffer_load_dwordx4 v[80:83], v3, s[12:15], s52 offen
    s_add_u32 s52, s43, 32768
    buffer_load_dwordx4 v[84:87], v3, s[12:15], s52 offen
    s_cmp_lg_u32 s25, 0
    s_cbranch_scc1 L_skw_68
    s_add_u32 s54, s43, 50048
    buffer_load_dword v115, v89, s[60:63], s54 offen
    s_add_u32 s54, s50, 0
    buffer_load_dword v115, v89, s[8:11], s54 offen
L_skw_68:
    s_waitcnt vmcnt(3)
    v_lshlrev_b32_sdwa v36, 3, v43 dst_sel:WORD_0 dst_unused:UNUSED_PAD src0_sel:DWORD src1_sel:DWORD
    v_lshrrev_b32 v38, 5, v8
    v_lshlrev_b32_sdwa v40, 3, v9 dst_sel:WORD_0 dst_unused:UNUSED_PAD src0_sel:DWORD src1_sel:WORD_1
    v_alignbit_b32 v42, v11, v10, 21

    v_alignbyte_b32 v10, v10, v9, 3
    v_alignbyte_b32 v9, v9, v8, 2
    v_alignbyte_b32 v8, v8, v43, 1
    v_and_b32 v38, 0xfff8, v38
    v_and_b32 v42, 0xfff8, v42
    s_cmp_lt_i32 s42, 768
    s_cbranch_scc1 L_ufix_69
L_uback_70:

    v_subrev_co_u32 v8, s[72:73], 2.0, v8
    v_subrev_co_u32 v9, s[74:75], 2.0, v9
    v_subrev_co_u32 v10, s[76:77], 2.0, v10
    v_subrev_co_u32 v11, s[78:79], 2.0, v11
    s_mov_b64 exec, s[72:73]
    ds_read_b64 v[36:37], v36
    s_mov_b64 exec, s[74:75]
    ds_read_b64 v[38:39], v38
    s_mov_b64 exec, s[76:77]
    ds_read_b64 v[40:41], v40
    s_mov_b64 exec, s[78:79]
    ds_read_b64 v[42:43], v42
    s_mov_b64 exec, -1
    s_movk_i32 s53, 5120
    buffer_load_dwordx4 v[90:93], v2, s[16:19], s53 offen offset:4
    buffer_load_dword v110, v2, s[16:19], s53 offen
L_batch_72:
    s_add_u32 s5, s38, 1

    s_movk_i32 s53, 7680
    buffer_load_dwordx4 v[94:97], v2, s[16:19], s53 offen offset:4
    buffer_load_dword v111, v2, s[16:19], s53 offen
    v_subrev_co_u32 v4, s[64:65], 2.0, v4
    v_subrev_co_u32 v5, s[66:67], 2.0, v5
    v_subrev_co_u32 v6, s[68:69], 2.0, v6
    v_subrev_co_u32 v7, s[70:71], 2.0, v7
    v_subrev_co_u32 v8, s[72:73], 2.0, v8
    v_subrev_co_u32 v9, s[74:75], 2.0, v9
    v_subrev_co_u32 v10, s[76:77], 2.0, v10
    v_subrev_co_u32 v11, s[78:79], 2.0, v11
    v_subrev_co_u32 v12, s[80:81], 2.0, v12
    v_subrev_co_u32 v13, s[82:83], 2.0, v13
    v_subrev_co_u32 v14, s[84:85], 2.0, v14
    v_subrev_co_u32 v15, s[86:87], 2.0, v15
    s_waitcnt lgkmcnt(0)
    s_barrier
    s_waitcnt vmcnt(4)
    ds_write_addtid_b32 v76 offset:0
    ds_write_addtid_b32 v77 offset:256
    ds_write_addtid_b32 v78 offset:512
    ds_write_addtid_b32 v79 offset:768
    s_waitcnt vmcnt(3)
    ds_write_addtid_b32 v80 offset:16384
    ds_write_addtid_b32 v81 offset:16640
    ds_write_addtid_b32 v82 offset:16896
    ds_write_addtid_b32 v83 offset:17152
    s_waitcnt vmcnt(2)
    ds_write_addtid_b32 v84 offset:32768
    ds_write_addtid_b32 v85 offset:33024
    ds_write_addtid_b32 v86 offset:33280
    ds_write_addtid_b32 v87 offset:33536
    v_lshlrev_b32 v119, 2, v0
    s_waitcnt vmcnt(5)
    s_mov_b64 exec, s[48:49]
    ds_write_b32 v119, v88 offset:49152
    s_mov_b64 exec, -1
    s_add_u32 s43, s43, 50048
    s_add_u32 s14, s43, 50000
    s_min_u32 s14, s14, s41
    s_add_u32 s52, s43, 49152
    s_cmp_ge_u32 s25, 4
    s_cbranch_scc1 L_sk3_78
    v_lshlrev_b32 v119, 2, v0
    buffer_load_dword v88, v119, s[12:15], s52 offen
L_sk3_78:
    buffer_load_dwordx4 v[76:79], v3, s[12:15], s43 offen
    s_waitcnt lgkmcnt(0)
    s_barrier
    s_add_u32 s52, s43, 16384
    buffer_load_dwordx4 v[80:83], v3, s[12:15], s52 offen
    s_add_u32 s52, s43, 32768
    buffer_load_dwordx4 v[84:87], v3, s[12:15], s52 offen
    s_mov_b64 exec, s[64:65]
    ds_read_b64 v[28:29], v28
    s_mov_b64 exec, s[66:67]
    ds_read_b64 v[30:31], v30
    s_mov_b64 exec, s[68:69]
    ds_read_b64 v[32:33], v32
    s_mov_b64 exec, s[70:71]
    ds_read_b64 v[34:35], v34
    s_mov_b64 exec, s[72:73]
    ds_read_b64 v[36:37], v36
    s_mov_b64 exec, s[74:75]
    ds_read_b64 v[38:39], v38
    s_mov_b64 exec, s[76:77]
    ds_read_b64 v[40:41], v40
    s_mov_b64 exec, s[78:79]
    ds_read_b64 v[42:43], v42
    s_mov_b64 exec, s[80:81]
    ds_read_b64 v[44:45], v44
    s_mov_b64 exec, s[82:83]
    ds_read_b64 v[46:47], v46
    s_mov_b64 exec, s[84:85]
    ds_read_b64 v[48:49], v48
    s_mov_b64 exec, s[86:87]
    ds_read_b64 v[50:51], v50
    s_mov_b64 exec, -1
    v_subrev_co_u32 v16, s[64:65], 2.0, v16
    v_subrev_co_u32 v17, s[66:67], 2.0, v17
    v_subrev_co_u32 v18, s[68:69], 2.0, v18
    v_subrev_co_u32 v19, s[70:71], 2.0, v19
    v_subrev_co_u32 v20, s[72:73], 2.0, v20
    v_subrev_co_u32 v21, s[74:75], 2.0, v21
    v_subrev_co_u32 v22, s[76:77], 2.0, v22
    v_subrev_co_u32 v23, s[78:79], 2.0, v23
    v_subrev_co_u32 v24, s[80:81], 2.0, v24
    v_subrev_co_u32 v25, s[82:83], 2.0, v25
    v_subrev_co_u32 v26, s[84:85], 2.0, v26
    v_subrev_co_u32 v27, s[86:87], 2.0, v27
    s_mov_b64 exec, s[64:65]
    ds_read_b64 v[52:53], v52
    s_mov_b64 exec, s[66:67]
    ds_read_b64 v[54:55], v54
    s_mov_b64 exec, s[68:69]
    ds_read_b64 v[56:57], v56
    s_mov_b64 exec, s[70:71]
    ds_read_b64 v[58:59], v58
    s_mov_b64 exec, s[72:73]
    ds_read_b64 v[60:61], v60
    s_mov_b64 exec, s[74:75]
    ds_read_b64 v[62:63], v62
    s_mov_b64 exec, s[76:77]
    ds_read_b64 v[64:65], v64
    s_mov_b64 exec, s[78:79]
    ds_read_b64 v[66:67], v66
    s_mov_b64 exec, s[80:81]
    ds_read_b64 v[68:69], v68
    s_mov_b64 exec, s[82:83]
    ds_read_b64 v[70:71], v70
    s_mov_b64 exec, s[84:85]
    ds_read_b64 v[72:73], v72
    s_mov_b64 exec, s[86:87]
    ds_read_b64 v[74:75], v74
    s_mov_b64 exec, -1
    s_cmp_le_i32 s42, 3072
    s_cbranch_scc1 L_nt1_74
    s_waitcnt vmcnt(10)
    v_lshlrev_b32_sdwa v120, 3, v114 dst_sel:WORD_0 dst_unused:UNUSED_PAD src0_sel:DWORD src1_sel:DWORD
    v_lshrrev_b32 v122, 5, v106
    v_lshlrev_b32_sdwa v124, 3, v107 dst_sel:WORD_0 dst_unused:UNUSED_PAD src0_sel:DWORD src1_sel:WORD_1
    v_alignbit_b32 v126, v109, v108, 21

    v_alignbyte_b32 v108, v108, v107, 3
    v_alignbyte_b32 v107, v107, v106, 2
    v_alignbyte_b32 v106, v106, v114, 1
    v_and_b32 v122, 0xfff8, v122
    v_and_b32 v126, 0xfff8, v126
    s_cmp_lt_i32 s42, 3328
    s_cbranch_scc1 L_ufix_79
L_uback_80:

    v_lshrrev_b32 v117, 30, v106
    v_and_b32 v106, 0x3fffffff, v106
    v_mul_u32_u24 v117, 50000, v117
    v_cmp_ne_u32 vcc, 0, v106
    v_add_u32 v120, v120, v117
    s_mov_b64 exec, vcc

    buffer_load_dwordx2 v[120:121], v120, s[8:11], s50 offen
    s_mov_b64 exec, -1
    v_lshrrev_b32 v117, 30, v107
    v_and_b32 v107, 0x3fffffff, v107
    v_mul_u32_u24 v117, 50000, v117
    v_cmp_ne_u32 vcc, 0, v107
    v_add_u32 v122, v122, v117
    s_mov_b64 exec, vcc

    buffer_load_dwordx2 v[122:123], v122, s[8:11], s50 offen
    s_mov_b64 exec, -1
    v_lshrrev_b32 v117, 30, v108
    v_and_b32 v108, 0x3fffffff, v108
    v_mul_u32_u24 v117, 50000, v117
    v_cmp_ne_u32 vcc, 0, v108
    v_add_u32 v124, v124, v117
    s_mov_b64 exec, vcc

    buffer_load_dwordx2 v[124:125], v124, s[8:11], s50 offen
    s_mov_b64 exec, -1
    v_lshrrev_b32 v117, 30, v109
    v_and_b32 v109, 0x3fffffff, v109
    v_mul_u32_u24 v117, 50000, v117
    v_cmp_ne_u32 vcc, 0, v109
    v_add_u32 v126, v126, v117
    s_mov_b64 exec, vcc

    buffer_load_dwordx2 v[126:127], v126, s[8:11], s50 offen
    s_mov_b64 exec, -1
L_nt1_74:
    v_subrev_co_u32 v4, s[64:65], 2.0, v4
    v_subrev_co_u32 v5, s[66:67], 2.0, v5
    v_subrev_co_u32 v6, s[68:69], 2.0, v6
    v_subrev_co_u32 v7, s[70:71], 2.0, v7
    v_subrev_co_u32 v8, s[72:73], 2.0, v8
    v_subrev_co_u32 v9, s[74:75], 2.0, v9
    v_subrev_co_u32 v10, s[76:77], 2.0, v10
    v_subrev_co_u32 v11, s[78:79], 2.0, v11
    v_subrev_co_u32 v12, s[80:81], 2.0, v12
    v_subrev_co_u32 v13, s[82:83], 2.0, v13
    v_subrev_co_u32 v14, s[84:85], 2.0, v14
    v_subrev_co_u32 v15, s[86:87], 2.0, v15
    s_waitcnt lgkmcnt(0)
    s_barrier
    s_waitcnt vmcnt(2)
    ds_write_addtid_b32 v76 offset:0
    ds_write_addtid_b32 v77 offset:256
    ds_write_addtid_b32 v78 offset:512
    ds_write_addtid_b32 v79 offset:768
    s_waitcnt vmcnt(1)
    ds_write_addtid_b32 v80 offset:16384
    ds_write_addtid_b32 v81 offset:16640
    ds_write_addtid_b32 v82 offset:16896
    ds_write_addtid_b32 v83 offset:17152
    s_waitcnt vmcnt(0)
    ds_write_addtid_b32 v84 offset:32768
    ds_write_addtid_b32 v85 offset:33024
    ds_write_addtid_b32 v86 offset:33280
    ds_write_addtid_b32 v87 offset:33536
    v_lshlrev_b32 v119, 2, v0
    s_waitcnt vmcnt(3)
    s_mov_b64 exec, s[48:49]
    ds_write_b32 v119, v88 offset:49152
    s_mov_b64 exec, -1
    s_add_u32 s43, s43, 50048
    s_add_u32 s14, s43, 50000
    s_min_u32 s14, s14, s41
    s_add_u32 s52, s43, 49152
    s_cmp_ge_u32 s25, 4
    s_cbranch_scc1 L_sk3_81
    v_lshlrev_b32 v119, 2, v0
    buffer_load_dword v88, v119, s[12:15], s52 offen
L_sk3_81:
    buffer_load_dwordx4 v[76:79], v3, s[12:15], s43 offen
    s_waitcnt lgkmcnt(0)
    s_barrier
    s_add_u32 s52, s43, 16384
    buffer_load_dwordx4 v[80:83], v3, s[12:15], s52 offen
    s_add_u32 s52, s43, 32768
    buffer_load_dwordx4 v[84:87], v3, s[12:15], s52 offen
    s_mov_b64 exec, s[64:65]
    ds_read_b64 v[28:29], v28
    s_mov_b64 exec, s[66:67]
    ds_read_b64 v[30:31], v30
    s_mov_b64 exec, s[68:69]
    ds_read_b64 v[32:33], v32
    s_mov_b64 exec, s[70:71]
    ds_read_b64 v[34:35], v34
    s_mov_b64 exec, s[72:73]
    ds_read_b64 v[36:37], v36
    s_mov_b64 exec, s[74:75]
    ds_read_b64 v[38:39], v38
    s_mov_b64 exec, s[76:77]
    ds_read_b64 v[40:41], v40
    s_mov_b64 exec, s[78:79]
    ds_read_b64 v[42:43], v42
    s_mov_b64 exec, s[80:81]
    ds_read_b64 v[44:45], v44
    s_mov_b64 exec, s[82:83]
    ds_read_b64 v[46:47], v46
    s_mov_b64 exec, s[84:85]
    ds_read_b64 v[48:49], v48
    s_mov_b64 exec, s[86:87]
    ds_read_b64 v[50:51], v50
    s_mov_b64 exec, -1
    v_subrev_co_u32 v16, s[64:65], 2.0, v16
    v_subrev_co_u32 v17, s[66:67], 2.0, v17
    v_subrev_co_u32 v18, s[68:69], 2.0, v18
    v_subrev_co_u32 v19, s[70:71], 2.0, v19
    v_subrev_co_u32 v20, s[72:73], 2.0, v20
    v_subrev_co_u32 v21, s[74:75], 2.0, v21
    v_subrev_co_u32 v22, s[76:77], 2.0, v22
    v_subrev_co_u32 v23, s[78:79], 2.0, v23
    v_subrev_co_u32 v24, s[80:81], 2.0, v24
    v_subrev_co_u32 v25, s[82:83], 2.0, v25
    v_subrev_co_u32 v26, s[84:85], 2.0, v26
    v_subrev_co_u32 v27, s[86:87], 2.0, v27
    s_mov_b64 exec, s[64:65]
    ds_read_b64 v[52:53], v52
    s_mov_b64 exec, s[66:67]
    ds_read_b64 v[54:55], v54
    s_mov_b64 exec, s[68:69]
    ds_read_b64 v[56:57], v56
    s_mov_b64 exec, s[70:71]
    ds_read_b64 v[58:59], v58
    s_mov_b64 exec, s[72:73]
    ds_read_b64 v[60:61], v60
    s_mov_b64 exec, s[74:75]
    ds_read_b64 v[62:63], v62
    s_mov_b64 exec, s[76:77]
    ds_read_b64 v[64:65], v64
    s_mov_b64 exec, s[78:79]
    ds_read_b64 v[66:67], v66
    s_mov_b64 exec, s[80:81]
    ds_read_b64 v[68:69], v68
    s_mov_b64 exec, s[82:83]
    ds_read_b64 v[70:71], v70
    s_mov_b64 exec, s[84:85]
    ds_read_b64 v[72:73], v72
    s_mov_b64 exec, s[86:87]
    ds_read_b64 v[74:75], v74
    s_mov_b64 exec, -1
    s_movk_i32 s53, 10240
    buffer_load_dwordx4 v[98:101], v2, s[16:19], s53 offen offset:4
    buffer_load_dword v112, v2, s[16:19], s53 offen
    s_movk_i32 s53, 12800
    buffer_load_dwordx4 v[102:105], v2, s[16:19], s53 offen offset:4
    buffer_load_dword v113, v2, s[16:19], s53 offen
    s_cmp_le_i32 s42, 3072
    s_cbranch_scc1 L_nt2_75
    s_waitcnt vmcnt(7)
    v_cmp_ne_u32 s[56:57], 0, v106
    v_cmp_ne_u32 s[58:59], 0, v107
    v_cmp_ne_u32 s[98:99], 0, v108
    v_cmp_ne_u32 vcc, 0, v109
    s_mov_b64 exec, s[56:57]
    v_cvt_f32_i32_sdwa v118, sext(v106) dst_sel:DWORD dst_unused:UNUSED_PAD src0_sel:WORD_0
    v_lshlrev_b32 v116, 16, v120
    v_and_b32 v117, s32, v120
    v_mul_f32 v118, s33, v118
    v_lshlrev_b32 v120, 16, v121
    v_and_b32 v121, s32, v121
    v_lshlrev_b32_sdwa v106, 3, v106 dst_sel:DWORD dst_unused:UNUSED_PAD src0_sel:DWORD src1_sel:WORD_1
    v_pk_fma_f32 v[116:117], v[116:117], v[118:119], s[28:29] op_sel_hi:[1,0,1]
    v_pk_fma_f32 v[120:121], v[120:121], v[118:119], s[28:29] op_sel_hi:[1,0,1]
    v_perm_b32 v116, v117, v116, s35
    v_perm_b32 v117, v121, v120, s35
    v_lshl_add_u64 v[116:117], v[116:117], 0, s[30:31]
    ds_add_rtn_u64 v[120:121], v106, v[116:117] offset:50000

    s_mov_b64 exec, s[58:59]
    v_cvt_f32_i32_sdwa v118, sext(v107) dst_sel:DWORD dst_unused:UNUSED_PAD src0_sel:WORD_0
    v_lshlrev_b32 v116, 16, v122
    v_and_b32 v117, s32, v122
    v_mul_f32 v118, s33, v118
    v_lshlrev_b32 v122, 16, v123
    v_and_b32 v123, s32, v123
    v_lshlrev_b32_sdwa v107, 3, v107 dst_sel:DWORD dst_unused:UNUSED_PAD src0_sel:DWORD src1_sel:WORD_1
    v_pk_fma_f32 v[116:117], v[116:117], v[118:119], s[28:29] op_sel_hi:[1,0,1]
    v_pk_fma_f32 v[122:123], v[122:123], v[118:119], s[28:29] op_sel_hi:[1,0,1]
    v_perm_b32 v116, v117, v116, s35
    v_perm_b32 v117, v123, v122, s35
    v_lshl_add_u64 v[116:117], v[116:117], 0, s[30:31]
    ds_add_rtn_u64 v[122:123], v107, v[116:117] offset:50000

    s_mov_b64 exec, s[98:99]
    v_cvt_f32_i32_sdwa v118, sext(v108) dst_sel:DWORD dst_unused:UNUSED_PAD src0_sel:WORD_0
    v_lshlrev_b32 v116, 16, v124
    v_and_b32 v117, s32, v124
    v_mul_f32 v118, s33, v118
    v_lshlrev_b32 v124, 16, v125
    v_and_b32 v125, s32, v125
    v_lshlrev_b32_sdwa v108, 3, v108 dst_sel:DWORD dst_unused:UNUSED_PAD src0_sel:DWORD src1_sel:WORD_1
    v_pk_fma_f32 v[116:117], v[116:117], v[118:119], s[28:29] op_sel_hi:[1,0,1]
    v_pk_fma_f32 v[124:125], v[124:125], v[118:119], s[28:29] op_sel_hi:[1,0,1]
    v_perm_b32 v116, v117, v116, s35
    v_perm_b32 v117, v125, v124, s35
    v_lshl_add_u64 v[116:117], v[116:117], 0, s[30:31]
    ds_add_rtn_u64 v[124:125], v108, v[116:117] offset:50000

    s_mov_b64 exec, vcc
    v_cvt_f32_i32_sdwa v118, sext(v109) dst_sel:DWORD dst_unused:UNUSED_PAD src0_sel:WORD_0
    v_lshlrev_b32 v116, 16, v126
    v_and_b32 v117, s32, v126
    v_mul_f32 v118, s33, v118
    v_lshlrev_b32 v126, 16, v127
    v_and_b32 v127, s32, v127
    v_lshlrev_b32_sdwa v109, 3, v109 dst_sel:DWORD dst_unused:UNUSED_PAD src0_sel:DWORD src1_sel:WORD_1
    v_pk_fma_f32 v[116:117], v[116:117], v[118:119], s[28:29] op_sel_hi:[1,0,1]
    v_pk_fma_f32 v[126:127], v[126:127], v[118:119], s[28:29] op_sel_hi:[1,0,1]
    v_perm_b32 v116, v117, v116, s35
    v_perm_b32 v117, v127, v126, s35
    v_lshl_add_u64 v[116:117], v[116:117], 0, s[30:31]
    ds_add_rtn_u64 v[126:127], v109, v[116:117] offset:50000

    s_waitcnt lgkmcnt(0)
    s_mov_b64 exec, s[56:57]
    v_or3_b32 v1, v120, v121, v1
    s_mov_b64 exec, s[58:59]
    v_or3_b32 v1, v122, v123, v1
    s_mov_b64 exec, s[98:99]
    v_or3_b32 v1, v124, v125, v1
    s_mov_b64 exec, vcc
    v_or3_b32 v1, v126, v127, v1
    s_mov_b64 exec, -1
L_nt2_75:
    s_cmp_le_u32 s40, 3584
    s_cbranch_scc1 L_noleft_76
    s_min_u32 s40, s40, 6524
    s_lshl_b32 s52, s38, 6
    s_add_u32 s52, s52, s36
    s_mul_i32 s52, s52, 32764
    s_and_b32 s52, s52, 0xffffff80
    s_add_u32 s20, s44, s52
    s_addc_u32 s21, s45, 0
    s_mul_i32 s52, s40, 5
    s_add_u32 s52, s52, 3
    s_and_b32 s22, s52, -4

    s_lshr_b32 s55, s39, 2
    s_add_u32 s55, s55, 3584
    v_and_b32 v120, 63, v0
    v_add_u32 v120, s55, v120
L_left_84:
    s_cmp_ge_u32 s55, s40
    s_cbranch_scc1 L_leftend_85
    v_mul_u32_u24 v121, 5, v120
    buffer_load_dword v122, v121, s[20:23], 0 offen offset:1
    buffer_load_ubyte v123, v121, s[20:23], 0 offen
    s_waitcnt vmcnt(0)

    v_perm_b32 v121, v123, v122, s24
    v_lshrrev_b32 v126, 30, v122
    v_and_b32 v121, 0x1fff, v121
    v_mul_u32_u24 v126, 6250, v126
    v_add_lshl_u32 v121, v121, v126, 3

    buffer_load_dwordx2 v[124:125], v121, s[8:11], s50 offen
    v_cmp_gt_u32 vcc, s40, v120
    s_waitcnt vmcnt(0)

    s_mov_b64 exec, vcc
    v_and_b32 v122, 0x3fffffff, v122
    v_cvt_f32_i32_sdwa v118, sext(v122) dst_sel:DWORD dst_unused:UNUSED_PAD src0_sel:WORD_0
    v_lshlrev_b32 v116, 16, v124
    v_and_b32 v117, s32, v124
    v_mul_f32 v118, s33, v118
    v_lshlrev_b32 v124, 16, v125
    v_and_b32 v125, s32, v125
    v_lshlrev_b32_sdwa v122, 3, v122 dst_sel:DWORD dst_unused:UNUSED_PAD src0_sel:DWORD src1_sel:WORD_1
    v_pk_fma_f32 v[116:117], v[116:117], v[118:119], s[28:29] op_sel_hi:[1,0,1]
    v_pk_fma_f32 v[124:125], v[124:125], v[118:119], s[28:29] op_sel_hi:[1,0,1]
    v_perm_b32 v116, v117, v116, s35
    v_perm_b32 v117, v125, v124, s35
    v_lshl_add_u64 v[116:117], v[116:117], 0, s[30:31]
    ds_add_rtn_u64 v[124:125], v122, v[116:117] offset:50000

    s_waitcnt lgkmcnt(0)
    v_or3_b32 v1, v124, v125, v1
    s_mov_b64 exec, -1
    v_add_u32 v120, 128, v120
    s_add_u32 s55, s55, 128
    s_branch L_left_84
L_leftend_85:

L_noleft_76:
    v_cmp_gt_u32 s[64:65], 2.0, v4
    v_and_b32 v4, 0x3fffffff, v4
    v_cmp_gt_u32 s[66:67], 2.0, v5
    v_and_b32 v5, 0x3fffffff, v5
    v_cmp_gt_u32 s[68:69], 2.0, v6
    v_and_b32 v6, 0x3fffffff, v6
    v_cmp_gt_u32 s[70:71], 2.0, v7
    v_and_b32 v7, 0x3fffffff, v7
    v_cmp_gt_u32 s[72:73], 2.0, v8
    v_and_b32 v8, 0x3fffffff, v8
    v_cmp_gt_u32 s[74:75], 2.0, v9
    v_and_b32 v9, 0x3fffffff, v9
    v_cmp_gt_u32 s[76:77], 2.0, v10
    v_and_b32 v10, 0x3fffffff, v10
    v_cmp_gt_u32 s[78:79], 2.0, v11
    v_and_b32 v11, 0x3fffffff, v11
    v_cmp_gt_u32 s[80:81], 2.0, v12
    v_and_b32 v12, 0x3fffffff, v12
    v_cmp_gt_u32 s[82:83], 2.0, v13
    v_and_b32 v13, 0x3fffffff, v13
    v_cmp_gt_u32 s[84:85], 2.0, v14
    v_and_b32 v14, 0x3fffffff, v14
    v_cmp_gt_u32 s[86:87], 2.0, v15
    v_and_b32 v15, 0x3fffffff, v15
    s_waitcnt lgkmcnt(0)
    s_barrier
    s_waitcnt vmcnt(6)
    ds_write_addtid_b32 v76 offset:0
    ds_write_addtid_b32 v77 offset:256
    ds_write_addtid_b32 v78 offset:512
    ds_write_addtid_b32 v79 offset:768
    s_waitcnt vmcnt(5)
    ds_write_addtid_b32 v80 offset:16384
    ds_write_addtid_b32 v81 offset:16640
    ds_write_addtid_b32 v82 offset:16896
    ds_write_addtid_b32 v83 offset:17152
    s_waitcnt vmcnt(4)
    ds_write_addtid_b32 v84 offset:32768
    ds_write_addtid_b32 v85 offset:33024
    ds_write_addtid_b32 v86 offset:33280
    ds_write_addtid_b32 v87 offset:33536
    v_lshlrev_b32 v119, 2, v0
    s_waitcnt vmcnt(7)
    s_mov_b64 exec, s[48:49]
    ds_write_b32 v119, v88 offset:49152
    s_mov_b64 exec, -1
    s_add_u32 s43, s43, 50048
    s_add_u32 s14, s43, 50000
    s_min_u32 s14, s14, s41
    s_add_u32 s52, s43, 49152
    s_cmp_ge_u32 s25, 4
    s_cbranch_scc1 L_sk3_86
    v_lshlrev_b32 v119, 2, v0
    buffer_load_dword v88, v119, s[12:15], s52 offen
L_sk3_86:
    buffer_load_dwordx4 v[76:79], v3, s[12:15], s43 offen
    s_waitcnt lgkmcnt(0)
    s_barrier
    s_add_u32 s52, s43, 16384
    buffer_load_dwordx4 v[80:83], v3, s[12:15], s52 offen
    s_add_u32 s52, s43, 32768
    buffer_load_dwordx4 v[84:87], v3, s[12:15], s52 offen
    s_mov_b64 exec, s[64:65]
    ds_read_b64 v[28:29], v28
    s_mov_b64 exec, s[66:67]
    ds_read_b64 v[30:31], v30
    s_mov_b64 exec, s[68:69]
    ds_read_b64 v[32:33], v32
    s_mov_b64 exec, s[70:71]
    ds_read_b64 v[34:35], v34
    s_mov_b64 exec, s[72:73]
    ds_read_b64 v[36:37], v36
    s_mov_b64 exec, s[74:75]
    ds_read_b64 v[38:39], v38
    s_mov_b64 exec, s[76:77]
    ds_read_b64 v[40:41], v40
    s_mov_b64 exec, s[78:79]
    ds_read_b64 v[42:43], v42
    s_mov_b64 exec, s[80:81]
    ds_read_b64 v[44:45], v44
    s_mov_b64 exec, s[82:83]
    ds_read_b64 v[46:47], v46
    s_mov_b64 exec, s[84:85]
    ds_read_b64 v[48:49], v48
    s_mov_b64 exec, s[86:87]
    ds_read_b64 v[50:51], v50
    s_mov_b64 exec, -1
    v_cmp_gt_u32 s[64:65], 2.0, v16
    v_and_b32 v16, 0x3fffffff, v16
    v_cmp_gt_u32 s[66:67], 2.0, v17
    v_and_b32 v17, 0x3fffffff, v17
    v_cmp_gt_u32 s[68:69], 2.0, v18
    v_and_b32 v18, 0x3fffffff, v18
    v_cmp_gt_u32 s[70:71], 2.0, v19
    v_and_b32 v19, 0x3fffffff, v19
    v_cmp_gt_u32 s[72:73], 2.0, v20
    v_and_b32 v20, 0x3fffffff, v20
    v_cmp_gt_u32 s[74:75], 2.0, v21
    v_and_b32 v21, 0x3fffffff, v21
    v_cmp_gt_u32 s[76:77], 2.0, v22
    v_and_b32 v22, 0x3fffffff, v22
    v_cmp_gt_u32 s[78:79], 2.0, v23
    v_and_b32 v23, 0x3fffffff, v23
    v_cmp_gt_u32 s[80:81], 2.0, v24
    v_and_b32 v24, 0x3fffffff, v24
    v_cmp_gt_u32 s[82:83], 2.0, v25
    v_and_b32 v25, 0x3fffffff, v25
    v_cmp_gt_u32 s[84:85], 2.0, v26
    v_and_b32 v26, 0x3fffffff, v26
    v_cmp_gt_u32 s[86:87], 2.0, v27
    v_and_b32 v27, 0x3fffffff, v27
    s_mov_b64 exec, s[64:65]
    ds_read_b64 v[52:53], v52
    s_mov_b64 exec, s[66:67]
    ds_read_b64 v[54:55], v54
    s_mov_b64 exec, s[68:69]
    ds_read_b64 v[56:57], v56
    s_mov_b64 exec, s[70:71]
    ds_read_b64 v[58:59], v58
    s_mov_b64 exec, s[72:73]
    ds_read_b64 v[60:61], v60
    s_mov_b64 exec, s[74:75]
    ds_read_b64 v[62:63], v62
    s_mov_b64 exec, s[76:77]
    ds_read_b64 v[64:65], v64
    s_mov_b64 exec, s[78:79]
    ds_read_b64 v[66:67], v66
    s_mov_b64 exec, s[80:81]
    ds_read_b64 v[68:69], v68
    s_mov_b64 exec, s[82:83]
    ds_read_b64 v[70:71], v70
    s_mov_b64 exec, s[84:85]
    ds_read_b64 v[72:73], v72
    s_mov_b64 exec, s[86:87]
    ds_read_b64 v[74:75], v74
    s_mov_b64 exec, -1
    s_cmp_ge_u32 s5, s4
    s_cbranch_scc1 L_bend_73
    s_waitcnt lgkmcnt(15)
    v_mad_i32_i16 v120, v28, v4, s96
    v_mad_i32_i16 v28, v28, v4, s96 op_sel:[1,0,0,0]
    v_mad_i32_i16 v121, v29, v4, s96
    v_mad_i32_i16 v29, v29, v4, s96 op_sel:[1,0,0,0]
    v_lshlrev_b32_sdwa v4, 3, v4 dst_sel:DWORD dst_unused:UNUSED_PAD src0_sel:DWORD src1_sel:WORD_1
    v_perm_b32 v28, v28, v120, s97
    v_perm_b32 v29, v29, v121, s97
    v_lshl_add_u64 v[28:29], v[28:29], 0, s[30:31]

    ds_add_rtn_u64 v[28:29], v4, v[28:29] offset:50000
    v_mad_i32_i16 v122, v30, v5, s96
    v_mad_i32_i16 v30, v30, v5, s96 op_sel:[1,0,0,0]
    v_mad_i32_i16 v123, v31, v5, s96
    v_mad_i32_i16 v31, v31, v5, s96 op_sel:[1,0,0,0]
    v_lshlrev_b32_sdwa v5, 3, v5 dst_sel:DWORD dst_unused:UNUSED_PAD src0_sel:DWORD src1_sel:WORD_1
    v_perm_b32 v30, v30, v122, s97
    v_perm_b32 v31, v31, v123, s97
    v_lshl_add_u64 v[30:31], v[30:31], 0, s[30:31]

    ds_add_rtn_u64 v[30:31], v5, v[30:31] offset:50000
    v_mad_i32_i16 v124, v32, v6, s96
    v_mad_i32_i16 v32, v32, v6, s96 op_sel:[1,0,0,0]
    v_mad_i32_i16 v125, v33, v6, s96
    v_mad_i32_i16 v33, v33, v6, s96 op_sel:[1,0,0,0]
    v_lshlrev_b32_sdwa v6, 3, v6 dst_sel:DWORD dst_unused:UNUSED_PAD src0_sel:DWORD src1_sel:WORD_1
    v_perm_b32 v32, v32, v124, s97
    v_perm_b32 v33, v33, v125, s97
    v_lshl_add_u64 v[32:33], v[32:33], 0, s[30:31]

    ds_add_rtn_u64 v[32:33], v6, v[32:33] offset:50000
    v_mad_i32_i16 v126, v34, v7, s96
    v_mad_i32_i16 v34, v34, v7, s96 op_sel:[1,0,0,0]
    v_mad_i32_i16 v127, v35, v7, s96
    v_mad_i32_i16 v35, v35, v7, s96 op_sel:[1,0,0,0]
    v_lshlrev_b32_sdwa v7, 3, v7 dst_sel:DWORD dst_unused:UNUSED_PAD src0_sel:DWORD src1_sel:WORD_1
    v_perm_b32 v34, v34, v126, s97
    v_perm_b32 v35, v35, v127, s97
    v_lshl_add_u64 v[34:35], v[34:35], 0, s[30:31]

    ds_add_rtn_u64 v[34:35], v7, v[34:35] offset:50000
    s_sub_u32 s53, s88, s39
    s_cmp_le_i32 s53, 3072
    s_cbranch_scc1 L_skt_87
    s_movk_i32 s53, 15360
    buffer_load_dwordx4 v[106:109], v2, s[16:19], s53 offen offset:4
    buffer_load_dword v114, v2, s[16:19], s53 offen
L_skt_87:
    v_mad_i32_i16 v120, v36, v8, s96
    v_mad_i32_i16 v36, v36, v8, s96 op_sel:[1,0,0,0]
    v_mad_i32_i16 v121, v37, v8, s96
    v_mad_i32_i16 v37, v37, v8, s96 op_sel:[1,0,0,0]
    v_lshlrev_b32_sdwa v8, 3, v8 dst_sel:DWORD dst_unused:UNUSED_PAD src0_sel:DWORD src1_sel:WORD_1
    v_perm_b32 v36, v36, v120, s97
    v_perm_b32 v37, v37, v121, s97
    v_lshl_add_u64 v[36:37], v[36:37], 0, s[30:31]

    ds_add_rtn_u64 v[36:37], v8, v[36:37] offset:50000
    v_mad_i32_i16 v122, v38, v9, s96
    v_mad_i32_i16 v38, v38, v9, s96 op_sel:[1,0,0,0]
    v_mad_i32_i16 v123, v39, v9, s96
    v_mad_i32_i16 v39, v39, v9, s96 op_sel:[1,0,0,0]
    v_lshlrev_b32_sdwa v9, 3, v9 dst_sel:DWORD dst_unused:UNUSED_PAD src0_sel:DWORD src1_sel:WORD_1
    v_perm_b32 v38, v38, v122, s97
    v_perm_b32 v39, v39, v123, s97
    v_lshl_add_u64 v[38:39], v[38:39], 0, s[30:31]

    ds_add_rtn_u64 v[38:39], v9, v[38:39] offset:50000
    v_mad_i32_i16 v124, v40, v10, s96
    v_mad_i32_i16 v40, v40, v10, s96 op_sel:[1,0,0,0]
    v_mad_i32_i16 v125, v41, v10, s96
    v_mad_i32_i16 v41, v41, v10, s96 op_sel:[1,0,0,0]
    v_lshlrev_b32_sdwa v10, 3, v10 dst_sel:DWORD dst_unused:UNUSED_PAD src0_sel:DWORD src1_sel:WORD_1
    v_perm_b32 v40, v40, v124, s97
    v_perm_b32 v41, v41, v125, s97
    v_lshl_add_u64 v[40:41], v[40:41], 0, s[30:31]

    ds_add_rtn_u64 v[40:41], v10, v[40:41] offset:50000
    v_mad_i32_i16 v126, v42, v11, s96
    v_mad_i32_i16 v42, v42, v11, s96 op_sel:[1,0,0,0]
    v_mad_i32_i16 v127, v43, v11, s96
    v_mad_i32_i16 v43, v43, v11, s96 op_sel:[1,0,0,0]
    v_lshlrev_b32_sdwa v11, 3, v11 dst_sel:DWORD dst_unused:UNUSED_PAD src0_sel:DWORD src1_sel:WORD_1
    v_perm_b32 v42, v42, v126, s97
    v_perm_b32 v43, v43, v127, s97
    v_lshl_add_u64 v[42:43], v[42:43], 0, s[30:31]

    ds_add_rtn_u64 v[42:43], v11, v[42:43] offset:50000
    s_waitcnt lgkmcnt(4)
    v_or3_b32 v1, v28, v29, v1
    v_or3_b32 v1, v30, v31, v1
    v_or3_b32 v1, v32, v33, v1
    v_or3_b32 v1, v34, v35, v1
    s_movk_i32 s53, 0
    buffer_load_dwordx4 v[4:7], v2, s[16:19], s53 offen offset:4 nt
    buffer_load_dword v35, v2, s[16:19], s53 offen nt
    v_mad_i32_i16 v120, v44, v12, s96
    v_mad_i32_i16 v44, v44, v12, s96 op_sel:[1,0,0,0]
    v_mad_i32_i16 v121, v45, v12, s96
    v_mad_i32_i16 v45, v45, v12, s96 op_sel:[1,0,0,0]
    v_lshlrev_b32_sdwa v12, 3, v12 dst_sel:DWORD dst_unused:UNUSED_PAD src0_sel:DWORD src1_sel:WORD_1
    v_perm_b32 v44, v44, v120, s97
    v_perm_b32 v45, v45, v121, s97
    v_lshl_add_u64 v[44:45], v[44:45], 0, s[30:31]

    ds_add_rtn_u64 v[44:45], v12, v[44:45] offset:50000
    v_mad_i32_i16 v122, v46, v13, s96
    v_mad_i32_i16 v46, v46, v13, s96 op_sel:[1,0,0,0]
    v_mad_i32_i16 v123, v47, v13, s96
    v_mad_i32_i16 v47, v47, v13, s96 op_sel:[1,0,0,0]
    v_lshlrev_b32_sdwa v13, 3, v13 dst_sel:DWORD dst_unused:UNUSED_PAD src0_sel:DWORD src1_sel:WORD_1
    v_perm_b32 v46, v46, v122, s97
    v_perm_b32 v47, v47, v123, s97
    v_lshl_add_u64 v[46:47], v[46:47], 0, s[30:31]

    ds_add_rtn_u64 v[46:47], v13, v[46:47] offset:50000
    v_mad_i32_i16 v124, v48, v14, s96
    v_mad_i32_i16 v48, v48, v14, s96 op_sel:[1,0,0,0]
    v_mad_i32_i16 v125, v49, v14, s96
    v_mad_i32_i16 v49, v49, v14, s96 op_sel:[1,0,0,0]
    v_lshlrev_b32_sdwa v14, 3, v14 dst_sel:DWORD dst_unused:UNUSED_PAD src0_sel:DWORD src1_sel:WORD_1
    v_perm_b32 v48, v48, v124, s97
    v_perm_b32 v49, v49, v125, s97
    v_lshl_add_u64 v[48:49], v[48:49], 0, s[30:31]

    ds_add_rtn_u64 v[48:49], v14, v[48:49] offset:50000
    v_mad_i32_i16 v126, v50, v15, s96
    v_mad_i32_i16 v50, v50, v15, s96 op_sel:[1,0,0,0]
    v_mad_i32_i16 v127, v51, v15, s96
    v_mad_i32_i16 v51, v51, v15, s96 op_sel:[1,0,0,0]
    v_lshlrev_b32_sdwa v15, 3, v15 dst_sel:DWORD dst_unused:UNUSED_PAD src0_sel:DWORD src1_sel:WORD_1
    v_perm_b32 v50, v50, v126, s97
    v_perm_b32 v51, v51, v127, s97
    v_lshl_add_u64 v[50:51], v[50:51], 0, s[30:31]

    ds_add_rtn_u64 v[50:51], v15, v[50:51] offset:50000
    s_waitcnt lgkmcnt(4)
    v_or3_b32 v1, v36, v37, v1
    v_or3_b32 v1, v38, v39, v1
    v_or3_b32 v1, v40, v41, v1
    v_or3_b32 v1, v42, v43, v1
    s_movk_i32 s53, 2560
    buffer_load_dwordx4 v[8:11], v2, s[16:19], s53 offen offset:4
    buffer_load_dword v43, v2, s[16:19], s53 offen
    s_barrier
    s_waitcnt vmcnt(6)
    ds_write_addtid_b32 v76 offset:0
    ds_write_addtid_b32 v77 offset:256
    ds_write_addtid_b32 v78 offset:512
    ds_write_addtid_b32 v79 offset:768
    s_waitcnt vmcnt(5)
    ds_write_addtid_b32 v80 offset:16384
    ds_write_addtid_b32 v81 offset:16640
    ds_write_addtid_b32 v82 offset:16896
    ds_write_addtid_b32 v83 offset:17152
    s_waitcnt vmcnt(4)
    ds_write_addtid_b32 v84 offset:32768
    ds_write_addtid_b32 v85 offset:33024
    ds_write_addtid_b32 v86 offset:33280
    ds_write_addtid_b32 v87 offset:33536
    v_lshlrev_b32 v119, 2, v0
    s_waitcnt vmcnt(7)
    s_mov_b64 exec, s[48:49]
    ds_write_b32 v119, v88 offset:49152
    s_mov_b64 exec, -1
    s_add_u32 s43, s43, 50048
    s_add_u32 s14, s43, 50000
    s_min_u32 s14, s14, s41
    s_mov_b32 s40, s88
    s_sub_u32 s42, s40, s39

    s_add_u32 s55, s38, 2
    s_min_u32 s55, s55, 31
    s_mov_b32 s88, s89
    s_mov_b32 s89, s90
    s_mov_b32 s90, s91
    s_mov_b32 s91, s92
    s_mov_b32 s92, s93
    s_mov_b32 s93, s94
    s_mov_b32 s94, s95
    s_mov_b32 s95, 0
    s_min_u32 s88, s88, 6524
    s_lshl_b32 s52, s55, 6
    s_add_u32 s52, s52, s36
    s_mul_i32 s52, s52, 32764
    s_and_b32 s52, s52, 0xffffff80
    s_add_u32 s16, s44, s52
    s_addc_u32 s17, s45, 0
    s_mul_i32 s52, s88, 5
    s_add_u32 s52, s52, 3
    s_and_b32 s18, s52, -4

    v_mad_i32_i16 v120, v52, v16, s96
    v_mad_i32_i16 v52, v52, v16, s96 op_sel:[1,0,0,0]
    v_mad_i32_i16 v121, v53, v16, s96
    v_mad_i32_i16 v53, v53, v16, s96 op_sel:[1,0,0,0]
    v_lshlrev_b32_sdwa v16, 3, v16 dst_sel:DWORD dst_unused:UNUSED_PAD src0_sel:DWORD src1_sel:WORD_1
    v_perm_b32 v52, v52, v120, s97
    v_perm_b32 v53, v53, v121, s97
    v_lshl_add_u64 v[52:53], v[52:53], 0, s[30:31]

    ds_add_rtn_u64 v[52:53], v16, v[52:53] offset:50000
    v_mad_i32_i16 v122, v54, v17, s96
    v_mad_i32_i16 v54, v54, v17, s96 op_sel:[1,0,0,0]
    v_mad_i32_i16 v123, v55, v17, s96
    v_mad_i32_i16 v55, v55, v17, s96 op_sel:[1,0,0,0]
    v_lshlrev_b32_sdwa v17, 3, v17 dst_sel:DWORD dst_unused:UNUSED_PAD src0_sel:DWORD src1_sel:WORD_1
    v_perm_b32 v54, v54, v122, s97
    v_perm_b32 v55, v55, v123, s97
    v_lshl_add_u64 v[54:55], v[54:55], 0, s[30:31]

    ds_add_rtn_u64 v[54:55], v17, v[54:55] offset:50000
    v_mad_i32_i16 v124, v56, v18, s96
    v_mad_i32_i16 v56, v56, v18, s96 op_sel:[1,0,0,0]
    v_mad_i32_i16 v125, v57, v18, s96
    v_mad_i32_i16 v57, v57, v18, s96 op_sel:[1,0,0,0]
    v_lshlrev_b32_sdwa v18, 3, v18 dst_sel:DWORD dst_unused:UNUSED_PAD src0_sel:DWORD src1_sel:WORD_1
    v_perm_b32 v56, v56, v124, s97
    v_perm_b32 v57, v57, v125, s97
    v_lshl_add_u64 v[56:57], v[56:57], 0, s[30:31]

    ds_add_rtn_u64 v[56:57], v18, v[56:57] offset:50000
    v_mad_i32_i16 v126, v58, v19, s96
    v_mad_i32_i16 v58, v58, v19, s96 op_sel:[1,0,0,0]
    v_mad_i32_i16 v127, v59, v19, s96
    v_mad_i32_i16 v59, v59, v19, s96 op_sel:[1,0,0,0]
    v_lshlrev_b32_sdwa v19, 3, v19 dst_sel:DWORD dst_unused:UNUSED_PAD src0_sel:DWORD src1_sel:WORD_1
    v_perm_b32 v58, v58, v126, s97
    v_perm_b32 v59, v59, v127, s97
    v_lshl_add_u64 v[58:59], v[58:59], 0, s[30:31]

    ds_add_rtn_u64 v[58:59], v19, v[58:59] offset:50000
    s_waitcnt lgkmcnt(15)
    v_or3_b32 v1, v44, v45, v1
    v_or3_b32 v1, v46, v47, v1
    v_or3_b32 v1, v48, v49, v1
    v_or3_b32 v1, v50, v51, v1
    s_waitcnt vmcnt(19)
    v_lshlrev_b32_sdwa v44, 3, v110 dst_sel:WORD_0 dst_unused:UNUSED_PAD src0_sel:DWORD src1_sel:DWORD
    v_lshrrev_b32 v46, 5, v90
    v_lshlrev_b32_sdwa v48, 3, v91 dst_sel:WORD_0 dst_unused:UNUSED_PAD src0_sel:DWORD src1_sel:WORD_1
    v_alignbit_b32 v50, v93, v92, 21

    v_mov_b32 v15, v93
    v_alignbyte_b32 v14, v92, v91, 3
    v_alignbyte_b32 v13, v91, v90, 2
    v_alignbyte_b32 v12, v90, v110, 1
    v_and_b32 v46, 0xfff8, v46
    v_and_b32 v50, 0xfff8, v50
    s_cmp_lt_i32 s42, 1280
    s_cbranch_scc1 L_ufix_90
L_uback_91:

    s_movk_i32 s53, 5120
    buffer_load_dwordx4 v[90:93], v2, s[16:19], s53 offen offset:4
    buffer_load_dword v110, v2, s[16:19], s53 offen
    s_waitcnt lgkmcnt(4)
    s_barrier
    v_subrev_co_u32 v12, s[80:81], 2.0, v12
    v_subrev_co_u32 v13, s[82:83], 2.0, v13
    v_subrev_co_u32 v14, s[84:85], 2.0, v14
    v_subrev_co_u32 v15, s[86:87], 2.0, v15
    s_mov_b64 exec, s[80:81]
    ds_read_b64 v[44:45], v44
    s_mov_b64 exec, s[82:83]
    ds_read_b64 v[46:47], v46
    s_mov_b64 exec, s[84:85]
    ds_read_b64 v[48:49], v48
    s_mov_b64 exec, s[86:87]
    ds_read_b64 v[50:51], v50
    s_mov_b64 exec, -1
    v_mad_i32_i16 v120, v60, v20, s96
    v_mad_i32_i16 v60, v60, v20, s96 op_sel:[1,0,0,0]
    v_mad_i32_i16 v121, v61, v20, s96
    v_mad_i32_i16 v61, v61, v20, s96 op_sel:[1,0,0,0]
    v_lshlrev_b32_sdwa v20, 3, v20 dst_sel:DWORD dst_unused:UNUSED_PAD src0_sel:DWORD src1_sel:WORD_1
    v_perm_b32 v60, v60, v120, s97
    v_perm_b32 v61, v61, v121, s97
    v_lshl_add_u64 v[60:61], v[60:61], 0, s[30:31]

    ds_add_rtn_u64 v[60:61], v20, v[60:61] offset:50000
    v_mad_i32_i16 v122, v62, v21, s96
    v_mad_i32_i16 v62, v62, v21, s96 op_sel:[1,0,0,0]
    v_mad_i32_i16 v123, v63, v21, s96
    v_mad_i32_i16 v63, v63, v21, s96 op_sel:[1,0,0,0]
    v_lshlrev_b32_sdwa v21, 3, v21 dst_sel:DWORD dst_unused:UNUSED_PAD src0_sel:DWORD src1_sel:WORD_1
    v_perm_b32 v62, v62, v122, s97
    v_perm_b32 v63, v63, v123, s97
    v_lshl_add_u64 v[62:63], v[62:63], 0, s[30:31]

    ds_add_rtn_u64 v[62:63], v21, v[62:63] offset:50000
    v_mad_i32_i16 v124, v64, v22, s96
    v_mad_i32_i16 v64, v64, v22, s96 op_sel:[1,0,0,0]
    v_mad_i32_i16 v125, v65, v22, s96
    v_mad_i32_i16 v65, v65, v22, s96 op_sel:[1,0,0,0]
    v_lshlrev_b32_sdwa v22, 3, v22 dst_sel:DWORD dst_unused:UNUSED_PAD src0_sel:DWORD src1_sel:WORD_1
    v_perm_b32 v64, v64, v124, s97
    v_perm_b32 v65, v65, v125, s97
    v_lshl_add_u64 v[64:65], v[64:65], 0, s[30:31]

    ds_add_rtn_u64 v[64:65], v22, v[64:65] offset:50000
    v_mad_i32_i16 v126, v66, v23, s96
    v_mad_i32_i16 v66, v66, v23, s96 op_sel:[1,0,0,0]
    v_mad_i32_i16 v127, v67, v23, s96
    v_mad_i32_i16 v67, v67, v23, s96 op_sel:[1,0,0,0]
    v_lshlrev_b32_sdwa v23, 3, v23 dst_sel:DWORD dst_unused:UNUSED_PAD src0_sel:DWORD src1_sel:WORD_1
    v_perm_b32 v66, v66, v126, s97
    v_perm_b32 v67, v67, v127, s97
    v_lshl_add_u64 v[66:67], v[66:67], 0, s[30:31]

    ds_add_rtn_u64 v[66:67], v23, v[66:67] offset:50000
    s_waitcnt lgkmcnt(8)
    v_or3_b32 v1, v52, v53, v1
    v_or3_b32 v1, v54, v55, v1
    v_or3_b32 v1, v56, v57, v1
    v_or3_b32 v1, v58, v59, v1
    s_waitcnt vmcnt(19)
    v_lshlrev_b32_sdwa v52, 3, v111 dst_sel:WORD_0 dst_unused:UNUSED_PAD src0_sel:DWORD src1_sel:DWORD
    v_lshrrev_b32 v54, 5, v94
    v_lshlrev_b32_sdwa v56, 3, v95 dst_sel:WORD_0 dst_unused:UNUSED_PAD src0_sel:DWORD src1_sel:WORD_1
    v_alignbit_b32 v58, v97, v96, 21

    v_mov_b32 v19, v97
    v_alignbyte_b32 v18, v96, v95, 3
    v_alignbyte_b32 v17, v95, v94, 2
    v_alignbyte_b32 v16, v94, v111, 1
    v_and_b32 v54, 0xfff8, v54
    v_and_b32 v58, 0xfff8, v58
    s_cmp_lt_i32 s42, 1792
    s_cbranch_scc1 L_ufix_93
L_uback_94:

    v_subrev_co_u32 v16, s[64:65], 2.0, v16
    v_subrev_co_u32 v17, s[66:67], 2.0, v17
    v_subrev_co_u32 v18, s[68:69], 2.0, v18
    v_subrev_co_u32 v19, s[70:71], 2.0, v19
    s_mov_b64 exec, s[64:65]
    ds_read_b64 v[52:53], v52
    s_mov_b64 exec, s[66:67]
    ds_read_b64 v[54:55], v54
    s_mov_b64 exec, s[68:69]
    ds_read_b64 v[56:57], v56
    s_mov_b64 exec, s[70:71]
    ds_read_b64 v[58:59], v58
    s_mov_b64 exec, -1
    v_mad_i32_i16 v120, v68, v24, s96
    v_mad_i32_i16 v68, v68, v24, s96 op_sel:[1,0,0,0]
    v_mad_i32_i16 v121, v69, v24, s96
    v_mad_i32_i16 v69, v69, v24, s96 op_sel:[1,0,0,0]
    v_lshlrev_b32_sdwa v24, 3, v24 dst_sel:DWORD dst_unused:UNUSED_PAD src0_sel:DWORD src1_sel:WORD_1
    v_perm_b32 v68, v68, v120, s97
    v_perm_b32 v69, v69, v121, s97
    v_lshl_add_u64 v[68:69], v[68:69], 0, s[30:31]

    ds_add_rtn_u64 v[68:69], v24, v[68:69] offset:50000
    v_mad_i32_i16 v122, v70, v25, s96
    v_mad_i32_i16 v70, v70, v25, s96 op_sel:[1,0,0,0]
    v_mad_i32_i16 v123, v71, v25, s96
    v_mad_i32_i16 v71, v71, v25, s96 op_sel:[1,0,0,0]
    v_lshlrev_b32_sdwa v25, 3, v25 dst_sel:DWORD dst_unused:UNUSED_PAD src0_sel:DWORD src1_sel:WORD_1
    v_perm_b32 v70, v70, v122, s97
    v_perm_b32 v71, v71, v123, s97
    v_lshl_add_u64 v[70:71], v[70:71], 0, s[30:31]

    ds_add_rtn_u64 v[70:71], v25, v[70:71] offset:50000
    v_mad_i32_i16 v124, v72, v26, s96
    v_mad_i32_i16 v72, v72, v26, s96 op_sel:[1,0,0,0]
    v_mad_i32_i16 v125, v73, v26, s96
    v_mad_i32_i16 v73, v73, v26, s96 op_sel:[1,0,0,0]
    v_lshlrev_b32_sdwa v26, 3, v26 dst_sel:DWORD dst_unused:UNUSED_PAD src0_sel:DWORD src1_sel:WORD_1
    v_perm_b32 v72, v72, v124, s97
    v_perm_b32 v73, v73, v125, s97
    v_lshl_add_u64 v[72:73], v[72:73], 0, s[30:31]

    ds_add_rtn_u64 v[72:73], v26, v[72:73] offset:50000
    v_mad_i32_i16 v126, v74, v27, s96
    v_mad_i32_i16 v74, v74, v27, s96 op_sel:[1,0,0,0]
    v_mad_i32_i16 v127, v75, v27, s96
    v_mad_i32_i16 v75, v75, v27, s96 op_sel:[1,0,0,0]
    v_lshlrev_b32_sdwa v27, 3, v27 dst_sel:DWORD dst_unused:UNUSED_PAD src0_sel:DWORD src1_sel:WORD_1
    v_perm_b32 v74, v74, v126, s97
    v_perm_b32 v75, v75, v127, s97
    v_lshl_add_u64 v[74:75], v[74:75], 0, s[30:31]

    ds_add_rtn_u64 v[74:75], v27, v[74:75] offset:50000
    s_waitcnt lgkmcnt(8)
    v_or3_b32 v1, v60, v61, v1
    v_or3_b32 v1, v62, v63, v1
    v_or3_b32 v1, v64, v65, v1
    v_or3_b32 v1, v66, v67, v1
    s_waitcnt vmcnt(11)
    v_lshlrev_b32_sdwa v60, 3, v112 dst_sel:WORD_0 dst_unused:UNUSED_PAD src0_sel:DWORD src1_sel:DWORD
    v_lshrrev_b32 v62, 5, v98
    v_lshlrev_b32_sdwa v64, 3, v99 dst_sel:WORD_0 dst_unused:UNUSED_PAD src0_sel:DWORD src1_sel:WORD_1
    v_alignbit_b32 v66, v101, v100, 21

    v_mov_b32 v23, v101
    v_alignbyte_b32 v22, v100, v99, 3
    v_alignbyte_b32 v21, v99, v98, 2
    v_alignbyte_b32 v20, v98, v112, 1
    v_and_b32 v62, 0xfff8, v62
    v_and_b32 v66, 0xfff8, v66
    s_cmp_lt_i32 s42, 2304
    s_cbranch_scc1 L_ufix_95
L_uback_96:

    v_subrev_co_u32 v20, s[72:73], 2.0, v20
    v_subrev_co_u32 v21, s[74:75], 2.0, v21
    v_subrev_co_u32 v22, s[76:77], 2.0, v22
    v_subrev_co_u32 v23, s[78:79], 2.0, v23
    s_mov_b64 exec, s[72:73]
    ds_read_b64 v[60:61], v60
    s_mov_b64 exec, s[74:75]
    ds_read_b64 v[62:63], v62
    s_mov_b64 exec, s[76:77]
    ds_read_b64 v[64:65], v64
    s_mov_b64 exec, s[78:79]
    ds_read_b64 v[66:67], v66
    s_mov_b64 exec, -1
    s_waitcnt lgkmcnt(4)
    v_or3_b32 v1, v68, v69, v1
    v_or3_b32 v1, v70, v71, v1
    v_or3_b32 v1, v72, v73, v1
    v_or3_b32 v1, v74, v75, v1
    s_waitcnt vmcnt(9)
    v_lshlrev_b32_sdwa v68, 3, v113 dst_sel:WORD_0 dst_unused:UNUSED_PAD src0_sel:DWORD src1_sel:DWORD
    v_lshrrev_b32 v70, 5, v102
    v_lshlrev_b32_sdwa v72, 3, v103 dst_sel:WORD_0 dst_unused:UNUSED_PAD src0_sel:DWORD src1_sel:WORD_1
    v_alignbit_b32 v74, v105, v104, 21

    v_mov_b32 v27, v105
    v_alignbyte_b32 v26, v104, v103, 3
    v_alignbyte_b32 v25, v103, v102, 2
    v_alignbyte_b32 v24, v102, v113, 1
    v_and_b32 v70, 0xfff8, v70
    v_and_b32 v74, 0xfff8, v74
    s_cmp_lt_i32 s42, 2816
    s_cbranch_scc1 L_ufix_97
L_uback_98:

    v_subrev_co_u32 v24, s[80:81], 2.0, v24
    v_subrev_co_u32 v25, s[82:83], 2.0, v25
    v_subrev_co_u32 v26, s[84:85], 2.0, v26
    v_subrev_co_u32 v27, s[86:87], 2.0, v27
    s_mov_b64 exec, s[80:81]
    ds_read_b64 v[68:69], v68
    s_mov_b64 exec, s[82:83]
    ds_read_b64 v[70:71], v70
    s_mov_b64 exec, s[84:85]
    ds_read_b64 v[72:73], v72
    s_mov_b64 exec, s[86:87]
    ds_read_b64 v[74:75], v74
    s_mov_b64 exec, -1
    s_add_u32 s52, s43, 49152
    s_cmp_ge_u32 s25, 4
    s_cbranch_scc1 L_sk3_99
    v_lshlrev_b32 v119, 2, v0
    buffer_load_dword v88, v119, s[12:15], s52 offen
L_sk3_99:
    buffer_load_dwordx4 v[76:79], v3, s[12:15], s43 offen
    s_add_u32 s52, s43, 16384
    buffer_load_dwordx4 v[80:83], v3, s[12:15], s52 offen
    s_add_u32 s52, s43, 32768
    buffer_load_dwordx4 v[84:87], v3, s[12:15], s52 offen
    s_cmp_lg_u32 s25, 0
    s_cbranch_scc1 L_skw_100
    s_add_u32 s54, s43, 50048
    buffer_load_dword v115, v89, s[60:63], s54 offen
    s_add_u32 s54, s50, 200000
    buffer_load_dword v115, v89, s[8:11], s54 offen
L_skw_100:
    s_waitcnt vmcnt(7)
    v_lshlrev_b32_sdwa v28, 3, v35 dst_sel:WORD_0 dst_unused:UNUSED_PAD src0_sel:DWORD src1_sel:DWORD
    v_lshrrev_b32 v30, 5, v4
    v_lshlrev_b32_sdwa v32, 3, v5 dst_sel:WORD_0 dst_unused:UNUSED_PAD src0_sel:DWORD src1_sel:WORD_1
    v_alignbit_b32 v34, v7, v6, 21

    v_alignbyte_b32 v6, v6, v5, 3
    v_alignbyte_b32 v5, v5, v4, 2
    v_alignbyte_b32 v4, v4, v35, 1
    v_and_b32 v30, 0xfff8, v30
    v_and_b32 v34, 0xfff8, v34
    s_cmp_lt_i32 s42, 256
    s_cbranch_scc1 L_ufix_101
L_uback_102:

    v_subrev_co_u32 v4, s[64:65], 2.0, v4
    v_subrev_co_u32 v5, s[66:67], 2.0, v5
    v_subrev_co_u32 v6, s[68:69], 2.0, v6
    v_subrev_co_u32 v7, s[70:71], 2.0, v7
    s_mov_b64 exec, s[64:65]
    ds_read_b64 v[28:29], v28
    s_mov_b64 exec, s[66:67]
    ds_read_b64 v[30:31], v30
    s_mov_b64 exec, s[68:69]
    ds_read_b64 v[32:33], v32
    s_mov_b64 exec, s[70:71]
    ds_read_b64 v[34:35], v34
    s_mov_b64 exec, -1
    s_waitcnt vmcnt(5)
    v_lshlrev_b32_sdwa v36, 3, v43 dst_sel:WORD_0 dst_unused:UNUSED_PAD src0_sel:DWORD src1_sel:DWORD
    v_lshrrev_b32 v38, 5, v8
    v_lshlrev_b32_sdwa v40, 3, v9 dst_sel:WORD_0 dst_unused:UNUSED_PAD src0_sel:DWORD src1_sel:WORD_1
    v_alignbit_b32 v42, v11, v10, 21

    v_alignbyte_b32 v10, v10, v9, 3
    v_alignbyte_b32 v9, v9, v8, 2
    v_alignbyte_b32 v8, v8, v43, 1
    v_and_b32 v38, 0xfff8, v38
    v_and_b32 v42, 0xfff8, v42
    s_cmp_lt_i32 s42, 768
    s_cbranch_scc1 L_ufix_103
L_uback_104:

    v_subrev_co_u32 v8, s[72:73], 2.0, v8
    v_subrev_co_u32 v9, s[74:75], 2.0, v9
    v_subrev_co_u32 v10, s[76:77], 2.0, v10
    v_subrev_co_u32 v11, s[78:79], 2.0, v11
    s_mov_b64 exec, s[72:73]
    ds_read_b64 v[36:37], v36
    s_mov_b64 exec, s[74:75]
    ds_read_b64 v[38:39], v38
    s_mov_b64 exec, s[76:77]
    ds_read_b64 v[40:41], v40
    s_mov_b64 exec, s[78:79]
    ds_read_b64 v[42:43], v42
    s_mov_b64 exec, -1
    s_mov_b32 s38, s5
    s_add_u32 s50, s50, 200000
    s_branch L_batch_72
L_bend_73:

    s_waitcnt vmcnt(0)
    s_load_dwordx2 s[68:69], s[0:1], 24
    s_load_dwordx4 s[88:91], s[0:1], 72
    s_load_dwordx2 s[76:77], s[0:1], 88
    s_load_dwordx2 s[80:81], s[0:1], 96
    s_mov_b32 s70, 1600000
    s_mov_b32 s71, 0x20000
    s_mov_b32 s78, 6400000
    s_mov_b32 s79, 0x20000
    s_movk_i32 s82, 256
    s_mov_b32 s83, 0x20000
    s_lshl_b32 s48, s36, 2
    s_mov_b32 s41, s37

    s_add_u32 s84, s6, 8896512
    s_addc_u32 s85, s7, 0
    s_mov_b32 s86, 76800000
    s_mov_b32 s87, 0x20000
    s_add_u32 s72, s6, 393216
    s_addc_u32 s73, s7, 0
    s_mov_b32 s74, 2097152
    s_mov_b32 s75, 0x20000
    s_waitcnt lgkmcnt(15)
    v_mad_i32_i16 v120, v28, v4, s96
    v_mad_i32_i16 v28, v28, v4, s96 op_sel:[1,0,0,0]
    v_mad_i32_i16 v121, v29, v4, s96
    v_mad_i32_i16 v29, v29, v4, s96 op_sel:[1,0,0,0]
    v_lshlrev_b32_sdwa v4, 3, v4 dst_sel:DWORD dst_unused:UNUSED_PAD src0_sel:DWORD src1_sel:WORD_1
    v_perm_b32 v28, v28, v120, s97
    v_perm_b32 v29, v29, v121, s97
    v_lshl_add_u64 v[28:29], v[28:29], 0, s[30:31]

    ds_add_rtn_u64 v[28:29], v4, v[28:29] offset:50000
    v_mad_i32_i16 v122, v30, v5, s96
    v_mad_i32_i16 v30, v30, v5, s96 op_sel:[1,0,0,0]
    v_mad_i32_i16 v123, v31, v5, s96
    v_mad_i32_i16 v31, v31, v5, s96 op_sel:[1,0,0,0]
    v_lshlrev_b32_sdwa v5, 3, v5 dst_sel:DWORD dst_unused:UNUSED_PAD src0_sel:DWORD src1_sel:WORD_1
    v_perm_b32 v30, v30, v122, s97
    v_perm_b32 v31, v31, v123, s97
    v_lshl_add_u64 v[30:31], v[30:31], 0, s[30:31]

    ds_add_rtn_u64 v[30:31], v5, v[30:31] offset:50000
    v_mad_i32_i16 v124, v32, v6, s96
    v_mad_i32_i16 v32, v32, v6, s96 op_sel:[1,0,0,0]
    v_mad_i32_i16 v125, v33, v6, s96
    v_mad_i32_i16 v33, v33, v6, s96 op_sel:[1,0,0,0]
    v_lshlrev_b32_sdwa v6, 3, v6 dst_sel:DWORD dst_unused:UNUSED_PAD src0_sel:DWORD src1_sel:WORD_1
    v_perm_b32 v32, v32, v124, s97
    v_perm_b32 v33, v33, v125, s97
    v_lshl_add_u64 v[32:33], v[32:33], 0, s[30:31]

    ds_add_rtn_u64 v[32:33], v6, v[32:33] offset:50000
    v_mad_i32_i16 v126, v34, v7, s96
    v_mad_i32_i16 v34, v34, v7, s96 op_sel:[1,0,0,0]
    v_mad_i32_i16 v127, v35, v7, s96
    v_mad_i32_i16 v35, v35, v7, s96 op_sel:[1,0,0,0]
    v_lshlrev_b32_sdwa v7, 3, v7 dst_sel:DWORD dst_unused:UNUSED_PAD src0_sel:DWORD src1_sel:WORD_1
    v_perm_b32 v34, v34, v126, s97
    v_perm_b32 v35, v35, v127, s97
    v_lshl_add_u64 v[34:35], v[34:35], 0, s[30:31]

    ds_add_rtn_u64 v[34:35], v7, v[34:35] offset:50000
    s_waitcnt lgkmcnt(0)
    s_load_dwordx8 s[12:19], s[88:89], 0
    s_load_dwordx8 s[56:63], s[90:91], 0

    s_mul_i32 s28, s41, 3125
    s_add_u32 s29, s28, 3126
    s_add_u32 s28, s28, 1
    s_lshr_b32 s28, s28, 1
    s_lshr_b32 s29, s29, 1
    s_sub_u32 s29, s29, s28
    s_sub_u32 s5, s29, 782
    s_mul_i32 s3, s36, 6250
    v_add_u32 v78, s28, v0
    v_mov_b32 v82, 0x2000000
    v_add_u32 v79, 782, v78
    v_cmp_gt_u32 vcc, 782, v0
    v_add_u32 v76, s3, v78
    v_add_u32 v77, s3, v79
    v_cndmask_b32 v76, v82, v76, vcc
    v_cmp_gt_u32 vcc, s5, v0
    v_lshlrev_b32 v78, 4, v78
    v_lshlrev_b32 v79, 4, v79
    v_cndmask_b32 v77, v82, v77, vcc
    v_lshlrev_b32 v80, 2, v76
    v_lshlrev_b32 v76, 4, v76
    v_lshlrev_b32 v81, 2, v77
    v_lshlrev_b32 v77, 4, v77
    buffer_load_dword v80, v80, s[68:71], 0 offen
    buffer_load_dword v81, v81, s[68:71], 0 offen
    buffer_load_dwordx4 v[86:89], v76, s[8:11], 0 offen
    buffer_load_dwordx4 v[90:93], v77, s[8:11], 0 offen

    v_mad_i32_i16 v120, v36, v8, s96
    v_mad_i32_i16 v36, v36, v8, s96 op_sel:[1,0,0,0]
    v_mad_i32_i16 v121, v37, v8, s96
    v_mad_i32_i16 v37, v37, v8, s96 op_sel:[1,0,0,0]
    v_lshlrev_b32_sdwa v8, 3, v8 dst_sel:DWORD dst_unused:UNUSED_PAD src0_sel:DWORD src1_sel:WORD_1
    v_perm_b32 v36, v36, v120, s97
    v_perm_b32 v37, v37, v121, s97
    v_lshl_add_u64 v[36:37], v[36:37], 0, s[30:31]

    ds_add_rtn_u64 v[36:37], v8, v[36:37] offset:50000
    v_mad_i32_i16 v122, v38, v9, s96
    v_mad_i32_i16 v38, v38, v9, s96 op_sel:[1,0,0,0]
    v_mad_i32_i16 v123, v39, v9, s96
    v_mad_i32_i16 v39, v39, v9, s96 op_sel:[1,0,0,0]
    v_lshlrev_b32_sdwa v9, 3, v9 dst_sel:DWORD dst_unused:UNUSED_PAD src0_sel:DWORD src1_sel:WORD_1
    v_perm_b32 v38, v38, v122, s97
    v_perm_b32 v39, v39, v123, s97
    v_lshl_add_u64 v[38:39], v[38:39], 0, s[30:31]

    ds_add_rtn_u64 v[38:39], v9, v[38:39] offset:50000
    v_mad_i32_i16 v124, v40, v10, s96
    v_mad_i32_i16 v40, v40, v10, s96 op_sel:[1,0,0,0]
    v_mad_i32_i16 v125, v41, v10, s96
    v_mad_i32_i16 v41, v41, v10, s96 op_sel:[1,0,0,0]
    v_lshlrev_b32_sdwa v10, 3, v10 dst_sel:DWORD dst_unused:UNUSED_PAD src0_sel:DWORD src1_sel:WORD_1
    v_perm_b32 v40, v40, v124, s97
    v_perm_b32 v41, v41, v125, s97
    v_lshl_add_u64 v[40:41], v[40:41], 0, s[30:31]

    ds_add_rtn_u64 v[40:41], v10, v[40:41] offset:50000
    v_mad_i32_i16 v126, v42, v11, s96
    v_mad_i32_i16 v42, v42, v11, s96 op_sel:[1,0,0,0]
    v_mad_i32_i16 v127, v43, v11, s96
    v_mad_i32_i16 v43, v43, v11, s96 op_sel:[1,0,0,0]
    v_lshlrev_b32_sdwa v11, 3, v11 dst_sel:DWORD dst_unused:UNUSED_PAD src0_sel:DWORD src1_sel:WORD_1
    v_perm_b32 v42, v42, v126, s97
    v_perm_b32 v43, v43, v127, s97
    v_lshl_add_u64 v[42:43], v[42:43], 0, s[30:31]

    ds_add_rtn_u64 v[42:43], v11, v[42:43] offset:50000
    v_or3_b32 v1, v28, v29, v1
    v_or3_b32 v1, v30, v31, v1
    v_or3_b32 v1, v32, v33, v1
    v_or3_b32 v1, v34, v35, v1
    v_mad_i32_i16 v120, v44, v12, s96
    v_mad_i32_i16 v44, v44, v12, s96 op_sel:[1,0,0,0]
    v_mad_i32_i16 v121, v45, v12, s96
    v_mad_i32_i16 v45, v45, v12, s96 op_sel:[1,0,0,0]
    v_lshlrev_b32_sdwa v12, 3, v12 dst_sel:DWORD dst_unused:UNUSED_PAD src0_sel:DWORD src1_sel:WORD_1
    v_perm_b32 v44, v44, v120, s97
    v_perm_b32 v45, v45, v121, s97
    v_lshl_add_u64 v[44:45], v[44:45], 0, s[30:31]

    ds_add_rtn_u64 v[44:45], v12, v[44:45] offset:50000
    v_mad_i32_i16 v122, v46, v13, s96
    v_mad_i32_i16 v46, v46, v13, s96 op_sel:[1,0,0,0]
    v_mad_i32_i16 v123, v47, v13, s96
    v_mad_i32_i16 v47, v47, v13, s96 op_sel:[1,0,0,0]
    v_lshlrev_b32_sdwa v13, 3, v13 dst_sel:DWORD dst_unused:UNUSED_PAD src0_sel:DWORD src1_sel:WORD_1
    v_perm_b32 v46, v46, v122, s97
    v_perm_b32 v47, v47, v123, s97
    v_lshl_add_u64 v[46:47], v[46:47], 0, s[30:31]

    ds_add_rtn_u64 v[46:47], v13, v[46:47] offset:50000
    v_mad_i32_i16 v124, v48, v14, s96
    v_mad_i32_i16 v48, v48, v14, s96 op_sel:[1,0,0,0]
    v_mad_i32_i16 v125, v49, v14, s96
    v_mad_i32_i16 v49, v49, v14, s96 op_sel:[1,0,0,0]
    v_lshlrev_b32_sdwa v14, 3, v14 dst_sel:DWORD dst_unused:UNUSED_PAD src0_sel:DWORD src1_sel:WORD_1
    v_perm_b32 v48, v48, v124, s97
    v_perm_b32 v49, v49, v125, s97
    v_lshl_add_u64 v[48:49], v[48:49], 0, s[30:31]

    ds_add_rtn_u64 v[48:49], v14, v[48:49] offset:50000
    v_mad_i32_i16 v126, v50, v15, s96
    v_mad_i32_i16 v50, v50, v15, s96 op_sel:[1,0,0,0]
    v_mad_i32_i16 v127, v51, v15, s96
    v_mad_i32_i16 v51, v51, v15, s96 op_sel:[1,0,0,0]
    v_lshlrev_b32_sdwa v15, 3, v15 dst_sel:DWORD dst_unused:UNUSED_PAD src0_sel:DWORD src1_sel:WORD_1
    v_perm_b32 v50, v50, v126, s97
    v_perm_b32 v51, v51, v127, s97
    v_lshl_add_u64 v[50:51], v[50:51], 0, s[30:31]

    ds_add_rtn_u64 v[50:51], v15, v[50:51] offset:50000
    s_waitcnt lgkmcnt(4)
    v_or3_b32 v1, v36, v37, v1
    v_or3_b32 v1, v38, v39, v1
    v_or3_b32 v1, v40, v41, v1
    v_or3_b32 v1, v42, v43, v1
    v_mad_i32_i16 v120, v52, v16, s96
    v_mad_i32_i16 v52, v52, v16, s96 op_sel:[1,0,0,0]
    v_mad_i32_i16 v121, v53, v16, s96
    v_mad_i32_i16 v53, v53, v16, s96 op_sel:[1,0,0,0]
    v_lshlrev_b32_sdwa v16, 3, v16 dst_sel:DWORD dst_unused:UNUSED_PAD src0_sel:DWORD src1_sel:WORD_1
    v_perm_b32 v52, v52, v120, s97
    v_perm_b32 v53, v53, v121, s97
    v_lshl_add_u64 v[52:53], v[52:53], 0, s[30:31]

    ds_add_rtn_u64 v[52:53], v16, v[52:53] offset:50000
    v_mad_i32_i16 v122, v54, v17, s96
    v_mad_i32_i16 v54, v54, v17, s96 op_sel:[1,0,0,0]
    v_mad_i32_i16 v123, v55, v17, s96
    v_mad_i32_i16 v55, v55, v17, s96 op_sel:[1,0,0,0]
    v_lshlrev_b32_sdwa v17, 3, v17 dst_sel:DWORD dst_unused:UNUSED_PAD src0_sel:DWORD src1_sel:WORD_1
    v_perm_b32 v54, v54, v122, s97
    v_perm_b32 v55, v55, v123, s97
    v_lshl_add_u64 v[54:55], v[54:55], 0, s[30:31]

    ds_add_rtn_u64 v[54:55], v17, v[54:55] offset:50000
    v_mad_i32_i16 v124, v56, v18, s96
    v_mad_i32_i16 v56, v56, v18, s96 op_sel:[1,0,0,0]
    v_mad_i32_i16 v125, v57, v18, s96
    v_mad_i32_i16 v57, v57, v18, s96 op_sel:[1,0,0,0]
    v_lshlrev_b32_sdwa v18, 3, v18 dst_sel:DWORD dst_unused:UNUSED_PAD src0_sel:DWORD src1_sel:WORD_1
    v_perm_b32 v56, v56, v124, s97
    v_perm_b32 v57, v57, v125, s97
    v_lshl_add_u64 v[56:57], v[56:57], 0, s[30:31]

    ds_add_rtn_u64 v[56:57], v18, v[56:57] offset:50000
    v_mad_i32_i16 v126, v58, v19, s96
    v_mad_i32_i16 v58, v58, v19, s96 op_sel:[1,0,0,0]
    v_mad_i32_i16 v127, v59, v19, s96
    v_mad_i32_i16 v59, v59, v19, s96 op_sel:[1,0,0,0]
    v_lshlrev_b32_sdwa v19, 3, v19 dst_sel:DWORD dst_unused:UNUSED_PAD src0_sel:DWORD src1_sel:WORD_1
    v_perm_b32 v58, v58, v126, s97
    v_perm_b32 v59, v59, v127, s97
    v_lshl_add_u64 v[58:59], v[58:59], 0, s[30:31]

    ds_add_rtn_u64 v[58:59], v19, v[58:59] offset:50000
    s_waitcnt lgkmcnt(4)
    v_or3_b32 v1, v44, v45, v1
    v_or3_b32 v1, v46, v47, v1
    v_or3_b32 v1, v48, v49, v1
    v_or3_b32 v1, v50, v51, v1
    s_waitcnt vmcnt(2)
    v_lshlrev_b32_sdwa v82, 5, v80 dst_sel:DWORD dst_unused:UNUSED_PAD src0_sel:DWORD src1_sel:WORD_0
    v_lshlrev_b32_sdwa v83, 5, v80 dst_sel:DWORD dst_unused:UNUSED_PAD src0_sel:DWORD src1_sel:WORD_1
    v_lshlrev_b32_sdwa v84, 5, v81 dst_sel:DWORD dst_unused:UNUSED_PAD src0_sel:DWORD src1_sel:WORD_0
    v_lshlrev_b32_sdwa v85, 5, v81 dst_sel:DWORD dst_unused:UNUSED_PAD src0_sel:DWORD src1_sel:WORD_1
    buffer_load_dwordx4 v[94:97], v82, s[72:75], 0 offen
    buffer_load_dwordx2 v[110:111], v82, s[72:75], 0 offen offset:16

    buffer_load_dwordx4 v[98:101], v83, s[72:75], 0 offen
    buffer_load_dwordx2 v[112:113], v83, s[72:75], 0 offen offset:16

    buffer_load_dwordx4 v[102:105], v84, s[72:75], 0 offen
    buffer_load_dwordx2 v[114:115], v84, s[72:75], 0 offen offset:16

    buffer_load_dwordx4 v[106:109], v85, s[72:75], 0 offen
    buffer_load_dwordx2 v[116:117], v85, s[72:75], 0 offen offset:16

    v_mad_i32_i16 v120, v60, v20, s96
    v_mad_i32_i16 v60, v60, v20, s96 op_sel:[1,0,0,0]
    v_mad_i32_i16 v121, v61, v20, s96
    v_mad_i32_i16 v61, v61, v20, s96 op_sel:[1,0,0,0]
    v_lshlrev_b32_sdwa v20, 3, v20 dst_sel:DWORD dst_unused:UNUSED_PAD src0_sel:DWORD src1_sel:WORD_1
    v_perm_b32 v60, v60, v120, s97
    v_perm_b32 v61, v61, v121, s97
    v_lshl_add_u64 v[60:61], v[60:61], 0, s[30:31]

    ds_add_rtn_u64 v[60:61], v20, v[60:61] offset:50000
    v_mad_i32_i16 v122, v62, v21, s96
    v_mad_i32_i16 v62, v62, v21, s96 op_sel:[1,0,0,0]
    v_mad_i32_i16 v123, v63, v21, s96
    v_mad_i32_i16 v63, v63, v21, s96 op_sel:[1,0,0,0]
    v_lshlrev_b32_sdwa v21, 3, v21 dst_sel:DWORD dst_unused:UNUSED_PAD src0_sel:DWORD src1_sel:WORD_1
    v_perm_b32 v62, v62, v122, s97
    v_perm_b32 v63, v63, v123, s97
    v_lshl_add_u64 v[62:63], v[62:63], 0, s[30:31]

    ds_add_rtn_u64 v[62:63], v21, v[62:63] offset:50000
    v_mad_i32_i16 v124, v64, v22, s96
    v_mad_i32_i16 v64, v64, v22, s96 op_sel:[1,0,0,0]
    v_mad_i32_i16 v125, v65, v22, s96
    v_mad_i32_i16 v65, v65, v22, s96 op_sel:[1,0,0,0]
    v_lshlrev_b32_sdwa v22, 3, v22 dst_sel:DWORD dst_unused:UNUSED_PAD src0_sel:DWORD src1_sel:WORD_1
    v_perm_b32 v64, v64, v124, s97
    v_perm_b32 v65, v65, v125, s97
    v_lshl_add_u64 v[64:65], v[64:65], 0, s[30:31]

    ds_add_rtn_u64 v[64:65], v22, v[64:65] offset:50000
    v_mad_i32_i16 v126, v66, v23, s96
    v_mad_i32_i16 v66, v66, v23, s96 op_sel:[1,0,0,0]
    v_mad_i32_i16 v127, v67, v23, s96
    v_mad_i32_i16 v67, v67, v23, s96 op_sel:[1,0,0,0]
    v_lshlrev_b32_sdwa v23, 3, v23 dst_sel:DWORD dst_unused:UNUSED_PAD src0_sel:DWORD src1_sel:WORD_1
    v_perm_b32 v66, v66, v126, s97
    v_perm_b32 v67, v67, v127, s97
    v_lshl_add_u64 v[66:67], v[66:67], 0, s[30:31]

    ds_add_rtn_u64 v[66:67], v23, v[66:67] offset:50000
    s_waitcnt lgkmcnt(4)
    v_or3_b32 v1, v52, v53, v1
    v_or3_b32 v1, v54, v55, v1
    v_or3_b32 v1, v56, v57, v1
    v_or3_b32 v1, v58, v59, v1
    v_mad_i32_i16 v120, v68, v24, s96
    v_mad_i32_i16 v68, v68, v24, s96 op_sel:[1,0,0,0]
    v_mad_i32_i16 v121, v69, v24, s96
    v_mad_i32_i16 v69, v69, v24, s96 op_sel:[1,0,0,0]
    v_lshlrev_b32_sdwa v24, 3, v24 dst_sel:DWORD dst_unused:UNUSED_PAD src0_sel:DWORD src1_sel:WORD_1
    v_perm_b32 v68, v68, v120, s97
    v_perm_b32 v69, v69, v121, s97
    v_lshl_add_u64 v[68:69], v[68:69], 0, s[30:31]

    ds_add_rtn_u64 v[68:69], v24, v[68:69] offset:50000
    v_mad_i32_i16 v122, v70, v25, s96
    v_mad_i32_i16 v70, v70, v25, s96 op_sel:[1,0,0,0]
    v_mad_i32_i16 v123, v71, v25, s96
    v_mad_i32_i16 v71, v71, v25, s96 op_sel:[1,0,0,0]
    v_lshlrev_b32_sdwa v25, 3, v25 dst_sel:DWORD dst_unused:UNUSED_PAD src0_sel:DWORD src1_sel:WORD_1
    v_perm_b32 v70, v70, v122, s97
    v_perm_b32 v71, v71, v123, s97
    v_lshl_add_u64 v[70:71], v[70:71], 0, s[30:31]

    ds_add_rtn_u64 v[70:71], v25, v[70:71] offset:50000
    v_mad_i32_i16 v124, v72, v26, s96
    v_mad_i32_i16 v72, v72, v26, s96 op_sel:[1,0,0,0]
    v_mad_i32_i16 v125, v73, v26, s96
    v_mad_i32_i16 v73, v73, v26, s96 op_sel:[1,0,0,0]
    v_lshlrev_b32_sdwa v26, 3, v26 dst_sel:DWORD dst_unused:UNUSED_PAD src0_sel:DWORD src1_sel:WORD_1
    v_perm_b32 v72, v72, v124, s97
    v_perm_b32 v73, v73, v125, s97
    v_lshl_add_u64 v[72:73], v[72:73], 0, s[30:31]

    ds_add_rtn_u64 v[72:73], v26, v[72:73] offset:50000
    v_mad_i32_i16 v126, v74, v27, s96
    v_mad_i32_i16 v74, v74, v27, s96 op_sel:[1,0,0,0]
    v_mad_i32_i16 v127, v75, v27, s96
    v_mad_i32_i16 v75, v75, v27, s96 op_sel:[1,0,0,0]
    v_lshlrev_b32_sdwa v27, 3, v27 dst_sel:DWORD dst_unused:UNUSED_PAD src0_sel:DWORD src1_sel:WORD_1
    v_perm_b32 v74, v74, v126, s97
    v_perm_b32 v75, v75, v127, s97
    v_lshl_add_u64 v[74:75], v[74:75], 0, s[30:31]

    ds_add_rtn_u64 v[74:75], v27, v[74:75] offset:50000
    s_waitcnt lgkmcnt(4)
    v_or3_b32 v1, v60, v61, v1
    v_or3_b32 v1, v62, v63, v1
    v_or3_b32 v1, v64, v65, v1
    v_or3_b32 v1, v66, v67, v1
    s_waitcnt lgkmcnt(0)
    v_or3_b32 v1, v68, v69, v1
    v_or3_b32 v1, v70, v71, v1
    v_or3_b32 v1, v72, v73, v1
    v_or3_b32 v1, v74, v75, v1
    s_barrier

    v_add_u32 v40, 50000, v3
    v_add_u32 v41, 115536, v3
    v_cmp_gt_u32 vcc, 106, v0

    v_mov_b32 v28, 0
    v_mov_b32 v29, 0
    v_mov_b32 v30, 0
    v_mov_b32 v31, 0
    ds_read_b128 v[4:7], v40 offset:0
    ds_read_b128 v[8:11], v40 offset:16384
    ds_read_b128 v[12:15], v40 offset:32768
    ds_read_b128 v[16:19], v40 offset:49152
    ds_read_b128 v[20:23], v41 offset:0
    ds_read_b128 v[24:27], v41 offset:16384
    s_mov_b64 exec, vcc
    ds_read_b128 v[28:31], v41 offset:32768
    s_mov_b64 exec, -1
    s_mul_i32 s3, s37, 6400000
    s_mul_i32 s5, s36, 100000
    s_add_u32 s3, s3, s5
    s_add_u32 s3, s3, 8896512
    v_bfrev_b32 v42, 1

    s_add_u32 s20, s6, s3
    s_addc_u32 s21, s7, 0
    s_mov_b32 s22, 100000
    s_mov_b32 s23, 0x20000
    s_sub_u32 s3, 0, s28
    v_add_u32 v43, s3, v0
    v_cmp_gt_u32 vcc, s29, v43
    s_mov_b32 s3, 0
    s_waitcnt lgkmcnt(6)
    v_cndmask_b32 v43, v3, v42, vcc
    buffer_store_dwordx4 v[4:7], v43, s[20:23], s3 offen sc1

    s_sub_u32 s3, 1024, s28
    v_add_u32 v43, s3, v0
    v_cmp_gt_u32 vcc, s29, v43
    s_mov_b32 s3, 16384
    s_waitcnt lgkmcnt(5)
    v_cndmask_b32 v43, v3, v42, vcc
    buffer_store_dwordx4 v[8:11], v43, s[20:23], s3 offen sc1

    s_sub_u32 s3, 2048, s28
    v_add_u32 v43, s3, v0
    v_cmp_gt_u32 vcc, s29, v43
    s_mov_b32 s3, 32768
    s_waitcnt lgkmcnt(4)
    v_cndmask_b32 v43, v3, v42, vcc
    buffer_store_dwordx4 v[12:15], v43, s[20:23], s3 offen sc1

    s_sub_u32 s3, 3072, s28
    v_add_u32 v43, s3, v0
    v_cmp_gt_u32 vcc, s29, v43
    s_mov_b32 s3, 49152
    s_waitcnt lgkmcnt(3)
    v_cndmask_b32 v43, v3, v42, vcc
    buffer_store_dwordx4 v[16:19], v43, s[20:23], s3 offen sc1

    s_sub_u32 s3, 4096, s28
    v_add_u32 v43, s3, v0
    v_cmp_gt_u32 vcc, s29, v43
    s_mov_b32 s3, 65536
    s_waitcnt lgkmcnt(2)
    v_cndmask_b32 v43, v3, v42, vcc
    buffer_store_dwordx4 v[20:23], v43, s[20:23], s3 offen sc1

    s_sub_u32 s3, 5120, s28
    v_add_u32 v43, s3, v0
    v_cmp_gt_u32 vcc, s29, v43
    s_mov_b32 s3, 81920
    s_waitcnt lgkmcnt(1)
    v_cndmask_b32 v43, v3, v42, vcc
    buffer_store_dwordx4 v[24:27], v43, s[20:23], s3 offen sc1

    s_sub_u32 s3, 6144, s28
    v_add_u32 v43, s3, v0
    v_cmp_gt_u32 vcc, s29, v43
    s_mov_b32 s3, 98304
    s_waitcnt lgkmcnt(0)
    v_cndmask_b32 v43, v3, v42, vcc
    buffer_store_dwordx4 v[28:31], v43, s[20:23], s3 offen sc1

    v_or3_b32 v1, v4, v5, v1
    v_or3_b32 v1, v6, v7, v1
    v_or3_b32 v1, v8, v9, v1
    v_or3_b32 v1, v10, v11, v1
    v_or3_b32 v1, v12, v13, v1
    v_or3_b32 v1, v14, v15, v1
    v_or3_b32 v1, v16, v17, v1
    v_or3_b32 v1, v18, v19, v1
    v_or3_b32 v1, v20, v21, v1
    v_or3_b32 v1, v22, v23, v1
    v_or3_b32 v1, v24, v25, v1
    v_or3_b32 v1, v26, v27, v1
    v_or3_b32 v1, v28, v29, v1
    v_or3_b32 v1, v30, v31, v1
    v_and_b32 v1, 0x80008000, v1
    v_cmp_ne_u32 vcc, 0, v1
    v_mov_b32 v40, 150024
    v_mov_b32 v41, 1
    s_cbranch_vccz L_nf_105
    ds_write_b32 v40, v41
L_nf_105:
    s_mov_b32 s33, 1
    s_mov_b32 s49, s37
    s_waitcnt vmcnt(0) lgkmcnt(0)

    s_barrier
    ds_read_b32 v41, v40
    s_waitcnt lgkmcnt(0)
    v_readfirstlane_b32 s3, v41
    s_nop 1
    s_cmp_lg_u32 s3, 0
    s_cbranch_scc1 L_p2slow_48

L_meet_107:
    v_readfirstlane_b32 s3, v0
    v_mov_b32 v118, 150016
    s_nop 0
    s_cmp_eq_u32 s3, 960
    s_cbranch_scc1 L_sync_114
L_bcast_109:
    s_barrier

    ds_read_b32 v119, v118
    s_waitcnt lgkmcnt(0)
    v_readfirstlane_b32 s35, v119
    s_nop 1
    s_bitcmp1_b32 s35, 16
    s_cbranch_scc1 L_fend_115
L_post_111:
    v_cmp_gt_u32 vcc, 782, v0
    s_mov_b64 exec, vcc
    s_cbranch_execz L_postend_112

    s_cmp_eq_u32 s49, 0
    s_cbranch_scc1 L_own_121
    s_mov_b32 s3, 0
    buffer_load_dwordx4 v[36:39], v76, s[84:87], s3 offen sc1
    buffer_load_dwordx4 v[52:55], v77, s[84:87], s3 offen sc1
L_obk_122:
    s_cmp_eq_u32 s49, 1
    s_cbranch_scc1 L_own_123
    s_mov_b32 s3, 6400000
    buffer_load_dwordx4 v[40:43], v76, s[84:87], s3 offen sc1
    buffer_load_dwordx4 v[56:59], v77, s[84:87], s3 offen sc1
L_obk_124:
    s_cmp_eq_u32 s49, 2
    s_cbranch_scc1 L_own_125
    s_mov_b32 s3, 12800000
    buffer_load_dwordx4 v[44:47], v76, s[84:87], s3 offen sc1
    buffer_load_dwordx4 v[60:63], v77, s[84:87], s3 offen sc1
L_obk_126:
    s_cmp_eq_u32 s49, 3
    s_cbranch_scc1 L_own_127
    s_mov_b32 s3, 19200000
    buffer_load_dwordx4 v[48:51], v76, s[84:87], s3 offen sc1
    buffer_load_dwordx4 v[64:67], v77, s[84:87], s3 offen sc1
L_obk_128:
    s_and_b32 s3, s35, 0xf0
    s_waitcnt vmcnt(0) lgkmcnt(0)
    s_cbranch_scc1 L_fgen_129

    v_add_u32 v36, v36, v40
    v_add_u32 v44, v44, v48
    v_add_u32 v37, v37, v41
    v_add_u32 v45, v45, v49
    v_add_u32 v38, v38, v42
    v_add_u32 v46, v46, v50
    v_add_u32 v39, v39, v43
    v_add_u32 v47, v47, v51
    v_add_u32_sdwa v4, v36, v44 dst_sel:DWORD dst_unused:UNUSED_PAD src0_sel:WORD_0 src1_sel:WORD_0
    v_add_u32_sdwa v5, v36, v44 dst_sel:DWORD dst_unused:UNUSED_PAD src0_sel:WORD_1 src1_sel:WORD_1
    v_add_u32_sdwa v6, v37, v45 dst_sel:DWORD dst_unused:UNUSED_PAD src0_sel:WORD_0 src1_sel:WORD_0
    v_add_u32_sdwa v7, v37, v45 dst_sel:DWORD dst_unused:UNUSED_PAD src0_sel:WORD_1 src1_sel:WORD_1
    v_add_u32_sdwa v8, v38, v46 dst_sel:DWORD dst_unused:UNUSED_PAD src0_sel:WORD_0 src1_sel:WORD_0
    v_add_u32_sdwa v9, v38, v46 dst_sel:DWORD dst_unused:UNUSED_PAD src0_sel:WORD_1 src1_sel:WORD_1
    v_add_u32_sdwa v10, v39, v47 dst_sel:DWORD dst_unused:UNUSED_PAD src0_sel:WORD_0 src1_sel:WORD_0
    v_add_u32_sdwa v11, v39, v47 dst_sel:DWORD dst_unused:UNUSED_PAD src0_sel:WORD_1 src1_sel:WORD_1
    v_add_u32 v52, v52, v56
    v_add_u32 v60, v60, v64
    v_add_u32 v53, v53, v57
    v_add_u32 v61, v61, v65
    v_add_u32 v54, v54, v58
    v_add_u32 v62, v62, v66
    v_add_u32 v55, v55, v59
    v_add_u32 v63, v63, v67
    v_add_u32_sdwa v12, v52, v60 dst_sel:DWORD dst_unused:UNUSED_PAD src0_sel:WORD_0 src1_sel:WORD_0
    v_add_u32_sdwa v13, v52, v60 dst_sel:DWORD dst_unused:UNUSED_PAD src0_sel:WORD_1 src1_sel:WORD_1
    v_add_u32_sdwa v14, v53, v61 dst_sel:DWORD dst_unused:UNUSED_PAD src0_sel:WORD_0 src1_sel:WORD_0
    v_add_u32_sdwa v15, v53, v61 dst_sel:DWORD dst_unused:UNUSED_PAD src0_sel:WORD_1 src1_sel:WORD_1
    v_add_u32_sdwa v16, v54, v62 dst_sel:DWORD dst_unused:UNUSED_PAD src0_sel:WORD_0 src1_sel:WORD_0
    v_add_u32_sdwa v17, v54, v62 dst_sel:DWORD dst_unused:UNUSED_PAD src0_sel:WORD_1 src1_sel:WORD_1
    v_add_u32_sdwa v18, v55, v63 dst_sel:DWORD dst_unused:UNUSED_PAD src0_sel:WORD_0 src1_sel:WORD_0
    v_add_u32_sdwa v19, v55, v63 dst_sel:DWORD dst_unused:UNUSED_PAD src0_sel:WORD_1 src1_sel:WORD_1
    v_add_u32 v4, 0xffff0000, v4
    v_add_u32 v5, 0xffff0000, v5
    v_add_u32 v6, 0xffff0000, v6
    v_add_u32 v7, 0xffff0000, v7
    v_add_u32 v8, 0xffff0000, v8
    v_add_u32 v9, 0xffff0000, v9
    v_add_u32 v10, 0xffff0000, v10
    v_add_u32 v11, 0xffff0000, v11
    v_add_u32 v12, 0xffff0000, v12
    v_add_u32 v13, 0xffff0000, v13
    v_add_u32 v14, 0xffff0000, v14
    v_add_u32 v15, 0xffff0000, v15
    v_add_u32 v16, 0xffff0000, v16
    v_add_u32 v17, 0xffff0000, v17
    v_add_u32 v18, 0xffff0000, v18
    v_add_u32 v19, 0xffff0000, v19
    v_cvt_f32_i32 v4, v4
    v_cvt_f32_i32 v5, v5
    v_cvt_f32_i32 v6, v6
    v_cvt_f32_i32 v7, v7
    v_cvt_f32_i32 v8, v8
    v_cvt_f32_i32 v9, v9
    v_cvt_f32_i32 v10, v10
    v_cvt_f32_i32 v11, v11
    v_cvt_f32_i32 v12, v12
    v_cvt_f32_i32 v13, v13
    v_cvt_f32_i32 v14, v14
    v_cvt_f32_i32 v15, v15
    v_cvt_f32_i32 v16, v16
    v_cvt_f32_i32 v17, v17
    v_cvt_f32_i32 v18, v18
    v_cvt_f32_i32 v19, v19
    v_mul_f32 v4, s34, v4
    v_mul_f32 v5, s34, v5
    v_mul_f32 v6, s34, v6
    v_mul_f32 v7, s34, v7
    v_mul_f32 v8, s34, v8
    v_mul_f32 v9, s34, v9
    v_mul_f32 v10, s34, v10
    v_mul_f32 v11, s34, v11
    v_mul_f32 v12, s34, v12
    v_mul_f32 v13, s34, v13
    v_mul_f32 v14, s34, v14
    v_mul_f32 v15, s34, v15
    v_mul_f32 v16, s34, v16
    v_mul_f32 v17, s34, v17
    v_mul_f32 v18, s34, v18
    v_mul_f32 v19, s34, v19
L_fbk_130:
    s_lshl_b32 s52, s12, 16
    v_mul_f32 v20, s52, v4
    v_mul_f32 v24, s52, v8
    v_mul_f32 v28, s52, v12
    v_mul_f32 v32, s52, v16
    s_and_b32 s53, s12, s32
    v_mul_f32 v21, s53, v4
    v_mul_f32 v25, s53, v8
    v_mul_f32 v29, s53, v12
    v_mul_f32 v33, s53, v16
    s_lshl_b32 s52, s13, 16
    v_mul_f32 v22, s52, v4
    v_mul_f32 v26, s52, v8
    v_mul_f32 v30, s52, v12
    v_mul_f32 v34, s52, v16
    s_and_b32 s53, s13, s32
    v_mul_f32 v23, s53, v4
    v_mul_f32 v27, s53, v8
    v_mul_f32 v31, s53, v12
    v_mul_f32 v35, s53, v16
    s_lshl_b32 s52, s14, 16
    v_fmac_f32 v20, s52, v5
    v_fmac_f32 v24, s52, v9
    v_fmac_f32 v28, s52, v13
    v_fmac_f32 v32, s52, v17
    s_and_b32 s53, s14, s32
    v_fmac_f32 v21, s53, v5
    v_fmac_f32 v25, s53, v9
    v_fmac_f32 v29, s53, v13
    v_fmac_f32 v33, s53, v17
    s_lshl_b32 s52, s15, 16
    v_fmac_f32 v22, s52, v5
    v_fmac_f32 v26, s52, v9
    v_fmac_f32 v30, s52, v13
    v_fmac_f32 v34, s52, v17
    s_and_b32 s53, s15, s32
    v_fmac_f32 v23, s53, v5
    v_fmac_f32 v27, s53, v9
    v_fmac_f32 v31, s53, v13
    v_fmac_f32 v35, s53, v17
    s_lshl_b32 s52, s16, 16
    v_fmac_f32 v20, s52, v6
    v_fmac_f32 v24, s52, v10
    v_fmac_f32 v28, s52, v14
    v_fmac_f32 v32, s52, v18
    s_and_b32 s53, s16, s32
    v_fmac_f32 v21, s53, v6
    v_fmac_f32 v25, s53, v10
    v_fmac_f32 v29, s53, v14
    v_fmac_f32 v33, s53, v18
    s_lshl_b32 s52, s17, 16
    v_fmac_f32 v22, s52, v6
    v_fmac_f32 v26, s52, v10
    v_fmac_f32 v30, s52, v14
    v_fmac_f32 v34, s52, v18
    s_and_b32 s53, s17, s32
    v_fmac_f32 v23, s53, v6
    v_fmac_f32 v27, s53, v10
    v_fmac_f32 v31, s53, v14
    v_fmac_f32 v35, s53, v18
    s_lshl_b32 s52, s18, 16
    v_fmac_f32 v20, s52, v7
    v_fmac_f32 v24, s52, v11
    v_fmac_f32 v28, s52, v15
    v_fmac_f32 v32, s52, v19
    s_and_b32 s53, s18, s32
    v_fmac_f32 v21, s53, v7
    v_fmac_f32 v25, s53, v11
    v_fmac_f32 v29, s53, v15
    v_fmac_f32 v33, s53, v19
    s_lshl_b32 s52, s19, 16
    v_fmac_f32 v22, s52, v7
    v_fmac_f32 v26, s52, v11
    v_fmac_f32 v30, s52, v15
    v_fmac_f32 v34, s52, v19
    s_and_b32 s53, s19, s32
    v_fmac_f32 v23, s53, v7
    v_fmac_f32 v27, s53, v11
    v_fmac_f32 v31, s53, v15
    v_fmac_f32 v35, s53, v19
    v_mul_f32 v20, v20, v94
    v_mul_f32 v21, v21, v95
    v_mul_f32 v22, v22, v96
    v_mul_f32 v23, v23, v97
    v_mul_f32 v24, v24, v98
    v_mul_f32 v25, v25, v99
    v_mul_f32 v26, v26, v100
    v_mul_f32 v27, v27, v101
    v_mul_f32 v28, v28, v102
    v_mul_f32 v29, v29, v103
    v_mul_f32 v30, v30, v104
    v_mul_f32 v31, v31, v105
    v_mul_f32 v32, v32, v106
    v_mul_f32 v33, v33, v107
    v_mul_f32 v34, v34, v108
    v_mul_f32 v35, v35, v109
    v_cvt_pk_bf16_f32 v20, v20, v21
    v_cvt_pk_bf16_f32 v22, v22, v23
    v_cvt_pk_bf16_f32 v24, v24, v25
    v_cvt_pk_bf16_f32 v26, v26, v27
    v_cvt_pk_bf16_f32 v28, v28, v29
    v_cvt_pk_bf16_f32 v30, v30, v31
    v_cvt_pk_bf16_f32 v32, v32, v33
    v_cvt_pk_bf16_f32 v34, v34, v35
    s_pack_ll_b32_b16 s52, s56, s58
    v_dot2_f32_bf16 v4, v20, s52, 0
    v_dot2_f32_bf16 v8, v24, s52, 0
    v_dot2_f32_bf16 v12, v28, s52, 0
    v_dot2_f32_bf16 v16, v32, s52, 0
    s_pack_hh_b32_b16 s53, s56, s58
    v_dot2_f32_bf16 v5, v20, s53, 0
    v_dot2_f32_bf16 v9, v24, s53, 0
    v_dot2_f32_bf16 v13, v28, s53, 0
    v_dot2_f32_bf16 v17, v32, s53, 0
    s_pack_ll_b32_b16 s52, s57, s59
    v_dot2_f32_bf16 v6, v20, s52, 0
    v_dot2_f32_bf16 v10, v24, s52, 0
    v_dot2_f32_bf16 v14, v28, s52, 0
    v_dot2_f32_bf16 v18, v32, s52, 0
    s_pack_hh_b32_b16 s53, s57, s59
    v_dot2_f32_bf16 v7, v20, s53, 0
    v_dot2_f32_bf16 v11, v24, s53, 0
    v_dot2_f32_bf16 v15, v28, s53, 0
    v_dot2_f32_bf16 v19, v32, s53, 0
    s_pack_ll_b32_b16 s52, s60, s62
    v_dot2_f32_bf16 v4, v22, s52, v4
    v_dot2_f32_bf16 v8, v26, s52, v8
    v_dot2_f32_bf16 v12, v30, s52, v12
    v_dot2_f32_bf16 v16, v34, s52, v16
    s_pack_hh_b32_b16 s53, s60, s62
    v_dot2_f32_bf16 v5, v22, s53, v5
    v_dot2_f32_bf16 v9, v26, s53, v9
    v_dot2_f32_bf16 v13, v30, s53, v13
    v_dot2_f32_bf16 v17, v34, s53, v17
    s_pack_ll_b32_b16 s52, s61, s63
    v_dot2_f32_bf16 v6, v22, s52, v6
    v_dot2_f32_bf16 v10, v26, s52, v10
    v_dot2_f32_bf16 v14, v30, s52, v14
    v_dot2_f32_bf16 v18, v34, s52, v18
    s_pack_hh_b32_b16 s53, s61, s63
    v_dot2_f32_bf16 v7, v22, s53, v7
    v_dot2_f32_bf16 v11, v26, s53, v11
    v_dot2_f32_bf16 v15, v30, s53, v15
    v_dot2_f32_bf16 v19, v34, s53, v19
    v_lshlrev_b32 v36, 16, v86
    v_and_b32 v37, s32, v86
    v_lshlrev_b32 v52, 16, v110
    v_and_b32 v53, s32, v110
    v_lshlrev_b32 v38, 16, v87
    v_and_b32 v39, s32, v87
    v_lshlrev_b32 v54, 16, v111
    v_and_b32 v55, s32, v111
    v_lshlrev_b32 v40, 16, v88
    v_and_b32 v41, s32, v88
    v_lshlrev_b32 v56, 16, v112
    v_and_b32 v57, s32, v112
    v_lshlrev_b32 v42, 16, v89
    v_and_b32 v43, s32, v89
    v_lshlrev_b32 v58, 16, v113
    v_and_b32 v59, s32, v113
    v_lshlrev_b32 v44, 16, v90
    v_and_b32 v45, s32, v90
    v_lshlrev_b32 v60, 16, v114
    v_and_b32 v61, s32, v114
    v_lshlrev_b32 v46, 16, v91
    v_and_b32 v47, s32, v91
    v_lshlrev_b32 v62, 16, v115
    v_and_b32 v63, s32, v115
    v_lshlrev_b32 v48, 16, v92
    v_and_b32 v49, s32, v92
    v_lshlrev_b32 v64, 16, v116
    v_and_b32 v65, s32, v116
    v_lshlrev_b32 v50, 16, v93
    v_and_b32 v51, s32, v93
    v_lshlrev_b32 v66, 16, v117
    v_and_b32 v67, s32, v117
    v_cvt_pk_bf16_f32 v4, v4, v5
    v_cvt_pk_bf16_f32 v6, v6, v7
    v_cvt_pk_bf16_f32 v8, v8, v9
    v_cvt_pk_bf16_f32 v10, v10, v11
    v_cvt_pk_bf16_f32 v12, v12, v13
    v_cvt_pk_bf16_f32 v14, v14, v15
    v_cvt_pk_bf16_f32 v16, v16, v17
    v_cvt_pk_bf16_f32 v18, v18, v19
    v_and_b32 v5, s32, v4
    v_lshlrev_b32 v4, 16, v4
    v_and_b32 v7, s32, v6
    v_lshlrev_b32 v6, 16, v6
    v_and_b32 v9, s32, v8
    v_lshlrev_b32 v8, 16, v8
    v_and_b32 v11, s32, v10
    v_lshlrev_b32 v10, 16, v10
    v_and_b32 v13, s32, v12
    v_lshlrev_b32 v12, 16, v12
    v_and_b32 v15, s32, v14
    v_lshlrev_b32 v14, 16, v14
    v_and_b32 v17, s32, v16
    v_lshlrev_b32 v16, 16, v16
    v_and_b32 v19, s32, v18
    v_lshlrev_b32 v18, 16, v18
    v_mul_f32 v4, v4, v52
    v_mul_f32 v5, v5, v53
    v_mul_f32 v6, v6, v54
    v_mul_f32 v7, v7, v55
    v_mul_f32 v8, v8, v56
    v_mul_f32 v9, v9, v57
    v_mul_f32 v10, v10, v58
    v_mul_f32 v11, v11, v59
    v_mul_f32 v12, v12, v60
    v_mul_f32 v13, v13, v61
    v_mul_f32 v14, v14, v62
    v_mul_f32 v15, v15, v63
    v_mul_f32 v16, v16, v64
    v_mul_f32 v17, v17, v65
    v_mul_f32 v18, v18, v66
    v_mul_f32 v19, v19, v67
    v_cvt_pk_bf16_f32 v4, v4, v5
    v_cvt_pk_bf16_f32 v6, v6, v7
    v_cvt_pk_bf16_f32 v8, v8, v9
    v_cvt_pk_bf16_f32 v10, v10, v11
    v_cvt_pk_bf16_f32 v12, v12, v13
    v_cvt_pk_bf16_f32 v14, v14, v15
    v_cvt_pk_bf16_f32 v16, v16, v17
    v_cvt_pk_bf16_f32 v18, v18, v19
    v_and_b32 v5, s32, v4
    v_lshlrev_b32 v4, 16, v4
    v_and_b32 v7, s32, v6
    v_lshlrev_b32 v6, 16, v6
    v_and_b32 v9, s32, v8
    v_lshlrev_b32 v8, 16, v8
    v_and_b32 v11, s32, v10
    v_lshlrev_b32 v10, 16, v10
    v_and_b32 v13, s32, v12
    v_lshlrev_b32 v12, 16, v12
    v_and_b32 v15, s32, v14
    v_lshlrev_b32 v14, 16, v14
    v_and_b32 v17, s32, v16
    v_lshlrev_b32 v16, 16, v16
    v_and_b32 v19, s32, v18
    v_lshlrev_b32 v18, 16, v18
    v_add_f32 v4, v4, v36
    v_add_f32 v5, v5, v37
    v_add_f32 v6, v6, v38
    v_add_f32 v7, v7, v39
    v_add_f32 v8, v8, v40
    v_add_f32 v9, v9, v41
    v_add_f32 v10, v10, v42
    v_add_f32 v11, v11, v43
    v_add_f32 v12, v12, v44
    v_add_f32 v13, v13, v45
    v_add_f32 v14, v14, v46
    v_add_f32 v15, v15, v47
    v_add_f32 v16, v16, v48
    v_add_f32 v17, v17, v49
    v_add_f32 v18, v18, v50
    v_add_f32 v19, v19, v51
    v_cvt_pk_bf16_f32 v20, v4, v5
    v_cvt_pk_bf16_f32 v21, v6, v7
    v_cvt_pk_bf16_f32 v22, v8, v9
    v_cvt_pk_bf16_f32 v23, v10, v11
    v_cvt_pk_bf16_f32 v24, v12, v13
    v_cvt_pk_bf16_f32 v25, v14, v15
    v_cvt_pk_bf16_f32 v26, v16, v17
    v_cvt_pk_bf16_f32 v27, v18, v19
    buffer_store_dwordx4 v[20:23], v76, s[76:79], 0 offen
    buffer_store_dwordx4 v[24:27], v77, s[76:79], 0 offen
L_postend_112:
    s_mov_b64 exec, -1

    s_bfe_u32 s3, s35, 0x40008
    s_cbranch_scc0 L_fend_115
    s_ff1_i32_b32 s41, s3
    s_add_u32 s3, s41, 8
    s_bitset0_b32 s35, s3
    s_mov_b32 s49, -1

    s_mul_i32 s28, s41, 3125
    s_add_u32 s29, s28, 3126
    s_add_u32 s28, s28, 1
    s_lshr_b32 s28, s28, 1
    s_lshr_b32 s29, s29, 1
    s_sub_u32 s29, s29, s28
    s_sub_u32 s5, s29, 782
    s_mul_i32 s3, s36, 6250
    v_add_u32 v78, s28, v0
    v_mov_b32 v82, 0x2000000
    v_add_u32 v79, 782, v78
    v_cmp_gt_u32 vcc, 782, v0
    v_add_u32 v76, s3, v78
    v_add_u32 v77, s3, v79
    v_cndmask_b32 v76, v82, v76, vcc
    v_cmp_gt_u32 vcc, s5, v0
    v_lshlrev_b32 v78, 4, v78
    v_lshlrev_b32 v79, 4, v79
    v_cndmask_b32 v77, v82, v77, vcc
    v_lshlrev_b32 v80, 2, v76
    v_lshlrev_b32 v76, 4, v76
    v_lshlrev_b32 v81, 2, v77
    v_lshlrev_b32 v77, 4, v77
    buffer_load_dword v80, v80, s[68:71], 0 offen
    buffer_load_dword v81, v81, s[68:71], 0 offen
    buffer_load_dwordx4 v[86:89], v76, s[8:11], 0 offen
    buffer_load_dwordx4 v[90:93], v77, s[8:11], 0 offen

    s_waitcnt vmcnt(2)
    v_lshlrev_b32_sdwa v82, 5, v80 dst_sel:DWORD dst_unused:UNUSED_PAD src0_sel:DWORD src1_sel:WORD_0
    v_lshlrev_b32_sdwa v83, 5, v80 dst_sel:DWORD dst_unused:UNUSED_PAD src0_sel:DWORD src1_sel:WORD_1
    v_lshlrev_b32_sdwa v84, 5, v81 dst_sel:DWORD dst_unused:UNUSED_PAD src0_sel:DWORD src1_sel:WORD_0
    v_lshlrev_b32_sdwa v85, 5, v81 dst_sel:DWORD dst_unused:UNUSED_PAD src0_sel:DWORD src1_sel:WORD_1
    buffer_load_dwordx4 v[94:97], v82, s[72:75], 0 offen
    buffer_load_dwordx2 v[110:111], v82, s[72:75], 0 offen offset:16

    buffer_load_dwordx4 v[98:101], v83, s[72:75], 0 offen
    buffer_load_dwordx2 v[112:113], v83, s[72:75], 0 offen offset:16

    buffer_load_dwordx4 v[102:105], v84, s[72:75], 0 offen
    buffer_load_dwordx2 v[114:115], v84, s[72:75], 0 offen offset:16

    buffer_load_dwordx4 v[106:109], v85, s[72:75], 0 offen
    buffer_load_dwordx2 v[116:117], v85, s[72:75], 0 offen offset:16

    s_branch L_post_111
L_fin_106:

    s_load_dwordx2 s[68:69], s[0:1], 24
    s_load_dwordx4 s[88:91], s[0:1], 72
    s_load_dwordx2 s[76:77], s[0:1], 88
    s_load_dwordx2 s[80:81], s[0:1], 96
    s_mov_b32 s70, 1600000
    s_mov_b32 s71, 0x20000
    s_mov_b32 s78, 6400000
    s_mov_b32 s79, 0x20000
    s_movk_i32 s82, 256
    s_mov_b32 s83, 0x20000
    s_lshl_b32 s48, s36, 2
    s_mov_b32 s41, s37

    s_add_u32 s84, s6, 8896512
    s_addc_u32 s85, s7, 0
    s_mov_b32 s86, 76800000
    s_mov_b32 s87, 0x20000
    s_add_u32 s72, s6, 393216
    s_addc_u32 s73, s7, 0
    s_mov_b32 s74, 2097152
    s_mov_b32 s75, 0x20000
    s_mov_b32 s49, -1
    s_waitcnt lgkmcnt(0)
    s_load_dwordx8 s[12:19], s[88:89], 0
    s_load_dwordx8 s[56:63], s[90:91], 0

    s_mul_i32 s28, s41, 3125
    s_add_u32 s29, s28, 3126
    s_add_u32 s28, s28, 1
    s_lshr_b32 s28, s28, 1
    s_lshr_b32 s29, s29, 1
    s_sub_u32 s29, s29, s28
    s_sub_u32 s5, s29, 782
    s_mul_i32 s3, s36, 6250
    v_add_u32 v78, s28, v0
    v_mov_b32 v82, 0x2000000
    v_add_u32 v79, 782, v78
    v_cmp_gt_u32 vcc, 782, v0
    v_add_u32 v76, s3, v78
    v_add_u32 v77, s3, v79
    v_cndmask_b32 v76, v82, v76, vcc
    v_cmp_gt_u32 vcc, s5, v0
    v_lshlrev_b32 v78, 4, v78
    v_lshlrev_b32 v79, 4, v79
    v_cndmask_b32 v77, v82, v77, vcc
    v_lshlrev_b32 v80, 2, v76
    v_lshlrev_b32 v76, 4, v76
    v_lshlrev_b32 v81, 2, v77
    v_lshlrev_b32 v77, 4, v77
    buffer_load_dword v80, v80, s[68:71], 0 offen
    buffer_load_dword v81, v81, s[68:71], 0 offen
    buffer_load_dwordx4 v[86:89], v76, s[8:11], 0 offen
    buffer_load_dwordx4 v[90:93], v77, s[8:11], 0 offen

    s_waitcnt vmcnt(2)
    v_lshlrev_b32_sdwa v82, 5, v80 dst_sel:DWORD dst_unused:UNUSED_PAD src0_sel:DWORD src1_sel:WORD_0
    v_lshlrev_b32_sdwa v83, 5, v80 dst_sel:DWORD dst_unused:UNUSED_PAD src0_sel:DWORD src1_sel:WORD_1
    v_lshlrev_b32_sdwa v84, 5, v81 dst_sel:DWORD dst_unused:UNUSED_PAD src0_sel:DWORD src1_sel:WORD_0
    v_lshlrev_b32_sdwa v85, 5, v81 dst_sel:DWORD dst_unused:UNUSED_PAD src0_sel:DWORD src1_sel:WORD_1
    buffer_load_dwordx4 v[94:97], v82, s[72:75], 0 offen
    buffer_load_dwordx2 v[110:111], v82, s[72:75], 0 offen offset:16

    buffer_load_dwordx4 v[98:101], v83, s[72:75], 0 offen
    buffer_load_dwordx2 v[112:113], v83, s[72:75], 0 offen offset:16

    buffer_load_dwordx4 v[102:105], v84, s[72:75], 0 offen
    buffer_load_dwordx2 v[114:115], v84, s[72:75], 0 offen offset:16

    buffer_load_dwordx4 v[106:109], v85, s[72:75], 0 offen
    buffer_load_dwordx2 v[116:117], v85, s[72:75], 0 offen offset:16

    s_waitcnt vmcnt(0) lgkmcnt(0)
    s_barrier
    s_branch L_meet_107
L_fend_115:

L_p2done_47:
    s_endpgm

L_ufix_57:
    v_and_b32 v117, 63, v0
    v_lshlrev_b32 v117, 2, v117
    s_sub_i32 s54, s42, 1024
    v_cmp_le_i32 vcc, s54, v117
    s_mov_b64 exec, vcc
    v_mov_b32 v12, 0
    v_mov_b32 v44, 0
    s_mov_b64 exec, -1
    s_sub_i32 s54, s42, 1025
    v_cmp_le_i32 vcc, s54, v117
    s_mov_b64 exec, vcc
    v_mov_b32 v13, 0
    v_mov_b32 v46, 0
    s_mov_b64 exec, -1
    s_sub_i32 s54, s42, 1026
    v_cmp_le_i32 vcc, s54, v117
    s_mov_b64 exec, vcc
    v_mov_b32 v14, 0
    v_mov_b32 v48, 0
    s_mov_b64 exec, -1
    s_sub_i32 s54, s42, 1027
    v_cmp_le_i32 vcc, s54, v117
    s_mov_b64 exec, vcc
    v_mov_b32 v15, 0
    v_mov_b32 v50, 0
    s_mov_b64 exec, -1
    s_branch L_uback_58
L_ufix_59:
    v_and_b32 v117, 63, v0
    v_lshlrev_b32 v117, 2, v117
    s_sub_i32 s54, s42, 1536
    v_cmp_le_i32 vcc, s54, v117
    s_mov_b64 exec, vcc
    v_mov_b32 v16, 0
    v_mov_b32 v52, 0
    s_mov_b64 exec, -1
    s_sub_i32 s54, s42, 1537
    v_cmp_le_i32 vcc, s54, v117
    s_mov_b64 exec, vcc
    v_mov_b32 v17, 0
    v_mov_b32 v54, 0
    s_mov_b64 exec, -1
    s_sub_i32 s54, s42, 1538
    v_cmp_le_i32 vcc, s54, v117
    s_mov_b64 exec, vcc
    v_mov_b32 v18, 0
    v_mov_b32 v56, 0
    s_mov_b64 exec, -1
    s_sub_i32 s54, s42, 1539
    v_cmp_le_i32 vcc, s54, v117
    s_mov_b64 exec, vcc
    v_mov_b32 v19, 0
    v_mov_b32 v58, 0
    s_mov_b64 exec, -1
    s_branch L_uback_60
L_ufix_61:
    v_and_b32 v117, 63, v0
    v_lshlrev_b32 v117, 2, v117
    s_sub_i32 s54, s42, 2048
    v_cmp_le_i32 vcc, s54, v117
    s_mov_b64 exec, vcc
    v_mov_b32 v20, 0
    v_mov_b32 v60, 0
    s_mov_b64 exec, -1
    s_sub_i32 s54, s42, 2049
    v_cmp_le_i32 vcc, s54, v117
    s_mov_b64 exec, vcc
    v_mov_b32 v21, 0
    v_mov_b32 v62, 0
    s_mov_b64 exec, -1
    s_sub_i32 s54, s42, 2050
    v_cmp_le_i32 vcc, s54, v117
    s_mov_b64 exec, vcc
    v_mov_b32 v22, 0
    v_mov_b32 v64, 0
    s_mov_b64 exec, -1
    s_sub_i32 s54, s42, 2051
    v_cmp_le_i32 vcc, s54, v117
    s_mov_b64 exec, vcc
    v_mov_b32 v23, 0
    v_mov_b32 v66, 0
    s_mov_b64 exec, -1
    s_branch L_uback_62
L_ufix_63:
    v_and_b32 v117, 63, v0
    v_lshlrev_b32 v117, 2, v117
    s_sub_i32 s54, s42, 2560
    v_cmp_le_i32 vcc, s54, v117
    s_mov_b64 exec, vcc
    v_mov_b32 v24, 0
    v_mov_b32 v68, 0
    s_mov_b64 exec, -1
    s_sub_i32 s54, s42, 2561
    v_cmp_le_i32 vcc, s54, v117
    s_mov_b64 exec, vcc
    v_mov_b32 v25, 0
    v_mov_b32 v70, 0
    s_mov_b64 exec, -1
    s_sub_i32 s54, s42, 2562
    v_cmp_le_i32 vcc, s54, v117
    s_mov_b64 exec, vcc
    v_mov_b32 v26, 0
    v_mov_b32 v72, 0
    s_mov_b64 exec, -1
    s_sub_i32 s54, s42, 2563
    v_cmp_le_i32 vcc, s54, v117
    s_mov_b64 exec, vcc
    v_mov_b32 v27, 0
    v_mov_b32 v74, 0
    s_mov_b64 exec, -1
    s_branch L_uback_64
L_ufix_65:
    v_and_b32 v117, 63, v0
    v_lshlrev_b32 v117, 2, v117
    s_sub_i32 s54, s42, 0
    v_cmp_le_i32 vcc, s54, v117
    s_mov_b64 exec, vcc
    v_mov_b32 v4, 0
    v_mov_b32 v28, 0
    s_mov_b64 exec, -1
    s_sub_i32 s54, s42, 1
    v_cmp_le_i32 vcc, s54, v117
    s_mov_b64 exec, vcc
    v_mov_b32 v5, 0
    v_mov_b32 v30, 0
    s_mov_b64 exec, -1
    s_sub_i32 s54, s42, 2
    v_cmp_le_i32 vcc, s54, v117
    s_mov_b64 exec, vcc
    v_mov_b32 v6, 0
    v_mov_b32 v32, 0
    s_mov_b64 exec, -1
    s_sub_i32 s54, s42, 3
    v_cmp_le_i32 vcc, s54, v117
    s_mov_b64 exec, vcc
    v_mov_b32 v7, 0
    v_mov_b32 v34, 0
    s_mov_b64 exec, -1
    s_branch L_uback_66
L_ufix_69:
    v_and_b32 v117, 63, v0
    v_lshlrev_b32 v117, 2, v117
    s_sub_i32 s54, s42, 512
    v_cmp_le_i32 vcc, s54, v117
    s_mov_b64 exec, vcc
    v_mov_b32 v8, 0
    v_mov_b32 v36, 0
    s_mov_b64 exec, -1
    s_sub_i32 s54, s42, 513
    v_cmp_le_i32 vcc, s54, v117
    s_mov_b64 exec, vcc
    v_mov_b32 v9, 0
    v_mov_b32 v38, 0
    s_mov_b64 exec, -1
    s_sub_i32 s54, s42, 514
    v_cmp_le_i32 vcc, s54, v117
    s_mov_b64 exec, vcc
    v_mov_b32 v10, 0
    v_mov_b32 v40, 0
    s_mov_b64 exec, -1
    s_sub_i32 s54, s42, 515
    v_cmp_le_i32 vcc, s54, v117
    s_mov_b64 exec, vcc
    v_mov_b32 v11, 0
    v_mov_b32 v42, 0
    s_mov_b64 exec, -1
    s_branch L_uback_70
L_ufix_79:
    v_and_b32 v117, 63, v0
    v_lshlrev_b32 v117, 2, v117
    s_sub_i32 s54, s42, 3072
    v_cmp_le_i32 vcc, s54, v117
    s_mov_b64 exec, vcc
    v_mov_b32 v106, 0
    v_mov_b32 v120, 0
    s_mov_b64 exec, -1
    s_sub_i32 s54, s42, 3073
    v_cmp_le_i32 vcc, s54, v117
    s_mov_b64 exec, vcc
    v_mov_b32 v107, 0
    v_mov_b32 v122, 0
    s_mov_b64 exec, -1
    s_sub_i32 s54, s42, 3074
    v_cmp_le_i32 vcc, s54, v117
    s_mov_b64 exec, vcc
    v_mov_b32 v108, 0
    v_mov_b32 v124, 0
    s_mov_b64 exec, -1
    s_sub_i32 s54, s42, 3075
    v_cmp_le_i32 vcc, s54, v117
    s_mov_b64 exec, vcc
    v_mov_b32 v109, 0
    v_mov_b32 v126, 0
    s_mov_b64 exec, -1
    s_branch L_uback_80
L_ufix_90:
    v_and_b32 v117, 63, v0
    v_lshlrev_b32 v117, 2, v117
    s_sub_i32 s54, s42, 1024
    v_cmp_le_i32 vcc, s54, v117
    s_mov_b64 exec, vcc
    v_mov_b32 v12, 0
    v_mov_b32 v44, 0
    s_mov_b64 exec, -1
    s_sub_i32 s54, s42, 1025
    v_cmp_le_i32 vcc, s54, v117
    s_mov_b64 exec, vcc
    v_mov_b32 v13, 0
    v_mov_b32 v46, 0
    s_mov_b64 exec, -1
    s_sub_i32 s54, s42, 1026
    v_cmp_le_i32 vcc, s54, v117
    s_mov_b64 exec, vcc
    v_mov_b32 v14, 0
    v_mov_b32 v48, 0
    s_mov_b64 exec, -1
    s_sub_i32 s54, s42, 1027
    v_cmp_le_i32 vcc, s54, v117
    s_mov_b64 exec, vcc
    v_mov_b32 v15, 0
    v_mov_b32 v50, 0
    s_mov_b64 exec, -1
    s_branch L_uback_91
L_ufix_93:
    v_and_b32 v117, 63, v0
    v_lshlrev_b32 v117, 2, v117
    s_sub_i32 s54, s42, 1536
    v_cmp_le_i32 vcc, s54, v117
    s_mov_b64 exec, vcc
    v_mov_b32 v16, 0
    v_mov_b32 v52, 0
    s_mov_b64 exec, -1
    s_sub_i32 s54, s42, 1537
    v_cmp_le_i32 vcc, s54, v117
    s_mov_b64 exec, vcc
    v_mov_b32 v17, 0
    v_mov_b32 v54, 0
    s_mov_b64 exec, -1
    s_sub_i32 s54, s42, 1538
    v_cmp_le_i32 vcc, s54, v117
    s_mov_b64 exec, vcc
    v_mov_b32 v18, 0
    v_mov_b32 v56, 0
    s_mov_b64 exec, -1
    s_sub_i32 s54, s42, 1539
    v_cmp_le_i32 vcc, s54, v117
    s_mov_b64 exec, vcc
    v_mov_b32 v19, 0
    v_mov_b32 v58, 0
    s_mov_b64 exec, -1
    s_branch L_uback_94
L_ufix_95:
    v_and_b32 v117, 63, v0
    v_lshlrev_b32 v117, 2, v117
    s_sub_i32 s54, s42, 2048
    v_cmp_le_i32 vcc, s54, v117
    s_mov_b64 exec, vcc
    v_mov_b32 v20, 0
    v_mov_b32 v60, 0
    s_mov_b64 exec, -1
    s_sub_i32 s54, s42, 2049
    v_cmp_le_i32 vcc, s54, v117
    s_mov_b64 exec, vcc
    v_mov_b32 v21, 0
    v_mov_b32 v62, 0
    s_mov_b64 exec, -1
    s_sub_i32 s54, s42, 2050
    v_cmp_le_i32 vcc, s54, v117
    s_mov_b64 exec, vcc
    v_mov_b32 v22, 0
    v_mov_b32 v64, 0
    s_mov_b64 exec, -1
    s_sub_i32 s54, s42, 2051
    v_cmp_le_i32 vcc, s54, v117
    s_mov_b64 exec, vcc
    v_mov_b32 v23, 0
    v_mov_b32 v66, 0
    s_mov_b64 exec, -1
    s_branch L_uback_96
L_ufix_97:
    v_and_b32 v117, 63, v0
    v_lshlrev_b32 v117, 2, v117
    s_sub_i32 s54, s42, 2560
    v_cmp_le_i32 vcc, s54, v117
    s_mov_b64 exec, vcc
    v_mov_b32 v24, 0
    v_mov_b32 v68, 0
    s_mov_b64 exec, -1
    s_sub_i32 s54, s42, 2561
    v_cmp_le_i32 vcc, s54, v117
    s_mov_b64 exec, vcc
    v_mov_b32 v25, 0
    v_mov_b32 v70, 0
    s_mov_b64 exec, -1
    s_sub_i32 s54, s42, 2562
    v_cmp_le_i32 vcc, s54, v117
    s_mov_b64 exec, vcc
    v_mov_b32 v26, 0
    v_mov_b32 v72, 0
    s_mov_b64 exec, -1
    s_sub_i32 s54, s42, 2563
    v_cmp_le_i32 vcc, s54, v117
    s_mov_b64 exec, vcc
    v_mov_b32 v27, 0
    v_mov_b32 v74, 0
    s_mov_b64 exec, -1
    s_branch L_uback_98
L_ufix_101:
    v_and_b32 v117, 63, v0
    v_lshlrev_b32 v117, 2, v117
    s_sub_i32 s54, s42, 0
    v_cmp_le_i32 vcc, s54, v117
    s_mov_b64 exec, vcc
    v_mov_b32 v4, 0
    v_mov_b32 v28, 0
    s_mov_b64 exec, -1
    s_sub_i32 s54, s42, 1
    v_cmp_le_i32 vcc, s54, v117
    s_mov_b64 exec, vcc
    v_mov_b32 v5, 0
    v_mov_b32 v30, 0
    s_mov_b64 exec, -1
    s_sub_i32 s54, s42, 2
    v_cmp_le_i32 vcc, s54, v117
    s_mov_b64 exec, vcc
    v_mov_b32 v6, 0
    v_mov_b32 v32, 0
    s_mov_b64 exec, -1
    s_sub_i32 s54, s42, 3
    v_cmp_le_i32 vcc, s54, v117
    s_mov_b64 exec, vcc
    v_mov_b32 v7, 0
    v_mov_b32 v34, 0
    s_mov_b64 exec, -1
    s_branch L_uback_102
L_ufix_103:
    v_and_b32 v117, 63, v0
    v_lshlrev_b32 v117, 2, v117
    s_sub_i32 s54, s42, 512
    v_cmp_le_i32 vcc, s54, v117
    s_mov_b64 exec, vcc
    v_mov_b32 v8, 0
    v_mov_b32 v36, 0
    s_mov_b64 exec, -1
    s_sub_i32 s54, s42, 513
    v_cmp_le_i32 vcc, s54, v117
    s_mov_b64 exec, vcc
    v_mov_b32 v9, 0
    v_mov_b32 v38, 0
    s_mov_b64 exec, -1
    s_sub_i32 s54, s42, 514
    v_cmp_le_i32 vcc, s54, v117
    s_mov_b64 exec, vcc
    v_mov_b32 v10, 0
    v_mov_b32 v40, 0
    s_mov_b64 exec, -1
    s_sub_i32 s54, s42, 515
    v_cmp_le_i32 vcc, s54, v117
    s_mov_b64 exec, vcc
    v_mov_b32 v11, 0
    v_mov_b32 v42, 0
    s_mov_b64 exec, -1
    s_branch L_uback_104
L_sync_114:
    v_and_b32 v40, 63, v0
    v_lshlrev_b32 v41, 20, v40
    v_mov_b32 v42, s33
    buffer_atomic_add v42, v41, s[80:83], s48 offen sc0
    s_waitcnt vmcnt(0)
    v_readfirstlane_b32 s4, v42
    s_movk_i32 s5, 400
    s_nop 0
    s_add_u32 s4, s4, s33
    s_bitcmp1_b32 s4, 2
    s_cbranch_scc1 L_tell_118
L_poll_116:
    s_sub_u32 s5, s5, 1
    s_cbranch_scc1 L_gave_117
    v_mov_b32 v42, 0
    buffer_atomic_add v42, v41, s[80:83], s48 offen sc0
    s_waitcnt vmcnt(0)
    v_readfirstlane_b32 s4, v42
    s_nop 1
    s_and_b32 s4, s4, 0xff
    s_bitcmp0_b32 s4, 2
    s_cbranch_scc1 L_poll_116
    s_branch L_tell_118
L_gave_117:
    s_cmp_lg_u32 s49, s37
    s_cbranch_scc1 L_gno_120
    v_add_lshl_u32 v40, v40, s28, 4
    s_mov_b32 s5, 0
L_gl_119:
    v_min_u32 v43, 100000, v40
    ds_read_b128 v[44:47], v43 offset:50000
    s_waitcnt lgkmcnt(0)
    buffer_store_dwordx4 v[44:47], v40, s[20:23], 0 offen sc1
    s_waitcnt vmcnt(0)
    v_add_u32 v40, 1024, v40
    s_add_u32 s5, s5, 64
    s_cmp_lt_u32 s5, s29
    s_cbranch_scc1 L_gl_119
L_gno_120:
    s_lshl_b32 s4, 0x100, s37
    v_mov_b32 v42, s4
    buffer_atomic_or v42, v41, s[80:83], s48 offen sc0
    s_waitcnt vmcnt(0)
    v_readfirstlane_b32 s4, v42
    s_nop 1
    s_and_b32 s4, s4, 0xff
    s_bitcmp1_b32 s4, 2
    s_cselect_b32 s4, s4, 0x10000
L_tell_118:
    v_mov_b32 v42, s4
    ds_write_b32 v118, v42
    s_waitcnt lgkmcnt(0)
    s_branch L_bcast_109

L_own_121:
    ds_read_b128 v[36:39], v78 offset:50000
    ds_read_b128 v[52:55], v79 offset:50000
    s_branch L_obk_122

L_own_123:
    ds_read_b128 v[40:43], v78 offset:50000
    ds_read_b128 v[56:59], v79 offset:50000
    s_branch L_obk_124

L_own_125:
    ds_read_b128 v[44:47], v78 offset:50000
    ds_read_b128 v[60:63], v79 offset:50000
    s_branch L_obk_126

L_own_127:
    ds_read_b128 v[48:51], v78 offset:50000
    ds_read_b128 v[64:67], v79 offset:50000
    s_branch L_obk_128

L_fgen_129:
    v_lshlrev_b32 v82, 1, v76
    v_lshlrev_b32 v83, 1, v77
    v_mov_b32 v4, 0
    v_mov_b32 v5, 0
    v_mov_b32 v6, 0
    v_mov_b32 v7, 0
    v_mov_b32 v8, 0
    v_mov_b32 v9, 0
    v_mov_b32 v10, 0
    v_mov_b32 v11, 0
    v_mov_b32 v12, 0
    v_mov_b32 v13, 0
    v_mov_b32 v14, 0
    v_mov_b32 v15, 0
    v_mov_b32 v16, 0
    v_mov_b32 v17, 0
    v_mov_b32 v18, 0
    v_mov_b32 v19, 0
    s_bitcmp1_b32 s35, 4
    s_cbranch_scc1 L_ffl_131
    v_cvt_f32_u32_sdwa v20, v36 dst_sel:DWORD dst_unused:UNUSED_PAD src0_sel:WORD_0
    v_cvt_f32_u32_sdwa v21, v36 dst_sel:DWORD dst_unused:UNUSED_PAD src0_sel:WORD_1
    v_cvt_f32_u32_sdwa v22, v37 dst_sel:DWORD dst_unused:UNUSED_PAD src0_sel:WORD_0
    v_cvt_f32_u32_sdwa v23, v37 dst_sel:DWORD dst_unused:UNUSED_PAD src0_sel:WORD_1
    v_cvt_f32_u32_sdwa v24, v38 dst_sel:DWORD dst_unused:UNUSED_PAD src0_sel:WORD_0
    v_cvt_f32_u32_sdwa v25, v38 dst_sel:DWORD dst_unused:UNUSED_PAD src0_sel:WORD_1
    v_cvt_f32_u32_sdwa v26, v39 dst_sel:DWORD dst_unused:UNUSED_PAD src0_sel:WORD_0
    v_cvt_f32_u32_sdwa v27, v39 dst_sel:DWORD dst_unused:UNUSED_PAD src0_sel:WORD_1
    v_cvt_f32_u32_sdwa v28, v52 dst_sel:DWORD dst_unused:UNUSED_PAD src0_sel:WORD_0
    v_cvt_f32_u32_sdwa v29, v52 dst_sel:DWORD dst_unused:UNUSED_PAD src0_sel:WORD_1
    v_cvt_f32_u32_sdwa v30, v53 dst_sel:DWORD dst_unused:UNUSED_PAD src0_sel:WORD_0
    v_cvt_f32_u32_sdwa v31, v53 dst_sel:DWORD dst_unused:UNUSED_PAD src0_sel:WORD_1
    v_cvt_f32_u32_sdwa v32, v54 dst_sel:DWORD dst_unused:UNUSED_PAD src0_sel:WORD_0
    v_cvt_f32_u32_sdwa v33, v54 dst_sel:DWORD dst_unused:UNUSED_PAD src0_sel:WORD_1
    v_cvt_f32_u32_sdwa v34, v55 dst_sel:DWORD dst_unused:UNUSED_PAD src0_sel:WORD_0
    v_cvt_f32_u32_sdwa v35, v55 dst_sel:DWORD dst_unused:UNUSED_PAD src0_sel:WORD_1
    v_add_f32 v20, 0xc6800000, v20
    v_fmac_f32 v4, s34, v20
    v_add_f32 v21, 0xc6800000, v21
    v_fmac_f32 v5, s34, v21
    v_add_f32 v22, 0xc6800000, v22
    v_fmac_f32 v6, s34, v22
    v_add_f32 v23, 0xc6800000, v23
    v_fmac_f32 v7, s34, v23
    v_add_f32 v24, 0xc6800000, v24
    v_fmac_f32 v8, s34, v24
    v_add_f32 v25, 0xc6800000, v25
    v_fmac_f32 v9, s34, v25
    v_add_f32 v26, 0xc6800000, v26
    v_fmac_f32 v10, s34, v26
    v_add_f32 v27, 0xc6800000, v27
    v_fmac_f32 v11, s34, v27
    v_add_f32 v28, 0xc6800000, v28
    v_fmac_f32 v12, s34, v28
    v_add_f32 v29, 0xc6800000, v29
    v_fmac_f32 v13, s34, v29
    v_add_f32 v30, 0xc6800000, v30
    v_fmac_f32 v14, s34, v30
    v_add_f32 v31, 0xc6800000, v31
    v_fmac_f32 v15, s34, v31
    v_add_f32 v32, 0xc6800000, v32
    v_fmac_f32 v16, s34, v32
    v_add_f32 v33, 0xc6800000, v33
    v_fmac_f32 v17, s34, v33
    v_add_f32 v34, 0xc6800000, v34
    v_fmac_f32 v18, s34, v34
    v_add_f32 v35, 0xc6800000, v35
    v_fmac_f32 v19, s34, v35
    s_branch L_fnx_132
L_ffl_131:
    s_mov_b32 s3, 25600000
    buffer_load_dwordx4 v[20:23], v82, s[84:87], s3 offen offset:0 sc1
    buffer_load_dwordx4 v[24:27], v82, s[84:87], s3 offen offset:16 sc1
    buffer_load_dwordx4 v[28:31], v83, s[84:87], s3 offen offset:0 sc1
    buffer_load_dwordx4 v[32:35], v83, s[84:87], s3 offen offset:16 sc1
    s_waitcnt vmcnt(0)
    v_add_f32 v4, v4, v20
    v_add_f32 v5, v5, v21
    v_add_f32 v6, v6, v22
    v_add_f32 v7, v7, v23
    v_add_f32 v8, v8, v24
    v_add_f32 v9, v9, v25
    v_add_f32 v10, v10, v26
    v_add_f32 v11, v11, v27
    v_add_f32 v12, v12, v28
    v_add_f32 v13, v13, v29
    v_add_f32 v14, v14, v30
    v_add_f32 v15, v15, v31
    v_add_f32 v16, v16, v32
    v_add_f32 v17, v17, v33
    v_add_f32 v18, v18, v34
    v_add_f32 v19, v19, v35
L_fnx_132:
    s_bitcmp1_b32 s35, 5
    s_cbranch_scc1 L_ffl_133
    v_cvt_f32_u32_sdwa v20, v40 dst_sel:DWORD dst_unused:UNUSED_PAD src0_sel:WORD_0
    v_cvt_f32_u32_sdwa v21, v40 dst_sel:DWORD dst_unused:UNUSED_PAD src0_sel:WORD_1
    v_cvt_f32_u32_sdwa v22, v41 dst_sel:DWORD dst_unused:UNUSED_PAD src0_sel:WORD_0
    v_cvt_f32_u32_sdwa v23, v41 dst_sel:DWORD dst_unused:UNUSED_PAD src0_sel:WORD_1
    v_cvt_f32_u32_sdwa v24, v42 dst_sel:DWORD dst_unused:UNUSED_PAD src0_sel:WORD_0
    v_cvt_f32_u32_sdwa v25, v42 dst_sel:DWORD dst_unused:UNUSED_PAD src0_sel:WORD_1
    v_cvt_f32_u32_sdwa v26, v43 dst_sel:DWORD dst_unused:UNUSED_PAD src0_sel:WORD_0
    v_cvt_f32_u32_sdwa v27, v43 dst_sel:DWORD dst_unused:UNUSED_PAD src0_sel:WORD_1
    v_cvt_f32_u32_sdwa v28, v56 dst_sel:DWORD dst_unused:UNUSED_PAD src0_sel:WORD_0
    v_cvt_f32_u32_sdwa v29, v56 dst_sel:DWORD dst_unused:UNUSED_PAD src0_sel:WORD_1
    v_cvt_f32_u32_sdwa v30, v57 dst_sel:DWORD dst_unused:UNUSED_PAD src0_sel:WORD_0
    v_cvt_f32_u32_sdwa v31, v57 dst_sel:DWORD dst_unused:UNUSED_PAD src0_sel:WORD_1
    v_cvt_f32_u32_sdwa v32, v58 dst_sel:DWORD dst_unused:UNUSED_PAD src0_sel:WORD_0
    v_cvt_f32_u32_sdwa v33, v58 dst_sel:DWORD dst_unused:UNUSED_PAD src0_sel:WORD_1
    v_cvt_f32_u32_sdwa v34, v59 dst_sel:DWORD dst_unused:UNUSED_PAD src0_sel:WORD_0
    v_cvt_f32_u32_sdwa v35, v59 dst_sel:DWORD dst_unused:UNUSED_PAD src0_sel:WORD_1
    v_add_f32 v20, 0xc6800000, v20
    v_fmac_f32 v4, s34, v20
    v_add_f32 v21, 0xc6800000, v21
    v_fmac_f32 v5, s34, v21
    v_add_f32 v22, 0xc6800000, v22
    v_fmac_f32 v6, s34, v22
    v_add_f32 v23, 0xc6800000, v23
    v_fmac_f32 v7, s34, v23
    v_add_f32 v24, 0xc6800000, v24
    v_fmac_f32 v8, s34, v24
    v_add_f32 v25, 0xc6800000, v25
    v_fmac_f32 v9, s34, v25
    v_add_f32 v26, 0xc6800000, v26
    v_fmac_f32 v10, s34, v26
    v_add_f32 v27, 0xc6800000, v27
    v_fmac_f32 v11, s34, v27
    v_add_f32 v28, 0xc6800000, v28
    v_fmac_f32 v12, s34, v28
    v_add_f32 v29, 0xc6800000, v29
    v_fmac_f32 v13, s34, v29
    v_add_f32 v30, 0xc6800000, v30
    v_fmac_f32 v14, s34, v30
    v_add_f32 v31, 0xc6800000, v31
    v_fmac_f32 v15, s34, v31
    v_add_f32 v32, 0xc6800000, v32
    v_fmac_f32 v16, s34, v32
    v_add_f32 v33, 0xc6800000, v33
    v_fmac_f32 v17, s34, v33
    v_add_f32 v34, 0xc6800000, v34
    v_fmac_f32 v18, s34, v34
    v_add_f32 v35, 0xc6800000, v35
    v_fmac_f32 v19, s34, v35
    s_branch L_fnx_134
L_ffl_133:
    s_mov_b32 s3, 38400000
    buffer_load_dwordx4 v[20:23], v82, s[84:87], s3 offen offset:0 sc1
    buffer_load_dwordx4 v[24:27], v82, s[84:87], s3 offen offset:16 sc1
    buffer_load_dwordx4 v[28:31], v83, s[84:87], s3 offen offset:0 sc1
    buffer_load_dwordx4 v[32:35], v83, s[84:87], s3 offen offset:16 sc1
    s_waitcnt vmcnt(0)
    v_add_f32 v4, v4, v20
    v_add_f32 v5, v5, v21
    v_add_f32 v6, v6, v22
    v_add_f32 v7, v7, v23
    v_add_f32 v8, v8, v24
    v_add_f32 v9, v9, v25
    v_add_f32 v10, v10, v26
    v_add_f32 v11, v11, v27
    v_add_f32 v12, v12, v28
    v_add_f32 v13, v13, v29
    v_add_f32 v14, v14, v30
    v_add_f32 v15, v15, v31
    v_add_f32 v16, v16, v32
    v_add_f32 v17, v17, v33
    v_add_f32 v18, v18, v34
    v_add_f32 v19, v19, v35
L_fnx_134:
    s_bitcmp1_b32 s35, 6
    s_cbranch_scc1 L_ffl_135
    v_cvt_f32_u32_sdwa v20, v44 dst_sel:DWORD dst_unused:UNUSED_PAD src0_sel:WORD_0
    v_cvt_f32_u32_sdwa v21, v44 dst_sel:DWORD dst_unused:UNUSED_PAD src0_sel:WORD_1
    v_cvt_f32_u32_sdwa v22, v45 dst_sel:DWORD dst_unused:UNUSED_PAD src0_sel:WORD_0
    v_cvt_f32_u32_sdwa v23, v45 dst_sel:DWORD dst_unused:UNUSED_PAD src0_sel:WORD_1
    v_cvt_f32_u32_sdwa v24, v46 dst_sel:DWORD dst_unused:UNUSED_PAD src0_sel:WORD_0
    v_cvt_f32_u32_sdwa v25, v46 dst_sel:DWORD dst_unused:UNUSED_PAD src0_sel:WORD_1
    v_cvt_f32_u32_sdwa v26, v47 dst_sel:DWORD dst_unused:UNUSED_PAD src0_sel:WORD_0
    v_cvt_f32_u32_sdwa v27, v47 dst_sel:DWORD dst_unused:UNUSED_PAD src0_sel:WORD_1
    v_cvt_f32_u32_sdwa v28, v60 dst_sel:DWORD dst_unused:UNUSED_PAD src0_sel:WORD_0
    v_cvt_f32_u32_sdwa v29, v60 dst_sel:DWORD dst_unused:UNUSED_PAD src0_sel:WORD_1
    v_cvt_f32_u32_sdwa v30, v61 dst_sel:DWORD dst_unused:UNUSED_PAD src0_sel:WORD_0
    v_cvt_f32_u32_sdwa v31, v61 dst_sel:DWORD dst_unused:UNUSED_PAD src0_sel:WORD_1
    v_cvt_f32_u32_sdwa v32, v62 dst_sel:DWORD dst_unused:UNUSED_PAD src0_sel:WORD_0
    v_cvt_f32_u32_sdwa v33, v62 dst_sel:DWORD dst_unused:UNUSED_PAD src0_sel:WORD_1
    v_cvt_f32_u32_sdwa v34, v63 dst_sel:DWORD dst_unused:UNUSED_PAD src0_sel:WORD_0
    v_cvt_f32_u32_sdwa v35, v63 dst_sel:DWORD dst_unused:UNUSED_PAD src0_sel:WORD_1
    v_add_f32 v20, 0xc6800000, v20
    v_fmac_f32 v4, s34, v20
    v_add_f32 v21, 0xc6800000, v21
    v_fmac_f32 v5, s34, v21
    v_add_f32 v22, 0xc6800000, v22
    v_fmac_f32 v6, s34, v22
    v_add_f32 v23, 0xc6800000, v23
    v_fmac_f32 v7, s34, v23
    v_add_f32 v24, 0xc6800000, v24
    v_fmac_f32 v8, s34, v24
    v_add_f32 v25, 0xc6800000, v25
    v_fmac_f32 v9, s34, v25
    v_add_f32 v26, 0xc6800000, v26
    v_fmac_f32 v10, s34, v26
    v_add_f32 v27, 0xc6800000, v27
    v_fmac_f32 v11, s34, v27
    v_add_f32 v28, 0xc6800000, v28
    v_fmac_f32 v12, s34, v28
    v_add_f32 v29, 0xc6800000, v29
    v_fmac_f32 v13, s34, v29
    v_add_f32 v30, 0xc6800000, v30
    v_fmac_f32 v14, s34, v30
    v_add_f32 v31, 0xc6800000, v31
    v_fmac_f32 v15, s34, v31
    v_add_f32 v32, 0xc6800000, v32
    v_fmac_f32 v16, s34, v32
    v_add_f32 v33, 0xc6800000, v33
    v_fmac_f32 v17, s34, v33
    v_add_f32 v34, 0xc6800000, v34
    v_fmac_f32 v18, s34, v34
    v_add_f32 v35, 0xc6800000, v35
    v_fmac_f32 v19, s34, v35
    s_branch L_fnx_136
L_ffl_135:
    s_mov_b32 s3, 51200000
    buffer_load_dwordx4 v[20:23], v82, s[84:87], s3 offen offset:0 sc1
    buffer_load_dwordx4 v[24:27], v82, s[84:87], s3 offen offset:16 sc1
    buffer_load_dwordx4 v[28:31], v83, s[84:87], s3 offen offset:0 sc1
    buffer_load_dwordx4 v[32:35], v83, s[84:87], s3 offen offset:16 sc1
    s_waitcnt vmcnt(0)
    v_add_f32 v4, v4, v20
    v_add_f32 v5, v5, v21
    v_add_f32 v6, v6, v22
    v_add_f32 v7, v7, v23
    v_add_f32 v8, v8, v24
    v_add_f32 v9, v9, v25
    v_add_f32 v10, v10, v26
    v_add_f32 v11, v11, v27
    v_add_f32 v12, v12, v28
    v_add_f32 v13, v13, v29
    v_add_f32 v14, v14, v30
    v_add_f32 v15, v15, v31
    v_add_f32 v16, v16, v32
    v_add_f32 v17, v17, v33
    v_add_f32 v18, v18, v34
    v_add_f32 v19, v19, v35
L_fnx_136:
    s_bitcmp1_b32 s35, 7
    s_cbranch_scc1 L_ffl_137
    v_cvt_f32_u32_sdwa v20, v48 dst_sel:DWORD dst_unused:UNUSED_PAD src0_sel:WORD_0
    v_cvt_f32_u32_sdwa v21, v48 dst_sel:DWORD dst_unused:UNUSED_PAD src0_sel:WORD_1
    v_cvt_f32_u32_sdwa v22, v49 dst_sel:DWORD dst_unused:UNUSED_PAD src0_sel:WORD_0
    v_cvt_f32_u32_sdwa v23, v49 dst_sel:DWORD dst_unused:UNUSED_PAD src0_sel:WORD_1
    v_cvt_f32_u32_sdwa v24, v50 dst_sel:DWORD dst_unused:UNUSED_PAD src0_sel:WORD_0
    v_cvt_f32_u32_sdwa v25, v50 dst_sel:DWORD dst_unused:UNUSED_PAD src0_sel:WORD_1
    v_cvt_f32_u32_sdwa v26, v51 dst_sel:DWORD dst_unused:UNUSED_PAD src0_sel:WORD_0
    v_cvt_f32_u32_sdwa v27, v51 dst_sel:DWORD dst_unused:UNUSED_PAD src0_sel:WORD_1
    v_cvt_f32_u32_sdwa v28, v64 dst_sel:DWORD dst_unused:UNUSED_PAD src0_sel:WORD_0
    v_cvt_f32_u32_sdwa v29, v64 dst_sel:DWORD dst_unused:UNUSED_PAD src0_sel:WORD_1
    v_cvt_f32_u32_sdwa v30, v65 dst_sel:DWORD dst_unused:UNUSED_PAD src0_sel:WORD_0
    v_cvt_f32_u32_sdwa v31, v65 dst_sel:DWORD dst_unused:UNUSED_PAD src0_sel:WORD_1
    v_cvt_f32_u32_sdwa v32, v66 dst_sel:DWORD dst_unused:UNUSED_PAD src0_sel:WORD_0
    v_cvt_f32_u32_sdwa v33, v66 dst_sel:DWORD dst_unused:UNUSED_PAD src0_sel:WORD_1
    v_cvt_f32_u32_sdwa v34, v67 dst_sel:DWORD dst_unused:UNUSED_PAD src0_sel:WORD_0
    v_cvt_f32_u32_sdwa v35, v67 dst_sel:DWORD dst_unused:UNUSED_PAD src0_sel:WORD_1
    v_add_f32 v20, 0xc6800000, v20
    v_fmac_f32 v4, s34, v20
    v_add_f32 v21, 0xc6800000, v21
    v_fmac_f32 v5, s34, v21
    v_add_f32 v22, 0xc6800000, v22
    v_fmac_f32 v6, s34, v22
    v_add_f32 v23, 0xc6800000, v23
    v_fmac_f32 v7, s34, v23
    v_add_f32 v24, 0xc6800000, v24
    v_fmac_f32 v8, s34, v24
    v_add_f32 v25, 0xc6800000, v25
    v_fmac_f32 v9, s34, v25
    v_add_f32 v26, 0xc6800000, v26
    v_fmac_f32 v10, s34, v26
    v_add_f32 v27, 0xc6800000, v27
    v_fmac_f32 v11, s34, v27
    v_add_f32 v28, 0xc6800000, v28
    v_fmac_f32 v12, s34, v28
    v_add_f32 v29, 0xc6800000, v29
    v_fmac_f32 v13, s34, v29
    v_add_f32 v30, 0xc6800000, v30
    v_fmac_f32 v14, s34, v30
    v_add_f32 v31, 0xc6800000, v31
    v_fmac_f32 v15, s34, v31
    v_add_f32 v32, 0xc6800000, v32
    v_fmac_f32 v16, s34, v32
    v_add_f32 v33, 0xc6800000, v33
    v_fmac_f32 v17, s34, v33
    v_add_f32 v34, 0xc6800000, v34
    v_fmac_f32 v18, s34, v34
    v_add_f32 v35, 0xc6800000, v35
    v_fmac_f32 v19, s34, v35
    s_branch L_fnx_138
L_ffl_137:
    s_mov_b32 s3, 64000000
    buffer_load_dwordx4 v[20:23], v82, s[84:87], s3 offen offset:0 sc1
    buffer_load_dwordx4 v[24:27], v82, s[84:87], s3 offen offset:16 sc1
    buffer_load_dwordx4 v[28:31], v83, s[84:87], s3 offen offset:0 sc1
    buffer_load_dwordx4 v[32:35], v83, s[84:87], s3 offen offset:16 sc1
    s_waitcnt vmcnt(0)
    v_add_f32 v4, v4, v20
    v_add_f32 v5, v5, v21
    v_add_f32 v6, v6, v22
    v_add_f32 v7, v7, v23
    v_add_f32 v8, v8, v24
    v_add_f32 v9, v9, v25
    v_add_f32 v10, v10, v26
    v_add_f32 v11, v11, v27
    v_add_f32 v12, v12, v28
    v_add_f32 v13, v13, v29
    v_add_f32 v14, v14, v30
    v_add_f32 v15, v15, v31
    v_add_f32 v16, v16, v32
    v_add_f32 v17, v17, v33
    v_add_f32 v18, v18, v34
    v_add_f32 v19, v19, v35
L_fnx_138:
    s_branch L_fbk_130
L_p2slow_48:
    s_waitcnt vmcnt(0) lgkmcnt(0)
    s_mov_b32 s51, 0
    s_movk_i32 s43, 6250
L_sweep_139:
    s_barrier

    v_mov_b32 v28, 0x0
    v_mov_b32 v29, 0x0
    v_mov_b32 v30, 0x0
    v_mov_b32 v31, 0x0
    v_add_u32 v32, 50000, v3
    v_add_u32 v33, 65536, v32

    ds_write_b128 v32, v[28:31] offset:0
    ds_write_b128 v32, v[28:31] offset:16384
    ds_write_b128 v32, v[28:31] offset:32768
    ds_write_b128 v32, v[28:31] offset:49152
    ds_write_b128 v33, v[28:31] offset:0
    ds_write_b128 v33, v[28:31] offset:16384
    v_cmp_gt_u32 vcc, 971, v0
    s_mov_b64 exec, vcc
    ds_write_b128 v33, v[28:31] offset:32768
    s_mov_b64 exec, -1
    s_mov_b32 s3, 32768
    s_load_dword s40, s[6:7], s3
    s_waitcnt lgkmcnt(0)
    s_barrier
    s_cmp_lg_u32 s40, 0
    s_cbranch_scc1 L_raw_144
    s_sub_u32 s38, s4, 8
L_sbatch_140:
    s_lshl_b32 s52, s36, 5
    s_add_u32 s52, s52, s38
    s_lshr_b32 s52, s52, 1
    s_lshl_b32 s52, s52, 2
    s_load_dword s40, s[46:47], s52
    s_mul_i32 s50, s38, 200000
    s_and_b32 s3, s38, 1
    s_lshl_b32 s3, s3, 4
    s_or_b32 s3, s3, 0x100000
    s_waitcnt lgkmcnt(0)
    s_bfe_u32 s40, s40, s3

    s_min_u32 s40, s40, 6524
    s_lshl_b32 s52, s38, 6
    s_add_u32 s52, s52, s36
    s_mul_i32 s52, s52, 32764
    s_and_b32 s52, s52, 0xffffff80
    s_add_u32 s20, s44, s52
    s_addc_u32 s21, s45, 0
    s_mul_i32 s52, s40, 5
    s_add_u32 s52, s52, 3
    s_and_b32 s22, s52, -4

    s_lshr_b32 s55, s39, 2
    s_add_u32 s55, s55, 0
    v_and_b32 v36, 63, v0
    v_add_u32 v36, s55, v36
L_left_145:
    s_cmp_ge_u32 s55, s40
    s_cbranch_scc1 L_leftend_146
    v_mul_u32_u24 v37, 5, v36
    buffer_load_dword v38, v37, s[20:23], 0 offen offset:1
    buffer_load_ubyte v39, v37, s[20:23], 0 offen
    s_waitcnt vmcnt(0)

    v_perm_b32 v37, v39, v38, s24
    v_lshrrev_b32 v42, 30, v38
    v_and_b32 v37, 0x1fff, v37
    v_mul_u32_u24 v42, 6250, v42
    v_add_lshl_u32 v37, v37, v42, 3

    buffer_load_dwordx2 v[40:41], v37, s[8:11], s50 offen
    v_cmp_gt_u32 vcc, s40, v36
    s_waitcnt vmcnt(0)

    v_bfe_u32 v44, v38, 16, 14
    v_subrev_u32 v44, s51, v44
    v_cmp_gt_u32 s[64:65], s43, v44
    s_and_b64 exec, vcc, s[64:65]
    v_lshlrev_b32 v45, 16, v38
    v_cmpx_ne_u32 vcc, 0, v45
    v_lshlrev_b32 v44, 4, v44
    v_bfe_i32 v38, v38, 0, 16
    v_cvt_f32_i32 v38, v38
    v_mul_f32 v38, 0x38004020, v38
    v_lshlrev_b32 v45, 16, v40
    v_and_b32 v46, s32, v40
    v_lshlrev_b32 v47, 16, v41
    v_and_b32 v48, s32, v41

    v_mul_f32 v45, v45, v38
    ds_add_f32 v44, v45 offset:50000
    v_mul_f32 v46, v46, v38
    ds_add_f32 v44, v46 offset:50004
    v_mul_f32 v47, v47, v38
    ds_add_f32 v44, v47 offset:50008
    v_mul_f32 v48, v48, v38
    ds_add_f32 v44, v48 offset:50012
    s_mov_b64 exec, -1
    v_add_u32 v36, 128, v36
    s_add_u32 s55, s55, 128
    s_branch L_left_145
L_leftend_146:

    s_add_u32 s38, s38, 1
    s_cmp_lt_u32 s38, s4
    s_cbranch_scc1 L_sbatch_140
    s_branch L_swend_142

L_raw_144:
    s_load_dwordx2 s[68:69], s[0:1], 8
    s_load_dwordx2 s[72:73], s[0:1], 16
    s_load_dwordx2 s[76:77], s[0:1], 32
    s_load_dwordx2 s[80:81], s[0:1], 48
    s_mov_b32 s70, 204800000
    s_mov_b32 s71, 0x20000
    s_mov_b32 s74, 204800000
    s_mov_b32 s75, 0x20000
    s_mov_b32 s78, 102400000
    s_mov_b32 s79, 0x20000
    s_waitcnt lgkmcnt(0)
    s_load_dword s82, s[80:81], 0
    s_mul_i32 s83, s36, 12500
    s_add_u32 s83, s83, s51
    s_mul_i32 s84, s37, 200000
    s_mov_b32 s85, 200000
    s_mov_b32 s38, 0
    v_lshlrev_b32 v44, 5, v0
    v_mov_b32 v45, 0.15915494
    s_waitcnt lgkmcnt(0)
    s_lshl_b32 s82, s82, 16
    v_mul_f32 v45, s82, v45
L_rawl_141:
    s_lshr_b32 s3, s38, 1
    buffer_load_dwordx4 v[46:49], v44, s[72:75], s38 offen
    buffer_load_dwordx4 v[50:53], v44, s[72:75], s38 offen offset:16
    buffer_load_dwordx4 v[54:57], v44, s[68:71], s38 offen
    buffer_load_dwordx4 v[58:61], v44, s[68:71], s38 offen offset:16
    buffer_load_dwordx4 v[62:65], v3, s[76:79], s3 offen
    s_waitcnt vmcnt(1)

    v_subrev_u32 v46, s83, v46
    v_subrev_u32 v82, s84, v54
    v_cmp_gt_u32 vcc, s43, v46
    v_cmp_gt_u32 s[64:65], s85, v82
    v_lshlrev_b32 v54, 3, v54
    s_nand_b64 exec, vcc, s[64:65]
    v_bfrev_b32 v54, 1
    s_mov_b64 exec, -1
    buffer_load_dwordx2 v[66:67], v54, s[8:11], 0 offen

    v_subrev_u32 v47, s83, v47
    v_subrev_u32 v82, s84, v55
    v_cmp_gt_u32 vcc, s43, v47
    v_cmp_gt_u32 s[64:65], s85, v82
    v_lshlrev_b32 v55, 3, v55
    s_nand_b64 exec, vcc, s[64:65]
    v_bfrev_b32 v55, 1
    s_mov_b64 exec, -1
    buffer_load_dwordx2 v[68:69], v55, s[8:11], 0 offen

    v_subrev_u32 v48, s83, v48
    v_subrev_u32 v82, s84, v56
    v_cmp_gt_u32 vcc, s43, v48
    v_cmp_gt_u32 s[64:65], s85, v82
    v_lshlrev_b32 v56, 3, v56
    s_nand_b64 exec, vcc, s[64:65]
    v_bfrev_b32 v56, 1
    s_mov_b64 exec, -1
    buffer_load_dwordx2 v[70:71], v56, s[8:11], 0 offen

    v_subrev_u32 v49, s83, v49
    v_subrev_u32 v82, s84, v57
    v_cmp_gt_u32 vcc, s43, v49
    v_cmp_gt_u32 s[64:65], s85, v82
    v_lshlrev_b32 v57, 3, v57
    s_nand_b64 exec, vcc, s[64:65]
    v_bfrev_b32 v57, 1
    s_mov_b64 exec, -1
    buffer_load_dwordx2 v[72:73], v57, s[8:11], 0 offen

    v_subrev_u32 v50, s83, v50
    v_subrev_u32 v82, s84, v58
    v_cmp_gt_u32 vcc, s43, v50
    v_cmp_gt_u32 s[64:65], s85, v82
    v_lshlrev_b32 v58, 3, v58
    s_nand_b64 exec, vcc, s[64:65]
    v_bfrev_b32 v58, 1
    s_mov_b64 exec, -1
    buffer_load_dwordx2 v[74:75], v58, s[8:11], 0 offen

    v_subrev_u32 v51, s83, v51
    v_subrev_u32 v82, s84, v59
    v_cmp_gt_u32 vcc, s43, v51
    v_cmp_gt_u32 s[64:65], s85, v82
    v_lshlrev_b32 v59, 3, v59
    s_nand_b64 exec, vcc, s[64:65]
    v_bfrev_b32 v59, 1
    s_mov_b64 exec, -1
    buffer_load_dwordx2 v[76:77], v59, s[8:11], 0 offen

    v_subrev_u32 v52, s83, v52
    v_subrev_u32 v82, s84, v60
    v_cmp_gt_u32 vcc, s43, v52
    v_cmp_gt_u32 s[64:65], s85, v82
    v_lshlrev_b32 v60, 3, v60
    s_nand_b64 exec, vcc, s[64:65]
    v_bfrev_b32 v60, 1
    s_mov_b64 exec, -1
    buffer_load_dwordx2 v[78:79], v60, s[8:11], 0 offen

    v_subrev_u32 v53, s83, v53
    v_subrev_u32 v82, s84, v61
    v_cmp_gt_u32 vcc, s43, v53
    v_cmp_gt_u32 s[64:65], s85, v82
    v_lshlrev_b32 v61, 3, v61
    s_nand_b64 exec, vcc, s[64:65]
    v_bfrev_b32 v61, 1
    s_mov_b64 exec, -1
    buffer_load_dwordx2 v[80:81], v61, s[8:11], 0 offen

    s_waitcnt vmcnt(0)
    v_cmp_le_i32 vcc, 0, v54
    s_mov_b64 exec, vcc
    s_cbranch_execz L_rsk_147
    v_lshlrev_b32 v82, 16, v62
    v_mul_f32 v82, v82, v45
    v_fract_f32 v82, v82
    v_cos_f32 v82, v82
    v_lshlrev_b32 v46, 4, v46
    v_lshlrev_b32 v83, 16, v66
    v_and_b32 v84, s32, v66
    v_lshlrev_b32 v85, 16, v67
    v_and_b32 v86, s32, v67

    v_mul_f32 v83, v83, v82
    ds_add_f32 v46, v83 offset:50000
    v_mul_f32 v84, v84, v82
    ds_add_f32 v46, v84 offset:50004
    v_mul_f32 v85, v85, v82
    ds_add_f32 v46, v85 offset:50008
    v_mul_f32 v86, v86, v82
    ds_add_f32 v46, v86 offset:50012
L_rsk_147:
    s_mov_b64 exec, -1
    v_cmp_le_i32 vcc, 0, v55
    s_mov_b64 exec, vcc
    s_cbranch_execz L_rsk_148
    v_and_b32 v82, s32, v62
    v_mul_f32 v82, v82, v45
    v_fract_f32 v82, v82
    v_cos_f32 v82, v82
    v_lshlrev_b32 v47, 4, v47
    v_lshlrev_b32 v83, 16, v68
    v_and_b32 v84, s32, v68
    v_lshlrev_b32 v85, 16, v69
    v_and_b32 v86, s32, v69

    v_mul_f32 v83, v83, v82
    ds_add_f32 v47, v83 offset:50000
    v_mul_f32 v84, v84, v82
    ds_add_f32 v47, v84 offset:50004
    v_mul_f32 v85, v85, v82
    ds_add_f32 v47, v85 offset:50008
    v_mul_f32 v86, v86, v82
    ds_add_f32 v47, v86 offset:50012
L_rsk_148:
    s_mov_b64 exec, -1
    v_cmp_le_i32 vcc, 0, v56
    s_mov_b64 exec, vcc
    s_cbranch_execz L_rsk_149
    v_lshlrev_b32 v82, 16, v63
    v_mul_f32 v82, v82, v45
    v_fract_f32 v82, v82
    v_cos_f32 v82, v82
    v_lshlrev_b32 v48, 4, v48
    v_lshlrev_b32 v83, 16, v70
    v_and_b32 v84, s32, v70
    v_lshlrev_b32 v85, 16, v71
    v_and_b32 v86, s32, v71

    v_mul_f32 v83, v83, v82
    ds_add_f32 v48, v83 offset:50000
    v_mul_f32 v84, v84, v82
    ds_add_f32 v48, v84 offset:50004
    v_mul_f32 v85, v85, v82
    ds_add_f32 v48, v85 offset:50008
    v_mul_f32 v86, v86, v82
    ds_add_f32 v48, v86 offset:50012
L_rsk_149:
    s_mov_b64 exec, -1
    v_cmp_le_i32 vcc, 0, v57
    s_mov_b64 exec, vcc
    s_cbranch_execz L_rsk_150
    v_and_b32 v82, s32, v63
    v_mul_f32 v82, v82, v45
    v_fract_f32 v82, v82
    v_cos_f32 v82, v82
    v_lshlrev_b32 v49, 4, v49
    v_lshlrev_b32 v83, 16, v72
    v_and_b32 v84, s32, v72
    v_lshlrev_b32 v85, 16, v73
    v_and_b32 v86, s32, v73

    v_mul_f32 v83, v83, v82
    ds_add_f32 v49, v83 offset:50000
    v_mul_f32 v84, v84, v82
    ds_add_f32 v49, v84 offset:50004
    v_mul_f32 v85, v85, v82
    ds_add_f32 v49, v85 offset:50008
    v_mul_f32 v86, v86, v82
    ds_add_f32 v49, v86 offset:50012
L_rsk_150:
    s_mov_b64 exec, -1
    v_cmp_le_i32 vcc, 0, v58
    s_mov_b64 exec, vcc
    s_cbranch_execz L_rsk_151
    v_lshlrev_b32 v82, 16, v64
    v_mul_f32 v82, v82, v45
    v_fract_f32 v82, v82
    v_cos_f32 v82, v82
    v_lshlrev_b32 v50, 4, v50
    v_lshlrev_b32 v83, 16, v74
    v_and_b32 v84, s32, v74
    v_lshlrev_b32 v85, 16, v75
    v_and_b32 v86, s32, v75

    v_mul_f32 v83, v83, v82
    ds_add_f32 v50, v83 offset:50000
    v_mul_f32 v84, v84, v82
    ds_add_f32 v50, v84 offset:50004
    v_mul_f32 v85, v85, v82
    ds_add_f32 v50, v85 offset:50008
    v_mul_f32 v86, v86, v82
    ds_add_f32 v50, v86 offset:50012
L_rsk_151:
    s_mov_b64 exec, -1
    v_cmp_le_i32 vcc, 0, v59
    s_mov_b64 exec, vcc
    s_cbranch_execz L_rsk_152
    v_and_b32 v82, s32, v64
    v_mul_f32 v82, v82, v45
    v_fract_f32 v82, v82
    v_cos_f32 v82, v82
    v_lshlrev_b32 v51, 4, v51
    v_lshlrev_b32 v83, 16, v76
    v_and_b32 v84, s32, v76
    v_lshlrev_b32 v85, 16, v77
    v_and_b32 v86, s32, v77

    v_mul_f32 v83, v83, v82
    ds_add_f32 v51, v83 offset:50000
    v_mul_f32 v84, v84, v82
    ds_add_f32 v51, v84 offset:50004
    v_mul_f32 v85, v85, v82
    ds_add_f32 v51, v85 offset:50008
    v_mul_f32 v86, v86, v82
    ds_add_f32 v51, v86 offset:50012
L_rsk_152:
    s_mov_b64 exec, -1
    v_cmp_le_i32 vcc, 0, v60
    s_mov_b64 exec, vcc
    s_cbranch_execz L_rsk_153
    v_lshlrev_b32 v82, 16, v65
    v_mul_f32 v82, v82, v45
    v_fract_f32 v82, v82
    v_cos_f32 v82, v82
    v_lshlrev_b32 v52, 4, v52
    v_lshlrev_b32 v83, 16, v78
    v_and_b32 v84, s32, v78
    v_lshlrev_b32 v85, 16, v79
    v_and_b32 v86, s32, v79

    v_mul_f32 v83, v83, v82
    ds_add_f32 v52, v83 offset:50000
    v_mul_f32 v84, v84, v82
    ds_add_f32 v52, v84 offset:50004
    v_mul_f32 v85, v85, v82
    ds_add_f32 v52, v85 offset:50008
    v_mul_f32 v86, v86, v82
    ds_add_f32 v52, v86 offset:50012
L_rsk_153:
    s_mov_b64 exec, -1
    v_cmp_le_i32 vcc, 0, v61
    s_mov_b64 exec, vcc
    s_cbranch_execz L_rsk_154
    v_and_b32 v82, s32, v65
    v_mul_f32 v82, v82, v45
    v_fract_f32 v82, v82
    v_cos_f32 v82, v82
    v_lshlrev_b32 v53, 4, v53
    v_lshlrev_b32 v83, 16, v80
    v_and_b32 v84, s32, v80
    v_lshlrev_b32 v85, 16, v81
    v_and_b32 v86, s32, v81

    v_mul_f32 v83, v83, v82
    ds_add_f32 v53, v83 offset:50000
    v_mul_f32 v84, v84, v82
    ds_add_f32 v53, v84 offset:50004
    v_mul_f32 v85, v85, v82
    ds_add_f32 v53, v85 offset:50008
    v_mul_f32 v86, v86, v82
    ds_add_f32 v53, v86 offset:50012
L_rsk_154:
    s_mov_b64 exec, -1
    s_add_u32 s38, s38, 32768
    s_cmp_lt_u32 s38, 204800000
    s_cbranch_scc1 L_rawl_141
L_swend_142:
    s_waitcnt lgkmcnt(0)
    s_barrier
    s_mul_i32 s3, s37, 800000
    s_mul_i32 s5, s36, 12500
    s_add_u32 s3, s3, s5
    s_add_u32 s3, s3, s51
    s_lshl_b32 s3, s3, 4
    s_add_u32 s3, s3, 34496512

    s_add_u32 s20, s6, s3
    s_addc_u32 s21, s7, 0
    s_mov_b32 s22, 100000
    s_mov_b32 s23, 0x20000
    v_mov_b32 v36, v3
    s_mov_b32 s38, 0
L_wl_143:
    v_min_u32 v37, 100000, v36
    ds_read_b128 v[28:31], v37 offset:50000
    s_waitcnt lgkmcnt(0)
    buffer_store_dwordx4 v[28:31], v36, s[20:23], 0 offen sc1
    s_waitcnt vmcnt(0)
    v_add_u32 v36, 16384, v36
    s_add_u32 s38, s38, 1024
    s_cmp_lt_u32 s38, 6250
    s_cbranch_scc1 L_wl_143
    s_add_u32 s51, s51, 6250
    s_cmp_lt_u32 s51, 12500
    s_cbranch_scc1 L_sweep_139
    s_lshl_b32 s33, 16, s37
    s_add_u32 s33, s33, 1
    s_branch L_fin_106

.section .rodata,"a"
.p2align 6
.amdhsa_kernel g1_kernel
  .amdhsa_next_free_vgpr 128
  .amdhsa_next_free_sgpr 102
  .amdhsa_accum_offset 128
  .amdhsa_group_segment_fixed_size 0
  .amdhsa_kernarg_size 112
  .amdhsa_user_sgpr_count 2
  .amdhsa_user_sgpr_kernarg_segment_ptr 1
  .amdhsa_system_sgpr_workgroup_id_x 1
  .amdhsa_float_denorm_mode_32 3
.end_amdhsa_kernel
.p2align 6
.amdhsa_kernel standalone__molecular_angular_gemnet__graph_kernel
  .amdhsa_next_free_vgpr 128
  .amdhsa_next_free_sgpr 102
  .amdhsa_accum_offset 128
  .amdhsa_group_segment_fixed_size 0
  .amdhsa_kernarg_size 112
  .amdhsa_user_sgpr_count 2
  .amdhsa_user_sgpr_kernarg_segment_ptr 1
  .amdhsa_system_sgpr_workgroup_id_x 1
  .amdhsa_float_denorm_mode_32 3
.end_amdhsa_kernel
```

```asm
; @launch kernel=g1_kernel grid=(256,1,1) block=(1024,1,1) lds=163840
; @launch kernel=standalone__molecular_angular_gemnet__graph_kernel grid=(256,1,1) block=(1024,1,1) lds=163840
.amdgcn_target "amdgcn-amd-amdhsa--gfx950"
.text
.globl g1_kernel
.p2align 8
.type g1_kernel,@function
g1_kernel:
    s_cmp_ge_u32 s2, 256
    s_cbranch_scc1 L_p1done_1
    s_load_dwordx4 s[80:83], s[0:1], 8
    s_load_dwordx2 s[84:85], s[0:1], 32
    s_load_dwordx2 s[86:87], s[0:1], 48
    s_load_dwordx4 s[4:7], s[0:1], 96
    s_load_dwordx2 s[78:79], s[0:1], 0
    v_lshlrev_b32 v1, 4, v0
    v_lshlrev_b32 v2, 3, v0
    v_lshlrev_b32 v98, 20, v0
    v_mov_b32 v108, 24576
    v_mov_b32 v110, 0
    v_mov_b32 v111, 0
    ds_write_b64 v2, v[110:111]
    s_mov_b64 exec, 1
    ds_write_b32 v108, v110
    s_mov_b64 exec, -1
    s_waitcnt lgkmcnt(0)
    s_load_dword s88, s[86:87], 0

    s_mov_b32 s96, s4
    s_mov_b32 s97, s5
    s_mov_b32 s98, 256
    s_mov_b32 s99, 0x20000
    v_readfirstlane_b32 s74, v0
    s_nop 1
    s_or_b32 s74, s74, s2
    s_cbranch_scc1 L_noinit_2

    v_mov_b32 v110, 1
    buffer_atomic_add v110, v98, s[96:99], 0 offen offset:64 sc0
    s_waitcnt vmcnt(0)
    v_readfirstlane_b32 s74, v110
    s_nop 1
    s_cmp_lg_u32 s74, 0
    s_cbranch_scc1 L_zno_4

    s_mov_b32 s92, s6
    s_mov_b32 s93, s7
    s_mov_b32 s94, 32784
    s_mov_b32 s95, 0x20000
    v_mov_b32 v110, 0
    v_mov_b32 v111, 0
    v_mov_b32 v112, 0
    v_mov_b32 v113, 0
L_zl_3:
    buffer_store_dwordx4 v[110:113], v1, s[92:95], s74 offen sc0 sc1
    s_add_u32 s74, s74, 1024
    s_cmp_le_u32 s74, 32768
    s_cbranch_scc1 L_zl_3
    v_mov_b32 v114, 1
    s_waitcnt vmcnt(0)
    buffer_atomic_add v114, v98, s[96:99], 0 offen offset:128
L_zno_4:

L_noinit_2:
    s_barrier
    s_mov_b32 s20, s78
    s_mov_b32 s21, s79
    s_mov_b32 s22, 6400000
    s_mov_b32 s23, 0x20000
    v_lshrrev_b32 v110, 3, v0
    v_and_b32 v111, 7, v0
    v_mul_u32_u24 v110, 49920, v110
    v_lshl_add_u32 v110, v111, 4, v110
    v_and_b32 v111, 63, v0
    v_and_b32 v112, 0x3c0, v0
    v_lshlrev_b32 v111, 2, v111
    v_lshl_or_b32 v111, v112, 4, v111
    v_lshlrev_b32 v100, 2, v0
    s_lshr_b32 s50, s2, 1
    s_and_b32 s53, s2, 1
    s_mul_i32 s3, s50, 50000
    s_mul_i32 s54, s53, 24576
    s_add_u32 s3, s3, s54

    buffer_load_dwordx4 v[56:59], v110, s[20:23], 0 offen
    s_add_u32 s20, s78, s3
    s_addc_u32 s21, s79, 0
    s_mov_b32 s22, 24576
    s_mov_b32 s23, 0x20000
    s_movk_i32 s3, 16384
    buffer_load_dword v116, v111, s[20:23], 0 offen offset:0
    buffer_load_dword v117, v111, s[20:23], 0 offen offset:256
    buffer_load_dword v118, v111, s[20:23], 0 offen offset:512
    buffer_load_dword v119, v111, s[20:23], 0 offen offset:768
    buffer_load_dword v120, v111, s[20:23], s3 offen offset:0
    buffer_load_dword v121, v111, s[20:23], s3 offen offset:256
    buffer_load_dword v122, v111, s[20:23], s3 offen offset:512
    buffer_load_dword v123, v111, s[20:23], s3 offen offset:768
    s_mul_i32 s22, s53, 25424
    s_movk_i32 s3, 24576

    buffer_load_dword v124, v100, s[20:23], s3 offen
    s_mul_i32 s3, s50, 50048
    s_add_u32 s3, s3, s54
    s_add_u32 s54, s3, 2490368

    v_readfirstlane_b32 s74, v0
    s_mov_b32 s55, 0x05040100
    s_nop 0
    s_cmp_lt_u32 s74, 768
    s_cbranch_scc1 L_nogate_5
    s_load_dwordx2 s[92:93], s[0:1], 40
    s_load_dwordx4 s[32:35], s[0:1], 56
    v_mov_b32 v110, 0
    s_waitcnt lgkmcnt(0)
    global_load_dwordx4 v[60:63], v110, s[92:93]

    global_load_dwordx4 v[64:67], v110, s[32:33] offset:0
    global_load_dwordx4 v[80:83], v110, s[34:35] offset:0
    global_load_dwordx4 v[68:71], v110, s[32:33] offset:16
    global_load_dwordx4 v[84:87], v110, s[34:35] offset:16
    global_load_dwordx4 v[72:75], v110, s[32:33] offset:32
    global_load_dwordx4 v[88:91], v110, s[34:35] offset:32
    global_load_dwordx4 v[76:79], v110, s[32:33] offset:48
    global_load_dwordx4 v[92:95], v110, s[34:35] offset:48
    s_lshl_b32 s74, s2, 8
    v_and_b32 v111, 255, v0
    v_add_u32 v111, s74, v111
    v_lshlrev_b32 v112, 16, v111
    v_lshlrev_b32 v111, 5, v111
    s_mov_b32 s75, 0x07060302
    s_waitcnt vmcnt(0)

    v_lshlrev_b32 v44, 16, v60
    v_and_b32 v45, 0xffff0000, v60
    v_lshlrev_b32 v46, 16, v61
    v_and_b32 v47, 0xffff0000, v61
    v_lshlrev_b32 v48, 16, v62
    v_and_b32 v49, 0xffff0000, v62
    v_lshlrev_b32 v50, 16, v63
    v_and_b32 v51, 0xffff0000, v63
    v_sub_f32 v44, v112, v44
    v_sub_f32 v45, v112, v45
    v_sub_f32 v46, v112, v46
    v_sub_f32 v47, v112, v47
    v_sub_f32 v48, v112, v48
    v_sub_f32 v49, v112, v49
    v_sub_f32 v50, v112, v50
    v_sub_f32 v51, v112, v51
    v_cvt_pk_bf16_f32 v44, v44, v45
    v_cvt_pk_bf16_f32 v46, v46, v47
    v_cvt_pk_bf16_f32 v48, v48, v49
    v_cvt_pk_bf16_f32 v50, v50, v51
    v_and_b32 v45, 0xffff0000, v44
    v_lshlrev_b32 v44, 16, v44
    v_and_b32 v47, 0xffff0000, v46
    v_lshlrev_b32 v46, 16, v46
    v_and_b32 v49, 0xffff0000, v48
    v_lshlrev_b32 v48, 16, v48
    v_and_b32 v51, 0xffff0000, v50
    v_lshlrev_b32 v50, 16, v50
    v_mul_f32 v44, v44, v44
    v_mul_f32 v45, v45, v45
    v_mul_f32 v46, v46, v46
    v_mul_f32 v47, v47, v47
    v_mul_f32 v48, v48, v48
    v_mul_f32 v49, v49, v49
    v_mul_f32 v50, v50, v50
    v_mul_f32 v51, v51, v51
    v_cvt_pk_bf16_f32 v44, v44, v45
    v_cvt_pk_bf16_f32 v46, v46, v47
    v_cvt_pk_bf16_f32 v48, v48, v49
    v_cvt_pk_bf16_f32 v50, v50, v51
    v_and_b32 v45, 0xffff0000, v44
    v_lshlrev_b32 v44, 16, v44
    v_and_b32 v47, 0xffff0000, v46
    v_lshlrev_b32 v46, 16, v46
    v_and_b32 v49, 0xffff0000, v48
    v_lshlrev_b32 v48, 16, v48
    v_and_b32 v51, 0xffff0000, v50
    v_lshlrev_b32 v50, 16, v50
    v_mul_f32 v44, 0xc1200000, v44
    v_mul_f32 v45, 0xc1200000, v45
    v_mul_f32 v46, 0xc1200000, v46
    v_mul_f32 v47, 0xc1200000, v47
    v_mul_f32 v48, 0xc1200000, v48
    v_mul_f32 v49, 0xc1200000, v49
    v_mul_f32 v50, 0xc1200000, v50
    v_mul_f32 v51, 0xc1200000, v51
    v_cvt_pk_bf16_f32 v44, v44, v45
    v_cvt_pk_bf16_f32 v46, v46, v47
    v_cvt_pk_bf16_f32 v48, v48, v49
    v_cvt_pk_bf16_f32 v50, v50, v51
    v_and_b32 v45, 0xffff0000, v44
    v_lshlrev_b32 v44, 16, v44
    v_and_b32 v47, 0xffff0000, v46
    v_lshlrev_b32 v46, 16, v46
    v_and_b32 v49, 0xffff0000, v48
    v_lshlrev_b32 v48, 16, v48
    v_and_b32 v51, 0xffff0000, v50
    v_lshlrev_b32 v50, 16, v50
    v_mul_f32 v44, 0x3fb8aa3b, v44
    v_mul_f32 v45, 0x3fb8aa3b, v45
    v_mul_f32 v46, 0x3fb8aa3b, v46
    v_mul_f32 v47, 0x3fb8aa3b, v47
    v_mul_f32 v48, 0x3fb8aa3b, v48
    v_mul_f32 v49, 0x3fb8aa3b, v49
    v_mul_f32 v50, 0x3fb8aa3b, v50
    v_mul_f32 v51, 0x3fb8aa3b, v51
    v_exp_f32 v44, v44
    v_exp_f32 v45, v45
    v_exp_f32 v46, v46
    v_exp_f32 v47, v47
    v_exp_f32 v48, v48
    v_exp_f32 v49, v49
    v_exp_f32 v50, v50
    v_exp_f32 v51, v51
    s_nop 0
    v_cvt_pk_bf16_f32 v44, v44, v45
    v_cvt_pk_bf16_f32 v46, v46, v47
    v_cvt_pk_bf16_f32 v48, v48, v49
    v_cvt_pk_bf16_f32 v50, v50, v51
    v_perm_b32 v113, v66, v64, s55
    v_dot2_f32_bf16 v52, v44, v113, 0

    v_perm_b32 v113, v66, v64, s75
    v_dot2_f32_bf16 v53, v44, v113, 0

    v_perm_b32 v113, v67, v65, s55
    v_dot2_f32_bf16 v54, v44, v113, 0

    v_perm_b32 v113, v67, v65, s75
    v_dot2_f32_bf16 v55, v44, v113, 0

    v_perm_b32 v113, v70, v68, s55
    v_dot2_f32_bf16 v52, v46, v113, v52

    v_perm_b32 v113, v70, v68, s75
    v_dot2_f32_bf16 v53, v46, v113, v53

    v_perm_b32 v113, v71, v69, s55
    v_dot2_f32_bf16 v54, v46, v113, v54

    v_perm_b32 v113, v71, v69, s75
    v_dot2_f32_bf16 v55, v46, v113, v55

    v_perm_b32 v113, v74, v72, s55
    v_dot2_f32_bf16 v52, v48, v113, v52

    v_perm_b32 v113, v74, v72, s75
    v_dot2_f32_bf16 v53, v48, v113, v53

    v_perm_b32 v113, v75, v73, s55
    v_dot2_f32_bf16 v54, v48, v113, v54

    v_perm_b32 v113, v75, v73, s75
    v_dot2_f32_bf16 v55, v48, v113, v55

    v_perm_b32 v113, v78, v76, s55
    v_dot2_f32_bf16 v52, v50, v113, v52

    v_perm_b32 v113, v78, v76, s75
    v_dot2_f32_bf16 v53, v50, v113, v53

    v_perm_b32 v113, v79, v77, s55
    v_dot2_f32_bf16 v54, v50, v113, v54

    v_perm_b32 v113, v79, v77, s75
    v_dot2_f32_bf16 v55, v50, v113, v55

    v_perm_b32 v113, v82, v80, s55
    v_dot2_f32_bf16 v60, v44, v113, 0

    v_perm_b32 v113, v82, v80, s75
    v_dot2_f32_bf16 v61, v44, v113, 0

    v_perm_b32 v113, v83, v81, s55
    v_dot2_f32_bf16 v62, v44, v113, 0

    v_perm_b32 v113, v83, v81, s75
    v_dot2_f32_bf16 v63, v44, v113, 0

    v_perm_b32 v113, v86, v84, s55
    v_dot2_f32_bf16 v60, v46, v113, v60

    v_perm_b32 v113, v86, v84, s75
    v_dot2_f32_bf16 v61, v46, v113, v61

    v_perm_b32 v113, v87, v85, s55
    v_dot2_f32_bf16 v62, v46, v113, v62

    v_perm_b32 v113, v87, v85, s75
    v_dot2_f32_bf16 v63, v46, v113, v63

    v_perm_b32 v113, v90, v88, s55
    v_dot2_f32_bf16 v60, v48, v113, v60

    v_perm_b32 v113, v90, v88, s75
    v_dot2_f32_bf16 v61, v48, v113, v61

    v_perm_b32 v113, v91, v89, s55
    v_dot2_f32_bf16 v62, v48, v113, v62

    v_perm_b32 v113, v91, v89, s75
    v_dot2_f32_bf16 v63, v48, v113, v63

    v_perm_b32 v113, v94, v92, s55
    v_dot2_f32_bf16 v60, v50, v113, v60

    v_perm_b32 v113, v94, v92, s75
    v_dot2_f32_bf16 v61, v50, v113, v61

    v_perm_b32 v113, v95, v93, s55
    v_dot2_f32_bf16 v62, v50, v113, v62

    v_perm_b32 v113, v95, v93, s75
    v_dot2_f32_bf16 v63, v50, v113, v63

    s_add_u32 s92, s6, 393216
    s_addc_u32 s93, s7, 0
    s_mov_b32 s94, 2097152
    s_mov_b32 s95, 0x20000
    v_cvt_pk_bf16_f32 v52, v52, v53
    v_cvt_pk_bf16_f32 v53, v54, v55
    buffer_store_dwordx4 v[60:63], v111, s[92:95], 0 offen
    buffer_store_dwordx2 v[52:53], v111, s[92:95], 0 offen offset:16
    s_nop 1
L_nogate_5:

    s_mov_b32 s8, s80
    s_mov_b32 s9, s81
    s_mov_b32 s10, 0
    s_mov_b32 s11, 0x20000
    s_mov_b32 s12, s82
    s_mov_b32 s13, s83
    s_mov_b32 s14, 0
    s_mov_b32 s15, 0x20000
    s_mov_b32 s16, s84
    s_mov_b32 s17, s85
    s_mov_b32 s18, 0
    s_mov_b32 s19, 0x20000
    s_lshr_b32 s74, s2, 1
    s_and_b32 s74, s74, 28
    s_lshr_b32 s86, 0x00102010, s74
    s_lshr_b32 s87, 0x44414241, s74
    s_lshr_b32 s41, 0x43221100, s74
    s_and_b32 s86, s86, 15
    s_and_b32 s87, s87, 15
    s_and_b32 s41, s41, 15
    s_lshr_b32 s74, s2, 6
    s_lshl_b32 s74, s74, 3
    s_and_b32 s75, s2, 7
    s_add_u32 s74, s74, s75
    s_mul_i32 s74, s74, 5
    s_add_u32 s41, s41, s74

    s_mul_i32 s78, s41, 16384
    s_add_u32 s49, s78, 16384
    s_cmp_ge_u32 s41, 3125
    s_cmovk_i32 s49, 0
    s_cmovk_i32 s78, 0
    s_lshl_b32 s10, s49, 2
    s_lshl_b32 s14, s49, 2
    s_lshl_b32 s18, s49, 1
    s_sub_u32 s79, s87, s86
    s_bfm_b32 s85, s79, s86
    s_lshl_b32 s86, s86, 12
    s_lshl_b32 s87, s87, 12
    s_min_u32 s87, s87, 16384

    s_add_u32 s79, s78, 0
    s_bitcmp1_b32 s85, 0
    s_cselect_b32 s79, s79, 0x1ff00000
    s_lshl_b32 s56, s79, 2
    s_lshl_b32 s61, s79, 1

    s_add_u32 s79, s78, 4096
    s_bitcmp1_b32 s85, 1
    s_cselect_b32 s79, s79, 0x1ff00000
    s_lshl_b32 s57, s79, 2
    s_lshl_b32 s62, s79, 1

    s_add_u32 s79, s78, 8192
    s_bitcmp1_b32 s85, 2
    s_cselect_b32 s79, s79, 0x1ff00000
    s_lshl_b32 s58, s79, 2
    s_lshl_b32 s63, s79, 1

    s_add_u32 s79, s78, 12288
    s_bitcmp1_b32 s85, 3
    s_cselect_b32 s79, s79, 0x1ff00000
    s_lshl_b32 s59, s79, 2
    s_lshl_b32 s64, s79, 1

    s_mov_b32 s82, s85
    s_mov_b32 s83, s86
    s_mov_b32 s84, s87
    s_add_u32 s41, s2, 160
    s_mul_i32 s74, s41, 16384
    s_mov_b32 s10, 204800000
    s_mov_b32 s14, 204800000
    s_mov_b32 s18, 102400000

    s_add_u32 s75, s74, 0
    s_lshl_b32 s76, s75, 2
    s_lshl_b32 s75, s75, 1
    s_bitcmp1_b32 s82, 0
    s_cselect_b32 s56, s56, s76
    s_cselect_b32 s61, s61, s75

    s_add_u32 s75, s74, 4096
    s_lshl_b32 s76, s75, 2
    s_lshl_b32 s75, s75, 1
    s_bitcmp1_b32 s82, 1
    s_cselect_b32 s57, s57, s76
    s_cselect_b32 s62, s62, s75

    s_add_u32 s75, s74, 8192
    s_lshl_b32 s76, s75, 2
    s_lshl_b32 s75, s75, 1
    s_bitcmp1_b32 s82, 2
    s_cselect_b32 s58, s58, s76
    s_cselect_b32 s63, s63, s75

    s_add_u32 s75, s74, 12288
    s_lshl_b32 s76, s75, 2
    s_lshl_b32 s75, s75, 1
    s_bitcmp1_b32 s82, 3
    s_cselect_b32 s59, s59, s76
    s_cselect_b32 s64, s64, s75

    buffer_load_dwordx4 v[20:23], v1, s[12:15], s56 offen nt
    buffer_load_dwordx4 v[4:7], v1, s[8:11], s56 offen nt
    buffer_load_dwordx2 v[36:37], v2, s[16:19], s61 offen nt
    buffer_load_dwordx4 v[24:27], v1, s[12:15], s57 offen nt
    buffer_load_dwordx4 v[8:11], v1, s[8:11], s57 offen nt
    buffer_load_dwordx2 v[38:39], v2, s[16:19], s62 offen nt
    buffer_load_dwordx4 v[28:31], v1, s[12:15], s58 offen nt
    buffer_load_dwordx4 v[12:15], v1, s[8:11], s58 offen nt
    buffer_load_dwordx2 v[40:41], v2, s[16:19], s63 offen nt
    buffer_load_dwordx4 v[32:35], v1, s[12:15], s59 offen nt
    buffer_load_dwordx4 v[16:19], v1, s[8:11], s59 offen nt
    buffer_load_dwordx2 v[42:43], v2, s[16:19], s64 offen nt
    s_mov_b32 s86, 0
    s_mov_b32 s87, 4
    s_mul_i32 s78, s41, 16384
    s_add_u32 s49, s78, 16384
    s_cmp_ge_u32 s41, 3125
    s_cmovk_i32 s49, 0
    s_cmovk_i32 s78, 0
    s_lshl_b32 s10, s49, 2
    s_lshl_b32 s14, s49, 2
    s_lshl_b32 s18, s49, 1
    s_sub_u32 s79, s87, s86
    s_bfm_b32 s85, s79, s86
    s_lshl_b32 s86, s86, 12
    s_lshl_b32 s87, s87, 12
    s_min_u32 s87, s87, 16384

    s_add_u32 s79, s78, 0
    s_bitcmp1_b32 s85, 0
    s_cselect_b32 s79, s79, 0x1ff00000
    s_lshl_b32 s56, s79, 2
    s_lshl_b32 s61, s79, 1

    s_add_u32 s79, s78, 4096
    s_bitcmp1_b32 s85, 1
    s_cselect_b32 s79, s79, 0x1ff00000
    s_lshl_b32 s57, s79, 2
    s_lshl_b32 s62, s79, 1

    s_add_u32 s79, s78, 8192
    s_bitcmp1_b32 s85, 2
    s_cselect_b32 s79, s79, 0x1ff00000
    s_lshl_b32 s58, s79, 2
    s_lshl_b32 s63, s79, 1

    s_add_u32 s79, s78, 12288
    s_bitcmp1_b32 s85, 3
    s_cselect_b32 s79, s79, 0x1ff00000
    s_lshl_b32 s59, s79, 2
    s_lshl_b32 s64, s79, 1

    s_getreg_b32 s5, hwreg(HW_REG_XCC_ID)
    s_and_b32 s5, s5, 7
    s_mul_i32 s3, s5, 4096

    s_add_u32 s20, s6, s3
    s_addc_u32 s21, s7, 0
    s_mov_b32 s22, 4096
    s_mov_b32 s23, 0x20000
    s_mul_i32 s3, s5, 67117056
    s_add_u32 s3, s3, 85721088
    s_add_u32 s24, s6, s3
    s_addc_u32 s25, s7, 0
    s_mov_b32 s26, 67117056
    s_mov_b32 s27, 0x20000
    s_add_u32 s36, s6, 32768
    s_addc_u32 s37, s7, 0
    s_mov_b32 s38, 4
    s_mov_b32 s39, 0x20000
    s_mov_b32 s40, 687195
    s_mov_b32 s42, -6250
    s_mov_b32 s43, 1942
    s_mov_b32 s45, 0x06050400
    s_mov_b32 s46, 0x05040c00
    s_mov_b32 s48, 6524
    s_mov_b32 s50, 0
    v_mov_b32 v104, 1
    v_mov_b32 v105, 0x46ff8000
    s_mov_b32 s55, 0x05040100
    v_mul_u32_u24 v106, 5, v0

    v_and_b32 v102, 15, v0
    v_lshrrev_b32 v103, 4, v0
    v_lshl_add_u32 v102, v102, 7, v103
    v_mul_u32_u24 v102, 32764, v102
    v_add_u32 v103, 2096896, v102

    v_and_b32 v102, 0xffffff80, v102
    v_and_b32 v103, 0xffffff80, v103
    s_movk_i32 s3, 1024
    v_cmp_gt_u32 s[66:67], s3, v0
    s_movk_i32 s3, 1024
    v_cmp_gt_u32 s[68:69], s3, v0
    s_waitcnt lgkmcnt(0)
    s_lshl_b32 s88, s88, 16
    v_mov_b32 v110, 0.15915494
    v_mul_f32 v110, s88, v110
    s_mov_b32 s3, 0x7fff7fff
    v_readfirstlane_b32 s44, v110

    s_waitcnt vmcnt(12)
    v_mov_b32 v61, 0
    v_mov_b32 v62, 0
    v_mov_b32 v63, 0
    v_dot2_f32_bf16 v61, v116, v116, v61
    v_dot2_f32_bf16 v61, v117, v117, v61
    v_dot2_f32_bf16 v61, v118, v118, v61
    v_dot2_f32_bf16 v61, v119, v119, v61
    v_dot2_f32_bf16 v61, v120, v120, v61
    v_dot2_f32_bf16 v61, v121, v121, v61
    v_dot2_f32_bf16 v61, v122, v122, v61
    v_dot2_f32_bf16 v61, v123, v123, v61
    v_dot2_f32_bf16 v61, v124, v124, v61
    v_dot2_f32_bf16 v62, v56, v56, v62
    v_dot2_f32_bf16 v62, v57, v57, v62
    v_dot2_f32_bf16 v62, v58, v58, v62
    v_dot2_f32_bf16 v62, v59, v59, v62
    v_and_b32 v60, s3, v116
    v_and_b32 v64, s3, v117
    v_pk_max_u16 v60, v60, v64
    v_and_b32 v64, s3, v118
    v_pk_max_u16 v60, v60, v64
    v_and_b32 v64, s3, v119
    v_pk_max_u16 v60, v60, v64
    v_and_b32 v64, s3, v120
    v_pk_max_u16 v60, v60, v64
    v_and_b32 v64, s3, v121
    v_pk_max_u16 v60, v60, v64
    v_and_b32 v64, s3, v122
    v_pk_max_u16 v60, v60, v64
    v_and_b32 v64, s3, v123
    v_pk_max_u16 v60, v60, v64
    v_and_b32 v64, s3, v124
    v_pk_max_u16 v60, v60, v64
    v_lshrrev_b32 v64, 16, v60
    v_and_b32 v60, 0xffff, v60
    v_max_u32 v60, v60, v64

    s_nop 1
    v_max_u32_dpp v60, v60, v60 row_shr:1 row_mask:0xf bank_mask:0xf
    s_nop 1
    v_max_u32_dpp v60, v60, v60 row_shr:2 row_mask:0xf bank_mask:0xf
    s_nop 1
    v_max_u32_dpp v60, v60, v60 row_shr:4 row_mask:0xf bank_mask:0xf
    s_nop 1
    v_max_u32_dpp v60, v60, v60 row_shr:8 row_mask:0xf bank_mask:0xf
    s_nop 1
    v_max_u32_dpp v60, v60, v60 row_bcast:15 row_mask:0xa bank_mask:0xf
    s_nop 1
    v_max_u32_dpp v60, v60, v60 row_bcast:31 row_mask:0xc bank_mask:0xf
    s_nop 1
    v_add_f32_dpp v61, v61, v61 row_shr:1 row_mask:0xf bank_mask:0xf
    s_nop 1
    v_add_f32_dpp v61, v61, v61 row_shr:2 row_mask:0xf bank_mask:0xf
    s_nop 1
    v_add_f32_dpp v61, v61, v61 row_shr:4 row_mask:0xf bank_mask:0xf
    s_nop 1
    v_add_f32_dpp v61, v61, v61 row_shr:8 row_mask:0xf bank_mask:0xf
    s_nop 1
    v_add_f32_dpp v61, v61, v61 row_bcast:15 row_mask:0xa bank_mask:0xf
    s_nop 1
    v_add_f32_dpp v61, v61, v61 row_bcast:31 row_mask:0xc bank_mask:0xf
    s_nop 1
    v_add_f32_dpp v62, v62, v62 row_shr:1 row_mask:0xf bank_mask:0xf
    s_nop 1
    v_add_f32_dpp v62, v62, v62 row_shr:2 row_mask:0xf bank_mask:0xf
    s_nop 1
    v_add_f32_dpp v62, v62, v62 row_shr:4 row_mask:0xf bank_mask:0xf
    s_nop 1
    v_add_f32_dpp v62, v62, v62 row_shr:8 row_mask:0xf bank_mask:0xf
    s_nop 1
    v_add_f32_dpp v62, v62, v62 row_bcast:15 row_mask:0xa bank_mask:0xf
    s_nop 1
    v_add_f32_dpp v62, v62, v62 row_bcast:31 row_mask:0xc bank_mask:0xf
    v_lshrrev_b32 v64, 6, v0
    v_lshlrev_b32 v64, 4, v64
    s_mov_b32 exec_lo, 0
    s_brev_b32 exec_hi, 1
    ds_write_b128 v64, v[60:63] offset:16384
    s_mov_b64 exec, -1

    s_bitcmp0_b32 s82, 0
    s_cbranch_scc1 L_ska_8
    s_waitcnt vmcnt(9)
    v_mul_hi_u32_u24 v45, s40, v20
    v_mul_hi_u32_u24 v44, s40, v4
    v_mul_hi_u32_u24 v47, s40, v21
    v_mul_hi_u32_u24 v46, s40, v5
    v_mul_hi_u32_u24 v49, s40, v22
    v_mul_hi_u32_u24 v48, s40, v6
    v_mul_hi_u32_u24 v51, s40, v23
    v_mul_hi_u32_u24 v50, s40, v7
    v_and_b32 v45, -2, v45
    v_mad_u32_u24 v4, v44, s43, v4
    v_and_b32 v76, -4, v44
    v_and_b32 v47, -2, v47
    v_mad_u32_u24 v5, v46, s43, v5
    v_and_b32 v77, -4, v46
    v_and_b32 v49, -2, v49
    v_mad_u32_u24 v6, v48, s43, v6
    v_and_b32 v78, -4, v48
    v_and_b32 v51, -2, v51
    v_mad_u32_u24 v7, v50, s43, v7
    v_and_b32 v79, -4, v50
    v_mad_i32_i24 v20, v45, s42, v20
    v_lshl_add_u32 v45, v45, 6, v76
    v_mad_i32_i24 v21, v47, s42, v21
    v_lshl_add_u32 v47, v47, 6, v77
    v_mad_i32_i24 v22, v49, s42, v22
    v_lshl_add_u32 v49, v49, 6, v78
    v_mad_i32_i24 v23, v51, s42, v23
    v_lshl_add_u32 v51, v51, 6, v79
    ds_add_rtn_u32 v76, v45, v104
    ds_add_rtn_u32 v77, v47, v104
    ds_add_rtn_u32 v78, v49, v104
    ds_add_rtn_u32 v79, v51, v104
    v_lshlrev_b32 v110, 16, v36
    v_and_b32 v111, 0xffff0000, v36
    v_lshlrev_b32 v112, 16, v37
    v_and_b32 v113, 0xffff0000, v37
    v_mul_f32 v110, s44, v110
    v_mul_f32 v111, s44, v111
    v_mul_f32 v112, s44, v112
    v_mul_f32 v113, s44, v113
    v_fract_f32 v110, v110
    v_fract_f32 v111, v111
    v_fract_f32 v112, v112
    v_fract_f32 v113, v113
    v_cos_f32 v110, v110
    v_cos_f32 v111, v111
    v_cos_f32 v112, v112
    v_cos_f32 v113, v113
    v_lshl_or_b32 v44, v44, 14, v20
    v_perm_b32 v45, v45, v4, s46
    v_bfe_u32 v4, v4, 8, 5

    v_lshl_or_b32 v46, v46, 14, v21
    v_perm_b32 v47, v47, v5, s46
    v_bfe_u32 v5, v5, 8, 5

    v_lshl_or_b32 v48, v48, 14, v22
    v_perm_b32 v49, v49, v6, s46
    v_bfe_u32 v6, v6, 8, 5

    v_lshl_or_b32 v50, v50, 14, v23
    v_perm_b32 v51, v51, v7, s46
    v_bfe_u32 v7, v7, 8, 5

    v_fmaak_f32 v110, v110, v105, 0x4b400010
    v_fmaak_f32 v111, v111, v105, 0x4b400010
    v_fmaak_f32 v112, v112, v105, 0x4b400010
    v_fmaak_f32 v113, v113, v105, 0x4b400010
    v_sub_u32 v110, v110, v4
    v_sub_u32 v111, v111, v5
    v_sub_u32 v112, v112, v6
    v_sub_u32 v113, v113, v7
    v_bfi_b32 v110, 31, v4, v110
    v_bfi_b32 v111, 31, v5, v111
    v_bfi_b32 v112, 31, v6, v112
    v_bfi_b32 v113, 31, v7, v113
    v_perm_b32 v44, v44, v110, s55
    v_perm_b32 v46, v46, v111, s55
    v_perm_b32 v48, v48, v112, s55
    v_perm_b32 v50, v50, v113, s55
    buffer_load_dwordx4 v[20:23], v1, s[12:15], s56 offen nt
    buffer_load_dwordx4 v[4:7], v1, s[8:11], s56 offen nt
    buffer_load_dwordx2 v[36:37], v2, s[16:19], s61 offen nt
L_bka_9:
    s_bitcmp0_b32 s82, 1
    s_cbranch_scc1 L_ska_10
    s_waitcnt vmcnt(9)
    v_mul_hi_u32_u24 v53, s40, v24
    v_mul_hi_u32_u24 v52, s40, v8
    v_mul_hi_u32_u24 v55, s40, v25
    v_mul_hi_u32_u24 v54, s40, v9
    v_mul_hi_u32_u24 v57, s40, v26
    v_mul_hi_u32_u24 v56, s40, v10
    v_mul_hi_u32_u24 v59, s40, v27
    v_mul_hi_u32_u24 v58, s40, v11
    v_and_b32 v53, -2, v53
    v_mad_u32_u24 v8, v52, s43, v8
    v_and_b32 v80, -4, v52
    v_and_b32 v55, -2, v55
    v_mad_u32_u24 v9, v54, s43, v9
    v_and_b32 v81, -4, v54
    v_and_b32 v57, -2, v57
    v_mad_u32_u24 v10, v56, s43, v10
    v_and_b32 v82, -4, v56
    v_and_b32 v59, -2, v59
    v_mad_u32_u24 v11, v58, s43, v11
    v_and_b32 v83, -4, v58
    v_mad_i32_i24 v24, v53, s42, v24
    v_lshl_add_u32 v53, v53, 6, v80
    v_mad_i32_i24 v25, v55, s42, v25
    v_lshl_add_u32 v55, v55, 6, v81
    v_mad_i32_i24 v26, v57, s42, v26
    v_lshl_add_u32 v57, v57, 6, v82
    v_mad_i32_i24 v27, v59, s42, v27
    v_lshl_add_u32 v59, v59, 6, v83
    ds_add_rtn_u32 v80, v53, v104
    ds_add_rtn_u32 v81, v55, v104
    ds_add_rtn_u32 v82, v57, v104
    ds_add_rtn_u32 v83, v59, v104
    v_lshlrev_b32 v110, 16, v38
    v_and_b32 v111, 0xffff0000, v38
    v_lshlrev_b32 v112, 16, v39
    v_and_b32 v113, 0xffff0000, v39
    v_mul_f32 v110, s44, v110
    v_mul_f32 v111, s44, v111
    v_mul_f32 v112, s44, v112
    v_mul_f32 v113, s44, v113
    v_fract_f32 v110, v110
    v_fract_f32 v111, v111
    v_fract_f32 v112, v112
    v_fract_f32 v113, v113
    v_cos_f32 v110, v110
    v_cos_f32 v111, v111
    v_cos_f32 v112, v112
    v_cos_f32 v113, v113
    v_lshl_or_b32 v52, v52, 14, v24
    v_perm_b32 v53, v53, v8, s46
    v_bfe_u32 v8, v8, 8, 5

    v_lshl_or_b32 v54, v54, 14, v25
    v_perm_b32 v55, v55, v9, s46
    v_bfe_u32 v9, v9, 8, 5

    v_lshl_or_b32 v56, v56, 14, v26
    v_perm_b32 v57, v57, v10, s46
    v_bfe_u32 v10, v10, 8, 5

    v_lshl_or_b32 v58, v58, 14, v27
    v_perm_b32 v59, v59, v11, s46
    v_bfe_u32 v11, v11, 8, 5

    v_fmaak_f32 v110, v110, v105, 0x4b400010
    v_fmaak_f32 v111, v111, v105, 0x4b400010
    v_fmaak_f32 v112, v112, v105, 0x4b400010
    v_fmaak_f32 v113, v113, v105, 0x4b400010
    v_sub_u32 v110, v110, v8
    v_sub_u32 v111, v111, v9
    v_sub_u32 v112, v112, v10
    v_sub_u32 v113, v113, v11
    v_bfi_b32 v110, 31, v8, v110
    v_bfi_b32 v111, 31, v9, v111
    v_bfi_b32 v112, 31, v10, v112
    v_bfi_b32 v113, 31, v11, v113
    v_perm_b32 v52, v52, v110, s55
    v_perm_b32 v54, v54, v111, s55
    v_perm_b32 v56, v56, v112, s55
    v_perm_b32 v58, v58, v113, s55
    buffer_load_dwordx4 v[24:27], v1, s[12:15], s57 offen nt
    buffer_load_dwordx4 v[8:11], v1, s[8:11], s57 offen nt
    buffer_load_dwordx2 v[38:39], v2, s[16:19], s62 offen nt
L_bka_11:
    s_bitcmp0_b32 s82, 2
    s_cbranch_scc1 L_ska_12
    s_waitcnt vmcnt(9)
    v_mul_hi_u32_u24 v61, s40, v28
    v_mul_hi_u32_u24 v60, s40, v12
    v_mul_hi_u32_u24 v63, s40, v29
    v_mul_hi_u32_u24 v62, s40, v13
    v_mul_hi_u32_u24 v65, s40, v30
    v_mul_hi_u32_u24 v64, s40, v14
    v_mul_hi_u32_u24 v67, s40, v31
    v_mul_hi_u32_u24 v66, s40, v15
    v_and_b32 v61, -2, v61
    v_mad_u32_u24 v12, v60, s43, v12
    v_and_b32 v84, -4, v60
    v_and_b32 v63, -2, v63
    v_mad_u32_u24 v13, v62, s43, v13
    v_and_b32 v85, -4, v62
    v_and_b32 v65, -2, v65
    v_mad_u32_u24 v14, v64, s43, v14
    v_and_b32 v86, -4, v64
    v_and_b32 v67, -2, v67
    v_mad_u32_u24 v15, v66, s43, v15
    v_and_b32 v87, -4, v66
    v_mad_i32_i24 v28, v61, s42, v28
    v_lshl_add_u32 v61, v61, 6, v84
    v_mad_i32_i24 v29, v63, s42, v29
    v_lshl_add_u32 v63, v63, 6, v85
    v_mad_i32_i24 v30, v65, s42, v30
    v_lshl_add_u32 v65, v65, 6, v86
    v_mad_i32_i24 v31, v67, s42, v31
    v_lshl_add_u32 v67, v67, 6, v87
    ds_add_rtn_u32 v84, v61, v104
    ds_add_rtn_u32 v85, v63, v104
    ds_add_rtn_u32 v86, v65, v104
    ds_add_rtn_u32 v87, v67, v104
    v_lshlrev_b32 v110, 16, v40
    v_and_b32 v111, 0xffff0000, v40
    v_lshlrev_b32 v112, 16, v41
    v_and_b32 v113, 0xffff0000, v41
    v_mul_f32 v110, s44, v110
    v_mul_f32 v111, s44, v111
    v_mul_f32 v112, s44, v112
    v_mul_f32 v113, s44, v113
    v_fract_f32 v110, v110
    v_fract_f32 v111, v111
    v_fract_f32 v112, v112
    v_fract_f32 v113, v113
    v_cos_f32 v110, v110
    v_cos_f32 v111, v111
    v_cos_f32 v112, v112
    v_cos_f32 v113, v113
    v_lshl_or_b32 v60, v60, 14, v28
    v_perm_b32 v61, v61, v12, s46
    v_bfe_u32 v12, v12, 8, 5

    v_lshl_or_b32 v62, v62, 14, v29
    v_perm_b32 v63, v63, v13, s46
    v_bfe_u32 v13, v13, 8, 5

    v_lshl_or_b32 v64, v64, 14, v30
    v_perm_b32 v65, v65, v14, s46
    v_bfe_u32 v14, v14, 8, 5

    v_lshl_or_b32 v66, v66, 14, v31
    v_perm_b32 v67, v67, v15, s46
    v_bfe_u32 v15, v15, 8, 5

    v_fmaak_f32 v110, v110, v105, 0x4b400010
    v_fmaak_f32 v111, v111, v105, 0x4b400010
    v_fmaak_f32 v112, v112, v105, 0x4b400010
    v_fmaak_f32 v113, v113, v105, 0x4b400010
    v_sub_u32 v110, v110, v12
    v_sub_u32 v111, v111, v13
    v_sub_u32 v112, v112, v14
    v_sub_u32 v113, v113, v15
    v_bfi_b32 v110, 31, v12, v110
    v_bfi_b32 v111, 31, v13, v111
    v_bfi_b32 v112, 31, v14, v112
    v_bfi_b32 v113, 31, v15, v113
    v_perm_b32 v60, v60, v110, s55
    v_perm_b32 v62, v62, v111, s55
    v_perm_b32 v64, v64, v112, s55
    v_perm_b32 v66, v66, v113, s55
    buffer_load_dwordx4 v[28:31], v1, s[12:15], s58 offen nt
    buffer_load_dwordx4 v[12:15], v1, s[8:11], s58 offen nt
    buffer_load_dwordx2 v[40:41], v2, s[16:19], s63 offen nt
L_bka_13:
    s_bitcmp0_b32 s82, 3
    s_cbranch_scc1 L_ska_14
    s_waitcnt vmcnt(9)
    s_mov_b64 exec, s[66:67]
    v_mul_hi_u32_u24 v69, s40, v32
    v_mul_hi_u32_u24 v68, s40, v16
    v_mul_hi_u32_u24 v71, s40, v33
    v_mul_hi_u32_u24 v70, s40, v17
    v_mul_hi_u32_u24 v73, s40, v34
    v_mul_hi_u32_u24 v72, s40, v18
    v_mul_hi_u32_u24 v75, s40, v35
    v_mul_hi_u32_u24 v74, s40, v19
    v_and_b32 v69, -2, v69
    v_mad_u32_u24 v16, v68, s43, v16
    v_and_b32 v88, -4, v68
    v_and_b32 v71, -2, v71
    v_mad_u32_u24 v17, v70, s43, v17
    v_and_b32 v89, -4, v70
    v_and_b32 v73, -2, v73
    v_mad_u32_u24 v18, v72, s43, v18
    v_and_b32 v90, -4, v72
    v_and_b32 v75, -2, v75
    v_mad_u32_u24 v19, v74, s43, v19
    v_and_b32 v91, -4, v74
    v_mad_i32_i24 v32, v69, s42, v32
    v_lshl_add_u32 v69, v69, 6, v88
    v_mad_i32_i24 v33, v71, s42, v33
    v_lshl_add_u32 v71, v71, 6, v89
    v_mad_i32_i24 v34, v73, s42, v34
    v_lshl_add_u32 v73, v73, 6, v90
    v_mad_i32_i24 v35, v75, s42, v35
    v_lshl_add_u32 v75, v75, 6, v91
    ds_add_rtn_u32 v88, v69, v104
    ds_add_rtn_u32 v89, v71, v104
    ds_add_rtn_u32 v90, v73, v104
    ds_add_rtn_u32 v91, v75, v104
    v_lshlrev_b32 v110, 16, v42
    v_and_b32 v111, 0xffff0000, v42
    v_lshlrev_b32 v112, 16, v43
    v_and_b32 v113, 0xffff0000, v43
    v_mul_f32 v110, s44, v110
    v_mul_f32 v111, s44, v111
    v_mul_f32 v112, s44, v112
    v_mul_f32 v113, s44, v113
    v_fract_f32 v110, v110
    v_fract_f32 v111, v111
    v_fract_f32 v112, v112
    v_fract_f32 v113, v113
    v_cos_f32 v110, v110
    v_cos_f32 v111, v111
    v_cos_f32 v112, v112
    v_cos_f32 v113, v113
    v_lshl_or_b32 v68, v68, 14, v32
    v_perm_b32 v69, v69, v16, s46
    v_bfe_u32 v16, v16, 8, 5

    v_lshl_or_b32 v70, v70, 14, v33
    v_perm_b32 v71, v71, v17, s46
    v_bfe_u32 v17, v17, 8, 5

    v_lshl_or_b32 v72, v72, 14, v34
    v_perm_b32 v73, v73, v18, s46
    v_bfe_u32 v18, v18, 8, 5

    v_lshl_or_b32 v74, v74, 14, v35
    v_perm_b32 v75, v75, v19, s46
    v_bfe_u32 v19, v19, 8, 5

    v_fmaak_f32 v110, v110, v105, 0x4b400010
    v_fmaak_f32 v111, v111, v105, 0x4b400010
    v_fmaak_f32 v112, v112, v105, 0x4b400010
    v_fmaak_f32 v113, v113, v105, 0x4b400010
    v_sub_u32 v110, v110, v16
    v_sub_u32 v111, v111, v17
    v_sub_u32 v112, v112, v18
    v_sub_u32 v113, v113, v19
    v_bfi_b32 v110, 31, v16, v110
    v_bfi_b32 v111, 31, v17, v111
    v_bfi_b32 v112, 31, v18, v112
    v_bfi_b32 v113, 31, v19, v113
    v_perm_b32 v68, v68, v110, s55
    v_perm_b32 v70, v70, v111, s55
    v_perm_b32 v72, v72, v112, s55
    v_perm_b32 v74, v74, v113, s55
    s_mov_b64 exec, -1
    buffer_load_dwordx4 v[32:35], v1, s[12:15], s59 offen nt
    buffer_load_dwordx4 v[16:19], v1, s[8:11], s59 offen nt
    buffer_load_dwordx2 v[42:43], v2, s[16:19], s64 offen nt
L_bka_15:
    v_readfirstlane_b32 s74, v0
    s_nop 1
    s_cmp_lg_u32 s74, 0
    s_cbranch_scc1 L_ready_17

    v_mov_b32 v100, 0
    buffer_atomic_add v100, v98, s[96:99], 0 offen offset:128 sc0
    s_waitcnt vmcnt(0)
    v_readfirstlane_b32 s74, v100
    s_nop 1
    s_cmp_lg_u32 s74, 0
    s_cbranch_scc1 L_ready_17

    v_mov_b32 v110, 1
    buffer_atomic_add v110, v98, s[96:99], 0 offen offset:64 sc0
    s_waitcnt vmcnt(0)
    v_readfirstlane_b32 s74, v110
    s_nop 1
    s_cmp_lg_u32 s74, 0
    s_cbranch_scc1 L_zno_19

    s_mov_b32 s92, s6
    s_mov_b32 s93, s7
    s_mov_b32 s94, 32784
    s_mov_b32 s95, 0x20000
    v_mov_b32 v110, 0
    v_mov_b32 v111, 0
    v_mov_b32 v112, 0
    v_mov_b32 v113, 0
L_zl_18:
    buffer_store_dwordx4 v[110:113], v1, s[92:95], s74 offen sc0 sc1
    s_add_u32 s74, s74, 1024
    s_cmp_le_u32 s74, 32768
    s_cbranch_scc1 L_zl_18
    v_mov_b32 v114, 1
    s_waitcnt vmcnt(0)
    buffer_atomic_add v114, v98, s[96:99], 0 offen offset:128
L_zno_19:

L_spin_16:
    v_mov_b32 v100, 0
    buffer_atomic_add v100, v98, s[96:99], 0 offen offset:128 sc0
    s_waitcnt vmcnt(0)
    v_readfirstlane_b32 s74, v100
    s_nop 1
    s_cmp_eq_u32 s74, 0
    s_cbranch_scc1 L_spin_16
L_ready_17:

    s_waitcnt lgkmcnt(0)
    s_barrier

    v_and_b32 v114, 15, v0
    v_lshlrev_b32 v114, 4, v114
    ds_read_b128 v[110:113], v114 offset:16384
    s_waitcnt lgkmcnt(0)

    s_nop 0
    v_max_u32_dpp v110, v110, v110 row_ror:1 row_mask:0xf bank_mask:0xf
    v_add_f32_dpp v111, v111, v111 row_ror:1 row_mask:0xf bank_mask:0xf
    v_add_f32_dpp v112, v112, v112 row_ror:1 row_mask:0xf bank_mask:0xf

    s_nop 0
    v_max_u32_dpp v110, v110, v110 row_ror:2 row_mask:0xf bank_mask:0xf
    v_add_f32_dpp v111, v111, v111 row_ror:2 row_mask:0xf bank_mask:0xf
    v_add_f32_dpp v112, v112, v112 row_ror:2 row_mask:0xf bank_mask:0xf

    s_nop 0
    v_max_u32_dpp v110, v110, v110 row_ror:4 row_mask:0xf bank_mask:0xf
    v_add_f32_dpp v111, v111, v111 row_ror:4 row_mask:0xf bank_mask:0xf
    v_add_f32_dpp v112, v112, v112 row_ror:4 row_mask:0xf bank_mask:0xf

    s_nop 0
    v_max_u32_dpp v110, v110, v110 row_ror:8 row_mask:0xf bank_mask:0xf
    v_add_f32_dpp v111, v111, v111 row_ror:8 row_mask:0xf bank_mask:0xf
    v_add_f32_dpp v112, v112, v112 row_ror:8 row_mask:0xf bank_mask:0xf

    v_rsq_f32 v112, v112
    v_readfirstlane_b32 s32, v110
    v_mul_f32 v112, 0x47decb04, v112
    v_readfirstlane_b32 s33, v111
    v_readfirstlane_b32 s34, v112

    ds_read_b64 v[94:95], v2
    s_waitcnt lgkmcnt(0)
    v_add_u32 v97, v94, v95
    s_nop 1
    v_add_u32_dpp v97, v97, v97 row_shr:1 row_mask:0xf bank_mask:0xf
    s_nop 1
    v_add_u32_dpp v97, v97, v97 row_shr:2 row_mask:0xf bank_mask:0xf
    s_nop 1
    v_add_u32_dpp v97, v97, v97 row_shr:4 row_mask:0xf bank_mask:0xf
    s_nop 1
    v_add_u32_dpp v97, v97, v97 row_shr:8 row_mask:0xf bank_mask:0xf
    s_nop 1
    v_add_u32_dpp v97, v97, v97 row_bcast:15 row_mask:0xa bank_mask:0xf
    s_nop 1
    v_add_u32_dpp v97, v97, v97 row_bcast:31 row_mask:0xc bank_mask:0xf
    s_mov_b32 exec_lo, 0
    s_brev_b32 exec_hi, 1
    ds_add_rtn_u32 v96, v108, v97
    s_mov_b64 exec, -1

    v_add_u32 v92, v94, v94
    v_add_u32 v93, v95, v95
    v_med3_u32 v92, v94, 2, v92
    v_med3_u32 v93, v95, 2, v93
    v_lshl_or_b32 v92, v93, 16, v92
    v_lshlrev_b32 v93, 2, v0
    buffer_atomic_add v92, v93, s[20:23], 0 offen sc0
    s_waitcnt lgkmcnt(0)
    v_readlane_b32 s77, v96, 63
    v_sub_u32 v97, v97, v95
    s_sub_u32 s50, s50, s83
    s_sub_u32 s77, s77, s50
    v_add_u32 v97, s77, v97
    v_sub_u32 v96, v97, v94
    v_lshlrev_b32 v111, 3, v97
    v_lshlrev_b32 v110, 3, v96
    v_mov_b32 v112, 0
    v_mov_b32 v113, 0
    ds_write_b64 v2, v[110:111] offset:8192
    ds_write_b64 v2, v[112:113]
    v_mad_i32_i24 v96, v96, -5, v102
    v_mad_i32_i24 v97, v97, -5, v103
    s_add_u32 s50, s50, s84
    s_mov_b32 s28, s82
    s_mov_b32 s29, s83
    s_mov_b32 s30, s84
    s_lshl_b32 s74, s29, 3
    s_lshl_b32 s75, s30, 3
    v_mov_b32 v125, s74
    v_mov_b32 v126, s75
    v_mov_b32 v127, -1

    s_waitcnt lgkmcnt(0)
    s_barrier

    s_mov_b64 exec, 1
    ds_write_b32 v125, v127 offset:24588
    ds_write_b32 v126, v127 offset:24596
    s_mov_b64 exec, -1

    s_bitcmp0_b32 s28, 0
    s_cbranch_scc1 L_skz_20
    v_lshrrev_b32 v110, 16, v45
    ds_read_b32 v110, v110 offset:8192
    v_lshrrev_b32 v111, 16, v47
    ds_read_b32 v111, v111 offset:8192
    v_lshrrev_b32 v112, 16, v49
    ds_read_b32 v112, v112 offset:8192
    v_lshrrev_b32 v113, 16, v51
    ds_read_b32 v113, v113 offset:8192
    s_waitcnt lgkmcnt(3)
    v_lshl_add_u32 v110, v76, 3, v110
    ds_write_b64 v110, v[44:45] offset:24592

    s_waitcnt lgkmcnt(3)
    v_lshl_add_u32 v111, v77, 3, v111
    ds_write_b64 v111, v[46:47] offset:24592

    s_waitcnt lgkmcnt(3)
    v_lshl_add_u32 v112, v78, 3, v112
    ds_write_b64 v112, v[48:49] offset:24592

    s_waitcnt lgkmcnt(3)
    v_lshl_add_u32 v113, v79, 3, v113
    ds_write_b64 v113, v[50:51] offset:24592

L_skz_20:
    s_bitcmp0_b32 s28, 1
    s_cbranch_scc1 L_skz_21
    v_lshrrev_b32 v110, 16, v53
    ds_read_b32 v110, v110 offset:8192
    v_lshrrev_b32 v111, 16, v55
    ds_read_b32 v111, v111 offset:8192
    v_lshrrev_b32 v112, 16, v57
    ds_read_b32 v112, v112 offset:8192
    v_lshrrev_b32 v113, 16, v59
    ds_read_b32 v113, v113 offset:8192
    s_waitcnt lgkmcnt(3)
    v_lshl_add_u32 v110, v80, 3, v110
    ds_write_b64 v110, v[52:53] offset:24592

    s_waitcnt lgkmcnt(3)
    v_lshl_add_u32 v111, v81, 3, v111
    ds_write_b64 v111, v[54:55] offset:24592

    s_waitcnt lgkmcnt(3)
    v_lshl_add_u32 v112, v82, 3, v112
    ds_write_b64 v112, v[56:57] offset:24592

    s_waitcnt lgkmcnt(3)
    v_lshl_add_u32 v113, v83, 3, v113
    ds_write_b64 v113, v[58:59] offset:24592

L_skz_21:
    s_bitcmp0_b32 s28, 2
    s_cbranch_scc1 L_skz_22
    v_lshrrev_b32 v110, 16, v61
    ds_read_b32 v110, v110 offset:8192
    v_lshrrev_b32 v111, 16, v63
    ds_read_b32 v111, v111 offset:8192
    v_lshrrev_b32 v112, 16, v65
    ds_read_b32 v112, v112 offset:8192
    v_lshrrev_b32 v113, 16, v67
    ds_read_b32 v113, v113 offset:8192
    s_waitcnt lgkmcnt(3)
    v_lshl_add_u32 v110, v84, 3, v110
    ds_write_b64 v110, v[60:61] offset:24592

    s_waitcnt lgkmcnt(3)
    v_lshl_add_u32 v111, v85, 3, v111
    ds_write_b64 v111, v[62:63] offset:24592

    s_waitcnt lgkmcnt(3)
    v_lshl_add_u32 v112, v86, 3, v112
    ds_write_b64 v112, v[64:65] offset:24592

    s_waitcnt lgkmcnt(3)
    v_lshl_add_u32 v113, v87, 3, v113
    ds_write_b64 v113, v[66:67] offset:24592

L_skz_22:
    s_bitcmp0_b32 s28, 3
    s_cbranch_scc1 L_skz_23
    s_mov_b64 exec, s[66:67]
    v_lshrrev_b32 v110, 16, v69
    ds_read_b32 v110, v110 offset:8192
    v_lshrrev_b32 v111, 16, v71
    ds_read_b32 v111, v111 offset:8192
    v_lshrrev_b32 v112, 16, v73
    ds_read_b32 v112, v112 offset:8192
    v_lshrrev_b32 v113, 16, v75
    ds_read_b32 v113, v113 offset:8192
    s_waitcnt lgkmcnt(3)
    v_lshl_add_u32 v110, v88, 3, v110
    ds_write_b64 v110, v[68:69] offset:24592

    s_waitcnt lgkmcnt(3)
    v_lshl_add_u32 v111, v89, 3, v111
    ds_write_b64 v111, v[70:71] offset:24592

    s_waitcnt lgkmcnt(3)
    v_lshl_add_u32 v112, v90, 3, v112
    ds_write_b64 v112, v[72:73] offset:24592

    s_waitcnt lgkmcnt(3)
    v_lshl_add_u32 v113, v91, 3, v113
    ds_write_b64 v113, v[74:75] offset:24592

    s_mov_b64 exec, -1
L_skz_23:
    v_mov_b32 v110, s32
    v_mov_b32 v111, s33
    v_mov_b32 v112, s34
    v_mov_b32 v113, 0
    v_mov_b32 v115, 0x4b400000

    s_add_u32 s92, s6, 135168
    s_addc_u32 s93, s7, 0
    s_mov_b32 s94, 4096
    s_mov_b32 s95, 0x20000
    s_lshl_b32 s3, s2, 4
    buffer_store_dwordx4 v[110:113], v98, s[92:95], s3 offen
    v_lshlrev_b32 v107, 16, v116
    v_and_b32 v116, 0xffff0000, v116
    v_fma_f32 v107, v107, s34, v115
    v_fma_f32 v116, v116, s34, v115
    v_perm_b32 v116, v116, v107, s55

    v_lshlrev_b32 v107, 16, v117
    v_and_b32 v117, 0xffff0000, v117
    v_fma_f32 v107, v107, s34, v115
    v_fma_f32 v117, v117, s34, v115
    v_perm_b32 v117, v117, v107, s55

    v_lshlrev_b32 v107, 16, v118
    v_and_b32 v118, 0xffff0000, v118
    v_fma_f32 v107, v107, s34, v115
    v_fma_f32 v118, v118, s34, v115
    v_perm_b32 v118, v118, v107, s55

    v_lshlrev_b32 v107, 16, v119
    v_and_b32 v119, 0xffff0000, v119
    v_fma_f32 v107, v107, s34, v115
    v_fma_f32 v119, v119, s34, v115
    v_perm_b32 v119, v119, v107, s55

    v_lshlrev_b32 v107, 16, v120
    v_and_b32 v120, 0xffff0000, v120
    v_fma_f32 v107, v107, s34, v115
    v_fma_f32 v120, v120, s34, v115
    v_perm_b32 v120, v120, v107, s55

    v_lshlrev_b32 v107, 16, v121
    v_and_b32 v121, 0xffff0000, v121
    v_fma_f32 v107, v107, s34, v115
    v_fma_f32 v121, v121, s34, v115
    v_perm_b32 v121, v121, v107, s55

    v_lshlrev_b32 v107, 16, v122
    v_and_b32 v122, 0xffff0000, v122
    v_fma_f32 v107, v107, s34, v115
    v_fma_f32 v122, v122, s34, v115
    v_perm_b32 v122, v122, v107, s55

    v_lshlrev_b32 v107, 16, v123
    v_and_b32 v123, 0xffff0000, v123
    v_fma_f32 v107, v107, s34, v115
    v_fma_f32 v123, v123, s34, v115
    v_perm_b32 v123, v123, v107, s55

    v_lshlrev_b32 v107, 16, v124
    v_and_b32 v124, 0xffff0000, v124
    v_fma_f32 v107, v107, s34, v115
    v_fma_f32 v124, v124, s34, v115
    v_perm_b32 v124, v124, v107, s55

    s_add_u32 s92, s6, s54
    s_addc_u32 s93, s7, 0
    s_mov_b32 s94, 24576
    s_mov_b32 s95, 0x20000
    s_movk_i32 s3, 16384
    buffer_store_dwordx4 v[116:119], v1, s[92:95], 0 offen
    buffer_store_dwordx4 v[120:123], v1, s[92:95], s3 offen
    s_mul_i32 s94, s53, 25424
    s_movk_i32 s3, 24576
    v_lshlrev_b32 v107, 2, v0

    buffer_store_dword v124, v107, s[92:95], s3 offen
    s_nop 1
    s_cmp_eq_u32 s49, 0
    s_cbranch_scc1 L_p1epi_7
L_p1loop_6:
    s_mov_b32 s82, s85
    s_mov_b32 s83, s86
    s_mov_b32 s84, s87
    v_mov_b32 v99, 1
    buffer_atomic_add v99, v98, s[96:99], 0 offen sc0
    s_bitcmp0_b32 s82, 0
    s_cbranch_scc1 L_ska_24
    s_waitcnt vmcnt(11)
    v_mul_hi_u32_u24 v45, s40, v20
    v_mul_hi_u32_u24 v44, s40, v4
    v_mul_hi_u32_u24 v47, s40, v21
    v_mul_hi_u32_u24 v46, s40, v5
    v_mul_hi_u32_u24 v49, s40, v22
    v_mul_hi_u32_u24 v48, s40, v6
    v_mul_hi_u32_u24 v51, s40, v23
    v_mul_hi_u32_u24 v50, s40, v7
    v_and_b32 v45, -2, v45
    v_mad_u32_u24 v4, v44, s43, v4
    v_and_b32 v76, -4, v44
    v_and_b32 v47, -2, v47
    v_mad_u32_u24 v5, v46, s43, v5
    v_and_b32 v77, -4, v46
    v_and_b32 v49, -2, v49
    v_mad_u32_u24 v6, v48, s43, v6
    v_and_b32 v78, -4, v48
    v_and_b32 v51, -2, v51
    v_mad_u32_u24 v7, v50, s43, v7
    v_and_b32 v79, -4, v50
    v_mad_i32_i24 v20, v45, s42, v20
    v_lshl_add_u32 v45, v45, 6, v76
    v_mad_i32_i24 v21, v47, s42, v21
    v_lshl_add_u32 v47, v47, 6, v77
    v_mad_i32_i24 v22, v49, s42, v22
    v_lshl_add_u32 v49, v49, 6, v78
    v_mad_i32_i24 v23, v51, s42, v23
    v_lshl_add_u32 v51, v51, 6, v79
    ds_add_rtn_u32 v76, v45, v104
    ds_add_rtn_u32 v77, v47, v104
    ds_add_rtn_u32 v78, v49, v104
    ds_add_rtn_u32 v79, v51, v104
    v_lshlrev_b32 v110, 16, v36
    v_and_b32 v111, 0xffff0000, v36
    v_lshlrev_b32 v112, 16, v37
    v_and_b32 v113, 0xffff0000, v37
    v_mul_f32 v110, s44, v110
    v_mul_f32 v111, s44, v111
    v_mul_f32 v112, s44, v112
    v_mul_f32 v113, s44, v113
    v_fract_f32 v110, v110
    v_fract_f32 v111, v111
    v_fract_f32 v112, v112
    v_fract_f32 v113, v113
    v_cos_f32 v110, v110
    v_cos_f32 v111, v111
    v_cos_f32 v112, v112
    v_cos_f32 v113, v113
    v_lshl_or_b32 v44, v44, 14, v20
    v_perm_b32 v45, v45, v4, s46
    v_bfe_u32 v4, v4, 8, 5

    v_lshl_or_b32 v46, v46, 14, v21
    v_perm_b32 v47, v47, v5, s46
    v_bfe_u32 v5, v5, 8, 5

    v_lshl_or_b32 v48, v48, 14, v22
    v_perm_b32 v49, v49, v6, s46
    v_bfe_u32 v6, v6, 8, 5

    v_lshl_or_b32 v50, v50, 14, v23
    v_perm_b32 v51, v51, v7, s46
    v_bfe_u32 v7, v7, 8, 5

    v_fmaak_f32 v110, v110, v105, 0x4b400010
    v_fmaak_f32 v111, v111, v105, 0x4b400010
    v_fmaak_f32 v112, v112, v105, 0x4b400010
    v_fmaak_f32 v113, v113, v105, 0x4b400010
    v_sub_u32 v110, v110, v4
    v_sub_u32 v111, v111, v5
    v_sub_u32 v112, v112, v6
    v_sub_u32 v113, v113, v7
    v_bfi_b32 v110, 31, v4, v110
    v_bfi_b32 v111, 31, v5, v111
    v_bfi_b32 v112, 31, v6, v112
    v_bfi_b32 v113, 31, v7, v113
    v_perm_b32 v44, v44, v110, s55
    v_perm_b32 v46, v46, v111, s55
    v_perm_b32 v48, v48, v112, s55
    v_perm_b32 v50, v50, v113, s55
L_ska_24:
    s_bitcmp0_b32 s82, 1
    s_cbranch_scc1 L_ska_25
    s_waitcnt vmcnt(8)
    v_mul_hi_u32_u24 v53, s40, v24
    v_mul_hi_u32_u24 v52, s40, v8
    v_mul_hi_u32_u24 v55, s40, v25
    v_mul_hi_u32_u24 v54, s40, v9
    v_mul_hi_u32_u24 v57, s40, v26
    v_mul_hi_u32_u24 v56, s40, v10
    v_mul_hi_u32_u24 v59, s40, v27
    v_mul_hi_u32_u24 v58, s40, v11
    v_and_b32 v53, -2, v53
    v_mad_u32_u24 v8, v52, s43, v8
    v_and_b32 v80, -4, v52
    v_and_b32 v55, -2, v55
    v_mad_u32_u24 v9, v54, s43, v9
    v_and_b32 v81, -4, v54
    v_and_b32 v57, -2, v57
    v_mad_u32_u24 v10, v56, s43, v10
    v_and_b32 v82, -4, v56
    v_and_b32 v59, -2, v59
    v_mad_u32_u24 v11, v58, s43, v11
    v_and_b32 v83, -4, v58
    v_mad_i32_i24 v24, v53, s42, v24
    v_lshl_add_u32 v53, v53, 6, v80
    v_mad_i32_i24 v25, v55, s42, v25
    v_lshl_add_u32 v55, v55, 6, v81
    v_mad_i32_i24 v26, v57, s42, v26
    v_lshl_add_u32 v57, v57, 6, v82
    v_mad_i32_i24 v27, v59, s42, v27
    v_lshl_add_u32 v59, v59, 6, v83
    ds_add_rtn_u32 v80, v53, v104
    ds_add_rtn_u32 v81, v55, v104
    ds_add_rtn_u32 v82, v57, v104
    ds_add_rtn_u32 v83, v59, v104
    v_lshlrev_b32 v110, 16, v38
    v_and_b32 v111, 0xffff0000, v38
    v_lshlrev_b32 v112, 16, v39
    v_and_b32 v113, 0xffff0000, v39
    v_mul_f32 v110, s44, v110
    v_mul_f32 v111, s44, v111
    v_mul_f32 v112, s44, v112
    v_mul_f32 v113, s44, v113
    v_fract_f32 v110, v110
    v_fract_f32 v111, v111
    v_fract_f32 v112, v112
    v_fract_f32 v113, v113
    v_cos_f32 v110, v110
    v_cos_f32 v111, v111
    v_cos_f32 v112, v112
    v_cos_f32 v113, v113
    v_lshl_or_b32 v52, v52, 14, v24
    v_perm_b32 v53, v53, v8, s46
    v_bfe_u32 v8, v8, 8, 5

    v_lshl_or_b32 v54, v54, 14, v25
    v_perm_b32 v55, v55, v9, s46
    v_bfe_u32 v9, v9, 8, 5

    v_lshl_or_b32 v56, v56, 14, v26
    v_perm_b32 v57, v57, v10, s46
    v_bfe_u32 v10, v10, 8, 5

    v_lshl_or_b32 v58, v58, 14, v27
    v_perm_b32 v59, v59, v11, s46
    v_bfe_u32 v11, v11, 8, 5

    v_fmaak_f32 v110, v110, v105, 0x4b400010
    v_fmaak_f32 v111, v111, v105, 0x4b400010
    v_fmaak_f32 v112, v112, v105, 0x4b400010
    v_fmaak_f32 v113, v113, v105, 0x4b400010
    v_sub_u32 v110, v110, v8
    v_sub_u32 v111, v111, v9
    v_sub_u32 v112, v112, v10
    v_sub_u32 v113, v113, v11
    v_bfi_b32 v110, 31, v8, v110
    v_bfi_b32 v111, 31, v9, v111
    v_bfi_b32 v112, 31, v10, v112
    v_bfi_b32 v113, 31, v11, v113
    v_perm_b32 v52, v52, v110, s55
    v_perm_b32 v54, v54, v111, s55
    v_perm_b32 v56, v56, v112, s55
    v_perm_b32 v58, v58, v113, s55
L_ska_25:
    s_bitcmp0_b32 s82, 2
    s_cbranch_scc1 L_ska_26
    s_waitcnt vmcnt(4)
    v_mul_hi_u32_u24 v61, s40, v28
    v_mul_hi_u32_u24 v60, s40, v12
    v_mul_hi_u32_u24 v63, s40, v29
    v_mul_hi_u32_u24 v62, s40, v13
    v_mul_hi_u32_u24 v65, s40, v30
    v_mul_hi_u32_u24 v64, s40, v14
    v_mul_hi_u32_u24 v67, s40, v31
    v_mul_hi_u32_u24 v66, s40, v15
    v_and_b32 v61, -2, v61
    v_mad_u32_u24 v12, v60, s43, v12
    v_and_b32 v84, -4, v60
    v_and_b32 v63, -2, v63
    v_mad_u32_u24 v13, v62, s43, v13
    v_and_b32 v85, -4, v62
    v_and_b32 v65, -2, v65
    v_mad_u32_u24 v14, v64, s43, v14
    v_and_b32 v86, -4, v64
    v_and_b32 v67, -2, v67
    v_mad_u32_u24 v15, v66, s43, v15
    v_and_b32 v87, -4, v66
    v_mad_i32_i24 v28, v61, s42, v28
    v_lshl_add_u32 v61, v61, 6, v84
    v_mad_i32_i24 v29, v63, s42, v29
    v_lshl_add_u32 v63, v63, 6, v85
    v_mad_i32_i24 v30, v65, s42, v30
    v_lshl_add_u32 v65, v65, 6, v86
    v_mad_i32_i24 v31, v67, s42, v31
    v_lshl_add_u32 v67, v67, 6, v87
    ds_add_rtn_u32 v84, v61, v104
    ds_add_rtn_u32 v85, v63, v104
    ds_add_rtn_u32 v86, v65, v104
    ds_add_rtn_u32 v87, v67, v104
    v_lshlrev_b32 v110, 16, v40
    v_and_b32 v111, 0xffff0000, v40
    v_lshlrev_b32 v112, 16, v41
    v_and_b32 v113, 0xffff0000, v41
    v_mul_f32 v110, s44, v110
    v_mul_f32 v111, s44, v111
    v_mul_f32 v112, s44, v112
    v_mul_f32 v113, s44, v113
    v_fract_f32 v110, v110
    v_fract_f32 v111, v111
    v_fract_f32 v112, v112
    v_fract_f32 v113, v113
    v_cos_f32 v110, v110
    v_cos_f32 v111, v111
    v_cos_f32 v112, v112
    v_cos_f32 v113, v113
    v_lshl_or_b32 v60, v60, 14, v28
    v_perm_b32 v61, v61, v12, s46
    v_bfe_u32 v12, v12, 8, 5

    v_lshl_or_b32 v62, v62, 14, v29
    v_perm_b32 v63, v63, v13, s46
    v_bfe_u32 v13, v13, 8, 5

    v_lshl_or_b32 v64, v64, 14, v30
    v_perm_b32 v65, v65, v14, s46
    v_bfe_u32 v14, v14, 8, 5

    v_lshl_or_b32 v66, v66, 14, v31
    v_perm_b32 v67, v67, v15, s46
    v_bfe_u32 v15, v15, 8, 5

    v_fmaak_f32 v110, v110, v105, 0x4b400010
    v_fmaak_f32 v111, v111, v105, 0x4b400010
    v_fmaak_f32 v112, v112, v105, 0x4b400010
    v_fmaak_f32 v113, v113, v105, 0x4b400010
    v_sub_u32 v110, v110, v12
    v_sub_u32 v111, v111, v13
    v_sub_u32 v112, v112, v14
    v_sub_u32 v113, v113, v15
    v_bfi_b32 v110, 31, v12, v110
    v_bfi_b32 v111, 31, v13, v111
    v_bfi_b32 v112, 31, v14, v112
    v_bfi_b32 v113, 31, v15, v113
    v_perm_b32 v60, v60, v110, s55
    v_perm_b32 v62, v62, v111, s55
    v_perm_b32 v64, v64, v112, s55
    v_perm_b32 v66, v66, v113, s55
L_ska_26:
    s_waitcnt vmcnt(1)
    s_waitcnt vmcnt(0)
    v_cmp_eq_u32 vcc, 0, v0
    s_mov_b64 exec, vcc
    ds_write_b32 v108, v99 offset:8
    s_mov_b64 exec, -1
    s_waitcnt vmcnt(5)
    v_lshrrev_b32 v93, 16, v92
    v_and_b32 v92, 0xffff, v92
    v_add_u32 v110, v92, v94
    v_mad_u32_u24 v92, v92, 5, v96
    v_add_u32 v111, v93, v95
    v_mad_u32_u24 v93, v93, 5, v97
    v_max_u32 v110, v110, v111
    v_cmp_le_u32 vcc, s48, v110
    s_cbranch_vccnz L_full_27
L_fback_28:
    ds_write_b64 v2, v[92:93] offset:16384

    s_waitcnt lgkmcnt(0)
    s_barrier
    ds_read_b32 v111, v108 offset:8
    s_waitcnt lgkmcnt(0)
    v_readfirstlane_b32 s41, v111
    s_nop 1

    s_add_u32 s41, s41, 416
    s_sub_u32 s78, s41, 2965
    s_lshr_b32 s79, s78, 1
    s_add_u32 s79, s79, 2965
    s_and_b32 s86, s78, 1
    s_lshl_b32 s86, s86, 1
    s_add_u32 s87, s86, 2
    s_cmp_lt_u32 s41, 2965
    s_cselect_b32 s41, s41, s79
    s_cmovk_i32 s86, 0
    s_cmovk_i32 s87, 4

    s_mul_i32 s78, s41, 16384
    s_add_u32 s49, s78, 16384
    s_cmp_ge_u32 s41, 3125
    s_cmovk_i32 s49, 0
    s_cmovk_i32 s78, 0
    s_lshl_b32 s10, s49, 2
    s_lshl_b32 s14, s49, 2
    s_lshl_b32 s18, s49, 1
    s_sub_u32 s79, s87, s86
    s_bfm_b32 s85, s79, s86
    s_lshl_b32 s86, s86, 12
    s_lshl_b32 s87, s87, 12
    s_min_u32 s87, s87, 16384

    s_add_u32 s79, s78, 0
    s_bitcmp1_b32 s85, 0
    s_cselect_b32 s79, s79, 0x1ff00000
    s_lshl_b32 s56, s79, 2
    s_lshl_b32 s61, s79, 1

    s_add_u32 s79, s78, 4096
    s_bitcmp1_b32 s85, 1
    s_cselect_b32 s79, s79, 0x1ff00000
    s_lshl_b32 s57, s79, 2
    s_lshl_b32 s62, s79, 1

    s_add_u32 s79, s78, 8192
    s_bitcmp1_b32 s85, 2
    s_cselect_b32 s79, s79, 0x1ff00000
    s_lshl_b32 s58, s79, 2
    s_lshl_b32 s63, s79, 1

    s_add_u32 s79, s78, 12288
    s_bitcmp1_b32 s85, 3
    s_cselect_b32 s79, s79, 0x1ff00000
    s_lshl_b32 s59, s79, 2
    s_lshl_b32 s64, s79, 1

    s_bitcmp0_b32 s28, 0
    s_cbranch_scc1 L_skw_29
    ds_read_b64 v[110:111], v2 offset:24592
    ds_read_b64 v[112:113], v2 offset:24600
    ds_read_b64 v[114:115], v2 offset:24584

    ds_read_b64 v[118:119], v2 offset:32784
    ds_read_b64 v[120:121], v2 offset:32792
    ds_read_b64 v[122:123], v2 offset:32776

    s_waitcnt lgkmcnt(3)
    v_lshrrev_b32 v116, 16, v111
    ds_read_b32 v116, v116 offset:16384

    s_waitcnt lgkmcnt(1)
    v_lshrrev_b32 v124, 16, v119
    ds_read_b32 v124, v124 offset:16384

    v_cmp_ne_u32_sdwa s[80:81], v111, v113 src0_sel:WORD_1 src1_sel:WORD_1
    v_cmp_ne_u32_sdwa vcc, v111, v115 src0_sel:WORD_1 src1_sel:WORD_1
    v_alignbyte_b32 v114, v111, v114, 1
    s_mov_b32 s54, -3
    v_perm_b32 v112, v112, v113, s45
    s_waitcnt lgkmcnt(1)
    v_add3_u32 v116, v116, v106, s54
    v_sub_u32 v117, 0, v116
    v_and_b32 v117, 3, v117
    s_mov_b64 exec, s[80:81]
    v_mov_b32 v117, 0
    v_mov_b32 v112, 0
    s_mov_b64 exec, vcc
    v_mov_b32 v117, 3

    s_mov_b64 exec, -1
    v_alignbyte_b32 v111, v112, v110, v117
    v_alignbyte_b32 v110, v110, v114, v117
    v_add_u32 v116, v116, v117

    buffer_store_dwordx2 v[110:111], v116, s[24:27], 0 offen
    v_cmp_ne_u32_sdwa s[80:81], v119, v121 src0_sel:WORD_1 src1_sel:WORD_1
    v_cmp_ne_u32_sdwa vcc, v119, v123 src0_sel:WORD_1 src1_sel:WORD_1
    v_alignbyte_b32 v122, v119, v122, 1
    s_mov_b32 s54, 5117
    v_perm_b32 v120, v120, v121, s45
    s_waitcnt lgkmcnt(0)
    v_add3_u32 v124, v124, v106, s54
    v_sub_u32 v125, 0, v124
    v_and_b32 v125, 3, v125
    s_mov_b64 exec, s[80:81]
    v_mov_b32 v125, 0
    v_mov_b32 v120, 0
    s_mov_b64 exec, vcc
    v_mov_b32 v125, 3

    s_mov_b64 exec, -1
    v_alignbyte_b32 v119, v120, v118, v125
    v_alignbyte_b32 v118, v118, v122, v125
    v_add_u32 v124, v124, v125

    buffer_store_dwordx2 v[118:119], v124, s[24:27], 0 offen
L_skw_29:
    s_bitcmp0_b32 s28, 0
    s_cbranch_scc1 L_skw_30
    ds_read_b64 v[110:111], v2 offset:40976
    ds_read_b64 v[112:113], v2 offset:40984
    ds_read_b64 v[114:115], v2 offset:40968

    ds_read_b64 v[118:119], v2 offset:49168
    ds_read_b64 v[120:121], v2 offset:49176
    ds_read_b64 v[122:123], v2 offset:49160

    s_waitcnt lgkmcnt(3)
    v_lshrrev_b32 v116, 16, v111
    ds_read_b32 v116, v116 offset:16384

    s_waitcnt lgkmcnt(1)
    v_lshrrev_b32 v124, 16, v119
    ds_read_b32 v124, v124 offset:16384

    v_cmp_ne_u32_sdwa s[80:81], v111, v113 src0_sel:WORD_1 src1_sel:WORD_1
    v_cmp_ne_u32_sdwa vcc, v111, v115 src0_sel:WORD_1 src1_sel:WORD_1
    v_alignbyte_b32 v114, v111, v114, 1
    s_mov_b32 s54, 10237
    v_perm_b32 v112, v112, v113, s45
    s_waitcnt lgkmcnt(1)
    v_add3_u32 v116, v116, v106, s54
    v_sub_u32 v117, 0, v116
    v_and_b32 v117, 3, v117
    s_mov_b64 exec, s[80:81]
    v_mov_b32 v117, 0
    v_mov_b32 v112, 0
    s_mov_b64 exec, vcc
    v_mov_b32 v117, 3

    s_mov_b64 exec, -1
    v_alignbyte_b32 v111, v112, v110, v117
    v_alignbyte_b32 v110, v110, v114, v117
    v_add_u32 v116, v116, v117

    buffer_store_dwordx2 v[110:111], v116, s[24:27], 0 offen
    v_cmp_ne_u32_sdwa s[80:81], v119, v121 src0_sel:WORD_1 src1_sel:WORD_1
    v_cmp_ne_u32_sdwa vcc, v119, v123 src0_sel:WORD_1 src1_sel:WORD_1
    v_alignbyte_b32 v122, v119, v122, 1
    s_mov_b32 s54, 15357
    v_perm_b32 v120, v120, v121, s45
    s_waitcnt lgkmcnt(0)
    v_add3_u32 v124, v124, v106, s54
    v_sub_u32 v125, 0, v124
    v_and_b32 v125, 3, v125
    s_mov_b64 exec, s[80:81]
    v_mov_b32 v125, 0
    v_mov_b32 v120, 0
    s_mov_b64 exec, vcc
    v_mov_b32 v125, 3

    s_mov_b64 exec, -1
    v_alignbyte_b32 v119, v120, v118, v125
    v_alignbyte_b32 v118, v118, v122, v125
    v_add_u32 v124, v124, v125

    buffer_store_dwordx2 v[118:119], v124, s[24:27], 0 offen
L_skw_30:
    s_bitcmp0_b32 s28, 1
    s_cbranch_scc1 L_skw_31
    v_add_u32 v107, 32768, v2
    ds_read_b64 v[110:111], v107 offset:24592
    ds_read_b64 v[112:113], v107 offset:24600
    ds_read_b64 v[114:115], v107 offset:24584

    ds_read_b64 v[118:119], v107 offset:32784
    ds_read_b64 v[120:121], v107 offset:32792
    ds_read_b64 v[122:123], v107 offset:32776

    s_waitcnt lgkmcnt(3)
    v_lshrrev_b32 v116, 16, v111
    ds_read_b32 v116, v116 offset:16384

    s_waitcnt lgkmcnt(1)
    v_lshrrev_b32 v124, 16, v119
    ds_read_b32 v124, v124 offset:16384

    v_cmp_ne_u32_sdwa s[80:81], v111, v113 src0_sel:WORD_1 src1_sel:WORD_1
    v_cmp_ne_u32_sdwa vcc, v111, v115 src0_sel:WORD_1 src1_sel:WORD_1
    v_alignbyte_b32 v114, v111, v114, 1
    s_mov_b32 s54, 20477
    v_perm_b32 v112, v112, v113, s45
    s_waitcnt lgkmcnt(1)
    v_add3_u32 v116, v116, v106, s54
    v_sub_u32 v117, 0, v116
    v_and_b32 v117, 3, v117
    s_mov_b64 exec, s[80:81]
    v_mov_b32 v117, 0
    v_mov_b32 v112, 0
    s_mov_b64 exec, vcc
    v_mov_b32 v117, 3

    s_mov_b64 exec, -1
    v_alignbyte_b32 v111, v112, v110, v117
    v_alignbyte_b32 v110, v110, v114, v117
    v_add_u32 v116, v116, v117

    buffer_store_dwordx2 v[110:111], v116, s[24:27], 0 offen
    v_cmp_ne_u32_sdwa s[80:81], v119, v121 src0_sel:WORD_1 src1_sel:WORD_1
    v_cmp_ne_u32_sdwa vcc, v119, v123 src0_sel:WORD_1 src1_sel:WORD_1
    v_alignbyte_b32 v122, v119, v122, 1
    s_mov_b32 s54, 25597
    v_perm_b32 v120, v120, v121, s45
    s_waitcnt lgkmcnt(0)
    v_add3_u32 v124, v124, v106, s54
    v_sub_u32 v125, 0, v124
    v_and_b32 v125, 3, v125
    s_mov_b64 exec, s[80:81]
    v_mov_b32 v125, 0
    v_mov_b32 v120, 0
    s_mov_b64 exec, vcc
    v_mov_b32 v125, 3

    s_mov_b64 exec, -1
    v_alignbyte_b32 v119, v120, v118, v125
    v_alignbyte_b32 v118, v118, v122, v125
    v_add_u32 v124, v124, v125

    buffer_store_dwordx2 v[118:119], v124, s[24:27], 0 offen
L_skw_31:
    s_bitcmp0_b32 s28, 1
    s_cbranch_scc1 L_skw_32
    v_add_u32 v107, 32768, v2
    ds_read_b64 v[110:111], v107 offset:40976
    ds_read_b64 v[112:113], v107 offset:40984
    ds_read_b64 v[114:115], v107 offset:40968

    ds_read_b64 v[118:119], v107 offset:49168
    ds_read_b64 v[120:121], v107 offset:49176
    ds_read_b64 v[122:123], v107 offset:49160

    s_waitcnt lgkmcnt(3)
    v_lshrrev_b32 v116, 16, v111
    ds_read_b32 v116, v116 offset:16384

    s_waitcnt lgkmcnt(1)
    v_lshrrev_b32 v124, 16, v119
    ds_read_b32 v124, v124 offset:16384

    v_cmp_ne_u32_sdwa s[80:81], v111, v113 src0_sel:WORD_1 src1_sel:WORD_1
    v_cmp_ne_u32_sdwa vcc, v111, v115 src0_sel:WORD_1 src1_sel:WORD_1
    v_alignbyte_b32 v114, v111, v114, 1
    s_mov_b32 s54, 30717
    v_perm_b32 v112, v112, v113, s45
    s_waitcnt lgkmcnt(1)
    v_add3_u32 v116, v116, v106, s54
    v_sub_u32 v117, 0, v116
    v_and_b32 v117, 3, v117
    s_mov_b64 exec, s[80:81]
    v_mov_b32 v117, 0
    v_mov_b32 v112, 0
    s_mov_b64 exec, vcc
    v_mov_b32 v117, 3

    s_mov_b64 exec, -1
    v_alignbyte_b32 v111, v112, v110, v117
    v_alignbyte_b32 v110, v110, v114, v117
    v_add_u32 v116, v116, v117

    buffer_store_dwordx2 v[110:111], v116, s[24:27], 0 offen
    v_cmp_ne_u32_sdwa s[80:81], v119, v121 src0_sel:WORD_1 src1_sel:WORD_1
    v_cmp_ne_u32_sdwa vcc, v119, v123 src0_sel:WORD_1 src1_sel:WORD_1
    v_alignbyte_b32 v122, v119, v122, 1
    s_mov_b32 s54, 35837
    v_perm_b32 v120, v120, v121, s45
    s_waitcnt lgkmcnt(0)
    v_add3_u32 v124, v124, v106, s54
    v_sub_u32 v125, 0, v124
    v_and_b32 v125, 3, v125
    s_mov_b64 exec, s[80:81]
    v_mov_b32 v125, 0
    v_mov_b32 v120, 0
    s_mov_b64 exec, vcc
    v_mov_b32 v125, 3

    s_mov_b64 exec, -1
    v_alignbyte_b32 v119, v120, v118, v125
    v_alignbyte_b32 v118, v118, v122, v125
    v_add_u32 v124, v124, v125

    buffer_store_dwordx2 v[118:119], v124, s[24:27], 0 offen
L_skw_32:
    s_bitcmp0_b32 s82, 3
    s_cbranch_scc1 L_ska_33
    s_mov_b64 exec, s[66:67]
    v_mul_hi_u32_u24 v69, s40, v32
    v_mul_hi_u32_u24 v68, s40, v16
    v_mul_hi_u32_u24 v71, s40, v33
    v_mul_hi_u32_u24 v70, s40, v17
    v_mul_hi_u32_u24 v73, s40, v34
    v_mul_hi_u32_u24 v72, s40, v18
    v_mul_hi_u32_u24 v75, s40, v35
    v_mul_hi_u32_u24 v74, s40, v19
    v_and_b32 v69, -2, v69
    v_mad_u32_u24 v16, v68, s43, v16
    v_and_b32 v88, -4, v68
    v_and_b32 v71, -2, v71
    v_mad_u32_u24 v17, v70, s43, v17
    v_and_b32 v89, -4, v70
    v_and_b32 v73, -2, v73
    v_mad_u32_u24 v18, v72, s43, v18
    v_and_b32 v90, -4, v72
    v_and_b32 v75, -2, v75
    v_mad_u32_u24 v19, v74, s43, v19
    v_and_b32 v91, -4, v74
    v_mad_i32_i24 v32, v69, s42, v32
    v_lshl_add_u32 v69, v69, 6, v88
    v_mad_i32_i24 v33, v71, s42, v33
    v_lshl_add_u32 v71, v71, 6, v89
    v_mad_i32_i24 v34, v73, s42, v34
    v_lshl_add_u32 v73, v73, 6, v90
    v_mad_i32_i24 v35, v75, s42, v35
    v_lshl_add_u32 v75, v75, 6, v91
    ds_add_rtn_u32 v88, v69, v104
    ds_add_rtn_u32 v89, v71, v104
    ds_add_rtn_u32 v90, v73, v104
    ds_add_rtn_u32 v91, v75, v104
    v_lshlrev_b32 v110, 16, v42
    v_and_b32 v111, 0xffff0000, v42
    v_lshlrev_b32 v112, 16, v43
    v_and_b32 v113, 0xffff0000, v43
    v_mul_f32 v110, s44, v110
    v_mul_f32 v111, s44, v111
    v_mul_f32 v112, s44, v112
    v_mul_f32 v113, s44, v113
    v_fract_f32 v110, v110
    v_fract_f32 v111, v111
    v_fract_f32 v112, v112
    v_fract_f32 v113, v113
    v_cos_f32 v110, v110
    v_cos_f32 v111, v111
    v_cos_f32 v112, v112
    v_cos_f32 v113, v113
    v_lshl_or_b32 v68, v68, 14, v32
    v_perm_b32 v69, v69, v16, s46
    v_bfe_u32 v16, v16, 8, 5

    v_lshl_or_b32 v70, v70, 14, v33
    v_perm_b32 v71, v71, v17, s46
    v_bfe_u32 v17, v17, 8, 5

    v_lshl_or_b32 v72, v72, 14, v34
    v_perm_b32 v73, v73, v18, s46
    v_bfe_u32 v18, v18, 8, 5

    v_lshl_or_b32 v74, v74, 14, v35
    v_perm_b32 v75, v75, v19, s46
    v_bfe_u32 v19, v19, 8, 5

    v_fmaak_f32 v110, v110, v105, 0x4b400010
    v_fmaak_f32 v111, v111, v105, 0x4b400010
    v_fmaak_f32 v112, v112, v105, 0x4b400010
    v_fmaak_f32 v113, v113, v105, 0x4b400010
    v_sub_u32 v110, v110, v16
    v_sub_u32 v111, v111, v17
    v_sub_u32 v112, v112, v18
    v_sub_u32 v113, v113, v19
    v_bfi_b32 v110, 31, v16, v110
    v_bfi_b32 v111, 31, v17, v111
    v_bfi_b32 v112, 31, v18, v112
    v_bfi_b32 v113, 31, v19, v113
    v_perm_b32 v68, v68, v110, s55
    v_perm_b32 v70, v70, v111, s55
    v_perm_b32 v72, v72, v112, s55
    v_perm_b32 v74, v74, v113, s55
    s_mov_b64 exec, -1
L_ska_33:
    s_bitcmp0_b32 s28, 2
    s_cbranch_scc1 L_skw_34
    v_add_u32 v107, 65536, v2
    ds_read_b64 v[110:111], v107 offset:24592
    ds_read_b64 v[112:113], v107 offset:24600
    ds_read_b64 v[114:115], v107 offset:24584

    ds_read_b64 v[118:119], v107 offset:32784
    ds_read_b64 v[120:121], v107 offset:32792
    ds_read_b64 v[122:123], v107 offset:32776

    s_waitcnt lgkmcnt(3)
    v_lshrrev_b32 v116, 16, v111
    ds_read_b32 v116, v116 offset:16384

    s_waitcnt lgkmcnt(1)
    v_lshrrev_b32 v124, 16, v119
    ds_read_b32 v124, v124 offset:16384

    v_cmp_ne_u32_sdwa s[80:81], v111, v113 src0_sel:WORD_1 src1_sel:WORD_1
    v_cmp_ne_u32_sdwa vcc, v111, v115 src0_sel:WORD_1 src1_sel:WORD_1
    v_alignbyte_b32 v114, v111, v114, 1
    s_mov_b32 s54, 40957
    v_perm_b32 v112, v112, v113, s45
    s_waitcnt lgkmcnt(1)
    v_add3_u32 v116, v116, v106, s54
    v_sub_u32 v117, 0, v116
    v_and_b32 v117, 3, v117
    s_mov_b64 exec, s[80:81]
    v_mov_b32 v117, 0
    v_mov_b32 v112, 0
    s_mov_b64 exec, vcc
    v_mov_b32 v117, 3

    s_mov_b64 exec, -1
    v_alignbyte_b32 v111, v112, v110, v117
    v_alignbyte_b32 v110, v110, v114, v117
    v_add_u32 v116, v116, v117

    buffer_store_dwordx2 v[110:111], v116, s[24:27], 0 offen
    v_cmp_ne_u32_sdwa s[80:81], v119, v121 src0_sel:WORD_1 src1_sel:WORD_1
    v_cmp_ne_u32_sdwa vcc, v119, v123 src0_sel:WORD_1 src1_sel:WORD_1
    v_alignbyte_b32 v122, v119, v122, 1
    s_mov_b32 s54, 46077
    v_perm_b32 v120, v120, v121, s45
    s_waitcnt lgkmcnt(0)
    v_add3_u32 v124, v124, v106, s54
    v_sub_u32 v125, 0, v124
    v_and_b32 v125, 3, v125
    s_mov_b64 exec, s[80:81]
    v_mov_b32 v125, 0
    v_mov_b32 v120, 0
    s_mov_b64 exec, vcc
    v_mov_b32 v125, 3

    s_mov_b64 exec, -1
    v_alignbyte_b32 v119, v120, v118, v125
    v_alignbyte_b32 v118, v118, v122, v125
    v_add_u32 v124, v124, v125

    buffer_store_dwordx2 v[118:119], v124, s[24:27], 0 offen
L_skw_34:
    s_bitcmp0_b32 s28, 2
    s_cbranch_scc1 L_skw_35
    v_add_u32 v107, 65536, v2
    ds_read_b64 v[110:111], v107 offset:40976
    ds_read_b64 v[112:113], v107 offset:40984
    ds_read_b64 v[114:115], v107 offset:40968

    ds_read_b64 v[118:119], v107 offset:49168
    ds_read_b64 v[120:121], v107 offset:49176
    ds_read_b64 v[122:123], v107 offset:49160

    s_waitcnt lgkmcnt(3)
    v_lshrrev_b32 v116, 16, v111
    ds_read_b32 v116, v116 offset:16384

    s_waitcnt lgkmcnt(1)
    v_lshrrev_b32 v124, 16, v119
    ds_read_b32 v124, v124 offset:16384

    v_cmp_ne_u32_sdwa s[80:81], v111, v113 src0_sel:WORD_1 src1_sel:WORD_1
    v_cmp_ne_u32_sdwa vcc, v111, v115 src0_sel:WORD_1 src1_sel:WORD_1
    v_alignbyte_b32 v114, v111, v114, 1
    s_mov_b32 s54, 51197
    v_perm_b32 v112, v112, v113, s45
    s_waitcnt lgkmcnt(1)
    v_add3_u32 v116, v116, v106, s54
    v_sub_u32 v117, 0, v116
    v_and_b32 v117, 3, v117
    s_mov_b64 exec, s[80:81]
    v_mov_b32 v117, 0
    v_mov_b32 v112, 0
    s_mov_b64 exec, vcc
    v_mov_b32 v117, 3

    s_mov_b64 exec, -1
    v_alignbyte_b32 v111, v112, v110, v117
    v_alignbyte_b32 v110, v110, v114, v117
    v_add_u32 v116, v116, v117

    buffer_store_dwordx2 v[110:111], v116, s[24:27], 0 offen
    v_cmp_ne_u32_sdwa s[80:81], v119, v121 src0_sel:WORD_1 src1_sel:WORD_1
    v_cmp_ne_u32_sdwa vcc, v119, v123 src0_sel:WORD_1 src1_sel:WORD_1
    v_alignbyte_b32 v122, v119, v122, 1
    s_mov_b32 s54, 56317
    v_perm_b32 v120, v120, v121, s45
    s_waitcnt lgkmcnt(0)
    v_add3_u32 v124, v124, v106, s54
    v_sub_u32 v125, 0, v124
    v_and_b32 v125, 3, v125
    s_mov_b64 exec, s[80:81]
    v_mov_b32 v125, 0
    v_mov_b32 v120, 0
    s_mov_b64 exec, vcc
    v_mov_b32 v125, 3

    s_mov_b64 exec, -1
    v_alignbyte_b32 v119, v120, v118, v125
    v_alignbyte_b32 v118, v118, v122, v125
    v_add_u32 v124, v124, v125

    buffer_store_dwordx2 v[118:119], v124, s[24:27], 0 offen
L_skw_35:
    s_bitcmp0_b32 s28, 3
    s_cbranch_scc1 L_skw_36
    v_add_u32 v107, 98304, v2
    ds_read_b64 v[110:111], v107 offset:24592
    ds_read_b64 v[112:113], v107 offset:24600
    ds_read_b64 v[114:115], v107 offset:24584

    ds_read_b64 v[118:119], v107 offset:32784
    ds_read_b64 v[120:121], v107 offset:32792
    ds_read_b64 v[122:123], v107 offset:32776

    s_waitcnt lgkmcnt(3)
    v_lshrrev_b32 v116, 16, v111
    ds_read_b32 v116, v116 offset:16384

    s_waitcnt lgkmcnt(1)
    v_lshrrev_b32 v124, 16, v119
    ds_read_b32 v124, v124 offset:16384

    v_cmp_ne_u32_sdwa s[80:81], v111, v113 src0_sel:WORD_1 src1_sel:WORD_1
    v_cmp_ne_u32_sdwa vcc, v111, v115 src0_sel:WORD_1 src1_sel:WORD_1
    v_alignbyte_b32 v114, v111, v114, 1
    s_mov_b32 s54, 61437
    v_perm_b32 v112, v112, v113, s45
    s_waitcnt lgkmcnt(1)
    v_add3_u32 v116, v116, v106, s54
    v_sub_u32 v117, 0, v116
    v_and_b32 v117, 3, v117
    s_mov_b64 exec, s[80:81]
    v_mov_b32 v117, 0
    v_mov_b32 v112, 0
    s_mov_b64 exec, vcc
    v_mov_b32 v117, 3

    s_mov_b64 exec, -1
    v_alignbyte_b32 v111, v112, v110, v117
    v_alignbyte_b32 v110, v110, v114, v117
    v_add_u32 v116, v116, v117

    buffer_store_dwordx2 v[110:111], v116, s[24:27], 0 offen
    v_cmp_ne_u32_sdwa s[80:81], v119, v121 src0_sel:WORD_1 src1_sel:WORD_1
    v_cmp_ne_u32_sdwa vcc, v119, v123 src0_sel:WORD_1 src1_sel:WORD_1
    v_alignbyte_b32 v122, v119, v122, 1
    s_mov_b32 s54, 66557
    v_perm_b32 v120, v120, v121, s45
    s_waitcnt lgkmcnt(0)
    v_add3_u32 v124, v124, v106, s54
    v_sub_u32 v125, 0, v124
    v_and_b32 v125, 3, v125
    s_mov_b64 exec, s[80:81]
    v_mov_b32 v125, 0
    v_mov_b32 v120, 0
    s_mov_b64 exec, vcc
    v_mov_b32 v125, 3

    s_mov_b64 exec, -1
    v_alignbyte_b32 v119, v120, v118, v125
    v_alignbyte_b32 v118, v118, v122, v125
    v_add_u32 v124, v124, v125

    buffer_store_dwordx2 v[118:119], v124, s[24:27], 0 offen
L_skw_36:
    s_bitcmp0_b32 s28, 3
    s_cbranch_scc1 L_skw_37
    v_add_u32 v107, 98304, v2
    ds_read_b64 v[110:111], v107 offset:40976
    ds_read_b64 v[112:113], v107 offset:40984
    ds_read_b64 v[114:115], v107 offset:40968

    ds_read_b64 v[118:119], v107 offset:49168
    ds_read_b64 v[120:121], v107 offset:49176
    ds_read_b64 v[122:123], v107 offset:49160

    s_waitcnt lgkmcnt(3)
    v_lshrrev_b32 v116, 16, v111
    ds_read_b32 v116, v116 offset:16384

    s_waitcnt lgkmcnt(1)
    v_lshrrev_b32 v124, 16, v119
    ds_read_b32 v124, v124 offset:16384

    v_cmp_ne_u32_sdwa s[80:81], v111, v113 src0_sel:WORD_1 src1_sel:WORD_1
    v_cmp_ne_u32_sdwa vcc, v111, v115 src0_sel:WORD_1 src1_sel:WORD_1
    v_alignbyte_b32 v114, v111, v114, 1
    s_mov_b32 s54, 71677
    v_perm_b32 v112, v112, v113, s45
    s_waitcnt lgkmcnt(1)
    v_add3_u32 v116, v116, v106, s54
    v_sub_u32 v117, 0, v116
    v_and_b32 v117, 3, v117
    s_mov_b64 exec, s[80:81]
    v_mov_b32 v117, 0
    v_mov_b32 v112, 0
    s_mov_b64 exec, vcc
    v_mov_b32 v117, 3

    s_mov_b64 exec, -1
    v_alignbyte_b32 v111, v112, v110, v117
    v_alignbyte_b32 v110, v110, v114, v117
    v_add_u32 v116, v116, v117

    buffer_store_dwordx2 v[110:111], v116, s[24:27], 0 offen
    v_cmp_ne_u32_sdwa s[80:81], v119, v121 src0_sel:WORD_1 src1_sel:WORD_1
    v_cmp_ne_u32_sdwa vcc, v119, v123 src0_sel:WORD_1 src1_sel:WORD_1
    v_alignbyte_b32 v122, v119, v122, 1
    s_mov_b32 s54, 76797
    v_perm_b32 v120, v120, v121, s45
    s_waitcnt lgkmcnt(0)
    v_add3_u32 v124, v124, v106, s54
    v_sub_u32 v125, 0, v124
    v_and_b32 v125, 3, v125
    s_mov_b64 exec, s[80:81]
    v_mov_b32 v125, 0
    v_mov_b32 v120, 0
    s_mov_b64 exec, vcc
    v_mov_b32 v125, 3

    s_mov_b64 exec, -1
    v_alignbyte_b32 v119, v120, v118, v125
    v_alignbyte_b32 v118, v118, v122, v125
    v_add_u32 v124, v124, v125

    buffer_store_dwordx2 v[118:119], v124, s[24:27], 0 offen
L_skw_37:
    s_waitcnt lgkmcnt(0)
    s_barrier

    buffer_load_dwordx4 v[20:23], v1, s[12:15], s56 offen nt
    buffer_load_dwordx4 v[4:7], v1, s[8:11], s56 offen nt
    buffer_load_dwordx2 v[36:37], v2, s[16:19], s61 offen nt
    buffer_load_dwordx4 v[24:27], v1, s[12:15], s57 offen nt
    buffer_load_dwordx4 v[8:11], v1, s[8:11], s57 offen nt
    buffer_load_dwordx2 v[38:39], v2, s[16:19], s62 offen nt
    ds_read_b64 v[94:95], v2
    s_waitcnt lgkmcnt(0)
    v_add_u32 v97, v94, v95
    s_nop 1
    v_add_u32_dpp v97, v97, v97 row_shr:1 row_mask:0xf bank_mask:0xf
    s_nop 1
    v_add_u32_dpp v97, v97, v97 row_shr:2 row_mask:0xf bank_mask:0xf
    s_nop 1
    v_add_u32_dpp v97, v97, v97 row_shr:4 row_mask:0xf bank_mask:0xf
    s_nop 1
    v_add_u32_dpp v97, v97, v97 row_shr:8 row_mask:0xf bank_mask:0xf
    s_nop 1
    v_add_u32_dpp v97, v97, v97 row_bcast:15 row_mask:0xa bank_mask:0xf
    s_nop 1
    v_add_u32_dpp v97, v97, v97 row_bcast:31 row_mask:0xc bank_mask:0xf
    s_mov_b32 exec_lo, 0
    s_brev_b32 exec_hi, 1
    ds_add_rtn_u32 v96, v108, v97
    s_mov_b64 exec, -1

    v_add_u32 v92, v94, v94
    v_add_u32 v93, v95, v95
    v_med3_u32 v92, v94, 2, v92
    v_med3_u32 v93, v95, 2, v93
    v_lshl_or_b32 v92, v93, 16, v92
    v_lshlrev_b32 v93, 2, v0
    buffer_atomic_add v92, v93, s[20:23], 0 offen sc0
    s_waitcnt lgkmcnt(0)
    v_readlane_b32 s77, v96, 63
    v_sub_u32 v97, v97, v95
    s_sub_u32 s50, s50, s83
    s_sub_u32 s77, s77, s50
    v_add_u32 v97, s77, v97
    v_sub_u32 v96, v97, v94
    v_lshlrev_b32 v111, 3, v97
    v_lshlrev_b32 v110, 3, v96
    v_mov_b32 v112, 0
    v_mov_b32 v113, 0
    ds_write_b64 v2, v[110:111] offset:8192
    ds_write_b64 v2, v[112:113]
    v_mad_i32_i24 v96, v96, -5, v102
    v_mad_i32_i24 v97, v97, -5, v103
    s_add_u32 s50, s50, s84
    s_mov_b32 s28, s82
    s_mov_b32 s29, s83
    s_mov_b32 s30, s84
    s_lshl_b32 s74, s29, 3
    s_lshl_b32 s75, s30, 3
    v_mov_b32 v125, s74
    v_mov_b32 v126, s75
    v_mov_b32 v127, -1

    s_waitcnt lgkmcnt(0)
    s_barrier

    s_mov_b64 exec, 1
    ds_write_b32 v125, v127 offset:24588
    ds_write_b32 v126, v127 offset:24596
    s_mov_b64 exec, -1

    s_bitcmp0_b32 s28, 0
    s_cbranch_scc1 L_skz_38
    v_lshrrev_b32 v110, 16, v45
    ds_read_b32 v110, v110 offset:8192
    v_lshrrev_b32 v111, 16, v47
    ds_read_b32 v111, v111 offset:8192
    v_lshrrev_b32 v112, 16, v49
    ds_read_b32 v112, v112 offset:8192
    v_lshrrev_b32 v113, 16, v51
    ds_read_b32 v113, v113 offset:8192
    v_lshrrev_b32 v114, 16, v53
    ds_read_b32 v114, v114 offset:8192
    v_lshrrev_b32 v115, 16, v55
    ds_read_b32 v115, v115 offset:8192
    v_lshrrev_b32 v116, 16, v57
    ds_read_b32 v116, v116 offset:8192
    v_lshrrev_b32 v117, 16, v59
    ds_read_b32 v117, v117 offset:8192
    s_waitcnt lgkmcnt(7)
    v_lshl_add_u32 v110, v76, 3, v110
    ds_write_b64 v110, v[44:45] offset:24592

    s_waitcnt lgkmcnt(7)
    v_lshl_add_u32 v111, v77, 3, v111
    ds_write_b64 v111, v[46:47] offset:24592

    s_waitcnt lgkmcnt(7)
    v_lshl_add_u32 v112, v78, 3, v112
    ds_write_b64 v112, v[48:49] offset:24592

    s_waitcnt lgkmcnt(7)
    v_lshl_add_u32 v113, v79, 3, v113
    ds_write_b64 v113, v[50:51] offset:24592

    s_waitcnt lgkmcnt(7)
    v_lshl_add_u32 v114, v80, 3, v114
    ds_write_b64 v114, v[52:53] offset:24592

    s_waitcnt lgkmcnt(7)
    v_lshl_add_u32 v115, v81, 3, v115
    ds_write_b64 v115, v[54:55] offset:24592

    s_waitcnt lgkmcnt(7)
    v_lshl_add_u32 v116, v82, 3, v116
    ds_write_b64 v116, v[56:57] offset:24592

    s_waitcnt lgkmcnt(7)
    v_lshl_add_u32 v117, v83, 3, v117
    ds_write_b64 v117, v[58:59] offset:24592

L_skz_38:
    buffer_load_dwordx4 v[28:31], v1, s[12:15], s58 offen nt
    buffer_load_dwordx4 v[12:15], v1, s[8:11], s58 offen nt
    buffer_load_dwordx2 v[40:41], v2, s[16:19], s63 offen nt
    s_bitcmp0_b32 s28, 2
    s_cbranch_scc1 L_skz_39
    v_lshrrev_b32 v110, 16, v61
    ds_read_b32 v110, v110 offset:8192
    v_lshrrev_b32 v111, 16, v63
    ds_read_b32 v111, v111 offset:8192
    v_lshrrev_b32 v112, 16, v65
    ds_read_b32 v112, v112 offset:8192
    v_lshrrev_b32 v113, 16, v67
    ds_read_b32 v113, v113 offset:8192
    s_waitcnt lgkmcnt(3)
    v_lshl_add_u32 v110, v84, 3, v110
    ds_write_b64 v110, v[60:61] offset:24592

    s_waitcnt lgkmcnt(3)
    v_lshl_add_u32 v111, v85, 3, v111
    ds_write_b64 v111, v[62:63] offset:24592

    s_waitcnt lgkmcnt(3)
    v_lshl_add_u32 v112, v86, 3, v112
    ds_write_b64 v112, v[64:65] offset:24592

    s_waitcnt lgkmcnt(3)
    v_lshl_add_u32 v113, v87, 3, v113
    ds_write_b64 v113, v[66:67] offset:24592

L_skz_39:
    s_bitcmp0_b32 s28, 3
    s_cbranch_scc1 L_skz_40
    s_mov_b64 exec, s[66:67]
    v_lshrrev_b32 v110, 16, v69
    ds_read_b32 v110, v110 offset:8192
    v_lshrrev_b32 v111, 16, v71
    ds_read_b32 v111, v111 offset:8192
    v_lshrrev_b32 v112, 16, v73
    ds_read_b32 v112, v112 offset:8192
    v_lshrrev_b32 v113, 16, v75
    ds_read_b32 v113, v113 offset:8192
    s_waitcnt lgkmcnt(3)
    v_lshl_add_u32 v110, v88, 3, v110
    ds_write_b64 v110, v[68:69] offset:24592

    s_waitcnt lgkmcnt(3)
    v_lshl_add_u32 v111, v89, 3, v111
    ds_write_b64 v111, v[70:71] offset:24592

    s_waitcnt lgkmcnt(3)
    v_lshl_add_u32 v112, v90, 3, v112
    ds_write_b64 v112, v[72:73] offset:24592

    s_waitcnt lgkmcnt(3)
    v_lshl_add_u32 v113, v91, 3, v113
    ds_write_b64 v113, v[74:75] offset:24592

    s_mov_b64 exec, -1
L_skz_40:
    buffer_load_dwordx4 v[32:35], v1, s[12:15], s59 offen nt
    buffer_load_dwordx4 v[16:19], v1, s[8:11], s59 offen nt
    buffer_load_dwordx2 v[42:43], v2, s[16:19], s64 offen nt
    s_cmp_lg_u32 s49, 0
    s_cbranch_scc1 L_p1loop_6
L_p1epi_7:
    s_waitcnt vmcnt(0)
    s_waitcnt vmcnt(4)
    v_lshrrev_b32 v93, 16, v92
    v_and_b32 v92, 0xffff, v92
    v_add_u32 v110, v92, v94
    v_mad_u32_u24 v92, v92, 5, v96
    v_add_u32 v111, v93, v95
    v_mad_u32_u24 v93, v93, 5, v97
    v_max_u32 v110, v110, v111
    v_cmp_le_u32 vcc, s48, v110
    s_cbranch_vccnz L_full_41
L_fback_42:
    ds_write_b64 v2, v[92:93] offset:16384

    s_waitcnt lgkmcnt(0)
    s_barrier

    s_bitcmp0_b32 s28, 0
    s_cbranch_scc1 L_skw_43
    ds_read_b64 v[4:5], v2 offset:24592
    ds_read_b64 v[6:7], v2 offset:24600
    ds_read_b64 v[8:9], v2 offset:24584

    ds_read_b64 v[12:13], v2 offset:32784
    ds_read_b64 v[14:15], v2 offset:32792
    ds_read_b64 v[16:17], v2 offset:32776

    ds_read_b64 v[20:21], v2 offset:40976
    ds_read_b64 v[22:23], v2 offset:40984
    ds_read_b64 v[24:25], v2 offset:40968

    ds_read_b64 v[28:29], v2 offset:49168
    ds_read_b64 v[30:31], v2 offset:49176
    ds_read_b64 v[32:33], v2 offset:49160

    s_waitcnt lgkmcnt(9)
    v_lshrrev_b32 v10, 16, v5
    ds_read_b32 v10, v10 offset:16384

    s_waitcnt lgkmcnt(7)
    v_lshrrev_b32 v18, 16, v13
    ds_read_b32 v18, v18 offset:16384

    s_waitcnt lgkmcnt(5)
    v_lshrrev_b32 v26, 16, v21
    ds_read_b32 v26, v26 offset:16384

    s_waitcnt lgkmcnt(3)
    v_lshrrev_b32 v34, 16, v29
    ds_read_b32 v34, v34 offset:16384

    v_cmp_ne_u32_sdwa s[80:81], v5, v7 src0_sel:WORD_1 src1_sel:WORD_1
    v_cmp_ne_u32_sdwa vcc, v5, v9 src0_sel:WORD_1 src1_sel:WORD_1
    v_alignbyte_b32 v8, v5, v8, 1
    s_mov_b32 s54, -3
    v_perm_b32 v6, v6, v7, s45
    s_waitcnt lgkmcnt(3)
    v_add3_u32 v10, v10, v106, s54
    v_sub_u32 v11, 0, v10
    v_and_b32 v11, 3, v11
    s_mov_b64 exec, s[80:81]
    v_mov_b32 v11, 0
    v_mov_b32 v6, 0
    s_mov_b64 exec, vcc
    v_mov_b32 v11, 3

    s_mov_b64 exec, -1
    v_alignbyte_b32 v5, v6, v4, v11
    v_alignbyte_b32 v4, v4, v8, v11
    v_add_u32 v10, v10, v11

    buffer_store_dwordx2 v[4:5], v10, s[24:27], 0 offen
    v_cmp_ne_u32_sdwa s[80:81], v13, v15 src0_sel:WORD_1 src1_sel:WORD_1
    v_cmp_ne_u32_sdwa vcc, v13, v17 src0_sel:WORD_1 src1_sel:WORD_1
    v_alignbyte_b32 v16, v13, v16, 1
    s_mov_b32 s54, 5117
    v_perm_b32 v14, v14, v15, s45
    s_waitcnt lgkmcnt(2)
    v_add3_u32 v18, v18, v106, s54
    v_sub_u32 v19, 0, v18
    v_and_b32 v19, 3, v19
    s_mov_b64 exec, s[80:81]
    v_mov_b32 v19, 0
    v_mov_b32 v14, 0
    s_mov_b64 exec, vcc
    v_mov_b32 v19, 3

    s_mov_b64 exec, -1
    v_alignbyte_b32 v13, v14, v12, v19
    v_alignbyte_b32 v12, v12, v16, v19
    v_add_u32 v18, v18, v19

    buffer_store_dwordx2 v[12:13], v18, s[24:27], 0 offen
    v_cmp_ne_u32_sdwa s[80:81], v21, v23 src0_sel:WORD_1 src1_sel:WORD_1
    v_cmp_ne_u32_sdwa vcc, v21, v25 src0_sel:WORD_1 src1_sel:WORD_1
    v_alignbyte_b32 v24, v21, v24, 1
    s_mov_b32 s54, 10237
    v_perm_b32 v22, v22, v23, s45
    s_waitcnt lgkmcnt(1)
    v_add3_u32 v26, v26, v106, s54
    v_sub_u32 v27, 0, v26
    v_and_b32 v27, 3, v27
    s_mov_b64 exec, s[80:81]
    v_mov_b32 v27, 0
    v_mov_b32 v22, 0
    s_mov_b64 exec, vcc
    v_mov_b32 v27, 3

    s_mov_b64 exec, -1
    v_alignbyte_b32 v21, v22, v20, v27
    v_alignbyte_b32 v20, v20, v24, v27
    v_add_u32 v26, v26, v27

    buffer_store_dwordx2 v[20:21], v26, s[24:27], 0 offen
    v_cmp_ne_u32_sdwa s[80:81], v29, v31 src0_sel:WORD_1 src1_sel:WORD_1
    v_cmp_ne_u32_sdwa vcc, v29, v33 src0_sel:WORD_1 src1_sel:WORD_1
    v_alignbyte_b32 v32, v29, v32, 1
    s_mov_b32 s54, 15357
    v_perm_b32 v30, v30, v31, s45
    s_waitcnt lgkmcnt(0)
    v_add3_u32 v34, v34, v106, s54
    v_sub_u32 v35, 0, v34
    v_and_b32 v35, 3, v35
    s_mov_b64 exec, s[80:81]
    v_mov_b32 v35, 0
    v_mov_b32 v30, 0
    s_mov_b64 exec, vcc
    v_mov_b32 v35, 3

    s_mov_b64 exec, -1
    v_alignbyte_b32 v29, v30, v28, v35
    v_alignbyte_b32 v28, v28, v32, v35
    v_add_u32 v34, v34, v35

    buffer_store_dwordx2 v[28:29], v34, s[24:27], 0 offen
L_skw_43:
    s_bitcmp0_b32 s28, 1
    s_cbranch_scc1 L_skw_44
    v_add_u32 v107, 32768, v2
    ds_read_b64 v[4:5], v107 offset:24592
    ds_read_b64 v[6:7], v107 offset:24600
    ds_read_b64 v[8:9], v107 offset:24584

    ds_read_b64 v[12:13], v107 offset:32784
    ds_read_b64 v[14:15], v107 offset:32792
    ds_read_b64 v[16:17], v107 offset:32776

    ds_read_b64 v[20:21], v107 offset:40976
    ds_read_b64 v[22:23], v107 offset:40984
    ds_read_b64 v[24:25], v107 offset:40968

    ds_read_b64 v[28:29], v107 offset:49168
    ds_read_b64 v[30:31], v107 offset:49176
    ds_read_b64 v[32:33], v107 offset:49160

    s_waitcnt lgkmcnt(9)
    v_lshrrev_b32 v10, 16, v5
    ds_read_b32 v10, v10 offset:16384

    s_waitcnt lgkmcnt(7)
    v_lshrrev_b32 v18, 16, v13
    ds_read_b32 v18, v18 offset:16384

    s_waitcnt lgkmcnt(5)
    v_lshrrev_b32 v26, 16, v21
    ds_read_b32 v26, v26 offset:16384

    s_waitcnt lgkmcnt(3)
    v_lshrrev_b32 v34, 16, v29
    ds_read_b32 v34, v34 offset:16384

    v_cmp_ne_u32_sdwa s[80:81], v5, v7 src0_sel:WORD_1 src1_sel:WORD_1
    v_cmp_ne_u32_sdwa vcc, v5, v9 src0_sel:WORD_1 src1_sel:WORD_1
    v_alignbyte_b32 v8, v5, v8, 1
    s_mov_b32 s54, 20477
    v_perm_b32 v6, v6, v7, s45
    s_waitcnt lgkmcnt(3)
    v_add3_u32 v10, v10, v106, s54
    v_sub_u32 v11, 0, v10
    v_and_b32 v11, 3, v11
    s_mov_b64 exec, s[80:81]
    v_mov_b32 v11, 0
    v_mov_b32 v6, 0
    s_mov_b64 exec, vcc
    v_mov_b32 v11, 3

    s_mov_b64 exec, -1
    v_alignbyte_b32 v5, v6, v4, v11
    v_alignbyte_b32 v4, v4, v8, v11
    v_add_u32 v10, v10, v11

    buffer_store_dwordx2 v[4:5], v10, s[24:27], 0 offen
    v_cmp_ne_u32_sdwa s[80:81], v13, v15 src0_sel:WORD_1 src1_sel:WORD_1
    v_cmp_ne_u32_sdwa vcc, v13, v17 src0_sel:WORD_1 src1_sel:WORD_1
    v_alignbyte_b32 v16, v13, v16, 1
    s_mov_b32 s54, 25597
    v_perm_b32 v14, v14, v15, s45
    s_waitcnt lgkmcnt(2)
    v_add3_u32 v18, v18, v106, s54
    v_sub_u32 v19, 0, v18
    v_and_b32 v19, 3, v19
    s_mov_b64 exec, s[80:81]
    v_mov_b32 v19, 0
    v_mov_b32 v14, 0
    s_mov_b64 exec, vcc
    v_mov_b32 v19, 3

    s_mov_b64 exec, -1
    v_alignbyte_b32 v13, v14, v12, v19
    v_alignbyte_b32 v12, v12, v16, v19
    v_add_u32 v18, v18, v19

    buffer_store_dwordx2 v[12:13], v18, s[24:27], 0 offen
    v_cmp_ne_u32_sdwa s[80:81], v21, v23 src0_sel:WORD_1 src1_sel:WORD_1
    v_cmp_ne_u32_sdwa vcc, v21, v25 src0_sel:WORD_1 src1_sel:WORD_1
    v_alignbyte_b32 v24, v21, v24, 1
    s_mov_b32 s54, 30717
    v_perm_b32 v22, v22, v23, s45
    s_waitcnt lgkmcnt(1)
    v_add3_u32 v26, v26, v106, s54
    v_sub_u32 v27, 0, v26
    v_and_b32 v27, 3, v27
    s_mov_b64 exec, s[80:81]
    v_mov_b32 v27, 0
    v_mov_b32 v22, 0
    s_mov_b64 exec, vcc
    v_mov_b32 v27, 3

    s_mov_b64 exec, -1
    v_alignbyte_b32 v21, v22, v20, v27
    v_alignbyte_b32 v20, v20, v24, v27
    v_add_u32 v26, v26, v27

    buffer_store_dwordx2 v[20:21], v26, s[24:27], 0 offen
    v_cmp_ne_u32_sdwa s[80:81], v29, v31 src0_sel:WORD_1 src1_sel:WORD_1
    v_cmp_ne_u32_sdwa vcc, v29, v33 src0_sel:WORD_1 src1_sel:WORD_1
    v_alignbyte_b32 v32, v29, v32, 1
    s_mov_b32 s54, 35837
    v_perm_b32 v30, v30, v31, s45
    s_waitcnt lgkmcnt(0)
    v_add3_u32 v34, v34, v106, s54
    v_sub_u32 v35, 0, v34
    v_and_b32 v35, 3, v35
    s_mov_b64 exec, s[80:81]
    v_mov_b32 v35, 0
    v_mov_b32 v30, 0
    s_mov_b64 exec, vcc
    v_mov_b32 v35, 3

    s_mov_b64 exec, -1
    v_alignbyte_b32 v29, v30, v28, v35
    v_alignbyte_b32 v28, v28, v32, v35
    v_add_u32 v34, v34, v35

    buffer_store_dwordx2 v[28:29], v34, s[24:27], 0 offen
L_skw_44:
    s_bitcmp0_b32 s28, 2
    s_cbranch_scc1 L_skw_45
    v_add_u32 v107, 65536, v2
    ds_read_b64 v[4:5], v107 offset:24592
    ds_read_b64 v[6:7], v107 offset:24600
    ds_read_b64 v[8:9], v107 offset:24584

    ds_read_b64 v[12:13], v107 offset:32784
    ds_read_b64 v[14:15], v107 offset:32792
    ds_read_b64 v[16:17], v107 offset:32776

    ds_read_b64 v[20:21], v107 offset:40976
    ds_read_b64 v[22:23], v107 offset:40984
    ds_read_b64 v[24:25], v107 offset:40968

    ds_read_b64 v[28:29], v107 offset:49168
    ds_read_b64 v[30:31], v107 offset:49176
    ds_read_b64 v[32:33], v107 offset:49160

    s_waitcnt lgkmcnt(9)
    v_lshrrev_b32 v10, 16, v5
    ds_read_b32 v10, v10 offset:16384

    s_waitcnt lgkmcnt(7)
    v_lshrrev_b32 v18, 16, v13
    ds_read_b32 v18, v18 offset:16384

    s_waitcnt lgkmcnt(5)
    v_lshrrev_b32 v26, 16, v21
    ds_read_b32 v26, v26 offset:16384

    s_waitcnt lgkmcnt(3)
    v_lshrrev_b32 v34, 16, v29
    ds_read_b32 v34, v34 offset:16384

    v_cmp_ne_u32_sdwa s[80:81], v5, v7 src0_sel:WORD_1 src1_sel:WORD_1
    v_cmp_ne_u32_sdwa vcc, v5, v9 src0_sel:WORD_1 src1_sel:WORD_1
    v_alignbyte_b32 v8, v5, v8, 1
    s_mov_b32 s54, 40957
    v_perm_b32 v6, v6, v7, s45
    s_waitcnt lgkmcnt(3)
    v_add3_u32 v10, v10, v106, s54
    v_sub_u32 v11, 0, v10
    v_and_b32 v11, 3, v11
    s_mov_b64 exec, s[80:81]
    v_mov_b32 v11, 0
    v_mov_b32 v6, 0
    s_mov_b64 exec, vcc
    v_mov_b32 v11, 3

    s_mov_b64 exec, -1
    v_alignbyte_b32 v5, v6, v4, v11
    v_alignbyte_b32 v4, v4, v8, v11
    v_add_u32 v10, v10, v11

    buffer_store_dwordx2 v[4:5], v10, s[24:27], 0 offen
    v_cmp_ne_u32_sdwa s[80:81], v13, v15 src0_sel:WORD_1 src1_sel:WORD_1
    v_cmp_ne_u32_sdwa vcc, v13, v17 src0_sel:WORD_1 src1_sel:WORD_1
    v_alignbyte_b32 v16, v13, v16, 1
    s_mov_b32 s54, 46077
    v_perm_b32 v14, v14, v15, s45
    s_waitcnt lgkmcnt(2)
    v_add3_u32 v18, v18, v106, s54
    v_sub_u32 v19, 0, v18
    v_and_b32 v19, 3, v19
    s_mov_b64 exec, s[80:81]
    v_mov_b32 v19, 0
    v_mov_b32 v14, 0
    s_mov_b64 exec, vcc
    v_mov_b32 v19, 3

    s_mov_b64 exec, -1
    v_alignbyte_b32 v13, v14, v12, v19
    v_alignbyte_b32 v12, v12, v16, v19
    v_add_u32 v18, v18, v19

    buffer_store_dwordx2 v[12:13], v18, s[24:27], 0 offen
    v_cmp_ne_u32_sdwa s[80:81], v21, v23 src0_sel:WORD_1 src1_sel:WORD_1
    v_cmp_ne_u32_sdwa vcc, v21, v25 src0_sel:WORD_1 src1_sel:WORD_1
    v_alignbyte_b32 v24, v21, v24, 1
    s_mov_b32 s54, 51197
    v_perm_b32 v22, v22, v23, s45
    s_waitcnt lgkmcnt(1)
    v_add3_u32 v26, v26, v106, s54
    v_sub_u32 v27, 0, v26
    v_and_b32 v27, 3, v27
    s_mov_b64 exec, s[80:81]
    v_mov_b32 v27, 0
    v_mov_b32 v22, 0
    s_mov_b64 exec, vcc
    v_mov_b32 v27, 3

    s_mov_b64 exec, -1
    v_alignbyte_b32 v21, v22, v20, v27
    v_alignbyte_b32 v20, v20, v24, v27
    v_add_u32 v26, v26, v27

    buffer_store_dwordx2 v[20:21], v26, s[24:27], 0 offen
    v_cmp_ne_u32_sdwa s[80:81], v29, v31 src0_sel:WORD_1 src1_sel:WORD_1
    v_cmp_ne_u32_sdwa vcc, v29, v33 src0_sel:WORD_1 src1_sel:WORD_1
    v_alignbyte_b32 v32, v29, v32, 1
    s_mov_b32 s54, 56317
    v_perm_b32 v30, v30, v31, s45
    s_waitcnt lgkmcnt(0)
    v_add3_u32 v34, v34, v106, s54
    v_sub_u32 v35, 0, v34
    v_and_b32 v35, 3, v35
    s_mov_b64 exec, s[80:81]
    v_mov_b32 v35, 0
    v_mov_b32 v30, 0
    s_mov_b64 exec, vcc
    v_mov_b32 v35, 3

    s_mov_b64 exec, -1
    v_alignbyte_b32 v29, v30, v28, v35
    v_alignbyte_b32 v28, v28, v32, v35
    v_add_u32 v34, v34, v35

    buffer_store_dwordx2 v[28:29], v34, s[24:27], 0 offen
L_skw_45:
    s_bitcmp0_b32 s28, 3
    s_cbranch_scc1 L_skw_46
    v_add_u32 v107, 98304, v2
    ds_read_b64 v[4:5], v107 offset:24592
    ds_read_b64 v[6:7], v107 offset:24600
    ds_read_b64 v[8:9], v107 offset:24584

    ds_read_b64 v[12:13], v107 offset:32784
    ds_read_b64 v[14:15], v107 offset:32792
    ds_read_b64 v[16:17], v107 offset:32776

    ds_read_b64 v[20:21], v107 offset:40976
    ds_read_b64 v[22:23], v107 offset:40984
    ds_read_b64 v[24:25], v107 offset:40968

    ds_read_b64 v[28:29], v107 offset:49168
    ds_read_b64 v[30:31], v107 offset:49176
    ds_read_b64 v[32:33], v107 offset:49160

    s_waitcnt lgkmcnt(9)
    v_lshrrev_b32 v10, 16, v5
    ds_read_b32 v10, v10 offset:16384

    s_waitcnt lgkmcnt(7)
    v_lshrrev_b32 v18, 16, v13
    ds_read_b32 v18, v18 offset:16384

    s_waitcnt lgkmcnt(5)
    v_lshrrev_b32 v26, 16, v21
    ds_read_b32 v26, v26 offset:16384

    s_waitcnt lgkmcnt(3)
    v_lshrrev_b32 v34, 16, v29
    ds_read_b32 v34, v34 offset:16384

    v_cmp_ne_u32_sdwa s[80:81], v5, v7 src0_sel:WORD_1 src1_sel:WORD_1
    v_cmp_ne_u32_sdwa vcc, v5, v9 src0_sel:WORD_1 src1_sel:WORD_1
    v_alignbyte_b32 v8, v5, v8, 1
    s_mov_b32 s54, 61437
    v_perm_b32 v6, v6, v7, s45
    s_waitcnt lgkmcnt(3)
    v_add3_u32 v10, v10, v106, s54
    v_sub_u32 v11, 0, v10
    v_and_b32 v11, 3, v11
    s_mov_b64 exec, s[80:81]
    v_mov_b32 v11, 0
    v_mov_b32 v6, 0
    s_mov_b64 exec, vcc
    v_mov_b32 v11, 3

    s_mov_b64 exec, -1
    v_alignbyte_b32 v5, v6, v4, v11
    v_alignbyte_b32 v4, v4, v8, v11
    v_add_u32 v10, v10, v11

    buffer_store_dwordx2 v[4:5], v10, s[24:27], 0 offen
    v_cmp_ne_u32_sdwa s[80:81], v13, v15 src0_sel:WORD_1 src1_sel:WORD_1
    v_cmp_ne_u32_sdwa vcc, v13, v17 src0_sel:WORD_1 src1_sel:WORD_1
    v_alignbyte_b32 v16, v13, v16, 1
    s_mov_b32 s54, 66557
    v_perm_b32 v14, v14, v15, s45
    s_waitcnt lgkmcnt(2)
    v_add3_u32 v18, v18, v106, s54
    v_sub_u32 v19, 0, v18
    v_and_b32 v19, 3, v19
    s_mov_b64 exec, s[80:81]
    v_mov_b32 v19, 0
    v_mov_b32 v14, 0
    s_mov_b64 exec, vcc
    v_mov_b32 v19, 3

    s_mov_b64 exec, -1
    v_alignbyte_b32 v13, v14, v12, v19
    v_alignbyte_b32 v12, v12, v16, v19
    v_add_u32 v18, v18, v19

    buffer_store_dwordx2 v[12:13], v18, s[24:27], 0 offen
    v_cmp_ne_u32_sdwa s[80:81], v21, v23 src0_sel:WORD_1 src1_sel:WORD_1
    v_cmp_ne_u32_sdwa vcc, v21, v25 src0_sel:WORD_1 src1_sel:WORD_1
    v_alignbyte_b32 v24, v21, v24, 1
    s_mov_b32 s54, 71677
    v_perm_b32 v22, v22, v23, s45
    s_waitcnt lgkmcnt(1)
    v_add3_u32 v26, v26, v106, s54
    v_sub_u32 v27, 0, v26
    v_and_b32 v27, 3, v27
    s_mov_b64 exec, s[80:81]
    v_mov_b32 v27, 0
    v_mov_b32 v22, 0
    s_mov_b64 exec, vcc
    v_mov_b32 v27, 3

    s_mov_b64 exec, -1
    v_alignbyte_b32 v21, v22, v20, v27
    v_alignbyte_b32 v20, v20, v24, v27
    v_add_u32 v26, v26, v27

    buffer_store_dwordx2 v[20:21], v26, s[24:27], 0 offen
    v_cmp_ne_u32_sdwa s[80:81], v29, v31 src0_sel:WORD_1 src1_sel:WORD_1
    v_cmp_ne_u32_sdwa vcc, v29, v33 src0_sel:WORD_1 src1_sel:WORD_1
    v_alignbyte_b32 v32, v29, v32, 1
    s_mov_b32 s54, 76797
    v_perm_b32 v30, v30, v31, s45
    s_waitcnt lgkmcnt(0)
    v_add3_u32 v34, v34, v106, s54
    v_sub_u32 v35, 0, v34
    v_and_b32 v35, 3, v35
    s_mov_b64 exec, s[80:81]
    v_mov_b32 v35, 0
    v_mov_b32 v30, 0
    s_mov_b64 exec, vcc
    v_mov_b32 v35, 3

    s_mov_b64 exec, -1
    v_alignbyte_b32 v29, v30, v28, v35
    v_alignbyte_b32 v28, v28, v32, v35
    v_add_u32 v34, v34, v35

    buffer_store_dwordx2 v[28:29], v34, s[24:27], 0 offen
L_skw_46:
L_p1done_1:
    s_endpgm

L_ska_8:
    v_bfrev_b32 v126, 1
    buffer_load_dword v3, v126, s[96:99], 0 offen
    buffer_load_dword v3, v126, s[96:99], 0 offen
    buffer_load_dword v3, v126, s[96:99], 0 offen
    s_branch L_bka_9
L_ska_10:
    v_bfrev_b32 v126, 1
    buffer_load_dword v3, v126, s[96:99], 0 offen
    buffer_load_dword v3, v126, s[96:99], 0 offen
    buffer_load_dword v3, v126, s[96:99], 0 offen
    s_branch L_bka_11
L_ska_12:
    v_bfrev_b32 v126, 1
    buffer_load_dword v3, v126, s[96:99], 0 offen
    buffer_load_dword v3, v126, s[96:99], 0 offen
    buffer_load_dword v3, v126, s[96:99], 0 offen
    s_branch L_bka_13
L_ska_14:
    v_bfrev_b32 v126, 1
    buffer_load_dword v3, v126, s[96:99], 0 offen
    buffer_load_dword v3, v126, s[96:99], 0 offen
    buffer_load_dword v3, v126, s[96:99], 0 offen
    s_branch L_bka_15
L_full_27:
    v_mov_b32 v110, 0
    s_mov_b64 exec, vcc
    v_bfrev_b32 v92, 1
    v_bfrev_b32 v93, 1
    s_mov_b64 exec, 1
    buffer_atomic_or v104, v110, s[36:39], 0 offen
    s_mov_b64 exec, -1
    s_branch L_fback_28

L_full_41:
    v_mov_b32 v110, 0
    s_mov_b64 exec, vcc
    v_bfrev_b32 v92, 1
    v_bfrev_b32 v93, 1
    s_mov_b64 exec, 1
    buffer_atomic_or v104, v110, s[36:39], 0 offen
    s_mov_b64 exec, -1
    s_branch L_fback_42

.globl standalone__molecular_angular_gemnet__graph_kernel
.p2align 8
.type standalone__molecular_angular_gemnet__graph_kernel,@function
standalone__molecular_angular_gemnet__graph_kernel:
    s_cmp_ge_u32 s2, 256
    s_cbranch_scc1 L_p2done_47
    s_load_dwordx2 s[8:9], s[0:1], 0
    s_load_dwordx2 s[6:7], s[0:1], 104
    v_lshrrev_b32 v4, 6, v0
    s_lshr_b32 s37, s2, 1
    s_and_b32 s37, s37, 3
    s_lshr_b32 s36, s2, 3
    s_lshl_b32 s36, s36, 1
    s_and_b32 s3, s2, 1
    s_or_b32 s36, s36, s3
    v_readfirstlane_b32 s4, v4
    v_and_b32 v2, 63, v0
    v_lshrrev_b32 v3, 9, v0
    v_lshl_or_b32 v2, v3, 6, v2
    v_mul_u32_u24 v2, 20, v2
    v_lshlrev_b32 v3, 4, v0

    s_waitcnt lgkmcnt(0)
    s_lshl_b32 m0, s4, 10
    s_mov_b32 s25, s4
    s_and_b32 s5, s4, 7
    s_lshr_b32 s39, s4, 3
    s_lshl_b32 s39, s39, 8
    s_mul_i32 s3, s5, 4096
    s_add_u32 s46, s6, s3
    s_addc_u32 s47, s7, 0
    s_mul_i32 s3, s5, 67117056
    s_add_u32 s3, s3, 85721088
    s_add_u32 s44, s6, s3
    s_addc_u32 s45, s7, 0
    s_mul_i32 s38, s37, 8
    s_add_u32 s4, s38, 8
    s_lshl_b32 s3, s36, 5
    s_add_u32 s3, s3, s38
    s_lshl_b32 s3, s3, 1
    s_load_dwordx4 s[92:95], s[46:47], s3
    s_mov_b32 s3, 32768
    s_load_dword s51, s[6:7], s3
    s_mov_b32 s10, 6400000
    s_mov_b32 s11, 0x20000

    s_add_u32 s12, s6, 2490368
    s_addc_u32 s13, s7, 0
    s_mov_b32 s14, 0
    s_mov_b32 s15, 0x20000
    s_add_u32 s60, s6, 2490368
    s_addc_u32 s61, s7, 0
    s_mov_b32 s62, 6406144
    s_mov_b32 s63, 0x20000
    s_mov_b32 s3, 135176
    s_load_dword s33, s[6:7], s3

    s_mul_i32 s43, s38, 200192
    s_mul_i32 s41, s4, 200192
    s_mul_i32 s50, s38, 200000
    s_add_u32 s14, s43, 50000

    s_add_u32 s52, s43, 49152
    s_cmp_ge_u32 s25, 4
    s_cbranch_scc1 L_sk3_49
    v_lshlrev_b32 v119, 2, v0
    buffer_load_dword v88, v119, s[12:15], s52 offen
L_sk3_49:
    buffer_load_dwordx4 v[76:79], v3, s[12:15], s43 offen
    s_add_u32 s52, s43, 16384
    buffer_load_dwordx4 v[80:83], v3, s[12:15], s52 offen
    s_add_u32 s52, s43, 32768
    buffer_load_dwordx4 v[84:87], v3, s[12:15], s52 offen
    s_add_u32 s20, s6, 135168
    s_addc_u32 s21, s7, 0
    s_mov_b32 s22, 4096
    s_mov_b32 s23, 0x20000
    v_and_b32 v44, 63, v0
    v_lshlrev_b32 v44, 4, v44
    buffer_load_dwordx2 v[120:121], v44, s[20:23], 0 offen offset:0
    buffer_load_dwordx2 v[122:123], v44, s[20:23], 0 offen offset:1024
    buffer_load_dwordx2 v[124:125], v44, s[20:23], 0 offen offset:2048
    buffer_load_dwordx2 v[126:127], v44, s[20:23], 0 offen offset:3072
    s_movk_i32 s40, 3072
    s_mov_b32 s19, 0x20000
    s_min_u32 s40, s40, 6524
    s_lshl_b32 s52, s38, 6
    s_add_u32 s52, s52, s36
    s_mul_i32 s52, s52, 32764
    s_and_b32 s52, s52, 0xffffff80
    s_add_u32 s16, s44, s52
    s_addc_u32 s17, s45, 0
    s_mul_i32 s52, s40, 5
    s_add_u32 s52, s52, 3
    s_and_b32 s18, s52, -4

    s_movk_i32 s53, 5120
    buffer_load_dwordx4 v[90:93], v2, s[16:19], s53 offen offset:4
    buffer_load_dword v110, v2, s[16:19], s53 offen
    s_movk_i32 s53, 7680
    buffer_load_dwordx4 v[94:97], v2, s[16:19], s53 offen offset:4
    buffer_load_dword v111, v2, s[16:19], s53 offen
    s_movk_i32 s53, 10240
    buffer_load_dwordx4 v[98:101], v2, s[16:19], s53 offen offset:4
    buffer_load_dword v112, v2, s[16:19], s53 offen
    s_lshr_b32 s3, s2, 3
    s_mul_i32 s3, s3, 49
    v_add_lshl_u32 v89, v0, s3, 7
    v_cmp_gt_u32 vcc, 49, v0
    v_bfrev_b32 v28, 1
    s_nop 0
    v_cndmask_b32 v89, v28, v89, vcc

    s_mov_b32 s19, 0x20000
    s_mov_b32 s28, 0x4b404000
    s_mov_b32 s29, 0x4b404000
    s_mov_b32 s30, 0xbfffc000
    s_mov_b32 s31, 0xbfffbfff
    s_mov_b32 s32, 0xffff0000
    s_mov_b32 s35, 0x05040100
    s_mov_b32 s97, 0x07060302
    s_mov_b32 s96, 0x40008000
    s_movk_i32 s3, 212
    v_cmp_gt_u32 s[48:49], s3, v0

    v_mov_b32 v1, 0
    s_mov_b32 s24, 0x0c0c0004
    v_mov_b32 v28, 0x40004000
    v_mov_b32 v29, 0x40004000
    v_mov_b32 v30, 0x40004000
    v_mov_b32 v31, 0x40004000
    v_add_u32 v32, 50000, v3
    v_add_u32 v33, 65536, v32

    ds_write_b128 v32, v[28:31] offset:0
    ds_write_b128 v32, v[28:31] offset:16384
    ds_write_b128 v32, v[28:31] offset:32768
    ds_write_b128 v32, v[28:31] offset:49152
    ds_write_b128 v33, v[28:31] offset:0
    ds_write_b128 v33, v[28:31] offset:16384
    v_cmp_gt_u32 vcc, 971, v0
    s_mov_b64 exec, vcc
    ds_write_b128 v33, v[28:31] offset:32768
    s_mov_b64 exec, -1
    s_waitcnt vmcnt(12)
    ds_write_addtid_b32 v76 offset:0
    ds_write_addtid_b32 v77 offset:256
    ds_write_addtid_b32 v78 offset:512
    ds_write_addtid_b32 v79 offset:768
    s_waitcnt vmcnt(11)
    ds_write_addtid_b32 v80 offset:16384
    ds_write_addtid_b32 v81 offset:16640
    ds_write_addtid_b32 v82 offset:16896
    ds_write_addtid_b32 v83 offset:17152
    s_waitcnt vmcnt(10)
    ds_write_addtid_b32 v84 offset:32768
    ds_write_addtid_b32 v85 offset:33024
    ds_write_addtid_b32 v86 offset:33280
    ds_write_addtid_b32 v87 offset:33536
    v_lshlrev_b32 v119, 2, v0
    s_waitcnt vmcnt(13)
    s_mov_b64 exec, s[48:49]
    ds_write_b32 v119, v88 offset:49152
    s_mov_b64 exec, -1
    s_add_u32 s43, s43, 50048
    s_add_u32 s14, s43, 50000
    s_min_u32 s14, s14, s41
    s_waitcnt lgkmcnt(0)
    s_and_b32 s88, s92, 0xffff
    s_lshr_b32 s89, s92, 16
    s_and_b32 s90, s93, 0xffff
    s_lshr_b32 s91, s93, 16
    s_and_b32 s92, s94, 0xffff
    s_lshr_b32 s93, s94, 16
    s_and_b32 s94, s95, 0xffff
    s_lshr_b32 s95, s95, 16
    s_waitcnt vmcnt(6)
    v_max3_u32 v120, v120, v122, v124
    v_add_f32 v121, v121, v123
    v_add_f32 v125, v125, v127
    v_max_u32 v120, v120, v126
    v_add_f32 v121, v121, v125

    s_nop 1
    v_max_u32_dpp v120, v120, v120 row_shr:1 row_mask:0xf bank_mask:0xf
    s_nop 1
    v_max_u32_dpp v120, v120, v120 row_shr:2 row_mask:0xf bank_mask:0xf
    s_nop 1
    v_max_u32_dpp v120, v120, v120 row_shr:4 row_mask:0xf bank_mask:0xf
    s_nop 1
    v_max_u32_dpp v120, v120, v120 row_shr:8 row_mask:0xf bank_mask:0xf
    s_nop 1
    v_max_u32_dpp v120, v120, v120 row_bcast:15 row_mask:0xa bank_mask:0xf
    s_nop 1
    v_max_u32_dpp v120, v120, v120 row_bcast:31 row_mask:0xc bank_mask:0xf
    s_nop 1
    v_add_f32_dpp v121, v121, v121 row_shr:1 row_mask:0xf bank_mask:0xf
    s_nop 1
    v_add_f32_dpp v121, v121, v121 row_shr:2 row_mask:0xf bank_mask:0xf
    s_nop 1
    v_add_f32_dpp v121, v121, v121 row_shr:4 row_mask:0xf bank_mask:0xf
    s_nop 1
    v_add_f32_dpp v121, v121, v121 row_shr:8 row_mask:0xf bank_mask:0xf
    s_nop 1
    v_add_f32_dpp v121, v121, v121 row_bcast:15 row_mask:0xa bank_mask:0xf
    s_nop 1
    v_add_f32_dpp v121, v121, v121 row_bcast:31 row_mask:0xc bank_mask:0xf
    v_lshlrev_b32 v120, 16, v120
    v_mul_f32 v121, 0x34a7c5ac, v121
    v_sqrt_f32 v121, v121
    v_mul_f32 v120, s33, v120
    v_mul_f32 v121, s33, v121
    v_cmp_gt_f32 vcc, 0x46fde800, v120
    s_mov_b64 s[64:65], vcc
    v_cmp_lt_f32 vcc, 0x44000000, v121
    v_mov_b32 v120, 0x37800000
    v_mul_f32 v120, s33, v120
    s_and_b64 vcc, vcc, s[64:65]
    v_mul_f32 v121, 0x46ff8000, v120
    v_rcp_f32 v121, v121
    v_readfirstlane_b32 s33, v120
    s_waitcnt lgkmcnt(0)
    s_barrier
    v_readfirstlane_b32 s34, v121
    v_mov_b32 v120, 150016
    v_mov_b32 v121, 0
    ds_write_b32 v120, v121 offset:8
    s_bitcmp0_b64 vcc, 63
    s_cbranch_scc1 L_p2slow_48
    s_cmp_lg_u32 s51, 0
    s_cbranch_scc1 L_p2slow_48

    s_min_u32 s88, s88, 6524
    s_lshl_b32 s52, s38, 6
    s_add_u32 s52, s52, s36
    s_mul_i32 s52, s52, 32764
    s_and_b32 s52, s52, 0xffffff80
    s_add_u32 s16, s44, s52
    s_addc_u32 s17, s45, 0
    s_mul_i32 s52, s88, 5
    s_add_u32 s52, s52, 3
    s_and_b32 s18, s52, -4

    s_movk_i32 s53, 12800
    buffer_load_dwordx4 v[102:105], v2, s[16:19], s53 offen offset:4
    buffer_load_dword v113, v2, s[16:19], s53 offen
    s_movk_i32 s53, 0
    buffer_load_dwordx4 v[4:7], v2, s[16:19], s53 offen offset:4 nt
    buffer_load_dword v35, v2, s[16:19], s53 offen nt
    s_movk_i32 s53, 2560
    buffer_load_dwordx4 v[8:11], v2, s[16:19], s53 offen offset:4
    buffer_load_dword v43, v2, s[16:19], s53 offen
    s_sub_u32 s53, s88, s39
    s_cmp_le_i32 s53, 3072
    s_cbranch_scc1 L_skt_56
    s_movk_i32 s53, 15360
    buffer_load_dwordx4 v[106:109], v2, s[16:19], s53 offen offset:4
    buffer_load_dword v114, v2, s[16:19], s53 offen
L_skt_56:
    s_mov_b32 s40, s88
    s_sub_u32 s42, s40, s39

    s_add_u32 s55, s38, 1
    s_min_u32 s55, s55, 31
    s_mov_b32 s88, s89
    s_mov_b32 s89, s90
    s_mov_b32 s90, s91
    s_mov_b32 s91, s92
    s_mov_b32 s92, s93
    s_mov_b32 s93, s94
    s_mov_b32 s94, s95
    s_mov_b32 s95, 0
    s_min_u32 s88, s88, 6524
    s_lshl_b32 s52, s55, 6
    s_add_u32 s52, s52, s36
    s_mul_i32 s52, s52, 32764
    s_and_b32 s52, s52, 0xffffff80
    s_add_u32 s16, s44, s52
    s_addc_u32 s17, s45, 0
    s_mul_i32 s52, s88, 5
    s_add_u32 s52, s52, 3
    s_and_b32 s18, s52, -4

    s_waitcnt vmcnt(10)
    v_lshlrev_b32_sdwa v44, 3, v110 dst_sel:WORD_0 dst_unused:UNUSED_PAD src0_sel:DWORD src1_sel:DWORD
    v_lshrrev_b32 v46, 5, v90
    v_lshlrev_b32_sdwa v48, 3, v91 dst_sel:WORD_0 dst_unused:UNUSED_PAD src0_sel:DWORD src1_sel:WORD_1
    v_alignbit_b32 v50, v93, v92, 21

    v_mov_b32 v15, v93
    v_alignbyte_b32 v14, v92, v91, 3
    v_alignbyte_b32 v13, v91, v90, 2
    v_alignbyte_b32 v12, v90, v110, 1
    v_and_b32 v46, 0xfff8, v46
    v_and_b32 v50, 0xfff8, v50
    s_cmp_lt_i32 s42, 1280
    s_cbranch_scc1 L_ufix_57
L_uback_58:

    v_subrev_co_u32 v12, s[80:81], 2.0, v12
    v_subrev_co_u32 v13, s[82:83], 2.0, v13
    v_subrev_co_u32 v14, s[84:85], 2.0, v14
    v_subrev_co_u32 v15, s[86:87], 2.0, v15
    s_mov_b64 exec, s[80:81]
    ds_read_b64 v[44:45], v44
    s_mov_b64 exec, s[82:83]
    ds_read_b64 v[46:47], v46
    s_mov_b64 exec, s[84:85]
    ds_read_b64 v[48:49], v48
    s_mov_b64 exec, s[86:87]
    ds_read_b64 v[50:51], v50
    s_mov_b64 exec, -1
    s_waitcnt vmcnt(8)
    v_lshlrev_b32_sdwa v52, 3, v111 dst_sel:WORD_0 dst_unused:UNUSED_PAD src0_sel:DWORD src1_sel:DWORD
    v_lshrrev_b32 v54, 5, v94
    v_lshlrev_b32_sdwa v56, 3, v95 dst_sel:WORD_0 dst_unused:UNUSED_PAD src0_sel:DWORD src1_sel:WORD_1
    v_alignbit_b32 v58, v97, v96, 21

    v_mov_b32 v19, v97
    v_alignbyte_b32 v18, v96, v95, 3
    v_alignbyte_b32 v17, v95, v94, 2
    v_alignbyte_b32 v16, v94, v111, 1
    v_and_b32 v54, 0xfff8, v54
    v_and_b32 v58, 0xfff8, v58
    s_cmp_lt_i32 s42, 1792
    s_cbranch_scc1 L_ufix_59
L_uback_60:

    v_subrev_co_u32 v16, s[64:65], 2.0, v16
    v_subrev_co_u32 v17, s[66:67], 2.0, v17
    v_subrev_co_u32 v18, s[68:69], 2.0, v18
    v_subrev_co_u32 v19, s[70:71], 2.0, v19
    s_mov_b64 exec, s[64:65]
    ds_read_b64 v[52:53], v52
    s_mov_b64 exec, s[66:67]
    ds_read_b64 v[54:55], v54
    s_mov_b64 exec, s[68:69]
    ds_read_b64 v[56:57], v56
    s_mov_b64 exec, s[70:71]
    ds_read_b64 v[58:59], v58
    s_mov_b64 exec, -1
    s_waitcnt vmcnt(6)
    v_lshlrev_b32_sdwa v60, 3, v112 dst_sel:WORD_0 dst_unused:UNUSED_PAD src0_sel:DWORD src1_sel:DWORD
    v_lshrrev_b32 v62, 5, v98
    v_lshlrev_b32_sdwa v64, 3, v99 dst_sel:WORD_0 dst_unused:UNUSED_PAD src0_sel:DWORD src1_sel:WORD_1
    v_alignbit_b32 v66, v101, v100, 21

    v_mov_b32 v23, v101
    v_alignbyte_b32 v22, v100, v99, 3
    v_alignbyte_b32 v21, v99, v98, 2
    v_alignbyte_b32 v20, v98, v112, 1
    v_and_b32 v62, 0xfff8, v62
    v_and_b32 v66, 0xfff8, v66
    s_cmp_lt_i32 s42, 2304
    s_cbranch_scc1 L_ufix_61
L_uback_62:

    v_subrev_co_u32 v20, s[72:73], 2.0, v20
    v_subrev_co_u32 v21, s[74:75], 2.0, v21
    v_subrev_co_u32 v22, s[76:77], 2.0, v22
    v_subrev_co_u32 v23, s[78:79], 2.0, v23
    s_mov_b64 exec, s[72:73]
    ds_read_b64 v[60:61], v60
    s_mov_b64 exec, s[74:75]
    ds_read_b64 v[62:63], v62
    s_mov_b64 exec, s[76:77]
    ds_read_b64 v[64:65], v64
    s_mov_b64 exec, s[78:79]
    ds_read_b64 v[66:67], v66
    s_mov_b64 exec, -1
    s_waitcnt vmcnt(4)
    v_lshlrev_b32_sdwa v68, 3, v113 dst_sel:WORD_0 dst_unused:UNUSED_PAD src0_sel:DWORD src1_sel:DWORD
    v_lshrrev_b32 v70, 5, v102
    v_lshlrev_b32_sdwa v72, 3, v103 dst_sel:WORD_0 dst_unused:UNUSED_PAD src0_sel:DWORD src1_sel:WORD_1
    v_alignbit_b32 v74, v105, v104, 21

    v_mov_b32 v27, v105
    v_alignbyte_b32 v26, v104, v103, 3
    v_alignbyte_b32 v25, v103, v102, 2
    v_alignbyte_b32 v24, v102, v113, 1
    v_and_b32 v70, 0xfff8, v70
    v_and_b32 v74, 0xfff8, v74
    s_cmp_lt_i32 s42, 2816
    s_cbranch_scc1 L_ufix_63
L_uback_64:

    v_subrev_co_u32 v24, s[80:81], 2.0, v24
    v_subrev_co_u32 v25, s[82:83], 2.0, v25
    v_subrev_co_u32 v26, s[84:85], 2.0, v26
    v_subrev_co_u32 v27, s[86:87], 2.0, v27
    s_mov_b64 exec, s[80:81]
    ds_read_b64 v[68:69], v68
    s_mov_b64 exec, s[82:83]
    ds_read_b64 v[70:71], v70
    s_mov_b64 exec, s[84:85]
    ds_read_b64 v[72:73], v72
    s_mov_b64 exec, s[86:87]
    ds_read_b64 v[74:75], v74
    s_mov_b64 exec, -1
    s_waitcnt vmcnt(2)
    v_lshlrev_b32_sdwa v28, 3, v35 dst_sel:WORD_0 dst_unused:UNUSED_PAD src0_sel:DWORD src1_sel:DWORD
    v_lshrrev_b32 v30, 5, v4
    v_lshlrev_b32_sdwa v32, 3, v5 dst_sel:WORD_0 dst_unused:UNUSED_PAD src0_sel:DWORD src1_sel:WORD_1
    v_alignbit_b32 v34, v7, v6, 21

    v_alignbyte_b32 v6, v6, v5, 3
    v_alignbyte_b32 v5, v5, v4, 2
    v_alignbyte_b32 v4, v4, v35, 1
    v_and_b32 v30, 0xfff8, v30
    v_and_b32 v34, 0xfff8, v34
    s_cmp_lt_i32 s42, 256
    s_cbranch_scc1 L_ufix_65
L_uback_66:

    v_subrev_co_u32 v4, s[64:65], 2.0, v4
    v_subrev_co_u32 v5, s[66:67], 2.0, v5
    v_subrev_co_u32 v6, s[68:69], 2.0, v6
    v_subrev_co_u32 v7, s[70:71], 2.0, v7
    s_mov_b64 exec, s[64:65]
    ds_read_b64 v[28:29], v28
    s_mov_b64 exec, s[66:67]
    ds_read_b64 v[30:31], v30
    s_mov_b64 exec, s[68:69]
    ds_read_b64 v[32:33], v32
    s_mov_b64 exec, s[70:71]
    ds_read_b64 v[34:35], v34
    s_mov_b64 exec, -1
    s_add_u32 s52, s43, 49152
    s_cmp_ge_u32 s25, 4
    s_cbranch_scc1 L_sk3_67
    v_lshlrev_b32 v119, 2, v0
    buffer_load_dword v88, v119, s[12:15], s52 offen
L_sk3_67:
    buffer_load_dwordx4 v[76:79], v3, s[12:15], s43 offen
    s_add_u32 s52, s43, 16384
    buffer_load_dwordx4 v[80:83], v3, s[12:15], s52 offen
    s_add_u32 s52, s43, 32768
    buffer_load_dwordx4 v[84:87], v3, s[12:15], s52 offen
    s_cmp_lg_u32 s25, 0
    s_cbranch_scc1 L_skw_68
    s_add_u32 s54, s43, 50048
    buffer_load_dword v115, v89, s[60:63], s54 offen
L_skw_68:
    s_waitcnt vmcnt(3)
    v_lshlrev_b32_sdwa v36, 3, v43 dst_sel:WORD_0 dst_unused:UNUSED_PAD src0_sel:DWORD src1_sel:DWORD
    v_lshrrev_b32 v38, 5, v8
    v_lshlrev_b32_sdwa v40, 3, v9 dst_sel:WORD_0 dst_unused:UNUSED_PAD src0_sel:DWORD src1_sel:WORD_1
    v_alignbit_b32 v42, v11, v10, 21

    v_alignbyte_b32 v10, v10, v9, 3
    v_alignbyte_b32 v9, v9, v8, 2
    v_alignbyte_b32 v8, v8, v43, 1
    v_and_b32 v38, 0xfff8, v38
    v_and_b32 v42, 0xfff8, v42
    s_cmp_lt_i32 s42, 768
    s_cbranch_scc1 L_ufix_69
L_uback_70:

    v_subrev_co_u32 v8, s[72:73], 2.0, v8
    v_subrev_co_u32 v9, s[74:75], 2.0, v9
    v_subrev_co_u32 v10, s[76:77], 2.0, v10
    v_subrev_co_u32 v11, s[78:79], 2.0, v11
    s_mov_b64 exec, s[72:73]
    ds_read_b64 v[36:37], v36
    s_mov_b64 exec, s[74:75]
    ds_read_b64 v[38:39], v38
    s_mov_b64 exec, s[76:77]
    ds_read_b64 v[40:41], v40
    s_mov_b64 exec, s[78:79]
    ds_read_b64 v[42:43], v42
    s_mov_b64 exec, -1
    s_cmp_le_i32 s42, 3072
    s_cbranch_scc1 L_nt_71
    s_waitcnt vmcnt(3)
    v_lshlrev_b32_sdwa v120, 3, v114 dst_sel:WORD_0 dst_unused:UNUSED_PAD src0_sel:DWORD src1_sel:DWORD
    v_lshrrev_b32 v122, 5, v106
    v_lshlrev_b32_sdwa v124, 3, v107 dst_sel:WORD_0 dst_unused:UNUSED_PAD src0_sel:DWORD src1_sel:WORD_1
    v_alignbit_b32 v126, v109, v108, 21

    v_alignbyte_b32 v108, v108, v107, 3
    v_alignbyte_b32 v107, v107, v106, 2
    v_alignbyte_b32 v106, v106, v114, 1
    v_and_b32 v122, 0xfff8, v122
    v_and_b32 v126, 0xfff8, v126
    s_cmp_lt_i32 s42, 3328
    s_cbranch_scc1 L_ufix_72
L_uback_73:

    v_subrev_co_u32 v106, s[56:57], 2.0, v106
    v_subrev_co_u32 v107, s[58:59], 2.0, v107
    v_subrev_co_u32 v108, s[98:99], 2.0, v108
    v_subrev_co_u32 v109, vcc, 2.0, v109
    s_mov_b64 exec, s[56:57]
    ds_read_b64 v[120:121], v120
    s_mov_b64 exec, s[58:59]
    ds_read_b64 v[122:123], v122
    s_mov_b64 exec, s[98:99]
    ds_read_b64 v[124:125], v124
    s_mov_b64 exec, vcc
    ds_read_b64 v[126:127], v126
    s_mov_b64 exec, -1
L_nt_71:
    s_movk_i32 s53, 5120
    buffer_load_dwordx4 v[90:93], v2, s[16:19], s53 offen offset:4
    buffer_load_dword v110, v2, s[16:19], s53 offen
L_batch_75:
    s_add_u32 s5, s38, 1

    v_subrev_co_u32 v4, s[64:65], 2.0, v4
    v_subrev_co_u32 v5, s[66:67], 2.0, v5
    v_subrev_co_u32 v6, s[68:69], 2.0, v6
    v_subrev_co_u32 v7, s[70:71], 2.0, v7
    v_subrev_co_u32 v8, s[72:73], 2.0, v8
    v_subrev_co_u32 v9, s[74:75], 2.0, v9
    v_subrev_co_u32 v10, s[76:77], 2.0, v10
    v_subrev_co_u32 v11, s[78:79], 2.0, v11
    v_subrev_co_u32 v12, s[80:81], 2.0, v12
    v_subrev_co_u32 v13, s[82:83], 2.0, v13
    v_subrev_co_u32 v14, s[84:85], 2.0, v14
    v_subrev_co_u32 v15, s[86:87], 2.0, v15
    s_waitcnt lgkmcnt(0)
    s_barrier
    s_waitcnt vmcnt(2)
    ds_write_addtid_b32 v76 offset:0
    ds_write_addtid_b32 v77 offset:256
    ds_write_addtid_b32 v78 offset:512
    ds_write_addtid_b32 v79 offset:768
    s_waitcnt vmcnt(1)
    ds_write_addtid_b32 v80 offset:16384
    ds_write_addtid_b32 v81 offset:16640
    ds_write_addtid_b32 v82 offset:16896
    ds_write_addtid_b32 v83 offset:17152
    s_waitcnt vmcnt(0)
    ds_write_addtid_b32 v84 offset:32768
    ds_write_addtid_b32 v85 offset:33024
    ds_write_addtid_b32 v86 offset:33280
    ds_write_addtid_b32 v87 offset:33536
    v_lshlrev_b32 v119, 2, v0
    s_waitcnt vmcnt(3)
    s_mov_b64 exec, s[48:49]
    ds_write_b32 v119, v88 offset:49152
    s_mov_b64 exec, -1
    s_add_u32 s43, s43, 50048
    s_add_u32 s14, s43, 50000
    s_min_u32 s14, s14, s41
    s_add_u32 s52, s43, 49152
    s_cmp_ge_u32 s25, 4
    s_cbranch_scc1 L_sk3_77
    v_lshlrev_b32 v119, 2, v0
    buffer_load_dword v88, v119, s[12:15], s52 offen
L_sk3_77:
    buffer_load_dwordx4 v[76:79], v3, s[12:15], s43 offen
    s_waitcnt lgkmcnt(0)
    s_barrier
    s_add_u32 s52, s43, 16384
    buffer_load_dwordx4 v[80:83], v3, s[12:15], s52 offen
    s_add_u32 s52, s43, 32768
    buffer_load_dwordx4 v[84:87], v3, s[12:15], s52 offen
    s_cmp_le_i32 s42, 3072
    s_cbranch_scc1 L_nt_78
    v_subrev_co_u32 v106, s[56:57], 2.0, v106
    v_subrev_co_u32 v107, s[58:59], 2.0, v107
    v_subrev_co_u32 v108, s[98:99], 2.0, v108
    v_subrev_co_u32 v109, vcc, 2.0, v109
    s_mov_b64 exec, s[56:57]
    ds_read_b64 v[120:121], v120
    s_mov_b64 exec, s[58:59]
    ds_read_b64 v[122:123], v122
    s_mov_b64 exec, s[98:99]
    ds_read_b64 v[124:125], v124
    s_mov_b64 exec, vcc
    ds_read_b64 v[126:127], v126
    s_mov_b64 exec, -1
L_nt_78:
    s_mov_b64 exec, s[64:65]
    ds_read_b64 v[28:29], v28
    s_mov_b64 exec, s[66:67]
    ds_read_b64 v[30:31], v30
    s_mov_b64 exec, s[68:69]
    ds_read_b64 v[32:33], v32
    s_mov_b64 exec, s[70:71]
    ds_read_b64 v[34:35], v34
    s_mov_b64 exec, s[72:73]
    ds_read_b64 v[36:37], v36
    s_mov_b64 exec, s[74:75]
    ds_read_b64 v[38:39], v38
    s_mov_b64 exec, s[76:77]
    ds_read_b64 v[40:41], v40
    s_mov_b64 exec, s[78:79]
    ds_read_b64 v[42:43], v42
    s_mov_b64 exec, s[80:81]
    ds_read_b64 v[44:45], v44
    s_mov_b64 exec, s[82:83]
    ds_read_b64 v[46:47], v46
    s_mov_b64 exec, s[84:85]
    ds_read_b64 v[48:49], v48
    s_mov_b64 exec, s[86:87]
    ds_read_b64 v[50:51], v50
    s_mov_b64 exec, -1
    v_subrev_co_u32 v16, s[64:65], 2.0, v16
    v_subrev_co_u32 v17, s[66:67], 2.0, v17
    v_subrev_co_u32 v18, s[68:69], 2.0, v18
    v_subrev_co_u32 v19, s[70:71], 2.0, v19
    v_subrev_co_u32 v20, s[72:73], 2.0, v20
    v_subrev_co_u32 v21, s[74:75], 2.0, v21
    v_subrev_co_u32 v22, s[76:77], 2.0, v22
    v_subrev_co_u32 v23, s[78:79], 2.0, v23
    v_subrev_co_u32 v24, s[80:81], 2.0, v24
    v_subrev_co_u32 v25, s[82:83], 2.0, v25
    v_subrev_co_u32 v26, s[84:85], 2.0, v26
    v_subrev_co_u32 v27, s[86:87], 2.0, v27
    s_mov_b64 exec, s[64:65]
    ds_read_b64 v[52:53], v52
    s_mov_b64 exec, s[66:67]
    ds_read_b64 v[54:55], v54
    s_mov_b64 exec, s[68:69]
    ds_read_b64 v[56:57], v56
    s_mov_b64 exec, s[70:71]
    ds_read_b64 v[58:59], v58
    s_mov_b64 exec, s[72:73]
    ds_read_b64 v[60:61], v60
    s_mov_b64 exec, s[74:75]
    ds_read_b64 v[62:63], v62
    s_mov_b64 exec, s[76:77]
    ds_read_b64 v[64:65], v64
    s_mov_b64 exec, s[78:79]
    ds_read_b64 v[66:67], v66
    s_mov_b64 exec, s[80:81]
    ds_read_b64 v[68:69], v68
    s_mov_b64 exec, s[82:83]
    ds_read_b64 v[70:71], v70
    s_mov_b64 exec, s[84:85]
    ds_read_b64 v[72:73], v72
    s_mov_b64 exec, s[86:87]
    ds_read_b64 v[74:75], v74
    s_mov_b64 exec, -1
    s_movk_i32 s53, 7680
    buffer_load_dwordx4 v[94:97], v2, s[16:19], s53 offen offset:4
    buffer_load_dword v111, v2, s[16:19], s53 offen
    v_subrev_co_u32 v4, s[64:65], 2.0, v4
    v_subrev_co_u32 v5, s[66:67], 2.0, v5
    v_subrev_co_u32 v6, s[68:69], 2.0, v6
    v_subrev_co_u32 v7, s[70:71], 2.0, v7
    v_subrev_co_u32 v8, s[72:73], 2.0, v8
    v_subrev_co_u32 v9, s[74:75], 2.0, v9
    v_subrev_co_u32 v10, s[76:77], 2.0, v10
    v_subrev_co_u32 v11, s[78:79], 2.0, v11
    v_subrev_co_u32 v12, s[80:81], 2.0, v12
    v_subrev_co_u32 v13, s[82:83], 2.0, v13
    v_subrev_co_u32 v14, s[84:85], 2.0, v14
    v_subrev_co_u32 v15, s[86:87], 2.0, v15
    s_waitcnt lgkmcnt(0)
    s_barrier
    s_waitcnt vmcnt(4)
    ds_write_addtid_b32 v76 offset:0
    ds_write_addtid_b32 v77 offset:256
    ds_write_addtid_b32 v78 offset:512
    ds_write_addtid_b32 v79 offset:768
    s_waitcnt vmcnt(3)
    ds_write_addtid_b32 v80 offset:16384
    ds_write_addtid_b32 v81 offset:16640
    ds_write_addtid_b32 v82 offset:16896
    ds_write_addtid_b32 v83 offset:17152
    s_waitcnt vmcnt(2)
    ds_write_addtid_b32 v84 offset:32768
    ds_write_addtid_b32 v85 offset:33024
    ds_write_addtid_b32 v86 offset:33280
    ds_write_addtid_b32 v87 offset:33536
    v_lshlrev_b32 v119, 2, v0
    s_waitcnt vmcnt(5)
    s_mov_b64 exec, s[48:49]
    ds_write_b32 v119, v88 offset:49152
    s_mov_b64 exec, -1
    s_add_u32 s43, s43, 50048
    s_add_u32 s14, s43, 50000
    s_min_u32 s14, s14, s41
    s_add_u32 s52, s43, 49152
    s_cmp_ge_u32 s25, 4
    s_cbranch_scc1 L_sk3_80
    v_lshlrev_b32 v119, 2, v0
    buffer_load_dword v88, v119, s[12:15], s52 offen
L_sk3_80:
    buffer_load_dwordx4 v[76:79], v3, s[12:15], s43 offen
    s_waitcnt lgkmcnt(0)
    s_barrier
    s_add_u32 s52, s43, 16384
    buffer_load_dwordx4 v[80:83], v3, s[12:15], s52 offen
    s_add_u32 s52, s43, 32768
    buffer_load_dwordx4 v[84:87], v3, s[12:15], s52 offen
    s_cmp_le_i32 s42, 3072
    s_cbranch_scc1 L_nt_81
    v_subrev_co_u32 v106, s[56:57], 2.0, v106
    v_subrev_co_u32 v107, s[58:59], 2.0, v107
    v_subrev_co_u32 v108, s[98:99], 2.0, v108
    v_subrev_co_u32 v109, vcc, 2.0, v109
    s_mov_b64 exec, s[56:57]
    ds_read_b64 v[120:121], v120
    s_mov_b64 exec, s[58:59]
    ds_read_b64 v[122:123], v122
    s_mov_b64 exec, s[98:99]
    ds_read_b64 v[124:125], v124
    s_mov_b64 exec, vcc
    ds_read_b64 v[126:127], v126
    s_mov_b64 exec, -1
L_nt_81:
    s_mov_b64 exec, s[64:65]
    ds_read_b64 v[28:29], v28
    s_mov_b64 exec, s[66:67]
    ds_read_b64 v[30:31], v30
    s_mov_b64 exec, s[68:69]
    ds_read_b64 v[32:33], v32
    s_mov_b64 exec, s[70:71]
    ds_read_b64 v[34:35], v34
    s_mov_b64 exec, s[72:73]
    ds_read_b64 v[36:37], v36
    s_mov_b64 exec, s[74:75]
    ds_read_b64 v[38:39], v38
    s_mov_b64 exec, s[76:77]
    ds_read_b64 v[40:41], v40
    s_mov_b64 exec, s[78:79]
    ds_read_b64 v[42:43], v42
    s_mov_b64 exec, s[80:81]
    ds_read_b64 v[44:45], v44
    s_mov_b64 exec, s[82:83]
    ds_read_b64 v[46:47], v46
    s_mov_b64 exec, s[84:85]
    ds_read_b64 v[48:49], v48
    s_mov_b64 exec, s[86:87]
    ds_read_b64 v[50:51], v50
    s_mov_b64 exec, -1
    v_subrev_co_u32 v16, s[64:65], 2.0, v16
    v_subrev_co_u32 v17, s[66:67], 2.0, v17
    v_subrev_co_u32 v18, s[68:69], 2.0, v18
    v_subrev_co_u32 v19, s[70:71], 2.0, v19
    v_subrev_co_u32 v20, s[72:73], 2.0, v20
    v_subrev_co_u32 v21, s[74:75], 2.0, v21
    v_subrev_co_u32 v22, s[76:77], 2.0, v22
    v_subrev_co_u32 v23, s[78:79], 2.0, v23
    v_subrev_co_u32 v24, s[80:81], 2.0, v24
    v_subrev_co_u32 v25, s[82:83], 2.0, v25
    v_subrev_co_u32 v26, s[84:85], 2.0, v26
    v_subrev_co_u32 v27, s[86:87], 2.0, v27
    s_mov_b64 exec, s[64:65]
    ds_read_b64 v[52:53], v52
    s_mov_b64 exec, s[66:67]
    ds_read_b64 v[54:55], v54
    s_mov_b64 exec, s[68:69]
    ds_read_b64 v[56:57], v56
    s_mov_b64 exec, s[70:71]
    ds_read_b64 v[58:59], v58
    s_mov_b64 exec, s[72:73]
    ds_read_b64 v[60:61], v60
    s_mov_b64 exec, s[74:75]
    ds_read_b64 v[62:63], v62
    s_mov_b64 exec, s[76:77]
    ds_read_b64 v[64:65], v64
    s_mov_b64 exec, s[78:79]
    ds_read_b64 v[66:67], v66
    s_mov_b64 exec, s[80:81]
    ds_read_b64 v[68:69], v68
    s_mov_b64 exec, s[82:83]
    ds_read_b64 v[70:71], v70
    s_mov_b64 exec, s[84:85]
    ds_read_b64 v[72:73], v72
    s_mov_b64 exec, s[86:87]
    ds_read_b64 v[74:75], v74
    s_mov_b64 exec, -1
    s_movk_i32 s53, 10240
    buffer_load_dwordx4 v[98:101], v2, s[16:19], s53 offen offset:4
    buffer_load_dword v112, v2, s[16:19], s53 offen
    s_movk_i32 s53, 12800
    buffer_load_dwordx4 v[102:105], v2, s[16:19], s53 offen offset:4
    buffer_load_dword v113, v2, s[16:19], s53 offen
    v_cmp_gt_u32 s[64:65], 2.0, v4
    v_and_b32 v4, 0x3fffffff, v4
    v_cmp_gt_u32 s[66:67], 2.0, v5
    v_and_b32 v5, 0x3fffffff, v5
    v_cmp_gt_u32 s[68:69], 2.0, v6
    v_and_b32 v6, 0x3fffffff, v6
    v_cmp_gt_u32 s[70:71], 2.0, v7
    v_and_b32 v7, 0x3fffffff, v7
    v_cmp_gt_u32 s[72:73], 2.0, v8
    v_and_b32 v8, 0x3fffffff, v8
    v_cmp_gt_u32 s[74:75], 2.0, v9
    v_and_b32 v9, 0x3fffffff, v9
    v_cmp_gt_u32 s[76:77], 2.0, v10
    v_and_b32 v10, 0x3fffffff, v10
    v_cmp_gt_u32 s[78:79], 2.0, v11
    v_and_b32 v11, 0x3fffffff, v11
    v_cmp_gt_u32 s[80:81], 2.0, v12
    v_and_b32 v12, 0x3fffffff, v12
    v_cmp_gt_u32 s[82:83], 2.0, v13
    v_and_b32 v13, 0x3fffffff, v13
    v_cmp_gt_u32 s[84:85], 2.0, v14
    v_and_b32 v14, 0x3fffffff, v14
    v_cmp_gt_u32 s[86:87], 2.0, v15
    v_and_b32 v15, 0x3fffffff, v15
    s_waitcnt lgkmcnt(0)
    s_barrier
    s_waitcnt vmcnt(6)
    ds_write_addtid_b32 v76 offset:0
    ds_write_addtid_b32 v77 offset:256
    ds_write_addtid_b32 v78 offset:512
    ds_write_addtid_b32 v79 offset:768
    s_waitcnt vmcnt(5)
    ds_write_addtid_b32 v80 offset:16384
    ds_write_addtid_b32 v81 offset:16640
    ds_write_addtid_b32 v82 offset:16896
    ds_write_addtid_b32 v83 offset:17152
    s_waitcnt vmcnt(4)
    ds_write_addtid_b32 v84 offset:32768
    ds_write_addtid_b32 v85 offset:33024
    ds_write_addtid_b32 v86 offset:33280
    ds_write_addtid_b32 v87 offset:33536
    v_lshlrev_b32 v119, 2, v0
    s_waitcnt vmcnt(7)
    s_mov_b64 exec, s[48:49]
    ds_write_b32 v119, v88 offset:49152
    s_mov_b64 exec, -1
    s_add_u32 s43, s43, 50048
    s_add_u32 s14, s43, 50000
    s_min_u32 s14, s14, s41
    s_add_u32 s52, s43, 49152
    s_cmp_ge_u32 s25, 4
    s_cbranch_scc1 L_sk3_84
    v_lshlrev_b32 v119, 2, v0
    buffer_load_dword v88, v119, s[12:15], s52 offen
L_sk3_84:
    buffer_load_dwordx4 v[76:79], v3, s[12:15], s43 offen
    s_waitcnt lgkmcnt(0)
    s_barrier
    s_add_u32 s52, s43, 16384
    buffer_load_dwordx4 v[80:83], v3, s[12:15], s52 offen
    s_add_u32 s52, s43, 32768
    buffer_load_dwordx4 v[84:87], v3, s[12:15], s52 offen
    s_cmp_le_i32 s42, 3072
    s_cbranch_scc1 L_nt_85
    v_cmp_gt_u32 s[56:57], 2.0, v106
    v_and_b32 v106, 0x3fffffff, v106
    v_cmp_gt_u32 s[58:59], 2.0, v107
    v_and_b32 v107, 0x3fffffff, v107
    v_cmp_gt_u32 s[98:99], 2.0, v108
    v_and_b32 v108, 0x3fffffff, v108
    v_cmp_gt_u32 vcc, 2.0, v109
    v_and_b32 v109, 0x3fffffff, v109
    s_mov_b64 exec, s[56:57]
    ds_read_b64 v[120:121], v120
    s_mov_b64 exec, s[58:59]
    ds_read_b64 v[122:123], v122
    s_mov_b64 exec, s[98:99]
    ds_read_b64 v[124:125], v124
    s_mov_b64 exec, vcc
    ds_read_b64 v[126:127], v126
    s_mov_b64 exec, -1
L_nt_85:
    s_mov_b64 exec, s[64:65]
    ds_read_b64 v[28:29], v28
    s_mov_b64 exec, s[66:67]
    ds_read_b64 v[30:31], v30
    s_mov_b64 exec, s[68:69]
    ds_read_b64 v[32:33], v32
    s_mov_b64 exec, s[70:71]
    ds_read_b64 v[34:35], v34
    s_mov_b64 exec, s[72:73]
    ds_read_b64 v[36:37], v36
    s_mov_b64 exec, s[74:75]
    ds_read_b64 v[38:39], v38
    s_mov_b64 exec, s[76:77]
    ds_read_b64 v[40:41], v40
    s_mov_b64 exec, s[78:79]
    ds_read_b64 v[42:43], v42
    s_mov_b64 exec, s[80:81]
    ds_read_b64 v[44:45], v44
    s_mov_b64 exec, s[82:83]
    ds_read_b64 v[46:47], v46
    s_mov_b64 exec, s[84:85]
    ds_read_b64 v[48:49], v48
    s_mov_b64 exec, s[86:87]
    ds_read_b64 v[50:51], v50
    s_mov_b64 exec, -1
    v_cmp_gt_u32 s[64:65], 2.0, v16
    v_and_b32 v16, 0x3fffffff, v16
    v_cmp_gt_u32 s[66:67], 2.0, v17
    v_and_b32 v17, 0x3fffffff, v17
    v_cmp_gt_u32 s[68:69], 2.0, v18
    v_and_b32 v18, 0x3fffffff, v18
    v_cmp_gt_u32 s[70:71], 2.0, v19
    v_and_b32 v19, 0x3fffffff, v19
    v_cmp_gt_u32 s[72:73], 2.0, v20
    v_and_b32 v20, 0x3fffffff, v20
    v_cmp_gt_u32 s[74:75], 2.0, v21
    v_and_b32 v21, 0x3fffffff, v21
    v_cmp_gt_u32 s[76:77], 2.0, v22
    v_and_b32 v22, 0x3fffffff, v22
    v_cmp_gt_u32 s[78:79], 2.0, v23
    v_and_b32 v23, 0x3fffffff, v23
    v_cmp_gt_u32 s[80:81], 2.0, v24
    v_and_b32 v24, 0x3fffffff, v24
    v_cmp_gt_u32 s[82:83], 2.0, v25
    v_and_b32 v25, 0x3fffffff, v25
    v_cmp_gt_u32 s[84:85], 2.0, v26
    v_and_b32 v26, 0x3fffffff, v26
    v_cmp_gt_u32 s[86:87], 2.0, v27
    v_and_b32 v27, 0x3fffffff, v27
    s_mov_b64 exec, s[64:65]
    ds_read_b64 v[52:53], v52
    s_mov_b64 exec, s[66:67]
    ds_read_b64 v[54:55], v54
    s_mov_b64 exec, s[68:69]
    ds_read_b64 v[56:57], v56
    s_mov_b64 exec, s[70:71]
    ds_read_b64 v[58:59], v58
    s_mov_b64 exec, s[72:73]
    ds_read_b64 v[60:61], v60
    s_mov_b64 exec, s[74:75]
    ds_read_b64 v[62:63], v62
    s_mov_b64 exec, s[76:77]
    ds_read_b64 v[64:65], v64
    s_mov_b64 exec, s[78:79]
    ds_read_b64 v[66:67], v66
    s_mov_b64 exec, s[80:81]
    ds_read_b64 v[68:69], v68
    s_mov_b64 exec, s[82:83]
    ds_read_b64 v[70:71], v70
    s_mov_b64 exec, s[84:85]
    ds_read_b64 v[72:73], v72
    s_mov_b64 exec, s[86:87]
    ds_read_b64 v[74:75], v74
    s_mov_b64 exec, -1
    s_cmp_ge_u32 s5, s4
    s_cbranch_scc1 L_bend_76
    s_cmp_le_i32 s42, 3072
    s_cbranch_scc1 L_nt_86
    s_waitcnt lgkmcnt(15)
    v_mad_i32_i16 v116, v120, v106, s96
    v_mad_i32_i16 v120, v120, v106, s96 op_sel:[1,0,0,0]
    v_mad_i32_i16 v117, v121, v106, s96
    v_mad_i32_i16 v121, v121, v106, s96 op_sel:[1,0,0,0]
    v_lshlrev_b32_sdwa v106, 3, v106 dst_sel:DWORD dst_unused:UNUSED_PAD src0_sel:DWORD src1_sel:WORD_1
    v_perm_b32 v120, v120, v116, s97
    v_perm_b32 v121, v121, v117, s97
    v_lshl_add_u64 v[120:121], v[120:121], 0, s[30:31]

    ds_add_rtn_u64 v[120:121], v106, v[120:121] offset:50000
    v_mad_i32_i16 v118, v122, v107, s96
    v_mad_i32_i16 v122, v122, v107, s96 op_sel:[1,0,0,0]
    v_mad_i32_i16 v119, v123, v107, s96
    v_mad_i32_i16 v123, v123, v107, s96 op_sel:[1,0,0,0]
    v_lshlrev_b32_sdwa v107, 3, v107 dst_sel:DWORD dst_unused:UNUSED_PAD src0_sel:DWORD src1_sel:WORD_1
    v_perm_b32 v122, v122, v118, s97
    v_perm_b32 v123, v123, v119, s97
    v_lshl_add_u64 v[122:123], v[122:123], 0, s[30:31]

    ds_add_rtn_u64 v[122:123], v107, v[122:123] offset:50000
    v_mad_i32_i16 v116, v124, v108, s96
    v_mad_i32_i16 v124, v124, v108, s96 op_sel:[1,0,0,0]
    v_mad_i32_i16 v117, v125, v108, s96
    v_mad_i32_i16 v125, v125, v108, s96 op_sel:[1,0,0,0]
    v_lshlrev_b32_sdwa v108, 3, v108 dst_sel:DWORD dst_unused:UNUSED_PAD src0_sel:DWORD src1_sel:WORD_1
    v_perm_b32 v124, v124, v116, s97
    v_perm_b32 v125, v125, v117, s97
    v_lshl_add_u64 v[124:125], v[124:125], 0, s[30:31]

    ds_add_rtn_u64 v[124:125], v108, v[124:125] offset:50000
    v_mad_i32_i16 v118, v126, v109, s96
    v_mad_i32_i16 v126, v126, v109, s96 op_sel:[1,0,0,0]
    v_mad_i32_i16 v119, v127, v109, s96
    v_mad_i32_i16 v127, v127, v109, s96 op_sel:[1,0,0,0]
    v_lshlrev_b32_sdwa v109, 3, v109 dst_sel:DWORD dst_unused:UNUSED_PAD src0_sel:DWORD src1_sel:WORD_1
    v_perm_b32 v126, v126, v118, s97
    v_perm_b32 v127, v127, v119, s97
    v_lshl_add_u64 v[126:127], v[126:127], 0, s[30:31]

    ds_add_rtn_u64 v[126:127], v109, v[126:127] offset:50000
L_nt_86:
    s_waitcnt lgkmcnt(15)
    v_mad_i32_i16 v116, v28, v4, s96
    v_mad_i32_i16 v28, v28, v4, s96 op_sel:[1,0,0,0]
    v_mad_i32_i16 v117, v29, v4, s96
    v_mad_i32_i16 v29, v29, v4, s96 op_sel:[1,0,0,0]
    v_lshlrev_b32_sdwa v4, 3, v4 dst_sel:DWORD dst_unused:UNUSED_PAD src0_sel:DWORD src1_sel:WORD_1
    v_perm_b32 v28, v28, v116, s97
    v_perm_b32 v29, v29, v117, s97
    v_lshl_add_u64 v[28:29], v[28:29], 0, s[30:31]

    ds_add_rtn_u64 v[28:29], v4, v[28:29] offset:50000
    v_mad_i32_i16 v118, v30, v5, s96
    v_mad_i32_i16 v30, v30, v5, s96 op_sel:[1,0,0,0]
    v_mad_i32_i16 v119, v31, v5, s96
    v_mad_i32_i16 v31, v31, v5, s96 op_sel:[1,0,0,0]
    v_lshlrev_b32_sdwa v5, 3, v5 dst_sel:DWORD dst_unused:UNUSED_PAD src0_sel:DWORD src1_sel:WORD_1
    v_perm_b32 v30, v30, v118, s97
    v_perm_b32 v31, v31, v119, s97
    v_lshl_add_u64 v[30:31], v[30:31], 0, s[30:31]

    ds_add_rtn_u64 v[30:31], v5, v[30:31] offset:50000
    v_mad_i32_i16 v116, v32, v6, s96
    v_mad_i32_i16 v32, v32, v6, s96 op_sel:[1,0,0,0]
    v_mad_i32_i16 v117, v33, v6, s96
    v_mad_i32_i16 v33, v33, v6, s96 op_sel:[1,0,0,0]
    v_lshlrev_b32_sdwa v6, 3, v6 dst_sel:DWORD dst_unused:UNUSED_PAD src0_sel:DWORD src1_sel:WORD_1
    v_perm_b32 v32, v32, v116, s97
    v_perm_b32 v33, v33, v117, s97
    v_lshl_add_u64 v[32:33], v[32:33], 0, s[30:31]

    ds_add_rtn_u64 v[32:33], v6, v[32:33] offset:50000
    v_mad_i32_i16 v118, v34, v7, s96
    v_mad_i32_i16 v34, v34, v7, s96 op_sel:[1,0,0,0]
    v_mad_i32_i16 v119, v35, v7, s96
    v_mad_i32_i16 v35, v35, v7, s96 op_sel:[1,0,0,0]
    v_lshlrev_b32_sdwa v7, 3, v7 dst_sel:DWORD dst_unused:UNUSED_PAD src0_sel:DWORD src1_sel:WORD_1
    v_perm_b32 v34, v34, v118, s97
    v_perm_b32 v35, v35, v119, s97
    v_lshl_add_u64 v[34:35], v[34:35], 0, s[30:31]

    ds_add_rtn_u64 v[34:35], v7, v[34:35] offset:50000
    s_sub_u32 s53, s88, s39
    s_cmp_le_i32 s53, 3072
    s_cbranch_scc1 L_skt_87
    s_movk_i32 s53, 15360
    buffer_load_dwordx4 v[106:109], v2, s[16:19], s53 offen offset:4
    buffer_load_dword v114, v2, s[16:19], s53 offen
L_skt_87:
    v_mad_i32_i16 v116, v36, v8, s96
    v_mad_i32_i16 v36, v36, v8, s96 op_sel:[1,0,0,0]
    v_mad_i32_i16 v117, v37, v8, s96
    v_mad_i32_i16 v37, v37, v8, s96 op_sel:[1,0,0,0]
    v_lshlrev_b32_sdwa v8, 3, v8 dst_sel:DWORD dst_unused:UNUSED_PAD src0_sel:DWORD src1_sel:WORD_1
    v_perm_b32 v36, v36, v116, s97
    v_perm_b32 v37, v37, v117, s97
    v_lshl_add_u64 v[36:37], v[36:37], 0, s[30:31]

    ds_add_rtn_u64 v[36:37], v8, v[36:37] offset:50000
    v_mad_i32_i16 v118, v38, v9, s96
    v_mad_i32_i16 v38, v38, v9, s96 op_sel:[1,0,0,0]
    v_mad_i32_i16 v119, v39, v9, s96
    v_mad_i32_i16 v39, v39, v9, s96 op_sel:[1,0,0,0]
    v_lshlrev_b32_sdwa v9, 3, v9 dst_sel:DWORD dst_unused:UNUSED_PAD src0_sel:DWORD src1_sel:WORD_1
    v_perm_b32 v38, v38, v118, s97
    v_perm_b32 v39, v39, v119, s97
    v_lshl_add_u64 v[38:39], v[38:39], 0, s[30:31]

    ds_add_rtn_u64 v[38:39], v9, v[38:39] offset:50000
    v_mad_i32_i16 v116, v40, v10, s96
    v_mad_i32_i16 v40, v40, v10, s96 op_sel:[1,0,0,0]
    v_mad_i32_i16 v117, v41, v10, s96
    v_mad_i32_i16 v41, v41, v10, s96 op_sel:[1,0,0,0]
    v_lshlrev_b32_sdwa v10, 3, v10 dst_sel:DWORD dst_unused:UNUSED_PAD src0_sel:DWORD src1_sel:WORD_1
    v_perm_b32 v40, v40, v116, s97
    v_perm_b32 v41, v41, v117, s97
    v_lshl_add_u64 v[40:41], v[40:41], 0, s[30:31]

    ds_add_rtn_u64 v[40:41], v10, v[40:41] offset:50000
    v_mad_i32_i16 v118, v42, v11, s96
    v_mad_i32_i16 v42, v42, v11, s96 op_sel:[1,0,0,0]
    v_mad_i32_i16 v119, v43, v11, s96
    v_mad_i32_i16 v43, v43, v11, s96 op_sel:[1,0,0,0]
    v_lshlrev_b32_sdwa v11, 3, v11 dst_sel:DWORD dst_unused:UNUSED_PAD src0_sel:DWORD src1_sel:WORD_1
    v_perm_b32 v42, v42, v118, s97
    v_perm_b32 v43, v43, v119, s97
    v_lshl_add_u64 v[42:43], v[42:43], 0, s[30:31]

    ds_add_rtn_u64 v[42:43], v11, v[42:43] offset:50000
    s_waitcnt lgkmcnt(4)
    v_or3_b32 v1, v28, v29, v1
    v_or3_b32 v1, v30, v31, v1
    v_or3_b32 v1, v32, v33, v1
    v_or3_b32 v1, v34, v35, v1
    s_cmp_le_i32 s42, 3072
    s_cbranch_scc1 L_nt_88
    v_or3_b32 v1, v120, v121, v1
    v_or3_b32 v1, v122, v123, v1
    v_or3_b32 v1, v124, v125, v1
    v_or3_b32 v1, v126, v127, v1
L_nt_88:
    s_cmp_le_u32 s40, 3584
    s_cbranch_scc1 L_noleft_89
    s_min_u32 s40, s40, 6524
    s_lshl_b32 s52, s38, 6
    s_add_u32 s52, s52, s36
    s_mul_i32 s52, s52, 32764
    s_and_b32 s52, s52, 0xffffff80
    s_add_u32 s20, s44, s52
    s_addc_u32 s21, s45, 0
    s_mul_i32 s52, s40, 5
    s_add_u32 s52, s52, 3
    s_and_b32 s22, s52, -4

    s_lshr_b32 s55, s39, 2
    s_add_u32 s55, s55, 3584
    v_and_b32 v120, 63, v0
    v_add_u32 v120, s55, v120
L_left_90:
    s_cmp_ge_u32 s55, s40
    s_cbranch_scc1 L_leftend_91
    v_mul_u32_u24 v121, 5, v120
    buffer_load_dword v122, v121, s[20:23], 0 offen offset:1
    buffer_load_ubyte v123, v121, s[20:23], 0 offen
    s_waitcnt vmcnt(0)

    v_perm_b32 v121, v123, v122, s24
    v_lshrrev_b32 v126, 30, v122
    v_and_b32 v121, 0x1fff, v121
    v_mul_u32_u24 v126, 6250, v126
    v_add_lshl_u32 v121, v121, v126, 3

    buffer_load_dwordx2 v[124:125], v121, s[8:11], s50 offen
    v_cmp_gt_u32 vcc, s40, v120
    s_waitcnt vmcnt(0)

    s_mov_b64 exec, vcc
    v_and_b32 v122, 0x3fffffff, v122
    v_cvt_f32_i32_sdwa v118, sext(v122) dst_sel:DWORD dst_unused:UNUSED_PAD src0_sel:WORD_0
    v_lshlrev_b32 v116, 16, v124
    v_and_b32 v117, s32, v124
    v_mul_f32 v118, s33, v118
    v_lshlrev_b32 v124, 16, v125
    v_and_b32 v125, s32, v125
    v_lshlrev_b32_sdwa v122, 3, v122 dst_sel:DWORD dst_unused:UNUSED_PAD src0_sel:DWORD src1_sel:WORD_1
    v_pk_fma_f32 v[116:117], v[116:117], v[118:119], s[28:29] op_sel_hi:[1,0,1]
    v_pk_fma_f32 v[124:125], v[124:125], v[118:119], s[28:29] op_sel_hi:[1,0,1]
    v_perm_b32 v116, v117, v116, s35
    v_perm_b32 v117, v125, v124, s35
    v_lshl_add_u64 v[116:117], v[116:117], 0, s[30:31]
    ds_add_rtn_u64 v[124:125], v122, v[116:117] offset:50000

    s_waitcnt lgkmcnt(0)
    v_or3_b32 v1, v124, v125, v1
    s_mov_b64 exec, -1
    v_add_u32 v120, 128, v120
    s_add_u32 s55, s55, 128
    s_branch L_left_90
L_leftend_91:

L_noleft_89:
    s_movk_i32 s53, 0
    buffer_load_dwordx4 v[4:7], v2, s[16:19], s53 offen offset:4 nt
    buffer_load_dword v35, v2, s[16:19], s53 offen nt
    v_mad_i32_i16 v120, v44, v12, s96
    v_mad_i32_i16 v44, v44, v12, s96 op_sel:[1,0,0,0]
    v_mad_i32_i16 v121, v45, v12, s96
    v_mad_i32_i16 v45, v45, v12, s96 op_sel:[1,0,0,0]
    v_lshlrev_b32_sdwa v12, 3, v12 dst_sel:DWORD dst_unused:UNUSED_PAD src0_sel:DWORD src1_sel:WORD_1
    v_perm_b32 v44, v44, v120, s97
    v_perm_b32 v45, v45, v121, s97
    v_lshl_add_u64 v[44:45], v[44:45], 0, s[30:31]

    ds_add_rtn_u64 v[44:45], v12, v[44:45] offset:50000
    v_mad_i32_i16 v122, v46, v13, s96
    v_mad_i32_i16 v46, v46, v13, s96 op_sel:[1,0,0,0]
    v_mad_i32_i16 v123, v47, v13, s96
    v_mad_i32_i16 v47, v47, v13, s96 op_sel:[1,0,0,0]
    v_lshlrev_b32_sdwa v13, 3, v13 dst_sel:DWORD dst_unused:UNUSED_PAD src0_sel:DWORD src1_sel:WORD_1
    v_perm_b32 v46, v46, v122, s97
    v_perm_b32 v47, v47, v123, s97
    v_lshl_add_u64 v[46:47], v[46:47], 0, s[30:31]

    ds_add_rtn_u64 v[46:47], v13, v[46:47] offset:50000
    v_mad_i32_i16 v124, v48, v14, s96
    v_mad_i32_i16 v48, v48, v14, s96 op_sel:[1,0,0,0]
    v_mad_i32_i16 v125, v49, v14, s96
    v_mad_i32_i16 v49, v49, v14, s96 op_sel:[1,0,0,0]
    v_lshlrev_b32_sdwa v14, 3, v14 dst_sel:DWORD dst_unused:UNUSED_PAD src0_sel:DWORD src1_sel:WORD_1
    v_perm_b32 v48, v48, v124, s97
    v_perm_b32 v49, v49, v125, s97
    v_lshl_add_u64 v[48:49], v[48:49], 0, s[30:31]

    ds_add_rtn_u64 v[48:49], v14, v[48:49] offset:50000
    v_mad_i32_i16 v126, v50, v15, s96
    v_mad_i32_i16 v50, v50, v15, s96 op_sel:[1,0,0,0]
    v_mad_i32_i16 v127, v51, v15, s96
    v_mad_i32_i16 v51, v51, v15, s96 op_sel:[1,0,0,0]
    v_lshlrev_b32_sdwa v15, 3, v15 dst_sel:DWORD dst_unused:UNUSED_PAD src0_sel:DWORD src1_sel:WORD_1
    v_perm_b32 v50, v50, v126, s97
    v_perm_b32 v51, v51, v127, s97
    v_lshl_add_u64 v[50:51], v[50:51], 0, s[30:31]

    ds_add_rtn_u64 v[50:51], v15, v[50:51] offset:50000
    s_waitcnt lgkmcnt(4)
    v_or3_b32 v1, v36, v37, v1
    v_or3_b32 v1, v38, v39, v1
    v_or3_b32 v1, v40, v41, v1
    v_or3_b32 v1, v42, v43, v1
    s_movk_i32 s53, 2560
    buffer_load_dwordx4 v[8:11], v2, s[16:19], s53 offen offset:4
    buffer_load_dword v43, v2, s[16:19], s53 offen
    s_barrier
    s_waitcnt vmcnt(6)
    ds_write_addtid_b32 v76 offset:0
    ds_write_addtid_b32 v77 offset:256
    ds_write_addtid_b32 v78 offset:512
    ds_write_addtid_b32 v79 offset:768
    s_waitcnt vmcnt(5)
    ds_write_addtid_b32 v80 offset:16384
    ds_write_addtid_b32 v81 offset:16640
    ds_write_addtid_b32 v82 offset:16896
    ds_write_addtid_b32 v83 offset:17152
    s_waitcnt vmcnt(4)
    ds_write_addtid_b32 v84 offset:32768
    ds_write_addtid_b32 v85 offset:33024
    ds_write_addtid_b32 v86 offset:33280
    ds_write_addtid_b32 v87 offset:33536
    v_lshlrev_b32 v119, 2, v0
    s_waitcnt vmcnt(7)
    s_mov_b64 exec, s[48:49]
    ds_write_b32 v119, v88 offset:49152
    s_mov_b64 exec, -1
    s_add_u32 s43, s43, 50048
    s_add_u32 s14, s43, 50000
    s_min_u32 s14, s14, s41
    s_mov_b32 s40, s88
    s_sub_u32 s42, s40, s39

    s_add_u32 s55, s38, 2
    s_min_u32 s55, s55, 31
    s_mov_b32 s88, s89
    s_mov_b32 s89, s90
    s_mov_b32 s90, s91
    s_mov_b32 s91, s92
    s_mov_b32 s92, s93
    s_mov_b32 s93, s94
    s_mov_b32 s94, s95
    s_mov_b32 s95, 0
    s_min_u32 s88, s88, 6524
    s_lshl_b32 s52, s55, 6
    s_add_u32 s52, s52, s36
    s_mul_i32 s52, s52, 32764
    s_and_b32 s52, s52, 0xffffff80
    s_add_u32 s16, s44, s52
    s_addc_u32 s17, s45, 0
    s_mul_i32 s52, s88, 5
    s_add_u32 s52, s52, 3
    s_and_b32 s18, s52, -4

    v_mad_i32_i16 v120, v52, v16, s96
    v_mad_i32_i16 v52, v52, v16, s96 op_sel:[1,0,0,0]
    v_mad_i32_i16 v121, v53, v16, s96
    v_mad_i32_i16 v53, v53, v16, s96 op_sel:[1,0,0,0]
    v_lshlrev_b32_sdwa v16, 3, v16 dst_sel:DWORD dst_unused:UNUSED_PAD src0_sel:DWORD src1_sel:WORD_1
    v_perm_b32 v52, v52, v120, s97
    v_perm_b32 v53, v53, v121, s97
    v_lshl_add_u64 v[52:53], v[52:53], 0, s[30:31]

    ds_add_rtn_u64 v[52:53], v16, v[52:53] offset:50000
    v_mad_i32_i16 v122, v54, v17, s96
    v_mad_i32_i16 v54, v54, v17, s96 op_sel:[1,0,0,0]
    v_mad_i32_i16 v123, v55, v17, s96
    v_mad_i32_i16 v55, v55, v17, s96 op_sel:[1,0,0,0]
    v_lshlrev_b32_sdwa v17, 3, v17 dst_sel:DWORD dst_unused:UNUSED_PAD src0_sel:DWORD src1_sel:WORD_1
    v_perm_b32 v54, v54, v122, s97
    v_perm_b32 v55, v55, v123, s97
    v_lshl_add_u64 v[54:55], v[54:55], 0, s[30:31]

    ds_add_rtn_u64 v[54:55], v17, v[54:55] offset:50000
    v_mad_i32_i16 v124, v56, v18, s96
    v_mad_i32_i16 v56, v56, v18, s96 op_sel:[1,0,0,0]
    v_mad_i32_i16 v125, v57, v18, s96
    v_mad_i32_i16 v57, v57, v18, s96 op_sel:[1,0,0,0]
    v_lshlrev_b32_sdwa v18, 3, v18 dst_sel:DWORD dst_unused:UNUSED_PAD src0_sel:DWORD src1_sel:WORD_1
    v_perm_b32 v56, v56, v124, s97
    v_perm_b32 v57, v57, v125, s97
    v_lshl_add_u64 v[56:57], v[56:57], 0, s[30:31]

    ds_add_rtn_u64 v[56:57], v18, v[56:57] offset:50000
    v_mad_i32_i16 v126, v58, v19, s96
    v_mad_i32_i16 v58, v58, v19, s96 op_sel:[1,0,0,0]
    v_mad_i32_i16 v127, v59, v19, s96
    v_mad_i32_i16 v59, v59, v19, s96 op_sel:[1,0,0,0]
    v_lshlrev_b32_sdwa v19, 3, v19 dst_sel:DWORD dst_unused:UNUSED_PAD src0_sel:DWORD src1_sel:WORD_1
    v_perm_b32 v58, v58, v126, s97
    v_perm_b32 v59, v59, v127, s97
    v_lshl_add_u64 v[58:59], v[58:59], 0, s[30:31]

    ds_add_rtn_u64 v[58:59], v19, v[58:59] offset:50000
    s_waitcnt lgkmcnt(15)
    v_or3_b32 v1, v44, v45, v1
    v_or3_b32 v1, v46, v47, v1
    v_or3_b32 v1, v48, v49, v1
    v_or3_b32 v1, v50, v51, v1
    s_waitcnt vmcnt(19)
    v_lshlrev_b32_sdwa v44, 3, v110 dst_sel:WORD_0 dst_unused:UNUSED_PAD src0_sel:DWORD src1_sel:DWORD
    v_lshrrev_b32 v46, 5, v90
    v_lshlrev_b32_sdwa v48, 3, v91 dst_sel:WORD_0 dst_unused:UNUSED_PAD src0_sel:DWORD src1_sel:WORD_1
    v_alignbit_b32 v50, v93, v92, 21

    v_mov_b32 v15, v93
    v_alignbyte_b32 v14, v92, v91, 3
    v_alignbyte_b32 v13, v91, v90, 2
    v_alignbyte_b32 v12, v90, v110, 1
    v_and_b32 v46, 0xfff8, v46
    v_and_b32 v50, 0xfff8, v50
    s_cmp_lt_i32 s42, 1280
    s_cbranch_scc1 L_ufix_94
L_uback_95:

    s_movk_i32 s53, 5120
    buffer_load_dwordx4 v[90:93], v2, s[16:19], s53 offen offset:4
    buffer_load_dword v110, v2, s[16:19], s53 offen
    v_mad_i32_i16 v120, v60, v20, s96
    v_mad_i32_i16 v60, v60, v20, s96 op_sel:[1,0,0,0]
    v_mad_i32_i16 v121, v61, v20, s96
    v_mad_i32_i16 v61, v61, v20, s96 op_sel:[1,0,0,0]
    v_lshlrev_b32_sdwa v20, 3, v20 dst_sel:DWORD dst_unused:UNUSED_PAD src0_sel:DWORD src1_sel:WORD_1
    v_perm_b32 v60, v60, v120, s97
    v_perm_b32 v61, v61, v121, s97
    v_lshl_add_u64 v[60:61], v[60:61], 0, s[30:31]

    ds_add_rtn_u64 v[60:61], v20, v[60:61] offset:50000
    v_mad_i32_i16 v122, v62, v21, s96
    v_mad_i32_i16 v62, v62, v21, s96 op_sel:[1,0,0,0]
    v_mad_i32_i16 v123, v63, v21, s96
    v_mad_i32_i16 v63, v63, v21, s96 op_sel:[1,0,0,0]
    v_lshlrev_b32_sdwa v21, 3, v21 dst_sel:DWORD dst_unused:UNUSED_PAD src0_sel:DWORD src1_sel:WORD_1
    v_perm_b32 v62, v62, v122, s97
    v_perm_b32 v63, v63, v123, s97
    v_lshl_add_u64 v[62:63], v[62:63], 0, s[30:31]

    ds_add_rtn_u64 v[62:63], v21, v[62:63] offset:50000
    v_mad_i32_i16 v124, v64, v22, s96
    v_mad_i32_i16 v64, v64, v22, s96 op_sel:[1,0,0,0]
    v_mad_i32_i16 v125, v65, v22, s96
    v_mad_i32_i16 v65, v65, v22, s96 op_sel:[1,0,0,0]
    v_lshlrev_b32_sdwa v22, 3, v22 dst_sel:DWORD dst_unused:UNUSED_PAD src0_sel:DWORD src1_sel:WORD_1
    v_perm_b32 v64, v64, v124, s97
    v_perm_b32 v65, v65, v125, s97
    v_lshl_add_u64 v[64:65], v[64:65], 0, s[30:31]

    ds_add_rtn_u64 v[64:65], v22, v[64:65] offset:50000
    v_mad_i32_i16 v126, v66, v23, s96
    v_mad_i32_i16 v66, v66, v23, s96 op_sel:[1,0,0,0]
    v_mad_i32_i16 v127, v67, v23, s96
    v_mad_i32_i16 v67, v67, v23, s96 op_sel:[1,0,0,0]
    v_lshlrev_b32_sdwa v23, 3, v23 dst_sel:DWORD dst_unused:UNUSED_PAD src0_sel:DWORD src1_sel:WORD_1
    v_perm_b32 v66, v66, v126, s97
    v_perm_b32 v67, v67, v127, s97
    v_lshl_add_u64 v[66:67], v[66:67], 0, s[30:31]

    ds_add_rtn_u64 v[66:67], v23, v[66:67] offset:50000
    s_waitcnt lgkmcnt(4)
    v_or3_b32 v1, v52, v53, v1
    v_or3_b32 v1, v54, v55, v1
    v_or3_b32 v1, v56, v57, v1
    v_or3_b32 v1, v58, v59, v1
    s_waitcnt vmcnt(16)
    v_lshlrev_b32_sdwa v52, 3, v111 dst_sel:WORD_0 dst_unused:UNUSED_PAD src0_sel:DWORD src1_sel:DWORD
    v_lshrrev_b32 v54, 5, v94
    v_lshlrev_b32_sdwa v56, 3, v95 dst_sel:WORD_0 dst_unused:UNUSED_PAD src0_sel:DWORD src1_sel:WORD_1
    v_alignbit_b32 v58, v97, v96, 21

    v_mov_b32 v19, v97
    v_alignbyte_b32 v18, v96, v95, 3
    v_alignbyte_b32 v17, v95, v94, 2
    v_alignbyte_b32 v16, v94, v111, 1
    v_and_b32 v54, 0xfff8, v54
    v_and_b32 v58, 0xfff8, v58
    s_cmp_lt_i32 s42, 1792
    s_cbranch_scc1 L_ufix_97
L_uback_98:

    s_cmp_lg_u32 s25, 0
    s_cbranch_scc1 L_skw_99
    s_add_u32 s54, s43, 50048
    buffer_load_dword v115, v89, s[60:63], s54 offen
L_skw_99:
    s_barrier
    v_subrev_co_u32 v12, s[80:81], 2.0, v12
    v_subrev_co_u32 v13, s[82:83], 2.0, v13
    v_subrev_co_u32 v14, s[84:85], 2.0, v14
    v_subrev_co_u32 v15, s[86:87], 2.0, v15
    s_mov_b64 exec, s[80:81]
    ds_read_b64 v[44:45], v44
    s_mov_b64 exec, s[82:83]
    ds_read_b64 v[46:47], v46
    s_mov_b64 exec, s[84:85]
    ds_read_b64 v[48:49], v48
    s_mov_b64 exec, s[86:87]
    ds_read_b64 v[50:51], v50
    s_mov_b64 exec, -1
    v_subrev_co_u32 v16, s[64:65], 2.0, v16
    v_subrev_co_u32 v17, s[66:67], 2.0, v17
    v_subrev_co_u32 v18, s[68:69], 2.0, v18
    v_subrev_co_u32 v19, s[70:71], 2.0, v19
    s_mov_b64 exec, s[64:65]
    ds_read_b64 v[52:53], v52
    s_mov_b64 exec, s[66:67]
    ds_read_b64 v[54:55], v54
    s_mov_b64 exec, s[68:69]
    ds_read_b64 v[56:57], v56
    s_mov_b64 exec, s[70:71]
    ds_read_b64 v[58:59], v58
    s_mov_b64 exec, -1
    v_mad_i32_i16 v120, v68, v24, s96
    v_mad_i32_i16 v68, v68, v24, s96 op_sel:[1,0,0,0]
    v_mad_i32_i16 v121, v69, v24, s96
    v_mad_i32_i16 v69, v69, v24, s96 op_sel:[1,0,0,0]
    v_lshlrev_b32_sdwa v24, 3, v24 dst_sel:DWORD dst_unused:UNUSED_PAD src0_sel:DWORD src1_sel:WORD_1
    v_perm_b32 v68, v68, v120, s97
    v_perm_b32 v69, v69, v121, s97
    v_lshl_add_u64 v[68:69], v[68:69], 0, s[30:31]

    ds_add_rtn_u64 v[68:69], v24, v[68:69] offset:50000
    v_mad_i32_i16 v122, v70, v25, s96
    v_mad_i32_i16 v70, v70, v25, s96 op_sel:[1,0,0,0]
    v_mad_i32_i16 v123, v71, v25, s96
    v_mad_i32_i16 v71, v71, v25, s96 op_sel:[1,0,0,0]
    v_lshlrev_b32_sdwa v25, 3, v25 dst_sel:DWORD dst_unused:UNUSED_PAD src0_sel:DWORD src1_sel:WORD_1
    v_perm_b32 v70, v70, v122, s97
    v_perm_b32 v71, v71, v123, s97
    v_lshl_add_u64 v[70:71], v[70:71], 0, s[30:31]

    ds_add_rtn_u64 v[70:71], v25, v[70:71] offset:50000
    v_mad_i32_i16 v124, v72, v26, s96
    v_mad_i32_i16 v72, v72, v26, s96 op_sel:[1,0,0,0]
    v_mad_i32_i16 v125, v73, v26, s96
    v_mad_i32_i16 v73, v73, v26, s96 op_sel:[1,0,0,0]
    v_lshlrev_b32_sdwa v26, 3, v26 dst_sel:DWORD dst_unused:UNUSED_PAD src0_sel:DWORD src1_sel:WORD_1
    v_perm_b32 v72, v72, v124, s97
    v_perm_b32 v73, v73, v125, s97
    v_lshl_add_u64 v[72:73], v[72:73], 0, s[30:31]

    ds_add_rtn_u64 v[72:73], v26, v[72:73] offset:50000
    v_mad_i32_i16 v126, v74, v27, s96
    v_mad_i32_i16 v74, v74, v27, s96 op_sel:[1,0,0,0]
    v_mad_i32_i16 v127, v75, v27, s96
    v_mad_i32_i16 v75, v75, v27, s96 op_sel:[1,0,0,0]
    v_lshlrev_b32_sdwa v27, 3, v27 dst_sel:DWORD dst_unused:UNUSED_PAD src0_sel:DWORD src1_sel:WORD_1
    v_perm_b32 v74, v74, v126, s97
    v_perm_b32 v75, v75, v127, s97
    v_lshl_add_u64 v[74:75], v[74:75], 0, s[30:31]

    ds_add_rtn_u64 v[74:75], v27, v[74:75] offset:50000
    s_waitcnt lgkmcnt(12)
    v_or3_b32 v1, v60, v61, v1
    v_or3_b32 v1, v62, v63, v1
    v_or3_b32 v1, v64, v65, v1
    v_or3_b32 v1, v66, v67, v1
    s_waitcnt vmcnt(11)
    v_lshlrev_b32_sdwa v60, 3, v112 dst_sel:WORD_0 dst_unused:UNUSED_PAD src0_sel:DWORD src1_sel:DWORD
    v_lshrrev_b32 v62, 5, v98
    v_lshlrev_b32_sdwa v64, 3, v99 dst_sel:WORD_0 dst_unused:UNUSED_PAD src0_sel:DWORD src1_sel:WORD_1
    v_alignbit_b32 v66, v101, v100, 21

    v_mov_b32 v23, v101
    v_alignbyte_b32 v22, v100, v99, 3
    v_alignbyte_b32 v21, v99, v98, 2
    v_alignbyte_b32 v20, v98, v112, 1
    v_and_b32 v62, 0xfff8, v62
    v_and_b32 v66, 0xfff8, v66
    s_cmp_lt_i32 s42, 2304
    s_cbranch_scc1 L_ufix_100
L_uback_101:

    v_subrev_co_u32 v20, s[72:73], 2.0, v20
    v_subrev_co_u32 v21, s[74:75], 2.0, v21
    v_subrev_co_u32 v22, s[76:77], 2.0, v22
    v_subrev_co_u32 v23, s[78:79], 2.0, v23
    s_mov_b64 exec, s[72:73]
    ds_read_b64 v[60:61], v60
    s_mov_b64 exec, s[74:75]
    ds_read_b64 v[62:63], v62
    s_mov_b64 exec, s[76:77]
    ds_read_b64 v[64:65], v64
    s_mov_b64 exec, s[78:79]
    ds_read_b64 v[66:67], v66
    s_mov_b64 exec, -1
    s_waitcnt lgkmcnt(4)
    v_or3_b32 v1, v68, v69, v1
    v_or3_b32 v1, v70, v71, v1
    v_or3_b32 v1, v72, v73, v1
    v_or3_b32 v1, v74, v75, v1
    s_waitcnt vmcnt(9)
    v_lshlrev_b32_sdwa v68, 3, v113 dst_sel:WORD_0 dst_unused:UNUSED_PAD src0_sel:DWORD src1_sel:DWORD
    v_lshrrev_b32 v70, 5, v102
    v_lshlrev_b32_sdwa v72, 3, v103 dst_sel:WORD_0 dst_unused:UNUSED_PAD src0_sel:DWORD src1_sel:WORD_1
    v_alignbit_b32 v74, v105, v104, 21

    v_mov_b32 v27, v105
    v_alignbyte_b32 v26, v104, v103, 3
    v_alignbyte_b32 v25, v103, v102, 2
    v_alignbyte_b32 v24, v102, v113, 1
    v_and_b32 v70, 0xfff8, v70
    v_and_b32 v74, 0xfff8, v74
    s_cmp_lt_i32 s42, 2816
    s_cbranch_scc1 L_ufix_102
L_uback_103:

    v_subrev_co_u32 v24, s[80:81], 2.0, v24
    v_subrev_co_u32 v25, s[82:83], 2.0, v25
    v_subrev_co_u32 v26, s[84:85], 2.0, v26
    v_subrev_co_u32 v27, s[86:87], 2.0, v27
    s_mov_b64 exec, s[80:81]
    ds_read_b64 v[68:69], v68
    s_mov_b64 exec, s[82:83]
    ds_read_b64 v[70:71], v70
    s_mov_b64 exec, s[84:85]
    ds_read_b64 v[72:73], v72
    s_mov_b64 exec, s[86:87]
    ds_read_b64 v[74:75], v74
    s_mov_b64 exec, -1
    s_add_u32 s52, s43, 49152
    s_cmp_ge_u32 s25, 4
    s_cbranch_scc1 L_sk3_104
    v_lshlrev_b32 v119, 2, v0
    buffer_load_dword v88, v119, s[12:15], s52 offen
L_sk3_104:
    buffer_load_dwordx4 v[76:79], v3, s[12:15], s43 offen
    s_add_u32 s52, s43, 16384
    buffer_load_dwordx4 v[80:83], v3, s[12:15], s52 offen
    s_add_u32 s52, s43, 32768
    buffer_load_dwordx4 v[84:87], v3, s[12:15], s52 offen
    s_waitcnt vmcnt(7)
    v_lshlrev_b32_sdwa v28, 3, v35 dst_sel:WORD_0 dst_unused:UNUSED_PAD src0_sel:DWORD src1_sel:DWORD
    v_lshrrev_b32 v30, 5, v4
    v_lshlrev_b32_sdwa v32, 3, v5 dst_sel:WORD_0 dst_unused:UNUSED_PAD src0_sel:DWORD src1_sel:WORD_1
    v_alignbit_b32 v34, v7, v6, 21

    v_alignbyte_b32 v6, v6, v5, 3
    v_alignbyte_b32 v5, v5, v4, 2
    v_alignbyte_b32 v4, v4, v35, 1
    v_and_b32 v30, 0xfff8, v30
    v_and_b32 v34, 0xfff8, v34
    s_cmp_lt_i32 s42, 256
    s_cbranch_scc1 L_ufix_105
L_uback_106:

    v_subrev_co_u32 v4, s[64:65], 2.0, v4
    v_subrev_co_u32 v5, s[66:67], 2.0, v5
    v_subrev_co_u32 v6, s[68:69], 2.0, v6
    v_subrev_co_u32 v7, s[70:71], 2.0, v7
    s_mov_b64 exec, s[64:65]
    ds_read_b64 v[28:29], v28
    s_mov_b64 exec, s[66:67]
    ds_read_b64 v[30:31], v30
    s_mov_b64 exec, s[68:69]
    ds_read_b64 v[32:33], v32
    s_mov_b64 exec, s[70:71]
    ds_read_b64 v[34:35], v34
    s_mov_b64 exec, -1
    s_waitcnt vmcnt(5)
    v_lshlrev_b32_sdwa v36, 3, v43 dst_sel:WORD_0 dst_unused:UNUSED_PAD src0_sel:DWORD src1_sel:DWORD
    v_lshrrev_b32 v38, 5, v8
    v_lshlrev_b32_sdwa v40, 3, v9 dst_sel:WORD_0 dst_unused:UNUSED_PAD src0_sel:DWORD src1_sel:WORD_1
    v_alignbit_b32 v42, v11, v10, 21

    v_alignbyte_b32 v10, v10, v9, 3
    v_alignbyte_b32 v9, v9, v8, 2
    v_alignbyte_b32 v8, v8, v43, 1
    v_and_b32 v38, 0xfff8, v38
    v_and_b32 v42, 0xfff8, v42
    s_cmp_lt_i32 s42, 768
    s_cbranch_scc1 L_ufix_107
L_uback_108:

    v_subrev_co_u32 v8, s[72:73], 2.0, v8
    v_subrev_co_u32 v9, s[74:75], 2.0, v9
    v_subrev_co_u32 v10, s[76:77], 2.0, v10
    v_subrev_co_u32 v11, s[78:79], 2.0, v11
    s_mov_b64 exec, s[72:73]
    ds_read_b64 v[36:37], v36
    s_mov_b64 exec, s[74:75]
    ds_read_b64 v[38:39], v38
    s_mov_b64 exec, s[76:77]
    ds_read_b64 v[40:41], v40
    s_mov_b64 exec, s[78:79]
    ds_read_b64 v[42:43], v42
    s_mov_b64 exec, -1
    s_cmp_le_i32 s42, 3072
    s_cbranch_scc1 L_nt_109
    s_waitcnt vmcnt(9)
    v_lshlrev_b32_sdwa v120, 3, v114 dst_sel:WORD_0 dst_unused:UNUSED_PAD src0_sel:DWORD src1_sel:DWORD
    v_lshrrev_b32 v122, 5, v106
    v_lshlrev_b32_sdwa v124, 3, v107 dst_sel:WORD_0 dst_unused:UNUSED_PAD src0_sel:DWORD src1_sel:WORD_1
    v_alignbit_b32 v126, v109, v108, 21

    v_alignbyte_b32 v108, v108, v107, 3
    v_alignbyte_b32 v107, v107, v106, 2
    v_alignbyte_b32 v106, v106, v114, 1
    v_and_b32 v122, 0xfff8, v122
    v_and_b32 v126, 0xfff8, v126
    s_cmp_lt_i32 s42, 3328
    s_cbranch_scc1 L_ufix_110
L_uback_111:

    v_subrev_co_u32 v106, s[56:57], 2.0, v106
    v_subrev_co_u32 v107, s[58:59], 2.0, v107
    v_subrev_co_u32 v108, s[98:99], 2.0, v108
    v_subrev_co_u32 v109, vcc, 2.0, v109
    s_mov_b64 exec, s[56:57]
    ds_read_b64 v[120:121], v120
    s_mov_b64 exec, s[58:59]
    ds_read_b64 v[122:123], v122
    s_mov_b64 exec, s[98:99]
    ds_read_b64 v[124:125], v124
    s_mov_b64 exec, vcc
    ds_read_b64 v[126:127], v126
    s_mov_b64 exec, -1
L_nt_109:
    s_mov_b32 s38, s5
    s_add_u32 s50, s50, 200000
    s_branch L_batch_75
L_bend_76:

    s_waitcnt vmcnt(0)
    s_load_dwordx2 s[68:69], s[0:1], 24
    s_load_dwordx4 s[88:91], s[0:1], 72
    s_load_dwordx2 s[76:77], s[0:1], 88
    s_load_dwordx2 s[80:81], s[0:1], 96
    s_mov_b32 s70, 1600000
    s_mov_b32 s71, 0x20000
    s_mov_b32 s78, 6400000
    s_mov_b32 s79, 0x20000
    s_movk_i32 s82, 256
    s_mov_b32 s83, 0x20000
    s_lshl_b32 s48, s36, 2
    s_mov_b32 s41, s37

    s_add_u32 s84, s6, 8896512
    s_addc_u32 s85, s7, 0
    s_mov_b32 s86, 76800000
    s_mov_b32 s87, 0x20000
    s_add_u32 s72, s6, 393216
    s_addc_u32 s73, s7, 0
    s_mov_b32 s74, 2097152
    s_mov_b32 s75, 0x20000
    s_cmp_le_i32 s42, 3072
    s_cbranch_scc1 L_nt_112
    s_waitcnt lgkmcnt(15)
    v_mad_i32_i16 v116, v120, v106, s96
    v_mad_i32_i16 v120, v120, v106, s96 op_sel:[1,0,0,0]
    v_mad_i32_i16 v117, v121, v106, s96
    v_mad_i32_i16 v121, v121, v106, s96 op_sel:[1,0,0,0]
    v_lshlrev_b32_sdwa v106, 3, v106 dst_sel:DWORD dst_unused:UNUSED_PAD src0_sel:DWORD src1_sel:WORD_1
    v_perm_b32 v120, v120, v116, s97
    v_perm_b32 v121, v121, v117, s97
    v_lshl_add_u64 v[120:121], v[120:121], 0, s[30:31]

    ds_add_rtn_u64 v[120:121], v106, v[120:121] offset:50000
    v_mad_i32_i16 v118, v122, v107, s96
    v_mad_i32_i16 v122, v122, v107, s96 op_sel:[1,0,0,0]
    v_mad_i32_i16 v119, v123, v107, s96
    v_mad_i32_i16 v123, v123, v107, s96 op_sel:[1,0,0,0]
    v_lshlrev_b32_sdwa v107, 3, v107 dst_sel:DWORD dst_unused:UNUSED_PAD src0_sel:DWORD src1_sel:WORD_1
    v_perm_b32 v122, v122, v118, s97
    v_perm_b32 v123, v123, v119, s97
    v_lshl_add_u64 v[122:123], v[122:123], 0, s[30:31]

    ds_add_rtn_u64 v[122:123], v107, v[122:123] offset:50000
    v_mad_i32_i16 v116, v124, v108, s96
    v_mad_i32_i16 v124, v124, v108, s96 op_sel:[1,0,0,0]
    v_mad_i32_i16 v117, v125, v108, s96
    v_mad_i32_i16 v125, v125, v108, s96 op_sel:[1,0,0,0]
    v_lshlrev_b32_sdwa v108, 3, v108 dst_sel:DWORD dst_unused:UNUSED_PAD src0_sel:DWORD src1_sel:WORD_1
    v_perm_b32 v124, v124, v116, s97
    v_perm_b32 v125, v125, v117, s97
    v_lshl_add_u64 v[124:125], v[124:125], 0, s[30:31]

    ds_add_rtn_u64 v[124:125], v108, v[124:125] offset:50000
    v_mad_i32_i16 v118, v126, v109, s96
    v_mad_i32_i16 v126, v126, v109, s96 op_sel:[1,0,0,0]
    v_mad_i32_i16 v119, v127, v109, s96
    v_mad_i32_i16 v127, v127, v109, s96 op_sel:[1,0,0,0]
    v_lshlrev_b32_sdwa v109, 3, v109 dst_sel:DWORD dst_unused:UNUSED_PAD src0_sel:DWORD src1_sel:WORD_1
    v_perm_b32 v126, v126, v118, s97
    v_perm_b32 v127, v127, v119, s97
    v_lshl_add_u64 v[126:127], v[126:127], 0, s[30:31]

    ds_add_rtn_u64 v[126:127], v109, v[126:127] offset:50000
L_nt_112:
    s_waitcnt lgkmcnt(15)
    v_mad_i32_i16 v116, v28, v4, s96
    v_mad_i32_i16 v28, v28, v4, s96 op_sel:[1,0,0,0]
    v_mad_i32_i16 v117, v29, v4, s96
    v_mad_i32_i16 v29, v29, v4, s96 op_sel:[1,0,0,0]
    v_lshlrev_b32_sdwa v4, 3, v4 dst_sel:DWORD dst_unused:UNUSED_PAD src0_sel:DWORD src1_sel:WORD_1
    v_perm_b32 v28, v28, v116, s97
    v_perm_b32 v29, v29, v117, s97
    v_lshl_add_u64 v[28:29], v[28:29], 0, s[30:31]

    ds_add_rtn_u64 v[28:29], v4, v[28:29] offset:50000
    v_mad_i32_i16 v118, v30, v5, s96
    v_mad_i32_i16 v30, v30, v5, s96 op_sel:[1,0,0,0]
    v_mad_i32_i16 v119, v31, v5, s96
    v_mad_i32_i16 v31, v31, v5, s96 op_sel:[1,0,0,0]
    v_lshlrev_b32_sdwa v5, 3, v5 dst_sel:DWORD dst_unused:UNUSED_PAD src0_sel:DWORD src1_sel:WORD_1
    v_perm_b32 v30, v30, v118, s97
    v_perm_b32 v31, v31, v119, s97
    v_lshl_add_u64 v[30:31], v[30:31], 0, s[30:31]

    ds_add_rtn_u64 v[30:31], v5, v[30:31] offset:50000
    v_mad_i32_i16 v116, v32, v6, s96
    v_mad_i32_i16 v32, v32, v6, s96 op_sel:[1,0,0,0]
    v_mad_i32_i16 v117, v33, v6, s96
    v_mad_i32_i16 v33, v33, v6, s96 op_sel:[1,0,0,0]
    v_lshlrev_b32_sdwa v6, 3, v6 dst_sel:DWORD dst_unused:UNUSED_PAD src0_sel:DWORD src1_sel:WORD_1
    v_perm_b32 v32, v32, v116, s97
    v_perm_b32 v33, v33, v117, s97
    v_lshl_add_u64 v[32:33], v[32:33], 0, s[30:31]

    ds_add_rtn_u64 v[32:33], v6, v[32:33] offset:50000
    v_mad_i32_i16 v118, v34, v7, s96
    v_mad_i32_i16 v34, v34, v7, s96 op_sel:[1,0,0,0]
    v_mad_i32_i16 v119, v35, v7, s96
    v_mad_i32_i16 v35, v35, v7, s96 op_sel:[1,0,0,0]
    v_lshlrev_b32_sdwa v7, 3, v7 dst_sel:DWORD dst_unused:UNUSED_PAD src0_sel:DWORD src1_sel:WORD_1
    v_perm_b32 v34, v34, v118, s97
    v_perm_b32 v35, v35, v119, s97
    v_lshl_add_u64 v[34:35], v[34:35], 0, s[30:31]

    ds_add_rtn_u64 v[34:35], v7, v[34:35] offset:50000
    v_mad_i32_i16 v116, v36, v8, s96
    v_mad_i32_i16 v36, v36, v8, s96 op_sel:[1,0,0,0]
    v_mad_i32_i16 v117, v37, v8, s96
    v_mad_i32_i16 v37, v37, v8, s96 op_sel:[1,0,0,0]
    v_lshlrev_b32_sdwa v8, 3, v8 dst_sel:DWORD dst_unused:UNUSED_PAD src0_sel:DWORD src1_sel:WORD_1
    v_perm_b32 v36, v36, v116, s97
    v_perm_b32 v37, v37, v117, s97
    v_lshl_add_u64 v[36:37], v[36:37], 0, s[30:31]

    ds_add_rtn_u64 v[36:37], v8, v[36:37] offset:50000
    v_mad_i32_i16 v118, v38, v9, s96
    v_mad_i32_i16 v38, v38, v9, s96 op_sel:[1,0,0,0]
    v_mad_i32_i16 v119, v39, v9, s96
    v_mad_i32_i16 v39, v39, v9, s96 op_sel:[1,0,0,0]
    v_lshlrev_b32_sdwa v9, 3, v9 dst_sel:DWORD dst_unused:UNUSED_PAD src0_sel:DWORD src1_sel:WORD_1
    v_perm_b32 v38, v38, v118, s97
    v_perm_b32 v39, v39, v119, s97
    v_lshl_add_u64 v[38:39], v[38:39], 0, s[30:31]

    ds_add_rtn_u64 v[38:39], v9, v[38:39] offset:50000
    v_mad_i32_i16 v116, v40, v10, s96
    v_mad_i32_i16 v40, v40, v10, s96 op_sel:[1,0,0,0]
    v_mad_i32_i16 v117, v41, v10, s96
    v_mad_i32_i16 v41, v41, v10, s96 op_sel:[1,0,0,0]
    v_lshlrev_b32_sdwa v10, 3, v10 dst_sel:DWORD dst_unused:UNUSED_PAD src0_sel:DWORD src1_sel:WORD_1
    v_perm_b32 v40, v40, v116, s97
    v_perm_b32 v41, v41, v117, s97
    v_lshl_add_u64 v[40:41], v[40:41], 0, s[30:31]

    ds_add_rtn_u64 v[40:41], v10, v[40:41] offset:50000
    v_mad_i32_i16 v118, v42, v11, s96
    v_mad_i32_i16 v42, v42, v11, s96 op_sel:[1,0,0,0]
    v_mad_i32_i16 v119, v43, v11, s96
    v_mad_i32_i16 v43, v43, v11, s96 op_sel:[1,0,0,0]
    v_lshlrev_b32_sdwa v11, 3, v11 dst_sel:DWORD dst_unused:UNUSED_PAD src0_sel:DWORD src1_sel:WORD_1
    v_perm_b32 v42, v42, v118, s97
    v_perm_b32 v43, v43, v119, s97
    v_lshl_add_u64 v[42:43], v[42:43], 0, s[30:31]

    ds_add_rtn_u64 v[42:43], v11, v[42:43] offset:50000
    s_waitcnt lgkmcnt(4)
    v_or3_b32 v1, v28, v29, v1
    v_or3_b32 v1, v30, v31, v1
    v_or3_b32 v1, v32, v33, v1
    v_or3_b32 v1, v34, v35, v1
    s_cmp_le_i32 s42, 3072
    s_cbranch_scc1 L_nt_113
    v_or3_b32 v1, v120, v121, v1
    v_or3_b32 v1, v122, v123, v1
    v_or3_b32 v1, v124, v125, v1
    v_or3_b32 v1, v126, v127, v1
L_nt_113:
    s_cmp_le_u32 s40, 3584
    s_cbranch_scc1 L_noleft_114
    s_min_u32 s40, s40, 6524
    s_lshl_b32 s52, s38, 6
    s_add_u32 s52, s52, s36
    s_mul_i32 s52, s52, 32764
    s_and_b32 s52, s52, 0xffffff80
    s_add_u32 s20, s44, s52
    s_addc_u32 s21, s45, 0
    s_mul_i32 s52, s40, 5
    s_add_u32 s52, s52, 3
    s_and_b32 s22, s52, -4

    s_lshr_b32 s55, s39, 2
    s_add_u32 s55, s55, 3584
    v_and_b32 v120, 63, v0
    v_add_u32 v120, s55, v120
L_left_115:
    s_cmp_ge_u32 s55, s40
    s_cbranch_scc1 L_leftend_116
    v_mul_u32_u24 v121, 5, v120
    buffer_load_dword v122, v121, s[20:23], 0 offen offset:1
    buffer_load_ubyte v123, v121, s[20:23], 0 offen
    s_waitcnt vmcnt(0)

    v_perm_b32 v121, v123, v122, s24
    v_lshrrev_b32 v126, 30, v122
    v_and_b32 v121, 0x1fff, v121
    v_mul_u32_u24 v126, 6250, v126
    v_add_lshl_u32 v121, v121, v126, 3

    buffer_load_dwordx2 v[124:125], v121, s[8:11], s50 offen
    v_cmp_gt_u32 vcc, s40, v120
    s_waitcnt vmcnt(0)

    s_mov_b64 exec, vcc
    v_and_b32 v122, 0x3fffffff, v122
    v_cvt_f32_i32_sdwa v118, sext(v122) dst_sel:DWORD dst_unused:UNUSED_PAD src0_sel:WORD_0
    v_lshlrev_b32 v116, 16, v124
    v_and_b32 v117, s32, v124
    v_mul_f32 v118, s33, v118
    v_lshlrev_b32 v124, 16, v125
    v_and_b32 v125, s32, v125
    v_lshlrev_b32_sdwa v122, 3, v122 dst_sel:DWORD dst_unused:UNUSED_PAD src0_sel:DWORD src1_sel:WORD_1
    v_pk_fma_f32 v[116:117], v[116:117], v[118:119], s[28:29] op_sel_hi:[1,0,1]
    v_pk_fma_f32 v[124:125], v[124:125], v[118:119], s[28:29] op_sel_hi:[1,0,1]
    v_perm_b32 v116, v117, v116, s35
    v_perm_b32 v117, v125, v124, s35
    v_lshl_add_u64 v[116:117], v[116:117], 0, s[30:31]
    ds_add_rtn_u64 v[124:125], v122, v[116:117] offset:50000

    s_waitcnt lgkmcnt(0)
    v_or3_b32 v1, v124, v125, v1
    s_mov_b64 exec, -1
    v_add_u32 v120, 128, v120
    s_add_u32 s55, s55, 128
    s_branch L_left_115
L_leftend_116:

L_noleft_114:
    s_waitcnt lgkmcnt(0)
    s_load_dwordx8 s[12:19], s[88:89], 0
    s_load_dwordx8 s[56:63], s[90:91], 0

    s_mul_i32 s28, s41, 3125
    s_add_u32 s29, s28, 3126
    s_add_u32 s28, s28, 1
    s_lshr_b32 s28, s28, 1
    s_lshr_b32 s29, s29, 1
    s_sub_u32 s29, s29, s28
    s_sub_u32 s5, s29, 782
    s_mul_i32 s3, s36, 6250
    v_add_u32 v78, s28, v0
    v_mov_b32 v82, 0x2000000
    v_add_u32 v79, 782, v78
    v_cmp_gt_u32 vcc, 782, v0
    v_add_u32 v76, s3, v78
    v_add_u32 v77, s3, v79
    v_cndmask_b32 v76, v82, v76, vcc
    v_cmp_gt_u32 vcc, s5, v0
    v_lshlrev_b32 v78, 4, v78
    v_lshlrev_b32 v79, 4, v79
    v_cndmask_b32 v77, v82, v77, vcc
    v_lshlrev_b32 v80, 2, v76
    v_lshlrev_b32 v76, 4, v76
    v_lshlrev_b32 v81, 2, v77
    v_lshlrev_b32 v77, 4, v77
    buffer_load_dword v80, v80, s[68:71], 0 offen
    buffer_load_dword v81, v81, s[68:71], 0 offen
    buffer_load_dwordx4 v[86:89], v76, s[8:11], 0 offen
    buffer_load_dwordx4 v[90:93], v77, s[8:11], 0 offen

    v_mad_i32_i16 v120, v44, v12, s96
    v_mad_i32_i16 v44, v44, v12, s96 op_sel:[1,0,0,0]
    v_mad_i32_i16 v121, v45, v12, s96
    v_mad_i32_i16 v45, v45, v12, s96 op_sel:[1,0,0,0]
    v_lshlrev_b32_sdwa v12, 3, v12 dst_sel:DWORD dst_unused:UNUSED_PAD src0_sel:DWORD src1_sel:WORD_1
    v_perm_b32 v44, v44, v120, s97
    v_perm_b32 v45, v45, v121, s97
    v_lshl_add_u64 v[44:45], v[44:45], 0, s[30:31]

    ds_add_rtn_u64 v[44:45], v12, v[44:45] offset:50000
    v_mad_i32_i16 v122, v46, v13, s96
    v_mad_i32_i16 v46, v46, v13, s96 op_sel:[1,0,0,0]
    v_mad_i32_i16 v123, v47, v13, s96
    v_mad_i32_i16 v47, v47, v13, s96 op_sel:[1,0,0,0]
    v_lshlrev_b32_sdwa v13, 3, v13 dst_sel:DWORD dst_unused:UNUSED_PAD src0_sel:DWORD src1_sel:WORD_1
    v_perm_b32 v46, v46, v122, s97
    v_perm_b32 v47, v47, v123, s97
    v_lshl_add_u64 v[46:47], v[46:47], 0, s[30:31]

    ds_add_rtn_u64 v[46:47], v13, v[46:47] offset:50000
    v_mad_i32_i16 v124, v48, v14, s96
    v_mad_i32_i16 v48, v48, v14, s96 op_sel:[1,0,0,0]
    v_mad_i32_i16 v125, v49, v14, s96
    v_mad_i32_i16 v49, v49, v14, s96 op_sel:[1,0,0,0]
    v_lshlrev_b32_sdwa v14, 3, v14 dst_sel:DWORD dst_unused:UNUSED_PAD src0_sel:DWORD src1_sel:WORD_1
    v_perm_b32 v48, v48, v124, s97
    v_perm_b32 v49, v49, v125, s97
    v_lshl_add_u64 v[48:49], v[48:49], 0, s[30:31]

    ds_add_rtn_u64 v[48:49], v14, v[48:49] offset:50000
    v_mad_i32_i16 v126, v50, v15, s96
    v_mad_i32_i16 v50, v50, v15, s96 op_sel:[1,0,0,0]
    v_mad_i32_i16 v127, v51, v15, s96
    v_mad_i32_i16 v51, v51, v15, s96 op_sel:[1,0,0,0]
    v_lshlrev_b32_sdwa v15, 3, v15 dst_sel:DWORD dst_unused:UNUSED_PAD src0_sel:DWORD src1_sel:WORD_1
    v_perm_b32 v50, v50, v126, s97
    v_perm_b32 v51, v51, v127, s97
    v_lshl_add_u64 v[50:51], v[50:51], 0, s[30:31]

    ds_add_rtn_u64 v[50:51], v15, v[50:51] offset:50000
    v_or3_b32 v1, v36, v37, v1
    v_or3_b32 v1, v38, v39, v1
    v_or3_b32 v1, v40, v41, v1
    v_or3_b32 v1, v42, v43, v1
    v_mad_i32_i16 v120, v52, v16, s96
    v_mad_i32_i16 v52, v52, v16, s96 op_sel:[1,0,0,0]
    v_mad_i32_i16 v121, v53, v16, s96
    v_mad_i32_i16 v53, v53, v16, s96 op_sel:[1,0,0,0]
    v_lshlrev_b32_sdwa v16, 3, v16 dst_sel:DWORD dst_unused:UNUSED_PAD src0_sel:DWORD src1_sel:WORD_1
    v_perm_b32 v52, v52, v120, s97
    v_perm_b32 v53, v53, v121, s97
    v_lshl_add_u64 v[52:53], v[52:53], 0, s[30:31]

    ds_add_rtn_u64 v[52:53], v16, v[52:53] offset:50000
    v_mad_i32_i16 v122, v54, v17, s96
    v_mad_i32_i16 v54, v54, v17, s96 op_sel:[1,0,0,0]
    v_mad_i32_i16 v123, v55, v17, s96
    v_mad_i32_i16 v55, v55, v17, s96 op_sel:[1,0,0,0]
    v_lshlrev_b32_sdwa v17, 3, v17 dst_sel:DWORD dst_unused:UNUSED_PAD src0_sel:DWORD src1_sel:WORD_1
    v_perm_b32 v54, v54, v122, s97
    v_perm_b32 v55, v55, v123, s97
    v_lshl_add_u64 v[54:55], v[54:55], 0, s[30:31]

    ds_add_rtn_u64 v[54:55], v17, v[54:55] offset:50000
    v_mad_i32_i16 v124, v56, v18, s96
    v_mad_i32_i16 v56, v56, v18, s96 op_sel:[1,0,0,0]
    v_mad_i32_i16 v125, v57, v18, s96
    v_mad_i32_i16 v57, v57, v18, s96 op_sel:[1,0,0,0]
    v_lshlrev_b32_sdwa v18, 3, v18 dst_sel:DWORD dst_unused:UNUSED_PAD src0_sel:DWORD src1_sel:WORD_1
    v_perm_b32 v56, v56, v124, s97
    v_perm_b32 v57, v57, v125, s97
    v_lshl_add_u64 v[56:57], v[56:57], 0, s[30:31]

    ds_add_rtn_u64 v[56:57], v18, v[56:57] offset:50000
    v_mad_i32_i16 v126, v58, v19, s96
    v_mad_i32_i16 v58, v58, v19, s96 op_sel:[1,0,0,0]
    v_mad_i32_i16 v127, v59, v19, s96
    v_mad_i32_i16 v59, v59, v19, s96 op_sel:[1,0,0,0]
    v_lshlrev_b32_sdwa v19, 3, v19 dst_sel:DWORD dst_unused:UNUSED_PAD src0_sel:DWORD src1_sel:WORD_1
    v_perm_b32 v58, v58, v126, s97
    v_perm_b32 v59, v59, v127, s97
    v_lshl_add_u64 v[58:59], v[58:59], 0, s[30:31]

    ds_add_rtn_u64 v[58:59], v19, v[58:59] offset:50000
    s_waitcnt lgkmcnt(4)
    v_or3_b32 v1, v44, v45, v1
    v_or3_b32 v1, v46, v47, v1
    v_or3_b32 v1, v48, v49, v1
    v_or3_b32 v1, v50, v51, v1
    s_waitcnt vmcnt(2)
    v_lshlrev_b32_sdwa v82, 5, v80 dst_sel:DWORD dst_unused:UNUSED_PAD src0_sel:DWORD src1_sel:WORD_0
    v_lshlrev_b32_sdwa v83, 5, v80 dst_sel:DWORD dst_unused:UNUSED_PAD src0_sel:DWORD src1_sel:WORD_1
    v_lshlrev_b32_sdwa v84, 5, v81 dst_sel:DWORD dst_unused:UNUSED_PAD src0_sel:DWORD src1_sel:WORD_0
    v_lshlrev_b32_sdwa v85, 5, v81 dst_sel:DWORD dst_unused:UNUSED_PAD src0_sel:DWORD src1_sel:WORD_1
    buffer_load_dwordx4 v[94:97], v82, s[72:75], 0 offen
    buffer_load_dwordx2 v[110:111], v82, s[72:75], 0 offen offset:16

    buffer_load_dwordx4 v[98:101], v83, s[72:75], 0 offen
    buffer_load_dwordx2 v[112:113], v83, s[72:75], 0 offen offset:16

    buffer_load_dwordx4 v[102:105], v84, s[72:75], 0 offen
    buffer_load_dwordx2 v[114:115], v84, s[72:75], 0 offen offset:16

    buffer_load_dwordx4 v[106:109], v85, s[72:75], 0 offen
    buffer_load_dwordx2 v[116:117], v85, s[72:75], 0 offen offset:16

    v_mad_i32_i16 v120, v60, v20, s96
    v_mad_i32_i16 v60, v60, v20, s96 op_sel:[1,0,0,0]
    v_mad_i32_i16 v121, v61, v20, s96
    v_mad_i32_i16 v61, v61, v20, s96 op_sel:[1,0,0,0]
    v_lshlrev_b32_sdwa v20, 3, v20 dst_sel:DWORD dst_unused:UNUSED_PAD src0_sel:DWORD src1_sel:WORD_1
    v_perm_b32 v60, v60, v120, s97
    v_perm_b32 v61, v61, v121, s97
    v_lshl_add_u64 v[60:61], v[60:61], 0, s[30:31]

    ds_add_rtn_u64 v[60:61], v20, v[60:61] offset:50000
    v_mad_i32_i16 v122, v62, v21, s96
    v_mad_i32_i16 v62, v62, v21, s96 op_sel:[1,0,0,0]
    v_mad_i32_i16 v123, v63, v21, s96
    v_mad_i32_i16 v63, v63, v21, s96 op_sel:[1,0,0,0]
    v_lshlrev_b32_sdwa v21, 3, v21 dst_sel:DWORD dst_unused:UNUSED_PAD src0_sel:DWORD src1_sel:WORD_1
    v_perm_b32 v62, v62, v122, s97
    v_perm_b32 v63, v63, v123, s97
    v_lshl_add_u64 v[62:63], v[62:63], 0, s[30:31]

    ds_add_rtn_u64 v[62:63], v21, v[62:63] offset:50000
    v_mad_i32_i16 v124, v64, v22, s96
    v_mad_i32_i16 v64, v64, v22, s96 op_sel:[1,0,0,0]
    v_mad_i32_i16 v125, v65, v22, s96
    v_mad_i32_i16 v65, v65, v22, s96 op_sel:[1,0,0,0]
    v_lshlrev_b32_sdwa v22, 3, v22 dst_sel:DWORD dst_unused:UNUSED_PAD src0_sel:DWORD src1_sel:WORD_1
    v_perm_b32 v64, v64, v124, s97
    v_perm_b32 v65, v65, v125, s97
    v_lshl_add_u64 v[64:65], v[64:65], 0, s[30:31]

    ds_add_rtn_u64 v[64:65], v22, v[64:65] offset:50000
    v_mad_i32_i16 v126, v66, v23, s96
    v_mad_i32_i16 v66, v66, v23, s96 op_sel:[1,0,0,0]
    v_mad_i32_i16 v127, v67, v23, s96
    v_mad_i32_i16 v67, v67, v23, s96 op_sel:[1,0,0,0]
    v_lshlrev_b32_sdwa v23, 3, v23 dst_sel:DWORD dst_unused:UNUSED_PAD src0_sel:DWORD src1_sel:WORD_1
    v_perm_b32 v66, v66, v126, s97
    v_perm_b32 v67, v67, v127, s97
    v_lshl_add_u64 v[66:67], v[66:67], 0, s[30:31]

    ds_add_rtn_u64 v[66:67], v23, v[66:67] offset:50000
    s_waitcnt lgkmcnt(4)
    v_or3_b32 v1, v52, v53, v1
    v_or3_b32 v1, v54, v55, v1
    v_or3_b32 v1, v56, v57, v1
    v_or3_b32 v1, v58, v59, v1
    v_mad_i32_i16 v120, v68, v24, s96
    v_mad_i32_i16 v68, v68, v24, s96 op_sel:[1,0,0,0]
    v_mad_i32_i16 v121, v69, v24, s96
    v_mad_i32_i16 v69, v69, v24, s96 op_sel:[1,0,0,0]
    v_lshlrev_b32_sdwa v24, 3, v24 dst_sel:DWORD dst_unused:UNUSED_PAD src0_sel:DWORD src1_sel:WORD_1
    v_perm_b32 v68, v68, v120, s97
    v_perm_b32 v69, v69, v121, s97
    v_lshl_add_u64 v[68:69], v[68:69], 0, s[30:31]

    ds_add_rtn_u64 v[68:69], v24, v[68:69] offset:50000
    v_mad_i32_i16 v122, v70, v25, s96
    v_mad_i32_i16 v70, v70, v25, s96 op_sel:[1,0,0,0]
    v_mad_i32_i16 v123, v71, v25, s96
    v_mad_i32_i16 v71, v71, v25, s96 op_sel:[1,0,0,0]
    v_lshlrev_b32_sdwa v25, 3, v25 dst_sel:DWORD dst_unused:UNUSED_PAD src0_sel:DWORD src1_sel:WORD_1
    v_perm_b32 v70, v70, v122, s97
    v_perm_b32 v71, v71, v123, s97
    v_lshl_add_u64 v[70:71], v[70:71], 0, s[30:31]

    ds_add_rtn_u64 v[70:71], v25, v[70:71] offset:50000
    v_mad_i32_i16 v124, v72, v26, s96
    v_mad_i32_i16 v72, v72, v26, s96 op_sel:[1,0,0,0]
    v_mad_i32_i16 v125, v73, v26, s96
    v_mad_i32_i16 v73, v73, v26, s96 op_sel:[1,0,0,0]
    v_lshlrev_b32_sdwa v26, 3, v26 dst_sel:DWORD dst_unused:UNUSED_PAD src0_sel:DWORD src1_sel:WORD_1
    v_perm_b32 v72, v72, v124, s97
    v_perm_b32 v73, v73, v125, s97
    v_lshl_add_u64 v[72:73], v[72:73], 0, s[30:31]

    ds_add_rtn_u64 v[72:73], v26, v[72:73] offset:50000
    v_mad_i32_i16 v126, v74, v27, s96
    v_mad_i32_i16 v74, v74, v27, s96 op_sel:[1,0,0,0]
    v_mad_i32_i16 v127, v75, v27, s96
    v_mad_i32_i16 v75, v75, v27, s96 op_sel:[1,0,0,0]
    v_lshlrev_b32_sdwa v27, 3, v27 dst_sel:DWORD dst_unused:UNUSED_PAD src0_sel:DWORD src1_sel:WORD_1
    v_perm_b32 v74, v74, v126, s97
    v_perm_b32 v75, v75, v127, s97
    v_lshl_add_u64 v[74:75], v[74:75], 0, s[30:31]

    ds_add_rtn_u64 v[74:75], v27, v[74:75] offset:50000
    s_waitcnt lgkmcnt(4)
    v_or3_b32 v1, v60, v61, v1
    v_or3_b32 v1, v62, v63, v1
    v_or3_b32 v1, v64, v65, v1
    v_or3_b32 v1, v66, v67, v1
    s_waitcnt lgkmcnt(0)
    v_or3_b32 v1, v68, v69, v1
    v_or3_b32 v1, v70, v71, v1
    v_or3_b32 v1, v72, v73, v1
    v_or3_b32 v1, v74, v75, v1
    s_barrier

    v_add_u32 v40, 50000, v3
    v_add_u32 v41, 115536, v3
    v_cmp_gt_u32 vcc, 106, v0

    v_mov_b32 v28, 0
    v_mov_b32 v29, 0
    v_mov_b32 v30, 0
    v_mov_b32 v31, 0
    ds_read_b128 v[4:7], v40 offset:0
    ds_read_b128 v[8:11], v40 offset:16384
    ds_read_b128 v[12:15], v40 offset:32768
    ds_read_b128 v[16:19], v40 offset:49152
    ds_read_b128 v[20:23], v41 offset:0
    ds_read_b128 v[24:27], v41 offset:16384
    s_mov_b64 exec, vcc
    ds_read_b128 v[28:31], v41 offset:32768
    s_mov_b64 exec, -1
    s_mul_i32 s3, s37, 6400000
    s_mul_i32 s5, s36, 100000
    s_add_u32 s3, s3, s5
    s_add_u32 s3, s3, 8896512
    v_bfrev_b32 v42, 1

    s_add_u32 s20, s6, s3
    s_addc_u32 s21, s7, 0
    s_mov_b32 s22, 100000
    s_mov_b32 s23, 0x20000
    s_sub_u32 s3, 0, s28
    v_add_u32 v43, s3, v0
    v_cmp_gt_u32 vcc, s29, v43
    s_mov_b32 s3, 0
    s_waitcnt lgkmcnt(6)
    v_cndmask_b32 v43, v3, v42, vcc
    buffer_store_dwordx4 v[4:7], v43, s[20:23], s3 offen sc1

    s_sub_u32 s3, 1024, s28
    v_add_u32 v43, s3, v0
    v_cmp_gt_u32 vcc, s29, v43
    s_mov_b32 s3, 16384
    s_waitcnt lgkmcnt(5)
    v_cndmask_b32 v43, v3, v42, vcc
    buffer_store_dwordx4 v[8:11], v43, s[20:23], s3 offen sc1

    s_sub_u32 s3, 2048, s28
    v_add_u32 v43, s3, v0
    v_cmp_gt_u32 vcc, s29, v43
    s_mov_b32 s3, 32768
    s_waitcnt lgkmcnt(4)
    v_cndmask_b32 v43, v3, v42, vcc
    buffer_store_dwordx4 v[12:15], v43, s[20:23], s3 offen sc1

    s_sub_u32 s3, 3072, s28
    v_add_u32 v43, s3, v0
    v_cmp_gt_u32 vcc, s29, v43
    s_mov_b32 s3, 49152
    s_waitcnt lgkmcnt(3)
    v_cndmask_b32 v43, v3, v42, vcc
    buffer_store_dwordx4 v[16:19], v43, s[20:23], s3 offen sc1

    s_sub_u32 s3, 4096, s28
    v_add_u32 v43, s3, v0
    v_cmp_gt_u32 vcc, s29, v43
    s_mov_b32 s3, 65536
    s_waitcnt lgkmcnt(2)
    v_cndmask_b32 v43, v3, v42, vcc
    buffer_store_dwordx4 v[20:23], v43, s[20:23], s3 offen sc1

    s_sub_u32 s3, 5120, s28
    v_add_u32 v43, s3, v0
    v_cmp_gt_u32 vcc, s29, v43
    s_mov_b32 s3, 81920
    s_waitcnt lgkmcnt(1)
    v_cndmask_b32 v43, v3, v42, vcc
    buffer_store_dwordx4 v[24:27], v43, s[20:23], s3 offen sc1

    s_sub_u32 s3, 6144, s28
    v_add_u32 v43, s3, v0
    v_cmp_gt_u32 vcc, s29, v43
    s_mov_b32 s3, 98304
    s_waitcnt lgkmcnt(0)
    v_cndmask_b32 v43, v3, v42, vcc
    buffer_store_dwordx4 v[28:31], v43, s[20:23], s3 offen sc1

    v_or3_b32 v1, v4, v5, v1
    v_or3_b32 v1, v6, v7, v1
    v_or3_b32 v1, v8, v9, v1
    v_or3_b32 v1, v10, v11, v1
    v_or3_b32 v1, v12, v13, v1
    v_or3_b32 v1, v14, v15, v1
    v_or3_b32 v1, v16, v17, v1
    v_or3_b32 v1, v18, v19, v1
    v_or3_b32 v1, v20, v21, v1
    v_or3_b32 v1, v22, v23, v1
    v_or3_b32 v1, v24, v25, v1
    v_or3_b32 v1, v26, v27, v1
    v_or3_b32 v1, v28, v29, v1
    v_or3_b32 v1, v30, v31, v1
    v_and_b32 v1, 0x80008000, v1
    v_cmp_ne_u32 vcc, 0, v1
    v_mov_b32 v40, 150024
    v_mov_b32 v41, 1
    s_cbranch_vccz L_nf_117
    ds_write_b32 v40, v41
L_nf_117:
    s_mov_b32 s33, 1
    s_mov_b32 s49, s37
    s_waitcnt vmcnt(0) lgkmcnt(0)

    s_barrier
    ds_read_b32 v41, v40
    s_waitcnt lgkmcnt(0)
    v_readfirstlane_b32 s3, v41
    s_nop 1
    s_cmp_lg_u32 s3, 0
    s_cbranch_scc1 L_p2slow_48

L_meet_119:
    v_readfirstlane_b32 s3, v0
    v_mov_b32 v118, 150016
    s_nop 0
    s_cmp_eq_u32 s3, 960
    s_cbranch_scc1 L_sync_126
L_bcast_121:
    s_barrier

    ds_read_b32 v119, v118
    s_waitcnt lgkmcnt(0)
    v_readfirstlane_b32 s35, v119
    s_nop 1
    s_bitcmp1_b32 s35, 16
    s_cbranch_scc1 L_fend_127
L_post_123:
    v_cmp_gt_u32 vcc, 782, v0
    s_mov_b64 exec, vcc
    s_cbranch_execz L_postend_124

    s_cmp_eq_u32 s49, 0
    s_cbranch_scc1 L_own_133
    s_mov_b32 s3, 0
    buffer_load_dwordx4 v[36:39], v76, s[84:87], s3 offen sc1
    buffer_load_dwordx4 v[52:55], v77, s[84:87], s3 offen sc1
L_obk_134:
    s_cmp_eq_u32 s49, 1
    s_cbranch_scc1 L_own_135
    s_mov_b32 s3, 6400000
    buffer_load_dwordx4 v[40:43], v76, s[84:87], s3 offen sc1
    buffer_load_dwordx4 v[56:59], v77, s[84:87], s3 offen sc1
L_obk_136:
    s_cmp_eq_u32 s49, 2
    s_cbranch_scc1 L_own_137
    s_mov_b32 s3, 12800000
    buffer_load_dwordx4 v[44:47], v76, s[84:87], s3 offen sc1
    buffer_load_dwordx4 v[60:63], v77, s[84:87], s3 offen sc1
L_obk_138:
    s_cmp_eq_u32 s49, 3
    s_cbranch_scc1 L_own_139
    s_mov_b32 s3, 19200000
    buffer_load_dwordx4 v[48:51], v76, s[84:87], s3 offen sc1
    buffer_load_dwordx4 v[64:67], v77, s[84:87], s3 offen sc1
L_obk_140:
    s_and_b32 s3, s35, 0xf0
    s_waitcnt vmcnt(0) lgkmcnt(0)
    s_cbranch_scc1 L_fgen_141

    v_add_u32 v36, v36, v40
    v_add_u32 v44, v44, v48
    v_add_u32 v37, v37, v41
    v_add_u32 v45, v45, v49
    v_add_u32 v38, v38, v42
    v_add_u32 v46, v46, v50
    v_add_u32 v39, v39, v43
    v_add_u32 v47, v47, v51
    v_add_u32_sdwa v4, v36, v44 dst_sel:DWORD dst_unused:UNUSED_PAD src0_sel:WORD_0 src1_sel:WORD_0
    v_add_u32_sdwa v5, v36, v44 dst_sel:DWORD dst_unused:UNUSED_PAD src0_sel:WORD_1 src1_sel:WORD_1
    v_add_u32_sdwa v6, v37, v45 dst_sel:DWORD dst_unused:UNUSED_PAD src0_sel:WORD_0 src1_sel:WORD_0
    v_add_u32_sdwa v7, v37, v45 dst_sel:DWORD dst_unused:UNUSED_PAD src0_sel:WORD_1 src1_sel:WORD_1
    v_add_u32_sdwa v8, v38, v46 dst_sel:DWORD dst_unused:UNUSED_PAD src0_sel:WORD_0 src1_sel:WORD_0
    v_add_u32_sdwa v9, v38, v46 dst_sel:DWORD dst_unused:UNUSED_PAD src0_sel:WORD_1 src1_sel:WORD_1
    v_add_u32_sdwa v10, v39, v47 dst_sel:DWORD dst_unused:UNUSED_PAD src0_sel:WORD_0 src1_sel:WORD_0
    v_add_u32_sdwa v11, v39, v47 dst_sel:DWORD dst_unused:UNUSED_PAD src0_sel:WORD_1 src1_sel:WORD_1
    v_add_u32 v52, v52, v56
    v_add_u32 v60, v60, v64
    v_add_u32 v53, v53, v57
    v_add_u32 v61, v61, v65
    v_add_u32 v54, v54, v58
    v_add_u32 v62, v62, v66
    v_add_u32 v55, v55, v59
    v_add_u32 v63, v63, v67
    v_add_u32_sdwa v12, v52, v60 dst_sel:DWORD dst_unused:UNUSED_PAD src0_sel:WORD_0 src1_sel:WORD_0
    v_add_u32_sdwa v13, v52, v60 dst_sel:DWORD dst_unused:UNUSED_PAD src0_sel:WORD_1 src1_sel:WORD_1
    v_add_u32_sdwa v14, v53, v61 dst_sel:DWORD dst_unused:UNUSED_PAD src0_sel:WORD_0 src1_sel:WORD_0
    v_add_u32_sdwa v15, v53, v61 dst_sel:DWORD dst_unused:UNUSED_PAD src0_sel:WORD_1 src1_sel:WORD_1
    v_add_u32_sdwa v16, v54, v62 dst_sel:DWORD dst_unused:UNUSED_PAD src0_sel:WORD_0 src1_sel:WORD_0
    v_add_u32_sdwa v17, v54, v62 dst_sel:DWORD dst_unused:UNUSED_PAD src0_sel:WORD_1 src1_sel:WORD_1
    v_add_u32_sdwa v18, v55, v63 dst_sel:DWORD dst_unused:UNUSED_PAD src0_sel:WORD_0 src1_sel:WORD_0
    v_add_u32_sdwa v19, v55, v63 dst_sel:DWORD dst_unused:UNUSED_PAD src0_sel:WORD_1 src1_sel:WORD_1
    v_add_u32 v4, 0xffff0000, v4
    v_add_u32 v5, 0xffff0000, v5
    v_add_u32 v6, 0xffff0000, v6
    v_add_u32 v7, 0xffff0000, v7
    v_add_u32 v8, 0xffff0000, v8
    v_add_u32 v9, 0xffff0000, v9
    v_add_u32 v10, 0xffff0000, v10
    v_add_u32 v11, 0xffff0000, v11
    v_add_u32 v12, 0xffff0000, v12
    v_add_u32 v13, 0xffff0000, v13
    v_add_u32 v14, 0xffff0000, v14
    v_add_u32 v15, 0xffff0000, v15
    v_add_u32 v16, 0xffff0000, v16
    v_add_u32 v17, 0xffff0000, v17
    v_add_u32 v18, 0xffff0000, v18
    v_add_u32 v19, 0xffff0000, v19
    v_cvt_f32_i32 v4, v4
    v_cvt_f32_i32 v5, v5
    v_cvt_f32_i32 v6, v6
    v_cvt_f32_i32 v7, v7
    v_cvt_f32_i32 v8, v8
    v_cvt_f32_i32 v9, v9
    v_cvt_f32_i32 v10, v10
    v_cvt_f32_i32 v11, v11
    v_cvt_f32_i32 v12, v12
    v_cvt_f32_i32 v13, v13
    v_cvt_f32_i32 v14, v14
    v_cvt_f32_i32 v15, v15
    v_cvt_f32_i32 v16, v16
    v_cvt_f32_i32 v17, v17
    v_cvt_f32_i32 v18, v18
    v_cvt_f32_i32 v19, v19
    v_mul_f32 v4, s34, v4
    v_mul_f32 v5, s34, v5
    v_mul_f32 v6, s34, v6
    v_mul_f32 v7, s34, v7
    v_mul_f32 v8, s34, v8
    v_mul_f32 v9, s34, v9
    v_mul_f32 v10, s34, v10
    v_mul_f32 v11, s34, v11
    v_mul_f32 v12, s34, v12
    v_mul_f32 v13, s34, v13
    v_mul_f32 v14, s34, v14
    v_mul_f32 v15, s34, v15
    v_mul_f32 v16, s34, v16
    v_mul_f32 v17, s34, v17
    v_mul_f32 v18, s34, v18
    v_mul_f32 v19, s34, v19
L_fbk_142:
    s_lshl_b32 s52, s12, 16
    v_mul_f32 v20, s52, v4
    v_mul_f32 v24, s52, v8
    v_mul_f32 v28, s52, v12
    v_mul_f32 v32, s52, v16
    s_and_b32 s53, s12, s32
    v_mul_f32 v21, s53, v4
    v_mul_f32 v25, s53, v8
    v_mul_f32 v29, s53, v12
    v_mul_f32 v33, s53, v16
    s_lshl_b32 s52, s13, 16
    v_mul_f32 v22, s52, v4
    v_mul_f32 v26, s52, v8
    v_mul_f32 v30, s52, v12
    v_mul_f32 v34, s52, v16
    s_and_b32 s53, s13, s32
    v_mul_f32 v23, s53, v4
    v_mul_f32 v27, s53, v8
    v_mul_f32 v31, s53, v12
    v_mul_f32 v35, s53, v16
    s_lshl_b32 s52, s14, 16
    v_fmac_f32 v20, s52, v5
    v_fmac_f32 v24, s52, v9
    v_fmac_f32 v28, s52, v13
    v_fmac_f32 v32, s52, v17
    s_and_b32 s53, s14, s32
    v_fmac_f32 v21, s53, v5
    v_fmac_f32 v25, s53, v9
    v_fmac_f32 v29, s53, v13
    v_fmac_f32 v33, s53, v17
    s_lshl_b32 s52, s15, 16
    v_fmac_f32 v22, s52, v5
    v_fmac_f32 v26, s52, v9
    v_fmac_f32 v30, s52, v13
    v_fmac_f32 v34, s52, v17
    s_and_b32 s53, s15, s32
    v_fmac_f32 v23, s53, v5
    v_fmac_f32 v27, s53, v9
    v_fmac_f32 v31, s53, v13
    v_fmac_f32 v35, s53, v17
    s_lshl_b32 s52, s16, 16
    v_fmac_f32 v20, s52, v6
    v_fmac_f32 v24, s52, v10
    v_fmac_f32 v28, s52, v14
    v_fmac_f32 v32, s52, v18
    s_and_b32 s53, s16, s32
    v_fmac_f32 v21, s53, v6
    v_fmac_f32 v25, s53, v10
    v_fmac_f32 v29, s53, v14
    v_fmac_f32 v33, s53, v18
    s_lshl_b32 s52, s17, 16
    v_fmac_f32 v22, s52, v6
    v_fmac_f32 v26, s52, v10
    v_fmac_f32 v30, s52, v14
    v_fmac_f32 v34, s52, v18
    s_and_b32 s53, s17, s32
    v_fmac_f32 v23, s53, v6
    v_fmac_f32 v27, s53, v10
    v_fmac_f32 v31, s53, v14
    v_fmac_f32 v35, s53, v18
    s_lshl_b32 s52, s18, 16
    v_fmac_f32 v20, s52, v7
    v_fmac_f32 v24, s52, v11
    v_fmac_f32 v28, s52, v15
    v_fmac_f32 v32, s52, v19
    s_and_b32 s53, s18, s32
    v_fmac_f32 v21, s53, v7
    v_fmac_f32 v25, s53, v11
    v_fmac_f32 v29, s53, v15
    v_fmac_f32 v33, s53, v19
    s_lshl_b32 s52, s19, 16
    v_fmac_f32 v22, s52, v7
    v_fmac_f32 v26, s52, v11
    v_fmac_f32 v30, s52, v15
    v_fmac_f32 v34, s52, v19
    s_and_b32 s53, s19, s32
    v_fmac_f32 v23, s53, v7
    v_fmac_f32 v27, s53, v11
    v_fmac_f32 v31, s53, v15
    v_fmac_f32 v35, s53, v19
    v_mul_f32 v20, v20, v94
    v_mul_f32 v21, v21, v95
    v_mul_f32 v22, v22, v96
    v_mul_f32 v23, v23, v97
    v_mul_f32 v24, v24, v98
    v_mul_f32 v25, v25, v99
    v_mul_f32 v26, v26, v100
    v_mul_f32 v27, v27, v101
    v_mul_f32 v28, v28, v102
    v_mul_f32 v29, v29, v103
    v_mul_f32 v30, v30, v104
    v_mul_f32 v31, v31, v105
    v_mul_f32 v32, v32, v106
    v_mul_f32 v33, v33, v107
    v_mul_f32 v34, v34, v108
    v_mul_f32 v35, v35, v109
    v_cvt_pk_bf16_f32 v20, v20, v21
    v_cvt_pk_bf16_f32 v22, v22, v23
    v_cvt_pk_bf16_f32 v24, v24, v25
    v_cvt_pk_bf16_f32 v26, v26, v27
    v_cvt_pk_bf16_f32 v28, v28, v29
    v_cvt_pk_bf16_f32 v30, v30, v31
    v_cvt_pk_bf16_f32 v32, v32, v33
    v_cvt_pk_bf16_f32 v34, v34, v35
    s_pack_ll_b32_b16 s52, s56, s58
    v_dot2_f32_bf16 v4, v20, s52, 0
    v_dot2_f32_bf16 v8, v24, s52, 0
    v_dot2_f32_bf16 v12, v28, s52, 0
    v_dot2_f32_bf16 v16, v32, s52, 0
    s_pack_hh_b32_b16 s53, s56, s58
    v_dot2_f32_bf16 v5, v20, s53, 0
    v_dot2_f32_bf16 v9, v24, s53, 0
    v_dot2_f32_bf16 v13, v28, s53, 0
    v_dot2_f32_bf16 v17, v32, s53, 0
    s_pack_ll_b32_b16 s52, s57, s59
    v_dot2_f32_bf16 v6, v20, s52, 0
    v_dot2_f32_bf16 v10, v24, s52, 0
    v_dot2_f32_bf16 v14, v28, s52, 0
    v_dot2_f32_bf16 v18, v32, s52, 0
    s_pack_hh_b32_b16 s53, s57, s59
    v_dot2_f32_bf16 v7, v20, s53, 0
    v_dot2_f32_bf16 v11, v24, s53, 0
    v_dot2_f32_bf16 v15, v28, s53, 0
    v_dot2_f32_bf16 v19, v32, s53, 0
    s_pack_ll_b32_b16 s52, s60, s62
    v_dot2_f32_bf16 v4, v22, s52, v4
    v_dot2_f32_bf16 v8, v26, s52, v8
    v_dot2_f32_bf16 v12, v30, s52, v12
    v_dot2_f32_bf16 v16, v34, s52, v16
    s_pack_hh_b32_b16 s53, s60, s62
    v_dot2_f32_bf16 v5, v22, s53, v5
    v_dot2_f32_bf16 v9, v26, s53, v9
    v_dot2_f32_bf16 v13, v30, s53, v13
    v_dot2_f32_bf16 v17, v34, s53, v17
    s_pack_ll_b32_b16 s52, s61, s63
    v_dot2_f32_bf16 v6, v22, s52, v6
    v_dot2_f32_bf16 v10, v26, s52, v10
    v_dot2_f32_bf16 v14, v30, s52, v14
    v_dot2_f32_bf16 v18, v34, s52, v18
    s_pack_hh_b32_b16 s53, s61, s63
    v_dot2_f32_bf16 v7, v22, s53, v7
    v_dot2_f32_bf16 v11, v26, s53, v11
    v_dot2_f32_bf16 v15, v30, s53, v15
    v_dot2_f32_bf16 v19, v34, s53, v19
    v_lshlrev_b32 v36, 16, v86
    v_and_b32 v37, s32, v86
    v_lshlrev_b32 v52, 16, v110
    v_and_b32 v53, s32, v110
    v_lshlrev_b32 v38, 16, v87
    v_and_b32 v39, s32, v87
    v_lshlrev_b32 v54, 16, v111
    v_and_b32 v55, s32, v111
    v_lshlrev_b32 v40, 16, v88
    v_and_b32 v41, s32, v88
    v_lshlrev_b32 v56, 16, v112
    v_and_b32 v57, s32, v112
    v_lshlrev_b32 v42, 16, v89
    v_and_b32 v43, s32, v89
    v_lshlrev_b32 v58, 16, v113
    v_and_b32 v59, s32, v113
    v_lshlrev_b32 v44, 16, v90
    v_and_b32 v45, s32, v90
    v_lshlrev_b32 v60, 16, v114
    v_and_b32 v61, s32, v114
    v_lshlrev_b32 v46, 16, v91
    v_and_b32 v47, s32, v91
    v_lshlrev_b32 v62, 16, v115
    v_and_b32 v63, s32, v115
    v_lshlrev_b32 v48, 16, v92
    v_and_b32 v49, s32, v92
    v_lshlrev_b32 v64, 16, v116
    v_and_b32 v65, s32, v116
    v_lshlrev_b32 v50, 16, v93
    v_and_b32 v51, s32, v93
    v_lshlrev_b32 v66, 16, v117
    v_and_b32 v67, s32, v117
    v_cvt_pk_bf16_f32 v4, v4, v5
    v_cvt_pk_bf16_f32 v6, v6, v7
    v_cvt_pk_bf16_f32 v8, v8, v9
    v_cvt_pk_bf16_f32 v10, v10, v11
    v_cvt_pk_bf16_f32 v12, v12, v13
    v_cvt_pk_bf16_f32 v14, v14, v15
    v_cvt_pk_bf16_f32 v16, v16, v17
    v_cvt_pk_bf16_f32 v18, v18, v19
    v_and_b32 v5, s32, v4
    v_lshlrev_b32 v4, 16, v4
    v_and_b32 v7, s32, v6
    v_lshlrev_b32 v6, 16, v6
    v_and_b32 v9, s32, v8
    v_lshlrev_b32 v8, 16, v8
    v_and_b32 v11, s32, v10
    v_lshlrev_b32 v10, 16, v10
    v_and_b32 v13, s32, v12
    v_lshlrev_b32 v12, 16, v12
    v_and_b32 v15, s32, v14
    v_lshlrev_b32 v14, 16, v14
    v_and_b32 v17, s32, v16
    v_lshlrev_b32 v16, 16, v16
    v_and_b32 v19, s32, v18
    v_lshlrev_b32 v18, 16, v18
    v_mul_f32 v4, v4, v52
    v_mul_f32 v5, v5, v53
    v_mul_f32 v6, v6, v54
    v_mul_f32 v7, v7, v55
    v_mul_f32 v8, v8, v56
    v_mul_f32 v9, v9, v57
    v_mul_f32 v10, v10, v58
    v_mul_f32 v11, v11, v59
    v_mul_f32 v12, v12, v60
    v_mul_f32 v13, v13, v61
    v_mul_f32 v14, v14, v62
    v_mul_f32 v15, v15, v63
    v_mul_f32 v16, v16, v64
    v_mul_f32 v17, v17, v65
    v_mul_f32 v18, v18, v66
    v_mul_f32 v19, v19, v67
    v_cvt_pk_bf16_f32 v4, v4, v5
    v_cvt_pk_bf16_f32 v6, v6, v7
    v_cvt_pk_bf16_f32 v8, v8, v9
    v_cvt_pk_bf16_f32 v10, v10, v11
    v_cvt_pk_bf16_f32 v12, v12, v13
    v_cvt_pk_bf16_f32 v14, v14, v15
    v_cvt_pk_bf16_f32 v16, v16, v17
    v_cvt_pk_bf16_f32 v18, v18, v19
    v_and_b32 v5, s32, v4
    v_lshlrev_b32 v4, 16, v4
    v_and_b32 v7, s32, v6
    v_lshlrev_b32 v6, 16, v6
    v_and_b32 v9, s32, v8
    v_lshlrev_b32 v8, 16, v8
    v_and_b32 v11, s32, v10
    v_lshlrev_b32 v10, 16, v10
    v_and_b32 v13, s32, v12
    v_lshlrev_b32 v12, 16, v12
    v_and_b32 v15, s32, v14
    v_lshlrev_b32 v14, 16, v14
    v_and_b32 v17, s32, v16
    v_lshlrev_b32 v16, 16, v16
    v_and_b32 v19, s32, v18
    v_lshlrev_b32 v18, 16, v18
    v_add_f32 v4, v4, v36
    v_add_f32 v5, v5, v37
    v_add_f32 v6, v6, v38
    v_add_f32 v7, v7, v39
    v_add_f32 v8, v8, v40
    v_add_f32 v9, v9, v41
    v_add_f32 v10, v10, v42
    v_add_f32 v11, v11, v43
    v_add_f32 v12, v12, v44
    v_add_f32 v13, v13, v45
    v_add_f32 v14, v14, v46
    v_add_f32 v15, v15, v47
    v_add_f32 v16, v16, v48
    v_add_f32 v17, v17, v49
    v_add_f32 v18, v18, v50
    v_add_f32 v19, v19, v51
    v_cvt_pk_bf16_f32 v20, v4, v5
    v_cvt_pk_bf16_f32 v21, v6, v7
    v_cvt_pk_bf16_f32 v22, v8, v9
    v_cvt_pk_bf16_f32 v23, v10, v11
    v_cvt_pk_bf16_f32 v24, v12, v13
    v_cvt_pk_bf16_f32 v25, v14, v15
    v_cvt_pk_bf16_f32 v26, v16, v17
    v_cvt_pk_bf16_f32 v27, v18, v19
    buffer_store_dwordx4 v[20:23], v76, s[76:79], 0 offen
    buffer_store_dwordx4 v[24:27], v77, s[76:79], 0 offen
L_postend_124:
    s_mov_b64 exec, -1

    s_bfe_u32 s3, s35, 0x40008
    s_cbranch_scc0 L_fend_127
    s_ff1_i32_b32 s41, s3
    s_add_u32 s3, s41, 8
    s_bitset0_b32 s35, s3
    s_mov_b32 s49, -1

    s_mul_i32 s28, s41, 3125
    s_add_u32 s29, s28, 3126
    s_add_u32 s28, s28, 1
    s_lshr_b32 s28, s28, 1
    s_lshr_b32 s29, s29, 1
    s_sub_u32 s29, s29, s28
    s_sub_u32 s5, s29, 782
    s_mul_i32 s3, s36, 6250
    v_add_u32 v78, s28, v0
    v_mov_b32 v82, 0x2000000
    v_add_u32 v79, 782, v78
    v_cmp_gt_u32 vcc, 782, v0
    v_add_u32 v76, s3, v78
    v_add_u32 v77, s3, v79
    v_cndmask_b32 v76, v82, v76, vcc
    v_cmp_gt_u32 vcc, s5, v0
    v_lshlrev_b32 v78, 4, v78
    v_lshlrev_b32 v79, 4, v79
    v_cndmask_b32 v77, v82, v77, vcc
    v_lshlrev_b32 v80, 2, v76
    v_lshlrev_b32 v76, 4, v76
    v_lshlrev_b32 v81, 2, v77
    v_lshlrev_b32 v77, 4, v77
    buffer_load_dword v80, v80, s[68:71], 0 offen
    buffer_load_dword v81, v81, s[68:71], 0 offen
    buffer_load_dwordx4 v[86:89], v76, s[8:11], 0 offen
    buffer_load_dwordx4 v[90:93], v77, s[8:11], 0 offen

    s_waitcnt vmcnt(2)
    v_lshlrev_b32_sdwa v82, 5, v80 dst_sel:DWORD dst_unused:UNUSED_PAD src0_sel:DWORD src1_sel:WORD_0
    v_lshlrev_b32_sdwa v83, 5, v80 dst_sel:DWORD dst_unused:UNUSED_PAD src0_sel:DWORD src1_sel:WORD_1
    v_lshlrev_b32_sdwa v84, 5, v81 dst_sel:DWORD dst_unused:UNUSED_PAD src0_sel:DWORD src1_sel:WORD_0
    v_lshlrev_b32_sdwa v85, 5, v81 dst_sel:DWORD dst_unused:UNUSED_PAD src0_sel:DWORD src1_sel:WORD_1
    buffer_load_dwordx4 v[94:97], v82, s[72:75], 0 offen
    buffer_load_dwordx2 v[110:111], v82, s[72:75], 0 offen offset:16

    buffer_load_dwordx4 v[98:101], v83, s[72:75], 0 offen
    buffer_load_dwordx2 v[112:113], v83, s[72:75], 0 offen offset:16

    buffer_load_dwordx4 v[102:105], v84, s[72:75], 0 offen
    buffer_load_dwordx2 v[114:115], v84, s[72:75], 0 offen offset:16

    buffer_load_dwordx4 v[106:109], v85, s[72:75], 0 offen
    buffer_load_dwordx2 v[116:117], v85, s[72:75], 0 offen offset:16

    s_branch L_post_123
L_fin_118:

    s_load_dwordx2 s[68:69], s[0:1], 24
    s_load_dwordx4 s[88:91], s[0:1], 72
    s_load_dwordx2 s[76:77], s[0:1], 88
    s_load_dwordx2 s[80:81], s[0:1], 96
    s_mov_b32 s70, 1600000
    s_mov_b32 s71, 0x20000
    s_mov_b32 s78, 6400000
    s_mov_b32 s79, 0x20000
    s_movk_i32 s82, 256
    s_mov_b32 s83, 0x20000
    s_lshl_b32 s48, s36, 2
    s_mov_b32 s41, s37

    s_add_u32 s84, s6, 8896512
    s_addc_u32 s85, s7, 0
    s_mov_b32 s86, 76800000
    s_mov_b32 s87, 0x20000
    s_add_u32 s72, s6, 393216
    s_addc_u32 s73, s7, 0
    s_mov_b32 s74, 2097152
    s_mov_b32 s75, 0x20000
    s_mov_b32 s49, -1
    s_waitcnt lgkmcnt(0)
    s_load_dwordx8 s[12:19], s[88:89], 0
    s_load_dwordx8 s[56:63], s[90:91], 0

    s_mul_i32 s28, s41, 3125
    s_add_u32 s29, s28, 3126
    s_add_u32 s28, s28, 1
    s_lshr_b32 s28, s28, 1
    s_lshr_b32 s29, s29, 1
    s_sub_u32 s29, s29, s28
    s_sub_u32 s5, s29, 782
    s_mul_i32 s3, s36, 6250
    v_add_u32 v78, s28, v0
    v_mov_b32 v82, 0x2000000
    v_add_u32 v79, 782, v78
    v_cmp_gt_u32 vcc, 782, v0
    v_add_u32 v76, s3, v78
    v_add_u32 v77, s3, v79
    v_cndmask_b32 v76, v82, v76, vcc
    v_cmp_gt_u32 vcc, s5, v0
    v_lshlrev_b32 v78, 4, v78
    v_lshlrev_b32 v79, 4, v79
    v_cndmask_b32 v77, v82, v77, vcc
    v_lshlrev_b32 v80, 2, v76
    v_lshlrev_b32 v76, 4, v76
    v_lshlrev_b32 v81, 2, v77
    v_lshlrev_b32 v77, 4, v77
    buffer_load_dword v80, v80, s[68:71], 0 offen
    buffer_load_dword v81, v81, s[68:71], 0 offen
    buffer_load_dwordx4 v[86:89], v76, s[8:11], 0 offen
    buffer_load_dwordx4 v[90:93], v77, s[8:11], 0 offen

    s_waitcnt vmcnt(2)
    v_lshlrev_b32_sdwa v82, 5, v80 dst_sel:DWORD dst_unused:UNUSED_PAD src0_sel:DWORD src1_sel:WORD_0
    v_lshlrev_b32_sdwa v83, 5, v80 dst_sel:DWORD dst_unused:UNUSED_PAD src0_sel:DWORD src1_sel:WORD_1
    v_lshlrev_b32_sdwa v84, 5, v81 dst_sel:DWORD dst_unused:UNUSED_PAD src0_sel:DWORD src1_sel:WORD_0
    v_lshlrev_b32_sdwa v85, 5, v81 dst_sel:DWORD dst_unused:UNUSED_PAD src0_sel:DWORD src1_sel:WORD_1
    buffer_load_dwordx4 v[94:97], v82, s[72:75], 0 offen
    buffer_load_dwordx2 v[110:111], v82, s[72:75], 0 offen offset:16

    buffer_load_dwordx4 v[98:101], v83, s[72:75], 0 offen
    buffer_load_dwordx2 v[112:113], v83, s[72:75], 0 offen offset:16

    buffer_load_dwordx4 v[102:105], v84, s[72:75], 0 offen
    buffer_load_dwordx2 v[114:115], v84, s[72:75], 0 offen offset:16

    buffer_load_dwordx4 v[106:109], v85, s[72:75], 0 offen
    buffer_load_dwordx2 v[116:117], v85, s[72:75], 0 offen offset:16

    s_waitcnt vmcnt(0) lgkmcnt(0)
    s_barrier
    s_branch L_meet_119
L_fend_127:

L_p2done_47:
    s_endpgm

L_ufix_57:
    v_and_b32 v117, 63, v0
    v_lshlrev_b32 v117, 2, v117
    s_sub_i32 s54, s42, 1024
    v_cmp_le_i32 vcc, s54, v117
    s_mov_b64 exec, vcc
    v_lshlrev_b32 v12, 14, v117
    v_mov_b32 v44, 0
    s_mov_b64 exec, -1
    s_sub_i32 s54, s42, 1025
    v_cmp_le_i32 vcc, s54, v117
    s_mov_b64 exec, vcc
    v_lshlrev_b32 v13, 14, v117
    v_mov_b32 v46, 0
    s_mov_b64 exec, -1
    s_sub_i32 s54, s42, 1026
    v_cmp_le_i32 vcc, s54, v117
    s_mov_b64 exec, vcc
    v_lshlrev_b32 v14, 14, v117
    v_mov_b32 v48, 0
    s_mov_b64 exec, -1
    s_sub_i32 s54, s42, 1027
    v_cmp_le_i32 vcc, s54, v117
    s_mov_b64 exec, vcc
    v_lshlrev_b32 v15, 14, v117
    v_mov_b32 v50, 0
    s_mov_b64 exec, -1
    s_branch L_uback_58
L_ufix_59:
    v_and_b32 v117, 63, v0
    v_lshlrev_b32 v117, 2, v117
    s_sub_i32 s54, s42, 1536
    v_cmp_le_i32 vcc, s54, v117
    s_mov_b64 exec, vcc
    v_lshlrev_b32 v16, 14, v117
    v_mov_b32 v52, 0
    s_mov_b64 exec, -1
    s_sub_i32 s54, s42, 1537
    v_cmp_le_i32 vcc, s54, v117
    s_mov_b64 exec, vcc
    v_lshlrev_b32 v17, 14, v117
    v_mov_b32 v54, 0
    s_mov_b64 exec, -1
    s_sub_i32 s54, s42, 1538
    v_cmp_le_i32 vcc, s54, v117
    s_mov_b64 exec, vcc
    v_lshlrev_b32 v18, 14, v117
    v_mov_b32 v56, 0
    s_mov_b64 exec, -1
    s_sub_i32 s54, s42, 1539
    v_cmp_le_i32 vcc, s54, v117
    s_mov_b64 exec, vcc
    v_lshlrev_b32 v19, 14, v117
    v_mov_b32 v58, 0
    s_mov_b64 exec, -1
    s_branch L_uback_60
L_ufix_61:
    v_and_b32 v117, 63, v0
    v_lshlrev_b32 v117, 2, v117
    s_sub_i32 s54, s42, 2048
    v_cmp_le_i32 vcc, s54, v117
    s_mov_b64 exec, vcc
    v_lshlrev_b32 v20, 14, v117
    v_mov_b32 v60, 0
    s_mov_b64 exec, -1
    s_sub_i32 s54, s42, 2049
    v_cmp_le_i32 vcc, s54, v117
    s_mov_b64 exec, vcc
    v_lshlrev_b32 v21, 14, v117
    v_mov_b32 v62, 0
    s_mov_b64 exec, -1
    s_sub_i32 s54, s42, 2050
    v_cmp_le_i32 vcc, s54, v117
    s_mov_b64 exec, vcc
    v_lshlrev_b32 v22, 14, v117
    v_mov_b32 v64, 0
    s_mov_b64 exec, -1
    s_sub_i32 s54, s42, 2051
    v_cmp_le_i32 vcc, s54, v117
    s_mov_b64 exec, vcc
    v_lshlrev_b32 v23, 14, v117
    v_mov_b32 v66, 0
    s_mov_b64 exec, -1
    s_branch L_uback_62
L_ufix_63:
    v_and_b32 v117, 63, v0
    v_lshlrev_b32 v117, 2, v117
    s_sub_i32 s54, s42, 2560
    v_cmp_le_i32 vcc, s54, v117
    s_mov_b64 exec, vcc
    v_lshlrev_b32 v24, 14, v117
    v_mov_b32 v68, 0
    s_mov_b64 exec, -1
    s_sub_i32 s54, s42, 2561
    v_cmp_le_i32 vcc, s54, v117
    s_mov_b64 exec, vcc
    v_lshlrev_b32 v25, 14, v117
    v_mov_b32 v70, 0
    s_mov_b64 exec, -1
    s_sub_i32 s54, s42, 2562
    v_cmp_le_i32 vcc, s54, v117
    s_mov_b64 exec, vcc
    v_lshlrev_b32 v26, 14, v117
    v_mov_b32 v72, 0
    s_mov_b64 exec, -1
    s_sub_i32 s54, s42, 2563
    v_cmp_le_i32 vcc, s54, v117
    s_mov_b64 exec, vcc
    v_lshlrev_b32 v27, 14, v117
    v_mov_b32 v74, 0
    s_mov_b64 exec, -1
    s_branch L_uback_64
L_ufix_65:
    v_and_b32 v117, 63, v0
    v_lshlrev_b32 v117, 2, v117
    s_sub_i32 s54, s42, 0
    v_cmp_le_i32 vcc, s54, v117
    s_mov_b64 exec, vcc
    v_lshlrev_b32 v4, 14, v117
    v_mov_b32 v28, 0
    s_mov_b64 exec, -1
    s_sub_i32 s54, s42, 1
    v_cmp_le_i32 vcc, s54, v117
    s_mov_b64 exec, vcc
    v_lshlrev_b32 v5, 14, v117
    v_mov_b32 v30, 0
    s_mov_b64 exec, -1
    s_sub_i32 s54, s42, 2
    v_cmp_le_i32 vcc, s54, v117
    s_mov_b64 exec, vcc
    v_lshlrev_b32 v6, 14, v117
    v_mov_b32 v32, 0
    s_mov_b64 exec, -1
    s_sub_i32 s54, s42, 3
    v_cmp_le_i32 vcc, s54, v117
    s_mov_b64 exec, vcc
    v_lshlrev_b32 v7, 14, v117
    v_mov_b32 v34, 0
    s_mov_b64 exec, -1
    s_branch L_uback_66
L_ufix_69:
    v_and_b32 v117, 63, v0
    v_lshlrev_b32 v117, 2, v117
    s_sub_i32 s54, s42, 512
    v_cmp_le_i32 vcc, s54, v117
    s_mov_b64 exec, vcc
    v_lshlrev_b32 v8, 14, v117
    v_mov_b32 v36, 0
    s_mov_b64 exec, -1
    s_sub_i32 s54, s42, 513
    v_cmp_le_i32 vcc, s54, v117
    s_mov_b64 exec, vcc
    v_lshlrev_b32 v9, 14, v117
    v_mov_b32 v38, 0
    s_mov_b64 exec, -1
    s_sub_i32 s54, s42, 514
    v_cmp_le_i32 vcc, s54, v117
    s_mov_b64 exec, vcc
    v_lshlrev_b32 v10, 14, v117
    v_mov_b32 v40, 0
    s_mov_b64 exec, -1
    s_sub_i32 s54, s42, 515
    v_cmp_le_i32 vcc, s54, v117
    s_mov_b64 exec, vcc
    v_lshlrev_b32 v11, 14, v117
    v_mov_b32 v42, 0
    s_mov_b64 exec, -1
    s_branch L_uback_70
L_ufix_72:
    v_and_b32 v117, 63, v0
    v_lshlrev_b32 v117, 2, v117
    s_sub_i32 s54, s42, 3072
    v_cmp_le_i32 vcc, s54, v117
    s_mov_b64 exec, vcc
    v_lshlrev_b32 v106, 14, v117
    v_mov_b32 v120, 0
    s_mov_b64 exec, -1
    s_sub_i32 s54, s42, 3073
    v_cmp_le_i32 vcc, s54, v117
    s_mov_b64 exec, vcc
    v_lshlrev_b32 v107, 14, v117
    v_mov_b32 v122, 0
    s_mov_b64 exec, -1
    s_sub_i32 s54, s42, 3074
    v_cmp_le_i32 vcc, s54, v117
    s_mov_b64 exec, vcc
    v_lshlrev_b32 v108, 14, v117
    v_mov_b32 v124, 0
    s_mov_b64 exec, -1
    s_sub_i32 s54, s42, 3075
    v_cmp_le_i32 vcc, s54, v117
    s_mov_b64 exec, vcc
    v_lshlrev_b32 v109, 14, v117
    v_mov_b32 v126, 0
    s_mov_b64 exec, -1
    s_branch L_uback_73
L_ufix_94:
    v_and_b32 v117, 63, v0
    v_lshlrev_b32 v117, 2, v117
    s_sub_i32 s54, s42, 1024
    v_cmp_le_i32 vcc, s54, v117
    s_mov_b64 exec, vcc
    v_lshlrev_b32 v12, 14, v117
    v_mov_b32 v44, 0
    s_mov_b64 exec, -1
    s_sub_i32 s54, s42, 1025
    v_cmp_le_i32 vcc, s54, v117
    s_mov_b64 exec, vcc
    v_lshlrev_b32 v13, 14, v117
    v_mov_b32 v46, 0
    s_mov_b64 exec, -1
    s_sub_i32 s54, s42, 1026
    v_cmp_le_i32 vcc, s54, v117
    s_mov_b64 exec, vcc
    v_lshlrev_b32 v14, 14, v117
    v_mov_b32 v48, 0
    s_mov_b64 exec, -1
    s_sub_i32 s54, s42, 1027
    v_cmp_le_i32 vcc, s54, v117
    s_mov_b64 exec, vcc
    v_lshlrev_b32 v15, 14, v117
    v_mov_b32 v50, 0
    s_mov_b64 exec, -1
    s_branch L_uback_95
L_ufix_97:
    v_and_b32 v117, 63, v0
    v_lshlrev_b32 v117, 2, v117
    s_sub_i32 s54, s42, 1536
    v_cmp_le_i32 vcc, s54, v117
    s_mov_b64 exec, vcc
    v_lshlrev_b32 v16, 14, v117
    v_mov_b32 v52, 0
    s_mov_b64 exec, -1
    s_sub_i32 s54, s42, 1537
    v_cmp_le_i32 vcc, s54, v117
    s_mov_b64 exec, vcc
    v_lshlrev_b32 v17, 14, v117
    v_mov_b32 v54, 0
    s_mov_b64 exec, -1
    s_sub_i32 s54, s42, 1538
    v_cmp_le_i32 vcc, s54, v117
    s_mov_b64 exec, vcc
    v_lshlrev_b32 v18, 14, v117
    v_mov_b32 v56, 0
    s_mov_b64 exec, -1
    s_sub_i32 s54, s42, 1539
    v_cmp_le_i32 vcc, s54, v117
    s_mov_b64 exec, vcc
    v_lshlrev_b32 v19, 14, v117
    v_mov_b32 v58, 0
    s_mov_b64 exec, -1
    s_branch L_uback_98
L_ufix_100:
    v_and_b32 v117, 63, v0
    v_lshlrev_b32 v117, 2, v117
    s_sub_i32 s54, s42, 2048
    v_cmp_le_i32 vcc, s54, v117
    s_mov_b64 exec, vcc
    v_lshlrev_b32 v20, 14, v117
    v_mov_b32 v60, 0
    s_mov_b64 exec, -1
    s_sub_i32 s54, s42, 2049
    v_cmp_le_i32 vcc, s54, v117
    s_mov_b64 exec, vcc
    v_lshlrev_b32 v21, 14, v117
    v_mov_b32 v62, 0
    s_mov_b64 exec, -1
    s_sub_i32 s54, s42, 2050
    v_cmp_le_i32 vcc, s54, v117
    s_mov_b64 exec, vcc
    v_lshlrev_b32 v22, 14, v117
    v_mov_b32 v64, 0
    s_mov_b64 exec, -1
    s_sub_i32 s54, s42, 2051
    v_cmp_le_i32 vcc, s54, v117
    s_mov_b64 exec, vcc
    v_lshlrev_b32 v23, 14, v117
    v_mov_b32 v66, 0
    s_mov_b64 exec, -1
    s_branch L_uback_101
L_ufix_102:
    v_and_b32 v117, 63, v0
    v_lshlrev_b32 v117, 2, v117
    s_sub_i32 s54, s42, 2560
    v_cmp_le_i32 vcc, s54, v117
    s_mov_b64 exec, vcc
    v_lshlrev_b32 v24, 14, v117
    v_mov_b32 v68, 0
    s_mov_b64 exec, -1
    s_sub_i32 s54, s42, 2561
    v_cmp_le_i32 vcc, s54, v117
    s_mov_b64 exec, vcc
    v_lshlrev_b32 v25, 14, v117
    v_mov_b32 v70, 0
    s_mov_b64 exec, -1
    s_sub_i32 s54, s42, 2562
    v_cmp_le_i32 vcc, s54, v117
    s_mov_b64 exec, vcc
    v_lshlrev_b32 v26, 14, v117
    v_mov_b32 v72, 0
    s_mov_b64 exec, -1
    s_sub_i32 s54, s42, 2563
    v_cmp_le_i32 vcc, s54, v117
    s_mov_b64 exec, vcc
    v_lshlrev_b32 v27, 14, v117
    v_mov_b32 v74, 0
    s_mov_b64 exec, -1
    s_branch L_uback_103
L_ufix_105:
    v_and_b32 v117, 63, v0
    v_lshlrev_b32 v117, 2, v117
    s_sub_i32 s54, s42, 0
    v_cmp_le_i32 vcc, s54, v117
    s_mov_b64 exec, vcc
    v_lshlrev_b32 v4, 14, v117
    v_mov_b32 v28, 0
    s_mov_b64 exec, -1
    s_sub_i32 s54, s42, 1
    v_cmp_le_i32 vcc, s54, v117
    s_mov_b64 exec, vcc
    v_lshlrev_b32 v5, 14, v117
    v_mov_b32 v30, 0
    s_mov_b64 exec, -1
    s_sub_i32 s54, s42, 2
    v_cmp_le_i32 vcc, s54, v117
    s_mov_b64 exec, vcc
    v_lshlrev_b32 v6, 14, v117
    v_mov_b32 v32, 0
    s_mov_b64 exec, -1
    s_sub_i32 s54, s42, 3
    v_cmp_le_i32 vcc, s54, v117
    s_mov_b64 exec, vcc
    v_lshlrev_b32 v7, 14, v117
    v_mov_b32 v34, 0
    s_mov_b64 exec, -1
    s_branch L_uback_106
L_ufix_107:
    v_and_b32 v117, 63, v0
    v_lshlrev_b32 v117, 2, v117
    s_sub_i32 s54, s42, 512
    v_cmp_le_i32 vcc, s54, v117
    s_mov_b64 exec, vcc
    v_lshlrev_b32 v8, 14, v117
    v_mov_b32 v36, 0
    s_mov_b64 exec, -1
    s_sub_i32 s54, s42, 513
    v_cmp_le_i32 vcc, s54, v117
    s_mov_b64 exec, vcc
    v_lshlrev_b32 v9, 14, v117
    v_mov_b32 v38, 0
    s_mov_b64 exec, -1
    s_sub_i32 s54, s42, 514
    v_cmp_le_i32 vcc, s54, v117
    s_mov_b64 exec, vcc
    v_lshlrev_b32 v10, 14, v117
    v_mov_b32 v40, 0
    s_mov_b64 exec, -1
    s_sub_i32 s54, s42, 515
    v_cmp_le_i32 vcc, s54, v117
    s_mov_b64 exec, vcc
    v_lshlrev_b32 v11, 14, v117
    v_mov_b32 v42, 0
    s_mov_b64 exec, -1
    s_branch L_uback_108
L_ufix_110:
    v_and_b32 v117, 63, v0
    v_lshlrev_b32 v117, 2, v117
    s_sub_i32 s54, s42, 3072
    v_cmp_le_i32 vcc, s54, v117
    s_mov_b64 exec, vcc
    v_lshlrev_b32 v106, 14, v117
    v_mov_b32 v120, 0
    s_mov_b64 exec, -1
    s_sub_i32 s54, s42, 3073
    v_cmp_le_i32 vcc, s54, v117
    s_mov_b64 exec, vcc
    v_lshlrev_b32 v107, 14, v117
    v_mov_b32 v122, 0
    s_mov_b64 exec, -1
    s_sub_i32 s54, s42, 3074
    v_cmp_le_i32 vcc, s54, v117
    s_mov_b64 exec, vcc
    v_lshlrev_b32 v108, 14, v117
    v_mov_b32 v124, 0
    s_mov_b64 exec, -1
    s_sub_i32 s54, s42, 3075
    v_cmp_le_i32 vcc, s54, v117
    s_mov_b64 exec, vcc
    v_lshlrev_b32 v109, 14, v117
    v_mov_b32 v126, 0
    s_mov_b64 exec, -1
    s_branch L_uback_111
L_sync_126:
    v_and_b32 v40, 63, v0
    v_lshlrev_b32 v41, 20, v40
    v_mov_b32 v42, s33
    buffer_atomic_add v42, v41, s[80:83], s48 offen sc0
    s_waitcnt vmcnt(0)
    v_readfirstlane_b32 s4, v42
    s_movk_i32 s5, 400
    s_nop 0
    s_add_u32 s4, s4, s33
    s_bitcmp1_b32 s4, 2
    s_cbranch_scc1 L_tell_130
L_poll_128:
    s_sub_u32 s5, s5, 1
    s_cbranch_scc1 L_gave_129
    v_mov_b32 v42, 0
    buffer_atomic_add v42, v41, s[80:83], s48 offen sc0
    s_waitcnt vmcnt(0)
    v_readfirstlane_b32 s4, v42
    s_nop 1
    s_and_b32 s4, s4, 0xff
    s_bitcmp0_b32 s4, 2
    s_cbranch_scc1 L_poll_128
    s_branch L_tell_130
L_gave_129:
    s_cmp_lg_u32 s49, s37
    s_cbranch_scc1 L_gno_132
    v_add_lshl_u32 v40, v40, s28, 4
    s_mov_b32 s5, 0
L_gl_131:
    v_min_u32 v43, 100000, v40
    ds_read_b128 v[44:47], v43 offset:50000
    s_waitcnt lgkmcnt(0)
    buffer_store_dwordx4 v[44:47], v40, s[20:23], 0 offen sc1
    s_waitcnt vmcnt(0)
    v_add_u32 v40, 1024, v40
    s_add_u32 s5, s5, 64
    s_cmp_lt_u32 s5, s29
    s_cbranch_scc1 L_gl_131
L_gno_132:
    s_lshl_b32 s4, 0x100, s37
    v_mov_b32 v42, s4
    buffer_atomic_or v42, v41, s[80:83], s48 offen sc0
    s_waitcnt vmcnt(0)
    v_readfirstlane_b32 s4, v42
    s_nop 1
    s_and_b32 s4, s4, 0xff
    s_bitcmp1_b32 s4, 2
    s_cselect_b32 s4, s4, 0x10000
L_tell_130:
    v_mov_b32 v42, s4
    ds_write_b32 v118, v42
    s_waitcnt lgkmcnt(0)
    s_branch L_bcast_121

L_own_133:
    ds_read_b128 v[36:39], v78 offset:50000
    ds_read_b128 v[52:55], v79 offset:50000
    s_branch L_obk_134

L_own_135:
    ds_read_b128 v[40:43], v78 offset:50000
    ds_read_b128 v[56:59], v79 offset:50000
    s_branch L_obk_136

L_own_137:
    ds_read_b128 v[44:47], v78 offset:50000
    ds_read_b128 v[60:63], v79 offset:50000
    s_branch L_obk_138

L_own_139:
    ds_read_b128 v[48:51], v78 offset:50000
    ds_read_b128 v[64:67], v79 offset:50000
    s_branch L_obk_140

L_fgen_141:
    v_lshlrev_b32 v82, 1, v76
    v_lshlrev_b32 v83, 1, v77
    v_mov_b32 v4, 0
    v_mov_b32 v5, 0
    v_mov_b32 v6, 0
    v_mov_b32 v7, 0
    v_mov_b32 v8, 0
    v_mov_b32 v9, 0
    v_mov_b32 v10, 0
    v_mov_b32 v11, 0
    v_mov_b32 v12, 0
    v_mov_b32 v13, 0
    v_mov_b32 v14, 0
    v_mov_b32 v15, 0
    v_mov_b32 v16, 0
    v_mov_b32 v17, 0
    v_mov_b32 v18, 0
    v_mov_b32 v19, 0
    s_bitcmp1_b32 s35, 4
    s_cbranch_scc1 L_ffl_143
    v_cvt_f32_u32_sdwa v20, v36 dst_sel:DWORD dst_unused:UNUSED_PAD src0_sel:WORD_0
    v_cvt_f32_u32_sdwa v21, v36 dst_sel:DWORD dst_unused:UNUSED_PAD src0_sel:WORD_1
    v_cvt_f32_u32_sdwa v22, v37 dst_sel:DWORD dst_unused:UNUSED_PAD src0_sel:WORD_0
    v_cvt_f32_u32_sdwa v23, v37 dst_sel:DWORD dst_unused:UNUSED_PAD src0_sel:WORD_1
    v_cvt_f32_u32_sdwa v24, v38 dst_sel:DWORD dst_unused:UNUSED_PAD src0_sel:WORD_0
    v_cvt_f32_u32_sdwa v25, v38 dst_sel:DWORD dst_unused:UNUSED_PAD src0_sel:WORD_1
    v_cvt_f32_u32_sdwa v26, v39 dst_sel:DWORD dst_unused:UNUSED_PAD src0_sel:WORD_0
    v_cvt_f32_u32_sdwa v27, v39 dst_sel:DWORD dst_unused:UNUSED_PAD src0_sel:WORD_1
    v_cvt_f32_u32_sdwa v28, v52 dst_sel:DWORD dst_unused:UNUSED_PAD src0_sel:WORD_0
    v_cvt_f32_u32_sdwa v29, v52 dst_sel:DWORD dst_unused:UNUSED_PAD src0_sel:WORD_1
    v_cvt_f32_u32_sdwa v30, v53 dst_sel:DWORD dst_unused:UNUSED_PAD src0_sel:WORD_0
    v_cvt_f32_u32_sdwa v31, v53 dst_sel:DWORD dst_unused:UNUSED_PAD src0_sel:WORD_1
    v_cvt_f32_u32_sdwa v32, v54 dst_sel:DWORD dst_unused:UNUSED_PAD src0_sel:WORD_0
    v_cvt_f32_u32_sdwa v33, v54 dst_sel:DWORD dst_unused:UNUSED_PAD src0_sel:WORD_1
    v_cvt_f32_u32_sdwa v34, v55 dst_sel:DWORD dst_unused:UNUSED_PAD src0_sel:WORD_0
    v_cvt_f32_u32_sdwa v35, v55 dst_sel:DWORD dst_unused:UNUSED_PAD src0_sel:WORD_1
    v_add_f32 v20, 0xc6800000, v20
    v_fmac_f32 v4, s34, v20
    v_add_f32 v21, 0xc6800000, v21
    v_fmac_f32 v5, s34, v21
    v_add_f32 v22, 0xc6800000, v22
    v_fmac_f32 v6, s34, v22
    v_add_f32 v23, 0xc6800000, v23
    v_fmac_f32 v7, s34, v23
    v_add_f32 v24, 0xc6800000, v24
    v_fmac_f32 v8, s34, v24
    v_add_f32 v25, 0xc6800000, v25
    v_fmac_f32 v9, s34, v25
    v_add_f32 v26, 0xc6800000, v26
    v_fmac_f32 v10, s34, v26
    v_add_f32 v27, 0xc6800000, v27
    v_fmac_f32 v11, s34, v27
    v_add_f32 v28, 0xc6800000, v28
    v_fmac_f32 v12, s34, v28
    v_add_f32 v29, 0xc6800000, v29
    v_fmac_f32 v13, s34, v29
    v_add_f32 v30, 0xc6800000, v30
    v_fmac_f32 v14, s34, v30
    v_add_f32 v31, 0xc6800000, v31
    v_fmac_f32 v15, s34, v31
    v_add_f32 v32, 0xc6800000, v32
    v_fmac_f32 v16, s34, v32
    v_add_f32 v33, 0xc6800000, v33
    v_fmac_f32 v17, s34, v33
    v_add_f32 v34, 0xc6800000, v34
    v_fmac_f32 v18, s34, v34
    v_add_f32 v35, 0xc6800000, v35
    v_fmac_f32 v19, s34, v35
    s_branch L_fnx_144
L_ffl_143:
    s_mov_b32 s3, 25600000
    buffer_load_dwordx4 v[20:23], v82, s[84:87], s3 offen offset:0 sc1
    buffer_load_dwordx4 v[24:27], v82, s[84:87], s3 offen offset:16 sc1
    buffer_load_dwordx4 v[28:31], v83, s[84:87], s3 offen offset:0 sc1
    buffer_load_dwordx4 v[32:35], v83, s[84:87], s3 offen offset:16 sc1
    s_waitcnt vmcnt(0)
    v_add_f32 v4, v4, v20
    v_add_f32 v5, v5, v21
    v_add_f32 v6, v6, v22
    v_add_f32 v7, v7, v23
    v_add_f32 v8, v8, v24
    v_add_f32 v9, v9, v25
    v_add_f32 v10, v10, v26
    v_add_f32 v11, v11, v27
    v_add_f32 v12, v12, v28
    v_add_f32 v13, v13, v29
    v_add_f32 v14, v14, v30
    v_add_f32 v15, v15, v31
    v_add_f32 v16, v16, v32
    v_add_f32 v17, v17, v33
    v_add_f32 v18, v18, v34
    v_add_f32 v19, v19, v35
L_fnx_144:
    s_bitcmp1_b32 s35, 5
    s_cbranch_scc1 L_ffl_145
    v_cvt_f32_u32_sdwa v20, v40 dst_sel:DWORD dst_unused:UNUSED_PAD src0_sel:WORD_0
    v_cvt_f32_u32_sdwa v21, v40 dst_sel:DWORD dst_unused:UNUSED_PAD src0_sel:WORD_1
    v_cvt_f32_u32_sdwa v22, v41 dst_sel:DWORD dst_unused:UNUSED_PAD src0_sel:WORD_0
    v_cvt_f32_u32_sdwa v23, v41 dst_sel:DWORD dst_unused:UNUSED_PAD src0_sel:WORD_1
    v_cvt_f32_u32_sdwa v24, v42 dst_sel:DWORD dst_unused:UNUSED_PAD src0_sel:WORD_0
    v_cvt_f32_u32_sdwa v25, v42 dst_sel:DWORD dst_unused:UNUSED_PAD src0_sel:WORD_1
    v_cvt_f32_u32_sdwa v26, v43 dst_sel:DWORD dst_unused:UNUSED_PAD src0_sel:WORD_0
    v_cvt_f32_u32_sdwa v27, v43 dst_sel:DWORD dst_unused:UNUSED_PAD src0_sel:WORD_1
    v_cvt_f32_u32_sdwa v28, v56 dst_sel:DWORD dst_unused:UNUSED_PAD src0_sel:WORD_0
    v_cvt_f32_u32_sdwa v29, v56 dst_sel:DWORD dst_unused:UNUSED_PAD src0_sel:WORD_1
    v_cvt_f32_u32_sdwa v30, v57 dst_sel:DWORD dst_unused:UNUSED_PAD src0_sel:WORD_0
    v_cvt_f32_u32_sdwa v31, v57 dst_sel:DWORD dst_unused:UNUSED_PAD src0_sel:WORD_1
    v_cvt_f32_u32_sdwa v32, v58 dst_sel:DWORD dst_unused:UNUSED_PAD src0_sel:WORD_0
    v_cvt_f32_u32_sdwa v33, v58 dst_sel:DWORD dst_unused:UNUSED_PAD src0_sel:WORD_1
    v_cvt_f32_u32_sdwa v34, v59 dst_sel:DWORD dst_unused:UNUSED_PAD src0_sel:WORD_0
    v_cvt_f32_u32_sdwa v35, v59 dst_sel:DWORD dst_unused:UNUSED_PAD src0_sel:WORD_1
    v_add_f32 v20, 0xc6800000, v20
    v_fmac_f32 v4, s34, v20
    v_add_f32 v21, 0xc6800000, v21
    v_fmac_f32 v5, s34, v21
    v_add_f32 v22, 0xc6800000, v22
    v_fmac_f32 v6, s34, v22
    v_add_f32 v23, 0xc6800000, v23
    v_fmac_f32 v7, s34, v23
    v_add_f32 v24, 0xc6800000, v24
    v_fmac_f32 v8, s34, v24
    v_add_f32 v25, 0xc6800000, v25
    v_fmac_f32 v9, s34, v25
    v_add_f32 v26, 0xc6800000, v26
    v_fmac_f32 v10, s34, v26
    v_add_f32 v27, 0xc6800000, v27
    v_fmac_f32 v11, s34, v27
    v_add_f32 v28, 0xc6800000, v28
    v_fmac_f32 v12, s34, v28
    v_add_f32 v29, 0xc6800000, v29
    v_fmac_f32 v13, s34, v29
    v_add_f32 v30, 0xc6800000, v30
    v_fmac_f32 v14, s34, v30
    v_add_f32 v31, 0xc6800000, v31
    v_fmac_f32 v15, s34, v31
    v_add_f32 v32, 0xc6800000, v32
    v_fmac_f32 v16, s34, v32
    v_add_f32 v33, 0xc6800000, v33
    v_fmac_f32 v17, s34, v33
    v_add_f32 v34, 0xc6800000, v34
    v_fmac_f32 v18, s34, v34
    v_add_f32 v35, 0xc6800000, v35
    v_fmac_f32 v19, s34, v35
    s_branch L_fnx_146
L_ffl_145:
    s_mov_b32 s3, 38400000
    buffer_load_dwordx4 v[20:23], v82, s[84:87], s3 offen offset:0 sc1
    buffer_load_dwordx4 v[24:27], v82, s[84:87], s3 offen offset:16 sc1
    buffer_load_dwordx4 v[28:31], v83, s[84:87], s3 offen offset:0 sc1
    buffer_load_dwordx4 v[32:35], v83, s[84:87], s3 offen offset:16 sc1
    s_waitcnt vmcnt(0)
    v_add_f32 v4, v4, v20
    v_add_f32 v5, v5, v21
    v_add_f32 v6, v6, v22
    v_add_f32 v7, v7, v23
    v_add_f32 v8, v8, v24
    v_add_f32 v9, v9, v25
    v_add_f32 v10, v10, v26
    v_add_f32 v11, v11, v27
    v_add_f32 v12, v12, v28
    v_add_f32 v13, v13, v29
    v_add_f32 v14, v14, v30
    v_add_f32 v15, v15, v31
    v_add_f32 v16, v16, v32
    v_add_f32 v17, v17, v33
    v_add_f32 v18, v18, v34
    v_add_f32 v19, v19, v35
L_fnx_146:
    s_bitcmp1_b32 s35, 6
    s_cbranch_scc1 L_ffl_147
    v_cvt_f32_u32_sdwa v20, v44 dst_sel:DWORD dst_unused:UNUSED_PAD src0_sel:WORD_0
    v_cvt_f32_u32_sdwa v21, v44 dst_sel:DWORD dst_unused:UNUSED_PAD src0_sel:WORD_1
    v_cvt_f32_u32_sdwa v22, v45 dst_sel:DWORD dst_unused:UNUSED_PAD src0_sel:WORD_0
    v_cvt_f32_u32_sdwa v23, v45 dst_sel:DWORD dst_unused:UNUSED_PAD src0_sel:WORD_1
    v_cvt_f32_u32_sdwa v24, v46 dst_sel:DWORD dst_unused:UNUSED_PAD src0_sel:WORD_0
    v_cvt_f32_u32_sdwa v25, v46 dst_sel:DWORD dst_unused:UNUSED_PAD src0_sel:WORD_1
    v_cvt_f32_u32_sdwa v26, v47 dst_sel:DWORD dst_unused:UNUSED_PAD src0_sel:WORD_0
    v_cvt_f32_u32_sdwa v27, v47 dst_sel:DWORD dst_unused:UNUSED_PAD src0_sel:WORD_1
    v_cvt_f32_u32_sdwa v28, v60 dst_sel:DWORD dst_unused:UNUSED_PAD src0_sel:WORD_0
    v_cvt_f32_u32_sdwa v29, v60 dst_sel:DWORD dst_unused:UNUSED_PAD src0_sel:WORD_1
    v_cvt_f32_u32_sdwa v30, v61 dst_sel:DWORD dst_unused:UNUSED_PAD src0_sel:WORD_0
    v_cvt_f32_u32_sdwa v31, v61 dst_sel:DWORD dst_unused:UNUSED_PAD src0_sel:WORD_1
    v_cvt_f32_u32_sdwa v32, v62 dst_sel:DWORD dst_unused:UNUSED_PAD src0_sel:WORD_0
    v_cvt_f32_u32_sdwa v33, v62 dst_sel:DWORD dst_unused:UNUSED_PAD src0_sel:WORD_1
    v_cvt_f32_u32_sdwa v34, v63 dst_sel:DWORD dst_unused:UNUSED_PAD src0_sel:WORD_0
    v_cvt_f32_u32_sdwa v35, v63 dst_sel:DWORD dst_unused:UNUSED_PAD src0_sel:WORD_1
    v_add_f32 v20, 0xc6800000, v20
    v_fmac_f32 v4, s34, v20
    v_add_f32 v21, 0xc6800000, v21
    v_fmac_f32 v5, s34, v21
    v_add_f32 v22, 0xc6800000, v22
    v_fmac_f32 v6, s34, v22
    v_add_f32 v23, 0xc6800000, v23
    v_fmac_f32 v7, s34, v23
    v_add_f32 v24, 0xc6800000, v24
    v_fmac_f32 v8, s34, v24
    v_add_f32 v25, 0xc6800000, v25
    v_fmac_f32 v9, s34, v25
    v_add_f32 v26, 0xc6800000, v26
    v_fmac_f32 v10, s34, v26
    v_add_f32 v27, 0xc6800000, v27
    v_fmac_f32 v11, s34, v27
    v_add_f32 v28, 0xc6800000, v28
    v_fmac_f32 v12, s34, v28
    v_add_f32 v29, 0xc6800000, v29
    v_fmac_f32 v13, s34, v29
    v_add_f32 v30, 0xc6800000, v30
    v_fmac_f32 v14, s34, v30
    v_add_f32 v31, 0xc6800000, v31
    v_fmac_f32 v15, s34, v31
    v_add_f32 v32, 0xc6800000, v32
    v_fmac_f32 v16, s34, v32
    v_add_f32 v33, 0xc6800000, v33
    v_fmac_f32 v17, s34, v33
    v_add_f32 v34, 0xc6800000, v34
    v_fmac_f32 v18, s34, v34
    v_add_f32 v35, 0xc6800000, v35
    v_fmac_f32 v19, s34, v35
    s_branch L_fnx_148
L_ffl_147:
    s_mov_b32 s3, 51200000
    buffer_load_dwordx4 v[20:23], v82, s[84:87], s3 offen offset:0 sc1
    buffer_load_dwordx4 v[24:27], v82, s[84:87], s3 offen offset:16 sc1
    buffer_load_dwordx4 v[28:31], v83, s[84:87], s3 offen offset:0 sc1
    buffer_load_dwordx4 v[32:35], v83, s[84:87], s3 offen offset:16 sc1
    s_waitcnt vmcnt(0)
    v_add_f32 v4, v4, v20
    v_add_f32 v5, v5, v21
    v_add_f32 v6, v6, v22
    v_add_f32 v7, v7, v23
    v_add_f32 v8, v8, v24
    v_add_f32 v9, v9, v25
    v_add_f32 v10, v10, v26
    v_add_f32 v11, v11, v27
    v_add_f32 v12, v12, v28
    v_add_f32 v13, v13, v29
    v_add_f32 v14, v14, v30
    v_add_f32 v15, v15, v31
    v_add_f32 v16, v16, v32
    v_add_f32 v17, v17, v33
    v_add_f32 v18, v18, v34
    v_add_f32 v19, v19, v35
L_fnx_148:
    s_bitcmp1_b32 s35, 7
    s_cbranch_scc1 L_ffl_149
    v_cvt_f32_u32_sdwa v20, v48 dst_sel:DWORD dst_unused:UNUSED_PAD src0_sel:WORD_0
    v_cvt_f32_u32_sdwa v21, v48 dst_sel:DWORD dst_unused:UNUSED_PAD src0_sel:WORD_1
    v_cvt_f32_u32_sdwa v22, v49 dst_sel:DWORD dst_unused:UNUSED_PAD src0_sel:WORD_0
    v_cvt_f32_u32_sdwa v23, v49 dst_sel:DWORD dst_unused:UNUSED_PAD src0_sel:WORD_1
    v_cvt_f32_u32_sdwa v24, v50 dst_sel:DWORD dst_unused:UNUSED_PAD src0_sel:WORD_0
    v_cvt_f32_u32_sdwa v25, v50 dst_sel:DWORD dst_unused:UNUSED_PAD src0_sel:WORD_1
    v_cvt_f32_u32_sdwa v26, v51 dst_sel:DWORD dst_unused:UNUSED_PAD src0_sel:WORD_0
    v_cvt_f32_u32_sdwa v27, v51 dst_sel:DWORD dst_unused:UNUSED_PAD src0_sel:WORD_1
    v_cvt_f32_u32_sdwa v28, v64 dst_sel:DWORD dst_unused:UNUSED_PAD src0_sel:WORD_0
    v_cvt_f32_u32_sdwa v29, v64 dst_sel:DWORD dst_unused:UNUSED_PAD src0_sel:WORD_1
    v_cvt_f32_u32_sdwa v30, v65 dst_sel:DWORD dst_unused:UNUSED_PAD src0_sel:WORD_0
    v_cvt_f32_u32_sdwa v31, v65 dst_sel:DWORD dst_unused:UNUSED_PAD src0_sel:WORD_1
    v_cvt_f32_u32_sdwa v32, v66 dst_sel:DWORD dst_unused:UNUSED_PAD src0_sel:WORD_0
    v_cvt_f32_u32_sdwa v33, v66 dst_sel:DWORD dst_unused:UNUSED_PAD src0_sel:WORD_1
    v_cvt_f32_u32_sdwa v34, v67 dst_sel:DWORD dst_unused:UNUSED_PAD src0_sel:WORD_0
    v_cvt_f32_u32_sdwa v35, v67 dst_sel:DWORD dst_unused:UNUSED_PAD src0_sel:WORD_1
    v_add_f32 v20, 0xc6800000, v20
    v_fmac_f32 v4, s34, v20
    v_add_f32 v21, 0xc6800000, v21
    v_fmac_f32 v5, s34, v21
    v_add_f32 v22, 0xc6800000, v22
    v_fmac_f32 v6, s34, v22
    v_add_f32 v23, 0xc6800000, v23
    v_fmac_f32 v7, s34, v23
    v_add_f32 v24, 0xc6800000, v24
    v_fmac_f32 v8, s34, v24
    v_add_f32 v25, 0xc6800000, v25
    v_fmac_f32 v9, s34, v25
    v_add_f32 v26, 0xc6800000, v26
    v_fmac_f32 v10, s34, v26
    v_add_f32 v27, 0xc6800000, v27
    v_fmac_f32 v11, s34, v27
    v_add_f32 v28, 0xc6800000, v28
    v_fmac_f32 v12, s34, v28
    v_add_f32 v29, 0xc6800000, v29
    v_fmac_f32 v13, s34, v29
    v_add_f32 v30, 0xc6800000, v30
    v_fmac_f32 v14, s34, v30
    v_add_f32 v31, 0xc6800000, v31
    v_fmac_f32 v15, s34, v31
    v_add_f32 v32, 0xc6800000, v32
    v_fmac_f32 v16, s34, v32
    v_add_f32 v33, 0xc6800000, v33
    v_fmac_f32 v17, s34, v33
    v_add_f32 v34, 0xc6800000, v34
    v_fmac_f32 v18, s34, v34
    v_add_f32 v35, 0xc6800000, v35
    v_fmac_f32 v19, s34, v35
    s_branch L_fnx_150
L_ffl_149:
    s_mov_b32 s3, 64000000
    buffer_load_dwordx4 v[20:23], v82, s[84:87], s3 offen offset:0 sc1
    buffer_load_dwordx4 v[24:27], v82, s[84:87], s3 offen offset:16 sc1
    buffer_load_dwordx4 v[28:31], v83, s[84:87], s3 offen offset:0 sc1
    buffer_load_dwordx4 v[32:35], v83, s[84:87], s3 offen offset:16 sc1
    s_waitcnt vmcnt(0)
    v_add_f32 v4, v4, v20
    v_add_f32 v5, v5, v21
    v_add_f32 v6, v6, v22
    v_add_f32 v7, v7, v23
    v_add_f32 v8, v8, v24
    v_add_f32 v9, v9, v25
    v_add_f32 v10, v10, v26
    v_add_f32 v11, v11, v27
    v_add_f32 v12, v12, v28
    v_add_f32 v13, v13, v29
    v_add_f32 v14, v14, v30
    v_add_f32 v15, v15, v31
    v_add_f32 v16, v16, v32
    v_add_f32 v17, v17, v33
    v_add_f32 v18, v18, v34
    v_add_f32 v19, v19, v35
L_fnx_150:
    s_branch L_fbk_142
L_p2slow_48:
    s_waitcnt vmcnt(0) lgkmcnt(0)
    s_mov_b32 s51, 0
    s_movk_i32 s43, 6250
L_sweep_151:
    s_barrier

    v_mov_b32 v28, 0x0
    v_mov_b32 v29, 0x0
    v_mov_b32 v30, 0x0
    v_mov_b32 v31, 0x0
    v_add_u32 v32, 50000, v3
    v_add_u32 v33, 65536, v32

    ds_write_b128 v32, v[28:31] offset:0
    ds_write_b128 v32, v[28:31] offset:16384
    ds_write_b128 v32, v[28:31] offset:32768
    ds_write_b128 v32, v[28:31] offset:49152
    ds_write_b128 v33, v[28:31] offset:0
    ds_write_b128 v33, v[28:31] offset:16384
    v_cmp_gt_u32 vcc, 971, v0
    s_mov_b64 exec, vcc
    ds_write_b128 v33, v[28:31] offset:32768
    s_mov_b64 exec, -1
    s_mov_b32 s3, 32768
    s_load_dword s40, s[6:7], s3
    s_waitcnt lgkmcnt(0)
    s_barrier
    s_cmp_lg_u32 s40, 0
    s_cbranch_scc1 L_raw_156
    s_sub_u32 s38, s4, 8
L_sbatch_152:
    s_lshl_b32 s52, s36, 5
    s_add_u32 s52, s52, s38
    s_lshr_b32 s52, s52, 1
    s_lshl_b32 s52, s52, 2
    s_load_dword s40, s[46:47], s52
    s_mul_i32 s50, s38, 200000
    s_and_b32 s3, s38, 1
    s_lshl_b32 s3, s3, 4
    s_or_b32 s3, s3, 0x100000
    s_waitcnt lgkmcnt(0)
    s_bfe_u32 s40, s40, s3

    s_min_u32 s40, s40, 6524
    s_lshl_b32 s52, s38, 6
    s_add_u32 s52, s52, s36
    s_mul_i32 s52, s52, 32764
    s_and_b32 s52, s52, 0xffffff80
    s_add_u32 s20, s44, s52
    s_addc_u32 s21, s45, 0
    s_mul_i32 s52, s40, 5
    s_add_u32 s52, s52, 3
    s_and_b32 s22, s52, -4

    s_lshr_b32 s55, s39, 2
    s_add_u32 s55, s55, 0
    v_and_b32 v36, 63, v0
    v_add_u32 v36, s55, v36
L_left_157:
    s_cmp_ge_u32 s55, s40
    s_cbranch_scc1 L_leftend_158
    v_mul_u32_u24 v37, 5, v36
    buffer_load_dword v38, v37, s[20:23], 0 offen offset:1
    buffer_load_ubyte v39, v37, s[20:23], 0 offen
    s_waitcnt vmcnt(0)

    v_perm_b32 v37, v39, v38, s24
    v_lshrrev_b32 v42, 30, v38
    v_and_b32 v37, 0x1fff, v37
    v_mul_u32_u24 v42, 6250, v42
    v_add_lshl_u32 v37, v37, v42, 3

    buffer_load_dwordx2 v[40:41], v37, s[8:11], s50 offen
    v_cmp_gt_u32 vcc, s40, v36
    s_waitcnt vmcnt(0)

    v_bfe_u32 v44, v38, 16, 14
    v_subrev_u32 v44, s51, v44
    v_cmp_gt_u32 s[64:65], s43, v44
    s_and_b64 exec, vcc, s[64:65]
    v_lshlrev_b32 v45, 16, v38
    v_cmpx_ne_u32 vcc, 0, v45
    v_lshlrev_b32 v44, 4, v44
    v_bfe_i32 v38, v38, 0, 16
    v_cvt_f32_i32 v38, v38
    v_mul_f32 v38, 0x38004020, v38
    v_lshlrev_b32 v45, 16, v40
    v_and_b32 v46, s32, v40
    v_lshlrev_b32 v47, 16, v41
    v_and_b32 v48, s32, v41

    v_mul_f32 v45, v45, v38
    ds_add_f32 v44, v45 offset:50000
    v_mul_f32 v46, v46, v38
    ds_add_f32 v44, v46 offset:50004
    v_mul_f32 v47, v47, v38
    ds_add_f32 v44, v47 offset:50008
    v_mul_f32 v48, v48, v38
    ds_add_f32 v44, v48 offset:50012
    s_mov_b64 exec, -1
    v_add_u32 v36, 128, v36
    s_add_u32 s55, s55, 128
    s_branch L_left_157
L_leftend_158:

    s_add_u32 s38, s38, 1
    s_cmp_lt_u32 s38, s4
    s_cbranch_scc1 L_sbatch_152
    s_branch L_swend_154

L_raw_156:
    s_load_dwordx2 s[68:69], s[0:1], 8
    s_load_dwordx2 s[72:73], s[0:1], 16
    s_load_dwordx2 s[76:77], s[0:1], 32
    s_load_dwordx2 s[80:81], s[0:1], 48
    s_mov_b32 s70, 204800000
    s_mov_b32 s71, 0x20000
    s_mov_b32 s74, 204800000
    s_mov_b32 s75, 0x20000
    s_mov_b32 s78, 102400000
    s_mov_b32 s79, 0x20000
    s_waitcnt lgkmcnt(0)
    s_load_dword s82, s[80:81], 0
    s_mul_i32 s83, s36, 12500
    s_add_u32 s83, s83, s51
    s_mul_i32 s84, s37, 200000
    s_mov_b32 s85, 200000
    s_mov_b32 s38, 0
    v_lshlrev_b32 v44, 5, v0
    v_mov_b32 v45, 0.15915494
    s_waitcnt lgkmcnt(0)
    s_lshl_b32 s82, s82, 16
    v_mul_f32 v45, s82, v45
L_rawl_153:
    s_lshr_b32 s3, s38, 1
    buffer_load_dwordx4 v[46:49], v44, s[72:75], s38 offen
    buffer_load_dwordx4 v[50:53], v44, s[72:75], s38 offen offset:16
    buffer_load_dwordx4 v[54:57], v44, s[68:71], s38 offen
    buffer_load_dwordx4 v[58:61], v44, s[68:71], s38 offen offset:16
    buffer_load_dwordx4 v[62:65], v3, s[76:79], s3 offen
    s_waitcnt vmcnt(1)

    v_subrev_u32 v46, s83, v46
    v_subrev_u32 v82, s84, v54
    v_cmp_gt_u32 vcc, s43, v46
    v_cmp_gt_u32 s[64:65], s85, v82
    v_lshlrev_b32 v54, 3, v54
    s_nand_b64 exec, vcc, s[64:65]
    v_bfrev_b32 v54, 1
    s_mov_b64 exec, -1
    buffer_load_dwordx2 v[66:67], v54, s[8:11], 0 offen

    v_subrev_u32 v47, s83, v47
    v_subrev_u32 v82, s84, v55
    v_cmp_gt_u32 vcc, s43, v47
    v_cmp_gt_u32 s[64:65], s85, v82
    v_lshlrev_b32 v55, 3, v55
    s_nand_b64 exec, vcc, s[64:65]
    v_bfrev_b32 v55, 1
    s_mov_b64 exec, -1
    buffer_load_dwordx2 v[68:69], v55, s[8:11], 0 offen

    v_subrev_u32 v48, s83, v48
    v_subrev_u32 v82, s84, v56
    v_cmp_gt_u32 vcc, s43, v48
    v_cmp_gt_u32 s[64:65], s85, v82
    v_lshlrev_b32 v56, 3, v56
    s_nand_b64 exec, vcc, s[64:65]
    v_bfrev_b32 v56, 1
    s_mov_b64 exec, -1
    buffer_load_dwordx2 v[70:71], v56, s[8:11], 0 offen

    v_subrev_u32 v49, s83, v49
    v_subrev_u32 v82, s84, v57
    v_cmp_gt_u32 vcc, s43, v49
    v_cmp_gt_u32 s[64:65], s85, v82
    v_lshlrev_b32 v57, 3, v57
    s_nand_b64 exec, vcc, s[64:65]
    v_bfrev_b32 v57, 1
    s_mov_b64 exec, -1
    buffer_load_dwordx2 v[72:73], v57, s[8:11], 0 offen

    v_subrev_u32 v50, s83, v50
    v_subrev_u32 v82, s84, v58
    v_cmp_gt_u32 vcc, s43, v50
    v_cmp_gt_u32 s[64:65], s85, v82
    v_lshlrev_b32 v58, 3, v58
    s_nand_b64 exec, vcc, s[64:65]
    v_bfrev_b32 v58, 1
    s_mov_b64 exec, -1
    buffer_load_dwordx2 v[74:75], v58, s[8:11], 0 offen

    v_subrev_u32 v51, s83, v51
    v_subrev_u32 v82, s84, v59
    v_cmp_gt_u32 vcc, s43, v51
    v_cmp_gt_u32 s[64:65], s85, v82
    v_lshlrev_b32 v59, 3, v59
    s_nand_b64 exec, vcc, s[64:65]
    v_bfrev_b32 v59, 1
    s_mov_b64 exec, -1
    buffer_load_dwordx2 v[76:77], v59, s[8:11], 0 offen

    v_subrev_u32 v52, s83, v52
    v_subrev_u32 v82, s84, v60
    v_cmp_gt_u32 vcc, s43, v52
    v_cmp_gt_u32 s[64:65], s85, v82
    v_lshlrev_b32 v60, 3, v60
    s_nand_b64 exec, vcc, s[64:65]
    v_bfrev_b32 v60, 1
    s_mov_b64 exec, -1
    buffer_load_dwordx2 v[78:79], v60, s[8:11], 0 offen

    v_subrev_u32 v53, s83, v53
    v_subrev_u32 v82, s84, v61
    v_cmp_gt_u32 vcc, s43, v53
    v_cmp_gt_u32 s[64:65], s85, v82
    v_lshlrev_b32 v61, 3, v61
    s_nand_b64 exec, vcc, s[64:65]
    v_bfrev_b32 v61, 1
    s_mov_b64 exec, -1
    buffer_load_dwordx2 v[80:81], v61, s[8:11], 0 offen

    s_waitcnt vmcnt(0)
    v_cmp_le_i32 vcc, 0, v54
    s_mov_b64 exec, vcc
    s_cbranch_execz L_rsk_159
    v_lshlrev_b32 v82, 16, v62
    v_mul_f32 v82, v82, v45
    v_fract_f32 v82, v82
    v_cos_f32 v82, v82
    v_lshlrev_b32 v46, 4, v46
    v_lshlrev_b32 v83, 16, v66
    v_and_b32 v84, s32, v66
    v_lshlrev_b32 v85, 16, v67
    v_and_b32 v86, s32, v67

    v_mul_f32 v83, v83, v82
    ds_add_f32 v46, v83 offset:50000
    v_mul_f32 v84, v84, v82
    ds_add_f32 v46, v84 offset:50004
    v_mul_f32 v85, v85, v82
    ds_add_f32 v46, v85 offset:50008
    v_mul_f32 v86, v86, v82
    ds_add_f32 v46, v86 offset:50012
L_rsk_159:
    s_mov_b64 exec, -1
    v_cmp_le_i32 vcc, 0, v55
    s_mov_b64 exec, vcc
    s_cbranch_execz L_rsk_160
    v_and_b32 v82, s32, v62
    v_mul_f32 v82, v82, v45
    v_fract_f32 v82, v82
    v_cos_f32 v82, v82
    v_lshlrev_b32 v47, 4, v47
    v_lshlrev_b32 v83, 16, v68
    v_and_b32 v84, s32, v68
    v_lshlrev_b32 v85, 16, v69
    v_and_b32 v86, s32, v69

    v_mul_f32 v83, v83, v82
    ds_add_f32 v47, v83 offset:50000
    v_mul_f32 v84, v84, v82
    ds_add_f32 v47, v84 offset:50004
    v_mul_f32 v85, v85, v82
    ds_add_f32 v47, v85 offset:50008
    v_mul_f32 v86, v86, v82
    ds_add_f32 v47, v86 offset:50012
L_rsk_160:
    s_mov_b64 exec, -1
    v_cmp_le_i32 vcc, 0, v56
    s_mov_b64 exec, vcc
    s_cbranch_execz L_rsk_161
    v_lshlrev_b32 v82, 16, v63
    v_mul_f32 v82, v82, v45
    v_fract_f32 v82, v82
    v_cos_f32 v82, v82
    v_lshlrev_b32 v48, 4, v48
    v_lshlrev_b32 v83, 16, v70
    v_and_b32 v84, s32, v70
    v_lshlrev_b32 v85, 16, v71
    v_and_b32 v86, s32, v71

    v_mul_f32 v83, v83, v82
    ds_add_f32 v48, v83 offset:50000
    v_mul_f32 v84, v84, v82
    ds_add_f32 v48, v84 offset:50004
    v_mul_f32 v85, v85, v82
    ds_add_f32 v48, v85 offset:50008
    v_mul_f32 v86, v86, v82
    ds_add_f32 v48, v86 offset:50012
L_rsk_161:
    s_mov_b64 exec, -1
    v_cmp_le_i32 vcc, 0, v57
    s_mov_b64 exec, vcc
    s_cbranch_execz L_rsk_162
    v_and_b32 v82, s32, v63
    v_mul_f32 v82, v82, v45
    v_fract_f32 v82, v82
    v_cos_f32 v82, v82
    v_lshlrev_b32 v49, 4, v49
    v_lshlrev_b32 v83, 16, v72
    v_and_b32 v84, s32, v72
    v_lshlrev_b32 v85, 16, v73
    v_and_b32 v86, s32, v73

    v_mul_f32 v83, v83, v82
    ds_add_f32 v49, v83 offset:50000
    v_mul_f32 v84, v84, v82
    ds_add_f32 v49, v84 offset:50004
    v_mul_f32 v85, v85, v82
    ds_add_f32 v49, v85 offset:50008
    v_mul_f32 v86, v86, v82
    ds_add_f32 v49, v86 offset:50012
L_rsk_162:
    s_mov_b64 exec, -1
    v_cmp_le_i32 vcc, 0, v58
    s_mov_b64 exec, vcc
    s_cbranch_execz L_rsk_163
    v_lshlrev_b32 v82, 16, v64
    v_mul_f32 v82, v82, v45
    v_fract_f32 v82, v82
    v_cos_f32 v82, v82
    v_lshlrev_b32 v50, 4, v50
    v_lshlrev_b32 v83, 16, v74
    v_and_b32 v84, s32, v74
    v_lshlrev_b32 v85, 16, v75
    v_and_b32 v86, s32, v75

    v_mul_f32 v83, v83, v82
    ds_add_f32 v50, v83 offset:50000
    v_mul_f32 v84, v84, v82
    ds_add_f32 v50, v84 offset:50004
    v_mul_f32 v85, v85, v82
    ds_add_f32 v50, v85 offset:50008
    v_mul_f32 v86, v86, v82
    ds_add_f32 v50, v86 offset:50012
L_rsk_163:
    s_mov_b64 exec, -1
    v_cmp_le_i32 vcc, 0, v59
    s_mov_b64 exec, vcc
    s_cbranch_execz L_rsk_164
    v_and_b32 v82, s32, v64
    v_mul_f32 v82, v82, v45
    v_fract_f32 v82, v82
    v_cos_f32 v82, v82
    v_lshlrev_b32 v51, 4, v51
    v_lshlrev_b32 v83, 16, v76
    v_and_b32 v84, s32, v76
    v_lshlrev_b32 v85, 16, v77
    v_and_b32 v86, s32, v77

    v_mul_f32 v83, v83, v82
    ds_add_f32 v51, v83 offset:50000
    v_mul_f32 v84, v84, v82
    ds_add_f32 v51, v84 offset:50004
    v_mul_f32 v85, v85, v82
    ds_add_f32 v51, v85 offset:50008
    v_mul_f32 v86, v86, v82
    ds_add_f32 v51, v86 offset:50012
L_rsk_164:
    s_mov_b64 exec, -1
    v_cmp_le_i32 vcc, 0, v60
    s_mov_b64 exec, vcc
    s_cbranch_execz L_rsk_165
    v_lshlrev_b32 v82, 16, v65
    v_mul_f32 v82, v82, v45
    v_fract_f32 v82, v82
    v_cos_f32 v82, v82
    v_lshlrev_b32 v52, 4, v52
    v_lshlrev_b32 v83, 16, v78
    v_and_b32 v84, s32, v78
    v_lshlrev_b32 v85, 16, v79
    v_and_b32 v86, s32, v79

    v_mul_f32 v83, v83, v82
    ds_add_f32 v52, v83 offset:50000
    v_mul_f32 v84, v84, v82
    ds_add_f32 v52, v84 offset:50004
    v_mul_f32 v85, v85, v82
    ds_add_f32 v52, v85 offset:50008
    v_mul_f32 v86, v86, v82
    ds_add_f32 v52, v86 offset:50012
L_rsk_165:
    s_mov_b64 exec, -1
    v_cmp_le_i32 vcc, 0, v61
    s_mov_b64 exec, vcc
    s_cbranch_execz L_rsk_166
    v_and_b32 v82, s32, v65
    v_mul_f32 v82, v82, v45
    v_fract_f32 v82, v82
    v_cos_f32 v82, v82
    v_lshlrev_b32 v53, 4, v53
    v_lshlrev_b32 v83, 16, v80
    v_and_b32 v84, s32, v80
    v_lshlrev_b32 v85, 16, v81
    v_and_b32 v86, s32, v81

    v_mul_f32 v83, v83, v82
    ds_add_f32 v53, v83 offset:50000
    v_mul_f32 v84, v84, v82
    ds_add_f32 v53, v84 offset:50004
    v_mul_f32 v85, v85, v82
    ds_add_f32 v53, v85 offset:50008
    v_mul_f32 v86, v86, v82
    ds_add_f32 v53, v86 offset:50012
L_rsk_166:
    s_mov_b64 exec, -1
    s_add_u32 s38, s38, 32768
    s_cmp_lt_u32 s38, 204800000
    s_cbranch_scc1 L_rawl_153
L_swend_154:
    s_waitcnt lgkmcnt(0)
    s_barrier
    s_mul_i32 s3, s37, 800000
    s_mul_i32 s5, s36, 12500
    s_add_u32 s3, s3, s5
    s_add_u32 s3, s3, s51
    s_lshl_b32 s3, s3, 4
    s_add_u32 s3, s3, 34496512

    s_add_u32 s20, s6, s3
    s_addc_u32 s21, s7, 0
    s_mov_b32 s22, 100000
    s_mov_b32 s23, 0x20000
    v_mov_b32 v36, v3
    s_mov_b32 s38, 0
L_wl_155:
    v_min_u32 v37, 100000, v36
    ds_read_b128 v[28:31], v37 offset:50000
    s_waitcnt lgkmcnt(0)
    buffer_store_dwordx4 v[28:31], v36, s[20:23], 0 offen sc1
    s_waitcnt vmcnt(0)
    v_add_u32 v36, 16384, v36
    s_add_u32 s38, s38, 1024
    s_cmp_lt_u32 s38, 6250
    s_cbranch_scc1 L_wl_155
    s_add_u32 s51, s51, 6250
    s_cmp_lt_u32 s51, 12500
    s_cbranch_scc1 L_sweep_151
    s_lshl_b32 s33, 16, s37
    s_add_u32 s33, s33, 1
    s_branch L_fin_118

.section .rodata,"a"
.p2align 6
.amdhsa_kernel g1_kernel
  .amdhsa_next_free_vgpr 128
  .amdhsa_next_free_sgpr 102
  .amdhsa_accum_offset 128
  .amdhsa_group_segment_fixed_size 0
  .amdhsa_kernarg_size 112
  .amdhsa_user_sgpr_count 2
  .amdhsa_user_sgpr_kernarg_segment_ptr 1
  .amdhsa_system_sgpr_workgroup_id_x 1
  .amdhsa_float_denorm_mode_32 3
.end_amdhsa_kernel
.p2align 6
.amdhsa_kernel standalone__molecular_angular_gemnet__graph_kernel
  .amdhsa_next_free_vgpr 128
  .amdhsa_next_free_sgpr 102
  .amdhsa_accum_offset 128
  .amdhsa_group_segment_fixed_size 0
  .amdhsa_kernarg_size 112
  .amdhsa_user_sgpr_count 2
  .amdhsa_user_sgpr_kernarg_segment_ptr 1
  .amdhsa_system_sgpr_workgroup_id_x 1
  .amdhsa_float_denorm_mode_32 3
.end_amdhsa_kernel
```

```asm
; @launch kernel=g1_kernel grid=(256,1,1) block=(1024,1,1) lds=163840
; @launch kernel=standalone__molecular_angular_gemnet__graph_kernel grid=(256,1,1) block=(1024,1,1) lds=163840
.amdgcn_target "amdgcn-amd-amdhsa--gfx950"
.text
.globl g1_kernel
.p2align 8
.type g1_kernel,@function
g1_kernel:
    s_cmp_ge_u32 s2, 256
    s_cbranch_scc1 L_p1done_1
    s_load_dwordx4 s[80:83], s[0:1], 8
    s_load_dwordx2 s[84:85], s[0:1], 32
    s_load_dwordx2 s[86:87], s[0:1], 48
    s_load_dwordx4 s[4:7], s[0:1], 96
    s_load_dwordx2 s[78:79], s[0:1], 0
    v_lshlrev_b32 v1, 4, v0
    v_lshlrev_b32 v2, 3, v0
    v_lshlrev_b32 v98, 20, v0
    v_mov_b32 v108, 24576
    v_mov_b32 v110, 0
    v_mov_b32 v111, 0
    ds_write_b64 v2, v[110:111]
    s_mov_b64 exec, 1
    ds_write_b32 v108, v110
    s_mov_b64 exec, -1
    s_waitcnt lgkmcnt(0)
    s_load_dword s88, s[86:87], 0

    s_mov_b32 s96, s4
    s_mov_b32 s97, s5
    s_mov_b32 s98, 256
    s_mov_b32 s99, 0x20000
    v_readfirstlane_b32 s74, v0
    s_nop 1
    s_or_b32 s74, s74, s2
    s_cbranch_scc1 L_noinit_2

    v_mov_b32 v110, 1
    buffer_atomic_add v110, v98, s[96:99], 0 offen offset:64 sc0
    s_waitcnt vmcnt(0)
    v_readfirstlane_b32 s74, v110
    s_nop 1
    s_cmp_lg_u32 s74, 0
    s_cbranch_scc1 L_zno_4

    s_mov_b32 s92, s6
    s_mov_b32 s93, s7
    s_mov_b32 s94, 32784
    s_mov_b32 s95, 0x20000
    v_mov_b32 v110, 0
    v_mov_b32 v111, 0
    v_mov_b32 v112, 0
    v_mov_b32 v113, 0
L_zl_3:
    buffer_store_dwordx4 v[110:113], v1, s[92:95], s74 offen sc0 sc1
    s_add_u32 s74, s74, 1024
    s_cmp_le_u32 s74, 32768
    s_cbranch_scc1 L_zl_3
    v_mov_b32 v114, 1
    s_waitcnt vmcnt(0)
    buffer_atomic_add v114, v98, s[96:99], 0 offen offset:128
L_zno_4:

L_noinit_2:
    s_barrier
    s_mov_b32 s20, s78
    s_mov_b32 s21, s79
    s_mov_b32 s22, 6400000
    s_mov_b32 s23, 0x20000
    v_lshrrev_b32 v110, 3, v0
    v_and_b32 v111, 7, v0
    v_mul_u32_u24 v110, 49920, v110
    v_lshl_add_u32 v110, v111, 4, v110
    v_and_b32 v111, 63, v0
    v_and_b32 v112, 0x3c0, v0
    v_lshlrev_b32 v111, 2, v111
    v_lshl_or_b32 v111, v112, 4, v111
    v_lshlrev_b32 v100, 2, v0
    s_lshr_b32 s50, s2, 1
    s_and_b32 s53, s2, 1
    s_mul_i32 s3, s50, 50000
    s_mul_i32 s54, s53, 24576
    s_add_u32 s3, s3, s54

    buffer_load_dwordx4 v[56:59], v110, s[20:23], 0 offen
    s_add_u32 s20, s78, s3
    s_addc_u32 s21, s79, 0
    s_mov_b32 s22, 24576
    s_mov_b32 s23, 0x20000
    s_movk_i32 s3, 16384
    buffer_load_dword v116, v111, s[20:23], 0 offen offset:0
    buffer_load_dword v117, v111, s[20:23], 0 offen offset:256
    buffer_load_dword v118, v111, s[20:23], 0 offen offset:512
    buffer_load_dword v119, v111, s[20:23], 0 offen offset:768
    buffer_load_dword v120, v111, s[20:23], s3 offen offset:0
    buffer_load_dword v121, v111, s[20:23], s3 offen offset:256
    buffer_load_dword v122, v111, s[20:23], s3 offen offset:512
    buffer_load_dword v123, v111, s[20:23], s3 offen offset:768
    s_mul_i32 s22, s53, 25424
    s_movk_i32 s3, 24576

    buffer_load_dword v124, v100, s[20:23], s3 offen
    s_mul_i32 s3, s50, 50048
    s_add_u32 s3, s3, s54
    s_add_u32 s54, s3, 2490368

    v_readfirstlane_b32 s74, v0
    s_mov_b32 s55, 0x05040100
    s_nop 0
    s_cmp_lt_u32 s74, 768
    s_cbranch_scc1 L_nogate_5
    s_load_dwordx2 s[92:93], s[0:1], 40
    s_load_dwordx4 s[32:35], s[0:1], 56
    v_mov_b32 v110, 0
    s_waitcnt lgkmcnt(0)
    global_load_dwordx4 v[60:63], v110, s[92:93]

    global_load_dwordx4 v[64:67], v110, s[32:33] offset:0
    global_load_dwordx4 v[80:83], v110, s[34:35] offset:0
    global_load_dwordx4 v[68:71], v110, s[32:33] offset:16
    global_load_dwordx4 v[84:87], v110, s[34:35] offset:16
    global_load_dwordx4 v[72:75], v110, s[32:33] offset:32
    global_load_dwordx4 v[88:91], v110, s[34:35] offset:32
    global_load_dwordx4 v[76:79], v110, s[32:33] offset:48
    global_load_dwordx4 v[92:95], v110, s[34:35] offset:48
    s_lshl_b32 s74, s2, 8
    v_and_b32 v111, 255, v0
    v_add_u32 v111, s74, v111
    v_lshlrev_b32 v112, 16, v111
    v_lshlrev_b32 v111, 5, v111
    s_mov_b32 s75, 0x07060302
    s_waitcnt vmcnt(0)

    v_lshlrev_b32 v44, 16, v60
    v_and_b32 v45, 0xffff0000, v60
    v_lshlrev_b32 v46, 16, v61
    v_and_b32 v47, 0xffff0000, v61
    v_lshlrev_b32 v48, 16, v62
    v_and_b32 v49, 0xffff0000, v62
    v_lshlrev_b32 v50, 16, v63
    v_and_b32 v51, 0xffff0000, v63
    v_sub_f32 v44, v112, v44
    v_sub_f32 v45, v112, v45
    v_sub_f32 v46, v112, v46
    v_sub_f32 v47, v112, v47
    v_sub_f32 v48, v112, v48
    v_sub_f32 v49, v112, v49
    v_sub_f32 v50, v112, v50
    v_sub_f32 v51, v112, v51
    v_cvt_pk_bf16_f32 v44, v44, v45
    v_cvt_pk_bf16_f32 v46, v46, v47
    v_cvt_pk_bf16_f32 v48, v48, v49
    v_cvt_pk_bf16_f32 v50, v50, v51
    v_and_b32 v45, 0xffff0000, v44
    v_lshlrev_b32 v44, 16, v44
    v_and_b32 v47, 0xffff0000, v46
    v_lshlrev_b32 v46, 16, v46
    v_and_b32 v49, 0xffff0000, v48
    v_lshlrev_b32 v48, 16, v48
    v_and_b32 v51, 0xffff0000, v50
    v_lshlrev_b32 v50, 16, v50
    v_mul_f32 v44, v44, v44
    v_mul_f32 v45, v45, v45
    v_mul_f32 v46, v46, v46
    v_mul_f32 v47, v47, v47
    v_mul_f32 v48, v48, v48
    v_mul_f32 v49, v49, v49
    v_mul_f32 v50, v50, v50
    v_mul_f32 v51, v51, v51
    v_cvt_pk_bf16_f32 v44, v44, v45
    v_cvt_pk_bf16_f32 v46, v46, v47
    v_cvt_pk_bf16_f32 v48, v48, v49
    v_cvt_pk_bf16_f32 v50, v50, v51
    v_and_b32 v45, 0xffff0000, v44
    v_lshlrev_b32 v44, 16, v44
    v_and_b32 v47, 0xffff0000, v46
    v_lshlrev_b32 v46, 16, v46
    v_and_b32 v49, 0xffff0000, v48
    v_lshlrev_b32 v48, 16, v48
    v_and_b32 v51, 0xffff0000, v50
    v_lshlrev_b32 v50, 16, v50
    v_mul_f32 v44, 0xc1200000, v44
    v_mul_f32 v45, 0xc1200000, v45
    v_mul_f32 v46, 0xc1200000, v46
    v_mul_f32 v47, 0xc1200000, v47
    v_mul_f32 v48, 0xc1200000, v48
    v_mul_f32 v49, 0xc1200000, v49
    v_mul_f32 v50, 0xc1200000, v50
    v_mul_f32 v51, 0xc1200000, v51
    v_cvt_pk_bf16_f32 v44, v44, v45
    v_cvt_pk_bf16_f32 v46, v46, v47
    v_cvt_pk_bf16_f32 v48, v48, v49
    v_cvt_pk_bf16_f32 v50, v50, v51
    v_and_b32 v45, 0xffff0000, v44
    v_lshlrev_b32 v44, 16, v44
    v_and_b32 v47, 0xffff0000, v46
    v_lshlrev_b32 v46, 16, v46
    v_and_b32 v49, 0xffff0000, v48
    v_lshlrev_b32 v48, 16, v48
    v_and_b32 v51, 0xffff0000, v50
    v_lshlrev_b32 v50, 16, v50
    v_mul_f32 v44, 0x3fb8aa3b, v44
    v_mul_f32 v45, 0x3fb8aa3b, v45
    v_mul_f32 v46, 0x3fb8aa3b, v46
    v_mul_f32 v47, 0x3fb8aa3b, v47
    v_mul_f32 v48, 0x3fb8aa3b, v48
    v_mul_f32 v49, 0x3fb8aa3b, v49
    v_mul_f32 v50, 0x3fb8aa3b, v50
    v_mul_f32 v51, 0x3fb8aa3b, v51
    v_exp_f32 v44, v44
    v_exp_f32 v45, v45
    v_exp_f32 v46, v46
    v_exp_f32 v47, v47
    v_exp_f32 v48, v48
    v_exp_f32 v49, v49
    v_exp_f32 v50, v50
    v_exp_f32 v51, v51
    s_nop 0
    v_cvt_pk_bf16_f32 v44, v44, v45
    v_cvt_pk_bf16_f32 v46, v46, v47
    v_cvt_pk_bf16_f32 v48, v48, v49
    v_cvt_pk_bf16_f32 v50, v50, v51
    v_perm_b32 v113, v66, v64, s55
    v_dot2_f32_bf16 v52, v44, v113, 0

    v_perm_b32 v113, v66, v64, s75
    v_dot2_f32_bf16 v53, v44, v113, 0

    v_perm_b32 v113, v67, v65, s55
    v_dot2_f32_bf16 v54, v44, v113, 0

    v_perm_b32 v113, v67, v65, s75
    v_dot2_f32_bf16 v55, v44, v113, 0

    v_perm_b32 v113, v70, v68, s55
    v_dot2_f32_bf16 v52, v46, v113, v52

    v_perm_b32 v113, v70, v68, s75
    v_dot2_f32_bf16 v53, v46, v113, v53

    v_perm_b32 v113, v71, v69, s55
    v_dot2_f32_bf16 v54, v46, v113, v54

    v_perm_b32 v113, v71, v69, s75
    v_dot2_f32_bf16 v55, v46, v113, v55

    v_perm_b32 v113, v74, v72, s55
    v_dot2_f32_bf16 v52, v48, v113, v52

    v_perm_b32 v113, v74, v72, s75
    v_dot2_f32_bf16 v53, v48, v113, v53

    v_perm_b32 v113, v75, v73, s55
    v_dot2_f32_bf16 v54, v48, v113, v54

    v_perm_b32 v113, v75, v73, s75
    v_dot2_f32_bf16 v55, v48, v113, v55

    v_perm_b32 v113, v78, v76, s55
    v_dot2_f32_bf16 v52, v50, v113, v52

    v_perm_b32 v113, v78, v76, s75
    v_dot2_f32_bf16 v53, v50, v113, v53

    v_perm_b32 v113, v79, v77, s55
    v_dot2_f32_bf16 v54, v50, v113, v54

    v_perm_b32 v113, v79, v77, s75
    v_dot2_f32_bf16 v55, v50, v113, v55

    v_perm_b32 v113, v82, v80, s55
    v_dot2_f32_bf16 v60, v44, v113, 0

    v_perm_b32 v113, v82, v80, s75
    v_dot2_f32_bf16 v61, v44, v113, 0

    v_perm_b32 v113, v83, v81, s55
    v_dot2_f32_bf16 v62, v44, v113, 0

    v_perm_b32 v113, v83, v81, s75
    v_dot2_f32_bf16 v63, v44, v113, 0

    v_perm_b32 v113, v86, v84, s55
    v_dot2_f32_bf16 v60, v46, v113, v60

    v_perm_b32 v113, v86, v84, s75
    v_dot2_f32_bf16 v61, v46, v113, v61

    v_perm_b32 v113, v87, v85, s55
    v_dot2_f32_bf16 v62, v46, v113, v62

    v_perm_b32 v113, v87, v85, s75
    v_dot2_f32_bf16 v63, v46, v113, v63

    v_perm_b32 v113, v90, v88, s55
    v_dot2_f32_bf16 v60, v48, v113, v60

    v_perm_b32 v113, v90, v88, s75
    v_dot2_f32_bf16 v61, v48, v113, v61

    v_perm_b32 v113, v91, v89, s55
    v_dot2_f32_bf16 v62, v48, v113, v62

    v_perm_b32 v113, v91, v89, s75
    v_dot2_f32_bf16 v63, v48, v113, v63

    v_perm_b32 v113, v94, v92, s55
    v_dot2_f32_bf16 v60, v50, v113, v60

    v_perm_b32 v113, v94, v92, s75
    v_dot2_f32_bf16 v61, v50, v113, v61

    v_perm_b32 v113, v95, v93, s55
    v_dot2_f32_bf16 v62, v50, v113, v62

    v_perm_b32 v113, v95, v93, s75
    v_dot2_f32_bf16 v63, v50, v113, v63

    s_add_u32 s92, s6, 393216
    s_addc_u32 s93, s7, 0
    s_mov_b32 s94, 2097152
    s_mov_b32 s95, 0x20000
    v_cvt_pk_bf16_f32 v52, v52, v53
    v_cvt_pk_bf16_f32 v53, v54, v55
    buffer_store_dwordx4 v[60:63], v111, s[92:95], 0 offen
    buffer_store_dwordx2 v[52:53], v111, s[92:95], 0 offen offset:16
    s_nop 1
L_nogate_5:

    s_mov_b32 s8, s80
    s_mov_b32 s9, s81
    s_mov_b32 s10, 0
    s_mov_b32 s11, 0x20000
    s_mov_b32 s12, s82
    s_mov_b32 s13, s83
    s_mov_b32 s14, 0
    s_mov_b32 s15, 0x20000
    s_mov_b32 s16, s84
    s_mov_b32 s17, s85
    s_mov_b32 s18, 0
    s_mov_b32 s19, 0x20000
    s_lshr_b32 s74, s2, 1
    s_and_b32 s74, s74, 28
    s_lshr_b32 s86, 0x00102010, s74
    s_lshr_b32 s87, 0x44414241, s74
    s_lshr_b32 s41, 0x43221100, s74
    s_and_b32 s86, s86, 15
    s_and_b32 s87, s87, 15
    s_and_b32 s41, s41, 15
    s_lshr_b32 s74, s2, 6
    s_lshl_b32 s74, s74, 3
    s_and_b32 s75, s2, 7
    s_add_u32 s74, s74, s75
    s_mul_i32 s74, s74, 5
    s_add_u32 s41, s41, s74

    s_mul_i32 s78, s41, 16384
    s_add_u32 s49, s78, 16384
    s_cmp_ge_u32 s41, 3125
    s_cmovk_i32 s49, 0
    s_cmovk_i32 s78, 0
    s_lshl_b32 s10, s49, 2
    s_lshl_b32 s14, s49, 2
    s_lshl_b32 s18, s49, 1
    s_sub_u32 s79, s87, s86
    s_bfm_b32 s85, s79, s86
    s_lshl_b32 s86, s86, 12
    s_lshl_b32 s87, s87, 12
    s_min_u32 s87, s87, 16384

    s_add_u32 s79, s78, 0
    s_bitcmp1_b32 s85, 0
    s_cselect_b32 s79, s79, 0x1ff00000
    s_lshl_b32 s56, s79, 2
    s_lshl_b32 s61, s79, 1

    s_add_u32 s79, s78, 4096
    s_bitcmp1_b32 s85, 1
    s_cselect_b32 s79, s79, 0x1ff00000
    s_lshl_b32 s57, s79, 2
    s_lshl_b32 s62, s79, 1

    s_add_u32 s79, s78, 8192
    s_bitcmp1_b32 s85, 2
    s_cselect_b32 s79, s79, 0x1ff00000
    s_lshl_b32 s58, s79, 2
    s_lshl_b32 s63, s79, 1

    s_add_u32 s79, s78, 12288
    s_bitcmp1_b32 s85, 3
    s_cselect_b32 s79, s79, 0x1ff00000
    s_lshl_b32 s59, s79, 2
    s_lshl_b32 s64, s79, 1

    s_mov_b32 s82, s85
    s_mov_b32 s83, s86
    s_mov_b32 s84, s87
    s_add_u32 s41, s2, 160
    s_mul_i32 s74, s41, 16384
    s_mov_b32 s10, 204800000
    s_mov_b32 s14, 204800000
    s_mov_b32 s18, 102400000

    s_add_u32 s75, s74, 0
    s_lshl_b32 s76, s75, 2
    s_lshl_b32 s75, s75, 1
    s_bitcmp1_b32 s82, 0
    s_cselect_b32 s56, s56, s76
    s_cselect_b32 s61, s61, s75

    s_add_u32 s75, s74, 4096
    s_lshl_b32 s76, s75, 2
    s_lshl_b32 s75, s75, 1
    s_bitcmp1_b32 s82, 1
    s_cselect_b32 s57, s57, s76
    s_cselect_b32 s62, s62, s75

    s_add_u32 s75, s74, 8192
    s_lshl_b32 s76, s75, 2
    s_lshl_b32 s75, s75, 1
    s_bitcmp1_b32 s82, 2
    s_cselect_b32 s58, s58, s76
    s_cselect_b32 s63, s63, s75

    s_add_u32 s75, s74, 12288
    s_lshl_b32 s76, s75, 2
    s_lshl_b32 s75, s75, 1
    s_bitcmp1_b32 s82, 3
    s_cselect_b32 s59, s59, s76
    s_cselect_b32 s64, s64, s75

    buffer_load_dwordx4 v[20:23], v1, s[12:15], s56 offen nt
    buffer_load_dwordx4 v[4:7], v1, s[8:11], s56 offen nt
    buffer_load_dwordx2 v[36:37], v2, s[16:19], s61 offen nt
    buffer_load_dwordx4 v[24:27], v1, s[12:15], s57 offen nt
    buffer_load_dwordx4 v[8:11], v1, s[8:11], s57 offen nt
    buffer_load_dwordx2 v[38:39], v2, s[16:19], s62 offen nt
    buffer_load_dwordx4 v[28:31], v1, s[12:15], s58 offen nt
    buffer_load_dwordx4 v[12:15], v1, s[8:11], s58 offen nt
    buffer_load_dwordx2 v[40:41], v2, s[16:19], s63 offen nt
    buffer_load_dwordx4 v[32:35], v1, s[12:15], s59 offen nt
    buffer_load_dwordx4 v[16:19], v1, s[8:11], s59 offen nt
    buffer_load_dwordx2 v[42:43], v2, s[16:19], s64 offen nt
    s_mov_b32 s86, 0
    s_mov_b32 s87, 4
    s_mul_i32 s78, s41, 16384
    s_add_u32 s49, s78, 16384
    s_cmp_ge_u32 s41, 3125
    s_cmovk_i32 s49, 0
    s_cmovk_i32 s78, 0
    s_lshl_b32 s10, s49, 2
    s_lshl_b32 s14, s49, 2
    s_lshl_b32 s18, s49, 1
    s_sub_u32 s79, s87, s86
    s_bfm_b32 s85, s79, s86
    s_lshl_b32 s86, s86, 12
    s_lshl_b32 s87, s87, 12
    s_min_u32 s87, s87, 16384

    s_add_u32 s79, s78, 0
    s_bitcmp1_b32 s85, 0
    s_cselect_b32 s79, s79, 0x1ff00000
    s_lshl_b32 s56, s79, 2
    s_lshl_b32 s61, s79, 1

    s_add_u32 s79, s78, 4096
    s_bitcmp1_b32 s85, 1
    s_cselect_b32 s79, s79, 0x1ff00000
    s_lshl_b32 s57, s79, 2
    s_lshl_b32 s62, s79, 1

    s_add_u32 s79, s78, 8192
    s_bitcmp1_b32 s85, 2
    s_cselect_b32 s79, s79, 0x1ff00000
    s_lshl_b32 s58, s79, 2
    s_lshl_b32 s63, s79, 1

    s_add_u32 s79, s78, 12288
    s_bitcmp1_b32 s85, 3
    s_cselect_b32 s79, s79, 0x1ff00000
    s_lshl_b32 s59, s79, 2
    s_lshl_b32 s64, s79, 1

    s_getreg_b32 s5, hwreg(HW_REG_XCC_ID)
    s_and_b32 s5, s5, 7
    s_mul_i32 s3, s5, 4096

    s_add_u32 s20, s6, s3
    s_addc_u32 s21, s7, 0
    s_mov_b32 s22, 4096
    s_mov_b32 s23, 0x20000
    s_mul_i32 s3, s5, 67117056
    s_add_u32 s3, s3, 85721088
    s_add_u32 s24, s6, s3
    s_addc_u32 s25, s7, 0
    s_mov_b32 s26, 67117056
    s_mov_b32 s27, 0x20000
    s_add_u32 s36, s6, 32768
    s_addc_u32 s37, s7, 0
    s_mov_b32 s38, 4
    s_mov_b32 s39, 0x20000
    s_mov_b32 s40, 687195
    s_mov_b32 s42, -6250
    s_mov_b32 s43, 1942
    s_mov_b32 s45, 0x06050400
    s_mov_b32 s46, 0x05040c00
    s_mov_b32 s48, 6524
    s_mov_b32 s50, 0
    v_mov_b32 v104, 1
    v_mov_b32 v105, 0x46ff8000
    s_mov_b32 s55, 0x05040100
    v_mul_u32_u24 v106, 5, v0

    v_and_b32 v102, 15, v0
    v_lshrrev_b32 v103, 4, v0
    v_lshl_add_u32 v102, v102, 7, v103
    v_mul_u32_u24 v102, 32764, v102
    v_add_u32 v103, 2096896, v102

    v_and_b32 v102, 0xffffff80, v102
    v_and_b32 v103, 0xffffff80, v103
    s_movk_i32 s3, 1024
    v_cmp_gt_u32 s[66:67], s3, v0
    s_movk_i32 s3, 1024
    v_cmp_gt_u32 s[68:69], s3, v0
    s_waitcnt lgkmcnt(0)
    s_lshl_b32 s88, s88, 16
    v_mov_b32 v110, 0.15915494
    v_mul_f32 v110, s88, v110
    s_mov_b32 s3, 0x7fff7fff
    v_readfirstlane_b32 s44, v110

    s_waitcnt vmcnt(12)
    v_mov_b32 v61, 0
    v_mov_b32 v62, 0
    v_mov_b32 v63, 0
    v_dot2_f32_bf16 v61, v116, v116, v61
    v_dot2_f32_bf16 v61, v117, v117, v61
    v_dot2_f32_bf16 v61, v118, v118, v61
    v_dot2_f32_bf16 v61, v119, v119, v61
    v_dot2_f32_bf16 v61, v120, v120, v61
    v_dot2_f32_bf16 v61, v121, v121, v61
    v_dot2_f32_bf16 v61, v122, v122, v61
    v_dot2_f32_bf16 v61, v123, v123, v61
    v_dot2_f32_bf16 v61, v124, v124, v61
    v_dot2_f32_bf16 v62, v56, v56, v62
    v_dot2_f32_bf16 v62, v57, v57, v62
    v_dot2_f32_bf16 v62, v58, v58, v62
    v_dot2_f32_bf16 v62, v59, v59, v62
    v_and_b32 v60, s3, v116
    v_and_b32 v64, s3, v117
    v_pk_max_u16 v60, v60, v64
    v_and_b32 v64, s3, v118
    v_pk_max_u16 v60, v60, v64
    v_and_b32 v64, s3, v119
    v_pk_max_u16 v60, v60, v64
    v_and_b32 v64, s3, v120
    v_pk_max_u16 v60, v60, v64
    v_and_b32 v64, s3, v121
    v_pk_max_u16 v60, v60, v64
    v_and_b32 v64, s3, v122
    v_pk_max_u16 v60, v60, v64
    v_and_b32 v64, s3, v123
    v_pk_max_u16 v60, v60, v64
    v_and_b32 v64, s3, v124
    v_pk_max_u16 v60, v60, v64
    v_lshrrev_b32 v64, 16, v60
    v_and_b32 v60, 0xffff, v60
    v_max_u32 v60, v60, v64

    s_nop 1
    v_max_u32_dpp v60, v60, v60 row_shr:1 row_mask:0xf bank_mask:0xf
    s_nop 1
    v_max_u32_dpp v60, v60, v60 row_shr:2 row_mask:0xf bank_mask:0xf
    s_nop 1
    v_max_u32_dpp v60, v60, v60 row_shr:4 row_mask:0xf bank_mask:0xf
    s_nop 1
    v_max_u32_dpp v60, v60, v60 row_shr:8 row_mask:0xf bank_mask:0xf
    s_nop 1
    v_max_u32_dpp v60, v60, v60 row_bcast:15 row_mask:0xa bank_mask:0xf
    s_nop 1
    v_max_u32_dpp v60, v60, v60 row_bcast:31 row_mask:0xc bank_mask:0xf
    s_nop 1
    v_add_f32_dpp v61, v61, v61 row_shr:1 row_mask:0xf bank_mask:0xf
    s_nop 1
    v_add_f32_dpp v61, v61, v61 row_shr:2 row_mask:0xf bank_mask:0xf
    s_nop 1
    v_add_f32_dpp v61, v61, v61 row_shr:4 row_mask:0xf bank_mask:0xf
    s_nop 1
    v_add_f32_dpp v61, v61, v61 row_shr:8 row_mask:0xf bank_mask:0xf
    s_nop 1
    v_add_f32_dpp v61, v61, v61 row_bcast:15 row_mask:0xa bank_mask:0xf
    s_nop 1
    v_add_f32_dpp v61, v61, v61 row_bcast:31 row_mask:0xc bank_mask:0xf
    s_nop 1
    v_add_f32_dpp v62, v62, v62 row_shr:1 row_mask:0xf bank_mask:0xf
    s_nop 1
    v_add_f32_dpp v62, v62, v62 row_shr:2 row_mask:0xf bank_mask:0xf
    s_nop 1
    v_add_f32_dpp v62, v62, v62 row_shr:4 row_mask:0xf bank_mask:0xf
    s_nop 1
    v_add_f32_dpp v62, v62, v62 row_shr:8 row_mask:0xf bank_mask:0xf
    s_nop 1
    v_add_f32_dpp v62, v62, v62 row_bcast:15 row_mask:0xa bank_mask:0xf
    s_nop 1
    v_add_f32_dpp v62, v62, v62 row_bcast:31 row_mask:0xc bank_mask:0xf
    v_lshrrev_b32 v64, 6, v0
    v_lshlrev_b32 v64, 4, v64
    s_mov_b32 exec_lo, 0
    s_brev_b32 exec_hi, 1
    ds_write_b128 v64, v[60:63] offset:16384
    s_mov_b64 exec, -1

    s_bitcmp0_b32 s82, 0
    s_cbranch_scc1 L_ska_8
    s_waitcnt vmcnt(9)
    v_mul_hi_u32_u24 v45, s40, v20
    v_mul_hi_u32_u24 v44, s40, v4
    v_mul_hi_u32_u24 v47, s40, v21
    v_mul_hi_u32_u24 v46, s40, v5
    v_mul_hi_u32_u24 v49, s40, v22
    v_mul_hi_u32_u24 v48, s40, v6
    v_mul_hi_u32_u24 v51, s40, v23
    v_mul_hi_u32_u24 v50, s40, v7
    v_and_b32 v45, -2, v45
    v_mad_u32_u24 v4, v44, s43, v4
    v_and_b32 v76, -4, v44
    v_and_b32 v47, -2, v47
    v_mad_u32_u24 v5, v46, s43, v5
    v_and_b32 v77, -4, v46
    v_and_b32 v49, -2, v49
    v_mad_u32_u24 v6, v48, s43, v6
    v_and_b32 v78, -4, v48
    v_and_b32 v51, -2, v51
    v_mad_u32_u24 v7, v50, s43, v7
    v_and_b32 v79, -4, v50
    v_mad_i32_i24 v20, v45, s42, v20
    v_lshl_add_u32 v45, v45, 6, v76
    v_mad_i32_i24 v21, v47, s42, v21
    v_lshl_add_u32 v47, v47, 6, v77
    v_mad_i32_i24 v22, v49, s42, v22
    v_lshl_add_u32 v49, v49, 6, v78
    v_mad_i32_i24 v23, v51, s42, v23
    v_lshl_add_u32 v51, v51, 6, v79
    ds_add_rtn_u32 v76, v45, v104
    ds_add_rtn_u32 v77, v47, v104
    ds_add_rtn_u32 v78, v49, v104
    ds_add_rtn_u32 v79, v51, v104
    v_lshlrev_b32 v110, 16, v36
    v_and_b32 v111, 0xffff0000, v36
    v_lshlrev_b32 v112, 16, v37
    v_and_b32 v113, 0xffff0000, v37
    v_mul_f32 v110, s44, v110
    v_mul_f32 v111, s44, v111
    v_mul_f32 v112, s44, v112
    v_mul_f32 v113, s44, v113
    v_fract_f32 v110, v110
    v_fract_f32 v111, v111
    v_fract_f32 v112, v112
    v_fract_f32 v113, v113
    v_cos_f32 v110, v110
    v_cos_f32 v111, v111
    v_cos_f32 v112, v112
    v_cos_f32 v113, v113
    v_lshl_or_b32 v44, v44, 14, v20
    v_perm_b32 v45, v45, v4, s46
    v_bfe_u32 v4, v4, 8, 5

    v_lshl_or_b32 v46, v46, 14, v21
    v_perm_b32 v47, v47, v5, s46
    v_bfe_u32 v5, v5, 8, 5

    v_lshl_or_b32 v48, v48, 14, v22
    v_perm_b32 v49, v49, v6, s46
    v_bfe_u32 v6, v6, 8, 5

    v_lshl_or_b32 v50, v50, 14, v23
    v_perm_b32 v51, v51, v7, s46
    v_bfe_u32 v7, v7, 8, 5

    v_fmaak_f32 v110, v110, v105, 0x4b400010
    v_fmaak_f32 v111, v111, v105, 0x4b400010
    v_fmaak_f32 v112, v112, v105, 0x4b400010
    v_fmaak_f32 v113, v113, v105, 0x4b400010
    v_sub_u32 v110, v110, v4
    v_sub_u32 v111, v111, v5
    v_sub_u32 v112, v112, v6
    v_sub_u32 v113, v113, v7
    v_bfi_b32 v110, 31, v4, v110
    v_bfi_b32 v111, 31, v5, v111
    v_bfi_b32 v112, 31, v6, v112
    v_bfi_b32 v113, 31, v7, v113
    v_perm_b32 v44, v44, v110, s55
    v_perm_b32 v46, v46, v111, s55
    v_perm_b32 v48, v48, v112, s55
    v_perm_b32 v50, v50, v113, s55
    buffer_load_dwordx4 v[20:23], v1, s[12:15], s56 offen nt
    buffer_load_dwordx4 v[4:7], v1, s[8:11], s56 offen nt
    buffer_load_dwordx2 v[36:37], v2, s[16:19], s61 offen nt
L_bka_9:
    s_bitcmp0_b32 s82, 1
    s_cbranch_scc1 L_ska_10
    s_waitcnt vmcnt(9)
    v_mul_hi_u32_u24 v53, s40, v24
    v_mul_hi_u32_u24 v52, s40, v8
    v_mul_hi_u32_u24 v55, s40, v25
    v_mul_hi_u32_u24 v54, s40, v9
    v_mul_hi_u32_u24 v57, s40, v26
    v_mul_hi_u32_u24 v56, s40, v10
    v_mul_hi_u32_u24 v59, s40, v27
    v_mul_hi_u32_u24 v58, s40, v11
    v_and_b32 v53, -2, v53
    v_mad_u32_u24 v8, v52, s43, v8
    v_and_b32 v80, -4, v52
    v_and_b32 v55, -2, v55
    v_mad_u32_u24 v9, v54, s43, v9
    v_and_b32 v81, -4, v54
    v_and_b32 v57, -2, v57
    v_mad_u32_u24 v10, v56, s43, v10
    v_and_b32 v82, -4, v56
    v_and_b32 v59, -2, v59
    v_mad_u32_u24 v11, v58, s43, v11
    v_and_b32 v83, -4, v58
    v_mad_i32_i24 v24, v53, s42, v24
    v_lshl_add_u32 v53, v53, 6, v80
    v_mad_i32_i24 v25, v55, s42, v25
    v_lshl_add_u32 v55, v55, 6, v81
    v_mad_i32_i24 v26, v57, s42, v26
    v_lshl_add_u32 v57, v57, 6, v82
    v_mad_i32_i24 v27, v59, s42, v27
    v_lshl_add_u32 v59, v59, 6, v83
    ds_add_rtn_u32 v80, v53, v104
    ds_add_rtn_u32 v81, v55, v104
    ds_add_rtn_u32 v82, v57, v104
    ds_add_rtn_u32 v83, v59, v104
    v_lshlrev_b32 v110, 16, v38
    v_and_b32 v111, 0xffff0000, v38
    v_lshlrev_b32 v112, 16, v39
    v_and_b32 v113, 0xffff0000, v39
    v_mul_f32 v110, s44, v110
    v_mul_f32 v111, s44, v111
    v_mul_f32 v112, s44, v112
    v_mul_f32 v113, s44, v113
    v_fract_f32 v110, v110
    v_fract_f32 v111, v111
    v_fract_f32 v112, v112
    v_fract_f32 v113, v113
    v_cos_f32 v110, v110
    v_cos_f32 v111, v111
    v_cos_f32 v112, v112
    v_cos_f32 v113, v113
    v_lshl_or_b32 v52, v52, 14, v24
    v_perm_b32 v53, v53, v8, s46
    v_bfe_u32 v8, v8, 8, 5

    v_lshl_or_b32 v54, v54, 14, v25
    v_perm_b32 v55, v55, v9, s46
    v_bfe_u32 v9, v9, 8, 5

    v_lshl_or_b32 v56, v56, 14, v26
    v_perm_b32 v57, v57, v10, s46
    v_bfe_u32 v10, v10, 8, 5

    v_lshl_or_b32 v58, v58, 14, v27
    v_perm_b32 v59, v59, v11, s46
    v_bfe_u32 v11, v11, 8, 5

    v_fmaak_f32 v110, v110, v105, 0x4b400010
    v_fmaak_f32 v111, v111, v105, 0x4b400010
    v_fmaak_f32 v112, v112, v105, 0x4b400010
    v_fmaak_f32 v113, v113, v105, 0x4b400010
    v_sub_u32 v110, v110, v8
    v_sub_u32 v111, v111, v9
    v_sub_u32 v112, v112, v10
    v_sub_u32 v113, v113, v11
    v_bfi_b32 v110, 31, v8, v110
    v_bfi_b32 v111, 31, v9, v111
    v_bfi_b32 v112, 31, v10, v112
    v_bfi_b32 v113, 31, v11, v113
    v_perm_b32 v52, v52, v110, s55
    v_perm_b32 v54, v54, v111, s55
    v_perm_b32 v56, v56, v112, s55
    v_perm_b32 v58, v58, v113, s55
    buffer_load_dwordx4 v[24:27], v1, s[12:15], s57 offen nt
    buffer_load_dwordx4 v[8:11], v1, s[8:11], s57 offen nt
    buffer_load_dwordx2 v[38:39], v2, s[16:19], s62 offen nt
L_bka_11:
    s_bitcmp0_b32 s82, 2
    s_cbranch_scc1 L_ska_12
    s_waitcnt vmcnt(9)
    v_mul_hi_u32_u24 v61, s40, v28
    v_mul_hi_u32_u24 v60, s40, v12
    v_mul_hi_u32_u24 v63, s40, v29
    v_mul_hi_u32_u24 v62, s40, v13
    v_mul_hi_u32_u24 v65, s40, v30
    v_mul_hi_u32_u24 v64, s40, v14
    v_mul_hi_u32_u24 v67, s40, v31
    v_mul_hi_u32_u24 v66, s40, v15
    v_and_b32 v61, -2, v61
    v_mad_u32_u24 v12, v60, s43, v12
    v_and_b32 v84, -4, v60
    v_and_b32 v63, -2, v63
    v_mad_u32_u24 v13, v62, s43, v13
    v_and_b32 v85, -4, v62
    v_and_b32 v65, -2, v65
    v_mad_u32_u24 v14, v64, s43, v14
    v_and_b32 v86, -4, v64
    v_and_b32 v67, -2, v67
    v_mad_u32_u24 v15, v66, s43, v15
    v_and_b32 v87, -4, v66
    v_mad_i32_i24 v28, v61, s42, v28
    v_lshl_add_u32 v61, v61, 6, v84
    v_mad_i32_i24 v29, v63, s42, v29
    v_lshl_add_u32 v63, v63, 6, v85
    v_mad_i32_i24 v30, v65, s42, v30
    v_lshl_add_u32 v65, v65, 6, v86
    v_mad_i32_i24 v31, v67, s42, v31
    v_lshl_add_u32 v67, v67, 6, v87
    ds_add_rtn_u32 v84, v61, v104
    ds_add_rtn_u32 v85, v63, v104
    ds_add_rtn_u32 v86, v65, v104
    ds_add_rtn_u32 v87, v67, v104
    v_lshlrev_b32 v110, 16, v40
    v_and_b32 v111, 0xffff0000, v40
    v_lshlrev_b32 v112, 16, v41
    v_and_b32 v113, 0xffff0000, v41
    v_mul_f32 v110, s44, v110
    v_mul_f32 v111, s44, v111
    v_mul_f32 v112, s44, v112
    v_mul_f32 v113, s44, v113
    v_fract_f32 v110, v110
    v_fract_f32 v111, v111
    v_fract_f32 v112, v112
    v_fract_f32 v113, v113
    v_cos_f32 v110, v110
    v_cos_f32 v111, v111
    v_cos_f32 v112, v112
    v_cos_f32 v113, v113
    v_lshl_or_b32 v60, v60, 14, v28
    v_perm_b32 v61, v61, v12, s46
    v_bfe_u32 v12, v12, 8, 5

    v_lshl_or_b32 v62, v62, 14, v29
    v_perm_b32 v63, v63, v13, s46
    v_bfe_u32 v13, v13, 8, 5

    v_lshl_or_b32 v64, v64, 14, v30
    v_perm_b32 v65, v65, v14, s46
    v_bfe_u32 v14, v14, 8, 5

    v_lshl_or_b32 v66, v66, 14, v31
    v_perm_b32 v67, v67, v15, s46
    v_bfe_u32 v15, v15, 8, 5

    v_fmaak_f32 v110, v110, v105, 0x4b400010
    v_fmaak_f32 v111, v111, v105, 0x4b400010
    v_fmaak_f32 v112, v112, v105, 0x4b400010
    v_fmaak_f32 v113, v113, v105, 0x4b400010
    v_sub_u32 v110, v110, v12
    v_sub_u32 v111, v111, v13
    v_sub_u32 v112, v112, v14
    v_sub_u32 v113, v113, v15
    v_bfi_b32 v110, 31, v12, v110
    v_bfi_b32 v111, 31, v13, v111
    v_bfi_b32 v112, 31, v14, v112
    v_bfi_b32 v113, 31, v15, v113
    v_perm_b32 v60, v60, v110, s55
    v_perm_b32 v62, v62, v111, s55
    v_perm_b32 v64, v64, v112, s55
    v_perm_b32 v66, v66, v113, s55
    buffer_load_dwordx4 v[28:31], v1, s[12:15], s58 offen nt
    buffer_load_dwordx4 v[12:15], v1, s[8:11], s58 offen nt
    buffer_load_dwordx2 v[40:41], v2, s[16:19], s63 offen nt
L_bka_13:
    s_bitcmp0_b32 s82, 3
    s_cbranch_scc1 L_ska_14
    s_waitcnt vmcnt(9)
    s_mov_b64 exec, s[66:67]
    v_mul_hi_u32_u24 v69, s40, v32
    v_mul_hi_u32_u24 v68, s40, v16
    v_mul_hi_u32_u24 v71, s40, v33
    v_mul_hi_u32_u24 v70, s40, v17
    v_mul_hi_u32_u24 v73, s40, v34
    v_mul_hi_u32_u24 v72, s40, v18
    v_mul_hi_u32_u24 v75, s40, v35
    v_mul_hi_u32_u24 v74, s40, v19
    v_and_b32 v69, -2, v69
    v_mad_u32_u24 v16, v68, s43, v16
    v_and_b32 v88, -4, v68
    v_and_b32 v71, -2, v71
    v_mad_u32_u24 v17, v70, s43, v17
    v_and_b32 v89, -4, v70
    v_and_b32 v73, -2, v73
    v_mad_u32_u24 v18, v72, s43, v18
    v_and_b32 v90, -4, v72
    v_and_b32 v75, -2, v75
    v_mad_u32_u24 v19, v74, s43, v19
    v_and_b32 v91, -4, v74
    v_mad_i32_i24 v32, v69, s42, v32
    v_lshl_add_u32 v69, v69, 6, v88
    v_mad_i32_i24 v33, v71, s42, v33
    v_lshl_add_u32 v71, v71, 6, v89
    v_mad_i32_i24 v34, v73, s42, v34
    v_lshl_add_u32 v73, v73, 6, v90
    v_mad_i32_i24 v35, v75, s42, v35
    v_lshl_add_u32 v75, v75, 6, v91
    ds_add_rtn_u32 v88, v69, v104
    ds_add_rtn_u32 v89, v71, v104
    ds_add_rtn_u32 v90, v73, v104
    ds_add_rtn_u32 v91, v75, v104
    v_lshlrev_b32 v110, 16, v42
    v_and_b32 v111, 0xffff0000, v42
    v_lshlrev_b32 v112, 16, v43
    v_and_b32 v113, 0xffff0000, v43
    v_mul_f32 v110, s44, v110
    v_mul_f32 v111, s44, v111
    v_mul_f32 v112, s44, v112
    v_mul_f32 v113, s44, v113
    v_fract_f32 v110, v110
    v_fract_f32 v111, v111
    v_fract_f32 v112, v112
    v_fract_f32 v113, v113
    v_cos_f32 v110, v110
    v_cos_f32 v111, v111
    v_cos_f32 v112, v112
    v_cos_f32 v113, v113
    v_lshl_or_b32 v68, v68, 14, v32
    v_perm_b32 v69, v69, v16, s46
    v_bfe_u32 v16, v16, 8, 5

    v_lshl_or_b32 v70, v70, 14, v33
    v_perm_b32 v71, v71, v17, s46
    v_bfe_u32 v17, v17, 8, 5

    v_lshl_or_b32 v72, v72, 14, v34
    v_perm_b32 v73, v73, v18, s46
    v_bfe_u32 v18, v18, 8, 5

    v_lshl_or_b32 v74, v74, 14, v35
    v_perm_b32 v75, v75, v19, s46
    v_bfe_u32 v19, v19, 8, 5

    v_fmaak_f32 v110, v110, v105, 0x4b400010
    v_fmaak_f32 v111, v111, v105, 0x4b400010
    v_fmaak_f32 v112, v112, v105, 0x4b400010
    v_fmaak_f32 v113, v113, v105, 0x4b400010
    v_sub_u32 v110, v110, v16
    v_sub_u32 v111, v111, v17
    v_sub_u32 v112, v112, v18
    v_sub_u32 v113, v113, v19
    v_bfi_b32 v110, 31, v16, v110
    v_bfi_b32 v111, 31, v17, v111
    v_bfi_b32 v112, 31, v18, v112
    v_bfi_b32 v113, 31, v19, v113
    v_perm_b32 v68, v68, v110, s55
    v_perm_b32 v70, v70, v111, s55
    v_perm_b32 v72, v72, v112, s55
    v_perm_b32 v74, v74, v113, s55
    s_mov_b64 exec, -1
    buffer_load_dwordx4 v[32:35], v1, s[12:15], s59 offen nt
    buffer_load_dwordx4 v[16:19], v1, s[8:11], s59 offen nt
    buffer_load_dwordx2 v[42:43], v2, s[16:19], s64 offen nt
L_bka_15:
    v_readfirstlane_b32 s74, v0
    s_nop 1
    s_cmp_lg_u32 s74, 0
    s_cbranch_scc1 L_ready_17

    v_mov_b32 v100, 0
    buffer_atomic_add v100, v98, s[96:99], 0 offen offset:128 sc0
    s_waitcnt vmcnt(0)
    v_readfirstlane_b32 s74, v100
    s_nop 1
    s_cmp_lg_u32 s74, 0
    s_cbranch_scc1 L_ready_17

    v_mov_b32 v110, 1
    buffer_atomic_add v110, v98, s[96:99], 0 offen offset:64 sc0
    s_waitcnt vmcnt(0)
    v_readfirstlane_b32 s74, v110
    s_nop 1
    s_cmp_lg_u32 s74, 0
    s_cbranch_scc1 L_zno_19

    s_mov_b32 s92, s6
    s_mov_b32 s93, s7
    s_mov_b32 s94, 32784
    s_mov_b32 s95, 0x20000
    v_mov_b32 v110, 0
    v_mov_b32 v111, 0
    v_mov_b32 v112, 0
    v_mov_b32 v113, 0
L_zl_18:
    buffer_store_dwordx4 v[110:113], v1, s[92:95], s74 offen sc0 sc1
    s_add_u32 s74, s74, 1024
    s_cmp_le_u32 s74, 32768
    s_cbranch_scc1 L_zl_18
    v_mov_b32 v114, 1
    s_waitcnt vmcnt(0)
    buffer_atomic_add v114, v98, s[96:99], 0 offen offset:128
L_zno_19:

L_spin_16:
    v_mov_b32 v100, 0
    buffer_atomic_add v100, v98, s[96:99], 0 offen offset:128 sc0
    s_waitcnt vmcnt(0)
    v_readfirstlane_b32 s74, v100
    s_nop 1
    s_cmp_eq_u32 s74, 0
    s_cbranch_scc1 L_spin_16
L_ready_17:

    s_waitcnt lgkmcnt(0)
    s_barrier

    v_and_b32 v114, 15, v0
    v_lshlrev_b32 v114, 4, v114
    ds_read_b128 v[110:113], v114 offset:16384
    s_waitcnt lgkmcnt(0)

    s_nop 0
    v_max_u32_dpp v110, v110, v110 row_ror:1 row_mask:0xf bank_mask:0xf
    v_add_f32_dpp v111, v111, v111 row_ror:1 row_mask:0xf bank_mask:0xf
    v_add_f32_dpp v112, v112, v112 row_ror:1 row_mask:0xf bank_mask:0xf

    s_nop 0
    v_max_u32_dpp v110, v110, v110 row_ror:2 row_mask:0xf bank_mask:0xf
    v_add_f32_dpp v111, v111, v111 row_ror:2 row_mask:0xf bank_mask:0xf
    v_add_f32_dpp v112, v112, v112 row_ror:2 row_mask:0xf bank_mask:0xf

    s_nop 0
    v_max_u32_dpp v110, v110, v110 row_ror:4 row_mask:0xf bank_mask:0xf
    v_add_f32_dpp v111, v111, v111 row_ror:4 row_mask:0xf bank_mask:0xf
    v_add_f32_dpp v112, v112, v112 row_ror:4 row_mask:0xf bank_mask:0xf

    s_nop 0
    v_max_u32_dpp v110, v110, v110 row_ror:8 row_mask:0xf bank_mask:0xf
    v_add_f32_dpp v111, v111, v111 row_ror:8 row_mask:0xf bank_mask:0xf
    v_add_f32_dpp v112, v112, v112 row_ror:8 row_mask:0xf bank_mask:0xf

    v_rsq_f32 v112, v112
    v_readfirstlane_b32 s32, v110
    v_mul_f32 v112, 0x47decb04, v112
    v_readfirstlane_b32 s33, v111
    v_readfirstlane_b32 s34, v112

    ds_read_b64 v[94:95], v2
    s_waitcnt lgkmcnt(0)
    v_add_u32 v97, v94, v95
    s_nop 1
    v_add_u32_dpp v97, v97, v97 row_shr:1 row_mask:0xf bank_mask:0xf
    s_nop 1
    v_add_u32_dpp v97, v97, v97 row_shr:2 row_mask:0xf bank_mask:0xf
    s_nop 1
    v_add_u32_dpp v97, v97, v97 row_shr:4 row_mask:0xf bank_mask:0xf
    s_nop 1
    v_add_u32_dpp v97, v97, v97 row_shr:8 row_mask:0xf bank_mask:0xf
    s_nop 1
    v_add_u32_dpp v97, v97, v97 row_bcast:15 row_mask:0xa bank_mask:0xf
    s_nop 1
    v_add_u32_dpp v97, v97, v97 row_bcast:31 row_mask:0xc bank_mask:0xf
    s_mov_b32 exec_lo, 0
    s_brev_b32 exec_hi, 1
    ds_add_rtn_u32 v96, v108, v97
    s_mov_b64 exec, -1

    v_add_u32 v92, v94, v94
    v_add_u32 v93, v95, v95
    v_med3_u32 v92, v94, 2, v92
    v_med3_u32 v93, v95, 2, v93
    v_lshl_or_b32 v92, v93, 16, v92
    v_lshlrev_b32 v93, 2, v0
    buffer_atomic_add v92, v93, s[20:23], 0 offen sc0
    s_waitcnt lgkmcnt(0)
    v_readlane_b32 s77, v96, 63
    v_sub_u32 v97, v97, v95
    s_sub_u32 s50, s50, s83
    s_sub_u32 s77, s77, s50
    v_add_u32 v97, s77, v97
    v_sub_u32 v96, v97, v94
    v_lshlrev_b32 v111, 3, v97
    v_lshlrev_b32 v110, 3, v96
    v_mov_b32 v112, 0
    v_mov_b32 v113, 0
    ds_write_b64 v2, v[110:111] offset:8192
    ds_write_b64 v2, v[112:113]
    v_mad_i32_i24 v96, v96, -5, v102
    v_mad_i32_i24 v97, v97, -5, v103
    s_add_u32 s50, s50, s84
    s_mov_b32 s28, s82
    s_mov_b32 s29, s83
    s_mov_b32 s30, s84
    s_lshl_b32 s74, s29, 3
    s_lshl_b32 s75, s30, 3
    v_mov_b32 v125, s74
    v_mov_b32 v126, s75
    v_mov_b32 v127, -1

    s_waitcnt lgkmcnt(0)
    s_barrier

    s_mov_b64 exec, 1
    ds_write_b32 v125, v127 offset:24588
    ds_write_b32 v126, v127 offset:24596
    s_mov_b64 exec, -1

    s_bitcmp0_b32 s28, 0
    s_cbranch_scc1 L_skz_20
    v_lshrrev_b32 v110, 16, v45
    ds_read_b32 v110, v110 offset:8192
    v_lshrrev_b32 v111, 16, v47
    ds_read_b32 v111, v111 offset:8192
    v_lshrrev_b32 v112, 16, v49
    ds_read_b32 v112, v112 offset:8192
    v_lshrrev_b32 v113, 16, v51
    ds_read_b32 v113, v113 offset:8192
    s_waitcnt lgkmcnt(3)
    v_lshl_add_u32 v110, v76, 3, v110
    ds_write_b64 v110, v[44:45] offset:24592

    s_waitcnt lgkmcnt(3)
    v_lshl_add_u32 v111, v77, 3, v111
    ds_write_b64 v111, v[46:47] offset:24592

    s_waitcnt lgkmcnt(3)
    v_lshl_add_u32 v112, v78, 3, v112
    ds_write_b64 v112, v[48:49] offset:24592

    s_waitcnt lgkmcnt(3)
    v_lshl_add_u32 v113, v79, 3, v113
    ds_write_b64 v113, v[50:51] offset:24592

L_skz_20:
    s_bitcmp0_b32 s28, 1
    s_cbranch_scc1 L_skz_21
    v_lshrrev_b32 v110, 16, v53
    ds_read_b32 v110, v110 offset:8192
    v_lshrrev_b32 v111, 16, v55
    ds_read_b32 v111, v111 offset:8192
    v_lshrrev_b32 v112, 16, v57
    ds_read_b32 v112, v112 offset:8192
    v_lshrrev_b32 v113, 16, v59
    ds_read_b32 v113, v113 offset:8192
    s_waitcnt lgkmcnt(3)
    v_lshl_add_u32 v110, v80, 3, v110
    ds_write_b64 v110, v[52:53] offset:24592

    s_waitcnt lgkmcnt(3)
    v_lshl_add_u32 v111, v81, 3, v111
    ds_write_b64 v111, v[54:55] offset:24592

    s_waitcnt lgkmcnt(3)
    v_lshl_add_u32 v112, v82, 3, v112
    ds_write_b64 v112, v[56:57] offset:24592

    s_waitcnt lgkmcnt(3)
    v_lshl_add_u32 v113, v83, 3, v113
    ds_write_b64 v113, v[58:59] offset:24592

L_skz_21:
    s_bitcmp0_b32 s28, 2
    s_cbranch_scc1 L_skz_22
    v_lshrrev_b32 v110, 16, v61
    ds_read_b32 v110, v110 offset:8192
    v_lshrrev_b32 v111, 16, v63
    ds_read_b32 v111, v111 offset:8192
    v_lshrrev_b32 v112, 16, v65
    ds_read_b32 v112, v112 offset:8192
    v_lshrrev_b32 v113, 16, v67
    ds_read_b32 v113, v113 offset:8192
    s_waitcnt lgkmcnt(3)
    v_lshl_add_u32 v110, v84, 3, v110
    ds_write_b64 v110, v[60:61] offset:24592

    s_waitcnt lgkmcnt(3)
    v_lshl_add_u32 v111, v85, 3, v111
    ds_write_b64 v111, v[62:63] offset:24592

    s_waitcnt lgkmcnt(3)
    v_lshl_add_u32 v112, v86, 3, v112
    ds_write_b64 v112, v[64:65] offset:24592

    s_waitcnt lgkmcnt(3)
    v_lshl_add_u32 v113, v87, 3, v113
    ds_write_b64 v113, v[66:67] offset:24592

L_skz_22:
    s_bitcmp0_b32 s28, 3
    s_cbranch_scc1 L_skz_23
    s_mov_b64 exec, s[66:67]
    v_lshrrev_b32 v110, 16, v69
    ds_read_b32 v110, v110 offset:8192
    v_lshrrev_b32 v111, 16, v71
    ds_read_b32 v111, v111 offset:8192
    v_lshrrev_b32 v112, 16, v73
    ds_read_b32 v112, v112 offset:8192
    v_lshrrev_b32 v113, 16, v75
    ds_read_b32 v113, v113 offset:8192
    s_waitcnt lgkmcnt(3)
    v_lshl_add_u32 v110, v88, 3, v110
    ds_write_b64 v110, v[68:69] offset:24592

    s_waitcnt lgkmcnt(3)
    v_lshl_add_u32 v111, v89, 3, v111
    ds_write_b64 v111, v[70:71] offset:24592

    s_waitcnt lgkmcnt(3)
    v_lshl_add_u32 v112, v90, 3, v112
    ds_write_b64 v112, v[72:73] offset:24592

    s_waitcnt lgkmcnt(3)
    v_lshl_add_u32 v113, v91, 3, v113
    ds_write_b64 v113, v[74:75] offset:24592

    s_mov_b64 exec, -1
L_skz_23:
    v_mov_b32 v110, s32
    v_mov_b32 v111, s33
    v_mov_b32 v112, s34
    v_mov_b32 v113, 0
    v_mov_b32 v115, 0x4b400000

    s_add_u32 s92, s6, 135168
    s_addc_u32 s93, s7, 0
    s_mov_b32 s94, 4096
    s_mov_b32 s95, 0x20000
    s_lshl_b32 s3, s2, 4
    buffer_store_dwordx4 v[110:113], v98, s[92:95], s3 offen
    v_lshlrev_b32 v107, 16, v116
    v_and_b32 v116, 0xffff0000, v116
    v_fma_f32 v107, v107, s34, v115
    v_fma_f32 v116, v116, s34, v115
    v_perm_b32 v116, v116, v107, s55

    v_lshlrev_b32 v107, 16, v117
    v_and_b32 v117, 0xffff0000, v117
    v_fma_f32 v107, v107, s34, v115
    v_fma_f32 v117, v117, s34, v115
    v_perm_b32 v117, v117, v107, s55

    v_lshlrev_b32 v107, 16, v118
    v_and_b32 v118, 0xffff0000, v118
    v_fma_f32 v107, v107, s34, v115
    v_fma_f32 v118, v118, s34, v115
    v_perm_b32 v118, v118, v107, s55

    v_lshlrev_b32 v107, 16, v119
    v_and_b32 v119, 0xffff0000, v119
    v_fma_f32 v107, v107, s34, v115
    v_fma_f32 v119, v119, s34, v115
    v_perm_b32 v119, v119, v107, s55

    v_lshlrev_b32 v107, 16, v120
    v_and_b32 v120, 0xffff0000, v120
    v_fma_f32 v107, v107, s34, v115
    v_fma_f32 v120, v120, s34, v115
    v_perm_b32 v120, v120, v107, s55

    v_lshlrev_b32 v107, 16, v121
    v_and_b32 v121, 0xffff0000, v121
    v_fma_f32 v107, v107, s34, v115
    v_fma_f32 v121, v121, s34, v115
    v_perm_b32 v121, v121, v107, s55

    v_lshlrev_b32 v107, 16, v122
    v_and_b32 v122, 0xffff0000, v122
    v_fma_f32 v107, v107, s34, v115
    v_fma_f32 v122, v122, s34, v115
    v_perm_b32 v122, v122, v107, s55

    v_lshlrev_b32 v107, 16, v123
    v_and_b32 v123, 0xffff0000, v123
    v_fma_f32 v107, v107, s34, v115
    v_fma_f32 v123, v123, s34, v115
    v_perm_b32 v123, v123, v107, s55

    v_lshlrev_b32 v107, 16, v124
    v_and_b32 v124, 0xffff0000, v124
    v_fma_f32 v107, v107, s34, v115
    v_fma_f32 v124, v124, s34, v115
    v_perm_b32 v124, v124, v107, s55

    s_add_u32 s92, s6, s54
    s_addc_u32 s93, s7, 0
    s_mov_b32 s94, 24576
    s_mov_b32 s95, 0x20000
    s_movk_i32 s3, 16384
    buffer_store_dwordx4 v[116:119], v1, s[92:95], 0 offen
    buffer_store_dwordx4 v[120:123], v1, s[92:95], s3 offen
    s_mul_i32 s94, s53, 25424
    s_movk_i32 s3, 24576
    v_lshlrev_b32 v107, 2, v0

    buffer_store_dword v124, v107, s[92:95], s3 offen
    s_nop 1
    s_cmp_eq_u32 s49, 0
    s_cbranch_scc1 L_p1epi_7
L_p1loop_6:
    s_mov_b32 s82, s85
    s_mov_b32 s83, s86
    s_mov_b32 s84, s87
    v_mov_b32 v99, 1
    buffer_atomic_add v99, v98, s[96:99], 0 offen sc0
    s_cmp_eq_u32 s82, 15
    s_cbranch_scc1 L_full_24
    s_waitcnt vmcnt(1)
L_full_24:
    s_bitcmp0_b32 s82, 0
    s_cbranch_scc1 L_ska_25
    s_waitcnt vmcnt(11)
    v_mul_hi_u32_u24 v45, s40, v20
    v_mul_hi_u32_u24 v44, s40, v4
    v_mul_hi_u32_u24 v47, s40, v21
    v_mul_hi_u32_u24 v46, s40, v5
    v_mul_hi_u32_u24 v49, s40, v22
    v_mul_hi_u32_u24 v48, s40, v6
    v_mul_hi_u32_u24 v51, s40, v23
    v_mul_hi_u32_u24 v50, s40, v7
    v_and_b32 v45, -2, v45
    v_mad_u32_u24 v4, v44, s43, v4
    v_and_b32 v76, -4, v44
    v_and_b32 v47, -2, v47
    v_mad_u32_u24 v5, v46, s43, v5
    v_and_b32 v77, -4, v46
    v_and_b32 v49, -2, v49
    v_mad_u32_u24 v6, v48, s43, v6
    v_and_b32 v78, -4, v48
    v_and_b32 v51, -2, v51
    v_mad_u32_u24 v7, v50, s43, v7
    v_and_b32 v79, -4, v50
    v_mad_i32_i24 v20, v45, s42, v20
    v_lshl_add_u32 v45, v45, 6, v76
    v_mad_i32_i24 v21, v47, s42, v21
    v_lshl_add_u32 v47, v47, 6, v77
    v_mad_i32_i24 v22, v49, s42, v22
    v_lshl_add_u32 v49, v49, 6, v78
    v_mad_i32_i24 v23, v51, s42, v23
    v_lshl_add_u32 v51, v51, 6, v79
    ds_add_rtn_u32 v76, v45, v104
    ds_add_rtn_u32 v77, v47, v104
    ds_add_rtn_u32 v78, v49, v104
    ds_add_rtn_u32 v79, v51, v104
    v_lshlrev_b32 v110, 16, v36
    v_and_b32 v111, 0xffff0000, v36
    v_lshlrev_b32 v112, 16, v37
    v_and_b32 v113, 0xffff0000, v37
    v_mul_f32 v110, s44, v110
    v_mul_f32 v111, s44, v111
    v_mul_f32 v112, s44, v112
    v_mul_f32 v113, s44, v113
    v_fract_f32 v110, v110
    v_fract_f32 v111, v111
    v_fract_f32 v112, v112
    v_fract_f32 v113, v113
    v_cos_f32 v110, v110
    v_cos_f32 v111, v111
    v_cos_f32 v112, v112
    v_cos_f32 v113, v113
    v_lshl_or_b32 v44, v44, 14, v20
    v_perm_b32 v45, v45, v4, s46
    v_bfe_u32 v4, v4, 8, 5

    v_lshl_or_b32 v46, v46, 14, v21
    v_perm_b32 v47, v47, v5, s46
    v_bfe_u32 v5, v5, 8, 5

    v_lshl_or_b32 v48, v48, 14, v22
    v_perm_b32 v49, v49, v6, s46
    v_bfe_u32 v6, v6, 8, 5

    v_lshl_or_b32 v50, v50, 14, v23
    v_perm_b32 v51, v51, v7, s46
    v_bfe_u32 v7, v7, 8, 5

    v_fmaak_f32 v110, v110, v105, 0x4b400010
    v_fmaak_f32 v111, v111, v105, 0x4b400010
    v_fmaak_f32 v112, v112, v105, 0x4b400010
    v_fmaak_f32 v113, v113, v105, 0x4b400010
    v_sub_u32 v110, v110, v4
    v_sub_u32 v111, v111, v5
    v_sub_u32 v112, v112, v6
    v_sub_u32 v113, v113, v7
    v_bfi_b32 v110, 31, v4, v110
    v_bfi_b32 v111, 31, v5, v111
    v_bfi_b32 v112, 31, v6, v112
    v_bfi_b32 v113, 31, v7, v113
    v_perm_b32 v44, v44, v110, s55
    v_perm_b32 v46, v46, v111, s55
    v_perm_b32 v48, v48, v112, s55
    v_perm_b32 v50, v50, v113, s55
L_ska_25:
    s_bitcmp0_b32 s82, 1
    s_cbranch_scc1 L_ska_26
    s_waitcnt vmcnt(8)
    v_mul_hi_u32_u24 v53, s40, v24
    v_mul_hi_u32_u24 v52, s40, v8
    v_mul_hi_u32_u24 v55, s40, v25
    v_mul_hi_u32_u24 v54, s40, v9
    v_mul_hi_u32_u24 v57, s40, v26
    v_mul_hi_u32_u24 v56, s40, v10
    v_mul_hi_u32_u24 v59, s40, v27
    v_mul_hi_u32_u24 v58, s40, v11
    v_and_b32 v53, -2, v53
    v_mad_u32_u24 v8, v52, s43, v8
    v_and_b32 v80, -4, v52
    v_and_b32 v55, -2, v55
    v_mad_u32_u24 v9, v54, s43, v9
    v_and_b32 v81, -4, v54
    v_and_b32 v57, -2, v57
    v_mad_u32_u24 v10, v56, s43, v10
    v_and_b32 v82, -4, v56
    v_and_b32 v59, -2, v59
    v_mad_u32_u24 v11, v58, s43, v11
    v_and_b32 v83, -4, v58
    v_mad_i32_i24 v24, v53, s42, v24
    v_lshl_add_u32 v53, v53, 6, v80
    v_mad_i32_i24 v25, v55, s42, v25
    v_lshl_add_u32 v55, v55, 6, v81
    v_mad_i32_i24 v26, v57, s42, v26
    v_lshl_add_u32 v57, v57, 6, v82
    v_mad_i32_i24 v27, v59, s42, v27
    v_lshl_add_u32 v59, v59, 6, v83
    ds_add_rtn_u32 v80, v53, v104
    ds_add_rtn_u32 v81, v55, v104
    ds_add_rtn_u32 v82, v57, v104
    ds_add_rtn_u32 v83, v59, v104
    v_lshlrev_b32 v110, 16, v38
    v_and_b32 v111, 0xffff0000, v38
    v_lshlrev_b32 v112, 16, v39
    v_and_b32 v113, 0xffff0000, v39
    v_mul_f32 v110, s44, v110
    v_mul_f32 v111, s44, v111
    v_mul_f32 v112, s44, v112
    v_mul_f32 v113, s44, v113
    v_fract_f32 v110, v110
    v_fract_f32 v111, v111
    v_fract_f32 v112, v112
    v_fract_f32 v113, v113
    v_cos_f32 v110, v110
    v_cos_f32 v111, v111
    v_cos_f32 v112, v112
    v_cos_f32 v113, v113
    v_lshl_or_b32 v52, v52, 14, v24
    v_perm_b32 v53, v53, v8, s46
    v_bfe_u32 v8, v8, 8, 5

    v_lshl_or_b32 v54, v54, 14, v25
    v_perm_b32 v55, v55, v9, s46
    v_bfe_u32 v9, v9, 8, 5

    v_lshl_or_b32 v56, v56, 14, v26
    v_perm_b32 v57, v57, v10, s46
    v_bfe_u32 v10, v10, 8, 5

    v_lshl_or_b32 v58, v58, 14, v27
    v_perm_b32 v59, v59, v11, s46
    v_bfe_u32 v11, v11, 8, 5

    v_fmaak_f32 v110, v110, v105, 0x4b400010
    v_fmaak_f32 v111, v111, v105, 0x4b400010
    v_fmaak_f32 v112, v112, v105, 0x4b400010
    v_fmaak_f32 v113, v113, v105, 0x4b400010
    v_sub_u32 v110, v110, v8
    v_sub_u32 v111, v111, v9
    v_sub_u32 v112, v112, v10
    v_sub_u32 v113, v113, v11
    v_bfi_b32 v110, 31, v8, v110
    v_bfi_b32 v111, 31, v9, v111
    v_bfi_b32 v112, 31, v10, v112
    v_bfi_b32 v113, 31, v11, v113
    v_perm_b32 v52, v52, v110, s55
    v_perm_b32 v54, v54, v111, s55
    v_perm_b32 v56, v56, v112, s55
    v_perm_b32 v58, v58, v113, s55
L_ska_26:
    s_bitcmp0_b32 s82, 2
    s_cbranch_scc1 L_ska_27
    s_waitcnt vmcnt(4)
    v_mul_hi_u32_u24 v61, s40, v28
    v_mul_hi_u32_u24 v60, s40, v12
    v_mul_hi_u32_u24 v63, s40, v29
    v_mul_hi_u32_u24 v62, s40, v13
    v_mul_hi_u32_u24 v65, s40, v30
    v_mul_hi_u32_u24 v64, s40, v14
    v_mul_hi_u32_u24 v67, s40, v31
    v_mul_hi_u32_u24 v66, s40, v15
    v_and_b32 v61, -2, v61
    v_mad_u32_u24 v12, v60, s43, v12
    v_and_b32 v84, -4, v60
    v_and_b32 v63, -2, v63
    v_mad_u32_u24 v13, v62, s43, v13
    v_and_b32 v85, -4, v62
    v_and_b32 v65, -2, v65
    v_mad_u32_u24 v14, v64, s43, v14
    v_and_b32 v86, -4, v64
    v_and_b32 v67, -2, v67
    v_mad_u32_u24 v15, v66, s43, v15
    v_and_b32 v87, -4, v66
    v_mad_i32_i24 v28, v61, s42, v28
    v_lshl_add_u32 v61, v61, 6, v84
    v_mad_i32_i24 v29, v63, s42, v29
    v_lshl_add_u32 v63, v63, 6, v85
    v_mad_i32_i24 v30, v65, s42, v30
    v_lshl_add_u32 v65, v65, 6, v86
    v_mad_i32_i24 v31, v67, s42, v31
    v_lshl_add_u32 v67, v67, 6, v87
    ds_add_rtn_u32 v84, v61, v104
    ds_add_rtn_u32 v85, v63, v104
    ds_add_rtn_u32 v86, v65, v104
    ds_add_rtn_u32 v87, v67, v104
    v_lshlrev_b32 v110, 16, v40
    v_and_b32 v111, 0xffff0000, v40
    v_lshlrev_b32 v112, 16, v41
    v_and_b32 v113, 0xffff0000, v41
    v_mul_f32 v110, s44, v110
    v_mul_f32 v111, s44, v111
    v_mul_f32 v112, s44, v112
    v_mul_f32 v113, s44, v113
    v_fract_f32 v110, v110
    v_fract_f32 v111, v111
    v_fract_f32 v112, v112
    v_fract_f32 v113, v113
    v_cos_f32 v110, v110
    v_cos_f32 v111, v111
    v_cos_f32 v112, v112
    v_cos_f32 v113, v113
    v_lshl_or_b32 v60, v60, 14, v28
    v_perm_b32 v61, v61, v12, s46
    v_bfe_u32 v12, v12, 8, 5

    v_lshl_or_b32 v62, v62, 14, v29
    v_perm_b32 v63, v63, v13, s46
    v_bfe_u32 v13, v13, 8, 5

    v_lshl_or_b32 v64, v64, 14, v30
    v_perm_b32 v65, v65, v14, s46
    v_bfe_u32 v14, v14, 8, 5

    v_lshl_or_b32 v66, v66, 14, v31
    v_perm_b32 v67, v67, v15, s46
    v_bfe_u32 v15, v15, 8, 5

    v_fmaak_f32 v110, v110, v105, 0x4b400010
    v_fmaak_f32 v111, v111, v105, 0x4b400010
    v_fmaak_f32 v112, v112, v105, 0x4b400010
    v_fmaak_f32 v113, v113, v105, 0x4b400010
    v_sub_u32 v110, v110, v12
    v_sub_u32 v111, v111, v13
    v_sub_u32 v112, v112, v14
    v_sub_u32 v113, v113, v15
    v_bfi_b32 v110, 31, v12, v110
    v_bfi_b32 v111, 31, v13, v111
    v_bfi_b32 v112, 31, v14, v112
    v_bfi_b32 v113, 31, v15, v113
    v_perm_b32 v60, v60, v110, s55
    v_perm_b32 v62, v62, v111, s55
    v_perm_b32 v64, v64, v112, s55
    v_perm_b32 v66, v66, v113, s55
L_ska_27:
    s_waitcnt vmcnt(1)
    s_waitcnt vmcnt(0)
    v_cmp_eq_u32 vcc, 0, v0
    s_mov_b64 exec, vcc
    ds_write_b32 v108, v99 offset:8
    s_mov_b64 exec, -1
    s_waitcnt vmcnt(5)
    v_lshrrev_b32 v93, 16, v92
    v_and_b32 v92, 0xffff, v92
    v_add_u32 v110, v92, v94
    v_mad_u32_u24 v92, v92, 5, v96
    v_add_u32 v111, v93, v95
    v_mad_u32_u24 v93, v93, 5, v97
    v_max_u32 v110, v110, v111
    v_cmp_le_u32 vcc, s48, v110
    s_cbranch_vccnz L_full_28
L_fback_29:
    ds_write_b64 v2, v[92:93] offset:16384

    s_waitcnt lgkmcnt(0)
    s_barrier
    ds_read_b32 v111, v108 offset:8
    s_waitcnt lgkmcnt(0)
    v_readfirstlane_b32 s41, v111
    s_nop 1

    s_add_u32 s41, s41, 416
    s_sub_u32 s78, s41, 2965
    s_lshr_b32 s79, s78, 1
    s_add_u32 s79, s79, 2965
    s_and_b32 s86, s78, 1
    s_lshl_b32 s86, s86, 1
    s_add_u32 s87, s86, 2
    s_cmp_lt_u32 s41, 2965
    s_cselect_b32 s41, s41, s79
    s_cmovk_i32 s86, 0
    s_cmovk_i32 s87, 4

    s_lshl_b32 s76, s86, 12
    s_sub_u32 s87, s87, s86
    s_mov_b32 s86, 0
    s_mul_i32 s78, s41, 16384
    s_add_u32 s49, s78, 16384
    s_cmp_ge_u32 s41, 3125
    s_cmovk_i32 s49, 0
    s_cmovk_i32 s78, 0
    s_lshl_b32 s10, s49, 2
    s_lshl_b32 s14, s49, 2
    s_lshl_b32 s18, s49, 1
    s_sub_u32 s79, s87, s86
    s_bfm_b32 s85, s79, s86
    s_lshl_b32 s86, s86, 12
    s_lshl_b32 s87, s87, 12
    s_min_u32 s87, s87, 16384

    s_add_u32 s78, s78, s76
    s_add_u32 s79, s78, 0
    s_bitcmp1_b32 s85, 0
    s_cselect_b32 s79, s79, 0x1ff00000
    s_lshl_b32 s56, s79, 2
    s_lshl_b32 s61, s79, 1

    s_add_u32 s79, s78, 4096
    s_bitcmp1_b32 s85, 1
    s_cselect_b32 s79, s79, 0x1ff00000
    s_lshl_b32 s57, s79, 2
    s_lshl_b32 s62, s79, 1

    s_add_u32 s79, s78, 8192
    s_bitcmp1_b32 s85, 2
    s_cselect_b32 s79, s79, 0x1ff00000
    s_lshl_b32 s58, s79, 2
    s_lshl_b32 s63, s79, 1

    s_add_u32 s79, s78, 12288
    s_bitcmp1_b32 s85, 3
    s_cselect_b32 s79, s79, 0x1ff00000
    s_lshl_b32 s59, s79, 2
    s_lshl_b32 s64, s79, 1

    s_cmp_eq_u32 s49, 0
    s_cmovk_i32 s85, 0
    s_bitcmp0_b32 s28, 0
    s_cbranch_scc1 L_skw_30
    ds_read_b64 v[110:111], v2 offset:24592
    ds_read_b64 v[112:113], v2 offset:24600
    ds_read_b64 v[114:115], v2 offset:24584

    ds_read_b64 v[118:119], v2 offset:32784
    ds_read_b64 v[120:121], v2 offset:32792
    ds_read_b64 v[122:123], v2 offset:32776

    s_waitcnt lgkmcnt(3)
    v_lshrrev_b32 v116, 16, v111
    ds_read_b32 v116, v116 offset:16384

    s_waitcnt lgkmcnt(1)
    v_lshrrev_b32 v124, 16, v119
    ds_read_b32 v124, v124 offset:16384

    v_cmp_ne_u32_sdwa s[80:81], v111, v113 src0_sel:WORD_1 src1_sel:WORD_1
    v_cmp_ne_u32_sdwa vcc, v111, v115 src0_sel:WORD_1 src1_sel:WORD_1
    v_alignbyte_b32 v114, v111, v114, 1
    s_mov_b32 s54, -3
    v_perm_b32 v112, v112, v113, s45
    s_waitcnt lgkmcnt(1)
    v_add3_u32 v116, v116, v106, s54
    v_sub_u32 v117, 0, v116
    v_and_b32 v117, 3, v117
    s_mov_b64 exec, s[80:81]
    v_mov_b32 v117, 0
    v_mov_b32 v112, 0
    s_mov_b64 exec, vcc
    v_mov_b32 v117, 3

    s_mov_b64 exec, -1
    v_alignbyte_b32 v111, v112, v110, v117
    v_alignbyte_b32 v110, v110, v114, v117
    v_add_u32 v116, v116, v117

    buffer_store_dwordx2 v[110:111], v116, s[24:27], 0 offen
    v_cmp_ne_u32_sdwa s[80:81], v119, v121 src0_sel:WORD_1 src1_sel:WORD_1
    v_cmp_ne_u32_sdwa vcc, v119, v123 src0_sel:WORD_1 src1_sel:WORD_1
    v_alignbyte_b32 v122, v119, v122, 1
    s_mov_b32 s54, 5117
    v_perm_b32 v120, v120, v121, s45
    s_waitcnt lgkmcnt(0)
    v_add3_u32 v124, v124, v106, s54
    v_sub_u32 v125, 0, v124
    v_and_b32 v125, 3, v125
    s_mov_b64 exec, s[80:81]
    v_mov_b32 v125, 0
    v_mov_b32 v120, 0
    s_mov_b64 exec, vcc
    v_mov_b32 v125, 3

    s_mov_b64 exec, -1
    v_alignbyte_b32 v119, v120, v118, v125
    v_alignbyte_b32 v118, v118, v122, v125
    v_add_u32 v124, v124, v125

    buffer_store_dwordx2 v[118:119], v124, s[24:27], 0 offen
L_skw_30:
    s_bitcmp0_b32 s28, 0
    s_cbranch_scc1 L_skw_31
    ds_read_b64 v[110:111], v2 offset:40976
    ds_read_b64 v[112:113], v2 offset:40984
    ds_read_b64 v[114:115], v2 offset:40968

    ds_read_b64 v[118:119], v2 offset:49168
    ds_read_b64 v[120:121], v2 offset:49176
    ds_read_b64 v[122:123], v2 offset:49160

    s_waitcnt lgkmcnt(3)
    v_lshrrev_b32 v116, 16, v111
    ds_read_b32 v116, v116 offset:16384

    s_waitcnt lgkmcnt(1)
    v_lshrrev_b32 v124, 16, v119
    ds_read_b32 v124, v124 offset:16384

    v_cmp_ne_u32_sdwa s[80:81], v111, v113 src0_sel:WORD_1 src1_sel:WORD_1
    v_cmp_ne_u32_sdwa vcc, v111, v115 src0_sel:WORD_1 src1_sel:WORD_1
    v_alignbyte_b32 v114, v111, v114, 1
    s_mov_b32 s54, 10237
    v_perm_b32 v112, v112, v113, s45
    s_waitcnt lgkmcnt(1)
    v_add3_u32 v116, v116, v106, s54
    v_sub_u32 v117, 0, v116
    v_and_b32 v117, 3, v117
    s_mov_b64 exec, s[80:81]
    v_mov_b32 v117, 0
    v_mov_b32 v112, 0
    s_mov_b64 exec, vcc
    v_mov_b32 v117, 3

    s_mov_b64 exec, -1
    v_alignbyte_b32 v111, v112, v110, v117
    v_alignbyte_b32 v110, v110, v114, v117
    v_add_u32 v116, v116, v117

    buffer_store_dwordx2 v[110:111], v116, s[24:27], 0 offen
    v_cmp_ne_u32_sdwa s[80:81], v119, v121 src0_sel:WORD_1 src1_sel:WORD_1
    v_cmp_ne_u32_sdwa vcc, v119, v123 src0_sel:WORD_1 src1_sel:WORD_1
    v_alignbyte_b32 v122, v119, v122, 1
    s_mov_b32 s54, 15357
    v_perm_b32 v120, v120, v121, s45
    s_waitcnt lgkmcnt(0)
    v_add3_u32 v124, v124, v106, s54
    v_sub_u32 v125, 0, v124
    v_and_b32 v125, 3, v125
    s_mov_b64 exec, s[80:81]
    v_mov_b32 v125, 0
    v_mov_b32 v120, 0
    s_mov_b64 exec, vcc
    v_mov_b32 v125, 3

    s_mov_b64 exec, -1
    v_alignbyte_b32 v119, v120, v118, v125
    v_alignbyte_b32 v118, v118, v122, v125
    v_add_u32 v124, v124, v125

    buffer_store_dwordx2 v[118:119], v124, s[24:27], 0 offen
L_skw_31:
    s_bitcmp0_b32 s28, 1
    s_cbranch_scc1 L_skw_32
    v_add_u32 v107, 32768, v2
    ds_read_b64 v[110:111], v107 offset:24592
    ds_read_b64 v[112:113], v107 offset:24600
    ds_read_b64 v[114:115], v107 offset:24584

    ds_read_b64 v[118:119], v107 offset:32784
    ds_read_b64 v[120:121], v107 offset:32792
    ds_read_b64 v[122:123], v107 offset:32776

    s_waitcnt lgkmcnt(3)
    v_lshrrev_b32 v116, 16, v111
    ds_read_b32 v116, v116 offset:16384

    s_waitcnt lgkmcnt(1)
    v_lshrrev_b32 v124, 16, v119
    ds_read_b32 v124, v124 offset:16384

    v_cmp_ne_u32_sdwa s[80:81], v111, v113 src0_sel:WORD_1 src1_sel:WORD_1
    v_cmp_ne_u32_sdwa vcc, v111, v115 src0_sel:WORD_1 src1_sel:WORD_1
    v_alignbyte_b32 v114, v111, v114, 1
    s_mov_b32 s54, 20477
    v_perm_b32 v112, v112, v113, s45
    s_waitcnt lgkmcnt(1)
    v_add3_u32 v116, v116, v106, s54
    v_sub_u32 v117, 0, v116
    v_and_b32 v117, 3, v117
    s_mov_b64 exec, s[80:81]
    v_mov_b32 v117, 0
    v_mov_b32 v112, 0
    s_mov_b64 exec, vcc
    v_mov_b32 v117, 3

    s_mov_b64 exec, -1
    v_alignbyte_b32 v111, v112, v110, v117
    v_alignbyte_b32 v110, v110, v114, v117
    v_add_u32 v116, v116, v117

    buffer_store_dwordx2 v[110:111], v116, s[24:27], 0 offen
    v_cmp_ne_u32_sdwa s[80:81], v119, v121 src0_sel:WORD_1 src1_sel:WORD_1
    v_cmp_ne_u32_sdwa vcc, v119, v123 src0_sel:WORD_1 src1_sel:WORD_1
    v_alignbyte_b32 v122, v119, v122, 1
    s_mov_b32 s54, 25597
    v_perm_b32 v120, v120, v121, s45
    s_waitcnt lgkmcnt(0)
    v_add3_u32 v124, v124, v106, s54
    v_sub_u32 v125, 0, v124
    v_and_b32 v125, 3, v125
    s_mov_b64 exec, s[80:81]
    v_mov_b32 v125, 0
    v_mov_b32 v120, 0
    s_mov_b64 exec, vcc
    v_mov_b32 v125, 3

    s_mov_b64 exec, -1
    v_alignbyte_b32 v119, v120, v118, v125
    v_alignbyte_b32 v118, v118, v122, v125
    v_add_u32 v124, v124, v125

    buffer_store_dwordx2 v[118:119], v124, s[24:27], 0 offen
L_skw_32:
    s_bitcmp0_b32 s28, 1
    s_cbranch_scc1 L_skw_33
    v_add_u32 v107, 32768, v2
    ds_read_b64 v[110:111], v107 offset:40976
    ds_read_b64 v[112:113], v107 offset:40984
    ds_read_b64 v[114:115], v107 offset:40968

    ds_read_b64 v[118:119], v107 offset:49168
    ds_read_b64 v[120:121], v107 offset:49176
    ds_read_b64 v[122:123], v107 offset:49160

    s_waitcnt lgkmcnt(3)
    v_lshrrev_b32 v116, 16, v111
    ds_read_b32 v116, v116 offset:16384

    s_waitcnt lgkmcnt(1)
    v_lshrrev_b32 v124, 16, v119
    ds_read_b32 v124, v124 offset:16384

    v_cmp_ne_u32_sdwa s[80:81], v111, v113 src0_sel:WORD_1 src1_sel:WORD_1
    v_cmp_ne_u32_sdwa vcc, v111, v115 src0_sel:WORD_1 src1_sel:WORD_1
    v_alignbyte_b32 v114, v111, v114, 1
    s_mov_b32 s54, 30717
    v_perm_b32 v112, v112, v113, s45
    s_waitcnt lgkmcnt(1)
    v_add3_u32 v116, v116, v106, s54
    v_sub_u32 v117, 0, v116
    v_and_b32 v117, 3, v117
    s_mov_b64 exec, s[80:81]
    v_mov_b32 v117, 0
    v_mov_b32 v112, 0
    s_mov_b64 exec, vcc
    v_mov_b32 v117, 3

    s_mov_b64 exec, -1
    v_alignbyte_b32 v111, v112, v110, v117
    v_alignbyte_b32 v110, v110, v114, v117
    v_add_u32 v116, v116, v117

    buffer_store_dwordx2 v[110:111], v116, s[24:27], 0 offen
    v_cmp_ne_u32_sdwa s[80:81], v119, v121 src0_sel:WORD_1 src1_sel:WORD_1
    v_cmp_ne_u32_sdwa vcc, v119, v123 src0_sel:WORD_1 src1_sel:WORD_1
    v_alignbyte_b32 v122, v119, v122, 1
    s_mov_b32 s54, 35837
    v_perm_b32 v120, v120, v121, s45
    s_waitcnt lgkmcnt(0)
    v_add3_u32 v124, v124, v106, s54
    v_sub_u32 v125, 0, v124
    v_and_b32 v125, 3, v125
    s_mov_b64 exec, s[80:81]
    v_mov_b32 v125, 0
    v_mov_b32 v120, 0
    s_mov_b64 exec, vcc
    v_mov_b32 v125, 3

    s_mov_b64 exec, -1
    v_alignbyte_b32 v119, v120, v118, v125
    v_alignbyte_b32 v118, v118, v122, v125
    v_add_u32 v124, v124, v125

    buffer_store_dwordx2 v[118:119], v124, s[24:27], 0 offen
L_skw_33:
    s_bitcmp0_b32 s82, 3
    s_cbranch_scc1 L_ska_34
    s_mov_b64 exec, s[66:67]
    v_mul_hi_u32_u24 v69, s40, v32
    v_mul_hi_u32_u24 v68, s40, v16
    v_mul_hi_u32_u24 v71, s40, v33
    v_mul_hi_u32_u24 v70, s40, v17
    v_mul_hi_u32_u24 v73, s40, v34
    v_mul_hi_u32_u24 v72, s40, v18
    v_mul_hi_u32_u24 v75, s40, v35
    v_mul_hi_u32_u24 v74, s40, v19
    v_and_b32 v69, -2, v69
    v_mad_u32_u24 v16, v68, s43, v16
    v_and_b32 v88, -4, v68
    v_and_b32 v71, -2, v71
    v_mad_u32_u24 v17, v70, s43, v17
    v_and_b32 v89, -4, v70
    v_and_b32 v73, -2, v73
    v_mad_u32_u24 v18, v72, s43, v18
    v_and_b32 v90, -4, v72
    v_and_b32 v75, -2, v75
    v_mad_u32_u24 v19, v74, s43, v19
    v_and_b32 v91, -4, v74
    v_mad_i32_i24 v32, v69, s42, v32
    v_lshl_add_u32 v69, v69, 6, v88
    v_mad_i32_i24 v33, v71, s42, v33
    v_lshl_add_u32 v71, v71, 6, v89
    v_mad_i32_i24 v34, v73, s42, v34
    v_lshl_add_u32 v73, v73, 6, v90
    v_mad_i32_i24 v35, v75, s42, v35
    v_lshl_add_u32 v75, v75, 6, v91
    ds_add_rtn_u32 v88, v69, v104
    ds_add_rtn_u32 v89, v71, v104
    ds_add_rtn_u32 v90, v73, v104
    ds_add_rtn_u32 v91, v75, v104
    v_lshlrev_b32 v110, 16, v42
    v_and_b32 v111, 0xffff0000, v42
    v_lshlrev_b32 v112, 16, v43
    v_and_b32 v113, 0xffff0000, v43
    v_mul_f32 v110, s44, v110
    v_mul_f32 v111, s44, v111
    v_mul_f32 v112, s44, v112
    v_mul_f32 v113, s44, v113
    v_fract_f32 v110, v110
    v_fract_f32 v111, v111
    v_fract_f32 v112, v112
    v_fract_f32 v113, v113
    v_cos_f32 v110, v110
    v_cos_f32 v111, v111
    v_cos_f32 v112, v112
    v_cos_f32 v113, v113
    v_lshl_or_b32 v68, v68, 14, v32
    v_perm_b32 v69, v69, v16, s46
    v_bfe_u32 v16, v16, 8, 5

    v_lshl_or_b32 v70, v70, 14, v33
    v_perm_b32 v71, v71, v17, s46
    v_bfe_u32 v17, v17, 8, 5

    v_lshl_or_b32 v72, v72, 14, v34
    v_perm_b32 v73, v73, v18, s46
    v_bfe_u32 v18, v18, 8, 5

    v_lshl_or_b32 v74, v74, 14, v35
    v_perm_b32 v75, v75, v19, s46
    v_bfe_u32 v19, v19, 8, 5

    v_fmaak_f32 v110, v110, v105, 0x4b400010
    v_fmaak_f32 v111, v111, v105, 0x4b400010
    v_fmaak_f32 v112, v112, v105, 0x4b400010
    v_fmaak_f32 v113, v113, v105, 0x4b400010
    v_sub_u32 v110, v110, v16
    v_sub_u32 v111, v111, v17
    v_sub_u32 v112, v112, v18
    v_sub_u32 v113, v113, v19
    v_bfi_b32 v110, 31, v16, v110
    v_bfi_b32 v111, 31, v17, v111
    v_bfi_b32 v112, 31, v18, v112
    v_bfi_b32 v113, 31, v19, v113
    v_perm_b32 v68, v68, v110, s55
    v_perm_b32 v70, v70, v111, s55
    v_perm_b32 v72, v72, v112, s55
    v_perm_b32 v74, v74, v113, s55
    s_mov_b64 exec, -1
L_ska_34:
    s_bitcmp0_b32 s28, 2
    s_cbranch_scc1 L_skw_35
    v_add_u32 v107, 65536, v2
    ds_read_b64 v[110:111], v107 offset:24592
    ds_read_b64 v[112:113], v107 offset:24600
    ds_read_b64 v[114:115], v107 offset:24584

    ds_read_b64 v[118:119], v107 offset:32784
    ds_read_b64 v[120:121], v107 offset:32792
    ds_read_b64 v[122:123], v107 offset:32776

    s_waitcnt lgkmcnt(3)
    v_lshrrev_b32 v116, 16, v111
    ds_read_b32 v116, v116 offset:16384

    s_waitcnt lgkmcnt(1)
    v_lshrrev_b32 v124, 16, v119
    ds_read_b32 v124, v124 offset:16384

    v_cmp_ne_u32_sdwa s[80:81], v111, v113 src0_sel:WORD_1 src1_sel:WORD_1
    v_cmp_ne_u32_sdwa vcc, v111, v115 src0_sel:WORD_1 src1_sel:WORD_1
    v_alignbyte_b32 v114, v111, v114, 1
    s_mov_b32 s54, 40957
    v_perm_b32 v112, v112, v113, s45
    s_waitcnt lgkmcnt(1)
    v_add3_u32 v116, v116, v106, s54
    v_sub_u32 v117, 0, v116
    v_and_b32 v117, 3, v117
    s_mov_b64 exec, s[80:81]
    v_mov_b32 v117, 0
    v_mov_b32 v112, 0
    s_mov_b64 exec, vcc
    v_mov_b32 v117, 3

    s_mov_b64 exec, -1
    v_alignbyte_b32 v111, v112, v110, v117
    v_alignbyte_b32 v110, v110, v114, v117
    v_add_u32 v116, v116, v117

    buffer_store_dwordx2 v[110:111], v116, s[24:27], 0 offen
    v_cmp_ne_u32_sdwa s[80:81], v119, v121 src0_sel:WORD_1 src1_sel:WORD_1
    v_cmp_ne_u32_sdwa vcc, v119, v123 src0_sel:WORD_1 src1_sel:WORD_1
    v_alignbyte_b32 v122, v119, v122, 1
    s_mov_b32 s54, 46077
    v_perm_b32 v120, v120, v121, s45
    s_waitcnt lgkmcnt(0)
    v_add3_u32 v124, v124, v106, s54
    v_sub_u32 v125, 0, v124
    v_and_b32 v125, 3, v125
    s_mov_b64 exec, s[80:81]
    v_mov_b32 v125, 0
    v_mov_b32 v120, 0
    s_mov_b64 exec, vcc
    v_mov_b32 v125, 3

    s_mov_b64 exec, -1
    v_alignbyte_b32 v119, v120, v118, v125
    v_alignbyte_b32 v118, v118, v122, v125
    v_add_u32 v124, v124, v125

    buffer_store_dwordx2 v[118:119], v124, s[24:27], 0 offen
L_skw_35:
    s_bitcmp0_b32 s28, 2
    s_cbranch_scc1 L_skw_36
    v_add_u32 v107, 65536, v2
    ds_read_b64 v[110:111], v107 offset:40976
    ds_read_b64 v[112:113], v107 offset:40984
    ds_read_b64 v[114:115], v107 offset:40968

    ds_read_b64 v[118:119], v107 offset:49168
    ds_read_b64 v[120:121], v107 offset:49176
    ds_read_b64 v[122:123], v107 offset:49160

    s_waitcnt lgkmcnt(3)
    v_lshrrev_b32 v116, 16, v111
    ds_read_b32 v116, v116 offset:16384

    s_waitcnt lgkmcnt(1)
    v_lshrrev_b32 v124, 16, v119
    ds_read_b32 v124, v124 offset:16384

    v_cmp_ne_u32_sdwa s[80:81], v111, v113 src0_sel:WORD_1 src1_sel:WORD_1
    v_cmp_ne_u32_sdwa vcc, v111, v115 src0_sel:WORD_1 src1_sel:WORD_1
    v_alignbyte_b32 v114, v111, v114, 1
    s_mov_b32 s54, 51197
    v_perm_b32 v112, v112, v113, s45
    s_waitcnt lgkmcnt(1)
    v_add3_u32 v116, v116, v106, s54
    v_sub_u32 v117, 0, v116
    v_and_b32 v117, 3, v117
    s_mov_b64 exec, s[80:81]
    v_mov_b32 v117, 0
    v_mov_b32 v112, 0
    s_mov_b64 exec, vcc
    v_mov_b32 v117, 3

    s_mov_b64 exec, -1
    v_alignbyte_b32 v111, v112, v110, v117
    v_alignbyte_b32 v110, v110, v114, v117
    v_add_u32 v116, v116, v117

    buffer_store_dwordx2 v[110:111], v116, s[24:27], 0 offen
    v_cmp_ne_u32_sdwa s[80:81], v119, v121 src0_sel:WORD_1 src1_sel:WORD_1
    v_cmp_ne_u32_sdwa vcc, v119, v123 src0_sel:WORD_1 src1_sel:WORD_1
    v_alignbyte_b32 v122, v119, v122, 1
    s_mov_b32 s54, 56317
    v_perm_b32 v120, v120, v121, s45
    s_waitcnt lgkmcnt(0)
    v_add3_u32 v124, v124, v106, s54
    v_sub_u32 v125, 0, v124
    v_and_b32 v125, 3, v125
    s_mov_b64 exec, s[80:81]
    v_mov_b32 v125, 0
    v_mov_b32 v120, 0
    s_mov_b64 exec, vcc
    v_mov_b32 v125, 3

    s_mov_b64 exec, -1
    v_alignbyte_b32 v119, v120, v118, v125
    v_alignbyte_b32 v118, v118, v122, v125
    v_add_u32 v124, v124, v125

    buffer_store_dwordx2 v[118:119], v124, s[24:27], 0 offen
L_skw_36:
    s_bitcmp0_b32 s28, 3
    s_cbranch_scc1 L_skw_37
    v_add_u32 v107, 98304, v2
    ds_read_b64 v[110:111], v107 offset:24592
    ds_read_b64 v[112:113], v107 offset:24600
    ds_read_b64 v[114:115], v107 offset:24584

    ds_read_b64 v[118:119], v107 offset:32784
    ds_read_b64 v[120:121], v107 offset:32792
    ds_read_b64 v[122:123], v107 offset:32776

    s_waitcnt lgkmcnt(3)
    v_lshrrev_b32 v116, 16, v111
    ds_read_b32 v116, v116 offset:16384

    s_waitcnt lgkmcnt(1)
    v_lshrrev_b32 v124, 16, v119
    ds_read_b32 v124, v124 offset:16384

    v_cmp_ne_u32_sdwa s[80:81], v111, v113 src0_sel:WORD_1 src1_sel:WORD_1
    v_cmp_ne_u32_sdwa vcc, v111, v115 src0_sel:WORD_1 src1_sel:WORD_1
    v_alignbyte_b32 v114, v111, v114, 1
    s_mov_b32 s54, 61437
    v_perm_b32 v112, v112, v113, s45
    s_waitcnt lgkmcnt(1)
    v_add3_u32 v116, v116, v106, s54
    v_sub_u32 v117, 0, v116
    v_and_b32 v117, 3, v117
    s_mov_b64 exec, s[80:81]
    v_mov_b32 v117, 0
    v_mov_b32 v112, 0
    s_mov_b64 exec, vcc
    v_mov_b32 v117, 3

    s_mov_b64 exec, -1
    v_alignbyte_b32 v111, v112, v110, v117
    v_alignbyte_b32 v110, v110, v114, v117
    v_add_u32 v116, v116, v117

    buffer_store_dwordx2 v[110:111], v116, s[24:27], 0 offen
    v_cmp_ne_u32_sdwa s[80:81], v119, v121 src0_sel:WORD_1 src1_sel:WORD_1
    v_cmp_ne_u32_sdwa vcc, v119, v123 src0_sel:WORD_1 src1_sel:WORD_1
    v_alignbyte_b32 v122, v119, v122, 1
    s_mov_b32 s54, 66557
    v_perm_b32 v120, v120, v121, s45
    s_waitcnt lgkmcnt(0)
    v_add3_u32 v124, v124, v106, s54
    v_sub_u32 v125, 0, v124
    v_and_b32 v125, 3, v125
    s_mov_b64 exec, s[80:81]
    v_mov_b32 v125, 0
    v_mov_b32 v120, 0
    s_mov_b64 exec, vcc
    v_mov_b32 v125, 3

    s_mov_b64 exec, -1
    v_alignbyte_b32 v119, v120, v118, v125
    v_alignbyte_b32 v118, v118, v122, v125
    v_add_u32 v124, v124, v125

    buffer_store_dwordx2 v[118:119], v124, s[24:27], 0 offen
L_skw_37:
    s_bitcmp0_b32 s28, 3
    s_cbranch_scc1 L_skw_38
    v_add_u32 v107, 98304, v2
    ds_read_b64 v[110:111], v107 offset:40976
    ds_read_b64 v[112:113], v107 offset:40984
    ds_read_b64 v[114:115], v107 offset:40968

    ds_read_b64 v[118:119], v107 offset:49168
    ds_read_b64 v[120:121], v107 offset:49176
    ds_read_b64 v[122:123], v107 offset:49160

    s_waitcnt lgkmcnt(3)
    v_lshrrev_b32 v116, 16, v111
    ds_read_b32 v116, v116 offset:16384

    s_waitcnt lgkmcnt(1)
    v_lshrrev_b32 v124, 16, v119
    ds_read_b32 v124, v124 offset:16384

    v_cmp_ne_u32_sdwa s[80:81], v111, v113 src0_sel:WORD_1 src1_sel:WORD_1
    v_cmp_ne_u32_sdwa vcc, v111, v115 src0_sel:WORD_1 src1_sel:WORD_1
    v_alignbyte_b32 v114, v111, v114, 1
    s_mov_b32 s54, 71677
    v_perm_b32 v112, v112, v113, s45
    s_waitcnt lgkmcnt(1)
    v_add3_u32 v116, v116, v106, s54
    v_sub_u32 v117, 0, v116
    v_and_b32 v117, 3, v117
    s_mov_b64 exec, s[80:81]
    v_mov_b32 v117, 0
    v_mov_b32 v112, 0
    s_mov_b64 exec, vcc
    v_mov_b32 v117, 3

    s_mov_b64 exec, -1
    v_alignbyte_b32 v111, v112, v110, v117
    v_alignbyte_b32 v110, v110, v114, v117
    v_add_u32 v116, v116, v117

    buffer_store_dwordx2 v[110:111], v116, s[24:27], 0 offen
    v_cmp_ne_u32_sdwa s[80:81], v119, v121 src0_sel:WORD_1 src1_sel:WORD_1
    v_cmp_ne_u32_sdwa vcc, v119, v123 src0_sel:WORD_1 src1_sel:WORD_1
    v_alignbyte_b32 v122, v119, v122, 1
    s_mov_b32 s54, 76797
    v_perm_b32 v120, v120, v121, s45
    s_waitcnt lgkmcnt(0)
    v_add3_u32 v124, v124, v106, s54
    v_sub_u32 v125, 0, v124
    v_and_b32 v125, 3, v125
    s_mov_b64 exec, s[80:81]
    v_mov_b32 v125, 0
    v_mov_b32 v120, 0
    s_mov_b64 exec, vcc
    v_mov_b32 v125, 3

    s_mov_b64 exec, -1
    v_alignbyte_b32 v119, v120, v118, v125
    v_alignbyte_b32 v118, v118, v122, v125
    v_add_u32 v124, v124, v125

    buffer_store_dwordx2 v[118:119], v124, s[24:27], 0 offen
L_skw_38:
    s_waitcnt lgkmcnt(0)
    s_barrier

    s_bitcmp0_b32 s85, 0
    s_cbranch_scc1 L_skl_39
    buffer_load_dwordx4 v[20:23], v1, s[12:15], s56 offen nt
    buffer_load_dwordx4 v[4:7], v1, s[8:11], s56 offen nt
    buffer_load_dwordx2 v[36:37], v2, s[16:19], s61 offen nt
L_skl_39:
    s_bitcmp0_b32 s85, 1
    s_cbranch_scc1 L_skl_40
    buffer_load_dwordx4 v[24:27], v1, s[12:15], s57 offen nt
    buffer_load_dwordx4 v[8:11], v1, s[8:11], s57 offen nt
    buffer_load_dwordx2 v[38:39], v2, s[16:19], s62 offen nt
L_skl_40:
    ds_read_b64 v[94:95], v2
    s_waitcnt lgkmcnt(0)
    v_add_u32 v97, v94, v95
    s_nop 1
    v_add_u32_dpp v97, v97, v97 row_shr:1 row_mask:0xf bank_mask:0xf
    s_nop 1
    v_add_u32_dpp v97, v97, v97 row_shr:2 row_mask:0xf bank_mask:0xf
    s_nop 1
    v_add_u32_dpp v97, v97, v97 row_shr:4 row_mask:0xf bank_mask:0xf
    s_nop 1
    v_add_u32_dpp v97, v97, v97 row_shr:8 row_mask:0xf bank_mask:0xf
    s_nop 1
    v_add_u32_dpp v97, v97, v97 row_bcast:15 row_mask:0xa bank_mask:0xf
    s_nop 1
    v_add_u32_dpp v97, v97, v97 row_bcast:31 row_mask:0xc bank_mask:0xf
    s_mov_b32 exec_lo, 0
    s_brev_b32 exec_hi, 1
    ds_add_rtn_u32 v96, v108, v97
    s_mov_b64 exec, -1

    v_add_u32 v92, v94, v94
    v_add_u32 v93, v95, v95
    v_med3_u32 v92, v94, 2, v92
    v_med3_u32 v93, v95, 2, v93
    v_lshl_or_b32 v92, v93, 16, v92
    v_lshlrev_b32 v93, 2, v0
    buffer_atomic_add v92, v93, s[20:23], 0 offen sc0
    s_waitcnt lgkmcnt(0)
    v_readlane_b32 s77, v96, 63
    v_sub_u32 v97, v97, v95
    s_sub_u32 s50, s50, s83
    s_sub_u32 s77, s77, s50
    v_add_u32 v97, s77, v97
    v_sub_u32 v96, v97, v94
    v_lshlrev_b32 v111, 3, v97
    v_lshlrev_b32 v110, 3, v96
    v_mov_b32 v112, 0
    v_mov_b32 v113, 0
    ds_write_b64 v2, v[110:111] offset:8192
    ds_write_b64 v2, v[112:113]
    v_mad_i32_i24 v96, v96, -5, v102
    v_mad_i32_i24 v97, v97, -5, v103
    s_add_u32 s50, s50, s84
    s_mov_b32 s28, s82
    s_mov_b32 s29, s83
    s_mov_b32 s30, s84
    s_lshl_b32 s74, s29, 3
    s_lshl_b32 s75, s30, 3
    v_mov_b32 v125, s74
    v_mov_b32 v126, s75
    v_mov_b32 v127, -1

    s_waitcnt lgkmcnt(0)
    s_barrier

    s_mov_b64 exec, 1
    ds_write_b32 v125, v127 offset:24588
    ds_write_b32 v126, v127 offset:24596
    s_mov_b64 exec, -1

    s_bitcmp0_b32 s28, 0
    s_cbranch_scc1 L_skz_41
    v_lshrrev_b32 v110, 16, v45
    ds_read_b32 v110, v110 offset:8192
    v_lshrrev_b32 v111, 16, v47
    ds_read_b32 v111, v111 offset:8192
    v_lshrrev_b32 v112, 16, v49
    ds_read_b32 v112, v112 offset:8192
    v_lshrrev_b32 v113, 16, v51
    ds_read_b32 v113, v113 offset:8192
    v_lshrrev_b32 v114, 16, v53
    ds_read_b32 v114, v114 offset:8192
    v_lshrrev_b32 v115, 16, v55
    ds_read_b32 v115, v115 offset:8192
    v_lshrrev_b32 v116, 16, v57
    ds_read_b32 v116, v116 offset:8192
    v_lshrrev_b32 v117, 16, v59
    ds_read_b32 v117, v117 offset:8192
    s_waitcnt lgkmcnt(7)
    v_lshl_add_u32 v110, v76, 3, v110
    ds_write_b64 v110, v[44:45] offset:24592

    s_waitcnt lgkmcnt(7)
    v_lshl_add_u32 v111, v77, 3, v111
    ds_write_b64 v111, v[46:47] offset:24592

    s_waitcnt lgkmcnt(7)
    v_lshl_add_u32 v112, v78, 3, v112
    ds_write_b64 v112, v[48:49] offset:24592

    s_waitcnt lgkmcnt(7)
    v_lshl_add_u32 v113, v79, 3, v113
    ds_write_b64 v113, v[50:51] offset:24592

    s_waitcnt lgkmcnt(7)
    v_lshl_add_u32 v114, v80, 3, v114
    ds_write_b64 v114, v[52:53] offset:24592

    s_waitcnt lgkmcnt(7)
    v_lshl_add_u32 v115, v81, 3, v115
    ds_write_b64 v115, v[54:55] offset:24592

    s_waitcnt lgkmcnt(7)
    v_lshl_add_u32 v116, v82, 3, v116
    ds_write_b64 v116, v[56:57] offset:24592

    s_waitcnt lgkmcnt(7)
    v_lshl_add_u32 v117, v83, 3, v117
    ds_write_b64 v117, v[58:59] offset:24592

L_skz_41:
    s_bitcmp0_b32 s85, 2
    s_cbranch_scc1 L_skl_42
    buffer_load_dwordx4 v[28:31], v1, s[12:15], s58 offen nt
    buffer_load_dwordx4 v[12:15], v1, s[8:11], s58 offen nt
    buffer_load_dwordx2 v[40:41], v2, s[16:19], s63 offen nt
L_skl_42:
    s_bitcmp0_b32 s28, 2
    s_cbranch_scc1 L_skz_43
    v_lshrrev_b32 v110, 16, v61
    ds_read_b32 v110, v110 offset:8192
    v_lshrrev_b32 v111, 16, v63
    ds_read_b32 v111, v111 offset:8192
    v_lshrrev_b32 v112, 16, v65
    ds_read_b32 v112, v112 offset:8192
    v_lshrrev_b32 v113, 16, v67
    ds_read_b32 v113, v113 offset:8192
    s_waitcnt lgkmcnt(3)
    v_lshl_add_u32 v110, v84, 3, v110
    ds_write_b64 v110, v[60:61] offset:24592

    s_waitcnt lgkmcnt(3)
    v_lshl_add_u32 v111, v85, 3, v111
    ds_write_b64 v111, v[62:63] offset:24592

    s_waitcnt lgkmcnt(3)
    v_lshl_add_u32 v112, v86, 3, v112
    ds_write_b64 v112, v[64:65] offset:24592

    s_waitcnt lgkmcnt(3)
    v_lshl_add_u32 v113, v87, 3, v113
    ds_write_b64 v113, v[66:67] offset:24592

L_skz_43:
    s_bitcmp0_b32 s28, 3
    s_cbranch_scc1 L_skz_44
    s_mov_b64 exec, s[66:67]
    v_lshrrev_b32 v110, 16, v69
    ds_read_b32 v110, v110 offset:8192
    v_lshrrev_b32 v111, 16, v71
    ds_read_b32 v111, v111 offset:8192
    v_lshrrev_b32 v112, 16, v73
    ds_read_b32 v112, v112 offset:8192
    v_lshrrev_b32 v113, 16, v75
    ds_read_b32 v113, v113 offset:8192
    s_waitcnt lgkmcnt(3)
    v_lshl_add_u32 v110, v88, 3, v110
    ds_write_b64 v110, v[68:69] offset:24592

    s_waitcnt lgkmcnt(3)
    v_lshl_add_u32 v111, v89, 3, v111
    ds_write_b64 v111, v[70:71] offset:24592

    s_waitcnt lgkmcnt(3)
    v_lshl_add_u32 v112, v90, 3, v112
    ds_write_b64 v112, v[72:73] offset:24592

    s_waitcnt lgkmcnt(3)
    v_lshl_add_u32 v113, v91, 3, v113
    ds_write_b64 v113, v[74:75] offset:24592

    s_mov_b64 exec, -1
L_skz_44:
    s_bitcmp0_b32 s85, 3
    s_cbranch_scc1 L_skl_45
    buffer_load_dwordx4 v[32:35], v1, s[12:15], s59 offen nt
    buffer_load_dwordx4 v[16:19], v1, s[8:11], s59 offen nt
    buffer_load_dwordx2 v[42:43], v2, s[16:19], s64 offen nt
L_skl_45:
    s_cmp_lg_u32 s49, 0
    s_cbranch_scc1 L_p1loop_6
L_p1epi_7:
    s_waitcnt vmcnt(0)
    s_waitcnt vmcnt(4)
    v_lshrrev_b32 v93, 16, v92
    v_and_b32 v92, 0xffff, v92
    v_add_u32 v110, v92, v94
    v_mad_u32_u24 v92, v92, 5, v96
    v_add_u32 v111, v93, v95
    v_mad_u32_u24 v93, v93, 5, v97
    v_max_u32 v110, v110, v111
    v_cmp_le_u32 vcc, s48, v110
    s_cbranch_vccnz L_full_46
L_fback_47:
    ds_write_b64 v2, v[92:93] offset:16384

    s_waitcnt lgkmcnt(0)
    s_barrier

    s_bitcmp0_b32 s28, 0
    s_cbranch_scc1 L_skw_48
    ds_read_b64 v[4:5], v2 offset:24592
    ds_read_b64 v[6:7], v2 offset:24600
    ds_read_b64 v[8:9], v2 offset:24584

    ds_read_b64 v[12:13], v2 offset:32784
    ds_read_b64 v[14:15], v2 offset:32792
    ds_read_b64 v[16:17], v2 offset:32776

    ds_read_b64 v[20:21], v2 offset:40976
    ds_read_b64 v[22:23], v2 offset:40984
    ds_read_b64 v[24:25], v2 offset:40968

    ds_read_b64 v[28:29], v2 offset:49168
    ds_read_b64 v[30:31], v2 offset:49176
    ds_read_b64 v[32:33], v2 offset:49160

    s_waitcnt lgkmcnt(9)
    v_lshrrev_b32 v10, 16, v5
    ds_read_b32 v10, v10 offset:16384

    s_waitcnt lgkmcnt(7)
    v_lshrrev_b32 v18, 16, v13
    ds_read_b32 v18, v18 offset:16384

    s_waitcnt lgkmcnt(5)
    v_lshrrev_b32 v26, 16, v21
    ds_read_b32 v26, v26 offset:16384

    s_waitcnt lgkmcnt(3)
    v_lshrrev_b32 v34, 16, v29
    ds_read_b32 v34, v34 offset:16384

    v_cmp_ne_u32_sdwa s[80:81], v5, v7 src0_sel:WORD_1 src1_sel:WORD_1
    v_cmp_ne_u32_sdwa vcc, v5, v9 src0_sel:WORD_1 src1_sel:WORD_1
    v_alignbyte_b32 v8, v5, v8, 1
    s_mov_b32 s54, -3
    v_perm_b32 v6, v6, v7, s45
    s_waitcnt lgkmcnt(3)
    v_add3_u32 v10, v10, v106, s54
    v_sub_u32 v11, 0, v10
    v_and_b32 v11, 3, v11
    s_mov_b64 exec, s[80:81]
    v_mov_b32 v11, 0
    v_mov_b32 v6, 0
    s_mov_b64 exec, vcc
    v_mov_b32 v11, 3

    s_mov_b64 exec, -1
    v_alignbyte_b32 v5, v6, v4, v11
    v_alignbyte_b32 v4, v4, v8, v11
    v_add_u32 v10, v10, v11

    buffer_store_dwordx2 v[4:5], v10, s[24:27], 0 offen
    v_cmp_ne_u32_sdwa s[80:81], v13, v15 src0_sel:WORD_1 src1_sel:WORD_1
    v_cmp_ne_u32_sdwa vcc, v13, v17 src0_sel:WORD_1 src1_sel:WORD_1
    v_alignbyte_b32 v16, v13, v16, 1
    s_mov_b32 s54, 5117
    v_perm_b32 v14, v14, v15, s45
    s_waitcnt lgkmcnt(2)
    v_add3_u32 v18, v18, v106, s54
    v_sub_u32 v19, 0, v18
    v_and_b32 v19, 3, v19
    s_mov_b64 exec, s[80:81]
    v_mov_b32 v19, 0
    v_mov_b32 v14, 0
    s_mov_b64 exec, vcc
    v_mov_b32 v19, 3

    s_mov_b64 exec, -1
    v_alignbyte_b32 v13, v14, v12, v19
    v_alignbyte_b32 v12, v12, v16, v19
    v_add_u32 v18, v18, v19

    buffer_store_dwordx2 v[12:13], v18, s[24:27], 0 offen
    v_cmp_ne_u32_sdwa s[80:81], v21, v23 src0_sel:WORD_1 src1_sel:WORD_1
    v_cmp_ne_u32_sdwa vcc, v21, v25 src0_sel:WORD_1 src1_sel:WORD_1
    v_alignbyte_b32 v24, v21, v24, 1
    s_mov_b32 s54, 10237
    v_perm_b32 v22, v22, v23, s45
    s_waitcnt lgkmcnt(1)
    v_add3_u32 v26, v26, v106, s54
    v_sub_u32 v27, 0, v26
    v_and_b32 v27, 3, v27
    s_mov_b64 exec, s[80:81]
    v_mov_b32 v27, 0
    v_mov_b32 v22, 0
    s_mov_b64 exec, vcc
    v_mov_b32 v27, 3

    s_mov_b64 exec, -1
    v_alignbyte_b32 v21, v22, v20, v27
    v_alignbyte_b32 v20, v20, v24, v27
    v_add_u32 v26, v26, v27

    buffer_store_dwordx2 v[20:21], v26, s[24:27], 0 offen
    v_cmp_ne_u32_sdwa s[80:81], v29, v31 src0_sel:WORD_1 src1_sel:WORD_1
    v_cmp_ne_u32_sdwa vcc, v29, v33 src0_sel:WORD_1 src1_sel:WORD_1
    v_alignbyte_b32 v32, v29, v32, 1
    s_mov_b32 s54, 15357
    v_perm_b32 v30, v30, v31, s45
    s_waitcnt lgkmcnt(0)
    v_add3_u32 v34, v34, v106, s54
    v_sub_u32 v35, 0, v34
    v_and_b32 v35, 3, v35
    s_mov_b64 exec, s[80:81]
    v_mov_b32 v35, 0
    v_mov_b32 v30, 0
    s_mov_b64 exec, vcc
    v_mov_b32 v35, 3

    s_mov_b64 exec, -1
    v_alignbyte_b32 v29, v30, v28, v35
    v_alignbyte_b32 v28, v28, v32, v35
    v_add_u32 v34, v34, v35

    buffer_store_dwordx2 v[28:29], v34, s[24:27], 0 offen
L_skw_48:
    s_bitcmp0_b32 s28, 1
    s_cbranch_scc1 L_skw_49
    v_add_u32 v107, 32768, v2
    ds_read_b64 v[4:5], v107 offset:24592
    ds_read_b64 v[6:7], v107 offset:24600
    ds_read_b64 v[8:9], v107 offset:24584

    ds_read_b64 v[12:13], v107 offset:32784
    ds_read_b64 v[14:15], v107 offset:32792
    ds_read_b64 v[16:17], v107 offset:32776

    ds_read_b64 v[20:21], v107 offset:40976
    ds_read_b64 v[22:23], v107 offset:40984
    ds_read_b64 v[24:25], v107 offset:40968

    ds_read_b64 v[28:29], v107 offset:49168
    ds_read_b64 v[30:31], v107 offset:49176
    ds_read_b64 v[32:33], v107 offset:49160

    s_waitcnt lgkmcnt(9)
    v_lshrrev_b32 v10, 16, v5
    ds_read_b32 v10, v10 offset:16384

    s_waitcnt lgkmcnt(7)
    v_lshrrev_b32 v18, 16, v13
    ds_read_b32 v18, v18 offset:16384

    s_waitcnt lgkmcnt(5)
    v_lshrrev_b32 v26, 16, v21
    ds_read_b32 v26, v26 offset:16384

    s_waitcnt lgkmcnt(3)
    v_lshrrev_b32 v34, 16, v29
    ds_read_b32 v34, v34 offset:16384

    v_cmp_ne_u32_sdwa s[80:81], v5, v7 src0_sel:WORD_1 src1_sel:WORD_1
    v_cmp_ne_u32_sdwa vcc, v5, v9 src0_sel:WORD_1 src1_sel:WORD_1
    v_alignbyte_b32 v8, v5, v8, 1
    s_mov_b32 s54, 20477
    v_perm_b32 v6, v6, v7, s45
    s_waitcnt lgkmcnt(3)
    v_add3_u32 v10, v10, v106, s54
    v_sub_u32 v11, 0, v10
    v_and_b32 v11, 3, v11
    s_mov_b64 exec, s[80:81]
    v_mov_b32 v11, 0
    v_mov_b32 v6, 0
    s_mov_b64 exec, vcc
    v_mov_b32 v11, 3

    s_mov_b64 exec, -1
    v_alignbyte_b32 v5, v6, v4, v11
    v_alignbyte_b32 v4, v4, v8, v11
    v_add_u32 v10, v10, v11

    buffer_store_dwordx2 v[4:5], v10, s[24:27], 0 offen
    v_cmp_ne_u32_sdwa s[80:81], v13, v15 src0_sel:WORD_1 src1_sel:WORD_1
    v_cmp_ne_u32_sdwa vcc, v13, v17 src0_sel:WORD_1 src1_sel:WORD_1
    v_alignbyte_b32 v16, v13, v16, 1
    s_mov_b32 s54, 25597
    v_perm_b32 v14, v14, v15, s45
    s_waitcnt lgkmcnt(2)
    v_add3_u32 v18, v18, v106, s54
    v_sub_u32 v19, 0, v18
    v_and_b32 v19, 3, v19
    s_mov_b64 exec, s[80:81]
    v_mov_b32 v19, 0
    v_mov_b32 v14, 0
    s_mov_b64 exec, vcc
    v_mov_b32 v19, 3

    s_mov_b64 exec, -1
    v_alignbyte_b32 v13, v14, v12, v19
    v_alignbyte_b32 v12, v12, v16, v19
    v_add_u32 v18, v18, v19

    buffer_store_dwordx2 v[12:13], v18, s[24:27], 0 offen
    v_cmp_ne_u32_sdwa s[80:81], v21, v23 src0_sel:WORD_1 src1_sel:WORD_1
    v_cmp_ne_u32_sdwa vcc, v21, v25 src0_sel:WORD_1 src1_sel:WORD_1
    v_alignbyte_b32 v24, v21, v24, 1
    s_mov_b32 s54, 30717
    v_perm_b32 v22, v22, v23, s45
    s_waitcnt lgkmcnt(1)
    v_add3_u32 v26, v26, v106, s54
    v_sub_u32 v27, 0, v26
    v_and_b32 v27, 3, v27
    s_mov_b64 exec, s[80:81]
    v_mov_b32 v27, 0
    v_mov_b32 v22, 0
    s_mov_b64 exec, vcc
    v_mov_b32 v27, 3

    s_mov_b64 exec, -1
    v_alignbyte_b32 v21, v22, v20, v27
    v_alignbyte_b32 v20, v20, v24, v27
    v_add_u32 v26, v26, v27

    buffer_store_dwordx2 v[20:21], v26, s[24:27], 0 offen
    v_cmp_ne_u32_sdwa s[80:81], v29, v31 src0_sel:WORD_1 src1_sel:WORD_1
    v_cmp_ne_u32_sdwa vcc, v29, v33 src0_sel:WORD_1 src1_sel:WORD_1
    v_alignbyte_b32 v32, v29, v32, 1
    s_mov_b32 s54, 35837
    v_perm_b32 v30, v30, v31, s45
    s_waitcnt lgkmcnt(0)
    v_add3_u32 v34, v34, v106, s54
    v_sub_u32 v35, 0, v34
    v_and_b32 v35, 3, v35
    s_mov_b64 exec, s[80:81]
    v_mov_b32 v35, 0
    v_mov_b32 v30, 0
    s_mov_b64 exec, vcc
    v_mov_b32 v35, 3

    s_mov_b64 exec, -1
    v_alignbyte_b32 v29, v30, v28, v35
    v_alignbyte_b32 v28, v28, v32, v35
    v_add_u32 v34, v34, v35

    buffer_store_dwordx2 v[28:29], v34, s[24:27], 0 offen
L_skw_49:
    s_bitcmp0_b32 s28, 2
    s_cbranch_scc1 L_skw_50
    v_add_u32 v107, 65536, v2
    ds_read_b64 v[4:5], v107 offset:24592
    ds_read_b64 v[6:7], v107 offset:24600
    ds_read_b64 v[8:9], v107 offset:24584

    ds_read_b64 v[12:13], v107 offset:32784
    ds_read_b64 v[14:15], v107 offset:32792
    ds_read_b64 v[16:17], v107 offset:32776

    ds_read_b64 v[20:21], v107 offset:40976
    ds_read_b64 v[22:23], v107 offset:40984
    ds_read_b64 v[24:25], v107 offset:40968

    ds_read_b64 v[28:29], v107 offset:49168
    ds_read_b64 v[30:31], v107 offset:49176
    ds_read_b64 v[32:33], v107 offset:49160

    s_waitcnt lgkmcnt(9)
    v_lshrrev_b32 v10, 16, v5
    ds_read_b32 v10, v10 offset:16384

    s_waitcnt lgkmcnt(7)
    v_lshrrev_b32 v18, 16, v13
    ds_read_b32 v18, v18 offset:16384

    s_waitcnt lgkmcnt(5)
    v_lshrrev_b32 v26, 16, v21
    ds_read_b32 v26, v26 offset:16384

    s_waitcnt lgkmcnt(3)
    v_lshrrev_b32 v34, 16, v29
    ds_read_b32 v34, v34 offset:16384

    v_cmp_ne_u32_sdwa s[80:81], v5, v7 src0_sel:WORD_1 src1_sel:WORD_1
    v_cmp_ne_u32_sdwa vcc, v5, v9 src0_sel:WORD_1 src1_sel:WORD_1
    v_alignbyte_b32 v8, v5, v8, 1
    s_mov_b32 s54, 40957
    v_perm_b32 v6, v6, v7, s45
    s_waitcnt lgkmcnt(3)
    v_add3_u32 v10, v10, v106, s54
    v_sub_u32 v11, 0, v10
    v_and_b32 v11, 3, v11
    s_mov_b64 exec, s[80:81]
    v_mov_b32 v11, 0
    v_mov_b32 v6, 0
    s_mov_b64 exec, vcc
    v_mov_b32 v11, 3

    s_mov_b64 exec, -1
    v_alignbyte_b32 v5, v6, v4, v11
    v_alignbyte_b32 v4, v4, v8, v11
    v_add_u32 v10, v10, v11

    buffer_store_dwordx2 v[4:5], v10, s[24:27], 0 offen
    v_cmp_ne_u32_sdwa s[80:81], v13, v15 src0_sel:WORD_1 src1_sel:WORD_1
    v_cmp_ne_u32_sdwa vcc, v13, v17 src0_sel:WORD_1 src1_sel:WORD_1
    v_alignbyte_b32 v16, v13, v16, 1
    s_mov_b32 s54, 46077
    v_perm_b32 v14, v14, v15, s45
    s_waitcnt lgkmcnt(2)
    v_add3_u32 v18, v18, v106, s54
    v_sub_u32 v19, 0, v18
    v_and_b32 v19, 3, v19
    s_mov_b64 exec, s[80:81]
    v_mov_b32 v19, 0
    v_mov_b32 v14, 0
    s_mov_b64 exec, vcc
    v_mov_b32 v19, 3

    s_mov_b64 exec, -1
    v_alignbyte_b32 v13, v14, v12, v19
    v_alignbyte_b32 v12, v12, v16, v19
    v_add_u32 v18, v18, v19

    buffer_store_dwordx2 v[12:13], v18, s[24:27], 0 offen
    v_cmp_ne_u32_sdwa s[80:81], v21, v23 src0_sel:WORD_1 src1_sel:WORD_1
    v_cmp_ne_u32_sdwa vcc, v21, v25 src0_sel:WORD_1 src1_sel:WORD_1
    v_alignbyte_b32 v24, v21, v24, 1
    s_mov_b32 s54, 51197
    v_perm_b32 v22, v22, v23, s45
    s_waitcnt lgkmcnt(1)
    v_add3_u32 v26, v26, v106, s54
    v_sub_u32 v27, 0, v26
    v_and_b32 v27, 3, v27
    s_mov_b64 exec, s[80:81]
    v_mov_b32 v27, 0
    v_mov_b32 v22, 0
    s_mov_b64 exec, vcc
    v_mov_b32 v27, 3

    s_mov_b64 exec, -1
    v_alignbyte_b32 v21, v22, v20, v27
    v_alignbyte_b32 v20, v20, v24, v27
    v_add_u32 v26, v26, v27

    buffer_store_dwordx2 v[20:21], v26, s[24:27], 0 offen
    v_cmp_ne_u32_sdwa s[80:81], v29, v31 src0_sel:WORD_1 src1_sel:WORD_1
    v_cmp_ne_u32_sdwa vcc, v29, v33 src0_sel:WORD_1 src1_sel:WORD_1
    v_alignbyte_b32 v32, v29, v32, 1
    s_mov_b32 s54, 56317
    v_perm_b32 v30, v30, v31, s45
    s_waitcnt lgkmcnt(0)
    v_add3_u32 v34, v34, v106, s54
    v_sub_u32 v35, 0, v34
    v_and_b32 v35, 3, v35
    s_mov_b64 exec, s[80:81]
    v_mov_b32 v35, 0
    v_mov_b32 v30, 0
    s_mov_b64 exec, vcc
    v_mov_b32 v35, 3

    s_mov_b64 exec, -1
    v_alignbyte_b32 v29, v30, v28, v35
    v_alignbyte_b32 v28, v28, v32, v35
    v_add_u32 v34, v34, v35

    buffer_store_dwordx2 v[28:29], v34, s[24:27], 0 offen
L_skw_50:
    s_bitcmp0_b32 s28, 3
    s_cbranch_scc1 L_skw_51
    v_add_u32 v107, 98304, v2
    ds_read_b64 v[4:5], v107 offset:24592
    ds_read_b64 v[6:7], v107 offset:24600
    ds_read_b64 v[8:9], v107 offset:24584

    ds_read_b64 v[12:13], v107 offset:32784
    ds_read_b64 v[14:15], v107 offset:32792
    ds_read_b64 v[16:17], v107 offset:32776

    ds_read_b64 v[20:21], v107 offset:40976
    ds_read_b64 v[22:23], v107 offset:40984
    ds_read_b64 v[24:25], v107 offset:40968

    ds_read_b64 v[28:29], v107 offset:49168
    ds_read_b64 v[30:31], v107 offset:49176
    ds_read_b64 v[32:33], v107 offset:49160

    s_waitcnt lgkmcnt(9)
    v_lshrrev_b32 v10, 16, v5
    ds_read_b32 v10, v10 offset:16384

    s_waitcnt lgkmcnt(7)
    v_lshrrev_b32 v18, 16, v13
    ds_read_b32 v18, v18 offset:16384

    s_waitcnt lgkmcnt(5)
    v_lshrrev_b32 v26, 16, v21
    ds_read_b32 v26, v26 offset:16384

    s_waitcnt lgkmcnt(3)
    v_lshrrev_b32 v34, 16, v29
    ds_read_b32 v34, v34 offset:16384

    v_cmp_ne_u32_sdwa s[80:81], v5, v7 src0_sel:WORD_1 src1_sel:WORD_1
    v_cmp_ne_u32_sdwa vcc, v5, v9 src0_sel:WORD_1 src1_sel:WORD_1
    v_alignbyte_b32 v8, v5, v8, 1
    s_mov_b32 s54, 61437
    v_perm_b32 v6, v6, v7, s45
    s_waitcnt lgkmcnt(3)
    v_add3_u32 v10, v10, v106, s54
    v_sub_u32 v11, 0, v10
    v_and_b32 v11, 3, v11
    s_mov_b64 exec, s[80:81]
    v_mov_b32 v11, 0
    v_mov_b32 v6, 0
    s_mov_b64 exec, vcc
    v_mov_b32 v11, 3

    s_mov_b64 exec, -1
    v_alignbyte_b32 v5, v6, v4, v11
    v_alignbyte_b32 v4, v4, v8, v11
    v_add_u32 v10, v10, v11

    buffer_store_dwordx2 v[4:5], v10, s[24:27], 0 offen
    v_cmp_ne_u32_sdwa s[80:81], v13, v15 src0_sel:WORD_1 src1_sel:WORD_1
    v_cmp_ne_u32_sdwa vcc, v13, v17 src0_sel:WORD_1 src1_sel:WORD_1
    v_alignbyte_b32 v16, v13, v16, 1
    s_mov_b32 s54, 66557
    v_perm_b32 v14, v14, v15, s45
    s_waitcnt lgkmcnt(2)
    v_add3_u32 v18, v18, v106, s54
    v_sub_u32 v19, 0, v18
    v_and_b32 v19, 3, v19
    s_mov_b64 exec, s[80:81]
    v_mov_b32 v19, 0
    v_mov_b32 v14, 0
    s_mov_b64 exec, vcc
    v_mov_b32 v19, 3

    s_mov_b64 exec, -1
    v_alignbyte_b32 v13, v14, v12, v19
    v_alignbyte_b32 v12, v12, v16, v19
    v_add_u32 v18, v18, v19

    buffer_store_dwordx2 v[12:13], v18, s[24:27], 0 offen
    v_cmp_ne_u32_sdwa s[80:81], v21, v23 src0_sel:WORD_1 src1_sel:WORD_1
    v_cmp_ne_u32_sdwa vcc, v21, v25 src0_sel:WORD_1 src1_sel:WORD_1
    v_alignbyte_b32 v24, v21, v24, 1
    s_mov_b32 s54, 71677
    v_perm_b32 v22, v22, v23, s45
    s_waitcnt lgkmcnt(1)
    v_add3_u32 v26, v26, v106, s54
    v_sub_u32 v27, 0, v26
    v_and_b32 v27, 3, v27
    s_mov_b64 exec, s[80:81]
    v_mov_b32 v27, 0
    v_mov_b32 v22, 0
    s_mov_b64 exec, vcc
    v_mov_b32 v27, 3

    s_mov_b64 exec, -1
    v_alignbyte_b32 v21, v22, v20, v27
    v_alignbyte_b32 v20, v20, v24, v27
    v_add_u32 v26, v26, v27

    buffer_store_dwordx2 v[20:21], v26, s[24:27], 0 offen
    v_cmp_ne_u32_sdwa s[80:81], v29, v31 src0_sel:WORD_1 src1_sel:WORD_1
    v_cmp_ne_u32_sdwa vcc, v29, v33 src0_sel:WORD_1 src1_sel:WORD_1
    v_alignbyte_b32 v32, v29, v32, 1
    s_mov_b32 s54, 76797
    v_perm_b32 v30, v30, v31, s45
    s_waitcnt lgkmcnt(0)
    v_add3_u32 v34, v34, v106, s54
    v_sub_u32 v35, 0, v34
    v_and_b32 v35, 3, v35
    s_mov_b64 exec, s[80:81]
    v_mov_b32 v35, 0
    v_mov_b32 v30, 0
    s_mov_b64 exec, vcc
    v_mov_b32 v35, 3

    s_mov_b64 exec, -1
    v_alignbyte_b32 v29, v30, v28, v35
    v_alignbyte_b32 v28, v28, v32, v35
    v_add_u32 v34, v34, v35

    buffer_store_dwordx2 v[28:29], v34, s[24:27], 0 offen
L_skw_51:
L_p1done_1:
    s_endpgm

L_ska_8:
    v_bfrev_b32 v126, 1
    buffer_load_dword v3, v126, s[96:99], 0 offen
    buffer_load_dword v3, v126, s[96:99], 0 offen
    buffer_load_dword v3, v126, s[96:99], 0 offen
    s_branch L_bka_9
L_ska_10:
    v_bfrev_b32 v126, 1
    buffer_load_dword v3, v126, s[96:99], 0 offen
    buffer_load_dword v3, v126, s[96:99], 0 offen
    buffer_load_dword v3, v126, s[96:99], 0 offen
    s_branch L_bka_11
L_ska_12:
    v_bfrev_b32 v126, 1
    buffer_load_dword v3, v126, s[96:99], 0 offen
    buffer_load_dword v3, v126, s[96:99], 0 offen
    buffer_load_dword v3, v126, s[96:99], 0 offen
    s_branch L_bka_13
L_ska_14:
    v_bfrev_b32 v126, 1
    buffer_load_dword v3, v126, s[96:99], 0 offen
    buffer_load_dword v3, v126, s[96:99], 0 offen
    buffer_load_dword v3, v126, s[96:99], 0 offen
    s_branch L_bka_15
L_full_28:
    v_mov_b32 v110, 0
    s_mov_b64 exec, vcc
    v_bfrev_b32 v92, 1
    v_bfrev_b32 v93, 1
    s_mov_b64 exec, 1
    buffer_atomic_or v104, v110, s[36:39], 0 offen
    s_mov_b64 exec, -1
    s_branch L_fback_29

L_full_46:
    v_mov_b32 v110, 0
    s_mov_b64 exec, vcc
    v_bfrev_b32 v92, 1
    v_bfrev_b32 v93, 1
    s_mov_b64 exec, 1
    buffer_atomic_or v104, v110, s[36:39], 0 offen
    s_mov_b64 exec, -1
    s_branch L_fback_47

.globl standalone__molecular_angular_gemnet__graph_kernel
.p2align 8
.type standalone__molecular_angular_gemnet__graph_kernel,@function
standalone__molecular_angular_gemnet__graph_kernel:
    s_cmp_ge_u32 s2, 256
    s_cbranch_scc1 L_p2done_52
    s_load_dwordx2 s[8:9], s[0:1], 0
    s_load_dwordx2 s[6:7], s[0:1], 104
    v_lshrrev_b32 v4, 6, v0
    s_lshr_b32 s37, s2, 1
    s_and_b32 s37, s37, 3
    s_lshr_b32 s36, s2, 3
    s_lshl_b32 s36, s36, 1
    s_and_b32 s3, s2, 1
    s_or_b32 s36, s36, s3
    v_readfirstlane_b32 s4, v4
    v_and_b32 v2, 63, v0
    v_lshrrev_b32 v3, 9, v0
    v_lshl_or_b32 v2, v3, 6, v2
    v_mul_u32_u24 v2, 20, v2
    v_lshlrev_b32 v3, 4, v0

    s_waitcnt lgkmcnt(0)
    s_lshl_b32 m0, s4, 10
    s_mov_b32 s25, s4
    s_and_b32 s5, s4, 7
    s_lshr_b32 s39, s4, 3
    s_lshl_b32 s39, s39, 8
    s_mul_i32 s3, s5, 4096
    s_add_u32 s46, s6, s3
    s_addc_u32 s47, s7, 0
    s_mul_i32 s3, s5, 67117056
    s_add_u32 s3, s3, 85721088
    s_add_u32 s44, s6, s3
    s_addc_u32 s45, s7, 0
    s_mul_i32 s38, s37, 8
    s_add_u32 s4, s38, 8
    s_lshl_b32 s3, s36, 5
    s_add_u32 s3, s3, s38
    s_lshl_b32 s3, s3, 1
    s_load_dwordx4 s[92:95], s[46:47], s3
    s_mov_b32 s3, 32768
    s_load_dword s51, s[6:7], s3
    s_mov_b32 s10, 6400000
    s_mov_b32 s11, 0x20000

    s_add_u32 s12, s6, 2490368
    s_addc_u32 s13, s7, 0
    s_mov_b32 s14, 0
    s_mov_b32 s15, 0x20000
    s_add_u32 s60, s6, 2490368
    s_addc_u32 s61, s7, 0
    s_mov_b32 s62, 6406144
    s_mov_b32 s63, 0x20000
    s_mov_b32 s3, 135176
    s_load_dword s33, s[6:7], s3

    s_mul_i32 s43, s38, 200192
    s_mul_i32 s41, s4, 200192
    s_mul_i32 s50, s38, 200000
    s_add_u32 s14, s43, 50000

    s_add_u32 s52, s43, 49152
    s_cmp_ge_u32 s25, 4
    s_cbranch_scc1 L_sk3_54
    v_lshlrev_b32 v119, 2, v0
    buffer_load_dword v88, v119, s[12:15], s52 offen
L_sk3_54:
    buffer_load_dwordx4 v[76:79], v3, s[12:15], s43 offen
    s_add_u32 s52, s43, 16384
    buffer_load_dwordx4 v[80:83], v3, s[12:15], s52 offen
    s_add_u32 s52, s43, 32768
    buffer_load_dwordx4 v[84:87], v3, s[12:15], s52 offen
    s_add_u32 s20, s6, 135168
    s_addc_u32 s21, s7, 0
    s_mov_b32 s22, 4096
    s_mov_b32 s23, 0x20000
    v_and_b32 v44, 63, v0
    v_lshlrev_b32 v44, 4, v44
    buffer_load_dwordx2 v[120:121], v44, s[20:23], 0 offen offset:0
    buffer_load_dwordx2 v[122:123], v44, s[20:23], 0 offen offset:1024
    buffer_load_dwordx2 v[124:125], v44, s[20:23], 0 offen offset:2048
    buffer_load_dwordx2 v[126:127], v44, s[20:23], 0 offen offset:3072
    s_movk_i32 s40, 3072
    s_mov_b32 s19, 0x20000
    s_min_u32 s40, s40, 6524
    s_lshl_b32 s52, s38, 6
    s_add_u32 s52, s52, s36
    s_mul_i32 s52, s52, 32764
    s_and_b32 s52, s52, 0xffffff80
    s_add_u32 s16, s44, s52
    s_addc_u32 s17, s45, 0
    s_mul_i32 s52, s40, 5
    s_add_u32 s52, s52, 3
    s_and_b32 s18, s52, -4

    s_movk_i32 s53, 5120
    buffer_load_dwordx4 v[90:93], v2, s[16:19], s53 offen offset:4
    buffer_load_dword v110, v2, s[16:19], s53 offen
    s_movk_i32 s53, 7680
    buffer_load_dwordx4 v[94:97], v2, s[16:19], s53 offen offset:4
    buffer_load_dword v111, v2, s[16:19], s53 offen
    s_movk_i32 s53, 10240
    buffer_load_dwordx4 v[98:101], v2, s[16:19], s53 offen offset:4
    buffer_load_dword v112, v2, s[16:19], s53 offen
    s_lshr_b32 s3, s2, 3
    s_mul_i32 s3, s3, 49
    v_add_lshl_u32 v89, v0, s3, 7
    v_cmp_gt_u32 vcc, 49, v0
    v_bfrev_b32 v28, 1
    s_nop 0
    v_cndmask_b32 v89, v28, v89, vcc

    s_mov_b32 s19, 0x20000
    s_mov_b32 s28, 0x4b404000
    s_mov_b32 s29, 0x4b404000
    s_mov_b32 s30, 0xbfffc000
    s_mov_b32 s31, 0xbfffbfff
    s_mov_b32 s32, 0xffff0000
    s_mov_b32 s35, 0x05040100
    s_mov_b32 s97, 0x07060302
    s_mov_b32 s96, 0x40008000
    s_movk_i32 s3, 212
    v_cmp_gt_u32 s[48:49], s3, v0

    v_mov_b32 v1, 0
    s_mov_b32 s24, 0x0c0c0004
    v_mov_b32 v28, 0x40004000
    v_mov_b32 v29, 0x40004000
    v_mov_b32 v30, 0x40004000
    v_mov_b32 v31, 0x40004000
    v_add_u32 v32, 50000, v3
    v_add_u32 v33, 65536, v32

    ds_write_b128 v32, v[28:31] offset:0
    ds_write_b128 v32, v[28:31] offset:16384
    ds_write_b128 v32, v[28:31] offset:32768
    ds_write_b128 v32, v[28:31] offset:49152
    ds_write_b128 v33, v[28:31] offset:0
    ds_write_b128 v33, v[28:31] offset:16384
    v_cmp_gt_u32 vcc, 971, v0
    s_mov_b64 exec, vcc
    ds_write_b128 v33, v[28:31] offset:32768
    s_mov_b64 exec, -1
    s_waitcnt vmcnt(12)
    ds_write_addtid_b32 v76 offset:0
    ds_write_addtid_b32 v77 offset:256
    ds_write_addtid_b32 v78 offset:512
    ds_write_addtid_b32 v79 offset:768
    s_waitcnt vmcnt(11)
    ds_write_addtid_b32 v80 offset:16384
    ds_write_addtid_b32 v81 offset:16640
    ds_write_addtid_b32 v82 offset:16896
    ds_write_addtid_b32 v83 offset:17152
    s_waitcnt vmcnt(10)
    ds_write_addtid_b32 v84 offset:32768
    ds_write_addtid_b32 v85 offset:33024
    ds_write_addtid_b32 v86 offset:33280
    ds_write_addtid_b32 v87 offset:33536
    v_lshlrev_b32 v119, 2, v0
    s_waitcnt vmcnt(13)
    s_mov_b64 exec, s[48:49]
    ds_write_b32 v119, v88 offset:49152
    s_mov_b64 exec, -1
    s_add_u32 s43, s43, 50048
    s_add_u32 s14, s43, 50000
    s_min_u32 s14, s14, s41
    s_waitcnt lgkmcnt(0)
    s_and_b32 s88, s92, 0xffff
    s_lshr_b32 s89, s92, 16
    s_and_b32 s90, s93, 0xffff
    s_lshr_b32 s91, s93, 16
    s_and_b32 s92, s94, 0xffff
    s_lshr_b32 s93, s94, 16
    s_and_b32 s94, s95, 0xffff
    s_lshr_b32 s95, s95, 16
    s_waitcnt vmcnt(6)
    v_max3_u32 v120, v120, v122, v124
    v_add_f32 v121, v121, v123
    v_add_f32 v125, v125, v127
    v_max_u32 v120, v120, v126
    v_add_f32 v121, v121, v125

    s_nop 1
    v_max_u32_dpp v120, v120, v120 row_shr:1 row_mask:0xf bank_mask:0xf
    s_nop 1
    v_max_u32_dpp v120, v120, v120 row_shr:2 row_mask:0xf bank_mask:0xf
    s_nop 1
    v_max_u32_dpp v120, v120, v120 row_shr:4 row_mask:0xf bank_mask:0xf
    s_nop 1
    v_max_u32_dpp v120, v120, v120 row_shr:8 row_mask:0xf bank_mask:0xf
    s_nop 1
    v_max_u32_dpp v120, v120, v120 row_bcast:15 row_mask:0xa bank_mask:0xf
    s_nop 1
    v_max_u32_dpp v120, v120, v120 row_bcast:31 row_mask:0xc bank_mask:0xf
    s_nop 1
    v_add_f32_dpp v121, v121, v121 row_shr:1 row_mask:0xf bank_mask:0xf
    s_nop 1
    v_add_f32_dpp v121, v121, v121 row_shr:2 row_mask:0xf bank_mask:0xf
    s_nop 1
    v_add_f32_dpp v121, v121, v121 row_shr:4 row_mask:0xf bank_mask:0xf
    s_nop 1
    v_add_f32_dpp v121, v121, v121 row_shr:8 row_mask:0xf bank_mask:0xf
    s_nop 1
    v_add_f32_dpp v121, v121, v121 row_bcast:15 row_mask:0xa bank_mask:0xf
    s_nop 1
    v_add_f32_dpp v121, v121, v121 row_bcast:31 row_mask:0xc bank_mask:0xf
    v_lshlrev_b32 v120, 16, v120
    v_mul_f32 v121, 0x34a7c5ac, v121
    v_sqrt_f32 v121, v121
    v_mul_f32 v120, s33, v120
    v_mul_f32 v121, s33, v121
    v_cmp_gt_f32 vcc, 0x46fde800, v120
    s_mov_b64 s[64:65], vcc
    v_cmp_lt_f32 vcc, 0x44000000, v121
    v_mov_b32 v120, 0x37800000
    v_mul_f32 v120, s33, v120
    s_and_b64 vcc, vcc, s[64:65]
    v_mul_f32 v121, 0x46ff8000, v120
    v_rcp_f32 v121, v121
    v_readfirstlane_b32 s33, v120
    s_waitcnt lgkmcnt(0)
    s_barrier
    v_readfirstlane_b32 s34, v121
    v_mov_b32 v120, 150016
    v_mov_b32 v121, 0
    ds_write_b32 v120, v121 offset:8
    s_bitcmp0_b64 vcc, 63
    s_cbranch_scc1 L_p2slow_53
    s_cmp_lg_u32 s51, 0
    s_cbranch_scc1 L_p2slow_53

    s_min_u32 s88, s88, 6524
    s_lshl_b32 s52, s38, 6
    s_add_u32 s52, s52, s36
    s_mul_i32 s52, s52, 32764
    s_and_b32 s52, s52, 0xffffff80
    s_add_u32 s16, s44, s52
    s_addc_u32 s17, s45, 0
    s_mul_i32 s52, s88, 5
    s_add_u32 s52, s52, 3
    s_and_b32 s18, s52, -4

    s_movk_i32 s53, 12800
    buffer_load_dwordx4 v[102:105], v2, s[16:19], s53 offen offset:4
    buffer_load_dword v113, v2, s[16:19], s53 offen
    s_movk_i32 s53, 0
    buffer_load_dwordx4 v[4:7], v2, s[16:19], s53 offen offset:4 nt
    buffer_load_dword v35, v2, s[16:19], s53 offen nt
    s_movk_i32 s53, 2560
    buffer_load_dwordx4 v[8:11], v2, s[16:19], s53 offen offset:4
    buffer_load_dword v43, v2, s[16:19], s53 offen
    s_sub_u32 s53, s88, s39
    s_cmp_le_i32 s53, 3072
    s_cbranch_scc1 L_skt_61
    s_movk_i32 s53, 15360
    buffer_load_dwordx4 v[106:109], v2, s[16:19], s53 offen offset:4
    buffer_load_dword v114, v2, s[16:19], s53 offen
L_skt_61:
    s_mov_b32 s40, s88
    s_sub_u32 s42, s40, s39

    s_add_u32 s55, s38, 1
    s_min_u32 s55, s55, 31
    s_mov_b32 s88, s89
    s_mov_b32 s89, s90
    s_mov_b32 s90, s91
    s_mov_b32 s91, s92
    s_mov_b32 s92, s93
    s_mov_b32 s93, s94
    s_mov_b32 s94, s95
    s_mov_b32 s95, 0
    s_min_u32 s88, s88, 6524
    s_lshl_b32 s52, s55, 6
    s_add_u32 s52, s52, s36
    s_mul_i32 s52, s52, 32764
    s_and_b32 s52, s52, 0xffffff80
    s_add_u32 s16, s44, s52
    s_addc_u32 s17, s45, 0
    s_mul_i32 s52, s88, 5
    s_add_u32 s52, s52, 3
    s_and_b32 s18, s52, -4

    s_waitcnt vmcnt(10)
    v_lshlrev_b32_sdwa v44, 3, v110 dst_sel:WORD_0 dst_unused:UNUSED_PAD src0_sel:DWORD src1_sel:DWORD
    v_lshrrev_b32 v46, 5, v90
    v_lshlrev_b32_sdwa v48, 3, v91 dst_sel:WORD_0 dst_unused:UNUSED_PAD src0_sel:DWORD src1_sel:WORD_1
    v_alignbit_b32 v50, v93, v92, 21

    v_mov_b32 v15, v93
    v_alignbyte_b32 v14, v92, v91, 3
    v_alignbyte_b32 v13, v91, v90, 2
    v_alignbyte_b32 v12, v90, v110, 1
    v_and_b32 v46, 0xfff8, v46
    v_and_b32 v50, 0xfff8, v50
    s_cmp_lt_i32 s42, 1280
    s_cbranch_scc1 L_ufix_62
L_uback_63:

    v_subrev_co_u32 v12, s[80:81], 2.0, v12
    v_subrev_co_u32 v13, s[82:83], 2.0, v13
    v_subrev_co_u32 v14, s[84:85], 2.0, v14
    v_subrev_co_u32 v15, s[86:87], 2.0, v15
    s_mov_b64 exec, s[80:81]
    ds_read_b64 v[44:45], v44
    s_mov_b64 exec, s[82:83]
    ds_read_b64 v[46:47], v46
    s_mov_b64 exec, s[84:85]
    ds_read_b64 v[48:49], v48
    s_mov_b64 exec, s[86:87]
    ds_read_b64 v[50:51], v50
    s_mov_b64 exec, -1
    s_waitcnt vmcnt(8)
    v_lshlrev_b32_sdwa v52, 3, v111 dst_sel:WORD_0 dst_unused:UNUSED_PAD src0_sel:DWORD src1_sel:DWORD
    v_lshrrev_b32 v54, 5, v94
    v_lshlrev_b32_sdwa v56, 3, v95 dst_sel:WORD_0 dst_unused:UNUSED_PAD src0_sel:DWORD src1_sel:WORD_1
    v_alignbit_b32 v58, v97, v96, 21

    v_mov_b32 v19, v97
    v_alignbyte_b32 v18, v96, v95, 3
    v_alignbyte_b32 v17, v95, v94, 2
    v_alignbyte_b32 v16, v94, v111, 1
    v_and_b32 v54, 0xfff8, v54
    v_and_b32 v58, 0xfff8, v58
    s_cmp_lt_i32 s42, 1792
    s_cbranch_scc1 L_ufix_64
L_uback_65:

    v_subrev_co_u32 v16, s[64:65], 2.0, v16
    v_subrev_co_u32 v17, s[66:67], 2.0, v17
    v_subrev_co_u32 v18, s[68:69], 2.0, v18
    v_subrev_co_u32 v19, s[70:71], 2.0, v19
    s_mov_b64 exec, s[64:65]
    ds_read_b64 v[52:53], v52
    s_mov_b64 exec, s[66:67]
    ds_read_b64 v[54:55], v54
    s_mov_b64 exec, s[68:69]
    ds_read_b64 v[56:57], v56
    s_mov_b64 exec, s[70:71]
    ds_read_b64 v[58:59], v58
    s_mov_b64 exec, -1
    s_waitcnt vmcnt(6)
    v_lshlrev_b32_sdwa v60, 3, v112 dst_sel:WORD_0 dst_unused:UNUSED_PAD src0_sel:DWORD src1_sel:DWORD
    v_lshrrev_b32 v62, 5, v98
    v_lshlrev_b32_sdwa v64, 3, v99 dst_sel:WORD_0 dst_unused:UNUSED_PAD src0_sel:DWORD src1_sel:WORD_1
    v_alignbit_b32 v66, v101, v100, 21

    v_mov_b32 v23, v101
    v_alignbyte_b32 v22, v100, v99, 3
    v_alignbyte_b32 v21, v99, v98, 2
    v_alignbyte_b32 v20, v98, v112, 1
    v_and_b32 v62, 0xfff8, v62
    v_and_b32 v66, 0xfff8, v66
    s_cmp_lt_i32 s42, 2304
    s_cbranch_scc1 L_ufix_66
L_uback_67:

    v_subrev_co_u32 v20, s[72:73], 2.0, v20
    v_subrev_co_u32 v21, s[74:75], 2.0, v21
    v_subrev_co_u32 v22, s[76:77], 2.0, v22
    v_subrev_co_u32 v23, s[78:79], 2.0, v23
    s_mov_b64 exec, s[72:73]
    ds_read_b64 v[60:61], v60
    s_mov_b64 exec, s[74:75]
    ds_read_b64 v[62:63], v62
    s_mov_b64 exec, s[76:77]
    ds_read_b64 v[64:65], v64
    s_mov_b64 exec, s[78:79]
    ds_read_b64 v[66:67], v66
    s_mov_b64 exec, -1
    s_waitcnt vmcnt(4)
    v_lshlrev_b32_sdwa v68, 3, v113 dst_sel:WORD_0 dst_unused:UNUSED_PAD src0_sel:DWORD src1_sel:DWORD
    v_lshrrev_b32 v70, 5, v102
    v_lshlrev_b32_sdwa v72, 3, v103 dst_sel:WORD_0 dst_unused:UNUSED_PAD src0_sel:DWORD src1_sel:WORD_1
    v_alignbit_b32 v74, v105, v104, 21

    v_mov_b32 v27, v105
    v_alignbyte_b32 v26, v104, v103, 3
    v_alignbyte_b32 v25, v103, v102, 2
    v_alignbyte_b32 v24, v102, v113, 1
    v_and_b32 v70, 0xfff8, v70
    v_and_b32 v74, 0xfff8, v74
    s_cmp_lt_i32 s42, 2816
    s_cbranch_scc1 L_ufix_68
L_uback_69:

    v_subrev_co_u32 v24, s[80:81], 2.0, v24
    v_subrev_co_u32 v25, s[82:83], 2.0, v25
    v_subrev_co_u32 v26, s[84:85], 2.0, v26
    v_subrev_co_u32 v27, s[86:87], 2.0, v27
    s_mov_b64 exec, s[80:81]
    ds_read_b64 v[68:69], v68
    s_mov_b64 exec, s[82:83]
    ds_read_b64 v[70:71], v70
    s_mov_b64 exec, s[84:85]
    ds_read_b64 v[72:73], v72
    s_mov_b64 exec, s[86:87]
    ds_read_b64 v[74:75], v74
    s_mov_b64 exec, -1
    s_waitcnt vmcnt(2)
    v_lshlrev_b32_sdwa v28, 3, v35 dst_sel:WORD_0 dst_unused:UNUSED_PAD src0_sel:DWORD src1_sel:DWORD
    v_lshrrev_b32 v30, 5, v4
    v_lshlrev_b32_sdwa v32, 3, v5 dst_sel:WORD_0 dst_unused:UNUSED_PAD src0_sel:DWORD src1_sel:WORD_1
    v_alignbit_b32 v34, v7, v6, 21

    v_alignbyte_b32 v6, v6, v5, 3
    v_alignbyte_b32 v5, v5, v4, 2
    v_alignbyte_b32 v4, v4, v35, 1
    v_and_b32 v30, 0xfff8, v30
    v_and_b32 v34, 0xfff8, v34
    s_cmp_lt_i32 s42, 256
    s_cbranch_scc1 L_ufix_70
L_uback_71:

    v_subrev_co_u32 v4, s[64:65], 2.0, v4
    v_subrev_co_u32 v5, s[66:67], 2.0, v5
    v_subrev_co_u32 v6, s[68:69], 2.0, v6
    v_subrev_co_u32 v7, s[70:71], 2.0, v7
    s_mov_b64 exec, s[64:65]
    ds_read_b64 v[28:29], v28
    s_mov_b64 exec, s[66:67]
    ds_read_b64 v[30:31], v30
    s_mov_b64 exec, s[68:69]
    ds_read_b64 v[32:33], v32
    s_mov_b64 exec, s[70:71]
    ds_read_b64 v[34:35], v34
    s_mov_b64 exec, -1
    s_add_u32 s52, s43, 49152
    s_cmp_ge_u32 s25, 4
    s_cbranch_scc1 L_sk3_72
    v_lshlrev_b32 v119, 2, v0
    buffer_load_dword v88, v119, s[12:15], s52 offen
L_sk3_72:
    buffer_load_dwordx4 v[76:79], v3, s[12:15], s43 offen
    s_add_u32 s52, s43, 16384
    buffer_load_dwordx4 v[80:83], v3, s[12:15], s52 offen
    s_add_u32 s52, s43, 32768
    buffer_load_dwordx4 v[84:87], v3, s[12:15], s52 offen
    s_cmp_lg_u32 s25, 0
    s_cbranch_scc1 L_skw_73
    s_add_u32 s54, s43, 50048
    buffer_load_dword v115, v89, s[60:63], s54 offen
    s_add_u32 s54, s50, 0
    buffer_load_dword v115, v89, s[8:11], s54 offen
L_skw_73:
    s_waitcnt vmcnt(3)
    v_lshlrev_b32_sdwa v36, 3, v43 dst_sel:WORD_0 dst_unused:UNUSED_PAD src0_sel:DWORD src1_sel:DWORD
    v_lshrrev_b32 v38, 5, v8
    v_lshlrev_b32_sdwa v40, 3, v9 dst_sel:WORD_0 dst_unused:UNUSED_PAD src0_sel:DWORD src1_sel:WORD_1
    v_alignbit_b32 v42, v11, v10, 21

    v_alignbyte_b32 v10, v10, v9, 3
    v_alignbyte_b32 v9, v9, v8, 2
    v_alignbyte_b32 v8, v8, v43, 1
    v_and_b32 v38, 0xfff8, v38
    v_and_b32 v42, 0xfff8, v42
    s_cmp_lt_i32 s42, 768
    s_cbranch_scc1 L_ufix_74
L_uback_75:

    v_subrev_co_u32 v8, s[72:73], 2.0, v8
    v_subrev_co_u32 v9, s[74:75], 2.0, v9
    v_subrev_co_u32 v10, s[76:77], 2.0, v10
    v_subrev_co_u32 v11, s[78:79], 2.0, v11
    s_mov_b64 exec, s[72:73]
    ds_read_b64 v[36:37], v36
    s_mov_b64 exec, s[74:75]
    ds_read_b64 v[38:39], v38
    s_mov_b64 exec, s[76:77]
    ds_read_b64 v[40:41], v40
    s_mov_b64 exec, s[78:79]
    ds_read_b64 v[42:43], v42
    s_mov_b64 exec, -1
    s_movk_i32 s53, 5120
    buffer_load_dwordx4 v[90:93], v2, s[16:19], s53 offen offset:4
    buffer_load_dword v110, v2, s[16:19], s53 offen
L_batch_77:
    s_add_u32 s5, s38, 1

    s_movk_i32 s53, 7680
    buffer_load_dwordx4 v[94:97], v2, s[16:19], s53 offen offset:4
    buffer_load_dword v111, v2, s[16:19], s53 offen
    v_subrev_co_u32 v4, s[64:65], 2.0, v4
    v_subrev_co_u32 v5, s[66:67], 2.0, v5
    v_subrev_co_u32 v6, s[68:69], 2.0, v6
    v_subrev_co_u32 v7, s[70:71], 2.0, v7
    v_subrev_co_u32 v8, s[72:73], 2.0, v8
    v_subrev_co_u32 v9, s[74:75], 2.0, v9
    v_subrev_co_u32 v10, s[76:77], 2.0, v10
    v_subrev_co_u32 v11, s[78:79], 2.0, v11
    v_subrev_co_u32 v12, s[80:81], 2.0, v12
    v_subrev_co_u32 v13, s[82:83], 2.0, v13
    v_subrev_co_u32 v14, s[84:85], 2.0, v14
    v_subrev_co_u32 v15, s[86:87], 2.0, v15
    s_waitcnt lgkmcnt(0)
    s_barrier
    s_waitcnt vmcnt(4)
    ds_write_addtid_b32 v76 offset:0
    ds_write_addtid_b32 v77 offset:256
    ds_write_addtid_b32 v78 offset:512
    ds_write_addtid_b32 v79 offset:768
    s_waitcnt vmcnt(3)
    ds_write_addtid_b32 v80 offset:16384
    ds_write_addtid_b32 v81 offset:16640
    ds_write_addtid_b32 v82 offset:16896
    ds_write_addtid_b32 v83 offset:17152
    s_waitcnt vmcnt(2)
    ds_write_addtid_b32 v84 offset:32768
    ds_write_addtid_b32 v85 offset:33024
    ds_write_addtid_b32 v86 offset:33280
    ds_write_addtid_b32 v87 offset:33536
    v_lshlrev_b32 v119, 2, v0
    s_waitcnt vmcnt(5)
    s_mov_b64 exec, s[48:49]
    ds_write_b32 v119, v88 offset:49152
    s_mov_b64 exec, -1
    s_add_u32 s43, s43, 50048
    s_add_u32 s14, s43, 50000
    s_min_u32 s14, s14, s41
    s_add_u32 s52, s43, 49152
    s_cmp_ge_u32 s25, 4
    s_cbranch_scc1 L_sk3_83
    v_lshlrev_b32 v119, 2, v0
    buffer_load_dword v88, v119, s[12:15], s52 offen
L_sk3_83:
    buffer_load_dwordx4 v[76:79], v3, s[12:15], s43 offen
    s_waitcnt lgkmcnt(0)
    s_barrier
    s_add_u32 s52, s43, 16384
    buffer_load_dwordx4 v[80:83], v3, s[12:15], s52 offen
    s_add_u32 s52, s43, 32768
    buffer_load_dwordx4 v[84:87], v3, s[12:15], s52 offen
    s_mov_b64 exec, s[64:65]
    ds_read_b64 v[28:29], v28
    s_mov_b64 exec, s[66:67]
    ds_read_b64 v[30:31], v30
    s_mov_b64 exec, s[68:69]
    ds_read_b64 v[32:33], v32
    s_mov_b64 exec, s[70:71]
    ds_read_b64 v[34:35], v34
    s_mov_b64 exec, s[72:73]
    ds_read_b64 v[36:37], v36
    s_mov_b64 exec, s[74:75]
    ds_read_b64 v[38:39], v38
    s_mov_b64 exec, s[76:77]
    ds_read_b64 v[40:41], v40
    s_mov_b64 exec, s[78:79]
    ds_read_b64 v[42:43], v42
    s_mov_b64 exec, s[80:81]
    ds_read_b64 v[44:45], v44
    s_mov_b64 exec, s[82:83]
    ds_read_b64 v[46:47], v46
    s_mov_b64 exec, s[84:85]
    ds_read_b64 v[48:49], v48
    s_mov_b64 exec, s[86:87]
    ds_read_b64 v[50:51], v50
    s_mov_b64 exec, -1
    v_subrev_co_u32 v16, s[64:65], 2.0, v16
    v_subrev_co_u32 v17, s[66:67], 2.0, v17
    v_subrev_co_u32 v18, s[68:69], 2.0, v18
    v_subrev_co_u32 v19, s[70:71], 2.0, v19
    v_subrev_co_u32 v20, s[72:73], 2.0, v20
    v_subrev_co_u32 v21, s[74:75], 2.0, v21
    v_subrev_co_u32 v22, s[76:77], 2.0, v22
    v_subrev_co_u32 v23, s[78:79], 2.0, v23
    v_subrev_co_u32 v24, s[80:81], 2.0, v24
    v_subrev_co_u32 v25, s[82:83], 2.0, v25
    v_subrev_co_u32 v26, s[84:85], 2.0, v26
    v_subrev_co_u32 v27, s[86:87], 2.0, v27
    s_mov_b64 exec, s[64:65]
    ds_read_b64 v[52:53], v52
    s_mov_b64 exec, s[66:67]
    ds_read_b64 v[54:55], v54
    s_mov_b64 exec, s[68:69]
    ds_read_b64 v[56:57], v56
    s_mov_b64 exec, s[70:71]
    ds_read_b64 v[58:59], v58
    s_mov_b64 exec, s[72:73]
    ds_read_b64 v[60:61], v60
    s_mov_b64 exec, s[74:75]
    ds_read_b64 v[62:63], v62
    s_mov_b64 exec, s[76:77]
    ds_read_b64 v[64:65], v64
    s_mov_b64 exec, s[78:79]
    ds_read_b64 v[66:67], v66
    s_mov_b64 exec, s[80:81]
    ds_read_b64 v[68:69], v68
    s_mov_b64 exec, s[82:83]
    ds_read_b64 v[70:71], v70
    s_mov_b64 exec, s[84:85]
    ds_read_b64 v[72:73], v72
    s_mov_b64 exec, s[86:87]
    ds_read_b64 v[74:75], v74
    s_mov_b64 exec, -1
    s_cmp_le_i32 s42, 3072
    s_cbranch_scc1 L_nt1_79
    s_waitcnt vmcnt(10)
    v_lshlrev_b32_sdwa v120, 3, v114 dst_sel:WORD_0 dst_unused:UNUSED_PAD src0_sel:DWORD src1_sel:DWORD
    v_lshrrev_b32 v122, 5, v106
    v_lshlrev_b32_sdwa v124, 3, v107 dst_sel:WORD_0 dst_unused:UNUSED_PAD src0_sel:DWORD src1_sel:WORD_1
    v_alignbit_b32 v126, v109, v108, 21

    v_alignbyte_b32 v108, v108, v107, 3
    v_alignbyte_b32 v107, v107, v106, 2
    v_alignbyte_b32 v106, v106, v114, 1
    v_and_b32 v122, 0xfff8, v122
    v_and_b32 v126, 0xfff8, v126
    s_cmp_lt_i32 s42, 3328
    s_cbranch_scc1 L_ufix_84
L_uback_85:

    v_lshrrev_b32 v117, 30, v106
    v_and_b32 v106, 0x3fffffff, v106
    v_mul_u32_u24 v117, 50000, v117
    v_cmp_ne_u32 vcc, 0, v106
    v_add_u32 v120, v120, v117
    s_mov_b64 exec, vcc

    buffer_load_dwordx2 v[120:121], v120, s[8:11], s50 offen
    s_mov_b64 exec, -1
    v_lshrrev_b32 v117, 30, v107
    v_and_b32 v107, 0x3fffffff, v107
    v_mul_u32_u24 v117, 50000, v117
    v_cmp_ne_u32 vcc, 0, v107
    v_add_u32 v122, v122, v117
    s_mov_b64 exec, vcc

    buffer_load_dwordx2 v[122:123], v122, s[8:11], s50 offen
    s_mov_b64 exec, -1
    v_lshrrev_b32 v117, 30, v108
    v_and_b32 v108, 0x3fffffff, v108
    v_mul_u32_u24 v117, 50000, v117
    v_cmp_ne_u32 vcc, 0, v108
    v_add_u32 v124, v124, v117
    s_mov_b64 exec, vcc

    buffer_load_dwordx2 v[124:125], v124, s[8:11], s50 offen
    s_mov_b64 exec, -1
    v_lshrrev_b32 v117, 30, v109
    v_and_b32 v109, 0x3fffffff, v109
    v_mul_u32_u24 v117, 50000, v117
    v_cmp_ne_u32 vcc, 0, v109
    v_add_u32 v126, v126, v117
    s_mov_b64 exec, vcc

    buffer_load_dwordx2 v[126:127], v126, s[8:11], s50 offen
    s_mov_b64 exec, -1
L_nt1_79:
    v_subrev_co_u32 v4, s[64:65], 2.0, v4
    v_subrev_co_u32 v5, s[66:67], 2.0, v5
    v_subrev_co_u32 v6, s[68:69], 2.0, v6
    v_subrev_co_u32 v7, s[70:71], 2.0, v7
    v_subrev_co_u32 v8, s[72:73], 2.0, v8
    v_subrev_co_u32 v9, s[74:75], 2.0, v9
    v_subrev_co_u32 v10, s[76:77], 2.0, v10
    v_subrev_co_u32 v11, s[78:79], 2.0, v11
    v_subrev_co_u32 v12, s[80:81], 2.0, v12
    v_subrev_co_u32 v13, s[82:83], 2.0, v13
    v_subrev_co_u32 v14, s[84:85], 2.0, v14
    v_subrev_co_u32 v15, s[86:87], 2.0, v15
    s_waitcnt lgkmcnt(0)
    s_barrier
    s_waitcnt vmcnt(2)
    ds_write_addtid_b32 v76 offset:0
    ds_write_addtid_b32 v77 offset:256
    ds_write_addtid_b32 v78 offset:512
    ds_write_addtid_b32 v79 offset:768
    s_waitcnt vmcnt(1)
    ds_write_addtid_b32 v80 offset:16384
    ds_write_addtid_b32 v81 offset:16640
    ds_write_addtid_b32 v82 offset:16896
    ds_write_addtid_b32 v83 offset:17152
    s_waitcnt vmcnt(0)
    ds_write_addtid_b32 v84 offset:32768
    ds_write_addtid_b32 v85 offset:33024
    ds_write_addtid_b32 v86 offset:33280
    ds_write_addtid_b32 v87 offset:33536
    v_lshlrev_b32 v119, 2, v0
    s_waitcnt vmcnt(3)
    s_mov_b64 exec, s[48:49]
    ds_write_b32 v119, v88 offset:49152
    s_mov_b64 exec, -1
    s_add_u32 s43, s43, 50048
    s_add_u32 s14, s43, 50000
    s_min_u32 s14, s14, s41
    s_add_u32 s52, s43, 49152
    s_cmp_ge_u32 s25, 4
    s_cbranch_scc1 L_sk3_86
    v_lshlrev_b32 v119, 2, v0
    buffer_load_dword v88, v119, s[12:15], s52 offen
L_sk3_86:
    buffer_load_dwordx4 v[76:79], v3, s[12:15], s43 offen
    s_waitcnt lgkmcnt(0)
    s_barrier
    s_add_u32 s52, s43, 16384
    buffer_load_dwordx4 v[80:83], v3, s[12:15], s52 offen
    s_add_u32 s52, s43, 32768
    buffer_load_dwordx4 v[84:87], v3, s[12:15], s52 offen
    s_mov_b64 exec, s[64:65]
    ds_read_b64 v[28:29], v28
    s_mov_b64 exec, s[66:67]
    ds_read_b64 v[30:31], v30
    s_mov_b64 exec, s[68:69]
    ds_read_b64 v[32:33], v32
    s_mov_b64 exec, s[70:71]
    ds_read_b64 v[34:35], v34
    s_mov_b64 exec, s[72:73]
    ds_read_b64 v[36:37], v36
    s_mov_b64 exec, s[74:75]
    ds_read_b64 v[38:39], v38
    s_mov_b64 exec, s[76:77]
    ds_read_b64 v[40:41], v40
    s_mov_b64 exec, s[78:79]
    ds_read_b64 v[42:43], v42
    s_mov_b64 exec, s[80:81]
    ds_read_b64 v[44:45], v44
    s_mov_b64 exec, s[82:83]
    ds_read_b64 v[46:47], v46
    s_mov_b64 exec, s[84:85]
    ds_read_b64 v[48:49], v48
    s_mov_b64 exec, s[86:87]
    ds_read_b64 v[50:51], v50
    s_mov_b64 exec, -1
    v_subrev_co_u32 v16, s[64:65], 2.0, v16
    v_subrev_co_u32 v17, s[66:67], 2.0, v17
    v_subrev_co_u32 v18, s[68:69], 2.0, v18
    v_subrev_co_u32 v19, s[70:71], 2.0, v19
    v_subrev_co_u32 v20, s[72:73], 2.0, v20
    v_subrev_co_u32 v21, s[74:75], 2.0, v21
    v_subrev_co_u32 v22, s[76:77], 2.0, v22
    v_subrev_co_u32 v23, s[78:79], 2.0, v23
    v_subrev_co_u32 v24, s[80:81], 2.0, v24
    v_subrev_co_u32 v25, s[82:83], 2.0, v25
    v_subrev_co_u32 v26, s[84:85], 2.0, v26
    v_subrev_co_u32 v27, s[86:87], 2.0, v27
    s_mov_b64 exec, s[64:65]
    ds_read_b64 v[52:53], v52
    s_mov_b64 exec, s[66:67]
    ds_read_b64 v[54:55], v54
    s_mov_b64 exec, s[68:69]
    ds_read_b64 v[56:57], v56
    s_mov_b64 exec, s[70:71]
    ds_read_b64 v[58:59], v58
    s_mov_b64 exec, s[72:73]
    ds_read_b64 v[60:61], v60
    s_mov_b64 exec, s[74:75]
    ds_read_b64 v[62:63], v62
    s_mov_b64 exec, s[76:77]
    ds_read_b64 v[64:65], v64
    s_mov_b64 exec, s[78:79]
    ds_read_b64 v[66:67], v66
    s_mov_b64 exec, s[80:81]
    ds_read_b64 v[68:69], v68
    s_mov_b64 exec, s[82:83]
    ds_read_b64 v[70:71], v70
    s_mov_b64 exec, s[84:85]
    ds_read_b64 v[72:73], v72
    s_mov_b64 exec, s[86:87]
    ds_read_b64 v[74:75], v74
    s_mov_b64 exec, -1
    s_movk_i32 s53, 10240
    buffer_load_dwordx4 v[98:101], v2, s[16:19], s53 offen offset:4
    buffer_load_dword v112, v2, s[16:19], s53 offen
    s_movk_i32 s53, 12800
    buffer_load_dwordx4 v[102:105], v2, s[16:19], s53 offen offset:4
    buffer_load_dword v113, v2, s[16:19], s53 offen
    s_cmp_le_i32 s42, 3072
    s_cbranch_scc1 L_nt2_80
    s_waitcnt vmcnt(7)
    v_cmp_ne_u32 s[56:57], 0, v106
    v_cmp_ne_u32 s[58:59], 0, v107
    v_cmp_ne_u32 s[98:99], 0, v108
    v_cmp_ne_u32 vcc, 0, v109
    s_mov_b64 exec, s[56:57]
    v_cvt_f32_i32_sdwa v118, sext(v106) dst_sel:DWORD dst_unused:UNUSED_PAD src0_sel:WORD_0
    v_lshlrev_b32 v116, 16, v120
    v_and_b32 v117, s32, v120
    v_mul_f32 v118, s33, v118
    v_lshlrev_b32 v120, 16, v121
    v_and_b32 v121, s32, v121
    v_lshlrev_b32_sdwa v106, 3, v106 dst_sel:DWORD dst_unused:UNUSED_PAD src0_sel:DWORD src1_sel:WORD_1
    v_pk_fma_f32 v[116:117], v[116:117], v[118:119], s[28:29] op_sel_hi:[1,0,1]
    v_pk_fma_f32 v[120:121], v[120:121], v[118:119], s[28:29] op_sel_hi:[1,0,1]
    v_perm_b32 v116, v117, v116, s35
    v_perm_b32 v117, v121, v120, s35
    v_lshl_add_u64 v[116:117], v[116:117], 0, s[30:31]
    ds_add_rtn_u64 v[120:121], v106, v[116:117] offset:50000

    s_mov_b64 exec, s[58:59]
    v_cvt_f32_i32_sdwa v118, sext(v107) dst_sel:DWORD dst_unused:UNUSED_PAD src0_sel:WORD_0
    v_lshlrev_b32 v116, 16, v122
    v_and_b32 v117, s32, v122
    v_mul_f32 v118, s33, v118
    v_lshlrev_b32 v122, 16, v123
    v_and_b32 v123, s32, v123
    v_lshlrev_b32_sdwa v107, 3, v107 dst_sel:DWORD dst_unused:UNUSED_PAD src0_sel:DWORD src1_sel:WORD_1
    v_pk_fma_f32 v[116:117], v[116:117], v[118:119], s[28:29] op_sel_hi:[1,0,1]
    v_pk_fma_f32 v[122:123], v[122:123], v[118:119], s[28:29] op_sel_hi:[1,0,1]
    v_perm_b32 v116, v117, v116, s35
    v_perm_b32 v117, v123, v122, s35
    v_lshl_add_u64 v[116:117], v[116:117], 0, s[30:31]
    ds_add_rtn_u64 v[122:123], v107, v[116:117] offset:50000

    s_mov_b64 exec, s[98:99]
    v_cvt_f32_i32_sdwa v118, sext(v108) dst_sel:DWORD dst_unused:UNUSED_PAD src0_sel:WORD_0
    v_lshlrev_b32 v116, 16, v124
    v_and_b32 v117, s32, v124
    v_mul_f32 v118, s33, v118
    v_lshlrev_b32 v124, 16, v125
    v_and_b32 v125, s32, v125
    v_lshlrev_b32_sdwa v108, 3, v108 dst_sel:DWORD dst_unused:UNUSED_PAD src0_sel:DWORD src1_sel:WORD_1
    v_pk_fma_f32 v[116:117], v[116:117], v[118:119], s[28:29] op_sel_hi:[1,0,1]
    v_pk_fma_f32 v[124:125], v[124:125], v[118:119], s[28:29] op_sel_hi:[1,0,1]
    v_perm_b32 v116, v117, v116, s35
    v_perm_b32 v117, v125, v124, s35
    v_lshl_add_u64 v[116:117], v[116:117], 0, s[30:31]
    ds_add_rtn_u64 v[124:125], v108, v[116:117] offset:50000

    s_mov_b64 exec, vcc
    v_cvt_f32_i32_sdwa v118, sext(v109) dst_sel:DWORD dst_unused:UNUSED_PAD src0_sel:WORD_0
    v_lshlrev_b32 v116, 16, v126
    v_and_b32 v117, s32, v126
    v_mul_f32 v118, s33, v118
    v_lshlrev_b32 v126, 16, v127
    v_and_b32 v127, s32, v127
    v_lshlrev_b32_sdwa v109, 3, v109 dst_sel:DWORD dst_unused:UNUSED_PAD src0_sel:DWORD src1_sel:WORD_1
    v_pk_fma_f32 v[116:117], v[116:117], v[118:119], s[28:29] op_sel_hi:[1,0,1]
    v_pk_fma_f32 v[126:127], v[126:127], v[118:119], s[28:29] op_sel_hi:[1,0,1]
    v_perm_b32 v116, v117, v116, s35
    v_perm_b32 v117, v127, v126, s35
    v_lshl_add_u64 v[116:117], v[116:117], 0, s[30:31]
    ds_add_rtn_u64 v[126:127], v109, v[116:117] offset:50000

    s_waitcnt lgkmcnt(0)
    s_mov_b64 exec, s[56:57]
    v_or3_b32 v1, v120, v121, v1
    s_mov_b64 exec, s[58:59]
    v_or3_b32 v1, v122, v123, v1
    s_mov_b64 exec, s[98:99]
    v_or3_b32 v1, v124, v125, v1
    s_mov_b64 exec, vcc
    v_or3_b32 v1, v126, v127, v1
    s_mov_b64 exec, -1
L_nt2_80:
    s_cmp_le_u32 s40, 3584
    s_cbranch_scc1 L_noleft_81
    s_min_u32 s40, s40, 6524
    s_lshl_b32 s52, s38, 6
    s_add_u32 s52, s52, s36
    s_mul_i32 s52, s52, 32764
    s_and_b32 s52, s52, 0xffffff80
    s_add_u32 s20, s44, s52
    s_addc_u32 s21, s45, 0
    s_mul_i32 s52, s40, 5
    s_add_u32 s52, s52, 3
    s_and_b32 s22, s52, -4

    s_lshr_b32 s55, s39, 2
    s_add_u32 s55, s55, 3584
    v_and_b32 v120, 63, v0
    v_add_u32 v120, s55, v120
L_left_89:
    s_cmp_ge_u32 s55, s40
    s_cbranch_scc1 L_leftend_90
    v_mul_u32_u24 v121, 5, v120
    buffer_load_dword v122, v121, s[20:23], 0 offen offset:1
    buffer_load_ubyte v123, v121, s[20:23], 0 offen
    s_waitcnt vmcnt(0)

    v_perm_b32 v121, v123, v122, s24
    v_lshrrev_b32 v126, 30, v122
    v_and_b32 v121, 0x1fff, v121
    v_mul_u32_u24 v126, 6250, v126
    v_add_lshl_u32 v121, v121, v126, 3

    buffer_load_dwordx2 v[124:125], v121, s[8:11], s50 offen
    v_cmp_gt_u32 vcc, s40, v120
    s_waitcnt vmcnt(0)

    s_mov_b64 exec, vcc
    v_and_b32 v122, 0x3fffffff, v122
    v_cvt_f32_i32_sdwa v118, sext(v122) dst_sel:DWORD dst_unused:UNUSED_PAD src0_sel:WORD_0
    v_lshlrev_b32 v116, 16, v124
    v_and_b32 v117, s32, v124
    v_mul_f32 v118, s33, v118
    v_lshlrev_b32 v124, 16, v125
    v_and_b32 v125, s32, v125
    v_lshlrev_b32_sdwa v122, 3, v122 dst_sel:DWORD dst_unused:UNUSED_PAD src0_sel:DWORD src1_sel:WORD_1
    v_pk_fma_f32 v[116:117], v[116:117], v[118:119], s[28:29] op_sel_hi:[1,0,1]
    v_pk_fma_f32 v[124:125], v[124:125], v[118:119], s[28:29] op_sel_hi:[1,0,1]
    v_perm_b32 v116, v117, v116, s35
    v_perm_b32 v117, v125, v124, s35
    v_lshl_add_u64 v[116:117], v[116:117], 0, s[30:31]
    ds_add_rtn_u64 v[124:125], v122, v[116:117] offset:50000

    s_waitcnt lgkmcnt(0)
    v_or3_b32 v1, v124, v125, v1
    s_mov_b64 exec, -1
    v_add_u32 v120, 128, v120
    s_add_u32 s55, s55, 128
    s_branch L_left_89
L_leftend_90:

L_noleft_81:
    v_cmp_gt_u32 s[64:65], 2.0, v4
    v_and_b32 v4, 0x3fffffff, v4
    v_cmp_gt_u32 s[66:67], 2.0, v5
    v_and_b32 v5, 0x3fffffff, v5
    v_cmp_gt_u32 s[68:69], 2.0, v6
    v_and_b32 v6, 0x3fffffff, v6
    v_cmp_gt_u32 s[70:71], 2.0, v7
    v_and_b32 v7, 0x3fffffff, v7
    v_cmp_gt_u32 s[72:73], 2.0, v8
    v_and_b32 v8, 0x3fffffff, v8
    v_cmp_gt_u32 s[74:75], 2.0, v9
    v_and_b32 v9, 0x3fffffff, v9
    v_cmp_gt_u32 s[76:77], 2.0, v10
    v_and_b32 v10, 0x3fffffff, v10
    v_cmp_gt_u32 s[78:79], 2.0, v11
    v_and_b32 v11, 0x3fffffff, v11
    v_cmp_gt_u32 s[80:81], 2.0, v12
    v_and_b32 v12, 0x3fffffff, v12
    v_cmp_gt_u32 s[82:83], 2.0, v13
    v_and_b32 v13, 0x3fffffff, v13
    v_cmp_gt_u32 s[84:85], 2.0, v14
    v_and_b32 v14, 0x3fffffff, v14
    v_cmp_gt_u32 s[86:87], 2.0, v15
    v_and_b32 v15, 0x3fffffff, v15
    s_waitcnt lgkmcnt(0)
    s_barrier
    s_waitcnt vmcnt(6)
    ds_write_addtid_b32 v76 offset:0
    ds_write_addtid_b32 v77 offset:256
    ds_write_addtid_b32 v78 offset:512
    ds_write_addtid_b32 v79 offset:768
    s_waitcnt vmcnt(5)
    ds_write_addtid_b32 v80 offset:16384
    ds_write_addtid_b32 v81 offset:16640
    ds_write_addtid_b32 v82 offset:16896
    ds_write_addtid_b32 v83 offset:17152
    s_waitcnt vmcnt(4)
    ds_write_addtid_b32 v84 offset:32768
    ds_write_addtid_b32 v85 offset:33024
    ds_write_addtid_b32 v86 offset:33280
    ds_write_addtid_b32 v87 offset:33536
    v_lshlrev_b32 v119, 2, v0
    s_waitcnt vmcnt(7)
    s_mov_b64 exec, s[48:49]
    ds_write_b32 v119, v88 offset:49152
    s_mov_b64 exec, -1
    s_add_u32 s43, s43, 50048
    s_add_u32 s14, s43, 50000
    s_min_u32 s14, s14, s41
    s_add_u32 s52, s43, 49152
    s_cmp_ge_u32 s25, 4
    s_cbranch_scc1 L_sk3_91
    v_lshlrev_b32 v119, 2, v0
    buffer_load_dword v88, v119, s[12:15], s52 offen
L_sk3_91:
    buffer_load_dwordx4 v[76:79], v3, s[12:15], s43 offen
    s_waitcnt lgkmcnt(0)
    s_barrier
    s_add_u32 s52, s43, 16384
    buffer_load_dwordx4 v[80:83], v3, s[12:15], s52 offen
    s_add_u32 s52, s43, 32768
    buffer_load_dwordx4 v[84:87], v3, s[12:15], s52 offen
    s_mov_b64 exec, s[64:65]
    ds_read_b64 v[28:29], v28
    s_mov_b64 exec, s[66:67]
    ds_read_b64 v[30:31], v30
    s_mov_b64 exec, s[68:69]
    ds_read_b64 v[32:33], v32
    s_mov_b64 exec, s[70:71]
    ds_read_b64 v[34:35], v34
    s_mov_b64 exec, s[72:73]
    ds_read_b64 v[36:37], v36
    s_mov_b64 exec, s[74:75]
    ds_read_b64 v[38:39], v38
    s_mov_b64 exec, s[76:77]
    ds_read_b64 v[40:41], v40
    s_mov_b64 exec, s[78:79]
    ds_read_b64 v[42:43], v42
    s_mov_b64 exec, s[80:81]
    ds_read_b64 v[44:45], v44
    s_mov_b64 exec, s[82:83]
    ds_read_b64 v[46:47], v46
    s_mov_b64 exec, s[84:85]
    ds_read_b64 v[48:49], v48
    s_mov_b64 exec, s[86:87]
    ds_read_b64 v[50:51], v50
    s_mov_b64 exec, -1
    v_cmp_gt_u32 s[64:65], 2.0, v16
    v_and_b32 v16, 0x3fffffff, v16
    v_cmp_gt_u32 s[66:67], 2.0, v17
    v_and_b32 v17, 0x3fffffff, v17
    v_cmp_gt_u32 s[68:69], 2.0, v18
    v_and_b32 v18, 0x3fffffff, v18
    v_cmp_gt_u32 s[70:71], 2.0, v19
    v_and_b32 v19, 0x3fffffff, v19
    v_cmp_gt_u32 s[72:73], 2.0, v20
    v_and_b32 v20, 0x3fffffff, v20
    v_cmp_gt_u32 s[74:75], 2.0, v21
    v_and_b32 v21, 0x3fffffff, v21
    v_cmp_gt_u32 s[76:77], 2.0, v22
    v_and_b32 v22, 0x3fffffff, v22
    v_cmp_gt_u32 s[78:79], 2.0, v23
    v_and_b32 v23, 0x3fffffff, v23
    v_cmp_gt_u32 s[80:81], 2.0, v24
    v_and_b32 v24, 0x3fffffff, v24
    v_cmp_gt_u32 s[82:83], 2.0, v25
    v_and_b32 v25, 0x3fffffff, v25
    v_cmp_gt_u32 s[84:85], 2.0, v26
    v_and_b32 v26, 0x3fffffff, v26
    v_cmp_gt_u32 s[86:87], 2.0, v27
    v_and_b32 v27, 0x3fffffff, v27
    s_mov_b64 exec, s[64:65]
    ds_read_b64 v[52:53], v52
    s_mov_b64 exec, s[66:67]
    ds_read_b64 v[54:55], v54
    s_mov_b64 exec, s[68:69]
    ds_read_b64 v[56:57], v56
    s_mov_b64 exec, s[70:71]
    ds_read_b64 v[58:59], v58
    s_mov_b64 exec, s[72:73]
    ds_read_b64 v[60:61], v60
    s_mov_b64 exec, s[74:75]
    ds_read_b64 v[62:63], v62
    s_mov_b64 exec, s[76:77]
    ds_read_b64 v[64:65], v64
    s_mov_b64 exec, s[78:79]
    ds_read_b64 v[66:67], v66
    s_mov_b64 exec, s[80:81]
    ds_read_b64 v[68:69], v68
    s_mov_b64 exec, s[82:83]
    ds_read_b64 v[70:71], v70
    s_mov_b64 exec, s[84:85]
    ds_read_b64 v[72:73], v72
    s_mov_b64 exec, s[86:87]
    ds_read_b64 v[74:75], v74
    s_mov_b64 exec, -1
    s_cmp_ge_u32 s5, s4
    s_cbranch_scc1 L_bend_78
    s_waitcnt lgkmcnt(15)
    v_mad_i32_i16 v120, v28, v4, s96
    v_mad_i32_i16 v28, v28, v4, s96 op_sel:[1,0,0,0]
    v_mad_i32_i16 v121, v29, v4, s96
    v_mad_i32_i16 v29, v29, v4, s96 op_sel:[1,0,0,0]
    v_lshlrev_b32_sdwa v4, 3, v4 dst_sel:DWORD dst_unused:UNUSED_PAD src0_sel:DWORD src1_sel:WORD_1
    v_perm_b32 v28, v28, v120, s97
    v_perm_b32 v29, v29, v121, s97
    v_lshl_add_u64 v[28:29], v[28:29], 0, s[30:31]

    ds_add_rtn_u64 v[28:29], v4, v[28:29] offset:50000
    v_mad_i32_i16 v122, v30, v5, s96
    v_mad_i32_i16 v30, v30, v5, s96 op_sel:[1,0,0,0]
    v_mad_i32_i16 v123, v31, v5, s96
    v_mad_i32_i16 v31, v31, v5, s96 op_sel:[1,0,0,0]
    v_lshlrev_b32_sdwa v5, 3, v5 dst_sel:DWORD dst_unused:UNUSED_PAD src0_sel:DWORD src1_sel:WORD_1
    v_perm_b32 v30, v30, v122, s97
    v_perm_b32 v31, v31, v123, s97
    v_lshl_add_u64 v[30:31], v[30:31], 0, s[30:31]

    ds_add_rtn_u64 v[30:31], v5, v[30:31] offset:50000
    v_mad_i32_i16 v124, v32, v6, s96
    v_mad_i32_i16 v32, v32, v6, s96 op_sel:[1,0,0,0]
    v_mad_i32_i16 v125, v33, v6, s96
    v_mad_i32_i16 v33, v33, v6, s96 op_sel:[1,0,0,0]
    v_lshlrev_b32_sdwa v6, 3, v6 dst_sel:DWORD dst_unused:UNUSED_PAD src0_sel:DWORD src1_sel:WORD_1
    v_perm_b32 v32, v32, v124, s97
    v_perm_b32 v33, v33, v125, s97
    v_lshl_add_u64 v[32:33], v[32:33], 0, s[30:31]

    ds_add_rtn_u64 v[32:33], v6, v[32:33] offset:50000
    v_mad_i32_i16 v126, v34, v7, s96
    v_mad_i32_i16 v34, v34, v7, s96 op_sel:[1,0,0,0]
    v_mad_i32_i16 v127, v35, v7, s96
    v_mad_i32_i16 v35, v35, v7, s96 op_sel:[1,0,0,0]
    v_lshlrev_b32_sdwa v7, 3, v7 dst_sel:DWORD dst_unused:UNUSED_PAD src0_sel:DWORD src1_sel:WORD_1
    v_perm_b32 v34, v34, v126, s97
    v_perm_b32 v35, v35, v127, s97
    v_lshl_add_u64 v[34:35], v[34:35], 0, s[30:31]

    ds_add_rtn_u64 v[34:35], v7, v[34:35] offset:50000
    s_sub_u32 s53, s88, s39
    s_cmp_le_i32 s53, 3072
    s_cbranch_scc1 L_skt_92
    s_movk_i32 s53, 15360
    buffer_load_dwordx4 v[106:109], v2, s[16:19], s53 offen offset:4
    buffer_load_dword v114, v2, s[16:19], s53 offen
L_skt_92:
    v_mad_i32_i16 v120, v36, v8, s96
    v_mad_i32_i16 v36, v36, v8, s96 op_sel:[1,0,0,0]
    v_mad_i32_i16 v121, v37, v8, s96
    v_mad_i32_i16 v37, v37, v8, s96 op_sel:[1,0,0,0]
    v_lshlrev_b32_sdwa v8, 3, v8 dst_sel:DWORD dst_unused:UNUSED_PAD src0_sel:DWORD src1_sel:WORD_1
    v_perm_b32 v36, v36, v120, s97
    v_perm_b32 v37, v37, v121, s97
    v_lshl_add_u64 v[36:37], v[36:37], 0, s[30:31]

    ds_add_rtn_u64 v[36:37], v8, v[36:37] offset:50000
    v_mad_i32_i16 v122, v38, v9, s96
    v_mad_i32_i16 v38, v38, v9, s96 op_sel:[1,0,0,0]
    v_mad_i32_i16 v123, v39, v9, s96
    v_mad_i32_i16 v39, v39, v9, s96 op_sel:[1,0,0,0]
    v_lshlrev_b32_sdwa v9, 3, v9 dst_sel:DWORD dst_unused:UNUSED_PAD src0_sel:DWORD src1_sel:WORD_1
    v_perm_b32 v38, v38, v122, s97
    v_perm_b32 v39, v39, v123, s97
    v_lshl_add_u64 v[38:39], v[38:39], 0, s[30:31]

    ds_add_rtn_u64 v[38:39], v9, v[38:39] offset:50000
    v_mad_i32_i16 v124, v40, v10, s96
    v_mad_i32_i16 v40, v40, v10, s96 op_sel:[1,0,0,0]
    v_mad_i32_i16 v125, v41, v10, s96
    v_mad_i32_i16 v41, v41, v10, s96 op_sel:[1,0,0,0]
    v_lshlrev_b32_sdwa v10, 3, v10 dst_sel:DWORD dst_unused:UNUSED_PAD src0_sel:DWORD src1_sel:WORD_1
    v_perm_b32 v40, v40, v124, s97
    v_perm_b32 v41, v41, v125, s97
    v_lshl_add_u64 v[40:41], v[40:41], 0, s[30:31]

    ds_add_rtn_u64 v[40:41], v10, v[40:41] offset:50000
    v_mad_i32_i16 v126, v42, v11, s96
    v_mad_i32_i16 v42, v42, v11, s96 op_sel:[1,0,0,0]
    v_mad_i32_i16 v127, v43, v11, s96
    v_mad_i32_i16 v43, v43, v11, s96 op_sel:[1,0,0,0]
    v_lshlrev_b32_sdwa v11, 3, v11 dst_sel:DWORD dst_unused:UNUSED_PAD src0_sel:DWORD src1_sel:WORD_1
    v_perm_b32 v42, v42, v126, s97
    v_perm_b32 v43, v43, v127, s97
    v_lshl_add_u64 v[42:43], v[42:43], 0, s[30:31]

    ds_add_rtn_u64 v[42:43], v11, v[42:43] offset:50000
    s_waitcnt lgkmcnt(4)
    v_or3_b32 v1, v28, v29, v1
    v_or3_b32 v1, v30, v31, v1
    v_or3_b32 v1, v32, v33, v1
    v_or3_b32 v1, v34, v35, v1
    s_movk_i32 s53, 0
    buffer_load_dwordx4 v[4:7], v2, s[16:19], s53 offen offset:4 nt
    buffer_load_dword v35, v2, s[16:19], s53 offen nt
    v_mad_i32_i16 v120, v44, v12, s96
    v_mad_i32_i16 v44, v44, v12, s96 op_sel:[1,0,0,0]
    v_mad_i32_i16 v121, v45, v12, s96
    v_mad_i32_i16 v45, v45, v12, s96 op_sel:[1,0,0,0]
    v_lshlrev_b32_sdwa v12, 3, v12 dst_sel:DWORD dst_unused:UNUSED_PAD src0_sel:DWORD src1_sel:WORD_1
    v_perm_b32 v44, v44, v120, s97
    v_perm_b32 v45, v45, v121, s97
    v_lshl_add_u64 v[44:45], v[44:45], 0, s[30:31]

    ds_add_rtn_u64 v[44:45], v12, v[44:45] offset:50000
    v_mad_i32_i16 v122, v46, v13, s96
    v_mad_i32_i16 v46, v46, v13, s96 op_sel:[1,0,0,0]
    v_mad_i32_i16 v123, v47, v13, s96
    v_mad_i32_i16 v47, v47, v13, s96 op_sel:[1,0,0,0]
    v_lshlrev_b32_sdwa v13, 3, v13 dst_sel:DWORD dst_unused:UNUSED_PAD src0_sel:DWORD src1_sel:WORD_1
    v_perm_b32 v46, v46, v122, s97
    v_perm_b32 v47, v47, v123, s97
    v_lshl_add_u64 v[46:47], v[46:47], 0, s[30:31]

    ds_add_rtn_u64 v[46:47], v13, v[46:47] offset:50000
    v_mad_i32_i16 v124, v48, v14, s96
    v_mad_i32_i16 v48, v48, v14, s96 op_sel:[1,0,0,0]
    v_mad_i32_i16 v125, v49, v14, s96
    v_mad_i32_i16 v49, v49, v14, s96 op_sel:[1,0,0,0]
    v_lshlrev_b32_sdwa v14, 3, v14 dst_sel:DWORD dst_unused:UNUSED_PAD src0_sel:DWORD src1_sel:WORD_1
    v_perm_b32 v48, v48, v124, s97
    v_perm_b32 v49, v49, v125, s97
    v_lshl_add_u64 v[48:49], v[48:49], 0, s[30:31]

    ds_add_rtn_u64 v[48:49], v14, v[48:49] offset:50000
    v_mad_i32_i16 v126, v50, v15, s96
    v_mad_i32_i16 v50, v50, v15, s96 op_sel:[1,0,0,0]
    v_mad_i32_i16 v127, v51, v15, s96
    v_mad_i32_i16 v51, v51, v15, s96 op_sel:[1,0,0,0]
    v_lshlrev_b32_sdwa v15, 3, v15 dst_sel:DWORD dst_unused:UNUSED_PAD src0_sel:DWORD src1_sel:WORD_1
    v_perm_b32 v50, v50, v126, s97
    v_perm_b32 v51, v51, v127, s97
    v_lshl_add_u64 v[50:51], v[50:51], 0, s[30:31]

    ds_add_rtn_u64 v[50:51], v15, v[50:51] offset:50000
    s_waitcnt lgkmcnt(4)
    v_or3_b32 v1, v36, v37, v1
    v_or3_b32 v1, v38, v39, v1
    v_or3_b32 v1, v40, v41, v1
    v_or3_b32 v1, v42, v43, v1
    s_movk_i32 s53, 2560
    buffer_load_dwordx4 v[8:11], v2, s[16:19], s53 offen offset:4
    buffer_load_dword v43, v2, s[16:19], s53 offen
    s_barrier
    s_waitcnt vmcnt(6)
    ds_write_addtid_b32 v76 offset:0
    ds_write_addtid_b32 v77 offset:256
    ds_write_addtid_b32 v78 offset:512
    ds_write_addtid_b32 v79 offset:768
    s_waitcnt vmcnt(5)
    ds_write_addtid_b32 v80 offset:16384
    ds_write_addtid_b32 v81 offset:16640
    ds_write_addtid_b32 v82 offset:16896
    ds_write_addtid_b32 v83 offset:17152
    s_waitcnt vmcnt(4)
    ds_write_addtid_b32 v84 offset:32768
    ds_write_addtid_b32 v85 offset:33024
    ds_write_addtid_b32 v86 offset:33280
    ds_write_addtid_b32 v87 offset:33536
    v_lshlrev_b32 v119, 2, v0
    s_waitcnt vmcnt(7)
    s_mov_b64 exec, s[48:49]
    ds_write_b32 v119, v88 offset:49152
    s_mov_b64 exec, -1
    s_add_u32 s43, s43, 50048
    s_add_u32 s14, s43, 50000
    s_min_u32 s14, s14, s41
    s_mov_b32 s40, s88
    s_sub_u32 s42, s40, s39

    s_add_u32 s55, s38, 2
    s_min_u32 s55, s55, 31
    s_mov_b32 s88, s89
    s_mov_b32 s89, s90
    s_mov_b32 s90, s91
    s_mov_b32 s91, s92
    s_mov_b32 s92, s93
    s_mov_b32 s93, s94
    s_mov_b32 s94, s95
    s_mov_b32 s95, 0
    s_min_u32 s88, s88, 6524
    s_lshl_b32 s52, s55, 6
    s_add_u32 s52, s52, s36
    s_mul_i32 s52, s52, 32764
    s_and_b32 s52, s52, 0xffffff80
    s_add_u32 s16, s44, s52
    s_addc_u32 s17, s45, 0
    s_mul_i32 s52, s88, 5
    s_add_u32 s52, s52, 3
    s_and_b32 s18, s52, -4

    v_mad_i32_i16 v120, v52, v16, s96
    v_mad_i32_i16 v52, v52, v16, s96 op_sel:[1,0,0,0]
    v_mad_i32_i16 v121, v53, v16, s96
    v_mad_i32_i16 v53, v53, v16, s96 op_sel:[1,0,0,0]
    v_lshlrev_b32_sdwa v16, 3, v16 dst_sel:DWORD dst_unused:UNUSED_PAD src0_sel:DWORD src1_sel:WORD_1
    v_perm_b32 v52, v52, v120, s97
    v_perm_b32 v53, v53, v121, s97
    v_lshl_add_u64 v[52:53], v[52:53], 0, s[30:31]

    ds_add_rtn_u64 v[52:53], v16, v[52:53] offset:50000
    v_mad_i32_i16 v122, v54, v17, s96
    v_mad_i32_i16 v54, v54, v17, s96 op_sel:[1,0,0,0]
    v_mad_i32_i16 v123, v55, v17, s96
    v_mad_i32_i16 v55, v55, v17, s96 op_sel:[1,0,0,0]
    v_lshlrev_b32_sdwa v17, 3, v17 dst_sel:DWORD dst_unused:UNUSED_PAD src0_sel:DWORD src1_sel:WORD_1
    v_perm_b32 v54, v54, v122, s97
    v_perm_b32 v55, v55, v123, s97
    v_lshl_add_u64 v[54:55], v[54:55], 0, s[30:31]

    ds_add_rtn_u64 v[54:55], v17, v[54:55] offset:50000
    v_mad_i32_i16 v124, v56, v18, s96
    v_mad_i32_i16 v56, v56, v18, s96 op_sel:[1,0,0,0]
    v_mad_i32_i16 v125, v57, v18, s96
    v_mad_i32_i16 v57, v57, v18, s96 op_sel:[1,0,0,0]
    v_lshlrev_b32_sdwa v18, 3, v18 dst_sel:DWORD dst_unused:UNUSED_PAD src0_sel:DWORD src1_sel:WORD_1
    v_perm_b32 v56, v56, v124, s97
    v_perm_b32 v57, v57, v125, s97
    v_lshl_add_u64 v[56:57], v[56:57], 0, s[30:31]

    ds_add_rtn_u64 v[56:57], v18, v[56:57] offset:50000
    v_mad_i32_i16 v126, v58, v19, s96
    v_mad_i32_i16 v58, v58, v19, s96 op_sel:[1,0,0,0]
    v_mad_i32_i16 v127, v59, v19, s96
    v_mad_i32_i16 v59, v59, v19, s96 op_sel:[1,0,0,0]
    v_lshlrev_b32_sdwa v19, 3, v19 dst_sel:DWORD dst_unused:UNUSED_PAD src0_sel:DWORD src1_sel:WORD_1
    v_perm_b32 v58, v58, v126, s97
    v_perm_b32 v59, v59, v127, s97
    v_lshl_add_u64 v[58:59], v[58:59], 0, s[30:31]

    ds_add_rtn_u64 v[58:59], v19, v[58:59] offset:50000
    s_waitcnt lgkmcnt(15)
    v_or3_b32 v1, v44, v45, v1
    v_or3_b32 v1, v46, v47, v1
    v_or3_b32 v1, v48, v49, v1
    v_or3_b32 v1, v50, v51, v1
    s_waitcnt vmcnt(19)
    v_lshlrev_b32_sdwa v44, 3, v110 dst_sel:WORD_0 dst_unused:UNUSED_PAD src0_sel:DWORD src1_sel:DWORD
    v_lshrrev_b32 v46, 5, v90
    v_lshlrev_b32_sdwa v48, 3, v91 dst_sel:WORD_0 dst_unused:UNUSED_PAD src0_sel:DWORD src1_sel:WORD_1
    v_alignbit_b32 v50, v93, v92, 21

    v_mov_b32 v15, v93
    v_alignbyte_b32 v14, v92, v91, 3
    v_alignbyte_b32 v13, v91, v90, 2
    v_alignbyte_b32 v12, v90, v110, 1
    v_and_b32 v46, 0xfff8, v46
    v_and_b32 v50, 0xfff8, v50
    s_cmp_lt_i32 s42, 1280
    s_cbranch_scc1 L_ufix_95
L_uback_96:

    s_movk_i32 s53, 5120
    buffer_load_dwordx4 v[90:93], v2, s[16:19], s53 offen offset:4
    buffer_load_dword v110, v2, s[16:19], s53 offen
    s_waitcnt lgkmcnt(4)
    s_barrier
    v_subrev_co_u32 v12, s[80:81], 2.0, v12
    v_subrev_co_u32 v13, s[82:83], 2.0, v13
    v_subrev_co_u32 v14, s[84:85], 2.0, v14
    v_subrev_co_u32 v15, s[86:87], 2.0, v15
    s_mov_b64 exec, s[80:81]
    ds_read_b64 v[44:45], v44
    s_mov_b64 exec, s[82:83]
    ds_read_b64 v[46:47], v46
    s_mov_b64 exec, s[84:85]
    ds_read_b64 v[48:49], v48
    s_mov_b64 exec, s[86:87]
    ds_read_b64 v[50:51], v50
    s_mov_b64 exec, -1
    v_mad_i32_i16 v120, v60, v20, s96
    v_mad_i32_i16 v60, v60, v20, s96 op_sel:[1,0,0,0]
    v_mad_i32_i16 v121, v61, v20, s96
    v_mad_i32_i16 v61, v61, v20, s96 op_sel:[1,0,0,0]
    v_lshlrev_b32_sdwa v20, 3, v20 dst_sel:DWORD dst_unused:UNUSED_PAD src0_sel:DWORD src1_sel:WORD_1
    v_perm_b32 v60, v60, v120, s97
    v_perm_b32 v61, v61, v121, s97
    v_lshl_add_u64 v[60:61], v[60:61], 0, s[30:31]

    ds_add_rtn_u64 v[60:61], v20, v[60:61] offset:50000
    v_mad_i32_i16 v122, v62, v21, s96
    v_mad_i32_i16 v62, v62, v21, s96 op_sel:[1,0,0,0]
    v_mad_i32_i16 v123, v63, v21, s96
    v_mad_i32_i16 v63, v63, v21, s96 op_sel:[1,0,0,0]
    v_lshlrev_b32_sdwa v21, 3, v21 dst_sel:DWORD dst_unused:UNUSED_PAD src0_sel:DWORD src1_sel:WORD_1
    v_perm_b32 v62, v62, v122, s97
    v_perm_b32 v63, v63, v123, s97
    v_lshl_add_u64 v[62:63], v[62:63], 0, s[30:31]

    ds_add_rtn_u64 v[62:63], v21, v[62:63] offset:50000
    v_mad_i32_i16 v124, v64, v22, s96
    v_mad_i32_i16 v64, v64, v22, s96 op_sel:[1,0,0,0]
    v_mad_i32_i16 v125, v65, v22, s96
    v_mad_i32_i16 v65, v65, v22, s96 op_sel:[1,0,0,0]
    v_lshlrev_b32_sdwa v22, 3, v22 dst_sel:DWORD dst_unused:UNUSED_PAD src0_sel:DWORD src1_sel:WORD_1
    v_perm_b32 v64, v64, v124, s97
    v_perm_b32 v65, v65, v125, s97
    v_lshl_add_u64 v[64:65], v[64:65], 0, s[30:31]

    ds_add_rtn_u64 v[64:65], v22, v[64:65] offset:50000
    v_mad_i32_i16 v126, v66, v23, s96
    v_mad_i32_i16 v66, v66, v23, s96 op_sel:[1,0,0,0]
    v_mad_i32_i16 v127, v67, v23, s96
    v_mad_i32_i16 v67, v67, v23, s96 op_sel:[1,0,0,0]
    v_lshlrev_b32_sdwa v23, 3, v23 dst_sel:DWORD dst_unused:UNUSED_PAD src0_sel:DWORD src1_sel:WORD_1
    v_perm_b32 v66, v66, v126, s97
    v_perm_b32 v67, v67, v127, s97
    v_lshl_add_u64 v[66:67], v[66:67], 0, s[30:31]

    ds_add_rtn_u64 v[66:67], v23, v[66:67] offset:50000
    s_waitcnt lgkmcnt(8)
    v_or3_b32 v1, v52, v53, v1
    v_or3_b32 v1, v54, v55, v1
    v_or3_b32 v1, v56, v57, v1
    v_or3_b32 v1, v58, v59, v1
    s_waitcnt vmcnt(19)
    v_lshlrev_b32_sdwa v52, 3, v111 dst_sel:WORD_0 dst_unused:UNUSED_PAD src0_sel:DWORD src1_sel:DWORD
    v_lshrrev_b32 v54, 5, v94
    v_lshlrev_b32_sdwa v56, 3, v95 dst_sel:WORD_0 dst_unused:UNUSED_PAD src0_sel:DWORD src1_sel:WORD_1
    v_alignbit_b32 v58, v97, v96, 21

    v_mov_b32 v19, v97
    v_alignbyte_b32 v18, v96, v95, 3
    v_alignbyte_b32 v17, v95, v94, 2
    v_alignbyte_b32 v16, v94, v111, 1
    v_and_b32 v54, 0xfff8, v54
    v_and_b32 v58, 0xfff8, v58
    s_cmp_lt_i32 s42, 1792
    s_cbranch_scc1 L_ufix_98
L_uback_99:

    v_subrev_co_u32 v16, s[64:65], 2.0, v16
    v_subrev_co_u32 v17, s[66:67], 2.0, v17
    v_subrev_co_u32 v18, s[68:69], 2.0, v18
    v_subrev_co_u32 v19, s[70:71], 2.0, v19
    s_mov_b64 exec, s[64:65]
    ds_read_b64 v[52:53], v52
    s_mov_b64 exec, s[66:67]
    ds_read_b64 v[54:55], v54
    s_mov_b64 exec, s[68:69]
    ds_read_b64 v[56:57], v56
    s_mov_b64 exec, s[70:71]
    ds_read_b64 v[58:59], v58
    s_mov_b64 exec, -1
    v_mad_i32_i16 v120, v68, v24, s96
    v_mad_i32_i16 v68, v68, v24, s96 op_sel:[1,0,0,0]
    v_mad_i32_i16 v121, v69, v24, s96
    v_mad_i32_i16 v69, v69, v24, s96 op_sel:[1,0,0,0]
    v_lshlrev_b32_sdwa v24, 3, v24 dst_sel:DWORD dst_unused:UNUSED_PAD src0_sel:DWORD src1_sel:WORD_1
    v_perm_b32 v68, v68, v120, s97
    v_perm_b32 v69, v69, v121, s97
    v_lshl_add_u64 v[68:69], v[68:69], 0, s[30:31]

    ds_add_rtn_u64 v[68:69], v24, v[68:69] offset:50000
    v_mad_i32_i16 v122, v70, v25, s96
    v_mad_i32_i16 v70, v70, v25, s96 op_sel:[1,0,0,0]
    v_mad_i32_i16 v123, v71, v25, s96
    v_mad_i32_i16 v71, v71, v25, s96 op_sel:[1,0,0,0]
    v_lshlrev_b32_sdwa v25, 3, v25 dst_sel:DWORD dst_unused:UNUSED_PAD src0_sel:DWORD src1_sel:WORD_1
    v_perm_b32 v70, v70, v122, s97
    v_perm_b32 v71, v71, v123, s97
    v_lshl_add_u64 v[70:71], v[70:71], 0, s[30:31]

    ds_add_rtn_u64 v[70:71], v25, v[70:71] offset:50000
    v_mad_i32_i16 v124, v72, v26, s96
    v_mad_i32_i16 v72, v72, v26, s96 op_sel:[1,0,0,0]
    v_mad_i32_i16 v125, v73, v26, s96
    v_mad_i32_i16 v73, v73, v26, s96 op_sel:[1,0,0,0]
    v_lshlrev_b32_sdwa v26, 3, v26 dst_sel:DWORD dst_unused:UNUSED_PAD src0_sel:DWORD src1_sel:WORD_1
    v_perm_b32 v72, v72, v124, s97
    v_perm_b32 v73, v73, v125, s97
    v_lshl_add_u64 v[72:73], v[72:73], 0, s[30:31]

    ds_add_rtn_u64 v[72:73], v26, v[72:73] offset:50000
    v_mad_i32_i16 v126, v74, v27, s96
    v_mad_i32_i16 v74, v74, v27, s96 op_sel:[1,0,0,0]
    v_mad_i32_i16 v127, v75, v27, s96
    v_mad_i32_i16 v75, v75, v27, s96 op_sel:[1,0,0,0]
    v_lshlrev_b32_sdwa v27, 3, v27 dst_sel:DWORD dst_unused:UNUSED_PAD src0_sel:DWORD src1_sel:WORD_1
    v_perm_b32 v74, v74, v126, s97
    v_perm_b32 v75, v75, v127, s97
    v_lshl_add_u64 v[74:75], v[74:75], 0, s[30:31]

    ds_add_rtn_u64 v[74:75], v27, v[74:75] offset:50000
    s_waitcnt lgkmcnt(8)
    v_or3_b32 v1, v60, v61, v1
    v_or3_b32 v1, v62, v63, v1
    v_or3_b32 v1, v64, v65, v1
    v_or3_b32 v1, v66, v67, v1
    s_waitcnt vmcnt(11)
    v_lshlrev_b32_sdwa v60, 3, v112 dst_sel:WORD_0 dst_unused:UNUSED_PAD src0_sel:DWORD src1_sel:DWORD
    v_lshrrev_b32 v62, 5, v98
    v_lshlrev_b32_sdwa v64, 3, v99 dst_sel:WORD_0 dst_unused:UNUSED_PAD src0_sel:DWORD src1_sel:WORD_1
    v_alignbit_b32 v66, v101, v100, 21

    v_mov_b32 v23, v101
    v_alignbyte_b32 v22, v100, v99, 3
    v_alignbyte_b32 v21, v99, v98, 2
    v_alignbyte_b32 v20, v98, v112, 1
    v_and_b32 v62, 0xfff8, v62
    v_and_b32 v66, 0xfff8, v66
    s_cmp_lt_i32 s42, 2304
    s_cbranch_scc1 L_ufix_100
L_uback_101:

    v_subrev_co_u32 v20, s[72:73], 2.0, v20
    v_subrev_co_u32 v21, s[74:75], 2.0, v21
    v_subrev_co_u32 v22, s[76:77], 2.0, v22
    v_subrev_co_u32 v23, s[78:79], 2.0, v23
    s_mov_b64 exec, s[72:73]
    ds_read_b64 v[60:61], v60
    s_mov_b64 exec, s[74:75]
    ds_read_b64 v[62:63], v62
    s_mov_b64 exec, s[76:77]
    ds_read_b64 v[64:65], v64
    s_mov_b64 exec, s[78:79]
    ds_read_b64 v[66:67], v66
    s_mov_b64 exec, -1
    s_waitcnt lgkmcnt(4)
    v_or3_b32 v1, v68, v69, v1
    v_or3_b32 v1, v70, v71, v1
    v_or3_b32 v1, v72, v73, v1
    v_or3_b32 v1, v74, v75, v1
    s_waitcnt vmcnt(9)
    v_lshlrev_b32_sdwa v68, 3, v113 dst_sel:WORD_0 dst_unused:UNUSED_PAD src0_sel:DWORD src1_sel:DWORD
    v_lshrrev_b32 v70, 5, v102
    v_lshlrev_b32_sdwa v72, 3, v103 dst_sel:WORD_0 dst_unused:UNUSED_PAD src0_sel:DWORD src1_sel:WORD_1
    v_alignbit_b32 v74, v105, v104, 21

    v_mov_b32 v27, v105
    v_alignbyte_b32 v26, v104, v103, 3
    v_alignbyte_b32 v25, v103, v102, 2
    v_alignbyte_b32 v24, v102, v113, 1
    v_and_b32 v70, 0xfff8, v70
    v_and_b32 v74, 0xfff8, v74
    s_cmp_lt_i32 s42, 2816
    s_cbranch_scc1 L_ufix_102
L_uback_103:

    v_subrev_co_u32 v24, s[80:81], 2.0, v24
    v_subrev_co_u32 v25, s[82:83], 2.0, v25
    v_subrev_co_u32 v26, s[84:85], 2.0, v26
    v_subrev_co_u32 v27, s[86:87], 2.0, v27
    s_mov_b64 exec, s[80:81]
    ds_read_b64 v[68:69], v68
    s_mov_b64 exec, s[82:83]
    ds_read_b64 v[70:71], v70
    s_mov_b64 exec, s[84:85]
    ds_read_b64 v[72:73], v72
    s_mov_b64 exec, s[86:87]
    ds_read_b64 v[74:75], v74
    s_mov_b64 exec, -1
    s_add_u32 s52, s43, 49152
    s_cmp_ge_u32 s25, 4
    s_cbranch_scc1 L_sk3_104
    v_lshlrev_b32 v119, 2, v0
    buffer_load_dword v88, v119, s[12:15], s52 offen
L_sk3_104:
    buffer_load_dwordx4 v[76:79], v3, s[12:15], s43 offen
    s_add_u32 s52, s43, 16384
    buffer_load_dwordx4 v[80:83], v3, s[12:15], s52 offen
    s_add_u32 s52, s43, 32768
    buffer_load_dwordx4 v[84:87], v3, s[12:15], s52 offen
    s_cmp_lg_u32 s25, 0
    s_cbranch_scc1 L_skw_105
    s_add_u32 s54, s43, 50048
    buffer_load_dword v115, v89, s[60:63], s54 offen
    s_add_u32 s54, s50, 200000
    buffer_load_dword v115, v89, s[8:11], s54 offen
L_skw_105:
    s_waitcnt vmcnt(7)
    v_lshlrev_b32_sdwa v28, 3, v35 dst_sel:WORD_0 dst_unused:UNUSED_PAD src0_sel:DWORD src1_sel:DWORD
    v_lshrrev_b32 v30, 5, v4
    v_lshlrev_b32_sdwa v32, 3, v5 dst_sel:WORD_0 dst_unused:UNUSED_PAD src0_sel:DWORD src1_sel:WORD_1
    v_alignbit_b32 v34, v7, v6, 21

    v_alignbyte_b32 v6, v6, v5, 3
    v_alignbyte_b32 v5, v5, v4, 2
    v_alignbyte_b32 v4, v4, v35, 1
    v_and_b32 v30, 0xfff8, v30
    v_and_b32 v34, 0xfff8, v34
    s_cmp_lt_i32 s42, 256
    s_cbranch_scc1 L_ufix_106
L_uback_107:

    v_subrev_co_u32 v4, s[64:65], 2.0, v4
    v_subrev_co_u32 v5, s[66:67], 2.0, v5
    v_subrev_co_u32 v6, s[68:69], 2.0, v6
    v_subrev_co_u32 v7, s[70:71], 2.0, v7
    s_mov_b64 exec, s[64:65]
    ds_read_b64 v[28:29], v28
    s_mov_b64 exec, s[66:67]
    ds_read_b64 v[30:31], v30
    s_mov_b64 exec, s[68:69]
    ds_read_b64 v[32:33], v32
    s_mov_b64 exec, s[70:71]
    ds_read_b64 v[34:35], v34
    s_mov_b64 exec, -1
    s_waitcnt vmcnt(5)
    v_lshlrev_b32_sdwa v36, 3, v43 dst_sel:WORD_0 dst_unused:UNUSED_PAD src0_sel:DWORD src1_sel:DWORD
    v_lshrrev_b32 v38, 5, v8
    v_lshlrev_b32_sdwa v40, 3, v9 dst_sel:WORD_0 dst_unused:UNUSED_PAD src0_sel:DWORD src1_sel:WORD_1
    v_alignbit_b32 v42, v11, v10, 21

    v_alignbyte_b32 v10, v10, v9, 3
    v_alignbyte_b32 v9, v9, v8, 2
    v_alignbyte_b32 v8, v8, v43, 1
    v_and_b32 v38, 0xfff8, v38
    v_and_b32 v42, 0xfff8, v42
    s_cmp_lt_i32 s42, 768
    s_cbranch_scc1 L_ufix_108
L_uback_109:

    v_subrev_co_u32 v8, s[72:73], 2.0, v8
    v_subrev_co_u32 v9, s[74:75], 2.0, v9
    v_subrev_co_u32 v10, s[76:77], 2.0, v10
    v_subrev_co_u32 v11, s[78:79], 2.0, v11
    s_mov_b64 exec, s[72:73]
    ds_read_b64 v[36:37], v36
    s_mov_b64 exec, s[74:75]
    ds_read_b64 v[38:39], v38
    s_mov_b64 exec, s[76:77]
    ds_read_b64 v[40:41], v40
    s_mov_b64 exec, s[78:79]
    ds_read_b64 v[42:43], v42
    s_mov_b64 exec, -1
    s_mov_b32 s38, s5
    s_add_u32 s50, s50, 200000
    s_branch L_batch_77
L_bend_78:

    s_waitcnt vmcnt(0)
    s_load_dwordx2 s[68:69], s[0:1], 24
    s_load_dwordx4 s[88:91], s[0:1], 72
    s_load_dwordx2 s[76:77], s[0:1], 88
    s_load_dwordx2 s[80:81], s[0:1], 96
    s_mov_b32 s70, 1600000
    s_mov_b32 s71, 0x20000
    s_mov_b32 s78, 6400000
    s_mov_b32 s79, 0x20000
    s_movk_i32 s82, 256
    s_mov_b32 s83, 0x20000
    s_lshl_b32 s48, s36, 2
    s_mov_b32 s41, s37

    s_add_u32 s84, s6, 8896512
    s_addc_u32 s85, s7, 0
    s_mov_b32 s86, 76800000
    s_mov_b32 s87, 0x20000
    s_add_u32 s72, s6, 393216
    s_addc_u32 s73, s7, 0
    s_mov_b32 s74, 2097152
    s_mov_b32 s75, 0x20000
    s_waitcnt lgkmcnt(15)
    v_mad_i32_i16 v120, v28, v4, s96
    v_mad_i32_i16 v28, v28, v4, s96 op_sel:[1,0,0,0]
    v_mad_i32_i16 v121, v29, v4, s96
    v_mad_i32_i16 v29, v29, v4, s96 op_sel:[1,0,0,0]
    v_lshlrev_b32_sdwa v4, 3, v4 dst_sel:DWORD dst_unused:UNUSED_PAD src0_sel:DWORD src1_sel:WORD_1
    v_perm_b32 v28, v28, v120, s97
    v_perm_b32 v29, v29, v121, s97
    v_lshl_add_u64 v[28:29], v[28:29], 0, s[30:31]

    ds_add_rtn_u64 v[28:29], v4, v[28:29] offset:50000
    v_mad_i32_i16 v122, v30, v5, s96
    v_mad_i32_i16 v30, v30, v5, s96 op_sel:[1,0,0,0]
    v_mad_i32_i16 v123, v31, v5, s96
    v_mad_i32_i16 v31, v31, v5, s96 op_sel:[1,0,0,0]
    v_lshlrev_b32_sdwa v5, 3, v5 dst_sel:DWORD dst_unused:UNUSED_PAD src0_sel:DWORD src1_sel:WORD_1
    v_perm_b32 v30, v30, v122, s97
    v_perm_b32 v31, v31, v123, s97
    v_lshl_add_u64 v[30:31], v[30:31], 0, s[30:31]

    ds_add_rtn_u64 v[30:31], v5, v[30:31] offset:50000
    v_mad_i32_i16 v124, v32, v6, s96
    v_mad_i32_i16 v32, v32, v6, s96 op_sel:[1,0,0,0]
    v_mad_i32_i16 v125, v33, v6, s96
    v_mad_i32_i16 v33, v33, v6, s96 op_sel:[1,0,0,0]
    v_lshlrev_b32_sdwa v6, 3, v6 dst_sel:DWORD dst_unused:UNUSED_PAD src0_sel:DWORD src1_sel:WORD_1
    v_perm_b32 v32, v32, v124, s97
    v_perm_b32 v33, v33, v125, s97
    v_lshl_add_u64 v[32:33], v[32:33], 0, s[30:31]

    ds_add_rtn_u64 v[32:33], v6, v[32:33] offset:50000
    v_mad_i32_i16 v126, v34, v7, s96
    v_mad_i32_i16 v34, v34, v7, s96 op_sel:[1,0,0,0]
    v_mad_i32_i16 v127, v35, v7, s96
    v_mad_i32_i16 v35, v35, v7, s96 op_sel:[1,0,0,0]
    v_lshlrev_b32_sdwa v7, 3, v7 dst_sel:DWORD dst_unused:UNUSED_PAD src0_sel:DWORD src1_sel:WORD_1
    v_perm_b32 v34, v34, v126, s97
    v_perm_b32 v35, v35, v127, s97
    v_lshl_add_u64 v[34:35], v[34:35], 0, s[30:31]

    ds_add_rtn_u64 v[34:35], v7, v[34:35] offset:50000
    s_waitcnt lgkmcnt(0)
    s_load_dwordx8 s[12:19], s[88:89], 0
    s_load_dwordx8 s[56:63], s[90:91], 0

    s_mul_i32 s28, s41, 3125
    s_add_u32 s29, s28, 3126
    s_add_u32 s28, s28, 1
    s_lshr_b32 s28, s28, 1
    s_lshr_b32 s29, s29, 1
    s_sub_u32 s29, s29, s28
    s_sub_u32 s5, s29, 782
    s_mul_i32 s3, s36, 6250
    v_add_u32 v78, s28, v0
    v_mov_b32 v82, 0x2000000
    v_add_u32 v79, 782, v78
    v_cmp_gt_u32 vcc, 782, v0
    v_add_u32 v76, s3, v78
    v_add_u32 v77, s3, v79
    v_cndmask_b32 v76, v82, v76, vcc
    v_cmp_gt_u32 vcc, s5, v0
    v_lshlrev_b32 v78, 4, v78
    v_lshlrev_b32 v79, 4, v79
    v_cndmask_b32 v77, v82, v77, vcc
    v_lshlrev_b32 v80, 2, v76
    v_lshlrev_b32 v76, 4, v76
    v_lshlrev_b32 v81, 2, v77
    v_lshlrev_b32 v77, 4, v77
    buffer_load_dword v80, v80, s[68:71], 0 offen
    buffer_load_dword v81, v81, s[68:71], 0 offen
    buffer_load_dwordx4 v[86:89], v76, s[8:11], 0 offen
    buffer_load_dwordx4 v[90:93], v77, s[8:11], 0 offen

    v_mad_i32_i16 v120, v36, v8, s96
    v_mad_i32_i16 v36, v36, v8, s96 op_sel:[1,0,0,0]
    v_mad_i32_i16 v121, v37, v8, s96
    v_mad_i32_i16 v37, v37, v8, s96 op_sel:[1,0,0,0]
    v_lshlrev_b32_sdwa v8, 3, v8 dst_sel:DWORD dst_unused:UNUSED_PAD src0_sel:DWORD src1_sel:WORD_1
    v_perm_b32 v36, v36, v120, s97
    v_perm_b32 v37, v37, v121, s97
    v_lshl_add_u64 v[36:37], v[36:37], 0, s[30:31]

    ds_add_rtn_u64 v[36:37], v8, v[36:37] offset:50000
    v_mad_i32_i16 v122, v38, v9, s96
    v_mad_i32_i16 v38, v38, v9, s96 op_sel:[1,0,0,0]
    v_mad_i32_i16 v123, v39, v9, s96
    v_mad_i32_i16 v39, v39, v9, s96 op_sel:[1,0,0,0]
    v_lshlrev_b32_sdwa v9, 3, v9 dst_sel:DWORD dst_unused:UNUSED_PAD src0_sel:DWORD src1_sel:WORD_1
    v_perm_b32 v38, v38, v122, s97
    v_perm_b32 v39, v39, v123, s97
    v_lshl_add_u64 v[38:39], v[38:39], 0, s[30:31]

    ds_add_rtn_u64 v[38:39], v9, v[38:39] offset:50000
    v_mad_i32_i16 v124, v40, v10, s96
    v_mad_i32_i16 v40, v40, v10, s96 op_sel:[1,0,0,0]
    v_mad_i32_i16 v125, v41, v10, s96
    v_mad_i32_i16 v41, v41, v10, s96 op_sel:[1,0,0,0]
    v_lshlrev_b32_sdwa v10, 3, v10 dst_sel:DWORD dst_unused:UNUSED_PAD src0_sel:DWORD src1_sel:WORD_1
    v_perm_b32 v40, v40, v124, s97
    v_perm_b32 v41, v41, v125, s97
    v_lshl_add_u64 v[40:41], v[40:41], 0, s[30:31]

    ds_add_rtn_u64 v[40:41], v10, v[40:41] offset:50000
    v_mad_i32_i16 v126, v42, v11, s96
    v_mad_i32_i16 v42, v42, v11, s96 op_sel:[1,0,0,0]
    v_mad_i32_i16 v127, v43, v11, s96
    v_mad_i32_i16 v43, v43, v11, s96 op_sel:[1,0,0,0]
    v_lshlrev_b32_sdwa v11, 3, v11 dst_sel:DWORD dst_unused:UNUSED_PAD src0_sel:DWORD src1_sel:WORD_1
    v_perm_b32 v42, v42, v126, s97
    v_perm_b32 v43, v43, v127, s97
    v_lshl_add_u64 v[42:43], v[42:43], 0, s[30:31]

    ds_add_rtn_u64 v[42:43], v11, v[42:43] offset:50000
    v_or3_b32 v1, v28, v29, v1
    v_or3_b32 v1, v30, v31, v1
    v_or3_b32 v1, v32, v33, v1
    v_or3_b32 v1, v34, v35, v1
    v_mad_i32_i16 v120, v44, v12, s96
    v_mad_i32_i16 v44, v44, v12, s96 op_sel:[1,0,0,0]
    v_mad_i32_i16 v121, v45, v12, s96
    v_mad_i32_i16 v45, v45, v12, s96 op_sel:[1,0,0,0]
    v_lshlrev_b32_sdwa v12, 3, v12 dst_sel:DWORD dst_unused:UNUSED_PAD src0_sel:DWORD src1_sel:WORD_1
    v_perm_b32 v44, v44, v120, s97
    v_perm_b32 v45, v45, v121, s97
    v_lshl_add_u64 v[44:45], v[44:45], 0, s[30:31]

    ds_add_rtn_u64 v[44:45], v12, v[44:45] offset:50000
    v_mad_i32_i16 v122, v46, v13, s96
    v_mad_i32_i16 v46, v46, v13, s96 op_sel:[1,0,0,0]
    v_mad_i32_i16 v123, v47, v13, s96
    v_mad_i32_i16 v47, v47, v13, s96 op_sel:[1,0,0,0]
    v_lshlrev_b32_sdwa v13, 3, v13 dst_sel:DWORD dst_unused:UNUSED_PAD src0_sel:DWORD src1_sel:WORD_1
    v_perm_b32 v46, v46, v122, s97
    v_perm_b32 v47, v47, v123, s97
    v_lshl_add_u64 v[46:47], v[46:47], 0, s[30:31]

    ds_add_rtn_u64 v[46:47], v13, v[46:47] offset:50000
    v_mad_i32_i16 v124, v48, v14, s96
    v_mad_i32_i16 v48, v48, v14, s96 op_sel:[1,0,0,0]
    v_mad_i32_i16 v125, v49, v14, s96
    v_mad_i32_i16 v49, v49, v14, s96 op_sel:[1,0,0,0]
    v_lshlrev_b32_sdwa v14, 3, v14 dst_sel:DWORD dst_unused:UNUSED_PAD src0_sel:DWORD src1_sel:WORD_1
    v_perm_b32 v48, v48, v124, s97
    v_perm_b32 v49, v49, v125, s97
    v_lshl_add_u64 v[48:49], v[48:49], 0, s[30:31]

    ds_add_rtn_u64 v[48:49], v14, v[48:49] offset:50000
    v_mad_i32_i16 v126, v50, v15, s96
    v_mad_i32_i16 v50, v50, v15, s96 op_sel:[1,0,0,0]
    v_mad_i32_i16 v127, v51, v15, s96
    v_mad_i32_i16 v51, v51, v15, s96 op_sel:[1,0,0,0]
    v_lshlrev_b32_sdwa v15, 3, v15 dst_sel:DWORD dst_unused:UNUSED_PAD src0_sel:DWORD src1_sel:WORD_1
    v_perm_b32 v50, v50, v126, s97
    v_perm_b32 v51, v51, v127, s97
    v_lshl_add_u64 v[50:51], v[50:51], 0, s[30:31]

    ds_add_rtn_u64 v[50:51], v15, v[50:51] offset:50000
    s_waitcnt lgkmcnt(4)
    v_or3_b32 v1, v36, v37, v1
    v_or3_b32 v1, v38, v39, v1
    v_or3_b32 v1, v40, v41, v1
    v_or3_b32 v1, v42, v43, v1
    v_mad_i32_i16 v120, v52, v16, s96
    v_mad_i32_i16 v52, v52, v16, s96 op_sel:[1,0,0,0]
    v_mad_i32_i16 v121, v53, v16, s96
    v_mad_i32_i16 v53, v53, v16, s96 op_sel:[1,0,0,0]
    v_lshlrev_b32_sdwa v16, 3, v16 dst_sel:DWORD dst_unused:UNUSED_PAD src0_sel:DWORD src1_sel:WORD_1
    v_perm_b32 v52, v52, v120, s97
    v_perm_b32 v53, v53, v121, s97
    v_lshl_add_u64 v[52:53], v[52:53], 0, s[30:31]

    ds_add_rtn_u64 v[52:53], v16, v[52:53] offset:50000
    v_mad_i32_i16 v122, v54, v17, s96
    v_mad_i32_i16 v54, v54, v17, s96 op_sel:[1,0,0,0]
    v_mad_i32_i16 v123, v55, v17, s96
    v_mad_i32_i16 v55, v55, v17, s96 op_sel:[1,0,0,0]
    v_lshlrev_b32_sdwa v17, 3, v17 dst_sel:DWORD dst_unused:UNUSED_PAD src0_sel:DWORD src1_sel:WORD_1
    v_perm_b32 v54, v54, v122, s97
    v_perm_b32 v55, v55, v123, s97
    v_lshl_add_u64 v[54:55], v[54:55], 0, s[30:31]

    ds_add_rtn_u64 v[54:55], v17, v[54:55] offset:50000
    v_mad_i32_i16 v124, v56, v18, s96
    v_mad_i32_i16 v56, v56, v18, s96 op_sel:[1,0,0,0]
    v_mad_i32_i16 v125, v57, v18, s96
    v_mad_i32_i16 v57, v57, v18, s96 op_sel:[1,0,0,0]
    v_lshlrev_b32_sdwa v18, 3, v18 dst_sel:DWORD dst_unused:UNUSED_PAD src0_sel:DWORD src1_sel:WORD_1
    v_perm_b32 v56, v56, v124, s97
    v_perm_b32 v57, v57, v125, s97
    v_lshl_add_u64 v[56:57], v[56:57], 0, s[30:31]

    ds_add_rtn_u64 v[56:57], v18, v[56:57] offset:50000
    v_mad_i32_i16 v126, v58, v19, s96
    v_mad_i32_i16 v58, v58, v19, s96 op_sel:[1,0,0,0]
    v_mad_i32_i16 v127, v59, v19, s96
    v_mad_i32_i16 v59, v59, v19, s96 op_sel:[1,0,0,0]
    v_lshlrev_b32_sdwa v19, 3, v19 dst_sel:DWORD dst_unused:UNUSED_PAD src0_sel:DWORD src1_sel:WORD_1
    v_perm_b32 v58, v58, v126, s97
    v_perm_b32 v59, v59, v127, s97
    v_lshl_add_u64 v[58:59], v[58:59], 0, s[30:31]

    ds_add_rtn_u64 v[58:59], v19, v[58:59] offset:50000
    s_waitcnt lgkmcnt(4)
    v_or3_b32 v1, v44, v45, v1
    v_or3_b32 v1, v46, v47, v1
    v_or3_b32 v1, v48, v49, v1
    v_or3_b32 v1, v50, v51, v1
    s_waitcnt vmcnt(2)
    v_lshlrev_b32_sdwa v82, 5, v80 dst_sel:DWORD dst_unused:UNUSED_PAD src0_sel:DWORD src1_sel:WORD_0
    v_lshlrev_b32_sdwa v83, 5, v80 dst_sel:DWORD dst_unused:UNUSED_PAD src0_sel:DWORD src1_sel:WORD_1
    v_lshlrev_b32_sdwa v84, 5, v81 dst_sel:DWORD dst_unused:UNUSED_PAD src0_sel:DWORD src1_sel:WORD_0
    v_lshlrev_b32_sdwa v85, 5, v81 dst_sel:DWORD dst_unused:UNUSED_PAD src0_sel:DWORD src1_sel:WORD_1
    buffer_load_dwordx4 v[94:97], v82, s[72:75], 0 offen
    buffer_load_dwordx2 v[110:111], v82, s[72:75], 0 offen offset:16

    buffer_load_dwordx4 v[98:101], v83, s[72:75], 0 offen
    buffer_load_dwordx2 v[112:113], v83, s[72:75], 0 offen offset:16

    buffer_load_dwordx4 v[102:105], v84, s[72:75], 0 offen
    buffer_load_dwordx2 v[114:115], v84, s[72:75], 0 offen offset:16

    buffer_load_dwordx4 v[106:109], v85, s[72:75], 0 offen
    buffer_load_dwordx2 v[116:117], v85, s[72:75], 0 offen offset:16

    v_mad_i32_i16 v120, v60, v20, s96
    v_mad_i32_i16 v60, v60, v20, s96 op_sel:[1,0,0,0]
    v_mad_i32_i16 v121, v61, v20, s96
    v_mad_i32_i16 v61, v61, v20, s96 op_sel:[1,0,0,0]
    v_lshlrev_b32_sdwa v20, 3, v20 dst_sel:DWORD dst_unused:UNUSED_PAD src0_sel:DWORD src1_sel:WORD_1
    v_perm_b32 v60, v60, v120, s97
    v_perm_b32 v61, v61, v121, s97
    v_lshl_add_u64 v[60:61], v[60:61], 0, s[30:31]

    ds_add_rtn_u64 v[60:61], v20, v[60:61] offset:50000
    v_mad_i32_i16 v122, v62, v21, s96
    v_mad_i32_i16 v62, v62, v21, s96 op_sel:[1,0,0,0]
    v_mad_i32_i16 v123, v63, v21, s96
    v_mad_i32_i16 v63, v63, v21, s96 op_sel:[1,0,0,0]
    v_lshlrev_b32_sdwa v21, 3, v21 dst_sel:DWORD dst_unused:UNUSED_PAD src0_sel:DWORD src1_sel:WORD_1
    v_perm_b32 v62, v62, v122, s97
    v_perm_b32 v63, v63, v123, s97
    v_lshl_add_u64 v[62:63], v[62:63], 0, s[30:31]

    ds_add_rtn_u64 v[62:63], v21, v[62:63] offset:50000
    v_mad_i32_i16 v124, v64, v22, s96
    v_mad_i32_i16 v64, v64, v22, s96 op_sel:[1,0,0,0]
    v_mad_i32_i16 v125, v65, v22, s96
    v_mad_i32_i16 v65, v65, v22, s96 op_sel:[1,0,0,0]
    v_lshlrev_b32_sdwa v22, 3, v22 dst_sel:DWORD dst_unused:UNUSED_PAD src0_sel:DWORD src1_sel:WORD_1
    v_perm_b32 v64, v64, v124, s97
    v_perm_b32 v65, v65, v125, s97
    v_lshl_add_u64 v[64:65], v[64:65], 0, s[30:31]

    ds_add_rtn_u64 v[64:65], v22, v[64:65] offset:50000
    v_mad_i32_i16 v126, v66, v23, s96
    v_mad_i32_i16 v66, v66, v23, s96 op_sel:[1,0,0,0]
    v_mad_i32_i16 v127, v67, v23, s96
    v_mad_i32_i16 v67, v67, v23, s96 op_sel:[1,0,0,0]
    v_lshlrev_b32_sdwa v23, 3, v23 dst_sel:DWORD dst_unused:UNUSED_PAD src0_sel:DWORD src1_sel:WORD_1
    v_perm_b32 v66, v66, v126, s97
    v_perm_b32 v67, v67, v127, s97
    v_lshl_add_u64 v[66:67], v[66:67], 0, s[30:31]

    ds_add_rtn_u64 v[66:67], v23, v[66:67] offset:50000
    s_waitcnt lgkmcnt(4)
    v_or3_b32 v1, v52, v53, v1
    v_or3_b32 v1, v54, v55, v1
    v_or3_b32 v1, v56, v57, v1
    v_or3_b32 v1, v58, v59, v1
    v_mad_i32_i16 v120, v68, v24, s96
    v_mad_i32_i16 v68, v68, v24, s96 op_sel:[1,0,0,0]
    v_mad_i32_i16 v121, v69, v24, s96
    v_mad_i32_i16 v69, v69, v24, s96 op_sel:[1,0,0,0]
    v_lshlrev_b32_sdwa v24, 3, v24 dst_sel:DWORD dst_unused:UNUSED_PAD src0_sel:DWORD src1_sel:WORD_1
    v_perm_b32 v68, v68, v120, s97
    v_perm_b32 v69, v69, v121, s97
    v_lshl_add_u64 v[68:69], v[68:69], 0, s[30:31]

    ds_add_rtn_u64 v[68:69], v24, v[68:69] offset:50000
    v_mad_i32_i16 v122, v70, v25, s96
    v_mad_i32_i16 v70, v70, v25, s96 op_sel:[1,0,0,0]
    v_mad_i32_i16 v123, v71, v25, s96
    v_mad_i32_i16 v71, v71, v25, s96 op_sel:[1,0,0,0]
    v_lshlrev_b32_sdwa v25, 3, v25 dst_sel:DWORD dst_unused:UNUSED_PAD src0_sel:DWORD src1_sel:WORD_1
    v_perm_b32 v70, v70, v122, s97
    v_perm_b32 v71, v71, v123, s97
    v_lshl_add_u64 v[70:71], v[70:71], 0, s[30:31]

    ds_add_rtn_u64 v[70:71], v25, v[70:71] offset:50000
    v_mad_i32_i16 v124, v72, v26, s96
    v_mad_i32_i16 v72, v72, v26, s96 op_sel:[1,0,0,0]
    v_mad_i32_i16 v125, v73, v26, s96
    v_mad_i32_i16 v73, v73, v26, s96 op_sel:[1,0,0,0]
    v_lshlrev_b32_sdwa v26, 3, v26 dst_sel:DWORD dst_unused:UNUSED_PAD src0_sel:DWORD src1_sel:WORD_1
    v_perm_b32 v72, v72, v124, s97
    v_perm_b32 v73, v73, v125, s97
    v_lshl_add_u64 v[72:73], v[72:73], 0, s[30:31]

    ds_add_rtn_u64 v[72:73], v26, v[72:73] offset:50000
    v_mad_i32_i16 v126, v74, v27, s96
    v_mad_i32_i16 v74, v74, v27, s96 op_sel:[1,0,0,0]
    v_mad_i32_i16 v127, v75, v27, s96
    v_mad_i32_i16 v75, v75, v27, s96 op_sel:[1,0,0,0]
    v_lshlrev_b32_sdwa v27, 3, v27 dst_sel:DWORD dst_unused:UNUSED_PAD src0_sel:DWORD src1_sel:WORD_1
    v_perm_b32 v74, v74, v126, s97
    v_perm_b32 v75, v75, v127, s97
    v_lshl_add_u64 v[74:75], v[74:75], 0, s[30:31]

    ds_add_rtn_u64 v[74:75], v27, v[74:75] offset:50000
    s_waitcnt lgkmcnt(4)
    v_or3_b32 v1, v60, v61, v1
    v_or3_b32 v1, v62, v63, v1
    v_or3_b32 v1, v64, v65, v1
    v_or3_b32 v1, v66, v67, v1
    s_waitcnt lgkmcnt(0)
    v_or3_b32 v1, v68, v69, v1
    v_or3_b32 v1, v70, v71, v1
    v_or3_b32 v1, v72, v73, v1
    v_or3_b32 v1, v74, v75, v1
    s_barrier

    v_add_u32 v40, 50000, v3
    v_add_u32 v41, 115536, v3
    v_cmp_gt_u32 vcc, 106, v0

    v_mov_b32 v28, 0
    v_mov_b32 v29, 0
    v_mov_b32 v30, 0
    v_mov_b32 v31, 0
    ds_read_b128 v[4:7], v40 offset:0
    ds_read_b128 v[8:11], v40 offset:16384
    ds_read_b128 v[12:15], v40 offset:32768
    ds_read_b128 v[16:19], v40 offset:49152
    ds_read_b128 v[20:23], v41 offset:0
    ds_read_b128 v[24:27], v41 offset:16384
    s_mov_b64 exec, vcc
    ds_read_b128 v[28:31], v41 offset:32768
    s_mov_b64 exec, -1
    s_mul_i32 s3, s37, 6400000
    s_mul_i32 s5, s36, 100000
    s_add_u32 s3, s3, s5
    s_add_u32 s3, s3, 8896512
    v_bfrev_b32 v42, 1

    s_add_u32 s20, s6, s3
    s_addc_u32 s21, s7, 0
    s_mov_b32 s22, 100000
    s_mov_b32 s23, 0x20000
    s_sub_u32 s3, 0, s28
    v_add_u32 v43, s3, v0
    v_cmp_gt_u32 vcc, s29, v43
    s_mov_b32 s3, 0
    s_waitcnt lgkmcnt(6)
    v_cndmask_b32 v43, v3, v42, vcc
    buffer_store_dwordx4 v[4:7], v43, s[20:23], s3 offen sc1

    s_sub_u32 s3, 1024, s28
    v_add_u32 v43, s3, v0
    v_cmp_gt_u32 vcc, s29, v43
    s_mov_b32 s3, 16384
    s_waitcnt lgkmcnt(5)
    v_cndmask_b32 v43, v3, v42, vcc
    buffer_store_dwordx4 v[8:11], v43, s[20:23], s3 offen sc1

    s_sub_u32 s3, 2048, s28
    v_add_u32 v43, s3, v0
    v_cmp_gt_u32 vcc, s29, v43
    s_mov_b32 s3, 32768
    s_waitcnt lgkmcnt(4)
    v_cndmask_b32 v43, v3, v42, vcc
    buffer_store_dwordx4 v[12:15], v43, s[20:23], s3 offen sc1

    s_sub_u32 s3, 3072, s28
    v_add_u32 v43, s3, v0
    v_cmp_gt_u32 vcc, s29, v43
    s_mov_b32 s3, 49152
    s_waitcnt lgkmcnt(3)
    v_cndmask_b32 v43, v3, v42, vcc
    buffer_store_dwordx4 v[16:19], v43, s[20:23], s3 offen sc1

    s_sub_u32 s3, 4096, s28
    v_add_u32 v43, s3, v0
    v_cmp_gt_u32 vcc, s29, v43
    s_mov_b32 s3, 65536
    s_waitcnt lgkmcnt(2)
    v_cndmask_b32 v43, v3, v42, vcc
    buffer_store_dwordx4 v[20:23], v43, s[20:23], s3 offen sc1

    s_sub_u32 s3, 5120, s28
    v_add_u32 v43, s3, v0
    v_cmp_gt_u32 vcc, s29, v43
    s_mov_b32 s3, 81920
    s_waitcnt lgkmcnt(1)
    v_cndmask_b32 v43, v3, v42, vcc
    buffer_store_dwordx4 v[24:27], v43, s[20:23], s3 offen sc1

    s_sub_u32 s3, 6144, s28
    v_add_u32 v43, s3, v0
    v_cmp_gt_u32 vcc, s29, v43
    s_mov_b32 s3, 98304
    s_waitcnt lgkmcnt(0)
    v_cndmask_b32 v43, v3, v42, vcc
    buffer_store_dwordx4 v[28:31], v43, s[20:23], s3 offen sc1

    v_or3_b32 v1, v4, v5, v1
    v_or3_b32 v1, v6, v7, v1
    v_or3_b32 v1, v8, v9, v1
    v_or3_b32 v1, v10, v11, v1
    v_or3_b32 v1, v12, v13, v1
    v_or3_b32 v1, v14, v15, v1
    v_or3_b32 v1, v16, v17, v1
    v_or3_b32 v1, v18, v19, v1
    v_or3_b32 v1, v20, v21, v1
    v_or3_b32 v1, v22, v23, v1
    v_or3_b32 v1, v24, v25, v1
    v_or3_b32 v1, v26, v27, v1
    v_or3_b32 v1, v28, v29, v1
    v_or3_b32 v1, v30, v31, v1
    v_and_b32 v1, 0x80008000, v1
    v_cmp_ne_u32 vcc, 0, v1
    v_mov_b32 v40, 150024
    v_mov_b32 v41, 1
    s_cbranch_vccz L_nf_110
    ds_write_b32 v40, v41
L_nf_110:
    s_mov_b32 s33, 1
    s_mov_b32 s49, s37
    s_waitcnt vmcnt(0) lgkmcnt(0)

    s_barrier
    ds_read_b32 v41, v40
    s_waitcnt lgkmcnt(0)
    v_readfirstlane_b32 s3, v41
    s_nop 1
    s_cmp_lg_u32 s3, 0
    s_cbranch_scc1 L_p2slow_53

L_meet_112:
    v_readfirstlane_b32 s3, v0
    v_mov_b32 v118, 150016
    s_nop 0
    s_cmp_eq_u32 s3, 960
    s_cbranch_scc1 L_sync_119
L_bcast_114:
    s_barrier

    ds_read_b32 v119, v118
    s_waitcnt lgkmcnt(0)
    v_readfirstlane_b32 s35, v119
    s_nop 1
    s_bitcmp1_b32 s35, 16
    s_cbranch_scc1 L_fend_120
L_post_116:
    v_cmp_gt_u32 vcc, 782, v0
    s_mov_b64 exec, vcc
    s_cbranch_execz L_postend_117

    s_cmp_eq_u32 s49, 0
    s_cbranch_scc1 L_own_126
    s_mov_b32 s3, 0
    buffer_load_dwordx4 v[36:39], v76, s[84:87], s3 offen sc1
    buffer_load_dwordx4 v[52:55], v77, s[84:87], s3 offen sc1
L_obk_127:
    s_cmp_eq_u32 s49, 1
    s_cbranch_scc1 L_own_128
    s_mov_b32 s3, 6400000
    buffer_load_dwordx4 v[40:43], v76, s[84:87], s3 offen sc1
    buffer_load_dwordx4 v[56:59], v77, s[84:87], s3 offen sc1
L_obk_129:
    s_cmp_eq_u32 s49, 2
    s_cbranch_scc1 L_own_130
    s_mov_b32 s3, 12800000
    buffer_load_dwordx4 v[44:47], v76, s[84:87], s3 offen sc1
    buffer_load_dwordx4 v[60:63], v77, s[84:87], s3 offen sc1
L_obk_131:
    s_cmp_eq_u32 s49, 3
    s_cbranch_scc1 L_own_132
    s_mov_b32 s3, 19200000
    buffer_load_dwordx4 v[48:51], v76, s[84:87], s3 offen sc1
    buffer_load_dwordx4 v[64:67], v77, s[84:87], s3 offen sc1
L_obk_133:
    s_and_b32 s3, s35, 0xf0
    s_waitcnt vmcnt(0) lgkmcnt(0)
    s_cbranch_scc1 L_fgen_134

    v_add_u32 v36, v36, v40
    v_add_u32 v44, v44, v48
    v_add_u32 v37, v37, v41
    v_add_u32 v45, v45, v49
    v_add_u32 v38, v38, v42
    v_add_u32 v46, v46, v50
    v_add_u32 v39, v39, v43
    v_add_u32 v47, v47, v51
    v_add_u32_sdwa v4, v36, v44 dst_sel:DWORD dst_unused:UNUSED_PAD src0_sel:WORD_0 src1_sel:WORD_0
    v_add_u32_sdwa v5, v36, v44 dst_sel:DWORD dst_unused:UNUSED_PAD src0_sel:WORD_1 src1_sel:WORD_1
    v_add_u32_sdwa v6, v37, v45 dst_sel:DWORD dst_unused:UNUSED_PAD src0_sel:WORD_0 src1_sel:WORD_0
    v_add_u32_sdwa v7, v37, v45 dst_sel:DWORD dst_unused:UNUSED_PAD src0_sel:WORD_1 src1_sel:WORD_1
    v_add_u32_sdwa v8, v38, v46 dst_sel:DWORD dst_unused:UNUSED_PAD src0_sel:WORD_0 src1_sel:WORD_0
    v_add_u32_sdwa v9, v38, v46 dst_sel:DWORD dst_unused:UNUSED_PAD src0_sel:WORD_1 src1_sel:WORD_1
    v_add_u32_sdwa v10, v39, v47 dst_sel:DWORD dst_unused:UNUSED_PAD src0_sel:WORD_0 src1_sel:WORD_0
    v_add_u32_sdwa v11, v39, v47 dst_sel:DWORD dst_unused:UNUSED_PAD src0_sel:WORD_1 src1_sel:WORD_1
    v_add_u32 v52, v52, v56
    v_add_u32 v60, v60, v64
    v_add_u32 v53, v53, v57
    v_add_u32 v61, v61, v65
    v_add_u32 v54, v54, v58
    v_add_u32 v62, v62, v66
    v_add_u32 v55, v55, v59
    v_add_u32 v63, v63, v67
    v_add_u32_sdwa v12, v52, v60 dst_sel:DWORD dst_unused:UNUSED_PAD src0_sel:WORD_0 src1_sel:WORD_0
    v_add_u32_sdwa v13, v52, v60 dst_sel:DWORD dst_unused:UNUSED_PAD src0_sel:WORD_1 src1_sel:WORD_1
    v_add_u32_sdwa v14, v53, v61 dst_sel:DWORD dst_unused:UNUSED_PAD src0_sel:WORD_0 src1_sel:WORD_0
    v_add_u32_sdwa v15, v53, v61 dst_sel:DWORD dst_unused:UNUSED_PAD src0_sel:WORD_1 src1_sel:WORD_1
    v_add_u32_sdwa v16, v54, v62 dst_sel:DWORD dst_unused:UNUSED_PAD src0_sel:WORD_0 src1_sel:WORD_0
    v_add_u32_sdwa v17, v54, v62 dst_sel:DWORD dst_unused:UNUSED_PAD src0_sel:WORD_1 src1_sel:WORD_1
    v_add_u32_sdwa v18, v55, v63 dst_sel:DWORD dst_unused:UNUSED_PAD src0_sel:WORD_0 src1_sel:WORD_0
    v_add_u32_sdwa v19, v55, v63 dst_sel:DWORD dst_unused:UNUSED_PAD src0_sel:WORD_1 src1_sel:WORD_1
    v_add_u32 v4, 0xffff0000, v4
    v_add_u32 v5, 0xffff0000, v5
    v_add_u32 v6, 0xffff0000, v6
    v_add_u32 v7, 0xffff0000, v7
    v_add_u32 v8, 0xffff0000, v8
    v_add_u32 v9, 0xffff0000, v9
    v_add_u32 v10, 0xffff0000, v10
    v_add_u32 v11, 0xffff0000, v11
    v_add_u32 v12, 0xffff0000, v12
    v_add_u32 v13, 0xffff0000, v13
    v_add_u32 v14, 0xffff0000, v14
    v_add_u32 v15, 0xffff0000, v15
    v_add_u32 v16, 0xffff0000, v16
    v_add_u32 v17, 0xffff0000, v17
    v_add_u32 v18, 0xffff0000, v18
    v_add_u32 v19, 0xffff0000, v19
    v_cvt_f32_i32 v4, v4
    v_cvt_f32_i32 v5, v5
    v_cvt_f32_i32 v6, v6
    v_cvt_f32_i32 v7, v7
    v_cvt_f32_i32 v8, v8
    v_cvt_f32_i32 v9, v9
    v_cvt_f32_i32 v10, v10
    v_cvt_f32_i32 v11, v11
    v_cvt_f32_i32 v12, v12
    v_cvt_f32_i32 v13, v13
    v_cvt_f32_i32 v14, v14
    v_cvt_f32_i32 v15, v15
    v_cvt_f32_i32 v16, v16
    v_cvt_f32_i32 v17, v17
    v_cvt_f32_i32 v18, v18
    v_cvt_f32_i32 v19, v19
    v_mul_f32 v4, s34, v4
    v_mul_f32 v5, s34, v5
    v_mul_f32 v6, s34, v6
    v_mul_f32 v7, s34, v7
    v_mul_f32 v8, s34, v8
    v_mul_f32 v9, s34, v9
    v_mul_f32 v10, s34, v10
    v_mul_f32 v11, s34, v11
    v_mul_f32 v12, s34, v12
    v_mul_f32 v13, s34, v13
    v_mul_f32 v14, s34, v14
    v_mul_f32 v15, s34, v15
    v_mul_f32 v16, s34, v16
    v_mul_f32 v17, s34, v17
    v_mul_f32 v18, s34, v18
    v_mul_f32 v19, s34, v19
L_fbk_135:
    s_lshl_b32 s52, s12, 16
    v_mul_f32 v20, s52, v4
    v_mul_f32 v24, s52, v8
    v_mul_f32 v28, s52, v12
    v_mul_f32 v32, s52, v16
    s_and_b32 s53, s12, s32
    v_mul_f32 v21, s53, v4
    v_mul_f32 v25, s53, v8
    v_mul_f32 v29, s53, v12
    v_mul_f32 v33, s53, v16
    s_lshl_b32 s52, s13, 16
    v_mul_f32 v22, s52, v4
    v_mul_f32 v26, s52, v8
    v_mul_f32 v30, s52, v12
    v_mul_f32 v34, s52, v16
    s_and_b32 s53, s13, s32
    v_mul_f32 v23, s53, v4
    v_mul_f32 v27, s53, v8
    v_mul_f32 v31, s53, v12
    v_mul_f32 v35, s53, v16
    s_lshl_b32 s52, s14, 16
    v_fmac_f32 v20, s52, v5
    v_fmac_f32 v24, s52, v9
    v_fmac_f32 v28, s52, v13
    v_fmac_f32 v32, s52, v17
    s_and_b32 s53, s14, s32
    v_fmac_f32 v21, s53, v5
    v_fmac_f32 v25, s53, v9
    v_fmac_f32 v29, s53, v13
    v_fmac_f32 v33, s53, v17
    s_lshl_b32 s52, s15, 16
    v_fmac_f32 v22, s52, v5
    v_fmac_f32 v26, s52, v9
    v_fmac_f32 v30, s52, v13
    v_fmac_f32 v34, s52, v17
    s_and_b32 s53, s15, s32
    v_fmac_f32 v23, s53, v5
    v_fmac_f32 v27, s53, v9
    v_fmac_f32 v31, s53, v13
    v_fmac_f32 v35, s53, v17
    s_lshl_b32 s52, s16, 16
    v_fmac_f32 v20, s52, v6
    v_fmac_f32 v24, s52, v10
    v_fmac_f32 v28, s52, v14
    v_fmac_f32 v32, s52, v18
    s_and_b32 s53, s16, s32
    v_fmac_f32 v21, s53, v6
    v_fmac_f32 v25, s53, v10
    v_fmac_f32 v29, s53, v14
    v_fmac_f32 v33, s53, v18
    s_lshl_b32 s52, s17, 16
    v_fmac_f32 v22, s52, v6
    v_fmac_f32 v26, s52, v10
    v_fmac_f32 v30, s52, v14
    v_fmac_f32 v34, s52, v18
    s_and_b32 s53, s17, s32
    v_fmac_f32 v23, s53, v6
    v_fmac_f32 v27, s53, v10
    v_fmac_f32 v31, s53, v14
    v_fmac_f32 v35, s53, v18
    s_lshl_b32 s52, s18, 16
    v_fmac_f32 v20, s52, v7
    v_fmac_f32 v24, s52, v11
    v_fmac_f32 v28, s52, v15
    v_fmac_f32 v32, s52, v19
    s_and_b32 s53, s18, s32
    v_fmac_f32 v21, s53, v7
    v_fmac_f32 v25, s53, v11
    v_fmac_f32 v29, s53, v15
    v_fmac_f32 v33, s53, v19
    s_lshl_b32 s52, s19, 16
    v_fmac_f32 v22, s52, v7
    v_fmac_f32 v26, s52, v11
    v_fmac_f32 v30, s52, v15
    v_fmac_f32 v34, s52, v19
    s_and_b32 s53, s19, s32
    v_fmac_f32 v23, s53, v7
    v_fmac_f32 v27, s53, v11
    v_fmac_f32 v31, s53, v15
    v_fmac_f32 v35, s53, v19
    v_mul_f32 v20, v20, v94
    v_mul_f32 v21, v21, v95
    v_mul_f32 v22, v22, v96
    v_mul_f32 v23, v23, v97
    v_mul_f32 v24, v24, v98
    v_mul_f32 v25, v25, v99
    v_mul_f32 v26, v26, v100
    v_mul_f32 v27, v27, v101
    v_mul_f32 v28, v28, v102
    v_mul_f32 v29, v29, v103
    v_mul_f32 v30, v30, v104
    v_mul_f32 v31, v31, v105
    v_mul_f32 v32, v32, v106
    v_mul_f32 v33, v33, v107
    v_mul_f32 v34, v34, v108
    v_mul_f32 v35, v35, v109
    v_cvt_pk_bf16_f32 v20, v20, v21
    v_cvt_pk_bf16_f32 v22, v22, v23
    v_cvt_pk_bf16_f32 v24, v24, v25
    v_cvt_pk_bf16_f32 v26, v26, v27
    v_cvt_pk_bf16_f32 v28, v28, v29
    v_cvt_pk_bf16_f32 v30, v30, v31
    v_cvt_pk_bf16_f32 v32, v32, v33
    v_cvt_pk_bf16_f32 v34, v34, v35
    s_pack_ll_b32_b16 s52, s56, s58
    v_dot2_f32_bf16 v4, v20, s52, 0
    v_dot2_f32_bf16 v8, v24, s52, 0
    v_dot2_f32_bf16 v12, v28, s52, 0
    v_dot2_f32_bf16 v16, v32, s52, 0
    s_pack_hh_b32_b16 s53, s56, s58
    v_dot2_f32_bf16 v5, v20, s53, 0
    v_dot2_f32_bf16 v9, v24, s53, 0
    v_dot2_f32_bf16 v13, v28, s53, 0
    v_dot2_f32_bf16 v17, v32, s53, 0
    s_pack_ll_b32_b16 s52, s57, s59
    v_dot2_f32_bf16 v6, v20, s52, 0
    v_dot2_f32_bf16 v10, v24, s52, 0
    v_dot2_f32_bf16 v14, v28, s52, 0
    v_dot2_f32_bf16 v18, v32, s52, 0
    s_pack_hh_b32_b16 s53, s57, s59
    v_dot2_f32_bf16 v7, v20, s53, 0
    v_dot2_f32_bf16 v11, v24, s53, 0
    v_dot2_f32_bf16 v15, v28, s53, 0
    v_dot2_f32_bf16 v19, v32, s53, 0
    s_pack_ll_b32_b16 s52, s60, s62
    v_dot2_f32_bf16 v4, v22, s52, v4
    v_dot2_f32_bf16 v8, v26, s52, v8
    v_dot2_f32_bf16 v12, v30, s52, v12
    v_dot2_f32_bf16 v16, v34, s52, v16
    s_pack_hh_b32_b16 s53, s60, s62
    v_dot2_f32_bf16 v5, v22, s53, v5
    v_dot2_f32_bf16 v9, v26, s53, v9
    v_dot2_f32_bf16 v13, v30, s53, v13
    v_dot2_f32_bf16 v17, v34, s53, v17
    s_pack_ll_b32_b16 s52, s61, s63
    v_dot2_f32_bf16 v6, v22, s52, v6
    v_dot2_f32_bf16 v10, v26, s52, v10
    v_dot2_f32_bf16 v14, v30, s52, v14
    v_dot2_f32_bf16 v18, v34, s52, v18
    s_pack_hh_b32_b16 s53, s61, s63
    v_dot2_f32_bf16 v7, v22, s53, v7
    v_dot2_f32_bf16 v11, v26, s53, v11
    v_dot2_f32_bf16 v15, v30, s53, v15
    v_dot2_f32_bf16 v19, v34, s53, v19
    v_lshlrev_b32 v36, 16, v86
    v_and_b32 v37, s32, v86
    v_lshlrev_b32 v52, 16, v110
    v_and_b32 v53, s32, v110
    v_lshlrev_b32 v38, 16, v87
    v_and_b32 v39, s32, v87
    v_lshlrev_b32 v54, 16, v111
    v_and_b32 v55, s32, v111
    v_lshlrev_b32 v40, 16, v88
    v_and_b32 v41, s32, v88
    v_lshlrev_b32 v56, 16, v112
    v_and_b32 v57, s32, v112
    v_lshlrev_b32 v42, 16, v89
    v_and_b32 v43, s32, v89
    v_lshlrev_b32 v58, 16, v113
    v_and_b32 v59, s32, v113
    v_lshlrev_b32 v44, 16, v90
    v_and_b32 v45, s32, v90
    v_lshlrev_b32 v60, 16, v114
    v_and_b32 v61, s32, v114
    v_lshlrev_b32 v46, 16, v91
    v_and_b32 v47, s32, v91
    v_lshlrev_b32 v62, 16, v115
    v_and_b32 v63, s32, v115
    v_lshlrev_b32 v48, 16, v92
    v_and_b32 v49, s32, v92
    v_lshlrev_b32 v64, 16, v116
    v_and_b32 v65, s32, v116
    v_lshlrev_b32 v50, 16, v93
    v_and_b32 v51, s32, v93
    v_lshlrev_b32 v66, 16, v117
    v_and_b32 v67, s32, v117
    v_cvt_pk_bf16_f32 v4, v4, v5
    v_cvt_pk_bf16_f32 v6, v6, v7
    v_cvt_pk_bf16_f32 v8, v8, v9
    v_cvt_pk_bf16_f32 v10, v10, v11
    v_cvt_pk_bf16_f32 v12, v12, v13
    v_cvt_pk_bf16_f32 v14, v14, v15
    v_cvt_pk_bf16_f32 v16, v16, v17
    v_cvt_pk_bf16_f32 v18, v18, v19
    v_and_b32 v5, s32, v4
    v_lshlrev_b32 v4, 16, v4
    v_and_b32 v7, s32, v6
    v_lshlrev_b32 v6, 16, v6
    v_and_b32 v9, s32, v8
    v_lshlrev_b32 v8, 16, v8
    v_and_b32 v11, s32, v10
    v_lshlrev_b32 v10, 16, v10
    v_and_b32 v13, s32, v12
    v_lshlrev_b32 v12, 16, v12
    v_and_b32 v15, s32, v14
    v_lshlrev_b32 v14, 16, v14
    v_and_b32 v17, s32, v16
    v_lshlrev_b32 v16, 16, v16
    v_and_b32 v19, s32, v18
    v_lshlrev_b32 v18, 16, v18
    v_mul_f32 v4, v4, v52
    v_mul_f32 v5, v5, v53
    v_mul_f32 v6, v6, v54
    v_mul_f32 v7, v7, v55
    v_mul_f32 v8, v8, v56
    v_mul_f32 v9, v9, v57
    v_mul_f32 v10, v10, v58
    v_mul_f32 v11, v11, v59
    v_mul_f32 v12, v12, v60
    v_mul_f32 v13, v13, v61
    v_mul_f32 v14, v14, v62
    v_mul_f32 v15, v15, v63
    v_mul_f32 v16, v16, v64
    v_mul_f32 v17, v17, v65
    v_mul_f32 v18, v18, v66
    v_mul_f32 v19, v19, v67
    v_cvt_pk_bf16_f32 v4, v4, v5
    v_cvt_pk_bf16_f32 v6, v6, v7
    v_cvt_pk_bf16_f32 v8, v8, v9
    v_cvt_pk_bf16_f32 v10, v10, v11
    v_cvt_pk_bf16_f32 v12, v12, v13
    v_cvt_pk_bf16_f32 v14, v14, v15
    v_cvt_pk_bf16_f32 v16, v16, v17
    v_cvt_pk_bf16_f32 v18, v18, v19
    v_and_b32 v5, s32, v4
    v_lshlrev_b32 v4, 16, v4
    v_and_b32 v7, s32, v6
    v_lshlrev_b32 v6, 16, v6
    v_and_b32 v9, s32, v8
    v_lshlrev_b32 v8, 16, v8
    v_and_b32 v11, s32, v10
    v_lshlrev_b32 v10, 16, v10
    v_and_b32 v13, s32, v12
    v_lshlrev_b32 v12, 16, v12
    v_and_b32 v15, s32, v14
    v_lshlrev_b32 v14, 16, v14
    v_and_b32 v17, s32, v16
    v_lshlrev_b32 v16, 16, v16
    v_and_b32 v19, s32, v18
    v_lshlrev_b32 v18, 16, v18
    v_add_f32 v4, v4, v36
    v_add_f32 v5, v5, v37
    v_add_f32 v6, v6, v38
    v_add_f32 v7, v7, v39
    v_add_f32 v8, v8, v40
    v_add_f32 v9, v9, v41
    v_add_f32 v10, v10, v42
    v_add_f32 v11, v11, v43
    v_add_f32 v12, v12, v44
    v_add_f32 v13, v13, v45
    v_add_f32 v14, v14, v46
    v_add_f32 v15, v15, v47
    v_add_f32 v16, v16, v48
    v_add_f32 v17, v17, v49
    v_add_f32 v18, v18, v50
    v_add_f32 v19, v19, v51
    v_cvt_pk_bf16_f32 v20, v4, v5
    v_cvt_pk_bf16_f32 v21, v6, v7
    v_cvt_pk_bf16_f32 v22, v8, v9
    v_cvt_pk_bf16_f32 v23, v10, v11
    v_cvt_pk_bf16_f32 v24, v12, v13
    v_cvt_pk_bf16_f32 v25, v14, v15
    v_cvt_pk_bf16_f32 v26, v16, v17
    v_cvt_pk_bf16_f32 v27, v18, v19
    buffer_store_dwordx4 v[20:23], v76, s[76:79], 0 offen
    buffer_store_dwordx4 v[24:27], v77, s[76:79], 0 offen
L_postend_117:
    s_mov_b64 exec, -1

    s_bfe_u32 s3, s35, 0x40008
    s_cbranch_scc0 L_fend_120
    s_ff1_i32_b32 s41, s3
    s_add_u32 s3, s41, 8
    s_bitset0_b32 s35, s3
    s_mov_b32 s49, -1

    s_mul_i32 s28, s41, 3125
    s_add_u32 s29, s28, 3126
    s_add_u32 s28, s28, 1
    s_lshr_b32 s28, s28, 1
    s_lshr_b32 s29, s29, 1
    s_sub_u32 s29, s29, s28
    s_sub_u32 s5, s29, 782
    s_mul_i32 s3, s36, 6250
    v_add_u32 v78, s28, v0
    v_mov_b32 v82, 0x2000000
    v_add_u32 v79, 782, v78
    v_cmp_gt_u32 vcc, 782, v0
    v_add_u32 v76, s3, v78
    v_add_u32 v77, s3, v79
    v_cndmask_b32 v76, v82, v76, vcc
    v_cmp_gt_u32 vcc, s5, v0
    v_lshlrev_b32 v78, 4, v78
    v_lshlrev_b32 v79, 4, v79
    v_cndmask_b32 v77, v82, v77, vcc
    v_lshlrev_b32 v80, 2, v76
    v_lshlrev_b32 v76, 4, v76
    v_lshlrev_b32 v81, 2, v77
    v_lshlrev_b32 v77, 4, v77
    buffer_load_dword v80, v80, s[68:71], 0 offen
    buffer_load_dword v81, v81, s[68:71], 0 offen
    buffer_load_dwordx4 v[86:89], v76, s[8:11], 0 offen
    buffer_load_dwordx4 v[90:93], v77, s[8:11], 0 offen

    s_waitcnt vmcnt(2)
    v_lshlrev_b32_sdwa v82, 5, v80 dst_sel:DWORD dst_unused:UNUSED_PAD src0_sel:DWORD src1_sel:WORD_0
    v_lshlrev_b32_sdwa v83, 5, v80 dst_sel:DWORD dst_unused:UNUSED_PAD src0_sel:DWORD src1_sel:WORD_1
    v_lshlrev_b32_sdwa v84, 5, v81 dst_sel:DWORD dst_unused:UNUSED_PAD src0_sel:DWORD src1_sel:WORD_0
    v_lshlrev_b32_sdwa v85, 5, v81 dst_sel:DWORD dst_unused:UNUSED_PAD src0_sel:DWORD src1_sel:WORD_1
    buffer_load_dwordx4 v[94:97], v82, s[72:75], 0 offen
    buffer_load_dwordx2 v[110:111], v82, s[72:75], 0 offen offset:16

    buffer_load_dwordx4 v[98:101], v83, s[72:75], 0 offen
    buffer_load_dwordx2 v[112:113], v83, s[72:75], 0 offen offset:16

    buffer_load_dwordx4 v[102:105], v84, s[72:75], 0 offen
    buffer_load_dwordx2 v[114:115], v84, s[72:75], 0 offen offset:16

    buffer_load_dwordx4 v[106:109], v85, s[72:75], 0 offen
    buffer_load_dwordx2 v[116:117], v85, s[72:75], 0 offen offset:16

    s_branch L_post_116
L_fin_111:

    s_load_dwordx2 s[68:69], s[0:1], 24
    s_load_dwordx4 s[88:91], s[0:1], 72
    s_load_dwordx2 s[76:77], s[0:1], 88
    s_load_dwordx2 s[80:81], s[0:1], 96
    s_mov_b32 s70, 1600000
    s_mov_b32 s71, 0x20000
    s_mov_b32 s78, 6400000
    s_mov_b32 s79, 0x20000
    s_movk_i32 s82, 256
    s_mov_b32 s83, 0x20000
    s_lshl_b32 s48, s36, 2
    s_mov_b32 s41, s37

    s_add_u32 s84, s6, 8896512
    s_addc_u32 s85, s7, 0
    s_mov_b32 s86, 76800000
    s_mov_b32 s87, 0x20000
    s_add_u32 s72, s6, 393216
    s_addc_u32 s73, s7, 0
    s_mov_b32 s74, 2097152
    s_mov_b32 s75, 0x20000
    s_mov_b32 s49, -1
    s_waitcnt lgkmcnt(0)
    s_load_dwordx8 s[12:19], s[88:89], 0
    s_load_dwordx8 s[56:63], s[90:91], 0

    s_mul_i32 s28, s41, 3125
    s_add_u32 s29, s28, 3126
    s_add_u32 s28, s28, 1
    s_lshr_b32 s28, s28, 1
    s_lshr_b32 s29, s29, 1
    s_sub_u32 s29, s29, s28
    s_sub_u32 s5, s29, 782
    s_mul_i32 s3, s36, 6250
    v_add_u32 v78, s28, v0
    v_mov_b32 v82, 0x2000000
    v_add_u32 v79, 782, v78
    v_cmp_gt_u32 vcc, 782, v0
    v_add_u32 v76, s3, v78
    v_add_u32 v77, s3, v79
    v_cndmask_b32 v76, v82, v76, vcc
    v_cmp_gt_u32 vcc, s5, v0
    v_lshlrev_b32 v78, 4, v78
    v_lshlrev_b32 v79, 4, v79
    v_cndmask_b32 v77, v82, v77, vcc
    v_lshlrev_b32 v80, 2, v76
    v_lshlrev_b32 v76, 4, v76
    v_lshlrev_b32 v81, 2, v77
    v_lshlrev_b32 v77, 4, v77
    buffer_load_dword v80, v80, s[68:71], 0 offen
    buffer_load_dword v81, v81, s[68:71], 0 offen
    buffer_load_dwordx4 v[86:89], v76, s[8:11], 0 offen
    buffer_load_dwordx4 v[90:93], v77, s[8:11], 0 offen

    s_waitcnt vmcnt(2)
    v_lshlrev_b32_sdwa v82, 5, v80 dst_sel:DWORD dst_unused:UNUSED_PAD src0_sel:DWORD src1_sel:WORD_0
    v_lshlrev_b32_sdwa v83, 5, v80 dst_sel:DWORD dst_unused:UNUSED_PAD src0_sel:DWORD src1_sel:WORD_1
    v_lshlrev_b32_sdwa v84, 5, v81 dst_sel:DWORD dst_unused:UNUSED_PAD src0_sel:DWORD src1_sel:WORD_0
    v_lshlrev_b32_sdwa v85, 5, v81 dst_sel:DWORD dst_unused:UNUSED_PAD src0_sel:DWORD src1_sel:WORD_1
    buffer_load_dwordx4 v[94:97], v82, s[72:75], 0 offen
    buffer_load_dwordx2 v[110:111], v82, s[72:75], 0 offen offset:16

    buffer_load_dwordx4 v[98:101], v83, s[72:75], 0 offen
    buffer_load_dwordx2 v[112:113], v83, s[72:75], 0 offen offset:16

    buffer_load_dwordx4 v[102:105], v84, s[72:75], 0 offen
    buffer_load_dwordx2 v[114:115], v84, s[72:75], 0 offen offset:16

    buffer_load_dwordx4 v[106:109], v85, s[72:75], 0 offen
    buffer_load_dwordx2 v[116:117], v85, s[72:75], 0 offen offset:16

    s_waitcnt vmcnt(0) lgkmcnt(0)
    s_barrier
    s_branch L_meet_112
L_fend_120:

L_p2done_52:
    s_endpgm

L_ufix_62:
    v_and_b32 v117, 63, v0
    v_lshlrev_b32 v117, 2, v117
    s_sub_i32 s54, s42, 1024
    v_cmp_le_i32 vcc, s54, v117
    s_mov_b64 exec, vcc
    v_mov_b32 v12, 0
    v_mov_b32 v44, 0
    s_mov_b64 exec, -1
    s_sub_i32 s54, s42, 1025
    v_cmp_le_i32 vcc, s54, v117
    s_mov_b64 exec, vcc
    v_mov_b32 v13, 0
    v_mov_b32 v46, 0
    s_mov_b64 exec, -1
    s_sub_i32 s54, s42, 1026
    v_cmp_le_i32 vcc, s54, v117
    s_mov_b64 exec, vcc
    v_mov_b32 v14, 0
    v_mov_b32 v48, 0
    s_mov_b64 exec, -1
    s_sub_i32 s54, s42, 1027
    v_cmp_le_i32 vcc, s54, v117
    s_mov_b64 exec, vcc
    v_mov_b32 v15, 0
    v_mov_b32 v50, 0
    s_mov_b64 exec, -1
    s_branch L_uback_63
L_ufix_64:
    v_and_b32 v117, 63, v0
    v_lshlrev_b32 v117, 2, v117
    s_sub_i32 s54, s42, 1536
    v_cmp_le_i32 vcc, s54, v117
    s_mov_b64 exec, vcc
    v_mov_b32 v16, 0
    v_mov_b32 v52, 0
    s_mov_b64 exec, -1
    s_sub_i32 s54, s42, 1537
    v_cmp_le_i32 vcc, s54, v117
    s_mov_b64 exec, vcc
    v_mov_b32 v17, 0
    v_mov_b32 v54, 0
    s_mov_b64 exec, -1
    s_sub_i32 s54, s42, 1538
    v_cmp_le_i32 vcc, s54, v117
    s_mov_b64 exec, vcc
    v_mov_b32 v18, 0
    v_mov_b32 v56, 0
    s_mov_b64 exec, -1
    s_sub_i32 s54, s42, 1539
    v_cmp_le_i32 vcc, s54, v117
    s_mov_b64 exec, vcc
    v_mov_b32 v19, 0
    v_mov_b32 v58, 0
    s_mov_b64 exec, -1
    s_branch L_uback_65
L_ufix_66:
    v_and_b32 v117, 63, v0
    v_lshlrev_b32 v117, 2, v117
    s_sub_i32 s54, s42, 2048
    v_cmp_le_i32 vcc, s54, v117
    s_mov_b64 exec, vcc
    v_mov_b32 v20, 0
    v_mov_b32 v60, 0
    s_mov_b64 exec, -1
    s_sub_i32 s54, s42, 2049
    v_cmp_le_i32 vcc, s54, v117
    s_mov_b64 exec, vcc
    v_mov_b32 v21, 0
    v_mov_b32 v62, 0
    s_mov_b64 exec, -1
    s_sub_i32 s54, s42, 2050
    v_cmp_le_i32 vcc, s54, v117
    s_mov_b64 exec, vcc
    v_mov_b32 v22, 0
    v_mov_b32 v64, 0
    s_mov_b64 exec, -1
    s_sub_i32 s54, s42, 2051
    v_cmp_le_i32 vcc, s54, v117
    s_mov_b64 exec, vcc
    v_mov_b32 v23, 0
    v_mov_b32 v66, 0
    s_mov_b64 exec, -1
    s_branch L_uback_67
L_ufix_68:
    v_and_b32 v117, 63, v0
    v_lshlrev_b32 v117, 2, v117
    s_sub_i32 s54, s42, 2560
    v_cmp_le_i32 vcc, s54, v117
    s_mov_b64 exec, vcc
    v_mov_b32 v24, 0
    v_mov_b32 v68, 0
    s_mov_b64 exec, -1
    s_sub_i32 s54, s42, 2561
    v_cmp_le_i32 vcc, s54, v117
    s_mov_b64 exec, vcc
    v_mov_b32 v25, 0
    v_mov_b32 v70, 0
    s_mov_b64 exec, -1
    s_sub_i32 s54, s42, 2562
    v_cmp_le_i32 vcc, s54, v117
    s_mov_b64 exec, vcc
    v_mov_b32 v26, 0
    v_mov_b32 v72, 0
    s_mov_b64 exec, -1
    s_sub_i32 s54, s42, 2563
    v_cmp_le_i32 vcc, s54, v117
    s_mov_b64 exec, vcc
    v_mov_b32 v27, 0
    v_mov_b32 v74, 0
    s_mov_b64 exec, -1
    s_branch L_uback_69
L_ufix_70:
    v_and_b32 v117, 63, v0
    v_lshlrev_b32 v117, 2, v117
    s_sub_i32 s54, s42, 0
    v_cmp_le_i32 vcc, s54, v117
    s_mov_b64 exec, vcc
    v_mov_b32 v4, 0
    v_mov_b32 v28, 0
    s_mov_b64 exec, -1
    s_sub_i32 s54, s42, 1
    v_cmp_le_i32 vcc, s54, v117
    s_mov_b64 exec, vcc
    v_mov_b32 v5, 0
    v_mov_b32 v30, 0
    s_mov_b64 exec, -1
    s_sub_i32 s54, s42, 2
    v_cmp_le_i32 vcc, s54, v117
    s_mov_b64 exec, vcc
    v_mov_b32 v6, 0
    v_mov_b32 v32, 0
    s_mov_b64 exec, -1
    s_sub_i32 s54, s42, 3
    v_cmp_le_i32 vcc, s54, v117
    s_mov_b64 exec, vcc
    v_mov_b32 v7, 0
    v_mov_b32 v34, 0
    s_mov_b64 exec, -1
    s_branch L_uback_71
L_ufix_74:
    v_and_b32 v117, 63, v0
    v_lshlrev_b32 v117, 2, v117
    s_sub_i32 s54, s42, 512
    v_cmp_le_i32 vcc, s54, v117
    s_mov_b64 exec, vcc
    v_mov_b32 v8, 0
    v_mov_b32 v36, 0
    s_mov_b64 exec, -1
    s_sub_i32 s54, s42, 513
    v_cmp_le_i32 vcc, s54, v117
    s_mov_b64 exec, vcc
    v_mov_b32 v9, 0
    v_mov_b32 v38, 0
    s_mov_b64 exec, -1
    s_sub_i32 s54, s42, 514
    v_cmp_le_i32 vcc, s54, v117
    s_mov_b64 exec, vcc
    v_mov_b32 v10, 0
    v_mov_b32 v40, 0
    s_mov_b64 exec, -1
    s_sub_i32 s54, s42, 515
    v_cmp_le_i32 vcc, s54, v117
    s_mov_b64 exec, vcc
    v_mov_b32 v11, 0
    v_mov_b32 v42, 0
    s_mov_b64 exec, -1
    s_branch L_uback_75
L_ufix_84:
    v_and_b32 v117, 63, v0
    v_lshlrev_b32 v117, 2, v117
    s_sub_i32 s54, s42, 3072
    v_cmp_le_i32 vcc, s54, v117
    s_mov_b64 exec, vcc
    v_mov_b32 v106, 0
    v_mov_b32 v120, 0
    s_mov_b64 exec, -1
    s_sub_i32 s54, s42, 3073
    v_cmp_le_i32 vcc, s54, v117
    s_mov_b64 exec, vcc
    v_mov_b32 v107, 0
    v_mov_b32 v122, 0
    s_mov_b64 exec, -1
    s_sub_i32 s54, s42, 3074
    v_cmp_le_i32 vcc, s54, v117
    s_mov_b64 exec, vcc
    v_mov_b32 v108, 0
    v_mov_b32 v124, 0
    s_mov_b64 exec, -1
    s_sub_i32 s54, s42, 3075
    v_cmp_le_i32 vcc, s54, v117
    s_mov_b64 exec, vcc
    v_mov_b32 v109, 0
    v_mov_b32 v126, 0
    s_mov_b64 exec, -1
    s_branch L_uback_85
L_ufix_95:
    v_and_b32 v117, 63, v0
    v_lshlrev_b32 v117, 2, v117
    s_sub_i32 s54, s42, 1024
    v_cmp_le_i32 vcc, s54, v117
    s_mov_b64 exec, vcc
    v_mov_b32 v12, 0
    v_mov_b32 v44, 0
    s_mov_b64 exec, -1
    s_sub_i32 s54, s42, 1025
    v_cmp_le_i32 vcc, s54, v117
    s_mov_b64 exec, vcc
    v_mov_b32 v13, 0
    v_mov_b32 v46, 0
    s_mov_b64 exec, -1
    s_sub_i32 s54, s42, 1026
    v_cmp_le_i32 vcc, s54, v117
    s_mov_b64 exec, vcc
    v_mov_b32 v14, 0
    v_mov_b32 v48, 0
    s_mov_b64 exec, -1
    s_sub_i32 s54, s42, 1027
    v_cmp_le_i32 vcc, s54, v117
    s_mov_b64 exec, vcc
    v_mov_b32 v15, 0
    v_mov_b32 v50, 0
    s_mov_b64 exec, -1
    s_branch L_uback_96
L_ufix_98:
    v_and_b32 v117, 63, v0
    v_lshlrev_b32 v117, 2, v117
    s_sub_i32 s54, s42, 1536
    v_cmp_le_i32 vcc, s54, v117
    s_mov_b64 exec, vcc
    v_mov_b32 v16, 0
    v_mov_b32 v52, 0
    s_mov_b64 exec, -1
    s_sub_i32 s54, s42, 1537
    v_cmp_le_i32 vcc, s54, v117
    s_mov_b64 exec, vcc
    v_mov_b32 v17, 0
    v_mov_b32 v54, 0
    s_mov_b64 exec, -1
    s_sub_i32 s54, s42, 1538
    v_cmp_le_i32 vcc, s54, v117
    s_mov_b64 exec, vcc
    v_mov_b32 v18, 0
    v_mov_b32 v56, 0
    s_mov_b64 exec, -1
    s_sub_i32 s54, s42, 1539
    v_cmp_le_i32 vcc, s54, v117
    s_mov_b64 exec, vcc
    v_mov_b32 v19, 0
    v_mov_b32 v58, 0
    s_mov_b64 exec, -1
    s_branch L_uback_99
L_ufix_100:
    v_and_b32 v117, 63, v0
    v_lshlrev_b32 v117, 2, v117
    s_sub_i32 s54, s42, 2048
    v_cmp_le_i32 vcc, s54, v117
    s_mov_b64 exec, vcc
    v_mov_b32 v20, 0
    v_mov_b32 v60, 0
    s_mov_b64 exec, -1
    s_sub_i32 s54, s42, 2049
    v_cmp_le_i32 vcc, s54, v117
    s_mov_b64 exec, vcc
    v_mov_b32 v21, 0
    v_mov_b32 v62, 0
    s_mov_b64 exec, -1
    s_sub_i32 s54, s42, 2050
    v_cmp_le_i32 vcc, s54, v117
    s_mov_b64 exec, vcc
    v_mov_b32 v22, 0
    v_mov_b32 v64, 0
    s_mov_b64 exec, -1
    s_sub_i32 s54, s42, 2051
    v_cmp_le_i32 vcc, s54, v117
    s_mov_b64 exec, vcc
    v_mov_b32 v23, 0
    v_mov_b32 v66, 0
    s_mov_b64 exec, -1
    s_branch L_uback_101
L_ufix_102:
    v_and_b32 v117, 63, v0
    v_lshlrev_b32 v117, 2, v117
    s_sub_i32 s54, s42, 2560
    v_cmp_le_i32 vcc, s54, v117
    s_mov_b64 exec, vcc
    v_mov_b32 v24, 0
    v_mov_b32 v68, 0
    s_mov_b64 exec, -1
    s_sub_i32 s54, s42, 2561
    v_cmp_le_i32 vcc, s54, v117
    s_mov_b64 exec, vcc
    v_mov_b32 v25, 0
    v_mov_b32 v70, 0
    s_mov_b64 exec, -1
    s_sub_i32 s54, s42, 2562
    v_cmp_le_i32 vcc, s54, v117
    s_mov_b64 exec, vcc
    v_mov_b32 v26, 0
    v_mov_b32 v72, 0
    s_mov_b64 exec, -1
    s_sub_i32 s54, s42, 2563
    v_cmp_le_i32 vcc, s54, v117
    s_mov_b64 exec, vcc
    v_mov_b32 v27, 0
    v_mov_b32 v74, 0
    s_mov_b64 exec, -1
    s_branch L_uback_103
L_ufix_106:
    v_and_b32 v117, 63, v0
    v_lshlrev_b32 v117, 2, v117
    s_sub_i32 s54, s42, 0
    v_cmp_le_i32 vcc, s54, v117
    s_mov_b64 exec, vcc
    v_mov_b32 v4, 0
    v_mov_b32 v28, 0
    s_mov_b64 exec, -1
    s_sub_i32 s54, s42, 1
    v_cmp_le_i32 vcc, s54, v117
    s_mov_b64 exec, vcc
    v_mov_b32 v5, 0
    v_mov_b32 v30, 0
    s_mov_b64 exec, -1
    s_sub_i32 s54, s42, 2
    v_cmp_le_i32 vcc, s54, v117
    s_mov_b64 exec, vcc
    v_mov_b32 v6, 0
    v_mov_b32 v32, 0
    s_mov_b64 exec, -1
    s_sub_i32 s54, s42, 3
    v_cmp_le_i32 vcc, s54, v117
    s_mov_b64 exec, vcc
    v_mov_b32 v7, 0
    v_mov_b32 v34, 0
    s_mov_b64 exec, -1
    s_branch L_uback_107
L_ufix_108:
    v_and_b32 v117, 63, v0
    v_lshlrev_b32 v117, 2, v117
    s_sub_i32 s54, s42, 512
    v_cmp_le_i32 vcc, s54, v117
    s_mov_b64 exec, vcc
    v_mov_b32 v8, 0
    v_mov_b32 v36, 0
    s_mov_b64 exec, -1
    s_sub_i32 s54, s42, 513
    v_cmp_le_i32 vcc, s54, v117
    s_mov_b64 exec, vcc
    v_mov_b32 v9, 0
    v_mov_b32 v38, 0
    s_mov_b64 exec, -1
    s_sub_i32 s54, s42, 514
    v_cmp_le_i32 vcc, s54, v117
    s_mov_b64 exec, vcc
    v_mov_b32 v10, 0
    v_mov_b32 v40, 0
    s_mov_b64 exec, -1
    s_sub_i32 s54, s42, 515
    v_cmp_le_i32 vcc, s54, v117
    s_mov_b64 exec, vcc
    v_mov_b32 v11, 0
    v_mov_b32 v42, 0
    s_mov_b64 exec, -1
    s_branch L_uback_109
L_sync_119:
    v_and_b32 v40, 63, v0
    v_lshlrev_b32 v41, 20, v40
    v_mov_b32 v42, s33
    buffer_atomic_add v42, v41, s[80:83], s48 offen sc0
    s_waitcnt vmcnt(0)
    v_readfirstlane_b32 s4, v42
    s_movk_i32 s5, 400
    s_nop 0
    s_add_u32 s4, s4, s33
    s_bitcmp1_b32 s4, 2
    s_cbranch_scc1 L_tell_123
L_poll_121:
    s_sub_u32 s5, s5, 1
    s_cbranch_scc1 L_gave_122
    v_mov_b32 v42, 0
    buffer_atomic_add v42, v41, s[80:83], s48 offen sc0
    s_waitcnt vmcnt(0)
    v_readfirstlane_b32 s4, v42
    s_nop 1
    s_and_b32 s4, s4, 0xff
    s_bitcmp0_b32 s4, 2
    s_cbranch_scc1 L_poll_121
    s_branch L_tell_123
L_gave_122:
    s_cmp_lg_u32 s49, s37
    s_cbranch_scc1 L_gno_125
    v_add_lshl_u32 v40, v40, s28, 4
    s_mov_b32 s5, 0
L_gl_124:
    v_min_u32 v43, 100000, v40
    ds_read_b128 v[44:47], v43 offset:50000
    s_waitcnt lgkmcnt(0)
    buffer_store_dwordx4 v[44:47], v40, s[20:23], 0 offen sc1
    s_waitcnt vmcnt(0)
    v_add_u32 v40, 1024, v40
    s_add_u32 s5, s5, 64
    s_cmp_lt_u32 s5, s29
    s_cbranch_scc1 L_gl_124
L_gno_125:
    s_lshl_b32 s4, 0x100, s37
    v_mov_b32 v42, s4
    buffer_atomic_or v42, v41, s[80:83], s48 offen sc0
    s_waitcnt vmcnt(0)
    v_readfirstlane_b32 s4, v42
    s_nop 1
    s_and_b32 s4, s4, 0xff
    s_bitcmp1_b32 s4, 2
    s_cselect_b32 s4, s4, 0x10000
L_tell_123:
    v_mov_b32 v42, s4
    ds_write_b32 v118, v42
    s_waitcnt lgkmcnt(0)
    s_branch L_bcast_114

L_own_126:
    ds_read_b128 v[36:39], v78 offset:50000
    ds_read_b128 v[52:55], v79 offset:50000
    s_branch L_obk_127

L_own_128:
    ds_read_b128 v[40:43], v78 offset:50000
    ds_read_b128 v[56:59], v79 offset:50000
    s_branch L_obk_129

L_own_130:
    ds_read_b128 v[44:47], v78 offset:50000
    ds_read_b128 v[60:63], v79 offset:50000
    s_branch L_obk_131

L_own_132:
    ds_read_b128 v[48:51], v78 offset:50000
    ds_read_b128 v[64:67], v79 offset:50000
    s_branch L_obk_133

L_fgen_134:
    v_lshlrev_b32 v82, 1, v76
    v_lshlrev_b32 v83, 1, v77
    v_mov_b32 v4, 0
    v_mov_b32 v5, 0
    v_mov_b32 v6, 0
    v_mov_b32 v7, 0
    v_mov_b32 v8, 0
    v_mov_b32 v9, 0
    v_mov_b32 v10, 0
    v_mov_b32 v11, 0
    v_mov_b32 v12, 0
    v_mov_b32 v13, 0
    v_mov_b32 v14, 0
    v_mov_b32 v15, 0
    v_mov_b32 v16, 0
    v_mov_b32 v17, 0
    v_mov_b32 v18, 0
    v_mov_b32 v19, 0
    s_bitcmp1_b32 s35, 4
    s_cbranch_scc1 L_ffl_136
    v_cvt_f32_u32_sdwa v20, v36 dst_sel:DWORD dst_unused:UNUSED_PAD src0_sel:WORD_0
    v_cvt_f32_u32_sdwa v21, v36 dst_sel:DWORD dst_unused:UNUSED_PAD src0_sel:WORD_1
    v_cvt_f32_u32_sdwa v22, v37 dst_sel:DWORD dst_unused:UNUSED_PAD src0_sel:WORD_0
    v_cvt_f32_u32_sdwa v23, v37 dst_sel:DWORD dst_unused:UNUSED_PAD src0_sel:WORD_1
    v_cvt_f32_u32_sdwa v24, v38 dst_sel:DWORD dst_unused:UNUSED_PAD src0_sel:WORD_0
    v_cvt_f32_u32_sdwa v25, v38 dst_sel:DWORD dst_unused:UNUSED_PAD src0_sel:WORD_1
    v_cvt_f32_u32_sdwa v26, v39 dst_sel:DWORD dst_unused:UNUSED_PAD src0_sel:WORD_0
    v_cvt_f32_u32_sdwa v27, v39 dst_sel:DWORD dst_unused:UNUSED_PAD src0_sel:WORD_1
    v_cvt_f32_u32_sdwa v28, v52 dst_sel:DWORD dst_unused:UNUSED_PAD src0_sel:WORD_0
    v_cvt_f32_u32_sdwa v29, v52 dst_sel:DWORD dst_unused:UNUSED_PAD src0_sel:WORD_1
    v_cvt_f32_u32_sdwa v30, v53 dst_sel:DWORD dst_unused:UNUSED_PAD src0_sel:WORD_0
    v_cvt_f32_u32_sdwa v31, v53 dst_sel:DWORD dst_unused:UNUSED_PAD src0_sel:WORD_1
    v_cvt_f32_u32_sdwa v32, v54 dst_sel:DWORD dst_unused:UNUSED_PAD src0_sel:WORD_0
    v_cvt_f32_u32_sdwa v33, v54 dst_sel:DWORD dst_unused:UNUSED_PAD src0_sel:WORD_1
    v_cvt_f32_u32_sdwa v34, v55 dst_sel:DWORD dst_unused:UNUSED_PAD src0_sel:WORD_0
    v_cvt_f32_u32_sdwa v35, v55 dst_sel:DWORD dst_unused:UNUSED_PAD src0_sel:WORD_1
    v_add_f32 v20, 0xc6800000, v20
    v_fmac_f32 v4, s34, v20
    v_add_f32 v21, 0xc6800000, v21
    v_fmac_f32 v5, s34, v21
    v_add_f32 v22, 0xc6800000, v22
    v_fmac_f32 v6, s34, v22
    v_add_f32 v23, 0xc6800000, v23
    v_fmac_f32 v7, s34, v23
    v_add_f32 v24, 0xc6800000, v24
    v_fmac_f32 v8, s34, v24
    v_add_f32 v25, 0xc6800000, v25
    v_fmac_f32 v9, s34, v25
    v_add_f32 v26, 0xc6800000, v26
    v_fmac_f32 v10, s34, v26
    v_add_f32 v27, 0xc6800000, v27
    v_fmac_f32 v11, s34, v27
    v_add_f32 v28, 0xc6800000, v28
    v_fmac_f32 v12, s34, v28
    v_add_f32 v29, 0xc6800000, v29
    v_fmac_f32 v13, s34, v29
    v_add_f32 v30, 0xc6800000, v30
    v_fmac_f32 v14, s34, v30
    v_add_f32 v31, 0xc6800000, v31
    v_fmac_f32 v15, s34, v31
    v_add_f32 v32, 0xc6800000, v32
    v_fmac_f32 v16, s34, v32
    v_add_f32 v33, 0xc6800000, v33
    v_fmac_f32 v17, s34, v33
    v_add_f32 v34, 0xc6800000, v34
    v_fmac_f32 v18, s34, v34
    v_add_f32 v35, 0xc6800000, v35
    v_fmac_f32 v19, s34, v35
    s_branch L_fnx_137
L_ffl_136:
    s_mov_b32 s3, 25600000
    buffer_load_dwordx4 v[20:23], v82, s[84:87], s3 offen offset:0 sc1
    buffer_load_dwordx4 v[24:27], v82, s[84:87], s3 offen offset:16 sc1
    buffer_load_dwordx4 v[28:31], v83, s[84:87], s3 offen offset:0 sc1
    buffer_load_dwordx4 v[32:35], v83, s[84:87], s3 offen offset:16 sc1
    s_waitcnt vmcnt(0)
    v_add_f32 v4, v4, v20
    v_add_f32 v5, v5, v21
    v_add_f32 v6, v6, v22
    v_add_f32 v7, v7, v23
    v_add_f32 v8, v8, v24
    v_add_f32 v9, v9, v25
    v_add_f32 v10, v10, v26
    v_add_f32 v11, v11, v27
    v_add_f32 v12, v12, v28
    v_add_f32 v13, v13, v29
    v_add_f32 v14, v14, v30
    v_add_f32 v15, v15, v31
    v_add_f32 v16, v16, v32
    v_add_f32 v17, v17, v33
    v_add_f32 v18, v18, v34
    v_add_f32 v19, v19, v35
L_fnx_137:
    s_bitcmp1_b32 s35, 5
    s_cbranch_scc1 L_ffl_138
    v_cvt_f32_u32_sdwa v20, v40 dst_sel:DWORD dst_unused:UNUSED_PAD src0_sel:WORD_0
    v_cvt_f32_u32_sdwa v21, v40 dst_sel:DWORD dst_unused:UNUSED_PAD src0_sel:WORD_1
    v_cvt_f32_u32_sdwa v22, v41 dst_sel:DWORD dst_unused:UNUSED_PAD src0_sel:WORD_0
    v_cvt_f32_u32_sdwa v23, v41 dst_sel:DWORD dst_unused:UNUSED_PAD src0_sel:WORD_1
    v_cvt_f32_u32_sdwa v24, v42 dst_sel:DWORD dst_unused:UNUSED_PAD src0_sel:WORD_0
    v_cvt_f32_u32_sdwa v25, v42 dst_sel:DWORD dst_unused:UNUSED_PAD src0_sel:WORD_1
    v_cvt_f32_u32_sdwa v26, v43 dst_sel:DWORD dst_unused:UNUSED_PAD src0_sel:WORD_0
    v_cvt_f32_u32_sdwa v27, v43 dst_sel:DWORD dst_unused:UNUSED_PAD src0_sel:WORD_1
    v_cvt_f32_u32_sdwa v28, v56 dst_sel:DWORD dst_unused:UNUSED_PAD src0_sel:WORD_0
    v_cvt_f32_u32_sdwa v29, v56 dst_sel:DWORD dst_unused:UNUSED_PAD src0_sel:WORD_1
    v_cvt_f32_u32_sdwa v30, v57 dst_sel:DWORD dst_unused:UNUSED_PAD src0_sel:WORD_0
    v_cvt_f32_u32_sdwa v31, v57 dst_sel:DWORD dst_unused:UNUSED_PAD src0_sel:WORD_1
    v_cvt_f32_u32_sdwa v32, v58 dst_sel:DWORD dst_unused:UNUSED_PAD src0_sel:WORD_0
    v_cvt_f32_u32_sdwa v33, v58 dst_sel:DWORD dst_unused:UNUSED_PAD src0_sel:WORD_1
    v_cvt_f32_u32_sdwa v34, v59 dst_sel:DWORD dst_unused:UNUSED_PAD src0_sel:WORD_0
    v_cvt_f32_u32_sdwa v35, v59 dst_sel:DWORD dst_unused:UNUSED_PAD src0_sel:WORD_1
    v_add_f32 v20, 0xc6800000, v20
    v_fmac_f32 v4, s34, v20
    v_add_f32 v21, 0xc6800000, v21
    v_fmac_f32 v5, s34, v21
    v_add_f32 v22, 0xc6800000, v22
    v_fmac_f32 v6, s34, v22
    v_add_f32 v23, 0xc6800000, v23
    v_fmac_f32 v7, s34, v23
    v_add_f32 v24, 0xc6800000, v24
    v_fmac_f32 v8, s34, v24
    v_add_f32 v25, 0xc6800000, v25
    v_fmac_f32 v9, s34, v25
    v_add_f32 v26, 0xc6800000, v26
    v_fmac_f32 v10, s34, v26
    v_add_f32 v27, 0xc6800000, v27
    v_fmac_f32 v11, s34, v27
    v_add_f32 v28, 0xc6800000, v28
    v_fmac_f32 v12, s34, v28
    v_add_f32 v29, 0xc6800000, v29
    v_fmac_f32 v13, s34, v29
    v_add_f32 v30, 0xc6800000, v30
    v_fmac_f32 v14, s34, v30
    v_add_f32 v31, 0xc6800000, v31
    v_fmac_f32 v15, s34, v31
    v_add_f32 v32, 0xc6800000, v32
    v_fmac_f32 v16, s34, v32
    v_add_f32 v33, 0xc6800000, v33
    v_fmac_f32 v17, s34, v33
    v_add_f32 v34, 0xc6800000, v34
    v_fmac_f32 v18, s34, v34
    v_add_f32 v35, 0xc6800000, v35
    v_fmac_f32 v19, s34, v35
    s_branch L_fnx_139
L_ffl_138:
    s_mov_b32 s3, 38400000
    buffer_load_dwordx4 v[20:23], v82, s[84:87], s3 offen offset:0 sc1
    buffer_load_dwordx4 v[24:27], v82, s[84:87], s3 offen offset:16 sc1
    buffer_load_dwordx4 v[28:31], v83, s[84:87], s3 offen offset:0 sc1
    buffer_load_dwordx4 v[32:35], v83, s[84:87], s3 offen offset:16 sc1
    s_waitcnt vmcnt(0)
    v_add_f32 v4, v4, v20
    v_add_f32 v5, v5, v21
    v_add_f32 v6, v6, v22
    v_add_f32 v7, v7, v23
    v_add_f32 v8, v8, v24
    v_add_f32 v9, v9, v25
    v_add_f32 v10, v10, v26
    v_add_f32 v11, v11, v27
    v_add_f32 v12, v12, v28
    v_add_f32 v13, v13, v29
    v_add_f32 v14, v14, v30
    v_add_f32 v15, v15, v31
    v_add_f32 v16, v16, v32
    v_add_f32 v17, v17, v33
    v_add_f32 v18, v18, v34
    v_add_f32 v19, v19, v35
L_fnx_139:
    s_bitcmp1_b32 s35, 6
    s_cbranch_scc1 L_ffl_140
    v_cvt_f32_u32_sdwa v20, v44 dst_sel:DWORD dst_unused:UNUSED_PAD src0_sel:WORD_0
    v_cvt_f32_u32_sdwa v21, v44 dst_sel:DWORD dst_unused:UNUSED_PAD src0_sel:WORD_1
    v_cvt_f32_u32_sdwa v22, v45 dst_sel:DWORD dst_unused:UNUSED_PAD src0_sel:WORD_0
    v_cvt_f32_u32_sdwa v23, v45 dst_sel:DWORD dst_unused:UNUSED_PAD src0_sel:WORD_1
    v_cvt_f32_u32_sdwa v24, v46 dst_sel:DWORD dst_unused:UNUSED_PAD src0_sel:WORD_0
    v_cvt_f32_u32_sdwa v25, v46 dst_sel:DWORD dst_unused:UNUSED_PAD src0_sel:WORD_1
    v_cvt_f32_u32_sdwa v26, v47 dst_sel:DWORD dst_unused:UNUSED_PAD src0_sel:WORD_0
    v_cvt_f32_u32_sdwa v27, v47 dst_sel:DWORD dst_unused:UNUSED_PAD src0_sel:WORD_1
    v_cvt_f32_u32_sdwa v28, v60 dst_sel:DWORD dst_unused:UNUSED_PAD src0_sel:WORD_0
    v_cvt_f32_u32_sdwa v29, v60 dst_sel:DWORD dst_unused:UNUSED_PAD src0_sel:WORD_1
    v_cvt_f32_u32_sdwa v30, v61 dst_sel:DWORD dst_unused:UNUSED_PAD src0_sel:WORD_0
    v_cvt_f32_u32_sdwa v31, v61 dst_sel:DWORD dst_unused:UNUSED_PAD src0_sel:WORD_1
    v_cvt_f32_u32_sdwa v32, v62 dst_sel:DWORD dst_unused:UNUSED_PAD src0_sel:WORD_0
    v_cvt_f32_u32_sdwa v33, v62 dst_sel:DWORD dst_unused:UNUSED_PAD src0_sel:WORD_1
    v_cvt_f32_u32_sdwa v34, v63 dst_sel:DWORD dst_unused:UNUSED_PAD src0_sel:WORD_0
    v_cvt_f32_u32_sdwa v35, v63 dst_sel:DWORD dst_unused:UNUSED_PAD src0_sel:WORD_1
    v_add_f32 v20, 0xc6800000, v20
    v_fmac_f32 v4, s34, v20
    v_add_f32 v21, 0xc6800000, v21
    v_fmac_f32 v5, s34, v21
    v_add_f32 v22, 0xc6800000, v22
    v_fmac_f32 v6, s34, v22
    v_add_f32 v23, 0xc6800000, v23
    v_fmac_f32 v7, s34, v23
    v_add_f32 v24, 0xc6800000, v24
    v_fmac_f32 v8, s34, v24
    v_add_f32 v25, 0xc6800000, v25
    v_fmac_f32 v9, s34, v25
    v_add_f32 v26, 0xc6800000, v26
    v_fmac_f32 v10, s34, v26
    v_add_f32 v27, 0xc6800000, v27
    v_fmac_f32 v11, s34, v27
    v_add_f32 v28, 0xc6800000, v28
    v_fmac_f32 v12, s34, v28
    v_add_f32 v29, 0xc6800000, v29
    v_fmac_f32 v13, s34, v29
    v_add_f32 v30, 0xc6800000, v30
    v_fmac_f32 v14, s34, v30
    v_add_f32 v31, 0xc6800000, v31
    v_fmac_f32 v15, s34, v31
    v_add_f32 v32, 0xc6800000, v32
    v_fmac_f32 v16, s34, v32
    v_add_f32 v33, 0xc6800000, v33
    v_fmac_f32 v17, s34, v33
    v_add_f32 v34, 0xc6800000, v34
    v_fmac_f32 v18, s34, v34
    v_add_f32 v35, 0xc6800000, v35
    v_fmac_f32 v19, s34, v35
    s_branch L_fnx_141
L_ffl_140:
    s_mov_b32 s3, 51200000
    buffer_load_dwordx4 v[20:23], v82, s[84:87], s3 offen offset:0 sc1
    buffer_load_dwordx4 v[24:27], v82, s[84:87], s3 offen offset:16 sc1
    buffer_load_dwordx4 v[28:31], v83, s[84:87], s3 offen offset:0 sc1
    buffer_load_dwordx4 v[32:35], v83, s[84:87], s3 offen offset:16 sc1
    s_waitcnt vmcnt(0)
    v_add_f32 v4, v4, v20
    v_add_f32 v5, v5, v21
    v_add_f32 v6, v6, v22
    v_add_f32 v7, v7, v23
    v_add_f32 v8, v8, v24
    v_add_f32 v9, v9, v25
    v_add_f32 v10, v10, v26
    v_add_f32 v11, v11, v27
    v_add_f32 v12, v12, v28
    v_add_f32 v13, v13, v29
    v_add_f32 v14, v14, v30
    v_add_f32 v15, v15, v31
    v_add_f32 v16, v16, v32
    v_add_f32 v17, v17, v33
    v_add_f32 v18, v18, v34
    v_add_f32 v19, v19, v35
L_fnx_141:
    s_bitcmp1_b32 s35, 7
    s_cbranch_scc1 L_ffl_142
    v_cvt_f32_u32_sdwa v20, v48 dst_sel:DWORD dst_unused:UNUSED_PAD src0_sel:WORD_0
    v_cvt_f32_u32_sdwa v21, v48 dst_sel:DWORD dst_unused:UNUSED_PAD src0_sel:WORD_1
    v_cvt_f32_u32_sdwa v22, v49 dst_sel:DWORD dst_unused:UNUSED_PAD src0_sel:WORD_0
    v_cvt_f32_u32_sdwa v23, v49 dst_sel:DWORD dst_unused:UNUSED_PAD src0_sel:WORD_1
    v_cvt_f32_u32_sdwa v24, v50 dst_sel:DWORD dst_unused:UNUSED_PAD src0_sel:WORD_0
    v_cvt_f32_u32_sdwa v25, v50 dst_sel:DWORD dst_unused:UNUSED_PAD src0_sel:WORD_1
    v_cvt_f32_u32_sdwa v26, v51 dst_sel:DWORD dst_unused:UNUSED_PAD src0_sel:WORD_0
    v_cvt_f32_u32_sdwa v27, v51 dst_sel:DWORD dst_unused:UNUSED_PAD src0_sel:WORD_1
    v_cvt_f32_u32_sdwa v28, v64 dst_sel:DWORD dst_unused:UNUSED_PAD src0_sel:WORD_0
    v_cvt_f32_u32_sdwa v29, v64 dst_sel:DWORD dst_unused:UNUSED_PAD src0_sel:WORD_1
    v_cvt_f32_u32_sdwa v30, v65 dst_sel:DWORD dst_unused:UNUSED_PAD src0_sel:WORD_0
    v_cvt_f32_u32_sdwa v31, v65 dst_sel:DWORD dst_unused:UNUSED_PAD src0_sel:WORD_1
    v_cvt_f32_u32_sdwa v32, v66 dst_sel:DWORD dst_unused:UNUSED_PAD src0_sel:WORD_0
    v_cvt_f32_u32_sdwa v33, v66 dst_sel:DWORD dst_unused:UNUSED_PAD src0_sel:WORD_1
    v_cvt_f32_u32_sdwa v34, v67 dst_sel:DWORD dst_unused:UNUSED_PAD src0_sel:WORD_0
    v_cvt_f32_u32_sdwa v35, v67 dst_sel:DWORD dst_unused:UNUSED_PAD src0_sel:WORD_1
    v_add_f32 v20, 0xc6800000, v20
    v_fmac_f32 v4, s34, v20
    v_add_f32 v21, 0xc6800000, v21
    v_fmac_f32 v5, s34, v21
    v_add_f32 v22, 0xc6800000, v22
    v_fmac_f32 v6, s34, v22
    v_add_f32 v23, 0xc6800000, v23
    v_fmac_f32 v7, s34, v23
    v_add_f32 v24, 0xc6800000, v24
    v_fmac_f32 v8, s34, v24
    v_add_f32 v25, 0xc6800000, v25
    v_fmac_f32 v9, s34, v25
    v_add_f32 v26, 0xc6800000, v26
    v_fmac_f32 v10, s34, v26
    v_add_f32 v27, 0xc6800000, v27
    v_fmac_f32 v11, s34, v27
    v_add_f32 v28, 0xc6800000, v28
    v_fmac_f32 v12, s34, v28
    v_add_f32 v29, 0xc6800000, v29
    v_fmac_f32 v13, s34, v29
    v_add_f32 v30, 0xc6800000, v30
    v_fmac_f32 v14, s34, v30
    v_add_f32 v31, 0xc6800000, v31
    v_fmac_f32 v15, s34, v31
    v_add_f32 v32, 0xc6800000, v32
    v_fmac_f32 v16, s34, v32
    v_add_f32 v33, 0xc6800000, v33
    v_fmac_f32 v17, s34, v33
    v_add_f32 v34, 0xc6800000, v34
    v_fmac_f32 v18, s34, v34
    v_add_f32 v35, 0xc6800000, v35
    v_fmac_f32 v19, s34, v35
    s_branch L_fnx_143
L_ffl_142:
    s_mov_b32 s3, 64000000
    buffer_load_dwordx4 v[20:23], v82, s[84:87], s3 offen offset:0 sc1
    buffer_load_dwordx4 v[24:27], v82, s[84:87], s3 offen offset:16 sc1
    buffer_load_dwordx4 v[28:31], v83, s[84:87], s3 offen offset:0 sc1
    buffer_load_dwordx4 v[32:35], v83, s[84:87], s3 offen offset:16 sc1
    s_waitcnt vmcnt(0)
    v_add_f32 v4, v4, v20
    v_add_f32 v5, v5, v21
    v_add_f32 v6, v6, v22
    v_add_f32 v7, v7, v23
    v_add_f32 v8, v8, v24
    v_add_f32 v9, v9, v25
    v_add_f32 v10, v10, v26
    v_add_f32 v11, v11, v27
    v_add_f32 v12, v12, v28
    v_add_f32 v13, v13, v29
    v_add_f32 v14, v14, v30
    v_add_f32 v15, v15, v31
    v_add_f32 v16, v16, v32
    v_add_f32 v17, v17, v33
    v_add_f32 v18, v18, v34
    v_add_f32 v19, v19, v35
L_fnx_143:
    s_branch L_fbk_135
L_p2slow_53:
    s_waitcnt vmcnt(0) lgkmcnt(0)
    s_mov_b32 s51, 0
    s_movk_i32 s43, 6250
L_sweep_144:
    s_barrier

    v_mov_b32 v28, 0x0
    v_mov_b32 v29, 0x0
    v_mov_b32 v30, 0x0
    v_mov_b32 v31, 0x0
    v_add_u32 v32, 50000, v3
    v_add_u32 v33, 65536, v32

    ds_write_b128 v32, v[28:31] offset:0
    ds_write_b128 v32, v[28:31] offset:16384
    ds_write_b128 v32, v[28:31] offset:32768
    ds_write_b128 v32, v[28:31] offset:49152
    ds_write_b128 v33, v[28:31] offset:0
    ds_write_b128 v33, v[28:31] offset:16384
    v_cmp_gt_u32 vcc, 971, v0
    s_mov_b64 exec, vcc
    ds_write_b128 v33, v[28:31] offset:32768
    s_mov_b64 exec, -1
    s_mov_b32 s3, 32768
    s_load_dword s40, s[6:7], s3
    s_waitcnt lgkmcnt(0)
    s_barrier
    s_cmp_lg_u32 s40, 0
    s_cbranch_scc1 L_raw_149
    s_sub_u32 s38, s4, 8
L_sbatch_145:
    s_lshl_b32 s52, s36, 5
    s_add_u32 s52, s52, s38
    s_lshr_b32 s52, s52, 1
    s_lshl_b32 s52, s52, 2
    s_load_dword s40, s[46:47], s52
    s_mul_i32 s50, s38, 200000
    s_and_b32 s3, s38, 1
    s_lshl_b32 s3, s3, 4
    s_or_b32 s3, s3, 0x100000
    s_waitcnt lgkmcnt(0)
    s_bfe_u32 s40, s40, s3

    s_min_u32 s40, s40, 6524
    s_lshl_b32 s52, s38, 6
    s_add_u32 s52, s52, s36
    s_mul_i32 s52, s52, 32764
    s_and_b32 s52, s52, 0xffffff80
    s_add_u32 s20, s44, s52
    s_addc_u32 s21, s45, 0
    s_mul_i32 s52, s40, 5
    s_add_u32 s52, s52, 3
    s_and_b32 s22, s52, -4

    s_lshr_b32 s55, s39, 2
    s_add_u32 s55, s55, 0
    v_and_b32 v36, 63, v0
    v_add_u32 v36, s55, v36
L_left_150:
    s_cmp_ge_u32 s55, s40
    s_cbranch_scc1 L_leftend_151
    v_mul_u32_u24 v37, 5, v36
    buffer_load_dword v38, v37, s[20:23], 0 offen offset:1
    buffer_load_ubyte v39, v37, s[20:23], 0 offen
    s_waitcnt vmcnt(0)

    v_perm_b32 v37, v39, v38, s24
    v_lshrrev_b32 v42, 30, v38
    v_and_b32 v37, 0x1fff, v37
    v_mul_u32_u24 v42, 6250, v42
    v_add_lshl_u32 v37, v37, v42, 3

    buffer_load_dwordx2 v[40:41], v37, s[8:11], s50 offen
    v_cmp_gt_u32 vcc, s40, v36
    s_waitcnt vmcnt(0)

    v_bfe_u32 v44, v38, 16, 14
    v_subrev_u32 v44, s51, v44
    v_cmp_gt_u32 s[64:65], s43, v44
    s_and_b64 exec, vcc, s[64:65]
    v_lshlrev_b32 v45, 16, v38
    v_cmpx_ne_u32 vcc, 0, v45
    v_lshlrev_b32 v44, 4, v44
    v_bfe_i32 v38, v38, 0, 16
    v_cvt_f32_i32 v38, v38
    v_mul_f32 v38, 0x38004020, v38
    v_lshlrev_b32 v45, 16, v40
    v_and_b32 v46, s32, v40
    v_lshlrev_b32 v47, 16, v41
    v_and_b32 v48, s32, v41

    v_mul_f32 v45, v45, v38
    ds_add_f32 v44, v45 offset:50000
    v_mul_f32 v46, v46, v38
    ds_add_f32 v44, v46 offset:50004
    v_mul_f32 v47, v47, v38
    ds_add_f32 v44, v47 offset:50008
    v_mul_f32 v48, v48, v38
    ds_add_f32 v44, v48 offset:50012
    s_mov_b64 exec, -1
    v_add_u32 v36, 128, v36
    s_add_u32 s55, s55, 128
    s_branch L_left_150
L_leftend_151:

    s_add_u32 s38, s38, 1
    s_cmp_lt_u32 s38, s4
    s_cbranch_scc1 L_sbatch_145
    s_branch L_swend_147

L_raw_149:
    s_load_dwordx2 s[68:69], s[0:1], 8
    s_load_dwordx2 s[72:73], s[0:1], 16
    s_load_dwordx2 s[76:77], s[0:1], 32
    s_load_dwordx2 s[80:81], s[0:1], 48
    s_mov_b32 s70, 204800000
    s_mov_b32 s71, 0x20000
    s_mov_b32 s74, 204800000
    s_mov_b32 s75, 0x20000
    s_mov_b32 s78, 102400000
    s_mov_b32 s79, 0x20000
    s_waitcnt lgkmcnt(0)
    s_load_dword s82, s[80:81], 0
    s_mul_i32 s83, s36, 12500
    s_add_u32 s83, s83, s51
    s_mul_i32 s84, s37, 200000
    s_mov_b32 s85, 200000
    s_mov_b32 s38, 0
    v_lshlrev_b32 v44, 5, v0
    v_mov_b32 v45, 0.15915494
    s_waitcnt lgkmcnt(0)
    s_lshl_b32 s82, s82, 16
    v_mul_f32 v45, s82, v45
L_rawl_146:
    s_lshr_b32 s3, s38, 1
    buffer_load_dwordx4 v[46:49], v44, s[72:75], s38 offen
    buffer_load_dwordx4 v[50:53], v44, s[72:75], s38 offen offset:16
    buffer_load_dwordx4 v[54:57], v44, s[68:71], s38 offen
    buffer_load_dwordx4 v[58:61], v44, s[68:71], s38 offen offset:16
    buffer_load_dwordx4 v[62:65], v3, s[76:79], s3 offen
    s_waitcnt vmcnt(1)

    v_subrev_u32 v46, s83, v46
    v_subrev_u32 v82, s84, v54
    v_cmp_gt_u32 vcc, s43, v46
    v_cmp_gt_u32 s[64:65], s85, v82
    v_lshlrev_b32 v54, 3, v54
    s_nand_b64 exec, vcc, s[64:65]
    v_bfrev_b32 v54, 1
    s_mov_b64 exec, -1
    buffer_load_dwordx2 v[66:67], v54, s[8:11], 0 offen

    v_subrev_u32 v47, s83, v47
    v_subrev_u32 v82, s84, v55
    v_cmp_gt_u32 vcc, s43, v47
    v_cmp_gt_u32 s[64:65], s85, v82
    v_lshlrev_b32 v55, 3, v55
    s_nand_b64 exec, vcc, s[64:65]
    v_bfrev_b32 v55, 1
    s_mov_b64 exec, -1
    buffer_load_dwordx2 v[68:69], v55, s[8:11], 0 offen

    v_subrev_u32 v48, s83, v48
    v_subrev_u32 v82, s84, v56
    v_cmp_gt_u32 vcc, s43, v48
    v_cmp_gt_u32 s[64:65], s85, v82
    v_lshlrev_b32 v56, 3, v56
    s_nand_b64 exec, vcc, s[64:65]
    v_bfrev_b32 v56, 1
    s_mov_b64 exec, -1
    buffer_load_dwordx2 v[70:71], v56, s[8:11], 0 offen

    v_subrev_u32 v49, s83, v49
    v_subrev_u32 v82, s84, v57
    v_cmp_gt_u32 vcc, s43, v49
    v_cmp_gt_u32 s[64:65], s85, v82
    v_lshlrev_b32 v57, 3, v57
    s_nand_b64 exec, vcc, s[64:65]
    v_bfrev_b32 v57, 1
    s_mov_b64 exec, -1
    buffer_load_dwordx2 v[72:73], v57, s[8:11], 0 offen

    v_subrev_u32 v50, s83, v50
    v_subrev_u32 v82, s84, v58
    v_cmp_gt_u32 vcc, s43, v50
    v_cmp_gt_u32 s[64:65], s85, v82
    v_lshlrev_b32 v58, 3, v58
    s_nand_b64 exec, vcc, s[64:65]
    v_bfrev_b32 v58, 1
    s_mov_b64 exec, -1
    buffer_load_dwordx2 v[74:75], v58, s[8:11], 0 offen

    v_subrev_u32 v51, s83, v51
    v_subrev_u32 v82, s84, v59
    v_cmp_gt_u32 vcc, s43, v51
    v_cmp_gt_u32 s[64:65], s85, v82
    v_lshlrev_b32 v59, 3, v59
    s_nand_b64 exec, vcc, s[64:65]
    v_bfrev_b32 v59, 1
    s_mov_b64 exec, -1
    buffer_load_dwordx2 v[76:77], v59, s[8:11], 0 offen

    v_subrev_u32 v52, s83, v52
    v_subrev_u32 v82, s84, v60
    v_cmp_gt_u32 vcc, s43, v52
    v_cmp_gt_u32 s[64:65], s85, v82
    v_lshlrev_b32 v60, 3, v60
    s_nand_b64 exec, vcc, s[64:65]
    v_bfrev_b32 v60, 1
    s_mov_b64 exec, -1
    buffer_load_dwordx2 v[78:79], v60, s[8:11], 0 offen

    v_subrev_u32 v53, s83, v53
    v_subrev_u32 v82, s84, v61
    v_cmp_gt_u32 vcc, s43, v53
    v_cmp_gt_u32 s[64:65], s85, v82
    v_lshlrev_b32 v61, 3, v61
    s_nand_b64 exec, vcc, s[64:65]
    v_bfrev_b32 v61, 1
    s_mov_b64 exec, -1
    buffer_load_dwordx2 v[80:81], v61, s[8:11], 0 offen

    s_waitcnt vmcnt(0)
    v_cmp_le_i32 vcc, 0, v54
    s_mov_b64 exec, vcc
    s_cbranch_execz L_rsk_152
    v_lshlrev_b32 v82, 16, v62
    v_mul_f32 v82, v82, v45
    v_fract_f32 v82, v82
    v_cos_f32 v82, v82
    v_lshlrev_b32 v46, 4, v46
    v_lshlrev_b32 v83, 16, v66
    v_and_b32 v84, s32, v66
    v_lshlrev_b32 v85, 16, v67
    v_and_b32 v86, s32, v67

    v_mul_f32 v83, v83, v82
    ds_add_f32 v46, v83 offset:50000
    v_mul_f32 v84, v84, v82
    ds_add_f32 v46, v84 offset:50004
    v_mul_f32 v85, v85, v82
    ds_add_f32 v46, v85 offset:50008
    v_mul_f32 v86, v86, v82
    ds_add_f32 v46, v86 offset:50012
L_rsk_152:
    s_mov_b64 exec, -1
    v_cmp_le_i32 vcc, 0, v55
    s_mov_b64 exec, vcc
    s_cbranch_execz L_rsk_153
    v_and_b32 v82, s32, v62
    v_mul_f32 v82, v82, v45
    v_fract_f32 v82, v82
    v_cos_f32 v82, v82
    v_lshlrev_b32 v47, 4, v47
    v_lshlrev_b32 v83, 16, v68
    v_and_b32 v84, s32, v68
    v_lshlrev_b32 v85, 16, v69
    v_and_b32 v86, s32, v69

    v_mul_f32 v83, v83, v82
    ds_add_f32 v47, v83 offset:50000
    v_mul_f32 v84, v84, v82
    ds_add_f32 v47, v84 offset:50004
    v_mul_f32 v85, v85, v82
    ds_add_f32 v47, v85 offset:50008
    v_mul_f32 v86, v86, v82
    ds_add_f32 v47, v86 offset:50012
L_rsk_153:
    s_mov_b64 exec, -1
    v_cmp_le_i32 vcc, 0, v56
    s_mov_b64 exec, vcc
    s_cbranch_execz L_rsk_154
    v_lshlrev_b32 v82, 16, v63
    v_mul_f32 v82, v82, v45
    v_fract_f32 v82, v82
    v_cos_f32 v82, v82
    v_lshlrev_b32 v48, 4, v48
    v_lshlrev_b32 v83, 16, v70
    v_and_b32 v84, s32, v70
    v_lshlrev_b32 v85, 16, v71
    v_and_b32 v86, s32, v71

    v_mul_f32 v83, v83, v82
    ds_add_f32 v48, v83 offset:50000
    v_mul_f32 v84, v84, v82
    ds_add_f32 v48, v84 offset:50004
    v_mul_f32 v85, v85, v82
    ds_add_f32 v48, v85 offset:50008
    v_mul_f32 v86, v86, v82
    ds_add_f32 v48, v86 offset:50012
L_rsk_154:
    s_mov_b64 exec, -1
    v_cmp_le_i32 vcc, 0, v57
    s_mov_b64 exec, vcc
    s_cbranch_execz L_rsk_155
    v_and_b32 v82, s32, v63
    v_mul_f32 v82, v82, v45
    v_fract_f32 v82, v82
    v_cos_f32 v82, v82
    v_lshlrev_b32 v49, 4, v49
    v_lshlrev_b32 v83, 16, v72
    v_and_b32 v84, s32, v72
    v_lshlrev_b32 v85, 16, v73
    v_and_b32 v86, s32, v73

    v_mul_f32 v83, v83, v82
    ds_add_f32 v49, v83 offset:50000
    v_mul_f32 v84, v84, v82
    ds_add_f32 v49, v84 offset:50004
    v_mul_f32 v85, v85, v82
    ds_add_f32 v49, v85 offset:50008
    v_mul_f32 v86, v86, v82
    ds_add_f32 v49, v86 offset:50012
L_rsk_155:
    s_mov_b64 exec, -1
    v_cmp_le_i32 vcc, 0, v58
    s_mov_b64 exec, vcc
    s_cbranch_execz L_rsk_156
    v_lshlrev_b32 v82, 16, v64
    v_mul_f32 v82, v82, v45
    v_fract_f32 v82, v82
    v_cos_f32 v82, v82
    v_lshlrev_b32 v50, 4, v50
    v_lshlrev_b32 v83, 16, v74
    v_and_b32 v84, s32, v74
    v_lshlrev_b32 v85, 16, v75
    v_and_b32 v86, s32, v75

    v_mul_f32 v83, v83, v82
    ds_add_f32 v50, v83 offset:50000
    v_mul_f32 v84, v84, v82
    ds_add_f32 v50, v84 offset:50004
    v_mul_f32 v85, v85, v82
    ds_add_f32 v50, v85 offset:50008
    v_mul_f32 v86, v86, v82
    ds_add_f32 v50, v86 offset:50012
L_rsk_156:
    s_mov_b64 exec, -1
    v_cmp_le_i32 vcc, 0, v59
    s_mov_b64 exec, vcc
    s_cbranch_execz L_rsk_157
    v_and_b32 v82, s32, v64
    v_mul_f32 v82, v82, v45
    v_fract_f32 v82, v82
    v_cos_f32 v82, v82
    v_lshlrev_b32 v51, 4, v51
    v_lshlrev_b32 v83, 16, v76
    v_and_b32 v84, s32, v76
    v_lshlrev_b32 v85, 16, v77
    v_and_b32 v86, s32, v77

    v_mul_f32 v83, v83, v82
    ds_add_f32 v51, v83 offset:50000
    v_mul_f32 v84, v84, v82
    ds_add_f32 v51, v84 offset:50004
    v_mul_f32 v85, v85, v82
    ds_add_f32 v51, v85 offset:50008
    v_mul_f32 v86, v86, v82
    ds_add_f32 v51, v86 offset:50012
L_rsk_157:
    s_mov_b64 exec, -1
    v_cmp_le_i32 vcc, 0, v60
    s_mov_b64 exec, vcc
    s_cbranch_execz L_rsk_158
    v_lshlrev_b32 v82, 16, v65
    v_mul_f32 v82, v82, v45
    v_fract_f32 v82, v82
    v_cos_f32 v82, v82
    v_lshlrev_b32 v52, 4, v52
    v_lshlrev_b32 v83, 16, v78
    v_and_b32 v84, s32, v78
    v_lshlrev_b32 v85, 16, v79
    v_and_b32 v86, s32, v79

    v_mul_f32 v83, v83, v82
    ds_add_f32 v52, v83 offset:50000
    v_mul_f32 v84, v84, v82
    ds_add_f32 v52, v84 offset:50004
    v_mul_f32 v85, v85, v82
    ds_add_f32 v52, v85 offset:50008
    v_mul_f32 v86, v86, v82
    ds_add_f32 v52, v86 offset:50012
L_rsk_158:
    s_mov_b64 exec, -1
    v_cmp_le_i32 vcc, 0, v61
    s_mov_b64 exec, vcc
    s_cbranch_execz L_rsk_159
    v_and_b32 v82, s32, v65
    v_mul_f32 v82, v82, v45
    v_fract_f32 v82, v82
    v_cos_f32 v82, v82
    v_lshlrev_b32 v53, 4, v53
    v_lshlrev_b32 v83, 16, v80
    v_and_b32 v84, s32, v80
    v_lshlrev_b32 v85, 16, v81
    v_and_b32 v86, s32, v81

    v_mul_f32 v83, v83, v82
    ds_add_f32 v53, v83 offset:50000
    v_mul_f32 v84, v84, v82
    ds_add_f32 v53, v84 offset:50004
    v_mul_f32 v85, v85, v82
    ds_add_f32 v53, v85 offset:50008
    v_mul_f32 v86, v86, v82
    ds_add_f32 v53, v86 offset:50012
L_rsk_159:
    s_mov_b64 exec, -1
    s_add_u32 s38, s38, 32768
    s_cmp_lt_u32 s38, 204800000
    s_cbranch_scc1 L_rawl_146
L_swend_147:
    s_waitcnt lgkmcnt(0)
    s_barrier
    s_mul_i32 s3, s37, 800000
    s_mul_i32 s5, s36, 12500
    s_add_u32 s3, s3, s5
    s_add_u32 s3, s3, s51
    s_lshl_b32 s3, s3, 4
    s_add_u32 s3, s3, 34496512

    s_add_u32 s20, s6, s3
    s_addc_u32 s21, s7, 0
    s_mov_b32 s22, 100000
    s_mov_b32 s23, 0x20000
    v_mov_b32 v36, v3
    s_mov_b32 s38, 0
L_wl_148:
    v_min_u32 v37, 100000, v36
    ds_read_b128 v[28:31], v37 offset:50000
    s_waitcnt lgkmcnt(0)
    buffer_store_dwordx4 v[28:31], v36, s[20:23], 0 offen sc1
    s_waitcnt vmcnt(0)
    v_add_u32 v36, 16384, v36
    s_add_u32 s38, s38, 1024
    s_cmp_lt_u32 s38, 6250
    s_cbranch_scc1 L_wl_148
    s_add_u32 s51, s51, 6250
    s_cmp_lt_u32 s51, 12500
    s_cbranch_scc1 L_sweep_144
    s_lshl_b32 s33, 16, s37
    s_add_u32 s33, s33, 1
    s_branch L_fin_111

.section .rodata,"a"
.p2align 6
.amdhsa_kernel g1_kernel
  .amdhsa_next_free_vgpr 128
  .amdhsa_next_free_sgpr 102
  .amdhsa_accum_offset 128
  .amdhsa_group_segment_fixed_size 0
  .amdhsa_kernarg_size 112
  .amdhsa_user_sgpr_count 2
  .amdhsa_user_sgpr_kernarg_segment_ptr 1
  .amdhsa_system_sgpr_workgroup_id_x 1
  .amdhsa_float_denorm_mode_32 3
.end_amdhsa_kernel
.p2align 6
.amdhsa_kernel standalone__molecular_angular_gemnet__graph_kernel
  .amdhsa_next_free_vgpr 128
  .amdhsa_next_free_sgpr 102
  .amdhsa_accum_offset 128
  .amdhsa_group_segment_fixed_size 0
  .amdhsa_kernarg_size 112
  .amdhsa_user_sgpr_count 2
  .amdhsa_user_sgpr_kernarg_segment_ptr 1
  .amdhsa_system_sgpr_workgroup_id_x 1
  .amdhsa_float_denorm_mode_32 3
.end_amdhsa_kernel
```

```asm
; @launch kernel=g1_kernel grid=(256,1,1) block=(1024,1,1) lds=163840
; @launch kernel=standalone__molecular_angular_gemnet__graph_kernel grid=(256,1,1) block=(1024,1,1) lds=163840
.amdgcn_target "amdgcn-amd-amdhsa--gfx950"
.text
.globl g1_kernel
.p2align 8
.type g1_kernel,@function
g1_kernel:
    s_cmp_ge_u32 s2, 256
    s_cbranch_scc1 L_p1done_1
    s_load_dwordx4 s[80:83], s[0:1], 8
    s_load_dwordx2 s[84:85], s[0:1], 32
    s_load_dwordx2 s[86:87], s[0:1], 48
    s_load_dwordx4 s[4:7], s[0:1], 96
    s_load_dwordx2 s[78:79], s[0:1], 0
    v_lshlrev_b32 v1, 4, v0
    v_lshlrev_b32 v2, 3, v0
    v_lshlrev_b32 v98, 20, v0
    v_mov_b32 v108, 24576
    v_mov_b32 v110, 0
    v_mov_b32 v111, 0
    ds_write_b64 v2, v[110:111]
    s_mov_b64 exec, 1
    ds_write_b32 v108, v110
    s_mov_b64 exec, -1
    s_waitcnt lgkmcnt(0)
    s_load_dword s88, s[86:87], 0

    s_mov_b32 s96, s4
    s_mov_b32 s97, s5
    s_mov_b32 s98, 256
    s_mov_b32 s99, 0x20000
    v_readfirstlane_b32 s74, v0
    s_nop 1
    s_or_b32 s74, s74, s2
    s_cbranch_scc1 L_noinit_2

    v_mov_b32 v110, 1
    buffer_atomic_add v110, v98, s[96:99], 0 offen offset:64 sc0
    s_waitcnt vmcnt(0)
    v_readfirstlane_b32 s74, v110
    s_nop 1
    s_cmp_lg_u32 s74, 0
    s_cbranch_scc1 L_zno_4

    s_mov_b32 s92, s6
    s_mov_b32 s93, s7
    s_mov_b32 s94, 32784
    s_mov_b32 s95, 0x20000
    v_mov_b32 v110, 0
    v_mov_b32 v111, 0
    v_mov_b32 v112, 0
    v_mov_b32 v113, 0
L_zl_3:
    buffer_store_dwordx4 v[110:113], v1, s[92:95], s74 offen sc0 sc1
    s_add_u32 s74, s74, 1024
    s_cmp_le_u32 s74, 32768
    s_cbranch_scc1 L_zl_3
    v_mov_b32 v114, 1
    s_waitcnt vmcnt(0)
    buffer_atomic_add v114, v98, s[96:99], 0 offen offset:128
L_zno_4:

L_noinit_2:
    s_barrier
    s_mov_b32 s20, s78
    s_mov_b32 s21, s79
    s_mov_b32 s22, 6400000
    s_mov_b32 s23, 0x20000
    v_lshrrev_b32 v110, 3, v0
    v_and_b32 v111, 7, v0
    v_mul_u32_u24 v110, 49920, v110
    v_lshl_add_u32 v110, v111, 4, v110
    v_and_b32 v111, 63, v0
    v_and_b32 v112, 0x3c0, v0
    v_lshlrev_b32 v111, 2, v111
    v_lshl_or_b32 v111, v112, 4, v111
    v_lshlrev_b32 v100, 2, v0
    s_lshr_b32 s50, s2, 1
    s_and_b32 s53, s2, 1
    s_mul_i32 s3, s50, 50000
    s_mul_i32 s54, s53, 24576
    s_add_u32 s3, s3, s54

    buffer_load_dwordx4 v[56:59], v110, s[20:23], 0 offen
    s_add_u32 s20, s78, s3
    s_addc_u32 s21, s79, 0
    s_mov_b32 s22, 24576
    s_mov_b32 s23, 0x20000
    s_movk_i32 s3, 16384
    buffer_load_dword v116, v111, s[20:23], 0 offen offset:0
    buffer_load_dword v117, v111, s[20:23], 0 offen offset:256
    buffer_load_dword v118, v111, s[20:23], 0 offen offset:512
    buffer_load_dword v119, v111, s[20:23], 0 offen offset:768
    buffer_load_dword v120, v111, s[20:23], s3 offen offset:0
    buffer_load_dword v121, v111, s[20:23], s3 offen offset:256
    buffer_load_dword v122, v111, s[20:23], s3 offen offset:512
    buffer_load_dword v123, v111, s[20:23], s3 offen offset:768
    s_mul_i32 s22, s53, 25424
    s_movk_i32 s3, 24576

    buffer_load_dword v124, v100, s[20:23], s3 offen
    s_mul_i32 s3, s50, 50048
    s_add_u32 s3, s3, s54
    s_add_u32 s54, s3, 2490368

    v_readfirstlane_b32 s74, v0
    s_mov_b32 s55, 0x05040100
    s_nop 0
    s_cmp_lt_u32 s74, 768
    s_cbranch_scc1 L_nogate_5
    s_load_dwordx2 s[92:93], s[0:1], 40
    s_load_dwordx4 s[32:35], s[0:1], 56
    v_mov_b32 v110, 0
    s_waitcnt lgkmcnt(0)
    global_load_dwordx4 v[60:63], v110, s[92:93]

    global_load_dwordx4 v[64:67], v110, s[32:33] offset:0
    global_load_dwordx4 v[80:83], v110, s[34:35] offset:0
    global_load_dwordx4 v[68:71], v110, s[32:33] offset:16
    global_load_dwordx4 v[84:87], v110, s[34:35] offset:16
    global_load_dwordx4 v[72:75], v110, s[32:33] offset:32
    global_load_dwordx4 v[88:91], v110, s[34:35] offset:32
    global_load_dwordx4 v[76:79], v110, s[32:33] offset:48
    global_load_dwordx4 v[92:95], v110, s[34:35] offset:48
    s_lshl_b32 s74, s2, 8
    v_and_b32 v111, 255, v0
    v_add_u32 v111, s74, v111
    v_lshlrev_b32 v112, 16, v111
    v_lshlrev_b32 v111, 5, v111
    s_mov_b32 s75, 0x07060302
    s_waitcnt vmcnt(0)

    v_lshlrev_b32 v44, 16, v60
    v_and_b32 v45, 0xffff0000, v60
    v_lshlrev_b32 v46, 16, v61
    v_and_b32 v47, 0xffff0000, v61
    v_lshlrev_b32 v48, 16, v62
    v_and_b32 v49, 0xffff0000, v62
    v_lshlrev_b32 v50, 16, v63
    v_and_b32 v51, 0xffff0000, v63
    v_sub_f32 v44, v112, v44
    v_sub_f32 v45, v112, v45
    v_sub_f32 v46, v112, v46
    v_sub_f32 v47, v112, v47
    v_sub_f32 v48, v112, v48
    v_sub_f32 v49, v112, v49
    v_sub_f32 v50, v112, v50
    v_sub_f32 v51, v112, v51
    v_cvt_pk_bf16_f32 v44, v44, v45
    v_cvt_pk_bf16_f32 v46, v46, v47
    v_cvt_pk_bf16_f32 v48, v48, v49
    v_cvt_pk_bf16_f32 v50, v50, v51
    v_and_b32 v45, 0xffff0000, v44
    v_lshlrev_b32 v44, 16, v44
    v_and_b32 v47, 0xffff0000, v46
    v_lshlrev_b32 v46, 16, v46
    v_and_b32 v49, 0xffff0000, v48
    v_lshlrev_b32 v48, 16, v48
    v_and_b32 v51, 0xffff0000, v50
    v_lshlrev_b32 v50, 16, v50
    v_mul_f32 v44, v44, v44
    v_mul_f32 v45, v45, v45
    v_mul_f32 v46, v46, v46
    v_mul_f32 v47, v47, v47
    v_mul_f32 v48, v48, v48
    v_mul_f32 v49, v49, v49
    v_mul_f32 v50, v50, v50
    v_mul_f32 v51, v51, v51
    v_cvt_pk_bf16_f32 v44, v44, v45
    v_cvt_pk_bf16_f32 v46, v46, v47
    v_cvt_pk_bf16_f32 v48, v48, v49
    v_cvt_pk_bf16_f32 v50, v50, v51
    v_and_b32 v45, 0xffff0000, v44
    v_lshlrev_b32 v44, 16, v44
    v_and_b32 v47, 0xffff0000, v46
    v_lshlrev_b32 v46, 16, v46
    v_and_b32 v49, 0xffff0000, v48
    v_lshlrev_b32 v48, 16, v48
    v_and_b32 v51, 0xffff0000, v50
    v_lshlrev_b32 v50, 16, v50
    v_mul_f32 v44, 0xc1200000, v44
    v_mul_f32 v45, 0xc1200000, v45
    v_mul_f32 v46, 0xc1200000, v46
    v_mul_f32 v47, 0xc1200000, v47
    v_mul_f32 v48, 0xc1200000, v48
    v_mul_f32 v49, 0xc1200000, v49
    v_mul_f32 v50, 0xc1200000, v50
    v_mul_f32 v51, 0xc1200000, v51
    v_cvt_pk_bf16_f32 v44, v44, v45
    v_cvt_pk_bf16_f32 v46, v46, v47
    v_cvt_pk_bf16_f32 v48, v48, v49
    v_cvt_pk_bf16_f32 v50, v50, v51
    v_and_b32 v45, 0xffff0000, v44
    v_lshlrev_b32 v44, 16, v44
    v_and_b32 v47, 0xffff0000, v46
    v_lshlrev_b32 v46, 16, v46
    v_and_b32 v49, 0xffff0000, v48
    v_lshlrev_b32 v48, 16, v48
    v_and_b32 v51, 0xffff0000, v50
    v_lshlrev_b32 v50, 16, v50
    v_mul_f32 v44, 0x3fb8aa3b, v44
    v_mul_f32 v45, 0x3fb8aa3b, v45
    v_mul_f32 v46, 0x3fb8aa3b, v46
    v_mul_f32 v47, 0x3fb8aa3b, v47
    v_mul_f32 v48, 0x3fb8aa3b, v48
    v_mul_f32 v49, 0x3fb8aa3b, v49
    v_mul_f32 v50, 0x3fb8aa3b, v50
    v_mul_f32 v51, 0x3fb8aa3b, v51
    v_exp_f32 v44, v44
    v_exp_f32 v45, v45
    v_exp_f32 v46, v46
    v_exp_f32 v47, v47
    v_exp_f32 v48, v48
    v_exp_f32 v49, v49
    v_exp_f32 v50, v50
    v_exp_f32 v51, v51
    s_nop 0
    v_cvt_pk_bf16_f32 v44, v44, v45
    v_cvt_pk_bf16_f32 v46, v46, v47
    v_cvt_pk_bf16_f32 v48, v48, v49
    v_cvt_pk_bf16_f32 v50, v50, v51
    v_perm_b32 v113, v66, v64, s55
    v_dot2_f32_bf16 v52, v44, v113, 0

    v_perm_b32 v113, v66, v64, s75
    v_dot2_f32_bf16 v53, v44, v113, 0

    v_perm_b32 v113, v67, v65, s55
    v_dot2_f32_bf16 v54, v44, v113, 0

    v_perm_b32 v113, v67, v65, s75
    v_dot2_f32_bf16 v55, v44, v113, 0

    v_perm_b32 v113, v70, v68, s55
    v_dot2_f32_bf16 v52, v46, v113, v52

    v_perm_b32 v113, v70, v68, s75
    v_dot2_f32_bf16 v53, v46, v113, v53

    v_perm_b32 v113, v71, v69, s55
    v_dot2_f32_bf16 v54, v46, v113, v54

    v_perm_b32 v113, v71, v69, s75
    v_dot2_f32_bf16 v55, v46, v113, v55

    v_perm_b32 v113, v74, v72, s55
    v_dot2_f32_bf16 v52, v48, v113, v52

    v_perm_b32 v113, v74, v72, s75
    v_dot2_f32_bf16 v53, v48, v113, v53

    v_perm_b32 v113, v75, v73, s55
    v_dot2_f32_bf16 v54, v48, v113, v54

    v_perm_b32 v113, v75, v73, s75
    v_dot2_f32_bf16 v55, v48, v113, v55

    v_perm_b32 v113, v78, v76, s55
    v_dot2_f32_bf16 v52, v50, v113, v52

    v_perm_b32 v113, v78, v76, s75
    v_dot2_f32_bf16 v53, v50, v113, v53

    v_perm_b32 v113, v79, v77, s55
    v_dot2_f32_bf16 v54, v50, v113, v54

    v_perm_b32 v113, v79, v77, s75
    v_dot2_f32_bf16 v55, v50, v113, v55

    v_perm_b32 v113, v82, v80, s55
    v_dot2_f32_bf16 v60, v44, v113, 0

    v_perm_b32 v113, v82, v80, s75
    v_dot2_f32_bf16 v61, v44, v113, 0

    v_perm_b32 v113, v83, v81, s55
    v_dot2_f32_bf16 v62, v44, v113, 0

    v_perm_b32 v113, v83, v81, s75
    v_dot2_f32_bf16 v63, v44, v113, 0

    v_perm_b32 v113, v86, v84, s55
    v_dot2_f32_bf16 v60, v46, v113, v60

    v_perm_b32 v113, v86, v84, s75
    v_dot2_f32_bf16 v61, v46, v113, v61

    v_perm_b32 v113, v87, v85, s55
    v_dot2_f32_bf16 v62, v46, v113, v62

    v_perm_b32 v113, v87, v85, s75
    v_dot2_f32_bf16 v63, v46, v113, v63

    v_perm_b32 v113, v90, v88, s55
    v_dot2_f32_bf16 v60, v48, v113, v60

    v_perm_b32 v113, v90, v88, s75
    v_dot2_f32_bf16 v61, v48, v113, v61

    v_perm_b32 v113, v91, v89, s55
    v_dot2_f32_bf16 v62, v48, v113, v62

    v_perm_b32 v113, v91, v89, s75
    v_dot2_f32_bf16 v63, v48, v113, v63

    v_perm_b32 v113, v94, v92, s55
    v_dot2_f32_bf16 v60, v50, v113, v60

    v_perm_b32 v113, v94, v92, s75
    v_dot2_f32_bf16 v61, v50, v113, v61

    v_perm_b32 v113, v95, v93, s55
    v_dot2_f32_bf16 v62, v50, v113, v62

    v_perm_b32 v113, v95, v93, s75
    v_dot2_f32_bf16 v63, v50, v113, v63

    s_add_u32 s92, s6, 393216
    s_addc_u32 s93, s7, 0
    s_mov_b32 s94, 2097152
    s_mov_b32 s95, 0x20000
    v_cvt_pk_bf16_f32 v52, v52, v53
    v_cvt_pk_bf16_f32 v53, v54, v55
    buffer_store_dwordx4 v[60:63], v111, s[92:95], 0 offen
    buffer_store_dwordx2 v[52:53], v111, s[92:95], 0 offen offset:16
    s_nop 1
L_nogate_5:

    s_mov_b32 s8, s80
    s_mov_b32 s9, s81
    s_mov_b32 s10, 0
    s_mov_b32 s11, 0x20000
    s_mov_b32 s12, s82
    s_mov_b32 s13, s83
    s_mov_b32 s14, 0
    s_mov_b32 s15, 0x20000
    s_mov_b32 s16, s84
    s_mov_b32 s17, s85
    s_mov_b32 s18, 0
    s_mov_b32 s19, 0x20000
    s_lshr_b32 s74, s2, 1
    s_and_b32 s74, s74, 28
    s_lshr_b32 s86, 0x00102010, s74
    s_lshr_b32 s87, 0x44414241, s74
    s_lshr_b32 s41, 0x43221100, s74
    s_and_b32 s86, s86, 15
    s_and_b32 s87, s87, 15
    s_and_b32 s41, s41, 15
    s_lshr_b32 s74, s2, 6
    s_lshl_b32 s74, s74, 3
    s_and_b32 s75, s2, 7
    s_add_u32 s74, s74, s75
    s_mul_i32 s74, s74, 5
    s_add_u32 s41, s41, s74

    s_mul_i32 s78, s41, 16384
    s_add_u32 s49, s78, 16384
    s_cmp_ge_u32 s41, 3125
    s_cmovk_i32 s49, 0
    s_cmovk_i32 s78, 0
    s_lshl_b32 s10, s49, 2
    s_lshl_b32 s14, s49, 2
    s_lshl_b32 s18, s49, 1
    s_sub_u32 s79, s87, s86
    s_bfm_b32 s85, s79, s86
    s_lshl_b32 s86, s86, 12
    s_lshl_b32 s87, s87, 12
    s_min_u32 s87, s87, 16384

    s_add_u32 s79, s78, 0
    s_bitcmp1_b32 s85, 0
    s_cselect_b32 s79, s79, 0x1ff00000
    s_lshl_b32 s56, s79, 2
    s_lshl_b32 s61, s79, 1

    s_add_u32 s79, s78, 4096
    s_bitcmp1_b32 s85, 1
    s_cselect_b32 s79, s79, 0x1ff00000
    s_lshl_b32 s57, s79, 2
    s_lshl_b32 s62, s79, 1

    s_add_u32 s79, s78, 8192
    s_bitcmp1_b32 s85, 2
    s_cselect_b32 s79, s79, 0x1ff00000
    s_lshl_b32 s58, s79, 2
    s_lshl_b32 s63, s79, 1

    s_add_u32 s79, s78, 12288
    s_bitcmp1_b32 s85, 3
    s_cselect_b32 s79, s79, 0x1ff00000
    s_lshl_b32 s59, s79, 2
    s_lshl_b32 s64, s79, 1

    s_mov_b32 s82, s85
    s_mov_b32 s83, s86
    s_mov_b32 s84, s87
    s_add_u32 s41, s2, 160
    s_mul_i32 s74, s41, 16384
    s_mov_b32 s10, 204800000
    s_mov_b32 s14, 204800000
    s_mov_b32 s18, 102400000

    s_add_u32 s75, s74, 0
    s_lshl_b32 s76, s75, 2
    s_lshl_b32 s75, s75, 1
    s_bitcmp1_b32 s82, 0
    s_cselect_b32 s56, s56, s76
    s_cselect_b32 s61, s61, s75

    s_add_u32 s75, s74, 4096
    s_lshl_b32 s76, s75, 2
    s_lshl_b32 s75, s75, 1
    s_bitcmp1_b32 s82, 1
    s_cselect_b32 s57, s57, s76
    s_cselect_b32 s62, s62, s75

    s_add_u32 s75, s74, 8192
    s_lshl_b32 s76, s75, 2
    s_lshl_b32 s75, s75, 1
    s_bitcmp1_b32 s82, 2
    s_cselect_b32 s58, s58, s76
    s_cselect_b32 s63, s63, s75

    s_add_u32 s75, s74, 12288
    s_lshl_b32 s76, s75, 2
    s_lshl_b32 s75, s75, 1
    s_bitcmp1_b32 s82, 3
    s_cselect_b32 s59, s59, s76
    s_cselect_b32 s64, s64, s75

    buffer_load_dwordx4 v[20:23], v1, s[12:15], s56 offen nt
    buffer_load_dwordx4 v[4:7], v1, s[8:11], s56 offen nt
    buffer_load_dwordx2 v[36:37], v2, s[16:19], s61 offen nt
    buffer_load_dwordx4 v[24:27], v1, s[12:15], s57 offen nt
    buffer_load_dwordx4 v[8:11], v1, s[8:11], s57 offen nt
    buffer_load_dwordx2 v[38:39], v2, s[16:19], s62 offen nt
    buffer_load_dwordx4 v[28:31], v1, s[12:15], s58 offen nt
    buffer_load_dwordx4 v[12:15], v1, s[8:11], s58 offen nt
    buffer_load_dwordx2 v[40:41], v2, s[16:19], s63 offen nt
    buffer_load_dwordx4 v[32:35], v1, s[12:15], s59 offen nt
    buffer_load_dwordx4 v[16:19], v1, s[8:11], s59 offen nt
    buffer_load_dwordx2 v[42:43], v2, s[16:19], s64 offen nt
    s_mov_b32 s86, 0
    s_mov_b32 s87, 4
    s_mul_i32 s78, s41, 16384
    s_add_u32 s49, s78, 16384
    s_cmp_ge_u32 s41, 3125
    s_cmovk_i32 s49, 0
    s_cmovk_i32 s78, 0
    s_lshl_b32 s10, s49, 2
    s_lshl_b32 s14, s49, 2
    s_lshl_b32 s18, s49, 1
    s_sub_u32 s79, s87, s86
    s_bfm_b32 s85, s79, s86
    s_lshl_b32 s86, s86, 12
    s_lshl_b32 s87, s87, 12
    s_min_u32 s87, s87, 16384

    s_add_u32 s79, s78, 0
    s_bitcmp1_b32 s85, 0
    s_cselect_b32 s79, s79, 0x1ff00000
    s_lshl_b32 s56, s79, 2
    s_lshl_b32 s61, s79, 1

    s_add_u32 s79, s78, 4096
    s_bitcmp1_b32 s85, 1
    s_cselect_b32 s79, s79, 0x1ff00000
    s_lshl_b32 s57, s79, 2
    s_lshl_b32 s62, s79, 1

    s_add_u32 s79, s78, 8192
    s_bitcmp1_b32 s85, 2
    s_cselect_b32 s79, s79, 0x1ff00000
    s_lshl_b32 s58, s79, 2
    s_lshl_b32 s63, s79, 1

    s_add_u32 s79, s78, 12288
    s_bitcmp1_b32 s85, 3
    s_cselect_b32 s79, s79, 0x1ff00000
    s_lshl_b32 s59, s79, 2
    s_lshl_b32 s64, s79, 1

    s_getreg_b32 s5, hwreg(HW_REG_XCC_ID)
    s_and_b32 s5, s5, 7
    s_mul_i32 s3, s5, 4096

    s_add_u32 s20, s6, s3
    s_addc_u32 s21, s7, 0
    s_mov_b32 s22, 4096
    s_mov_b32 s23, 0x20000
    s_mul_i32 s3, s5, 67117056
    s_add_u32 s3, s3, 85721088
    s_add_u32 s24, s6, s3
    s_addc_u32 s25, s7, 0
    s_mov_b32 s26, 67117056
    s_mov_b32 s27, 0x20000
    s_add_u32 s36, s6, 32768
    s_addc_u32 s37, s7, 0
    s_mov_b32 s38, 4
    s_mov_b32 s39, 0x20000
    s_mov_b32 s40, 687195
    s_mov_b32 s42, -6250
    s_mov_b32 s43, 1942
    s_mov_b32 s45, 0x06050400
    s_mov_b32 s46, 0x05040c00
    s_mov_b32 s48, 6524
    s_mov_b32 s50, 0
    v_mov_b32 v104, 1
    v_mov_b32 v101, 0
    v_mov_b32 v105, 0x46ff8000
    s_mov_b32 s55, 0x05040100
    v_mul_u32_u24 v106, 5, v0

    v_and_b32 v102, 15, v0
    v_lshrrev_b32 v103, 4, v0
    v_lshl_add_u32 v102, v102, 7, v103
    v_mul_u32_u24 v102, 32764, v102
    v_add_u32 v103, 2096896, v102

    v_and_b32 v102, 0xffffff80, v102
    v_and_b32 v103, 0xffffff80, v103
    s_movk_i32 s3, 1024
    v_cmp_gt_u32 s[66:67], s3, v0
    s_movk_i32 s3, 1024
    v_cmp_gt_u32 s[68:69], s3, v0
    s_waitcnt lgkmcnt(0)
    s_lshl_b32 s88, s88, 16
    v_mov_b32 v110, 0.15915494
    v_mul_f32 v110, s88, v110
    s_mov_b32 s3, 0x7fff7fff
    v_readfirstlane_b32 s44, v110

    s_waitcnt vmcnt(12)
    v_mov_b32 v61, 0
    v_mov_b32 v62, 0
    v_mov_b32 v63, 0
    v_dot2_f32_bf16 v61, v116, v116, v61
    v_dot2_f32_bf16 v61, v117, v117, v61
    v_dot2_f32_bf16 v61, v118, v118, v61
    v_dot2_f32_bf16 v61, v119, v119, v61
    v_dot2_f32_bf16 v61, v120, v120, v61
    v_dot2_f32_bf16 v61, v121, v121, v61
    v_dot2_f32_bf16 v61, v122, v122, v61
    v_dot2_f32_bf16 v61, v123, v123, v61
    v_dot2_f32_bf16 v61, v124, v124, v61
    v_dot2_f32_bf16 v62, v56, v56, v62
    v_dot2_f32_bf16 v62, v57, v57, v62
    v_dot2_f32_bf16 v62, v58, v58, v62
    v_dot2_f32_bf16 v62, v59, v59, v62
    v_and_b32 v60, s3, v116
    v_and_b32 v64, s3, v117
    v_pk_max_u16 v60, v60, v64
    v_and_b32 v64, s3, v118
    v_pk_max_u16 v60, v60, v64
    v_and_b32 v64, s3, v119
    v_pk_max_u16 v60, v60, v64
    v_and_b32 v64, s3, v120
    v_pk_max_u16 v60, v60, v64
    v_and_b32 v64, s3, v121
    v_pk_max_u16 v60, v60, v64
    v_and_b32 v64, s3, v122
    v_pk_max_u16 v60, v60, v64
    v_and_b32 v64, s3, v123
    v_pk_max_u16 v60, v60, v64
    v_and_b32 v64, s3, v124
    v_pk_max_u16 v60, v60, v64
    v_lshrrev_b32 v64, 16, v60
    v_and_b32 v60, 0xffff, v60
    v_max_u32 v60, v60, v64

    s_nop 1
    v_max_u32_dpp v60, v60, v60 row_shr:1 row_mask:0xf bank_mask:0xf
    s_nop 1
    v_max_u32_dpp v60, v60, v60 row_shr:2 row_mask:0xf bank_mask:0xf
    s_nop 1
    v_max_u32_dpp v60, v60, v60 row_shr:4 row_mask:0xf bank_mask:0xf
    s_nop 1
    v_max_u32_dpp v60, v60, v60 row_shr:8 row_mask:0xf bank_mask:0xf
    s_nop 1
    v_max_u32_dpp v60, v60, v60 row_bcast:15 row_mask:0xa bank_mask:0xf
    s_nop 1
    v_max_u32_dpp v60, v60, v60 row_bcast:31 row_mask:0xc bank_mask:0xf
    s_nop 1
    v_add_f32_dpp v61, v61, v61 row_shr:1 row_mask:0xf bank_mask:0xf
    s_nop 1
    v_add_f32_dpp v61, v61, v61 row_shr:2 row_mask:0xf bank_mask:0xf
    s_nop 1
    v_add_f32_dpp v61, v61, v61 row_shr:4 row_mask:0xf bank_mask:0xf
    s_nop 1
    v_add_f32_dpp v61, v61, v61 row_shr:8 row_mask:0xf bank_mask:0xf
    s_nop 1
    v_add_f32_dpp v61, v61, v61 row_bcast:15 row_mask:0xa bank_mask:0xf
    s_nop 1
    v_add_f32_dpp v61, v61, v61 row_bcast:31 row_mask:0xc bank_mask:0xf
    s_nop 1
    v_add_f32_dpp v62, v62, v62 row_shr:1 row_mask:0xf bank_mask:0xf
    s_nop 1
    v_add_f32_dpp v62, v62, v62 row_shr:2 row_mask:0xf bank_mask:0xf
    s_nop 1
    v_add_f32_dpp v62, v62, v62 row_shr:4 row_mask:0xf bank_mask:0xf
    s_nop 1
    v_add_f32_dpp v62, v62, v62 row_shr:8 row_mask:0xf bank_mask:0xf
    s_nop 1
    v_add_f32_dpp v62, v62, v62 row_bcast:15 row_mask:0xa bank_mask:0xf
    s_nop 1
    v_add_f32_dpp v62, v62, v62 row_bcast:31 row_mask:0xc bank_mask:0xf
    v_lshrrev_b32 v64, 6, v0
    v_lshlrev_b32 v64, 4, v64
    s_mov_b32 exec_lo, 0
    s_brev_b32 exec_hi, 1
    ds_write_b128 v64, v[60:63] offset:16384
    s_mov_b64 exec, -1

    s_bitcmp0_b32 s82, 0
    s_cbranch_scc1 L_ska_8
    s_waitcnt vmcnt(9)
    v_mul_hi_u32_u24 v45, s40, v20
    v_mul_hi_u32_u24 v44, s40, v4
    v_mul_hi_u32_u24 v47, s40, v21
    v_mul_hi_u32_u24 v46, s40, v5
    v_mul_hi_u32_u24 v49, s40, v22
    v_mul_hi_u32_u24 v48, s40, v6
    v_mul_hi_u32_u24 v51, s40, v23
    v_mul_hi_u32_u24 v50, s40, v7
    v_and_b32 v45, -2, v45
    v_mad_u32_u24 v4, v44, s43, v4
    v_and_b32 v76, -4, v44
    v_and_b32 v47, -2, v47
    v_mad_u32_u24 v5, v46, s43, v5
    v_and_b32 v77, -4, v46
    v_and_b32 v49, -2, v49
    v_mad_u32_u24 v6, v48, s43, v6
    v_and_b32 v78, -4, v48
    v_and_b32 v51, -2, v51
    v_mad_u32_u24 v7, v50, s43, v7
    v_and_b32 v79, -4, v50
    v_mad_i32_i24 v20, v45, s42, v20
    v_lshl_add_u32 v45, v45, 6, v76
    v_mad_i32_i24 v21, v47, s42, v21
    v_lshl_add_u32 v47, v47, 6, v77
    v_mad_i32_i24 v22, v49, s42, v22
    v_lshl_add_u32 v49, v49, 6, v78
    v_mad_i32_i24 v23, v51, s42, v23
    v_lshl_add_u32 v51, v51, 6, v79
    ds_add_rtn_u32 v76, v45, v104
    ds_add_rtn_u32 v77, v47, v104
    ds_add_rtn_u32 v78, v49, v104
    ds_add_rtn_u32 v79, v51, v104
    v_lshlrev_b32 v110, 16, v36
    v_and_b32 v111, 0xffff0000, v36
    v_lshlrev_b32 v112, 16, v37
    v_and_b32 v113, 0xffff0000, v37
    v_mul_f32 v110, s44, v110
    v_mul_f32 v111, s44, v111
    v_mul_f32 v112, s44, v112
    v_mul_f32 v113, s44, v113
    v_max3_f32 v101, |v110|, |v111|, v101
    v_max3_f32 v101, |v112|, |v113|, v101
    v_cos_f32 v110, v110
    v_cos_f32 v111, v111
    v_cos_f32 v112, v112
    v_cos_f32 v113, v113
    v_lshl_or_b32 v44, v44, 14, v20
    v_perm_b32 v45, v45, v4, s46
    v_bfe_u32 v4, v4, 8, 5

    v_lshl_or_b32 v46, v46, 14, v21
    v_perm_b32 v47, v47, v5, s46
    v_bfe_u32 v5, v5, 8, 5

    v_lshl_or_b32 v48, v48, 14, v22
    v_perm_b32 v49, v49, v6, s46
    v_bfe_u32 v6, v6, 8, 5

    v_lshl_or_b32 v50, v50, 14, v23
    v_perm_b32 v51, v51, v7, s46
    v_bfe_u32 v7, v7, 8, 5

    v_fmaak_f32 v110, v110, v105, 0x4b400010
    v_fmaak_f32 v111, v111, v105, 0x4b400010
    v_fmaak_f32 v112, v112, v105, 0x4b400010
    v_fmaak_f32 v113, v113, v105, 0x4b400010
    v_sub_u32 v110, v110, v4
    v_sub_u32 v111, v111, v5
    v_sub_u32 v112, v112, v6
    v_sub_u32 v113, v113, v7
    v_bfi_b32 v110, 31, v4, v110
    v_bfi_b32 v111, 31, v5, v111
    v_bfi_b32 v112, 31, v6, v112
    v_bfi_b32 v113, 31, v7, v113
    v_perm_b32 v44, v44, v110, s55
    v_perm_b32 v46, v46, v111, s55
    v_perm_b32 v48, v48, v112, s55
    v_perm_b32 v50, v50, v113, s55
    buffer_load_dwordx4 v[20:23], v1, s[12:15], s56 offen nt
    buffer_load_dwordx4 v[4:7], v1, s[8:11], s56 offen nt
    buffer_load_dwordx2 v[36:37], v2, s[16:19], s61 offen nt
L_bka_9:
    s_bitcmp0_b32 s82, 1
    s_cbranch_scc1 L_ska_10
    s_waitcnt vmcnt(9)
    v_mul_hi_u32_u24 v53, s40, v24
    v_mul_hi_u32_u24 v52, s40, v8
    v_mul_hi_u32_u24 v55, s40, v25
    v_mul_hi_u32_u24 v54, s40, v9
    v_mul_hi_u32_u24 v57, s40, v26
    v_mul_hi_u32_u24 v56, s40, v10
    v_mul_hi_u32_u24 v59, s40, v27
    v_mul_hi_u32_u24 v58, s40, v11
    v_and_b32 v53, -2, v53
    v_mad_u32_u24 v8, v52, s43, v8
    v_and_b32 v80, -4, v52
    v_and_b32 v55, -2, v55
    v_mad_u32_u24 v9, v54, s43, v9
    v_and_b32 v81, -4, v54
    v_and_b32 v57, -2, v57
    v_mad_u32_u24 v10, v56, s43, v10
    v_and_b32 v82, -4, v56
    v_and_b32 v59, -2, v59
    v_mad_u32_u24 v11, v58, s43, v11
    v_and_b32 v83, -4, v58
    v_mad_i32_i24 v24, v53, s42, v24
    v_lshl_add_u32 v53, v53, 6, v80
    v_mad_i32_i24 v25, v55, s42, v25
    v_lshl_add_u32 v55, v55, 6, v81
    v_mad_i32_i24 v26, v57, s42, v26
    v_lshl_add_u32 v57, v57, 6, v82
    v_mad_i32_i24 v27, v59, s42, v27
    v_lshl_add_u32 v59, v59, 6, v83
    ds_add_rtn_u32 v80, v53, v104
    ds_add_rtn_u32 v81, v55, v104
    ds_add_rtn_u32 v82, v57, v104
    ds_add_rtn_u32 v83, v59, v104
    v_lshlrev_b32 v110, 16, v38
    v_and_b32 v111, 0xffff0000, v38
    v_lshlrev_b32 v112, 16, v39
    v_and_b32 v113, 0xffff0000, v39
    v_mul_f32 v110, s44, v110
    v_mul_f32 v111, s44, v111
    v_mul_f32 v112, s44, v112
    v_mul_f32 v113, s44, v113
    v_max3_f32 v101, |v110|, |v111|, v101
    v_max3_f32 v101, |v112|, |v113|, v101
    v_cos_f32 v110, v110
    v_cos_f32 v111, v111
    v_cos_f32 v112, v112
    v_cos_f32 v113, v113
    v_lshl_or_b32 v52, v52, 14, v24
    v_perm_b32 v53, v53, v8, s46
    v_bfe_u32 v8, v8, 8, 5

    v_lshl_or_b32 v54, v54, 14, v25
    v_perm_b32 v55, v55, v9, s46
    v_bfe_u32 v9, v9, 8, 5

    v_lshl_or_b32 v56, v56, 14, v26
    v_perm_b32 v57, v57, v10, s46
    v_bfe_u32 v10, v10, 8, 5

    v_lshl_or_b32 v58, v58, 14, v27
    v_perm_b32 v59, v59, v11, s46
    v_bfe_u32 v11, v11, 8, 5

    v_fmaak_f32 v110, v110, v105, 0x4b400010
    v_fmaak_f32 v111, v111, v105, 0x4b400010
    v_fmaak_f32 v112, v112, v105, 0x4b400010
    v_fmaak_f32 v113, v113, v105, 0x4b400010
    v_sub_u32 v110, v110, v8
    v_sub_u32 v111, v111, v9
    v_sub_u32 v112, v112, v10
    v_sub_u32 v113, v113, v11
    v_bfi_b32 v110, 31, v8, v110
    v_bfi_b32 v111, 31, v9, v111
    v_bfi_b32 v112, 31, v10, v112
    v_bfi_b32 v113, 31, v11, v113
    v_perm_b32 v52, v52, v110, s55
    v_perm_b32 v54, v54, v111, s55
    v_perm_b32 v56, v56, v112, s55
    v_perm_b32 v58, v58, v113, s55
    buffer_load_dwordx4 v[24:27], v1, s[12:15], s57 offen nt
    buffer_load_dwordx4 v[8:11], v1, s[8:11], s57 offen nt
    buffer_load_dwordx2 v[38:39], v2, s[16:19], s62 offen nt
L_bka_11:
    s_bitcmp0_b32 s82, 2
    s_cbranch_scc1 L_ska_12
    s_waitcnt vmcnt(9)
    v_mul_hi_u32_u24 v61, s40, v28
    v_mul_hi_u32_u24 v60, s40, v12
    v_mul_hi_u32_u24 v63, s40, v29
    v_mul_hi_u32_u24 v62, s40, v13
    v_mul_hi_u32_u24 v65, s40, v30
    v_mul_hi_u32_u24 v64, s40, v14
    v_mul_hi_u32_u24 v67, s40, v31
    v_mul_hi_u32_u24 v66, s40, v15
    v_and_b32 v61, -2, v61
    v_mad_u32_u24 v12, v60, s43, v12
    v_and_b32 v84, -4, v60
    v_and_b32 v63, -2, v63
    v_mad_u32_u24 v13, v62, s43, v13
    v_and_b32 v85, -4, v62
    v_and_b32 v65, -2, v65
    v_mad_u32_u24 v14, v64, s43, v14
    v_and_b32 v86, -4, v64
    v_and_b32 v67, -2, v67
    v_mad_u32_u24 v15, v66, s43, v15
    v_and_b32 v87, -4, v66
    v_mad_i32_i24 v28, v61, s42, v28
    v_lshl_add_u32 v61, v61, 6, v84
    v_mad_i32_i24 v29, v63, s42, v29
    v_lshl_add_u32 v63, v63, 6, v85
    v_mad_i32_i24 v30, v65, s42, v30
    v_lshl_add_u32 v65, v65, 6, v86
    v_mad_i32_i24 v31, v67, s42, v31
    v_lshl_add_u32 v67, v67, 6, v87
    ds_add_rtn_u32 v84, v61, v104
    ds_add_rtn_u32 v85, v63, v104
    ds_add_rtn_u32 v86, v65, v104
    ds_add_rtn_u32 v87, v67, v104
    v_lshlrev_b32 v110, 16, v40
    v_and_b32 v111, 0xffff0000, v40
    v_lshlrev_b32 v112, 16, v41
    v_and_b32 v113, 0xffff0000, v41
    v_mul_f32 v110, s44, v110
    v_mul_f32 v111, s44, v111
    v_mul_f32 v112, s44, v112
    v_mul_f32 v113, s44, v113
    v_max3_f32 v101, |v110|, |v111|, v101
    v_max3_f32 v101, |v112|, |v113|, v101
    v_cos_f32 v110, v110
    v_cos_f32 v111, v111
    v_cos_f32 v112, v112
    v_cos_f32 v113, v113
    v_lshl_or_b32 v60, v60, 14, v28
    v_perm_b32 v61, v61, v12, s46
    v_bfe_u32 v12, v12, 8, 5

    v_lshl_or_b32 v62, v62, 14, v29
    v_perm_b32 v63, v63, v13, s46
    v_bfe_u32 v13, v13, 8, 5

    v_lshl_or_b32 v64, v64, 14, v30
    v_perm_b32 v65, v65, v14, s46
    v_bfe_u32 v14, v14, 8, 5

    v_lshl_or_b32 v66, v66, 14, v31
    v_perm_b32 v67, v67, v15, s46
    v_bfe_u32 v15, v15, 8, 5

    v_fmaak_f32 v110, v110, v105, 0x4b400010
    v_fmaak_f32 v111, v111, v105, 0x4b400010
    v_fmaak_f32 v112, v112, v105, 0x4b400010
    v_fmaak_f32 v113, v113, v105, 0x4b400010
    v_sub_u32 v110, v110, v12
    v_sub_u32 v111, v111, v13
    v_sub_u32 v112, v112, v14
    v_sub_u32 v113, v113, v15
    v_bfi_b32 v110, 31, v12, v110
    v_bfi_b32 v111, 31, v13, v111
    v_bfi_b32 v112, 31, v14, v112
    v_bfi_b32 v113, 31, v15, v113
    v_perm_b32 v60, v60, v110, s55
    v_perm_b32 v62, v62, v111, s55
    v_perm_b32 v64, v64, v112, s55
    v_perm_b32 v66, v66, v113, s55
    buffer_load_dwordx4 v[28:31], v1, s[12:15], s58 offen nt
    buffer_load_dwordx4 v[12:15], v1, s[8:11], s58 offen nt
    buffer_load_dwordx2 v[40:41], v2, s[16:19], s63 offen nt
L_bka_13:
    s_bitcmp0_b32 s82, 3
    s_cbranch_scc1 L_ska_14
    s_waitcnt vmcnt(9)
    s_mov_b64 exec, s[66:67]
    v_mul_hi_u32_u24 v69, s40, v32
    v_mul_hi_u32_u24 v68, s40, v16
    v_mul_hi_u32_u24 v71, s40, v33
    v_mul_hi_u32_u24 v70, s40, v17
    v_mul_hi_u32_u24 v73, s40, v34
    v_mul_hi_u32_u24 v72, s40, v18
    v_mul_hi_u32_u24 v75, s40, v35
    v_mul_hi_u32_u24 v74, s40, v19
    v_and_b32 v69, -2, v69
    v_mad_u32_u24 v16, v68, s43, v16
    v_and_b32 v88, -4, v68
    v_and_b32 v71, -2, v71
    v_mad_u32_u24 v17, v70, s43, v17
    v_and_b32 v89, -4, v70
    v_and_b32 v73, -2, v73
    v_mad_u32_u24 v18, v72, s43, v18
    v_and_b32 v90, -4, v72
    v_and_b32 v75, -2, v75
    v_mad_u32_u24 v19, v74, s43, v19
    v_and_b32 v91, -4, v74
    v_mad_i32_i24 v32, v69, s42, v32
    v_lshl_add_u32 v69, v69, 6, v88
    v_mad_i32_i24 v33, v71, s42, v33
    v_lshl_add_u32 v71, v71, 6, v89
    v_mad_i32_i24 v34, v73, s42, v34
    v_lshl_add_u32 v73, v73, 6, v90
    v_mad_i32_i24 v35, v75, s42, v35
    v_lshl_add_u32 v75, v75, 6, v91
    ds_add_rtn_u32 v88, v69, v104
    ds_add_rtn_u32 v89, v71, v104
    ds_add_rtn_u32 v90, v73, v104
    ds_add_rtn_u32 v91, v75, v104
    v_lshlrev_b32 v110, 16, v42
    v_and_b32 v111, 0xffff0000, v42
    v_lshlrev_b32 v112, 16, v43
    v_and_b32 v113, 0xffff0000, v43
    v_mul_f32 v110, s44, v110
    v_mul_f32 v111, s44, v111
    v_mul_f32 v112, s44, v112
    v_mul_f32 v113, s44, v113
    v_max3_f32 v101, |v110|, |v111|, v101
    v_max3_f32 v101, |v112|, |v113|, v101
    v_cos_f32 v110, v110
    v_cos_f32 v111, v111
    v_cos_f32 v112, v112
    v_cos_f32 v113, v113
    v_lshl_or_b32 v68, v68, 14, v32
    v_perm_b32 v69, v69, v16, s46
    v_bfe_u32 v16, v16, 8, 5

    v_lshl_or_b32 v70, v70, 14, v33
    v_perm_b32 v71, v71, v17, s46
    v_bfe_u32 v17, v17, 8, 5

    v_lshl_or_b32 v72, v72, 14, v34
    v_perm_b32 v73, v73, v18, s46
    v_bfe_u32 v18, v18, 8, 5

    v_lshl_or_b32 v74, v74, 14, v35
    v_perm_b32 v75, v75, v19, s46
    v_bfe_u32 v19, v19, 8, 5

    v_fmaak_f32 v110, v110, v105, 0x4b400010
    v_fmaak_f32 v111, v111, v105, 0x4b400010
    v_fmaak_f32 v112, v112, v105, 0x4b400010
    v_fmaak_f32 v113, v113, v105, 0x4b400010
    v_sub_u32 v110, v110, v16
    v_sub_u32 v111, v111, v17
    v_sub_u32 v112, v112, v18
    v_sub_u32 v113, v113, v19
    v_bfi_b32 v110, 31, v16, v110
    v_bfi_b32 v111, 31, v17, v111
    v_bfi_b32 v112, 31, v18, v112
    v_bfi_b32 v113, 31, v19, v113
    v_perm_b32 v68, v68, v110, s55
    v_perm_b32 v70, v70, v111, s55
    v_perm_b32 v72, v72, v112, s55
    v_perm_b32 v74, v74, v113, s55
    s_mov_b64 exec, -1
    buffer_load_dwordx4 v[32:35], v1, s[12:15], s59 offen nt
    buffer_load_dwordx4 v[16:19], v1, s[8:11], s59 offen nt
    buffer_load_dwordx2 v[42:43], v2, s[16:19], s64 offen nt
L_bka_15:
    v_readfirstlane_b32 s74, v0
    s_nop 1
    s_cmp_lg_u32 s74, 0
    s_cbranch_scc1 L_ready_17

    v_mov_b32 v100, 0
    buffer_atomic_add v100, v98, s[96:99], 0 offen offset:128 sc0
    s_waitcnt vmcnt(0)
    v_readfirstlane_b32 s74, v100
    s_nop 1
    s_cmp_lg_u32 s74, 0
    s_cbranch_scc1 L_ready_17

    v_mov_b32 v110, 1
    buffer_atomic_add v110, v98, s[96:99], 0 offen offset:64 sc0
    s_waitcnt vmcnt(0)
    v_readfirstlane_b32 s74, v110
    s_nop 1
    s_cmp_lg_u32 s74, 0
    s_cbranch_scc1 L_zno_19

    s_mov_b32 s92, s6
    s_mov_b32 s93, s7
    s_mov_b32 s94, 32784
    s_mov_b32 s95, 0x20000
    v_mov_b32 v110, 0
    v_mov_b32 v111, 0
    v_mov_b32 v112, 0
    v_mov_b32 v113, 0
L_zl_18:
    buffer_store_dwordx4 v[110:113], v1, s[92:95], s74 offen sc0 sc1
    s_add_u32 s74, s74, 1024
    s_cmp_le_u32 s74, 32768
    s_cbranch_scc1 L_zl_18
    v_mov_b32 v114, 1
    s_waitcnt vmcnt(0)
    buffer_atomic_add v114, v98, s[96:99], 0 offen offset:128
L_zno_19:

L_spin_16:
    v_mov_b32 v100, 0
    buffer_atomic_add v100, v98, s[96:99], 0 offen offset:128 sc0
    s_waitcnt vmcnt(0)
    v_readfirstlane_b32 s74, v100
    s_nop 1
    s_cmp_eq_u32 s74, 0
    s_cbranch_scc1 L_spin_16
L_ready_17:

    s_waitcnt lgkmcnt(0)
    s_barrier

    v_and_b32 v114, 15, v0
    v_lshlrev_b32 v114, 4, v114
    ds_read_b128 v[110:113], v114 offset:16384
    s_waitcnt lgkmcnt(0)

    s_nop 0
    v_max_u32_dpp v110, v110, v110 row_ror:1 row_mask:0xf bank_mask:0xf
    v_add_f32_dpp v111, v111, v111 row_ror:1 row_mask:0xf bank_mask:0xf
    v_add_f32_dpp v112, v112, v112 row_ror:1 row_mask:0xf bank_mask:0xf

    s_nop 0
    v_max_u32_dpp v110, v110, v110 row_ror:2 row_mask:0xf bank_mask:0xf
    v_add_f32_dpp v111, v111, v111 row_ror:2 row_mask:0xf bank_mask:0xf
    v_add_f32_dpp v112, v112, v112 row_ror:2 row_mask:0xf bank_mask:0xf

    s_nop 0
    v_max_u32_dpp v110, v110, v110 row_ror:4 row_mask:0xf bank_mask:0xf
    v_add_f32_dpp v111, v111, v111 row_ror:4 row_mask:0xf bank_mask:0xf
    v_add_f32_dpp v112, v112, v112 row_ror:4 row_mask:0xf bank_mask:0xf

    s_nop 0
    v_max_u32_dpp v110, v110, v110 row_ror:8 row_mask:0xf bank_mask:0xf
    v_add_f32_dpp v111, v111, v111 row_ror:8 row_mask:0xf bank_mask:0xf
    v_add_f32_dpp v112, v112, v112 row_ror:8 row_mask:0xf bank_mask:0xf

    v_rsq_f32 v112, v112
    v_readfirstlane_b32 s32, v110
    v_mul_f32 v112, 0x47decb04, v112
    v_readfirstlane_b32 s33, v111
    v_readfirstlane_b32 s34, v112

    ds_read_b64 v[94:95], v2
    s_waitcnt lgkmcnt(0)
    v_add_u32 v97, v94, v95
    s_nop 1
    v_add_u32_dpp v97, v97, v97 row_shr:1 row_mask:0xf bank_mask:0xf
    s_nop 1
    v_add_u32_dpp v97, v97, v97 row_shr:2 row_mask:0xf bank_mask:0xf
    s_nop 1
    v_add_u32_dpp v97, v97, v97 row_shr:4 row_mask:0xf bank_mask:0xf
    s_nop 1
    v_add_u32_dpp v97, v97, v97 row_shr:8 row_mask:0xf bank_mask:0xf
    s_nop 1
    v_add_u32_dpp v97, v97, v97 row_bcast:15 row_mask:0xa bank_mask:0xf
    s_nop 1
    v_add_u32_dpp v97, v97, v97 row_bcast:31 row_mask:0xc bank_mask:0xf
    s_mov_b32 exec_lo, 0
    s_brev_b32 exec_hi, 1
    ds_add_rtn_u32 v96, v108, v97
    s_mov_b64 exec, -1

    v_add_u32 v92, v94, v94
    v_add_u32 v93, v95, v95
    v_med3_u32 v92, v94, 2, v92
    v_med3_u32 v93, v95, 2, v93
    v_lshl_or_b32 v92, v93, 16, v92
    v_lshlrev_b32 v93, 2, v0
    buffer_atomic_add v92, v93, s[20:23], 0 offen sc0
    s_waitcnt lgkmcnt(0)
    v_readlane_b32 s77, v96, 63
    v_sub_u32 v97, v97, v95
    s_sub_u32 s50, s50, s83
    s_sub_u32 s77, s77, s50
    v_add_u32 v97, s77, v97
    v_sub_u32 v96, v97, v94
    v_lshlrev_b32 v111, 3, v97
    v_lshlrev_b32 v110, 3, v96
    v_mov_b32 v112, 0
    v_mov_b32 v113, 0
    ds_write_b64 v2, v[110:111] offset:8192
    ds_write_b64 v2, v[112:113]
    v_mad_i32_i24 v96, v96, -5, v102
    v_mad_i32_i24 v97, v97, -5, v103
    s_add_u32 s50, s50, s84
    s_mov_b32 s28, s82
    s_mov_b32 s29, s83
    s_mov_b32 s30, s84
    s_lshl_b32 s74, s29, 3
    s_lshl_b32 s75, s30, 3
    v_mov_b32 v125, s74
    v_mov_b32 v126, s75
    v_mov_b32 v127, -1

    s_waitcnt lgkmcnt(0)
    s_barrier

    s_mov_b64 exec, 1
    ds_write_b32 v125, v127 offset:24588
    ds_write_b32 v126, v127 offset:24596
    s_mov_b64 exec, -1

    s_bitcmp0_b32 s28, 0
    s_cbranch_scc1 L_skz_20
    v_lshrrev_b32 v110, 16, v45
    ds_read_b32 v110, v110 offset:8192
    v_lshrrev_b32 v111, 16, v47
    ds_read_b32 v111, v111 offset:8192
    v_lshrrev_b32 v112, 16, v49
    ds_read_b32 v112, v112 offset:8192
    v_lshrrev_b32 v113, 16, v51
    ds_read_b32 v113, v113 offset:8192
    s_waitcnt lgkmcnt(3)
    v_lshl_add_u32 v110, v76, 3, v110
    ds_write_b64 v110, v[44:45] offset:24592

    s_waitcnt lgkmcnt(3)
    v_lshl_add_u32 v111, v77, 3, v111
    ds_write_b64 v111, v[46:47] offset:24592

    s_waitcnt lgkmcnt(3)
    v_lshl_add_u32 v112, v78, 3, v112
    ds_write_b64 v112, v[48:49] offset:24592

    s_waitcnt lgkmcnt(3)
    v_lshl_add_u32 v113, v79, 3, v113
    ds_write_b64 v113, v[50:51] offset:24592

L_skz_20:
    s_bitcmp0_b32 s28, 1
    s_cbranch_scc1 L_skz_21
    v_lshrrev_b32 v110, 16, v53
    ds_read_b32 v110, v110 offset:8192
    v_lshrrev_b32 v111, 16, v55
    ds_read_b32 v111, v111 offset:8192
    v_lshrrev_b32 v112, 16, v57
    ds_read_b32 v112, v112 offset:8192
    v_lshrrev_b32 v113, 16, v59
    ds_read_b32 v113, v113 offset:8192
    s_waitcnt lgkmcnt(3)
    v_lshl_add_u32 v110, v80, 3, v110
    ds_write_b64 v110, v[52:53] offset:24592

    s_waitcnt lgkmcnt(3)
    v_lshl_add_u32 v111, v81, 3, v111
    ds_write_b64 v111, v[54:55] offset:24592

    s_waitcnt lgkmcnt(3)
    v_lshl_add_u32 v112, v82, 3, v112
    ds_write_b64 v112, v[56:57] offset:24592

    s_waitcnt lgkmcnt(3)
    v_lshl_add_u32 v113, v83, 3, v113
    ds_write_b64 v113, v[58:59] offset:24592

L_skz_21:
    s_bitcmp0_b32 s28, 2
    s_cbranch_scc1 L_skz_22
    v_lshrrev_b32 v110, 16, v61
    ds_read_b32 v110, v110 offset:8192
    v_lshrrev_b32 v111, 16, v63
    ds_read_b32 v111, v111 offset:8192
    v_lshrrev_b32 v112, 16, v65
    ds_read_b32 v112, v112 offset:8192
    v_lshrrev_b32 v113, 16, v67
    ds_read_b32 v113, v113 offset:8192
    s_waitcnt lgkmcnt(3)
    v_lshl_add_u32 v110, v84, 3, v110
    ds_write_b64 v110, v[60:61] offset:24592

    s_waitcnt lgkmcnt(3)
    v_lshl_add_u32 v111, v85, 3, v111
    ds_write_b64 v111, v[62:63] offset:24592

    s_waitcnt lgkmcnt(3)
    v_lshl_add_u32 v112, v86, 3, v112
    ds_write_b64 v112, v[64:65] offset:24592

    s_waitcnt lgkmcnt(3)
    v_lshl_add_u32 v113, v87, 3, v113
    ds_write_b64 v113, v[66:67] offset:24592

L_skz_22:
    s_bitcmp0_b32 s28, 3
    s_cbranch_scc1 L_skz_23
    s_mov_b64 exec, s[66:67]
    v_lshrrev_b32 v110, 16, v69
    ds_read_b32 v110, v110 offset:8192
    v_lshrrev_b32 v111, 16, v71
    ds_read_b32 v111, v111 offset:8192
    v_lshrrev_b32 v112, 16, v73
    ds_read_b32 v112, v112 offset:8192
    v_lshrrev_b32 v113, 16, v75
    ds_read_b32 v113, v113 offset:8192
    s_waitcnt lgkmcnt(3)
    v_lshl_add_u32 v110, v88, 3, v110
    ds_write_b64 v110, v[68:69] offset:24592

    s_waitcnt lgkmcnt(3)
    v_lshl_add_u32 v111, v89, 3, v111
    ds_write_b64 v111, v[70:71] offset:24592

    s_waitcnt lgkmcnt(3)
    v_lshl_add_u32 v112, v90, 3, v112
    ds_write_b64 v112, v[72:73] offset:24592

    s_waitcnt lgkmcnt(3)
    v_lshl_add_u32 v113, v91, 3, v113
    ds_write_b64 v113, v[74:75] offset:24592

    s_mov_b64 exec, -1
L_skz_23:
    v_mov_b32 v110, s32
    v_mov_b32 v111, s33
    v_mov_b32 v112, s34
    v_mov_b32 v113, 0
    v_mov_b32 v115, 0x4b400000

    s_add_u32 s92, s6, 135168
    s_addc_u32 s93, s7, 0
    s_mov_b32 s94, 4096
    s_mov_b32 s95, 0x20000
    s_lshl_b32 s3, s2, 4
    buffer_store_dwordx4 v[110:113], v98, s[92:95], s3 offen
    v_lshlrev_b32 v107, 16, v116
    v_and_b32 v116, 0xffff0000, v116
    v_fma_f32 v107, v107, s34, v115
    v_fma_f32 v116, v116, s34, v115
    v_perm_b32 v116, v116, v107, s55

    v_lshlrev_b32 v107, 16, v117
    v_and_b32 v117, 0xffff0000, v117
    v_fma_f32 v107, v107, s34, v115
    v_fma_f32 v117, v117, s34, v115
    v_perm_b32 v117, v117, v107, s55

    v_lshlrev_b32 v107, 16, v118
    v_and_b32 v118, 0xffff0000, v118
    v_fma_f32 v107, v107, s34, v115
    v_fma_f32 v118, v118, s34, v115
    v_perm_b32 v118, v118, v107, s55

    v_lshlrev_b32 v107, 16, v119
    v_and_b32 v119, 0xffff0000, v119
    v_fma_f32 v107, v107, s34, v115
    v_fma_f32 v119, v119, s34, v115
    v_perm_b32 v119, v119, v107, s55

    v_lshlrev_b32 v107, 16, v120
    v_and_b32 v120, 0xffff0000, v120
    v_fma_f32 v107, v107, s34, v115
    v_fma_f32 v120, v120, s34, v115
    v_perm_b32 v120, v120, v107, s55

    v_lshlrev_b32 v107, 16, v121
    v_and_b32 v121, 0xffff0000, v121
    v_fma_f32 v107, v107, s34, v115
    v_fma_f32 v121, v121, s34, v115
    v_perm_b32 v121, v121, v107, s55

    v_lshlrev_b32 v107, 16, v122
    v_and_b32 v122, 0xffff0000, v122
    v_fma_f32 v107, v107, s34, v115
    v_fma_f32 v122, v122, s34, v115
    v_perm_b32 v122, v122, v107, s55

    v_lshlrev_b32 v107, 16, v123
    v_and_b32 v123, 0xffff0000, v123
    v_fma_f32 v107, v107, s34, v115
    v_fma_f32 v123, v123, s34, v115
    v_perm_b32 v123, v123, v107, s55

    v_lshlrev_b32 v107, 16, v124
    v_and_b32 v124, 0xffff0000, v124
    v_fma_f32 v107, v107, s34, v115
    v_fma_f32 v124, v124, s34, v115
    v_perm_b32 v124, v124, v107, s55

    s_add_u32 s92, s6, s54
    s_addc_u32 s93, s7, 0
    s_mov_b32 s94, 24576
    s_mov_b32 s95, 0x20000
    s_movk_i32 s3, 16384
    buffer_store_dwordx4 v[116:119], v1, s[92:95], 0 offen
    buffer_store_dwordx4 v[120:123], v1, s[92:95], s3 offen
    s_mul_i32 s94, s53, 25424
    s_movk_i32 s3, 24576
    v_lshlrev_b32 v107, 2, v0

    buffer_store_dword v124, v107, s[92:95], s3 offen
    s_nop 1
    s_cmp_eq_u32 s49, 0
    s_cbranch_scc1 L_p1epi_7
L_p1loop_6:
    s_mov_b32 s82, s85
    s_mov_b32 s83, s86
    s_mov_b32 s84, s87
    v_mov_b32 v99, 1
    buffer_atomic_add v99, v98, s[96:99], 0 offen sc0
    s_cmp_eq_u32 s82, 15
    s_cbranch_scc1 L_full_24
    s_waitcnt vmcnt(1)
L_full_24:
    s_bitcmp0_b32 s82, 0
    s_cbranch_scc1 L_ska_25
    s_waitcnt vmcnt(11)
    v_mul_hi_u32_u24 v45, s40, v20
    v_mul_hi_u32_u24 v44, s40, v4
    v_mul_hi_u32_u24 v47, s40, v21
    v_mul_hi_u32_u24 v46, s40, v5
    v_mul_hi_u32_u24 v49, s40, v22
    v_mul_hi_u32_u24 v48, s40, v6
    v_mul_hi_u32_u24 v51, s40, v23
    v_mul_hi_u32_u24 v50, s40, v7
    v_and_b32 v45, -2, v45
    v_mad_u32_u24 v4, v44, s43, v4
    v_and_b32 v76, -4, v44
    v_and_b32 v47, -2, v47
    v_mad_u32_u24 v5, v46, s43, v5
    v_and_b32 v77, -4, v46
    v_and_b32 v49, -2, v49
    v_mad_u32_u24 v6, v48, s43, v6
    v_and_b32 v78, -4, v48
    v_and_b32 v51, -2, v51
    v_mad_u32_u24 v7, v50, s43, v7
    v_and_b32 v79, -4, v50
    v_mad_i32_i24 v20, v45, s42, v20
    v_lshl_add_u32 v45, v45, 6, v76
    v_mad_i32_i24 v21, v47, s42, v21
    v_lshl_add_u32 v47, v47, 6, v77
    v_mad_i32_i24 v22, v49, s42, v22
    v_lshl_add_u32 v49, v49, 6, v78
    v_mad_i32_i24 v23, v51, s42, v23
    v_lshl_add_u32 v51, v51, 6, v79
    ds_add_rtn_u32 v76, v45, v104
    ds_add_rtn_u32 v77, v47, v104
    ds_add_rtn_u32 v78, v49, v104
    ds_add_rtn_u32 v79, v51, v104
    v_lshlrev_b32 v110, 16, v36
    v_and_b32 v111, 0xffff0000, v36
    v_lshlrev_b32 v112, 16, v37
    v_and_b32 v113, 0xffff0000, v37
    v_mul_f32 v110, s44, v110
    v_mul_f32 v111, s44, v111
    v_mul_f32 v112, s44, v112
    v_mul_f32 v113, s44, v113
    v_max3_f32 v101, |v110|, |v111|, v101
    v_max3_f32 v101, |v112|, |v113|, v101
    v_cos_f32 v110, v110
    v_cos_f32 v111, v111
    v_cos_f32 v112, v112
    v_cos_f32 v113, v113
    v_lshl_or_b32 v44, v44, 14, v20
    v_perm_b32 v45, v45, v4, s46
    v_bfe_u32 v4, v4, 8, 5

    v_lshl_or_b32 v46, v46, 14, v21
    v_perm_b32 v47, v47, v5, s46
    v_bfe_u32 v5, v5, 8, 5

    v_lshl_or_b32 v48, v48, 14, v22
    v_perm_b32 v49, v49, v6, s46
    v_bfe_u32 v6, v6, 8, 5

    v_lshl_or_b32 v50, v50, 14, v23
    v_perm_b32 v51, v51, v7, s46
    v_bfe_u32 v7, v7, 8, 5

    v_fmaak_f32 v110, v110, v105, 0x4b400010
    v_fmaak_f32 v111, v111, v105, 0x4b400010
    v_fmaak_f32 v112, v112, v105, 0x4b400010
    v_fmaak_f32 v113, v113, v105, 0x4b400010
    v_sub_u32 v110, v110, v4
    v_sub_u32 v111, v111, v5
    v_sub_u32 v112, v112, v6
    v_sub_u32 v113, v113, v7
    v_bfi_b32 v110, 31, v4, v110
    v_bfi_b32 v111, 31, v5, v111
    v_bfi_b32 v112, 31, v6, v112
    v_bfi_b32 v113, 31, v7, v113
    v_perm_b32 v44, v44, v110, s55
    v_perm_b32 v46, v46, v111, s55
    v_perm_b32 v48, v48, v112, s55
    v_perm_b32 v50, v50, v113, s55
L_ska_25:
    s_bitcmp0_b32 s82, 1
    s_cbranch_scc1 L_ska_26
    s_waitcnt vmcnt(8)
    v_mul_hi_u32_u24 v53, s40, v24
    v_mul_hi_u32_u24 v52, s40, v8
    v_mul_hi_u32_u24 v55, s40, v25
    v_mul_hi_u32_u24 v54, s40, v9
    v_mul_hi_u32_u24 v57, s40, v26
    v_mul_hi_u32_u24 v56, s40, v10
    v_mul_hi_u32_u24 v59, s40, v27
    v_mul_hi_u32_u24 v58, s40, v11
    v_and_b32 v53, -2, v53
    v_mad_u32_u24 v8, v52, s43, v8
    v_and_b32 v80, -4, v52
    v_and_b32 v55, -2, v55
    v_mad_u32_u24 v9, v54, s43, v9
    v_and_b32 v81, -4, v54
    v_and_b32 v57, -2, v57
    v_mad_u32_u24 v10, v56, s43, v10
    v_and_b32 v82, -4, v56
    v_and_b32 v59, -2, v59
    v_mad_u32_u24 v11, v58, s43, v11
    v_and_b32 v83, -4, v58
    v_mad_i32_i24 v24, v53, s42, v24
    v_lshl_add_u32 v53, v53, 6, v80
    v_mad_i32_i24 v25, v55, s42, v25
    v_lshl_add_u32 v55, v55, 6, v81
    v_mad_i32_i24 v26, v57, s42, v26
    v_lshl_add_u32 v57, v57, 6, v82
    v_mad_i32_i24 v27, v59, s42, v27
    v_lshl_add_u32 v59, v59, 6, v83
    ds_add_rtn_u32 v80, v53, v104
    ds_add_rtn_u32 v81, v55, v104
    ds_add_rtn_u32 v82, v57, v104
    ds_add_rtn_u32 v83, v59, v104
    v_lshlrev_b32 v110, 16, v38
    v_and_b32 v111, 0xffff0000, v38
    v_lshlrev_b32 v112, 16, v39
    v_and_b32 v113, 0xffff0000, v39
    v_mul_f32 v110, s44, v110
    v_mul_f32 v111, s44, v111
    v_mul_f32 v112, s44, v112
    v_mul_f32 v113, s44, v113
    v_max3_f32 v101, |v110|, |v111|, v101
    v_max3_f32 v101, |v112|, |v113|, v101
    v_cos_f32 v110, v110
    v_cos_f32 v111, v111
    v_cos_f32 v112, v112
    v_cos_f32 v113, v113
    v_lshl_or_b32 v52, v52, 14, v24
    v_perm_b32 v53, v53, v8, s46
    v_bfe_u32 v8, v8, 8, 5

    v_lshl_or_b32 v54, v54, 14, v25
    v_perm_b32 v55, v55, v9, s46
    v_bfe_u32 v9, v9, 8, 5

    v_lshl_or_b32 v56, v56, 14, v26
    v_perm_b32 v57, v57, v10, s46
    v_bfe_u32 v10, v10, 8, 5

    v_lshl_or_b32 v58, v58, 14, v27
    v_perm_b32 v59, v59, v11, s46
    v_bfe_u32 v11, v11, 8, 5

    v_fmaak_f32 v110, v110, v105, 0x4b400010
    v_fmaak_f32 v111, v111, v105, 0x4b400010
    v_fmaak_f32 v112, v112, v105, 0x4b400010
    v_fmaak_f32 v113, v113, v105, 0x4b400010
    v_sub_u32 v110, v110, v8
    v_sub_u32 v111, v111, v9
    v_sub_u32 v112, v112, v10
    v_sub_u32 v113, v113, v11
    v_bfi_b32 v110, 31, v8, v110
    v_bfi_b32 v111, 31, v9, v111
    v_bfi_b32 v112, 31, v10, v112
    v_bfi_b32 v113, 31, v11, v113
    v_perm_b32 v52, v52, v110, s55
    v_perm_b32 v54, v54, v111, s55
    v_perm_b32 v56, v56, v112, s55
    v_perm_b32 v58, v58, v113, s55
L_ska_26:
    s_bitcmp0_b32 s82, 2
    s_cbranch_scc1 L_ska_27
    s_waitcnt vmcnt(4)
    v_mul_hi_u32_u24 v61, s40, v28
    v_mul_hi_u32_u24 v60, s40, v12
    v_mul_hi_u32_u24 v63, s40, v29
    v_mul_hi_u32_u24 v62, s40, v13
    v_mul_hi_u32_u24 v65, s40, v30
    v_mul_hi_u32_u24 v64, s40, v14
    v_mul_hi_u32_u24 v67, s40, v31
    v_mul_hi_u32_u24 v66, s40, v15
    v_and_b32 v61, -2, v61
    v_mad_u32_u24 v12, v60, s43, v12
    v_and_b32 v84, -4, v60
    v_and_b32 v63, -2, v63
    v_mad_u32_u24 v13, v62, s43, v13
    v_and_b32 v85, -4, v62
    v_and_b32 v65, -2, v65
    v_mad_u32_u24 v14, v64, s43, v14
    v_and_b32 v86, -4, v64
    v_and_b32 v67, -2, v67
    v_mad_u32_u24 v15, v66, s43, v15
    v_and_b32 v87, -4, v66
    v_mad_i32_i24 v28, v61, s42, v28
    v_lshl_add_u32 v61, v61, 6, v84
    v_mad_i32_i24 v29, v63, s42, v29
    v_lshl_add_u32 v63, v63, 6, v85
    v_mad_i32_i24 v30, v65, s42, v30
    v_lshl_add_u32 v65, v65, 6, v86
    v_mad_i32_i24 v31, v67, s42, v31
    v_lshl_add_u32 v67, v67, 6, v87
    ds_add_rtn_u32 v84, v61, v104
    ds_add_rtn_u32 v85, v63, v104
    ds_add_rtn_u32 v86, v65, v104
    ds_add_rtn_u32 v87, v67, v104
    v_lshlrev_b32 v110, 16, v40
    v_and_b32 v111, 0xffff0000, v40
    v_lshlrev_b32 v112, 16, v41
    v_and_b32 v113, 0xffff0000, v41
    v_mul_f32 v110, s44, v110
    v_mul_f32 v111, s44, v111
    v_mul_f32 v112, s44, v112
    v_mul_f32 v113, s44, v113
    v_max3_f32 v101, |v110|, |v111|, v101
    v_max3_f32 v101, |v112|, |v113|, v101
    v_cos_f32 v110, v110
    v_cos_f32 v111, v111
    v_cos_f32 v112, v112
    v_cos_f32 v113, v113
    v_lshl_or_b32 v60, v60, 14, v28
    v_perm_b32 v61, v61, v12, s46
    v_bfe_u32 v12, v12, 8, 5

    v_lshl_or_b32 v62, v62, 14, v29
    v_perm_b32 v63, v63, v13, s46
    v_bfe_u32 v13, v13, 8, 5

    v_lshl_or_b32 v64, v64, 14, v30
    v_perm_b32 v65, v65, v14, s46
    v_bfe_u32 v14, v14, 8, 5

    v_lshl_or_b32 v66, v66, 14, v31
    v_perm_b32 v67, v67, v15, s46
    v_bfe_u32 v15, v15, 8, 5

    v_fmaak_f32 v110, v110, v105, 0x4b400010
    v_fmaak_f32 v111, v111, v105, 0x4b400010
    v_fmaak_f32 v112, v112, v105, 0x4b400010
    v_fmaak_f32 v113, v113, v105, 0x4b400010
    v_sub_u32 v110, v110, v12
    v_sub_u32 v111, v111, v13
    v_sub_u32 v112, v112, v14
    v_sub_u32 v113, v113, v15
    v_bfi_b32 v110, 31, v12, v110
    v_bfi_b32 v111, 31, v13, v111
    v_bfi_b32 v112, 31, v14, v112
    v_bfi_b32 v113, 31, v15, v113
    v_perm_b32 v60, v60, v110, s55
    v_perm_b32 v62, v62, v111, s55
    v_perm_b32 v64, v64, v112, s55
    v_perm_b32 v66, v66, v113, s55
L_ska_27:
    s_waitcnt vmcnt(1)
    s_waitcnt vmcnt(0)
    v_cmp_eq_u32 vcc, 0, v0
    s_mov_b64 exec, vcc
    ds_write_b32 v108, v99 offset:8
    s_mov_b64 exec, -1
    s_waitcnt vmcnt(5)
    v_lshrrev_b32 v93, 16, v92
    v_and_b32 v92, 0xffff, v92
    v_add_u32 v110, v92, v94
    v_mad_u32_u24 v92, v92, 5, v96
    v_add_u32 v111, v93, v95
    v_mad_u32_u24 v93, v93, 5, v97
    v_max_u32 v110, v110, v111
    v_cmp_le_u32 vcc, s48, v110
    s_cbranch_vccnz L_full_28
L_fback_29:
    ds_write_b64 v2, v[92:93] offset:16384

    s_waitcnt lgkmcnt(0)
    s_barrier
    ds_read_b32 v111, v108 offset:8
    s_waitcnt lgkmcnt(0)
    v_readfirstlane_b32 s41, v111
    s_nop 1

    s_add_u32 s41, s41, 416
    s_sub_u32 s78, s41, 2965
    s_lshr_b32 s79, s78, 1
    s_add_u32 s79, s79, 2965
    s_and_b32 s86, s78, 1
    s_lshl_b32 s86, s86, 1
    s_add_u32 s87, s86, 2
    s_cmp_lt_u32 s41, 2965
    s_cselect_b32 s41, s41, s79
    s_cmovk_i32 s86, 0
    s_cmovk_i32 s87, 4

    s_lshl_b32 s76, s86, 12
    s_sub_u32 s87, s87, s86
    s_mov_b32 s86, 0
    s_mul_i32 s78, s41, 16384
    s_add_u32 s49, s78, 16384
    s_cmp_ge_u32 s41, 3125
    s_cmovk_i32 s49, 0
    s_cmovk_i32 s78, 0
    s_lshl_b32 s10, s49, 2
    s_lshl_b32 s14, s49, 2
    s_lshl_b32 s18, s49, 1
    s_sub_u32 s79, s87, s86
    s_bfm_b32 s85, s79, s86
    s_lshl_b32 s86, s86, 12
    s_lshl_b32 s87, s87, 12
    s_min_u32 s87, s87, 16384

    s_add_u32 s78, s78, s76
    s_add_u32 s79, s78, 0
    s_bitcmp1_b32 s85, 0
    s_cselect_b32 s79, s79, 0x1ff00000
    s_lshl_b32 s56, s79, 2
    s_lshl_b32 s61, s79, 1

    s_add_u32 s79, s78, 4096
    s_bitcmp1_b32 s85, 1
    s_cselect_b32 s79, s79, 0x1ff00000
    s_lshl_b32 s57, s79, 2
    s_lshl_b32 s62, s79, 1

    s_add_u32 s79, s78, 8192
    s_bitcmp1_b32 s85, 2
    s_cselect_b32 s79, s79, 0x1ff00000
    s_lshl_b32 s58, s79, 2
    s_lshl_b32 s63, s79, 1

    s_add_u32 s79, s78, 12288
    s_bitcmp1_b32 s85, 3
    s_cselect_b32 s79, s79, 0x1ff00000
    s_lshl_b32 s59, s79, 2
    s_lshl_b32 s64, s79, 1

    s_cmp_eq_u32 s49, 0
    s_cmovk_i32 s85, 0
    s_bitcmp0_b32 s28, 0
    s_cbranch_scc1 L_skw_30
    ds_read_b64 v[110:111], v2 offset:24592
    ds_read_b64 v[112:113], v2 offset:24600
    ds_read_b64 v[114:115], v2 offset:24584

    ds_read_b64 v[118:119], v2 offset:32784
    ds_read_b64 v[120:121], v2 offset:32792
    ds_read_b64 v[122:123], v2 offset:32776

    s_waitcnt lgkmcnt(3)
    v_lshrrev_b32 v116, 16, v111
    ds_read_b32 v116, v116 offset:16384

    s_waitcnt lgkmcnt(1)
    v_lshrrev_b32 v124, 16, v119
    ds_read_b32 v124, v124 offset:16384

    v_cmp_ne_u32_sdwa s[80:81], v111, v113 src0_sel:WORD_1 src1_sel:WORD_1
    v_cmp_ne_u32_sdwa vcc, v111, v115 src0_sel:WORD_1 src1_sel:WORD_1
    v_alignbyte_b32 v114, v111, v114, 1
    s_mov_b32 s54, -3
    v_perm_b32 v112, v112, v113, s45
    s_waitcnt lgkmcnt(1)
    v_add3_u32 v116, v116, v106, s54
    v_sub_u32 v117, 0, v116
    v_and_b32 v117, 3, v117
    s_mov_b64 exec, s[80:81]
    v_mov_b32 v117, 0
    v_mov_b32 v112, 0
    s_mov_b64 exec, vcc
    v_mov_b32 v117, 3

    s_mov_b64 exec, -1
    v_alignbyte_b32 v111, v112, v110, v117
    v_alignbyte_b32 v110, v110, v114, v117
    v_add_u32 v116, v116, v117

    buffer_store_dwordx2 v[110:111], v116, s[24:27], 0 offen
    v_cmp_ne_u32_sdwa s[80:81], v119, v121 src0_sel:WORD_1 src1_sel:WORD_1
    v_cmp_ne_u32_sdwa vcc, v119, v123 src0_sel:WORD_1 src1_sel:WORD_1
    v_alignbyte_b32 v122, v119, v122, 1
    s_mov_b32 s54, 5117
    v_perm_b32 v120, v120, v121, s45
    s_waitcnt lgkmcnt(0)
    v_add3_u32 v124, v124, v106, s54
    v_sub_u32 v125, 0, v124
    v_and_b32 v125, 3, v125
    s_mov_b64 exec, s[80:81]
    v_mov_b32 v125, 0
    v_mov_b32 v120, 0
    s_mov_b64 exec, vcc
    v_mov_b32 v125, 3

    s_mov_b64 exec, -1
    v_alignbyte_b32 v119, v120, v118, v125
    v_alignbyte_b32 v118, v118, v122, v125
    v_add_u32 v124, v124, v125

    buffer_store_dwordx2 v[118:119], v124, s[24:27], 0 offen
L_skw_30:
    s_bitcmp0_b32 s28, 0
    s_cbranch_scc1 L_skw_31
    ds_read_b64 v[110:111], v2 offset:40976
    ds_read_b64 v[112:113], v2 offset:40984
    ds_read_b64 v[114:115], v2 offset:40968

    ds_read_b64 v[118:119], v2 offset:49168
    ds_read_b64 v[120:121], v2 offset:49176
    ds_read_b64 v[122:123], v2 offset:49160

    s_waitcnt lgkmcnt(3)
    v_lshrrev_b32 v116, 16, v111
    ds_read_b32 v116, v116 offset:16384

    s_waitcnt lgkmcnt(1)
    v_lshrrev_b32 v124, 16, v119
    ds_read_b32 v124, v124 offset:16384

    v_cmp_ne_u32_sdwa s[80:81], v111, v113 src0_sel:WORD_1 src1_sel:WORD_1
    v_cmp_ne_u32_sdwa vcc, v111, v115 src0_sel:WORD_1 src1_sel:WORD_1
    v_alignbyte_b32 v114, v111, v114, 1
    s_mov_b32 s54, 10237
    v_perm_b32 v112, v112, v113, s45
    s_waitcnt lgkmcnt(1)
    v_add3_u32 v116, v116, v106, s54
    v_sub_u32 v117, 0, v116
    v_and_b32 v117, 3, v117
    s_mov_b64 exec, s[80:81]
    v_mov_b32 v117, 0
    v_mov_b32 v112, 0
    s_mov_b64 exec, vcc
    v_mov_b32 v117, 3

    s_mov_b64 exec, -1
    v_alignbyte_b32 v111, v112, v110, v117
    v_alignbyte_b32 v110, v110, v114, v117
    v_add_u32 v116, v116, v117

    buffer_store_dwordx2 v[110:111], v116, s[24:27], 0 offen
    v_cmp_ne_u32_sdwa s[80:81], v119, v121 src0_sel:WORD_1 src1_sel:WORD_1
    v_cmp_ne_u32_sdwa vcc, v119, v123 src0_sel:WORD_1 src1_sel:WORD_1
    v_alignbyte_b32 v122, v119, v122, 1
    s_mov_b32 s54, 15357
    v_perm_b32 v120, v120, v121, s45
    s_waitcnt lgkmcnt(0)
    v_add3_u32 v124, v124, v106, s54
    v_sub_u32 v125, 0, v124
    v_and_b32 v125, 3, v125
    s_mov_b64 exec, s[80:81]
    v_mov_b32 v125, 0
    v_mov_b32 v120, 0
    s_mov_b64 exec, vcc
    v_mov_b32 v125, 3

    s_mov_b64 exec, -1
    v_alignbyte_b32 v119, v120, v118, v125
    v_alignbyte_b32 v118, v118, v122, v125
    v_add_u32 v124, v124, v125

    buffer_store_dwordx2 v[118:119], v124, s[24:27], 0 offen
L_skw_31:
    s_bitcmp0_b32 s28, 1
    s_cbranch_scc1 L_skw_32
    v_add_u32 v107, 32768, v2
    ds_read_b64 v[110:111], v107 offset:24592
    ds_read_b64 v[112:113], v107 offset:24600
    ds_read_b64 v[114:115], v107 offset:24584

    ds_read_b64 v[118:119], v107 offset:32784
    ds_read_b64 v[120:121], v107 offset:32792
    ds_read_b64 v[122:123], v107 offset:32776

    s_waitcnt lgkmcnt(3)
    v_lshrrev_b32 v116, 16, v111
    ds_read_b32 v116, v116 offset:16384

    s_waitcnt lgkmcnt(1)
    v_lshrrev_b32 v124, 16, v119
    ds_read_b32 v124, v124 offset:16384

    v_cmp_ne_u32_sdwa s[80:81], v111, v113 src0_sel:WORD_1 src1_sel:WORD_1
    v_cmp_ne_u32_sdwa vcc, v111, v115 src0_sel:WORD_1 src1_sel:WORD_1
    v_alignbyte_b32 v114, v111, v114, 1
    s_mov_b32 s54, 20477
    v_perm_b32 v112, v112, v113, s45
    s_waitcnt lgkmcnt(1)
    v_add3_u32 v116, v116, v106, s54
    v_sub_u32 v117, 0, v116
    v_and_b32 v117, 3, v117
    s_mov_b64 exec, s[80:81]
    v_mov_b32 v117, 0
    v_mov_b32 v112, 0
    s_mov_b64 exec, vcc
    v_mov_b32 v117, 3

    s_mov_b64 exec, -1
    v_alignbyte_b32 v111, v112, v110, v117
    v_alignbyte_b32 v110, v110, v114, v117
    v_add_u32 v116, v116, v117

    buffer_store_dwordx2 v[110:111], v116, s[24:27], 0 offen
    v_cmp_ne_u32_sdwa s[80:81], v119, v121 src0_sel:WORD_1 src1_sel:WORD_1
    v_cmp_ne_u32_sdwa vcc, v119, v123 src0_sel:WORD_1 src1_sel:WORD_1
    v_alignbyte_b32 v122, v119, v122, 1
    s_mov_b32 s54, 25597
    v_perm_b32 v120, v120, v121, s45
    s_waitcnt lgkmcnt(0)
    v_add3_u32 v124, v124, v106, s54
    v_sub_u32 v125, 0, v124
    v_and_b32 v125, 3, v125
    s_mov_b64 exec, s[80:81]
    v_mov_b32 v125, 0
    v_mov_b32 v120, 0
    s_mov_b64 exec, vcc
    v_mov_b32 v125, 3

    s_mov_b64 exec, -1
    v_alignbyte_b32 v119, v120, v118, v125
    v_alignbyte_b32 v118, v118, v122, v125
    v_add_u32 v124, v124, v125

    buffer_store_dwordx2 v[118:119], v124, s[24:27], 0 offen
L_skw_32:
    s_bitcmp0_b32 s28, 1
    s_cbranch_scc1 L_skw_33
    v_add_u32 v107, 32768, v2
    ds_read_b64 v[110:111], v107 offset:40976
    ds_read_b64 v[112:113], v107 offset:40984
    ds_read_b64 v[114:115], v107 offset:40968

    ds_read_b64 v[118:119], v107 offset:49168
    ds_read_b64 v[120:121], v107 offset:49176
    ds_read_b64 v[122:123], v107 offset:49160

    s_waitcnt lgkmcnt(3)
    v_lshrrev_b32 v116, 16, v111
    ds_read_b32 v116, v116 offset:16384

    s_waitcnt lgkmcnt(1)
    v_lshrrev_b32 v124, 16, v119
    ds_read_b32 v124, v124 offset:16384

    v_cmp_ne_u32_sdwa s[80:81], v111, v113 src0_sel:WORD_1 src1_sel:WORD_1
    v_cmp_ne_u32_sdwa vcc, v111, v115 src0_sel:WORD_1 src1_sel:WORD_1
    v_alignbyte_b32 v114, v111, v114, 1
    s_mov_b32 s54, 30717
    v_perm_b32 v112, v112, v113, s45
    s_waitcnt lgkmcnt(1)
    v_add3_u32 v116, v116, v106, s54
    v_sub_u32 v117, 0, v116
    v_and_b32 v117, 3, v117
    s_mov_b64 exec, s[80:81]
    v_mov_b32 v117, 0
    v_mov_b32 v112, 0
    s_mov_b64 exec, vcc
    v_mov_b32 v117, 3

    s_mov_b64 exec, -1
    v_alignbyte_b32 v111, v112, v110, v117
    v_alignbyte_b32 v110, v110, v114, v117
    v_add_u32 v116, v116, v117

    buffer_store_dwordx2 v[110:111], v116, s[24:27], 0 offen
    v_cmp_ne_u32_sdwa s[80:81], v119, v121 src0_sel:WORD_1 src1_sel:WORD_1
    v_cmp_ne_u32_sdwa vcc, v119, v123 src0_sel:WORD_1 src1_sel:WORD_1
    v_alignbyte_b32 v122, v119, v122, 1
    s_mov_b32 s54, 35837
    v_perm_b32 v120, v120, v121, s45
    s_waitcnt lgkmcnt(0)
    v_add3_u32 v124, v124, v106, s54
    v_sub_u32 v125, 0, v124
    v_and_b32 v125, 3, v125
    s_mov_b64 exec, s[80:81]
    v_mov_b32 v125, 0
    v_mov_b32 v120, 0
    s_mov_b64 exec, vcc
    v_mov_b32 v125, 3

    s_mov_b64 exec, -1
    v_alignbyte_b32 v119, v120, v118, v125
    v_alignbyte_b32 v118, v118, v122, v125
    v_add_u32 v124, v124, v125

    buffer_store_dwordx2 v[118:119], v124, s[24:27], 0 offen
L_skw_33:
    s_bitcmp0_b32 s82, 3
    s_cbranch_scc1 L_ska_34
    s_mov_b64 exec, s[66:67]
    v_mul_hi_u32_u24 v69, s40, v32
    v_mul_hi_u32_u24 v68, s40, v16
    v_mul_hi_u32_u24 v71, s40, v33
    v_mul_hi_u32_u24 v70, s40, v17
    v_mul_hi_u32_u24 v73, s40, v34
    v_mul_hi_u32_u24 v72, s40, v18
    v_mul_hi_u32_u24 v75, s40, v35
    v_mul_hi_u32_u24 v74, s40, v19
    v_and_b32 v69, -2, v69
    v_mad_u32_u24 v16, v68, s43, v16
    v_and_b32 v88, -4, v68
    v_and_b32 v71, -2, v71
    v_mad_u32_u24 v17, v70, s43, v17
    v_and_b32 v89, -4, v70
    v_and_b32 v73, -2, v73
    v_mad_u32_u24 v18, v72, s43, v18
    v_and_b32 v90, -4, v72
    v_and_b32 v75, -2, v75
    v_mad_u32_u24 v19, v74, s43, v19
    v_and_b32 v91, -4, v74
    v_mad_i32_i24 v32, v69, s42, v32
    v_lshl_add_u32 v69, v69, 6, v88
    v_mad_i32_i24 v33, v71, s42, v33
    v_lshl_add_u32 v71, v71, 6, v89
    v_mad_i32_i24 v34, v73, s42, v34
    v_lshl_add_u32 v73, v73, 6, v90
    v_mad_i32_i24 v35, v75, s42, v35
    v_lshl_add_u32 v75, v75, 6, v91
    ds_add_rtn_u32 v88, v69, v104
    ds_add_rtn_u32 v89, v71, v104
    ds_add_rtn_u32 v90, v73, v104
    ds_add_rtn_u32 v91, v75, v104
    v_lshlrev_b32 v110, 16, v42
    v_and_b32 v111, 0xffff0000, v42
    v_lshlrev_b32 v112, 16, v43
    v_and_b32 v113, 0xffff0000, v43
    v_mul_f32 v110, s44, v110
    v_mul_f32 v111, s44, v111
    v_mul_f32 v112, s44, v112
    v_mul_f32 v113, s44, v113
    v_max3_f32 v101, |v110|, |v111|, v101
    v_max3_f32 v101, |v112|, |v113|, v101
    v_cos_f32 v110, v110
    v_cos_f32 v111, v111
    v_cos_f32 v112, v112
    v_cos_f32 v113, v113
    v_lshl_or_b32 v68, v68, 14, v32
    v_perm_b32 v69, v69, v16, s46
    v_bfe_u32 v16, v16, 8, 5

    v_lshl_or_b32 v70, v70, 14, v33
    v_perm_b32 v71, v71, v17, s46
    v_bfe_u32 v17, v17, 8, 5

    v_lshl_or_b32 v72, v72, 14, v34
    v_perm_b32 v73, v73, v18, s46
    v_bfe_u32 v18, v18, 8, 5

    v_lshl_or_b32 v74, v74, 14, v35
    v_perm_b32 v75, v75, v19, s46
    v_bfe_u32 v19, v19, 8, 5

    v_fmaak_f32 v110, v110, v105, 0x4b400010
    v_fmaak_f32 v111, v111, v105, 0x4b400010
    v_fmaak_f32 v112, v112, v105, 0x4b400010
    v_fmaak_f32 v113, v113, v105, 0x4b400010
    v_sub_u32 v110, v110, v16
    v_sub_u32 v111, v111, v17
    v_sub_u32 v112, v112, v18
    v_sub_u32 v113, v113, v19
    v_bfi_b32 v110, 31, v16, v110
    v_bfi_b32 v111, 31, v17, v111
    v_bfi_b32 v112, 31, v18, v112
    v_bfi_b32 v113, 31, v19, v113
    v_perm_b32 v68, v68, v110, s55
    v_perm_b32 v70, v70, v111, s55
    v_perm_b32 v72, v72, v112, s55
    v_perm_b32 v74, v74, v113, s55
    s_mov_b64 exec, -1
L_ska_34:
    s_bitcmp0_b32 s28, 2
    s_cbranch_scc1 L_skw_35
    v_add_u32 v107, 65536, v2
    ds_read_b64 v[110:111], v107 offset:24592
    ds_read_b64 v[112:113], v107 offset:24600
    ds_read_b64 v[114:115], v107 offset:24584

    ds_read_b64 v[118:119], v107 offset:32784
    ds_read_b64 v[120:121], v107 offset:32792
    ds_read_b64 v[122:123], v107 offset:32776

    s_waitcnt lgkmcnt(3)
    v_lshrrev_b32 v116, 16, v111
    ds_read_b32 v116, v116 offset:16384

    s_waitcnt lgkmcnt(1)
    v_lshrrev_b32 v124, 16, v119
    ds_read_b32 v124, v124 offset:16384

    v_cmp_ne_u32_sdwa s[80:81], v111, v113 src0_sel:WORD_1 src1_sel:WORD_1
    v_cmp_ne_u32_sdwa vcc, v111, v115 src0_sel:WORD_1 src1_sel:WORD_1
    v_alignbyte_b32 v114, v111, v114, 1
    s_mov_b32 s54, 40957
    v_perm_b32 v112, v112, v113, s45
    s_waitcnt lgkmcnt(1)
    v_add3_u32 v116, v116, v106, s54
    v_sub_u32 v117, 0, v116
    v_and_b32 v117, 3, v117
    s_mov_b64 exec, s[80:81]
    v_mov_b32 v117, 0
    v_mov_b32 v112, 0
    s_mov_b64 exec, vcc
    v_mov_b32 v117, 3

    s_mov_b64 exec, -1
    v_alignbyte_b32 v111, v112, v110, v117
    v_alignbyte_b32 v110, v110, v114, v117
    v_add_u32 v116, v116, v117

    buffer_store_dwordx2 v[110:111], v116, s[24:27], 0 offen
    v_cmp_ne_u32_sdwa s[80:81], v119, v121 src0_sel:WORD_1 src1_sel:WORD_1
    v_cmp_ne_u32_sdwa vcc, v119, v123 src0_sel:WORD_1 src1_sel:WORD_1
    v_alignbyte_b32 v122, v119, v122, 1
    s_mov_b32 s54, 46077
    v_perm_b32 v120, v120, v121, s45
    s_waitcnt lgkmcnt(0)
    v_add3_u32 v124, v124, v106, s54
    v_sub_u32 v125, 0, v124
    v_and_b32 v125, 3, v125
    s_mov_b64 exec, s[80:81]
    v_mov_b32 v125, 0
    v_mov_b32 v120, 0
    s_mov_b64 exec, vcc
    v_mov_b32 v125, 3

    s_mov_b64 exec, -1
    v_alignbyte_b32 v119, v120, v118, v125
    v_alignbyte_b32 v118, v118, v122, v125
    v_add_u32 v124, v124, v125

    buffer_store_dwordx2 v[118:119], v124, s[24:27], 0 offen
L_skw_35:
    s_bitcmp0_b32 s28, 2
    s_cbranch_scc1 L_skw_36
    v_add_u32 v107, 65536, v2
    ds_read_b64 v[110:111], v107 offset:40976
    ds_read_b64 v[112:113], v107 offset:40984
    ds_read_b64 v[114:115], v107 offset:40968

    ds_read_b64 v[118:119], v107 offset:49168
    ds_read_b64 v[120:121], v107 offset:49176
    ds_read_b64 v[122:123], v107 offset:49160

    s_waitcnt lgkmcnt(3)
    v_lshrrev_b32 v116, 16, v111
    ds_read_b32 v116, v116 offset:16384

    s_waitcnt lgkmcnt(1)
    v_lshrrev_b32 v124, 16, v119
    ds_read_b32 v124, v124 offset:16384

    v_cmp_ne_u32_sdwa s[80:81], v111, v113 src0_sel:WORD_1 src1_sel:WORD_1
    v_cmp_ne_u32_sdwa vcc, v111, v115 src0_sel:WORD_1 src1_sel:WORD_1
    v_alignbyte_b32 v114, v111, v114, 1
    s_mov_b32 s54, 51197
    v_perm_b32 v112, v112, v113, s45
    s_waitcnt lgkmcnt(1)
    v_add3_u32 v116, v116, v106, s54
    v_sub_u32 v117, 0, v116
    v_and_b32 v117, 3, v117
    s_mov_b64 exec, s[80:81]
    v_mov_b32 v117, 0
    v_mov_b32 v112, 0
    s_mov_b64 exec, vcc
    v_mov_b32 v117, 3

    s_mov_b64 exec, -1
    v_alignbyte_b32 v111, v112, v110, v117
    v_alignbyte_b32 v110, v110, v114, v117
    v_add_u32 v116, v116, v117

    buffer_store_dwordx2 v[110:111], v116, s[24:27], 0 offen
    v_cmp_ne_u32_sdwa s[80:81], v119, v121 src0_sel:WORD_1 src1_sel:WORD_1
    v_cmp_ne_u32_sdwa vcc, v119, v123 src0_sel:WORD_1 src1_sel:WORD_1
    v_alignbyte_b32 v122, v119, v122, 1
    s_mov_b32 s54, 56317
    v_perm_b32 v120, v120, v121, s45
    s_waitcnt lgkmcnt(0)
    v_add3_u32 v124, v124, v106, s54
    v_sub_u32 v125, 0, v124
    v_and_b32 v125, 3, v125
    s_mov_b64 exec, s[80:81]
    v_mov_b32 v125, 0
    v_mov_b32 v120, 0
    s_mov_b64 exec, vcc
    v_mov_b32 v125, 3

    s_mov_b64 exec, -1
    v_alignbyte_b32 v119, v120, v118, v125
    v_alignbyte_b32 v118, v118, v122, v125
    v_add_u32 v124, v124, v125

    buffer_store_dwordx2 v[118:119], v124, s[24:27], 0 offen
L_skw_36:
    s_bitcmp0_b32 s28, 3
    s_cbranch_scc1 L_skw_37
    v_add_u32 v107, 98304, v2
    ds_read_b64 v[110:111], v107 offset:24592
    ds_read_b64 v[112:113], v107 offset:24600
    ds_read_b64 v[114:115], v107 offset:24584

    ds_read_b64 v[118:119], v107 offset:32784
    ds_read_b64 v[120:121], v107 offset:32792
    ds_read_b64 v[122:123], v107 offset:32776

    s_waitcnt lgkmcnt(3)
    v_lshrrev_b32 v116, 16, v111
    ds_read_b32 v116, v116 offset:16384

    s_waitcnt lgkmcnt(1)
    v_lshrrev_b32 v124, 16, v119
    ds_read_b32 v124, v124 offset:16384

    v_cmp_ne_u32_sdwa s[80:81], v111, v113 src0_sel:WORD_1 src1_sel:WORD_1
    v_cmp_ne_u32_sdwa vcc, v111, v115 src0_sel:WORD_1 src1_sel:WORD_1
    v_alignbyte_b32 v114, v111, v114, 1
    s_mov_b32 s54, 61437
    v_perm_b32 v112, v112, v113, s45
    s_waitcnt lgkmcnt(1)
    v_add3_u32 v116, v116, v106, s54
    v_sub_u32 v117, 0, v116
    v_and_b32 v117, 3, v117
    s_mov_b64 exec, s[80:81]
    v_mov_b32 v117, 0
    v_mov_b32 v112, 0
    s_mov_b64 exec, vcc
    v_mov_b32 v117, 3

    s_mov_b64 exec, -1
    v_alignbyte_b32 v111, v112, v110, v117
    v_alignbyte_b32 v110, v110, v114, v117
    v_add_u32 v116, v116, v117

    buffer_store_dwordx2 v[110:111], v116, s[24:27], 0 offen
    v_cmp_ne_u32_sdwa s[80:81], v119, v121 src0_sel:WORD_1 src1_sel:WORD_1
    v_cmp_ne_u32_sdwa vcc, v119, v123 src0_sel:WORD_1 src1_sel:WORD_1
    v_alignbyte_b32 v122, v119, v122, 1
    s_mov_b32 s54, 66557
    v_perm_b32 v120, v120, v121, s45
    s_waitcnt lgkmcnt(0)
    v_add3_u32 v124, v124, v106, s54
    v_sub_u32 v125, 0, v124
    v_and_b32 v125, 3, v125
    s_mov_b64 exec, s[80:81]
    v_mov_b32 v125, 0
    v_mov_b32 v120, 0
    s_mov_b64 exec, vcc
    v_mov_b32 v125, 3

    s_mov_b64 exec, -1
    v_alignbyte_b32 v119, v120, v118, v125
    v_alignbyte_b32 v118, v118, v122, v125
    v_add_u32 v124, v124, v125

    buffer_store_dwordx2 v[118:119], v124, s[24:27], 0 offen
L_skw_37:
    s_bitcmp0_b32 s28, 3
    s_cbranch_scc1 L_skw_38
    v_add_u32 v107, 98304, v2
    ds_read_b64 v[110:111], v107 offset:40976
    ds_read_b64 v[112:113], v107 offset:40984
    ds_read_b64 v[114:115], v107 offset:40968

    ds_read_b64 v[118:119], v107 offset:49168
    ds_read_b64 v[120:121], v107 offset:49176
    ds_read_b64 v[122:123], v107 offset:49160

    s_waitcnt lgkmcnt(3)
    v_lshrrev_b32 v116, 16, v111
    ds_read_b32 v116, v116 offset:16384

    s_waitcnt lgkmcnt(1)
    v_lshrrev_b32 v124, 16, v119
    ds_read_b32 v124, v124 offset:16384

    v_cmp_ne_u32_sdwa s[80:81], v111, v113 src0_sel:WORD_1 src1_sel:WORD_1
    v_cmp_ne_u32_sdwa vcc, v111, v115 src0_sel:WORD_1 src1_sel:WORD_1
    v_alignbyte_b32 v114, v111, v114, 1
    s_mov_b32 s54, 71677
    v_perm_b32 v112, v112, v113, s45
    s_waitcnt lgkmcnt(1)
    v_add3_u32 v116, v116, v106, s54
    v_sub_u32 v117, 0, v116
    v_and_b32 v117, 3, v117
    s_mov_b64 exec, s[80:81]
    v_mov_b32 v117, 0
    v_mov_b32 v112, 0
    s_mov_b64 exec, vcc
    v_mov_b32 v117, 3

    s_mov_b64 exec, -1
    v_alignbyte_b32 v111, v112, v110, v117
    v_alignbyte_b32 v110, v110, v114, v117
    v_add_u32 v116, v116, v117

    buffer_store_dwordx2 v[110:111], v116, s[24:27], 0 offen
    v_cmp_ne_u32_sdwa s[80:81], v119, v121 src0_sel:WORD_1 src1_sel:WORD_1
    v_cmp_ne_u32_sdwa vcc, v119, v123 src0_sel:WORD_1 src1_sel:WORD_1
    v_alignbyte_b32 v122, v119, v122, 1
    s_mov_b32 s54, 76797
    v_perm_b32 v120, v120, v121, s45
    s_waitcnt lgkmcnt(0)
    v_add3_u32 v124, v124, v106, s54
    v_sub_u32 v125, 0, v124
    v_and_b32 v125, 3, v125
    s_mov_b64 exec, s[80:81]
    v_mov_b32 v125, 0
    v_mov_b32 v120, 0
    s_mov_b64 exec, vcc
    v_mov_b32 v125, 3

    s_mov_b64 exec, -1
    v_alignbyte_b32 v119, v120, v118, v125
    v_alignbyte_b32 v118, v118, v122, v125
    v_add_u32 v124, v124, v125

    buffer_store_dwordx2 v[118:119], v124, s[24:27], 0 offen
L_skw_38:
    s_waitcnt lgkmcnt(0)
    s_barrier

    s_bitcmp0_b32 s85, 0
    s_cbranch_scc1 L_skl_39
    buffer_load_dwordx4 v[20:23], v1, s[12:15], s56 offen nt
    buffer_load_dwordx4 v[4:7], v1, s[8:11], s56 offen nt
    buffer_load_dwordx2 v[36:37], v2, s[16:19], s61 offen nt
L_skl_39:
    s_bitcmp0_b32 s85, 1
    s_cbranch_scc1 L_skl_40
    buffer_load_dwordx4 v[24:27], v1, s[12:15], s57 offen nt
    buffer_load_dwordx4 v[8:11], v1, s[8:11], s57 offen nt
    buffer_load_dwordx2 v[38:39], v2, s[16:19], s62 offen nt
L_skl_40:
    ds_read_b64 v[94:95], v2
    s_waitcnt lgkmcnt(0)
    v_add_u32 v97, v94, v95
    s_nop 1
    v_add_u32_dpp v97, v97, v97 row_shr:1 row_mask:0xf bank_mask:0xf
    s_nop 1
    v_add_u32_dpp v97, v97, v97 row_shr:2 row_mask:0xf bank_mask:0xf
    s_nop 1
    v_add_u32_dpp v97, v97, v97 row_shr:4 row_mask:0xf bank_mask:0xf
    s_nop 1
    v_add_u32_dpp v97, v97, v97 row_shr:8 row_mask:0xf bank_mask:0xf
    s_nop 1
    v_add_u32_dpp v97, v97, v97 row_bcast:15 row_mask:0xa bank_mask:0xf
    s_nop 1
    v_add_u32_dpp v97, v97, v97 row_bcast:31 row_mask:0xc bank_mask:0xf
    s_mov_b32 exec_lo, 0
    s_brev_b32 exec_hi, 1
    ds_add_rtn_u32 v96, v108, v97
    s_mov_b64 exec, -1

    v_add_u32 v92, v94, v94
    v_add_u32 v93, v95, v95
    v_med3_u32 v92, v94, 2, v92
    v_med3_u32 v93, v95, 2, v93
    v_lshl_or_b32 v92, v93, 16, v92
    v_lshlrev_b32 v93, 2, v0
    buffer_atomic_add v92, v93, s[20:23], 0 offen sc0
    s_waitcnt lgkmcnt(0)
    v_readlane_b32 s77, v96, 63
    v_sub_u32 v97, v97, v95
    s_sub_u32 s50, s50, s83
    s_sub_u32 s77, s77, s50
    v_add_u32 v97, s77, v97
    v_sub_u32 v96, v97, v94
    v_lshlrev_b32 v111, 3, v97
    v_lshlrev_b32 v110, 3, v96
    v_mov_b32 v112, 0
    v_mov_b32 v113, 0
    ds_write_b64 v2, v[110:111] offset:8192
    ds_write_b64 v2, v[112:113]
    v_mad_i32_i24 v96, v96, -5, v102
    v_mad_i32_i24 v97, v97, -5, v103
    s_add_u32 s50, s50, s84
    s_mov_b32 s28, s82
    s_mov_b32 s29, s83
    s_mov_b32 s30, s84
    s_lshl_b32 s74, s29, 3
    s_lshl_b32 s75, s30, 3
    v_mov_b32 v125, s74
    v_mov_b32 v126, s75
    v_mov_b32 v127, -1

    s_waitcnt lgkmcnt(0)
    s_barrier

    s_mov_b64 exec, 1
    ds_write_b32 v125, v127 offset:24588
    ds_write_b32 v126, v127 offset:24596
    s_mov_b64 exec, -1

    s_bitcmp0_b32 s28, 0
    s_cbranch_scc1 L_skz_41
    v_lshrrev_b32 v110, 16, v45
    ds_read_b32 v110, v110 offset:8192
    v_lshrrev_b32 v111, 16, v47
    ds_read_b32 v111, v111 offset:8192
    v_lshrrev_b32 v112, 16, v49
    ds_read_b32 v112, v112 offset:8192
    v_lshrrev_b32 v113, 16, v51
    ds_read_b32 v113, v113 offset:8192
    v_lshrrev_b32 v114, 16, v53
    ds_read_b32 v114, v114 offset:8192
    v_lshrrev_b32 v115, 16, v55
    ds_read_b32 v115, v115 offset:8192
    v_lshrrev_b32 v116, 16, v57
    ds_read_b32 v116, v116 offset:8192
    v_lshrrev_b32 v117, 16, v59
    ds_read_b32 v117, v117 offset:8192
    s_waitcnt lgkmcnt(7)
    v_lshl_add_u32 v110, v76, 3, v110
    ds_write_b64 v110, v[44:45] offset:24592

    s_waitcnt lgkmcnt(7)
    v_lshl_add_u32 v111, v77, 3, v111
    ds_write_b64 v111, v[46:47] offset:24592

    s_waitcnt lgkmcnt(7)
    v_lshl_add_u32 v112, v78, 3, v112
    ds_write_b64 v112, v[48:49] offset:24592

    s_waitcnt lgkmcnt(7)
    v_lshl_add_u32 v113, v79, 3, v113
    ds_write_b64 v113, v[50:51] offset:24592

    s_waitcnt lgkmcnt(7)
    v_lshl_add_u32 v114, v80, 3, v114
    ds_write_b64 v114, v[52:53] offset:24592

    s_waitcnt lgkmcnt(7)
    v_lshl_add_u32 v115, v81, 3, v115
    ds_write_b64 v115, v[54:55] offset:24592

    s_waitcnt lgkmcnt(7)
    v_lshl_add_u32 v116, v82, 3, v116
    ds_write_b64 v116, v[56:57] offset:24592

    s_waitcnt lgkmcnt(7)
    v_lshl_add_u32 v117, v83, 3, v117
    ds_write_b64 v117, v[58:59] offset:24592

L_skz_41:
    s_bitcmp0_b32 s85, 2
    s_cbranch_scc1 L_skl_42
    buffer_load_dwordx4 v[28:31], v1, s[12:15], s58 offen nt
    buffer_load_dwordx4 v[12:15], v1, s[8:11], s58 offen nt
    buffer_load_dwordx2 v[40:41], v2, s[16:19], s63 offen nt
L_skl_42:
    s_bitcmp0_b32 s28, 2
    s_cbranch_scc1 L_skz_43
    v_lshrrev_b32 v110, 16, v61
    ds_read_b32 v110, v110 offset:8192
    v_lshrrev_b32 v111, 16, v63
    ds_read_b32 v111, v111 offset:8192
    v_lshrrev_b32 v112, 16, v65
    ds_read_b32 v112, v112 offset:8192
    v_lshrrev_b32 v113, 16, v67
    ds_read_b32 v113, v113 offset:8192
    s_waitcnt lgkmcnt(3)
    v_lshl_add_u32 v110, v84, 3, v110
    ds_write_b64 v110, v[60:61] offset:24592

    s_waitcnt lgkmcnt(3)
    v_lshl_add_u32 v111, v85, 3, v111
    ds_write_b64 v111, v[62:63] offset:24592

    s_waitcnt lgkmcnt(3)
    v_lshl_add_u32 v112, v86, 3, v112
    ds_write_b64 v112, v[64:65] offset:24592

    s_waitcnt lgkmcnt(3)
    v_lshl_add_u32 v113, v87, 3, v113
    ds_write_b64 v113, v[66:67] offset:24592

L_skz_43:
    s_bitcmp0_b32 s28, 3
    s_cbranch_scc1 L_skz_44
    s_mov_b64 exec, s[66:67]
    v_lshrrev_b32 v110, 16, v69
    ds_read_b32 v110, v110 offset:8192
    v_lshrrev_b32 v111, 16, v71
    ds_read_b32 v111, v111 offset:8192
    v_lshrrev_b32 v112, 16, v73
    ds_read_b32 v112, v112 offset:8192
    v_lshrrev_b32 v113, 16, v75
    ds_read_b32 v113, v113 offset:8192
    s_waitcnt lgkmcnt(3)
    v_lshl_add_u32 v110, v88, 3, v110
    ds_write_b64 v110, v[68:69] offset:24592

    s_waitcnt lgkmcnt(3)
    v_lshl_add_u32 v111, v89, 3, v111
    ds_write_b64 v111, v[70:71] offset:24592

    s_waitcnt lgkmcnt(3)
    v_lshl_add_u32 v112, v90, 3, v112
    ds_write_b64 v112, v[72:73] offset:24592

    s_waitcnt lgkmcnt(3)
    v_lshl_add_u32 v113, v91, 3, v113
    ds_write_b64 v113, v[74:75] offset:24592

    s_mov_b64 exec, -1
L_skz_44:
    s_bitcmp0_b32 s85, 3
    s_cbranch_scc1 L_skl_45
    buffer_load_dwordx4 v[32:35], v1, s[12:15], s59 offen nt
    buffer_load_dwordx4 v[16:19], v1, s[8:11], s59 offen nt
    buffer_load_dwordx2 v[42:43], v2, s[16:19], s64 offen nt
L_skl_45:
    s_cmp_lg_u32 s49, 0
    s_cbranch_scc1 L_p1loop_6
L_p1epi_7:
    s_waitcnt vmcnt(0)
    s_waitcnt vmcnt(4)
    v_lshrrev_b32 v93, 16, v92
    v_and_b32 v92, 0xffff, v92
    v_add_u32 v110, v92, v94
    v_mad_u32_u24 v92, v92, 5, v96
    v_add_u32 v111, v93, v95
    v_mad_u32_u24 v93, v93, 5, v97
    v_max_u32 v110, v110, v111
    v_cmp_le_u32 vcc, s48, v110
    s_cbranch_vccnz L_full_46
L_fback_47:
    ds_write_b64 v2, v[92:93] offset:16384

    s_waitcnt lgkmcnt(0)
    s_barrier

    v_cmp_lt_f32 vcc, 0x437f0000, v101
    v_mov_b32 v110, 0
    s_cbranch_vccz L_okr_48
    s_mov_b64 exec, 1
    buffer_atomic_or v104, v110, s[36:39], 0 offen
    s_mov_b64 exec, -1
L_okr_48:

    s_bitcmp0_b32 s28, 0
    s_cbranch_scc1 L_skw_49
    ds_read_b64 v[4:5], v2 offset:24592
    ds_read_b64 v[6:7], v2 offset:24600
    ds_read_b64 v[8:9], v2 offset:24584

    ds_read_b64 v[12:13], v2 offset:32784
    ds_read_b64 v[14:15], v2 offset:32792
    ds_read_b64 v[16:17], v2 offset:32776

    ds_read_b64 v[20:21], v2 offset:40976
    ds_read_b64 v[22:23], v2 offset:40984
    ds_read_b64 v[24:25], v2 offset:40968

    ds_read_b64 v[28:29], v2 offset:49168
    ds_read_b64 v[30:31], v2 offset:49176
    ds_read_b64 v[32:33], v2 offset:49160

    s_waitcnt lgkmcnt(9)
    v_lshrrev_b32 v10, 16, v5
    ds_read_b32 v10, v10 offset:16384

    s_waitcnt lgkmcnt(7)
    v_lshrrev_b32 v18, 16, v13
    ds_read_b32 v18, v18 offset:16384

    s_waitcnt lgkmcnt(5)
    v_lshrrev_b32 v26, 16, v21
    ds_read_b32 v26, v26 offset:16384

    s_waitcnt lgkmcnt(3)
    v_lshrrev_b32 v34, 16, v29
    ds_read_b32 v34, v34 offset:16384

    v_cmp_ne_u32_sdwa s[80:81], v5, v7 src0_sel:WORD_1 src1_sel:WORD_1
    v_cmp_ne_u32_sdwa vcc, v5, v9 src0_sel:WORD_1 src1_sel:WORD_1
    v_alignbyte_b32 v8, v5, v8, 1
    s_mov_b32 s54, -3
    v_perm_b32 v6, v6, v7, s45
    s_waitcnt lgkmcnt(3)
    v_add3_u32 v10, v10, v106, s54
    v_sub_u32 v11, 0, v10
    v_and_b32 v11, 3, v11
    s_mov_b64 exec, s[80:81]
    v_mov_b32 v11, 0
    v_mov_b32 v6, 0
    s_mov_b64 exec, vcc
    v_mov_b32 v11, 3

    s_mov_b64 exec, -1
    v_alignbyte_b32 v5, v6, v4, v11
    v_alignbyte_b32 v4, v4, v8, v11
    v_add_u32 v10, v10, v11

    buffer_store_dwordx2 v[4:5], v10, s[24:27], 0 offen
    v_cmp_ne_u32_sdwa s[80:81], v13, v15 src0_sel:WORD_1 src1_sel:WORD_1
    v_cmp_ne_u32_sdwa vcc, v13, v17 src0_sel:WORD_1 src1_sel:WORD_1
    v_alignbyte_b32 v16, v13, v16, 1
    s_mov_b32 s54, 5117
    v_perm_b32 v14, v14, v15, s45
    s_waitcnt lgkmcnt(2)
    v_add3_u32 v18, v18, v106, s54
    v_sub_u32 v19, 0, v18
    v_and_b32 v19, 3, v19
    s_mov_b64 exec, s[80:81]
    v_mov_b32 v19, 0
    v_mov_b32 v14, 0
    s_mov_b64 exec, vcc
    v_mov_b32 v19, 3

    s_mov_b64 exec, -1
    v_alignbyte_b32 v13, v14, v12, v19
    v_alignbyte_b32 v12, v12, v16, v19
    v_add_u32 v18, v18, v19

    buffer_store_dwordx2 v[12:13], v18, s[24:27], 0 offen
    v_cmp_ne_u32_sdwa s[80:81], v21, v23 src0_sel:WORD_1 src1_sel:WORD_1
    v_cmp_ne_u32_sdwa vcc, v21, v25 src0_sel:WORD_1 src1_sel:WORD_1
    v_alignbyte_b32 v24, v21, v24, 1
    s_mov_b32 s54, 10237
    v_perm_b32 v22, v22, v23, s45
    s_waitcnt lgkmcnt(1)
    v_add3_u32 v26, v26, v106, s54
    v_sub_u32 v27, 0, v26
    v_and_b32 v27, 3, v27
    s_mov_b64 exec, s[80:81]
    v_mov_b32 v27, 0
    v_mov_b32 v22, 0
    s_mov_b64 exec, vcc
    v_mov_b32 v27, 3

    s_mov_b64 exec, -1
    v_alignbyte_b32 v21, v22, v20, v27
    v_alignbyte_b32 v20, v20, v24, v27
    v_add_u32 v26, v26, v27

    buffer_store_dwordx2 v[20:21], v26, s[24:27], 0 offen
    v_cmp_ne_u32_sdwa s[80:81], v29, v31 src0_sel:WORD_1 src1_sel:WORD_1
    v_cmp_ne_u32_sdwa vcc, v29, v33 src0_sel:WORD_1 src1_sel:WORD_1
    v_alignbyte_b32 v32, v29, v32, 1
    s_mov_b32 s54, 15357
    v_perm_b32 v30, v30, v31, s45
    s_waitcnt lgkmcnt(0)
    v_add3_u32 v34, v34, v106, s54
    v_sub_u32 v35, 0, v34
    v_and_b32 v35, 3, v35
    s_mov_b64 exec, s[80:81]
    v_mov_b32 v35, 0
    v_mov_b32 v30, 0
    s_mov_b64 exec, vcc
    v_mov_b32 v35, 3

    s_mov_b64 exec, -1
    v_alignbyte_b32 v29, v30, v28, v35
    v_alignbyte_b32 v28, v28, v32, v35
    v_add_u32 v34, v34, v35

    buffer_store_dwordx2 v[28:29], v34, s[24:27], 0 offen
L_skw_49:
    s_bitcmp0_b32 s28, 1
    s_cbranch_scc1 L_skw_50
    v_add_u32 v107, 32768, v2
    ds_read_b64 v[4:5], v107 offset:24592
    ds_read_b64 v[6:7], v107 offset:24600
    ds_read_b64 v[8:9], v107 offset:24584

    ds_read_b64 v[12:13], v107 offset:32784
    ds_read_b64 v[14:15], v107 offset:32792
    ds_read_b64 v[16:17], v107 offset:32776

    ds_read_b64 v[20:21], v107 offset:40976
    ds_read_b64 v[22:23], v107 offset:40984
    ds_read_b64 v[24:25], v107 offset:40968

    ds_read_b64 v[28:29], v107 offset:49168
    ds_read_b64 v[30:31], v107 offset:49176
    ds_read_b64 v[32:33], v107 offset:49160

    s_waitcnt lgkmcnt(9)
    v_lshrrev_b32 v10, 16, v5
    ds_read_b32 v10, v10 offset:16384

    s_waitcnt lgkmcnt(7)
    v_lshrrev_b32 v18, 16, v13
    ds_read_b32 v18, v18 offset:16384

    s_waitcnt lgkmcnt(5)
    v_lshrrev_b32 v26, 16, v21
    ds_read_b32 v26, v26 offset:16384

    s_waitcnt lgkmcnt(3)
    v_lshrrev_b32 v34, 16, v29
    ds_read_b32 v34, v34 offset:16384

    v_cmp_ne_u32_sdwa s[80:81], v5, v7 src0_sel:WORD_1 src1_sel:WORD_1
    v_cmp_ne_u32_sdwa vcc, v5, v9 src0_sel:WORD_1 src1_sel:WORD_1
    v_alignbyte_b32 v8, v5, v8, 1
    s_mov_b32 s54, 20477
    v_perm_b32 v6, v6, v7, s45
    s_waitcnt lgkmcnt(3)
    v_add3_u32 v10, v10, v106, s54
    v_sub_u32 v11, 0, v10
    v_and_b32 v11, 3, v11
    s_mov_b64 exec, s[80:81]
    v_mov_b32 v11, 0
    v_mov_b32 v6, 0
    s_mov_b64 exec, vcc
    v_mov_b32 v11, 3

    s_mov_b64 exec, -1
    v_alignbyte_b32 v5, v6, v4, v11
    v_alignbyte_b32 v4, v4, v8, v11
    v_add_u32 v10, v10, v11

    buffer_store_dwordx2 v[4:5], v10, s[24:27], 0 offen
    v_cmp_ne_u32_sdwa s[80:81], v13, v15 src0_sel:WORD_1 src1_sel:WORD_1
    v_cmp_ne_u32_sdwa vcc, v13, v17 src0_sel:WORD_1 src1_sel:WORD_1
    v_alignbyte_b32 v16, v13, v16, 1
    s_mov_b32 s54, 25597
    v_perm_b32 v14, v14, v15, s45
    s_waitcnt lgkmcnt(2)
    v_add3_u32 v18, v18, v106, s54
    v_sub_u32 v19, 0, v18
    v_and_b32 v19, 3, v19
    s_mov_b64 exec, s[80:81]
    v_mov_b32 v19, 0
    v_mov_b32 v14, 0
    s_mov_b64 exec, vcc
    v_mov_b32 v19, 3

    s_mov_b64 exec, -1
    v_alignbyte_b32 v13, v14, v12, v19
    v_alignbyte_b32 v12, v12, v16, v19
    v_add_u32 v18, v18, v19

    buffer_store_dwordx2 v[12:13], v18, s[24:27], 0 offen
    v_cmp_ne_u32_sdwa s[80:81], v21, v23 src0_sel:WORD_1 src1_sel:WORD_1
    v_cmp_ne_u32_sdwa vcc, v21, v25 src0_sel:WORD_1 src1_sel:WORD_1
    v_alignbyte_b32 v24, v21, v24, 1
    s_mov_b32 s54, 30717
    v_perm_b32 v22, v22, v23, s45
    s_waitcnt lgkmcnt(1)
    v_add3_u32 v26, v26, v106, s54
    v_sub_u32 v27, 0, v26
    v_and_b32 v27, 3, v27
    s_mov_b64 exec, s[80:81]
    v_mov_b32 v27, 0
    v_mov_b32 v22, 0
    s_mov_b64 exec, vcc
    v_mov_b32 v27, 3

    s_mov_b64 exec, -1
    v_alignbyte_b32 v21, v22, v20, v27
    v_alignbyte_b32 v20, v20, v24, v27
    v_add_u32 v26, v26, v27

    buffer_store_dwordx2 v[20:21], v26, s[24:27], 0 offen
    v_cmp_ne_u32_sdwa s[80:81], v29, v31 src0_sel:WORD_1 src1_sel:WORD_1
    v_cmp_ne_u32_sdwa vcc, v29, v33 src0_sel:WORD_1 src1_sel:WORD_1
    v_alignbyte_b32 v32, v29, v32, 1
    s_mov_b32 s54, 35837
    v_perm_b32 v30, v30, v31, s45
    s_waitcnt lgkmcnt(0)
    v_add3_u32 v34, v34, v106, s54
    v_sub_u32 v35, 0, v34
    v_and_b32 v35, 3, v35
    s_mov_b64 exec, s[80:81]
    v_mov_b32 v35, 0
    v_mov_b32 v30, 0
    s_mov_b64 exec, vcc
    v_mov_b32 v35, 3

    s_mov_b64 exec, -1
    v_alignbyte_b32 v29, v30, v28, v35
    v_alignbyte_b32 v28, v28, v32, v35
    v_add_u32 v34, v34, v35

    buffer_store_dwordx2 v[28:29], v34, s[24:27], 0 offen
L_skw_50:
    s_bitcmp0_b32 s28, 2
    s_cbranch_scc1 L_skw_51
    v_add_u32 v107, 65536, v2
    ds_read_b64 v[4:5], v107 offset:24592
    ds_read_b64 v[6:7], v107 offset:24600
    ds_read_b64 v[8:9], v107 offset:24584

    ds_read_b64 v[12:13], v107 offset:32784
    ds_read_b64 v[14:15], v107 offset:32792
    ds_read_b64 v[16:17], v107 offset:32776

    ds_read_b64 v[20:21], v107 offset:40976
    ds_read_b64 v[22:23], v107 offset:40984
    ds_read_b64 v[24:25], v107 offset:40968

    ds_read_b64 v[28:29], v107 offset:49168
    ds_read_b64 v[30:31], v107 offset:49176
    ds_read_b64 v[32:33], v107 offset:49160

    s_waitcnt lgkmcnt(9)
    v_lshrrev_b32 v10, 16, v5
    ds_read_b32 v10, v10 offset:16384

    s_waitcnt lgkmcnt(7)
    v_lshrrev_b32 v18, 16, v13
    ds_read_b32 v18, v18 offset:16384

    s_waitcnt lgkmcnt(5)
    v_lshrrev_b32 v26, 16, v21
    ds_read_b32 v26, v26 offset:16384

    s_waitcnt lgkmcnt(3)
    v_lshrrev_b32 v34, 16, v29
    ds_read_b32 v34, v34 offset:16384

    v_cmp_ne_u32_sdwa s[80:81], v5, v7 src0_sel:WORD_1 src1_sel:WORD_1
    v_cmp_ne_u32_sdwa vcc, v5, v9 src0_sel:WORD_1 src1_sel:WORD_1
    v_alignbyte_b32 v8, v5, v8, 1
    s_mov_b32 s54, 40957
    v_perm_b32 v6, v6, v7, s45
    s_waitcnt lgkmcnt(3)
    v_add3_u32 v10, v10, v106, s54
    v_sub_u32 v11, 0, v10
    v_and_b32 v11, 3, v11
    s_mov_b64 exec, s[80:81]
    v_mov_b32 v11, 0
    v_mov_b32 v6, 0
    s_mov_b64 exec, vcc
    v_mov_b32 v11, 3

    s_mov_b64 exec, -1
    v_alignbyte_b32 v5, v6, v4, v11
    v_alignbyte_b32 v4, v4, v8, v11
    v_add_u32 v10, v10, v11

    buffer_store_dwordx2 v[4:5], v10, s[24:27], 0 offen
    v_cmp_ne_u32_sdwa s[80:81], v13, v15 src0_sel:WORD_1 src1_sel:WORD_1
    v_cmp_ne_u32_sdwa vcc, v13, v17 src0_sel:WORD_1 src1_sel:WORD_1
    v_alignbyte_b32 v16, v13, v16, 1
    s_mov_b32 s54, 46077
    v_perm_b32 v14, v14, v15, s45
    s_waitcnt lgkmcnt(2)
    v_add3_u32 v18, v18, v106, s54
    v_sub_u32 v19, 0, v18
    v_and_b32 v19, 3, v19
    s_mov_b64 exec, s[80:81]
    v_mov_b32 v19, 0
    v_mov_b32 v14, 0
    s_mov_b64 exec, vcc
    v_mov_b32 v19, 3

    s_mov_b64 exec, -1
    v_alignbyte_b32 v13, v14, v12, v19
    v_alignbyte_b32 v12, v12, v16, v19
    v_add_u32 v18, v18, v19

    buffer_store_dwordx2 v[12:13], v18, s[24:27], 0 offen
    v_cmp_ne_u32_sdwa s[80:81], v21, v23 src0_sel:WORD_1 src1_sel:WORD_1
    v_cmp_ne_u32_sdwa vcc, v21, v25 src0_sel:WORD_1 src1_sel:WORD_1
    v_alignbyte_b32 v24, v21, v24, 1
    s_mov_b32 s54, 51197
    v_perm_b32 v22, v22, v23, s45
    s_waitcnt lgkmcnt(1)
    v_add3_u32 v26, v26, v106, s54
    v_sub_u32 v27, 0, v26
    v_and_b32 v27, 3, v27
    s_mov_b64 exec, s[80:81]
    v_mov_b32 v27, 0
    v_mov_b32 v22, 0
    s_mov_b64 exec, vcc
    v_mov_b32 v27, 3

    s_mov_b64 exec, -1
    v_alignbyte_b32 v21, v22, v20, v27
    v_alignbyte_b32 v20, v20, v24, v27
    v_add_u32 v26, v26, v27

    buffer_store_dwordx2 v[20:21], v26, s[24:27], 0 offen
    v_cmp_ne_u32_sdwa s[80:81], v29, v31 src0_sel:WORD_1 src1_sel:WORD_1
    v_cmp_ne_u32_sdwa vcc, v29, v33 src0_sel:WORD_1 src1_sel:WORD_1
    v_alignbyte_b32 v32, v29, v32, 1
    s_mov_b32 s54, 56317
    v_perm_b32 v30, v30, v31, s45
    s_waitcnt lgkmcnt(0)
    v_add3_u32 v34, v34, v106, s54
    v_sub_u32 v35, 0, v34
    v_and_b32 v35, 3, v35
    s_mov_b64 exec, s[80:81]
    v_mov_b32 v35, 0
    v_mov_b32 v30, 0
    s_mov_b64 exec, vcc
    v_mov_b32 v35, 3

    s_mov_b64 exec, -1
    v_alignbyte_b32 v29, v30, v28, v35
    v_alignbyte_b32 v28, v28, v32, v35
    v_add_u32 v34, v34, v35

    buffer_store_dwordx2 v[28:29], v34, s[24:27], 0 offen
L_skw_51:
    s_bitcmp0_b32 s28, 3
    s_cbranch_scc1 L_skw_52
    v_add_u32 v107, 98304, v2
    ds_read_b64 v[4:5], v107 offset:24592
    ds_read_b64 v[6:7], v107 offset:24600
    ds_read_b64 v[8:9], v107 offset:24584

    ds_read_b64 v[12:13], v107 offset:32784
    ds_read_b64 v[14:15], v107 offset:32792
    ds_read_b64 v[16:17], v107 offset:32776

    ds_read_b64 v[20:21], v107 offset:40976
    ds_read_b64 v[22:23], v107 offset:40984
    ds_read_b64 v[24:25], v107 offset:40968

    ds_read_b64 v[28:29], v107 offset:49168
    ds_read_b64 v[30:31], v107 offset:49176
    ds_read_b64 v[32:33], v107 offset:49160

    s_waitcnt lgkmcnt(9)
    v_lshrrev_b32 v10, 16, v5
    ds_read_b32 v10, v10 offset:16384

    s_waitcnt lgkmcnt(7)
    v_lshrrev_b32 v18, 16, v13
    ds_read_b32 v18, v18 offset:16384

    s_waitcnt lgkmcnt(5)
    v_lshrrev_b32 v26, 16, v21
    ds_read_b32 v26, v26 offset:16384

    s_waitcnt lgkmcnt(3)
    v_lshrrev_b32 v34, 16, v29
    ds_read_b32 v34, v34 offset:16384

    v_cmp_ne_u32_sdwa s[80:81], v5, v7 src0_sel:WORD_1 src1_sel:WORD_1
    v_cmp_ne_u32_sdwa vcc, v5, v9 src0_sel:WORD_1 src1_sel:WORD_1
    v_alignbyte_b32 v8, v5, v8, 1
    s_mov_b32 s54, 61437
    v_perm_b32 v6, v6, v7, s45
    s_waitcnt lgkmcnt(3)
    v_add3_u32 v10, v10, v106, s54
    v_sub_u32 v11, 0, v10
    v_and_b32 v11, 3, v11
    s_mov_b64 exec, s[80:81]
    v_mov_b32 v11, 0
    v_mov_b32 v6, 0
    s_mov_b64 exec, vcc
    v_mov_b32 v11, 3

    s_mov_b64 exec, -1
    v_alignbyte_b32 v5, v6, v4, v11
    v_alignbyte_b32 v4, v4, v8, v11
    v_add_u32 v10, v10, v11

    buffer_store_dwordx2 v[4:5], v10, s[24:27], 0 offen
    v_cmp_ne_u32_sdwa s[80:81], v13, v15 src0_sel:WORD_1 src1_sel:WORD_1
    v_cmp_ne_u32_sdwa vcc, v13, v17 src0_sel:WORD_1 src1_sel:WORD_1
    v_alignbyte_b32 v16, v13, v16, 1
    s_mov_b32 s54, 66557
    v_perm_b32 v14, v14, v15, s45
    s_waitcnt lgkmcnt(2)
    v_add3_u32 v18, v18, v106, s54
    v_sub_u32 v19, 0, v18
    v_and_b32 v19, 3, v19
    s_mov_b64 exec, s[80:81]
    v_mov_b32 v19, 0
    v_mov_b32 v14, 0
    s_mov_b64 exec, vcc
    v_mov_b32 v19, 3

    s_mov_b64 exec, -1
    v_alignbyte_b32 v13, v14, v12, v19
    v_alignbyte_b32 v12, v12, v16, v19
    v_add_u32 v18, v18, v19

    buffer_store_dwordx2 v[12:13], v18, s[24:27], 0 offen
    v_cmp_ne_u32_sdwa s[80:81], v21, v23 src0_sel:WORD_1 src1_sel:WORD_1
    v_cmp_ne_u32_sdwa vcc, v21, v25 src0_sel:WORD_1 src1_sel:WORD_1
    v_alignbyte_b32 v24, v21, v24, 1
    s_mov_b32 s54, 71677
    v_perm_b32 v22, v22, v23, s45
    s_waitcnt lgkmcnt(1)
    v_add3_u32 v26, v26, v106, s54
    v_sub_u32 v27, 0, v26
    v_and_b32 v27, 3, v27
    s_mov_b64 exec, s[80:81]
    v_mov_b32 v27, 0
    v_mov_b32 v22, 0
    s_mov_b64 exec, vcc
    v_mov_b32 v27, 3

    s_mov_b64 exec, -1
    v_alignbyte_b32 v21, v22, v20, v27
    v_alignbyte_b32 v20, v20, v24, v27
    v_add_u32 v26, v26, v27

    buffer_store_dwordx2 v[20:21], v26, s[24:27], 0 offen
    v_cmp_ne_u32_sdwa s[80:81], v29, v31 src0_sel:WORD_1 src1_sel:WORD_1
    v_cmp_ne_u32_sdwa vcc, v29, v33 src0_sel:WORD_1 src1_sel:WORD_1
    v_alignbyte_b32 v32, v29, v32, 1
    s_mov_b32 s54, 76797
    v_perm_b32 v30, v30, v31, s45
    s_waitcnt lgkmcnt(0)
    v_add3_u32 v34, v34, v106, s54
    v_sub_u32 v35, 0, v34
    v_and_b32 v35, 3, v35
    s_mov_b64 exec, s[80:81]
    v_mov_b32 v35, 0
    v_mov_b32 v30, 0
    s_mov_b64 exec, vcc
    v_mov_b32 v35, 3

    s_mov_b64 exec, -1
    v_alignbyte_b32 v29, v30, v28, v35
    v_alignbyte_b32 v28, v28, v32, v35
    v_add_u32 v34, v34, v35

    buffer_store_dwordx2 v[28:29], v34, s[24:27], 0 offen
L_skw_52:
L_p1done_1:
    s_endpgm

L_ska_8:
    v_bfrev_b32 v126, 1
    buffer_load_dword v3, v126, s[96:99], 0 offen
    buffer_load_dword v3, v126, s[96:99], 0 offen
    buffer_load_dword v3, v126, s[96:99], 0 offen
    s_branch L_bka_9
L_ska_10:
    v_bfrev_b32 v126, 1
    buffer_load_dword v3, v126, s[96:99], 0 offen
    buffer_load_dword v3, v126, s[96:99], 0 offen
    buffer_load_dword v3, v126, s[96:99], 0 offen
    s_branch L_bka_11
L_ska_12:
    v_bfrev_b32 v126, 1
    buffer_load_dword v3, v126, s[96:99], 0 offen
    buffer_load_dword v3, v126, s[96:99], 0 offen
    buffer_load_dword v3, v126, s[96:99], 0 offen
    s_branch L_bka_13
L_ska_14:
    v_bfrev_b32 v126, 1
    buffer_load_dword v3, v126, s[96:99], 0 offen
    buffer_load_dword v3, v126, s[96:99], 0 offen
    buffer_load_dword v3, v126, s[96:99], 0 offen
    s_branch L_bka_15
L_full_28:
    v_mov_b32 v110, 0
    s_mov_b64 exec, vcc
    v_bfrev_b32 v92, 1
    v_bfrev_b32 v93, 1
    s_mov_b64 exec, 1
    buffer_atomic_or v104, v110, s[36:39], 0 offen
    s_mov_b64 exec, -1
    s_branch L_fback_29

L_full_46:
    v_mov_b32 v110, 0
    s_mov_b64 exec, vcc
    v_bfrev_b32 v92, 1
    v_bfrev_b32 v93, 1
    s_mov_b64 exec, 1
    buffer_atomic_or v104, v110, s[36:39], 0 offen
    s_mov_b64 exec, -1
    s_branch L_fback_47

.globl standalone__molecular_angular_gemnet__graph_kernel
.p2align 8
.type standalone__molecular_angular_gemnet__graph_kernel,@function
standalone__molecular_angular_gemnet__graph_kernel:
    s_cmp_ge_u32 s2, 256
    s_cbranch_scc1 L_p2done_53
    s_load_dwordx2 s[8:9], s[0:1], 0
    s_load_dwordx2 s[6:7], s[0:1], 104
    v_lshrrev_b32 v4, 6, v0
    s_lshr_b32 s37, s2, 1
    s_and_b32 s37, s37, 3
    s_lshr_b32 s36, s2, 3
    s_lshl_b32 s36, s36, 1
    s_and_b32 s3, s2, 1
    s_or_b32 s36, s36, s3
    v_readfirstlane_b32 s4, v4
    v_and_b32 v2, 63, v0
    v_lshrrev_b32 v3, 9, v0
    v_lshl_or_b32 v2, v3, 6, v2
    v_mul_u32_u24 v2, 20, v2
    v_lshlrev_b32 v3, 4, v0

    s_waitcnt lgkmcnt(0)
    s_lshl_b32 m0, s4, 10
    s_mov_b32 s25, s4
    s_and_b32 s5, s4, 7
    s_lshr_b32 s39, s4, 3
    s_lshl_b32 s39, s39, 8
    s_mul_i32 s3, s5, 4096
    s_add_u32 s46, s6, s3
    s_addc_u32 s47, s7, 0
    s_mul_i32 s3, s5, 67117056
    s_add_u32 s3, s3, 85721088
    s_add_u32 s44, s6, s3
    s_addc_u32 s45, s7, 0
    s_mul_i32 s38, s37, 8
    s_add_u32 s4, s38, 8
    s_lshl_b32 s3, s36, 5
    s_add_u32 s3, s3, s38
    s_lshl_b32 s3, s3, 1
    s_load_dwordx4 s[92:95], s[46:47], s3
    s_mov_b32 s3, 32768
    s_load_dword s51, s[6:7], s3
    s_mov_b32 s10, 6400000
    s_mov_b32 s11, 0x20000

    s_add_u32 s12, s6, 2490368
    s_addc_u32 s13, s7, 0
    s_mov_b32 s14, 0
    s_mov_b32 s15, 0x20000
    s_add_u32 s60, s6, 2490368
    s_addc_u32 s61, s7, 0
    s_mov_b32 s62, 6406144
    s_mov_b32 s63, 0x20000
    s_mov_b32 s3, 135176
    s_load_dword s33, s[6:7], s3

    s_mul_i32 s43, s38, 200192
    s_mul_i32 s41, s4, 200192
    s_mul_i32 s50, s38, 200000
    s_add_u32 s14, s43, 50000

    s_add_u32 s52, s43, 49152
    s_cmp_ge_u32 s25, 4
    s_cbranch_scc1 L_sk3_55
    v_lshlrev_b32 v119, 2, v0
    buffer_load_dword v88, v119, s[12:15], s52 offen
L_sk3_55:
    buffer_load_dwordx4 v[76:79], v3, s[12:15], s43 offen
    s_add_u32 s52, s43, 16384
    buffer_load_dwordx4 v[80:83], v3, s[12:15], s52 offen
    s_add_u32 s52, s43, 32768
    buffer_load_dwordx4 v[84:87], v3, s[12:15], s52 offen
    s_add_u32 s20, s6, 135168
    s_addc_u32 s21, s7, 0
    s_mov_b32 s22, 4096
    s_mov_b32 s23, 0x20000
    v_and_b32 v44, 63, v0
    v_lshlrev_b32 v44, 4, v44
    buffer_load_dwordx2 v[120:121], v44, s[20:23], 0 offen offset:0
    buffer_load_dwordx2 v[122:123], v44, s[20:23], 0 offen offset:1024
    buffer_load_dwordx2 v[124:125], v44, s[20:23], 0 offen offset:2048
    buffer_load_dwordx2 v[126:127], v44, s[20:23], 0 offen offset:3072
    s_movk_i32 s40, 3072
    s_mov_b32 s19, 0x20000
    s_min_u32 s40, s40, 6524
    s_lshl_b32 s52, s38, 6
    s_add_u32 s52, s52, s36
    s_mul_i32 s52, s52, 32764
    s_and_b32 s52, s52, 0xffffff80
    s_add_u32 s16, s44, s52
    s_addc_u32 s17, s45, 0
    s_mul_i32 s52, s40, 5
    s_add_u32 s52, s52, 3
    s_and_b32 s18, s52, -4

    s_movk_i32 s53, 5120
    buffer_load_dwordx4 v[90:93], v2, s[16:19], s53 offen offset:4
    buffer_load_dword v110, v2, s[16:19], s53 offen
    s_movk_i32 s53, 7680
    buffer_load_dwordx4 v[94:97], v2, s[16:19], s53 offen offset:4
    buffer_load_dword v111, v2, s[16:19], s53 offen
    s_movk_i32 s53, 10240
    buffer_load_dwordx4 v[98:101], v2, s[16:19], s53 offen offset:4
    buffer_load_dword v112, v2, s[16:19], s53 offen
    s_lshr_b32 s3, s2, 3
    s_mul_i32 s3, s3, 49
    v_add_lshl_u32 v89, v0, s3, 7
    v_cmp_gt_u32 vcc, 49, v0
    v_bfrev_b32 v28, 1
    s_nop 0
    v_cndmask_b32 v89, v28, v89, vcc

    s_mov_b32 s19, 0x20000
    s_mov_b32 s28, 0x4b404000
    s_mov_b32 s29, 0x4b404000
    s_mov_b32 s30, 0xbfffc000
    s_mov_b32 s31, 0xbfffbfff
    s_mov_b32 s32, 0xffff0000
    s_mov_b32 s35, 0x05040100
    s_mov_b32 s97, 0x07060302
    s_mov_b32 s96, 0x40008000
    s_movk_i32 s3, 212
    v_cmp_gt_u32 s[48:49], s3, v0

    v_mov_b32 v1, 0
    s_mov_b32 s24, 0x0c0c0004
    v_mov_b32 v28, 0x40004000
    v_mov_b32 v29, 0x40004000
    v_mov_b32 v30, 0x40004000
    v_mov_b32 v31, 0x40004000
    v_add_u32 v32, 50000, v3
    v_add_u32 v33, 65536, v32

    ds_write_b128 v32, v[28:31] offset:0
    ds_write_b128 v32, v[28:31] offset:16384
    ds_write_b128 v32, v[28:31] offset:32768
    ds_write_b128 v32, v[28:31] offset:49152
    ds_write_b128 v33, v[28:31] offset:0
    ds_write_b128 v33, v[28:31] offset:16384
    v_cmp_gt_u32 vcc, 971, v0
    s_mov_b64 exec, vcc
    ds_write_b128 v33, v[28:31] offset:32768
    s_mov_b64 exec, -1
    s_waitcnt vmcnt(12)
    ds_write_addtid_b32 v76 offset:0
    ds_write_addtid_b32 v77 offset:256
    ds_write_addtid_b32 v78 offset:512
    ds_write_addtid_b32 v79 offset:768
    s_waitcnt vmcnt(11)
    ds_write_addtid_b32 v80 offset:16384
    ds_write_addtid_b32 v81 offset:16640
    ds_write_addtid_b32 v82 offset:16896
    ds_write_addtid_b32 v83 offset:17152
    s_waitcnt vmcnt(10)
    ds_write_addtid_b32 v84 offset:32768
    ds_write_addtid_b32 v85 offset:33024
    ds_write_addtid_b32 v86 offset:33280
    ds_write_addtid_b32 v87 offset:33536
    v_lshlrev_b32 v119, 2, v0
    s_waitcnt vmcnt(13)
    s_mov_b64 exec, s[48:49]
    ds_write_b32 v119, v88 offset:49152
    s_mov_b64 exec, -1
    s_add_u32 s43, s43, 50048
    s_add_u32 s14, s43, 50000
    s_min_u32 s14, s14, s41
    s_waitcnt lgkmcnt(0)
    s_and_b32 s88, s92, 0xffff
    s_lshr_b32 s89, s92, 16
    s_and_b32 s90, s93, 0xffff
    s_lshr_b32 s91, s93, 16
    s_and_b32 s92, s94, 0xffff
    s_lshr_b32 s93, s94, 16
    s_and_b32 s94, s95, 0xffff
    s_lshr_b32 s95, s95, 16
    s_waitcnt vmcnt(6)
    v_max3_u32 v120, v120, v122, v124
    v_add_f32 v121, v121, v123
    v_add_f32 v125, v125, v127
    v_max_u32 v120, v120, v126
    v_add_f32 v121, v121, v125

    s_nop 1
    v_max_u32_dpp v120, v120, v120 row_shr:1 row_mask:0xf bank_mask:0xf
    s_nop 1
    v_max_u32_dpp v120, v120, v120 row_shr:2 row_mask:0xf bank_mask:0xf
    s_nop 1
    v_max_u32_dpp v120, v120, v120 row_shr:4 row_mask:0xf bank_mask:0xf
    s_nop 1
    v_max_u32_dpp v120, v120, v120 row_shr:8 row_mask:0xf bank_mask:0xf
    s_nop 1
    v_max_u32_dpp v120, v120, v120 row_bcast:15 row_mask:0xa bank_mask:0xf
    s_nop 1
    v_max_u32_dpp v120, v120, v120 row_bcast:31 row_mask:0xc bank_mask:0xf
    s_nop 1
    v_add_f32_dpp v121, v121, v121 row_shr:1 row_mask:0xf bank_mask:0xf
    s_nop 1
    v_add_f32_dpp v121, v121, v121 row_shr:2 row_mask:0xf bank_mask:0xf
    s_nop 1
    v_add_f32_dpp v121, v121, v121 row_shr:4 row_mask:0xf bank_mask:0xf
    s_nop 1
    v_add_f32_dpp v121, v121, v121 row_shr:8 row_mask:0xf bank_mask:0xf
    s_nop 1
    v_add_f32_dpp v121, v121, v121 row_bcast:15 row_mask:0xa bank_mask:0xf
    s_nop 1
    v_add_f32_dpp v121, v121, v121 row_bcast:31 row_mask:0xc bank_mask:0xf
    v_lshlrev_b32 v120, 16, v120
    v_mul_f32 v121, 0x34a7c5ac, v121
    v_sqrt_f32 v121, v121
    v_mul_f32 v120, s33, v120
    v_mul_f32 v121, s33, v121
    v_cmp_gt_f32 vcc, 0x46fde800, v120
    s_mov_b64 s[64:65], vcc
    v_cmp_lt_f32 vcc, 0x44000000, v121
    v_mov_b32 v120, 0x37800000
    v_mul_f32 v120, s33, v120
    s_and_b64 vcc, vcc, s[64:65]
    v_mul_f32 v121, 0x46ff8000, v120
    v_rcp_f32 v121, v121
    v_readfirstlane_b32 s33, v120
    s_waitcnt lgkmcnt(0)
    s_barrier
    v_readfirstlane_b32 s34, v121
    v_mov_b32 v120, 150016
    v_mov_b32 v121, 0
    ds_write_b32 v120, v121 offset:8
    s_bitcmp0_b64 vcc, 63
    s_cbranch_scc1 L_p2slow_54
    s_cmp_lg_u32 s51, 0
    s_cbranch_scc1 L_p2slow_54

    s_min_u32 s88, s88, 6524
    s_lshl_b32 s52, s38, 6
    s_add_u32 s52, s52, s36
    s_mul_i32 s52, s52, 32764
    s_and_b32 s52, s52, 0xffffff80
    s_add_u32 s16, s44, s52
    s_addc_u32 s17, s45, 0
    s_mul_i32 s52, s88, 5
    s_add_u32 s52, s52, 3
    s_and_b32 s18, s52, -4

    s_movk_i32 s53, 12800
    buffer_load_dwordx4 v[102:105], v2, s[16:19], s53 offen offset:4
    buffer_load_dword v113, v2, s[16:19], s53 offen
    s_movk_i32 s53, 0
    buffer_load_dwordx4 v[4:7], v2, s[16:19], s53 offen offset:4 nt
    buffer_load_dword v35, v2, s[16:19], s53 offen nt
    s_movk_i32 s53, 2560
    buffer_load_dwordx4 v[8:11], v2, s[16:19], s53 offen offset:4
    buffer_load_dword v43, v2, s[16:19], s53 offen
    s_sub_u32 s53, s88, s39
    s_cmp_le_i32 s53, 3072
    s_cbranch_scc1 L_skt_62
    s_movk_i32 s53, 15360
    buffer_load_dwordx4 v[106:109], v2, s[16:19], s53 offen offset:4
    buffer_load_dword v114, v2, s[16:19], s53 offen
L_skt_62:
    s_mov_b32 s40, s88
    s_sub_u32 s42, s40, s39

    s_add_u32 s55, s38, 1
    s_min_u32 s55, s55, 31
    s_mov_b32 s88, s89
    s_mov_b32 s89, s90
    s_mov_b32 s90, s91
    s_mov_b32 s91, s92
    s_mov_b32 s92, s93
    s_mov_b32 s93, s94
    s_mov_b32 s94, s95
    s_mov_b32 s95, 0
    s_min_u32 s88, s88, 6524
    s_lshl_b32 s52, s55, 6
    s_add_u32 s52, s52, s36
    s_mul_i32 s52, s52, 32764
    s_and_b32 s52, s52, 0xffffff80
    s_add_u32 s16, s44, s52
    s_addc_u32 s17, s45, 0
    s_mul_i32 s52, s88, 5
    s_add_u32 s52, s52, 3
    s_and_b32 s18, s52, -4

    s_waitcnt vmcnt(10)
    v_lshlrev_b32_sdwa v44, 3, v110 dst_sel:WORD_0 dst_unused:UNUSED_PAD src0_sel:DWORD src1_sel:DWORD
    v_lshrrev_b32 v46, 5, v90
    v_lshlrev_b32_sdwa v48, 3, v91 dst_sel:WORD_0 dst_unused:UNUSED_PAD src0_sel:DWORD src1_sel:WORD_1
    v_alignbit_b32 v50, v93, v92, 21

    v_mov_b32 v15, v93
    v_alignbyte_b32 v14, v92, v91, 3
    v_alignbyte_b32 v13, v91, v90, 2
    v_alignbyte_b32 v12, v90, v110, 1
    v_and_b32 v46, 0xfff8, v46
    v_and_b32 v50, 0xfff8, v50
    s_cmp_lt_i32 s42, 1280
    s_cbranch_scc1 L_ufix_63
L_uback_64:

    v_subrev_co_u32 v12, s[80:81], 2.0, v12
    v_subrev_co_u32 v13, s[82:83], 2.0, v13
    v_subrev_co_u32 v14, s[84:85], 2.0, v14
    v_subrev_co_u32 v15, s[86:87], 2.0, v15
    s_mov_b64 exec, s[80:81]
    ds_read_b64 v[44:45], v44
    s_mov_b64 exec, s[82:83]
    ds_read_b64 v[46:47], v46
    s_mov_b64 exec, s[84:85]
    ds_read_b64 v[48:49], v48
    s_mov_b64 exec, s[86:87]
    ds_read_b64 v[50:51], v50
    s_mov_b64 exec, -1
    s_waitcnt vmcnt(8)
    v_lshlrev_b32_sdwa v52, 3, v111 dst_sel:WORD_0 dst_unused:UNUSED_PAD src0_sel:DWORD src1_sel:DWORD
    v_lshrrev_b32 v54, 5, v94
    v_lshlrev_b32_sdwa v56, 3, v95 dst_sel:WORD_0 dst_unused:UNUSED_PAD src0_sel:DWORD src1_sel:WORD_1
    v_alignbit_b32 v58, v97, v96, 21

    v_mov_b32 v19, v97
    v_alignbyte_b32 v18, v96, v95, 3
    v_alignbyte_b32 v17, v95, v94, 2
    v_alignbyte_b32 v16, v94, v111, 1
    v_and_b32 v54, 0xfff8, v54
    v_and_b32 v58, 0xfff8, v58
    s_cmp_lt_i32 s42, 1792
    s_cbranch_scc1 L_ufix_65
L_uback_66:

    v_subrev_co_u32 v16, s[64:65], 2.0, v16
    v_subrev_co_u32 v17, s[66:67], 2.0, v17
    v_subrev_co_u32 v18, s[68:69], 2.0, v18
    v_subrev_co_u32 v19, s[70:71], 2.0, v19
    s_mov_b64 exec, s[64:65]
    ds_read_b64 v[52:53], v52
    s_mov_b64 exec, s[66:67]
    ds_read_b64 v[54:55], v54
    s_mov_b64 exec, s[68:69]
    ds_read_b64 v[56:57], v56
    s_mov_b64 exec, s[70:71]
    ds_read_b64 v[58:59], v58
    s_mov_b64 exec, -1
    s_waitcnt vmcnt(6)
    v_lshlrev_b32_sdwa v60, 3, v112 dst_sel:WORD_0 dst_unused:UNUSED_PAD src0_sel:DWORD src1_sel:DWORD
    v_lshrrev_b32 v62, 5, v98
    v_lshlrev_b32_sdwa v64, 3, v99 dst_sel:WORD_0 dst_unused:UNUSED_PAD src0_sel:DWORD src1_sel:WORD_1
    v_alignbit_b32 v66, v101, v100, 21

    v_mov_b32 v23, v101
    v_alignbyte_b32 v22, v100, v99, 3
    v_alignbyte_b32 v21, v99, v98, 2
    v_alignbyte_b32 v20, v98, v112, 1
    v_and_b32 v62, 0xfff8, v62
    v_and_b32 v66, 0xfff8, v66
    s_cmp_lt_i32 s42, 2304
    s_cbranch_scc1 L_ufix_67
L_uback_68:

    v_subrev_co_u32 v20, s[72:73], 2.0, v20
    v_subrev_co_u32 v21, s[74:75], 2.0, v21
    v_subrev_co_u32 v22, s[76:77], 2.0, v22
    v_subrev_co_u32 v23, s[78:79], 2.0, v23
    s_mov_b64 exec, s[72:73]
    ds_read_b64 v[60:61], v60
    s_mov_b64 exec, s[74:75]
    ds_read_b64 v[62:63], v62
    s_mov_b64 exec, s[76:77]
    ds_read_b64 v[64:65], v64
    s_mov_b64 exec, s[78:79]
    ds_read_b64 v[66:67], v66
    s_mov_b64 exec, -1
    s_waitcnt vmcnt(4)
    v_lshlrev_b32_sdwa v68, 3, v113 dst_sel:WORD_0 dst_unused:UNUSED_PAD src0_sel:DWORD src1_sel:DWORD
    v_lshrrev_b32 v70, 5, v102
    v_lshlrev_b32_sdwa v72, 3, v103 dst_sel:WORD_0 dst_unused:UNUSED_PAD src0_sel:DWORD src1_sel:WORD_1
    v_alignbit_b32 v74, v105, v104, 21

    v_mov_b32 v27, v105
    v_alignbyte_b32 v26, v104, v103, 3
    v_alignbyte_b32 v25, v103, v102, 2
    v_alignbyte_b32 v24, v102, v113, 1
    v_and_b32 v70, 0xfff8, v70
    v_and_b32 v74, 0xfff8, v74
    s_cmp_lt_i32 s42, 2816
    s_cbranch_scc1 L_ufix_69
L_uback_70:

    v_subrev_co_u32 v24, s[80:81], 2.0, v24
    v_subrev_co_u32 v25, s[82:83], 2.0, v25
    v_subrev_co_u32 v26, s[84:85], 2.0, v26
    v_subrev_co_u32 v27, s[86:87], 2.0, v27
    s_mov_b64 exec, s[80:81]
    ds_read_b64 v[68:69], v68
    s_mov_b64 exec, s[82:83]
    ds_read_b64 v[70:71], v70
    s_mov_b64 exec, s[84:85]
    ds_read_b64 v[72:73], v72
    s_mov_b64 exec, s[86:87]
    ds_read_b64 v[74:75], v74
    s_mov_b64 exec, -1
    s_waitcnt vmcnt(2)
    v_lshlrev_b32_sdwa v28, 3, v35 dst_sel:WORD_0 dst_unused:UNUSED_PAD src0_sel:DWORD src1_sel:DWORD
    v_lshrrev_b32 v30, 5, v4
    v_lshlrev_b32_sdwa v32, 3, v5 dst_sel:WORD_0 dst_unused:UNUSED_PAD src0_sel:DWORD src1_sel:WORD_1
    v_alignbit_b32 v34, v7, v6, 21

    v_alignbyte_b32 v6, v6, v5, 3
    v_alignbyte_b32 v5, v5, v4, 2
    v_alignbyte_b32 v4, v4, v35, 1
    v_and_b32 v30, 0xfff8, v30
    v_and_b32 v34, 0xfff8, v34
    s_cmp_lt_i32 s42, 256
    s_cbranch_scc1 L_ufix_71
L_uback_72:

    v_subrev_co_u32 v4, s[64:65], 2.0, v4
    v_subrev_co_u32 v5, s[66:67], 2.0, v5
    v_subrev_co_u32 v6, s[68:69], 2.0, v6
    v_subrev_co_u32 v7, s[70:71], 2.0, v7
    s_mov_b64 exec, s[64:65]
    ds_read_b64 v[28:29], v28
    s_mov_b64 exec, s[66:67]
    ds_read_b64 v[30:31], v30
    s_mov_b64 exec, s[68:69]
    ds_read_b64 v[32:33], v32
    s_mov_b64 exec, s[70:71]
    ds_read_b64 v[34:35], v34
    s_mov_b64 exec, -1
    s_add_u32 s52, s43, 49152
    s_cmp_ge_u32 s25, 4
    s_cbranch_scc1 L_sk3_73
    v_lshlrev_b32 v119, 2, v0
    buffer_load_dword v88, v119, s[12:15], s52 offen
L_sk3_73:
    buffer_load_dwordx4 v[76:79], v3, s[12:15], s43 offen
    s_add_u32 s52, s43, 16384
    buffer_load_dwordx4 v[80:83], v3, s[12:15], s52 offen
    s_add_u32 s52, s43, 32768
    buffer_load_dwordx4 v[84:87], v3, s[12:15], s52 offen
    s_cmp_lg_u32 s25, 0
    s_cbranch_scc1 L_skw_74
    s_add_u32 s54, s43, 50048
    buffer_load_dword v115, v89, s[60:63], s54 offen
    s_add_u32 s54, s50, 0
    buffer_load_dword v115, v89, s[8:11], s54 offen
L_skw_74:
    s_waitcnt vmcnt(3)
    v_lshlrev_b32_sdwa v36, 3, v43 dst_sel:WORD_0 dst_unused:UNUSED_PAD src0_sel:DWORD src1_sel:DWORD
    v_lshrrev_b32 v38, 5, v8
    v_lshlrev_b32_sdwa v40, 3, v9 dst_sel:WORD_0 dst_unused:UNUSED_PAD src0_sel:DWORD src1_sel:WORD_1
    v_alignbit_b32 v42, v11, v10, 21

    v_alignbyte_b32 v10, v10, v9, 3
    v_alignbyte_b32 v9, v9, v8, 2
    v_alignbyte_b32 v8, v8, v43, 1
    v_and_b32 v38, 0xfff8, v38
    v_and_b32 v42, 0xfff8, v42
    s_cmp_lt_i32 s42, 768
    s_cbranch_scc1 L_ufix_75
L_uback_76:

    v_subrev_co_u32 v8, s[72:73], 2.0, v8
    v_subrev_co_u32 v9, s[74:75], 2.0, v9
    v_subrev_co_u32 v10, s[76:77], 2.0, v10
    v_subrev_co_u32 v11, s[78:79], 2.0, v11
    s_mov_b64 exec, s[72:73]
    ds_read_b64 v[36:37], v36
    s_mov_b64 exec, s[74:75]
    ds_read_b64 v[38:39], v38
    s_mov_b64 exec, s[76:77]
    ds_read_b64 v[40:41], v40
    s_mov_b64 exec, s[78:79]
    ds_read_b64 v[42:43], v42
    s_mov_b64 exec, -1
    s_movk_i32 s53, 5120
    buffer_load_dwordx4 v[90:93], v2, s[16:19], s53 offen offset:4
    buffer_load_dword v110, v2, s[16:19], s53 offen
L_batch_78:
    s_add_u32 s5, s38, 1

    s_movk_i32 s53, 7680
    buffer_load_dwordx4 v[94:97], v2, s[16:19], s53 offen offset:4
    buffer_load_dword v111, v2, s[16:19], s53 offen
    v_subrev_co_u32 v4, s[64:65], 2.0, v4
    v_subrev_co_u32 v5, s[66:67], 2.0, v5
    v_subrev_co_u32 v6, s[68:69], 2.0, v6
    v_subrev_co_u32 v7, s[70:71], 2.0, v7
    v_subrev_co_u32 v8, s[72:73], 2.0, v8
    v_subrev_co_u32 v9, s[74:75], 2.0, v9
    v_subrev_co_u32 v10, s[76:77], 2.0, v10
    v_subrev_co_u32 v11, s[78:79], 2.0, v11
    v_subrev_co_u32 v12, s[80:81], 2.0, v12
    v_subrev_co_u32 v13, s[82:83], 2.0, v13
    v_subrev_co_u32 v14, s[84:85], 2.0, v14
    v_subrev_co_u32 v15, s[86:87], 2.0, v15
    s_waitcnt lgkmcnt(0)
    s_barrier
    s_waitcnt vmcnt(4)
    ds_write_addtid_b32 v76 offset:0
    ds_write_addtid_b32 v77 offset:256
    ds_write_addtid_b32 v78 offset:512
    ds_write_addtid_b32 v79 offset:768
    s_waitcnt vmcnt(3)
    ds_write_addtid_b32 v80 offset:16384
    ds_write_addtid_b32 v81 offset:16640
    ds_write_addtid_b32 v82 offset:16896
    ds_write_addtid_b32 v83 offset:17152
    s_waitcnt vmcnt(2)
    ds_write_addtid_b32 v84 offset:32768
    ds_write_addtid_b32 v85 offset:33024
    ds_write_addtid_b32 v86 offset:33280
    ds_write_addtid_b32 v87 offset:33536
    v_lshlrev_b32 v119, 2, v0
    s_waitcnt vmcnt(5)
    s_mov_b64 exec, s[48:49]
    ds_write_b32 v119, v88 offset:49152
    s_mov_b64 exec, -1
    s_add_u32 s43, s43, 50048
    s_add_u32 s14, s43, 50000
    s_min_u32 s14, s14, s41
    s_add_u32 s52, s43, 49152
    s_cmp_ge_u32 s25, 4
    s_cbranch_scc1 L_sk3_84
    v_lshlrev_b32 v119, 2, v0
    buffer_load_dword v88, v119, s[12:15], s52 offen
L_sk3_84:
    buffer_load_dwordx4 v[76:79], v3, s[12:15], s43 offen
    s_waitcnt lgkmcnt(0)
    s_barrier
    s_add_u32 s52, s43, 16384
    buffer_load_dwordx4 v[80:83], v3, s[12:15], s52 offen
    s_add_u32 s52, s43, 32768
    buffer_load_dwordx4 v[84:87], v3, s[12:15], s52 offen
    s_mov_b64 exec, s[64:65]
    ds_read_b64 v[28:29], v28
    s_mov_b64 exec, s[66:67]
    ds_read_b64 v[30:31], v30
    s_mov_b64 exec, s[68:69]
    ds_read_b64 v[32:33], v32
    s_mov_b64 exec, s[70:71]
    ds_read_b64 v[34:35], v34
    s_mov_b64 exec, s[72:73]
    ds_read_b64 v[36:37], v36
    s_mov_b64 exec, s[74:75]
    ds_read_b64 v[38:39], v38
    s_mov_b64 exec, s[76:77]
    ds_read_b64 v[40:41], v40
    s_mov_b64 exec, s[78:79]
    ds_read_b64 v[42:43], v42
    s_mov_b64 exec, s[80:81]
    ds_read_b64 v[44:45], v44
    s_mov_b64 exec, s[82:83]
    ds_read_b64 v[46:47], v46
    s_mov_b64 exec, s[84:85]
    ds_read_b64 v[48:49], v48
    s_mov_b64 exec, s[86:87]
    ds_read_b64 v[50:51], v50
    s_mov_b64 exec, -1
    v_subrev_co_u32 v16, s[64:65], 2.0, v16
    v_subrev_co_u32 v17, s[66:67], 2.0, v17
    v_subrev_co_u32 v18, s[68:69], 2.0, v18
    v_subrev_co_u32 v19, s[70:71], 2.0, v19
    v_subrev_co_u32 v20, s[72:73], 2.0, v20
    v_subrev_co_u32 v21, s[74:75], 2.0, v21
    v_subrev_co_u32 v22, s[76:77], 2.0, v22
    v_subrev_co_u32 v23, s[78:79], 2.0, v23
    v_subrev_co_u32 v24, s[80:81], 2.0, v24
    v_subrev_co_u32 v25, s[82:83], 2.0, v25
    v_subrev_co_u32 v26, s[84:85], 2.0, v26
    v_subrev_co_u32 v27, s[86:87], 2.0, v27
    s_mov_b64 exec, s[64:65]
    ds_read_b64 v[52:53], v52
    s_mov_b64 exec, s[66:67]
    ds_read_b64 v[54:55], v54
    s_mov_b64 exec, s[68:69]
    ds_read_b64 v[56:57], v56
    s_mov_b64 exec, s[70:71]
    ds_read_b64 v[58:59], v58
    s_mov_b64 exec, s[72:73]
    ds_read_b64 v[60:61], v60
    s_mov_b64 exec, s[74:75]
    ds_read_b64 v[62:63], v62
    s_mov_b64 exec, s[76:77]
    ds_read_b64 v[64:65], v64
    s_mov_b64 exec, s[78:79]
    ds_read_b64 v[66:67], v66
    s_mov_b64 exec, s[80:81]
    ds_read_b64 v[68:69], v68
    s_mov_b64 exec, s[82:83]
    ds_read_b64 v[70:71], v70
    s_mov_b64 exec, s[84:85]
    ds_read_b64 v[72:73], v72
    s_mov_b64 exec, s[86:87]
    ds_read_b64 v[74:75], v74
    s_mov_b64 exec, -1
    s_cmp_le_i32 s42, 3072
    s_cbranch_scc1 L_nt1_80
    s_waitcnt vmcnt(10)
    v_lshlrev_b32_sdwa v120, 3, v114 dst_sel:WORD_0 dst_unused:UNUSED_PAD src0_sel:DWORD src1_sel:DWORD
    v_lshrrev_b32 v122, 5, v106
    v_lshlrev_b32_sdwa v124, 3, v107 dst_sel:WORD_0 dst_unused:UNUSED_PAD src0_sel:DWORD src1_sel:WORD_1
    v_alignbit_b32 v126, v109, v108, 21

    v_alignbyte_b32 v108, v108, v107, 3
    v_alignbyte_b32 v107, v107, v106, 2
    v_alignbyte_b32 v106, v106, v114, 1
    v_and_b32 v122, 0xfff8, v122
    v_and_b32 v126, 0xfff8, v126
    s_cmp_lt_i32 s42, 3328
    s_cbranch_scc1 L_ufix_85
L_uback_86:

    v_lshrrev_b32 v117, 30, v106
    v_and_b32 v106, 0x3fffffff, v106
    v_mul_u32_u24 v117, 50000, v117
    v_cmp_ne_u32 vcc, 0, v106
    v_add_u32 v120, v120, v117
    s_mov_b64 exec, vcc

    buffer_load_dwordx2 v[120:121], v120, s[8:11], s50 offen
    s_mov_b64 exec, -1
    v_lshrrev_b32 v117, 30, v107
    v_and_b32 v107, 0x3fffffff, v107
    v_mul_u32_u24 v117, 50000, v117
    v_cmp_ne_u32 vcc, 0, v107
    v_add_u32 v122, v122, v117
    s_mov_b64 exec, vcc

    buffer_load_dwordx2 v[122:123], v122, s[8:11], s50 offen
    s_mov_b64 exec, -1
    v_lshrrev_b32 v117, 30, v108
    v_and_b32 v108, 0x3fffffff, v108
    v_mul_u32_u24 v117, 50000, v117
    v_cmp_ne_u32 vcc, 0, v108
    v_add_u32 v124, v124, v117
    s_mov_b64 exec, vcc

    buffer_load_dwordx2 v[124:125], v124, s[8:11], s50 offen
    s_mov_b64 exec, -1
    v_lshrrev_b32 v117, 30, v109
    v_and_b32 v109, 0x3fffffff, v109
    v_mul_u32_u24 v117, 50000, v117
    v_cmp_ne_u32 vcc, 0, v109
    v_add_u32 v126, v126, v117
    s_mov_b64 exec, vcc

    buffer_load_dwordx2 v[126:127], v126, s[8:11], s50 offen
    s_mov_b64 exec, -1
L_nt1_80:
    v_subrev_co_u32 v4, s[64:65], 2.0, v4
    v_subrev_co_u32 v5, s[66:67], 2.0, v5
    v_subrev_co_u32 v6, s[68:69], 2.0, v6
    v_subrev_co_u32 v7, s[70:71], 2.0, v7
    v_subrev_co_u32 v8, s[72:73], 2.0, v8
    v_subrev_co_u32 v9, s[74:75], 2.0, v9
    v_subrev_co_u32 v10, s[76:77], 2.0, v10
    v_subrev_co_u32 v11, s[78:79], 2.0, v11
    v_subrev_co_u32 v12, s[80:81], 2.0, v12
    v_subrev_co_u32 v13, s[82:83], 2.0, v13
    v_subrev_co_u32 v14, s[84:85], 2.0, v14
    v_subrev_co_u32 v15, s[86:87], 2.0, v15
    s_waitcnt lgkmcnt(0)
    s_barrier
    s_waitcnt vmcnt(2)
    ds_write_addtid_b32 v76 offset:0
    ds_write_addtid_b32 v77 offset:256
    ds_write_addtid_b32 v78 offset:512
    ds_write_addtid_b32 v79 offset:768
    s_waitcnt vmcnt(1)
    ds_write_addtid_b32 v80 offset:16384
    ds_write_addtid_b32 v81 offset:16640
    ds_write_addtid_b32 v82 offset:16896
    ds_write_addtid_b32 v83 offset:17152
    s_waitcnt vmcnt(0)
    ds_write_addtid_b32 v84 offset:32768
    ds_write_addtid_b32 v85 offset:33024
    ds_write_addtid_b32 v86 offset:33280
    ds_write_addtid_b32 v87 offset:33536
    v_lshlrev_b32 v119, 2, v0
    s_waitcnt vmcnt(3)
    s_mov_b64 exec, s[48:49]
    ds_write_b32 v119, v88 offset:49152
    s_mov_b64 exec, -1
    s_add_u32 s43, s43, 50048
    s_add_u32 s14, s43, 50000
    s_min_u32 s14, s14, s41
    s_add_u32 s52, s43, 49152
    s_cmp_ge_u32 s25, 4
    s_cbranch_scc1 L_sk3_87
    v_lshlrev_b32 v119, 2, v0
    buffer_load_dword v88, v119, s[12:15], s52 offen
L_sk3_87:
    buffer_load_dwordx4 v[76:79], v3, s[12:15], s43 offen
    s_waitcnt lgkmcnt(0)
    s_barrier
    s_add_u32 s52, s43, 16384
    buffer_load_dwordx4 v[80:83], v3, s[12:15], s52 offen
    s_add_u32 s52, s43, 32768
    buffer_load_dwordx4 v[84:87], v3, s[12:15], s52 offen
    s_mov_b64 exec, s[64:65]
    ds_read_b64 v[28:29], v28
    s_mov_b64 exec, s[66:67]
    ds_read_b64 v[30:31], v30
    s_mov_b64 exec, s[68:69]
    ds_read_b64 v[32:33], v32
    s_mov_b64 exec, s[70:71]
    ds_read_b64 v[34:35], v34
    s_mov_b64 exec, s[72:73]
    ds_read_b64 v[36:37], v36
    s_mov_b64 exec, s[74:75]
    ds_read_b64 v[38:39], v38
    s_mov_b64 exec, s[76:77]
    ds_read_b64 v[40:41], v40
    s_mov_b64 exec, s[78:79]
    ds_read_b64 v[42:43], v42
    s_mov_b64 exec, s[80:81]
    ds_read_b64 v[44:45], v44
    s_mov_b64 exec, s[82:83]
    ds_read_b64 v[46:47], v46
    s_mov_b64 exec, s[84:85]
    ds_read_b64 v[48:49], v48
    s_mov_b64 exec, s[86:87]
    ds_read_b64 v[50:51], v50
    s_mov_b64 exec, -1
    v_subrev_co_u32 v16, s[64:65], 2.0, v16
    v_subrev_co_u32 v17, s[66:67], 2.0, v17
    v_subrev_co_u32 v18, s[68:69], 2.0, v18
    v_subrev_co_u32 v19, s[70:71], 2.0, v19
    v_subrev_co_u32 v20, s[72:73], 2.0, v20
    v_subrev_co_u32 v21, s[74:75], 2.0, v21
    v_subrev_co_u32 v22, s[76:77], 2.0, v22
    v_subrev_co_u32 v23, s[78:79], 2.0, v23
    v_subrev_co_u32 v24, s[80:81], 2.0, v24
    v_subrev_co_u32 v25, s[82:83], 2.0, v25
    v_subrev_co_u32 v26, s[84:85], 2.0, v26
    v_subrev_co_u32 v27, s[86:87], 2.0, v27
    s_mov_b64 exec, s[64:65]
    ds_read_b64 v[52:53], v52
    s_mov_b64 exec, s[66:67]
    ds_read_b64 v[54:55], v54
    s_mov_b64 exec, s[68:69]
    ds_read_b64 v[56:57], v56
    s_mov_b64 exec, s[70:71]
    ds_read_b64 v[58:59], v58
    s_mov_b64 exec, s[72:73]
    ds_read_b64 v[60:61], v60
    s_mov_b64 exec, s[74:75]
    ds_read_b64 v[62:63], v62
    s_mov_b64 exec, s[76:77]
    ds_read_b64 v[64:65], v64
    s_mov_b64 exec, s[78:79]
    ds_read_b64 v[66:67], v66
    s_mov_b64 exec, s[80:81]
    ds_read_b64 v[68:69], v68
    s_mov_b64 exec, s[82:83]
    ds_read_b64 v[70:71], v70
    s_mov_b64 exec, s[84:85]
    ds_read_b64 v[72:73], v72
    s_mov_b64 exec, s[86:87]
    ds_read_b64 v[74:75], v74
    s_mov_b64 exec, -1
    s_movk_i32 s53, 10240
    buffer_load_dwordx4 v[98:101], v2, s[16:19], s53 offen offset:4
    buffer_load_dword v112, v2, s[16:19], s53 offen
    s_movk_i32 s53, 12800
    buffer_load_dwordx4 v[102:105], v2, s[16:19], s53 offen offset:4
    buffer_load_dword v113, v2, s[16:19], s53 offen
    s_cmp_le_i32 s42, 3072
    s_cbranch_scc1 L_nt2_81
    s_waitcnt vmcnt(7)
    v_cmp_ne_u32 s[56:57], 0, v106
    v_cmp_ne_u32 s[58:59], 0, v107
    v_cmp_ne_u32 s[98:99], 0, v108
    v_cmp_ne_u32 vcc, 0, v109
    s_mov_b64 exec, s[56:57]
    v_cvt_f32_i32_sdwa v118, sext(v106) dst_sel:DWORD dst_unused:UNUSED_PAD src0_sel:WORD_0
    v_lshlrev_b32 v116, 16, v120
    v_and_b32 v117, s32, v120
    v_mul_f32 v118, s33, v118
    v_lshlrev_b32 v120, 16, v121
    v_and_b32 v121, s32, v121
    v_lshlrev_b32_sdwa v106, 3, v106 dst_sel:DWORD dst_unused:UNUSED_PAD src0_sel:DWORD src1_sel:WORD_1
    v_pk_fma_f32 v[116:117], v[116:117], v[118:119], s[28:29] op_sel_hi:[1,0,1]
    v_pk_fma_f32 v[120:121], v[120:121], v[118:119], s[28:29] op_sel_hi:[1,0,1]
    v_perm_b32 v116, v117, v116, s35
    v_perm_b32 v117, v121, v120, s35
    v_lshl_add_u64 v[116:117], v[116:117], 0, s[30:31]
    ds_add_rtn_u64 v[120:121], v106, v[116:117] offset:50000

    s_mov_b64 exec, s[58:59]
    v_cvt_f32_i32_sdwa v118, sext(v107) dst_sel:DWORD dst_unused:UNUSED_PAD src0_sel:WORD_0
    v_lshlrev_b32 v116, 16, v122
    v_and_b32 v117, s32, v122
    v_mul_f32 v118, s33, v118
    v_lshlrev_b32 v122, 16, v123
    v_and_b32 v123, s32, v123
    v_lshlrev_b32_sdwa v107, 3, v107 dst_sel:DWORD dst_unused:UNUSED_PAD src0_sel:DWORD src1_sel:WORD_1
    v_pk_fma_f32 v[116:117], v[116:117], v[118:119], s[28:29] op_sel_hi:[1,0,1]
    v_pk_fma_f32 v[122:123], v[122:123], v[118:119], s[28:29] op_sel_hi:[1,0,1]
    v_perm_b32 v116, v117, v116, s35
    v_perm_b32 v117, v123, v122, s35
    v_lshl_add_u64 v[116:117], v[116:117], 0, s[30:31]
    ds_add_rtn_u64 v[122:123], v107, v[116:117] offset:50000

    s_mov_b64 exec, s[98:99]
    v_cvt_f32_i32_sdwa v118, sext(v108) dst_sel:DWORD dst_unused:UNUSED_PAD src0_sel:WORD_0
    v_lshlrev_b32 v116, 16, v124
    v_and_b32 v117, s32, v124
    v_mul_f32 v118, s33, v118
    v_lshlrev_b32 v124, 16, v125
    v_and_b32 v125, s32, v125
    v_lshlrev_b32_sdwa v108, 3, v108 dst_sel:DWORD dst_unused:UNUSED_PAD src0_sel:DWORD src1_sel:WORD_1
    v_pk_fma_f32 v[116:117], v[116:117], v[118:119], s[28:29] op_sel_hi:[1,0,1]
    v_pk_fma_f32 v[124:125], v[124:125], v[118:119], s[28:29] op_sel_hi:[1,0,1]
    v_perm_b32 v116, v117, v116, s35
    v_perm_b32 v117, v125, v124, s35
    v_lshl_add_u64 v[116:117], v[116:117], 0, s[30:31]
    ds_add_rtn_u64 v[124:125], v108, v[116:117] offset:50000

    s_mov_b64 exec, vcc
    v_cvt_f32_i32_sdwa v118, sext(v109) dst_sel:DWORD dst_unused:UNUSED_PAD src0_sel:WORD_0
    v_lshlrev_b32 v116, 16, v126
    v_and_b32 v117, s32, v126
    v_mul_f32 v118, s33, v118
    v_lshlrev_b32 v126, 16, v127
    v_and_b32 v127, s32, v127
    v_lshlrev_b32_sdwa v109, 3, v109 dst_sel:DWORD dst_unused:UNUSED_PAD src0_sel:DWORD src1_sel:WORD_1
    v_pk_fma_f32 v[116:117], v[116:117], v[118:119], s[28:29] op_sel_hi:[1,0,1]
    v_pk_fma_f32 v[126:127], v[126:127], v[118:119], s[28:29] op_sel_hi:[1,0,1]
    v_perm_b32 v116, v117, v116, s35
    v_perm_b32 v117, v127, v126, s35
    v_lshl_add_u64 v[116:117], v[116:117], 0, s[30:31]
    ds_add_rtn_u64 v[126:127], v109, v[116:117] offset:50000

    s_waitcnt lgkmcnt(0)
    s_mov_b64 exec, s[56:57]
    v_or3_b32 v1, v120, v121, v1
    s_mov_b64 exec, s[58:59]
    v_or3_b32 v1, v122, v123, v1
    s_mov_b64 exec, s[98:99]
    v_or3_b32 v1, v124, v125, v1
    s_mov_b64 exec, vcc
    v_or3_b32 v1, v126, v127, v1
    s_mov_b64 exec, -1
L_nt2_81:
    s_cmp_le_u32 s40, 3584
    s_cbranch_scc1 L_noleft_82
    s_min_u32 s40, s40, 6524
    s_lshl_b32 s52, s38, 6
    s_add_u32 s52, s52, s36
    s_mul_i32 s52, s52, 32764
    s_and_b32 s52, s52, 0xffffff80
    s_add_u32 s20, s44, s52
    s_addc_u32 s21, s45, 0
    s_mul_i32 s52, s40, 5
    s_add_u32 s52, s52, 3
    s_and_b32 s22, s52, -4

    s_lshr_b32 s55, s39, 2
    s_add_u32 s55, s55, 3584
    v_and_b32 v120, 63, v0
    v_add_u32 v120, s55, v120
L_left_90:
    s_cmp_ge_u32 s55, s40
    s_cbranch_scc1 L_leftend_91
    v_mul_u32_u24 v121, 5, v120
    buffer_load_dword v122, v121, s[20:23], 0 offen offset:1
    buffer_load_ubyte v123, v121, s[20:23], 0 offen
    s_waitcnt vmcnt(0)

    v_perm_b32 v121, v123, v122, s24
    v_lshrrev_b32 v126, 30, v122
    v_and_b32 v121, 0x1fff, v121
    v_mul_u32_u24 v126, 6250, v126
    v_add_lshl_u32 v121, v121, v126, 3

    buffer_load_dwordx2 v[124:125], v121, s[8:11], s50 offen
    v_cmp_gt_u32 vcc, s40, v120
    s_waitcnt vmcnt(0)

    s_mov_b64 exec, vcc
    v_and_b32 v122, 0x3fffffff, v122
    v_cvt_f32_i32_sdwa v118, sext(v122) dst_sel:DWORD dst_unused:UNUSED_PAD src0_sel:WORD_0
    v_lshlrev_b32 v116, 16, v124
    v_and_b32 v117, s32, v124
    v_mul_f32 v118, s33, v118
    v_lshlrev_b32 v124, 16, v125
    v_and_b32 v125, s32, v125
    v_lshlrev_b32_sdwa v122, 3, v122 dst_sel:DWORD dst_unused:UNUSED_PAD src0_sel:DWORD src1_sel:WORD_1
    v_pk_fma_f32 v[116:117], v[116:117], v[118:119], s[28:29] op_sel_hi:[1,0,1]
    v_pk_fma_f32 v[124:125], v[124:125], v[118:119], s[28:29] op_sel_hi:[1,0,1]
    v_perm_b32 v116, v117, v116, s35
    v_perm_b32 v117, v125, v124, s35
    v_lshl_add_u64 v[116:117], v[116:117], 0, s[30:31]
    ds_add_rtn_u64 v[124:125], v122, v[116:117] offset:50000

    s_waitcnt lgkmcnt(0)
    v_or3_b32 v1, v124, v125, v1
    s_mov_b64 exec, -1
    v_add_u32 v120, 128, v120
    s_add_u32 s55, s55, 128
    s_branch L_left_90
L_leftend_91:

L_noleft_82:
    v_cmp_gt_u32 s[64:65], 2.0, v4
    v_and_b32 v4, 0x3fffffff, v4
    v_cmp_gt_u32 s[66:67], 2.0, v5
    v_and_b32 v5, 0x3fffffff, v5
    v_cmp_gt_u32 s[68:69], 2.0, v6
    v_and_b32 v6, 0x3fffffff, v6
    v_cmp_gt_u32 s[70:71], 2.0, v7
    v_and_b32 v7, 0x3fffffff, v7
    v_cmp_gt_u32 s[72:73], 2.0, v8
    v_and_b32 v8, 0x3fffffff, v8
    v_cmp_gt_u32 s[74:75], 2.0, v9
    v_and_b32 v9, 0x3fffffff, v9
    v_cmp_gt_u32 s[76:77], 2.0, v10
    v_and_b32 v10, 0x3fffffff, v10
    v_cmp_gt_u32 s[78:79], 2.0, v11
    v_and_b32 v11, 0x3fffffff, v11
    v_cmp_gt_u32 s[80:81], 2.0, v12
    v_and_b32 v12, 0x3fffffff, v12
    v_cmp_gt_u32 s[82:83], 2.0, v13
    v_and_b32 v13, 0x3fffffff, v13
    v_cmp_gt_u32 s[84:85], 2.0, v14
    v_and_b32 v14, 0x3fffffff, v14
    v_cmp_gt_u32 s[86:87], 2.0, v15
    v_and_b32 v15, 0x3fffffff, v15
    s_waitcnt lgkmcnt(0)
    s_barrier
    s_waitcnt vmcnt(6)
    ds_write_addtid_b32 v76 offset:0
    ds_write_addtid_b32 v77 offset:256
    ds_write_addtid_b32 v78 offset:512
    ds_write_addtid_b32 v79 offset:768
    s_waitcnt vmcnt(5)
    ds_write_addtid_b32 v80 offset:16384
    ds_write_addtid_b32 v81 offset:16640
    ds_write_addtid_b32 v82 offset:16896
    ds_write_addtid_b32 v83 offset:17152
    s_waitcnt vmcnt(4)
    ds_write_addtid_b32 v84 offset:32768
    ds_write_addtid_b32 v85 offset:33024
    ds_write_addtid_b32 v86 offset:33280
    ds_write_addtid_b32 v87 offset:33536
    v_lshlrev_b32 v119, 2, v0
    s_waitcnt vmcnt(7)
    s_mov_b64 exec, s[48:49]
    ds_write_b32 v119, v88 offset:49152
    s_mov_b64 exec, -1
    s_add_u32 s43, s43, 50048
    s_add_u32 s14, s43, 50000
    s_min_u32 s14, s14, s41
    s_add_u32 s52, s43, 49152
    s_cmp_ge_u32 s25, 4
    s_cbranch_scc1 L_sk3_92
    v_lshlrev_b32 v119, 2, v0
    buffer_load_dword v88, v119, s[12:15], s52 offen
L_sk3_92:
    buffer_load_dwordx4 v[76:79], v3, s[12:15], s43 offen
    s_waitcnt lgkmcnt(0)
    s_barrier
    s_add_u32 s52, s43, 16384
    buffer_load_dwordx4 v[80:83], v3, s[12:15], s52 offen
    s_add_u32 s52, s43, 32768
    buffer_load_dwordx4 v[84:87], v3, s[12:15], s52 offen
    s_mov_b64 exec, s[64:65]
    ds_read_b64 v[28:29], v28
    s_mov_b64 exec, s[66:67]
    ds_read_b64 v[30:31], v30
    s_mov_b64 exec, s[68:69]
    ds_read_b64 v[32:33], v32
    s_mov_b64 exec, s[70:71]
    ds_read_b64 v[34:35], v34
    s_mov_b64 exec, s[72:73]
    ds_read_b64 v[36:37], v36
    s_mov_b64 exec, s[74:75]
    ds_read_b64 v[38:39], v38
    s_mov_b64 exec, s[76:77]
    ds_read_b64 v[40:41], v40
    s_mov_b64 exec, s[78:79]
    ds_read_b64 v[42:43], v42
    s_mov_b64 exec, s[80:81]
    ds_read_b64 v[44:45], v44
    s_mov_b64 exec, s[82:83]
    ds_read_b64 v[46:47], v46
    s_mov_b64 exec, s[84:85]
    ds_read_b64 v[48:49], v48
    s_mov_b64 exec, s[86:87]
    ds_read_b64 v[50:51], v50
    s_mov_b64 exec, -1
    v_cmp_gt_u32 s[64:65], 2.0, v16
    v_and_b32 v16, 0x3fffffff, v16
    v_cmp_gt_u32 s[66:67], 2.0, v17
    v_and_b32 v17, 0x3fffffff, v17
    v_cmp_gt_u32 s[68:69], 2.0, v18
    v_and_b32 v18, 0x3fffffff, v18
    v_cmp_gt_u32 s[70:71], 2.0, v19
    v_and_b32 v19, 0x3fffffff, v19
    v_cmp_gt_u32 s[72:73], 2.0, v20
    v_and_b32 v20, 0x3fffffff, v20
    v_cmp_gt_u32 s[74:75], 2.0, v21
    v_and_b32 v21, 0x3fffffff, v21
    v_cmp_gt_u32 s[76:77], 2.0, v22
    v_and_b32 v22, 0x3fffffff, v22
    v_cmp_gt_u32 s[78:79], 2.0, v23
    v_and_b32 v23, 0x3fffffff, v23
    v_cmp_gt_u32 s[80:81], 2.0, v24
    v_and_b32 v24, 0x3fffffff, v24
    v_cmp_gt_u32 s[82:83], 2.0, v25
    v_and_b32 v25, 0x3fffffff, v25
    v_cmp_gt_u32 s[84:85], 2.0, v26
    v_and_b32 v26, 0x3fffffff, v26
    v_cmp_gt_u32 s[86:87], 2.0, v27
    v_and_b32 v27, 0x3fffffff, v27
    s_mov_b64 exec, s[64:65]
    ds_read_b64 v[52:53], v52
    s_mov_b64 exec, s[66:67]
    ds_read_b64 v[54:55], v54
    s_mov_b64 exec, s[68:69]
    ds_read_b64 v[56:57], v56
    s_mov_b64 exec, s[70:71]
    ds_read_b64 v[58:59], v58
    s_mov_b64 exec, s[72:73]
    ds_read_b64 v[60:61], v60
    s_mov_b64 exec, s[74:75]
    ds_read_b64 v[62:63], v62
    s_mov_b64 exec, s[76:77]
    ds_read_b64 v[64:65], v64
    s_mov_b64 exec, s[78:79]
    ds_read_b64 v[66:67], v66
    s_mov_b64 exec, s[80:81]
    ds_read_b64 v[68:69], v68
    s_mov_b64 exec, s[82:83]
    ds_read_b64 v[70:71], v70
    s_mov_b64 exec, s[84:85]
    ds_read_b64 v[72:73], v72
    s_mov_b64 exec, s[86:87]
    ds_read_b64 v[74:75], v74
    s_mov_b64 exec, -1
    s_cmp_ge_u32 s5, s4
    s_cbranch_scc1 L_bend_79
    s_waitcnt lgkmcnt(15)
    v_mad_i32_i16 v120, v28, v4, s96
    v_mad_i32_i16 v28, v28, v4, s96 op_sel:[1,0,0,0]
    v_mad_i32_i16 v121, v29, v4, s96
    v_mad_i32_i16 v29, v29, v4, s96 op_sel:[1,0,0,0]
    v_lshlrev_b32_sdwa v4, 3, v4 dst_sel:DWORD dst_unused:UNUSED_PAD src0_sel:DWORD src1_sel:WORD_1
    v_perm_b32 v28, v28, v120, s97
    v_perm_b32 v29, v29, v121, s97
    v_lshl_add_u64 v[28:29], v[28:29], 0, s[30:31]

    ds_add_rtn_u64 v[28:29], v4, v[28:29] offset:50000
    v_mad_i32_i16 v122, v30, v5, s96
    v_mad_i32_i16 v30, v30, v5, s96 op_sel:[1,0,0,0]
    v_mad_i32_i16 v123, v31, v5, s96
    v_mad_i32_i16 v31, v31, v5, s96 op_sel:[1,0,0,0]
    v_lshlrev_b32_sdwa v5, 3, v5 dst_sel:DWORD dst_unused:UNUSED_PAD src0_sel:DWORD src1_sel:WORD_1
    v_perm_b32 v30, v30, v122, s97
    v_perm_b32 v31, v31, v123, s97
    v_lshl_add_u64 v[30:31], v[30:31], 0, s[30:31]

    ds_add_rtn_u64 v[30:31], v5, v[30:31] offset:50000
    v_mad_i32_i16 v124, v32, v6, s96
    v_mad_i32_i16 v32, v32, v6, s96 op_sel:[1,0,0,0]
    v_mad_i32_i16 v125, v33, v6, s96
    v_mad_i32_i16 v33, v33, v6, s96 op_sel:[1,0,0,0]
    v_lshlrev_b32_sdwa v6, 3, v6 dst_sel:DWORD dst_unused:UNUSED_PAD src0_sel:DWORD src1_sel:WORD_1
    v_perm_b32 v32, v32, v124, s97
    v_perm_b32 v33, v33, v125, s97
    v_lshl_add_u64 v[32:33], v[32:33], 0, s[30:31]

    ds_add_rtn_u64 v[32:33], v6, v[32:33] offset:50000
    v_mad_i32_i16 v126, v34, v7, s96
    v_mad_i32_i16 v34, v34, v7, s96 op_sel:[1,0,0,0]
    v_mad_i32_i16 v127, v35, v7, s96
    v_mad_i32_i16 v35, v35, v7, s96 op_sel:[1,0,0,0]
    v_lshlrev_b32_sdwa v7, 3, v7 dst_sel:DWORD dst_unused:UNUSED_PAD src0_sel:DWORD src1_sel:WORD_1
    v_perm_b32 v34, v34, v126, s97
    v_perm_b32 v35, v35, v127, s97
    v_lshl_add_u64 v[34:35], v[34:35], 0, s[30:31]

    ds_add_rtn_u64 v[34:35], v7, v[34:35] offset:50000
    s_sub_u32 s53, s88, s39
    s_cmp_le_i32 s53, 3072
    s_cbranch_scc1 L_skt_93
    s_movk_i32 s53, 15360
    buffer_load_dwordx4 v[106:109], v2, s[16:19], s53 offen offset:4
    buffer_load_dword v114, v2, s[16:19], s53 offen
L_skt_93:
    v_mad_i32_i16 v120, v36, v8, s96
    v_mad_i32_i16 v36, v36, v8, s96 op_sel:[1,0,0,0]
    v_mad_i32_i16 v121, v37, v8, s96
    v_mad_i32_i16 v37, v37, v8, s96 op_sel:[1,0,0,0]
    v_lshlrev_b32_sdwa v8, 3, v8 dst_sel:DWORD dst_unused:UNUSED_PAD src0_sel:DWORD src1_sel:WORD_1
    v_perm_b32 v36, v36, v120, s97
    v_perm_b32 v37, v37, v121, s97
    v_lshl_add_u64 v[36:37], v[36:37], 0, s[30:31]

    ds_add_rtn_u64 v[36:37], v8, v[36:37] offset:50000
    v_mad_i32_i16 v122, v38, v9, s96
    v_mad_i32_i16 v38, v38, v9, s96 op_sel:[1,0,0,0]
    v_mad_i32_i16 v123, v39, v9, s96
    v_mad_i32_i16 v39, v39, v9, s96 op_sel:[1,0,0,0]
    v_lshlrev_b32_sdwa v9, 3, v9 dst_sel:DWORD dst_unused:UNUSED_PAD src0_sel:DWORD src1_sel:WORD_1
    v_perm_b32 v38, v38, v122, s97
    v_perm_b32 v39, v39, v123, s97
    v_lshl_add_u64 v[38:39], v[38:39], 0, s[30:31]

    ds_add_rtn_u64 v[38:39], v9, v[38:39] offset:50000
    v_mad_i32_i16 v124, v40, v10, s96
    v_mad_i32_i16 v40, v40, v10, s96 op_sel:[1,0,0,0]
    v_mad_i32_i16 v125, v41, v10, s96
    v_mad_i32_i16 v41, v41, v10, s96 op_sel:[1,0,0,0]
    v_lshlrev_b32_sdwa v10, 3, v10 dst_sel:DWORD dst_unused:UNUSED_PAD src0_sel:DWORD src1_sel:WORD_1
    v_perm_b32 v40, v40, v124, s97
    v_perm_b32 v41, v41, v125, s97
    v_lshl_add_u64 v[40:41], v[40:41], 0, s[30:31]

    ds_add_rtn_u64 v[40:41], v10, v[40:41] offset:50000
    v_mad_i32_i16 v126, v42, v11, s96
    v_mad_i32_i16 v42, v42, v11, s96 op_sel:[1,0,0,0]
    v_mad_i32_i16 v127, v43, v11, s96
    v_mad_i32_i16 v43, v43, v11, s96 op_sel:[1,0,0,0]
    v_lshlrev_b32_sdwa v11, 3, v11 dst_sel:DWORD dst_unused:UNUSED_PAD src0_sel:DWORD src1_sel:WORD_1
    v_perm_b32 v42, v42, v126, s97
    v_perm_b32 v43, v43, v127, s97
    v_lshl_add_u64 v[42:43], v[42:43], 0, s[30:31]

    ds_add_rtn_u64 v[42:43], v11, v[42:43] offset:50000
    s_waitcnt lgkmcnt(4)
    v_or3_b32 v1, v28, v29, v1
    v_or3_b32 v1, v30, v31, v1
    v_or3_b32 v1, v32, v33, v1
    v_or3_b32 v1, v34, v35, v1
    s_movk_i32 s53, 0
    buffer_load_dwordx4 v[4:7], v2, s[16:19], s53 offen offset:4 nt
    buffer_load_dword v35, v2, s[16:19], s53 offen nt
    v_mad_i32_i16 v120, v44, v12, s96
    v_mad_i32_i16 v44, v44, v12, s96 op_sel:[1,0,0,0]
    v_mad_i32_i16 v121, v45, v12, s96
    v_mad_i32_i16 v45, v45, v12, s96 op_sel:[1,0,0,0]
    v_lshlrev_b32_sdwa v12, 3, v12 dst_sel:DWORD dst_unused:UNUSED_PAD src0_sel:DWORD src1_sel:WORD_1
    v_perm_b32 v44, v44, v120, s97
    v_perm_b32 v45, v45, v121, s97
    v_lshl_add_u64 v[44:45], v[44:45], 0, s[30:31]

    ds_add_rtn_u64 v[44:45], v12, v[44:45] offset:50000
    v_mad_i32_i16 v122, v46, v13, s96
    v_mad_i32_i16 v46, v46, v13, s96 op_sel:[1,0,0,0]
    v_mad_i32_i16 v123, v47, v13, s96
    v_mad_i32_i16 v47, v47, v13, s96 op_sel:[1,0,0,0]
    v_lshlrev_b32_sdwa v13, 3, v13 dst_sel:DWORD dst_unused:UNUSED_PAD src0_sel:DWORD src1_sel:WORD_1
    v_perm_b32 v46, v46, v122, s97
    v_perm_b32 v47, v47, v123, s97
    v_lshl_add_u64 v[46:47], v[46:47], 0, s[30:31]

    ds_add_rtn_u64 v[46:47], v13, v[46:47] offset:50000
    v_mad_i32_i16 v124, v48, v14, s96
    v_mad_i32_i16 v48, v48, v14, s96 op_sel:[1,0,0,0]
    v_mad_i32_i16 v125, v49, v14, s96
    v_mad_i32_i16 v49, v49, v14, s96 op_sel:[1,0,0,0]
    v_lshlrev_b32_sdwa v14, 3, v14 dst_sel:DWORD dst_unused:UNUSED_PAD src0_sel:DWORD src1_sel:WORD_1
    v_perm_b32 v48, v48, v124, s97
    v_perm_b32 v49, v49, v125, s97
    v_lshl_add_u64 v[48:49], v[48:49], 0, s[30:31]

    ds_add_rtn_u64 v[48:49], v14, v[48:49] offset:50000
    v_mad_i32_i16 v126, v50, v15, s96
    v_mad_i32_i16 v50, v50, v15, s96 op_sel:[1,0,0,0]
    v_mad_i32_i16 v127, v51, v15, s96
    v_mad_i32_i16 v51, v51, v15, s96 op_sel:[1,0,0,0]
    v_lshlrev_b32_sdwa v15, 3, v15 dst_sel:DWORD dst_unused:UNUSED_PAD src0_sel:DWORD src1_sel:WORD_1
    v_perm_b32 v50, v50, v126, s97
    v_perm_b32 v51, v51, v127, s97
    v_lshl_add_u64 v[50:51], v[50:51], 0, s[30:31]

    ds_add_rtn_u64 v[50:51], v15, v[50:51] offset:50000
    s_waitcnt lgkmcnt(4)
    v_or3_b32 v1, v36, v37, v1
    v_or3_b32 v1, v38, v39, v1
    v_or3_b32 v1, v40, v41, v1
    v_or3_b32 v1, v42, v43, v1
    s_movk_i32 s53, 2560
    buffer_load_dwordx4 v[8:11], v2, s[16:19], s53 offen offset:4
    buffer_load_dword v43, v2, s[16:19], s53 offen
    s_barrier
    s_waitcnt vmcnt(6)
    ds_write_addtid_b32 v76 offset:0
    ds_write_addtid_b32 v77 offset:256
    ds_write_addtid_b32 v78 offset:512
    ds_write_addtid_b32 v79 offset:768
    s_waitcnt vmcnt(5)
    ds_write_addtid_b32 v80 offset:16384
    ds_write_addtid_b32 v81 offset:16640
    ds_write_addtid_b32 v82 offset:16896
    ds_write_addtid_b32 v83 offset:17152
    s_waitcnt vmcnt(4)
    ds_write_addtid_b32 v84 offset:32768
    ds_write_addtid_b32 v85 offset:33024
    ds_write_addtid_b32 v86 offset:33280
    ds_write_addtid_b32 v87 offset:33536
    v_lshlrev_b32 v119, 2, v0
    s_waitcnt vmcnt(7)
    s_mov_b64 exec, s[48:49]
    ds_write_b32 v119, v88 offset:49152
    s_mov_b64 exec, -1
    s_add_u32 s43, s43, 50048
    s_add_u32 s14, s43, 50000
    s_min_u32 s14, s14, s41
    s_mov_b32 s40, s88
    s_sub_u32 s42, s40, s39

    s_add_u32 s55, s38, 2
    s_min_u32 s55, s55, 31
    s_mov_b32 s88, s89
    s_mov_b32 s89, s90
    s_mov_b32 s90, s91
    s_mov_b32 s91, s92
    s_mov_b32 s92, s93
    s_mov_b32 s93, s94
    s_mov_b32 s94, s95
    s_mov_b32 s95, 0
    s_min_u32 s88, s88, 6524
    s_lshl_b32 s52, s55, 6
    s_add_u32 s52, s52, s36
    s_mul_i32 s52, s52, 32764
    s_and_b32 s52, s52, 0xffffff80
    s_add_u32 s16, s44, s52
    s_addc_u32 s17, s45, 0
    s_mul_i32 s52, s88, 5
    s_add_u32 s52, s52, 3
    s_and_b32 s18, s52, -4

    v_mad_i32_i16 v120, v52, v16, s96
    v_mad_i32_i16 v52, v52, v16, s96 op_sel:[1,0,0,0]
    v_mad_i32_i16 v121, v53, v16, s96
    v_mad_i32_i16 v53, v53, v16, s96 op_sel:[1,0,0,0]
    v_lshlrev_b32_sdwa v16, 3, v16 dst_sel:DWORD dst_unused:UNUSED_PAD src0_sel:DWORD src1_sel:WORD_1
    v_perm_b32 v52, v52, v120, s97
    v_perm_b32 v53, v53, v121, s97
    v_lshl_add_u64 v[52:53], v[52:53], 0, s[30:31]

    ds_add_rtn_u64 v[52:53], v16, v[52:53] offset:50000
    v_mad_i32_i16 v122, v54, v17, s96
    v_mad_i32_i16 v54, v54, v17, s96 op_sel:[1,0,0,0]
    v_mad_i32_i16 v123, v55, v17, s96
    v_mad_i32_i16 v55, v55, v17, s96 op_sel:[1,0,0,0]
    v_lshlrev_b32_sdwa v17, 3, v17 dst_sel:DWORD dst_unused:UNUSED_PAD src0_sel:DWORD src1_sel:WORD_1
    v_perm_b32 v54, v54, v122, s97
    v_perm_b32 v55, v55, v123, s97
    v_lshl_add_u64 v[54:55], v[54:55], 0, s[30:31]

    ds_add_rtn_u64 v[54:55], v17, v[54:55] offset:50000
    v_mad_i32_i16 v124, v56, v18, s96
    v_mad_i32_i16 v56, v56, v18, s96 op_sel:[1,0,0,0]
    v_mad_i32_i16 v125, v57, v18, s96
    v_mad_i32_i16 v57, v57, v18, s96 op_sel:[1,0,0,0]
    v_lshlrev_b32_sdwa v18, 3, v18 dst_sel:DWORD dst_unused:UNUSED_PAD src0_sel:DWORD src1_sel:WORD_1
    v_perm_b32 v56, v56, v124, s97
    v_perm_b32 v57, v57, v125, s97
    v_lshl_add_u64 v[56:57], v[56:57], 0, s[30:31]

    ds_add_rtn_u64 v[56:57], v18, v[56:57] offset:50000
    v_mad_i32_i16 v126, v58, v19, s96
    v_mad_i32_i16 v58, v58, v19, s96 op_sel:[1,0,0,0]
    v_mad_i32_i16 v127, v59, v19, s96
    v_mad_i32_i16 v59, v59, v19, s96 op_sel:[1,0,0,0]
    v_lshlrev_b32_sdwa v19, 3, v19 dst_sel:DWORD dst_unused:UNUSED_PAD src0_sel:DWORD src1_sel:WORD_1
    v_perm_b32 v58, v58, v126, s97
    v_perm_b32 v59, v59, v127, s97
    v_lshl_add_u64 v[58:59], v[58:59], 0, s[30:31]

    ds_add_rtn_u64 v[58:59], v19, v[58:59] offset:50000
    s_waitcnt lgkmcnt(15)
    v_or3_b32 v1, v44, v45, v1
    v_or3_b32 v1, v46, v47, v1
    v_or3_b32 v1, v48, v49, v1
    v_or3_b32 v1, v50, v51, v1
    s_waitcnt vmcnt(19)
    v_lshlrev_b32_sdwa v44, 3, v110 dst_sel:WORD_0 dst_unused:UNUSED_PAD src0_sel:DWORD src1_sel:DWORD
    v_lshrrev_b32 v46, 5, v90
    v_lshlrev_b32_sdwa v48, 3, v91 dst_sel:WORD_0 dst_unused:UNUSED_PAD src0_sel:DWORD src1_sel:WORD_1
    v_alignbit_b32 v50, v93, v92, 21

    v_mov_b32 v15, v93
    v_alignbyte_b32 v14, v92, v91, 3
    v_alignbyte_b32 v13, v91, v90, 2
    v_alignbyte_b32 v12, v90, v110, 1
    v_and_b32 v46, 0xfff8, v46
    v_and_b32 v50, 0xfff8, v50
    s_cmp_lt_i32 s42, 1280
    s_cbranch_scc1 L_ufix_96
L_uback_97:

    s_movk_i32 s53, 5120
    buffer_load_dwordx4 v[90:93], v2, s[16:19], s53 offen offset:4
    buffer_load_dword v110, v2, s[16:19], s53 offen
    s_waitcnt lgkmcnt(4)
    s_barrier
    v_subrev_co_u32 v12, s[80:81], 2.0, v12
    v_subrev_co_u32 v13, s[82:83], 2.0, v13
    v_subrev_co_u32 v14, s[84:85], 2.0, v14
    v_subrev_co_u32 v15, s[86:87], 2.0, v15
    s_mov_b64 exec, s[80:81]
    ds_read_b64 v[44:45], v44
    s_mov_b64 exec, s[82:83]
    ds_read_b64 v[46:47], v46
    s_mov_b64 exec, s[84:85]
    ds_read_b64 v[48:49], v48
    s_mov_b64 exec, s[86:87]
    ds_read_b64 v[50:51], v50
    s_mov_b64 exec, -1
    v_mad_i32_i16 v120, v60, v20, s96
    v_mad_i32_i16 v60, v60, v20, s96 op_sel:[1,0,0,0]
    v_mad_i32_i16 v121, v61, v20, s96
    v_mad_i32_i16 v61, v61, v20, s96 op_sel:[1,0,0,0]
    v_lshlrev_b32_sdwa v20, 3, v20 dst_sel:DWORD dst_unused:UNUSED_PAD src0_sel:DWORD src1_sel:WORD_1
    v_perm_b32 v60, v60, v120, s97
    v_perm_b32 v61, v61, v121, s97
    v_lshl_add_u64 v[60:61], v[60:61], 0, s[30:31]

    ds_add_rtn_u64 v[60:61], v20, v[60:61] offset:50000
    v_mad_i32_i16 v122, v62, v21, s96
    v_mad_i32_i16 v62, v62, v21, s96 op_sel:[1,0,0,0]
    v_mad_i32_i16 v123, v63, v21, s96
    v_mad_i32_i16 v63, v63, v21, s96 op_sel:[1,0,0,0]
    v_lshlrev_b32_sdwa v21, 3, v21 dst_sel:DWORD dst_unused:UNUSED_PAD src0_sel:DWORD src1_sel:WORD_1
    v_perm_b32 v62, v62, v122, s97
    v_perm_b32 v63, v63, v123, s97
    v_lshl_add_u64 v[62:63], v[62:63], 0, s[30:31]

    ds_add_rtn_u64 v[62:63], v21, v[62:63] offset:50000
    v_mad_i32_i16 v124, v64, v22, s96
    v_mad_i32_i16 v64, v64, v22, s96 op_sel:[1,0,0,0]
    v_mad_i32_i16 v125, v65, v22, s96
    v_mad_i32_i16 v65, v65, v22, s96 op_sel:[1,0,0,0]
    v_lshlrev_b32_sdwa v22, 3, v22 dst_sel:DWORD dst_unused:UNUSED_PAD src0_sel:DWORD src1_sel:WORD_1
    v_perm_b32 v64, v64, v124, s97
    v_perm_b32 v65, v65, v125, s97
    v_lshl_add_u64 v[64:65], v[64:65], 0, s[30:31]

    ds_add_rtn_u64 v[64:65], v22, v[64:65] offset:50000
    v_mad_i32_i16 v126, v66, v23, s96
    v_mad_i32_i16 v66, v66, v23, s96 op_sel:[1,0,0,0]
    v_mad_i32_i16 v127, v67, v23, s96
    v_mad_i32_i16 v67, v67, v23, s96 op_sel:[1,0,0,0]
    v_lshlrev_b32_sdwa v23, 3, v23 dst_sel:DWORD dst_unused:UNUSED_PAD src0_sel:DWORD src1_sel:WORD_1
    v_perm_b32 v66, v66, v126, s97
    v_perm_b32 v67, v67, v127, s97
    v_lshl_add_u64 v[66:67], v[66:67], 0, s[30:31]

    ds_add_rtn_u64 v[66:67], v23, v[66:67] offset:50000
    s_waitcnt lgkmcnt(8)
    v_or3_b32 v1, v52, v53, v1
    v_or3_b32 v1, v54, v55, v1
    v_or3_b32 v1, v56, v57, v1
    v_or3_b32 v1, v58, v59, v1
    s_waitcnt vmcnt(19)
    v_lshlrev_b32_sdwa v52, 3, v111 dst_sel:WORD_0 dst_unused:UNUSED_PAD src0_sel:DWORD src1_sel:DWORD
    v_lshrrev_b32 v54, 5, v94
    v_lshlrev_b32_sdwa v56, 3, v95 dst_sel:WORD_0 dst_unused:UNUSED_PAD src0_sel:DWORD src1_sel:WORD_1
    v_alignbit_b32 v58, v97, v96, 21

    v_mov_b32 v19, v97
    v_alignbyte_b32 v18, v96, v95, 3
    v_alignbyte_b32 v17, v95, v94, 2
    v_alignbyte_b32 v16, v94, v111, 1
    v_and_b32 v54, 0xfff8, v54
    v_and_b32 v58, 0xfff8, v58
    s_cmp_lt_i32 s42, 1792
    s_cbranch_scc1 L_ufix_99
L_uback_100:

    v_subrev_co_u32 v16, s[64:65], 2.0, v16
    v_subrev_co_u32 v17, s[66:67], 2.0, v17
    v_subrev_co_u32 v18, s[68:69], 2.0, v18
    v_subrev_co_u32 v19, s[70:71], 2.0, v19
    s_mov_b64 exec, s[64:65]
    ds_read_b64 v[52:53], v52
    s_mov_b64 exec, s[66:67]
    ds_read_b64 v[54:55], v54
    s_mov_b64 exec, s[68:69]
    ds_read_b64 v[56:57], v56
    s_mov_b64 exec, s[70:71]
    ds_read_b64 v[58:59], v58
    s_mov_b64 exec, -1
    v_mad_i32_i16 v120, v68, v24, s96
    v_mad_i32_i16 v68, v68, v24, s96 op_sel:[1,0,0,0]
    v_mad_i32_i16 v121, v69, v24, s96
    v_mad_i32_i16 v69, v69, v24, s96 op_sel:[1,0,0,0]
    v_lshlrev_b32_sdwa v24, 3, v24 dst_sel:DWORD dst_unused:UNUSED_PAD src0_sel:DWORD src1_sel:WORD_1
    v_perm_b32 v68, v68, v120, s97
    v_perm_b32 v69, v69, v121, s97
    v_lshl_add_u64 v[68:69], v[68:69], 0, s[30:31]

    ds_add_rtn_u64 v[68:69], v24, v[68:69] offset:50000
    v_mad_i32_i16 v122, v70, v25, s96
    v_mad_i32_i16 v70, v70, v25, s96 op_sel:[1,0,0,0]
    v_mad_i32_i16 v123, v71, v25, s96
    v_mad_i32_i16 v71, v71, v25, s96 op_sel:[1,0,0,0]
    v_lshlrev_b32_sdwa v25, 3, v25 dst_sel:DWORD dst_unused:UNUSED_PAD src0_sel:DWORD src1_sel:WORD_1
    v_perm_b32 v70, v70, v122, s97
    v_perm_b32 v71, v71, v123, s97
    v_lshl_add_u64 v[70:71], v[70:71], 0, s[30:31]

    ds_add_rtn_u64 v[70:71], v25, v[70:71] offset:50000
    v_mad_i32_i16 v124, v72, v26, s96
    v_mad_i32_i16 v72, v72, v26, s96 op_sel:[1,0,0,0]
    v_mad_i32_i16 v125, v73, v26, s96
    v_mad_i32_i16 v73, v73, v26, s96 op_sel:[1,0,0,0]
    v_lshlrev_b32_sdwa v26, 3, v26 dst_sel:DWORD dst_unused:UNUSED_PAD src0_sel:DWORD src1_sel:WORD_1
    v_perm_b32 v72, v72, v124, s97
    v_perm_b32 v73, v73, v125, s97
    v_lshl_add_u64 v[72:73], v[72:73], 0, s[30:31]

    ds_add_rtn_u64 v[72:73], v26, v[72:73] offset:50000
    v_mad_i32_i16 v126, v74, v27, s96
    v_mad_i32_i16 v74, v74, v27, s96 op_sel:[1,0,0,0]
    v_mad_i32_i16 v127, v75, v27, s96
    v_mad_i32_i16 v75, v75, v27, s96 op_sel:[1,0,0,0]
    v_lshlrev_b32_sdwa v27, 3, v27 dst_sel:DWORD dst_unused:UNUSED_PAD src0_sel:DWORD src1_sel:WORD_1
    v_perm_b32 v74, v74, v126, s97
    v_perm_b32 v75, v75, v127, s97
    v_lshl_add_u64 v[74:75], v[74:75], 0, s[30:31]

    ds_add_rtn_u64 v[74:75], v27, v[74:75] offset:50000
    s_waitcnt lgkmcnt(8)
    v_or3_b32 v1, v60, v61, v1
    v_or3_b32 v1, v62, v63, v1
    v_or3_b32 v1, v64, v65, v1
    v_or3_b32 v1, v66, v67, v1
    s_waitcnt vmcnt(11)
    v_lshlrev_b32_sdwa v60, 3, v112 dst_sel:WORD_0 dst_unused:UNUSED_PAD src0_sel:DWORD src1_sel:DWORD
    v_lshrrev_b32 v62, 5, v98
    v_lshlrev_b32_sdwa v64, 3, v99 dst_sel:WORD_0 dst_unused:UNUSED_PAD src0_sel:DWORD src1_sel:WORD_1
    v_alignbit_b32 v66, v101, v100, 21

    v_mov_b32 v23, v101
    v_alignbyte_b32 v22, v100, v99, 3
    v_alignbyte_b32 v21, v99, v98, 2
    v_alignbyte_b32 v20, v98, v112, 1
    v_and_b32 v62, 0xfff8, v62
    v_and_b32 v66, 0xfff8, v66
    s_cmp_lt_i32 s42, 2304
    s_cbranch_scc1 L_ufix_101
L_uback_102:

    v_subrev_co_u32 v20, s[72:73], 2.0, v20
    v_subrev_co_u32 v21, s[74:75], 2.0, v21
    v_subrev_co_u32 v22, s[76:77], 2.0, v22
    v_subrev_co_u32 v23, s[78:79], 2.0, v23
    s_mov_b64 exec, s[72:73]
    ds_read_b64 v[60:61], v60
    s_mov_b64 exec, s[74:75]
    ds_read_b64 v[62:63], v62
    s_mov_b64 exec, s[76:77]
    ds_read_b64 v[64:65], v64
    s_mov_b64 exec, s[78:79]
    ds_read_b64 v[66:67], v66
    s_mov_b64 exec, -1
    s_waitcnt lgkmcnt(4)
    v_or3_b32 v1, v68, v69, v1
    v_or3_b32 v1, v70, v71, v1
    v_or3_b32 v1, v72, v73, v1
    v_or3_b32 v1, v74, v75, v1
    s_waitcnt vmcnt(9)
    v_lshlrev_b32_sdwa v68, 3, v113 dst_sel:WORD_0 dst_unused:UNUSED_PAD src0_sel:DWORD src1_sel:DWORD
    v_lshrrev_b32 v70, 5, v102
    v_lshlrev_b32_sdwa v72, 3, v103 dst_sel:WORD_0 dst_unused:UNUSED_PAD src0_sel:DWORD src1_sel:WORD_1
    v_alignbit_b32 v74, v105, v104, 21

    v_mov_b32 v27, v105
    v_alignbyte_b32 v26, v104, v103, 3
    v_alignbyte_b32 v25, v103, v102, 2
    v_alignbyte_b32 v24, v102, v113, 1
    v_and_b32 v70, 0xfff8, v70
    v_and_b32 v74, 0xfff8, v74
    s_cmp_lt_i32 s42, 2816
    s_cbranch_scc1 L_ufix_103
L_uback_104:

    v_subrev_co_u32 v24, s[80:81], 2.0, v24
    v_subrev_co_u32 v25, s[82:83], 2.0, v25
    v_subrev_co_u32 v26, s[84:85], 2.0, v26
    v_subrev_co_u32 v27, s[86:87], 2.0, v27
    s_mov_b64 exec, s[80:81]
    ds_read_b64 v[68:69], v68
    s_mov_b64 exec, s[82:83]
    ds_read_b64 v[70:71], v70
    s_mov_b64 exec, s[84:85]
    ds_read_b64 v[72:73], v72
    s_mov_b64 exec, s[86:87]
    ds_read_b64 v[74:75], v74
    s_mov_b64 exec, -1
    s_add_u32 s52, s43, 49152
    s_cmp_ge_u32 s25, 4
    s_cbranch_scc1 L_sk3_105
    v_lshlrev_b32 v119, 2, v0
    buffer_load_dword v88, v119, s[12:15], s52 offen
L_sk3_105:
    buffer_load_dwordx4 v[76:79], v3, s[12:15], s43 offen
    s_add_u32 s52, s43, 16384
    buffer_load_dwordx4 v[80:83], v3, s[12:15], s52 offen
    s_add_u32 s52, s43, 32768
    buffer_load_dwordx4 v[84:87], v3, s[12:15], s52 offen
    s_cmp_lg_u32 s25, 0
    s_cbranch_scc1 L_skw_106
    s_add_u32 s54, s43, 50048
    buffer_load_dword v115, v89, s[60:63], s54 offen
    s_add_u32 s54, s50, 200000
    buffer_load_dword v115, v89, s[8:11], s54 offen
L_skw_106:
    s_waitcnt vmcnt(7)
    v_lshlrev_b32_sdwa v28, 3, v35 dst_sel:WORD_0 dst_unused:UNUSED_PAD src0_sel:DWORD src1_sel:DWORD
    v_lshrrev_b32 v30, 5, v4
    v_lshlrev_b32_sdwa v32, 3, v5 dst_sel:WORD_0 dst_unused:UNUSED_PAD src0_sel:DWORD src1_sel:WORD_1
    v_alignbit_b32 v34, v7, v6, 21

    v_alignbyte_b32 v6, v6, v5, 3
    v_alignbyte_b32 v5, v5, v4, 2
    v_alignbyte_b32 v4, v4, v35, 1
    v_and_b32 v30, 0xfff8, v30
    v_and_b32 v34, 0xfff8, v34
    s_cmp_lt_i32 s42, 256
    s_cbranch_scc1 L_ufix_107
L_uback_108:

    v_subrev_co_u32 v4, s[64:65], 2.0, v4
    v_subrev_co_u32 v5, s[66:67], 2.0, v5
    v_subrev_co_u32 v6, s[68:69], 2.0, v6
    v_subrev_co_u32 v7, s[70:71], 2.0, v7
    s_mov_b64 exec, s[64:65]
    ds_read_b64 v[28:29], v28
    s_mov_b64 exec, s[66:67]
    ds_read_b64 v[30:31], v30
    s_mov_b64 exec, s[68:69]
    ds_read_b64 v[32:33], v32
    s_mov_b64 exec, s[70:71]
    ds_read_b64 v[34:35], v34
    s_mov_b64 exec, -1
    s_waitcnt vmcnt(5)
    v_lshlrev_b32_sdwa v36, 3, v43 dst_sel:WORD_0 dst_unused:UNUSED_PAD src0_sel:DWORD src1_sel:DWORD
    v_lshrrev_b32 v38, 5, v8
    v_lshlrev_b32_sdwa v40, 3, v9 dst_sel:WORD_0 dst_unused:UNUSED_PAD src0_sel:DWORD src1_sel:WORD_1
    v_alignbit_b32 v42, v11, v10, 21

    v_alignbyte_b32 v10, v10, v9, 3
    v_alignbyte_b32 v9, v9, v8, 2
    v_alignbyte_b32 v8, v8, v43, 1
    v_and_b32 v38, 0xfff8, v38
    v_and_b32 v42, 0xfff8, v42
    s_cmp_lt_i32 s42, 768
    s_cbranch_scc1 L_ufix_109
L_uback_110:

    v_subrev_co_u32 v8, s[72:73], 2.0, v8
    v_subrev_co_u32 v9, s[74:75], 2.0, v9
    v_subrev_co_u32 v10, s[76:77], 2.0, v10
    v_subrev_co_u32 v11, s[78:79], 2.0, v11
    s_mov_b64 exec, s[72:73]
    ds_read_b64 v[36:37], v36
    s_mov_b64 exec, s[74:75]
    ds_read_b64 v[38:39], v38
    s_mov_b64 exec, s[76:77]
    ds_read_b64 v[40:41], v40
    s_mov_b64 exec, s[78:79]
    ds_read_b64 v[42:43], v42
    s_mov_b64 exec, -1
    s_mov_b32 s38, s5
    s_add_u32 s50, s50, 200000
    s_branch L_batch_78
L_bend_79:

    s_waitcnt vmcnt(0)
    s_load_dwordx2 s[68:69], s[0:1], 24
    s_load_dwordx4 s[88:91], s[0:1], 72
    s_load_dwordx2 s[76:77], s[0:1], 88
    s_load_dwordx2 s[80:81], s[0:1], 96
    s_mov_b32 s70, 1600000
    s_mov_b32 s71, 0x20000
    s_mov_b32 s78, 6400000
    s_mov_b32 s79, 0x20000
    s_movk_i32 s82, 256
    s_mov_b32 s83, 0x20000
    s_lshl_b32 s48, s36, 2
    s_mov_b32 s41, s37

    s_add_u32 s84, s6, 8896512
    s_addc_u32 s85, s7, 0
    s_mov_b32 s86, 76800000
    s_mov_b32 s87, 0x20000
    s_add_u32 s72, s6, 393216
    s_addc_u32 s73, s7, 0
    s_mov_b32 s74, 2097152
    s_mov_b32 s75, 0x20000
    s_waitcnt lgkmcnt(15)
    v_mad_i32_i16 v120, v28, v4, s96
    v_mad_i32_i16 v28, v28, v4, s96 op_sel:[1,0,0,0]
    v_mad_i32_i16 v121, v29, v4, s96
    v_mad_i32_i16 v29, v29, v4, s96 op_sel:[1,0,0,0]
    v_lshlrev_b32_sdwa v4, 3, v4 dst_sel:DWORD dst_unused:UNUSED_PAD src0_sel:DWORD src1_sel:WORD_1
    v_perm_b32 v28, v28, v120, s97
    v_perm_b32 v29, v29, v121, s97
    v_lshl_add_u64 v[28:29], v[28:29], 0, s[30:31]

    ds_add_rtn_u64 v[28:29], v4, v[28:29] offset:50000
    v_mad_i32_i16 v122, v30, v5, s96
    v_mad_i32_i16 v30, v30, v5, s96 op_sel:[1,0,0,0]
    v_mad_i32_i16 v123, v31, v5, s96
    v_mad_i32_i16 v31, v31, v5, s96 op_sel:[1,0,0,0]
    v_lshlrev_b32_sdwa v5, 3, v5 dst_sel:DWORD dst_unused:UNUSED_PAD src0_sel:DWORD src1_sel:WORD_1
    v_perm_b32 v30, v30, v122, s97
    v_perm_b32 v31, v31, v123, s97
    v_lshl_add_u64 v[30:31], v[30:31], 0, s[30:31]

    ds_add_rtn_u64 v[30:31], v5, v[30:31] offset:50000
    v_mad_i32_i16 v124, v32, v6, s96
    v_mad_i32_i16 v32, v32, v6, s96 op_sel:[1,0,0,0]
    v_mad_i32_i16 v125, v33, v6, s96
    v_mad_i32_i16 v33, v33, v6, s96 op_sel:[1,0,0,0]
    v_lshlrev_b32_sdwa v6, 3, v6 dst_sel:DWORD dst_unused:UNUSED_PAD src0_sel:DWORD src1_sel:WORD_1
    v_perm_b32 v32, v32, v124, s97
    v_perm_b32 v33, v33, v125, s97
    v_lshl_add_u64 v[32:33], v[32:33], 0, s[30:31]

    ds_add_rtn_u64 v[32:33], v6, v[32:33] offset:50000
    v_mad_i32_i16 v126, v34, v7, s96
    v_mad_i32_i16 v34, v34, v7, s96 op_sel:[1,0,0,0]
    v_mad_i32_i16 v127, v35, v7, s96
    v_mad_i32_i16 v35, v35, v7, s96 op_sel:[1,0,0,0]
    v_lshlrev_b32_sdwa v7, 3, v7 dst_sel:DWORD dst_unused:UNUSED_PAD src0_sel:DWORD src1_sel:WORD_1
    v_perm_b32 v34, v34, v126, s97
    v_perm_b32 v35, v35, v127, s97
    v_lshl_add_u64 v[34:35], v[34:35], 0, s[30:31]

    ds_add_rtn_u64 v[34:35], v7, v[34:35] offset:50000
    s_waitcnt lgkmcnt(0)
    s_load_dwordx8 s[12:19], s[88:89], 0
    s_load_dwordx8 s[56:63], s[90:91], 0

    s_mul_i32 s28, s41, 3125
    s_add_u32 s29, s28, 3126
    s_add_u32 s28, s28, 1
    s_lshr_b32 s28, s28, 1
    s_lshr_b32 s29, s29, 1
    s_sub_u32 s29, s29, s28
    s_sub_u32 s5, s29, 782
    s_mul_i32 s3, s36, 6250
    v_add_u32 v78, s28, v0
    v_mov_b32 v82, 0x2000000
    v_add_u32 v79, 782, v78
    v_cmp_gt_u32 vcc, 782, v0
    v_add_u32 v76, s3, v78
    v_add_u32 v77, s3, v79
    v_cndmask_b32 v76, v82, v76, vcc
    v_cmp_gt_u32 vcc, s5, v0
    v_lshlrev_b32 v78, 4, v78
    v_lshlrev_b32 v79, 4, v79
    v_cndmask_b32 v77, v82, v77, vcc
    v_lshlrev_b32 v80, 2, v76
    v_lshlrev_b32 v76, 4, v76
    v_lshlrev_b32 v81, 2, v77
    v_lshlrev_b32 v77, 4, v77
    buffer_load_dword v80, v80, s[68:71], 0 offen
    buffer_load_dword v81, v81, s[68:71], 0 offen
    buffer_load_dwordx4 v[86:89], v76, s[8:11], 0 offen
    buffer_load_dwordx4 v[90:93], v77, s[8:11], 0 offen

    v_mad_i32_i16 v120, v36, v8, s96
    v_mad_i32_i16 v36, v36, v8, s96 op_sel:[1,0,0,0]
    v_mad_i32_i16 v121, v37, v8, s96
    v_mad_i32_i16 v37, v37, v8, s96 op_sel:[1,0,0,0]
    v_lshlrev_b32_sdwa v8, 3, v8 dst_sel:DWORD dst_unused:UNUSED_PAD src0_sel:DWORD src1_sel:WORD_1
    v_perm_b32 v36, v36, v120, s97
    v_perm_b32 v37, v37, v121, s97
    v_lshl_add_u64 v[36:37], v[36:37], 0, s[30:31]

    ds_add_rtn_u64 v[36:37], v8, v[36:37] offset:50000
    v_mad_i32_i16 v122, v38, v9, s96
    v_mad_i32_i16 v38, v38, v9, s96 op_sel:[1,0,0,0]
    v_mad_i32_i16 v123, v39, v9, s96
    v_mad_i32_i16 v39, v39, v9, s96 op_sel:[1,0,0,0]
    v_lshlrev_b32_sdwa v9, 3, v9 dst_sel:DWORD dst_unused:UNUSED_PAD src0_sel:DWORD src1_sel:WORD_1
    v_perm_b32 v38, v38, v122, s97
    v_perm_b32 v39, v39, v123, s97
    v_lshl_add_u64 v[38:39], v[38:39], 0, s[30:31]

    ds_add_rtn_u64 v[38:39], v9, v[38:39] offset:50000
    v_mad_i32_i16 v124, v40, v10, s96
    v_mad_i32_i16 v40, v40, v10, s96 op_sel:[1,0,0,0]
    v_mad_i32_i16 v125, v41, v10, s96
    v_mad_i32_i16 v41, v41, v10, s96 op_sel:[1,0,0,0]
    v_lshlrev_b32_sdwa v10, 3, v10 dst_sel:DWORD dst_unused:UNUSED_PAD src0_sel:DWORD src1_sel:WORD_1
    v_perm_b32 v40, v40, v124, s97
    v_perm_b32 v41, v41, v125, s97
    v_lshl_add_u64 v[40:41], v[40:41], 0, s[30:31]

    ds_add_rtn_u64 v[40:41], v10, v[40:41] offset:50000
    v_mad_i32_i16 v126, v42, v11, s96
    v_mad_i32_i16 v42, v42, v11, s96 op_sel:[1,0,0,0]
    v_mad_i32_i16 v127, v43, v11, s96
    v_mad_i32_i16 v43, v43, v11, s96 op_sel:[1,0,0,0]
    v_lshlrev_b32_sdwa v11, 3, v11 dst_sel:DWORD dst_unused:UNUSED_PAD src0_sel:DWORD src1_sel:WORD_1
    v_perm_b32 v42, v42, v126, s97
    v_perm_b32 v43, v43, v127, s97
    v_lshl_add_u64 v[42:43], v[42:43], 0, s[30:31]

    ds_add_rtn_u64 v[42:43], v11, v[42:43] offset:50000
    v_or3_b32 v1, v28, v29, v1
    v_or3_b32 v1, v30, v31, v1
    v_or3_b32 v1, v32, v33, v1
    v_or3_b32 v1, v34, v35, v1
    v_mad_i32_i16 v120, v44, v12, s96
    v_mad_i32_i16 v44, v44, v12, s96 op_sel:[1,0,0,0]
    v_mad_i32_i16 v121, v45, v12, s96
    v_mad_i32_i16 v45, v45, v12, s96 op_sel:[1,0,0,0]
    v_lshlrev_b32_sdwa v12, 3, v12 dst_sel:DWORD dst_unused:UNUSED_PAD src0_sel:DWORD src1_sel:WORD_1
    v_perm_b32 v44, v44, v120, s97
    v_perm_b32 v45, v45, v121, s97
    v_lshl_add_u64 v[44:45], v[44:45], 0, s[30:31]

    ds_add_rtn_u64 v[44:45], v12, v[44:45] offset:50000
    v_mad_i32_i16 v122, v46, v13, s96
    v_mad_i32_i16 v46, v46, v13, s96 op_sel:[1,0,0,0]
    v_mad_i32_i16 v123, v47, v13, s96
    v_mad_i32_i16 v47, v47, v13, s96 op_sel:[1,0,0,0]
    v_lshlrev_b32_sdwa v13, 3, v13 dst_sel:DWORD dst_unused:UNUSED_PAD src0_sel:DWORD src1_sel:WORD_1
    v_perm_b32 v46, v46, v122, s97
    v_perm_b32 v47, v47, v123, s97
    v_lshl_add_u64 v[46:47], v[46:47], 0, s[30:31]

    ds_add_rtn_u64 v[46:47], v13, v[46:47] offset:50000
    v_mad_i32_i16 v124, v48, v14, s96
    v_mad_i32_i16 v48, v48, v14, s96 op_sel:[1,0,0,0]
    v_mad_i32_i16 v125, v49, v14, s96
    v_mad_i32_i16 v49, v49, v14, s96 op_sel:[1,0,0,0]
    v_lshlrev_b32_sdwa v14, 3, v14 dst_sel:DWORD dst_unused:UNUSED_PAD src0_sel:DWORD src1_sel:WORD_1
    v_perm_b32 v48, v48, v124, s97
    v_perm_b32 v49, v49, v125, s97
    v_lshl_add_u64 v[48:49], v[48:49], 0, s[30:31]

    ds_add_rtn_u64 v[48:49], v14, v[48:49] offset:50000
    v_mad_i32_i16 v126, v50, v15, s96
    v_mad_i32_i16 v50, v50, v15, s96 op_sel:[1,0,0,0]
    v_mad_i32_i16 v127, v51, v15, s96
    v_mad_i32_i16 v51, v51, v15, s96 op_sel:[1,0,0,0]
    v_lshlrev_b32_sdwa v15, 3, v15 dst_sel:DWORD dst_unused:UNUSED_PAD src0_sel:DWORD src1_sel:WORD_1
    v_perm_b32 v50, v50, v126, s97
    v_perm_b32 v51, v51, v127, s97
    v_lshl_add_u64 v[50:51], v[50:51], 0, s[30:31]

    ds_add_rtn_u64 v[50:51], v15, v[50:51] offset:50000
    s_waitcnt lgkmcnt(4)
    v_or3_b32 v1, v36, v37, v1
    v_or3_b32 v1, v38, v39, v1
    v_or3_b32 v1, v40, v41, v1
    v_or3_b32 v1, v42, v43, v1
    v_mad_i32_i16 v120, v52, v16, s96
    v_mad_i32_i16 v52, v52, v16, s96 op_sel:[1,0,0,0]
    v_mad_i32_i16 v121, v53, v16, s96
    v_mad_i32_i16 v53, v53, v16, s96 op_sel:[1,0,0,0]
    v_lshlrev_b32_sdwa v16, 3, v16 dst_sel:DWORD dst_unused:UNUSED_PAD src0_sel:DWORD src1_sel:WORD_1
    v_perm_b32 v52, v52, v120, s97
    v_perm_b32 v53, v53, v121, s97
    v_lshl_add_u64 v[52:53], v[52:53], 0, s[30:31]

    ds_add_rtn_u64 v[52:53], v16, v[52:53] offset:50000
    v_mad_i32_i16 v122, v54, v17, s96
    v_mad_i32_i16 v54, v54, v17, s96 op_sel:[1,0,0,0]
    v_mad_i32_i16 v123, v55, v17, s96
    v_mad_i32_i16 v55, v55, v17, s96 op_sel:[1,0,0,0]
    v_lshlrev_b32_sdwa v17, 3, v17 dst_sel:DWORD dst_unused:UNUSED_PAD src0_sel:DWORD src1_sel:WORD_1
    v_perm_b32 v54, v54, v122, s97
    v_perm_b32 v55, v55, v123, s97
    v_lshl_add_u64 v[54:55], v[54:55], 0, s[30:31]

    ds_add_rtn_u64 v[54:55], v17, v[54:55] offset:50000
    v_mad_i32_i16 v124, v56, v18, s96
    v_mad_i32_i16 v56, v56, v18, s96 op_sel:[1,0,0,0]
    v_mad_i32_i16 v125, v57, v18, s96
    v_mad_i32_i16 v57, v57, v18, s96 op_sel:[1,0,0,0]
    v_lshlrev_b32_sdwa v18, 3, v18 dst_sel:DWORD dst_unused:UNUSED_PAD src0_sel:DWORD src1_sel:WORD_1
    v_perm_b32 v56, v56, v124, s97
    v_perm_b32 v57, v57, v125, s97
    v_lshl_add_u64 v[56:57], v[56:57], 0, s[30:31]

    ds_add_rtn_u64 v[56:57], v18, v[56:57] offset:50000
    v_mad_i32_i16 v126, v58, v19, s96
    v_mad_i32_i16 v58, v58, v19, s96 op_sel:[1,0,0,0]
    v_mad_i32_i16 v127, v59, v19, s96
    v_mad_i32_i16 v59, v59, v19, s96 op_sel:[1,0,0,0]
    v_lshlrev_b32_sdwa v19, 3, v19 dst_sel:DWORD dst_unused:UNUSED_PAD src0_sel:DWORD src1_sel:WORD_1
    v_perm_b32 v58, v58, v126, s97
    v_perm_b32 v59, v59, v127, s97
    v_lshl_add_u64 v[58:59], v[58:59], 0, s[30:31]

    ds_add_rtn_u64 v[58:59], v19, v[58:59] offset:50000
    s_waitcnt lgkmcnt(4)
    v_or3_b32 v1, v44, v45, v1
    v_or3_b32 v1, v46, v47, v1
    v_or3_b32 v1, v48, v49, v1
    v_or3_b32 v1, v50, v51, v1
    s_waitcnt vmcnt(2)
    v_lshlrev_b32_sdwa v82, 5, v80 dst_sel:DWORD dst_unused:UNUSED_PAD src0_sel:DWORD src1_sel:WORD_0
    v_lshlrev_b32_sdwa v83, 5, v80 dst_sel:DWORD dst_unused:UNUSED_PAD src0_sel:DWORD src1_sel:WORD_1
    v_lshlrev_b32_sdwa v84, 5, v81 dst_sel:DWORD dst_unused:UNUSED_PAD src0_sel:DWORD src1_sel:WORD_0
    v_lshlrev_b32_sdwa v85, 5, v81 dst_sel:DWORD dst_unused:UNUSED_PAD src0_sel:DWORD src1_sel:WORD_1
    buffer_load_dwordx4 v[94:97], v82, s[72:75], 0 offen
    buffer_load_dwordx2 v[110:111], v82, s[72:75], 0 offen offset:16

    buffer_load_dwordx4 v[98:101], v83, s[72:75], 0 offen
    buffer_load_dwordx2 v[112:113], v83, s[72:75], 0 offen offset:16

    buffer_load_dwordx4 v[102:105], v84, s[72:75], 0 offen
    buffer_load_dwordx2 v[114:115], v84, s[72:75], 0 offen offset:16

    buffer_load_dwordx4 v[106:109], v85, s[72:75], 0 offen
    buffer_load_dwordx2 v[116:117], v85, s[72:75], 0 offen offset:16

    v_mad_i32_i16 v120, v60, v20, s96
    v_mad_i32_i16 v60, v60, v20, s96 op_sel:[1,0,0,0]
    v_mad_i32_i16 v121, v61, v20, s96
    v_mad_i32_i16 v61, v61, v20, s96 op_sel:[1,0,0,0]
    v_lshlrev_b32_sdwa v20, 3, v20 dst_sel:DWORD dst_unused:UNUSED_PAD src0_sel:DWORD src1_sel:WORD_1
    v_perm_b32 v60, v60, v120, s97
    v_perm_b32 v61, v61, v121, s97
    v_lshl_add_u64 v[60:61], v[60:61], 0, s[30:31]

    ds_add_rtn_u64 v[60:61], v20, v[60:61] offset:50000
    v_mad_i32_i16 v122, v62, v21, s96
    v_mad_i32_i16 v62, v62, v21, s96 op_sel:[1,0,0,0]
    v_mad_i32_i16 v123, v63, v21, s96
    v_mad_i32_i16 v63, v63, v21, s96 op_sel:[1,0,0,0]
    v_lshlrev_b32_sdwa v21, 3, v21 dst_sel:DWORD dst_unused:UNUSED_PAD src0_sel:DWORD src1_sel:WORD_1
    v_perm_b32 v62, v62, v122, s97
    v_perm_b32 v63, v63, v123, s97
    v_lshl_add_u64 v[62:63], v[62:63], 0, s[30:31]

    ds_add_rtn_u64 v[62:63], v21, v[62:63] offset:50000
    v_mad_i32_i16 v124, v64, v22, s96
    v_mad_i32_i16 v64, v64, v22, s96 op_sel:[1,0,0,0]
    v_mad_i32_i16 v125, v65, v22, s96
    v_mad_i32_i16 v65, v65, v22, s96 op_sel:[1,0,0,0]
    v_lshlrev_b32_sdwa v22, 3, v22 dst_sel:DWORD dst_unused:UNUSED_PAD src0_sel:DWORD src1_sel:WORD_1
    v_perm_b32 v64, v64, v124, s97
    v_perm_b32 v65, v65, v125, s97
    v_lshl_add_u64 v[64:65], v[64:65], 0, s[30:31]

    ds_add_rtn_u64 v[64:65], v22, v[64:65] offset:50000
    v_mad_i32_i16 v126, v66, v23, s96
    v_mad_i32_i16 v66, v66, v23, s96 op_sel:[1,0,0,0]
    v_mad_i32_i16 v127, v67, v23, s96
    v_mad_i32_i16 v67, v67, v23, s96 op_sel:[1,0,0,0]
    v_lshlrev_b32_sdwa v23, 3, v23 dst_sel:DWORD dst_unused:UNUSED_PAD src0_sel:DWORD src1_sel:WORD_1
    v_perm_b32 v66, v66, v126, s97
    v_perm_b32 v67, v67, v127, s97
    v_lshl_add_u64 v[66:67], v[66:67], 0, s[30:31]

    ds_add_rtn_u64 v[66:67], v23, v[66:67] offset:50000
    s_waitcnt lgkmcnt(4)
    v_or3_b32 v1, v52, v53, v1
    v_or3_b32 v1, v54, v55, v1
    v_or3_b32 v1, v56, v57, v1
    v_or3_b32 v1, v58, v59, v1
    v_mad_i32_i16 v120, v68, v24, s96
    v_mad_i32_i16 v68, v68, v24, s96 op_sel:[1,0,0,0]
    v_mad_i32_i16 v121, v69, v24, s96
    v_mad_i32_i16 v69, v69, v24, s96 op_sel:[1,0,0,0]
    v_lshlrev_b32_sdwa v24, 3, v24 dst_sel:DWORD dst_unused:UNUSED_PAD src0_sel:DWORD src1_sel:WORD_1
    v_perm_b32 v68, v68, v120, s97
    v_perm_b32 v69, v69, v121, s97
    v_lshl_add_u64 v[68:69], v[68:69], 0, s[30:31]

    ds_add_rtn_u64 v[68:69], v24, v[68:69] offset:50000
    v_mad_i32_i16 v122, v70, v25, s96
    v_mad_i32_i16 v70, v70, v25, s96 op_sel:[1,0,0,0]
    v_mad_i32_i16 v123, v71, v25, s96
    v_mad_i32_i16 v71, v71, v25, s96 op_sel:[1,0,0,0]
    v_lshlrev_b32_sdwa v25, 3, v25 dst_sel:DWORD dst_unused:UNUSED_PAD src0_sel:DWORD src1_sel:WORD_1
    v_perm_b32 v70, v70, v122, s97
    v_perm_b32 v71, v71, v123, s97
    v_lshl_add_u64 v[70:71], v[70:71], 0, s[30:31]

    ds_add_rtn_u64 v[70:71], v25, v[70:71] offset:50000
    v_mad_i32_i16 v124, v72, v26, s96
    v_mad_i32_i16 v72, v72, v26, s96 op_sel:[1,0,0,0]
    v_mad_i32_i16 v125, v73, v26, s96
    v_mad_i32_i16 v73, v73, v26, s96 op_sel:[1,0,0,0]
    v_lshlrev_b32_sdwa v26, 3, v26 dst_sel:DWORD dst_unused:UNUSED_PAD src0_sel:DWORD src1_sel:WORD_1
    v_perm_b32 v72, v72, v124, s97
    v_perm_b32 v73, v73, v125, s97
    v_lshl_add_u64 v[72:73], v[72:73], 0, s[30:31]

    ds_add_rtn_u64 v[72:73], v26, v[72:73] offset:50000
    v_mad_i32_i16 v126, v74, v27, s96
    v_mad_i32_i16 v74, v74, v27, s96 op_sel:[1,0,0,0]
    v_mad_i32_i16 v127, v75, v27, s96
    v_mad_i32_i16 v75, v75, v27, s96 op_sel:[1,0,0,0]
    v_lshlrev_b32_sdwa v27, 3, v27 dst_sel:DWORD dst_unused:UNUSED_PAD src0_sel:DWORD src1_sel:WORD_1
    v_perm_b32 v74, v74, v126, s97
    v_perm_b32 v75, v75, v127, s97
    v_lshl_add_u64 v[74:75], v[74:75], 0, s[30:31]

    ds_add_rtn_u64 v[74:75], v27, v[74:75] offset:50000
    s_waitcnt lgkmcnt(4)
    v_or3_b32 v1, v60, v61, v1
    v_or3_b32 v1, v62, v63, v1
    v_or3_b32 v1, v64, v65, v1
    v_or3_b32 v1, v66, v67, v1
    s_waitcnt lgkmcnt(0)
    v_or3_b32 v1, v68, v69, v1
    v_or3_b32 v1, v70, v71, v1
    v_or3_b32 v1, v72, v73, v1
    v_or3_b32 v1, v74, v75, v1
    s_barrier

    v_add_u32 v40, 50000, v3
    v_add_u32 v41, 115536, v3
    v_cmp_gt_u32 vcc, 106, v0

    v_mov_b32 v28, 0
    v_mov_b32 v29, 0
    v_mov_b32 v30, 0
    v_mov_b32 v31, 0
    ds_read_b128 v[4:7], v40 offset:0
    ds_read_b128 v[8:11], v40 offset:16384
    ds_read_b128 v[12:15], v40 offset:32768
    ds_read_b128 v[16:19], v40 offset:49152
    ds_read_b128 v[20:23], v41 offset:0
    ds_read_b128 v[24:27], v41 offset:16384
    s_mov_b64 exec, vcc
    ds_read_b128 v[28:31], v41 offset:32768
    s_mov_b64 exec, -1
    s_mul_i32 s3, s37, 6400000
    s_mul_i32 s5, s36, 100000
    s_add_u32 s3, s3, s5
    s_add_u32 s3, s3, 8896512
    v_bfrev_b32 v42, 1

    s_add_u32 s20, s6, s3
    s_addc_u32 s21, s7, 0
    s_mov_b32 s22, 100000
    s_mov_b32 s23, 0x20000
    s_sub_u32 s3, 0, s28
    v_add_u32 v43, s3, v0
    v_cmp_gt_u32 vcc, s29, v43
    s_mov_b32 s3, 0
    s_waitcnt lgkmcnt(6)
    v_cndmask_b32 v43, v3, v42, vcc
    buffer_store_dwordx4 v[4:7], v43, s[20:23], s3 offen sc1

    s_sub_u32 s3, 1024, s28
    v_add_u32 v43, s3, v0
    v_cmp_gt_u32 vcc, s29, v43
    s_mov_b32 s3, 16384
    s_waitcnt lgkmcnt(5)
    v_cndmask_b32 v43, v3, v42, vcc
    buffer_store_dwordx4 v[8:11], v43, s[20:23], s3 offen sc1

    s_sub_u32 s3, 2048, s28
    v_add_u32 v43, s3, v0
    v_cmp_gt_u32 vcc, s29, v43
    s_mov_b32 s3, 32768
    s_waitcnt lgkmcnt(4)
    v_cndmask_b32 v43, v3, v42, vcc
    buffer_store_dwordx4 v[12:15], v43, s[20:23], s3 offen sc1

    s_sub_u32 s3, 3072, s28
    v_add_u32 v43, s3, v0
    v_cmp_gt_u32 vcc, s29, v43
    s_mov_b32 s3, 49152
    s_waitcnt lgkmcnt(3)
    v_cndmask_b32 v43, v3, v42, vcc
    buffer_store_dwordx4 v[16:19], v43, s[20:23], s3 offen sc1

    s_sub_u32 s3, 4096, s28
    v_add_u32 v43, s3, v0
    v_cmp_gt_u32 vcc, s29, v43
    s_mov_b32 s3, 65536
    s_waitcnt lgkmcnt(2)
    v_cndmask_b32 v43, v3, v42, vcc
    buffer_store_dwordx4 v[20:23], v43, s[20:23], s3 offen sc1

    s_sub_u32 s3, 5120, s28
    v_add_u32 v43, s3, v0
    v_cmp_gt_u32 vcc, s29, v43
    s_mov_b32 s3, 81920
    s_waitcnt lgkmcnt(1)
    v_cndmask_b32 v43, v3, v42, vcc
    buffer_store_dwordx4 v[24:27], v43, s[20:23], s3 offen sc1

    s_sub_u32 s3, 6144, s28
    v_add_u32 v43, s3, v0
    v_cmp_gt_u32 vcc, s29, v43
    s_mov_b32 s3, 98304
    s_waitcnt lgkmcnt(0)
    v_cndmask_b32 v43, v3, v42, vcc
    buffer_store_dwordx4 v[28:31], v43, s[20:23], s3 offen sc1

    v_or3_b32 v1, v4, v5, v1
    v_or3_b32 v1, v6, v7, v1
    v_or3_b32 v1, v8, v9, v1
    v_or3_b32 v1, v10, v11, v1
    v_or3_b32 v1, v12, v13, v1
    v_or3_b32 v1, v14, v15, v1
    v_or3_b32 v1, v16, v17, v1
    v_or3_b32 v1, v18, v19, v1
    v_or3_b32 v1, v20, v21, v1
    v_or3_b32 v1, v22, v23, v1
    v_or3_b32 v1, v24, v25, v1
    v_or3_b32 v1, v26, v27, v1
    v_or3_b32 v1, v28, v29, v1
    v_or3_b32 v1, v30, v31, v1
    v_and_b32 v1, 0x80008000, v1
    v_cmp_ne_u32 vcc, 0, v1
    v_mov_b32 v40, 150024
    v_mov_b32 v41, 1
    s_cbranch_vccz L_nf_111
    ds_write_b32 v40, v41
L_nf_111:
    s_mov_b32 s33, 1
    s_mov_b32 s49, s37
    s_waitcnt vmcnt(0) lgkmcnt(0)

    s_barrier
    ds_read_b32 v41, v40
    s_waitcnt lgkmcnt(0)
    v_readfirstlane_b32 s3, v41
    s_nop 1
    s_cmp_lg_u32 s3, 0
    s_cbranch_scc1 L_p2slow_54

L_meet_113:
    v_readfirstlane_b32 s3, v0
    v_mov_b32 v118, 150016
    s_nop 0
    s_cmp_eq_u32 s3, 960
    s_cbranch_scc1 L_sync_120
L_bcast_115:
    s_barrier

    ds_read_b32 v119, v118
    s_waitcnt lgkmcnt(0)
    v_readfirstlane_b32 s35, v119
    s_nop 1
    s_bitcmp1_b32 s35, 16
    s_cbranch_scc1 L_fend_121
L_post_117:
    v_cmp_gt_u32 vcc, 782, v0
    s_mov_b64 exec, vcc
    s_cbranch_execz L_postend_118

    s_cmp_eq_u32 s49, 0
    s_cbranch_scc1 L_own_127
    s_mov_b32 s3, 0
    buffer_load_dwordx4 v[36:39], v76, s[84:87], s3 offen sc1
    buffer_load_dwordx4 v[52:55], v77, s[84:87], s3 offen sc1
L_obk_128:
    s_cmp_eq_u32 s49, 1
    s_cbranch_scc1 L_own_129
    s_mov_b32 s3, 6400000
    buffer_load_dwordx4 v[40:43], v76, s[84:87], s3 offen sc1
    buffer_load_dwordx4 v[56:59], v77, s[84:87], s3 offen sc1
L_obk_130:
    s_cmp_eq_u32 s49, 2
    s_cbranch_scc1 L_own_131
    s_mov_b32 s3, 12800000
    buffer_load_dwordx4 v[44:47], v76, s[84:87], s3 offen sc1
    buffer_load_dwordx4 v[60:63], v77, s[84:87], s3 offen sc1
L_obk_132:
    s_cmp_eq_u32 s49, 3
    s_cbranch_scc1 L_own_133
    s_mov_b32 s3, 19200000
    buffer_load_dwordx4 v[48:51], v76, s[84:87], s3 offen sc1
    buffer_load_dwordx4 v[64:67], v77, s[84:87], s3 offen sc1
L_obk_134:
    s_and_b32 s3, s35, 0xf0
    s_waitcnt vmcnt(0) lgkmcnt(0)
    s_cbranch_scc1 L_fgen_135

    v_add_u32 v36, v36, v40
    v_add_u32 v44, v44, v48
    v_add_u32 v37, v37, v41
    v_add_u32 v45, v45, v49
    v_add_u32 v38, v38, v42
    v_add_u32 v46, v46, v50
    v_add_u32 v39, v39, v43
    v_add_u32 v47, v47, v51
    v_add_u32_sdwa v4, v36, v44 dst_sel:DWORD dst_unused:UNUSED_PAD src0_sel:WORD_0 src1_sel:WORD_0
    v_add_u32_sdwa v5, v36, v44 dst_sel:DWORD dst_unused:UNUSED_PAD src0_sel:WORD_1 src1_sel:WORD_1
    v_add_u32_sdwa v6, v37, v45 dst_sel:DWORD dst_unused:UNUSED_PAD src0_sel:WORD_0 src1_sel:WORD_0
    v_add_u32_sdwa v7, v37, v45 dst_sel:DWORD dst_unused:UNUSED_PAD src0_sel:WORD_1 src1_sel:WORD_1
    v_add_u32_sdwa v8, v38, v46 dst_sel:DWORD dst_unused:UNUSED_PAD src0_sel:WORD_0 src1_sel:WORD_0
    v_add_u32_sdwa v9, v38, v46 dst_sel:DWORD dst_unused:UNUSED_PAD src0_sel:WORD_1 src1_sel:WORD_1
    v_add_u32_sdwa v10, v39, v47 dst_sel:DWORD dst_unused:UNUSED_PAD src0_sel:WORD_0 src1_sel:WORD_0
    v_add_u32_sdwa v11, v39, v47 dst_sel:DWORD dst_unused:UNUSED_PAD src0_sel:WORD_1 src1_sel:WORD_1
    v_add_u32 v52, v52, v56
    v_add_u32 v60, v60, v64
    v_add_u32 v53, v53, v57
    v_add_u32 v61, v61, v65
    v_add_u32 v54, v54, v58
    v_add_u32 v62, v62, v66
    v_add_u32 v55, v55, v59
    v_add_u32 v63, v63, v67
    v_add_u32_sdwa v12, v52, v60 dst_sel:DWORD dst_unused:UNUSED_PAD src0_sel:WORD_0 src1_sel:WORD_0
    v_add_u32_sdwa v13, v52, v60 dst_sel:DWORD dst_unused:UNUSED_PAD src0_sel:WORD_1 src1_sel:WORD_1
    v_add_u32_sdwa v14, v53, v61 dst_sel:DWORD dst_unused:UNUSED_PAD src0_sel:WORD_0 src1_sel:WORD_0
    v_add_u32_sdwa v15, v53, v61 dst_sel:DWORD dst_unused:UNUSED_PAD src0_sel:WORD_1 src1_sel:WORD_1
    v_add_u32_sdwa v16, v54, v62 dst_sel:DWORD dst_unused:UNUSED_PAD src0_sel:WORD_0 src1_sel:WORD_0
    v_add_u32_sdwa v17, v54, v62 dst_sel:DWORD dst_unused:UNUSED_PAD src0_sel:WORD_1 src1_sel:WORD_1
    v_add_u32_sdwa v18, v55, v63 dst_sel:DWORD dst_unused:UNUSED_PAD src0_sel:WORD_0 src1_sel:WORD_0
    v_add_u32_sdwa v19, v55, v63 dst_sel:DWORD dst_unused:UNUSED_PAD src0_sel:WORD_1 src1_sel:WORD_1
    v_add_u32 v4, 0xffff0000, v4
    v_add_u32 v5, 0xffff0000, v5
    v_add_u32 v6, 0xffff0000, v6
    v_add_u32 v7, 0xffff0000, v7
    v_add_u32 v8, 0xffff0000, v8
    v_add_u32 v9, 0xffff0000, v9
    v_add_u32 v10, 0xffff0000, v10
    v_add_u32 v11, 0xffff0000, v11
    v_add_u32 v12, 0xffff0000, v12
    v_add_u32 v13, 0xffff0000, v13
    v_add_u32 v14, 0xffff0000, v14
    v_add_u32 v15, 0xffff0000, v15
    v_add_u32 v16, 0xffff0000, v16
    v_add_u32 v17, 0xffff0000, v17
    v_add_u32 v18, 0xffff0000, v18
    v_add_u32 v19, 0xffff0000, v19
    v_cvt_f32_i32 v4, v4
    v_cvt_f32_i32 v5, v5
    v_cvt_f32_i32 v6, v6
    v_cvt_f32_i32 v7, v7
    v_cvt_f32_i32 v8, v8
    v_cvt_f32_i32 v9, v9
    v_cvt_f32_i32 v10, v10
    v_cvt_f32_i32 v11, v11
    v_cvt_f32_i32 v12, v12
    v_cvt_f32_i32 v13, v13
    v_cvt_f32_i32 v14, v14
    v_cvt_f32_i32 v15, v15
    v_cvt_f32_i32 v16, v16
    v_cvt_f32_i32 v17, v17
    v_cvt_f32_i32 v18, v18
    v_cvt_f32_i32 v19, v19
    v_mul_f32 v4, s34, v4
    v_mul_f32 v5, s34, v5
    v_mul_f32 v6, s34, v6
    v_mul_f32 v7, s34, v7
    v_mul_f32 v8, s34, v8
    v_mul_f32 v9, s34, v9
    v_mul_f32 v10, s34, v10
    v_mul_f32 v11, s34, v11
    v_mul_f32 v12, s34, v12
    v_mul_f32 v13, s34, v13
    v_mul_f32 v14, s34, v14
    v_mul_f32 v15, s34, v15
    v_mul_f32 v16, s34, v16
    v_mul_f32 v17, s34, v17
    v_mul_f32 v18, s34, v18
    v_mul_f32 v19, s34, v19
L_fbk_136:
    s_lshl_b32 s52, s12, 16
    v_mul_f32 v20, s52, v4
    v_mul_f32 v24, s52, v8
    v_mul_f32 v28, s52, v12
    v_mul_f32 v32, s52, v16
    s_and_b32 s53, s12, s32
    v_mul_f32 v21, s53, v4
    v_mul_f32 v25, s53, v8
    v_mul_f32 v29, s53, v12
    v_mul_f32 v33, s53, v16
    s_lshl_b32 s52, s13, 16
    v_mul_f32 v22, s52, v4
    v_mul_f32 v26, s52, v8
    v_mul_f32 v30, s52, v12
    v_mul_f32 v34, s52, v16
    s_and_b32 s53, s13, s32
    v_mul_f32 v23, s53, v4
    v_mul_f32 v27, s53, v8
    v_mul_f32 v31, s53, v12
    v_mul_f32 v35, s53, v16
    s_lshl_b32 s52, s14, 16
    v_fmac_f32 v20, s52, v5
    v_fmac_f32 v24, s52, v9
    v_fmac_f32 v28, s52, v13
    v_fmac_f32 v32, s52, v17
    s_and_b32 s53, s14, s32
    v_fmac_f32 v21, s53, v5
    v_fmac_f32 v25, s53, v9
    v_fmac_f32 v29, s53, v13
    v_fmac_f32 v33, s53, v17
    s_lshl_b32 s52, s15, 16
    v_fmac_f32 v22, s52, v5
    v_fmac_f32 v26, s52, v9
    v_fmac_f32 v30, s52, v13
    v_fmac_f32 v34, s52, v17
    s_and_b32 s53, s15, s32
    v_fmac_f32 v23, s53, v5
    v_fmac_f32 v27, s53, v9
    v_fmac_f32 v31, s53, v13
    v_fmac_f32 v35, s53, v17
    s_lshl_b32 s52, s16, 16
    v_fmac_f32 v20, s52, v6
    v_fmac_f32 v24, s52, v10
    v_fmac_f32 v28, s52, v14
    v_fmac_f32 v32, s52, v18
    s_and_b32 s53, s16, s32
    v_fmac_f32 v21, s53, v6
    v_fmac_f32 v25, s53, v10
    v_fmac_f32 v29, s53, v14
    v_fmac_f32 v33, s53, v18
    s_lshl_b32 s52, s17, 16
    v_fmac_f32 v22, s52, v6
    v_fmac_f32 v26, s52, v10
    v_fmac_f32 v30, s52, v14
    v_fmac_f32 v34, s52, v18
    s_and_b32 s53, s17, s32
    v_fmac_f32 v23, s53, v6
    v_fmac_f32 v27, s53, v10
    v_fmac_f32 v31, s53, v14
    v_fmac_f32 v35, s53, v18
    s_lshl_b32 s52, s18, 16
    v_fmac_f32 v20, s52, v7
    v_fmac_f32 v24, s52, v11
    v_fmac_f32 v28, s52, v15
    v_fmac_f32 v32, s52, v19
    s_and_b32 s53, s18, s32
    v_fmac_f32 v21, s53, v7
    v_fmac_f32 v25, s53, v11
    v_fmac_f32 v29, s53, v15
    v_fmac_f32 v33, s53, v19
    s_lshl_b32 s52, s19, 16
    v_fmac_f32 v22, s52, v7
    v_fmac_f32 v26, s52, v11
    v_fmac_f32 v30, s52, v15
    v_fmac_f32 v34, s52, v19
    s_and_b32 s53, s19, s32
    v_fmac_f32 v23, s53, v7
    v_fmac_f32 v27, s53, v11
    v_fmac_f32 v31, s53, v15
    v_fmac_f32 v35, s53, v19
    v_mul_f32 v20, v20, v94
    v_mul_f32 v21, v21, v95
    v_mul_f32 v22, v22, v96
    v_mul_f32 v23, v23, v97
    v_mul_f32 v24, v24, v98
    v_mul_f32 v25, v25, v99
    v_mul_f32 v26, v26, v100
    v_mul_f32 v27, v27, v101
    v_mul_f32 v28, v28, v102
    v_mul_f32 v29, v29, v103
    v_mul_f32 v30, v30, v104
    v_mul_f32 v31, v31, v105
    v_mul_f32 v32, v32, v106
    v_mul_f32 v33, v33, v107
    v_mul_f32 v34, v34, v108
    v_mul_f32 v35, v35, v109
    v_cvt_pk_bf16_f32 v20, v20, v21
    v_cvt_pk_bf16_f32 v22, v22, v23
    v_cvt_pk_bf16_f32 v24, v24, v25
    v_cvt_pk_bf16_f32 v26, v26, v27
    v_cvt_pk_bf16_f32 v28, v28, v29
    v_cvt_pk_bf16_f32 v30, v30, v31
    v_cvt_pk_bf16_f32 v32, v32, v33
    v_cvt_pk_bf16_f32 v34, v34, v35
    s_pack_ll_b32_b16 s52, s56, s58
    v_dot2_f32_bf16 v4, v20, s52, 0
    v_dot2_f32_bf16 v8, v24, s52, 0
    v_dot2_f32_bf16 v12, v28, s52, 0
    v_dot2_f32_bf16 v16, v32, s52, 0
    s_pack_hh_b32_b16 s53, s56, s58
    v_dot2_f32_bf16 v5, v20, s53, 0
    v_dot2_f32_bf16 v9, v24, s53, 0
    v_dot2_f32_bf16 v13, v28, s53, 0
    v_dot2_f32_bf16 v17, v32, s53, 0
    s_pack_ll_b32_b16 s52, s57, s59
    v_dot2_f32_bf16 v6, v20, s52, 0
    v_dot2_f32_bf16 v10, v24, s52, 0
    v_dot2_f32_bf16 v14, v28, s52, 0
    v_dot2_f32_bf16 v18, v32, s52, 0
    s_pack_hh_b32_b16 s53, s57, s59
    v_dot2_f32_bf16 v7, v20, s53, 0
    v_dot2_f32_bf16 v11, v24, s53, 0
    v_dot2_f32_bf16 v15, v28, s53, 0
    v_dot2_f32_bf16 v19, v32, s53, 0
    s_pack_ll_b32_b16 s52, s60, s62
    v_dot2_f32_bf16 v4, v22, s52, v4
    v_dot2_f32_bf16 v8, v26, s52, v8
    v_dot2_f32_bf16 v12, v30, s52, v12
    v_dot2_f32_bf16 v16, v34, s52, v16
    s_pack_hh_b32_b16 s53, s60, s62
    v_dot2_f32_bf16 v5, v22, s53, v5
    v_dot2_f32_bf16 v9, v26, s53, v9
    v_dot2_f32_bf16 v13, v30, s53, v13
    v_dot2_f32_bf16 v17, v34, s53, v17
    s_pack_ll_b32_b16 s52, s61, s63
    v_dot2_f32_bf16 v6, v22, s52, v6
    v_dot2_f32_bf16 v10, v26, s52, v10
    v_dot2_f32_bf16 v14, v30, s52, v14
    v_dot2_f32_bf16 v18, v34, s52, v18
    s_pack_hh_b32_b16 s53, s61, s63
    v_dot2_f32_bf16 v7, v22, s53, v7
    v_dot2_f32_bf16 v11, v26, s53, v11
    v_dot2_f32_bf16 v15, v30, s53, v15
    v_dot2_f32_bf16 v19, v34, s53, v19
    v_lshlrev_b32 v36, 16, v86
    v_and_b32 v37, s32, v86
    v_lshlrev_b32 v52, 16, v110
    v_and_b32 v53, s32, v110
    v_lshlrev_b32 v38, 16, v87
    v_and_b32 v39, s32, v87
    v_lshlrev_b32 v54, 16, v111
    v_and_b32 v55, s32, v111
    v_lshlrev_b32 v40, 16, v88
    v_and_b32 v41, s32, v88
    v_lshlrev_b32 v56, 16, v112
    v_and_b32 v57, s32, v112
    v_lshlrev_b32 v42, 16, v89
    v_and_b32 v43, s32, v89
    v_lshlrev_b32 v58, 16, v113
    v_and_b32 v59, s32, v113
    v_lshlrev_b32 v44, 16, v90
    v_and_b32 v45, s32, v90
    v_lshlrev_b32 v60, 16, v114
    v_and_b32 v61, s32, v114
    v_lshlrev_b32 v46, 16, v91
    v_and_b32 v47, s32, v91
    v_lshlrev_b32 v62, 16, v115
    v_and_b32 v63, s32, v115
    v_lshlrev_b32 v48, 16, v92
    v_and_b32 v49, s32, v92
    v_lshlrev_b32 v64, 16, v116
    v_and_b32 v65, s32, v116
    v_lshlrev_b32 v50, 16, v93
    v_and_b32 v51, s32, v93
    v_lshlrev_b32 v66, 16, v117
    v_and_b32 v67, s32, v117
    v_cvt_pk_bf16_f32 v4, v4, v5
    v_cvt_pk_bf16_f32 v6, v6, v7
    v_cvt_pk_bf16_f32 v8, v8, v9
    v_cvt_pk_bf16_f32 v10, v10, v11
    v_cvt_pk_bf16_f32 v12, v12, v13
    v_cvt_pk_bf16_f32 v14, v14, v15
    v_cvt_pk_bf16_f32 v16, v16, v17
    v_cvt_pk_bf16_f32 v18, v18, v19
    v_and_b32 v5, s32, v4
    v_lshlrev_b32 v4, 16, v4
    v_and_b32 v7, s32, v6
    v_lshlrev_b32 v6, 16, v6
    v_and_b32 v9, s32, v8
    v_lshlrev_b32 v8, 16, v8
    v_and_b32 v11, s32, v10
    v_lshlrev_b32 v10, 16, v10
    v_and_b32 v13, s32, v12
    v_lshlrev_b32 v12, 16, v12
    v_and_b32 v15, s32, v14
    v_lshlrev_b32 v14, 16, v14
    v_and_b32 v17, s32, v16
    v_lshlrev_b32 v16, 16, v16
    v_and_b32 v19, s32, v18
    v_lshlrev_b32 v18, 16, v18
    v_mul_f32 v4, v4, v52
    v_mul_f32 v5, v5, v53
    v_mul_f32 v6, v6, v54
    v_mul_f32 v7, v7, v55
    v_mul_f32 v8, v8, v56
    v_mul_f32 v9, v9, v57
    v_mul_f32 v10, v10, v58
    v_mul_f32 v11, v11, v59
    v_mul_f32 v12, v12, v60
    v_mul_f32 v13, v13, v61
    v_mul_f32 v14, v14, v62
    v_mul_f32 v15, v15, v63
    v_mul_f32 v16, v16, v64
    v_mul_f32 v17, v17, v65
    v_mul_f32 v18, v18, v66
    v_mul_f32 v19, v19, v67
    v_cvt_pk_bf16_f32 v4, v4, v5
    v_cvt_pk_bf16_f32 v6, v6, v7
    v_cvt_pk_bf16_f32 v8, v8, v9
    v_cvt_pk_bf16_f32 v10, v10, v11
    v_cvt_pk_bf16_f32 v12, v12, v13
    v_cvt_pk_bf16_f32 v14, v14, v15
    v_cvt_pk_bf16_f32 v16, v16, v17
    v_cvt_pk_bf16_f32 v18, v18, v19
    v_and_b32 v5, s32, v4
    v_lshlrev_b32 v4, 16, v4
    v_and_b32 v7, s32, v6
    v_lshlrev_b32 v6, 16, v6
    v_and_b32 v9, s32, v8
    v_lshlrev_b32 v8, 16, v8
    v_and_b32 v11, s32, v10
    v_lshlrev_b32 v10, 16, v10
    v_and_b32 v13, s32, v12
    v_lshlrev_b32 v12, 16, v12
    v_and_b32 v15, s32, v14
    v_lshlrev_b32 v14, 16, v14
    v_and_b32 v17, s32, v16
    v_lshlrev_b32 v16, 16, v16
    v_and_b32 v19, s32, v18
    v_lshlrev_b32 v18, 16, v18
    v_add_f32 v4, v4, v36
    v_add_f32 v5, v5, v37
    v_add_f32 v6, v6, v38
    v_add_f32 v7, v7, v39
    v_add_f32 v8, v8, v40
    v_add_f32 v9, v9, v41
    v_add_f32 v10, v10, v42
    v_add_f32 v11, v11, v43
    v_add_f32 v12, v12, v44
    v_add_f32 v13, v13, v45
    v_add_f32 v14, v14, v46
    v_add_f32 v15, v15, v47
    v_add_f32 v16, v16, v48
    v_add_f32 v17, v17, v49
    v_add_f32 v18, v18, v50
    v_add_f32 v19, v19, v51
    v_cvt_pk_bf16_f32 v20, v4, v5
    v_cvt_pk_bf16_f32 v21, v6, v7
    v_cvt_pk_bf16_f32 v22, v8, v9
    v_cvt_pk_bf16_f32 v23, v10, v11
    v_cvt_pk_bf16_f32 v24, v12, v13
    v_cvt_pk_bf16_f32 v25, v14, v15
    v_cvt_pk_bf16_f32 v26, v16, v17
    v_cvt_pk_bf16_f32 v27, v18, v19
    buffer_store_dwordx4 v[20:23], v76, s[76:79], 0 offen
    buffer_store_dwordx4 v[24:27], v77, s[76:79], 0 offen
L_postend_118:
    s_mov_b64 exec, -1

    s_bfe_u32 s3, s35, 0x40008
    s_cbranch_scc0 L_fend_121
    s_ff1_i32_b32 s41, s3
    s_add_u32 s3, s41, 8
    s_bitset0_b32 s35, s3
    s_mov_b32 s49, -1

    s_mul_i32 s28, s41, 3125
    s_add_u32 s29, s28, 3126
    s_add_u32 s28, s28, 1
    s_lshr_b32 s28, s28, 1
    s_lshr_b32 s29, s29, 1
    s_sub_u32 s29, s29, s28
    s_sub_u32 s5, s29, 782
    s_mul_i32 s3, s36, 6250
    v_add_u32 v78, s28, v0
    v_mov_b32 v82, 0x2000000
    v_add_u32 v79, 782, v78
    v_cmp_gt_u32 vcc, 782, v0
    v_add_u32 v76, s3, v78
    v_add_u32 v77, s3, v79
    v_cndmask_b32 v76, v82, v76, vcc
    v_cmp_gt_u32 vcc, s5, v0
    v_lshlrev_b32 v78, 4, v78
    v_lshlrev_b32 v79, 4, v79
    v_cndmask_b32 v77, v82, v77, vcc
    v_lshlrev_b32 v80, 2, v76
    v_lshlrev_b32 v76, 4, v76
    v_lshlrev_b32 v81, 2, v77
    v_lshlrev_b32 v77, 4, v77
    buffer_load_dword v80, v80, s[68:71], 0 offen
    buffer_load_dword v81, v81, s[68:71], 0 offen
    buffer_load_dwordx4 v[86:89], v76, s[8:11], 0 offen
    buffer_load_dwordx4 v[90:93], v77, s[8:11], 0 offen

    s_waitcnt vmcnt(2)
    v_lshlrev_b32_sdwa v82, 5, v80 dst_sel:DWORD dst_unused:UNUSED_PAD src0_sel:DWORD src1_sel:WORD_0
    v_lshlrev_b32_sdwa v83, 5, v80 dst_sel:DWORD dst_unused:UNUSED_PAD src0_sel:DWORD src1_sel:WORD_1
    v_lshlrev_b32_sdwa v84, 5, v81 dst_sel:DWORD dst_unused:UNUSED_PAD src0_sel:DWORD src1_sel:WORD_0
    v_lshlrev_b32_sdwa v85, 5, v81 dst_sel:DWORD dst_unused:UNUSED_PAD src0_sel:DWORD src1_sel:WORD_1
    buffer_load_dwordx4 v[94:97], v82, s[72:75], 0 offen
    buffer_load_dwordx2 v[110:111], v82, s[72:75], 0 offen offset:16

    buffer_load_dwordx4 v[98:101], v83, s[72:75], 0 offen
    buffer_load_dwordx2 v[112:113], v83, s[72:75], 0 offen offset:16

    buffer_load_dwordx4 v[102:105], v84, s[72:75], 0 offen
    buffer_load_dwordx2 v[114:115], v84, s[72:75], 0 offen offset:16

    buffer_load_dwordx4 v[106:109], v85, s[72:75], 0 offen
    buffer_load_dwordx2 v[116:117], v85, s[72:75], 0 offen offset:16

    s_branch L_post_117
L_fin_112:

    s_load_dwordx2 s[68:69], s[0:1], 24
    s_load_dwordx4 s[88:91], s[0:1], 72
    s_load_dwordx2 s[76:77], s[0:1], 88
    s_load_dwordx2 s[80:81], s[0:1], 96
    s_mov_b32 s70, 1600000
    s_mov_b32 s71, 0x20000
    s_mov_b32 s78, 6400000
    s_mov_b32 s79, 0x20000
    s_movk_i32 s82, 256
    s_mov_b32 s83, 0x20000
    s_lshl_b32 s48, s36, 2
    s_mov_b32 s41, s37

    s_add_u32 s84, s6, 8896512
    s_addc_u32 s85, s7, 0
    s_mov_b32 s86, 76800000
    s_mov_b32 s87, 0x20000
    s_add_u32 s72, s6, 393216
    s_addc_u32 s73, s7, 0
    s_mov_b32 s74, 2097152
    s_mov_b32 s75, 0x20000
    s_mov_b32 s49, -1
    s_waitcnt lgkmcnt(0)
    s_load_dwordx8 s[12:19], s[88:89], 0
    s_load_dwordx8 s[56:63], s[90:91], 0

    s_mul_i32 s28, s41, 3125
    s_add_u32 s29, s28, 3126
    s_add_u32 s28, s28, 1
    s_lshr_b32 s28, s28, 1
    s_lshr_b32 s29, s29, 1
    s_sub_u32 s29, s29, s28
    s_sub_u32 s5, s29, 782
    s_mul_i32 s3, s36, 6250
    v_add_u32 v78, s28, v0
    v_mov_b32 v82, 0x2000000
    v_add_u32 v79, 782, v78
    v_cmp_gt_u32 vcc, 782, v0
    v_add_u32 v76, s3, v78
    v_add_u32 v77, s3, v79
    v_cndmask_b32 v76, v82, v76, vcc
    v_cmp_gt_u32 vcc, s5, v0
    v_lshlrev_b32 v78, 4, v78
    v_lshlrev_b32 v79, 4, v79
    v_cndmask_b32 v77, v82, v77, vcc
    v_lshlrev_b32 v80, 2, v76
    v_lshlrev_b32 v76, 4, v76
    v_lshlrev_b32 v81, 2, v77
    v_lshlrev_b32 v77, 4, v77
    buffer_load_dword v80, v80, s[68:71], 0 offen
    buffer_load_dword v81, v81, s[68:71], 0 offen
    buffer_load_dwordx4 v[86:89], v76, s[8:11], 0 offen
    buffer_load_dwordx4 v[90:93], v77, s[8:11], 0 offen

    s_waitcnt vmcnt(2)
    v_lshlrev_b32_sdwa v82, 5, v80 dst_sel:DWORD dst_unused:UNUSED_PAD src0_sel:DWORD src1_sel:WORD_0
    v_lshlrev_b32_sdwa v83, 5, v80 dst_sel:DWORD dst_unused:UNUSED_PAD src0_sel:DWORD src1_sel:WORD_1
    v_lshlrev_b32_sdwa v84, 5, v81 dst_sel:DWORD dst_unused:UNUSED_PAD src0_sel:DWORD src1_sel:WORD_0
    v_lshlrev_b32_sdwa v85, 5, v81 dst_sel:DWORD dst_unused:UNUSED_PAD src0_sel:DWORD src1_sel:WORD_1
    buffer_load_dwordx4 v[94:97], v82, s[72:75], 0 offen
    buffer_load_dwordx2 v[110:111], v82, s[72:75], 0 offen offset:16

    buffer_load_dwordx4 v[98:101], v83, s[72:75], 0 offen
    buffer_load_dwordx2 v[112:113], v83, s[72:75], 0 offen offset:16

    buffer_load_dwordx4 v[102:105], v84, s[72:75], 0 offen
    buffer_load_dwordx2 v[114:115], v84, s[72:75], 0 offen offset:16

    buffer_load_dwordx4 v[106:109], v85, s[72:75], 0 offen
    buffer_load_dwordx2 v[116:117], v85, s[72:75], 0 offen offset:16

    s_waitcnt vmcnt(0) lgkmcnt(0)
    s_barrier
    s_branch L_meet_113
L_fend_121:

L_p2done_53:
    s_endpgm

L_ufix_63:
    v_and_b32 v117, 63, v0
    v_lshlrev_b32 v117, 2, v117
    s_sub_i32 s54, s42, 1024
    v_cmp_le_i32 vcc, s54, v117
    s_mov_b64 exec, vcc
    v_mov_b32 v12, 0
    v_mov_b32 v44, 0
    s_mov_b64 exec, -1
    s_sub_i32 s54, s42, 1025
    v_cmp_le_i32 vcc, s54, v117
    s_mov_b64 exec, vcc
    v_mov_b32 v13, 0
    v_mov_b32 v46, 0
    s_mov_b64 exec, -1
    s_sub_i32 s54, s42, 1026
    v_cmp_le_i32 vcc, s54, v117
    s_mov_b64 exec, vcc
    v_mov_b32 v14, 0
    v_mov_b32 v48, 0
    s_mov_b64 exec, -1
    s_sub_i32 s54, s42, 1027
    v_cmp_le_i32 vcc, s54, v117
    s_mov_b64 exec, vcc
    v_mov_b32 v15, 0
    v_mov_b32 v50, 0
    s_mov_b64 exec, -1
    s_branch L_uback_64
L_ufix_65:
    v_and_b32 v117, 63, v0
    v_lshlrev_b32 v117, 2, v117
    s_sub_i32 s54, s42, 1536
    v_cmp_le_i32 vcc, s54, v117
    s_mov_b64 exec, vcc
    v_mov_b32 v16, 0
    v_mov_b32 v52, 0
    s_mov_b64 exec, -1
    s_sub_i32 s54, s42, 1537
    v_cmp_le_i32 vcc, s54, v117
    s_mov_b64 exec, vcc
    v_mov_b32 v17, 0
    v_mov_b32 v54, 0
    s_mov_b64 exec, -1
    s_sub_i32 s54, s42, 1538
    v_cmp_le_i32 vcc, s54, v117
    s_mov_b64 exec, vcc
    v_mov_b32 v18, 0
    v_mov_b32 v56, 0
    s_mov_b64 exec, -1
    s_sub_i32 s54, s42, 1539
    v_cmp_le_i32 vcc, s54, v117
    s_mov_b64 exec, vcc
    v_mov_b32 v19, 0
    v_mov_b32 v58, 0
    s_mov_b64 exec, -1
    s_branch L_uback_66
L_ufix_67:
    v_and_b32 v117, 63, v0
    v_lshlrev_b32 v117, 2, v117
    s_sub_i32 s54, s42, 2048
    v_cmp_le_i32 vcc, s54, v117
    s_mov_b64 exec, vcc
    v_mov_b32 v20, 0
    v_mov_b32 v60, 0
    s_mov_b64 exec, -1
    s_sub_i32 s54, s42, 2049
    v_cmp_le_i32 vcc, s54, v117
    s_mov_b64 exec, vcc
    v_mov_b32 v21, 0
    v_mov_b32 v62, 0
    s_mov_b64 exec, -1
    s_sub_i32 s54, s42, 2050
    v_cmp_le_i32 vcc, s54, v117
    s_mov_b64 exec, vcc
    v_mov_b32 v22, 0
    v_mov_b32 v64, 0
    s_mov_b64 exec, -1
    s_sub_i32 s54, s42, 2051
    v_cmp_le_i32 vcc, s54, v117
    s_mov_b64 exec, vcc
    v_mov_b32 v23, 0
    v_mov_b32 v66, 0
    s_mov_b64 exec, -1
    s_branch L_uback_68
L_ufix_69:
    v_and_b32 v117, 63, v0
    v_lshlrev_b32 v117, 2, v117
    s_sub_i32 s54, s42, 2560
    v_cmp_le_i32 vcc, s54, v117
    s_mov_b64 exec, vcc
    v_mov_b32 v24, 0
    v_mov_b32 v68, 0
    s_mov_b64 exec, -1
    s_sub_i32 s54, s42, 2561
    v_cmp_le_i32 vcc, s54, v117
    s_mov_b64 exec, vcc
    v_mov_b32 v25, 0
    v_mov_b32 v70, 0
    s_mov_b64 exec, -1
    s_sub_i32 s54, s42, 2562
    v_cmp_le_i32 vcc, s54, v117
    s_mov_b64 exec, vcc
    v_mov_b32 v26, 0
    v_mov_b32 v72, 0
    s_mov_b64 exec, -1
    s_sub_i32 s54, s42, 2563
    v_cmp_le_i32 vcc, s54, v117
    s_mov_b64 exec, vcc
    v_mov_b32 v27, 0
    v_mov_b32 v74, 0
    s_mov_b64 exec, -1
    s_branch L_uback_70
L_ufix_71:
    v_and_b32 v117, 63, v0
    v_lshlrev_b32 v117, 2, v117
    s_sub_i32 s54, s42, 0
    v_cmp_le_i32 vcc, s54, v117
    s_mov_b64 exec, vcc
    v_mov_b32 v4, 0
    v_mov_b32 v28, 0
    s_mov_b64 exec, -1
    s_sub_i32 s54, s42, 1
    v_cmp_le_i32 vcc, s54, v117
    s_mov_b64 exec, vcc
    v_mov_b32 v5, 0
    v_mov_b32 v30, 0
    s_mov_b64 exec, -1
    s_sub_i32 s54, s42, 2
    v_cmp_le_i32 vcc, s54, v117
    s_mov_b64 exec, vcc
    v_mov_b32 v6, 0
    v_mov_b32 v32, 0
    s_mov_b64 exec, -1
    s_sub_i32 s54, s42, 3
    v_cmp_le_i32 vcc, s54, v117
    s_mov_b64 exec, vcc
    v_mov_b32 v7, 0
    v_mov_b32 v34, 0
    s_mov_b64 exec, -1
    s_branch L_uback_72
L_ufix_75:
    v_and_b32 v117, 63, v0
    v_lshlrev_b32 v117, 2, v117
    s_sub_i32 s54, s42, 512
    v_cmp_le_i32 vcc, s54, v117
    s_mov_b64 exec, vcc
    v_mov_b32 v8, 0
    v_mov_b32 v36, 0
    s_mov_b64 exec, -1
    s_sub_i32 s54, s42, 513
    v_cmp_le_i32 vcc, s54, v117
    s_mov_b64 exec, vcc
    v_mov_b32 v9, 0
    v_mov_b32 v38, 0
    s_mov_b64 exec, -1
    s_sub_i32 s54, s42, 514
    v_cmp_le_i32 vcc, s54, v117
    s_mov_b64 exec, vcc
    v_mov_b32 v10, 0
    v_mov_b32 v40, 0
    s_mov_b64 exec, -1
    s_sub_i32 s54, s42, 515
    v_cmp_le_i32 vcc, s54, v117
    s_mov_b64 exec, vcc
    v_mov_b32 v11, 0
    v_mov_b32 v42, 0
    s_mov_b64 exec, -1
    s_branch L_uback_76
L_ufix_85:
    v_and_b32 v117, 63, v0
    v_lshlrev_b32 v117, 2, v117
    s_sub_i32 s54, s42, 3072
    v_cmp_le_i32 vcc, s54, v117
    s_mov_b64 exec, vcc
    v_mov_b32 v106, 0
    v_mov_b32 v120, 0
    s_mov_b64 exec, -1
    s_sub_i32 s54, s42, 3073
    v_cmp_le_i32 vcc, s54, v117
    s_mov_b64 exec, vcc
    v_mov_b32 v107, 0
    v_mov_b32 v122, 0
    s_mov_b64 exec, -1
    s_sub_i32 s54, s42, 3074
    v_cmp_le_i32 vcc, s54, v117
    s_mov_b64 exec, vcc
    v_mov_b32 v108, 0
    v_mov_b32 v124, 0
    s_mov_b64 exec, -1
    s_sub_i32 s54, s42, 3075
    v_cmp_le_i32 vcc, s54, v117
    s_mov_b64 exec, vcc
    v_mov_b32 v109, 0
    v_mov_b32 v126, 0
    s_mov_b64 exec, -1
    s_branch L_uback_86
L_ufix_96:
    v_and_b32 v117, 63, v0
    v_lshlrev_b32 v117, 2, v117
    s_sub_i32 s54, s42, 1024
    v_cmp_le_i32 vcc, s54, v117
    s_mov_b64 exec, vcc
    v_mov_b32 v12, 0
    v_mov_b32 v44, 0
    s_mov_b64 exec, -1
    s_sub_i32 s54, s42, 1025
    v_cmp_le_i32 vcc, s54, v117
    s_mov_b64 exec, vcc
    v_mov_b32 v13, 0
    v_mov_b32 v46, 0
    s_mov_b64 exec, -1
    s_sub_i32 s54, s42, 1026
    v_cmp_le_i32 vcc, s54, v117
    s_mov_b64 exec, vcc
    v_mov_b32 v14, 0
    v_mov_b32 v48, 0
    s_mov_b64 exec, -1
    s_sub_i32 s54, s42, 1027
    v_cmp_le_i32 vcc, s54, v117
    s_mov_b64 exec, vcc
    v_mov_b32 v15, 0
    v_mov_b32 v50, 0
    s_mov_b64 exec, -1
    s_branch L_uback_97
L_ufix_99:
    v_and_b32 v117, 63, v0
    v_lshlrev_b32 v117, 2, v117
    s_sub_i32 s54, s42, 1536
    v_cmp_le_i32 vcc, s54, v117
    s_mov_b64 exec, vcc
    v_mov_b32 v16, 0
    v_mov_b32 v52, 0
    s_mov_b64 exec, -1
    s_sub_i32 s54, s42, 1537
    v_cmp_le_i32 vcc, s54, v117
    s_mov_b64 exec, vcc
    v_mov_b32 v17, 0
    v_mov_b32 v54, 0
    s_mov_b64 exec, -1
    s_sub_i32 s54, s42, 1538
    v_cmp_le_i32 vcc, s54, v117
    s_mov_b64 exec, vcc
    v_mov_b32 v18, 0
    v_mov_b32 v56, 0
    s_mov_b64 exec, -1
    s_sub_i32 s54, s42, 1539
    v_cmp_le_i32 vcc, s54, v117
    s_mov_b64 exec, vcc
    v_mov_b32 v19, 0
    v_mov_b32 v58, 0
    s_mov_b64 exec, -1
    s_branch L_uback_100
L_ufix_101:
    v_and_b32 v117, 63, v0
    v_lshlrev_b32 v117, 2, v117
    s_sub_i32 s54, s42, 2048
    v_cmp_le_i32 vcc, s54, v117
    s_mov_b64 exec, vcc
    v_mov_b32 v20, 0
    v_mov_b32 v60, 0
    s_mov_b64 exec, -1
    s_sub_i32 s54, s42, 2049
    v_cmp_le_i32 vcc, s54, v117
    s_mov_b64 exec, vcc
    v_mov_b32 v21, 0
    v_mov_b32 v62, 0
    s_mov_b64 exec, -1
    s_sub_i32 s54, s42, 2050
    v_cmp_le_i32 vcc, s54, v117
    s_mov_b64 exec, vcc
    v_mov_b32 v22, 0
    v_mov_b32 v64, 0
    s_mov_b64 exec, -1
    s_sub_i32 s54, s42, 2051
    v_cmp_le_i32 vcc, s54, v117
    s_mov_b64 exec, vcc
    v_mov_b32 v23, 0
    v_mov_b32 v66, 0
    s_mov_b64 exec, -1
    s_branch L_uback_102
L_ufix_103:
    v_and_b32 v117, 63, v0
    v_lshlrev_b32 v117, 2, v117
    s_sub_i32 s54, s42, 2560
    v_cmp_le_i32 vcc, s54, v117
    s_mov_b64 exec, vcc
    v_mov_b32 v24, 0
    v_mov_b32 v68, 0
    s_mov_b64 exec, -1
    s_sub_i32 s54, s42, 2561
    v_cmp_le_i32 vcc, s54, v117
    s_mov_b64 exec, vcc
    v_mov_b32 v25, 0
    v_mov_b32 v70, 0
    s_mov_b64 exec, -1
    s_sub_i32 s54, s42, 2562
    v_cmp_le_i32 vcc, s54, v117
    s_mov_b64 exec, vcc
    v_mov_b32 v26, 0
    v_mov_b32 v72, 0
    s_mov_b64 exec, -1
    s_sub_i32 s54, s42, 2563
    v_cmp_le_i32 vcc, s54, v117
    s_mov_b64 exec, vcc
    v_mov_b32 v27, 0
    v_mov_b32 v74, 0
    s_mov_b64 exec, -1
    s_branch L_uback_104
L_ufix_107:
    v_and_b32 v117, 63, v0
    v_lshlrev_b32 v117, 2, v117
    s_sub_i32 s54, s42, 0
    v_cmp_le_i32 vcc, s54, v117
    s_mov_b64 exec, vcc
    v_mov_b32 v4, 0
    v_mov_b32 v28, 0
    s_mov_b64 exec, -1
    s_sub_i32 s54, s42, 1
    v_cmp_le_i32 vcc, s54, v117
    s_mov_b64 exec, vcc
    v_mov_b32 v5, 0
    v_mov_b32 v30, 0
    s_mov_b64 exec, -1
    s_sub_i32 s54, s42, 2
    v_cmp_le_i32 vcc, s54, v117
    s_mov_b64 exec, vcc
    v_mov_b32 v6, 0
    v_mov_b32 v32, 0
    s_mov_b64 exec, -1
    s_sub_i32 s54, s42, 3
    v_cmp_le_i32 vcc, s54, v117
    s_mov_b64 exec, vcc
    v_mov_b32 v7, 0
    v_mov_b32 v34, 0
    s_mov_b64 exec, -1
    s_branch L_uback_108
L_ufix_109:
    v_and_b32 v117, 63, v0
    v_lshlrev_b32 v117, 2, v117
    s_sub_i32 s54, s42, 512
    v_cmp_le_i32 vcc, s54, v117
    s_mov_b64 exec, vcc
    v_mov_b32 v8, 0
    v_mov_b32 v36, 0
    s_mov_b64 exec, -1
    s_sub_i32 s54, s42, 513
    v_cmp_le_i32 vcc, s54, v117
    s_mov_b64 exec, vcc
    v_mov_b32 v9, 0
    v_mov_b32 v38, 0
    s_mov_b64 exec, -1
    s_sub_i32 s54, s42, 514
    v_cmp_le_i32 vcc, s54, v117
    s_mov_b64 exec, vcc
    v_mov_b32 v10, 0
    v_mov_b32 v40, 0
    s_mov_b64 exec, -1
    s_sub_i32 s54, s42, 515
    v_cmp_le_i32 vcc, s54, v117
    s_mov_b64 exec, vcc
    v_mov_b32 v11, 0
    v_mov_b32 v42, 0
    s_mov_b64 exec, -1
    s_branch L_uback_110
L_sync_120:
    v_and_b32 v40, 63, v0
    v_lshlrev_b32 v41, 20, v40
    v_mov_b32 v42, s33
    buffer_atomic_add v42, v41, s[80:83], s48 offen sc0
    s_waitcnt vmcnt(0)
    v_readfirstlane_b32 s4, v42
    s_movk_i32 s5, 400
    s_nop 0
    s_add_u32 s4, s4, s33
    s_bitcmp1_b32 s4, 2
    s_cbranch_scc1 L_tell_124
L_poll_122:
    s_sub_u32 s5, s5, 1
    s_cbranch_scc1 L_gave_123
    v_mov_b32 v42, 0
    buffer_atomic_add v42, v41, s[80:83], s48 offen sc0
    s_waitcnt vmcnt(0)
    v_readfirstlane_b32 s4, v42
    s_nop 1
    s_and_b32 s4, s4, 0xff
    s_bitcmp0_b32 s4, 2
    s_cbranch_scc1 L_poll_122
    s_branch L_tell_124
L_gave_123:
    s_cmp_lg_u32 s49, s37
    s_cbranch_scc1 L_gno_126
    v_add_lshl_u32 v40, v40, s28, 4
    s_mov_b32 s5, 0
L_gl_125:
    v_min_u32 v43, 100000, v40
    ds_read_b128 v[44:47], v43 offset:50000
    s_waitcnt lgkmcnt(0)
    buffer_store_dwordx4 v[44:47], v40, s[20:23], 0 offen sc1
    s_waitcnt vmcnt(0)
    v_add_u32 v40, 1024, v40
    s_add_u32 s5, s5, 64
    s_cmp_lt_u32 s5, s29
    s_cbranch_scc1 L_gl_125
L_gno_126:
    s_lshl_b32 s4, 0x100, s37
    v_mov_b32 v42, s4
    buffer_atomic_or v42, v41, s[80:83], s48 offen sc0
    s_waitcnt vmcnt(0)
    v_readfirstlane_b32 s4, v42
    s_nop 1
    s_and_b32 s4, s4, 0xff
    s_bitcmp1_b32 s4, 2
    s_cselect_b32 s4, s4, 0x10000
L_tell_124:
    v_mov_b32 v42, s4
    ds_write_b32 v118, v42
    s_waitcnt lgkmcnt(0)
    s_branch L_bcast_115

L_own_127:
    ds_read_b128 v[36:39], v78 offset:50000
    ds_read_b128 v[52:55], v79 offset:50000
    s_branch L_obk_128

L_own_129:
    ds_read_b128 v[40:43], v78 offset:50000
    ds_read_b128 v[56:59], v79 offset:50000
    s_branch L_obk_130

L_own_131:
    ds_read_b128 v[44:47], v78 offset:50000
    ds_read_b128 v[60:63], v79 offset:50000
    s_branch L_obk_132

L_own_133:
    ds_read_b128 v[48:51], v78 offset:50000
    ds_read_b128 v[64:67], v79 offset:50000
    s_branch L_obk_134

L_fgen_135:
    v_lshlrev_b32 v82, 1, v76
    v_lshlrev_b32 v83, 1, v77
    v_mov_b32 v4, 0
    v_mov_b32 v5, 0
    v_mov_b32 v6, 0
    v_mov_b32 v7, 0
    v_mov_b32 v8, 0
    v_mov_b32 v9, 0
    v_mov_b32 v10, 0
    v_mov_b32 v11, 0
    v_mov_b32 v12, 0
    v_mov_b32 v13, 0
    v_mov_b32 v14, 0
    v_mov_b32 v15, 0
    v_mov_b32 v16, 0
    v_mov_b32 v17, 0
    v_mov_b32 v18, 0
    v_mov_b32 v19, 0
    s_bitcmp1_b32 s35, 4
    s_cbranch_scc1 L_ffl_137
    v_cvt_f32_u32_sdwa v20, v36 dst_sel:DWORD dst_unused:UNUSED_PAD src0_sel:WORD_0
    v_cvt_f32_u32_sdwa v21, v36 dst_sel:DWORD dst_unused:UNUSED_PAD src0_sel:WORD_1
    v_cvt_f32_u32_sdwa v22, v37 dst_sel:DWORD dst_unused:UNUSED_PAD src0_sel:WORD_0
    v_cvt_f32_u32_sdwa v23, v37 dst_sel:DWORD dst_unused:UNUSED_PAD src0_sel:WORD_1
    v_cvt_f32_u32_sdwa v24, v38 dst_sel:DWORD dst_unused:UNUSED_PAD src0_sel:WORD_0
    v_cvt_f32_u32_sdwa v25, v38 dst_sel:DWORD dst_unused:UNUSED_PAD src0_sel:WORD_1
    v_cvt_f32_u32_sdwa v26, v39 dst_sel:DWORD dst_unused:UNUSED_PAD src0_sel:WORD_0
    v_cvt_f32_u32_sdwa v27, v39 dst_sel:DWORD dst_unused:UNUSED_PAD src0_sel:WORD_1
    v_cvt_f32_u32_sdwa v28, v52 dst_sel:DWORD dst_unused:UNUSED_PAD src0_sel:WORD_0
    v_cvt_f32_u32_sdwa v29, v52 dst_sel:DWORD dst_unused:UNUSED_PAD src0_sel:WORD_1
    v_cvt_f32_u32_sdwa v30, v53 dst_sel:DWORD dst_unused:UNUSED_PAD src0_sel:WORD_0
    v_cvt_f32_u32_sdwa v31, v53 dst_sel:DWORD dst_unused:UNUSED_PAD src0_sel:WORD_1
    v_cvt_f32_u32_sdwa v32, v54 dst_sel:DWORD dst_unused:UNUSED_PAD src0_sel:WORD_0
    v_cvt_f32_u32_sdwa v33, v54 dst_sel:DWORD dst_unused:UNUSED_PAD src0_sel:WORD_1
    v_cvt_f32_u32_sdwa v34, v55 dst_sel:DWORD dst_unused:UNUSED_PAD src0_sel:WORD_0
    v_cvt_f32_u32_sdwa v35, v55 dst_sel:DWORD dst_unused:UNUSED_PAD src0_sel:WORD_1
    v_add_f32 v20, 0xc6800000, v20
    v_fmac_f32 v4, s34, v20
    v_add_f32 v21, 0xc6800000, v21
    v_fmac_f32 v5, s34, v21
    v_add_f32 v22, 0xc6800000, v22
    v_fmac_f32 v6, s34, v22
    v_add_f32 v23, 0xc6800000, v23
    v_fmac_f32 v7, s34, v23
    v_add_f32 v24, 0xc6800000, v24
    v_fmac_f32 v8, s34, v24
    v_add_f32 v25, 0xc6800000, v25
    v_fmac_f32 v9, s34, v25
    v_add_f32 v26, 0xc6800000, v26
    v_fmac_f32 v10, s34, v26
    v_add_f32 v27, 0xc6800000, v27
    v_fmac_f32 v11, s34, v27
    v_add_f32 v28, 0xc6800000, v28
    v_fmac_f32 v12, s34, v28
    v_add_f32 v29, 0xc6800000, v29
    v_fmac_f32 v13, s34, v29
    v_add_f32 v30, 0xc6800000, v30
    v_fmac_f32 v14, s34, v30
    v_add_f32 v31, 0xc6800000, v31
    v_fmac_f32 v15, s34, v31
    v_add_f32 v32, 0xc6800000, v32
    v_fmac_f32 v16, s34, v32
    v_add_f32 v33, 0xc6800000, v33
    v_fmac_f32 v17, s34, v33
    v_add_f32 v34, 0xc6800000, v34
    v_fmac_f32 v18, s34, v34
    v_add_f32 v35, 0xc6800000, v35
    v_fmac_f32 v19, s34, v35
    s_branch L_fnx_138
L_ffl_137:
    s_mov_b32 s3, 25600000
    buffer_load_dwordx4 v[20:23], v82, s[84:87], s3 offen offset:0 sc1
    buffer_load_dwordx4 v[24:27], v82, s[84:87], s3 offen offset:16 sc1
    buffer_load_dwordx4 v[28:31], v83, s[84:87], s3 offen offset:0 sc1
    buffer_load_dwordx4 v[32:35], v83, s[84:87], s3 offen offset:16 sc1
    s_waitcnt vmcnt(0)
    v_add_f32 v4, v4, v20
    v_add_f32 v5, v5, v21
    v_add_f32 v6, v6, v22
    v_add_f32 v7, v7, v23
    v_add_f32 v8, v8, v24
    v_add_f32 v9, v9, v25
    v_add_f32 v10, v10, v26
    v_add_f32 v11, v11, v27
    v_add_f32 v12, v12, v28
    v_add_f32 v13, v13, v29
    v_add_f32 v14, v14, v30
    v_add_f32 v15, v15, v31
    v_add_f32 v16, v16, v32
    v_add_f32 v17, v17, v33
    v_add_f32 v18, v18, v34
    v_add_f32 v19, v19, v35
L_fnx_138:
    s_bitcmp1_b32 s35, 5
    s_cbranch_scc1 L_ffl_139
    v_cvt_f32_u32_sdwa v20, v40 dst_sel:DWORD dst_unused:UNUSED_PAD src0_sel:WORD_0
    v_cvt_f32_u32_sdwa v21, v40 dst_sel:DWORD dst_unused:UNUSED_PAD src0_sel:WORD_1
    v_cvt_f32_u32_sdwa v22, v41 dst_sel:DWORD dst_unused:UNUSED_PAD src0_sel:WORD_0
    v_cvt_f32_u32_sdwa v23, v41 dst_sel:DWORD dst_unused:UNUSED_PAD src0_sel:WORD_1
    v_cvt_f32_u32_sdwa v24, v42 dst_sel:DWORD dst_unused:UNUSED_PAD src0_sel:WORD_0
    v_cvt_f32_u32_sdwa v25, v42 dst_sel:DWORD dst_unused:UNUSED_PAD src0_sel:WORD_1
    v_cvt_f32_u32_sdwa v26, v43 dst_sel:DWORD dst_unused:UNUSED_PAD src0_sel:WORD_0
    v_cvt_f32_u32_sdwa v27, v43 dst_sel:DWORD dst_unused:UNUSED_PAD src0_sel:WORD_1
    v_cvt_f32_u32_sdwa v28, v56 dst_sel:DWORD dst_unused:UNUSED_PAD src0_sel:WORD_0
    v_cvt_f32_u32_sdwa v29, v56 dst_sel:DWORD dst_unused:UNUSED_PAD src0_sel:WORD_1
    v_cvt_f32_u32_sdwa v30, v57 dst_sel:DWORD dst_unused:UNUSED_PAD src0_sel:WORD_0
    v_cvt_f32_u32_sdwa v31, v57 dst_sel:DWORD dst_unused:UNUSED_PAD src0_sel:WORD_1
    v_cvt_f32_u32_sdwa v32, v58 dst_sel:DWORD dst_unused:UNUSED_PAD src0_sel:WORD_0
    v_cvt_f32_u32_sdwa v33, v58 dst_sel:DWORD dst_unused:UNUSED_PAD src0_sel:WORD_1
    v_cvt_f32_u32_sdwa v34, v59 dst_sel:DWORD dst_unused:UNUSED_PAD src0_sel:WORD_0
    v_cvt_f32_u32_sdwa v35, v59 dst_sel:DWORD dst_unused:UNUSED_PAD src0_sel:WORD_1
    v_add_f32 v20, 0xc6800000, v20
    v_fmac_f32 v4, s34, v20
    v_add_f32 v21, 0xc6800000, v21
    v_fmac_f32 v5, s34, v21
    v_add_f32 v22, 0xc6800000, v22
    v_fmac_f32 v6, s34, v22
    v_add_f32 v23, 0xc6800000, v23
    v_fmac_f32 v7, s34, v23
    v_add_f32 v24, 0xc6800000, v24
    v_fmac_f32 v8, s34, v24
    v_add_f32 v25, 0xc6800000, v25
    v_fmac_f32 v9, s34, v25
    v_add_f32 v26, 0xc6800000, v26
    v_fmac_f32 v10, s34, v26
    v_add_f32 v27, 0xc6800000, v27
    v_fmac_f32 v11, s34, v27
    v_add_f32 v28, 0xc6800000, v28
    v_fmac_f32 v12, s34, v28
    v_add_f32 v29, 0xc6800000, v29
    v_fmac_f32 v13, s34, v29
    v_add_f32 v30, 0xc6800000, v30
    v_fmac_f32 v14, s34, v30
    v_add_f32 v31, 0xc6800000, v31
    v_fmac_f32 v15, s34, v31
    v_add_f32 v32, 0xc6800000, v32
    v_fmac_f32 v16, s34, v32
    v_add_f32 v33, 0xc6800000, v33
    v_fmac_f32 v17, s34, v33
    v_add_f32 v34, 0xc6800000, v34
    v_fmac_f32 v18, s34, v34
    v_add_f32 v35, 0xc6800000, v35
    v_fmac_f32 v19, s34, v35
    s_branch L_fnx_140
L_ffl_139:
    s_mov_b32 s3, 38400000
    buffer_load_dwordx4 v[20:23], v82, s[84:87], s3 offen offset:0 sc1
    buffer_load_dwordx4 v[24:27], v82, s[84:87], s3 offen offset:16 sc1
    buffer_load_dwordx4 v[28:31], v83, s[84:87], s3 offen offset:0 sc1
    buffer_load_dwordx4 v[32:35], v83, s[84:87], s3 offen offset:16 sc1
    s_waitcnt vmcnt(0)
    v_add_f32 v4, v4, v20
    v_add_f32 v5, v5, v21
    v_add_f32 v6, v6, v22
    v_add_f32 v7, v7, v23
    v_add_f32 v8, v8, v24
    v_add_f32 v9, v9, v25
    v_add_f32 v10, v10, v26
    v_add_f32 v11, v11, v27
    v_add_f32 v12, v12, v28
    v_add_f32 v13, v13, v29
    v_add_f32 v14, v14, v30
    v_add_f32 v15, v15, v31
    v_add_f32 v16, v16, v32
    v_add_f32 v17, v17, v33
    v_add_f32 v18, v18, v34
    v_add_f32 v19, v19, v35
L_fnx_140:
    s_bitcmp1_b32 s35, 6
    s_cbranch_scc1 L_ffl_141
    v_cvt_f32_u32_sdwa v20, v44 dst_sel:DWORD dst_unused:UNUSED_PAD src0_sel:WORD_0
    v_cvt_f32_u32_sdwa v21, v44 dst_sel:DWORD dst_unused:UNUSED_PAD src0_sel:WORD_1
    v_cvt_f32_u32_sdwa v22, v45 dst_sel:DWORD dst_unused:UNUSED_PAD src0_sel:WORD_0
    v_cvt_f32_u32_sdwa v23, v45 dst_sel:DWORD dst_unused:UNUSED_PAD src0_sel:WORD_1
    v_cvt_f32_u32_sdwa v24, v46 dst_sel:DWORD dst_unused:UNUSED_PAD src0_sel:WORD_0
    v_cvt_f32_u32_sdwa v25, v46 dst_sel:DWORD dst_unused:UNUSED_PAD src0_sel:WORD_1
    v_cvt_f32_u32_sdwa v26, v47 dst_sel:DWORD dst_unused:UNUSED_PAD src0_sel:WORD_0
    v_cvt_f32_u32_sdwa v27, v47 dst_sel:DWORD dst_unused:UNUSED_PAD src0_sel:WORD_1
    v_cvt_f32_u32_sdwa v28, v60 dst_sel:DWORD dst_unused:UNUSED_PAD src0_sel:WORD_0
    v_cvt_f32_u32_sdwa v29, v60 dst_sel:DWORD dst_unused:UNUSED_PAD src0_sel:WORD_1
    v_cvt_f32_u32_sdwa v30, v61 dst_sel:DWORD dst_unused:UNUSED_PAD src0_sel:WORD_0
    v_cvt_f32_u32_sdwa v31, v61 dst_sel:DWORD dst_unused:UNUSED_PAD src0_sel:WORD_1
    v_cvt_f32_u32_sdwa v32, v62 dst_sel:DWORD dst_unused:UNUSED_PAD src0_sel:WORD_0
    v_cvt_f32_u32_sdwa v33, v62 dst_sel:DWORD dst_unused:UNUSED_PAD src0_sel:WORD_1
    v_cvt_f32_u32_sdwa v34, v63 dst_sel:DWORD dst_unused:UNUSED_PAD src0_sel:WORD_0
    v_cvt_f32_u32_sdwa v35, v63 dst_sel:DWORD dst_unused:UNUSED_PAD src0_sel:WORD_1
    v_add_f32 v20, 0xc6800000, v20
    v_fmac_f32 v4, s34, v20
    v_add_f32 v21, 0xc6800000, v21
    v_fmac_f32 v5, s34, v21
    v_add_f32 v22, 0xc6800000, v22
    v_fmac_f32 v6, s34, v22
    v_add_f32 v23, 0xc6800000, v23
    v_fmac_f32 v7, s34, v23
    v_add_f32 v24, 0xc6800000, v24
    v_fmac_f32 v8, s34, v24
    v_add_f32 v25, 0xc6800000, v25
    v_fmac_f32 v9, s34, v25
    v_add_f32 v26, 0xc6800000, v26
    v_fmac_f32 v10, s34, v26
    v_add_f32 v27, 0xc6800000, v27
    v_fmac_f32 v11, s34, v27
    v_add_f32 v28, 0xc6800000, v28
    v_fmac_f32 v12, s34, v28
    v_add_f32 v29, 0xc6800000, v29
    v_fmac_f32 v13, s34, v29
    v_add_f32 v30, 0xc6800000, v30
    v_fmac_f32 v14, s34, v30
    v_add_f32 v31, 0xc6800000, v31
    v_fmac_f32 v15, s34, v31
    v_add_f32 v32, 0xc6800000, v32
    v_fmac_f32 v16, s34, v32
    v_add_f32 v33, 0xc6800000, v33
    v_fmac_f32 v17, s34, v33
    v_add_f32 v34, 0xc6800000, v34
    v_fmac_f32 v18, s34, v34
    v_add_f32 v35, 0xc6800000, v35
    v_fmac_f32 v19, s34, v35
    s_branch L_fnx_142
L_ffl_141:
    s_mov_b32 s3, 51200000
    buffer_load_dwordx4 v[20:23], v82, s[84:87], s3 offen offset:0 sc1
    buffer_load_dwordx4 v[24:27], v82, s[84:87], s3 offen offset:16 sc1
    buffer_load_dwordx4 v[28:31], v83, s[84:87], s3 offen offset:0 sc1
    buffer_load_dwordx4 v[32:35], v83, s[84:87], s3 offen offset:16 sc1
    s_waitcnt vmcnt(0)
    v_add_f32 v4, v4, v20
    v_add_f32 v5, v5, v21
    v_add_f32 v6, v6, v22
    v_add_f32 v7, v7, v23
    v_add_f32 v8, v8, v24
    v_add_f32 v9, v9, v25
    v_add_f32 v10, v10, v26
    v_add_f32 v11, v11, v27
    v_add_f32 v12, v12, v28
    v_add_f32 v13, v13, v29
    v_add_f32 v14, v14, v30
    v_add_f32 v15, v15, v31
    v_add_f32 v16, v16, v32
    v_add_f32 v17, v17, v33
    v_add_f32 v18, v18, v34
    v_add_f32 v19, v19, v35
L_fnx_142:
    s_bitcmp1_b32 s35, 7
    s_cbranch_scc1 L_ffl_143
    v_cvt_f32_u32_sdwa v20, v48 dst_sel:DWORD dst_unused:UNUSED_PAD src0_sel:WORD_0
    v_cvt_f32_u32_sdwa v21, v48 dst_sel:DWORD dst_unused:UNUSED_PAD src0_sel:WORD_1
    v_cvt_f32_u32_sdwa v22, v49 dst_sel:DWORD dst_unused:UNUSED_PAD src0_sel:WORD_0
    v_cvt_f32_u32_sdwa v23, v49 dst_sel:DWORD dst_unused:UNUSED_PAD src0_sel:WORD_1
    v_cvt_f32_u32_sdwa v24, v50 dst_sel:DWORD dst_unused:UNUSED_PAD src0_sel:WORD_0
    v_cvt_f32_u32_sdwa v25, v50 dst_sel:DWORD dst_unused:UNUSED_PAD src0_sel:WORD_1
    v_cvt_f32_u32_sdwa v26, v51 dst_sel:DWORD dst_unused:UNUSED_PAD src0_sel:WORD_0
    v_cvt_f32_u32_sdwa v27, v51 dst_sel:DWORD dst_unused:UNUSED_PAD src0_sel:WORD_1
    v_cvt_f32_u32_sdwa v28, v64 dst_sel:DWORD dst_unused:UNUSED_PAD src0_sel:WORD_0
    v_cvt_f32_u32_sdwa v29, v64 dst_sel:DWORD dst_unused:UNUSED_PAD src0_sel:WORD_1
    v_cvt_f32_u32_sdwa v30, v65 dst_sel:DWORD dst_unused:UNUSED_PAD src0_sel:WORD_0
    v_cvt_f32_u32_sdwa v31, v65 dst_sel:DWORD dst_unused:UNUSED_PAD src0_sel:WORD_1
    v_cvt_f32_u32_sdwa v32, v66 dst_sel:DWORD dst_unused:UNUSED_PAD src0_sel:WORD_0
    v_cvt_f32_u32_sdwa v33, v66 dst_sel:DWORD dst_unused:UNUSED_PAD src0_sel:WORD_1
    v_cvt_f32_u32_sdwa v34, v67 dst_sel:DWORD dst_unused:UNUSED_PAD src0_sel:WORD_0
    v_cvt_f32_u32_sdwa v35, v67 dst_sel:DWORD dst_unused:UNUSED_PAD src0_sel:WORD_1
    v_add_f32 v20, 0xc6800000, v20
    v_fmac_f32 v4, s34, v20
    v_add_f32 v21, 0xc6800000, v21
    v_fmac_f32 v5, s34, v21
    v_add_f32 v22, 0xc6800000, v22
    v_fmac_f32 v6, s34, v22
    v_add_f32 v23, 0xc6800000, v23
    v_fmac_f32 v7, s34, v23
    v_add_f32 v24, 0xc6800000, v24
    v_fmac_f32 v8, s34, v24
    v_add_f32 v25, 0xc6800000, v25
    v_fmac_f32 v9, s34, v25
    v_add_f32 v26, 0xc6800000, v26
    v_fmac_f32 v10, s34, v26
    v_add_f32 v27, 0xc6800000, v27
    v_fmac_f32 v11, s34, v27
    v_add_f32 v28, 0xc6800000, v28
    v_fmac_f32 v12, s34, v28
    v_add_f32 v29, 0xc6800000, v29
    v_fmac_f32 v13, s34, v29
    v_add_f32 v30, 0xc6800000, v30
    v_fmac_f32 v14, s34, v30
    v_add_f32 v31, 0xc6800000, v31
    v_fmac_f32 v15, s34, v31
    v_add_f32 v32, 0xc6800000, v32
    v_fmac_f32 v16, s34, v32
    v_add_f32 v33, 0xc6800000, v33
    v_fmac_f32 v17, s34, v33
    v_add_f32 v34, 0xc6800000, v34
    v_fmac_f32 v18, s34, v34
    v_add_f32 v35, 0xc6800000, v35
    v_fmac_f32 v19, s34, v35
    s_branch L_fnx_144
L_ffl_143:
    s_mov_b32 s3, 64000000
    buffer_load_dwordx4 v[20:23], v82, s[84:87], s3 offen offset:0 sc1
    buffer_load_dwordx4 v[24:27], v82, s[84:87], s3 offen offset:16 sc1
    buffer_load_dwordx4 v[28:31], v83, s[84:87], s3 offen offset:0 sc1
    buffer_load_dwordx4 v[32:35], v83, s[84:87], s3 offen offset:16 sc1
    s_waitcnt vmcnt(0)
    v_add_f32 v4, v4, v20
    v_add_f32 v5, v5, v21
    v_add_f32 v6, v6, v22
    v_add_f32 v7, v7, v23
    v_add_f32 v8, v8, v24
    v_add_f32 v9, v9, v25
    v_add_f32 v10, v10, v26
    v_add_f32 v11, v11, v27
    v_add_f32 v12, v12, v28
    v_add_f32 v13, v13, v29
    v_add_f32 v14, v14, v30
    v_add_f32 v15, v15, v31
    v_add_f32 v16, v16, v32
    v_add_f32 v17, v17, v33
    v_add_f32 v18, v18, v34
    v_add_f32 v19, v19, v35
L_fnx_144:
    s_branch L_fbk_136
L_p2slow_54:
    s_waitcnt vmcnt(0) lgkmcnt(0)
    s_mov_b32 s51, 0
    s_movk_i32 s43, 6250
L_sweep_145:
    s_barrier

    v_mov_b32 v28, 0x0
    v_mov_b32 v29, 0x0
    v_mov_b32 v30, 0x0
    v_mov_b32 v31, 0x0
    v_add_u32 v32, 50000, v3
    v_add_u32 v33, 65536, v32

    ds_write_b128 v32, v[28:31] offset:0
    ds_write_b128 v32, v[28:31] offset:16384
    ds_write_b128 v32, v[28:31] offset:32768
    ds_write_b128 v32, v[28:31] offset:49152
    ds_write_b128 v33, v[28:31] offset:0
    ds_write_b128 v33, v[28:31] offset:16384
    v_cmp_gt_u32 vcc, 971, v0
    s_mov_b64 exec, vcc
    ds_write_b128 v33, v[28:31] offset:32768
    s_mov_b64 exec, -1
    s_mov_b32 s3, 32768
    s_load_dword s40, s[6:7], s3
    s_waitcnt lgkmcnt(0)
    s_barrier
    s_cmp_lg_u32 s40, 0
    s_cbranch_scc1 L_raw_150
    s_sub_u32 s38, s4, 8
L_sbatch_146:
    s_lshl_b32 s52, s36, 5
    s_add_u32 s52, s52, s38
    s_lshr_b32 s52, s52, 1
    s_lshl_b32 s52, s52, 2
    s_load_dword s40, s[46:47], s52
    s_mul_i32 s50, s38, 200000
    s_and_b32 s3, s38, 1
    s_lshl_b32 s3, s3, 4
    s_or_b32 s3, s3, 0x100000
    s_waitcnt lgkmcnt(0)
    s_bfe_u32 s40, s40, s3

    s_min_u32 s40, s40, 6524
    s_lshl_b32 s52, s38, 6
    s_add_u32 s52, s52, s36
    s_mul_i32 s52, s52, 32764
    s_and_b32 s52, s52, 0xffffff80
    s_add_u32 s20, s44, s52
    s_addc_u32 s21, s45, 0
    s_mul_i32 s52, s40, 5
    s_add_u32 s52, s52, 3
    s_and_b32 s22, s52, -4

    s_lshr_b32 s55, s39, 2
    s_add_u32 s55, s55, 0
    v_and_b32 v36, 63, v0
    v_add_u32 v36, s55, v36
L_left_151:
    s_cmp_ge_u32 s55, s40
    s_cbranch_scc1 L_leftend_152
    v_mul_u32_u24 v37, 5, v36
    buffer_load_dword v38, v37, s[20:23], 0 offen offset:1
    buffer_load_ubyte v39, v37, s[20:23], 0 offen
    s_waitcnt vmcnt(0)

    v_perm_b32 v37, v39, v38, s24
    v_lshrrev_b32 v42, 30, v38
    v_and_b32 v37, 0x1fff, v37
    v_mul_u32_u24 v42, 6250, v42
    v_add_lshl_u32 v37, v37, v42, 3

    buffer_load_dwordx2 v[40:41], v37, s[8:11], s50 offen
    v_cmp_gt_u32 vcc, s40, v36
    s_waitcnt vmcnt(0)

    v_bfe_u32 v44, v38, 16, 14
    v_subrev_u32 v44, s51, v44
    v_cmp_gt_u32 s[64:65], s43, v44
    s_and_b64 exec, vcc, s[64:65]
    v_lshlrev_b32 v45, 16, v38
    v_cmpx_ne_u32 vcc, 0, v45
    v_lshlrev_b32 v44, 4, v44
    v_bfe_i32 v38, v38, 0, 16
    v_cvt_f32_i32 v38, v38
    v_mul_f32 v38, 0x38004020, v38
    v_lshlrev_b32 v45, 16, v40
    v_and_b32 v46, s32, v40
    v_lshlrev_b32 v47, 16, v41
    v_and_b32 v48, s32, v41

    v_mul_f32 v45, v45, v38
    ds_add_f32 v44, v45 offset:50000
    v_mul_f32 v46, v46, v38
    ds_add_f32 v44, v46 offset:50004
    v_mul_f32 v47, v47, v38
    ds_add_f32 v44, v47 offset:50008
    v_mul_f32 v48, v48, v38
    ds_add_f32 v44, v48 offset:50012
    s_mov_b64 exec, -1
    v_add_u32 v36, 128, v36
    s_add_u32 s55, s55, 128
    s_branch L_left_151
L_leftend_152:

    s_add_u32 s38, s38, 1
    s_cmp_lt_u32 s38, s4
    s_cbranch_scc1 L_sbatch_146
    s_branch L_swend_148

L_raw_150:
    s_load_dwordx2 s[68:69], s[0:1], 8
    s_load_dwordx2 s[72:73], s[0:1], 16
    s_load_dwordx2 s[76:77], s[0:1], 32
    s_load_dwordx2 s[80:81], s[0:1], 48
    s_mov_b32 s70, 204800000
    s_mov_b32 s71, 0x20000
    s_mov_b32 s74, 204800000
    s_mov_b32 s75, 0x20000
    s_mov_b32 s78, 102400000
    s_mov_b32 s79, 0x20000
    s_waitcnt lgkmcnt(0)
    s_load_dword s82, s[80:81], 0
    s_mul_i32 s83, s36, 12500
    s_add_u32 s83, s83, s51
    s_mul_i32 s84, s37, 200000
    s_mov_b32 s85, 200000
    s_mov_b32 s38, 0
    v_lshlrev_b32 v44, 5, v0
    v_mov_b32 v45, 0.15915494
    s_waitcnt lgkmcnt(0)
    s_lshl_b32 s82, s82, 16
    v_mul_f32 v45, s82, v45
L_rawl_147:
    s_lshr_b32 s3, s38, 1
    buffer_load_dwordx4 v[46:49], v44, s[72:75], s38 offen
    buffer_load_dwordx4 v[50:53], v44, s[72:75], s38 offen offset:16
    buffer_load_dwordx4 v[54:57], v44, s[68:71], s38 offen
    buffer_load_dwordx4 v[58:61], v44, s[68:71], s38 offen offset:16
    buffer_load_dwordx4 v[62:65], v3, s[76:79], s3 offen
    s_waitcnt vmcnt(1)

    v_subrev_u32 v46, s83, v46
    v_subrev_u32 v82, s84, v54
    v_cmp_gt_u32 vcc, s43, v46
    v_cmp_gt_u32 s[64:65], s85, v82
    v_lshlrev_b32 v54, 3, v54
    s_nand_b64 exec, vcc, s[64:65]
    v_bfrev_b32 v54, 1
    s_mov_b64 exec, -1
    buffer_load_dwordx2 v[66:67], v54, s[8:11], 0 offen

    v_subrev_u32 v47, s83, v47
    v_subrev_u32 v82, s84, v55
    v_cmp_gt_u32 vcc, s43, v47
    v_cmp_gt_u32 s[64:65], s85, v82
    v_lshlrev_b32 v55, 3, v55
    s_nand_b64 exec, vcc, s[64:65]
    v_bfrev_b32 v55, 1
    s_mov_b64 exec, -1
    buffer_load_dwordx2 v[68:69], v55, s[8:11], 0 offen

    v_subrev_u32 v48, s83, v48
    v_subrev_u32 v82, s84, v56
    v_cmp_gt_u32 vcc, s43, v48
    v_cmp_gt_u32 s[64:65], s85, v82
    v_lshlrev_b32 v56, 3, v56
    s_nand_b64 exec, vcc, s[64:65]
    v_bfrev_b32 v56, 1
    s_mov_b64 exec, -1
    buffer_load_dwordx2 v[70:71], v56, s[8:11], 0 offen

    v_subrev_u32 v49, s83, v49
    v_subrev_u32 v82, s84, v57
    v_cmp_gt_u32 vcc, s43, v49
    v_cmp_gt_u32 s[64:65], s85, v82
    v_lshlrev_b32 v57, 3, v57
    s_nand_b64 exec, vcc, s[64:65]
    v_bfrev_b32 v57, 1
    s_mov_b64 exec, -1
    buffer_load_dwordx2 v[72:73], v57, s[8:11], 0 offen

    v_subrev_u32 v50, s83, v50
    v_subrev_u32 v82, s84, v58
    v_cmp_gt_u32 vcc, s43, v50
    v_cmp_gt_u32 s[64:65], s85, v82
    v_lshlrev_b32 v58, 3, v58
    s_nand_b64 exec, vcc, s[64:65]
    v_bfrev_b32 v58, 1
    s_mov_b64 exec, -1
    buffer_load_dwordx2 v[74:75], v58, s[8:11], 0 offen

    v_subrev_u32 v51, s83, v51
    v_subrev_u32 v82, s84, v59
    v_cmp_gt_u32 vcc, s43, v51
    v_cmp_gt_u32 s[64:65], s85, v82
    v_lshlrev_b32 v59, 3, v59
    s_nand_b64 exec, vcc, s[64:65]
    v_bfrev_b32 v59, 1
    s_mov_b64 exec, -1
    buffer_load_dwordx2 v[76:77], v59, s[8:11], 0 offen

    v_subrev_u32 v52, s83, v52
    v_subrev_u32 v82, s84, v60
    v_cmp_gt_u32 vcc, s43, v52
    v_cmp_gt_u32 s[64:65], s85, v82
    v_lshlrev_b32 v60, 3, v60
    s_nand_b64 exec, vcc, s[64:65]
    v_bfrev_b32 v60, 1
    s_mov_b64 exec, -1
    buffer_load_dwordx2 v[78:79], v60, s[8:11], 0 offen

    v_subrev_u32 v53, s83, v53
    v_subrev_u32 v82, s84, v61
    v_cmp_gt_u32 vcc, s43, v53
    v_cmp_gt_u32 s[64:65], s85, v82
    v_lshlrev_b32 v61, 3, v61
    s_nand_b64 exec, vcc, s[64:65]
    v_bfrev_b32 v61, 1
    s_mov_b64 exec, -1
    buffer_load_dwordx2 v[80:81], v61, s[8:11], 0 offen

    s_waitcnt vmcnt(0)
    v_cmp_le_i32 vcc, 0, v54
    s_mov_b64 exec, vcc
    s_cbranch_execz L_rsk_153
    v_lshlrev_b32 v82, 16, v62
    v_mul_f32 v82, v82, v45
    v_fract_f32 v82, v82
    v_cos_f32 v82, v82
    v_lshlrev_b32 v46, 4, v46
    v_lshlrev_b32 v83, 16, v66
    v_and_b32 v84, s32, v66
    v_lshlrev_b32 v85, 16, v67
    v_and_b32 v86, s32, v67

    v_mul_f32 v83, v83, v82
    ds_add_f32 v46, v83 offset:50000
    v_mul_f32 v84, v84, v82
    ds_add_f32 v46, v84 offset:50004
    v_mul_f32 v85, v85, v82
    ds_add_f32 v46, v85 offset:50008
    v_mul_f32 v86, v86, v82
    ds_add_f32 v46, v86 offset:50012
L_rsk_153:
    s_mov_b64 exec, -1
    v_cmp_le_i32 vcc, 0, v55
    s_mov_b64 exec, vcc
    s_cbranch_execz L_rsk_154
    v_and_b32 v82, s32, v62
    v_mul_f32 v82, v82, v45
    v_fract_f32 v82, v82
    v_cos_f32 v82, v82
    v_lshlrev_b32 v47, 4, v47
    v_lshlrev_b32 v83, 16, v68
    v_and_b32 v84, s32, v68
    v_lshlrev_b32 v85, 16, v69
    v_and_b32 v86, s32, v69

    v_mul_f32 v83, v83, v82
    ds_add_f32 v47, v83 offset:50000
    v_mul_f32 v84, v84, v82
    ds_add_f32 v47, v84 offset:50004
    v_mul_f32 v85, v85, v82
    ds_add_f32 v47, v85 offset:50008
    v_mul_f32 v86, v86, v82
    ds_add_f32 v47, v86 offset:50012
L_rsk_154:
    s_mov_b64 exec, -1
    v_cmp_le_i32 vcc, 0, v56
    s_mov_b64 exec, vcc
    s_cbranch_execz L_rsk_155
    v_lshlrev_b32 v82, 16, v63
    v_mul_f32 v82, v82, v45
    v_fract_f32 v82, v82
    v_cos_f32 v82, v82
    v_lshlrev_b32 v48, 4, v48
    v_lshlrev_b32 v83, 16, v70
    v_and_b32 v84, s32, v70
    v_lshlrev_b32 v85, 16, v71
    v_and_b32 v86, s32, v71

    v_mul_f32 v83, v83, v82
    ds_add_f32 v48, v83 offset:50000
    v_mul_f32 v84, v84, v82
    ds_add_f32 v48, v84 offset:50004
    v_mul_f32 v85, v85, v82
    ds_add_f32 v48, v85 offset:50008
    v_mul_f32 v86, v86, v82
    ds_add_f32 v48, v86 offset:50012
L_rsk_155:
    s_mov_b64 exec, -1
    v_cmp_le_i32 vcc, 0, v57
    s_mov_b64 exec, vcc
    s_cbranch_execz L_rsk_156
    v_and_b32 v82, s32, v63
    v_mul_f32 v82, v82, v45
    v_fract_f32 v82, v82
    v_cos_f32 v82, v82
    v_lshlrev_b32 v49, 4, v49
    v_lshlrev_b32 v83, 16, v72
    v_and_b32 v84, s32, v72
    v_lshlrev_b32 v85, 16, v73
    v_and_b32 v86, s32, v73

    v_mul_f32 v83, v83, v82
    ds_add_f32 v49, v83 offset:50000
    v_mul_f32 v84, v84, v82
    ds_add_f32 v49, v84 offset:50004
    v_mul_f32 v85, v85, v82
    ds_add_f32 v49, v85 offset:50008
    v_mul_f32 v86, v86, v82
    ds_add_f32 v49, v86 offset:50012
L_rsk_156:
    s_mov_b64 exec, -1
    v_cmp_le_i32 vcc, 0, v58
    s_mov_b64 exec, vcc
    s_cbranch_execz L_rsk_157
    v_lshlrev_b32 v82, 16, v64
    v_mul_f32 v82, v82, v45
    v_fract_f32 v82, v82
    v_cos_f32 v82, v82
    v_lshlrev_b32 v50, 4, v50
    v_lshlrev_b32 v83, 16, v74
    v_and_b32 v84, s32, v74
    v_lshlrev_b32 v85, 16, v75
    v_and_b32 v86, s32, v75

    v_mul_f32 v83, v83, v82
    ds_add_f32 v50, v83 offset:50000
    v_mul_f32 v84, v84, v82
    ds_add_f32 v50, v84 offset:50004
    v_mul_f32 v85, v85, v82
    ds_add_f32 v50, v85 offset:50008
    v_mul_f32 v86, v86, v82
    ds_add_f32 v50, v86 offset:50012
L_rsk_157:
    s_mov_b64 exec, -1
    v_cmp_le_i32 vcc, 0, v59
    s_mov_b64 exec, vcc
    s_cbranch_execz L_rsk_158
    v_and_b32 v82, s32, v64
    v_mul_f32 v82, v82, v45
    v_fract_f32 v82, v82
    v_cos_f32 v82, v82
    v_lshlrev_b32 v51, 4, v51
    v_lshlrev_b32 v83, 16, v76
    v_and_b32 v84, s32, v76
    v_lshlrev_b32 v85, 16, v77
    v_and_b32 v86, s32, v77

    v_mul_f32 v83, v83, v82
    ds_add_f32 v51, v83 offset:50000
    v_mul_f32 v84, v84, v82
    ds_add_f32 v51, v84 offset:50004
    v_mul_f32 v85, v85, v82
    ds_add_f32 v51, v85 offset:50008
    v_mul_f32 v86, v86, v82
    ds_add_f32 v51, v86 offset:50012
L_rsk_158:
    s_mov_b64 exec, -1
    v_cmp_le_i32 vcc, 0, v60
    s_mov_b64 exec, vcc
    s_cbranch_execz L_rsk_159
    v_lshlrev_b32 v82, 16, v65
    v_mul_f32 v82, v82, v45
    v_fract_f32 v82, v82
    v_cos_f32 v82, v82
    v_lshlrev_b32 v52, 4, v52
    v_lshlrev_b32 v83, 16, v78
    v_and_b32 v84, s32, v78
    v_lshlrev_b32 v85, 16, v79
    v_and_b32 v86, s32, v79

    v_mul_f32 v83, v83, v82
    ds_add_f32 v52, v83 offset:50000
    v_mul_f32 v84, v84, v82
    ds_add_f32 v52, v84 offset:50004
    v_mul_f32 v85, v85, v82
    ds_add_f32 v52, v85 offset:50008
    v_mul_f32 v86, v86, v82
    ds_add_f32 v52, v86 offset:50012
L_rsk_159:
    s_mov_b64 exec, -1
    v_cmp_le_i32 vcc, 0, v61
    s_mov_b64 exec, vcc
    s_cbranch_execz L_rsk_160
    v_and_b32 v82, s32, v65
    v_mul_f32 v82, v82, v45
    v_fract_f32 v82, v82
    v_cos_f32 v82, v82
    v_lshlrev_b32 v53, 4, v53
    v_lshlrev_b32 v83, 16, v80
    v_and_b32 v84, s32, v80
    v_lshlrev_b32 v85, 16, v81
    v_and_b32 v86, s32, v81

    v_mul_f32 v83, v83, v82
    ds_add_f32 v53, v83 offset:50000
    v_mul_f32 v84, v84, v82
    ds_add_f32 v53, v84 offset:50004
    v_mul_f32 v85, v85, v82
    ds_add_f32 v53, v85 offset:50008
    v_mul_f32 v86, v86, v82
    ds_add_f32 v53, v86 offset:50012
L_rsk_160:
    s_mov_b64 exec, -1
    s_add_u32 s38, s38, 32768
    s_cmp_lt_u32 s38, 204800000
    s_cbranch_scc1 L_rawl_147
L_swend_148:
    s_waitcnt lgkmcnt(0)
    s_barrier
    s_mul_i32 s3, s37, 800000
    s_mul_i32 s5, s36, 12500
    s_add_u32 s3, s3, s5
    s_add_u32 s3, s3, s51
    s_lshl_b32 s3, s3, 4
    s_add_u32 s3, s3, 34496512

    s_add_u32 s20, s6, s3
    s_addc_u32 s21, s7, 0
    s_mov_b32 s22, 100000
    s_mov_b32 s23, 0x20000
    v_mov_b32 v36, v3
    s_mov_b32 s38, 0
L_wl_149:
    v_min_u32 v37, 100000, v36
    ds_read_b128 v[28:31], v37 offset:50000
    s_waitcnt lgkmcnt(0)
    buffer_store_dwordx4 v[28:31], v36, s[20:23], 0 offen sc1
    s_waitcnt vmcnt(0)
    v_add_u32 v36, 16384, v36
    s_add_u32 s38, s38, 1024
    s_cmp_lt_u32 s38, 6250
    s_cbranch_scc1 L_wl_149
    s_add_u32 s51, s51, 6250
    s_cmp_lt_u32 s51, 12500
    s_cbranch_scc1 L_sweep_145
    s_lshl_b32 s33, 16, s37
    s_add_u32 s33, s33, 1
    s_branch L_fin_112

.section .rodata,"a"
.p2align 6
.amdhsa_kernel g1_kernel
  .amdhsa_next_free_vgpr 128
  .amdhsa_next_free_sgpr 102
  .amdhsa_accum_offset 128
  .amdhsa_group_segment_fixed_size 0
  .amdhsa_kernarg_size 112
  .amdhsa_user_sgpr_count 2
  .amdhsa_user_sgpr_kernarg_segment_ptr 1
  .amdhsa_system_sgpr_workgroup_id_x 1
  .amdhsa_float_denorm_mode_32 3
.end_amdhsa_kernel
.p2align 6
.amdhsa_kernel standalone__molecular_angular_gemnet__graph_kernel
  .amdhsa_next_free_vgpr 128
  .amdhsa_next_free_sgpr 102
  .amdhsa_accum_offset 128
  .amdhsa_group_segment_fixed_size 0
  .amdhsa_kernarg_size 112
  .amdhsa_user_sgpr_count 2
  .amdhsa_user_sgpr_kernarg_segment_ptr 1
  .amdhsa_system_sgpr_workgroup_id_x 1
  .amdhsa_float_denorm_mode_32 3
.end_amdhsa_kernel
```
